```python
import torch

def _softmax(x, axis=-1):
    return torch.softmax(x, dim=axis)
def _gelu(x):
    return torch.nn.functional.gelu(x, approximate="tanh")
def _silu(x):
    return torch.nn.functional.silu(x)
def _sigmoid(x):
    return torch.sigmoid(x)
def _layernorm(x, axis=-1, eps=1e-5):
    m = x.mean(dim=axis, keepdim=True)
    v = x.var(dim=axis, keepdim=True, unbiased=False)
    return (x - m) / torch.sqrt(v + eps)
def _scatter_add(tgt, idx, src, axis=0):
    return tgt.clone().index_add_(axis, idx, src)
def _segment_sum(src, seg, n):
    out = torch.zeros((n,) + src.shape[1:], dtype=src.dtype)
    return out.index_add_(0, seg, src)
def _pad(x, pw):
    flat = tuple(v for pair in reversed(pw) for v in pair)
    return torch.nn.functional.pad(x, flat)

kernel_name = 'interleave_layers__ssm_conv_h3__mixer_s_mlp__prompt'

def setup_inputs():

    _w = (lambda a: (lambda t: t.to(torch.bfloat16) if t.is_floating_point() else t)(torch.as_tensor(a)))
    def _A_setup():
        B, S, D = 1, 2048, 1024
        ks = 4
        return {
            "q": _w((lambda *s: torch.randn(*s, dtype=torch.bfloat16) * 0.05)(B, S, D)),
            "k": _w((lambda *s: torch.randn(*s, dtype=torch.bfloat16) * 0.4)(B, S, D)),
            "v": _w((lambda *s: torch.randn(*s, dtype=torch.bfloat16) * 0.4)(B, S, D)),
            "shift_k": _w((lambda *s: torch.randn(*s, dtype=torch.bfloat16) * 0.4)(D, ks) * 0.5),
            "ssm_k": _w((lambda *s: torch.randn(*s, dtype=torch.bfloat16) * 0.4)(D, S) * (1.0 / S ** 0.5)),
            "ssm_D": _w((lambda *s: torch.randn(*s, dtype=torch.bfloat16) * 0.4)(D)),
        }
    _A_in = _A_setup()

    def _B_setup():
        B, S, D, F = 1, 2048, 1024, 3584
        return {
            "x":  _w((lambda *s: torch.randn(*s, dtype=torch.bfloat16) * 0.05)(B, S, D)),
            "w1": _w((lambda *s: torch.randn(*s, dtype=torch.bfloat16) * 1.6)(D, D) * (D ** -0.5)),
            "w2": _w((lambda *s: torch.randn(*s, dtype=torch.bfloat16) * 1.6)(D, D) * (D ** -0.5)),
            "w3": _w((lambda *s: torch.randn(*s, dtype=torch.bfloat16) * 1.6)(D, F) * (D ** -0.5)),
            "w4": _w((lambda *s: torch.randn(*s, dtype=torch.bfloat16) * 1.6)(F, D) * (F ** -0.5)),
        }
    _B_in = _B_setup()

    return {
        "A_q": _A_in["q"],
        "A_k": _A_in["k"],
        "A_v": _A_in["v"],
        "A_shift_k": _A_in["shift_k"],
        "A_ssm_k": _A_in["ssm_k"],
        "A_ssm_D": _A_in["ssm_D"],
        "B_x": _B_in["x"],
        "B_w1": _B_in["w1"],
        "B_w2": _B_in["w2"],
        "B_w3": _B_in["w3"],
        "B_w4": _B_in["w4"],
    }

def reference(A_q, A_k, A_v, A_shift_k, A_ssm_k, A_ssm_D, B_x, B_w1, B_w2, B_w3, B_w4):
    def _A_ref(q, k, v, shift_k, ssm_k, ssm_D):
        B, S, D = q.shape
        ks = shift_k.shape[-1]
        k_pad = _pad(k, ((0, 0), (ks - 1, 0), (0, 0)))
        k_shift = torch.zeros_like(k)
        for t in range(ks):
            k_shift = k_shift + k_pad[:, t:t + S, :] * shift_k[:, ks - 1 - t][None, None, :]
        kv = k_shift * v
        L = 2 * S
        kv_pad = _pad(kv, ((0, 0), (0, S), (0, 0)))
        kf_pad = _pad(ssm_k, ((0, 0), (0, S)))
        kv_f = (lambda x, axes=(-2,-1): torch.fft.rfft2(x.float(), dim=axes))(kv_pad[:, None, :, :], axes=(1, 2))
        kf_f = (lambda x, axes=(-2,-1): torch.fft.rfft2(x.float(), dim=axes))(kf_pad[:, None, :], axes=(1, 2))
        kf_f = (lambda x, *d: x.permute(*d))(kf_f, 1, 2, 0)
        y_f = kv_f * kf_f[None, :, :, :]
        y = (lambda x, s, axes=(-2,-1): torch.fft.irfft2(x, s=s, dim=axes).to(torch.bfloat16))(y_f, (1, L), axes=(1, 2))[:, 0, :S, :]
        y = y + kv * ssm_D[None, None, :]
        return q * y

    def _B_ref(x, w1, w2, w3, w4):
        B, S, D = x.shape
        h = _gelu(_layernorm(x, axis=-1) @ w1)
        c = D // 4
        g0 = _pad(h[:, :, 0*c:1*c], ((0, 0), (1, 0), (0, 0)))[:, :S, :]
        g1 = _pad(h[:, :, 1*c:2*c], ((0, 0), (0, 1), (0, 0)))[:, 1:, :]
        g2 = _pad(h[:, :, 2*c:3*c], ((0, 0), (2, 0), (0, 0)))[:, :S, :]
        g3 = _pad(h[:, :, 3*c:   ], ((0, 0), (0, 2), (0, 0)))[:, 2:, :]
        hs = torch.concatenate([g0, g1, g2, g3], axis=-1) @ w2
        x1 = x + hs
        h2 = _gelu(_layernorm(x1, axis=-1) @ w3) @ w4
        return x1 + h2

    x = A_q
    x = x + _A_ref(_layernorm(x, axis=-1), A_k, A_v, A_shift_k, A_ssm_k, A_ssm_D)
    x = x + _B_ref(_layernorm(x, axis=-1), B_w1, B_w2, B_w3, B_w4)
    x = x + _A_ref(_layernorm(x, axis=-1), A_k, A_v, A_shift_k, A_ssm_k, A_ssm_D)
    x = x + _B_ref(_layernorm(x, axis=-1), B_w1, B_w2, B_w3, B_w4)
    return x
```

```asm
; @launch grid=(256,1,1) block=(512,1,1) lds=163840
.amdgcn_target "amdgcn-amd-amdhsa--gfx950"
.text
.globl interleave_layers__ssm_conv_h3__mixer_s_mlp__prompt_kernel
.p2align 8
.type interleave_layers__ssm_conv_h3__mixer_s_mlp__prompt_kernel,@function
interleave_layers__ssm_conv_h3__mixer_s_mlp__prompt_kernel:
    s_cmp_ge_u32 s2, 256
    s_cbranch_scc1 K_end
    s_load_dwordx8 s[8:15], s[0:1], 8
    s_load_dwordx2 s[6:7], s[0:1], 0
    s_load_dwordx8 s[68:75], s[0:1], 56
    s_load_dwordx2 s[4:5], s[0:1], 104
    s_load_dwordx2 s[84:85], s[0:1], 96
    s_memrealtime s[46:47]
    v_lshrrev_b32 v1, 6, v0
    s_nop 0
    v_readfirstlane_b32 s30, v1
    s_getpc_b64 s[48:49]
K_pc:
    s_lshr_b32 s36, s2, 3
    s_lshl_b32 s36, s36, 11
    v_lshlrev_b32 v4, 2, v0
    v_add_u32 v4, s36, v4
    v_cmp_gt_u32 vcc, K_end-K_pc-8, v4
    s_nop 0
    s_and_saveexec_b64 s[36:37], vcc
    s_cbranch_execz K_3
    v_mov_b32 v5, s49
    v_add_co_u32 v4, vcc, s48, v4
    s_nop 1
    v_addc_co_u32 v5, vcc, 0, v5, vcc
    global_load_dword v250, v[4:5], off
K_3:
    s_mov_b64 exec, -1
    v_and_b32 v6, 31, v0
    v_lshrrev_b32 v7, 5, v0
    s_and_b32 s34, s2, 7
    s_lshr_b32 s35, s2, 3
    s_lshl_b32 s36, s35, 17
    s_lshl_b32 s37, s34, 8
    s_add_u32 s36, s36, s37
    v_lshlrev_b32 v8, 13, v7
    v_lshl_add_u32 v8, v6, 3, v8
    v_add_u32 v12, s36, v8
    v_add_u32 v14, 4096, v12
    s_mov_b32 s18, 4194304
    s_mov_b32 s19, 0x20000
    s_mov_b32 s22, s18
    s_mov_b32 s23, s19
    s_waitcnt lgkmcnt(0)
    s_mov_b32 s86, 256
    s_mov_b32 s87, 0x20000
    v_mov_b32 v78, 0
    s_lshl_b32 s45, s2, 3
    s_add_u32 s45, s45, s30
    s_cmp_lg_u32 s45, 4
    s_cbranch_scc1 KV_t0
    s_lshl_b32 s44, s46, 6
    s_or_b32 s44, s44, 1
    v_mov_b32 v76, s44
    s_mov_b64 exec, 1
    buffer_store_dword v76, v78, s[84:87], 0 offen sc1
    s_mov_b64 exec, -1
KV_t0:
    s_mov_b64 s[16:17], s[8:9]
    s_mov_b64 s[20:21], s[10:11]
    buffer_load_dwordx2 v[28:29], v12, s[16:19], 0 offen offset:0 nt
    buffer_load_dwordx2 v[30:31], v12, s[16:19], 0 offen offset:2048 nt
    buffer_load_dwordx2 v[32:33], v14, s[16:19], 0 offen offset:0 nt
    buffer_load_dwordx2 v[34:35], v14, s[16:19], 0 offen offset:2048 nt
    buffer_load_dwordx2 v[36:37], v12, s[20:23], 0 offen offset:0 nt
    buffer_load_dwordx2 v[38:39], v12, s[20:23], 0 offen offset:2048 nt
    buffer_load_dwordx2 v[40:41], v14, s[20:23], 0 offen offset:0 nt
    buffer_load_dwordx2 v[42:43], v14, s[20:23], 0 offen offset:2048 nt
    v_subrev_u32 v9, 6144, v12
    v_subrev_u32 v10, 4096, v12
    v_subrev_u32 v11, 2048, v12
    s_lshl_b32 s37, s34, 10
    v_lshlrev_b32 v16, 5, v6
    v_add_u32 v16, s37, v16
    s_mov_b32 s24, s12
    s_mov_b32 s25, s13
    s_mov_b32 s26, 0x2000
    s_mov_b32 s27, 0x20000
    buffer_load_dwordx4 v[44:47], v16, s[24:27], 0 offen offset:0
    buffer_load_dwordx4 v[48:51], v16, s[24:27], 0 offen offset:16
    buffer_load_dwordx2 v[22:23], v9, s[16:19], 0 offen nt
    buffer_load_dwordx2 v[24:25], v10, s[16:19], 0 offen nt
    buffer_load_dwordx2 v[26:27], v11, s[16:19], 0 offen nt
    v_and_b32 v1, 63, v0
    v_lshlrev_b32 v2, 4, v1
    v_lshlrev_b32 v3, 2, v1
    s_and_b32 s32, s2, 7
    s_lshr_b32 s33, s2, 3
    s_and_b32 s28, s32, 2
    s_lshr_b32 s34, s32, 2
    s_or_b32 s28, s28, s34
    s_lshl_b32 s28, s28, 2
    s_and_b32 s34, s33, 3
    s_add_u32 s28, s28, s34
    s_and_b32 s31, s32, 1
    s_lshr_b32 s33, s33, 2
    s_lshl_b32 s29, s31, 3
    s_add_u32 s29, s29, s33
    s_lshl_b32 s67, s33, 1
    s_and_b32 s67, s67, 0
    s_mov_b32 s60, 0
    s_mov_b32 s61, 40000
    s_mov_b32 s52, 0
    s_mov_b32 s55, 0
    s_mov_b32 s92, 0
    s_mov_b32 s93, 0
    s_mov_b32 s94, 0
    s_mov_b32 s56, s4
    s_mov_b32 s57, s5
    s_mov_b32 s58, 0xa000000
    s_mov_b32 s59, 0x20000
    v_and_b32 v179, 7, v0
    v_lshrrev_b32 v204, 6, v0
    v_lshlrev_b32 v204, 4, v204
    v_bfe_u32 v205, v0, 3, 3
    v_add_u32 v204, v204, v205
    s_lshr_b32 s78, s29, 1
    s_lshl_b32 s78, s78, 16
    s_and_b32 s79, s29, 1
    s_lshl_b32 s79, s79, 7
    s_add_u32 s78, s78, s79
    s_lshr_b32 s79, s30, 1
    s_lshl_b32 s79, s79, 13
    s_add_u32 s78, s78, s79
    v_lshlrev_b32 v176, 8, v204
    v_lshl_add_u32 v176, v179, 4, v176
    v_add_u32 v176, s78, v176
    s_lshl_b32 s78, s28, 7
    s_lshl_b32 s79, s29, 3
    s_add_u32 s78, s78, s79
    v_add_u32 v177, s78, v179
    v_lshlrev_b32 v178, 11, v177
    v_lshrrev_b32 v205, 2, v204
    v_lshlrev_b32 v205, 3, v205
    v_and_b32 v204, 3, v204
    v_add_u32 v204, v204, v205
    v_lshl_add_u32 v178, v204, 3, v178
    v_lshlrev_b32 v177, 3, v177
    v_lshl_add_u32 v177, v204, 14, v177
    s_add_u32 s62, s4, 33554432
    s_addc_u32 s63, s5, 0
    s_and_b32 s41, s30, 3
    s_and_b32 s38, s2, 7
    s_lshl_b32 s38, s38, 5
    s_lshr_b32 s39, s2, 3
    s_add_u32 s38, s38, s39
    s_lshl_b32 s39, s38, 2
    s_add_u32 s39, s39, s41
    s_mul_i32 s40, s41, 24576
    s_lshl_b32 s36, s39, 12
    s_add_u32 s12, s14, s36
    s_addc_u32 s13, s15, 0
    s_mov_b32 s14, 4096
    s_mov_b32 s15, 0x20000
    s_lshr_b32 s45, s30, 2
    s_lshl_b32 s45, s45, 11
    s_add_u32 s36, s45, 0xffffffc0
    v_add_u32 v70, s36, v2
    v_add_u32 v71, 16, v70
    s_add_u32 s36, s45, 0x3c0
    v_add_u32 v72, s36, v2
    v_add_u32 v73, 16, v72
    s_mov_b32 s36, 4032
    v_add_u32 v74, s36, v2
    v_add_u32 v75, 16, v74
    s_mov_b32 s8, s6
    s_mov_b32 s9, s7
    s_mov_b32 s10, 0x400000
    s_mov_b32 s11, 0x20000
    s_and_b32 s34, s2, 7
    s_lshr_b32 s35, s2, 3
    v_mov_b32 v80, 0
    v_mov_b32 v81, 0
    v_mov_b32 v82, 0
    v_mov_b32 v83, 0
    v_add_u32 v86, s40, v2
    ds_write_b128 v86, v[80:83] offset:22784
    s_bfm_b64 exec, 26, 0
    ds_write_b128 v86, v[80:83] offset:23808
    s_mov_b64 exec, -1
    v_lshlrev_b32 v8, 2, v7
    v_sub_u32 v8, 60, v8
    v_lshrrev_b32 v85, 3, v8
    v_bfe_u32 v84, v6, 1, 3
    v_xor_b32 v85, v85, v84
    v_lshlrev_b32 v85, 4, v85
    v_and_b32 v8, 7, v8
    v_lshl_add_u32 v85, v8, 1, v85
    v_lshl_add_u32 v84, v6, 9, v85
    v_add_u32 v84, 98304, v84
    s_waitcnt vmcnt(0)
    s_cmp_lg_u32 s30, 4
    s_cbranch_scc1 KV_t1
    buffer_load_dword v76, v78, s[84:87], 0 offen sc1
KV_t1:
    buffer_load_dwordx4 v[52:55], v70, s[12:15], 0 offen nt
    buffer_load_dwordx2 v[56:57], v71, s[12:15], 0 offen nt
    buffer_load_dwordx4 v[58:61], v72, s[12:15], 0 offen nt
    buffer_load_dwordx2 v[62:63], v73, s[12:15], 0 offen nt
    buffer_load_dwordx4 v[64:67], v74, s[12:15], 0 offen nt
    buffer_load_dwordx2 v[68:69], v75, s[12:15], 0 offen nt
    buffer_load_dwordx2 v[180:181], v178, s[8:11], 0 offen offset:0 nt
    buffer_load_dwordx2 v[182:183], v178, s[8:11], 0 offen offset:32 nt
    buffer_load_dwordx2 v[184:185], v178, s[8:11], 0 offen offset:128 nt
    buffer_load_dwordx2 v[186:187], v178, s[8:11], 0 offen offset:160 nt
    v_lshlrev_b32 v88, 16, v44
    v_and_b32 v90, 0xffff0000, v44
    v_lshlrev_b32 v92, 16, v45
    v_and_b32 v94, 0xffff0000, v45
    v_lshlrev_b32 v89, 16, v46
    v_and_b32 v91, 0xffff0000, v46
    v_lshlrev_b32 v93, 16, v47
    v_and_b32 v95, 0xffff0000, v47
    v_lshlrev_b32 v96, 16, v22
    v_and_b32 v97, 0xffff0000, v22
    v_lshlrev_b32 v98, 16, v24
    v_and_b32 v99, 0xffff0000, v24
    v_lshlrev_b32 v100, 16, v26
    v_and_b32 v101, 0xffff0000, v26
    v_lshlrev_b32 v102, 16, v28
    v_and_b32 v103, 0xffff0000, v28
    v_lshlrev_b32 v104, 16, v30
    v_and_b32 v105, 0xffff0000, v30
    v_lshlrev_b32 v106, 16, v32
    v_and_b32 v107, 0xffff0000, v32
    v_lshlrev_b32 v108, 16, v34
    v_and_b32 v109, 0xffff0000, v34
    v_lshlrev_b32 v110, 16, v36
    v_and_b32 v111, 0xffff0000, v36
    v_lshlrev_b32 v112, 16, v38
    v_and_b32 v113, 0xffff0000, v38
    v_lshlrev_b32 v114, 16, v40
    v_and_b32 v115, 0xffff0000, v40
    v_lshlrev_b32 v116, 16, v42
    v_and_b32 v117, 0xffff0000, v42
    v_pk_mul_f32 v[118:119], v[96:97], v[94:95]
    v_pk_mul_f32 v[120:121], v[98:99], v[94:95]
    v_pk_mul_f32 v[122:123], v[100:101], v[94:95]
    v_pk_mul_f32 v[124:125], v[102:103], v[94:95]
    v_cvt_pk_bf16_f32 v144, v118, v119
    v_cvt_pk_bf16_f32 v145, v120, v121
    v_cvt_pk_bf16_f32 v146, v122, v123
    v_cvt_pk_bf16_f32 v147, v124, v125
    v_lshlrev_b32 v118, 16, v144
    v_and_b32 v119, 0xffff0000, v144
    v_lshlrev_b32 v120, 16, v145
    v_and_b32 v121, 0xffff0000, v145
    v_lshlrev_b32 v122, 16, v146
    v_and_b32 v123, 0xffff0000, v146
    v_lshlrev_b32 v124, 16, v147
    v_and_b32 v125, 0xffff0000, v147
    v_pk_mul_f32 v[126:127], v[98:99], v[92:93]
    v_pk_mul_f32 v[128:129], v[100:101], v[92:93]
    v_pk_mul_f32 v[130:131], v[102:103], v[92:93]
    v_pk_mul_f32 v[132:133], v[104:105], v[92:93]
    v_cvt_pk_bf16_f32 v144, v126, v127
    v_cvt_pk_bf16_f32 v145, v128, v129
    v_cvt_pk_bf16_f32 v146, v130, v131
    v_cvt_pk_bf16_f32 v147, v132, v133
    v_lshlrev_b32 v126, 16, v144
    v_and_b32 v127, 0xffff0000, v144
    v_lshlrev_b32 v128, 16, v145
    v_and_b32 v129, 0xffff0000, v145
    v_lshlrev_b32 v130, 16, v146
    v_and_b32 v131, 0xffff0000, v146
    v_lshlrev_b32 v132, 16, v147
    v_and_b32 v133, 0xffff0000, v147
    v_pk_add_f32 v[118:119], v[118:119], v[126:127]
    v_pk_add_f32 v[120:121], v[120:121], v[128:129]
    v_pk_add_f32 v[122:123], v[122:123], v[130:131]
    v_pk_add_f32 v[124:125], v[124:125], v[132:133]
    v_cvt_pk_bf16_f32 v144, v118, v119
    v_cvt_pk_bf16_f32 v145, v120, v121
    v_cvt_pk_bf16_f32 v146, v122, v123
    v_cvt_pk_bf16_f32 v147, v124, v125
    v_lshlrev_b32 v118, 16, v144
    v_and_b32 v119, 0xffff0000, v144
    v_lshlrev_b32 v120, 16, v145
    v_and_b32 v121, 0xffff0000, v145
    v_lshlrev_b32 v122, 16, v146
    v_and_b32 v123, 0xffff0000, v146
    v_lshlrev_b32 v124, 16, v147
    v_and_b32 v125, 0xffff0000, v147
    v_pk_mul_f32 v[126:127], v[100:101], v[90:91]
    v_pk_mul_f32 v[128:129], v[102:103], v[90:91]
    v_pk_mul_f32 v[130:131], v[104:105], v[90:91]
    v_pk_mul_f32 v[132:133], v[106:107], v[90:91]
    v_cvt_pk_bf16_f32 v144, v126, v127
    v_cvt_pk_bf16_f32 v145, v128, v129
    v_cvt_pk_bf16_f32 v146, v130, v131
    v_cvt_pk_bf16_f32 v147, v132, v133
    v_lshlrev_b32 v126, 16, v144
    v_and_b32 v127, 0xffff0000, v144
    v_lshlrev_b32 v128, 16, v145
    v_and_b32 v129, 0xffff0000, v145
    v_lshlrev_b32 v130, 16, v146
    v_and_b32 v131, 0xffff0000, v146
    v_lshlrev_b32 v132, 16, v147
    v_and_b32 v133, 0xffff0000, v147
    v_pk_add_f32 v[118:119], v[118:119], v[126:127]
    v_pk_add_f32 v[120:121], v[120:121], v[128:129]
    v_pk_add_f32 v[122:123], v[122:123], v[130:131]
    v_pk_add_f32 v[124:125], v[124:125], v[132:133]
    v_cvt_pk_bf16_f32 v144, v118, v119
    v_cvt_pk_bf16_f32 v145, v120, v121
    v_cvt_pk_bf16_f32 v146, v122, v123
    v_cvt_pk_bf16_f32 v147, v124, v125
    v_lshlrev_b32 v118, 16, v144
    v_and_b32 v119, 0xffff0000, v144
    v_lshlrev_b32 v120, 16, v145
    v_and_b32 v121, 0xffff0000, v145
    v_lshlrev_b32 v122, 16, v146
    v_and_b32 v123, 0xffff0000, v146
    v_lshlrev_b32 v124, 16, v147
    v_and_b32 v125, 0xffff0000, v147
    v_pk_mul_f32 v[126:127], v[102:103], v[88:89]
    v_pk_mul_f32 v[128:129], v[104:105], v[88:89]
    v_pk_mul_f32 v[130:131], v[106:107], v[88:89]
    v_pk_mul_f32 v[132:133], v[108:109], v[88:89]
    v_cvt_pk_bf16_f32 v144, v126, v127
    v_cvt_pk_bf16_f32 v145, v128, v129
    v_cvt_pk_bf16_f32 v146, v130, v131
    v_cvt_pk_bf16_f32 v147, v132, v133
    v_lshlrev_b32 v126, 16, v144
    v_and_b32 v127, 0xffff0000, v144
    v_lshlrev_b32 v128, 16, v145
    v_and_b32 v129, 0xffff0000, v145
    v_lshlrev_b32 v130, 16, v146
    v_and_b32 v131, 0xffff0000, v146
    v_lshlrev_b32 v132, 16, v147
    v_and_b32 v133, 0xffff0000, v147
    v_pk_add_f32 v[118:119], v[118:119], v[126:127]
    v_pk_add_f32 v[120:121], v[120:121], v[128:129]
    v_pk_add_f32 v[122:123], v[122:123], v[130:131]
    v_pk_add_f32 v[124:125], v[124:125], v[132:133]
    v_cvt_pk_bf16_f32 v144, v118, v119
    v_cvt_pk_bf16_f32 v145, v120, v121
    v_cvt_pk_bf16_f32 v146, v122, v123
    v_cvt_pk_bf16_f32 v147, v124, v125
    v_lshlrev_b32 v118, 16, v144
    v_and_b32 v119, 0xffff0000, v144
    v_lshlrev_b32 v120, 16, v145
    v_and_b32 v121, 0xffff0000, v145
    v_lshlrev_b32 v122, 16, v146
    v_and_b32 v123, 0xffff0000, v146
    v_lshlrev_b32 v124, 16, v147
    v_and_b32 v125, 0xffff0000, v147
    v_pk_mul_f32 v[118:119], v[118:119], v[110:111]
    v_pk_mul_f32 v[120:121], v[120:121], v[112:113]
    v_pk_mul_f32 v[122:123], v[122:123], v[114:115]
    v_pk_mul_f32 v[124:125], v[124:125], v[116:117]
    v_cvt_pk_bf16_f32 v136, v124, v122
    v_cvt_pk_bf16_f32 v137, v120, v118
    ds_write_b64 v84, v[136:137] offset:0
    v_cvt_pk_bf16_f32 v138, v125, v123
    v_cvt_pk_bf16_f32 v139, v121, v119
    ds_write_b64 v84, v[138:139] offset:128
    v_lshlrev_b32 v88, 16, v48
    v_and_b32 v90, 0xffff0000, v48
    v_lshlrev_b32 v92, 16, v49
    v_and_b32 v94, 0xffff0000, v49
    v_lshlrev_b32 v89, 16, v50
    v_and_b32 v91, 0xffff0000, v50
    v_lshlrev_b32 v93, 16, v51
    v_and_b32 v95, 0xffff0000, v51
    v_lshlrev_b32 v96, 16, v23
    v_and_b32 v97, 0xffff0000, v23
    v_lshlrev_b32 v98, 16, v25
    v_and_b32 v99, 0xffff0000, v25
    v_lshlrev_b32 v100, 16, v27
    v_and_b32 v101, 0xffff0000, v27
    v_lshlrev_b32 v102, 16, v29
    v_and_b32 v103, 0xffff0000, v29
    v_lshlrev_b32 v104, 16, v31
    v_and_b32 v105, 0xffff0000, v31
    v_lshlrev_b32 v106, 16, v33
    v_and_b32 v107, 0xffff0000, v33
    v_lshlrev_b32 v108, 16, v35
    v_and_b32 v109, 0xffff0000, v35
    v_lshlrev_b32 v110, 16, v37
    v_and_b32 v111, 0xffff0000, v37
    v_lshlrev_b32 v112, 16, v39
    v_and_b32 v113, 0xffff0000, v39
    v_lshlrev_b32 v114, 16, v41
    v_and_b32 v115, 0xffff0000, v41
    v_lshlrev_b32 v116, 16, v43
    v_and_b32 v117, 0xffff0000, v43
    v_pk_mul_f32 v[118:119], v[96:97], v[94:95]
    v_pk_mul_f32 v[120:121], v[98:99], v[94:95]
    v_pk_mul_f32 v[122:123], v[100:101], v[94:95]
    v_pk_mul_f32 v[124:125], v[102:103], v[94:95]
    v_cvt_pk_bf16_f32 v144, v118, v119
    v_cvt_pk_bf16_f32 v145, v120, v121
    v_cvt_pk_bf16_f32 v146, v122, v123
    v_cvt_pk_bf16_f32 v147, v124, v125
    v_lshlrev_b32 v118, 16, v144
    v_and_b32 v119, 0xffff0000, v144
    v_lshlrev_b32 v120, 16, v145
    v_and_b32 v121, 0xffff0000, v145
    v_lshlrev_b32 v122, 16, v146
    v_and_b32 v123, 0xffff0000, v146
    v_lshlrev_b32 v124, 16, v147
    v_and_b32 v125, 0xffff0000, v147
    v_pk_mul_f32 v[126:127], v[98:99], v[92:93]
    v_pk_mul_f32 v[128:129], v[100:101], v[92:93]
    v_pk_mul_f32 v[130:131], v[102:103], v[92:93]
    v_pk_mul_f32 v[132:133], v[104:105], v[92:93]
    v_cvt_pk_bf16_f32 v144, v126, v127
    v_cvt_pk_bf16_f32 v145, v128, v129
    v_cvt_pk_bf16_f32 v146, v130, v131
    v_cvt_pk_bf16_f32 v147, v132, v133
    v_lshlrev_b32 v126, 16, v144
    v_and_b32 v127, 0xffff0000, v144
    v_lshlrev_b32 v128, 16, v145
    v_and_b32 v129, 0xffff0000, v145
    v_lshlrev_b32 v130, 16, v146
    v_and_b32 v131, 0xffff0000, v146
    v_lshlrev_b32 v132, 16, v147
    v_and_b32 v133, 0xffff0000, v147
    v_pk_add_f32 v[118:119], v[118:119], v[126:127]
    v_pk_add_f32 v[120:121], v[120:121], v[128:129]
    v_pk_add_f32 v[122:123], v[122:123], v[130:131]
    v_pk_add_f32 v[124:125], v[124:125], v[132:133]
    v_cvt_pk_bf16_f32 v144, v118, v119
    v_cvt_pk_bf16_f32 v145, v120, v121
    v_cvt_pk_bf16_f32 v146, v122, v123
    v_cvt_pk_bf16_f32 v147, v124, v125
    v_lshlrev_b32 v118, 16, v144
    v_and_b32 v119, 0xffff0000, v144
    v_lshlrev_b32 v120, 16, v145
    v_and_b32 v121, 0xffff0000, v145
    v_lshlrev_b32 v122, 16, v146
    v_and_b32 v123, 0xffff0000, v146
    v_lshlrev_b32 v124, 16, v147
    v_and_b32 v125, 0xffff0000, v147
    v_pk_mul_f32 v[126:127], v[100:101], v[90:91]
    v_pk_mul_f32 v[128:129], v[102:103], v[90:91]
    v_pk_mul_f32 v[130:131], v[104:105], v[90:91]
    v_pk_mul_f32 v[132:133], v[106:107], v[90:91]
    v_cvt_pk_bf16_f32 v144, v126, v127
    v_cvt_pk_bf16_f32 v145, v128, v129
    v_cvt_pk_bf16_f32 v146, v130, v131
    v_cvt_pk_bf16_f32 v147, v132, v133
    v_lshlrev_b32 v126, 16, v144
    v_and_b32 v127, 0xffff0000, v144
    v_lshlrev_b32 v128, 16, v145
    v_and_b32 v129, 0xffff0000, v145
    v_lshlrev_b32 v130, 16, v146
    v_and_b32 v131, 0xffff0000, v146
    v_lshlrev_b32 v132, 16, v147
    v_and_b32 v133, 0xffff0000, v147
    v_pk_add_f32 v[118:119], v[118:119], v[126:127]
    v_pk_add_f32 v[120:121], v[120:121], v[128:129]
    v_pk_add_f32 v[122:123], v[122:123], v[130:131]
    v_pk_add_f32 v[124:125], v[124:125], v[132:133]
    v_cvt_pk_bf16_f32 v144, v118, v119
    v_cvt_pk_bf16_f32 v145, v120, v121
    v_cvt_pk_bf16_f32 v146, v122, v123
    v_cvt_pk_bf16_f32 v147, v124, v125
    v_lshlrev_b32 v118, 16, v144
    v_and_b32 v119, 0xffff0000, v144
    v_lshlrev_b32 v120, 16, v145
    v_and_b32 v121, 0xffff0000, v145
    v_lshlrev_b32 v122, 16, v146
    v_and_b32 v123, 0xffff0000, v146
    v_lshlrev_b32 v124, 16, v147
    v_and_b32 v125, 0xffff0000, v147
    v_pk_mul_f32 v[126:127], v[102:103], v[88:89]
    v_pk_mul_f32 v[128:129], v[104:105], v[88:89]
    v_pk_mul_f32 v[130:131], v[106:107], v[88:89]
    v_pk_mul_f32 v[132:133], v[108:109], v[88:89]
    v_cvt_pk_bf16_f32 v144, v126, v127
    v_cvt_pk_bf16_f32 v145, v128, v129
    v_cvt_pk_bf16_f32 v146, v130, v131
    v_cvt_pk_bf16_f32 v147, v132, v133
    v_lshlrev_b32 v126, 16, v144
    v_and_b32 v127, 0xffff0000, v144
    v_lshlrev_b32 v128, 16, v145
    v_and_b32 v129, 0xffff0000, v145
    v_lshlrev_b32 v130, 16, v146
    v_and_b32 v131, 0xffff0000, v146
    v_lshlrev_b32 v132, 16, v147
    v_and_b32 v133, 0xffff0000, v147
    v_pk_add_f32 v[118:119], v[118:119], v[126:127]
    v_pk_add_f32 v[120:121], v[120:121], v[128:129]
    v_pk_add_f32 v[122:123], v[122:123], v[130:131]
    v_pk_add_f32 v[124:125], v[124:125], v[132:133]
    v_cvt_pk_bf16_f32 v144, v118, v119
    v_cvt_pk_bf16_f32 v145, v120, v121
    v_cvt_pk_bf16_f32 v146, v122, v123
    v_cvt_pk_bf16_f32 v147, v124, v125
    v_lshlrev_b32 v118, 16, v144
    v_and_b32 v119, 0xffff0000, v144
    v_lshlrev_b32 v120, 16, v145
    v_and_b32 v121, 0xffff0000, v145
    v_lshlrev_b32 v122, 16, v146
    v_and_b32 v123, 0xffff0000, v146
    v_lshlrev_b32 v124, 16, v147
    v_and_b32 v125, 0xffff0000, v147
    v_pk_mul_f32 v[118:119], v[118:119], v[110:111]
    v_pk_mul_f32 v[120:121], v[120:121], v[112:113]
    v_pk_mul_f32 v[122:123], v[122:123], v[114:115]
    v_pk_mul_f32 v[124:125], v[124:125], v[116:117]
    v_cvt_pk_bf16_f32 v140, v124, v122
    v_cvt_pk_bf16_f32 v141, v120, v118
    ds_write_b64 v84, v[140:141] offset:256
    v_cvt_pk_bf16_f32 v142, v125, v123
    v_cvt_pk_bf16_f32 v143, v121, v119
    ds_write_b64 v84, v[142:143] offset:384
    s_cmp_lg_u32 s30, 4
    s_cbranch_scc1 HB_2
    v_add_u32 v18, 162816, v3
    ds_write_b32 v18, v78
    s_mov_b32 s53, 0
    s_waitcnt vmcnt(10)
HB_p:
    v_readfirstlane_b32 s52, v76
    s_nop 0
    s_cmp_lg_u32 s52, 0
    s_cbranch_scc1 HB_q
    buffer_load_dword v76, v78, s[84:87], 0 offen sc1
    s_waitcnt vmcnt(0)
    s_add_u32 s53, s53, 1
    s_cmp_lt_u32 s53, s61
    s_cbranch_scc1 HB_p
    s_mov_b32 s52, 1
    s_mov_b32 s61, 0
HB_q:
    v_mov_b32 v18, 162828
    v_mov_b32 v19, s52
    s_waitcnt lgkmcnt(0)
    ds_write_b32 v18, v19
HB_2:
    s_add_u32 s16, s4, 0x1800000
    s_addc_u32 s17, s5, 0
    s_mov_b32 s18, 0x400000
    s_mov_b32 s19, 0x20000
    v_lshrrev_b32 v8, 3, v0
    v_and_b32 v85, 7, v0
    v_lshlrev_b32 v149, 12, v8
    v_lshl_add_u32 v149, v85, 4, v149
    s_lshl_b32 s36, s34, 19
    s_sub_u32 s37, 31, s35
    s_lshl_b32 s37, s37, 7
    s_add_u32 s36, s36, s37
    s_add_u32 s37, s36, 262144
    v_lshrrev_b32 v148, 3, v8
    v_xor_b32 v148, v148, v85
    v_lshlrev_b32 v148, 4, v148
    v_lshl_add_u32 v148, v8, 7, v148
    v_add_u32 v148, 98304, v148
    v_mov_b32 v18, 162828
    s_waitcnt lgkmcnt(0)
    s_barrier
    ds_read_b128 v[152:155], v148 offset:0
    ds_read_b128 v[156:159], v148 offset:8192
    ds_read_b32 v19, v18
    s_waitcnt lgkmcnt(2)
    buffer_store_dwordx4 v[152:155], v149, s[16:19], s36 offen sc1
    s_waitcnt lgkmcnt(1)
    buffer_store_dwordx4 v[156:159], v149, s[16:19], s37 offen sc1
    s_waitcnt lgkmcnt(0)
    v_readfirstlane_b32 s52, v19
    s_cmp_lg_u32 s30, 0
    s_cbranch_scc1 KV_ni
    s_cmp_ge_u32 s35, 16
    s_cbranch_scc1 KV_ni
    v_mov_b32 v8, s52
    s_lshl_b32 s37, s34, 7
    s_lshl_b32 s53, s35, 10
    s_add_u32 s37, s37, s53
    s_add_u32 s37, s37, 23101440
    s_mov_b64 exec, 1
    buffer_store_dword v8, v78, s[56:59], s37 offen sc1
    s_mov_b64 exec, -1
KV_ni:
    s_cmp_ge_u32 s2, 255
    s_cbranch_scc1 KV_n3
    s_cmp_lg_u32 s30, 5
    s_cbranch_scc1 KV_n3
    s_and_b32 s42, s2, 31
    s_lshl_b32 s42, s42, 8
    s_lshr_b32 s43, s2, 5
    s_lshl_b32 s43, s43, 14
    s_add_u32 s42, s42, s43
    s_add_u32 s42, s42, 35520512
    v_and_b32 v8, 1, v1
    v_lshlrev_b32 v8, 13, v8
    v_lshrrev_b32 v85, 1, v1
    v_lshl_add_u32 v8, v85, 7, v8
    s_mov_b64 exec, 0xf
    buffer_store_dword v8, v8, s[56:59], s42 offen sc1
    s_mov_b64 exec, -1
KV_n3:
    s_lshl_b32 s36, s34, 5
    s_add_u32 s36, s36, s35
    s_lshl_b32 s36, s36, 7
    s_add_u32 s36, s36, 23068672
    v_mov_b32 v18, 1
    v_mov_b32 v19, 162820
    v_mov_b32 v21, 0
    s_mov_b64 exec, 1
    s_waitcnt vmcnt(0)
    ds_add_rtn_u32 v20, v19, v18
    v_mov_b32 v19, s52
    s_waitcnt lgkmcnt(0)
    v_readfirstlane_b32 s54, v20
    s_nop 0
    s_and_b32 s54, s54, 7
    s_cmp_lg_u32 s54, 7
    s_cbranch_scc1 pub_1
    buffer_store_dword v19, v21, s[56:59], s36 offen sc1
pub_1:
    s_mov_b64 exec, -1
    v_add_u32 v160, s45, v86
    v_alignbit_b32 v88, v53, v52, 16
    v_mov_b32 v92, v53
    v_alignbit_b32 v96, v54, v53, 16
    v_alignbit_b32 v89, v54, v53, 16
    v_mov_b32 v93, v54
    v_alignbit_b32 v97, v55, v54, 16
    v_alignbit_b32 v90, v55, v54, 16
    v_mov_b32 v94, v55
    v_alignbit_b32 v98, v56, v55, 16
    v_alignbit_b32 v91, v56, v55, 16
    v_mov_b32 v95, v56
    v_alignbit_b32 v99, v57, v56, 16
    ds_write_b128 v160, v[88:91] offset:0
    ds_write_b128 v160, v[92:95] offset:4160
    ds_write_b128 v160, v[96:99] offset:8320
    ds_write_b128 v160, v[54:57] offset:12480
    v_alignbit_b32 v100, v59, v58, 16
    v_mov_b32 v104, v59
    v_alignbit_b32 v108, v60, v59, 16
    v_alignbit_b32 v101, v60, v59, 16
    v_mov_b32 v105, v60
    v_alignbit_b32 v109, v61, v60, 16
    v_alignbit_b32 v102, v61, v60, 16
    v_mov_b32 v106, v61
    v_alignbit_b32 v110, v62, v61, 16
    v_alignbit_b32 v103, v62, v61, 16
    v_mov_b32 v107, v62
    v_alignbit_b32 v111, v63, v62, 16
    ds_write_b128 v160, v[100:103] offset:1024
    ds_write_b128 v160, v[104:107] offset:5184
    ds_write_b128 v160, v[108:111] offset:9344
    ds_write_b128 v160, v[60:63] offset:13504
    v_alignbit_b32 v112, v65, v64, 16
    v_mov_b32 v116, v65
    v_alignbit_b32 v120, v66, v65, 16
    v_alignbit_b32 v113, v66, v65, 16
    v_mov_b32 v117, v66
    v_alignbit_b32 v121, v67, v66, 16
    v_alignbit_b32 v114, v67, v66, 16
    v_mov_b32 v118, v67
    v_alignbit_b32 v122, v68, v67, 16
    v_alignbit_b32 v115, v68, v67, 16
    v_mov_b32 v119, v68
    v_alignbit_b32 v123, v69, v68, 16
    s_mov_b64 exec, 0xf
    ds_write_b128 v86, v[112:115] offset:4096
    ds_write_b128 v86, v[116:119] offset:8256
    ds_write_b128 v86, v[120:123] offset:12416
    ds_write_b128 v86, v[66:69] offset:16576
    s_mov_b64 exec, -1
    s_waitcnt lgkmcnt(0)
    v_lshlrev_b32 v40, 6, v179
    v_add_u32 v40, 161792, v40
    s_lshl_b32 s35, s30, 3
    v_add_u32 v39, s35, v40
    s_waitcnt vmcnt(0)
    v_lshlrev_b32 v206, 16, v180
    v_and_b32 v207, 0xffff0000, v180
    v_lshlrev_b32 v208, 16, v181
    v_and_b32 v209, 0xffff0000, v181
    v_lshlrev_b32 v210, 16, v182
    v_and_b32 v211, 0xffff0000, v182
    v_lshlrev_b32 v212, 16, v183
    v_and_b32 v213, 0xffff0000, v183
    v_lshlrev_b32 v214, 16, v184
    v_and_b32 v215, 0xffff0000, v184
    v_lshlrev_b32 v216, 16, v185
    v_and_b32 v217, 0xffff0000, v185
    v_lshlrev_b32 v218, 16, v186
    v_and_b32 v219, 0xffff0000, v186
    v_lshlrev_b32 v220, 16, v187
    v_and_b32 v221, 0xffff0000, v187
    v_pk_add_f32 v[32:33], v[206:207], v[208:209]
    v_pk_mul_f32 v[34:35], v[206:207], v[206:207]
    v_pk_fma_f32 v[34:35], v[208:209], v[208:209], v[34:35]
    v_pk_add_f32 v[32:33], v[32:33], v[210:211]
    v_pk_fma_f32 v[34:35], v[210:211], v[210:211], v[34:35]
    v_pk_add_f32 v[32:33], v[32:33], v[212:213]
    v_pk_fma_f32 v[34:35], v[212:213], v[212:213], v[34:35]
    v_pk_add_f32 v[32:33], v[32:33], v[214:215]
    v_pk_fma_f32 v[34:35], v[214:215], v[214:215], v[34:35]
    v_pk_add_f32 v[32:33], v[32:33], v[216:217]
    v_pk_fma_f32 v[34:35], v[216:217], v[216:217], v[34:35]
    v_pk_add_f32 v[32:33], v[32:33], v[218:219]
    v_pk_fma_f32 v[34:35], v[218:219], v[218:219], v[34:35]
    v_pk_add_f32 v[32:33], v[32:33], v[220:221]
    v_pk_fma_f32 v[34:35], v[220:221], v[220:221], v[34:35]
    v_add_f32 v30, v32, v33
    v_add_f32 v31, v34, v35
    s_nop 0
    v_add_f32_dpp v30, v30, v30 row_ror:8 row_mask:0xf bank_mask:0xf
    v_add_f32_dpp v31, v31, v31 row_ror:8 row_mask:0xf bank_mask:0xf
    v_mov_b32 v32, v30
    v_mov_b32 v33, v31
    s_nop 0
    v_permlane16_swap_b32 v30, v32
    v_permlane16_swap_b32 v31, v33
    v_pk_add_f32 v[30:31], v[30:31], v[32:33]
    v_mov_b32 v32, v30
    v_mov_b32 v33, v31
    s_nop 0
    v_permlane32_swap_b32 v30, v32
    v_permlane32_swap_b32 v31, v33
    v_pk_add_f32 v[30:31], v[30:31], v[32:33]
    ds_write_b64 v39, v[30:31] offset:0
    s_waitcnt lgkmcnt(0)
    s_barrier
    ds_read_b128 v[12:15], v40 offset:0
    ds_read_b128 v[16:19], v40 offset:16
    ds_read_b128 v[20:23], v40 offset:32
    ds_read_b128 v[24:27], v40 offset:48
    s_waitcnt lgkmcnt(0)
    v_pk_add_f32 v[12:13], v[12:13], v[14:15]
    v_pk_add_f32 v[16:17], v[16:17], v[18:19]
    v_pk_add_f32 v[20:21], v[20:21], v[22:23]
    v_pk_add_f32 v[24:25], v[24:25], v[26:27]
    v_pk_add_f32 v[12:13], v[12:13], v[16:17]
    v_pk_add_f32 v[20:21], v[20:21], v[24:25]
    v_pk_add_f32 v[12:13], v[12:13], v[20:21]
    v_mul_f32 v36, 0x3a800000, v12
    v_mul_f32 v38, 0x3a800000, v13
    v_fma_f32 v38, -v36, v36, v38
    v_max_f32 v38, 0, v38
    v_cvt_pk_bf16_f32 v36, v36, v36
    v_lshlrev_b32 v36, 16, v36
    v_cvt_pk_bf16_f32 v38, v38, v38
    v_lshlrev_b32 v38, 16, v38
    v_add_f32 v38, 0x3727c5ac, v38
    v_cvt_pk_bf16_f32 v38, v38, v38
    v_lshlrev_b32 v38, 16, v38
    v_sqrt_f32 v38, v38
    s_nop 0
    v_cvt_pk_bf16_f32 v38, v38, v38
    v_lshlrev_b32 v38, 16, v38
    v_rcp_f32 v37, v38
    v_sub_f32 v32, 0, v36
    v_mov_b32 v34, v37
    v_sub_f32 v33, 0, v36
    v_mov_b32 v35, v37
    v_pk_add_f32 v[12:13], v[206:207], v[32:33]
    v_cvt_pk_bf16_f32 v28, v12, v13
    v_lshlrev_b32 v12, 16, v28
    v_and_b32 v13, 0xffff0000, v28
    v_pk_mul_f32 v[12:13], v[12:13], v[34:35]
    v_cvt_pk_bf16_f32 v188, v12, v13
    v_pk_add_f32 v[14:15], v[208:209], v[32:33]
    v_cvt_pk_bf16_f32 v28, v14, v15
    v_lshlrev_b32 v14, 16, v28
    v_and_b32 v15, 0xffff0000, v28
    v_pk_mul_f32 v[14:15], v[14:15], v[34:35]
    v_cvt_pk_bf16_f32 v189, v14, v15
    v_pk_add_f32 v[16:17], v[210:211], v[32:33]
    v_cvt_pk_bf16_f32 v28, v16, v17
    v_lshlrev_b32 v16, 16, v28
    v_and_b32 v17, 0xffff0000, v28
    v_pk_mul_f32 v[16:17], v[16:17], v[34:35]
    v_cvt_pk_bf16_f32 v190, v16, v17
    v_pk_add_f32 v[18:19], v[212:213], v[32:33]
    v_cvt_pk_bf16_f32 v28, v18, v19
    v_lshlrev_b32 v18, 16, v28
    v_and_b32 v19, 0xffff0000, v28
    v_pk_mul_f32 v[18:19], v[18:19], v[34:35]
    v_cvt_pk_bf16_f32 v191, v18, v19
    v_pk_add_f32 v[20:21], v[214:215], v[32:33]
    v_cvt_pk_bf16_f32 v28, v20, v21
    v_lshlrev_b32 v20, 16, v28
    v_and_b32 v21, 0xffff0000, v28
    v_pk_mul_f32 v[20:21], v[20:21], v[34:35]
    v_cvt_pk_bf16_f32 v192, v20, v21
    v_pk_add_f32 v[22:23], v[216:217], v[32:33]
    v_cvt_pk_bf16_f32 v28, v22, v23
    v_lshlrev_b32 v22, 16, v28
    v_and_b32 v23, 0xffff0000, v28
    v_pk_mul_f32 v[22:23], v[22:23], v[34:35]
    v_cvt_pk_bf16_f32 v193, v22, v23
    v_pk_add_f32 v[24:25], v[218:219], v[32:33]
    v_cvt_pk_bf16_f32 v28, v24, v25
    v_lshlrev_b32 v24, 16, v28
    v_and_b32 v25, 0xffff0000, v28
    v_pk_mul_f32 v[24:25], v[24:25], v[34:35]
    v_cvt_pk_bf16_f32 v194, v24, v25
    v_pk_add_f32 v[26:27], v[220:221], v[32:33]
    v_cvt_pk_bf16_f32 v28, v26, v27
    v_lshlrev_b32 v26, 16, v28
    v_and_b32 v27, 0xffff0000, v28
    v_pk_mul_f32 v[26:27], v[26:27], v[34:35]
    v_cvt_pk_bf16_f32 v195, v26, v27
    v_mov_b32 v238, 0
    v_mov_b32 v239, 0
    v_mov_b32 v240, 0
    v_mov_b32 v241, 0
    v_mov_b32 v242, 0
    v_mov_b32 v243, 0
    v_mov_b32 v244, 0
    v_mov_b32 v245, 0
    v_mov_b32 v246, 0
    v_mov_b32 v247, 0
    s_cmp_ge_u32 s30, 4
    s_cbranch_scc1 FR_b
    s_load_dwordx2 s[10:11], s[0:1], 40
    s_and_b32 s38, s2, 7
    s_lshl_b32 s38, s38, 5
    s_lshr_b32 s39, s2, 3
    s_add_u32 s38, s38, s39
    s_lshl_b32 s39, s38, 2
    s_add_u32 s39, s39, s30
    s_mul_i32 s40, s30, 24576
    s_lshl_b32 s36, s39, 12
    s_add_u32 s36, s36, 25165824
    s_add_u32 s16, s4, s36
    s_addc_u32 s17, s5, 0
    s_mov_b32 s18, 4096
    s_mov_b32 s19, 0x20000
    s_waitcnt lgkmcnt(0)
    s_lshr_b32 s36, s39, 1
    s_lshl_b32 s36, s36, 2
    s_load_dword s41, s[10:11], s36
    v_lshrrev_b32 v6, 2, v1
    v_mul_u32_u24 v12, 96, v6
    v_and_b32 v6, 3, v1
    v_lshl_add_u32 v12, v6, 4, v12
    v_add_u32 v12, s40, v12
    v_and_b32 v35, 15, v1
    v_lshrrev_b32 v36, 4, v1
    v_and_b32 v6, 3, v35
    v_mul_u32_u24 v32, 4160, v6
    v_lshl_add_u32 v32, v36, 4, v32
    v_lshrrev_b32 v6, 2, v35
    v_lshl_add_u32 v32, v6, 3, v32
    v_add_u32 v32, s40, v32
    v_sub_u32 v6, 15, v35
    v_mul_u32_u24 v34, 96, v6
    v_add_u32 v34, s40, v34
    v_lshl_add_u32 v33, v36, 4, v34
    v_pk_mov_b32 v[40:41], 0, 0
    v_pk_mov_b32 v[42:43], 0, 0
    v_pk_mov_b32 v[44:45], 0, 0
    v_pk_mov_b32 v[46:47], 0, 0
    v_pk_mov_b32 v[48:49], 0, 0
    v_pk_mov_b32 v[50:51], 0, 0
    v_pk_mov_b32 v[52:53], 0, 0
    v_pk_mov_b32 v[54:55], 0, 0
    v_pk_mov_b32 v[56:57], 0, 0
    v_pk_mov_b32 v[58:59], 0, 0
    v_pk_mov_b32 v[60:61], 0, 0
    v_pk_mov_b32 v[62:63], 0, 0
    v_pk_mov_b32 v[64:65], 0, 0
    v_pk_mov_b32 v[66:67], 0, 0
    v_pk_mov_b32 v[68:69], 0, 0
    v_pk_mov_b32 v[70:71], 0, 0
    ds_read_b64 v[72:73], v32 offset:0
    ds_read_b64 v[74:75], v32 offset:8
    ds_read_b64 v[76:77], v32 offset:32
    ds_read_b64 v[78:79], v32 offset:40
    ds_read_b64 v[80:81], v32 offset:1024
    ds_read_b64 v[82:83], v32 offset:1032
    ds_read_b64 v[84:85], v32 offset:1056
    ds_read_b64 v[86:87], v32 offset:1064
    ds_read_b64 v[88:89], v32 offset:2048
    ds_read_b64 v[90:91], v32 offset:2056
    ds_read_b64 v[92:93], v32 offset:2080
    ds_read_b64 v[94:95], v32 offset:2088
    ds_read_b64 v[96:97], v32 offset:3072
    ds_read_b64 v[98:99], v32 offset:3080
    ds_read_b64 v[100:101], v32 offset:3104
    ds_read_b64 v[102:103], v32 offset:3112
    s_cmp_lg_u32 s30, 0
    s_cbranch_scc1 CV_w
    s_and_b32 s36, s2, 7
    s_lshl_b32 s36, s36, 12
    s_add_u32 s36, s36, 23068672
    v_lshlrev_b32 v9, 7, v1
    v_add_u32 v9, s36, v9
    s_mov_b32 s53, 0
    s_add_u32 s54, s52, 0
    s_bfm_b64 exec, 32, 0
poll_2:
    buffer_load_dword v8, v9, s[56:59], 0 offen sc1
    s_waitcnt vmcnt(0)
    v_xor_b32 v8, s54, v8
    v_cmp_eq_u32 vcc, 0, v8
    s_nop 0
    s_cmp_eq_u64 vcc, exec
    s_cbranch_scc1 pok_3
    s_sleep 5
    s_add_u32 s53, s53, 1
    s_cmp_lt_u32 s53, s61
    s_cbranch_scc1 poll_2
    s_mov_b32 s61, 0
pok_3:
    s_mov_b64 exec, -1
    v_mov_b32 v8, 162832
    v_mov_b32 v9, 1
    s_waitcnt lgkmcnt(0)
    ds_write_b32 v8, v9
CV_w:
    v_mov_b32 v8, 162832
spin_4:
    ds_read_b32 v9, v8
    s_waitcnt lgkmcnt(0)
    v_readfirstlane_b32 s53, v9
    s_nop 0
    s_cmp_ge_u32 s53, 1
    s_cbranch_scc0 spin_4
    buffer_load_dwordx4 v[16:19], v2, s[16:19], 0 offen offset:0 sc1
    buffer_load_dwordx4 v[20:23], v2, s[16:19], 0 offen offset:1024 sc1
    buffer_load_dwordx4 v[24:27], v2, s[16:19], 0 offen offset:2048 sc1
    buffer_load_dwordx4 v[28:31], v2, s[16:19], 0 offen offset:3072 sc1
    s_waitcnt vmcnt(3)
    ds_write_b128 v12, v[16:19] offset:16640
    s_waitcnt vmcnt(2)
    ds_write_b128 v12, v[20:23] offset:18176
    s_waitcnt vmcnt(1)
    ds_write_b128 v12, v[24:27] offset:19712
    s_waitcnt vmcnt(0)
    ds_write_b128 v12, v[28:31] offset:21248
    v_mov_b32 v8, 162836
    v_mov_b32 v9, 1
    s_mov_b64 exec, 1
    ds_add_u32 v8, v9
    s_mov_b64 exec, -1
    s_waitcnt lgkmcnt(0)
    ds_read_b128 v[136:139], v33 offset:21248
    ds_read_b128 v[140:143], v33 offset:19712
    ds_read_b128 v[144:147], v33 offset:18176
    ds_read_b128 v[148:151], v33 offset:16640
    s_mov_b32 s43, 0
CV_r:
    s_waitcnt lgkmcnt(0)
    v_mfma_f32_16x16x32_bf16 v[40:43], v[72:75], v[136:139], v[40:43]
    v_mfma_f32_16x16x32_bf16 v[48:51], v[72:75], v[140:143], v[48:51]
    v_mfma_f32_16x16x32_bf16 v[56:59], v[72:75], v[144:147], v[56:59]
    v_mfma_f32_16x16x32_bf16 v[64:67], v[72:75], v[148:151], v[64:67]
    v_mfma_f32_16x16x32_bf16 v[44:47], v[76:79], v[136:139], v[44:47]
    v_mfma_f32_16x16x32_bf16 v[52:55], v[76:79], v[140:143], v[52:55]
    v_mfma_f32_16x16x32_bf16 v[60:63], v[76:79], v[144:147], v[60:63]
    v_mfma_f32_16x16x32_bf16 v[68:71], v[76:79], v[148:151], v[68:71]
    v_mfma_f32_16x16x32_bf16 v[48:51], v[80:83], v[136:139], v[48:51]
    v_mfma_f32_16x16x32_bf16 v[56:59], v[80:83], v[140:143], v[56:59]
    v_mfma_f32_16x16x32_bf16 v[64:67], v[80:83], v[144:147], v[64:67]
    v_mfma_f32_16x16x32_bf16 v[52:55], v[84:87], v[136:139], v[52:55]
    v_mfma_f32_16x16x32_bf16 v[60:63], v[84:87], v[140:143], v[60:63]
    v_mfma_f32_16x16x32_bf16 v[68:71], v[84:87], v[144:147], v[68:71]
    v_mfma_f32_16x16x32_bf16 v[56:59], v[88:91], v[136:139], v[56:59]
    v_mfma_f32_16x16x32_bf16 v[64:67], v[88:91], v[140:143], v[64:67]
    v_mfma_f32_16x16x32_bf16 v[60:63], v[92:95], v[136:139], v[60:63]
    v_mfma_f32_16x16x32_bf16 v[68:71], v[92:95], v[140:143], v[68:71]
    v_mfma_f32_16x16x32_bf16 v[64:67], v[96:99], v[136:139], v[64:67]
    v_mfma_f32_16x16x32_bf16 v[68:71], v[100:103], v[136:139], v[68:71]
    ds_read_b128 v[152:155], v33 offset:21344
    ds_read_b128 v[156:159], v33 offset:19808
    ds_read_b128 v[160:163], v33 offset:18272
    ds_read_b128 v[164:167], v33 offset:16736
    ds_read_b64 v[104:105], v32 offset:64
    ds_read_b64 v[106:107], v32 offset:72
    ds_read_b64 v[108:109], v32 offset:96
    ds_read_b64 v[110:111], v32 offset:104
    ds_read_b64 v[112:113], v32 offset:1088
    ds_read_b64 v[114:115], v32 offset:1096
    ds_read_b64 v[116:117], v32 offset:1120
    ds_read_b64 v[118:119], v32 offset:1128
    ds_read_b64 v[120:121], v32 offset:2112
    ds_read_b64 v[122:123], v32 offset:2120
    ds_read_b64 v[124:125], v32 offset:2144
    ds_read_b64 v[126:127], v32 offset:2152
    ds_read_b64 v[128:129], v32 offset:3136
    ds_read_b64 v[130:131], v32 offset:3144
    ds_read_b64 v[132:133], v32 offset:3168
    ds_read_b64 v[134:135], v32 offset:3176
    s_waitcnt lgkmcnt(0)
    v_mfma_f32_16x16x32_bf16 v[40:43], v[104:107], v[152:155], v[40:43]
    v_mfma_f32_16x16x32_bf16 v[48:51], v[104:107], v[156:159], v[48:51]
    v_mfma_f32_16x16x32_bf16 v[56:59], v[104:107], v[160:163], v[56:59]
    v_mfma_f32_16x16x32_bf16 v[64:67], v[104:107], v[164:167], v[64:67]
    v_mfma_f32_16x16x32_bf16 v[44:47], v[108:111], v[152:155], v[44:47]
    v_mfma_f32_16x16x32_bf16 v[52:55], v[108:111], v[156:159], v[52:55]
    v_mfma_f32_16x16x32_bf16 v[60:63], v[108:111], v[160:163], v[60:63]
    v_mfma_f32_16x16x32_bf16 v[68:71], v[108:111], v[164:167], v[68:71]
    v_mfma_f32_16x16x32_bf16 v[48:51], v[112:115], v[152:155], v[48:51]
    v_mfma_f32_16x16x32_bf16 v[56:59], v[112:115], v[156:159], v[56:59]
    v_mfma_f32_16x16x32_bf16 v[64:67], v[112:115], v[160:163], v[64:67]
    v_mfma_f32_16x16x32_bf16 v[52:55], v[116:119], v[152:155], v[52:55]
    v_mfma_f32_16x16x32_bf16 v[60:63], v[116:119], v[156:159], v[60:63]
    v_mfma_f32_16x16x32_bf16 v[68:71], v[116:119], v[160:163], v[68:71]
    v_mfma_f32_16x16x32_bf16 v[56:59], v[120:123], v[152:155], v[56:59]
    v_mfma_f32_16x16x32_bf16 v[64:67], v[120:123], v[156:159], v[64:67]
    v_mfma_f32_16x16x32_bf16 v[60:63], v[124:127], v[152:155], v[60:63]
    v_mfma_f32_16x16x32_bf16 v[68:71], v[124:127], v[156:159], v[68:71]
    v_mfma_f32_16x16x32_bf16 v[64:67], v[128:131], v[152:155], v[64:67]
    v_mfma_f32_16x16x32_bf16 v[68:71], v[132:135], v[152:155], v[68:71]
    ds_read_b128 v[136:139], v33 offset:21440
    ds_read_b128 v[140:143], v33 offset:19904
    ds_read_b128 v[144:147], v33 offset:18368
    ds_read_b128 v[148:151], v33 offset:16832
    ds_read_b64 v[72:73], v32 offset:128
    ds_read_b64 v[74:75], v32 offset:136
    ds_read_b64 v[76:77], v32 offset:160
    ds_read_b64 v[78:79], v32 offset:168
    ds_read_b64 v[80:81], v32 offset:1152
    ds_read_b64 v[82:83], v32 offset:1160
    ds_read_b64 v[84:85], v32 offset:1184
    ds_read_b64 v[86:87], v32 offset:1192
    ds_read_b64 v[88:89], v32 offset:2176
    ds_read_b64 v[90:91], v32 offset:2184
    ds_read_b64 v[92:93], v32 offset:2208
    ds_read_b64 v[94:95], v32 offset:2216
    ds_read_b64 v[96:97], v32 offset:3200
    ds_read_b64 v[98:99], v32 offset:3208
    ds_read_b64 v[100:101], v32 offset:3232
    ds_read_b64 v[102:103], v32 offset:3240
    v_add_u32 v32, 128, v32
    v_add_u32 v33, 192, v33
    s_add_u32 s43, s43, 1
    s_cmp_lt_u32 s43, 3
    s_cbranch_scc1 CV_r
CV_l:
    s_waitcnt lgkmcnt(0)
    v_mfma_f32_16x16x32_bf16 v[40:43], v[72:75], v[136:139], v[40:43]
    ds_read_b128 v[152:155], v33 offset:21344
    ds_read_b128 v[156:159], v33 offset:19808
    v_mfma_f32_16x16x32_bf16 v[48:51], v[72:75], v[140:143], v[48:51]
    ds_read_b128 v[160:163], v33 offset:18272
    v_mfma_f32_16x16x32_bf16 v[56:59], v[72:75], v[144:147], v[56:59]
    ds_read_b128 v[164:167], v33 offset:16736
    v_mfma_f32_16x16x32_bf16 v[64:67], v[72:75], v[148:151], v[64:67]
    ds_read_b64 v[104:105], v32 offset:64
    ds_read_b64 v[106:107], v32 offset:72
    v_mfma_f32_16x16x32_bf16 v[44:47], v[76:79], v[136:139], v[44:47]
    ds_read_b64 v[108:109], v32 offset:96
    v_mfma_f32_16x16x32_bf16 v[52:55], v[76:79], v[140:143], v[52:55]
    ds_read_b64 v[110:111], v32 offset:104
    v_mfma_f32_16x16x32_bf16 v[60:63], v[76:79], v[144:147], v[60:63]
    ds_read_b64 v[112:113], v32 offset:1088
    ds_read_b64 v[114:115], v32 offset:1096
    v_mfma_f32_16x16x32_bf16 v[68:71], v[76:79], v[148:151], v[68:71]
    ds_read_b64 v[116:117], v32 offset:1120
    v_mfma_f32_16x16x32_bf16 v[48:51], v[80:83], v[136:139], v[48:51]
    ds_read_b64 v[118:119], v32 offset:1128
    v_mfma_f32_16x16x32_bf16 v[56:59], v[80:83], v[140:143], v[56:59]
    ds_read_b64 v[120:121], v32 offset:2112
    ds_read_b64 v[122:123], v32 offset:2120
    v_mfma_f32_16x16x32_bf16 v[64:67], v[80:83], v[144:147], v[64:67]
    ds_read_b64 v[124:125], v32 offset:2144
    v_mfma_f32_16x16x32_bf16 v[52:55], v[84:87], v[136:139], v[52:55]
    ds_read_b64 v[126:127], v32 offset:2152
    v_mfma_f32_16x16x32_bf16 v[60:63], v[84:87], v[140:143], v[60:63]
    ds_read_b64 v[128:129], v32 offset:3136
    ds_read_b64 v[130:131], v32 offset:3144
    v_mfma_f32_16x16x32_bf16 v[68:71], v[84:87], v[144:147], v[68:71]
    ds_read_b64 v[132:133], v32 offset:3168
    v_mfma_f32_16x16x32_bf16 v[56:59], v[88:91], v[136:139], v[56:59]
    ds_read_b64 v[134:135], v32 offset:3176
    v_mfma_f32_16x16x32_bf16 v[64:67], v[88:91], v[140:143], v[64:67]
    v_mfma_f32_16x16x32_bf16 v[60:63], v[92:95], v[136:139], v[60:63]
    v_mfma_f32_16x16x32_bf16 v[68:71], v[92:95], v[140:143], v[68:71]
    v_mfma_f32_16x16x32_bf16 v[64:67], v[96:99], v[136:139], v[64:67]
    v_mfma_f32_16x16x32_bf16 v[68:71], v[100:103], v[136:139], v[68:71]
    s_waitcnt lgkmcnt(0)
    v_mfma_f32_16x16x32_bf16 v[40:43], v[104:107], v[152:155], v[40:43]
    ds_read_b128 v[136:139], v33 offset:21440
    ds_read_b128 v[140:143], v33 offset:19904
    v_mfma_f32_16x16x32_bf16 v[48:51], v[104:107], v[156:159], v[48:51]
    ds_read_b128 v[144:147], v33 offset:18368
    v_mfma_f32_16x16x32_bf16 v[56:59], v[104:107], v[160:163], v[56:59]
    ds_read_b128 v[148:151], v33 offset:16832
    v_mfma_f32_16x16x32_bf16 v[64:67], v[104:107], v[164:167], v[64:67]
    ds_read_b64 v[72:73], v32 offset:128
    ds_read_b64 v[74:75], v32 offset:136
    v_mfma_f32_16x16x32_bf16 v[44:47], v[108:111], v[152:155], v[44:47]
    ds_read_b64 v[76:77], v32 offset:160
    v_mfma_f32_16x16x32_bf16 v[52:55], v[108:111], v[156:159], v[52:55]
    ds_read_b64 v[78:79], v32 offset:168
    v_mfma_f32_16x16x32_bf16 v[60:63], v[108:111], v[160:163], v[60:63]
    ds_read_b64 v[80:81], v32 offset:1152
    ds_read_b64 v[82:83], v32 offset:1160
    v_mfma_f32_16x16x32_bf16 v[68:71], v[108:111], v[164:167], v[68:71]
    ds_read_b64 v[84:85], v32 offset:1184
    v_mfma_f32_16x16x32_bf16 v[48:51], v[112:115], v[152:155], v[48:51]
    ds_read_b64 v[86:87], v32 offset:1192
    v_mfma_f32_16x16x32_bf16 v[56:59], v[112:115], v[156:159], v[56:59]
    ds_read_b64 v[88:89], v32 offset:2176
    ds_read_b64 v[90:91], v32 offset:2184
    v_mfma_f32_16x16x32_bf16 v[64:67], v[112:115], v[160:163], v[64:67]
    ds_read_b64 v[92:93], v32 offset:2208
    v_mfma_f32_16x16x32_bf16 v[52:55], v[116:119], v[152:155], v[52:55]
    ds_read_b64 v[94:95], v32 offset:2216
    v_mfma_f32_16x16x32_bf16 v[60:63], v[116:119], v[156:159], v[60:63]
    ds_read_b64 v[96:97], v32 offset:3200
    ds_read_b64 v[98:99], v32 offset:3208
    v_mfma_f32_16x16x32_bf16 v[68:71], v[116:119], v[160:163], v[68:71]
    ds_read_b64 v[100:101], v32 offset:3232
    v_mfma_f32_16x16x32_bf16 v[56:59], v[120:123], v[152:155], v[56:59]
    ds_read_b64 v[102:103], v32 offset:3240
    v_mfma_f32_16x16x32_bf16 v[64:67], v[120:123], v[156:159], v[64:67]
    v_add_u32 v32, 128, v32
    v_add_u32 v33, 192, v33
    v_mfma_f32_16x16x32_bf16 v[60:63], v[124:127], v[152:155], v[60:63]
    s_add_u32 s43, s43, 1
    v_mfma_f32_16x16x32_bf16 v[68:71], v[124:127], v[156:159], v[68:71]
    s_cmp_lt_u32 s43, 8
    v_mfma_f32_16x16x32_bf16 v[64:67], v[128:131], v[152:155], v[64:67]
    v_mfma_f32_16x16x32_bf16 v[68:71], v[132:135], v[152:155], v[68:71]
    s_cbranch_scc1 CV_l
    s_bitcmp1_b32 s39, 0
    s_cselect_b32 s36, 0, 16
    s_lshl_b32 s41, s41, s36
    s_and_b32 s41, s41, 0xffff0000
    v_mov_b32 v170, s41
    v_mov_b32 v171, s41
    v_sub_u32 v6, 3, v36
    v_lshl_add_u32 v34, v6, 3, v34
    ds_read_b64 v[16:17], v34 offset:21280
    ds_read_b64 v[18:19], v34 offset:21248
    ds_read_b64 v[20:21], v34 offset:19744
    ds_read_b64 v[22:23], v34 offset:19712
    ds_read_b64 v[24:25], v34 offset:18208
    ds_read_b64 v[26:27], v34 offset:18176
    ds_read_b64 v[28:29], v34 offset:16672
    ds_read_b64 v[30:31], v34 offset:16640
    s_mul_i32 s36, s30, 24640
    v_mul_u32_u24 v168, 72, v35
    v_lshl_add_u32 v168, v36, 3, v168
    v_add_u32 v168, s36, v168
    s_waitcnt lgkmcnt(0)
    v_lshlrev_b32 v131, 16, v16
    v_and_b32 v130, 0xffff0000, v16
    v_lshlrev_b32 v129, 16, v17
    v_and_b32 v128, 0xffff0000, v17
    v_pk_mul_f32 v[128:129], v[128:129], v[170:171]
    v_pk_mul_f32 v[130:131], v[130:131], v[170:171]
    v_cvt_pk_bf16_f32 v132, v128, v129
    v_lshlrev_b32 v128, 16, v132
    v_and_b32 v129, 0xffff0000, v132
    v_cvt_pk_bf16_f32 v133, v130, v131
    v_lshlrev_b32 v130, 16, v133
    v_and_b32 v131, 0xffff0000, v133
    v_cvt_pk_bf16_f32 v132, v40, v41
    v_lshlrev_b32 v40, 16, v132
    v_and_b32 v41, 0xffff0000, v132
    v_cvt_pk_bf16_f32 v133, v42, v43
    v_lshlrev_b32 v42, 16, v133
    v_and_b32 v43, 0xffff0000, v133
    v_pk_add_f32 v[40:41], v[40:41], v[128:129]
    v_pk_add_f32 v[42:43], v[42:43], v[130:131]
    v_cvt_pk_bf16_f32 v152, v40, v41
    v_cvt_pk_bf16_f32 v153, v42, v43
    ds_write_b64 v168, v[152:153] offset:0
    v_lshlrev_b32 v131, 16, v18
    v_and_b32 v130, 0xffff0000, v18
    v_lshlrev_b32 v129, 16, v19
    v_and_b32 v128, 0xffff0000, v19
    v_pk_mul_f32 v[128:129], v[128:129], v[170:171]
    v_pk_mul_f32 v[130:131], v[130:131], v[170:171]
    v_cvt_pk_bf16_f32 v132, v128, v129
    v_lshlrev_b32 v128, 16, v132
    v_and_b32 v129, 0xffff0000, v132
    v_cvt_pk_bf16_f32 v133, v130, v131
    v_lshlrev_b32 v130, 16, v133
    v_and_b32 v131, 0xffff0000, v133
    v_cvt_pk_bf16_f32 v132, v44, v45
    v_lshlrev_b32 v44, 16, v132
    v_and_b32 v45, 0xffff0000, v132
    v_cvt_pk_bf16_f32 v133, v46, v47
    v_lshlrev_b32 v46, 16, v133
    v_and_b32 v47, 0xffff0000, v133
    v_pk_add_f32 v[44:45], v[44:45], v[128:129]
    v_pk_add_f32 v[46:47], v[46:47], v[130:131]
    v_cvt_pk_bf16_f32 v154, v44, v45
    v_cvt_pk_bf16_f32 v155, v46, v47
    ds_write_b64 v168, v[154:155] offset:32
    v_lshlrev_b32 v131, 16, v20
    v_and_b32 v130, 0xffff0000, v20
    v_lshlrev_b32 v129, 16, v21
    v_and_b32 v128, 0xffff0000, v21
    v_pk_mul_f32 v[128:129], v[128:129], v[170:171]
    v_pk_mul_f32 v[130:131], v[130:131], v[170:171]
    v_cvt_pk_bf16_f32 v132, v128, v129
    v_lshlrev_b32 v128, 16, v132
    v_and_b32 v129, 0xffff0000, v132
    v_cvt_pk_bf16_f32 v133, v130, v131
    v_lshlrev_b32 v130, 16, v133
    v_and_b32 v131, 0xffff0000, v133
    v_cvt_pk_bf16_f32 v132, v48, v49
    v_lshlrev_b32 v48, 16, v132
    v_and_b32 v49, 0xffff0000, v132
    v_cvt_pk_bf16_f32 v133, v50, v51
    v_lshlrev_b32 v50, 16, v133
    v_and_b32 v51, 0xffff0000, v133
    v_pk_add_f32 v[48:49], v[48:49], v[128:129]
    v_pk_add_f32 v[50:51], v[50:51], v[130:131]
    v_cvt_pk_bf16_f32 v156, v48, v49
    v_cvt_pk_bf16_f32 v157, v50, v51
    ds_write_b64 v168, v[156:157] offset:1152
    v_lshlrev_b32 v131, 16, v22
    v_and_b32 v130, 0xffff0000, v22
    v_lshlrev_b32 v129, 16, v23
    v_and_b32 v128, 0xffff0000, v23
    v_pk_mul_f32 v[128:129], v[128:129], v[170:171]
    v_pk_mul_f32 v[130:131], v[130:131], v[170:171]
    v_cvt_pk_bf16_f32 v132, v128, v129
    v_lshlrev_b32 v128, 16, v132
    v_and_b32 v129, 0xffff0000, v132
    v_cvt_pk_bf16_f32 v133, v130, v131
    v_lshlrev_b32 v130, 16, v133
    v_and_b32 v131, 0xffff0000, v133
    v_cvt_pk_bf16_f32 v132, v52, v53
    v_lshlrev_b32 v52, 16, v132
    v_and_b32 v53, 0xffff0000, v132
    v_cvt_pk_bf16_f32 v133, v54, v55
    v_lshlrev_b32 v54, 16, v133
    v_and_b32 v55, 0xffff0000, v133
    v_pk_add_f32 v[52:53], v[52:53], v[128:129]
    v_pk_add_f32 v[54:55], v[54:55], v[130:131]
    v_cvt_pk_bf16_f32 v158, v52, v53
    v_cvt_pk_bf16_f32 v159, v54, v55
    ds_write_b64 v168, v[158:159] offset:1184
    v_lshlrev_b32 v131, 16, v24
    v_and_b32 v130, 0xffff0000, v24
    v_lshlrev_b32 v129, 16, v25
    v_and_b32 v128, 0xffff0000, v25
    v_pk_mul_f32 v[128:129], v[128:129], v[170:171]
    v_pk_mul_f32 v[130:131], v[130:131], v[170:171]
    v_cvt_pk_bf16_f32 v132, v128, v129
    v_lshlrev_b32 v128, 16, v132
    v_and_b32 v129, 0xffff0000, v132
    v_cvt_pk_bf16_f32 v133, v130, v131
    v_lshlrev_b32 v130, 16, v133
    v_and_b32 v131, 0xffff0000, v133
    v_cvt_pk_bf16_f32 v132, v56, v57
    v_lshlrev_b32 v56, 16, v132
    v_and_b32 v57, 0xffff0000, v132
    v_cvt_pk_bf16_f32 v133, v58, v59
    v_lshlrev_b32 v58, 16, v133
    v_and_b32 v59, 0xffff0000, v133
    v_pk_add_f32 v[56:57], v[56:57], v[128:129]
    v_pk_add_f32 v[58:59], v[58:59], v[130:131]
    v_cvt_pk_bf16_f32 v160, v56, v57
    v_cvt_pk_bf16_f32 v161, v58, v59
    ds_write_b64 v168, v[160:161] offset:2304
    v_lshlrev_b32 v131, 16, v26
    v_and_b32 v130, 0xffff0000, v26
    v_lshlrev_b32 v129, 16, v27
    v_and_b32 v128, 0xffff0000, v27
    v_pk_mul_f32 v[128:129], v[128:129], v[170:171]
    v_pk_mul_f32 v[130:131], v[130:131], v[170:171]
    v_cvt_pk_bf16_f32 v132, v128, v129
    v_lshlrev_b32 v128, 16, v132
    v_and_b32 v129, 0xffff0000, v132
    v_cvt_pk_bf16_f32 v133, v130, v131
    v_lshlrev_b32 v130, 16, v133
    v_and_b32 v131, 0xffff0000, v133
    v_cvt_pk_bf16_f32 v132, v60, v61
    v_lshlrev_b32 v60, 16, v132
    v_and_b32 v61, 0xffff0000, v132
    v_cvt_pk_bf16_f32 v133, v62, v63
    v_lshlrev_b32 v62, 16, v133
    v_and_b32 v63, 0xffff0000, v133
    v_pk_add_f32 v[60:61], v[60:61], v[128:129]
    v_pk_add_f32 v[62:63], v[62:63], v[130:131]
    v_cvt_pk_bf16_f32 v162, v60, v61
    v_cvt_pk_bf16_f32 v163, v62, v63
    ds_write_b64 v168, v[162:163] offset:2336
    v_lshlrev_b32 v131, 16, v28
    v_and_b32 v130, 0xffff0000, v28
    v_lshlrev_b32 v129, 16, v29
    v_and_b32 v128, 0xffff0000, v29
    v_pk_mul_f32 v[128:129], v[128:129], v[170:171]
    v_pk_mul_f32 v[130:131], v[130:131], v[170:171]
    v_cvt_pk_bf16_f32 v132, v128, v129
    v_lshlrev_b32 v128, 16, v132
    v_and_b32 v129, 0xffff0000, v132
    v_cvt_pk_bf16_f32 v133, v130, v131
    v_lshlrev_b32 v130, 16, v133
    v_and_b32 v131, 0xffff0000, v133
    v_cvt_pk_bf16_f32 v132, v64, v65
    v_lshlrev_b32 v64, 16, v132
    v_and_b32 v65, 0xffff0000, v132
    v_cvt_pk_bf16_f32 v133, v66, v67
    v_lshlrev_b32 v66, 16, v133
    v_and_b32 v67, 0xffff0000, v133
    v_pk_add_f32 v[64:65], v[64:65], v[128:129]
    v_pk_add_f32 v[66:67], v[66:67], v[130:131]
    v_cvt_pk_bf16_f32 v164, v64, v65
    v_cvt_pk_bf16_f32 v165, v66, v67
    ds_write_b64 v168, v[164:165] offset:3456
    v_lshlrev_b32 v131, 16, v30
    v_and_b32 v130, 0xffff0000, v30
    v_lshlrev_b32 v129, 16, v31
    v_and_b32 v128, 0xffff0000, v31
    v_pk_mul_f32 v[128:129], v[128:129], v[170:171]
    v_pk_mul_f32 v[130:131], v[130:131], v[170:171]
    v_cvt_pk_bf16_f32 v132, v128, v129
    v_lshlrev_b32 v128, 16, v132
    v_and_b32 v129, 0xffff0000, v132
    v_cvt_pk_bf16_f32 v133, v130, v131
    v_lshlrev_b32 v130, 16, v133
    v_and_b32 v131, 0xffff0000, v133
    v_cvt_pk_bf16_f32 v132, v68, v69
    v_lshlrev_b32 v68, 16, v132
    v_and_b32 v69, 0xffff0000, v132
    v_cvt_pk_bf16_f32 v133, v70, v71
    v_lshlrev_b32 v70, 16, v133
    v_and_b32 v71, 0xffff0000, v133
    v_pk_add_f32 v[68:69], v[68:69], v[128:129]
    v_pk_add_f32 v[70:71], v[70:71], v[130:131]
    v_cvt_pk_bf16_f32 v166, v68, v69
    v_cvt_pk_bf16_f32 v167, v70, v71
    ds_write_b64 v168, v[166:167] offset:3488
    s_add_u32 s12, s4, 0x1c00000
    s_addc_u32 s13, s5, 0
    s_mov_b32 s14, 0x400000
    s_mov_b32 s15, 0x20000
    v_bfe_u32 v6, v1, 2, 2
    v_mul_u32_u24 v172, 24640, v6
    v_lshrrev_b32 v6, 1, v36
    v_mul_u32_u24 v6, 72, v6
    v_add_u32 v172, v172, v6
    v_and_b32 v6, 1, v36
    v_lshl_add_u32 v172, v6, 5, v172
    v_and_b32 v6, 3, v1
    v_lshl_add_u32 v172, v6, 3, v172
    s_mul_i32 s36, s30, 1152
    v_add_u32 v172, s36, v172
    v_lshlrev_b32 v173, 3, v1
    s_lshl_b32 s36, s38, 14
    s_lshl_b32 s37, s30, 12
    s_add_u32 s36, s36, s37
    v_mov_b32 v8, 162824
    v_mov_b32 v9, 1
    s_waitcnt lgkmcnt(0)
    s_mov_b64 exec, 1
    ds_add_u32 v8, v9
    s_mov_b64 exec, -1
    v_mov_b32 v8, 162824
spin_5:
    ds_read_b32 v9, v8
    s_waitcnt lgkmcnt(0)
    v_readfirstlane_b32 s53, v9
    s_nop 0
    s_cmp_ge_u32 s53, 4
    s_cbranch_scc0 spin_5
    ds_read_b64_tr_b16 v[104:105], v172 offset:0
    ds_read_b64_tr_b16 v[106:107], v172 offset:144
    ds_read_b64_tr_b16 v[108:109], v172 offset:288
    ds_read_b64_tr_b16 v[110:111], v172 offset:432
    ds_read_b64_tr_b16 v[112:113], v172 offset:576
    ds_read_b64_tr_b16 v[114:115], v172 offset:720
    ds_read_b64_tr_b16 v[116:117], v172 offset:864
    ds_read_b64_tr_b16 v[118:119], v172 offset:1008
    s_waitcnt lgkmcnt(7)
    buffer_store_dwordx2 v[104:105], v173, s[12:15], s36 offen offset:0 sc1
    s_waitcnt lgkmcnt(6)
    buffer_store_dwordx2 v[106:107], v173, s[12:15], s36 offen offset:512 sc1
    s_waitcnt lgkmcnt(5)
    buffer_store_dwordx2 v[108:109], v173, s[12:15], s36 offen offset:1024 sc1
    s_waitcnt lgkmcnt(4)
    buffer_store_dwordx2 v[110:111], v173, s[12:15], s36 offen offset:1536 sc1
    s_waitcnt lgkmcnt(3)
    buffer_store_dwordx2 v[112:113], v173, s[12:15], s36 offen offset:2048 sc1
    s_waitcnt lgkmcnt(2)
    buffer_store_dwordx2 v[114:115], v173, s[12:15], s36 offen offset:2560 sc1
    s_waitcnt lgkmcnt(1)
    buffer_store_dwordx2 v[116:117], v173, s[12:15], s36 offen offset:3072 sc1
    s_waitcnt lgkmcnt(0)
    buffer_store_dwordx2 v[118:119], v173, s[12:15], s36 offen offset:3584 sc1
    s_and_b32 s36, s2, 7
    s_lshl_b32 s36, s36, 7
    s_add_u32 s36, s36, 23101440
    v_mov_b32 v6, 1
    v_mov_b32 v7, 162820
    v_lshlrev_b32 v9, 10, v1
    s_mov_b64 exec, 1
    s_waitcnt vmcnt(0)
    s_waitcnt lgkmcnt(0)
    ds_add_rtn_u32 v8, v7, v6
    ds_read_b32 v10, v7 offset:28
    s_waitcnt lgkmcnt(0)
    v_readfirstlane_b32 s54, v8
    v_readfirstlane_b32 s53, v10
    s_cmp_lg_u32 s54, 15
    s_cbranch_scc1 fa_6
    s_mov_b64 exec, 0xffff
    s_or_b32 s53, s53, 1
    v_mov_b32 v6, s53
    buffer_atomic_add v6, v9, s[56:59], s36 offen sc1
fa_6:
    s_mov_b64 exec, -1
    s_branch FR_end
FR_b:
    s_getpc_b64 s[34:35]
K_tpc:
    s_lshl_b32 s36, s29, 2
    s_and_b32 s37, s28, 3
    s_add_u32 s36, s36, s37
    s_lshl_b32 s36, s36, 6
    s_add_u32 s36, s36, K_tab-K_tpc
    s_add_u32 s34, s34, s36
    s_addc_u32 s35, s35, 0
    v_and_b32 v248, 31, v1
    v_lshlrev_b32 v248, 1, v248
    global_load_ushort v251, v248, s[34:35]
    v_lshrrev_b32 v253, 3, v1
    v_lshlrev_b32 v238, 11, v253
    v_and_b32 v253, 6, v253
    v_and_b32 v254, 7, v1
    v_xor_b32 v253, v253, v254
    v_lshl_add_u32 v238, v253, 4, v238
    v_lshrrev_b32 v253, 4, v1
    v_lshlrev_b32 v239, 11, v253
    v_add_u32 v253, 0, v253
    v_lshlrev_b32 v253, 1, v253
    v_and_b32 v254, 15, v1
    v_xor_b32 v253, v253, v254
    v_lshl_add_u32 v239, v253, 4, v239
    v_lshrrev_b32 v253, 4, v1
    v_lshlrev_b32 v240, 11, v253
    v_add_u32 v253, 4, v253
    v_lshlrev_b32 v253, 1, v253
    v_and_b32 v254, 15, v1
    v_xor_b32 v253, v253, v254
    v_lshl_add_u32 v240, v253, 4, v240
    v_add_u32 v254, 0, v1
    v_mul_u32_u24 v253, 2341, v254
    v_lshrrev_b32 v253, 16, v253
    v_mul_u32_u24 v241, 28, v253
    v_sub_u32 v254, v254, v241
    v_mul_u32_u24 v241, 7168, v253
    v_lshrrev_b32 v253, 1, v253
    v_and_b32 v253, 2, v253
    v_xor_b32 v254, v254, v253
    v_lshl_add_u32 v241, v254, 4, v241
    v_add_u32 v254, 64, v1
    v_mul_u32_u24 v253, 2341, v254
    v_lshrrev_b32 v253, 16, v253
    v_mul_u32_u24 v242, 28, v253
    v_sub_u32 v254, v254, v242
    v_mul_u32_u24 v242, 7168, v253
    v_lshrrev_b32 v253, 1, v253
    v_and_b32 v253, 2, v253
    v_xor_b32 v254, v254, v253
    v_lshl_add_u32 v242, v254, 4, v242
    v_add_u32 v254, 128, v1
    v_mul_u32_u24 v253, 2341, v254
    v_lshrrev_b32 v253, 16, v253
    v_mul_u32_u24 v243, 28, v253
    v_sub_u32 v254, v254, v243
    v_mul_u32_u24 v243, 7168, v253
    v_lshrrev_b32 v253, 1, v253
    v_and_b32 v253, 2, v253
    v_xor_b32 v254, v254, v253
    v_lshl_add_u32 v243, v254, 4, v243
    v_add_u32 v254, 192, v1
    v_mul_u32_u24 v253, 2341, v254
    v_lshrrev_b32 v253, 16, v253
    v_mul_u32_u24 v244, 28, v253
    v_sub_u32 v254, v254, v244
    v_mul_u32_u24 v244, 7168, v253
    v_lshrrev_b32 v253, 1, v253
    v_and_b32 v253, 2, v253
    v_xor_b32 v254, v254, v253
    v_lshl_add_u32 v244, v254, 4, v244
    v_add_u32 v254, 256, v1
    v_mul_u32_u24 v253, 2341, v254
    v_lshrrev_b32 v253, 16, v253
    v_mul_u32_u24 v245, 28, v253
    v_sub_u32 v254, v254, v245
    v_mul_u32_u24 v245, 7168, v253
    v_lshrrev_b32 v253, 1, v253
    v_and_b32 v253, 2, v253
    v_xor_b32 v254, v254, v253
    v_lshl_add_u32 v245, v254, 4, v245
    v_add_u32 v254, 320, v1
    v_mul_u32_u24 v253, 2341, v254
    v_lshrrev_b32 v253, 16, v253
    v_mul_u32_u24 v246, 28, v253
    v_sub_u32 v254, v254, v246
    v_mul_u32_u24 v246, 7168, v253
    v_lshrrev_b32 v253, 1, v253
    v_and_b32 v253, 2, v253
    v_xor_b32 v254, v254, v253
    v_lshl_add_u32 v246, v254, 4, v246
    v_add_u32 v254, 384, v1
    v_mul_u32_u24 v253, 2341, v254
    v_lshrrev_b32 v253, 16, v253
    v_mul_u32_u24 v247, 28, v253
    v_sub_u32 v254, v254, v247
    v_mul_u32_u24 v247, 7168, v253
    v_lshrrev_b32 v253, 1, v253
    v_and_b32 v253, 2, v253
    v_xor_b32 v254, v254, v253
    v_lshl_add_u32 v247, v254, 4, v247
    s_cmp_ge_u32 s30, 6
    s_cbranch_scc1 FB_cs
    s_cmp_ge_u32 s2, 255
    s_cbranch_scc1 FB_np
    s_cmp_lg_u32 s30, 5
    s_cbranch_scc1 FB_np
    s_and_b32 s42, s2, 31
    s_lshl_b32 s42, s42, 8
    s_lshr_b32 s43, s2, 5
    s_lshl_b32 s43, s43, 14
    s_add_u32 s42, s42, s43
    s_add_u32 s42, s42, 35520512
    v_mov_b32 v14, 0
    s_mov_b64 exec, 1
    s_mov_b32 s46, -1
    s_mov_b32 s47, -1
    s_mov_b32 s43, 0
FB_ml:
    s_add_u32 s45, s42, 0
    s_memtime s[34:35]
    s_waitcnt lgkmcnt(0)
    buffer_load_dword v13, v14, s[56:59], s45 offen sc1
    s_waitcnt vmcnt(0)
    s_memtime s[36:37]
    s_waitcnt lgkmcnt(0)
    s_sub_u32 s36, s36, s34
    s_min_u32 s46, s46, s36
    s_add_u32 s45, s42, 8192
    s_memtime s[34:35]
    s_waitcnt lgkmcnt(0)
    buffer_load_dword v13, v14, s[56:59], s45 offen sc1
    s_waitcnt vmcnt(0)
    s_memtime s[36:37]
    s_waitcnt lgkmcnt(0)
    s_sub_u32 s36, s36, s34
    s_min_u32 s47, s47, s36
    s_add_u32 s42, s42, 128
    s_add_u32 s43, s43, 1
    s_cmp_lt_u32 s43, 2
    s_cbranch_scc1 FB_ml
    s_cmp_lt_u32 s47, s46
    s_cselect_b32 s45, 1, 0
    s_lshr_b32 s46, s28, 2
    s_xor_b32 s45, s45, s46
    s_and_b32 s45, s45, 1
    s_lshl_b32 s45, s45, 8
    s_mov_b64 exec, -1
    v_mov_b32 v6, 162848
    v_mov_b32 v7, s45
    s_waitcnt lgkmcnt(0)
    ds_write_b32 v6, v7
FB_np:
    s_cmp_lg_u32 s30, 4
    s_cbranch_scc1 FB_ni
    v_mov_b32 v12, s52
    s_lshr_b32 s53, s28, 3
    s_lshl_b32 s53, s53, 2
    s_and_b32 s54, s28, 3
    s_add_u32 s53, s53, s54
    s_lshl_b32 s53, s53, 23
    s_lshr_b32 s54, s28, 2
    s_xor_b32 s54, s54, s94
    s_and_b32 s54, s54, 1
    s_lshl_b32 s54, s54, 13
    s_add_u32 s37, s53, s54
    s_add_u32 s37, s37, 33554432
    s_andn2_b32 s37, s37, 0x2000
    s_lshl_b32 s53, s29, 7
    s_add_u32 s37, s37, s53
    s_add_u32 s37, s37, 1835008
    v_and_b32 v13, 1, v1
    v_lshlrev_b32 v13, 13, v13
    v_lshrrev_b32 v14, 1, v1
    v_lshl_add_u32 v13, v14, 26, v13
    s_mov_b64 exec, 0xf
    buffer_store_dword v12, v13, s[56:59], s37 offen sc1
    s_cmp_lg_u32 s28, 0
    s_cbranch_scc1 FB_n2
    s_add_u32 s37, s53, 23117824
    s_mov_b64 exec, 1
    buffer_store_dword v12, v13, s[56:59], s37 offen sc1
FB_n2:
    s_mov_b64 exec, -1
    v_mov_b32 v16, 0
    v_mov_b32 v17, 0
    v_mov_b32 v18, 0
    v_mov_b32 v19, 0
    s_lshr_b32 s36, s2, 7
    s_lshl_b32 s36, s36, 24
    s_add_u32 s36, s36, 167772160
    s_add_u32 s20, s4, s36
    s_addc_u32 s21, s5, 0
    s_mov_b32 s22, 8388608
    s_mov_b32 s23, 0x20000
    s_and_b32 s36, s2, 127
    s_mul_i32 s36, s36, 65536
    s_add_u32 s36, s36, 16352
    v_and_b32 v13, 1, v1
    v_lshlrev_b32 v13, 4, v13
    v_bfe_u32 v14, v1, 1, 1
    v_lshl_add_u32 v13, v14, 13, v13
    v_bfe_u32 v14, v1, 2, 1
    v_mul_u32_u24 v14, 32800, v14
    v_add_u32 v13, v13, v14
    s_mov_b64 exec, 0xff
    buffer_store_dwordx4 v[16:19], v13, s[20:23], s36 offen sc1
    s_mov_b64 exec, -1
FB_ni:
    v_mov_b32 v6, 162832
spin_7:
    s_sleep 2
    ds_read_b32 v7, v6
    s_waitcnt lgkmcnt(0)
    v_readfirstlane_b32 s53, v7
    s_nop 0
    s_cmp_ge_u32 s53, 1
    s_cbranch_scc0 spin_7
    s_load_dwordx2 s[48:49], s[0:1], 64
    s_lshl_b32 s45, s2, 1
    s_and_b32 s50, s30, 1
    s_add_u32 s45, s45, s50
    s_mul_i32 s45, s45, 4096
    s_mov_b32 s50, 2097152
    s_mov_b32 s51, 0x20000
    s_waitcnt lgkmcnt(0)
    buffer_load_dwordx4 v[232:235], v2, s[48:51], s45 offen offset:0
    buffer_load_dwordx4 v[232:235], v2, s[48:51], s45 offen offset:1024
    buffer_load_dwordx4 v[232:235], v2, s[48:51], s45 offen offset:2048
    buffer_load_dwordx4 v[232:235], v2, s[48:51], s45 offen offset:3072
    s_and_b32 s36, s2, 7
    s_lshl_b32 s36, s36, 7
    s_add_u32 s36, s36, 23101440
    v_mov_b32 v6, 1
    v_mov_b32 v7, 162820
    v_lshlrev_b32 v9, 10, v1
    s_mov_b64 exec, 1
    s_waitcnt vmcnt(0)
    s_waitcnt lgkmcnt(0)
    ds_add_rtn_u32 v8, v7, v6
    ds_read_b32 v10, v7 offset:28
    s_waitcnt lgkmcnt(0)
    v_readfirstlane_b32 s54, v8
    v_readfirstlane_b32 s53, v10
    s_cmp_lg_u32 s54, 15
    s_cbranch_scc1 fa_8
    s_mov_b64 exec, 0xffff
    s_or_b32 s53, s53, 1
    v_mov_b32 v6, s53
    buffer_atomic_add v6, v9, s[56:59], s36 offen sc1
fa_8:
    s_mov_b64 exec, -1
    v_bfe_u32 v252, v251, 2, 2
    v_lshlrev_b32 v248, 14, v252
    v_and_b32 v252, 3, v251
    v_lshl_add_u32 v248, v252, 11, v248
    v_bfe_u32 v252, v251, 7, 3
    v_lshlrev_b32 v249, 14, v252
    v_bfe_u32 v252, v251, 4, 3
    v_lshl_add_u32 v249, v252, 10, v249
    v_bfe_u32 v252, v251, 13, 3
    v_lshlrev_b32 v250, 14, v252
    v_bfe_u32 v252, v251, 10, 3
    v_lshl_add_u32 v250, v252, 10, v250
    v_mov_b32 v6, 162840
spin_9:
    s_sleep 4
    ds_read_b32 v7, v6
    s_waitcnt lgkmcnt(0)
    v_readfirstlane_b32 s53, v7
    s_nop 0
    s_cmp_ge_u32 s53, 2
    s_cbranch_scc0 spin_9
    s_call_b64 s[76:77], SUB_park
    v_mov_b32 v6, 162840
spin_10:
    s_sleep 3
    ds_read_b32 v7, v6
    s_waitcnt lgkmcnt(0)
    v_readfirstlane_b32 s53, v7
    s_nop 0
    s_cmp_ge_u32 s53, 4
    s_cbranch_scc0 spin_10
    s_mov_b64 s[12:13], s[68:69]
    s_mov_b32 s14, 2097152
    s_mov_b32 s15, 0x20000
    s_and_b32 s35, s30, 1
    s_mul_i32 s38, s29, 128
    s_mul_i32 s41, s35, 65536
    s_add_u32 s38, s38, s41
    s_mul_i32 s41, s35, 4096
    s_add_u32 s41, s41, 24576
    s_mov_b32 s42, 0
    s_mov_b32 s44, s67
    s_mov_b32 s42, 73728
    s_mov_b32 s44, s67
    s_add_u32 s44, s44, 9
    s_and_b32 s44, s44, 15
    s_call_b64 s[76:77], SUB_w_issue_1
    s_waitcnt vmcnt(8)
    s_mov_b32 s42, 81920
    s_mov_b32 s44, s67
    s_add_u32 s44, s44, 10
    s_and_b32 s44, s44, 15
    s_call_b64 s[76:77], SUB_w_issue_1
    s_waitcnt vmcnt(8)
    s_mov_b32 s42, 90112
    s_mov_b32 s44, s67
    s_add_u32 s44, s44, 11
    s_and_b32 s44, s44, 15
    s_call_b64 s[76:77], SUB_w_issue_1
    s_waitcnt vmcnt(8)
    s_mov_b32 s42, 98304
    s_mov_b32 s44, s67
    s_add_u32 s44, s44, 12
    s_and_b32 s44, s44, 15
    s_call_b64 s[76:77], SUB_w_issue_1
    s_waitcnt vmcnt(8)
    s_mov_b32 s42, 106496
    s_mov_b32 s44, s67
    s_add_u32 s44, s44, 13
    s_and_b32 s44, s44, 15
    s_call_b64 s[76:77], SUB_w_issue_1
    s_waitcnt vmcnt(8)
    s_mov_b32 s42, 114688
    s_mov_b32 s44, s67
    s_add_u32 s44, s44, 14
    s_and_b32 s44, s44, 15
    s_call_b64 s[76:77], SUB_w_issue_1
    s_waitcnt vmcnt(8)
    s_mov_b32 s42, 122880
    s_mov_b32 s44, s67
    s_add_u32 s44, s44, 15
    s_and_b32 s44, s44, 15
    s_call_b64 s[76:77], SUB_w_issue_1
    s_waitcnt vmcnt(8)
    v_mov_b32 v6, 162820
spin_11:
    s_sleep 3
    ds_read_b32 v7, v6
    s_waitcnt lgkmcnt(0)
    v_readfirstlane_b32 s53, v7
    s_nop 0
    s_cmp_ge_u32 s53, 16
    s_cbranch_scc0 spin_11
    s_mov_b32 s42, 32768
    s_mov_b32 s44, s67
    s_add_u32 s44, s44, 4
    s_and_b32 s44, s44, 15
    s_call_b64 s[76:77], SUB_w_issue_1
    s_waitcnt vmcnt(8)
    s_mov_b32 s42, 40960
    s_mov_b32 s44, s67
    s_add_u32 s44, s44, 5
    s_and_b32 s44, s44, 15
    s_call_b64 s[76:77], SUB_w_issue_1
    s_waitcnt vmcnt(8)
    s_mov_b32 s42, 49152
    s_mov_b32 s44, s67
    s_add_u32 s44, s44, 6
    s_and_b32 s44, s44, 15
    s_call_b64 s[76:77], SUB_w_issue_1
    s_waitcnt vmcnt(8)
    s_mov_b32 s42, 57344
    s_mov_b32 s44, s67
    s_add_u32 s44, s44, 7
    s_and_b32 s44, s44, 15
    s_call_b64 s[76:77], SUB_w_issue_1
    s_waitcnt vmcnt(8)
    s_mov_b32 s42, 65536
    s_mov_b32 s44, s67
    s_add_u32 s44, s44, 8
    s_and_b32 s44, s44, 15
    s_call_b64 s[76:77], SUB_w_issue_1
    s_waitcnt vmcnt(8)
    s_branch FR_end
FB_cs:
    v_and_b32 v164, 15, v1
    v_mov_b32 v165, 0x3f803f80
    v_cmp_eq_u32 vcc, 0, v164
    s_nop 1
    v_cndmask_b32 v16, 0, v165, vcc
    v_cndmask_b32 v17, 0, v165, vcc
    v_cndmask_b32 v18, 0, v165, vcc
    v_cndmask_b32 v19, 0, v165, vcc
    v_cmp_eq_u32 vcc, 1, v164
    s_nop 1
    v_cndmask_b32 v20, 0, v165, vcc
    v_cndmask_b32 v21, 0, v165, vcc
    v_cndmask_b32 v22, 0, v165, vcc
    v_cndmask_b32 v23, 0, v165, vcc
    v_cmp_eq_u32 vcc, 2, v164
    s_nop 1
    v_cndmask_b32 v24, 0, v165, vcc
    v_cndmask_b32 v25, 0, v165, vcc
    v_cndmask_b32 v26, 0, v165, vcc
    v_cndmask_b32 v27, 0, v165, vcc
    v_cmp_eq_u32 vcc, 3, v164
    s_nop 1
    v_cndmask_b32 v28, 0, v165, vcc
    v_cndmask_b32 v29, 0, v165, vcc
    v_cndmask_b32 v30, 0, v165, vcc
    v_cndmask_b32 v31, 0, v165, vcc
    v_cmp_eq_u32 vcc, 4, v164
    s_nop 1
    v_cndmask_b32 v32, 0, v165, vcc
    v_cndmask_b32 v33, 0, v165, vcc
    v_cndmask_b32 v34, 0, v165, vcc
    v_cndmask_b32 v35, 0, v165, vcc
    v_cmp_eq_u32 vcc, 5, v164
    s_nop 1
    v_cndmask_b32 v36, 0, v165, vcc
    v_cndmask_b32 v37, 0, v165, vcc
    v_cndmask_b32 v38, 0, v165, vcc
    v_cndmask_b32 v39, 0, v165, vcc
    v_cmp_eq_u32 vcc, 6, v164
    s_nop 1
    v_cndmask_b32 v40, 0, v165, vcc
    v_cndmask_b32 v41, 0, v165, vcc
    v_cndmask_b32 v42, 0, v165, vcc
    v_cndmask_b32 v43, 0, v165, vcc
    v_cmp_eq_u32 vcc, 7, v164
    s_nop 1
    v_cndmask_b32 v44, 0, v165, vcc
    v_cndmask_b32 v45, 0, v165, vcc
    v_cndmask_b32 v46, 0, v165, vcc
    v_cndmask_b32 v47, 0, v165, vcc
    v_cmp_eq_u32 vcc, 8, v164
    s_nop 1
    v_cndmask_b32 v48, 0, v165, vcc
    v_cndmask_b32 v49, 0, v165, vcc
    v_cndmask_b32 v50, 0, v165, vcc
    v_cndmask_b32 v51, 0, v165, vcc
    v_cmp_eq_u32 vcc, 9, v164
    s_nop 1
    v_cndmask_b32 v52, 0, v165, vcc
    v_cndmask_b32 v53, 0, v165, vcc
    v_cndmask_b32 v54, 0, v165, vcc
    v_cndmask_b32 v55, 0, v165, vcc
    v_cmp_eq_u32 vcc, 10, v164
    s_nop 1
    v_cndmask_b32 v56, 0, v165, vcc
    v_cndmask_b32 v57, 0, v165, vcc
    v_cndmask_b32 v58, 0, v165, vcc
    v_cndmask_b32 v59, 0, v165, vcc
    v_cmp_eq_u32 vcc, 11, v164
    s_nop 1
    v_cndmask_b32 v60, 0, v165, vcc
    v_cndmask_b32 v61, 0, v165, vcc
    v_cndmask_b32 v62, 0, v165, vcc
    v_cndmask_b32 v63, 0, v165, vcc
    v_cmp_eq_u32 vcc, 12, v164
    s_nop 1
    v_cndmask_b32 v64, 0, v165, vcc
    v_cndmask_b32 v65, 0, v165, vcc
    v_cndmask_b32 v66, 0, v165, vcc
    v_cndmask_b32 v67, 0, v165, vcc
    v_cmp_eq_u32 vcc, 13, v164
    s_nop 1
    v_cndmask_b32 v68, 0, v165, vcc
    v_cndmask_b32 v69, 0, v165, vcc
    v_cndmask_b32 v70, 0, v165, vcc
    v_cndmask_b32 v71, 0, v165, vcc
    s_mov_b32 s35, 0
    v_lshrrev_b32 v253, 2, v1
    v_mul_u32_u24 v144, 128, v253
    v_and_b32 v254, 3, v1
    v_lshl_add_u32 v144, v254, 3, v144
    v_add_u32 v144, 24576, v144
    v_bfe_u32 v253, v253, 1, 2
    s_mul_i32 s36, s35, 4
    s_add_u32 s36, s36, 3
    v_xor_b32 v254, s36, v253
    v_lshl_add_u32 v147, v254, 5, v144
    s_mul_i32 s36, s35, 4
    s_add_u32 s36, s36, 2
    v_xor_b32 v254, s36, v253
    v_lshl_add_u32 v146, v254, 5, v144
    s_mul_i32 s36, s35, 4
    s_add_u32 s36, s36, 1
    v_xor_b32 v254, s36, v253
    v_lshl_add_u32 v145, v254, 5, v144
    s_mul_i32 s36, s35, 4
    s_add_u32 s36, s36, 0
    v_xor_b32 v254, s36, v253
    v_lshl_add_u32 v144, v254, 5, v144
    s_and_b32 s35, s30, 1
    s_mul_i32 s35, s35, 4096
    s_add_u32 s35, s35, 73728
    v_add_u32 v144, s35, v144
    v_add_u32 v145, s35, v145
    v_add_u32 v146, s35, v146
    v_add_u32 v147, s35, v147
    s_mov_b32 s35, 0
    v_lshrrev_b32 v253, 2, v1
    v_mul_u32_u24 v148, 448, v253
    v_and_b32 v254, 3, v1
    v_lshl_add_u32 v148, v254, 3, v148
    v_add_u32 v148, 73728, v148
    s_mul_i32 s36, s35, 224
    v_add_u32 v148, s36, v148
    v_bfe_u32 v253, v1, 4, 1
    v_lshlrev_b32 v253, 5, v253
    s_cmp_eq_u32 s35, 0
    s_cselect_b32 s36, 1, -1
    v_mul_lo_u32 v253, v253, s36
    v_sub_u32 v149, v148, v253
    v_add_u32 v148, v148, v253
    s_and_b32 s35, s30, 1
    s_mul_i32 s35, s35, 14336
    s_add_u32 s35, s35, 32768
    v_add_u32 v148, s35, v148
    v_add_u32 v149, s35, v149
    s_mov_b32 s35, 1
    v_lshrrev_b32 v253, 2, v1
    v_mul_u32_u24 v150, 448, v253
    v_and_b32 v254, 3, v1
    v_lshl_add_u32 v150, v254, 3, v150
    v_add_u32 v150, 73728, v150
    s_mul_i32 s36, s35, 224
    v_add_u32 v150, s36, v150
    v_bfe_u32 v253, v1, 4, 1
    v_lshlrev_b32 v253, 5, v253
    s_cmp_eq_u32 s35, 0
    s_cselect_b32 s36, 1, -1
    v_mul_lo_u32 v253, v253, s36
    v_sub_u32 v151, v150, v253
    v_add_u32 v150, v150, v253
    s_and_b32 s35, s30, 1
    s_mul_i32 s35, s35, 14336
    s_add_u32 s35, s35, 32768
    v_add_u32 v150, s35, v150
    v_add_u32 v151, s35, v151
    v_mov_b32 v156, 0
    v_mov_b32 v157, 0
    v_mov_b32 v158, 0
    v_mov_b32 v159, 0
    v_mov_b32 v160, 0
    v_mov_b32 v161, 0
    v_mov_b32 v162, 0
    v_mov_b32 v163, 0
    v_lshrrev_b32 v166, 4, v1
    v_lshlrev_b32 v166, 4, v166
    v_lshl_add_u32 v166, v164, 6, v166
    v_mov_b32 v165, 0x7f000000
    v_cmp_gt_u32 vcc, 4, v164
    s_nop 1
    v_cndmask_b32 v167, v165, v166, vcc
    v_cmp_gt_u32 vcc, 14, v164
    s_nop 1
    v_cndmask_b32 v168, v165, v166, vcc
    v_mov_b32 v6, 162832
spin_12:
    s_sleep 2
    ds_read_b32 v7, v6
    s_waitcnt lgkmcnt(0)
    v_readfirstlane_b32 s53, v7
    s_nop 0
    s_cmp_ge_u32 s53, 1
    s_cbranch_scc0 spin_12
    s_mov_b64 s[12:13], s[68:69]
    s_mov_b32 s14, 2097152
    s_mov_b32 s15, 0x20000
    s_and_b32 s35, s30, 1
    s_mul_i32 s38, s29, 128
    s_mul_i32 s41, s35, 65536
    s_add_u32 s38, s38, s41
    s_mul_i32 s41, s35, 4096
    s_add_u32 s41, s41, 24576
    s_mov_b32 s42, 0
    s_mov_b32 s44, s67
    s_mov_b32 s42, 73728
    s_mov_b32 s44, s28
    s_add_u32 s19, s41, s42
    s_mul_i32 s16, s44, 131072
    s_add_u32 s16, s16, s38
    s_add_u32 s44, s44, 1
    s_and_b32 s44, s44, 15
    s_add_u32 s42, s42, 8192
    s_cmp_eq_u32 s42, 131072
    s_cselect_b32 s42, 0, s42
    s_mov_b32 m0, s19
    s_mov_b32 s39, s16
    buffer_load_dwordx4 v238, s[12:15], s39 offen lds
    s_add_u32 m0, m0, 1024
    s_add_u32 s39, s39, 16384
    buffer_load_dwordx4 v238, s[12:15], s39 offen lds
    s_add_u32 m0, m0, 1024
    s_add_u32 s39, s39, 16384
    buffer_load_dwordx4 v238, s[12:15], s39 offen lds
    s_add_u32 m0, m0, 1024
    s_add_u32 s39, s39, 16384
    buffer_load_dwordx4 v238, s[12:15], s39 offen lds
    s_mov_b64 s[12:13], s[72:73]
    s_mov_b32 s14, 7340032
    s_mov_b32 s15, 0x20000
    s_and_b32 s35, s30, 1
    s_mul_i32 s38, s29, 448
    s_mul_i32 s41, s35, 229376
    s_add_u32 s38, s38, s41
    s_mul_i32 s41, s35, 14336
    s_add_u32 s41, s41, 73728
    s_mov_b32 s42, 0
    s_mov_b32 s44, 0
    s_mov_b32 s42, 32768
    s_mov_b32 s44, s28
    s_add_u32 s19, s41, s42
    s_mul_i32 s16, s44, 458752
    s_add_u32 s16, s16, s38
    s_add_u32 s44, s44, 1
    s_and_b32 s44, s44, 15
    s_add_u32 s42, s42, 28672
    s_cmp_eq_u32 s42, 86016
    s_cselect_b32 s42, 0, s42
    s_mov_b32 m0, s19
    s_mov_b32 s39, s16
    buffer_load_dwordx4 v241, s[12:15], s39 offen lds
    s_add_u32 m0, m0, 1024
    s_nop 0
    buffer_load_dwordx4 v242, s[12:15], s39 offen lds
    s_add_u32 m0, m0, 1024
    s_nop 0
    buffer_load_dwordx4 v243, s[12:15], s39 offen lds
    s_add_u32 m0, m0, 1024
    s_nop 0
    buffer_load_dwordx4 v244, s[12:15], s39 offen lds
    s_add_u32 m0, m0, 1024
    s_nop 0
    buffer_load_dwordx4 v245, s[12:15], s39 offen lds
    s_add_u32 m0, m0, 1024
    s_nop 0
    buffer_load_dwordx4 v246, s[12:15], s39 offen lds
    s_add_u32 m0, m0, 1024
    s_nop 0
    buffer_load_dwordx4 v247, s[12:15], s39 offen lds
    s_add_u32 m0, m0, 1024
    s_add_u32 s39, s39, 114688
    buffer_load_dwordx4 v241, s[12:15], s39 offen lds
    s_add_u32 m0, m0, 1024
    s_nop 0
    buffer_load_dwordx4 v242, s[12:15], s39 offen lds
    s_add_u32 m0, m0, 1024
    s_nop 0
    buffer_load_dwordx4 v243, s[12:15], s39 offen lds
    s_add_u32 m0, m0, 1024
    s_nop 0
    buffer_load_dwordx4 v244, s[12:15], s39 offen lds
    s_add_u32 m0, m0, 1024
    s_nop 0
    buffer_load_dwordx4 v245, s[12:15], s39 offen lds
    s_add_u32 m0, m0, 1024
    s_nop 0
    buffer_load_dwordx4 v246, s[12:15], s39 offen lds
    s_add_u32 m0, m0, 1024
    s_nop 0
    buffer_load_dwordx4 v247, s[12:15], s39 offen lds
    s_waitcnt vmcnt(14)
    ds_read_b64_tr_b16 v[128:129], v144 offset:0
    ds_read_b64_tr_b16 v[130:131], v144 offset:2048
    ds_read_b64_tr_b16 v[132:133], v145 offset:0
    ds_read_b64_tr_b16 v[134:135], v145 offset:2048
    ds_read_b64_tr_b16 v[136:137], v146 offset:0
    ds_read_b64_tr_b16 v[138:139], v146 offset:2048
    ds_read_b64_tr_b16 v[140:141], v147 offset:0
    ds_read_b64_tr_b16 v[142:143], v147 offset:2048
    s_add_u32 s20, s4, 0x1400000
    s_addc_u32 s21, s5, 0
    s_mov_b32 s22, 0x20000
    s_mov_b32 s23, 0x20000
    s_lshl_b32 s35, s28, 1
    s_and_b32 s36, s30, 1
    s_add_u32 s35, s35, s36
    s_mul_i32 s35, s35, 4096
    s_mul_i32 s36, s29, 256
    s_add_u32 s35, s35, s36
    s_waitcnt lgkmcnt(0)
    v_mfma_f32_16x16x32_bf16 v[160:163], v[128:131], v[16:19], v[160:163]
    v_mfma_f32_16x16x32_bf16 v[160:163], v[132:135], v[20:23], v[160:163]
    v_mfma_f32_16x16x32_bf16 v[160:163], v[136:139], v[24:27], v[160:163]
    v_mfma_f32_16x16x32_bf16 v[160:163], v[140:143], v[28:31], v[160:163]
    s_nop 7
    buffer_store_dwordx4 v[160:163], v167, s[20:23], s35 offen sc1
    s_waitcnt vmcnt(1)
    v_mov_b32 v6, 162840
    v_mov_b32 v7, 1
    s_mov_b64 exec, 1
    ds_add_u32 v6, v7
    s_mov_b64 exec, -1
    ds_read_b64_tr_b16 v[72:73], v148 offset:0
    ds_read_b64_tr_b16 v[74:75], v148 offset:7168
    ds_read_b64_tr_b16 v[76:77], v149 offset:32
    ds_read_b64_tr_b16 v[78:79], v149 offset:7200
    ds_read_b64_tr_b16 v[80:81], v148 offset:64
    ds_read_b64_tr_b16 v[82:83], v148 offset:7232
    ds_read_b64_tr_b16 v[84:85], v149 offset:96
    ds_read_b64_tr_b16 v[86:87], v149 offset:7264
    ds_read_b64_tr_b16 v[88:89], v148 offset:128
    ds_read_b64_tr_b16 v[90:91], v148 offset:7296
    ds_read_b64_tr_b16 v[92:93], v149 offset:160
    ds_read_b64_tr_b16 v[94:95], v149 offset:7328
    ds_read_b64_tr_b16 v[96:97], v148 offset:192
    ds_read_b64_tr_b16 v[98:99], v148 offset:7360
    ds_read_b64_tr_b16 v[100:101], v150 offset:0
    ds_read_b64_tr_b16 v[102:103], v150 offset:7168
    ds_read_b64_tr_b16 v[104:105], v151 offset:32
    ds_read_b64_tr_b16 v[106:107], v151 offset:7200
    ds_read_b64_tr_b16 v[108:109], v150 offset:64
    ds_read_b64_tr_b16 v[110:111], v150 offset:7232
    ds_read_b64_tr_b16 v[112:113], v151 offset:96
    ds_read_b64_tr_b16 v[114:115], v151 offset:7264
    ds_read_b64_tr_b16 v[116:117], v150 offset:128
    ds_read_b64_tr_b16 v[118:119], v150 offset:7296
    ds_read_b64_tr_b16 v[120:121], v151 offset:160
    ds_read_b64_tr_b16 v[122:123], v151 offset:7328
    ds_read_b64_tr_b16 v[124:125], v150 offset:192
    ds_read_b64_tr_b16 v[126:127], v150 offset:7360
    s_add_u32 s20, s4, 0x1420000
    s_addc_u32 s21, s5, 0
    s_mov_b32 s22, 0x70000
    s_mov_b32 s23, 0x20000
    s_lshl_b32 s35, s28, 1
    s_and_b32 s36, s30, 1
    s_add_u32 s35, s35, s36
    s_mul_i32 s35, s35, 14336
    s_mul_i32 s36, s29, 896
    s_add_u32 s35, s35, s36
    s_waitcnt lgkmcnt(0)
    v_mfma_f32_16x16x32_bf16 v[156:159], v[72:75], v[16:19], v[156:159]
    v_mfma_f32_16x16x32_bf16 v[156:159], v[76:79], v[20:23], v[156:159]
    v_mfma_f32_16x16x32_bf16 v[156:159], v[80:83], v[24:27], v[156:159]
    v_mfma_f32_16x16x32_bf16 v[156:159], v[84:87], v[28:31], v[156:159]
    v_mfma_f32_16x16x32_bf16 v[156:159], v[88:91], v[32:35], v[156:159]
    v_mfma_f32_16x16x32_bf16 v[156:159], v[92:95], v[36:39], v[156:159]
    v_mfma_f32_16x16x32_bf16 v[156:159], v[96:99], v[40:43], v[156:159]
    v_mfma_f32_16x16x32_bf16 v[156:159], v[100:103], v[44:47], v[156:159]
    v_mfma_f32_16x16x32_bf16 v[156:159], v[104:107], v[48:51], v[156:159]
    v_mfma_f32_16x16x32_bf16 v[156:159], v[108:111], v[52:55], v[156:159]
    v_mfma_f32_16x16x32_bf16 v[156:159], v[112:115], v[56:59], v[156:159]
    v_mfma_f32_16x16x32_bf16 v[156:159], v[116:119], v[60:63], v[156:159]
    v_mfma_f32_16x16x32_bf16 v[156:159], v[120:123], v[64:67], v[156:159]
    v_mfma_f32_16x16x32_bf16 v[156:159], v[124:127], v[68:71], v[156:159]
    s_nop 7
    buffer_store_dwordx4 v[156:159], v168, s[20:23], s35 offen sc1
    s_and_b32 s36, s2, 7
    s_lshl_b32 s36, s36, 7
    s_add_u32 s36, s36, 23101440
    v_mov_b32 v6, 1
    v_mov_b32 v7, 162820
    v_lshlrev_b32 v9, 10, v1
    s_mov_b64 exec, 1
    s_waitcnt lgkmcnt(0)
    ds_add_rtn_u32 v8, v7, v6
    ds_read_b32 v10, v7 offset:28
    s_waitcnt lgkmcnt(0)
    v_readfirstlane_b32 s54, v8
    v_readfirstlane_b32 s53, v10
    s_cmp_lg_u32 s54, 15
    s_cbranch_scc1 fa_13
    s_mov_b64 exec, 0xffff
    s_or_b32 s53, s53, 1
    v_mov_b32 v6, s53
    buffer_atomic_add v6, v9, s[56:59], s36 offen sc1
fa_13:
    s_mov_b64 exec, -1
    v_and_b32 v252, 15, v251
    v_mul_u32_u24 v248, 458752, v252
    s_and_b32 s36, s30, 1
    s_mul_i32 s36, s36, 6
    s_add_u32 s36, s36, 4
    v_bfe_u32 v252, v251, s36, 6
    v_mul_u32_u24 v250, 37, v252
    v_lshrrev_b32 v250, 8, v250
    v_mul_u32_u24 v250, 7, v250
    v_sub_u32 v250, v252, v250
    v_cmp_eq_u32 vcc, 3, v250
    s_nop 1
    v_cndmask_b32 v250, 0, 1, vcc
    v_lshl_add_u32 v249, v252, 16, v250
    v_mov_b32 v6, 162840
    v_mov_b32 v7, 1
    s_mov_b64 exec, 1
    ds_add_u32 v6, v7
    s_mov_b64 exec, -1
    s_setprio 0
    s_call_b64 s[76:77], SUB_park
    s_mov_b64 s[12:13], s[68:69]
    s_mov_b32 s14, 2097152
    s_mov_b32 s15, 0x20000
    s_and_b32 s35, s30, 1
    s_mul_i32 s38, s29, 128
    s_mul_i32 s41, s35, 65536
    s_add_u32 s38, s38, s41
    s_mul_i32 s41, s35, 4096
    s_add_u32 s41, s41, 24576
    s_mov_b32 s42, 0
    s_mov_b32 s44, s67
    v_mov_b32 v6, 162820
spin_14:
    s_sleep 3
    ds_read_b32 v7, v6
    s_waitcnt lgkmcnt(0)
    v_readfirstlane_b32 s53, v7
    s_nop 0
    s_cmp_ge_u32 s53, 16
    s_cbranch_scc0 spin_14
    s_mov_b32 s42, 0
    s_mov_b32 s44, s67
    s_add_u32 s44, s44, 0
    s_and_b32 s44, s44, 15
    s_call_b64 s[76:77], SUB_w_issue_1
    s_waitcnt vmcnt(8)
    s_mov_b32 s42, 8192
    s_mov_b32 s44, s67
    s_add_u32 s44, s44, 1
    s_and_b32 s44, s44, 15
    s_call_b64 s[76:77], SUB_w_issue_1
    s_waitcnt vmcnt(8)
    s_mov_b32 s42, 16384
    s_mov_b32 s44, s67
    s_add_u32 s44, s44, 2
    s_and_b32 s44, s44, 15
    s_call_b64 s[76:77], SUB_w_issue_1
    s_waitcnt vmcnt(8)
    s_mov_b32 s42, 24576
    s_mov_b32 s44, s67
    s_add_u32 s44, s44, 3
    s_and_b32 s44, s44, 15
    s_call_b64 s[76:77], SUB_w_issue_1
    s_waitcnt vmcnt(8)
FR_end:
LAYER:
    v_lshlrev_b32 v40, 6, v179
    v_add_u32 v40, 161792, v40
    s_lshl_b32 s35, s30, 3
    v_add_u32 v39, s35, v40
    s_cmp_eq_u32 s60, 0
    s_cbranch_scc1 R_l0
    s_sub_u32 s8, s62, 0x3b00000
    s_subb_u32 s9, s63, 0
    s_mov_b32 s10, 0x7e000
    s_mov_b32 s11, 0x20000
    s_sub_u32 s12, s62, 0x3a80000
    s_subb_u32 s13, s63, 0
    s_mov_b32 s14, 0x7e000
    s_mov_b32 s15, 0x20000
    s_waitcnt vmcnt(0)
    v_lshlrev_b32 v222, 16, v196
    v_and_b32 v223, 0xffff0000, v196
    v_lshlrev_b32 v206, 16, v180
    v_and_b32 v207, 0xffff0000, v180
    v_lshlrev_b32 v12, 16, v188
    v_and_b32 v13, 0xffff0000, v188
    v_pk_add_f32 v[206:207], v[206:207], v[12:13]
    v_lshlrev_b32 v224, 16, v197
    v_and_b32 v225, 0xffff0000, v197
    v_lshlrev_b32 v208, 16, v181
    v_and_b32 v209, 0xffff0000, v181
    v_lshlrev_b32 v14, 16, v189
    v_and_b32 v15, 0xffff0000, v189
    v_pk_add_f32 v[208:209], v[208:209], v[14:15]
    v_lshlrev_b32 v226, 16, v198
    v_and_b32 v227, 0xffff0000, v198
    v_lshlrev_b32 v210, 16, v182
    v_and_b32 v211, 0xffff0000, v182
    v_lshlrev_b32 v16, 16, v190
    v_and_b32 v17, 0xffff0000, v190
    v_pk_add_f32 v[210:211], v[210:211], v[16:17]
    v_lshlrev_b32 v228, 16, v199
    v_and_b32 v229, 0xffff0000, v199
    v_lshlrev_b32 v212, 16, v183
    v_and_b32 v213, 0xffff0000, v183
    v_lshlrev_b32 v18, 16, v191
    v_and_b32 v19, 0xffff0000, v191
    v_pk_add_f32 v[212:213], v[212:213], v[18:19]
    v_lshlrev_b32 v230, 16, v200
    v_and_b32 v231, 0xffff0000, v200
    v_lshlrev_b32 v214, 16, v184
    v_and_b32 v215, 0xffff0000, v184
    v_lshlrev_b32 v20, 16, v192
    v_and_b32 v21, 0xffff0000, v192
    v_pk_add_f32 v[214:215], v[214:215], v[20:21]
    v_lshlrev_b32 v232, 16, v201
    v_and_b32 v233, 0xffff0000, v201
    v_lshlrev_b32 v216, 16, v185
    v_and_b32 v217, 0xffff0000, v185
    v_lshlrev_b32 v22, 16, v193
    v_and_b32 v23, 0xffff0000, v193
    v_pk_add_f32 v[216:217], v[216:217], v[22:23]
    v_lshlrev_b32 v234, 16, v202
    v_and_b32 v235, 0xffff0000, v202
    v_lshlrev_b32 v218, 16, v186
    v_and_b32 v219, 0xffff0000, v186
    v_lshlrev_b32 v24, 16, v194
    v_and_b32 v25, 0xffff0000, v194
    v_pk_add_f32 v[218:219], v[218:219], v[24:25]
    v_lshlrev_b32 v236, 16, v203
    v_and_b32 v237, 0xffff0000, v203
    v_lshlrev_b32 v220, 16, v187
    v_and_b32 v221, 0xffff0000, v187
    v_lshlrev_b32 v26, 16, v195
    v_and_b32 v27, 0xffff0000, v195
    v_pk_add_f32 v[220:221], v[220:221], v[26:27]
    s_cmp_lg_u32 s30, 4
    s_cbranch_scc1 pdone_15
    s_lshl_b32 s54, s60, 2
    s_add_u32 s54, s54, 0
    v_mov_b32 v8, 162872
spin_16:
    s_sleep 8
    ds_read_b32 v9, v8
    s_waitcnt lgkmcnt(0)
    v_readfirstlane_b32 s53, v9
    s_nop 0
    s_cmp_ge_u32 s53, s54
    s_cbranch_scc0 spin_16
    s_add_u32 s54, s55, 0xfc000400
    v_mov_b32 v9, s54
    s_mov_b32 s53, 0
    s_add_u32 s54, s52, 16
    s_bfm_b64 exec, 1, 0
poll_17:
    buffer_load_dword v8, v9, s[56:59], 0 offen sc1
    s_waitcnt vmcnt(0)
    v_xor_b32 v8, s54, v8
    v_cmp_eq_u32 vcc, 0, v8
    s_nop 0
    s_cmp_eq_u64 vcc, exec
    s_cbranch_scc1 pok_18
    s_sleep 5
    s_add_u32 s53, s53, 1
    s_cmp_lt_u32 s53, s61
    s_cbranch_scc1 poll_17
    s_mov_b32 s61, 0
pok_18:
    s_mov_b64 exec, -1
pdone_15:
    s_barrier
    buffer_load_dwordx4 v[180:183], v176, s[8:11], 0 offen offset:0 sc1
    buffer_load_dwordx4 v[188:191], v176, s[12:15], 0 offen offset:0 sc1
    buffer_load_dwordx4 v[184:187], v176, s[8:11], 0 offen offset:2048 sc1
    buffer_load_dwordx4 v[192:195], v176, s[12:15], 0 offen offset:2048 sc1
    s_waitcnt vmcnt(2)
    v_lshlrev_b32 v12, 16, v180
    v_and_b32 v13, 0xffff0000, v180
    v_lshlrev_b32 v14, 16, v188
    v_and_b32 v15, 0xffff0000, v188
    v_pk_add_f32 v[12:13], v[12:13], v[14:15]
    v_pk_add_f32 v[206:207], v[206:207], v[12:13]
    v_cvt_pk_bf16_f32 v28, v206, v207
    v_lshlrev_b32 v206, 16, v28
    v_and_b32 v207, 0xffff0000, v28
    v_lshlrev_b32 v16, 16, v181
    v_and_b32 v17, 0xffff0000, v181
    v_lshlrev_b32 v18, 16, v189
    v_and_b32 v19, 0xffff0000, v189
    v_pk_add_f32 v[16:17], v[16:17], v[18:19]
    v_pk_add_f32 v[208:209], v[208:209], v[16:17]
    v_cvt_pk_bf16_f32 v28, v208, v209
    v_lshlrev_b32 v208, 16, v28
    v_and_b32 v209, 0xffff0000, v28
    v_lshlrev_b32 v20, 16, v182
    v_and_b32 v21, 0xffff0000, v182
    v_lshlrev_b32 v22, 16, v190
    v_and_b32 v23, 0xffff0000, v190
    v_pk_add_f32 v[20:21], v[20:21], v[22:23]
    v_pk_add_f32 v[210:211], v[210:211], v[20:21]
    v_cvt_pk_bf16_f32 v28, v210, v211
    v_lshlrev_b32 v210, 16, v28
    v_and_b32 v211, 0xffff0000, v28
    v_lshlrev_b32 v24, 16, v183
    v_and_b32 v25, 0xffff0000, v183
    v_lshlrev_b32 v26, 16, v191
    v_and_b32 v27, 0xffff0000, v191
    v_pk_add_f32 v[24:25], v[24:25], v[26:27]
    v_pk_add_f32 v[212:213], v[212:213], v[24:25]
    v_cvt_pk_bf16_f32 v28, v212, v213
    v_lshlrev_b32 v212, 16, v28
    v_and_b32 v213, 0xffff0000, v28
    s_waitcnt vmcnt(0)
    v_lshlrev_b32 v12, 16, v184
    v_and_b32 v13, 0xffff0000, v184
    v_lshlrev_b32 v14, 16, v192
    v_and_b32 v15, 0xffff0000, v192
    v_pk_add_f32 v[12:13], v[12:13], v[14:15]
    v_pk_add_f32 v[214:215], v[214:215], v[12:13]
    v_cvt_pk_bf16_f32 v28, v214, v215
    v_lshlrev_b32 v214, 16, v28
    v_and_b32 v215, 0xffff0000, v28
    v_lshlrev_b32 v16, 16, v185
    v_and_b32 v17, 0xffff0000, v185
    v_lshlrev_b32 v18, 16, v193
    v_and_b32 v19, 0xffff0000, v193
    v_pk_add_f32 v[16:17], v[16:17], v[18:19]
    v_pk_add_f32 v[216:217], v[216:217], v[16:17]
    v_cvt_pk_bf16_f32 v28, v216, v217
    v_lshlrev_b32 v216, 16, v28
    v_and_b32 v217, 0xffff0000, v28
    v_lshlrev_b32 v20, 16, v186
    v_and_b32 v21, 0xffff0000, v186
    v_lshlrev_b32 v22, 16, v194
    v_and_b32 v23, 0xffff0000, v194
    v_pk_add_f32 v[20:21], v[20:21], v[22:23]
    v_pk_add_f32 v[218:219], v[218:219], v[20:21]
    v_cvt_pk_bf16_f32 v28, v218, v219
    v_lshlrev_b32 v218, 16, v28
    v_and_b32 v219, 0xffff0000, v28
    v_lshlrev_b32 v24, 16, v187
    v_and_b32 v25, 0xffff0000, v187
    v_lshlrev_b32 v26, 16, v195
    v_and_b32 v27, 0xffff0000, v195
    v_pk_add_f32 v[24:25], v[24:25], v[26:27]
    v_pk_add_f32 v[220:221], v[220:221], v[24:25]
    v_cvt_pk_bf16_f32 v28, v220, v221
    v_lshlrev_b32 v220, 16, v28
    v_and_b32 v221, 0xffff0000, v28
    v_pk_add_f32 v[32:33], v[206:207], v[208:209]
    v_pk_mul_f32 v[34:35], v[206:207], v[206:207]
    v_pk_fma_f32 v[34:35], v[208:209], v[208:209], v[34:35]
    v_pk_add_f32 v[32:33], v[32:33], v[210:211]
    v_pk_fma_f32 v[34:35], v[210:211], v[210:211], v[34:35]
    v_pk_add_f32 v[32:33], v[32:33], v[212:213]
    v_pk_fma_f32 v[34:35], v[212:213], v[212:213], v[34:35]
    v_pk_add_f32 v[32:33], v[32:33], v[214:215]
    v_pk_fma_f32 v[34:35], v[214:215], v[214:215], v[34:35]
    v_pk_add_f32 v[32:33], v[32:33], v[216:217]
    v_pk_fma_f32 v[34:35], v[216:217], v[216:217], v[34:35]
    v_pk_add_f32 v[32:33], v[32:33], v[218:219]
    v_pk_fma_f32 v[34:35], v[218:219], v[218:219], v[34:35]
    v_pk_add_f32 v[32:33], v[32:33], v[220:221]
    v_pk_fma_f32 v[34:35], v[220:221], v[220:221], v[34:35]
    v_add_f32 v30, v32, v33
    v_add_f32 v31, v34, v35
    s_nop 0
    v_add_f32_dpp v30, v30, v30 row_ror:8 row_mask:0xf bank_mask:0xf
    v_add_f32_dpp v31, v31, v31 row_ror:8 row_mask:0xf bank_mask:0xf
    v_mov_b32 v32, v30
    v_mov_b32 v33, v31
    s_nop 0
    v_permlane16_swap_b32 v30, v32
    v_permlane16_swap_b32 v31, v33
    v_pk_add_f32 v[30:31], v[30:31], v[32:33]
    v_mov_b32 v32, v30
    v_mov_b32 v33, v31
    s_nop 0
    v_permlane32_swap_b32 v30, v32
    v_permlane32_swap_b32 v31, v33
    v_pk_add_f32 v[30:31], v[30:31], v[32:33]
    ds_write_b64 v39, v[30:31] offset:0
    s_waitcnt lgkmcnt(0)
    s_barrier
    ds_read_b128 v[12:15], v40 offset:0
    ds_read_b128 v[16:19], v40 offset:16
    ds_read_b128 v[20:23], v40 offset:32
    ds_read_b128 v[24:27], v40 offset:48
    s_waitcnt lgkmcnt(0)
    v_pk_add_f32 v[12:13], v[12:13], v[14:15]
    v_pk_add_f32 v[16:17], v[16:17], v[18:19]
    v_pk_add_f32 v[20:21], v[20:21], v[22:23]
    v_pk_add_f32 v[24:25], v[24:25], v[26:27]
    v_pk_add_f32 v[12:13], v[12:13], v[16:17]
    v_pk_add_f32 v[20:21], v[20:21], v[24:25]
    v_pk_add_f32 v[12:13], v[12:13], v[20:21]
    v_mul_f32 v36, 0x3a800000, v12
    v_mul_f32 v38, 0x3a800000, v13
    v_fma_f32 v38, -v36, v36, v38
    v_max_f32 v38, 0, v38
    v_cvt_pk_bf16_f32 v36, v36, v36
    v_lshlrev_b32 v36, 16, v36
    v_cvt_pk_bf16_f32 v38, v38, v38
    v_lshlrev_b32 v38, 16, v38
    v_add_f32 v38, 0x3727c5ac, v38
    v_cvt_pk_bf16_f32 v38, v38, v38
    v_lshlrev_b32 v38, 16, v38
    v_sqrt_f32 v38, v38
    s_nop 0
    v_cvt_pk_bf16_f32 v38, v38, v38
    v_lshlrev_b32 v38, 16, v38
    v_rcp_f32 v37, v38
    s_add_u32 s20, s62, 0x400000
    s_addc_u32 s21, s63, 0
    s_mov_b32 s22, 0x7e000
    s_mov_b32 s23, 0x20000
    v_pk_add_f32 v[12:13], v[206:207], v[36:37] op_sel_hi:[1,0] neg_lo:[0,1] neg_hi:[0,1]
    v_pk_mul_f32 v[12:13], v[12:13], v[36:37] op_sel:[0,1] op_sel_hi:[1,1]
    v_pk_fma_f32 v[206:207], v[12:13], v[222:223], v[206:207]
    v_cvt_pk_bf16_f32 v180, v206, v207
    v_pk_add_f32 v[14:15], v[208:209], v[36:37] op_sel_hi:[1,0] neg_lo:[0,1] neg_hi:[0,1]
    v_pk_mul_f32 v[14:15], v[14:15], v[36:37] op_sel:[0,1] op_sel_hi:[1,1]
    v_pk_fma_f32 v[208:209], v[14:15], v[224:225], v[208:209]
    v_cvt_pk_bf16_f32 v181, v208, v209
    v_pk_add_f32 v[16:17], v[210:211], v[36:37] op_sel_hi:[1,0] neg_lo:[0,1] neg_hi:[0,1]
    v_pk_mul_f32 v[16:17], v[16:17], v[36:37] op_sel:[0,1] op_sel_hi:[1,1]
    v_pk_fma_f32 v[210:211], v[16:17], v[226:227], v[210:211]
    v_cvt_pk_bf16_f32 v182, v210, v211
    v_pk_add_f32 v[18:19], v[212:213], v[36:37] op_sel_hi:[1,0] neg_lo:[0,1] neg_hi:[0,1]
    v_pk_mul_f32 v[18:19], v[18:19], v[36:37] op_sel:[0,1] op_sel_hi:[1,1]
    v_pk_fma_f32 v[212:213], v[18:19], v[228:229], v[212:213]
    v_cvt_pk_bf16_f32 v183, v212, v213
    buffer_store_dwordx4 v[180:183], v176, s[20:23], 0 offen offset:0 sc1
    v_pk_add_f32 v[20:21], v[214:215], v[36:37] op_sel_hi:[1,0] neg_lo:[0,1] neg_hi:[0,1]
    v_pk_mul_f32 v[20:21], v[20:21], v[36:37] op_sel:[0,1] op_sel_hi:[1,1]
    v_pk_fma_f32 v[214:215], v[20:21], v[230:231], v[214:215]
    v_cvt_pk_bf16_f32 v184, v214, v215
    v_pk_add_f32 v[22:23], v[216:217], v[36:37] op_sel_hi:[1,0] neg_lo:[0,1] neg_hi:[0,1]
    v_pk_mul_f32 v[22:23], v[22:23], v[36:37] op_sel:[0,1] op_sel_hi:[1,1]
    v_pk_fma_f32 v[216:217], v[22:23], v[232:233], v[216:217]
    v_cvt_pk_bf16_f32 v185, v216, v217
    v_pk_add_f32 v[24:25], v[218:219], v[36:37] op_sel_hi:[1,0] neg_lo:[0,1] neg_hi:[0,1]
    v_pk_mul_f32 v[24:25], v[24:25], v[36:37] op_sel:[0,1] op_sel_hi:[1,1]
    v_pk_fma_f32 v[218:219], v[24:25], v[234:235], v[218:219]
    v_cvt_pk_bf16_f32 v186, v218, v219
    v_pk_add_f32 v[26:27], v[220:221], v[36:37] op_sel_hi:[1,0] neg_lo:[0,1] neg_hi:[0,1]
    v_pk_mul_f32 v[26:27], v[26:27], v[36:37] op_sel:[0,1] op_sel_hi:[1,1]
    v_pk_fma_f32 v[220:221], v[26:27], v[236:237], v[220:221]
    v_cvt_pk_bf16_f32 v187, v220, v221
    buffer_store_dwordx4 v[184:187], v176, s[20:23], 0 offen offset:2048 sc1
    s_branch R_s2
R_l0:
    v_lshlrev_b32 v206, 16, v180
    v_and_b32 v207, 0xffff0000, v180
    v_lshlrev_b32 v12, 16, v188
    v_and_b32 v13, 0xffff0000, v188
    v_lshlrev_b32 v208, 16, v181
    v_and_b32 v209, 0xffff0000, v181
    v_lshlrev_b32 v14, 16, v189
    v_and_b32 v15, 0xffff0000, v189
    v_lshlrev_b32 v210, 16, v182
    v_and_b32 v211, 0xffff0000, v182
    v_lshlrev_b32 v16, 16, v190
    v_and_b32 v17, 0xffff0000, v190
    v_lshlrev_b32 v212, 16, v183
    v_and_b32 v213, 0xffff0000, v183
    v_lshlrev_b32 v18, 16, v191
    v_and_b32 v19, 0xffff0000, v191
    v_lshlrev_b32 v214, 16, v184
    v_and_b32 v215, 0xffff0000, v184
    v_lshlrev_b32 v20, 16, v192
    v_and_b32 v21, 0xffff0000, v192
    v_lshlrev_b32 v216, 16, v185
    v_and_b32 v217, 0xffff0000, v185
    v_lshlrev_b32 v22, 16, v193
    v_and_b32 v23, 0xffff0000, v193
    v_lshlrev_b32 v218, 16, v186
    v_and_b32 v219, 0xffff0000, v186
    v_lshlrev_b32 v24, 16, v194
    v_and_b32 v25, 0xffff0000, v194
    v_lshlrev_b32 v220, 16, v187
    v_and_b32 v221, 0xffff0000, v187
    v_lshlrev_b32 v26, 16, v195
    v_and_b32 v27, 0xffff0000, v195
    s_cmp_lg_u32 s30, 4
    s_cbranch_scc1 R_fw
    v_mov_b32 v222, 162820
spin_19:
    s_sleep 4
    ds_read_b32 v223, v222
    s_waitcnt lgkmcnt(0)
    v_readfirstlane_b32 s53, v223
    s_nop 0
    s_cmp_ge_u32 s53, 16
    s_cbranch_scc0 spin_19
    s_lshl_b32 s36, s28, 10
    s_add_u32 s36, s36, 23101440
    v_lshlrev_b32 v226, 7, v1
    v_add_u32 v226, s36, v226
    s_mov_b32 s53, 0
    s_mov_b64 exec, 0xff
R_fp:
    buffer_load_dword v222, v226, s[56:59], 0 offen sc1
    s_waitcnt vmcnt(0)
    v_subrev_u32 v222, s52, v222
    v_and_b32 v223, 0xffffc0ff, v222
    v_cmp_eq_u32 vcc, 32, v223
    s_nop 0
    s_cmp_eq_u64 vcc, exec
    s_cbranch_scc1 R_fq
    s_sleep 3
    s_add_u32 s53, s53, 1
    s_cmp_lt_u32 s53, s61
    s_cbranch_scc1 R_fp
    s_mov_b32 s61, 0
R_fq:
    v_lshrrev_b32 v222, 8, v222
    v_mov_b32 v223, 162844
    ds_add_u32 v223, v222
    s_mov_b64 exec, -1
    s_waitcnt lgkmcnt(0)
R_fw:
    s_barrier
    s_add_u32 s80, s4, 0x1c00000
    s_addc_u32 s81, s5, 0
    s_mov_b32 s82, 0x400000
    s_mov_b32 s83, 0x20000
    s_mov_b32 s78, 0
    buffer_load_dwordx2 v[196:197], v177, s[80:83], s78 offen sc1
    s_mov_b32 s78, 65536
    buffer_load_dwordx2 v[198:199], v177, s[80:83], s78 offen sc1
    s_mov_b32 s78, 262144
    buffer_load_dwordx2 v[200:201], v177, s[80:83], s78 offen sc1
    s_mov_b32 s78, 327680
    buffer_load_dwordx2 v[202:203], v177, s[80:83], s78 offen sc1
    v_mov_b32 v222, 162844
    ds_read_b32 v223, v222
    s_waitcnt lgkmcnt(0)
    v_readfirstlane_b32 s94, v223
    s_nop 0
    s_cmp_gt_u32 s94, 127
    s_cselect_b32 s94, 1, 0
    s_lshr_b32 s53, s28, 3
    s_lshl_b32 s53, s53, 2
    s_and_b32 s54, s28, 3
    s_add_u32 s53, s53, s54
    s_lshl_b32 s53, s53, 23
    s_lshr_b32 s54, s28, 2
    s_xor_b32 s54, s54, s94
    s_and_b32 s54, s54, 1
    s_lshl_b32 s54, s54, 13
    s_add_u32 s55, s53, s54
    s_add_u32 s55, s55, 33554432
    s_add_u32 s62, s4, s55
    s_addc_u32 s63, s5, 0
    s_sub_u32 s36, s28, 1
    s_max_i32 s36, s36, 0
    s_lshr_b32 s53, s36, 3
    s_lshl_b32 s53, s53, 2
    s_and_b32 s54, s36, 3
    s_add_u32 s53, s53, s54
    s_lshl_b32 s53, s53, 23
    s_lshr_b32 s54, s36, 2
    s_xor_b32 s54, s54, s94
    s_and_b32 s54, s54, 1
    s_lshl_b32 s54, s54, 13
    s_add_u32 s92, s53, s54
    s_add_u32 s92, s92, 33554432
    s_sub_u32 s92, s92, s55
    s_add_u32 s36, s28, 1
    s_min_u32 s36, s36, 15
    s_lshr_b32 s53, s36, 3
    s_lshl_b32 s53, s53, 2
    s_and_b32 s54, s36, 3
    s_add_u32 s53, s53, s54
    s_lshl_b32 s53, s53, 23
    s_lshr_b32 s54, s36, 2
    s_xor_b32 s54, s54, s94
    s_and_b32 s54, s54, 1
    s_lshl_b32 s54, s54, 13
    s_add_u32 s93, s53, s54
    s_add_u32 s93, s93, 33554432
    s_sub_u32 s93, s93, s55
    s_add_u32 s55, s55, 1835008
    s_add_u32 s20, s62, 0x400000
    s_addc_u32 s21, s63, 0
    s_mov_b32 s22, 0x7e000
    s_mov_b32 s23, 0x20000
    s_waitcnt vmcnt(0)
    v_lshlrev_b32 v222, 16, v196
    v_and_b32 v223, 0xffff0000, v196
    v_pk_mul_f32 v[12:13], v[12:13], v[222:223]
    v_cvt_pk_bf16_f32 v28, v12, v13
    v_lshlrev_b32 v12, 16, v28
    v_and_b32 v13, 0xffff0000, v28
    v_pk_add_f32 v[206:207], v[206:207], v[12:13]
    v_cvt_pk_bf16_f32 v180, v206, v207
    v_lshlrev_b32 v222, 16, v197
    v_and_b32 v223, 0xffff0000, v197
    v_pk_mul_f32 v[14:15], v[14:15], v[222:223]
    v_cvt_pk_bf16_f32 v28, v14, v15
    v_lshlrev_b32 v14, 16, v28
    v_and_b32 v15, 0xffff0000, v28
    v_pk_add_f32 v[208:209], v[208:209], v[14:15]
    v_cvt_pk_bf16_f32 v181, v208, v209
    v_lshlrev_b32 v222, 16, v198
    v_and_b32 v223, 0xffff0000, v198
    v_pk_mul_f32 v[16:17], v[16:17], v[222:223]
    v_cvt_pk_bf16_f32 v28, v16, v17
    v_lshlrev_b32 v16, 16, v28
    v_and_b32 v17, 0xffff0000, v28
    v_pk_add_f32 v[210:211], v[210:211], v[16:17]
    v_cvt_pk_bf16_f32 v182, v210, v211
    v_lshlrev_b32 v222, 16, v199
    v_and_b32 v223, 0xffff0000, v199
    v_pk_mul_f32 v[18:19], v[18:19], v[222:223]
    v_cvt_pk_bf16_f32 v28, v18, v19
    v_lshlrev_b32 v18, 16, v28
    v_and_b32 v19, 0xffff0000, v28
    v_pk_add_f32 v[212:213], v[212:213], v[18:19]
    v_cvt_pk_bf16_f32 v183, v212, v213
    buffer_store_dwordx4 v[180:183], v176, s[20:23], 0 offen offset:0 sc1
    v_lshlrev_b32 v222, 16, v200
    v_and_b32 v223, 0xffff0000, v200
    v_pk_mul_f32 v[20:21], v[20:21], v[222:223]
    v_cvt_pk_bf16_f32 v28, v20, v21
    v_lshlrev_b32 v20, 16, v28
    v_and_b32 v21, 0xffff0000, v28
    v_pk_add_f32 v[214:215], v[214:215], v[20:21]
    v_cvt_pk_bf16_f32 v184, v214, v215
    v_lshlrev_b32 v222, 16, v201
    v_and_b32 v223, 0xffff0000, v201
    v_pk_mul_f32 v[22:23], v[22:23], v[222:223]
    v_cvt_pk_bf16_f32 v28, v22, v23
    v_lshlrev_b32 v22, 16, v28
    v_and_b32 v23, 0xffff0000, v28
    v_pk_add_f32 v[216:217], v[216:217], v[22:23]
    v_cvt_pk_bf16_f32 v185, v216, v217
    v_lshlrev_b32 v222, 16, v202
    v_and_b32 v223, 0xffff0000, v202
    v_pk_mul_f32 v[24:25], v[24:25], v[222:223]
    v_cvt_pk_bf16_f32 v28, v24, v25
    v_lshlrev_b32 v24, 16, v28
    v_and_b32 v25, 0xffff0000, v28
    v_pk_add_f32 v[218:219], v[218:219], v[24:25]
    v_cvt_pk_bf16_f32 v186, v218, v219
    v_lshlrev_b32 v222, 16, v203
    v_and_b32 v223, 0xffff0000, v203
    v_pk_mul_f32 v[26:27], v[26:27], v[222:223]
    v_cvt_pk_bf16_f32 v28, v26, v27
    v_lshlrev_b32 v26, 16, v28
    v_and_b32 v27, 0xffff0000, v28
    v_pk_add_f32 v[220:221], v[220:221], v[26:27]
    v_cvt_pk_bf16_f32 v187, v220, v221
    buffer_store_dwordx4 v[184:187], v176, s[20:23], 0 offen offset:2048 sc1
R_s2:
    v_lshlrev_b32 v206, 16, v180
    v_and_b32 v207, 0xffff0000, v180
    v_lshlrev_b32 v208, 16, v181
    v_and_b32 v209, 0xffff0000, v181
    v_lshlrev_b32 v210, 16, v182
    v_and_b32 v211, 0xffff0000, v182
    v_lshlrev_b32 v212, 16, v183
    v_and_b32 v213, 0xffff0000, v183
    v_lshlrev_b32 v214, 16, v184
    v_and_b32 v215, 0xffff0000, v184
    v_lshlrev_b32 v216, 16, v185
    v_and_b32 v217, 0xffff0000, v185
    v_lshlrev_b32 v218, 16, v186
    v_and_b32 v219, 0xffff0000, v186
    v_lshlrev_b32 v220, 16, v187
    v_and_b32 v221, 0xffff0000, v187
    v_pk_add_f32 v[32:33], v[206:207], v[208:209]
    v_pk_mul_f32 v[34:35], v[206:207], v[206:207]
    v_pk_fma_f32 v[34:35], v[208:209], v[208:209], v[34:35]
    v_pk_add_f32 v[32:33], v[32:33], v[210:211]
    v_pk_fma_f32 v[34:35], v[210:211], v[210:211], v[34:35]
    v_pk_add_f32 v[32:33], v[32:33], v[212:213]
    v_pk_fma_f32 v[34:35], v[212:213], v[212:213], v[34:35]
    v_pk_add_f32 v[32:33], v[32:33], v[214:215]
    v_pk_fma_f32 v[34:35], v[214:215], v[214:215], v[34:35]
    v_pk_add_f32 v[32:33], v[32:33], v[216:217]
    v_pk_fma_f32 v[34:35], v[216:217], v[216:217], v[34:35]
    v_pk_add_f32 v[32:33], v[32:33], v[218:219]
    v_pk_fma_f32 v[34:35], v[218:219], v[218:219], v[34:35]
    v_pk_add_f32 v[32:33], v[32:33], v[220:221]
    v_pk_fma_f32 v[34:35], v[220:221], v[220:221], v[34:35]
    v_add_f32 v30, v32, v33
    v_add_f32 v31, v34, v35
    s_nop 0
    v_add_f32_dpp v30, v30, v30 row_ror:8 row_mask:0xf bank_mask:0xf
    v_add_f32_dpp v31, v31, v31 row_ror:8 row_mask:0xf bank_mask:0xf
    v_mov_b32 v32, v30
    v_mov_b32 v33, v31
    s_nop 0
    v_permlane16_swap_b32 v30, v32
    v_permlane16_swap_b32 v31, v33
    v_pk_add_f32 v[30:31], v[30:31], v[32:33]
    v_mov_b32 v32, v30
    v_mov_b32 v33, v31
    s_nop 0
    v_permlane32_swap_b32 v30, v32
    v_permlane32_swap_b32 v31, v33
    v_pk_add_f32 v[30:31], v[30:31], v[32:33]
    ds_write_b64 v39, v[30:31] offset:512
    s_add_u32 s53, s55, 0
    v_mov_b32 v8, 1
    v_mov_b32 v9, 162820
    v_mov_b32 v11, 0
    s_mov_b64 exec, 1
    s_waitcnt vmcnt(0)
    ds_add_rtn_u32 v10, v9, v8
    s_waitcnt lgkmcnt(0)
    v_readfirstlane_b32 s54, v10
    s_nop 0
    s_and_b32 s54, s54, 7
    s_cmp_lg_u32 s54, 7
    s_cbranch_scc1 pub_20
    buffer_atomic_add v8, v11, s[56:59], s53 offen sc1
    s_cmp_lg_u32 s60, 0
    s_cbranch_scc1 pub_20
    s_lshl_b32 s53, s29, 7
    s_add_u32 s53, s53, 23117824
    buffer_atomic_add v8, v11, s[56:59], s53 offen sc1
pub_20:
    s_mov_b64 exec, -1
    s_barrier
    s_cmp_lg_u32 s30, 0
    s_cbranch_scc1 R_nl
    ds_read_b128 v[12:15], v40 offset:512
    ds_read_b128 v[16:19], v40 offset:528
    ds_read_b128 v[20:23], v40 offset:544
    ds_read_b128 v[24:27], v40 offset:560
    s_waitcnt lgkmcnt(0)
    v_pk_add_f32 v[12:13], v[12:13], v[14:15]
    v_pk_add_f32 v[16:17], v[16:17], v[18:19]
    v_pk_add_f32 v[20:21], v[20:21], v[22:23]
    v_pk_add_f32 v[24:25], v[24:25], v[26:27]
    v_pk_add_f32 v[12:13], v[12:13], v[16:17]
    v_pk_add_f32 v[20:21], v[20:21], v[24:25]
    v_pk_add_f32 v[12:13], v[12:13], v[20:21]
    v_mul_f32 v36, 0x3a800000, v12
    v_mul_f32 v38, 0x3a800000, v13
    v_fma_f32 v38, -v36, v36, v38
    v_max_f32 v38, 0, v38
    v_mov_b32 v42, v36
    v_mov_b32 v43, v38
    v_cvt_pk_bf16_f32 v36, v36, v36
    v_lshlrev_b32 v36, 16, v36
    v_cvt_pk_bf16_f32 v38, v38, v38
    v_lshlrev_b32 v38, 16, v38
    v_add_f32 v38, 0x3727c5ac, v38
    v_cvt_pk_bf16_f32 v38, v38, v38
    v_lshlrev_b32 v38, 16, v38
    v_sqrt_f32 v38, v38
    s_nop 0
    v_cvt_pk_bf16_f32 v38, v38, v38
    v_lshlrev_b32 v38, 16, v38
    v_mov_b32 v41, v38
    v_rcp_f32 v37, v38
    v_sub_f32 v42, v42, v36
    v_mul_f32 v42, v42, v37
    v_mul_f32 v43, v43, v37
    v_mul_f32 v43, v43, v37
    v_cvt_pk_bf16_f32 v42, v42, v42
    v_lshlrev_b32 v42, 16, v42
    v_cvt_pk_bf16_f32 v43, v43, v43
    v_lshlrev_b32 v43, 16, v43
    v_add_f32 v43, 0x3727c5ac, v43
    v_cvt_pk_bf16_f32 v43, v43, v43
    v_lshlrev_b32 v43, 16, v43
    v_sqrt_f32 v43, v43
    s_nop 0
    v_cvt_pk_bf16_f32 v43, v43, v43
    v_lshlrev_b32 v43, 16, v43
    v_rcp_f32 v44, v43
    v_mov_b32 v224, v36
    v_mov_b32 v225, v37
    v_fma_f32 v226, v42, v41, v36
    v_mul_f32 v227, v37, v44
    s_add_u32 s24, s62, 0x1d0000
    s_addc_u32 s25, s63, 0
    s_mov_b32 s26, 0x800
    s_mov_b32 s27, 0x20000
    s_lshl_b32 s36, s29, 3
    v_add_u32 v6, s36, v179
    v_lshlrev_b32 v6, 4, v6
    s_mov_b64 exec, 0xff
    buffer_store_dwordx4 v[224:227], v6, s[24:27], 0 offen sc1
    s_mov_b64 exec, -1
    s_add_u32 s53, s55, 1280
    v_mov_b32 v8, 1
    v_mov_b32 v9, 162816
    v_mov_b32 v11, 0
    s_mov_b64 exec, 1
    s_waitcnt vmcnt(0)
    buffer_atomic_add v8, v11, s[56:59], s53 offen sc1
pub_21:
    s_mov_b64 exec, -1
R_nl:
    s_cmp_ge_u32 s30, 4
    s_cbranch_scc1 LOADERS
    s_mov_b32 s34, s30
    s_mov_b32 s35, 0
    v_and_b32 v22, 15, v1
    v_lshrrev_b32 v23, 4, v1
    s_mul_i32 s37, s34, 2
    s_mul_i32 s38, s29, 4
    s_mul_i32 s36, s35, 4
    s_add_u32 s38, s38, s36
    s_add_u32 s8, s62, 0x400000
    s_addc_u32 s9, s63, 0
    s_mov_b32 s10, 0x7e000
    s_mov_b32 s11, 0x20000
    v_add_u32 v126, 0, v2
    v_add_u32 v127, 65536, v2
    v_add_u32 v128, 4096, v2
    v_add_u32 v129, 69632, v2
    s_lshr_b32 s36, s67, 2
    s_add_u32 s36, s36, 0
    s_and_b32 s36, s36, 3
    s_lshl_b32 s44, s36, 14
    s_lshl_b32 s36, s34, 17
    s_add_u32 s44, s44, s36
    s_lshr_b32 s36, s67, 2
    s_add_u32 s36, s36, 1
    s_and_b32 s36, s36, 3
    s_lshl_b32 s45, s36, 14
    s_lshl_b32 s36, s34, 17
    s_add_u32 s45, s45, s36
    s_lshr_b32 s36, s67, 2
    s_add_u32 s36, s36, 2
    s_and_b32 s36, s36, 3
    s_lshl_b32 s46, s36, 14
    s_lshl_b32 s36, s34, 17
    s_add_u32 s46, s46, s36
    s_lshr_b32 s36, s67, 2
    s_add_u32 s36, s36, 3
    s_and_b32 s36, s36, 3
    s_lshl_b32 s47, s36, 14
    s_lshl_b32 s36, s34, 17
    s_add_u32 s47, s47, s36
    v_lshrrev_b32 v6, 2, v1
    v_mul_u32_u24 v13, 128, v6
    v_and_b32 v7, 3, v1
    v_lshl_add_u32 v13, v7, 3, v13
    v_add_u32 v13, 24576, v13
    v_bfe_u32 v6, v6, 1, 2
    s_mul_i32 s36, s35, 4
    s_add_u32 s36, s36, 3
    v_xor_b32 v7, s36, v6
    v_lshl_add_u32 v16, v7, 5, v13
    s_mul_i32 s36, s35, 4
    s_add_u32 s36, s36, 2
    v_xor_b32 v7, s36, v6
    v_lshl_add_u32 v15, v7, 5, v13
    s_mul_i32 s36, s35, 4
    s_add_u32 s36, s36, 1
    v_xor_b32 v7, s36, v6
    v_lshl_add_u32 v14, v7, 5, v13
    s_mul_i32 s36, s35, 4
    s_add_u32 s36, s36, 0
    v_xor_b32 v7, s36, v6
    v_lshl_add_u32 v13, v7, 5, v13
    v_pk_mov_b32 v[24:25], 0, 0
    v_pk_mov_b32 v[26:27], 0, 0
    v_pk_mov_b32 v[28:29], 0, 0
    v_pk_mov_b32 v[30:31], 0, 0
    v_pk_mov_b32 v[32:33], 0, 0
    v_pk_mov_b32 v[34:35], 0, 0
    v_pk_mov_b32 v[36:37], 0, 0
    v_pk_mov_b32 v[38:39], 0, 0
    v_pk_mov_b32 v[40:41], 0, 0
    v_pk_mov_b32 v[42:43], 0, 0
    v_pk_mov_b32 v[44:45], 0, 0
    v_pk_mov_b32 v[46:47], 0, 0
    v_pk_mov_b32 v[48:49], 0, 0
    v_pk_mov_b32 v[50:51], 0, 0
    v_pk_mov_b32 v[52:53], 0, 0
    v_pk_mov_b32 v[54:55], 0, 0
    s_mov_b32 s43, 0
    s_waitcnt lgkmcnt(0)
    s_barrier
    buffer_load_dwordx4 v[176:179], v126, s[8:11], s44 offen offset:0
    buffer_load_dwordx4 v[180:183], v127, s[8:11], s44 offen offset:0
    buffer_load_dwordx4 v[184:187], v126, s[8:11], s44 offen offset:1024
    buffer_load_dwordx4 v[188:191], v127, s[8:11], s44 offen offset:1024
    buffer_load_dwordx4 v[192:195], v126, s[8:11], s44 offen offset:2048
    buffer_load_dwordx4 v[196:199], v127, s[8:11], s44 offen offset:2048
    buffer_load_dwordx4 v[200:203], v126, s[8:11], s44 offen offset:3072
    buffer_load_dwordx4 v[204:207], v127, s[8:11], s44 offen offset:3072
    ds_read_b64_tr_b16 v[56:57], v13 offset:0
    ds_read_b64_tr_b16 v[58:59], v13 offset:2048
    ds_read_b64_tr_b16 v[60:61], v14 offset:0
    ds_read_b64_tr_b16 v[62:63], v14 offset:2048
    ds_read_b64_tr_b16 v[64:65], v15 offset:0
    ds_read_b64_tr_b16 v[66:67], v15 offset:2048
    ds_read_b64_tr_b16 v[68:69], v16 offset:0
    ds_read_b64_tr_b16 v[70:71], v16 offset:2048
    ds_read_b64_tr_b16 v[72:73], v13 offset:4096
    ds_read_b64_tr_b16 v[74:75], v13 offset:6144
    ds_read_b64_tr_b16 v[76:77], v14 offset:4096
    ds_read_b64_tr_b16 v[78:79], v14 offset:6144
    ds_read_b64_tr_b16 v[80:81], v15 offset:4096
    ds_read_b64_tr_b16 v[82:83], v15 offset:6144
    ds_read_b64_tr_b16 v[84:85], v16 offset:4096
    ds_read_b64_tr_b16 v[86:87], v16 offset:6144
    buffer_load_dwordx4 v[208:211], v128, s[8:11], s44 offen offset:0
    buffer_load_dwordx4 v[212:215], v129, s[8:11], s44 offen offset:0
    buffer_load_dwordx4 v[216:219], v128, s[8:11], s44 offen offset:1024
    buffer_load_dwordx4 v[220:223], v129, s[8:11], s44 offen offset:1024
    buffer_load_dwordx4 v[224:227], v128, s[8:11], s44 offen offset:2048
    buffer_load_dwordx4 v[228:231], v129, s[8:11], s44 offen offset:2048
    s_waitcnt vmcnt(10) lgkmcnt(0)
dm_22:
    v_mfma_f32_16x16x32_bf16 v[24:27], v[56:59], v[176:179], v[24:27]
    ds_read_b64_tr_b16 v[88:89], v13 offset:8192
    buffer_load_dwordx4 v[232:235], v128, s[8:11], s44 offen offset:3072
    v_mfma_f32_16x16x32_bf16 v[40:43], v[56:59], v[180:183], v[40:43]
    ds_read_b64_tr_b16 v[90:91], v13 offset:10240
    buffer_load_dwordx4 v[236:239], v129, s[8:11], s44 offen offset:3072
    v_mfma_f32_16x16x32_bf16 v[44:47], v[60:63], v[180:183], v[44:47]
    ds_read_b64_tr_b16 v[92:93], v14 offset:8192
    s_mov_b32 s44, s45
    v_mfma_f32_16x16x32_bf16 v[28:31], v[60:63], v[176:179], v[28:31]
    ds_read_b64_tr_b16 v[94:95], v14 offset:10240
    s_mov_b32 s45, s46
    v_mfma_f32_16x16x32_bf16 v[32:35], v[64:67], v[176:179], v[32:35]
    ds_read_b64_tr_b16 v[96:97], v15 offset:8192
    s_mov_b32 s46, s47
    v_mfma_f32_16x16x32_bf16 v[48:51], v[64:67], v[180:183], v[48:51]
    ds_read_b64_tr_b16 v[98:99], v15 offset:10240
    s_mov_b32 s47, 1048576
    v_mfma_f32_16x16x32_bf16 v[52:55], v[68:71], v[180:183], v[52:55]
    ds_read_b64_tr_b16 v[100:101], v16 offset:8192
    v_mfma_f32_16x16x32_bf16 v[36:39], v[68:71], v[176:179], v[36:39]
    ds_read_b64_tr_b16 v[102:103], v16 offset:10240
    s_waitcnt lgkmcnt(8)
    v_mfma_f32_16x16x32_bf16 v[24:27], v[72:75], v[184:187], v[24:27]
    ds_read_b64_tr_b16 v[104:105], v13 offset:12288
    buffer_load_dwordx4 v[176:179], v126, s[8:11], s44 offen offset:0
    v_mfma_f32_16x16x32_bf16 v[40:43], v[72:75], v[188:191], v[40:43]
    ds_read_b64_tr_b16 v[106:107], v13 offset:14336
    buffer_load_dwordx4 v[180:183], v127, s[8:11], s44 offen offset:0
    v_mfma_f32_16x16x32_bf16 v[44:47], v[76:79], v[188:191], v[44:47]
    ds_read_b64_tr_b16 v[108:109], v14 offset:12288
    s_waitcnt vmcnt(10)
    v_mfma_f32_16x16x32_bf16 v[28:31], v[76:79], v[184:187], v[28:31]
    ds_read_b64_tr_b16 v[110:111], v14 offset:14336
    v_mfma_f32_16x16x32_bf16 v[32:35], v[80:83], v[184:187], v[32:35]
    ds_read_b64_tr_b16 v[112:113], v15 offset:12288
    v_mfma_f32_16x16x32_bf16 v[48:51], v[80:83], v[188:191], v[48:51]
    ds_read_b64_tr_b16 v[114:115], v15 offset:14336
    v_mfma_f32_16x16x32_bf16 v[52:55], v[84:87], v[188:191], v[52:55]
    ds_read_b64_tr_b16 v[116:117], v16 offset:12288
    ds_read_b64_tr_b16 v[118:119], v16 offset:14336
    v_mfma_f32_16x16x32_bf16 v[36:39], v[84:87], v[184:187], v[36:39]
    s_waitcnt lgkmcnt(8)
    v_mfma_f32_16x16x32_bf16 v[24:27], v[88:91], v[192:195], v[24:27]
    ds_read_b64_tr_b16 v[56:57], v13 offset:16384
    buffer_load_dwordx4 v[184:187], v126, s[8:11], s44 offen offset:1024
    v_mfma_f32_16x16x32_bf16 v[40:43], v[88:91], v[196:199], v[40:43]
    ds_read_b64_tr_b16 v[58:59], v13 offset:18432
    buffer_load_dwordx4 v[188:191], v127, s[8:11], s44 offen offset:1024
    v_mfma_f32_16x16x32_bf16 v[44:47], v[92:95], v[196:199], v[44:47]
    ds_read_b64_tr_b16 v[60:61], v14 offset:16384
    v_mfma_f32_16x16x32_bf16 v[28:31], v[92:95], v[192:195], v[28:31]
    ds_read_b64_tr_b16 v[62:63], v14 offset:18432
    v_mfma_f32_16x16x32_bf16 v[32:35], v[96:99], v[192:195], v[32:35]
    ds_read_b64_tr_b16 v[64:65], v15 offset:16384
    v_mfma_f32_16x16x32_bf16 v[48:51], v[96:99], v[196:199], v[48:51]
    ds_read_b64_tr_b16 v[66:67], v15 offset:18432
    v_mfma_f32_16x16x32_bf16 v[52:55], v[100:103], v[196:199], v[52:55]
    ds_read_b64_tr_b16 v[68:69], v16 offset:16384
    v_mfma_f32_16x16x32_bf16 v[36:39], v[100:103], v[192:195], v[36:39]
    ds_read_b64_tr_b16 v[70:71], v16 offset:18432
    s_waitcnt lgkmcnt(8)
    v_mfma_f32_16x16x32_bf16 v[24:27], v[104:107], v[200:203], v[24:27]
    ds_read_b64_tr_b16 v[72:73], v13 offset:20480
    buffer_load_dwordx4 v[192:195], v126, s[8:11], s44 offen offset:2048
    v_mfma_f32_16x16x32_bf16 v[40:43], v[104:107], v[204:207], v[40:43]
    ds_read_b64_tr_b16 v[74:75], v13 offset:22528
    buffer_load_dwordx4 v[196:199], v127, s[8:11], s44 offen offset:2048
    v_mfma_f32_16x16x32_bf16 v[44:47], v[108:111], v[204:207], v[44:47]
    ds_read_b64_tr_b16 v[76:77], v14 offset:20480
    s_waitcnt vmcnt(10)
    v_mfma_f32_16x16x32_bf16 v[28:31], v[108:111], v[200:203], v[28:31]
    ds_read_b64_tr_b16 v[78:79], v14 offset:22528
    v_mfma_f32_16x16x32_bf16 v[32:35], v[112:115], v[200:203], v[32:35]
    ds_read_b64_tr_b16 v[80:81], v15 offset:20480
    v_mfma_f32_16x16x32_bf16 v[48:51], v[112:115], v[204:207], v[48:51]
    ds_read_b64_tr_b16 v[82:83], v15 offset:22528
    v_mfma_f32_16x16x32_bf16 v[52:55], v[116:119], v[204:207], v[52:55]
    ds_read_b64_tr_b16 v[84:85], v16 offset:20480
    ds_read_b64_tr_b16 v[86:87], v16 offset:22528
    v_mfma_f32_16x16x32_bf16 v[36:39], v[116:119], v[200:203], v[36:39]
    s_waitcnt lgkmcnt(8)
    v_mfma_f32_16x16x32_bf16 v[24:27], v[56:59], v[208:211], v[24:27]
    ds_read_b64_tr_b16 v[88:89], v13 offset:24576
    buffer_load_dwordx4 v[200:203], v126, s[8:11], s44 offen offset:3072
    v_mfma_f32_16x16x32_bf16 v[40:43], v[56:59], v[212:215], v[40:43]
    ds_read_b64_tr_b16 v[90:91], v13 offset:26624
    buffer_load_dwordx4 v[204:207], v127, s[8:11], s44 offen offset:3072
    v_mfma_f32_16x16x32_bf16 v[44:47], v[60:63], v[212:215], v[44:47]
    ds_read_b64_tr_b16 v[92:93], v14 offset:24576
    s_add_u32 s43, s43, 1
    v_mfma_f32_16x16x32_bf16 v[28:31], v[60:63], v[208:211], v[28:31]
    ds_read_b64_tr_b16 v[94:95], v14 offset:26624
    s_cmp_eq_u32 s43, 4
    v_mfma_f32_16x16x32_bf16 v[32:35], v[64:67], v[208:211], v[32:35]
    ds_read_b64_tr_b16 v[96:97], v15 offset:24576
    v_mfma_f32_16x16x32_bf16 v[48:51], v[64:67], v[212:215], v[48:51]
    ds_read_b64_tr_b16 v[98:99], v15 offset:26624
    v_mfma_f32_16x16x32_bf16 v[52:55], v[68:71], v[212:215], v[52:55]
    ds_read_b64_tr_b16 v[100:101], v16 offset:24576
    v_mfma_f32_16x16x32_bf16 v[36:39], v[68:71], v[208:211], v[36:39]
    ds_read_b64_tr_b16 v[102:103], v16 offset:26624
    s_waitcnt lgkmcnt(8)
    v_mfma_f32_16x16x32_bf16 v[24:27], v[72:75], v[216:219], v[24:27]
    ds_read_b64_tr_b16 v[104:105], v13 offset:28672
    buffer_load_dwordx4 v[208:211], v128, s[8:11], s44 offen offset:0
    v_mfma_f32_16x16x32_bf16 v[40:43], v[72:75], v[220:223], v[40:43]
    ds_read_b64_tr_b16 v[106:107], v13 offset:30720
    buffer_load_dwordx4 v[212:215], v129, s[8:11], s44 offen offset:0
    v_mfma_f32_16x16x32_bf16 v[44:47], v[76:79], v[220:223], v[44:47]
    ds_read_b64_tr_b16 v[108:109], v14 offset:28672
    s_waitcnt vmcnt(10)
    v_mfma_f32_16x16x32_bf16 v[28:31], v[76:79], v[216:219], v[28:31]
    ds_read_b64_tr_b16 v[110:111], v14 offset:30720
    v_add_u32 v13, 32768, v13
    v_mfma_f32_16x16x32_bf16 v[32:35], v[80:83], v[216:219], v[32:35]
    ds_read_b64_tr_b16 v[112:113], v15 offset:28672
    v_add_u32 v14, 32768, v14
    v_mfma_f32_16x16x32_bf16 v[48:51], v[80:83], v[220:223], v[48:51]
    ds_read_b64_tr_b16 v[114:115], v15 offset:30720
    v_add_u32 v15, 32768, v15
    v_mfma_f32_16x16x32_bf16 v[52:55], v[84:87], v[220:223], v[52:55]
    ds_read_b64_tr_b16 v[116:117], v16 offset:28672
    ds_read_b64_tr_b16 v[118:119], v16 offset:30720
    v_mfma_f32_16x16x32_bf16 v[36:39], v[84:87], v[216:219], v[36:39]
    v_add_u32 v16, 32768, v16
    s_waitcnt lgkmcnt(8)
    s_cbranch_scc1 dm_22x
    v_mfma_f32_16x16x32_bf16 v[24:27], v[88:91], v[224:227], v[24:27]
    ds_read_b64_tr_b16 v[56:57], v13 offset:0
    buffer_load_dwordx4 v[216:219], v128, s[8:11], s44 offen offset:1024
    v_mfma_f32_16x16x32_bf16 v[40:43], v[88:91], v[228:231], v[40:43]
    ds_read_b64_tr_b16 v[58:59], v13 offset:2048
    buffer_load_dwordx4 v[220:223], v129, s[8:11], s44 offen offset:1024
    v_mfma_f32_16x16x32_bf16 v[44:47], v[92:95], v[228:231], v[44:47]
    ds_read_b64_tr_b16 v[60:61], v14 offset:0
    v_mfma_f32_16x16x32_bf16 v[28:31], v[92:95], v[224:227], v[28:31]
    ds_read_b64_tr_b16 v[62:63], v14 offset:2048
    v_mfma_f32_16x16x32_bf16 v[32:35], v[96:99], v[224:227], v[32:35]
    ds_read_b64_tr_b16 v[64:65], v15 offset:0
    v_mfma_f32_16x16x32_bf16 v[48:51], v[96:99], v[228:231], v[48:51]
    ds_read_b64_tr_b16 v[66:67], v15 offset:2048
    v_mfma_f32_16x16x32_bf16 v[52:55], v[100:103], v[228:231], v[52:55]
    ds_read_b64_tr_b16 v[68:69], v16 offset:0
    v_mfma_f32_16x16x32_bf16 v[36:39], v[100:103], v[224:227], v[36:39]
    ds_read_b64_tr_b16 v[70:71], v16 offset:2048
    s_waitcnt lgkmcnt(8)
    v_mfma_f32_16x16x32_bf16 v[24:27], v[104:107], v[232:235], v[24:27]
    ds_read_b64_tr_b16 v[72:73], v13 offset:4096
    buffer_load_dwordx4 v[224:227], v128, s[8:11], s44 offen offset:2048
    v_mfma_f32_16x16x32_bf16 v[40:43], v[104:107], v[236:239], v[40:43]
    ds_read_b64_tr_b16 v[74:75], v13 offset:6144
    buffer_load_dwordx4 v[228:231], v129, s[8:11], s44 offen offset:2048
    v_mfma_f32_16x16x32_bf16 v[44:47], v[108:111], v[236:239], v[44:47]
    ds_read_b64_tr_b16 v[76:77], v14 offset:4096
    s_waitcnt vmcnt(10)
    v_mfma_f32_16x16x32_bf16 v[28:31], v[108:111], v[232:235], v[28:31]
    ds_read_b64_tr_b16 v[78:79], v14 offset:6144
    v_mfma_f32_16x16x32_bf16 v[32:35], v[112:115], v[232:235], v[32:35]
    ds_read_b64_tr_b16 v[80:81], v15 offset:4096
    v_mfma_f32_16x16x32_bf16 v[48:51], v[112:115], v[236:239], v[48:51]
    ds_read_b64_tr_b16 v[82:83], v15 offset:6144
    v_mfma_f32_16x16x32_bf16 v[52:55], v[116:119], v[236:239], v[52:55]
    ds_read_b64_tr_b16 v[84:85], v16 offset:4096
    ds_read_b64_tr_b16 v[86:87], v16 offset:6144
    v_mfma_f32_16x16x32_bf16 v[36:39], v[116:119], v[232:235], v[36:39]
    s_waitcnt lgkmcnt(8)
    s_branch dm_22
dm_22x:
    v_mfma_f32_16x16x32_bf16 v[24:27], v[88:91], v[224:227], v[24:27]
    s_add_u32 s24, s62, 0x400000
    s_addc_u32 s25, s63, 0
    s_mov_b32 s26, 0x7e000
    v_mfma_f32_16x16x32_bf16 v[40:43], v[88:91], v[228:231], v[40:43]
    s_mov_b32 s27, 0x20000
    s_lshr_b32 s36, s38, 1
    v_mfma_f32_16x16x32_bf16 v[44:47], v[92:95], v[228:231], v[44:47]
    s_lshr_b32 s53, s36, 3
    s_lshl_b32 s53, s53, 14
    v_mfma_f32_16x16x32_bf16 v[28:31], v[92:95], v[224:227], v[28:31]
    s_and_b32 s40, s36, 7
    s_lshl_b32 s40, s40, 10
    v_mfma_f32_16x16x32_bf16 v[32:35], v[96:99], v[224:227], v[32:35]
    s_add_u32 s40, s40, s53
    s_lshl_b32 s36, s37, 16
    s_add_u32 s40, s40, s36
    v_mfma_f32_16x16x32_bf16 v[48:51], v[96:99], v[228:231], v[48:51]
    s_add_u32 s36, s40, 0
    buffer_load_dwordx4 v[160:163], v2, s[24:27], s36 offen offset:0 sc1
    v_mfma_f32_16x16x32_bf16 v[52:55], v[100:103], v[228:231], v[52:55]
    buffer_load_dwordx4 v[164:167], v2, s[24:27], s36 offen offset:1024 sc1
    s_add_u32 s36, s40, 65536
    v_mfma_f32_16x16x32_bf16 v[36:39], v[100:103], v[224:227], v[36:39]
    buffer_load_dwordx4 v[168:171], v2, s[24:27], s36 offen offset:0 sc1
    buffer_load_dwordx4 v[172:175], v2, s[24:27], s36 offen offset:1024 sc1
    s_waitcnt lgkmcnt(0)
    s_barrier
    v_mfma_f32_16x16x32_bf16 v[24:27], v[104:107], v[232:235], v[24:27]
    s_mul_i32 s36, s35, 256
    s_add_u32 s36, s36, 163328
    v_lshlrev_b32 v6, 4, v23
    v_add_u32 v6, s36, v6
    ds_read_b128 v[56:59], v6 offset:0
    v_mfma_f32_16x16x32_bf16 v[40:43], v[104:107], v[236:239], v[40:43]
    ds_read_b128 v[60:63], v6 offset:64
    ds_read_b128 v[64:67], v6 offset:128
    ds_read_b128 v[68:71], v6 offset:192
    s_lshl_b32 s36, s37, 8
    s_add_u32 s36, s36, 160776
    v_mfma_f32_16x16x32_bf16 v[44:47], v[108:111], v[236:239], v[44:47]
    v_lshlrev_b32 v7, 4, v22
    v_add_u32 v7, s36, v7
    ds_read_b64 v[72:73], v7 offset:0
    ds_read_b64 v[74:75], v7 offset:256
    s_lshl_b32 s53, s60, 24
    v_mfma_f32_16x16x32_bf16 v[28:31], v[108:111], v[232:235], v[28:31]
    s_add_u32 s53, s53, 167772160
    s_add_u32 s16, s4, s53
    s_addc_u32 s17, s5, 0
    s_mov_b32 s18, 8388608
    s_mov_b32 s19, 0x20000
    v_mfma_f32_16x16x32_bf16 v[32:35], v[112:115], v[232:235], v[32:35]
    v_mul_u32_u24 v12, 65536, v23
    v_lshl_add_u32 v12, v22, 4, v12
    s_mul_i32 s39, s38, 131072
    s_lshl_b32 s36, s37, 8
    s_add_u32 s39, s39, s36
    v_mfma_f32_16x16x32_bf16 v[48:51], v[112:115], v[236:239], v[48:51]
    s_add_u32 s39, s39, 16384
    s_lshl_b32 s36, s28, 11
    s_add_u32 s39, s39, s36
    s_lshr_b32 s36, s29, 2
    s_xor_b32 s36, s36, s94
    v_mfma_f32_16x16x32_bf16 v[52:55], v[116:119], v[236:239], v[52:55]
    s_and_b32 s36, s36, 1
    s_lshl_b32 s36, s36, 13
    s_add_u32 s39, s39, s36
    s_add_u32 s40, s39, 262144
    v_mfma_f32_16x16x32_bf16 v[36:39], v[116:119], v[232:235], v[36:39]
    s_waitcnt lgkmcnt(0)
    v_mul_f32 v134, 0xc0135761, v73
    v_mul_f32 v135, v73, v73
    v_mul_f32 v135, v135, v134
    v_mul_f32 v135, 0x3d372713, v135
    v_rcp_f32 v73, v73
    v_mul_f32 v136, 0xc0135761, v75
    v_mul_f32 v137, v75, v75
    v_mul_f32 v137, v137, v136
    v_mul_f32 v137, 0x3d372713, v137
    v_rcp_f32 v75, v75
    v_pk_fma_f32 v[24:25], v[72:73], v[56:57], v[24:25] op_sel_hi:[0,1,1] neg_lo:[1,0,0] neg_hi:[1,0,0]
    v_pk_fma_f32 v[26:27], v[72:73], v[58:59], v[26:27] op_sel_hi:[0,1,1] neg_lo:[1,0,0] neg_hi:[1,0,0]
    v_pk_mul_f32 v[122:123], v[24:25], v[24:25]
    v_pk_mul_f32 v[124:125], v[26:27], v[26:27]
    v_pk_fma_f32 v[122:123], v[122:123], v[134:135], v[134:135] op_sel:[0,1,0] op_sel_hi:[1,1,0]
    v_pk_fma_f32 v[124:125], v[124:125], v[134:135], v[134:135] op_sel:[0,1,0] op_sel_hi:[1,1,0]
    v_pk_mul_f32 v[122:123], v[122:123], v[24:25]
    v_pk_mul_f32 v[124:125], v[124:125], v[26:27]
    v_exp_f32 v122, v122
    v_exp_f32 v123, v123
    v_exp_f32 v124, v124
    v_exp_f32 v125, v125
    v_pk_fma_f32 v[122:123], v[122:123], v[72:73], v[72:73] op_sel:[0,1,1] op_sel_hi:[1,1,1]
    v_pk_fma_f32 v[124:125], v[124:125], v[72:73], v[72:73] op_sel:[0,1,1] op_sel_hi:[1,1,1]
    v_rcp_f32 v122, v122
    v_rcp_f32 v123, v123
    v_rcp_f32 v124, v124
    v_rcp_f32 v125, v125
    v_pk_mul_f32 v[24:25], v[24:25], v[122:123]
    v_pk_mul_f32 v[26:27], v[26:27], v[124:125]
    v_pk_fma_f32 v[28:29], v[72:73], v[60:61], v[28:29] op_sel_hi:[0,1,1] neg_lo:[1,0,0] neg_hi:[1,0,0]
    v_pk_fma_f32 v[30:31], v[72:73], v[62:63], v[30:31] op_sel_hi:[0,1,1] neg_lo:[1,0,0] neg_hi:[1,0,0]
    v_pk_mul_f32 v[122:123], v[28:29], v[28:29]
    v_pk_mul_f32 v[124:125], v[30:31], v[30:31]
    v_pk_fma_f32 v[122:123], v[122:123], v[134:135], v[134:135] op_sel:[0,1,0] op_sel_hi:[1,1,0]
    v_pk_fma_f32 v[124:125], v[124:125], v[134:135], v[134:135] op_sel:[0,1,0] op_sel_hi:[1,1,0]
    v_pk_mul_f32 v[122:123], v[122:123], v[28:29]
    v_pk_mul_f32 v[124:125], v[124:125], v[30:31]
    v_exp_f32 v122, v122
    v_exp_f32 v123, v123
    v_exp_f32 v124, v124
    v_exp_f32 v125, v125
    v_pk_fma_f32 v[122:123], v[122:123], v[72:73], v[72:73] op_sel:[0,1,1] op_sel_hi:[1,1,1]
    v_pk_fma_f32 v[124:125], v[124:125], v[72:73], v[72:73] op_sel:[0,1,1] op_sel_hi:[1,1,1]
    v_rcp_f32 v122, v122
    v_rcp_f32 v123, v123
    v_rcp_f32 v124, v124
    v_rcp_f32 v125, v125
    v_pk_mul_f32 v[28:29], v[28:29], v[122:123]
    v_pk_mul_f32 v[30:31], v[30:31], v[124:125]
    v_cvt_pk_bf16_f32 v24, v24, v25
    v_cvt_pk_bf16_f32 v25, v26, v27
    v_cvt_pk_bf16_f32 v26, v28, v29
    v_cvt_pk_bf16_f32 v27, v30, v31
    buffer_store_dwordx4 v[24:27], v12, s[16:19], s39 offen offset:0 sc1
    v_pk_fma_f32 v[40:41], v[74:75], v[56:57], v[40:41] op_sel_hi:[0,1,1] neg_lo:[1,0,0] neg_hi:[1,0,0]
    v_pk_fma_f32 v[42:43], v[74:75], v[58:59], v[42:43] op_sel_hi:[0,1,1] neg_lo:[1,0,0] neg_hi:[1,0,0]
    v_pk_mul_f32 v[122:123], v[40:41], v[40:41]
    v_pk_mul_f32 v[124:125], v[42:43], v[42:43]
    v_pk_fma_f32 v[122:123], v[122:123], v[136:137], v[136:137] op_sel:[0,1,0] op_sel_hi:[1,1,0]
    v_pk_fma_f32 v[124:125], v[124:125], v[136:137], v[136:137] op_sel:[0,1,0] op_sel_hi:[1,1,0]
    v_pk_mul_f32 v[122:123], v[122:123], v[40:41]
    v_pk_mul_f32 v[124:125], v[124:125], v[42:43]
    v_exp_f32 v122, v122
    v_exp_f32 v123, v123
    v_exp_f32 v124, v124
    v_exp_f32 v125, v125
    v_pk_fma_f32 v[122:123], v[122:123], v[74:75], v[74:75] op_sel:[0,1,1] op_sel_hi:[1,1,1]
    v_pk_fma_f32 v[124:125], v[124:125], v[74:75], v[74:75] op_sel:[0,1,1] op_sel_hi:[1,1,1]
    v_rcp_f32 v122, v122
    v_rcp_f32 v123, v123
    v_rcp_f32 v124, v124
    v_rcp_f32 v125, v125
    v_pk_mul_f32 v[40:41], v[40:41], v[122:123]
    v_pk_mul_f32 v[42:43], v[42:43], v[124:125]
    v_pk_fma_f32 v[44:45], v[74:75], v[60:61], v[44:45] op_sel_hi:[0,1,1] neg_lo:[1,0,0] neg_hi:[1,0,0]
    v_pk_fma_f32 v[46:47], v[74:75], v[62:63], v[46:47] op_sel_hi:[0,1,1] neg_lo:[1,0,0] neg_hi:[1,0,0]
    v_pk_mul_f32 v[122:123], v[44:45], v[44:45]
    v_pk_mul_f32 v[124:125], v[46:47], v[46:47]
    v_pk_fma_f32 v[122:123], v[122:123], v[136:137], v[136:137] op_sel:[0,1,0] op_sel_hi:[1,1,0]
    v_pk_fma_f32 v[124:125], v[124:125], v[136:137], v[136:137] op_sel:[0,1,0] op_sel_hi:[1,1,0]
    v_pk_mul_f32 v[122:123], v[122:123], v[44:45]
    v_pk_mul_f32 v[124:125], v[124:125], v[46:47]
    v_exp_f32 v122, v122
    v_exp_f32 v123, v123
    v_exp_f32 v124, v124
    v_exp_f32 v125, v125
    v_pk_fma_f32 v[122:123], v[122:123], v[74:75], v[74:75] op_sel:[0,1,1] op_sel_hi:[1,1,1]
    v_pk_fma_f32 v[124:125], v[124:125], v[74:75], v[74:75] op_sel:[0,1,1] op_sel_hi:[1,1,1]
    v_rcp_f32 v122, v122
    v_rcp_f32 v123, v123
    v_rcp_f32 v124, v124
    v_rcp_f32 v125, v125
    v_pk_mul_f32 v[44:45], v[44:45], v[122:123]
    v_pk_mul_f32 v[46:47], v[46:47], v[124:125]
    v_cvt_pk_bf16_f32 v40, v40, v41
    v_cvt_pk_bf16_f32 v41, v42, v43
    v_cvt_pk_bf16_f32 v42, v44, v45
    v_cvt_pk_bf16_f32 v43, v46, v47
    buffer_store_dwordx4 v[40:43], v12, s[16:19], s39 offen offset:256 sc1
    v_pk_fma_f32 v[32:33], v[72:73], v[64:65], v[32:33] op_sel_hi:[0,1,1] neg_lo:[1,0,0] neg_hi:[1,0,0]
    v_pk_fma_f32 v[34:35], v[72:73], v[66:67], v[34:35] op_sel_hi:[0,1,1] neg_lo:[1,0,0] neg_hi:[1,0,0]
    v_pk_mul_f32 v[122:123], v[32:33], v[32:33]
    v_pk_mul_f32 v[124:125], v[34:35], v[34:35]
    v_pk_fma_f32 v[122:123], v[122:123], v[134:135], v[134:135] op_sel:[0,1,0] op_sel_hi:[1,1,0]
    v_pk_fma_f32 v[124:125], v[124:125], v[134:135], v[134:135] op_sel:[0,1,0] op_sel_hi:[1,1,0]
    v_pk_mul_f32 v[122:123], v[122:123], v[32:33]
    v_pk_mul_f32 v[124:125], v[124:125], v[34:35]
    v_exp_f32 v122, v122
    v_exp_f32 v123, v123
    v_exp_f32 v124, v124
    v_exp_f32 v125, v125
    v_pk_fma_f32 v[122:123], v[122:123], v[72:73], v[72:73] op_sel:[0,1,1] op_sel_hi:[1,1,1]
    v_pk_fma_f32 v[124:125], v[124:125], v[72:73], v[72:73] op_sel:[0,1,1] op_sel_hi:[1,1,1]
    v_rcp_f32 v122, v122
    v_rcp_f32 v123, v123
    v_rcp_f32 v124, v124
    v_rcp_f32 v125, v125
    v_pk_mul_f32 v[32:33], v[32:33], v[122:123]
    v_pk_mul_f32 v[34:35], v[34:35], v[124:125]
    v_pk_fma_f32 v[36:37], v[72:73], v[68:69], v[36:37] op_sel_hi:[0,1,1] neg_lo:[1,0,0] neg_hi:[1,0,0]
    v_pk_fma_f32 v[38:39], v[72:73], v[70:71], v[38:39] op_sel_hi:[0,1,1] neg_lo:[1,0,0] neg_hi:[1,0,0]
    v_pk_mul_f32 v[122:123], v[36:37], v[36:37]
    v_pk_mul_f32 v[124:125], v[38:39], v[38:39]
    v_pk_fma_f32 v[122:123], v[122:123], v[134:135], v[134:135] op_sel:[0,1,0] op_sel_hi:[1,1,0]
    v_pk_fma_f32 v[124:125], v[124:125], v[134:135], v[134:135] op_sel:[0,1,0] op_sel_hi:[1,1,0]
    v_pk_mul_f32 v[122:123], v[122:123], v[36:37]
    v_pk_mul_f32 v[124:125], v[124:125], v[38:39]
    v_exp_f32 v122, v122
    v_exp_f32 v123, v123
    v_exp_f32 v124, v124
    v_exp_f32 v125, v125
    v_pk_fma_f32 v[122:123], v[122:123], v[72:73], v[72:73] op_sel:[0,1,1] op_sel_hi:[1,1,1]
    v_pk_fma_f32 v[124:125], v[124:125], v[72:73], v[72:73] op_sel:[0,1,1] op_sel_hi:[1,1,1]
    v_rcp_f32 v122, v122
    v_rcp_f32 v123, v123
    v_rcp_f32 v124, v124
    v_rcp_f32 v125, v125
    v_pk_mul_f32 v[36:37], v[36:37], v[122:123]
    v_pk_mul_f32 v[38:39], v[38:39], v[124:125]
    v_cvt_pk_bf16_f32 v32, v32, v33
    v_cvt_pk_bf16_f32 v33, v34, v35
    v_cvt_pk_bf16_f32 v34, v36, v37
    v_cvt_pk_bf16_f32 v35, v38, v39
    buffer_store_dwordx4 v[32:35], v12, s[16:19], s40 offen offset:0 sc1
    v_pk_fma_f32 v[48:49], v[74:75], v[64:65], v[48:49] op_sel_hi:[0,1,1] neg_lo:[1,0,0] neg_hi:[1,0,0]
    v_pk_fma_f32 v[50:51], v[74:75], v[66:67], v[50:51] op_sel_hi:[0,1,1] neg_lo:[1,0,0] neg_hi:[1,0,0]
    v_pk_mul_f32 v[122:123], v[48:49], v[48:49]
    v_pk_mul_f32 v[124:125], v[50:51], v[50:51]
    v_pk_fma_f32 v[122:123], v[122:123], v[136:137], v[136:137] op_sel:[0,1,0] op_sel_hi:[1,1,0]
    v_pk_fma_f32 v[124:125], v[124:125], v[136:137], v[136:137] op_sel:[0,1,0] op_sel_hi:[1,1,0]
    v_pk_mul_f32 v[122:123], v[122:123], v[48:49]
    v_pk_mul_f32 v[124:125], v[124:125], v[50:51]
    v_exp_f32 v122, v122
    v_exp_f32 v123, v123
    v_exp_f32 v124, v124
    v_exp_f32 v125, v125
    v_pk_fma_f32 v[122:123], v[122:123], v[74:75], v[74:75] op_sel:[0,1,1] op_sel_hi:[1,1,1]
    v_pk_fma_f32 v[124:125], v[124:125], v[74:75], v[74:75] op_sel:[0,1,1] op_sel_hi:[1,1,1]
    v_rcp_f32 v122, v122
    v_rcp_f32 v123, v123
    v_rcp_f32 v124, v124
    v_rcp_f32 v125, v125
    v_pk_mul_f32 v[48:49], v[48:49], v[122:123]
    v_pk_mul_f32 v[50:51], v[50:51], v[124:125]
    v_pk_fma_f32 v[52:53], v[74:75], v[68:69], v[52:53] op_sel_hi:[0,1,1] neg_lo:[1,0,0] neg_hi:[1,0,0]
    v_pk_fma_f32 v[54:55], v[74:75], v[70:71], v[54:55] op_sel_hi:[0,1,1] neg_lo:[1,0,0] neg_hi:[1,0,0]
    v_pk_mul_f32 v[122:123], v[52:53], v[52:53]
    v_pk_mul_f32 v[124:125], v[54:55], v[54:55]
    v_pk_fma_f32 v[122:123], v[122:123], v[136:137], v[136:137] op_sel:[0,1,0] op_sel_hi:[1,1,0]
    v_pk_fma_f32 v[124:125], v[124:125], v[136:137], v[136:137] op_sel:[0,1,0] op_sel_hi:[1,1,0]
    v_pk_mul_f32 v[122:123], v[122:123], v[52:53]
    v_pk_mul_f32 v[124:125], v[124:125], v[54:55]
    v_exp_f32 v122, v122
    v_exp_f32 v123, v123
    v_exp_f32 v124, v124
    v_exp_f32 v125, v125
    v_pk_fma_f32 v[122:123], v[122:123], v[74:75], v[74:75] op_sel:[0,1,1] op_sel_hi:[1,1,1]
    v_pk_fma_f32 v[124:125], v[124:125], v[74:75], v[74:75] op_sel:[0,1,1] op_sel_hi:[1,1,1]
    v_rcp_f32 v122, v122
    v_rcp_f32 v123, v123
    v_rcp_f32 v124, v124
    v_rcp_f32 v125, v125
    v_pk_mul_f32 v[52:53], v[52:53], v[122:123]
    v_pk_mul_f32 v[54:55], v[54:55], v[124:125]
    v_cvt_pk_bf16_f32 v48, v48, v49
    v_cvt_pk_bf16_f32 v49, v50, v51
    v_cvt_pk_bf16_f32 v50, v52, v53
    v_cvt_pk_bf16_f32 v51, v54, v55
    buffer_store_dwordx4 v[48:51], v12, s[16:19], s40 offen offset:256 sc1
    s_add_u32 s53, s55, 256
    s_and_b32 s54, s29, 4
    s_lshl_b32 s54, s54, 5
    s_add_u32 s53, s53, s54
    v_mov_b32 v8, 1
    v_mov_b32 v9, 162816
    v_mov_b32 v11, 0
    s_mov_b64 exec, 1
    s_waitcnt vmcnt(0)
    ds_add_rtn_u32 v10, v9, v8
    s_waitcnt lgkmcnt(0)
    v_readfirstlane_b32 s54, v10
    s_nop 0
    s_and_b32 s54, s54, 3
    s_cmp_lg_u32 s54, 3
    s_cbranch_scc1 pub_23
    buffer_atomic_add v8, v11, s[56:59], s53 offen sc1
    v_mov_b32 v9, 162872
    ds_add_u32 v9, v8
pub_23:
    s_mov_b64 exec, -1
    s_mov_b32 s34, s30
    s_mov_b32 s35, 0
    v_and_b32 v22, 15, v1
    v_lshrrev_b32 v23, 4, v1
    s_mul_i32 s37, s34, 2
    s_mul_i32 s38, s29, 4
    s_mul_i32 s36, s35, 4
    s_add_u32 s38, s38, s36
    s_lshr_b32 s36, s38, 1
    s_lshr_b32 s53, s36, 3
    s_lshl_b32 s53, s53, 14
    s_and_b32 s39, s36, 7
    s_lshl_b32 s39, s39, 10
    s_add_u32 s39, s39, s53
    s_lshl_b32 s36, s37, 16
    s_add_u32 s39, s39, s36
    s_lshl_b32 s53, s60, 24
    s_add_u32 s53, s53, 167772160
    s_add_u32 s8, s4, s53
    s_addc_u32 s9, s5, 0
    s_mov_b32 s10, 8388608
    s_mov_b32 s11, 0x20000
    v_mul_u32_u24 v126, 65536, v23
    v_lshl_add_u32 v126, v22, 4, v126
    v_add_u32 v127, 262144, v126
    v_add_u32 v128, 524288, v126
    v_add_u32 v129, 786432, v126
    v_add_u32 v130, 1048576, v126
    v_add_u32 v131, 1310720, v126
    v_add_u32 v132, 1572864, v126
    v_add_u32 v133, 1835008, v126
    s_lshr_b32 s36, s67, 2
    s_add_u32 s36, s36, 0
    s_and_b32 s36, s36, 3
    s_mul_i32 s44, s36, 2097152
    s_xor_b32 s53, s36, s94
    s_and_b32 s53, s53, 1
    s_lshl_b32 s53, s53, 13
    s_add_u32 s44, s44, s53
    s_lshr_b32 s53, s36, 1
    s_lshl_b32 s53, s53, 4
    s_add_u32 s53, s53, 16
    s_sub_u32 s54, 0, s53
    s_bitcmp1_b32 s36, 0
    s_cselect_b32 s53, s53, s54
    s_add_u32 s44, s44, s53
    s_lshl_b32 s36, s28, 2
    s_add_u32 s36, s36, s34
    s_lshl_b32 s36, s36, 9
    s_add_u32 s36, s36, 16384
    s_add_u32 s44, s44, s36
    s_lshr_b32 s36, s67, 2
    s_add_u32 s36, s36, 1
    s_and_b32 s36, s36, 3
    s_mul_i32 s45, s36, 2097152
    s_xor_b32 s53, s36, s94
    s_and_b32 s53, s53, 1
    s_lshl_b32 s53, s53, 13
    s_add_u32 s45, s45, s53
    s_lshr_b32 s53, s36, 1
    s_lshl_b32 s53, s53, 4
    s_add_u32 s53, s53, 16
    s_sub_u32 s54, 0, s53
    s_bitcmp1_b32 s36, 0
    s_cselect_b32 s53, s53, s54
    s_add_u32 s45, s45, s53
    s_lshl_b32 s36, s28, 2
    s_add_u32 s36, s36, s34
    s_lshl_b32 s36, s36, 9
    s_add_u32 s36, s36, 16384
    s_add_u32 s45, s45, s36
    s_lshr_b32 s36, s67, 2
    s_add_u32 s36, s36, 2
    s_and_b32 s36, s36, 3
    s_mul_i32 s46, s36, 2097152
    s_xor_b32 s53, s36, s94
    s_and_b32 s53, s53, 1
    s_lshl_b32 s53, s53, 13
    s_add_u32 s46, s46, s53
    s_lshr_b32 s53, s36, 1
    s_lshl_b32 s53, s53, 4
    s_add_u32 s53, s53, 16
    s_sub_u32 s54, 0, s53
    s_bitcmp1_b32 s36, 0
    s_cselect_b32 s53, s53, s54
    s_add_u32 s46, s46, s53
    s_lshl_b32 s36, s28, 2
    s_add_u32 s36, s36, s34
    s_lshl_b32 s36, s36, 9
    s_add_u32 s36, s36, 16384
    s_add_u32 s46, s46, s36
    s_lshr_b32 s36, s67, 2
    s_add_u32 s36, s36, 3
    s_and_b32 s36, s36, 3
    s_mul_i32 s47, s36, 2097152
    s_xor_b32 s53, s36, s94
    s_and_b32 s53, s53, 1
    s_lshl_b32 s53, s53, 13
    s_add_u32 s47, s47, s53
    s_lshr_b32 s53, s36, 1
    s_lshl_b32 s53, s53, 4
    s_add_u32 s53, s53, 16
    s_sub_u32 s54, 0, s53
    s_bitcmp1_b32 s36, 0
    s_cselect_b32 s53, s53, s54
    s_add_u32 s47, s47, s53
    s_lshl_b32 s36, s28, 2
    s_add_u32 s36, s36, s34
    s_lshl_b32 s36, s36, 9
    s_add_u32 s36, s36, 16384
    s_add_u32 s47, s47, s36
    v_lshrrev_b32 v6, 2, v1
    v_mul_u32_u24 v13, 128, v6
    v_and_b32 v7, 3, v1
    v_lshl_add_u32 v13, v7, 3, v13
    v_add_u32 v13, 0, v13
    v_bfe_u32 v6, v6, 1, 2
    s_mul_i32 s36, s35, 4
    s_add_u32 s36, s36, 3
    v_xor_b32 v7, s36, v6
    v_lshl_add_u32 v16, v7, 5, v13
    s_mul_i32 s36, s35, 4
    s_add_u32 s36, s36, 2
    v_xor_b32 v7, s36, v6
    v_lshl_add_u32 v15, v7, 5, v13
    s_mul_i32 s36, s35, 4
    s_add_u32 s36, s36, 1
    v_xor_b32 v7, s36, v6
    v_lshl_add_u32 v14, v7, 5, v13
    s_mul_i32 s36, s35, 4
    s_add_u32 s36, s36, 0
    v_xor_b32 v7, s36, v6
    v_lshl_add_u32 v13, v7, 5, v13
    s_lshl_b32 s36, s37, 8
    s_add_u32 s36, s36, 160768
    v_lshlrev_b32 v7, 4, v22
    v_add_u32 v7, s36, v7
    ds_read_b64 v[56:57], v7 offset:0
    ds_read_b64 v[58:59], v7 offset:256
    s_waitcnt lgkmcnt(0)
    v_lshlrev_b32 v24, 16, v160
    v_and_b32 v25, 0xffff0000, v160
    v_pk_add_f32 v[24:25], v[24:25], v[56:57] op_sel_hi:[1,0] neg_lo:[0,1] neg_hi:[0,1]
    v_cvt_pk_bf16_f32 v120, v24, v25
    v_lshlrev_b32 v24, 16, v120
    v_and_b32 v25, 0xffff0000, v120
    v_pk_mul_f32 v[24:25], v[24:25], v[56:57] op_sel:[0,1] op_sel_hi:[1,1]
    v_cvt_pk_bf16_f32 v120, v24, v25
    v_lshlrev_b32 v24, 16, v120
    v_and_b32 v25, 0xffff0000, v120
    v_lshlrev_b32 v26, 16, v161
    v_and_b32 v27, 0xffff0000, v161
    v_pk_add_f32 v[26:27], v[26:27], v[56:57] op_sel_hi:[1,0] neg_lo:[0,1] neg_hi:[0,1]
    v_cvt_pk_bf16_f32 v120, v26, v27
    v_lshlrev_b32 v26, 16, v120
    v_and_b32 v27, 0xffff0000, v120
    v_pk_mul_f32 v[26:27], v[26:27], v[56:57] op_sel:[0,1] op_sel_hi:[1,1]
    v_cvt_pk_bf16_f32 v120, v26, v27
    v_lshlrev_b32 v26, 16, v120
    v_and_b32 v27, 0xffff0000, v120
    v_lshlrev_b32 v28, 16, v162
    v_and_b32 v29, 0xffff0000, v162
    v_pk_add_f32 v[28:29], v[28:29], v[56:57] op_sel_hi:[1,0] neg_lo:[0,1] neg_hi:[0,1]
    v_cvt_pk_bf16_f32 v120, v28, v29
    v_lshlrev_b32 v28, 16, v120
    v_and_b32 v29, 0xffff0000, v120
    v_pk_mul_f32 v[28:29], v[28:29], v[56:57] op_sel:[0,1] op_sel_hi:[1,1]
    v_cvt_pk_bf16_f32 v120, v28, v29
    v_lshlrev_b32 v28, 16, v120
    v_and_b32 v29, 0xffff0000, v120
    v_lshlrev_b32 v30, 16, v163
    v_and_b32 v31, 0xffff0000, v163
    v_pk_add_f32 v[30:31], v[30:31], v[56:57] op_sel_hi:[1,0] neg_lo:[0,1] neg_hi:[0,1]
    v_cvt_pk_bf16_f32 v120, v30, v31
    v_lshlrev_b32 v30, 16, v120
    v_and_b32 v31, 0xffff0000, v120
    v_pk_mul_f32 v[30:31], v[30:31], v[56:57] op_sel:[0,1] op_sel_hi:[1,1]
    v_cvt_pk_bf16_f32 v120, v30, v31
    v_lshlrev_b32 v30, 16, v120
    v_and_b32 v31, 0xffff0000, v120
    v_lshlrev_b32 v32, 16, v164
    v_and_b32 v33, 0xffff0000, v164
    v_pk_add_f32 v[32:33], v[32:33], v[56:57] op_sel_hi:[1,0] neg_lo:[0,1] neg_hi:[0,1]
    v_cvt_pk_bf16_f32 v120, v32, v33
    v_lshlrev_b32 v32, 16, v120
    v_and_b32 v33, 0xffff0000, v120
    v_pk_mul_f32 v[32:33], v[32:33], v[56:57] op_sel:[0,1] op_sel_hi:[1,1]
    v_cvt_pk_bf16_f32 v120, v32, v33
    v_lshlrev_b32 v32, 16, v120
    v_and_b32 v33, 0xffff0000, v120
    v_lshlrev_b32 v34, 16, v165
    v_and_b32 v35, 0xffff0000, v165
    v_pk_add_f32 v[34:35], v[34:35], v[56:57] op_sel_hi:[1,0] neg_lo:[0,1] neg_hi:[0,1]
    v_cvt_pk_bf16_f32 v120, v34, v35
    v_lshlrev_b32 v34, 16, v120
    v_and_b32 v35, 0xffff0000, v120
    v_pk_mul_f32 v[34:35], v[34:35], v[56:57] op_sel:[0,1] op_sel_hi:[1,1]
    v_cvt_pk_bf16_f32 v120, v34, v35
    v_lshlrev_b32 v34, 16, v120
    v_and_b32 v35, 0xffff0000, v120
    v_lshlrev_b32 v36, 16, v166
    v_and_b32 v37, 0xffff0000, v166
    v_pk_add_f32 v[36:37], v[36:37], v[56:57] op_sel_hi:[1,0] neg_lo:[0,1] neg_hi:[0,1]
    v_cvt_pk_bf16_f32 v120, v36, v37
    v_lshlrev_b32 v36, 16, v120
    v_and_b32 v37, 0xffff0000, v120
    v_pk_mul_f32 v[36:37], v[36:37], v[56:57] op_sel:[0,1] op_sel_hi:[1,1]
    v_cvt_pk_bf16_f32 v120, v36, v37
    v_lshlrev_b32 v36, 16, v120
    v_and_b32 v37, 0xffff0000, v120
    v_lshlrev_b32 v38, 16, v167
    v_and_b32 v39, 0xffff0000, v167
    v_pk_add_f32 v[38:39], v[38:39], v[56:57] op_sel_hi:[1,0] neg_lo:[0,1] neg_hi:[0,1]
    v_cvt_pk_bf16_f32 v120, v38, v39
    v_lshlrev_b32 v38, 16, v120
    v_and_b32 v39, 0xffff0000, v120
    v_pk_mul_f32 v[38:39], v[38:39], v[56:57] op_sel:[0,1] op_sel_hi:[1,1]
    v_cvt_pk_bf16_f32 v120, v38, v39
    v_lshlrev_b32 v38, 16, v120
    v_and_b32 v39, 0xffff0000, v120
    v_lshlrev_b32 v40, 16, v168
    v_and_b32 v41, 0xffff0000, v168
    v_pk_add_f32 v[40:41], v[40:41], v[58:59] op_sel_hi:[1,0] neg_lo:[0,1] neg_hi:[0,1]
    v_cvt_pk_bf16_f32 v120, v40, v41
    v_lshlrev_b32 v40, 16, v120
    v_and_b32 v41, 0xffff0000, v120
    v_pk_mul_f32 v[40:41], v[40:41], v[58:59] op_sel:[0,1] op_sel_hi:[1,1]
    v_cvt_pk_bf16_f32 v120, v40, v41
    v_lshlrev_b32 v40, 16, v120
    v_and_b32 v41, 0xffff0000, v120
    v_lshlrev_b32 v42, 16, v169
    v_and_b32 v43, 0xffff0000, v169
    v_pk_add_f32 v[42:43], v[42:43], v[58:59] op_sel_hi:[1,0] neg_lo:[0,1] neg_hi:[0,1]
    v_cvt_pk_bf16_f32 v120, v42, v43
    v_lshlrev_b32 v42, 16, v120
    v_and_b32 v43, 0xffff0000, v120
    v_pk_mul_f32 v[42:43], v[42:43], v[58:59] op_sel:[0,1] op_sel_hi:[1,1]
    v_cvt_pk_bf16_f32 v120, v42, v43
    v_lshlrev_b32 v42, 16, v120
    v_and_b32 v43, 0xffff0000, v120
    v_lshlrev_b32 v44, 16, v170
    v_and_b32 v45, 0xffff0000, v170
    v_pk_add_f32 v[44:45], v[44:45], v[58:59] op_sel_hi:[1,0] neg_lo:[0,1] neg_hi:[0,1]
    v_cvt_pk_bf16_f32 v120, v44, v45
    v_lshlrev_b32 v44, 16, v120
    v_and_b32 v45, 0xffff0000, v120
    v_pk_mul_f32 v[44:45], v[44:45], v[58:59] op_sel:[0,1] op_sel_hi:[1,1]
    v_cvt_pk_bf16_f32 v120, v44, v45
    v_lshlrev_b32 v44, 16, v120
    v_and_b32 v45, 0xffff0000, v120
    v_lshlrev_b32 v46, 16, v171
    v_and_b32 v47, 0xffff0000, v171
    v_pk_add_f32 v[46:47], v[46:47], v[58:59] op_sel_hi:[1,0] neg_lo:[0,1] neg_hi:[0,1]
    v_cvt_pk_bf16_f32 v120, v46, v47
    v_lshlrev_b32 v46, 16, v120
    v_and_b32 v47, 0xffff0000, v120
    v_pk_mul_f32 v[46:47], v[46:47], v[58:59] op_sel:[0,1] op_sel_hi:[1,1]
    v_cvt_pk_bf16_f32 v120, v46, v47
    v_lshlrev_b32 v46, 16, v120
    v_and_b32 v47, 0xffff0000, v120
    v_lshlrev_b32 v48, 16, v172
    v_and_b32 v49, 0xffff0000, v172
    v_pk_add_f32 v[48:49], v[48:49], v[58:59] op_sel_hi:[1,0] neg_lo:[0,1] neg_hi:[0,1]
    v_cvt_pk_bf16_f32 v120, v48, v49
    v_lshlrev_b32 v48, 16, v120
    v_and_b32 v49, 0xffff0000, v120
    v_pk_mul_f32 v[48:49], v[48:49], v[58:59] op_sel:[0,1] op_sel_hi:[1,1]
    v_cvt_pk_bf16_f32 v120, v48, v49
    v_lshlrev_b32 v48, 16, v120
    v_and_b32 v49, 0xffff0000, v120
    v_lshlrev_b32 v50, 16, v173
    v_and_b32 v51, 0xffff0000, v173
    v_pk_add_f32 v[50:51], v[50:51], v[58:59] op_sel_hi:[1,0] neg_lo:[0,1] neg_hi:[0,1]
    v_cvt_pk_bf16_f32 v120, v50, v51
    v_lshlrev_b32 v50, 16, v120
    v_and_b32 v51, 0xffff0000, v120
    v_pk_mul_f32 v[50:51], v[50:51], v[58:59] op_sel:[0,1] op_sel_hi:[1,1]
    v_cvt_pk_bf16_f32 v120, v50, v51
    v_lshlrev_b32 v50, 16, v120
    v_and_b32 v51, 0xffff0000, v120
    v_lshlrev_b32 v52, 16, v174
    v_and_b32 v53, 0xffff0000, v174
    v_pk_add_f32 v[52:53], v[52:53], v[58:59] op_sel_hi:[1,0] neg_lo:[0,1] neg_hi:[0,1]
    v_cvt_pk_bf16_f32 v120, v52, v53
    v_lshlrev_b32 v52, 16, v120
    v_and_b32 v53, 0xffff0000, v120
    v_pk_mul_f32 v[52:53], v[52:53], v[58:59] op_sel:[0,1] op_sel_hi:[1,1]
    v_cvt_pk_bf16_f32 v120, v52, v53
    v_lshlrev_b32 v52, 16, v120
    v_and_b32 v53, 0xffff0000, v120
    v_lshlrev_b32 v54, 16, v175
    v_and_b32 v55, 0xffff0000, v175
    v_pk_add_f32 v[54:55], v[54:55], v[58:59] op_sel_hi:[1,0] neg_lo:[0,1] neg_hi:[0,1]
    v_cvt_pk_bf16_f32 v120, v54, v55
    v_lshlrev_b32 v54, 16, v120
    v_and_b32 v55, 0xffff0000, v120
    v_pk_mul_f32 v[54:55], v[54:55], v[58:59] op_sel:[0,1] op_sel_hi:[1,1]
    v_cvt_pk_bf16_f32 v120, v54, v55
    v_lshlrev_b32 v54, 16, v120
    v_and_b32 v55, 0xffff0000, v120
    s_mov_b32 s43, 0
    s_waitcnt lgkmcnt(0)
    s_barrier
    buffer_load_dwordx4 v[176:179], v126, s[8:11], s44 offen offset:0
    buffer_load_dwordx4 v[180:183], v126, s[8:11], s44 offen offset:256
    buffer_load_dwordx4 v[184:187], v127, s[8:11], s44 offen offset:0
    buffer_load_dwordx4 v[188:191], v127, s[8:11], s44 offen offset:256
    buffer_load_dwordx4 v[192:195], v128, s[8:11], s44 offen offset:0
    buffer_load_dwordx4 v[196:199], v128, s[8:11], s44 offen offset:256
    buffer_load_dwordx4 v[200:203], v129, s[8:11], s44 offen offset:0
    buffer_load_dwordx4 v[204:207], v129, s[8:11], s44 offen offset:256
    ds_read_b64_tr_b16 v[56:57], v13 offset:0
    ds_read_b64_tr_b16 v[58:59], v13 offset:2048
    ds_read_b64_tr_b16 v[60:61], v14 offset:0
    ds_read_b64_tr_b16 v[62:63], v14 offset:2048
    ds_read_b64_tr_b16 v[64:65], v15 offset:0
    ds_read_b64_tr_b16 v[66:67], v15 offset:2048
    ds_read_b64_tr_b16 v[68:69], v16 offset:0
    ds_read_b64_tr_b16 v[70:71], v16 offset:2048
    ds_read_b64_tr_b16 v[72:73], v13 offset:4096
    ds_read_b64_tr_b16 v[74:75], v13 offset:6144
    ds_read_b64_tr_b16 v[76:77], v14 offset:4096
    ds_read_b64_tr_b16 v[78:79], v14 offset:6144
    ds_read_b64_tr_b16 v[80:81], v15 offset:4096
    ds_read_b64_tr_b16 v[82:83], v15 offset:6144
    ds_read_b64_tr_b16 v[84:85], v16 offset:4096
    ds_read_b64_tr_b16 v[86:87], v16 offset:6144
    buffer_load_dwordx4 v[208:211], v130, s[8:11], s44 offen offset:0
    buffer_load_dwordx4 v[212:215], v130, s[8:11], s44 offen offset:256
    buffer_load_dwordx4 v[216:219], v131, s[8:11], s44 offen offset:0
    buffer_load_dwordx4 v[220:223], v131, s[8:11], s44 offen offset:256
    buffer_load_dwordx4 v[224:227], v132, s[8:11], s44 offen offset:0
    buffer_load_dwordx4 v[228:231], v132, s[8:11], s44 offen offset:256
    s_waitcnt vmcnt(10) lgkmcnt(0)
dm_24:
    v_mfma_f32_16x16x32_bf16 v[24:27], v[56:59], v[176:179], v[24:27]
    ds_read_b64_tr_b16 v[88:89], v13 offset:8192
    buffer_load_dwordx4 v[232:235], v133, s[8:11], s44 offen offset:0
    v_mfma_f32_16x16x32_bf16 v[40:43], v[56:59], v[180:183], v[40:43]
    ds_read_b64_tr_b16 v[90:91], v13 offset:10240
    buffer_load_dwordx4 v[236:239], v133, s[8:11], s44 offen offset:256
    v_mfma_f32_16x16x32_bf16 v[44:47], v[60:63], v[180:183], v[44:47]
    ds_read_b64_tr_b16 v[92:93], v14 offset:8192
    s_mov_b32 s44, s45
    v_mfma_f32_16x16x32_bf16 v[28:31], v[60:63], v[176:179], v[28:31]
    ds_read_b64_tr_b16 v[94:95], v14 offset:10240
    s_mov_b32 s45, s46
    v_mfma_f32_16x16x32_bf16 v[32:35], v[64:67], v[176:179], v[32:35]
    ds_read_b64_tr_b16 v[96:97], v15 offset:8192
    s_mov_b32 s46, s47
    v_mfma_f32_16x16x32_bf16 v[48:51], v[64:67], v[180:183], v[48:51]
    ds_read_b64_tr_b16 v[98:99], v15 offset:10240
    s_mov_b32 s47, 8388608
    v_mfma_f32_16x16x32_bf16 v[52:55], v[68:71], v[180:183], v[52:55]
    ds_read_b64_tr_b16 v[100:101], v16 offset:8192
    v_mfma_f32_16x16x32_bf16 v[36:39], v[68:71], v[176:179], v[36:39]
    ds_read_b64_tr_b16 v[102:103], v16 offset:10240
    s_waitcnt lgkmcnt(8)
    v_mfma_f32_16x16x32_bf16 v[24:27], v[72:75], v[184:187], v[24:27]
    ds_read_b64_tr_b16 v[104:105], v13 offset:12288
    buffer_load_dwordx4 v[176:179], v126, s[8:11], s44 offen offset:0
    v_mfma_f32_16x16x32_bf16 v[40:43], v[72:75], v[188:191], v[40:43]
    ds_read_b64_tr_b16 v[106:107], v13 offset:14336
    buffer_load_dwordx4 v[180:183], v126, s[8:11], s44 offen offset:256
    v_mfma_f32_16x16x32_bf16 v[44:47], v[76:79], v[188:191], v[44:47]
    ds_read_b64_tr_b16 v[108:109], v14 offset:12288
    s_waitcnt vmcnt(10)
    v_mfma_f32_16x16x32_bf16 v[28:31], v[76:79], v[184:187], v[28:31]
    ds_read_b64_tr_b16 v[110:111], v14 offset:14336
    v_mfma_f32_16x16x32_bf16 v[32:35], v[80:83], v[184:187], v[32:35]
    ds_read_b64_tr_b16 v[112:113], v15 offset:12288
    v_mfma_f32_16x16x32_bf16 v[48:51], v[80:83], v[188:191], v[48:51]
    ds_read_b64_tr_b16 v[114:115], v15 offset:14336
    v_mfma_f32_16x16x32_bf16 v[52:55], v[84:87], v[188:191], v[52:55]
    ds_read_b64_tr_b16 v[116:117], v16 offset:12288
    ds_read_b64_tr_b16 v[118:119], v16 offset:14336
    v_mfma_f32_16x16x32_bf16 v[36:39], v[84:87], v[184:187], v[36:39]
    s_waitcnt lgkmcnt(8)
    v_mfma_f32_16x16x32_bf16 v[24:27], v[88:91], v[192:195], v[24:27]
    ds_read_b64_tr_b16 v[56:57], v13 offset:16384
    buffer_load_dwordx4 v[184:187], v127, s[8:11], s44 offen offset:0
    v_mfma_f32_16x16x32_bf16 v[40:43], v[88:91], v[196:199], v[40:43]
    ds_read_b64_tr_b16 v[58:59], v13 offset:18432
    buffer_load_dwordx4 v[188:191], v127, s[8:11], s44 offen offset:256
    v_mfma_f32_16x16x32_bf16 v[44:47], v[92:95], v[196:199], v[44:47]
    ds_read_b64_tr_b16 v[60:61], v14 offset:16384
    v_mfma_f32_16x16x32_bf16 v[28:31], v[92:95], v[192:195], v[28:31]
    ds_read_b64_tr_b16 v[62:63], v14 offset:18432
    v_mfma_f32_16x16x32_bf16 v[32:35], v[96:99], v[192:195], v[32:35]
    ds_read_b64_tr_b16 v[64:65], v15 offset:16384
    v_mfma_f32_16x16x32_bf16 v[48:51], v[96:99], v[196:199], v[48:51]
    ds_read_b64_tr_b16 v[66:67], v15 offset:18432
    v_mfma_f32_16x16x32_bf16 v[52:55], v[100:103], v[196:199], v[52:55]
    ds_read_b64_tr_b16 v[68:69], v16 offset:16384
    v_mfma_f32_16x16x32_bf16 v[36:39], v[100:103], v[192:195], v[36:39]
    ds_read_b64_tr_b16 v[70:71], v16 offset:18432
    s_waitcnt lgkmcnt(8)
    v_mfma_f32_16x16x32_bf16 v[24:27], v[104:107], v[200:203], v[24:27]
    ds_read_b64_tr_b16 v[72:73], v13 offset:20480
    buffer_load_dwordx4 v[192:195], v128, s[8:11], s44 offen offset:0
    v_mfma_f32_16x16x32_bf16 v[40:43], v[104:107], v[204:207], v[40:43]
    ds_read_b64_tr_b16 v[74:75], v13 offset:22528
    buffer_load_dwordx4 v[196:199], v128, s[8:11], s44 offen offset:256
    v_mfma_f32_16x16x32_bf16 v[44:47], v[108:111], v[204:207], v[44:47]
    ds_read_b64_tr_b16 v[76:77], v14 offset:20480
    s_waitcnt vmcnt(10)
    v_mfma_f32_16x16x32_bf16 v[28:31], v[108:111], v[200:203], v[28:31]
    ds_read_b64_tr_b16 v[78:79], v14 offset:22528
    v_mfma_f32_16x16x32_bf16 v[32:35], v[112:115], v[200:203], v[32:35]
    ds_read_b64_tr_b16 v[80:81], v15 offset:20480
    v_mfma_f32_16x16x32_bf16 v[48:51], v[112:115], v[204:207], v[48:51]
    ds_read_b64_tr_b16 v[82:83], v15 offset:22528
    v_mfma_f32_16x16x32_bf16 v[52:55], v[116:119], v[204:207], v[52:55]
    ds_read_b64_tr_b16 v[84:85], v16 offset:20480
    ds_read_b64_tr_b16 v[86:87], v16 offset:22528
    v_mfma_f32_16x16x32_bf16 v[36:39], v[116:119], v[200:203], v[36:39]
    s_waitcnt lgkmcnt(8)
    v_mfma_f32_16x16x32_bf16 v[24:27], v[56:59], v[208:211], v[24:27]
    ds_read_b64_tr_b16 v[88:89], v13 offset:24576
    buffer_load_dwordx4 v[200:203], v129, s[8:11], s44 offen offset:0
    v_mfma_f32_16x16x32_bf16 v[40:43], v[56:59], v[212:215], v[40:43]
    ds_read_b64_tr_b16 v[90:91], v13 offset:26624
    buffer_load_dwordx4 v[204:207], v129, s[8:11], s44 offen offset:256
    v_mfma_f32_16x16x32_bf16 v[44:47], v[60:63], v[212:215], v[44:47]
    ds_read_b64_tr_b16 v[92:93], v14 offset:24576
    s_add_u32 s43, s43, 1
    v_mfma_f32_16x16x32_bf16 v[28:31], v[60:63], v[208:211], v[28:31]
    ds_read_b64_tr_b16 v[94:95], v14 offset:26624
    s_cmp_eq_u32 s43, 4
    v_mfma_f32_16x16x32_bf16 v[32:35], v[64:67], v[208:211], v[32:35]
    ds_read_b64_tr_b16 v[96:97], v15 offset:24576
    v_mfma_f32_16x16x32_bf16 v[48:51], v[64:67], v[212:215], v[48:51]
    ds_read_b64_tr_b16 v[98:99], v15 offset:26624
    v_mfma_f32_16x16x32_bf16 v[52:55], v[68:71], v[212:215], v[52:55]
    ds_read_b64_tr_b16 v[100:101], v16 offset:24576
    v_mfma_f32_16x16x32_bf16 v[36:39], v[68:71], v[208:211], v[36:39]
    ds_read_b64_tr_b16 v[102:103], v16 offset:26624
    s_waitcnt lgkmcnt(8)
    v_mfma_f32_16x16x32_bf16 v[24:27], v[72:75], v[216:219], v[24:27]
    ds_read_b64_tr_b16 v[104:105], v13 offset:28672
    buffer_load_dwordx4 v[208:211], v130, s[8:11], s44 offen offset:0
    v_mfma_f32_16x16x32_bf16 v[40:43], v[72:75], v[220:223], v[40:43]
    ds_read_b64_tr_b16 v[106:107], v13 offset:30720
    buffer_load_dwordx4 v[212:215], v130, s[8:11], s44 offen offset:256
    v_mfma_f32_16x16x32_bf16 v[44:47], v[76:79], v[220:223], v[44:47]
    ds_read_b64_tr_b16 v[108:109], v14 offset:28672
    s_waitcnt vmcnt(10)
    v_mfma_f32_16x16x32_bf16 v[28:31], v[76:79], v[216:219], v[28:31]
    ds_read_b64_tr_b16 v[110:111], v14 offset:30720
    v_add_u32 v13, 32768, v13
    v_mfma_f32_16x16x32_bf16 v[32:35], v[80:83], v[216:219], v[32:35]
    ds_read_b64_tr_b16 v[112:113], v15 offset:28672
    v_add_u32 v14, 32768, v14
    v_mfma_f32_16x16x32_bf16 v[48:51], v[80:83], v[220:223], v[48:51]
    ds_read_b64_tr_b16 v[114:115], v15 offset:30720
    v_add_u32 v15, 32768, v15
    v_mfma_f32_16x16x32_bf16 v[52:55], v[84:87], v[220:223], v[52:55]
    ds_read_b64_tr_b16 v[116:117], v16 offset:28672
    ds_read_b64_tr_b16 v[118:119], v16 offset:30720
    v_mfma_f32_16x16x32_bf16 v[36:39], v[84:87], v[216:219], v[36:39]
    v_add_u32 v16, 32768, v16
    s_waitcnt lgkmcnt(8)
    s_cbranch_scc1 dm_24x
    v_mfma_f32_16x16x32_bf16 v[24:27], v[88:91], v[224:227], v[24:27]
    ds_read_b64_tr_b16 v[56:57], v13 offset:0
    buffer_load_dwordx4 v[216:219], v131, s[8:11], s44 offen offset:0
    v_mfma_f32_16x16x32_bf16 v[40:43], v[88:91], v[228:231], v[40:43]
    ds_read_b64_tr_b16 v[58:59], v13 offset:2048
    buffer_load_dwordx4 v[220:223], v131, s[8:11], s44 offen offset:256
    v_mfma_f32_16x16x32_bf16 v[44:47], v[92:95], v[228:231], v[44:47]
    ds_read_b64_tr_b16 v[60:61], v14 offset:0
    v_mfma_f32_16x16x32_bf16 v[28:31], v[92:95], v[224:227], v[28:31]
    ds_read_b64_tr_b16 v[62:63], v14 offset:2048
    v_mfma_f32_16x16x32_bf16 v[32:35], v[96:99], v[224:227], v[32:35]
    ds_read_b64_tr_b16 v[64:65], v15 offset:0
    v_mfma_f32_16x16x32_bf16 v[48:51], v[96:99], v[228:231], v[48:51]
    ds_read_b64_tr_b16 v[66:67], v15 offset:2048
    v_mfma_f32_16x16x32_bf16 v[52:55], v[100:103], v[228:231], v[52:55]
    ds_read_b64_tr_b16 v[68:69], v16 offset:0
    v_mfma_f32_16x16x32_bf16 v[36:39], v[100:103], v[224:227], v[36:39]
    ds_read_b64_tr_b16 v[70:71], v16 offset:2048
    s_waitcnt lgkmcnt(8)
    v_mfma_f32_16x16x32_bf16 v[24:27], v[104:107], v[232:235], v[24:27]
    ds_read_b64_tr_b16 v[72:73], v13 offset:4096
    buffer_load_dwordx4 v[224:227], v132, s[8:11], s44 offen offset:0
    v_mfma_f32_16x16x32_bf16 v[40:43], v[104:107], v[236:239], v[40:43]
    ds_read_b64_tr_b16 v[74:75], v13 offset:6144
    buffer_load_dwordx4 v[228:231], v132, s[8:11], s44 offen offset:256
    v_mfma_f32_16x16x32_bf16 v[44:47], v[108:111], v[236:239], v[44:47]
    ds_read_b64_tr_b16 v[76:77], v14 offset:4096
    s_waitcnt vmcnt(10)
    v_mfma_f32_16x16x32_bf16 v[28:31], v[108:111], v[232:235], v[28:31]
    ds_read_b64_tr_b16 v[78:79], v14 offset:6144
    v_mfma_f32_16x16x32_bf16 v[32:35], v[112:115], v[232:235], v[32:35]
    ds_read_b64_tr_b16 v[80:81], v15 offset:4096
    v_mfma_f32_16x16x32_bf16 v[48:51], v[112:115], v[236:239], v[48:51]
    ds_read_b64_tr_b16 v[82:83], v15 offset:6144
    v_mfma_f32_16x16x32_bf16 v[52:55], v[116:119], v[236:239], v[52:55]
    ds_read_b64_tr_b16 v[84:85], v16 offset:4096
    ds_read_b64_tr_b16 v[86:87], v16 offset:6144
    v_mfma_f32_16x16x32_bf16 v[36:39], v[116:119], v[232:235], v[36:39]
    s_waitcnt lgkmcnt(8)
    s_branch dm_24
dm_24x:
    v_mfma_f32_16x16x32_bf16 v[24:27], v[88:91], v[224:227], v[24:27]
    v_mfma_f32_16x16x32_bf16 v[40:43], v[88:91], v[228:231], v[40:43]
    v_mfma_f32_16x16x32_bf16 v[44:47], v[92:95], v[228:231], v[44:47]
    v_mfma_f32_16x16x32_bf16 v[28:31], v[92:95], v[224:227], v[28:31]
    v_mfma_f32_16x16x32_bf16 v[32:35], v[96:99], v[224:227], v[32:35]
    v_mfma_f32_16x16x32_bf16 v[48:51], v[96:99], v[228:231], v[48:51]
    v_mfma_f32_16x16x32_bf16 v[52:55], v[100:103], v[228:231], v[52:55]
    v_mfma_f32_16x16x32_bf16 v[36:39], v[100:103], v[224:227], v[36:39]
    s_waitcnt lgkmcnt(0)
    v_mfma_f32_16x16x32_bf16 v[24:27], v[104:107], v[232:235], v[24:27]
    s_add_u32 s16, s62, 0x480000
    s_addc_u32 s17, s63, 0
    v_mfma_f32_16x16x32_bf16 v[40:43], v[104:107], v[236:239], v[40:43]
    s_mov_b32 s18, 0x7e000
    v_mfma_f32_16x16x32_bf16 v[44:47], v[108:111], v[236:239], v[44:47]
    s_mov_b32 s19, 0x20000
    v_mfma_f32_16x16x32_bf16 v[28:31], v[108:111], v[232:235], v[28:31]
    s_add_u32 s44, s62, 0x1c8000
    v_mfma_f32_16x16x32_bf16 v[32:35], v[112:115], v[232:235], v[32:35]
    s_addc_u32 s45, s63, 0
    v_mfma_f32_16x16x32_bf16 v[48:51], v[112:115], v[236:239], v[48:51]
    s_mov_b32 s46, 0x6000
    v_mfma_f32_16x16x32_bf16 v[52:55], v[116:119], v[236:239], v[52:55]
    s_mov_b32 s47, 0x20000
    v_mfma_f32_16x16x32_bf16 v[36:39], v[116:119], v[232:235], v[36:39]
    s_add_u32 s36, s39, 0
    v_cvt_pk_bf16_f32 v160, v24, v25
    v_cvt_pk_bf16_f32 v161, v26, v27
    v_cvt_pk_bf16_f32 v162, v28, v29
    v_cvt_pk_bf16_f32 v163, v30, v31
    buffer_store_dwordx4 v[160:163], v2, s[16:19], s36 offen offset:0 sc1
    v_cvt_pk_bf16_f32 v164, v32, v33
    v_cvt_pk_bf16_f32 v165, v34, v35
    v_cvt_pk_bf16_f32 v166, v36, v37
    v_cvt_pk_bf16_f32 v167, v38, v39
    buffer_store_dwordx4 v[164:167], v2, s[16:19], s36 offen offset:1024 sc1
    s_add_u32 s36, s39, 65536
    v_cvt_pk_bf16_f32 v168, v40, v41
    v_cvt_pk_bf16_f32 v169, v42, v43
    v_cvt_pk_bf16_f32 v170, v44, v45
    v_cvt_pk_bf16_f32 v171, v46, v47
    buffer_store_dwordx4 v[168:171], v2, s[16:19], s36 offen offset:0 sc1
    v_cvt_pk_bf16_f32 v172, v48, v49
    v_cvt_pk_bf16_f32 v173, v50, v51
    v_cvt_pk_bf16_f32 v174, v52, v53
    v_cvt_pk_bf16_f32 v175, v54, v55
    buffer_store_dwordx4 v[172:175], v2, s[16:19], s36 offen offset:1024 sc1
    s_barrier
    s_lshl_b32 s36, s37, 11
    v_add_u32 v7, s36, v2
    ds_write_b128 v7, v[160:163] offset:0
    ds_write_b128 v7, v[164:167] offset:1024
    ds_write_b128 v7, v[168:171] offset:2048
    ds_write_b128 v7, v[172:175] offset:3072
    v_lshlrev_b32 v24, 16, v160
    v_and_b32 v25, 0xffff0000, v160
    v_lshlrev_b32 v26, 16, v161
    v_and_b32 v27, 0xffff0000, v161
    v_lshlrev_b32 v28, 16, v162
    v_and_b32 v29, 0xffff0000, v162
    v_lshlrev_b32 v30, 16, v163
    v_and_b32 v31, 0xffff0000, v163
    v_lshlrev_b32 v32, 16, v164
    v_and_b32 v33, 0xffff0000, v164
    v_lshlrev_b32 v34, 16, v165
    v_and_b32 v35, 0xffff0000, v165
    v_lshlrev_b32 v36, 16, v166
    v_and_b32 v37, 0xffff0000, v166
    v_lshlrev_b32 v38, 16, v167
    v_and_b32 v39, 0xffff0000, v167
    v_lshlrev_b32 v40, 16, v168
    v_and_b32 v41, 0xffff0000, v168
    v_lshlrev_b32 v42, 16, v169
    v_and_b32 v43, 0xffff0000, v169
    v_lshlrev_b32 v44, 16, v170
    v_and_b32 v45, 0xffff0000, v170
    v_lshlrev_b32 v46, 16, v171
    v_and_b32 v47, 0xffff0000, v171
    v_lshlrev_b32 v48, 16, v172
    v_and_b32 v49, 0xffff0000, v172
    v_lshlrev_b32 v50, 16, v173
    v_and_b32 v51, 0xffff0000, v173
    v_lshlrev_b32 v52, 16, v174
    v_and_b32 v53, 0xffff0000, v174
    v_lshlrev_b32 v54, 16, v175
    v_and_b32 v55, 0xffff0000, v175
    s_add_u32 s53, s55, 512
    v_mov_b32 v8, 1
    v_mov_b32 v9, 162816
    v_mov_b32 v11, 0
    s_mov_b64 exec, 1
    s_waitcnt vmcnt(0)
    ds_add_rtn_u32 v10, v9, v8
    s_waitcnt lgkmcnt(0)
    v_readfirstlane_b32 s54, v10
    s_nop 0
    s_and_b32 s54, s54, 3
    s_cmp_lg_u32 s54, 3
    s_cbranch_scc1 pub_25
    buffer_atomic_add v8, v11, s[56:59], s53 offen sc1
    v_mov_b32 v9, 162872
    ds_add_u32 v9, v8
pub_25:
    s_mov_b64 exec, -1
    v_pk_add_f32 v[140:141], v[24:25], v[26:27]
    v_pk_mul_f32 v[134:135], v[24:25], v[24:25]
    v_pk_fma_f32 v[134:135], v[26:27], v[26:27], v[134:135]
    v_pk_add_f32 v[140:141], v[140:141], v[28:29]
    v_pk_fma_f32 v[134:135], v[28:29], v[28:29], v[134:135]
    v_pk_add_f32 v[140:141], v[140:141], v[30:31]
    v_pk_fma_f32 v[134:135], v[30:31], v[30:31], v[134:135]
    v_pk_add_f32 v[140:141], v[140:141], v[32:33]
    v_pk_fma_f32 v[134:135], v[32:33], v[32:33], v[134:135]
    v_pk_add_f32 v[140:141], v[140:141], v[34:35]
    v_pk_fma_f32 v[134:135], v[34:35], v[34:35], v[134:135]
    v_pk_add_f32 v[140:141], v[140:141], v[36:37]
    v_pk_fma_f32 v[134:135], v[36:37], v[36:37], v[134:135]
    v_pk_add_f32 v[140:141], v[140:141], v[38:39]
    v_pk_fma_f32 v[134:135], v[38:39], v[38:39], v[134:135]
    v_add_f32 v136, v140, v141
    v_add_f32 v137, v134, v135
    v_mov_b32 v140, v136
    v_mov_b32 v141, v137
    s_nop 0
    v_permlane16_swap_b32 v136, v140
    v_permlane16_swap_b32 v137, v141
    v_pk_add_f32 v[136:137], v[136:137], v[140:141]
    v_mov_b32 v140, v136
    v_mov_b32 v141, v137
    s_nop 0
    v_permlane32_swap_b32 v136, v140
    v_permlane32_swap_b32 v137, v141
    v_pk_add_f32 v[136:137], v[136:137], v[140:141]
    v_pk_add_f32 v[140:141], v[40:41], v[42:43]
    v_pk_mul_f32 v[134:135], v[40:41], v[40:41]
    v_pk_fma_f32 v[134:135], v[42:43], v[42:43], v[134:135]
    v_pk_add_f32 v[140:141], v[140:141], v[44:45]
    v_pk_fma_f32 v[134:135], v[44:45], v[44:45], v[134:135]
    v_pk_add_f32 v[140:141], v[140:141], v[46:47]
    v_pk_fma_f32 v[134:135], v[46:47], v[46:47], v[134:135]
    v_pk_add_f32 v[140:141], v[140:141], v[48:49]
    v_pk_fma_f32 v[134:135], v[48:49], v[48:49], v[134:135]
    v_pk_add_f32 v[140:141], v[140:141], v[50:51]
    v_pk_fma_f32 v[134:135], v[50:51], v[50:51], v[134:135]
    v_pk_add_f32 v[140:141], v[140:141], v[52:53]
    v_pk_fma_f32 v[134:135], v[52:53], v[52:53], v[134:135]
    v_pk_add_f32 v[140:141], v[140:141], v[54:55]
    v_pk_fma_f32 v[134:135], v[54:55], v[54:55], v[134:135]
    v_add_f32 v138, v140, v141
    v_add_f32 v139, v134, v135
    v_mov_b32 v140, v138
    v_mov_b32 v141, v139
    s_nop 0
    v_permlane16_swap_b32 v138, v140
    v_permlane16_swap_b32 v139, v141
    v_pk_add_f32 v[138:139], v[138:139], v[140:141]
    v_mov_b32 v140, v138
    v_mov_b32 v141, v139
    s_nop 0
    v_permlane32_swap_b32 v138, v140
    v_permlane32_swap_b32 v139, v141
    v_pk_add_f32 v[138:139], v[138:139], v[140:141]
    v_cmp_eq_u32 vcc, 0, v23
    s_nop 1
    v_cndmask_b32 v136, v138, v136, vcc
    v_cndmask_b32 v137, v139, v137, vcc
    s_lshr_b32 s53, s29, 3
    s_lshl_b32 s53, s53, 14
    s_and_b32 s40, s29, 7
    s_lshl_b32 s40, s40, 10
    s_add_u32 s40, s40, s53
    s_lshl_b32 s36, s34, 8
    s_add_u32 s40, s40, s36
    v_lshlrev_b32 v7, 3, v1
    s_bfm_b64 exec, 32, 0
    buffer_store_dwordx2 v[136:137], v7, s[44:47], s40 offen sc1
    s_mov_b64 exec, -1
    s_lshr_b32 s34, s30, 1
    s_and_b32 s35, s30, 1
    v_and_b32 v22, 15, v1
    v_lshrrev_b32 v23, 4, v1
    s_mul_i32 s37, s34, 4
    s_mul_i32 s38, s29, 14
    s_mul_i32 s36, s35, 7
    s_add_u32 s38, s38, s36
    s_mul_i32 s36, s34, 8192
    v_add_u32 v12, s36, v2
    v_lshrrev_b32 v6, 2, v1
    v_mul_u32_u24 v13, 448, v6
    v_and_b32 v7, 3, v1
    v_lshl_add_u32 v13, v7, 3, v13
    v_add_u32 v13, 73728, v13
    s_mul_i32 s36, s35, 224
    v_add_u32 v13, s36, v13
    v_bfe_u32 v6, v1, 4, 1
    v_lshlrev_b32 v6, 5, v6
    s_cmp_eq_u32 s35, 0
    s_cselect_b32 s36, 1, -1
    v_mul_lo_u32 v6, v6, s36
    v_sub_u32 v14, v13, v6
    v_add_u32 v13, v13, v6
    s_add_u32 s53, s55, 1408
    v_mov_b32 v8, 1
    v_mov_b32 v9, 162864
    v_mov_b32 v11, 0
    s_mov_b64 exec, 1
    s_waitcnt vmcnt(0)
    ds_add_rtn_u32 v10, v9, v8
    s_waitcnt lgkmcnt(0)
    v_readfirstlane_b32 s54, v10
    s_nop 0
    s_and_b32 s54, s54, 3
    s_cmp_lg_u32 s54, 3
    s_cbranch_scc1 pub_26
    buffer_atomic_add v8, v11, s[56:59], s53 offen sc1
pub_26:
    s_mov_b64 exec, -1
    v_pk_mov_b32 v[24:25], 0, 0
    v_pk_mov_b32 v[26:27], 0, 0
    v_pk_mov_b32 v[28:29], 0, 0
    v_pk_mov_b32 v[30:31], 0, 0
    v_pk_mov_b32 v[32:33], 0, 0
    v_pk_mov_b32 v[34:35], 0, 0
    v_pk_mov_b32 v[36:37], 0, 0
    v_pk_mov_b32 v[38:39], 0, 0
    v_pk_mov_b32 v[40:41], 0, 0
    v_pk_mov_b32 v[42:43], 0, 0
    v_pk_mov_b32 v[44:45], 0, 0
    v_pk_mov_b32 v[46:47], 0, 0
    v_pk_mov_b32 v[48:49], 0, 0
    v_pk_mov_b32 v[50:51], 0, 0
    v_pk_mov_b32 v[52:53], 0, 0
    v_pk_mov_b32 v[54:55], 0, 0
    v_pk_mov_b32 v[56:57], 0, 0
    v_pk_mov_b32 v[58:59], 0, 0
    v_pk_mov_b32 v[60:61], 0, 0
    v_pk_mov_b32 v[62:63], 0, 0
    v_pk_mov_b32 v[64:65], 0, 0
    v_pk_mov_b32 v[66:67], 0, 0
    v_pk_mov_b32 v[68:69], 0, 0
    v_pk_mov_b32 v[70:71], 0, 0
    v_pk_mov_b32 v[72:73], 0, 0
    v_pk_mov_b32 v[74:75], 0, 0
    v_pk_mov_b32 v[76:77], 0, 0
    v_pk_mov_b32 v[78:79], 0, 0
    v_pk_mov_b32 v[80:81], 0, 0
    v_pk_mov_b32 v[82:83], 0, 0
    v_pk_mov_b32 v[84:85], 0, 0
    v_pk_mov_b32 v[86:87], 0, 0
    v_pk_mov_b32 v[88:89], 0, 0
    v_pk_mov_b32 v[90:91], 0, 0
    v_pk_mov_b32 v[92:93], 0, 0
    v_pk_mov_b32 v[94:95], 0, 0
    v_pk_mov_b32 v[96:97], 0, 0
    v_pk_mov_b32 v[98:99], 0, 0
    v_pk_mov_b32 v[100:101], 0, 0
    v_pk_mov_b32 v[102:103], 0, 0
    v_pk_mov_b32 v[104:105], 0, 0
    v_pk_mov_b32 v[106:107], 0, 0
    v_pk_mov_b32 v[108:109], 0, 0
    v_pk_mov_b32 v[110:111], 0, 0
    v_pk_mov_b32 v[112:113], 0, 0
    v_pk_mov_b32 v[114:115], 0, 0
    v_pk_mov_b32 v[116:117], 0, 0
    v_pk_mov_b32 v[118:119], 0, 0
    v_pk_mov_b32 v[120:121], 0, 0
    v_pk_mov_b32 v[122:123], 0, 0
    v_pk_mov_b32 v[124:125], 0, 0
    v_pk_mov_b32 v[126:127], 0, 0
    v_pk_mov_b32 v[128:129], 0, 0
    v_pk_mov_b32 v[130:131], 0, 0
    v_pk_mov_b32 v[132:133], 0, 0
    v_pk_mov_b32 v[134:135], 0, 0
    s_mov_b32 s42, 0
    s_mov_b32 s43, 0
    s_mov_b32 s48, 57344
    v_mov_b32 v17, v12
    v_add_u32 v18, 57344, v13
    v_add_u32 v19, 57344, v14
    s_waitcnt lgkmcnt(0)
    s_barrier
    ds_read_b128 v[136:139], v17 offset:0
    ds_read_b128 v[140:143], v17 offset:2048
    ds_read_b128 v[144:147], v17 offset:4096
    ds_read_b128 v[148:151], v17 offset:6144
    ds_read_b64_tr_b16 v[152:153], v18 offset:0
    ds_read_b64_tr_b16 v[154:155], v18 offset:7168
    ds_read_b64_tr_b16 v[156:157], v19 offset:32
    ds_read_b64_tr_b16 v[158:159], v19 offset:7200
    ds_read_b64_tr_b16 v[160:161], v18 offset:64
    ds_read_b64_tr_b16 v[162:163], v18 offset:7232
    ds_read_b64_tr_b16 v[164:165], v19 offset:96
    ds_read_b64_tr_b16 v[166:167], v19 offset:7264
    ds_read_b64_tr_b16 v[168:169], v18 offset:128
    ds_read_b64_tr_b16 v[170:171], v18 offset:7296
    ds_read_b64_tr_b16 v[172:173], v19 offset:160
    ds_read_b64_tr_b16 v[174:175], v19 offset:7328
    ds_read_b64_tr_b16 v[176:177], v18 offset:192
    ds_read_b64_tr_b16 v[178:179], v18 offset:7360
    s_waitcnt lgkmcnt(0)
    v_mfma_f32_16x16x32_bf16 v[24:27], v[152:155], v[136:139], v[24:27]
    ds_read_b128 v[180:183], v17 offset:1024
    v_mfma_f32_16x16x32_bf16 v[52:55], v[152:155], v[140:143], v[52:55]
    ds_read_b128 v[184:187], v17 offset:3072
    v_mfma_f32_16x16x32_bf16 v[80:83], v[152:155], v[144:147], v[80:83]
    ds_read_b128 v[188:191], v17 offset:5120
    v_mfma_f32_16x16x32_bf16 v[108:111], v[152:155], v[148:151], v[108:111]
    ds_read_b128 v[192:195], v17 offset:7168
    v_mfma_f32_16x16x32_bf16 v[112:115], v[156:159], v[148:151], v[112:115]
    ds_read_b64_tr_b16 v[196:197], v18 offset:14336
    v_mfma_f32_16x16x32_bf16 v[84:87], v[156:159], v[144:147], v[84:87]
    ds_read_b64_tr_b16 v[198:199], v18 offset:21504
    v_mfma_f32_16x16x32_bf16 v[56:59], v[156:159], v[140:143], v[56:59]
    v_mfma_f32_16x16x32_bf16 v[28:31], v[156:159], v[136:139], v[28:31]
    ds_read_b64_tr_b16 v[200:201], v19 offset:14368
    v_mfma_f32_16x16x32_bf16 v[32:35], v[160:163], v[136:139], v[32:35]
    ds_read_b64_tr_b16 v[202:203], v19 offset:21536
    v_mfma_f32_16x16x32_bf16 v[60:63], v[160:163], v[140:143], v[60:63]
    ds_read_b64_tr_b16 v[204:205], v18 offset:14400
    v_mfma_f32_16x16x32_bf16 v[88:91], v[160:163], v[144:147], v[88:91]
    ds_read_b64_tr_b16 v[206:207], v18 offset:21568
    v_mfma_f32_16x16x32_bf16 v[116:119], v[160:163], v[148:151], v[116:119]
    ds_read_b64_tr_b16 v[208:209], v19 offset:14432
    v_mfma_f32_16x16x32_bf16 v[120:123], v[164:167], v[148:151], v[120:123]
    ds_read_b64_tr_b16 v[210:211], v19 offset:21600
    v_mfma_f32_16x16x32_bf16 v[92:95], v[164:167], v[144:147], v[92:95]
    v_mfma_f32_16x16x32_bf16 v[64:67], v[164:167], v[140:143], v[64:67]
    ds_read_b64_tr_b16 v[212:213], v18 offset:14464
    v_mfma_f32_16x16x32_bf16 v[36:39], v[164:167], v[136:139], v[36:39]
    ds_read_b64_tr_b16 v[214:215], v18 offset:21632
    v_mfma_f32_16x16x32_bf16 v[40:43], v[168:171], v[136:139], v[40:43]
    ds_read_b64_tr_b16 v[216:217], v19 offset:14496
    v_mfma_f32_16x16x32_bf16 v[68:71], v[168:171], v[140:143], v[68:71]
    ds_read_b64_tr_b16 v[218:219], v19 offset:21664
    v_mfma_f32_16x16x32_bf16 v[96:99], v[168:171], v[144:147], v[96:99]
    ds_read_b64_tr_b16 v[220:221], v18 offset:14528
    v_mfma_f32_16x16x32_bf16 v[124:127], v[168:171], v[148:151], v[124:127]
    ds_read_b64_tr_b16 v[222:223], v18 offset:21696
    v_mfma_f32_16x16x32_bf16 v[128:131], v[172:175], v[148:151], v[128:131]
    s_add_u32 s42, s42, 16384
    s_cmp_eq_u32 s42, 49152
    v_mfma_f32_16x16x32_bf16 v[100:103], v[172:175], v[144:147], v[100:103]
    s_cselect_b32 s42, 0, s42
    s_add_u32 s48, s48, 28672
    v_mfma_f32_16x16x32_bf16 v[72:75], v[172:175], v[140:143], v[72:75]
    s_cmp_eq_u32 s48, 86016
    s_cselect_b32 s48, 0, s48
    v_mfma_f32_16x16x32_bf16 v[44:47], v[172:175], v[136:139], v[44:47]
    v_add_u32 v17, s42, v12
    v_add_u32 v18, s48, v13
    v_mfma_f32_16x16x32_bf16 v[48:51], v[176:179], v[136:139], v[48:51]
    v_add_u32 v19, s48, v14
    v_mfma_f32_16x16x32_bf16 v[76:79], v[176:179], v[140:143], v[76:79]
    v_mfma_f32_16x16x32_bf16 v[104:107], v[176:179], v[144:147], v[104:107]
    v_mfma_f32_16x16x32_bf16 v[132:135], v[176:179], v[148:151], v[132:135]
    s_waitcnt lgkmcnt(0)
    v_mfma_f32_16x16x32_bf16 v[24:27], v[196:199], v[180:183], v[24:27]
    v_mfma_f32_16x16x32_bf16 v[52:55], v[196:199], v[184:187], v[52:55]
    v_mfma_f32_16x16x32_bf16 v[80:83], v[196:199], v[188:191], v[80:83]
    v_mfma_f32_16x16x32_bf16 v[108:111], v[196:199], v[192:195], v[108:111]
    v_mfma_f32_16x16x32_bf16 v[112:115], v[200:203], v[192:195], v[112:115]
    v_mfma_f32_16x16x32_bf16 v[84:87], v[200:203], v[188:191], v[84:87]
    v_mfma_f32_16x16x32_bf16 v[56:59], v[200:203], v[184:187], v[56:59]
    v_mfma_f32_16x16x32_bf16 v[28:31], v[200:203], v[180:183], v[28:31]
    v_mfma_f32_16x16x32_bf16 v[32:35], v[204:207], v[180:183], v[32:35]
    v_mfma_f32_16x16x32_bf16 v[60:63], v[204:207], v[184:187], v[60:63]
    v_mfma_f32_16x16x32_bf16 v[88:91], v[204:207], v[188:191], v[88:91]
    v_mfma_f32_16x16x32_bf16 v[116:119], v[204:207], v[192:195], v[116:119]
    v_mfma_f32_16x16x32_bf16 v[120:123], v[208:211], v[192:195], v[120:123]
    v_mfma_f32_16x16x32_bf16 v[92:95], v[208:211], v[188:191], v[92:95]
    v_mfma_f32_16x16x32_bf16 v[64:67], v[208:211], v[184:187], v[64:67]
    v_mfma_f32_16x16x32_bf16 v[36:39], v[208:211], v[180:183], v[36:39]
    v_mfma_f32_16x16x32_bf16 v[40:43], v[212:215], v[180:183], v[40:43]
    v_mfma_f32_16x16x32_bf16 v[68:71], v[212:215], v[184:187], v[68:71]
    v_mfma_f32_16x16x32_bf16 v[96:99], v[212:215], v[188:191], v[96:99]
    v_mfma_f32_16x16x32_bf16 v[124:127], v[212:215], v[192:195], v[124:127]
    v_mfma_f32_16x16x32_bf16 v[128:131], v[216:219], v[192:195], v[128:131]
    s_add_u32 s43, s43, 1
    v_mfma_f32_16x16x32_bf16 v[100:103], v[216:219], v[188:191], v[100:103]
    v_mfma_f32_16x16x32_bf16 v[72:75], v[216:219], v[184:187], v[72:75]
    v_mfma_f32_16x16x32_bf16 v[44:47], v[216:219], v[180:183], v[44:47]
    v_mfma_f32_16x16x32_bf16 v[48:51], v[220:223], v[180:183], v[48:51]
    v_mfma_f32_16x16x32_bf16 v[76:79], v[220:223], v[184:187], v[76:79]
    v_mfma_f32_16x16x32_bf16 v[104:107], v[220:223], v[188:191], v[104:107]
    v_mfma_f32_16x16x32_bf16 v[132:135], v[220:223], v[192:195], v[132:135]
    s_barrier
    ds_read_b128 v[136:139], v17 offset:0
    ds_read_b128 v[140:143], v17 offset:2048
    ds_read_b128 v[144:147], v17 offset:4096
    ds_read_b128 v[148:151], v17 offset:6144
    ds_read_b64_tr_b16 v[152:153], v18 offset:0
    ds_read_b64_tr_b16 v[154:155], v18 offset:7168
    ds_read_b64_tr_b16 v[156:157], v19 offset:32
    ds_read_b64_tr_b16 v[158:159], v19 offset:7200
    ds_read_b64_tr_b16 v[160:161], v18 offset:64
    ds_read_b64_tr_b16 v[162:163], v18 offset:7232
    ds_read_b64_tr_b16 v[164:165], v19 offset:96
    ds_read_b64_tr_b16 v[166:167], v19 offset:7264
    ds_read_b64_tr_b16 v[168:169], v18 offset:128
    ds_read_b64_tr_b16 v[170:171], v18 offset:7296
    ds_read_b64_tr_b16 v[172:173], v19 offset:160
    ds_read_b64_tr_b16 v[174:175], v19 offset:7328
    ds_read_b64_tr_b16 v[176:177], v18 offset:192
    ds_read_b64_tr_b16 v[178:179], v18 offset:7360
mm_27:
    s_waitcnt lgkmcnt(0)
    v_mfma_f32_16x16x32_bf16 v[24:27], v[152:155], v[136:139], v[24:27]
    ds_read_b128 v[180:183], v17 offset:1024
    v_mfma_f32_16x16x32_bf16 v[52:55], v[152:155], v[140:143], v[52:55]
    ds_read_b128 v[184:187], v17 offset:3072
    v_mfma_f32_16x16x32_bf16 v[80:83], v[152:155], v[144:147], v[80:83]
    ds_read_b128 v[188:191], v17 offset:5120
    v_mfma_f32_16x16x32_bf16 v[108:111], v[152:155], v[148:151], v[108:111]
    ds_read_b128 v[192:195], v17 offset:7168
    v_mfma_f32_16x16x32_bf16 v[112:115], v[156:159], v[148:151], v[112:115]
    ds_read_b64_tr_b16 v[196:197], v18 offset:14336
    v_mfma_f32_16x16x32_bf16 v[84:87], v[156:159], v[144:147], v[84:87]
    ds_read_b64_tr_b16 v[198:199], v18 offset:21504
    v_mfma_f32_16x16x32_bf16 v[56:59], v[156:159], v[140:143], v[56:59]
    v_mfma_f32_16x16x32_bf16 v[28:31], v[156:159], v[136:139], v[28:31]
    ds_read_b64_tr_b16 v[200:201], v19 offset:14368
    v_mfma_f32_16x16x32_bf16 v[32:35], v[160:163], v[136:139], v[32:35]
    ds_read_b64_tr_b16 v[202:203], v19 offset:21536
    v_mfma_f32_16x16x32_bf16 v[60:63], v[160:163], v[140:143], v[60:63]
    ds_read_b64_tr_b16 v[204:205], v18 offset:14400
    v_mfma_f32_16x16x32_bf16 v[88:91], v[160:163], v[144:147], v[88:91]
    ds_read_b64_tr_b16 v[206:207], v18 offset:21568
    v_mfma_f32_16x16x32_bf16 v[116:119], v[160:163], v[148:151], v[116:119]
    ds_read_b64_tr_b16 v[208:209], v19 offset:14432
    v_mfma_f32_16x16x32_bf16 v[120:123], v[164:167], v[148:151], v[120:123]
    ds_read_b64_tr_b16 v[210:211], v19 offset:21600
    v_mfma_f32_16x16x32_bf16 v[92:95], v[164:167], v[144:147], v[92:95]
    v_mfma_f32_16x16x32_bf16 v[64:67], v[164:167], v[140:143], v[64:67]
    ds_read_b64_tr_b16 v[212:213], v18 offset:14464
    v_mfma_f32_16x16x32_bf16 v[36:39], v[164:167], v[136:139], v[36:39]
    ds_read_b64_tr_b16 v[214:215], v18 offset:21632
    v_mfma_f32_16x16x32_bf16 v[40:43], v[168:171], v[136:139], v[40:43]
    ds_read_b64_tr_b16 v[216:217], v19 offset:14496
    v_mfma_f32_16x16x32_bf16 v[68:71], v[168:171], v[140:143], v[68:71]
    ds_read_b64_tr_b16 v[218:219], v19 offset:21664
    v_mfma_f32_16x16x32_bf16 v[96:99], v[168:171], v[144:147], v[96:99]
    ds_read_b64_tr_b16 v[220:221], v18 offset:14528
    v_mfma_f32_16x16x32_bf16 v[124:127], v[168:171], v[148:151], v[124:127]
    ds_read_b64_tr_b16 v[222:223], v18 offset:21696
    v_mfma_f32_16x16x32_bf16 v[128:131], v[172:175], v[148:151], v[128:131]
    s_add_u32 s42, s42, 16384
    s_cmp_eq_u32 s42, 49152
    v_mfma_f32_16x16x32_bf16 v[100:103], v[172:175], v[144:147], v[100:103]
    s_cselect_b32 s42, 0, s42
    s_add_u32 s48, s48, 28672
    v_mfma_f32_16x16x32_bf16 v[72:75], v[172:175], v[140:143], v[72:75]
    s_cmp_eq_u32 s48, 86016
    s_cselect_b32 s48, 0, s48
    v_mfma_f32_16x16x32_bf16 v[44:47], v[172:175], v[136:139], v[44:47]
    v_add_u32 v17, s42, v12
    v_add_u32 v18, s48, v13
    v_mfma_f32_16x16x32_bf16 v[48:51], v[176:179], v[136:139], v[48:51]
    v_add_u32 v19, s48, v14
    v_mfma_f32_16x16x32_bf16 v[76:79], v[176:179], v[140:143], v[76:79]
    v_mfma_f32_16x16x32_bf16 v[104:107], v[176:179], v[144:147], v[104:107]
    v_mfma_f32_16x16x32_bf16 v[132:135], v[176:179], v[148:151], v[132:135]
    s_waitcnt lgkmcnt(0)
    s_barrier
    v_mfma_f32_16x16x32_bf16 v[24:27], v[196:199], v[180:183], v[24:27]
    ds_read_b128 v[136:139], v17 offset:0
    v_mfma_f32_16x16x32_bf16 v[52:55], v[196:199], v[184:187], v[52:55]
    ds_read_b128 v[140:143], v17 offset:2048
    v_mfma_f32_16x16x32_bf16 v[80:83], v[196:199], v[188:191], v[80:83]
    ds_read_b128 v[144:147], v17 offset:4096
    v_mfma_f32_16x16x32_bf16 v[108:111], v[196:199], v[192:195], v[108:111]
    ds_read_b128 v[148:151], v17 offset:6144
    v_mfma_f32_16x16x32_bf16 v[112:115], v[200:203], v[192:195], v[112:115]
    ds_read_b64_tr_b16 v[152:153], v18 offset:0
    v_mfma_f32_16x16x32_bf16 v[84:87], v[200:203], v[188:191], v[84:87]
    ds_read_b64_tr_b16 v[154:155], v18 offset:7168
    v_mfma_f32_16x16x32_bf16 v[56:59], v[200:203], v[184:187], v[56:59]
    v_mfma_f32_16x16x32_bf16 v[28:31], v[200:203], v[180:183], v[28:31]
    ds_read_b64_tr_b16 v[156:157], v19 offset:32
    v_mfma_f32_16x16x32_bf16 v[32:35], v[204:207], v[180:183], v[32:35]
    ds_read_b64_tr_b16 v[158:159], v19 offset:7200
    v_mfma_f32_16x16x32_bf16 v[60:63], v[204:207], v[184:187], v[60:63]
    ds_read_b64_tr_b16 v[160:161], v18 offset:64
    v_mfma_f32_16x16x32_bf16 v[88:91], v[204:207], v[188:191], v[88:91]
    ds_read_b64_tr_b16 v[162:163], v18 offset:7232
    v_mfma_f32_16x16x32_bf16 v[116:119], v[204:207], v[192:195], v[116:119]
    ds_read_b64_tr_b16 v[164:165], v19 offset:96
    v_mfma_f32_16x16x32_bf16 v[120:123], v[208:211], v[192:195], v[120:123]
    ds_read_b64_tr_b16 v[166:167], v19 offset:7264
    v_mfma_f32_16x16x32_bf16 v[92:95], v[208:211], v[188:191], v[92:95]
    v_mfma_f32_16x16x32_bf16 v[64:67], v[208:211], v[184:187], v[64:67]
    ds_read_b64_tr_b16 v[168:169], v18 offset:128
    v_mfma_f32_16x16x32_bf16 v[36:39], v[208:211], v[180:183], v[36:39]
    ds_read_b64_tr_b16 v[170:171], v18 offset:7296
    v_mfma_f32_16x16x32_bf16 v[40:43], v[212:215], v[180:183], v[40:43]
    ds_read_b64_tr_b16 v[172:173], v19 offset:160
    v_mfma_f32_16x16x32_bf16 v[68:71], v[212:215], v[184:187], v[68:71]
    ds_read_b64_tr_b16 v[174:175], v19 offset:7328
    v_mfma_f32_16x16x32_bf16 v[96:99], v[212:215], v[188:191], v[96:99]
    ds_read_b64_tr_b16 v[176:177], v18 offset:192
    v_mfma_f32_16x16x32_bf16 v[124:127], v[212:215], v[192:195], v[124:127]
    ds_read_b64_tr_b16 v[178:179], v18 offset:7360
    v_mfma_f32_16x16x32_bf16 v[128:131], v[216:219], v[192:195], v[128:131]
    s_add_u32 s43, s43, 1
    v_mfma_f32_16x16x32_bf16 v[100:103], v[216:219], v[188:191], v[100:103]
    s_cmp_lt_u32 s43, 15
    v_mfma_f32_16x16x32_bf16 v[72:75], v[216:219], v[184:187], v[72:75]
    v_mfma_f32_16x16x32_bf16 v[44:47], v[216:219], v[180:183], v[44:47]
    v_mfma_f32_16x16x32_bf16 v[48:51], v[220:223], v[180:183], v[48:51]
    v_mfma_f32_16x16x32_bf16 v[76:79], v[220:223], v[184:187], v[76:79]
    v_mfma_f32_16x16x32_bf16 v[104:107], v[220:223], v[188:191], v[104:107]
    v_mfma_f32_16x16x32_bf16 v[132:135], v[220:223], v[192:195], v[132:135]
    s_cbranch_scc1 mm_27
    s_waitcnt lgkmcnt(0)
    v_mfma_f32_16x16x32_bf16 v[24:27], v[152:155], v[136:139], v[24:27]
    ds_read_b128 v[180:183], v17 offset:1024
    v_mfma_f32_16x16x32_bf16 v[52:55], v[152:155], v[140:143], v[52:55]
    ds_read_b128 v[184:187], v17 offset:3072
    v_mfma_f32_16x16x32_bf16 v[80:83], v[152:155], v[144:147], v[80:83]
    ds_read_b128 v[188:191], v17 offset:5120
    v_mfma_f32_16x16x32_bf16 v[108:111], v[152:155], v[148:151], v[108:111]
    ds_read_b128 v[192:195], v17 offset:7168
    v_mfma_f32_16x16x32_bf16 v[112:115], v[156:159], v[148:151], v[112:115]
    ds_read_b64_tr_b16 v[196:197], v18 offset:14336
    v_mfma_f32_16x16x32_bf16 v[84:87], v[156:159], v[144:147], v[84:87]
    ds_read_b64_tr_b16 v[198:199], v18 offset:21504
    v_mfma_f32_16x16x32_bf16 v[56:59], v[156:159], v[140:143], v[56:59]
    v_mfma_f32_16x16x32_bf16 v[28:31], v[156:159], v[136:139], v[28:31]
    ds_read_b64_tr_b16 v[200:201], v19 offset:14368
    v_mfma_f32_16x16x32_bf16 v[32:35], v[160:163], v[136:139], v[32:35]
    ds_read_b64_tr_b16 v[202:203], v19 offset:21536
    v_mfma_f32_16x16x32_bf16 v[60:63], v[160:163], v[140:143], v[60:63]
    ds_read_b64_tr_b16 v[204:205], v18 offset:14400
    v_mfma_f32_16x16x32_bf16 v[88:91], v[160:163], v[144:147], v[88:91]
    ds_read_b64_tr_b16 v[206:207], v18 offset:21568
    v_mfma_f32_16x16x32_bf16 v[116:119], v[160:163], v[148:151], v[116:119]
    ds_read_b64_tr_b16 v[208:209], v19 offset:14432
    v_mfma_f32_16x16x32_bf16 v[120:123], v[164:167], v[148:151], v[120:123]
    ds_read_b64_tr_b16 v[210:211], v19 offset:21600
    v_mfma_f32_16x16x32_bf16 v[92:95], v[164:167], v[144:147], v[92:95]
    v_mfma_f32_16x16x32_bf16 v[64:67], v[164:167], v[140:143], v[64:67]
    ds_read_b64_tr_b16 v[212:213], v18 offset:14464
    v_mfma_f32_16x16x32_bf16 v[36:39], v[164:167], v[136:139], v[36:39]
    ds_read_b64_tr_b16 v[214:215], v18 offset:21632
    v_mfma_f32_16x16x32_bf16 v[40:43], v[168:171], v[136:139], v[40:43]
    ds_read_b64_tr_b16 v[216:217], v19 offset:14496
    v_mfma_f32_16x16x32_bf16 v[68:71], v[168:171], v[140:143], v[68:71]
    ds_read_b64_tr_b16 v[218:219], v19 offset:21664
    v_mfma_f32_16x16x32_bf16 v[96:99], v[168:171], v[144:147], v[96:99]
    ds_read_b64_tr_b16 v[220:221], v18 offset:14528
    v_mfma_f32_16x16x32_bf16 v[124:127], v[168:171], v[148:151], v[124:127]
    ds_read_b64_tr_b16 v[222:223], v18 offset:21696
    v_mfma_f32_16x16x32_bf16 v[128:131], v[172:175], v[148:151], v[128:131]
    v_mfma_f32_16x16x32_bf16 v[100:103], v[172:175], v[144:147], v[100:103]
    v_mfma_f32_16x16x32_bf16 v[72:75], v[172:175], v[140:143], v[72:75]
    v_mfma_f32_16x16x32_bf16 v[44:47], v[172:175], v[136:139], v[44:47]
    v_mfma_f32_16x16x32_bf16 v[48:51], v[176:179], v[136:139], v[48:51]
    v_mfma_f32_16x16x32_bf16 v[76:79], v[176:179], v[140:143], v[76:79]
    v_mfma_f32_16x16x32_bf16 v[104:107], v[176:179], v[144:147], v[104:107]
    v_mfma_f32_16x16x32_bf16 v[132:135], v[176:179], v[148:151], v[132:135]
    s_waitcnt lgkmcnt(0)
    s_barrier
    v_mfma_f32_16x16x32_bf16 v[24:27], v[196:199], v[180:183], v[24:27]
    s_mul_i32 s36, s35, 448
    s_add_u32 s36, s36, 159744
    v_lshlrev_b32 v6, 4, v23
    v_add_u32 v6, s36, v6
    v_mfma_f32_16x16x32_bf16 v[52:55], v[196:199], v[184:187], v[52:55]
    ds_read_b128 v[136:139], v6 offset:0
    ds_read_b128 v[140:143], v6 offset:64
    ds_read_b128 v[144:147], v6 offset:128
    v_mfma_f32_16x16x32_bf16 v[80:83], v[196:199], v[188:191], v[80:83]
    ds_read_b128 v[148:151], v6 offset:192
    ds_read_b128 v[152:155], v6 offset:256
    ds_read_b128 v[156:159], v6 offset:320
    v_mfma_f32_16x16x32_bf16 v[108:111], v[196:199], v[192:195], v[108:111]
    ds_read_b128 v[160:163], v6 offset:384
    s_lshl_b32 s36, s34, 9
    s_add_u32 s36, s36, 160768
    v_mfma_f32_16x16x32_bf16 v[112:115], v[200:203], v[192:195], v[112:115]
    v_lshlrev_b32 v7, 3, v22
    v_add_u32 v7, s36, v7
    ds_read_b64 v[164:165], v7 offset:0
    v_mfma_f32_16x16x32_bf16 v[84:87], v[200:203], v[188:191], v[84:87]
    ds_read_b64 v[166:167], v7 offset:128
    ds_read_b64 v[168:169], v7 offset:256
    ds_read_b64 v[170:171], v7 offset:384
    v_mfma_f32_16x16x32_bf16 v[56:59], v[200:203], v[184:187], v[56:59]
    s_mov_b32 s16, s62
    s_mov_b32 s17, s63
    s_mov_b32 s18, 0x1be000
    v_mfma_f32_16x16x32_bf16 v[28:31], v[200:203], v[180:183], v[28:31]
    s_mov_b32 s19, 0x20000
    s_mul_i32 s39, s37, 229376
    s_lshr_b32 s36, s38, 1
    v_mfma_f32_16x16x32_bf16 v[32:35], v[204:207], v[180:183], v[32:35]
    s_add_u32 s36, s36, 0
    s_lshr_b32 s53, s36, 3
    s_lshl_b32 s53, s53, 14
    v_mfma_f32_16x16x32_bf16 v[60:63], v[204:207], v[184:187], v[60:63]
    s_and_b32 s44, s36, 7
    s_lshl_b32 s44, s44, 10
    s_add_u32 s44, s44, s53
    v_mfma_f32_16x16x32_bf16 v[88:91], v[204:207], v[188:191], v[88:91]
    s_add_u32 s44, s44, s39
    s_lshr_b32 s36, s38, 1
    s_add_u32 s36, s36, 1
    s_lshr_b32 s53, s36, 3
    v_mfma_f32_16x16x32_bf16 v[116:119], v[204:207], v[192:195], v[116:119]
    s_lshl_b32 s53, s53, 14
    s_and_b32 s45, s36, 7
    s_lshl_b32 s45, s45, 10
    v_mfma_f32_16x16x32_bf16 v[120:123], v[208:211], v[192:195], v[120:123]
    s_add_u32 s45, s45, s53
    s_add_u32 s45, s45, s39
    s_lshr_b32 s36, s38, 1
    v_mfma_f32_16x16x32_bf16 v[92:95], v[208:211], v[188:191], v[92:95]
    s_add_u32 s36, s36, 2
    s_lshr_b32 s53, s36, 3
    s_lshl_b32 s53, s53, 14
    v_mfma_f32_16x16x32_bf16 v[64:67], v[208:211], v[184:187], v[64:67]
    s_and_b32 s46, s36, 7
    s_lshl_b32 s46, s46, 10
    s_add_u32 s46, s46, s53
    v_mfma_f32_16x16x32_bf16 v[36:39], v[208:211], v[180:183], v[36:39]
    s_add_u32 s46, s46, s39
    s_lshr_b32 s36, s38, 1
    s_add_u32 s36, s36, 3
    v_mfma_f32_16x16x32_bf16 v[40:43], v[212:215], v[180:183], v[40:43]
    s_lshr_b32 s53, s36, 3
    s_lshl_b32 s53, s53, 14
    s_and_b32 s47, s36, 7
    v_mfma_f32_16x16x32_bf16 v[68:71], v[212:215], v[184:187], v[68:71]
    s_lshl_b32 s47, s47, 10
    s_add_u32 s47, s47, s53
    s_add_u32 s47, s47, s39
    v_mfma_f32_16x16x32_bf16 v[96:99], v[212:215], v[188:191], v[96:99]
    s_lshl_b32 s36, s37, 1
    s_add_u32 s36, s36, s35
    s_lshl_b32 s36, s36, 10
    v_mfma_f32_16x16x32_bf16 v[124:127], v[212:215], v[192:195], v[124:127]
    v_add_u32 v12, s36, v2
    v_lshrrev_b32 v238, 1, v23
    v_lshlrev_b32 v238, 8, v238
    v_mfma_f32_16x16x32_bf16 v[128:131], v[216:219], v[192:195], v[128:131]
    v_lshl_add_u32 v238, v22, 4, v238
    v_and_b32 v224, 1, v23
    v_lshl_add_u32 v238, v224, 3, v238
    v_mfma_f32_16x16x32_bf16 v[100:103], v[216:219], v[188:191], v[100:103]
    v_mfma_f32_16x16x32_bf16 v[72:75], v[216:219], v[184:187], v[72:75]
    v_mfma_f32_16x16x32_bf16 v[44:47], v[216:219], v[180:183], v[44:47]
    v_mfma_f32_16x16x32_bf16 v[48:51], v[220:223], v[180:183], v[48:51]
    v_mfma_f32_16x16x32_bf16 v[76:79], v[220:223], v[184:187], v[76:79]
    v_mfma_f32_16x16x32_bf16 v[104:107], v[220:223], v[188:191], v[104:107]
    v_mfma_f32_16x16x32_bf16 v[132:135], v[220:223], v[192:195], v[132:135]
    s_waitcnt lgkmcnt(0)
    v_mul_f32 v184, 0xc0135761, v165
    v_mul_f32 v185, v165, v165
    v_mul_f32 v185, v185, v184
    v_mul_f32 v185, 0x3d372713, v185
    v_rcp_f32 v165, v165
    v_mul_f32 v186, 0xc0135761, v167
    v_mul_f32 v187, v167, v167
    v_mul_f32 v187, v187, v186
    v_mul_f32 v187, 0x3d372713, v187
    v_rcp_f32 v167, v167
    v_mul_f32 v188, 0xc0135761, v169
    v_mul_f32 v189, v169, v169
    v_mul_f32 v189, v189, v188
    v_mul_f32 v189, 0x3d372713, v189
    v_rcp_f32 v169, v169
    v_mul_f32 v190, 0xc0135761, v171
    v_mul_f32 v191, v171, v171
    v_mul_f32 v191, v191, v190
    v_mul_f32 v191, 0x3d372713, v191
    v_rcp_f32 v171, v171
    s_cmp_eq_u32 s35, 1
    s_cbranch_scc1 G3_e1
    v_pk_fma_f32 v[24:25], v[164:165], v[136:137], v[24:25] op_sel_hi:[0,1,1] neg_lo:[1,0,0] neg_hi:[1,0,0]
    v_pk_fma_f32 v[26:27], v[164:165], v[138:139], v[26:27] op_sel_hi:[0,1,1] neg_lo:[1,0,0] neg_hi:[1,0,0]
    v_pk_mul_f32 v[226:227], v[24:25], v[24:25]
    v_pk_mul_f32 v[228:229], v[26:27], v[26:27]
    v_pk_fma_f32 v[226:227], v[226:227], v[184:185], v[184:185] op_sel:[0,1,0] op_sel_hi:[1,1,0]
    v_pk_fma_f32 v[228:229], v[228:229], v[184:185], v[184:185] op_sel:[0,1,0] op_sel_hi:[1,1,0]
    v_pk_mul_f32 v[226:227], v[226:227], v[24:25]
    v_pk_mul_f32 v[228:229], v[228:229], v[26:27]
    v_exp_f32 v226, v226
    v_exp_f32 v227, v227
    v_exp_f32 v228, v228
    v_exp_f32 v229, v229
    v_pk_fma_f32 v[226:227], v[226:227], v[164:165], v[164:165] op_sel:[0,1,1] op_sel_hi:[1,1,1]
    v_pk_fma_f32 v[228:229], v[228:229], v[164:165], v[164:165] op_sel:[0,1,1] op_sel_hi:[1,1,1]
    v_rcp_f32 v226, v226
    v_rcp_f32 v227, v227
    v_rcp_f32 v228, v228
    v_rcp_f32 v229, v229
    v_pk_mul_f32 v[24:25], v[24:25], v[226:227]
    v_pk_mul_f32 v[26:27], v[26:27], v[228:229]
    v_pk_fma_f32 v[28:29], v[164:165], v[140:141], v[28:29] op_sel_hi:[0,1,1] neg_lo:[1,0,0] neg_hi:[1,0,0]
    v_pk_fma_f32 v[30:31], v[164:165], v[142:143], v[30:31] op_sel_hi:[0,1,1] neg_lo:[1,0,0] neg_hi:[1,0,0]
    v_pk_mul_f32 v[226:227], v[28:29], v[28:29]
    v_pk_mul_f32 v[228:229], v[30:31], v[30:31]
    v_pk_fma_f32 v[226:227], v[226:227], v[184:185], v[184:185] op_sel:[0,1,0] op_sel_hi:[1,1,0]
    v_pk_fma_f32 v[228:229], v[228:229], v[184:185], v[184:185] op_sel:[0,1,0] op_sel_hi:[1,1,0]
    v_pk_mul_f32 v[226:227], v[226:227], v[28:29]
    v_pk_mul_f32 v[228:229], v[228:229], v[30:31]
    v_exp_f32 v226, v226
    v_exp_f32 v227, v227
    v_exp_f32 v228, v228
    v_exp_f32 v229, v229
    v_pk_fma_f32 v[226:227], v[226:227], v[164:165], v[164:165] op_sel:[0,1,1] op_sel_hi:[1,1,1]
    v_pk_fma_f32 v[228:229], v[228:229], v[164:165], v[164:165] op_sel:[0,1,1] op_sel_hi:[1,1,1]
    v_rcp_f32 v226, v226
    v_rcp_f32 v227, v227
    v_rcp_f32 v228, v228
    v_rcp_f32 v229, v229
    v_pk_mul_f32 v[28:29], v[28:29], v[226:227]
    v_pk_mul_f32 v[30:31], v[30:31], v[228:229]
    v_cvt_pk_bf16_f32 v24, v24, v25
    v_cvt_pk_bf16_f32 v25, v26, v27
    v_cvt_pk_bf16_f32 v26, v28, v29
    v_cvt_pk_bf16_f32 v27, v30, v31
    ds_write_b128 v12, v[24:27] offset:0
    s_add_u32 s36, s44, 0
    buffer_store_dwordx4 v[24:27], v2, s[16:19], s36 offen sc1
    v_pk_fma_f32 v[52:53], v[166:167], v[136:137], v[52:53] op_sel_hi:[0,1,1] neg_lo:[1,0,0] neg_hi:[1,0,0]
    v_pk_fma_f32 v[54:55], v[166:167], v[138:139], v[54:55] op_sel_hi:[0,1,1] neg_lo:[1,0,0] neg_hi:[1,0,0]
    v_pk_mul_f32 v[226:227], v[52:53], v[52:53]
    v_pk_mul_f32 v[228:229], v[54:55], v[54:55]
    v_pk_fma_f32 v[226:227], v[226:227], v[186:187], v[186:187] op_sel:[0,1,0] op_sel_hi:[1,1,0]
    v_pk_fma_f32 v[228:229], v[228:229], v[186:187], v[186:187] op_sel:[0,1,0] op_sel_hi:[1,1,0]
    v_pk_mul_f32 v[226:227], v[226:227], v[52:53]
    v_pk_mul_f32 v[228:229], v[228:229], v[54:55]
    v_exp_f32 v226, v226
    v_exp_f32 v227, v227
    v_exp_f32 v228, v228
    v_exp_f32 v229, v229
    v_pk_fma_f32 v[226:227], v[226:227], v[166:167], v[166:167] op_sel:[0,1,1] op_sel_hi:[1,1,1]
    v_pk_fma_f32 v[228:229], v[228:229], v[166:167], v[166:167] op_sel:[0,1,1] op_sel_hi:[1,1,1]
    v_rcp_f32 v226, v226
    v_rcp_f32 v227, v227
    v_rcp_f32 v228, v228
    v_rcp_f32 v229, v229
    v_pk_mul_f32 v[52:53], v[52:53], v[226:227]
    v_pk_mul_f32 v[54:55], v[54:55], v[228:229]
    v_pk_fma_f32 v[56:57], v[166:167], v[140:141], v[56:57] op_sel_hi:[0,1,1] neg_lo:[1,0,0] neg_hi:[1,0,0]
    v_pk_fma_f32 v[58:59], v[166:167], v[142:143], v[58:59] op_sel_hi:[0,1,1] neg_lo:[1,0,0] neg_hi:[1,0,0]
    v_pk_mul_f32 v[226:227], v[56:57], v[56:57]
    v_pk_mul_f32 v[228:229], v[58:59], v[58:59]
    v_pk_fma_f32 v[226:227], v[226:227], v[186:187], v[186:187] op_sel:[0,1,0] op_sel_hi:[1,1,0]
    v_pk_fma_f32 v[228:229], v[228:229], v[186:187], v[186:187] op_sel:[0,1,0] op_sel_hi:[1,1,0]
    v_pk_mul_f32 v[226:227], v[226:227], v[56:57]
    v_pk_mul_f32 v[228:229], v[228:229], v[58:59]
    v_exp_f32 v226, v226
    v_exp_f32 v227, v227
    v_exp_f32 v228, v228
    v_exp_f32 v229, v229
    v_pk_fma_f32 v[226:227], v[226:227], v[166:167], v[166:167] op_sel:[0,1,1] op_sel_hi:[1,1,1]
    v_pk_fma_f32 v[228:229], v[228:229], v[166:167], v[166:167] op_sel:[0,1,1] op_sel_hi:[1,1,1]
    v_rcp_f32 v226, v226
    v_rcp_f32 v227, v227
    v_rcp_f32 v228, v228
    v_rcp_f32 v229, v229
    v_pk_mul_f32 v[56:57], v[56:57], v[226:227]
    v_pk_mul_f32 v[58:59], v[58:59], v[228:229]
    v_cvt_pk_bf16_f32 v52, v52, v53
    v_cvt_pk_bf16_f32 v53, v54, v55
    v_cvt_pk_bf16_f32 v54, v56, v57
    v_cvt_pk_bf16_f32 v55, v58, v59
    ds_write_b128 v12, v[52:55] offset:2048
    s_add_u32 s36, s44, 229376
    buffer_store_dwordx4 v[52:55], v2, s[16:19], s36 offen sc1
    v_pk_fma_f32 v[80:81], v[168:169], v[136:137], v[80:81] op_sel_hi:[0,1,1] neg_lo:[1,0,0] neg_hi:[1,0,0]
    v_pk_fma_f32 v[82:83], v[168:169], v[138:139], v[82:83] op_sel_hi:[0,1,1] neg_lo:[1,0,0] neg_hi:[1,0,0]
    v_pk_mul_f32 v[226:227], v[80:81], v[80:81]
    v_pk_mul_f32 v[228:229], v[82:83], v[82:83]
    v_pk_fma_f32 v[226:227], v[226:227], v[188:189], v[188:189] op_sel:[0,1,0] op_sel_hi:[1,1,0]
    v_pk_fma_f32 v[228:229], v[228:229], v[188:189], v[188:189] op_sel:[0,1,0] op_sel_hi:[1,1,0]
    v_pk_mul_f32 v[226:227], v[226:227], v[80:81]
    v_pk_mul_f32 v[228:229], v[228:229], v[82:83]
    v_exp_f32 v226, v226
    v_exp_f32 v227, v227
    v_exp_f32 v228, v228
    v_exp_f32 v229, v229
    v_pk_fma_f32 v[226:227], v[226:227], v[168:169], v[168:169] op_sel:[0,1,1] op_sel_hi:[1,1,1]
    v_pk_fma_f32 v[228:229], v[228:229], v[168:169], v[168:169] op_sel:[0,1,1] op_sel_hi:[1,1,1]
    v_rcp_f32 v226, v226
    v_rcp_f32 v227, v227
    v_rcp_f32 v228, v228
    v_rcp_f32 v229, v229
    v_pk_mul_f32 v[80:81], v[80:81], v[226:227]
    v_pk_mul_f32 v[82:83], v[82:83], v[228:229]
    v_pk_fma_f32 v[84:85], v[168:169], v[140:141], v[84:85] op_sel_hi:[0,1,1] neg_lo:[1,0,0] neg_hi:[1,0,0]
    v_pk_fma_f32 v[86:87], v[168:169], v[142:143], v[86:87] op_sel_hi:[0,1,1] neg_lo:[1,0,0] neg_hi:[1,0,0]
    v_pk_mul_f32 v[226:227], v[84:85], v[84:85]
    v_pk_mul_f32 v[228:229], v[86:87], v[86:87]
    v_pk_fma_f32 v[226:227], v[226:227], v[188:189], v[188:189] op_sel:[0,1,0] op_sel_hi:[1,1,0]
    v_pk_fma_f32 v[228:229], v[228:229], v[188:189], v[188:189] op_sel:[0,1,0] op_sel_hi:[1,1,0]
    v_pk_mul_f32 v[226:227], v[226:227], v[84:85]
    v_pk_mul_f32 v[228:229], v[228:229], v[86:87]
    v_exp_f32 v226, v226
    v_exp_f32 v227, v227
    v_exp_f32 v228, v228
    v_exp_f32 v229, v229
    v_pk_fma_f32 v[226:227], v[226:227], v[168:169], v[168:169] op_sel:[0,1,1] op_sel_hi:[1,1,1]
    v_pk_fma_f32 v[228:229], v[228:229], v[168:169], v[168:169] op_sel:[0,1,1] op_sel_hi:[1,1,1]
    v_rcp_f32 v226, v226
    v_rcp_f32 v227, v227
    v_rcp_f32 v228, v228
    v_rcp_f32 v229, v229
    v_pk_mul_f32 v[84:85], v[84:85], v[226:227]
    v_pk_mul_f32 v[86:87], v[86:87], v[228:229]
    v_cvt_pk_bf16_f32 v80, v80, v81
    v_cvt_pk_bf16_f32 v81, v82, v83
    v_cvt_pk_bf16_f32 v82, v84, v85
    v_cvt_pk_bf16_f32 v83, v86, v87
    ds_write_b128 v12, v[80:83] offset:4096
    s_add_u32 s36, s44, 458752
    buffer_store_dwordx4 v[80:83], v2, s[16:19], s36 offen sc1
    v_pk_fma_f32 v[108:109], v[170:171], v[136:137], v[108:109] op_sel_hi:[0,1,1] neg_lo:[1,0,0] neg_hi:[1,0,0]
    v_pk_fma_f32 v[110:111], v[170:171], v[138:139], v[110:111] op_sel_hi:[0,1,1] neg_lo:[1,0,0] neg_hi:[1,0,0]
    v_pk_mul_f32 v[226:227], v[108:109], v[108:109]
    v_pk_mul_f32 v[228:229], v[110:111], v[110:111]
    v_pk_fma_f32 v[226:227], v[226:227], v[190:191], v[190:191] op_sel:[0,1,0] op_sel_hi:[1,1,0]
    v_pk_fma_f32 v[228:229], v[228:229], v[190:191], v[190:191] op_sel:[0,1,0] op_sel_hi:[1,1,0]
    v_pk_mul_f32 v[226:227], v[226:227], v[108:109]
    v_pk_mul_f32 v[228:229], v[228:229], v[110:111]
    v_exp_f32 v226, v226
    v_exp_f32 v227, v227
    v_exp_f32 v228, v228
    v_exp_f32 v229, v229
    v_pk_fma_f32 v[226:227], v[226:227], v[170:171], v[170:171] op_sel:[0,1,1] op_sel_hi:[1,1,1]
    v_pk_fma_f32 v[228:229], v[228:229], v[170:171], v[170:171] op_sel:[0,1,1] op_sel_hi:[1,1,1]
    v_rcp_f32 v226, v226
    v_rcp_f32 v227, v227
    v_rcp_f32 v228, v228
    v_rcp_f32 v229, v229
    v_pk_mul_f32 v[108:109], v[108:109], v[226:227]
    v_pk_mul_f32 v[110:111], v[110:111], v[228:229]
    v_pk_fma_f32 v[112:113], v[170:171], v[140:141], v[112:113] op_sel_hi:[0,1,1] neg_lo:[1,0,0] neg_hi:[1,0,0]
    v_pk_fma_f32 v[114:115], v[170:171], v[142:143], v[114:115] op_sel_hi:[0,1,1] neg_lo:[1,0,0] neg_hi:[1,0,0]
    v_pk_mul_f32 v[226:227], v[112:113], v[112:113]
    v_pk_mul_f32 v[228:229], v[114:115], v[114:115]
    v_pk_fma_f32 v[226:227], v[226:227], v[190:191], v[190:191] op_sel:[0,1,0] op_sel_hi:[1,1,0]
    v_pk_fma_f32 v[228:229], v[228:229], v[190:191], v[190:191] op_sel:[0,1,0] op_sel_hi:[1,1,0]
    v_pk_mul_f32 v[226:227], v[226:227], v[112:113]
    v_pk_mul_f32 v[228:229], v[228:229], v[114:115]
    v_exp_f32 v226, v226
    v_exp_f32 v227, v227
    v_exp_f32 v228, v228
    v_exp_f32 v229, v229
    v_pk_fma_f32 v[226:227], v[226:227], v[170:171], v[170:171] op_sel:[0,1,1] op_sel_hi:[1,1,1]
    v_pk_fma_f32 v[228:229], v[228:229], v[170:171], v[170:171] op_sel:[0,1,1] op_sel_hi:[1,1,1]
    v_rcp_f32 v226, v226
    v_rcp_f32 v227, v227
    v_rcp_f32 v228, v228
    v_rcp_f32 v229, v229
    v_pk_mul_f32 v[112:113], v[112:113], v[226:227]
    v_pk_mul_f32 v[114:115], v[114:115], v[228:229]
    v_cvt_pk_bf16_f32 v108, v108, v109
    v_cvt_pk_bf16_f32 v109, v110, v111
    v_cvt_pk_bf16_f32 v110, v112, v113
    v_cvt_pk_bf16_f32 v111, v114, v115
    ds_write_b128 v12, v[108:111] offset:6144
    s_add_u32 s36, s44, 688128
    buffer_store_dwordx4 v[108:111], v2, s[16:19], s36 offen sc1
    v_pk_fma_f32 v[32:33], v[164:165], v[144:145], v[32:33] op_sel_hi:[0,1,1] neg_lo:[1,0,0] neg_hi:[1,0,0]
    v_pk_fma_f32 v[34:35], v[164:165], v[146:147], v[34:35] op_sel_hi:[0,1,1] neg_lo:[1,0,0] neg_hi:[1,0,0]
    v_pk_mul_f32 v[226:227], v[32:33], v[32:33]
    v_pk_mul_f32 v[228:229], v[34:35], v[34:35]
    v_pk_fma_f32 v[226:227], v[226:227], v[184:185], v[184:185] op_sel:[0,1,0] op_sel_hi:[1,1,0]
    v_pk_fma_f32 v[228:229], v[228:229], v[184:185], v[184:185] op_sel:[0,1,0] op_sel_hi:[1,1,0]
    v_pk_mul_f32 v[226:227], v[226:227], v[32:33]
    v_pk_mul_f32 v[228:229], v[228:229], v[34:35]
    v_exp_f32 v226, v226
    v_exp_f32 v227, v227
    v_exp_f32 v228, v228
    v_exp_f32 v229, v229
    v_pk_fma_f32 v[226:227], v[226:227], v[164:165], v[164:165] op_sel:[0,1,1] op_sel_hi:[1,1,1]
    v_pk_fma_f32 v[228:229], v[228:229], v[164:165], v[164:165] op_sel:[0,1,1] op_sel_hi:[1,1,1]
    v_rcp_f32 v226, v226
    v_rcp_f32 v227, v227
    v_rcp_f32 v228, v228
    v_rcp_f32 v229, v229
    v_pk_mul_f32 v[32:33], v[32:33], v[226:227]
    v_pk_mul_f32 v[34:35], v[34:35], v[228:229]
    v_pk_fma_f32 v[36:37], v[164:165], v[148:149], v[36:37] op_sel_hi:[0,1,1] neg_lo:[1,0,0] neg_hi:[1,0,0]
    v_pk_fma_f32 v[38:39], v[164:165], v[150:151], v[38:39] op_sel_hi:[0,1,1] neg_lo:[1,0,0] neg_hi:[1,0,0]
    v_pk_mul_f32 v[226:227], v[36:37], v[36:37]
    v_pk_mul_f32 v[228:229], v[38:39], v[38:39]
    v_pk_fma_f32 v[226:227], v[226:227], v[184:185], v[184:185] op_sel:[0,1,0] op_sel_hi:[1,1,0]
    v_pk_fma_f32 v[228:229], v[228:229], v[184:185], v[184:185] op_sel:[0,1,0] op_sel_hi:[1,1,0]
    v_pk_mul_f32 v[226:227], v[226:227], v[36:37]
    v_pk_mul_f32 v[228:229], v[228:229], v[38:39]
    v_exp_f32 v226, v226
    v_exp_f32 v227, v227
    v_exp_f32 v228, v228
    v_exp_f32 v229, v229
    v_pk_fma_f32 v[226:227], v[226:227], v[164:165], v[164:165] op_sel:[0,1,1] op_sel_hi:[1,1,1]
    v_pk_fma_f32 v[228:229], v[228:229], v[164:165], v[164:165] op_sel:[0,1,1] op_sel_hi:[1,1,1]
    v_rcp_f32 v226, v226
    v_rcp_f32 v227, v227
    v_rcp_f32 v228, v228
    v_rcp_f32 v229, v229
    v_pk_mul_f32 v[36:37], v[36:37], v[226:227]
    v_pk_mul_f32 v[38:39], v[38:39], v[228:229]
    v_cvt_pk_bf16_f32 v32, v32, v33
    v_cvt_pk_bf16_f32 v33, v34, v35
    v_cvt_pk_bf16_f32 v34, v36, v37
    v_cvt_pk_bf16_f32 v35, v38, v39
    ds_write_b128 v12, v[32:35] offset:16384
    s_add_u32 s53, s55, 1792
    s_lshl_b32 s54, s31, 7
    s_add_u32 s53, s53, s54
    v_mov_b32 v8, 1
    v_mov_b32 v9, 162864
    v_mov_b32 v11, 0
    s_mov_b64 exec, 1
    s_waitcnt vmcnt(0)
    ds_add_rtn_u32 v10, v9, v8
    s_waitcnt lgkmcnt(0)
    v_readfirstlane_b32 s54, v10
    s_nop 0
    s_and_b32 s54, s54, 3
    s_cmp_lg_u32 s54, 3
    s_cbranch_scc1 pub_28
    buffer_atomic_add v8, v11, s[56:59], s53 offen sc1
    v_mov_b32 v9, 162872
    ds_add_u32 v9, v8
pub_28:
    s_mov_b64 exec, -1
    v_pk_fma_f32 v[60:61], v[166:167], v[144:145], v[60:61] op_sel_hi:[0,1,1] neg_lo:[1,0,0] neg_hi:[1,0,0]
    v_pk_fma_f32 v[62:63], v[166:167], v[146:147], v[62:63] op_sel_hi:[0,1,1] neg_lo:[1,0,0] neg_hi:[1,0,0]
    v_pk_mul_f32 v[226:227], v[60:61], v[60:61]
    v_pk_mul_f32 v[228:229], v[62:63], v[62:63]
    v_pk_fma_f32 v[226:227], v[226:227], v[186:187], v[186:187] op_sel:[0,1,0] op_sel_hi:[1,1,0]
    v_pk_fma_f32 v[228:229], v[228:229], v[186:187], v[186:187] op_sel:[0,1,0] op_sel_hi:[1,1,0]
    v_pk_mul_f32 v[226:227], v[226:227], v[60:61]
    v_pk_mul_f32 v[228:229], v[228:229], v[62:63]
    v_exp_f32 v226, v226
    v_exp_f32 v227, v227
    v_exp_f32 v228, v228
    v_exp_f32 v229, v229
    v_pk_fma_f32 v[226:227], v[226:227], v[166:167], v[166:167] op_sel:[0,1,1] op_sel_hi:[1,1,1]
    v_pk_fma_f32 v[228:229], v[228:229], v[166:167], v[166:167] op_sel:[0,1,1] op_sel_hi:[1,1,1]
    v_rcp_f32 v226, v226
    v_rcp_f32 v227, v227
    v_rcp_f32 v228, v228
    v_rcp_f32 v229, v229
    v_pk_mul_f32 v[60:61], v[60:61], v[226:227]
    v_pk_mul_f32 v[62:63], v[62:63], v[228:229]
    v_pk_fma_f32 v[64:65], v[166:167], v[148:149], v[64:65] op_sel_hi:[0,1,1] neg_lo:[1,0,0] neg_hi:[1,0,0]
    v_pk_fma_f32 v[66:67], v[166:167], v[150:151], v[66:67] op_sel_hi:[0,1,1] neg_lo:[1,0,0] neg_hi:[1,0,0]
    v_pk_mul_f32 v[226:227], v[64:65], v[64:65]
    v_pk_mul_f32 v[228:229], v[66:67], v[66:67]
    v_pk_fma_f32 v[226:227], v[226:227], v[186:187], v[186:187] op_sel:[0,1,0] op_sel_hi:[1,1,0]
    v_pk_fma_f32 v[228:229], v[228:229], v[186:187], v[186:187] op_sel:[0,1,0] op_sel_hi:[1,1,0]
    v_pk_mul_f32 v[226:227], v[226:227], v[64:65]
    v_pk_mul_f32 v[228:229], v[228:229], v[66:67]
    v_exp_f32 v226, v226
    v_exp_f32 v227, v227
    v_exp_f32 v228, v228
    v_exp_f32 v229, v229
    v_pk_fma_f32 v[226:227], v[226:227], v[166:167], v[166:167] op_sel:[0,1,1] op_sel_hi:[1,1,1]
    v_pk_fma_f32 v[228:229], v[228:229], v[166:167], v[166:167] op_sel:[0,1,1] op_sel_hi:[1,1,1]
    v_rcp_f32 v226, v226
    v_rcp_f32 v227, v227
    v_rcp_f32 v228, v228
    v_rcp_f32 v229, v229
    v_pk_mul_f32 v[64:65], v[64:65], v[226:227]
    v_pk_mul_f32 v[66:67], v[66:67], v[228:229]
    v_cvt_pk_bf16_f32 v60, v60, v61
    v_cvt_pk_bf16_f32 v61, v62, v63
    v_cvt_pk_bf16_f32 v62, v64, v65
    v_cvt_pk_bf16_f32 v63, v66, v67
    ds_write_b128 v12, v[60:63] offset:18432
    v_pk_fma_f32 v[88:89], v[168:169], v[144:145], v[88:89] op_sel_hi:[0,1,1] neg_lo:[1,0,0] neg_hi:[1,0,0]
    v_pk_fma_f32 v[90:91], v[168:169], v[146:147], v[90:91] op_sel_hi:[0,1,1] neg_lo:[1,0,0] neg_hi:[1,0,0]
    v_pk_mul_f32 v[226:227], v[88:89], v[88:89]
    v_pk_mul_f32 v[228:229], v[90:91], v[90:91]
    v_pk_fma_f32 v[226:227], v[226:227], v[188:189], v[188:189] op_sel:[0,1,0] op_sel_hi:[1,1,0]
    v_pk_fma_f32 v[228:229], v[228:229], v[188:189], v[188:189] op_sel:[0,1,0] op_sel_hi:[1,1,0]
    v_pk_mul_f32 v[226:227], v[226:227], v[88:89]
    v_pk_mul_f32 v[228:229], v[228:229], v[90:91]
    v_exp_f32 v226, v226
    v_exp_f32 v227, v227
    v_exp_f32 v228, v228
    v_exp_f32 v229, v229
    v_pk_fma_f32 v[226:227], v[226:227], v[168:169], v[168:169] op_sel:[0,1,1] op_sel_hi:[1,1,1]
    v_pk_fma_f32 v[228:229], v[228:229], v[168:169], v[168:169] op_sel:[0,1,1] op_sel_hi:[1,1,1]
    v_rcp_f32 v226, v226
    v_rcp_f32 v227, v227
    v_rcp_f32 v228, v228
    v_rcp_f32 v229, v229
    v_pk_mul_f32 v[88:89], v[88:89], v[226:227]
    v_pk_mul_f32 v[90:91], v[90:91], v[228:229]
    v_pk_fma_f32 v[92:93], v[168:169], v[148:149], v[92:93] op_sel_hi:[0,1,1] neg_lo:[1,0,0] neg_hi:[1,0,0]
    v_pk_fma_f32 v[94:95], v[168:169], v[150:151], v[94:95] op_sel_hi:[0,1,1] neg_lo:[1,0,0] neg_hi:[1,0,0]
    v_pk_mul_f32 v[226:227], v[92:93], v[92:93]
    v_pk_mul_f32 v[228:229], v[94:95], v[94:95]
    v_pk_fma_f32 v[226:227], v[226:227], v[188:189], v[188:189] op_sel:[0,1,0] op_sel_hi:[1,1,0]
    v_pk_fma_f32 v[228:229], v[228:229], v[188:189], v[188:189] op_sel:[0,1,0] op_sel_hi:[1,1,0]
    v_pk_mul_f32 v[226:227], v[226:227], v[92:93]
    v_pk_mul_f32 v[228:229], v[228:229], v[94:95]
    v_exp_f32 v226, v226
    v_exp_f32 v227, v227
    v_exp_f32 v228, v228
    v_exp_f32 v229, v229
    v_pk_fma_f32 v[226:227], v[226:227], v[168:169], v[168:169] op_sel:[0,1,1] op_sel_hi:[1,1,1]
    v_pk_fma_f32 v[228:229], v[228:229], v[168:169], v[168:169] op_sel:[0,1,1] op_sel_hi:[1,1,1]
    v_rcp_f32 v226, v226
    v_rcp_f32 v227, v227
    v_rcp_f32 v228, v228
    v_rcp_f32 v229, v229
    v_pk_mul_f32 v[92:93], v[92:93], v[226:227]
    v_pk_mul_f32 v[94:95], v[94:95], v[228:229]
    v_cvt_pk_bf16_f32 v88, v88, v89
    v_cvt_pk_bf16_f32 v89, v90, v91
    v_cvt_pk_bf16_f32 v90, v92, v93
    v_cvt_pk_bf16_f32 v91, v94, v95
    ds_write_b128 v12, v[88:91] offset:20480
    v_pk_fma_f32 v[116:117], v[170:171], v[144:145], v[116:117] op_sel_hi:[0,1,1] neg_lo:[1,0,0] neg_hi:[1,0,0]
    v_pk_fma_f32 v[118:119], v[170:171], v[146:147], v[118:119] op_sel_hi:[0,1,1] neg_lo:[1,0,0] neg_hi:[1,0,0]
    v_pk_mul_f32 v[226:227], v[116:117], v[116:117]
    v_pk_mul_f32 v[228:229], v[118:119], v[118:119]
    v_pk_fma_f32 v[226:227], v[226:227], v[190:191], v[190:191] op_sel:[0,1,0] op_sel_hi:[1,1,0]
    v_pk_fma_f32 v[228:229], v[228:229], v[190:191], v[190:191] op_sel:[0,1,0] op_sel_hi:[1,1,0]
    v_pk_mul_f32 v[226:227], v[226:227], v[116:117]
    v_pk_mul_f32 v[228:229], v[228:229], v[118:119]
    v_exp_f32 v226, v226
    v_exp_f32 v227, v227
    v_exp_f32 v228, v228
    v_exp_f32 v229, v229
    v_pk_fma_f32 v[226:227], v[226:227], v[170:171], v[170:171] op_sel:[0,1,1] op_sel_hi:[1,1,1]
    v_pk_fma_f32 v[228:229], v[228:229], v[170:171], v[170:171] op_sel:[0,1,1] op_sel_hi:[1,1,1]
    v_rcp_f32 v226, v226
    v_rcp_f32 v227, v227
    v_rcp_f32 v228, v228
    v_rcp_f32 v229, v229
    v_pk_mul_f32 v[116:117], v[116:117], v[226:227]
    v_pk_mul_f32 v[118:119], v[118:119], v[228:229]
    v_pk_fma_f32 v[120:121], v[170:171], v[148:149], v[120:121] op_sel_hi:[0,1,1] neg_lo:[1,0,0] neg_hi:[1,0,0]
    v_pk_fma_f32 v[122:123], v[170:171], v[150:151], v[122:123] op_sel_hi:[0,1,1] neg_lo:[1,0,0] neg_hi:[1,0,0]
    v_pk_mul_f32 v[226:227], v[120:121], v[120:121]
    v_pk_mul_f32 v[228:229], v[122:123], v[122:123]
    v_pk_fma_f32 v[226:227], v[226:227], v[190:191], v[190:191] op_sel:[0,1,0] op_sel_hi:[1,1,0]
    v_pk_fma_f32 v[228:229], v[228:229], v[190:191], v[190:191] op_sel:[0,1,0] op_sel_hi:[1,1,0]
    v_pk_mul_f32 v[226:227], v[226:227], v[120:121]
    v_pk_mul_f32 v[228:229], v[228:229], v[122:123]
    v_exp_f32 v226, v226
    v_exp_f32 v227, v227
    v_exp_f32 v228, v228
    v_exp_f32 v229, v229
    v_pk_fma_f32 v[226:227], v[226:227], v[170:171], v[170:171] op_sel:[0,1,1] op_sel_hi:[1,1,1]
    v_pk_fma_f32 v[228:229], v[228:229], v[170:171], v[170:171] op_sel:[0,1,1] op_sel_hi:[1,1,1]
    v_rcp_f32 v226, v226
    v_rcp_f32 v227, v227
    v_rcp_f32 v228, v228
    v_rcp_f32 v229, v229
    v_pk_mul_f32 v[120:121], v[120:121], v[226:227]
    v_pk_mul_f32 v[122:123], v[122:123], v[228:229]
    v_cvt_pk_bf16_f32 v116, v116, v117
    v_cvt_pk_bf16_f32 v117, v118, v119
    v_cvt_pk_bf16_f32 v118, v120, v121
    v_cvt_pk_bf16_f32 v119, v122, v123
    ds_write_b128 v12, v[116:119] offset:22528
    v_pk_fma_f32 v[40:41], v[164:165], v[152:153], v[40:41] op_sel_hi:[0,1,1] neg_lo:[1,0,0] neg_hi:[1,0,0]
    v_pk_fma_f32 v[42:43], v[164:165], v[154:155], v[42:43] op_sel_hi:[0,1,1] neg_lo:[1,0,0] neg_hi:[1,0,0]
    v_pk_mul_f32 v[226:227], v[40:41], v[40:41]
    v_pk_mul_f32 v[228:229], v[42:43], v[42:43]
    v_pk_fma_f32 v[226:227], v[226:227], v[184:185], v[184:185] op_sel:[0,1,0] op_sel_hi:[1,1,0]
    v_pk_fma_f32 v[228:229], v[228:229], v[184:185], v[184:185] op_sel:[0,1,0] op_sel_hi:[1,1,0]
    v_pk_mul_f32 v[226:227], v[226:227], v[40:41]
    v_pk_mul_f32 v[228:229], v[228:229], v[42:43]
    v_exp_f32 v226, v226
    v_exp_f32 v227, v227
    v_exp_f32 v228, v228
    v_exp_f32 v229, v229
    v_pk_fma_f32 v[226:227], v[226:227], v[164:165], v[164:165] op_sel:[0,1,1] op_sel_hi:[1,1,1]
    v_pk_fma_f32 v[228:229], v[228:229], v[164:165], v[164:165] op_sel:[0,1,1] op_sel_hi:[1,1,1]
    v_rcp_f32 v226, v226
    v_rcp_f32 v227, v227
    v_rcp_f32 v228, v228
    v_rcp_f32 v229, v229
    v_pk_mul_f32 v[40:41], v[40:41], v[226:227]
    v_pk_mul_f32 v[42:43], v[42:43], v[228:229]
    v_pk_fma_f32 v[44:45], v[164:165], v[156:157], v[44:45] op_sel_hi:[0,1,1] neg_lo:[1,0,0] neg_hi:[1,0,0]
    v_pk_fma_f32 v[46:47], v[164:165], v[158:159], v[46:47] op_sel_hi:[0,1,1] neg_lo:[1,0,0] neg_hi:[1,0,0]
    v_pk_mul_f32 v[226:227], v[44:45], v[44:45]
    v_pk_mul_f32 v[228:229], v[46:47], v[46:47]
    v_pk_fma_f32 v[226:227], v[226:227], v[184:185], v[184:185] op_sel:[0,1,0] op_sel_hi:[1,1,0]
    v_pk_fma_f32 v[228:229], v[228:229], v[184:185], v[184:185] op_sel:[0,1,0] op_sel_hi:[1,1,0]
    v_pk_mul_f32 v[226:227], v[226:227], v[44:45]
    v_pk_mul_f32 v[228:229], v[228:229], v[46:47]
    v_exp_f32 v226, v226
    v_exp_f32 v227, v227
    v_exp_f32 v228, v228
    v_exp_f32 v229, v229
    v_pk_fma_f32 v[226:227], v[226:227], v[164:165], v[164:165] op_sel:[0,1,1] op_sel_hi:[1,1,1]
    v_pk_fma_f32 v[228:229], v[228:229], v[164:165], v[164:165] op_sel:[0,1,1] op_sel_hi:[1,1,1]
    v_rcp_f32 v226, v226
    v_rcp_f32 v227, v227
    v_rcp_f32 v228, v228
    v_rcp_f32 v229, v229
    v_pk_mul_f32 v[44:45], v[44:45], v[226:227]
    v_pk_mul_f32 v[46:47], v[46:47], v[228:229]
    v_cvt_pk_bf16_f32 v200, v40, v41
    v_cvt_pk_bf16_f32 v201, v42, v43
    v_cvt_pk_bf16_f32 v202, v44, v45
    v_cvt_pk_bf16_f32 v203, v46, v47
    ds_write_b128 v12, v[200:203] offset:32768
    v_pk_fma_f32 v[68:69], v[166:167], v[152:153], v[68:69] op_sel_hi:[0,1,1] neg_lo:[1,0,0] neg_hi:[1,0,0]
    v_pk_fma_f32 v[70:71], v[166:167], v[154:155], v[70:71] op_sel_hi:[0,1,1] neg_lo:[1,0,0] neg_hi:[1,0,0]
    v_pk_mul_f32 v[226:227], v[68:69], v[68:69]
    v_pk_mul_f32 v[228:229], v[70:71], v[70:71]
    v_pk_fma_f32 v[226:227], v[226:227], v[186:187], v[186:187] op_sel:[0,1,0] op_sel_hi:[1,1,0]
    v_pk_fma_f32 v[228:229], v[228:229], v[186:187], v[186:187] op_sel:[0,1,0] op_sel_hi:[1,1,0]
    v_pk_mul_f32 v[226:227], v[226:227], v[68:69]
    v_pk_mul_f32 v[228:229], v[228:229], v[70:71]
    v_exp_f32 v226, v226
    v_exp_f32 v227, v227
    v_exp_f32 v228, v228
    v_exp_f32 v229, v229
    v_pk_fma_f32 v[226:227], v[226:227], v[166:167], v[166:167] op_sel:[0,1,1] op_sel_hi:[1,1,1]
    v_pk_fma_f32 v[228:229], v[228:229], v[166:167], v[166:167] op_sel:[0,1,1] op_sel_hi:[1,1,1]
    v_rcp_f32 v226, v226
    v_rcp_f32 v227, v227
    v_rcp_f32 v228, v228
    v_rcp_f32 v229, v229
    v_pk_mul_f32 v[68:69], v[68:69], v[226:227]
    v_pk_mul_f32 v[70:71], v[70:71], v[228:229]
    v_pk_fma_f32 v[72:73], v[166:167], v[156:157], v[72:73] op_sel_hi:[0,1,1] neg_lo:[1,0,0] neg_hi:[1,0,0]
    v_pk_fma_f32 v[74:75], v[166:167], v[158:159], v[74:75] op_sel_hi:[0,1,1] neg_lo:[1,0,0] neg_hi:[1,0,0]
    v_pk_mul_f32 v[226:227], v[72:73], v[72:73]
    v_pk_mul_f32 v[228:229], v[74:75], v[74:75]
    v_pk_fma_f32 v[226:227], v[226:227], v[186:187], v[186:187] op_sel:[0,1,0] op_sel_hi:[1,1,0]
    v_pk_fma_f32 v[228:229], v[228:229], v[186:187], v[186:187] op_sel:[0,1,0] op_sel_hi:[1,1,0]
    v_pk_mul_f32 v[226:227], v[226:227], v[72:73]
    v_pk_mul_f32 v[228:229], v[228:229], v[74:75]
    v_exp_f32 v226, v226
    v_exp_f32 v227, v227
    v_exp_f32 v228, v228
    v_exp_f32 v229, v229
    v_pk_fma_f32 v[226:227], v[226:227], v[166:167], v[166:167] op_sel:[0,1,1] op_sel_hi:[1,1,1]
    v_pk_fma_f32 v[228:229], v[228:229], v[166:167], v[166:167] op_sel:[0,1,1] op_sel_hi:[1,1,1]
    v_rcp_f32 v226, v226
    v_rcp_f32 v227, v227
    v_rcp_f32 v228, v228
    v_rcp_f32 v229, v229
    v_pk_mul_f32 v[72:73], v[72:73], v[226:227]
    v_pk_mul_f32 v[74:75], v[74:75], v[228:229]
    v_cvt_pk_bf16_f32 v204, v68, v69
    v_cvt_pk_bf16_f32 v205, v70, v71
    v_cvt_pk_bf16_f32 v206, v72, v73
    v_cvt_pk_bf16_f32 v207, v74, v75
    ds_write_b128 v12, v[204:207] offset:34816
    v_pk_fma_f32 v[96:97], v[168:169], v[152:153], v[96:97] op_sel_hi:[0,1,1] neg_lo:[1,0,0] neg_hi:[1,0,0]
    v_pk_fma_f32 v[98:99], v[168:169], v[154:155], v[98:99] op_sel_hi:[0,1,1] neg_lo:[1,0,0] neg_hi:[1,0,0]
    v_pk_mul_f32 v[226:227], v[96:97], v[96:97]
    v_pk_mul_f32 v[228:229], v[98:99], v[98:99]
    v_pk_fma_f32 v[226:227], v[226:227], v[188:189], v[188:189] op_sel:[0,1,0] op_sel_hi:[1,1,0]
    v_pk_fma_f32 v[228:229], v[228:229], v[188:189], v[188:189] op_sel:[0,1,0] op_sel_hi:[1,1,0]
    v_pk_mul_f32 v[226:227], v[226:227], v[96:97]
    v_pk_mul_f32 v[228:229], v[228:229], v[98:99]
    v_exp_f32 v226, v226
    v_exp_f32 v227, v227
    v_exp_f32 v228, v228
    v_exp_f32 v229, v229
    v_pk_fma_f32 v[226:227], v[226:227], v[168:169], v[168:169] op_sel:[0,1,1] op_sel_hi:[1,1,1]
    v_pk_fma_f32 v[228:229], v[228:229], v[168:169], v[168:169] op_sel:[0,1,1] op_sel_hi:[1,1,1]
    v_rcp_f32 v226, v226
    v_rcp_f32 v227, v227
    v_rcp_f32 v228, v228
    v_rcp_f32 v229, v229
    v_pk_mul_f32 v[96:97], v[96:97], v[226:227]
    v_pk_mul_f32 v[98:99], v[98:99], v[228:229]
    v_pk_fma_f32 v[100:101], v[168:169], v[156:157], v[100:101] op_sel_hi:[0,1,1] neg_lo:[1,0,0] neg_hi:[1,0,0]
    v_pk_fma_f32 v[102:103], v[168:169], v[158:159], v[102:103] op_sel_hi:[0,1,1] neg_lo:[1,0,0] neg_hi:[1,0,0]
    v_pk_mul_f32 v[226:227], v[100:101], v[100:101]
    v_pk_mul_f32 v[228:229], v[102:103], v[102:103]
    v_pk_fma_f32 v[226:227], v[226:227], v[188:189], v[188:189] op_sel:[0,1,0] op_sel_hi:[1,1,0]
    v_pk_fma_f32 v[228:229], v[228:229], v[188:189], v[188:189] op_sel:[0,1,0] op_sel_hi:[1,1,0]
    v_pk_mul_f32 v[226:227], v[226:227], v[100:101]
    v_pk_mul_f32 v[228:229], v[228:229], v[102:103]
    v_exp_f32 v226, v226
    v_exp_f32 v227, v227
    v_exp_f32 v228, v228
    v_exp_f32 v229, v229
    v_pk_fma_f32 v[226:227], v[226:227], v[168:169], v[168:169] op_sel:[0,1,1] op_sel_hi:[1,1,1]
    v_pk_fma_f32 v[228:229], v[228:229], v[168:169], v[168:169] op_sel:[0,1,1] op_sel_hi:[1,1,1]
    v_rcp_f32 v226, v226
    v_rcp_f32 v227, v227
    v_rcp_f32 v228, v228
    v_rcp_f32 v229, v229
    v_pk_mul_f32 v[100:101], v[100:101], v[226:227]
    v_pk_mul_f32 v[102:103], v[102:103], v[228:229]
    v_cvt_pk_bf16_f32 v208, v96, v97
    v_cvt_pk_bf16_f32 v209, v98, v99
    v_cvt_pk_bf16_f32 v210, v100, v101
    v_cvt_pk_bf16_f32 v211, v102, v103
    ds_write_b128 v12, v[208:211] offset:36864
    v_pk_fma_f32 v[124:125], v[170:171], v[152:153], v[124:125] op_sel_hi:[0,1,1] neg_lo:[1,0,0] neg_hi:[1,0,0]
    v_pk_fma_f32 v[126:127], v[170:171], v[154:155], v[126:127] op_sel_hi:[0,1,1] neg_lo:[1,0,0] neg_hi:[1,0,0]
    v_pk_mul_f32 v[226:227], v[124:125], v[124:125]
    v_pk_mul_f32 v[228:229], v[126:127], v[126:127]
    v_pk_fma_f32 v[226:227], v[226:227], v[190:191], v[190:191] op_sel:[0,1,0] op_sel_hi:[1,1,0]
    v_pk_fma_f32 v[228:229], v[228:229], v[190:191], v[190:191] op_sel:[0,1,0] op_sel_hi:[1,1,0]
    v_pk_mul_f32 v[226:227], v[226:227], v[124:125]
    v_pk_mul_f32 v[228:229], v[228:229], v[126:127]
    v_exp_f32 v226, v226
    v_exp_f32 v227, v227
    v_exp_f32 v228, v228
    v_exp_f32 v229, v229
    v_pk_fma_f32 v[226:227], v[226:227], v[170:171], v[170:171] op_sel:[0,1,1] op_sel_hi:[1,1,1]
    v_pk_fma_f32 v[228:229], v[228:229], v[170:171], v[170:171] op_sel:[0,1,1] op_sel_hi:[1,1,1]
    v_rcp_f32 v226, v226
    v_rcp_f32 v227, v227
    v_rcp_f32 v228, v228
    v_rcp_f32 v229, v229
    v_pk_mul_f32 v[124:125], v[124:125], v[226:227]
    v_pk_mul_f32 v[126:127], v[126:127], v[228:229]
    v_pk_fma_f32 v[128:129], v[170:171], v[156:157], v[128:129] op_sel_hi:[0,1,1] neg_lo:[1,0,0] neg_hi:[1,0,0]
    v_pk_fma_f32 v[130:131], v[170:171], v[158:159], v[130:131] op_sel_hi:[0,1,1] neg_lo:[1,0,0] neg_hi:[1,0,0]
    v_pk_mul_f32 v[226:227], v[128:129], v[128:129]
    v_pk_mul_f32 v[228:229], v[130:131], v[130:131]
    v_pk_fma_f32 v[226:227], v[226:227], v[190:191], v[190:191] op_sel:[0,1,0] op_sel_hi:[1,1,0]
    v_pk_fma_f32 v[228:229], v[228:229], v[190:191], v[190:191] op_sel:[0,1,0] op_sel_hi:[1,1,0]
    v_pk_mul_f32 v[226:227], v[226:227], v[128:129]
    v_pk_mul_f32 v[228:229], v[228:229], v[130:131]
    v_exp_f32 v226, v226
    v_exp_f32 v227, v227
    v_exp_f32 v228, v228
    v_exp_f32 v229, v229
    v_pk_fma_f32 v[226:227], v[226:227], v[170:171], v[170:171] op_sel:[0,1,1] op_sel_hi:[1,1,1]
    v_pk_fma_f32 v[228:229], v[228:229], v[170:171], v[170:171] op_sel:[0,1,1] op_sel_hi:[1,1,1]
    v_rcp_f32 v226, v226
    v_rcp_f32 v227, v227
    v_rcp_f32 v228, v228
    v_rcp_f32 v229, v229
    v_pk_mul_f32 v[128:129], v[128:129], v[226:227]
    v_pk_mul_f32 v[130:131], v[130:131], v[228:229]
    v_cvt_pk_bf16_f32 v212, v124, v125
    v_cvt_pk_bf16_f32 v213, v126, v127
    v_cvt_pk_bf16_f32 v214, v128, v129
    v_cvt_pk_bf16_f32 v215, v130, v131
    ds_write_b128 v12, v[212:215] offset:38912
    v_pk_fma_f32 v[48:49], v[164:165], v[160:161], v[48:49] op_sel_hi:[0,1,1] neg_lo:[1,0,0] neg_hi:[1,0,0]
    v_pk_fma_f32 v[50:51], v[164:165], v[162:163], v[50:51] op_sel_hi:[0,1,1] neg_lo:[1,0,0] neg_hi:[1,0,0]
    v_pk_mul_f32 v[226:227], v[48:49], v[48:49]
    v_pk_mul_f32 v[228:229], v[50:51], v[50:51]
    v_pk_fma_f32 v[226:227], v[226:227], v[184:185], v[184:185] op_sel:[0,1,0] op_sel_hi:[1,1,0]
    v_pk_fma_f32 v[228:229], v[228:229], v[184:185], v[184:185] op_sel:[0,1,0] op_sel_hi:[1,1,0]
    v_pk_mul_f32 v[226:227], v[226:227], v[48:49]
    v_pk_mul_f32 v[228:229], v[228:229], v[50:51]
    v_exp_f32 v226, v226
    v_exp_f32 v227, v227
    v_exp_f32 v228, v228
    v_exp_f32 v229, v229
    v_pk_fma_f32 v[226:227], v[226:227], v[164:165], v[164:165] op_sel:[0,1,1] op_sel_hi:[1,1,1]
    v_pk_fma_f32 v[228:229], v[228:229], v[164:165], v[164:165] op_sel:[0,1,1] op_sel_hi:[1,1,1]
    v_rcp_f32 v226, v226
    v_rcp_f32 v227, v227
    v_rcp_f32 v228, v228
    v_rcp_f32 v229, v229
    v_pk_mul_f32 v[48:49], v[48:49], v[226:227]
    v_pk_mul_f32 v[50:51], v[50:51], v[228:229]
    v_cvt_pk_bf16_f32 v216, v48, v49
    v_cvt_pk_bf16_f32 v217, v50, v51
    s_add_u32 s36, s45, 0
    buffer_store_dwordx4 v[32:35], v2, s[16:19], s36 offen sc1
    v_pk_fma_f32 v[76:77], v[166:167], v[160:161], v[76:77] op_sel_hi:[0,1,1] neg_lo:[1,0,0] neg_hi:[1,0,0]
    v_pk_fma_f32 v[78:79], v[166:167], v[162:163], v[78:79] op_sel_hi:[0,1,1] neg_lo:[1,0,0] neg_hi:[1,0,0]
    v_pk_mul_f32 v[226:227], v[76:77], v[76:77]
    v_pk_mul_f32 v[228:229], v[78:79], v[78:79]
    v_pk_fma_f32 v[226:227], v[226:227], v[186:187], v[186:187] op_sel:[0,1,0] op_sel_hi:[1,1,0]
    v_pk_fma_f32 v[228:229], v[228:229], v[186:187], v[186:187] op_sel:[0,1,0] op_sel_hi:[1,1,0]
    v_pk_mul_f32 v[226:227], v[226:227], v[76:77]
    v_pk_mul_f32 v[228:229], v[228:229], v[78:79]
    v_exp_f32 v226, v226
    v_exp_f32 v227, v227
    v_exp_f32 v228, v228
    v_exp_f32 v229, v229
    v_pk_fma_f32 v[226:227], v[226:227], v[166:167], v[166:167] op_sel:[0,1,1] op_sel_hi:[1,1,1]
    v_pk_fma_f32 v[228:229], v[228:229], v[166:167], v[166:167] op_sel:[0,1,1] op_sel_hi:[1,1,1]
    v_rcp_f32 v226, v226
    v_rcp_f32 v227, v227
    v_rcp_f32 v228, v228
    v_rcp_f32 v229, v229
    v_pk_mul_f32 v[76:77], v[76:77], v[226:227]
    v_pk_mul_f32 v[78:79], v[78:79], v[228:229]
    v_cvt_pk_bf16_f32 v218, v76, v77
    v_cvt_pk_bf16_f32 v219, v78, v79
    s_add_u32 s36, s45, 229376
    buffer_store_dwordx4 v[60:63], v2, s[16:19], s36 offen sc1
    v_pk_fma_f32 v[104:105], v[168:169], v[160:161], v[104:105] op_sel_hi:[0,1,1] neg_lo:[1,0,0] neg_hi:[1,0,0]
    v_pk_fma_f32 v[106:107], v[168:169], v[162:163], v[106:107] op_sel_hi:[0,1,1] neg_lo:[1,0,0] neg_hi:[1,0,0]
    v_pk_mul_f32 v[226:227], v[104:105], v[104:105]
    v_pk_mul_f32 v[228:229], v[106:107], v[106:107]
    v_pk_fma_f32 v[226:227], v[226:227], v[188:189], v[188:189] op_sel:[0,1,0] op_sel_hi:[1,1,0]
    v_pk_fma_f32 v[228:229], v[228:229], v[188:189], v[188:189] op_sel:[0,1,0] op_sel_hi:[1,1,0]
    v_pk_mul_f32 v[226:227], v[226:227], v[104:105]
    v_pk_mul_f32 v[228:229], v[228:229], v[106:107]
    v_exp_f32 v226, v226
    v_exp_f32 v227, v227
    v_exp_f32 v228, v228
    v_exp_f32 v229, v229
    v_pk_fma_f32 v[226:227], v[226:227], v[168:169], v[168:169] op_sel:[0,1,1] op_sel_hi:[1,1,1]
    v_pk_fma_f32 v[228:229], v[228:229], v[168:169], v[168:169] op_sel:[0,1,1] op_sel_hi:[1,1,1]
    v_rcp_f32 v226, v226
    v_rcp_f32 v227, v227
    v_rcp_f32 v228, v228
    v_rcp_f32 v229, v229
    v_pk_mul_f32 v[104:105], v[104:105], v[226:227]
    v_pk_mul_f32 v[106:107], v[106:107], v[228:229]
    v_cvt_pk_bf16_f32 v220, v104, v105
    v_cvt_pk_bf16_f32 v221, v106, v107
    s_add_u32 s36, s45, 458752
    buffer_store_dwordx4 v[88:91], v2, s[16:19], s36 offen sc1
    v_pk_fma_f32 v[132:133], v[170:171], v[160:161], v[132:133] op_sel_hi:[0,1,1] neg_lo:[1,0,0] neg_hi:[1,0,0]
    v_pk_fma_f32 v[134:135], v[170:171], v[162:163], v[134:135] op_sel_hi:[0,1,1] neg_lo:[1,0,0] neg_hi:[1,0,0]
    v_pk_mul_f32 v[226:227], v[132:133], v[132:133]
    v_pk_mul_f32 v[228:229], v[134:135], v[134:135]
    v_pk_fma_f32 v[226:227], v[226:227], v[190:191], v[190:191] op_sel:[0,1,0] op_sel_hi:[1,1,0]
    v_pk_fma_f32 v[228:229], v[228:229], v[190:191], v[190:191] op_sel:[0,1,0] op_sel_hi:[1,1,0]
    v_pk_mul_f32 v[226:227], v[226:227], v[132:133]
    v_pk_mul_f32 v[228:229], v[228:229], v[134:135]
    v_exp_f32 v226, v226
    v_exp_f32 v227, v227
    v_exp_f32 v228, v228
    v_exp_f32 v229, v229
    v_pk_fma_f32 v[226:227], v[226:227], v[170:171], v[170:171] op_sel:[0,1,1] op_sel_hi:[1,1,1]
    v_pk_fma_f32 v[228:229], v[228:229], v[170:171], v[170:171] op_sel:[0,1,1] op_sel_hi:[1,1,1]
    v_rcp_f32 v226, v226
    v_rcp_f32 v227, v227
    v_rcp_f32 v228, v228
    v_rcp_f32 v229, v229
    v_pk_mul_f32 v[132:133], v[132:133], v[226:227]
    v_pk_mul_f32 v[134:135], v[134:135], v[228:229]
    v_cvt_pk_bf16_f32 v222, v132, v133
    v_cvt_pk_bf16_f32 v223, v134, v135
    s_add_u32 s36, s45, 688128
    buffer_store_dwordx4 v[116:119], v2, s[16:19], s36 offen sc1
    s_waitcnt lgkmcnt(0)
    s_mov_b32 s44, s46
    s_mov_b32 s45, s47
    s_branch G3_e2
G3_e1:
    v_pk_fma_f32 v[28:29], v[164:165], v[140:141], v[28:29] op_sel_hi:[0,1,1] neg_lo:[1,0,0] neg_hi:[1,0,0]
    v_pk_fma_f32 v[30:31], v[164:165], v[142:143], v[30:31] op_sel_hi:[0,1,1] neg_lo:[1,0,0] neg_hi:[1,0,0]
    v_pk_mul_f32 v[226:227], v[28:29], v[28:29]
    v_pk_mul_f32 v[228:229], v[30:31], v[30:31]
    v_pk_fma_f32 v[226:227], v[226:227], v[184:185], v[184:185] op_sel:[0,1,0] op_sel_hi:[1,1,0]
    v_pk_fma_f32 v[228:229], v[228:229], v[184:185], v[184:185] op_sel:[0,1,0] op_sel_hi:[1,1,0]
    v_pk_mul_f32 v[226:227], v[226:227], v[28:29]
    v_pk_mul_f32 v[228:229], v[228:229], v[30:31]
    v_exp_f32 v226, v226
    v_exp_f32 v227, v227
    v_exp_f32 v228, v228
    v_exp_f32 v229, v229
    v_pk_fma_f32 v[226:227], v[226:227], v[164:165], v[164:165] op_sel:[0,1,1] op_sel_hi:[1,1,1]
    v_pk_fma_f32 v[228:229], v[228:229], v[164:165], v[164:165] op_sel:[0,1,1] op_sel_hi:[1,1,1]
    v_rcp_f32 v226, v226
    v_rcp_f32 v227, v227
    v_rcp_f32 v228, v228
    v_rcp_f32 v229, v229
    v_pk_mul_f32 v[28:29], v[28:29], v[226:227]
    v_pk_mul_f32 v[30:31], v[30:31], v[228:229]
    v_pk_fma_f32 v[32:33], v[164:165], v[144:145], v[32:33] op_sel_hi:[0,1,1] neg_lo:[1,0,0] neg_hi:[1,0,0]
    v_pk_fma_f32 v[34:35], v[164:165], v[146:147], v[34:35] op_sel_hi:[0,1,1] neg_lo:[1,0,0] neg_hi:[1,0,0]
    v_pk_mul_f32 v[226:227], v[32:33], v[32:33]
    v_pk_mul_f32 v[228:229], v[34:35], v[34:35]
    v_pk_fma_f32 v[226:227], v[226:227], v[184:185], v[184:185] op_sel:[0,1,0] op_sel_hi:[1,1,0]
    v_pk_fma_f32 v[228:229], v[228:229], v[184:185], v[184:185] op_sel:[0,1,0] op_sel_hi:[1,1,0]
    v_pk_mul_f32 v[226:227], v[226:227], v[32:33]
    v_pk_mul_f32 v[228:229], v[228:229], v[34:35]
    v_exp_f32 v226, v226
    v_exp_f32 v227, v227
    v_exp_f32 v228, v228
    v_exp_f32 v229, v229
    v_pk_fma_f32 v[226:227], v[226:227], v[164:165], v[164:165] op_sel:[0,1,1] op_sel_hi:[1,1,1]
    v_pk_fma_f32 v[228:229], v[228:229], v[164:165], v[164:165] op_sel:[0,1,1] op_sel_hi:[1,1,1]
    v_rcp_f32 v226, v226
    v_rcp_f32 v227, v227
    v_rcp_f32 v228, v228
    v_rcp_f32 v229, v229
    v_pk_mul_f32 v[32:33], v[32:33], v[226:227]
    v_pk_mul_f32 v[34:35], v[34:35], v[228:229]
    v_cvt_pk_bf16_f32 v28, v28, v29
    v_cvt_pk_bf16_f32 v29, v30, v31
    v_cvt_pk_bf16_f32 v30, v32, v33
    v_cvt_pk_bf16_f32 v31, v34, v35
    ds_write_b128 v12, v[28:31] offset:0
    s_add_u32 s36, s45, 0
    buffer_store_dwordx4 v[28:31], v2, s[16:19], s36 offen sc1
    v_pk_fma_f32 v[56:57], v[166:167], v[140:141], v[56:57] op_sel_hi:[0,1,1] neg_lo:[1,0,0] neg_hi:[1,0,0]
    v_pk_fma_f32 v[58:59], v[166:167], v[142:143], v[58:59] op_sel_hi:[0,1,1] neg_lo:[1,0,0] neg_hi:[1,0,0]
    v_pk_mul_f32 v[226:227], v[56:57], v[56:57]
    v_pk_mul_f32 v[228:229], v[58:59], v[58:59]
    v_pk_fma_f32 v[226:227], v[226:227], v[186:187], v[186:187] op_sel:[0,1,0] op_sel_hi:[1,1,0]
    v_pk_fma_f32 v[228:229], v[228:229], v[186:187], v[186:187] op_sel:[0,1,0] op_sel_hi:[1,1,0]
    v_pk_mul_f32 v[226:227], v[226:227], v[56:57]
    v_pk_mul_f32 v[228:229], v[228:229], v[58:59]
    v_exp_f32 v226, v226
    v_exp_f32 v227, v227
    v_exp_f32 v228, v228
    v_exp_f32 v229, v229
    v_pk_fma_f32 v[226:227], v[226:227], v[166:167], v[166:167] op_sel:[0,1,1] op_sel_hi:[1,1,1]
    v_pk_fma_f32 v[228:229], v[228:229], v[166:167], v[166:167] op_sel:[0,1,1] op_sel_hi:[1,1,1]
    v_rcp_f32 v226, v226
    v_rcp_f32 v227, v227
    v_rcp_f32 v228, v228
    v_rcp_f32 v229, v229
    v_pk_mul_f32 v[56:57], v[56:57], v[226:227]
    v_pk_mul_f32 v[58:59], v[58:59], v[228:229]
    v_pk_fma_f32 v[60:61], v[166:167], v[144:145], v[60:61] op_sel_hi:[0,1,1] neg_lo:[1,0,0] neg_hi:[1,0,0]
    v_pk_fma_f32 v[62:63], v[166:167], v[146:147], v[62:63] op_sel_hi:[0,1,1] neg_lo:[1,0,0] neg_hi:[1,0,0]
    v_pk_mul_f32 v[226:227], v[60:61], v[60:61]
    v_pk_mul_f32 v[228:229], v[62:63], v[62:63]
    v_pk_fma_f32 v[226:227], v[226:227], v[186:187], v[186:187] op_sel:[0,1,0] op_sel_hi:[1,1,0]
    v_pk_fma_f32 v[228:229], v[228:229], v[186:187], v[186:187] op_sel:[0,1,0] op_sel_hi:[1,1,0]
    v_pk_mul_f32 v[226:227], v[226:227], v[60:61]
    v_pk_mul_f32 v[228:229], v[228:229], v[62:63]
    v_exp_f32 v226, v226
    v_exp_f32 v227, v227
    v_exp_f32 v228, v228
    v_exp_f32 v229, v229
    v_pk_fma_f32 v[226:227], v[226:227], v[166:167], v[166:167] op_sel:[0,1,1] op_sel_hi:[1,1,1]
    v_pk_fma_f32 v[228:229], v[228:229], v[166:167], v[166:167] op_sel:[0,1,1] op_sel_hi:[1,1,1]
    v_rcp_f32 v226, v226
    v_rcp_f32 v227, v227
    v_rcp_f32 v228, v228
    v_rcp_f32 v229, v229
    v_pk_mul_f32 v[60:61], v[60:61], v[226:227]
    v_pk_mul_f32 v[62:63], v[62:63], v[228:229]
    v_cvt_pk_bf16_f32 v56, v56, v57
    v_cvt_pk_bf16_f32 v57, v58, v59
    v_cvt_pk_bf16_f32 v58, v60, v61
    v_cvt_pk_bf16_f32 v59, v62, v63
    ds_write_b128 v12, v[56:59] offset:2048
    s_add_u32 s36, s45, 229376
    buffer_store_dwordx4 v[56:59], v2, s[16:19], s36 offen sc1
    v_pk_fma_f32 v[84:85], v[168:169], v[140:141], v[84:85] op_sel_hi:[0,1,1] neg_lo:[1,0,0] neg_hi:[1,0,0]
    v_pk_fma_f32 v[86:87], v[168:169], v[142:143], v[86:87] op_sel_hi:[0,1,1] neg_lo:[1,0,0] neg_hi:[1,0,0]
    v_pk_mul_f32 v[226:227], v[84:85], v[84:85]
    v_pk_mul_f32 v[228:229], v[86:87], v[86:87]
    v_pk_fma_f32 v[226:227], v[226:227], v[188:189], v[188:189] op_sel:[0,1,0] op_sel_hi:[1,1,0]
    v_pk_fma_f32 v[228:229], v[228:229], v[188:189], v[188:189] op_sel:[0,1,0] op_sel_hi:[1,1,0]
    v_pk_mul_f32 v[226:227], v[226:227], v[84:85]
    v_pk_mul_f32 v[228:229], v[228:229], v[86:87]
    v_exp_f32 v226, v226
    v_exp_f32 v227, v227
    v_exp_f32 v228, v228
    v_exp_f32 v229, v229
    v_pk_fma_f32 v[226:227], v[226:227], v[168:169], v[168:169] op_sel:[0,1,1] op_sel_hi:[1,1,1]
    v_pk_fma_f32 v[228:229], v[228:229], v[168:169], v[168:169] op_sel:[0,1,1] op_sel_hi:[1,1,1]
    v_rcp_f32 v226, v226
    v_rcp_f32 v227, v227
    v_rcp_f32 v228, v228
    v_rcp_f32 v229, v229
    v_pk_mul_f32 v[84:85], v[84:85], v[226:227]
    v_pk_mul_f32 v[86:87], v[86:87], v[228:229]
    v_pk_fma_f32 v[88:89], v[168:169], v[144:145], v[88:89] op_sel_hi:[0,1,1] neg_lo:[1,0,0] neg_hi:[1,0,0]
    v_pk_fma_f32 v[90:91], v[168:169], v[146:147], v[90:91] op_sel_hi:[0,1,1] neg_lo:[1,0,0] neg_hi:[1,0,0]
    v_pk_mul_f32 v[226:227], v[88:89], v[88:89]
    v_pk_mul_f32 v[228:229], v[90:91], v[90:91]
    v_pk_fma_f32 v[226:227], v[226:227], v[188:189], v[188:189] op_sel:[0,1,0] op_sel_hi:[1,1,0]
    v_pk_fma_f32 v[228:229], v[228:229], v[188:189], v[188:189] op_sel:[0,1,0] op_sel_hi:[1,1,0]
    v_pk_mul_f32 v[226:227], v[226:227], v[88:89]
    v_pk_mul_f32 v[228:229], v[228:229], v[90:91]
    v_exp_f32 v226, v226
    v_exp_f32 v227, v227
    v_exp_f32 v228, v228
    v_exp_f32 v229, v229
    v_pk_fma_f32 v[226:227], v[226:227], v[168:169], v[168:169] op_sel:[0,1,1] op_sel_hi:[1,1,1]
    v_pk_fma_f32 v[228:229], v[228:229], v[168:169], v[168:169] op_sel:[0,1,1] op_sel_hi:[1,1,1]
    v_rcp_f32 v226, v226
    v_rcp_f32 v227, v227
    v_rcp_f32 v228, v228
    v_rcp_f32 v229, v229
    v_pk_mul_f32 v[88:89], v[88:89], v[226:227]
    v_pk_mul_f32 v[90:91], v[90:91], v[228:229]
    v_cvt_pk_bf16_f32 v84, v84, v85
    v_cvt_pk_bf16_f32 v85, v86, v87
    v_cvt_pk_bf16_f32 v86, v88, v89
    v_cvt_pk_bf16_f32 v87, v90, v91
    ds_write_b128 v12, v[84:87] offset:4096
    s_add_u32 s36, s45, 458752
    buffer_store_dwordx4 v[84:87], v2, s[16:19], s36 offen sc1
    v_pk_fma_f32 v[112:113], v[170:171], v[140:141], v[112:113] op_sel_hi:[0,1,1] neg_lo:[1,0,0] neg_hi:[1,0,0]
    v_pk_fma_f32 v[114:115], v[170:171], v[142:143], v[114:115] op_sel_hi:[0,1,1] neg_lo:[1,0,0] neg_hi:[1,0,0]
    v_pk_mul_f32 v[226:227], v[112:113], v[112:113]
    v_pk_mul_f32 v[228:229], v[114:115], v[114:115]
    v_pk_fma_f32 v[226:227], v[226:227], v[190:191], v[190:191] op_sel:[0,1,0] op_sel_hi:[1,1,0]
    v_pk_fma_f32 v[228:229], v[228:229], v[190:191], v[190:191] op_sel:[0,1,0] op_sel_hi:[1,1,0]
    v_pk_mul_f32 v[226:227], v[226:227], v[112:113]
    v_pk_mul_f32 v[228:229], v[228:229], v[114:115]
    v_exp_f32 v226, v226
    v_exp_f32 v227, v227
    v_exp_f32 v228, v228
    v_exp_f32 v229, v229
    v_pk_fma_f32 v[226:227], v[226:227], v[170:171], v[170:171] op_sel:[0,1,1] op_sel_hi:[1,1,1]
    v_pk_fma_f32 v[228:229], v[228:229], v[170:171], v[170:171] op_sel:[0,1,1] op_sel_hi:[1,1,1]
    v_rcp_f32 v226, v226
    v_rcp_f32 v227, v227
    v_rcp_f32 v228, v228
    v_rcp_f32 v229, v229
    v_pk_mul_f32 v[112:113], v[112:113], v[226:227]
    v_pk_mul_f32 v[114:115], v[114:115], v[228:229]
    v_pk_fma_f32 v[116:117], v[170:171], v[144:145], v[116:117] op_sel_hi:[0,1,1] neg_lo:[1,0,0] neg_hi:[1,0,0]
    v_pk_fma_f32 v[118:119], v[170:171], v[146:147], v[118:119] op_sel_hi:[0,1,1] neg_lo:[1,0,0] neg_hi:[1,0,0]
    v_pk_mul_f32 v[226:227], v[116:117], v[116:117]
    v_pk_mul_f32 v[228:229], v[118:119], v[118:119]
    v_pk_fma_f32 v[226:227], v[226:227], v[190:191], v[190:191] op_sel:[0,1,0] op_sel_hi:[1,1,0]
    v_pk_fma_f32 v[228:229], v[228:229], v[190:191], v[190:191] op_sel:[0,1,0] op_sel_hi:[1,1,0]
    v_pk_mul_f32 v[226:227], v[226:227], v[116:117]
    v_pk_mul_f32 v[228:229], v[228:229], v[118:119]
    v_exp_f32 v226, v226
    v_exp_f32 v227, v227
    v_exp_f32 v228, v228
    v_exp_f32 v229, v229
    v_pk_fma_f32 v[226:227], v[226:227], v[170:171], v[170:171] op_sel:[0,1,1] op_sel_hi:[1,1,1]
    v_pk_fma_f32 v[228:229], v[228:229], v[170:171], v[170:171] op_sel:[0,1,1] op_sel_hi:[1,1,1]
    v_rcp_f32 v226, v226
    v_rcp_f32 v227, v227
    v_rcp_f32 v228, v228
    v_rcp_f32 v229, v229
    v_pk_mul_f32 v[116:117], v[116:117], v[226:227]
    v_pk_mul_f32 v[118:119], v[118:119], v[228:229]
    v_cvt_pk_bf16_f32 v112, v112, v113
    v_cvt_pk_bf16_f32 v113, v114, v115
    v_cvt_pk_bf16_f32 v114, v116, v117
    v_cvt_pk_bf16_f32 v115, v118, v119
    ds_write_b128 v12, v[112:115] offset:6144
    s_add_u32 s36, s45, 688128
    buffer_store_dwordx4 v[112:115], v2, s[16:19], s36 offen sc1
    v_pk_fma_f32 v[36:37], v[164:165], v[148:149], v[36:37] op_sel_hi:[0,1,1] neg_lo:[1,0,0] neg_hi:[1,0,0]
    v_pk_fma_f32 v[38:39], v[164:165], v[150:151], v[38:39] op_sel_hi:[0,1,1] neg_lo:[1,0,0] neg_hi:[1,0,0]
    v_pk_mul_f32 v[226:227], v[36:37], v[36:37]
    v_pk_mul_f32 v[228:229], v[38:39], v[38:39]
    v_pk_fma_f32 v[226:227], v[226:227], v[184:185], v[184:185] op_sel:[0,1,0] op_sel_hi:[1,1,0]
    v_pk_fma_f32 v[228:229], v[228:229], v[184:185], v[184:185] op_sel:[0,1,0] op_sel_hi:[1,1,0]
    v_pk_mul_f32 v[226:227], v[226:227], v[36:37]
    v_pk_mul_f32 v[228:229], v[228:229], v[38:39]
    v_exp_f32 v226, v226
    v_exp_f32 v227, v227
    v_exp_f32 v228, v228
    v_exp_f32 v229, v229
    v_pk_fma_f32 v[226:227], v[226:227], v[164:165], v[164:165] op_sel:[0,1,1] op_sel_hi:[1,1,1]
    v_pk_fma_f32 v[228:229], v[228:229], v[164:165], v[164:165] op_sel:[0,1,1] op_sel_hi:[1,1,1]
    v_rcp_f32 v226, v226
    v_rcp_f32 v227, v227
    v_rcp_f32 v228, v228
    v_rcp_f32 v229, v229
    v_pk_mul_f32 v[36:37], v[36:37], v[226:227]
    v_pk_mul_f32 v[38:39], v[38:39], v[228:229]
    v_pk_fma_f32 v[40:41], v[164:165], v[152:153], v[40:41] op_sel_hi:[0,1,1] neg_lo:[1,0,0] neg_hi:[1,0,0]
    v_pk_fma_f32 v[42:43], v[164:165], v[154:155], v[42:43] op_sel_hi:[0,1,1] neg_lo:[1,0,0] neg_hi:[1,0,0]
    v_pk_mul_f32 v[226:227], v[40:41], v[40:41]
    v_pk_mul_f32 v[228:229], v[42:43], v[42:43]
    v_pk_fma_f32 v[226:227], v[226:227], v[184:185], v[184:185] op_sel:[0,1,0] op_sel_hi:[1,1,0]
    v_pk_fma_f32 v[228:229], v[228:229], v[184:185], v[184:185] op_sel:[0,1,0] op_sel_hi:[1,1,0]
    v_pk_mul_f32 v[226:227], v[226:227], v[40:41]
    v_pk_mul_f32 v[228:229], v[228:229], v[42:43]
    v_exp_f32 v226, v226
    v_exp_f32 v227, v227
    v_exp_f32 v228, v228
    v_exp_f32 v229, v229
    v_pk_fma_f32 v[226:227], v[226:227], v[164:165], v[164:165] op_sel:[0,1,1] op_sel_hi:[1,1,1]
    v_pk_fma_f32 v[228:229], v[228:229], v[164:165], v[164:165] op_sel:[0,1,1] op_sel_hi:[1,1,1]
    v_rcp_f32 v226, v226
    v_rcp_f32 v227, v227
    v_rcp_f32 v228, v228
    v_rcp_f32 v229, v229
    v_pk_mul_f32 v[40:41], v[40:41], v[226:227]
    v_pk_mul_f32 v[42:43], v[42:43], v[228:229]
    v_cvt_pk_bf16_f32 v36, v36, v37
    v_cvt_pk_bf16_f32 v37, v38, v39
    v_cvt_pk_bf16_f32 v38, v40, v41
    v_cvt_pk_bf16_f32 v39, v42, v43
    ds_write_b128 v12, v[36:39] offset:16384
    s_add_u32 s53, s55, 1792
    s_lshl_b32 s54, s31, 7
    s_add_u32 s53, s53, s54
    v_mov_b32 v8, 1
    v_mov_b32 v9, 162864
    v_mov_b32 v11, 0
    s_mov_b64 exec, 1
    s_waitcnt vmcnt(0)
    ds_add_rtn_u32 v10, v9, v8
    s_waitcnt lgkmcnt(0)
    v_readfirstlane_b32 s54, v10
    s_nop 0
    s_and_b32 s54, s54, 3
    s_cmp_lg_u32 s54, 3
    s_cbranch_scc1 pub_29
    buffer_atomic_add v8, v11, s[56:59], s53 offen sc1
    v_mov_b32 v9, 162872
    ds_add_u32 v9, v8
pub_29:
    s_mov_b64 exec, -1
    v_pk_fma_f32 v[64:65], v[166:167], v[148:149], v[64:65] op_sel_hi:[0,1,1] neg_lo:[1,0,0] neg_hi:[1,0,0]
    v_pk_fma_f32 v[66:67], v[166:167], v[150:151], v[66:67] op_sel_hi:[0,1,1] neg_lo:[1,0,0] neg_hi:[1,0,0]
    v_pk_mul_f32 v[226:227], v[64:65], v[64:65]
    v_pk_mul_f32 v[228:229], v[66:67], v[66:67]
    v_pk_fma_f32 v[226:227], v[226:227], v[186:187], v[186:187] op_sel:[0,1,0] op_sel_hi:[1,1,0]
    v_pk_fma_f32 v[228:229], v[228:229], v[186:187], v[186:187] op_sel:[0,1,0] op_sel_hi:[1,1,0]
    v_pk_mul_f32 v[226:227], v[226:227], v[64:65]
    v_pk_mul_f32 v[228:229], v[228:229], v[66:67]
    v_exp_f32 v226, v226
    v_exp_f32 v227, v227
    v_exp_f32 v228, v228
    v_exp_f32 v229, v229
    v_pk_fma_f32 v[226:227], v[226:227], v[166:167], v[166:167] op_sel:[0,1,1] op_sel_hi:[1,1,1]
    v_pk_fma_f32 v[228:229], v[228:229], v[166:167], v[166:167] op_sel:[0,1,1] op_sel_hi:[1,1,1]
    v_rcp_f32 v226, v226
    v_rcp_f32 v227, v227
    v_rcp_f32 v228, v228
    v_rcp_f32 v229, v229
    v_pk_mul_f32 v[64:65], v[64:65], v[226:227]
    v_pk_mul_f32 v[66:67], v[66:67], v[228:229]
    v_pk_fma_f32 v[68:69], v[166:167], v[152:153], v[68:69] op_sel_hi:[0,1,1] neg_lo:[1,0,0] neg_hi:[1,0,0]
    v_pk_fma_f32 v[70:71], v[166:167], v[154:155], v[70:71] op_sel_hi:[0,1,1] neg_lo:[1,0,0] neg_hi:[1,0,0]
    v_pk_mul_f32 v[226:227], v[68:69], v[68:69]
    v_pk_mul_f32 v[228:229], v[70:71], v[70:71]
    v_pk_fma_f32 v[226:227], v[226:227], v[186:187], v[186:187] op_sel:[0,1,0] op_sel_hi:[1,1,0]
    v_pk_fma_f32 v[228:229], v[228:229], v[186:187], v[186:187] op_sel:[0,1,0] op_sel_hi:[1,1,0]
    v_pk_mul_f32 v[226:227], v[226:227], v[68:69]
    v_pk_mul_f32 v[228:229], v[228:229], v[70:71]
    v_exp_f32 v226, v226
    v_exp_f32 v227, v227
    v_exp_f32 v228, v228
    v_exp_f32 v229, v229
    v_pk_fma_f32 v[226:227], v[226:227], v[166:167], v[166:167] op_sel:[0,1,1] op_sel_hi:[1,1,1]
    v_pk_fma_f32 v[228:229], v[228:229], v[166:167], v[166:167] op_sel:[0,1,1] op_sel_hi:[1,1,1]
    v_rcp_f32 v226, v226
    v_rcp_f32 v227, v227
    v_rcp_f32 v228, v228
    v_rcp_f32 v229, v229
    v_pk_mul_f32 v[68:69], v[68:69], v[226:227]
    v_pk_mul_f32 v[70:71], v[70:71], v[228:229]
    v_cvt_pk_bf16_f32 v64, v64, v65
    v_cvt_pk_bf16_f32 v65, v66, v67
    v_cvt_pk_bf16_f32 v66, v68, v69
    v_cvt_pk_bf16_f32 v67, v70, v71
    ds_write_b128 v12, v[64:67] offset:18432
    v_pk_fma_f32 v[92:93], v[168:169], v[148:149], v[92:93] op_sel_hi:[0,1,1] neg_lo:[1,0,0] neg_hi:[1,0,0]
    v_pk_fma_f32 v[94:95], v[168:169], v[150:151], v[94:95] op_sel_hi:[0,1,1] neg_lo:[1,0,0] neg_hi:[1,0,0]
    v_pk_mul_f32 v[226:227], v[92:93], v[92:93]
    v_pk_mul_f32 v[228:229], v[94:95], v[94:95]
    v_pk_fma_f32 v[226:227], v[226:227], v[188:189], v[188:189] op_sel:[0,1,0] op_sel_hi:[1,1,0]
    v_pk_fma_f32 v[228:229], v[228:229], v[188:189], v[188:189] op_sel:[0,1,0] op_sel_hi:[1,1,0]
    v_pk_mul_f32 v[226:227], v[226:227], v[92:93]
    v_pk_mul_f32 v[228:229], v[228:229], v[94:95]
    v_exp_f32 v226, v226
    v_exp_f32 v227, v227
    v_exp_f32 v228, v228
    v_exp_f32 v229, v229
    v_pk_fma_f32 v[226:227], v[226:227], v[168:169], v[168:169] op_sel:[0,1,1] op_sel_hi:[1,1,1]
    v_pk_fma_f32 v[228:229], v[228:229], v[168:169], v[168:169] op_sel:[0,1,1] op_sel_hi:[1,1,1]
    v_rcp_f32 v226, v226
    v_rcp_f32 v227, v227
    v_rcp_f32 v228, v228
    v_rcp_f32 v229, v229
    v_pk_mul_f32 v[92:93], v[92:93], v[226:227]
    v_pk_mul_f32 v[94:95], v[94:95], v[228:229]
    v_pk_fma_f32 v[96:97], v[168:169], v[152:153], v[96:97] op_sel_hi:[0,1,1] neg_lo:[1,0,0] neg_hi:[1,0,0]
    v_pk_fma_f32 v[98:99], v[168:169], v[154:155], v[98:99] op_sel_hi:[0,1,1] neg_lo:[1,0,0] neg_hi:[1,0,0]
    v_pk_mul_f32 v[226:227], v[96:97], v[96:97]
    v_pk_mul_f32 v[228:229], v[98:99], v[98:99]
    v_pk_fma_f32 v[226:227], v[226:227], v[188:189], v[188:189] op_sel:[0,1,0] op_sel_hi:[1,1,0]
    v_pk_fma_f32 v[228:229], v[228:229], v[188:189], v[188:189] op_sel:[0,1,0] op_sel_hi:[1,1,0]
    v_pk_mul_f32 v[226:227], v[226:227], v[96:97]
    v_pk_mul_f32 v[228:229], v[228:229], v[98:99]
    v_exp_f32 v226, v226
    v_exp_f32 v227, v227
    v_exp_f32 v228, v228
    v_exp_f32 v229, v229
    v_pk_fma_f32 v[226:227], v[226:227], v[168:169], v[168:169] op_sel:[0,1,1] op_sel_hi:[1,1,1]
    v_pk_fma_f32 v[228:229], v[228:229], v[168:169], v[168:169] op_sel:[0,1,1] op_sel_hi:[1,1,1]
    v_rcp_f32 v226, v226
    v_rcp_f32 v227, v227
    v_rcp_f32 v228, v228
    v_rcp_f32 v229, v229
    v_pk_mul_f32 v[96:97], v[96:97], v[226:227]
    v_pk_mul_f32 v[98:99], v[98:99], v[228:229]
    v_cvt_pk_bf16_f32 v92, v92, v93
    v_cvt_pk_bf16_f32 v93, v94, v95
    v_cvt_pk_bf16_f32 v94, v96, v97
    v_cvt_pk_bf16_f32 v95, v98, v99
    ds_write_b128 v12, v[92:95] offset:20480
    v_pk_fma_f32 v[120:121], v[170:171], v[148:149], v[120:121] op_sel_hi:[0,1,1] neg_lo:[1,0,0] neg_hi:[1,0,0]
    v_pk_fma_f32 v[122:123], v[170:171], v[150:151], v[122:123] op_sel_hi:[0,1,1] neg_lo:[1,0,0] neg_hi:[1,0,0]
    v_pk_mul_f32 v[226:227], v[120:121], v[120:121]
    v_pk_mul_f32 v[228:229], v[122:123], v[122:123]
    v_pk_fma_f32 v[226:227], v[226:227], v[190:191], v[190:191] op_sel:[0,1,0] op_sel_hi:[1,1,0]
    v_pk_fma_f32 v[228:229], v[228:229], v[190:191], v[190:191] op_sel:[0,1,0] op_sel_hi:[1,1,0]
    v_pk_mul_f32 v[226:227], v[226:227], v[120:121]
    v_pk_mul_f32 v[228:229], v[228:229], v[122:123]
    v_exp_f32 v226, v226
    v_exp_f32 v227, v227
    v_exp_f32 v228, v228
    v_exp_f32 v229, v229
    v_pk_fma_f32 v[226:227], v[226:227], v[170:171], v[170:171] op_sel:[0,1,1] op_sel_hi:[1,1,1]
    v_pk_fma_f32 v[228:229], v[228:229], v[170:171], v[170:171] op_sel:[0,1,1] op_sel_hi:[1,1,1]
    v_rcp_f32 v226, v226
    v_rcp_f32 v227, v227
    v_rcp_f32 v228, v228
    v_rcp_f32 v229, v229
    v_pk_mul_f32 v[120:121], v[120:121], v[226:227]
    v_pk_mul_f32 v[122:123], v[122:123], v[228:229]
    v_pk_fma_f32 v[124:125], v[170:171], v[152:153], v[124:125] op_sel_hi:[0,1,1] neg_lo:[1,0,0] neg_hi:[1,0,0]
    v_pk_fma_f32 v[126:127], v[170:171], v[154:155], v[126:127] op_sel_hi:[0,1,1] neg_lo:[1,0,0] neg_hi:[1,0,0]
    v_pk_mul_f32 v[226:227], v[124:125], v[124:125]
    v_pk_mul_f32 v[228:229], v[126:127], v[126:127]
    v_pk_fma_f32 v[226:227], v[226:227], v[190:191], v[190:191] op_sel:[0,1,0] op_sel_hi:[1,1,0]
    v_pk_fma_f32 v[228:229], v[228:229], v[190:191], v[190:191] op_sel:[0,1,0] op_sel_hi:[1,1,0]
    v_pk_mul_f32 v[226:227], v[226:227], v[124:125]
    v_pk_mul_f32 v[228:229], v[228:229], v[126:127]
    v_exp_f32 v226, v226
    v_exp_f32 v227, v227
    v_exp_f32 v228, v228
    v_exp_f32 v229, v229
    v_pk_fma_f32 v[226:227], v[226:227], v[170:171], v[170:171] op_sel:[0,1,1] op_sel_hi:[1,1,1]
    v_pk_fma_f32 v[228:229], v[228:229], v[170:171], v[170:171] op_sel:[0,1,1] op_sel_hi:[1,1,1]
    v_rcp_f32 v226, v226
    v_rcp_f32 v227, v227
    v_rcp_f32 v228, v228
    v_rcp_f32 v229, v229
    v_pk_mul_f32 v[124:125], v[124:125], v[226:227]
    v_pk_mul_f32 v[126:127], v[126:127], v[228:229]
    v_cvt_pk_bf16_f32 v120, v120, v121
    v_cvt_pk_bf16_f32 v121, v122, v123
    v_cvt_pk_bf16_f32 v122, v124, v125
    v_cvt_pk_bf16_f32 v123, v126, v127
    ds_write_b128 v12, v[120:123] offset:22528
    v_pk_fma_f32 v[44:45], v[164:165], v[156:157], v[44:45] op_sel_hi:[0,1,1] neg_lo:[1,0,0] neg_hi:[1,0,0]
    v_pk_fma_f32 v[46:47], v[164:165], v[158:159], v[46:47] op_sel_hi:[0,1,1] neg_lo:[1,0,0] neg_hi:[1,0,0]
    v_pk_mul_f32 v[226:227], v[44:45], v[44:45]
    v_pk_mul_f32 v[228:229], v[46:47], v[46:47]
    v_pk_fma_f32 v[226:227], v[226:227], v[184:185], v[184:185] op_sel:[0,1,0] op_sel_hi:[1,1,0]
    v_pk_fma_f32 v[228:229], v[228:229], v[184:185], v[184:185] op_sel:[0,1,0] op_sel_hi:[1,1,0]
    v_pk_mul_f32 v[226:227], v[226:227], v[44:45]
    v_pk_mul_f32 v[228:229], v[228:229], v[46:47]
    v_exp_f32 v226, v226
    v_exp_f32 v227, v227
    v_exp_f32 v228, v228
    v_exp_f32 v229, v229
    v_pk_fma_f32 v[226:227], v[226:227], v[164:165], v[164:165] op_sel:[0,1,1] op_sel_hi:[1,1,1]
    v_pk_fma_f32 v[228:229], v[228:229], v[164:165], v[164:165] op_sel:[0,1,1] op_sel_hi:[1,1,1]
    v_rcp_f32 v226, v226
    v_rcp_f32 v227, v227
    v_rcp_f32 v228, v228
    v_rcp_f32 v229, v229
    v_pk_mul_f32 v[44:45], v[44:45], v[226:227]
    v_pk_mul_f32 v[46:47], v[46:47], v[228:229]
    v_pk_fma_f32 v[48:49], v[164:165], v[160:161], v[48:49] op_sel_hi:[0,1,1] neg_lo:[1,0,0] neg_hi:[1,0,0]
    v_pk_fma_f32 v[50:51], v[164:165], v[162:163], v[50:51] op_sel_hi:[0,1,1] neg_lo:[1,0,0] neg_hi:[1,0,0]
    v_pk_mul_f32 v[226:227], v[48:49], v[48:49]
    v_pk_mul_f32 v[228:229], v[50:51], v[50:51]
    v_pk_fma_f32 v[226:227], v[226:227], v[184:185], v[184:185] op_sel:[0,1,0] op_sel_hi:[1,1,0]
    v_pk_fma_f32 v[228:229], v[228:229], v[184:185], v[184:185] op_sel:[0,1,0] op_sel_hi:[1,1,0]
    v_pk_mul_f32 v[226:227], v[226:227], v[48:49]
    v_pk_mul_f32 v[228:229], v[228:229], v[50:51]
    v_exp_f32 v226, v226
    v_exp_f32 v227, v227
    v_exp_f32 v228, v228
    v_exp_f32 v229, v229
    v_pk_fma_f32 v[226:227], v[226:227], v[164:165], v[164:165] op_sel:[0,1,1] op_sel_hi:[1,1,1]
    v_pk_fma_f32 v[228:229], v[228:229], v[164:165], v[164:165] op_sel:[0,1,1] op_sel_hi:[1,1,1]
    v_rcp_f32 v226, v226
    v_rcp_f32 v227, v227
    v_rcp_f32 v228, v228
    v_rcp_f32 v229, v229
    v_pk_mul_f32 v[48:49], v[48:49], v[226:227]
    v_pk_mul_f32 v[50:51], v[50:51], v[228:229]
    v_cvt_pk_bf16_f32 v200, v44, v45
    v_cvt_pk_bf16_f32 v201, v46, v47
    v_cvt_pk_bf16_f32 v202, v48, v49
    v_cvt_pk_bf16_f32 v203, v50, v51
    ds_write_b128 v12, v[200:203] offset:32768
    v_pk_fma_f32 v[72:73], v[166:167], v[156:157], v[72:73] op_sel_hi:[0,1,1] neg_lo:[1,0,0] neg_hi:[1,0,0]
    v_pk_fma_f32 v[74:75], v[166:167], v[158:159], v[74:75] op_sel_hi:[0,1,1] neg_lo:[1,0,0] neg_hi:[1,0,0]
    v_pk_mul_f32 v[226:227], v[72:73], v[72:73]
    v_pk_mul_f32 v[228:229], v[74:75], v[74:75]
    v_pk_fma_f32 v[226:227], v[226:227], v[186:187], v[186:187] op_sel:[0,1,0] op_sel_hi:[1,1,0]
    v_pk_fma_f32 v[228:229], v[228:229], v[186:187], v[186:187] op_sel:[0,1,0] op_sel_hi:[1,1,0]
    v_pk_mul_f32 v[226:227], v[226:227], v[72:73]
    v_pk_mul_f32 v[228:229], v[228:229], v[74:75]
    v_exp_f32 v226, v226
    v_exp_f32 v227, v227
    v_exp_f32 v228, v228
    v_exp_f32 v229, v229
    v_pk_fma_f32 v[226:227], v[226:227], v[166:167], v[166:167] op_sel:[0,1,1] op_sel_hi:[1,1,1]
    v_pk_fma_f32 v[228:229], v[228:229], v[166:167], v[166:167] op_sel:[0,1,1] op_sel_hi:[1,1,1]
    v_rcp_f32 v226, v226
    v_rcp_f32 v227, v227
    v_rcp_f32 v228, v228
    v_rcp_f32 v229, v229
    v_pk_mul_f32 v[72:73], v[72:73], v[226:227]
    v_pk_mul_f32 v[74:75], v[74:75], v[228:229]
    v_pk_fma_f32 v[76:77], v[166:167], v[160:161], v[76:77] op_sel_hi:[0,1,1] neg_lo:[1,0,0] neg_hi:[1,0,0]
    v_pk_fma_f32 v[78:79], v[166:167], v[162:163], v[78:79] op_sel_hi:[0,1,1] neg_lo:[1,0,0] neg_hi:[1,0,0]
    v_pk_mul_f32 v[226:227], v[76:77], v[76:77]
    v_pk_mul_f32 v[228:229], v[78:79], v[78:79]
    v_pk_fma_f32 v[226:227], v[226:227], v[186:187], v[186:187] op_sel:[0,1,0] op_sel_hi:[1,1,0]
    v_pk_fma_f32 v[228:229], v[228:229], v[186:187], v[186:187] op_sel:[0,1,0] op_sel_hi:[1,1,0]
    v_pk_mul_f32 v[226:227], v[226:227], v[76:77]
    v_pk_mul_f32 v[228:229], v[228:229], v[78:79]
    v_exp_f32 v226, v226
    v_exp_f32 v227, v227
    v_exp_f32 v228, v228
    v_exp_f32 v229, v229
    v_pk_fma_f32 v[226:227], v[226:227], v[166:167], v[166:167] op_sel:[0,1,1] op_sel_hi:[1,1,1]
    v_pk_fma_f32 v[228:229], v[228:229], v[166:167], v[166:167] op_sel:[0,1,1] op_sel_hi:[1,1,1]
    v_rcp_f32 v226, v226
    v_rcp_f32 v227, v227
    v_rcp_f32 v228, v228
    v_rcp_f32 v229, v229
    v_pk_mul_f32 v[76:77], v[76:77], v[226:227]
    v_pk_mul_f32 v[78:79], v[78:79], v[228:229]
    v_cvt_pk_bf16_f32 v204, v72, v73
    v_cvt_pk_bf16_f32 v205, v74, v75
    v_cvt_pk_bf16_f32 v206, v76, v77
    v_cvt_pk_bf16_f32 v207, v78, v79
    ds_write_b128 v12, v[204:207] offset:34816
    v_pk_fma_f32 v[100:101], v[168:169], v[156:157], v[100:101] op_sel_hi:[0,1,1] neg_lo:[1,0,0] neg_hi:[1,0,0]
    v_pk_fma_f32 v[102:103], v[168:169], v[158:159], v[102:103] op_sel_hi:[0,1,1] neg_lo:[1,0,0] neg_hi:[1,0,0]
    v_pk_mul_f32 v[226:227], v[100:101], v[100:101]
    v_pk_mul_f32 v[228:229], v[102:103], v[102:103]
    v_pk_fma_f32 v[226:227], v[226:227], v[188:189], v[188:189] op_sel:[0,1,0] op_sel_hi:[1,1,0]
    v_pk_fma_f32 v[228:229], v[228:229], v[188:189], v[188:189] op_sel:[0,1,0] op_sel_hi:[1,1,0]
    v_pk_mul_f32 v[226:227], v[226:227], v[100:101]
    v_pk_mul_f32 v[228:229], v[228:229], v[102:103]
    v_exp_f32 v226, v226
    v_exp_f32 v227, v227
    v_exp_f32 v228, v228
    v_exp_f32 v229, v229
    v_pk_fma_f32 v[226:227], v[226:227], v[168:169], v[168:169] op_sel:[0,1,1] op_sel_hi:[1,1,1]
    v_pk_fma_f32 v[228:229], v[228:229], v[168:169], v[168:169] op_sel:[0,1,1] op_sel_hi:[1,1,1]
    v_rcp_f32 v226, v226
    v_rcp_f32 v227, v227
    v_rcp_f32 v228, v228
    v_rcp_f32 v229, v229
    v_pk_mul_f32 v[100:101], v[100:101], v[226:227]
    v_pk_mul_f32 v[102:103], v[102:103], v[228:229]
    v_pk_fma_f32 v[104:105], v[168:169], v[160:161], v[104:105] op_sel_hi:[0,1,1] neg_lo:[1,0,0] neg_hi:[1,0,0]
    v_pk_fma_f32 v[106:107], v[168:169], v[162:163], v[106:107] op_sel_hi:[0,1,1] neg_lo:[1,0,0] neg_hi:[1,0,0]
    v_pk_mul_f32 v[226:227], v[104:105], v[104:105]
    v_pk_mul_f32 v[228:229], v[106:107], v[106:107]
    v_pk_fma_f32 v[226:227], v[226:227], v[188:189], v[188:189] op_sel:[0,1,0] op_sel_hi:[1,1,0]
    v_pk_fma_f32 v[228:229], v[228:229], v[188:189], v[188:189] op_sel:[0,1,0] op_sel_hi:[1,1,0]
    v_pk_mul_f32 v[226:227], v[226:227], v[104:105]
    v_pk_mul_f32 v[228:229], v[228:229], v[106:107]
    v_exp_f32 v226, v226
    v_exp_f32 v227, v227
    v_exp_f32 v228, v228
    v_exp_f32 v229, v229
    v_pk_fma_f32 v[226:227], v[226:227], v[168:169], v[168:169] op_sel:[0,1,1] op_sel_hi:[1,1,1]
    v_pk_fma_f32 v[228:229], v[228:229], v[168:169], v[168:169] op_sel:[0,1,1] op_sel_hi:[1,1,1]
    v_rcp_f32 v226, v226
    v_rcp_f32 v227, v227
    v_rcp_f32 v228, v228
    v_rcp_f32 v229, v229
    v_pk_mul_f32 v[104:105], v[104:105], v[226:227]
    v_pk_mul_f32 v[106:107], v[106:107], v[228:229]
    v_cvt_pk_bf16_f32 v208, v100, v101
    v_cvt_pk_bf16_f32 v209, v102, v103
    v_cvt_pk_bf16_f32 v210, v104, v105
    v_cvt_pk_bf16_f32 v211, v106, v107
    ds_write_b128 v12, v[208:211] offset:36864
    v_pk_fma_f32 v[128:129], v[170:171], v[156:157], v[128:129] op_sel_hi:[0,1,1] neg_lo:[1,0,0] neg_hi:[1,0,0]
    v_pk_fma_f32 v[130:131], v[170:171], v[158:159], v[130:131] op_sel_hi:[0,1,1] neg_lo:[1,0,0] neg_hi:[1,0,0]
    v_pk_mul_f32 v[226:227], v[128:129], v[128:129]
    v_pk_mul_f32 v[228:229], v[130:131], v[130:131]
    v_pk_fma_f32 v[226:227], v[226:227], v[190:191], v[190:191] op_sel:[0,1,0] op_sel_hi:[1,1,0]
    v_pk_fma_f32 v[228:229], v[228:229], v[190:191], v[190:191] op_sel:[0,1,0] op_sel_hi:[1,1,0]
    v_pk_mul_f32 v[226:227], v[226:227], v[128:129]
    v_pk_mul_f32 v[228:229], v[228:229], v[130:131]
    v_exp_f32 v226, v226
    v_exp_f32 v227, v227
    v_exp_f32 v228, v228
    v_exp_f32 v229, v229
    v_pk_fma_f32 v[226:227], v[226:227], v[170:171], v[170:171] op_sel:[0,1,1] op_sel_hi:[1,1,1]
    v_pk_fma_f32 v[228:229], v[228:229], v[170:171], v[170:171] op_sel:[0,1,1] op_sel_hi:[1,1,1]
    v_rcp_f32 v226, v226
    v_rcp_f32 v227, v227
    v_rcp_f32 v228, v228
    v_rcp_f32 v229, v229
    v_pk_mul_f32 v[128:129], v[128:129], v[226:227]
    v_pk_mul_f32 v[130:131], v[130:131], v[228:229]
    v_pk_fma_f32 v[132:133], v[170:171], v[160:161], v[132:133] op_sel_hi:[0,1,1] neg_lo:[1,0,0] neg_hi:[1,0,0]
    v_pk_fma_f32 v[134:135], v[170:171], v[162:163], v[134:135] op_sel_hi:[0,1,1] neg_lo:[1,0,0] neg_hi:[1,0,0]
    v_pk_mul_f32 v[226:227], v[132:133], v[132:133]
    v_pk_mul_f32 v[228:229], v[134:135], v[134:135]
    v_pk_fma_f32 v[226:227], v[226:227], v[190:191], v[190:191] op_sel:[0,1,0] op_sel_hi:[1,1,0]
    v_pk_fma_f32 v[228:229], v[228:229], v[190:191], v[190:191] op_sel:[0,1,0] op_sel_hi:[1,1,0]
    v_pk_mul_f32 v[226:227], v[226:227], v[132:133]
    v_pk_mul_f32 v[228:229], v[228:229], v[134:135]
    v_exp_f32 v226, v226
    v_exp_f32 v227, v227
    v_exp_f32 v228, v228
    v_exp_f32 v229, v229
    v_pk_fma_f32 v[226:227], v[226:227], v[170:171], v[170:171] op_sel:[0,1,1] op_sel_hi:[1,1,1]
    v_pk_fma_f32 v[228:229], v[228:229], v[170:171], v[170:171] op_sel:[0,1,1] op_sel_hi:[1,1,1]
    v_rcp_f32 v226, v226
    v_rcp_f32 v227, v227
    v_rcp_f32 v228, v228
    v_rcp_f32 v229, v229
    v_pk_mul_f32 v[132:133], v[132:133], v[226:227]
    v_pk_mul_f32 v[134:135], v[134:135], v[228:229]
    v_cvt_pk_bf16_f32 v212, v128, v129
    v_cvt_pk_bf16_f32 v213, v130, v131
    v_cvt_pk_bf16_f32 v214, v132, v133
    v_cvt_pk_bf16_f32 v215, v134, v135
    ds_write_b128 v12, v[212:215] offset:38912
    v_pk_fma_f32 v[24:25], v[164:165], v[136:137], v[24:25] op_sel_hi:[0,1,1] neg_lo:[1,0,0] neg_hi:[1,0,0]
    v_pk_fma_f32 v[26:27], v[164:165], v[138:139], v[26:27] op_sel_hi:[0,1,1] neg_lo:[1,0,0] neg_hi:[1,0,0]
    v_pk_mul_f32 v[226:227], v[24:25], v[24:25]
    v_pk_mul_f32 v[228:229], v[26:27], v[26:27]
    v_pk_fma_f32 v[226:227], v[226:227], v[184:185], v[184:185] op_sel:[0,1,0] op_sel_hi:[1,1,0]
    v_pk_fma_f32 v[228:229], v[228:229], v[184:185], v[184:185] op_sel:[0,1,0] op_sel_hi:[1,1,0]
    v_pk_mul_f32 v[226:227], v[226:227], v[24:25]
    v_pk_mul_f32 v[228:229], v[228:229], v[26:27]
    v_exp_f32 v226, v226
    v_exp_f32 v227, v227
    v_exp_f32 v228, v228
    v_exp_f32 v229, v229
    v_pk_fma_f32 v[226:227], v[226:227], v[164:165], v[164:165] op_sel:[0,1,1] op_sel_hi:[1,1,1]
    v_pk_fma_f32 v[228:229], v[228:229], v[164:165], v[164:165] op_sel:[0,1,1] op_sel_hi:[1,1,1]
    v_rcp_f32 v226, v226
    v_rcp_f32 v227, v227
    v_rcp_f32 v228, v228
    v_rcp_f32 v229, v229
    v_pk_mul_f32 v[24:25], v[24:25], v[226:227]
    v_pk_mul_f32 v[26:27], v[26:27], v[228:229]
    v_cvt_pk_bf16_f32 v216, v24, v25
    v_cvt_pk_bf16_f32 v217, v26, v27
    s_add_u32 s36, s46, 0
    buffer_store_dwordx4 v[36:39], v2, s[16:19], s36 offen sc1
    v_pk_fma_f32 v[52:53], v[166:167], v[136:137], v[52:53] op_sel_hi:[0,1,1] neg_lo:[1,0,0] neg_hi:[1,0,0]
    v_pk_fma_f32 v[54:55], v[166:167], v[138:139], v[54:55] op_sel_hi:[0,1,1] neg_lo:[1,0,0] neg_hi:[1,0,0]
    v_pk_mul_f32 v[226:227], v[52:53], v[52:53]
    v_pk_mul_f32 v[228:229], v[54:55], v[54:55]
    v_pk_fma_f32 v[226:227], v[226:227], v[186:187], v[186:187] op_sel:[0,1,0] op_sel_hi:[1,1,0]
    v_pk_fma_f32 v[228:229], v[228:229], v[186:187], v[186:187] op_sel:[0,1,0] op_sel_hi:[1,1,0]
    v_pk_mul_f32 v[226:227], v[226:227], v[52:53]
    v_pk_mul_f32 v[228:229], v[228:229], v[54:55]
    v_exp_f32 v226, v226
    v_exp_f32 v227, v227
    v_exp_f32 v228, v228
    v_exp_f32 v229, v229
    v_pk_fma_f32 v[226:227], v[226:227], v[166:167], v[166:167] op_sel:[0,1,1] op_sel_hi:[1,1,1]
    v_pk_fma_f32 v[228:229], v[228:229], v[166:167], v[166:167] op_sel:[0,1,1] op_sel_hi:[1,1,1]
    v_rcp_f32 v226, v226
    v_rcp_f32 v227, v227
    v_rcp_f32 v228, v228
    v_rcp_f32 v229, v229
    v_pk_mul_f32 v[52:53], v[52:53], v[226:227]
    v_pk_mul_f32 v[54:55], v[54:55], v[228:229]
    v_cvt_pk_bf16_f32 v218, v52, v53
    v_cvt_pk_bf16_f32 v219, v54, v55
    s_add_u32 s36, s46, 229376
    buffer_store_dwordx4 v[64:67], v2, s[16:19], s36 offen sc1
    v_pk_fma_f32 v[80:81], v[168:169], v[136:137], v[80:81] op_sel_hi:[0,1,1] neg_lo:[1,0,0] neg_hi:[1,0,0]
    v_pk_fma_f32 v[82:83], v[168:169], v[138:139], v[82:83] op_sel_hi:[0,1,1] neg_lo:[1,0,0] neg_hi:[1,0,0]
    v_pk_mul_f32 v[226:227], v[80:81], v[80:81]
    v_pk_mul_f32 v[228:229], v[82:83], v[82:83]
    v_pk_fma_f32 v[226:227], v[226:227], v[188:189], v[188:189] op_sel:[0,1,0] op_sel_hi:[1,1,0]
    v_pk_fma_f32 v[228:229], v[228:229], v[188:189], v[188:189] op_sel:[0,1,0] op_sel_hi:[1,1,0]
    v_pk_mul_f32 v[226:227], v[226:227], v[80:81]
    v_pk_mul_f32 v[228:229], v[228:229], v[82:83]
    v_exp_f32 v226, v226
    v_exp_f32 v227, v227
    v_exp_f32 v228, v228
    v_exp_f32 v229, v229
    v_pk_fma_f32 v[226:227], v[226:227], v[168:169], v[168:169] op_sel:[0,1,1] op_sel_hi:[1,1,1]
    v_pk_fma_f32 v[228:229], v[228:229], v[168:169], v[168:169] op_sel:[0,1,1] op_sel_hi:[1,1,1]
    v_rcp_f32 v226, v226
    v_rcp_f32 v227, v227
    v_rcp_f32 v228, v228
    v_rcp_f32 v229, v229
    v_pk_mul_f32 v[80:81], v[80:81], v[226:227]
    v_pk_mul_f32 v[82:83], v[82:83], v[228:229]
    v_cvt_pk_bf16_f32 v220, v80, v81
    v_cvt_pk_bf16_f32 v221, v82, v83
    s_add_u32 s36, s46, 458752
    buffer_store_dwordx4 v[92:95], v2, s[16:19], s36 offen sc1
    v_pk_fma_f32 v[108:109], v[170:171], v[136:137], v[108:109] op_sel_hi:[0,1,1] neg_lo:[1,0,0] neg_hi:[1,0,0]
    v_pk_fma_f32 v[110:111], v[170:171], v[138:139], v[110:111] op_sel_hi:[0,1,1] neg_lo:[1,0,0] neg_hi:[1,0,0]
    v_pk_mul_f32 v[226:227], v[108:109], v[108:109]
    v_pk_mul_f32 v[228:229], v[110:111], v[110:111]
    v_pk_fma_f32 v[226:227], v[226:227], v[190:191], v[190:191] op_sel:[0,1,0] op_sel_hi:[1,1,0]
    v_pk_fma_f32 v[228:229], v[228:229], v[190:191], v[190:191] op_sel:[0,1,0] op_sel_hi:[1,1,0]
    v_pk_mul_f32 v[226:227], v[226:227], v[108:109]
    v_pk_mul_f32 v[228:229], v[228:229], v[110:111]
    v_exp_f32 v226, v226
    v_exp_f32 v227, v227
    v_exp_f32 v228, v228
    v_exp_f32 v229, v229
    v_pk_fma_f32 v[226:227], v[226:227], v[170:171], v[170:171] op_sel:[0,1,1] op_sel_hi:[1,1,1]
    v_pk_fma_f32 v[228:229], v[228:229], v[170:171], v[170:171] op_sel:[0,1,1] op_sel_hi:[1,1,1]
    v_rcp_f32 v226, v226
    v_rcp_f32 v227, v227
    v_rcp_f32 v228, v228
    v_rcp_f32 v229, v229
    v_pk_mul_f32 v[108:109], v[108:109], v[226:227]
    v_pk_mul_f32 v[110:111], v[110:111], v[228:229]
    v_cvt_pk_bf16_f32 v222, v108, v109
    v_cvt_pk_bf16_f32 v223, v110, v111
    s_add_u32 s36, s46, 688128
    buffer_store_dwordx4 v[120:123], v2, s[16:19], s36 offen sc1
    s_waitcnt lgkmcnt(0)
    s_add_u32 s45, s44, 512
    s_mov_b32 s44, s47
G3_e2:
    s_lshr_b32 s34, s30, 1
    s_and_b32 s35, s30, 1
    v_and_b32 v22, 15, v1
    v_lshrrev_b32 v23, 4, v1
    s_mul_i32 s37, s34, 4
    s_mul_i32 s38, s33, 8
    s_mul_i32 s36, s35, 4
    s_add_u32 s38, s38, s36
    s_lshr_b32 s36, s38, 1
    s_lshr_b32 s53, s36, 3
    s_lshl_b32 s53, s53, 14
    s_and_b32 s39, s36, 7
    s_lshl_b32 s39, s39, 10
    s_add_u32 s39, s39, s53
    s_lshl_b32 s36, s37, 16
    s_add_u32 s39, s39, s36
    s_mul_i32 s36, s34, 8192
    v_add_u32 v12, s36, v2
    v_lshrrev_b32 v6, 2, v1
    v_mul_u32_u24 v13, 256, v6
    v_and_b32 v7, 3, v1
    v_lshl_add_u32 v13, v7, 3, v13
    v_add_u32 v13, 49152, v13
    v_and_b32 v6, 7, v6
    s_mul_i32 s36, s35, 4
    s_add_u32 s36, s36, 3
    v_xor_b32 v7, s36, v6
    v_lshl_add_u32 v16, v7, 5, v13
    s_mul_i32 s36, s35, 4
    s_add_u32 s36, s36, 2
    v_xor_b32 v7, s36, v6
    v_lshl_add_u32 v15, v7, 5, v13
    s_mul_i32 s36, s35, 4
    s_add_u32 s36, s36, 1
    v_xor_b32 v7, s36, v6
    v_lshl_add_u32 v14, v7, 5, v13
    s_mul_i32 s36, s35, 4
    s_add_u32 s36, s36, 0
    v_xor_b32 v7, s36, v6
    v_lshl_add_u32 v13, v7, 5, v13
    v_pk_mov_b32 v[24:25], 0, 0
    v_pk_mov_b32 v[26:27], 0, 0
    v_pk_mov_b32 v[28:29], 0, 0
    v_pk_mov_b32 v[30:31], 0, 0
    v_pk_mov_b32 v[32:33], 0, 0
    v_pk_mov_b32 v[34:35], 0, 0
    v_pk_mov_b32 v[36:37], 0, 0
    v_pk_mov_b32 v[38:39], 0, 0
    v_pk_mov_b32 v[40:41], 0, 0
    v_pk_mov_b32 v[42:43], 0, 0
    v_pk_mov_b32 v[44:45], 0, 0
    v_pk_mov_b32 v[46:47], 0, 0
    v_pk_mov_b32 v[48:49], 0, 0
    v_pk_mov_b32 v[50:51], 0, 0
    v_pk_mov_b32 v[52:53], 0, 0
    v_pk_mov_b32 v[54:55], 0, 0
    v_pk_mov_b32 v[56:57], 0, 0
    v_pk_mov_b32 v[58:59], 0, 0
    v_pk_mov_b32 v[60:61], 0, 0
    v_pk_mov_b32 v[62:63], 0, 0
    v_pk_mov_b32 v[64:65], 0, 0
    v_pk_mov_b32 v[66:67], 0, 0
    v_pk_mov_b32 v[68:69], 0, 0
    v_pk_mov_b32 v[70:71], 0, 0
    v_pk_mov_b32 v[72:73], 0, 0
    v_pk_mov_b32 v[74:75], 0, 0
    v_pk_mov_b32 v[76:77], 0, 0
    v_pk_mov_b32 v[78:79], 0, 0
    v_pk_mov_b32 v[80:81], 0, 0
    v_pk_mov_b32 v[82:83], 0, 0
    v_pk_mov_b32 v[84:85], 0, 0
    v_pk_mov_b32 v[86:87], 0, 0
    s_mov_b32 s42, 0
    s_mov_b32 s43, 0
    s_mov_b32 s48, 0
    v_mov_b32 v17, v12
    v_add_u32 v18, 0, v13
    v_add_u32 v19, 0, v14
    v_add_u32 v20, 0, v15
    v_add_u32 v21, 0, v16
    s_waitcnt lgkmcnt(0)
    s_barrier
    ds_read_b128 v[88:91], v17 offset:0
    ds_read_b128 v[92:95], v17 offset:2048
    ds_read_b128 v[96:99], v17 offset:4096
    ds_read_b128 v[100:103], v17 offset:6144
    ds_read_b64_tr_b16 v[104:105], v18 offset:0
    ds_read_b64_tr_b16 v[106:107], v18 offset:4096
    ds_read_b64_tr_b16 v[108:109], v19 offset:0
    ds_read_b64_tr_b16 v[110:111], v19 offset:4096
    ds_read_b64_tr_b16 v[112:113], v20 offset:0
    ds_read_b64_tr_b16 v[114:115], v20 offset:4096
    ds_read_b64_tr_b16 v[116:117], v21 offset:0
    ds_read_b64_tr_b16 v[118:119], v21 offset:4096
    s_waitcnt lgkmcnt(0)
    v_mfma_f32_16x16x32_bf16 v[24:27], v[104:107], v[88:91], v[24:27]
    ds_read_b128 v[120:123], v17 offset:1024
    ds_read_b128 v[124:127], v17 offset:3072
    v_mfma_f32_16x16x32_bf16 v[40:43], v[104:107], v[92:95], v[40:43]
    ds_read_b128 v[128:131], v17 offset:5120
    v_mfma_f32_16x16x32_bf16 v[56:59], v[104:107], v[96:99], v[56:59]
    ds_read_b128 v[132:135], v17 offset:7168
    v_mfma_f32_16x16x32_bf16 v[72:75], v[104:107], v[100:103], v[72:75]
    s_add_u32 s36, s44, 0
    buffer_store_dwordx4 v[200:203], v2, s[16:19], s36 offen sc1
    v_mfma_f32_16x16x32_bf16 v[76:79], v[108:111], v[100:103], v[76:79]
    ds_read_b64_tr_b16 v[136:137], v18 offset:8192
    v_mfma_f32_16x16x32_bf16 v[60:63], v[108:111], v[96:99], v[60:63]
    ds_read_b64_tr_b16 v[138:139], v18 offset:12288
    v_mfma_f32_16x16x32_bf16 v[44:47], v[108:111], v[92:95], v[44:47]
    ds_read_b64_tr_b16 v[140:141], v19 offset:8192
    s_add_u32 s36, s45, 0
    buffer_store_dwordx2 v[216:217], v238, s[16:19], s36 offen sc1
    v_mfma_f32_16x16x32_bf16 v[28:31], v[108:111], v[88:91], v[28:31]
    ds_read_b64_tr_b16 v[142:143], v19 offset:12288
    v_mfma_f32_16x16x32_bf16 v[32:35], v[112:115], v[88:91], v[32:35]
    ds_read_b64_tr_b16 v[144:145], v20 offset:8192
    v_mfma_f32_16x16x32_bf16 v[48:51], v[112:115], v[92:95], v[48:51]
    ds_read_b64_tr_b16 v[146:147], v20 offset:12288
    v_mfma_f32_16x16x32_bf16 v[64:67], v[112:115], v[96:99], v[64:67]
    ds_read_b64_tr_b16 v[148:149], v21 offset:8192
    v_mfma_f32_16x16x32_bf16 v[80:83], v[112:115], v[100:103], v[80:83]
    ds_read_b64_tr_b16 v[150:151], v21 offset:12288
    s_add_u32 s42, s42, 16384
    s_cmp_eq_u32 s42, 49152
    s_cselect_b32 s42, 0, s42
    v_mfma_f32_16x16x32_bf16 v[84:87], v[116:119], v[100:103], v[84:87]
    s_add_u32 s48, s48, 16384
    s_cmp_eq_u32 s48, 98304
    s_cselect_b32 s48, 0, s48
    v_mfma_f32_16x16x32_bf16 v[68:71], v[116:119], v[96:99], v[68:71]
    v_add_u32 v17, s42, v12
    v_add_u32 v18, s48, v13
    v_add_u32 v19, s48, v14
    v_mfma_f32_16x16x32_bf16 v[52:55], v[116:119], v[92:95], v[52:55]
    v_add_u32 v20, s48, v15
    v_add_u32 v21, s48, v16
    v_mfma_f32_16x16x32_bf16 v[36:39], v[116:119], v[88:91], v[36:39]
    s_waitcnt lgkmcnt(0)
    s_barrier
    v_mfma_f32_16x16x32_bf16 v[24:27], v[136:139], v[120:123], v[24:27]
    ds_read_b128 v[88:91], v17 offset:0
    ds_read_b128 v[92:95], v17 offset:2048
    v_mfma_f32_16x16x32_bf16 v[40:43], v[136:139], v[124:127], v[40:43]
    ds_read_b128 v[96:99], v17 offset:4096
    v_mfma_f32_16x16x32_bf16 v[56:59], v[136:139], v[128:131], v[56:59]
    ds_read_b128 v[100:103], v17 offset:6144
    v_mfma_f32_16x16x32_bf16 v[72:75], v[136:139], v[132:135], v[72:75]
    s_add_u32 s36, s44, 229376
    buffer_store_dwordx4 v[204:207], v2, s[16:19], s36 offen sc1
    v_mfma_f32_16x16x32_bf16 v[76:79], v[140:143], v[132:135], v[76:79]
    ds_read_b64_tr_b16 v[104:105], v18 offset:0
    v_mfma_f32_16x16x32_bf16 v[60:63], v[140:143], v[128:131], v[60:63]
    ds_read_b64_tr_b16 v[106:107], v18 offset:4096
    v_mfma_f32_16x16x32_bf16 v[44:47], v[140:143], v[124:127], v[44:47]
    ds_read_b64_tr_b16 v[108:109], v19 offset:0
    s_add_u32 s36, s45, 229376
    buffer_store_dwordx2 v[218:219], v238, s[16:19], s36 offen sc1
    v_mfma_f32_16x16x32_bf16 v[28:31], v[140:143], v[120:123], v[28:31]
    ds_read_b64_tr_b16 v[110:111], v19 offset:4096
    v_mfma_f32_16x16x32_bf16 v[32:35], v[144:147], v[120:123], v[32:35]
    ds_read_b64_tr_b16 v[112:113], v20 offset:0
    v_mfma_f32_16x16x32_bf16 v[48:51], v[144:147], v[124:127], v[48:51]
    ds_read_b64_tr_b16 v[114:115], v20 offset:4096
    v_mfma_f32_16x16x32_bf16 v[64:67], v[144:147], v[128:131], v[64:67]
    ds_read_b64_tr_b16 v[116:117], v21 offset:0
    v_mfma_f32_16x16x32_bf16 v[80:83], v[144:147], v[132:135], v[80:83]
    ds_read_b64_tr_b16 v[118:119], v21 offset:4096
    s_add_u32 s43, s43, 1
    v_mfma_f32_16x16x32_bf16 v[84:87], v[148:151], v[132:135], v[84:87]
    s_cmp_lt_u32 s43, 27
    v_mfma_f32_16x16x32_bf16 v[68:71], v[148:151], v[128:131], v[68:71]
    v_mfma_f32_16x16x32_bf16 v[52:55], v[148:151], v[124:127], v[52:55]
    v_mfma_f32_16x16x32_bf16 v[36:39], v[148:151], v[120:123], v[36:39]
    s_waitcnt lgkmcnt(0)
    v_mfma_f32_16x16x32_bf16 v[24:27], v[104:107], v[88:91], v[24:27]
    ds_read_b128 v[120:123], v17 offset:1024
    ds_read_b128 v[124:127], v17 offset:3072
    v_mfma_f32_16x16x32_bf16 v[40:43], v[104:107], v[92:95], v[40:43]
    ds_read_b128 v[128:131], v17 offset:5120
    v_mfma_f32_16x16x32_bf16 v[56:59], v[104:107], v[96:99], v[56:59]
    ds_read_b128 v[132:135], v17 offset:7168
    v_mfma_f32_16x16x32_bf16 v[72:75], v[104:107], v[100:103], v[72:75]
    s_add_u32 s36, s44, 458752
    buffer_store_dwordx4 v[208:211], v2, s[16:19], s36 offen sc1
    v_mfma_f32_16x16x32_bf16 v[76:79], v[108:111], v[100:103], v[76:79]
    ds_read_b64_tr_b16 v[136:137], v18 offset:8192
    v_mfma_f32_16x16x32_bf16 v[60:63], v[108:111], v[96:99], v[60:63]
    ds_read_b64_tr_b16 v[138:139], v18 offset:12288
    v_mfma_f32_16x16x32_bf16 v[44:47], v[108:111], v[92:95], v[44:47]
    ds_read_b64_tr_b16 v[140:141], v19 offset:8192
    s_add_u32 s36, s45, 458752
    buffer_store_dwordx2 v[220:221], v238, s[16:19], s36 offen sc1
    v_mfma_f32_16x16x32_bf16 v[28:31], v[108:111], v[88:91], v[28:31]
    ds_read_b64_tr_b16 v[142:143], v19 offset:12288
    v_mfma_f32_16x16x32_bf16 v[32:35], v[112:115], v[88:91], v[32:35]
    ds_read_b64_tr_b16 v[144:145], v20 offset:8192
    v_mfma_f32_16x16x32_bf16 v[48:51], v[112:115], v[92:95], v[48:51]
    ds_read_b64_tr_b16 v[146:147], v20 offset:12288
    v_mfma_f32_16x16x32_bf16 v[64:67], v[112:115], v[96:99], v[64:67]
    ds_read_b64_tr_b16 v[148:149], v21 offset:8192
    v_mfma_f32_16x16x32_bf16 v[80:83], v[112:115], v[100:103], v[80:83]
    ds_read_b64_tr_b16 v[150:151], v21 offset:12288
    s_add_u32 s42, s42, 16384
    s_cmp_eq_u32 s42, 49152
    s_cselect_b32 s42, 0, s42
    v_mfma_f32_16x16x32_bf16 v[84:87], v[116:119], v[100:103], v[84:87]
    s_add_u32 s48, s48, 16384
    s_cmp_eq_u32 s48, 98304
    s_cselect_b32 s48, 0, s48
    v_mfma_f32_16x16x32_bf16 v[68:71], v[116:119], v[96:99], v[68:71]
    v_add_u32 v17, s42, v12
    v_add_u32 v18, s48, v13
    v_add_u32 v19, s48, v14
    v_mfma_f32_16x16x32_bf16 v[52:55], v[116:119], v[92:95], v[52:55]
    v_add_u32 v20, s48, v15
    v_add_u32 v21, s48, v16
    v_mfma_f32_16x16x32_bf16 v[36:39], v[116:119], v[88:91], v[36:39]
    s_waitcnt lgkmcnt(0)
    s_barrier
    v_mfma_f32_16x16x32_bf16 v[24:27], v[136:139], v[120:123], v[24:27]
    ds_read_b128 v[88:91], v17 offset:0
    ds_read_b128 v[92:95], v17 offset:2048
    v_mfma_f32_16x16x32_bf16 v[40:43], v[136:139], v[124:127], v[40:43]
    ds_read_b128 v[96:99], v17 offset:4096
    v_mfma_f32_16x16x32_bf16 v[56:59], v[136:139], v[128:131], v[56:59]
    ds_read_b128 v[100:103], v17 offset:6144
    v_mfma_f32_16x16x32_bf16 v[72:75], v[136:139], v[132:135], v[72:75]
    s_add_u32 s36, s44, 688128
    buffer_store_dwordx4 v[212:215], v2, s[16:19], s36 offen sc1
    v_mfma_f32_16x16x32_bf16 v[76:79], v[140:143], v[132:135], v[76:79]
    ds_read_b64_tr_b16 v[104:105], v18 offset:0
    v_mfma_f32_16x16x32_bf16 v[60:63], v[140:143], v[128:131], v[60:63]
    ds_read_b64_tr_b16 v[106:107], v18 offset:4096
    v_mfma_f32_16x16x32_bf16 v[44:47], v[140:143], v[124:127], v[44:47]
    ds_read_b64_tr_b16 v[108:109], v19 offset:0
    s_add_u32 s36, s45, 688128
    buffer_store_dwordx2 v[222:223], v238, s[16:19], s36 offen sc1
    v_mfma_f32_16x16x32_bf16 v[28:31], v[140:143], v[120:123], v[28:31]
    ds_read_b64_tr_b16 v[110:111], v19 offset:4096
    v_mfma_f32_16x16x32_bf16 v[32:35], v[144:147], v[120:123], v[32:35]
    ds_read_b64_tr_b16 v[112:113], v20 offset:0
    v_mfma_f32_16x16x32_bf16 v[48:51], v[144:147], v[124:127], v[48:51]
    ds_read_b64_tr_b16 v[114:115], v20 offset:4096
    v_mfma_f32_16x16x32_bf16 v[64:67], v[144:147], v[128:131], v[64:67]
    ds_read_b64_tr_b16 v[116:117], v21 offset:0
    v_mfma_f32_16x16x32_bf16 v[80:83], v[144:147], v[132:135], v[80:83]
    ds_read_b64_tr_b16 v[118:119], v21 offset:4096
    s_add_u32 s43, s43, 1
    v_mfma_f32_16x16x32_bf16 v[84:87], v[148:151], v[132:135], v[84:87]
    s_cmp_lt_u32 s43, 27
    v_mfma_f32_16x16x32_bf16 v[68:71], v[148:151], v[128:131], v[68:71]
    v_mfma_f32_16x16x32_bf16 v[52:55], v[148:151], v[124:127], v[52:55]
    v_mfma_f32_16x16x32_bf16 v[36:39], v[148:151], v[120:123], v[36:39]
    s_add_u32 s53, s55, 1536
    s_lshl_b32 s54, s31, 7
    s_add_u32 s53, s53, s54
    v_mov_b32 v8, 1
    v_mov_b32 v9, 162816
    v_mov_b32 v11, 0
    s_mov_b64 exec, 1
    s_waitcnt vmcnt(8)
    ds_add_rtn_u32 v10, v9, v8
    s_waitcnt lgkmcnt(0)
    v_readfirstlane_b32 s54, v10
    s_nop 0
    s_and_b32 s54, s54, 3
    s_cmp_lg_u32 s54, 3
    s_cbranch_scc1 pub_30
    buffer_atomic_add v8, v11, s[56:59], s53 offen sc1
pub_30:
    s_mov_b64 exec, -1
mm_31:
    s_waitcnt lgkmcnt(0)
    v_mfma_f32_16x16x32_bf16 v[24:27], v[104:107], v[88:91], v[24:27]
    ds_read_b128 v[120:123], v17 offset:1024
    v_mfma_f32_16x16x32_bf16 v[40:43], v[104:107], v[92:95], v[40:43]
    ds_read_b128 v[124:127], v17 offset:3072
    v_mfma_f32_16x16x32_bf16 v[56:59], v[104:107], v[96:99], v[56:59]
    ds_read_b128 v[128:131], v17 offset:5120
    v_mfma_f32_16x16x32_bf16 v[72:75], v[104:107], v[100:103], v[72:75]
    ds_read_b128 v[132:135], v17 offset:7168
    v_mfma_f32_16x16x32_bf16 v[76:79], v[108:111], v[100:103], v[76:79]
    ds_read_b64_tr_b16 v[136:137], v18 offset:8192
    v_mfma_f32_16x16x32_bf16 v[60:63], v[108:111], v[96:99], v[60:63]
    ds_read_b64_tr_b16 v[138:139], v18 offset:12288
    v_mfma_f32_16x16x32_bf16 v[44:47], v[108:111], v[92:95], v[44:47]
    ds_read_b64_tr_b16 v[140:141], v19 offset:8192
    v_mfma_f32_16x16x32_bf16 v[28:31], v[108:111], v[88:91], v[28:31]
    ds_read_b64_tr_b16 v[142:143], v19 offset:12288
    v_mfma_f32_16x16x32_bf16 v[32:35], v[112:115], v[88:91], v[32:35]
    ds_read_b64_tr_b16 v[144:145], v20 offset:8192
    v_mfma_f32_16x16x32_bf16 v[48:51], v[112:115], v[92:95], v[48:51]
    ds_read_b64_tr_b16 v[146:147], v20 offset:12288
    v_mfma_f32_16x16x32_bf16 v[64:67], v[112:115], v[96:99], v[64:67]
    ds_read_b64_tr_b16 v[148:149], v21 offset:8192
    v_mfma_f32_16x16x32_bf16 v[80:83], v[112:115], v[100:103], v[80:83]
    ds_read_b64_tr_b16 v[150:151], v21 offset:12288
    s_add_u32 s42, s42, 16384
    s_cmp_eq_u32 s42, 49152
    s_cselect_b32 s42, 0, s42
    v_mfma_f32_16x16x32_bf16 v[84:87], v[116:119], v[100:103], v[84:87]
    s_add_u32 s48, s48, 16384
    s_cmp_eq_u32 s48, 98304
    s_cselect_b32 s48, 0, s48
    v_mfma_f32_16x16x32_bf16 v[68:71], v[116:119], v[96:99], v[68:71]
    v_add_u32 v17, s42, v12
    v_add_u32 v18, s48, v13
    v_add_u32 v19, s48, v14
    v_mfma_f32_16x16x32_bf16 v[52:55], v[116:119], v[92:95], v[52:55]
    v_add_u32 v20, s48, v15
    v_add_u32 v21, s48, v16
    v_mfma_f32_16x16x32_bf16 v[36:39], v[116:119], v[88:91], v[36:39]
    s_waitcnt lgkmcnt(0)
    s_barrier
    v_mfma_f32_16x16x32_bf16 v[24:27], v[136:139], v[120:123], v[24:27]
    ds_read_b128 v[88:91], v17 offset:0
    v_mfma_f32_16x16x32_bf16 v[40:43], v[136:139], v[124:127], v[40:43]
    ds_read_b128 v[92:95], v17 offset:2048
    v_mfma_f32_16x16x32_bf16 v[56:59], v[136:139], v[128:131], v[56:59]
    ds_read_b128 v[96:99], v17 offset:4096
    v_mfma_f32_16x16x32_bf16 v[72:75], v[136:139], v[132:135], v[72:75]
    ds_read_b128 v[100:103], v17 offset:6144
    v_mfma_f32_16x16x32_bf16 v[76:79], v[140:143], v[132:135], v[76:79]
    ds_read_b64_tr_b16 v[104:105], v18 offset:0
    v_mfma_f32_16x16x32_bf16 v[60:63], v[140:143], v[128:131], v[60:63]
    ds_read_b64_tr_b16 v[106:107], v18 offset:4096
    v_mfma_f32_16x16x32_bf16 v[44:47], v[140:143], v[124:127], v[44:47]
    ds_read_b64_tr_b16 v[108:109], v19 offset:0
    v_mfma_f32_16x16x32_bf16 v[28:31], v[140:143], v[120:123], v[28:31]
    ds_read_b64_tr_b16 v[110:111], v19 offset:4096
    v_mfma_f32_16x16x32_bf16 v[32:35], v[144:147], v[120:123], v[32:35]
    ds_read_b64_tr_b16 v[112:113], v20 offset:0
    v_mfma_f32_16x16x32_bf16 v[48:51], v[144:147], v[124:127], v[48:51]
    ds_read_b64_tr_b16 v[114:115], v20 offset:4096
    v_mfma_f32_16x16x32_bf16 v[64:67], v[144:147], v[128:131], v[64:67]
    ds_read_b64_tr_b16 v[116:117], v21 offset:0
    v_mfma_f32_16x16x32_bf16 v[80:83], v[144:147], v[132:135], v[80:83]
    ds_read_b64_tr_b16 v[118:119], v21 offset:4096
    s_add_u32 s43, s43, 1
    v_mfma_f32_16x16x32_bf16 v[84:87], v[148:151], v[132:135], v[84:87]
    s_cmp_lt_u32 s43, 4
    v_mfma_f32_16x16x32_bf16 v[68:71], v[148:151], v[128:131], v[68:71]
    v_mfma_f32_16x16x32_bf16 v[52:55], v[148:151], v[124:127], v[52:55]
    v_mfma_f32_16x16x32_bf16 v[36:39], v[148:151], v[120:123], v[36:39]
    s_cbranch_scc1 mm_31
    s_add_u32 s53, s55, 768
    s_lshl_b32 s54, s31, 7
    s_add_u32 s53, s53, s54
    v_mov_b32 v8, 1
    v_mov_b32 v9, 162816
    v_mov_b32 v11, 0
    s_mov_b64 exec, 1
    s_waitcnt vmcnt(0)
    ds_add_rtn_u32 v10, v9, v8
    s_waitcnt lgkmcnt(0)
    v_readfirstlane_b32 s54, v10
    s_nop 0
    s_and_b32 s54, s54, 3
    s_cmp_lg_u32 s54, 3
    s_cbranch_scc1 pub_32
    buffer_atomic_add v8, v11, s[56:59], s53 offen sc1
pub_32:
    s_mov_b64 exec, -1
mm_33:
    s_waitcnt lgkmcnt(0)
    v_mfma_f32_16x16x32_bf16 v[24:27], v[104:107], v[88:91], v[24:27]
    ds_read_b128 v[120:123], v17 offset:1024
    v_mfma_f32_16x16x32_bf16 v[40:43], v[104:107], v[92:95], v[40:43]
    ds_read_b128 v[124:127], v17 offset:3072
    v_mfma_f32_16x16x32_bf16 v[56:59], v[104:107], v[96:99], v[56:59]
    ds_read_b128 v[128:131], v17 offset:5120
    v_mfma_f32_16x16x32_bf16 v[72:75], v[104:107], v[100:103], v[72:75]
    ds_read_b128 v[132:135], v17 offset:7168
    v_mfma_f32_16x16x32_bf16 v[76:79], v[108:111], v[100:103], v[76:79]
    ds_read_b64_tr_b16 v[136:137], v18 offset:8192
    v_mfma_f32_16x16x32_bf16 v[60:63], v[108:111], v[96:99], v[60:63]
    ds_read_b64_tr_b16 v[138:139], v18 offset:12288
    v_mfma_f32_16x16x32_bf16 v[44:47], v[108:111], v[92:95], v[44:47]
    ds_read_b64_tr_b16 v[140:141], v19 offset:8192
    v_mfma_f32_16x16x32_bf16 v[28:31], v[108:111], v[88:91], v[28:31]
    ds_read_b64_tr_b16 v[142:143], v19 offset:12288
    v_mfma_f32_16x16x32_bf16 v[32:35], v[112:115], v[88:91], v[32:35]
    ds_read_b64_tr_b16 v[144:145], v20 offset:8192
    v_mfma_f32_16x16x32_bf16 v[48:51], v[112:115], v[92:95], v[48:51]
    ds_read_b64_tr_b16 v[146:147], v20 offset:12288
    v_mfma_f32_16x16x32_bf16 v[64:67], v[112:115], v[96:99], v[64:67]
    ds_read_b64_tr_b16 v[148:149], v21 offset:8192
    v_mfma_f32_16x16x32_bf16 v[80:83], v[112:115], v[100:103], v[80:83]
    ds_read_b64_tr_b16 v[150:151], v21 offset:12288
    s_add_u32 s42, s42, 16384
    s_cmp_eq_u32 s42, 49152
    s_cselect_b32 s42, 0, s42
    v_mfma_f32_16x16x32_bf16 v[84:87], v[116:119], v[100:103], v[84:87]
    s_add_u32 s48, s48, 16384
    s_cmp_eq_u32 s48, 98304
    s_cselect_b32 s48, 0, s48
    v_mfma_f32_16x16x32_bf16 v[68:71], v[116:119], v[96:99], v[68:71]
    v_add_u32 v17, s42, v12
    v_add_u32 v18, s48, v13
    v_add_u32 v19, s48, v14
    v_mfma_f32_16x16x32_bf16 v[52:55], v[116:119], v[92:95], v[52:55]
    v_add_u32 v20, s48, v15
    v_add_u32 v21, s48, v16
    v_mfma_f32_16x16x32_bf16 v[36:39], v[116:119], v[88:91], v[36:39]
    s_waitcnt lgkmcnt(0)
    s_barrier
    v_mfma_f32_16x16x32_bf16 v[24:27], v[136:139], v[120:123], v[24:27]
    ds_read_b128 v[88:91], v17 offset:0
    v_mfma_f32_16x16x32_bf16 v[40:43], v[136:139], v[124:127], v[40:43]
    ds_read_b128 v[92:95], v17 offset:2048
    v_mfma_f32_16x16x32_bf16 v[56:59], v[136:139], v[128:131], v[56:59]
    ds_read_b128 v[96:99], v17 offset:4096
    v_mfma_f32_16x16x32_bf16 v[72:75], v[136:139], v[132:135], v[72:75]
    ds_read_b128 v[100:103], v17 offset:6144
    v_mfma_f32_16x16x32_bf16 v[76:79], v[140:143], v[132:135], v[76:79]
    ds_read_b64_tr_b16 v[104:105], v18 offset:0
    v_mfma_f32_16x16x32_bf16 v[60:63], v[140:143], v[128:131], v[60:63]
    ds_read_b64_tr_b16 v[106:107], v18 offset:4096
    v_mfma_f32_16x16x32_bf16 v[44:47], v[140:143], v[124:127], v[44:47]
    ds_read_b64_tr_b16 v[108:109], v19 offset:0
    v_mfma_f32_16x16x32_bf16 v[28:31], v[140:143], v[120:123], v[28:31]
    ds_read_b64_tr_b16 v[110:111], v19 offset:4096
    v_mfma_f32_16x16x32_bf16 v[32:35], v[144:147], v[120:123], v[32:35]
    ds_read_b64_tr_b16 v[112:113], v20 offset:0
    v_mfma_f32_16x16x32_bf16 v[48:51], v[144:147], v[124:127], v[48:51]
    ds_read_b64_tr_b16 v[114:115], v20 offset:4096
    v_mfma_f32_16x16x32_bf16 v[64:67], v[144:147], v[128:131], v[64:67]
    ds_read_b64_tr_b16 v[116:117], v21 offset:0
    v_mfma_f32_16x16x32_bf16 v[80:83], v[144:147], v[132:135], v[80:83]
    ds_read_b64_tr_b16 v[118:119], v21 offset:4096
    s_add_u32 s43, s43, 1
    v_mfma_f32_16x16x32_bf16 v[84:87], v[148:151], v[132:135], v[84:87]
    s_cmp_lt_u32 s43, 27
    v_mfma_f32_16x16x32_bf16 v[68:71], v[148:151], v[128:131], v[68:71]
    v_mfma_f32_16x16x32_bf16 v[52:55], v[148:151], v[124:127], v[52:55]
    v_mfma_f32_16x16x32_bf16 v[36:39], v[148:151], v[120:123], v[36:39]
    s_cbranch_scc1 mm_33
    s_waitcnt lgkmcnt(0)
    s_cmp_eq_u32 s60, 1
    s_cbranch_scc1 G4_last
    v_mfma_f32_16x16x32_bf16 v[24:27], v[104:107], v[88:91], v[24:27]
    ds_read_b128 v[120:123], v17 offset:1024
    ds_read_b128 v[124:127], v17 offset:3072
    ds_read_b128 v[128:131], v17 offset:5120
    ds_read_b128 v[132:135], v17 offset:7168
    ds_read_b64_tr_b16 v[136:137], v18 offset:8192
    ds_read_b64_tr_b16 v[138:139], v18 offset:12288
    v_mfma_f32_16x16x32_bf16 v[40:43], v[104:107], v[92:95], v[40:43]
    ds_read_b64_tr_b16 v[140:141], v19 offset:8192
    ds_read_b64_tr_b16 v[142:143], v19 offset:12288
    ds_read_b64_tr_b16 v[144:145], v20 offset:8192
    ds_read_b64_tr_b16 v[146:147], v20 offset:12288
    ds_read_b64_tr_b16 v[148:149], v21 offset:8192
    v_mfma_f32_16x16x32_bf16 v[56:59], v[104:107], v[96:99], v[56:59]
    ds_read_b64_tr_b16 v[150:151], v21 offset:12288
    v_and_b32 v179, 7, v0
    v_lshrrev_b32 v204, 6, v0
    v_lshlrev_b32 v204, 4, v204
    v_bfe_u32 v205, v0, 3, 3
    v_mfma_f32_16x16x32_bf16 v[72:75], v[104:107], v[100:103], v[72:75]
    v_add_u32 v204, v204, v205
    s_lshr_b32 s78, s29, 1
    s_lshl_b32 s78, s78, 16
    s_and_b32 s79, s29, 1
    s_lshl_b32 s79, s79, 7
    s_add_u32 s78, s78, s79
    v_mfma_f32_16x16x32_bf16 v[76:79], v[108:111], v[100:103], v[76:79]
    s_lshr_b32 s79, s30, 1
    s_lshl_b32 s79, s79, 13
    s_add_u32 s78, s78, s79
    v_lshlrev_b32 v176, 8, v204
    v_lshl_add_u32 v176, v179, 4, v176
    v_mfma_f32_16x16x32_bf16 v[60:63], v[108:111], v[96:99], v[60:63]
    v_add_u32 v176, s78, v176
    s_lshl_b32 s78, s28, 7
    s_lshl_b32 s79, s29, 3
    s_add_u32 s78, s78, s79
    v_add_u32 v177, s78, v179
    v_mfma_f32_16x16x32_bf16 v[44:47], v[108:111], v[92:95], v[44:47]
    v_lshlrev_b32 v178, 11, v177
    v_lshrrev_b32 v205, 2, v204
    v_lshlrev_b32 v205, 3, v205
    v_and_b32 v204, 3, v204
    v_add_u32 v204, v204, v205
    v_lshl_add_u32 v178, v204, 3, v178
    v_mfma_f32_16x16x32_bf16 v[28:31], v[108:111], v[88:91], v[28:31]
    v_lshlrev_b32 v177, 3, v177
    v_lshl_add_u32 v177, v204, 14, v177
    s_add_u32 s84, s62, 0x400000
    s_addc_u32 s85, s63, 0
    s_mov_b32 s86, 0x7e000
    v_mfma_f32_16x16x32_bf16 v[32:35], v[112:115], v[88:91], v[32:35]
    s_mov_b32 s87, 0x20000
    s_add_u32 s88, s62, 0x480000
    s_addc_u32 s89, s63, 0
    s_mov_b32 s90, 0x7e000
    s_mov_b32 s91, 0x20000
    v_mfma_f32_16x16x32_bf16 v[48:51], v[112:115], v[92:95], v[48:51]
    buffer_load_dwordx4 v[180:183], v176, s[84:87], 0 offen offset:0 sc1
    buffer_load_dwordx4 v[188:191], v176, s[88:91], 0 offen offset:0 sc1
    buffer_load_dwordx4 v[184:187], v176, s[84:87], 0 offen offset:2048 sc1
    buffer_load_dwordx4 v[192:195], v176, s[88:91], 0 offen offset:2048 sc1
    s_add_u32 s80, s4, 0x1c00000
    s_addc_u32 s81, s5, 0
    v_mfma_f32_16x16x32_bf16 v[64:67], v[112:115], v[96:99], v[64:67]
    s_mov_b32 s82, 0x400000
    s_mov_b32 s83, 0x20000
    s_mov_b32 s78, 0
    buffer_load_dwordx2 v[196:197], v177, s[80:83], s78 offen sc1
    s_mov_b32 s78, 65536
    v_mfma_f32_16x16x32_bf16 v[80:83], v[112:115], v[100:103], v[80:83]
    buffer_load_dwordx2 v[198:199], v177, s[80:83], s78 offen sc1
    s_mov_b32 s78, 262144
    buffer_load_dwordx2 v[200:201], v177, s[80:83], s78 offen sc1
    s_mov_b32 s78, 327680
    buffer_load_dwordx2 v[202:203], v177, s[80:83], s78 offen sc1
    v_mfma_f32_16x16x32_bf16 v[84:87], v[116:119], v[100:103], v[84:87]
    v_mfma_f32_16x16x32_bf16 v[68:71], v[116:119], v[96:99], v[68:71]
    v_mfma_f32_16x16x32_bf16 v[52:55], v[116:119], v[92:95], v[52:55]
    v_mfma_f32_16x16x32_bf16 v[36:39], v[116:119], v[88:91], v[36:39]
    s_waitcnt lgkmcnt(0)
    v_mfma_f32_16x16x32_bf16 v[24:27], v[136:139], v[120:123], v[24:27]
    s_mul_i32 s36, s31, 524288
    v_mfma_f32_16x16x32_bf16 v[40:43], v[136:139], v[124:127], v[40:43]
    v_mfma_f32_16x16x32_bf16 v[56:59], v[136:139], v[128:131], v[56:59]
    s_add_u32 s36, s36, 5242880
    v_mfma_f32_16x16x32_bf16 v[72:75], v[136:139], v[132:135], v[72:75]
    v_mfma_f32_16x16x32_bf16 v[76:79], v[140:143], v[132:135], v[76:79]
    s_add_u32 s16, s62, s36
    v_mfma_f32_16x16x32_bf16 v[60:63], v[140:143], v[128:131], v[60:63]
    v_mfma_f32_16x16x32_bf16 v[44:47], v[140:143], v[124:127], v[44:47]
    s_addc_u32 s17, s63, 0
    v_mfma_f32_16x16x32_bf16 v[28:31], v[140:143], v[120:123], v[28:31]
    v_mfma_f32_16x16x32_bf16 v[32:35], v[144:147], v[120:123], v[32:35]
    s_mov_b32 s18, 516096
    v_mfma_f32_16x16x32_bf16 v[48:51], v[144:147], v[124:127], v[48:51]
    v_mfma_f32_16x16x32_bf16 v[64:67], v[144:147], v[128:131], v[64:67]
    s_mov_b32 s19, 0x20000
    v_mfma_f32_16x16x32_bf16 v[80:83], v[144:147], v[132:135], v[80:83]
    v_mfma_f32_16x16x32_bf16 v[84:87], v[148:151], v[132:135], v[84:87]
    v_mfma_f32_16x16x32_bf16 v[68:71], v[148:151], v[128:131], v[68:71]
    v_mfma_f32_16x16x32_bf16 v[52:55], v[148:151], v[124:127], v[52:55]
    v_mfma_f32_16x16x32_bf16 v[36:39], v[148:151], v[120:123], v[36:39]
    s_add_u32 s36, s39, 0
    v_cvt_pk_bf16_f32 v24, v24, v25
    v_cvt_pk_bf16_f32 v25, v26, v27
    v_cvt_pk_bf16_f32 v26, v28, v29
    v_cvt_pk_bf16_f32 v27, v30, v31
    buffer_store_dwordx4 v[24:27], v2, s[16:19], s36 offen offset:0 sc1
    v_cvt_pk_bf16_f32 v32, v32, v33
    v_cvt_pk_bf16_f32 v33, v34, v35
    v_cvt_pk_bf16_f32 v34, v36, v37
    v_cvt_pk_bf16_f32 v35, v38, v39
    buffer_store_dwordx4 v[32:35], v2, s[16:19], s36 offen offset:1024 sc1
    s_add_u32 s36, s39, 65536
    v_cvt_pk_bf16_f32 v40, v40, v41
    v_cvt_pk_bf16_f32 v41, v42, v43
    v_cvt_pk_bf16_f32 v42, v44, v45
    v_cvt_pk_bf16_f32 v43, v46, v47
    buffer_store_dwordx4 v[40:43], v2, s[16:19], s36 offen offset:0 sc1
    v_cvt_pk_bf16_f32 v48, v48, v49
    v_cvt_pk_bf16_f32 v49, v50, v51
    v_cvt_pk_bf16_f32 v50, v52, v53
    v_cvt_pk_bf16_f32 v51, v54, v55
    buffer_store_dwordx4 v[48:51], v2, s[16:19], s36 offen offset:1024 sc1
    s_add_u32 s36, s39, 131072
    v_cvt_pk_bf16_f32 v56, v56, v57
    v_cvt_pk_bf16_f32 v57, v58, v59
    v_cvt_pk_bf16_f32 v58, v60, v61
    v_cvt_pk_bf16_f32 v59, v62, v63
    buffer_store_dwordx4 v[56:59], v2, s[16:19], s36 offen offset:0 sc1
    v_cvt_pk_bf16_f32 v64, v64, v65
    v_cvt_pk_bf16_f32 v65, v66, v67
    v_cvt_pk_bf16_f32 v66, v68, v69
    v_cvt_pk_bf16_f32 v67, v70, v71
    buffer_store_dwordx4 v[64:67], v2, s[16:19], s36 offen offset:1024 sc1
    s_add_u32 s36, s39, 196608
    v_cvt_pk_bf16_f32 v72, v72, v73
    v_cvt_pk_bf16_f32 v73, v74, v75
    v_cvt_pk_bf16_f32 v74, v76, v77
    v_cvt_pk_bf16_f32 v75, v78, v79
    buffer_store_dwordx4 v[72:75], v2, s[16:19], s36 offen offset:0 sc1
    v_cvt_pk_bf16_f32 v80, v80, v81
    v_cvt_pk_bf16_f32 v81, v82, v83
    v_cvt_pk_bf16_f32 v82, v84, v85
    v_cvt_pk_bf16_f32 v83, v86, v87
    buffer_store_dwordx4 v[80:83], v2, s[16:19], s36 offen offset:1024 sc1
    s_barrier
    s_add_u32 s53, s55, 1024
    v_mov_b32 v8, 1
    v_mov_b32 v9, 162816
    v_mov_b32 v11, 0
    s_mov_b64 exec, 1
    s_waitcnt vmcnt(0)
    ds_add_rtn_u32 v10, v9, v8
    s_waitcnt lgkmcnt(0)
    v_readfirstlane_b32 s54, v10
    s_nop 0
    s_and_b32 s54, s54, 3
    s_cmp_lg_u32 s54, 3
    s_cbranch_scc1 pub_34
    buffer_atomic_add v8, v11, s[56:59], s53 offen sc1
    v_mov_b32 v9, 162872
    ds_add_u32 v9, v8
pub_34:
    s_mov_b64 exec, -1
    s_branch NEXT
G4_last:
    v_mfma_f32_16x16x32_bf16 v[24:27], v[104:107], v[88:91], v[24:27]
    ds_read_b128 v[120:123], v17 offset:1024
    ds_read_b128 v[124:127], v17 offset:3072
    ds_read_b128 v[128:131], v17 offset:5120
    v_mfma_f32_16x16x32_bf16 v[40:43], v[104:107], v[92:95], v[40:43]
    ds_read_b128 v[132:135], v17 offset:7168
    ds_read_b64_tr_b16 v[136:137], v18 offset:8192
    ds_read_b64_tr_b16 v[138:139], v18 offset:12288
    v_mfma_f32_16x16x32_bf16 v[56:59], v[104:107], v[96:99], v[56:59]
    ds_read_b64_tr_b16 v[140:141], v19 offset:8192
    ds_read_b64_tr_b16 v[142:143], v19 offset:12288
    ds_read_b64_tr_b16 v[144:145], v20 offset:8192
    v_mfma_f32_16x16x32_bf16 v[72:75], v[104:107], v[100:103], v[72:75]
    ds_read_b64_tr_b16 v[146:147], v20 offset:12288
    ds_read_b64_tr_b16 v[148:149], v21 offset:8192
    ds_read_b64_tr_b16 v[150:151], v21 offset:12288
    v_mfma_f32_16x16x32_bf16 v[76:79], v[108:111], v[100:103], v[76:79]
    s_load_dwordx2 s[6:7], s[0:1], 88
    s_add_u32 s84, s62, 0x400000
    s_addc_u32 s85, s63, 0
    v_mfma_f32_16x16x32_bf16 v[60:63], v[108:111], v[96:99], v[60:63]
    s_mov_b32 s86, 0x7e000
    s_mov_b32 s87, 0x20000
    s_add_u32 s88, s62, 0x480000
    v_mfma_f32_16x16x32_bf16 v[44:47], v[108:111], v[92:95], v[44:47]
    s_addc_u32 s89, s63, 0
    s_mov_b32 s90, 0x7e000
    s_mov_b32 s91, 0x20000
    v_mfma_f32_16x16x32_bf16 v[28:31], v[108:111], v[88:91], v[28:31]
    s_lshl_b32 s40, s31, 17
    s_add_u32 s40, s40, s39
    s_xor_b32 s41, s31, 1
    v_mfma_f32_16x16x32_bf16 v[32:35], v[112:115], v[88:91], v[32:35]
    s_lshl_b32 s41, s41, 17
    s_add_u32 s41, s41, s39
    s_add_u32 s36, s40, 0
    v_mfma_f32_16x16x32_bf16 v[48:51], v[112:115], v[92:95], v[48:51]
    buffer_load_dwordx4 v[176:179], v2, s[84:87], s36 offen offset:0 sc1
    buffer_load_dwordx4 v[180:183], v2, s[88:91], s36 offen offset:0 sc1
    buffer_load_dwordx4 v[184:187], v2, s[84:87], s36 offen offset:1024 sc1
    v_mfma_f32_16x16x32_bf16 v[64:67], v[112:115], v[96:99], v[64:67]
    buffer_load_dwordx4 v[188:191], v2, s[88:91], s36 offen offset:1024 sc1
    s_add_u32 s36, s40, 65536
    buffer_load_dwordx4 v[192:195], v2, s[84:87], s36 offen offset:0 sc1
    v_mfma_f32_16x16x32_bf16 v[80:83], v[112:115], v[100:103], v[80:83]
    buffer_load_dwordx4 v[196:199], v2, s[88:91], s36 offen offset:0 sc1
    buffer_load_dwordx4 v[200:203], v2, s[84:87], s36 offen offset:1024 sc1
    buffer_load_dwordx4 v[204:207], v2, s[88:91], s36 offen offset:1024 sc1
    v_mfma_f32_16x16x32_bf16 v[84:87], v[116:119], v[100:103], v[84:87]
    v_mfma_f32_16x16x32_bf16 v[68:71], v[116:119], v[96:99], v[68:71]
    v_mfma_f32_16x16x32_bf16 v[52:55], v[116:119], v[92:95], v[52:55]
    v_mfma_f32_16x16x32_bf16 v[36:39], v[116:119], v[88:91], v[36:39]
    s_waitcnt lgkmcnt(0)
    v_mfma_f32_16x16x32_bf16 v[24:27], v[136:139], v[120:123], v[24:27]
    s_add_u32 s16, s62, 0x500000
    s_addc_u32 s17, s63, 0
    s_mov_b32 s18, 0x7e000
    s_mov_b32 s19, 0x20000
    v_mfma_f32_16x16x32_bf16 v[40:43], v[136:139], v[124:127], v[40:43]
    s_mov_b32 s20, s6
    s_mov_b32 s21, s7
    s_mov_b32 s22, 0x400000
    v_mfma_f32_16x16x32_bf16 v[56:59], v[136:139], v[128:131], v[56:59]
    s_mov_b32 s23, 0x20000
    s_lshl_b32 s44, s29, 2
    s_add_u32 s44, s44, s30
    v_mfma_f32_16x16x32_bf16 v[72:75], v[136:139], v[132:135], v[72:75]
    s_lshl_b32 s44, s44, 7
    s_xor_b32 s45, s44, 4096
    s_add_u32 s44, s44, s55
    v_mfma_f32_16x16x32_bf16 v[76:79], v[140:143], v[132:135], v[76:79]
    s_add_u32 s44, s44, 16384
    s_add_u32 s45, s45, s55
    s_add_u32 s45, s45, 16384
    v_mfma_f32_16x16x32_bf16 v[60:63], v[140:143], v[128:131], v[60:63]
    v_mov_b32 v9, s45
    v_mov_b32 v10, s52
    v_mov_b32 v11, 0
    v_mfma_f32_16x16x32_bf16 v[44:47], v[140:143], v[124:127], v[44:47]
    s_lshl_b32 s46, s28, 3
    s_add_u32 s46, s46, s37
    s_lshl_b32 s47, s31, 1
    v_mfma_f32_16x16x32_bf16 v[28:31], v[140:143], v[120:123], v[28:31]
    s_add_u32 s46, s46, s47
    s_lshl_b32 s46, s46, 15
    s_lshl_b32 s47, s38, 5
    v_mfma_f32_16x16x32_bf16 v[32:35], v[144:147], v[120:123], v[32:35]
    s_add_u32 s46, s46, s47
    s_add_u32 s47, s46, 32768
    v_and_b32 v225, 1, v23
    v_mfma_f32_16x16x32_bf16 v[48:51], v[144:147], v[124:127], v[48:51]
    v_lshlrev_b32 v224, 11, v22
    v_lshl_add_u32 v224, v225, 5, v224
    v_lshrrev_b32 v225, 1, v23
    v_mfma_f32_16x16x32_bf16 v[64:67], v[144:147], v[128:131], v[64:67]
    v_lshl_add_u32 v224, v225, 4, v224
    v_cmp_gt_u32 s[48:49], 8, v22
    v_lshrrev_b32 v225, 3, v22
    v_mfma_f32_16x16x32_bf16 v[80:83], v[144:147], v[132:135], v[80:83]
    v_mul_u32_u24 v225, 16320, v225
    v_sub_u32 v224, v224, v225
    v_add_u32 v225, 16384, v224
    v_mfma_f32_16x16x32_bf16 v[84:87], v[148:151], v[132:135], v[84:87]
    v_mfma_f32_16x16x32_bf16 v[68:71], v[148:151], v[128:131], v[68:71]
    v_mfma_f32_16x16x32_bf16 v[52:55], v[148:151], v[124:127], v[52:55]
    v_mfma_f32_16x16x32_bf16 v[36:39], v[148:151], v[120:123], v[36:39]
    s_cmp_eq_u32 s31, 0
    s_cbranch_scc1 G4_k0
    v_swap_b32 v24, v56
    v_swap_b32 v25, v57
    v_swap_b32 v26, v58
    v_swap_b32 v27, v59
    v_swap_b32 v28, v60
    v_swap_b32 v29, v61
    v_swap_b32 v30, v62
    v_swap_b32 v31, v63
    v_swap_b32 v32, v64
    v_swap_b32 v33, v65
    v_swap_b32 v34, v66
    v_swap_b32 v35, v67
    v_swap_b32 v36, v68
    v_swap_b32 v37, v69
    v_swap_b32 v38, v70
    v_swap_b32 v39, v71
    v_swap_b32 v40, v72
    v_swap_b32 v41, v73
    v_swap_b32 v42, v74
    v_swap_b32 v43, v75
    v_swap_b32 v44, v76
    v_swap_b32 v45, v77
    v_swap_b32 v46, v78
    v_swap_b32 v47, v79
    v_swap_b32 v48, v80
    v_swap_b32 v49, v81
    v_swap_b32 v50, v82
    v_swap_b32 v51, v83
    v_swap_b32 v52, v84
    v_swap_b32 v53, v85
    v_swap_b32 v54, v86
    v_swap_b32 v55, v87
G4_k0:
    s_add_u32 s36, s41, 0
    v_cvt_pk_bf16_f32 v56, v56, v57
    v_cvt_pk_bf16_f32 v57, v58, v59
    v_cvt_pk_bf16_f32 v58, v60, v61
    v_cvt_pk_bf16_f32 v59, v62, v63
    buffer_store_dwordx4 v[56:59], v2, s[16:19], s36 offen offset:0 sc1
    v_cvt_pk_bf16_f32 v64, v64, v65
    v_cvt_pk_bf16_f32 v65, v66, v67
    v_cvt_pk_bf16_f32 v66, v68, v69
    v_cvt_pk_bf16_f32 v67, v70, v71
    buffer_store_dwordx4 v[64:67], v2, s[16:19], s36 offen offset:1024 sc1
    s_add_u32 s36, s41, 65536
    v_cvt_pk_bf16_f32 v72, v72, v73
    v_cvt_pk_bf16_f32 v73, v74, v75
    v_cvt_pk_bf16_f32 v74, v76, v77
    v_cvt_pk_bf16_f32 v75, v78, v79
    buffer_store_dwordx4 v[72:75], v2, s[16:19], s36 offen offset:0 sc1
    v_cvt_pk_bf16_f32 v80, v80, v81
    v_cvt_pk_bf16_f32 v81, v82, v83
    v_cvt_pk_bf16_f32 v82, v84, v85
    v_cvt_pk_bf16_f32 v83, v86, v87
    buffer_store_dwordx4 v[80:83], v2, s[16:19], s36 offen offset:1024 sc1
    s_waitcnt vmcnt(4)
    v_lshlrev_b32 v226, 16, v176
    v_and_b32 v227, 0xffff0000, v176
    v_pk_add_f32 v[24:25], v[24:25], v[226:227]
    v_lshlrev_b32 v228, 16, v177
    v_and_b32 v229, 0xffff0000, v177
    v_pk_add_f32 v[26:27], v[26:27], v[228:229]
    v_lshlrev_b32 v226, 16, v178
    v_and_b32 v227, 0xffff0000, v178
    v_pk_add_f32 v[28:29], v[28:29], v[226:227]
    v_lshlrev_b32 v228, 16, v179
    v_and_b32 v229, 0xffff0000, v179
    v_pk_add_f32 v[30:31], v[30:31], v[228:229]
    v_lshlrev_b32 v226, 16, v184
    v_and_b32 v227, 0xffff0000, v184
    v_pk_add_f32 v[32:33], v[32:33], v[226:227]
    v_lshlrev_b32 v228, 16, v185
    v_and_b32 v229, 0xffff0000, v185
    v_pk_add_f32 v[34:35], v[34:35], v[228:229]
    v_lshlrev_b32 v226, 16, v186
    v_and_b32 v227, 0xffff0000, v186
    v_pk_add_f32 v[36:37], v[36:37], v[226:227]
    v_lshlrev_b32 v228, 16, v187
    v_and_b32 v229, 0xffff0000, v187
    v_pk_add_f32 v[38:39], v[38:39], v[228:229]
    v_lshlrev_b32 v226, 16, v192
    v_and_b32 v227, 0xffff0000, v192
    v_pk_add_f32 v[40:41], v[40:41], v[226:227]
    v_lshlrev_b32 v228, 16, v193
    v_and_b32 v229, 0xffff0000, v193
    v_pk_add_f32 v[42:43], v[42:43], v[228:229]
    v_lshlrev_b32 v226, 16, v194
    v_and_b32 v227, 0xffff0000, v194
    v_pk_add_f32 v[44:45], v[44:45], v[226:227]
    v_lshlrev_b32 v228, 16, v195
    v_and_b32 v229, 0xffff0000, v195
    v_pk_add_f32 v[46:47], v[46:47], v[228:229]
    v_lshlrev_b32 v226, 16, v200
    v_and_b32 v227, 0xffff0000, v200
    v_pk_add_f32 v[48:49], v[48:49], v[226:227]
    v_lshlrev_b32 v228, 16, v201
    v_and_b32 v229, 0xffff0000, v201
    v_pk_add_f32 v[50:51], v[50:51], v[228:229]
    v_lshlrev_b32 v226, 16, v202
    v_and_b32 v227, 0xffff0000, v202
    v_pk_add_f32 v[52:53], v[52:53], v[226:227]
    v_lshlrev_b32 v228, 16, v203
    v_and_b32 v229, 0xffff0000, v203
    v_pk_add_f32 v[54:55], v[54:55], v[228:229]
    s_waitcnt vmcnt(0)
    s_mov_b64 exec, 1
    buffer_store_dword v10, v11, s[56:59], s44 offen sc1
    s_mov_b64 exec, -1
    v_lshlrev_b32 v226, 16, v180
    v_and_b32 v227, 0xffff0000, v180
    v_pk_add_f32 v[24:25], v[24:25], v[226:227]
    v_lshlrev_b32 v228, 16, v181
    v_and_b32 v229, 0xffff0000, v181
    v_pk_add_f32 v[26:27], v[26:27], v[228:229]
    v_lshlrev_b32 v226, 16, v182
    v_and_b32 v227, 0xffff0000, v182
    v_pk_add_f32 v[28:29], v[28:29], v[226:227]
    v_lshlrev_b32 v228, 16, v183
    v_and_b32 v229, 0xffff0000, v183
    v_pk_add_f32 v[30:31], v[30:31], v[228:229]
    v_lshlrev_b32 v226, 16, v188
    v_and_b32 v227, 0xffff0000, v188
    v_pk_add_f32 v[32:33], v[32:33], v[226:227]
    v_lshlrev_b32 v228, 16, v189
    v_and_b32 v229, 0xffff0000, v189
    v_pk_add_f32 v[34:35], v[34:35], v[228:229]
    v_lshlrev_b32 v226, 16, v190
    v_and_b32 v227, 0xffff0000, v190
    v_pk_add_f32 v[36:37], v[36:37], v[226:227]
    v_lshlrev_b32 v228, 16, v191
    v_and_b32 v229, 0xffff0000, v191
    v_pk_add_f32 v[38:39], v[38:39], v[228:229]
    v_lshlrev_b32 v226, 16, v196
    v_and_b32 v227, 0xffff0000, v196
    v_pk_add_f32 v[40:41], v[40:41], v[226:227]
    v_lshlrev_b32 v228, 16, v197
    v_and_b32 v229, 0xffff0000, v197
    v_pk_add_f32 v[42:43], v[42:43], v[228:229]
    v_lshlrev_b32 v226, 16, v198
    v_and_b32 v227, 0xffff0000, v198
    v_pk_add_f32 v[44:45], v[44:45], v[226:227]
    v_lshlrev_b32 v228, 16, v199
    v_and_b32 v229, 0xffff0000, v199
    v_pk_add_f32 v[46:47], v[46:47], v[228:229]
    v_lshlrev_b32 v226, 16, v204
    v_and_b32 v227, 0xffff0000, v204
    v_pk_add_f32 v[48:49], v[48:49], v[226:227]
    v_lshlrev_b32 v228, 16, v205
    v_and_b32 v229, 0xffff0000, v205
    v_pk_add_f32 v[50:51], v[50:51], v[228:229]
    v_lshlrev_b32 v226, 16, v206
    v_and_b32 v227, 0xffff0000, v206
    v_pk_add_f32 v[52:53], v[52:53], v[226:227]
    v_lshlrev_b32 v228, 16, v207
    v_and_b32 v229, 0xffff0000, v207
    v_pk_add_f32 v[54:55], v[54:55], v[228:229]
    s_mov_b32 s53, 0
    s_add_u32 s54, s52, 0
    s_bfm_b64 exec, 1, 0
poll_35:
    buffer_load_dword v8, v9, s[56:59], 0 offen sc1
    s_waitcnt vmcnt(0)
    v_xor_b32 v8, s54, v8
    v_cmp_eq_u32 vcc, 0, v8
    s_nop 0
    s_cmp_eq_u64 vcc, exec
    s_cbranch_scc1 pok_36
    s_sleep 2
    s_add_u32 s53, s53, 1
    s_cmp_lt_u32 s53, s61
    s_cbranch_scc1 poll_35
    s_mov_b32 s61, 0
pok_36:
    s_mov_b64 exec, -1
    s_add_u32 s36, s40, 0
    buffer_load_dwordx4 v[208:211], v2, s[16:19], s36 offen offset:0 sc1
    buffer_load_dwordx4 v[212:215], v2, s[16:19], s36 offen offset:1024 sc1
    s_add_u32 s36, s40, 65536
    buffer_load_dwordx4 v[216:219], v2, s[16:19], s36 offen offset:0 sc1
    buffer_load_dwordx4 v[220:223], v2, s[16:19], s36 offen offset:1024 sc1
    s_waitcnt vmcnt(3)
    v_lshlrev_b32 v226, 16, v208
    v_and_b32 v227, 0xffff0000, v208
    v_pk_add_f32 v[24:25], v[24:25], v[226:227]
    v_lshlrev_b32 v228, 16, v209
    v_and_b32 v229, 0xffff0000, v209
    v_pk_add_f32 v[26:27], v[26:27], v[228:229]
    v_lshlrev_b32 v226, 16, v210
    v_and_b32 v227, 0xffff0000, v210
    v_pk_add_f32 v[28:29], v[28:29], v[226:227]
    v_lshlrev_b32 v228, 16, v211
    v_and_b32 v229, 0xffff0000, v211
    v_pk_add_f32 v[30:31], v[30:31], v[228:229]
    v_cvt_pk_bf16_f32 v24, v24, v25
    v_cvt_pk_bf16_f32 v25, v26, v27
    v_cvt_pk_bf16_f32 v26, v28, v29
    v_cvt_pk_bf16_f32 v27, v30, v31
    s_nop 0
    v_permlane16_swap_b32 v24, v26
    v_permlane16_swap_b32 v25, v27
    s_waitcnt vmcnt(2)
    v_lshlrev_b32 v226, 16, v212
    v_and_b32 v227, 0xffff0000, v212
    v_pk_add_f32 v[32:33], v[32:33], v[226:227]
    v_lshlrev_b32 v228, 16, v213
    v_and_b32 v229, 0xffff0000, v213
    v_pk_add_f32 v[34:35], v[34:35], v[228:229]
    v_lshlrev_b32 v226, 16, v214
    v_and_b32 v227, 0xffff0000, v214
    v_pk_add_f32 v[36:37], v[36:37], v[226:227]
    v_lshlrev_b32 v228, 16, v215
    v_and_b32 v229, 0xffff0000, v215
    v_pk_add_f32 v[38:39], v[38:39], v[228:229]
    v_cvt_pk_bf16_f32 v32, v32, v33
    v_cvt_pk_bf16_f32 v33, v34, v35
    v_cvt_pk_bf16_f32 v34, v36, v37
    v_cvt_pk_bf16_f32 v35, v38, v39
    s_nop 0
    v_permlane16_swap_b32 v32, v34
    v_permlane16_swap_b32 v33, v35
    v_cndmask_b32 v36, v24, v32, s[48:49]
    v_cndmask_b32 v37, v25, v33, s[48:49]
    v_cndmask_b32 v38, v26, v34, s[48:49]
    v_cndmask_b32 v39, v27, v35, s[48:49]
    v_mov_b32_dpp v28, v36 row_ror:8 row_mask:0xf bank_mask:0xf
    v_mov_b32_dpp v29, v37 row_ror:8 row_mask:0xf bank_mask:0xf
    v_mov_b32_dpp v30, v38 row_ror:8 row_mask:0xf bank_mask:0xf
    v_mov_b32_dpp v31, v39 row_ror:8 row_mask:0xf bank_mask:0xf
    v_cndmask_b32 v24, v28, v24, s[48:49]
    v_cndmask_b32 v32, v32, v28, s[48:49]
    v_cndmask_b32 v25, v29, v25, s[48:49]
    v_cndmask_b32 v33, v33, v29, s[48:49]
    v_cndmask_b32 v26, v30, v26, s[48:49]
    v_cndmask_b32 v34, v34, v30, s[48:49]
    v_cndmask_b32 v27, v31, v27, s[48:49]
    v_cndmask_b32 v35, v35, v31, s[48:49]
    buffer_store_dwordx4 v[24:27], v224, s[20:23], s46 offen sc1
    buffer_store_dwordx4 v[32:35], v225, s[20:23], s46 offen sc1
    s_waitcnt vmcnt(3)
    v_lshlrev_b32 v226, 16, v216
    v_and_b32 v227, 0xffff0000, v216
    v_pk_add_f32 v[40:41], v[40:41], v[226:227]
    v_lshlrev_b32 v228, 16, v217
    v_and_b32 v229, 0xffff0000, v217
    v_pk_add_f32 v[42:43], v[42:43], v[228:229]
    v_lshlrev_b32 v226, 16, v218
    v_and_b32 v227, 0xffff0000, v218
    v_pk_add_f32 v[44:45], v[44:45], v[226:227]
    v_lshlrev_b32 v228, 16, v219
    v_and_b32 v229, 0xffff0000, v219
    v_pk_add_f32 v[46:47], v[46:47], v[228:229]
    v_cvt_pk_bf16_f32 v40, v40, v41
    v_cvt_pk_bf16_f32 v41, v42, v43
    v_cvt_pk_bf16_f32 v42, v44, v45
    v_cvt_pk_bf16_f32 v43, v46, v47
    s_nop 0
    v_permlane16_swap_b32 v40, v42
    v_permlane16_swap_b32 v41, v43
    s_waitcnt vmcnt(2)
    v_lshlrev_b32 v226, 16, v220
    v_and_b32 v227, 0xffff0000, v220
    v_pk_add_f32 v[48:49], v[48:49], v[226:227]
    v_lshlrev_b32 v228, 16, v221
    v_and_b32 v229, 0xffff0000, v221
    v_pk_add_f32 v[50:51], v[50:51], v[228:229]
    v_lshlrev_b32 v226, 16, v222
    v_and_b32 v227, 0xffff0000, v222
    v_pk_add_f32 v[52:53], v[52:53], v[226:227]
    v_lshlrev_b32 v228, 16, v223
    v_and_b32 v229, 0xffff0000, v223
    v_pk_add_f32 v[54:55], v[54:55], v[228:229]
    v_cvt_pk_bf16_f32 v48, v48, v49
    v_cvt_pk_bf16_f32 v49, v50, v51
    v_cvt_pk_bf16_f32 v50, v52, v53
    v_cvt_pk_bf16_f32 v51, v54, v55
    s_nop 0
    v_permlane16_swap_b32 v48, v50
    v_permlane16_swap_b32 v49, v51
    v_cndmask_b32 v52, v40, v48, s[48:49]
    v_cndmask_b32 v53, v41, v49, s[48:49]
    v_cndmask_b32 v54, v42, v50, s[48:49]
    v_cndmask_b32 v55, v43, v51, s[48:49]
    v_mov_b32_dpp v44, v52 row_ror:8 row_mask:0xf bank_mask:0xf
    v_mov_b32_dpp v45, v53 row_ror:8 row_mask:0xf bank_mask:0xf
    v_mov_b32_dpp v46, v54 row_ror:8 row_mask:0xf bank_mask:0xf
    v_mov_b32_dpp v47, v55 row_ror:8 row_mask:0xf bank_mask:0xf
    v_cndmask_b32 v40, v44, v40, s[48:49]
    v_cndmask_b32 v48, v48, v44, s[48:49]
    v_cndmask_b32 v41, v45, v41, s[48:49]
    v_cndmask_b32 v49, v49, v45, s[48:49]
    v_cndmask_b32 v42, v46, v42, s[48:49]
    v_cndmask_b32 v50, v50, v46, s[48:49]
    v_cndmask_b32 v43, v47, v43, s[48:49]
    v_cndmask_b32 v51, v51, v47, s[48:49]
    buffer_store_dwordx4 v[40:43], v224, s[20:23], s47 offen sc1
    buffer_store_dwordx4 v[48:51], v225, s[20:23], s47 offen sc1
    s_branch K_fin
LOADERS:
    s_cmp_ge_u32 s30, 6
    s_cbranch_scc1 WLOAD
    s_add_u32 s54, s55, 0x500
    v_mov_b32 v182, s54
    s_lshl_b32 s53, s29, 7
    s_add_u32 s53, s53, 23117824
    v_mov_b32 v186, s53
    s_cmp_lg_u32 s30, 4
    s_cbranch_scc1 pdone_37
    s_add_u32 s54, s55, 0x0
    v_mov_b32 v9, s54
    s_mov_b32 s53, 0
    s_add_u32 s54, s52, 16
    s_bfm_b64 exec, 1, 0
poll_38:
    buffer_load_dword v8, v9, s[56:59], 0 offen sc1
    s_waitcnt vmcnt(0)
    v_xor_b32 v8, s54, v8
    v_cmp_eq_u32 vcc, 0, v8
    s_nop 0
    s_cmp_eq_u64 vcc, exec
    s_cbranch_scc1 pok_39
    s_sleep 5
    s_add_u32 s53, s53, 1
    s_cmp_lt_u32 s53, s61
    s_cbranch_scc1 poll_38
    s_mov_b32 s61, 0
pok_39:
    s_mov_b64 exec, -1
pdone_37:
    s_barrier
    s_mov_b64 exec, 1
    buffer_load_dword v187, v186, s[56:59], 0 offen sc1
    s_mov_b64 exec, -1
    s_waitcnt vmcnt(0)
    v_readfirstlane_b32 s53, v187
    s_add_u32 s54, s52, 16
    s_cmp_eq_u32 s53, s54
    s_cbranch_scc1 fok_40
    s_mov_b32 s53, 0
    s_add_u32 s54, s52, 16
    s_bfm_b64 exec, 1, 0
poll_41:
    buffer_load_dword v187, v186, s[56:59], 0 offen sc1
    s_waitcnt vmcnt(0)
    v_xor_b32 v187, s54, v187
    v_cmp_eq_u32 vcc, 0, v187
    s_nop 0
    s_cmp_eq_u64 vcc, exec
    s_cbranch_scc1 pok_42
    s_sleep 5
    s_add_u32 s53, s53, 1
    s_cmp_lt_u32 s53, s61
    s_cbranch_scc1 poll_41
    s_mov_b32 s61, 0
pok_42:
    s_mov_b64 exec, -1
fok_40:
    s_add_u32 s24, s4, 0x1400000
    s_addc_u32 s25, s5, 0
    s_mov_b32 s26, 0x20000
    s_mov_b32 s27, 0x20000
    s_cmp_eq_u32 s60, 0
    s_cselect_b32 s26, s26, 0
    s_and_b32 s36, s30, 1
    s_mul_i32 s36, s36, 128
    s_mul_i32 s37, s29, 256
    s_add_u32 s37, s36, s37
    v_lshrrev_b32 v184, 3, v1
    v_mul_u32_u24 v184, 4096, v184
    v_and_b32 v23, 112, v2
    v_add_u32 v184, v184, v23
    buffer_load_dwordx4 v[24:27], v184, s[24:27], s37 offen sc1
    s_add_u32 s37, s37, 32768
    buffer_load_dwordx4 v[28:31], v184, s[24:27], s37 offen sc1
    s_add_u32 s37, s37, 32768
    buffer_load_dwordx4 v[32:35], v184, s[24:27], s37 offen sc1
    s_add_u32 s37, s37, 32768
    buffer_load_dwordx4 v[36:39], v184, s[24:27], s37 offen sc1
    s_add_u32 s37, s37, 32768
    s_mov_b64 exec, 1
    buffer_load_dword v183, v182, s[56:59], 0 offen sc1
    s_mov_b64 exec, -1
    s_waitcnt vmcnt(0)
    v_readfirstlane_b32 s53, v183
    s_add_u32 s54, s52, 16
    s_cmp_eq_u32 s53, s54
    s_cbranch_scc1 fok_43
    s_mov_b32 s53, 0
    s_add_u32 s54, s52, 16
    s_bfm_b64 exec, 1, 0
poll_44:
    buffer_load_dword v183, v182, s[56:59], 0 offen sc1
    s_waitcnt vmcnt(0)
    v_xor_b32 v183, s54, v183
    v_cmp_eq_u32 vcc, 0, v183
    s_nop 0
    s_cmp_eq_u64 vcc, exec
    s_cbranch_scc1 pok_45
    s_sleep 5
    s_add_u32 s53, s53, 1
    s_cmp_lt_u32 s53, s61
    s_cbranch_scc1 poll_44
    s_mov_b32 s61, 0
pok_45:
    s_mov_b64 exec, -1
fok_43:
    s_add_u32 s20, s62, 0x1d0000
    s_addc_u32 s21, s63, 0
    s_mov_b32 s22, 0x800
    s_mov_b32 s23, 0x20000
    s_and_b32 s35, s30, 1
    s_lshl_b32 s35, s35, 10
    buffer_load_dwordx4 v[16:19], v2, s[20:23], s35 offen sc1
    s_cmp_lg_u32 s60, 0
    s_cbranch_scc1 pc_46
    v_pk_add_f32 v[24:25], v[24:25], v[28:29]
    v_pk_add_f32 v[26:27], v[26:27], v[30:31]
    v_pk_add_f32 v[24:25], v[24:25], v[32:33]
    v_pk_add_f32 v[26:27], v[26:27], v[34:35]
    v_pk_add_f32 v[24:25], v[24:25], v[36:37]
pc_46:
    s_cmp_lg_u32 s60, 0
    s_cbranch_scc1 pc_47
    v_pk_add_f32 v[26:27], v[26:27], v[38:39]
    v_add_f32_dpp v24, v24, v24 row_ror:8 row_mask:0xf bank_mask:0xf
    v_add_f32_dpp v25, v25, v25 row_ror:8 row_mask:0xf bank_mask:0xf
    v_add_f32_dpp v26, v26, v26 row_ror:8 row_mask:0xf bank_mask:0xf
    v_add_f32_dpp v27, v27, v27 row_ror:8 row_mask:0xf bank_mask:0xf
pc_47:
    s_cmp_lg_u32 s60, 0
    s_cbranch_scc1 pc_48
    v_mov_b32 v28, v24
    v_mov_b32 v29, v25
    v_mov_b32 v30, v26
    v_mov_b32 v31, v27
    v_permlane16_swap_b32 v24, v28
pc_48:
    s_cmp_lg_u32 s60, 0
    s_cbranch_scc1 pc_49
    v_permlane16_swap_b32 v25, v29
    v_permlane16_swap_b32 v26, v30
    v_permlane16_swap_b32 v27, v31
    v_pk_add_f32 v[24:25], v[24:25], v[28:29]
    v_pk_add_f32 v[26:27], v[26:27], v[30:31]
pc_49:
    s_cmp_lg_u32 s60, 0
    s_cbranch_scc1 pc_50
    v_mov_b32 v28, v24
    v_mov_b32 v29, v25
    v_mov_b32 v30, v26
    v_mov_b32 v31, v27
    v_permlane32_swap_b32 v24, v28
pc_50:
    s_cmp_lg_u32 s60, 0
    s_cbranch_scc1 pc_51
    v_permlane32_swap_b32 v25, v29
    v_permlane32_swap_b32 v26, v30
    v_permlane32_swap_b32 v27, v31
    v_pk_add_f32 v[24:25], v[24:25], v[28:29]
    v_pk_add_f32 v[26:27], v[26:27], v[30:31]
pc_51:
    s_cmp_lg_u32 s60, 0
    s_cbranch_scc1 pc_52
    s_and_b32 s36, s30, 1
    s_mul_i32 s36, s36, 128
    s_add_u32 s36, s36, 163328
    v_add_u32 v23, s36, v2
    s_bfm_b64 exec, 8, 0
    ds_write_b128 v23, v[24:27]
    s_mov_b64 exec, -1
    s_waitcnt lgkmcnt(0)
pc_52:
    s_waitcnt vmcnt(0)
    s_and_b32 s36, s30, 1
    s_lshl_b32 s36, s36, 10
    s_add_u32 s36, s36, 160768
    v_add_u32 v181, s36, v2
    ds_write_b128 v181, v[16:19]
    s_waitcnt lgkmcnt(0)
    s_barrier
    s_call_b64 s[76:77], SUB_after_g1
    s_cmp_lg_u32 s30, 4
    s_cbranch_scc1 pdone_54
    s_lshl_b32 s54, s60, 2
    s_add_u32 s54, s54, 1
    v_mov_b32 v8, 162872
spin_55:
    s_sleep 8
    ds_read_b32 v9, v8
    s_waitcnt lgkmcnt(0)
    v_readfirstlane_b32 s53, v9
    s_nop 0
    s_cmp_ge_u32 s53, s54
    s_cbranch_scc0 spin_55
    s_add_u32 s54, s55, 0x100
    v_mov_b32 v9, s54
    s_add_u32 s53, s54, 128
    v_writelane_b32 v9, s53, 1
    s_add_u32 s53, s53, s93
    v_writelane_b32 v9, s53, 3
    s_add_u32 s53, s54, s92
    v_writelane_b32 v9, s53, 2
    s_mov_b32 s53, 0
    s_add_u32 s54, s52, 8
    s_bfm_b64 exec, 4, 0
poll_56:
    buffer_load_dword v8, v9, s[56:59], 0 offen sc1
    s_waitcnt vmcnt(0)
    v_xor_b32 v8, s54, v8
    v_cmp_eq_u32 vcc, 0, v8
    s_nop 0
    s_cmp_eq_u64 vcc, exec
    s_cbranch_scc1 pok_57
    s_sleep 5
    s_add_u32 s53, s53, 1
    s_cmp_lt_u32 s53, s61
    s_cbranch_scc1 poll_56
    s_mov_b32 s61, 0
pok_57:
    s_mov_b64 exec, -1
pdone_54:
    s_barrier
    s_barrier
    s_call_b64 s[76:77], SUB_after_g2
    s_and_b32 s35, s30, 1
    s_add_u32 s12, s62, 0x480000
    s_addc_u32 s13, s63, 0
    s_mov_b32 s14, 0x7e000
    s_mov_b32 s15, 0x20000
    s_mul_i32 s38, s35, 262144
    s_lshl_b32 s41, s35, 13
    s_mov_b32 s42, 0
    s_mov_b32 s44, 0
    s_add_u32 s54, s55, 0x200
    v_mov_b32 v9, s54
    s_add_u32 s44, s44, 1
    s_and_b32 s44, s44, 15
    s_mov_b32 s42, 16384
    s_add_u32 s54, s55, 0x580
    v_mov_b32 v182, s54
    v_lshlrev_b32 v181, 3, v1
    s_add_u32 s19, s41, s42
    v_readlane_b32 s16, v248, s44
    s_nop 0
    s_add_u32 s16, s16, s38
    s_add_u32 s44, s44, 1
    s_and_b32 s44, s44, 15
    s_add_u32 s42, s42, 16384
    s_cmp_eq_u32 s42, 49152
    s_cselect_b32 s42, 0, s42
    s_mov_b32 m0, s19
    s_mov_b32 s39, s16
    s_waitcnt vmcnt(0)
    s_barrier
    s_mov_b32 s53, 0
    s_add_u32 s54, s52, 16
    s_bfm_b64 exec, 1, 0
poll_58:
    buffer_load_dword v8, v9, s[56:59], 0 offen sc1
    s_waitcnt vmcnt(0)
    v_xor_b32 v8, s54, v8
    v_cmp_eq_u32 vcc, 0, v8
    s_nop 0
    s_cmp_eq_u64 vcc, exec
    s_cbranch_scc1 pok_59
    s_sleep 5
    s_add_u32 s53, s53, 1
    s_cmp_lt_u32 s53, s61
    s_cbranch_scc1 poll_58
    s_mov_b32 s61, 0
pok_59:
    s_mov_b64 exec, -1
    buffer_load_dwordx4 v2, s[12:15], s39 offen sc1 lds
    buffer_load_dwordx4 v2, s[12:15], s39 offen offset:1024 sc1 lds
    s_add_u32 s19, s41, s42
    v_readlane_b32 s16, v248, s44
    s_nop 0
    s_add_u32 s16, s16, s38
    s_add_u32 s44, s44, 1
    s_and_b32 s44, s44, 15
    s_add_u32 s42, s42, 16384
    s_cmp_eq_u32 s42, 49152
    s_cselect_b32 s42, 0, s42
    s_add_u32 m0, m0, 2048
    s_add_u32 s39, s39, 65536
    buffer_load_dwordx4 v2, s[12:15], s39 offen sc1 lds
    buffer_load_dwordx4 v2, s[12:15], s39 offen offset:1024 sc1 lds
    s_add_u32 m0, m0, 2048
    s_add_u32 s39, s39, 65536
    buffer_load_dwordx4 v2, s[12:15], s39 offen sc1 lds
    buffer_load_dwordx4 v2, s[12:15], s39 offen offset:1024 sc1 lds
    s_add_u32 m0, m0, 2048
    s_add_u32 s39, s39, 65536
    buffer_load_dwordx4 v2, s[12:15], s39 offen sc1 lds
    buffer_load_dwordx4 v2, s[12:15], s39 offen offset:1024 sc1 lds
    s_mov_b32 m0, s19
    s_mov_b32 s39, s16
    buffer_load_dwordx4 v2, s[12:15], s39 offen sc1 lds
    buffer_load_dwordx4 v2, s[12:15], s39 offen offset:1024 sc1 lds
    s_add_u32 s19, s41, s42
    v_readlane_b32 s16, v248, s44
    s_nop 0
    s_add_u32 s16, s16, s38
    s_add_u32 s44, s44, 1
    s_and_b32 s44, s44, 15
    s_add_u32 s42, s42, 16384
    s_cmp_eq_u32 s42, 49152
    s_cselect_b32 s42, 0, s42
    s_add_u32 m0, m0, 2048
    s_add_u32 s39, s39, 65536
    buffer_load_dwordx4 v2, s[12:15], s39 offen sc1 lds
    buffer_load_dwordx4 v2, s[12:15], s39 offen offset:1024 sc1 lds
    s_add_u32 m0, m0, 2048
    s_add_u32 s39, s39, 65536
    buffer_load_dwordx4 v2, s[12:15], s39 offen sc1 lds
    buffer_load_dwordx4 v2, s[12:15], s39 offen offset:1024 sc1 lds
    s_add_u32 m0, m0, 2048
    s_add_u32 s39, s39, 65536
    buffer_load_dwordx4 v2, s[12:15], s39 offen sc1 lds
    buffer_load_dwordx4 v2, s[12:15], s39 offen offset:1024 sc1 lds
    s_mov_b32 m0, s19
    s_mov_b32 s39, s16
    s_waitcnt vmcnt(8)
    s_barrier
    buffer_load_dwordx4 v2, s[12:15], s39 offen sc1 lds
    buffer_load_dwordx4 v2, s[12:15], s39 offen offset:1024 sc1 lds
    s_add_u32 s19, s41, s42
    v_readlane_b32 s16, v248, s44
    s_nop 0
    s_add_u32 s16, s16, s38
    s_add_u32 s44, s44, 1
    s_and_b32 s44, s44, 15
    s_add_u32 s42, s42, 16384
    s_cmp_eq_u32 s42, 49152
    s_cselect_b32 s42, 0, s42
    s_add_u32 m0, m0, 2048
    s_add_u32 s39, s39, 65536
    buffer_load_dwordx4 v2, s[12:15], s39 offen sc1 lds
    buffer_load_dwordx4 v2, s[12:15], s39 offen offset:1024 sc1 lds
    s_add_u32 m0, m0, 2048
    s_add_u32 s39, s39, 65536
    buffer_load_dwordx4 v2, s[12:15], s39 offen sc1 lds
    buffer_load_dwordx4 v2, s[12:15], s39 offen offset:1024 sc1 lds
    s_add_u32 m0, m0, 2048
    s_add_u32 s39, s39, 65536
    buffer_load_dwordx4 v2, s[12:15], s39 offen sc1 lds
    buffer_load_dwordx4 v2, s[12:15], s39 offen offset:1024 sc1 lds
    s_mov_b32 m0, s19
    s_mov_b32 s39, s16
    s_add_u32 s24, s4, 0x1420000
    s_addc_u32 s25, s5, 0
    s_mov_b32 s26, 0x70000
    s_mov_b32 s27, 0x20000
    s_cmp_eq_u32 s60, 0
    s_cselect_b32 s26, s26, 0
    s_and_b32 s36, s30, 1
    s_mul_i32 s36, s36, 448
    s_mul_i32 s37, s29, 896
    s_add_u32 s37, s36, s37
    v_lshrrev_b32 v184, 5, v1
    v_mul_u32_u24 v184, 14336, v184
    v_and_b32 v191, 496, v2
    v_add_u32 v184, v184, v191
    buffer_load_dwordx4 v[192:195], v184, s[24:27], s37 offen sc1
    s_add_u32 s37, s37, 28672
    buffer_load_dwordx4 v[196:199], v184, s[24:27], s37 offen sc1
    s_add_u32 s37, s37, 28672
    buffer_load_dwordx4 v[200:203], v184, s[24:27], s37 offen sc1
    s_add_u32 s37, s37, 28672
    buffer_load_dwordx4 v[204:207], v184, s[24:27], s37 offen sc1
    s_add_u32 s37, s37, 28672
    s_waitcnt vmcnt(12)
    s_barrier
    buffer_load_dwordx4 v2, s[12:15], s39 offen sc1 lds
    buffer_load_dwordx4 v2, s[12:15], s39 offen offset:1024 sc1 lds
    s_add_u32 s19, s41, s42
    v_readlane_b32 s16, v248, s44
    s_nop 0
    s_add_u32 s16, s16, s38
    s_add_u32 s44, s44, 1
    s_and_b32 s44, s44, 15
    s_add_u32 s42, s42, 16384
    s_cmp_eq_u32 s42, 49152
    s_cselect_b32 s42, 0, s42
    s_add_u32 m0, m0, 2048
    s_add_u32 s39, s39, 65536
    buffer_load_dwordx4 v2, s[12:15], s39 offen sc1 lds
    buffer_load_dwordx4 v2, s[12:15], s39 offen offset:1024 sc1 lds
    s_add_u32 m0, m0, 2048
    s_add_u32 s39, s39, 65536
    buffer_load_dwordx4 v2, s[12:15], s39 offen sc1 lds
    buffer_load_dwordx4 v2, s[12:15], s39 offen offset:1024 sc1 lds
    s_add_u32 m0, m0, 2048
    s_add_u32 s39, s39, 65536
    buffer_load_dwordx4 v2, s[12:15], s39 offen sc1 lds
    buffer_load_dwordx4 v2, s[12:15], s39 offen offset:1024 sc1 lds
    s_mov_b32 m0, s19
    s_mov_b32 s39, s16
    buffer_load_dwordx4 v[208:211], v184, s[24:27], s37 offen sc1
    s_add_u32 s37, s37, 28672
    buffer_load_dwordx4 v[212:215], v184, s[24:27], s37 offen sc1
    s_add_u32 s37, s37, 28672
    buffer_load_dwordx4 v[216:219], v184, s[24:27], s37 offen sc1
    s_add_u32 s37, s37, 28672
    buffer_load_dwordx4 v[220:223], v184, s[24:27], s37 offen sc1
    s_add_u32 s37, s37, 28672
    buffer_load_dwordx4 v[224:227], v184, s[24:27], s37 offen sc1
    s_add_u32 s37, s37, 28672
    s_waitcnt vmcnt(17)
    s_barrier
    buffer_load_dwordx4 v2, s[12:15], s39 offen sc1 lds
    buffer_load_dwordx4 v2, s[12:15], s39 offen offset:1024 sc1 lds
    s_add_u32 s19, s41, s42
    v_readlane_b32 s16, v248, s44
    s_nop 0
    s_add_u32 s16, s16, s38
    s_add_u32 s44, s44, 1
    s_and_b32 s44, s44, 15
    s_add_u32 s42, s42, 16384
    s_cmp_eq_u32 s42, 49152
    s_cselect_b32 s42, 0, s42
    s_add_u32 m0, m0, 2048
    s_add_u32 s39, s39, 65536
    buffer_load_dwordx4 v2, s[12:15], s39 offen sc1 lds
    buffer_load_dwordx4 v2, s[12:15], s39 offen offset:1024 sc1 lds
    s_add_u32 m0, m0, 2048
    s_add_u32 s39, s39, 65536
    buffer_load_dwordx4 v2, s[12:15], s39 offen sc1 lds
    buffer_load_dwordx4 v2, s[12:15], s39 offen offset:1024 sc1 lds
    s_add_u32 m0, m0, 2048
    s_add_u32 s39, s39, 65536
    buffer_load_dwordx4 v2, s[12:15], s39 offen sc1 lds
    buffer_load_dwordx4 v2, s[12:15], s39 offen offset:1024 sc1 lds
    s_mov_b32 m0, s19
    s_mov_b32 s39, s16
    s_waitcnt vmcnt(13)
    s_barrier
    buffer_load_dwordx4 v2, s[12:15], s39 offen sc1 lds
    buffer_load_dwordx4 v2, s[12:15], s39 offen offset:1024 sc1 lds
    s_add_u32 s19, s41, s42
    v_readlane_b32 s16, v248, s44
    s_nop 0
    s_add_u32 s16, s16, s38
    s_add_u32 s44, s44, 1
    s_and_b32 s44, s44, 15
    s_add_u32 s42, s42, 16384
    s_cmp_eq_u32 s42, 49152
    s_cselect_b32 s42, 0, s42
    s_add_u32 m0, m0, 2048
    s_add_u32 s39, s39, 65536
    buffer_load_dwordx4 v2, s[12:15], s39 offen sc1 lds
    buffer_load_dwordx4 v2, s[12:15], s39 offen offset:1024 sc1 lds
    s_add_u32 m0, m0, 2048
    s_add_u32 s39, s39, 65536
    buffer_load_dwordx4 v2, s[12:15], s39 offen sc1 lds
    buffer_load_dwordx4 v2, s[12:15], s39 offen offset:1024 sc1 lds
    s_add_u32 m0, m0, 2048
    s_add_u32 s39, s39, 65536
    buffer_load_dwordx4 v2, s[12:15], s39 offen sc1 lds
    buffer_load_dwordx4 v2, s[12:15], s39 offen offset:1024 sc1 lds
    s_mov_b32 m0, s19
    s_mov_b32 s39, s16
    s_waitcnt vmcnt(16)
    s_cmp_lg_u32 s60, 0
    s_cbranch_scc1 pc_60
    v_pk_add_f32 v[192:193], v[192:193], v[196:197]
    v_pk_add_f32 v[194:195], v[194:195], v[198:199]
    v_pk_add_f32 v[192:193], v[192:193], v[200:201]
    v_pk_add_f32 v[194:195], v[194:195], v[202:203]
    v_pk_add_f32 v[192:193], v[192:193], v[204:205]
    v_pk_add_f32 v[194:195], v[194:195], v[206:207]
    v_pk_add_f32 v[192:193], v[192:193], v[208:209]
    v_pk_add_f32 v[194:195], v[194:195], v[210:211]
pc_60:
    s_mov_b64 exec, 1
    buffer_load_dword v183, v182, s[56:59], 0 offen sc1
    s_mov_b64 exec, -1
    s_waitcnt vmcnt(9)
    s_barrier
    buffer_load_dwordx4 v2, s[12:15], s39 offen sc1 lds
    buffer_load_dwordx4 v2, s[12:15], s39 offen offset:1024 sc1 lds
    s_add_u32 s19, s41, s42
    v_readlane_b32 s16, v248, s44
    s_nop 0
    s_add_u32 s16, s16, s38
    s_add_u32 s44, s44, 1
    s_and_b32 s44, s44, 15
    s_add_u32 s42, s42, 16384
    s_cmp_eq_u32 s42, 49152
    s_cselect_b32 s42, 0, s42
    s_add_u32 m0, m0, 2048
    s_add_u32 s39, s39, 65536
    buffer_load_dwordx4 v2, s[12:15], s39 offen sc1 lds
    buffer_load_dwordx4 v2, s[12:15], s39 offen offset:1024 sc1 lds
    s_add_u32 m0, m0, 2048
    s_add_u32 s39, s39, 65536
    buffer_load_dwordx4 v2, s[12:15], s39 offen sc1 lds
    buffer_load_dwordx4 v2, s[12:15], s39 offen offset:1024 sc1 lds
    s_add_u32 m0, m0, 2048
    s_add_u32 s39, s39, 65536
    buffer_load_dwordx4 v2, s[12:15], s39 offen sc1 lds
    buffer_load_dwordx4 v2, s[12:15], s39 offen offset:1024 sc1 lds
    s_mov_b32 m0, s19
    s_mov_b32 s39, s16
    s_cmp_lg_u32 s60, 0
    s_cbranch_scc1 pc_61
    v_pk_add_f32 v[192:193], v[192:193], v[212:213]
    v_pk_add_f32 v[194:195], v[194:195], v[214:215]
    v_pk_add_f32 v[192:193], v[192:193], v[216:217]
    v_pk_add_f32 v[194:195], v[194:195], v[218:219]
    v_pk_add_f32 v[192:193], v[192:193], v[220:221]
    v_pk_add_f32 v[194:195], v[194:195], v[222:223]
    v_pk_add_f32 v[192:193], v[192:193], v[224:225]
    v_pk_add_f32 v[194:195], v[194:195], v[226:227]
pc_61:
    buffer_load_dwordx4 v[196:199], v184, s[24:27], s37 offen sc1
    s_add_u32 s37, s37, 28672
    buffer_load_dwordx4 v[200:203], v184, s[24:27], s37 offen sc1
    s_add_u32 s37, s37, 28672
    buffer_load_dwordx4 v[204:207], v184, s[24:27], s37 offen sc1
    s_add_u32 s37, s37, 28672
    buffer_load_dwordx4 v[208:211], v184, s[24:27], s37 offen sc1
    s_add_u32 s37, s37, 28672
    buffer_load_dwordx4 v[212:215], v184, s[24:27], s37 offen sc1
    s_add_u32 s37, s37, 28672
    buffer_load_dwordx4 v[216:219], v184, s[24:27], s37 offen sc1
    s_add_u32 s37, s37, 28672
    buffer_load_dwordx4 v[220:223], v184, s[24:27], s37 offen sc1
    s_add_u32 s37, s37, 28672
    s_waitcnt vmcnt(16)
    s_barrier
    buffer_load_dwordx4 v2, s[12:15], s39 offen sc1 lds
    buffer_load_dwordx4 v2, s[12:15], s39 offen offset:1024 sc1 lds
    s_add_u32 s19, s41, s42
    v_readlane_b32 s16, v248, s44
    s_nop 0
    s_add_u32 s16, s16, s38
    s_add_u32 s44, s44, 1
    s_and_b32 s44, s44, 15
    s_add_u32 s42, s42, 16384
    s_cmp_eq_u32 s42, 49152
    s_cselect_b32 s42, 0, s42
    s_add_u32 m0, m0, 2048
    s_add_u32 s39, s39, 65536
    buffer_load_dwordx4 v2, s[12:15], s39 offen sc1 lds
    buffer_load_dwordx4 v2, s[12:15], s39 offen offset:1024 sc1 lds
    s_add_u32 m0, m0, 2048
    s_add_u32 s39, s39, 65536
    buffer_load_dwordx4 v2, s[12:15], s39 offen sc1 lds
    buffer_load_dwordx4 v2, s[12:15], s39 offen offset:1024 sc1 lds
    s_add_u32 m0, m0, 2048
    s_add_u32 s39, s39, 65536
    buffer_load_dwordx4 v2, s[12:15], s39 offen sc1 lds
    buffer_load_dwordx4 v2, s[12:15], s39 offen offset:1024 sc1 lds
    s_mov_b32 m0, s19
    s_mov_b32 s39, s16
    s_waitcnt vmcnt(23)
    v_readfirstlane_b32 s53, v183
    s_add_u32 s54, s52, 16
    s_cmp_eq_u32 s53, s54
    s_cbranch_scc1 fok_62
    s_mov_b32 s53, 0
    s_add_u32 s54, s52, 16
    s_bfm_b64 exec, 1, 0
poll_63:
    buffer_load_dword v183, v182, s[56:59], 0 offen sc1
    s_waitcnt vmcnt(0)
    v_xor_b32 v183, s54, v183
    v_cmp_eq_u32 vcc, 0, v183
    s_nop 0
    s_cmp_eq_u64 vcc, exec
    s_cbranch_scc1 pok_64
    s_sleep 5
    s_add_u32 s53, s53, 1
    s_cmp_lt_u32 s53, s61
    s_cbranch_scc1 poll_63
    s_mov_b32 s61, 0
pok_64:
    s_mov_b64 exec, -1
fok_62:
    s_add_u32 s20, s62, 0x1c8000
    s_addc_u32 s21, s63, 0
    s_mov_b32 s22, 0x6000
    s_mov_b32 s23, 0x20000
    s_and_b32 s35, s30, 1
    s_lshl_b32 s35, s35, 9
    s_add_u32 s36, s35, 0
    buffer_load_dwordx2 v[16:17], v181, s[20:23], s36 offen offset:0 sc1
    buffer_load_dwordx2 v[18:19], v181, s[20:23], s36 offen offset:1024 sc1
    buffer_load_dwordx2 v[20:21], v181, s[20:23], s36 offen offset:2048 sc1
    buffer_load_dwordx2 v[22:23], v181, s[20:23], s36 offen offset:3072 sc1
    s_add_u32 s36, s36, 4096
    buffer_load_dwordx2 v[24:25], v181, s[20:23], s36 offen offset:0 sc1
    buffer_load_dwordx2 v[26:27], v181, s[20:23], s36 offen offset:1024 sc1
    buffer_load_dwordx2 v[28:29], v181, s[20:23], s36 offen offset:2048 sc1
    buffer_load_dwordx2 v[30:31], v181, s[20:23], s36 offen offset:3072 sc1
    s_waitcnt vmcnt(23)
    s_barrier
    buffer_load_dwordx4 v2, s[12:15], s39 offen sc1 lds
    buffer_load_dwordx4 v2, s[12:15], s39 offen offset:1024 sc1 lds
    s_add_u32 s19, s41, s42
    v_readlane_b32 s16, v248, s44
    s_nop 0
    s_add_u32 s16, s16, s38
    s_add_u32 s44, s44, 1
    s_and_b32 s44, s44, 15
    s_add_u32 s42, s42, 16384
    s_cmp_eq_u32 s42, 49152
    s_cselect_b32 s42, 0, s42
    s_add_u32 m0, m0, 2048
    s_add_u32 s39, s39, 65536
    buffer_load_dwordx4 v2, s[12:15], s39 offen sc1 lds
    buffer_load_dwordx4 v2, s[12:15], s39 offen offset:1024 sc1 lds
    s_add_u32 m0, m0, 2048
    s_add_u32 s39, s39, 65536
    buffer_load_dwordx4 v2, s[12:15], s39 offen sc1 lds
    buffer_load_dwordx4 v2, s[12:15], s39 offen offset:1024 sc1 lds
    s_add_u32 m0, m0, 2048
    s_add_u32 s39, s39, 65536
    buffer_load_dwordx4 v2, s[12:15], s39 offen sc1 lds
    buffer_load_dwordx4 v2, s[12:15], s39 offen offset:1024 sc1 lds
    s_mov_b32 m0, s19
    s_mov_b32 s39, s16
    s_add_u32 s36, s35, 16384
    buffer_load_dwordx2 v[32:33], v181, s[20:23], s36 offen offset:0 sc1
    buffer_load_dwordx2 v[34:35], v181, s[20:23], s36 offen offset:1024 sc1
    buffer_load_dwordx2 v[36:37], v181, s[20:23], s36 offen offset:2048 sc1
    buffer_load_dwordx2 v[38:39], v181, s[20:23], s36 offen offset:3072 sc1
    s_add_u32 s36, s36, 4096
    buffer_load_dwordx2 v[40:41], v181, s[20:23], s36 offen offset:0 sc1
    buffer_load_dwordx2 v[42:43], v181, s[20:23], s36 offen offset:1024 sc1
    buffer_load_dwordx2 v[44:45], v181, s[20:23], s36 offen offset:2048 sc1
    buffer_load_dwordx2 v[46:47], v181, s[20:23], s36 offen offset:3072 sc1
    s_waitcnt vmcnt(24)
    s_barrier
    buffer_load_dwordx4 v2, s[12:15], s39 offen sc1 lds
    buffer_load_dwordx4 v2, s[12:15], s39 offen offset:1024 sc1 lds
    s_add_u32 s19, s41, s42
    v_readlane_b32 s16, v248, s44
    s_nop 0
    s_add_u32 s16, s16, s38
    s_add_u32 s44, s44, 1
    s_and_b32 s44, s44, 15
    s_add_u32 s42, s42, 16384
    s_cmp_eq_u32 s42, 49152
    s_cselect_b32 s42, 0, s42
    s_add_u32 m0, m0, 2048
    s_add_u32 s39, s39, 65536
    buffer_load_dwordx4 v2, s[12:15], s39 offen sc1 lds
    buffer_load_dwordx4 v2, s[12:15], s39 offen offset:1024 sc1 lds
    s_add_u32 m0, m0, 2048
    s_add_u32 s39, s39, 65536
    buffer_load_dwordx4 v2, s[12:15], s39 offen sc1 lds
    buffer_load_dwordx4 v2, s[12:15], s39 offen offset:1024 sc1 lds
    s_add_u32 m0, m0, 2048
    s_add_u32 s39, s39, 65536
    buffer_load_dwordx4 v2, s[12:15], s39 offen sc1 lds
    buffer_load_dwordx4 v2, s[12:15], s39 offen offset:1024 sc1 lds
    s_mov_b32 m0, s19
    s_mov_b32 s39, s16
    s_waitcnt vmcnt(40)
    s_cmp_lg_u32 s60, 0
    s_cbranch_scc1 pc_65
    v_pk_add_f32 v[192:193], v[192:193], v[196:197]
    v_pk_add_f32 v[194:195], v[194:195], v[198:199]
    v_pk_add_f32 v[192:193], v[192:193], v[200:201]
    v_pk_add_f32 v[194:195], v[194:195], v[202:203]
    v_pk_add_f32 v[192:193], v[192:193], v[204:205]
    v_pk_add_f32 v[194:195], v[194:195], v[206:207]
    v_pk_add_f32 v[192:193], v[192:193], v[208:209]
    v_pk_add_f32 v[194:195], v[194:195], v[210:211]
pc_65:
    s_waitcnt vmcnt(16)
    s_barrier
    buffer_load_dwordx4 v2, s[12:15], s39 offen sc1 lds
    buffer_load_dwordx4 v2, s[12:15], s39 offen offset:1024 sc1 lds
    s_add_u32 s19, s41, s42
    v_readlane_b32 s16, v248, s44
    s_nop 0
    s_add_u32 s16, s16, s38
    s_add_u32 s44, s44, 1
    s_and_b32 s44, s44, 15
    s_add_u32 s42, s42, 16384
    s_cmp_eq_u32 s42, 49152
    s_cselect_b32 s42, 0, s42
    s_add_u32 m0, m0, 2048
    s_add_u32 s39, s39, 65536
    buffer_load_dwordx4 v2, s[12:15], s39 offen sc1 lds
    buffer_load_dwordx4 v2, s[12:15], s39 offen offset:1024 sc1 lds
    s_add_u32 m0, m0, 2048
    s_add_u32 s39, s39, 65536
    buffer_load_dwordx4 v2, s[12:15], s39 offen sc1 lds
    buffer_load_dwordx4 v2, s[12:15], s39 offen offset:1024 sc1 lds
    s_add_u32 m0, m0, 2048
    s_add_u32 s39, s39, 65536
    buffer_load_dwordx4 v2, s[12:15], s39 offen sc1 lds
    buffer_load_dwordx4 v2, s[12:15], s39 offen offset:1024 sc1 lds
    s_mov_b32 m0, s19
    s_mov_b32 s39, s16
    s_cmp_lg_u32 s60, 0
    s_cbranch_scc1 pc_66
    v_pk_add_f32 v[192:193], v[192:193], v[212:213]
    v_pk_add_f32 v[194:195], v[194:195], v[214:215]
    v_pk_add_f32 v[192:193], v[192:193], v[216:217]
    v_pk_add_f32 v[194:195], v[194:195], v[218:219]
    v_pk_add_f32 v[192:193], v[192:193], v[220:221]
    v_pk_add_f32 v[194:195], v[194:195], v[222:223]
pc_66:
    s_waitcnt vmcnt(8)
    s_barrier
    buffer_load_dwordx4 v2, s[12:15], s39 offen sc1 lds
    buffer_load_dwordx4 v2, s[12:15], s39 offen offset:1024 sc1 lds
    s_add_u32 s19, s41, s42
    v_readlane_b32 s16, v248, s44
    s_nop 0
    s_add_u32 s16, s16, s38
    s_add_u32 s44, s44, 1
    s_and_b32 s44, s44, 15
    s_add_u32 s42, s42, 16384
    s_cmp_eq_u32 s42, 49152
    s_cselect_b32 s42, 0, s42
    s_add_u32 m0, m0, 2048
    s_add_u32 s39, s39, 65536
    buffer_load_dwordx4 v2, s[12:15], s39 offen sc1 lds
    buffer_load_dwordx4 v2, s[12:15], s39 offen offset:1024 sc1 lds
    s_add_u32 m0, m0, 2048
    s_add_u32 s39, s39, 65536
    buffer_load_dwordx4 v2, s[12:15], s39 offen sc1 lds
    buffer_load_dwordx4 v2, s[12:15], s39 offen offset:1024 sc1 lds
    s_add_u32 m0, m0, 2048
    s_add_u32 s39, s39, 65536
    buffer_load_dwordx4 v2, s[12:15], s39 offen sc1 lds
    buffer_load_dwordx4 v2, s[12:15], s39 offen offset:1024 sc1 lds
    s_mov_b32 m0, s19
    s_mov_b32 s39, s16
    s_cmp_lg_u32 s60, 0
    s_cbranch_scc1 pc_67
    v_mov_b32 v196, v192
    v_mov_b32 v197, v193
    v_mov_b32 v198, v194
    v_mov_b32 v199, v195
    v_permlane32_swap_b32 v192, v196
    v_permlane32_swap_b32 v193, v197
    v_permlane32_swap_b32 v194, v198
    v_permlane32_swap_b32 v195, v199
    v_pk_add_f32 v[192:193], v[192:193], v[196:197]
    v_pk_add_f32 v[194:195], v[194:195], v[198:199]
    s_and_b32 s36, s30, 1
    s_mul_i32 s36, s36, 448
    s_add_u32 s36, s36, 159744
    v_add_u32 v191, s36, v2
    s_bfm_b64 exec, 28, 0
    ds_write_b128 v191, v[192:195]
    s_mov_b64 exec, -1
    s_waitcnt lgkmcnt(0)
pc_67:
    s_waitcnt vmcnt(8)
    s_barrier
    buffer_load_dwordx4 v2, s[12:15], s39 offen sc1 lds
    buffer_load_dwordx4 v2, s[12:15], s39 offen offset:1024 sc1 lds
    s_add_u32 s19, s41, s42
    v_readlane_b32 s16, v248, s44
    s_nop 0
    s_add_u32 s16, s16, s38
    s_add_u32 s44, s44, 1
    s_and_b32 s44, s44, 15
    s_add_u32 s42, s42, 16384
    s_cmp_eq_u32 s42, 49152
    s_cselect_b32 s42, 0, s42
    s_add_u32 m0, m0, 2048
    s_add_u32 s39, s39, 65536
    buffer_load_dwordx4 v2, s[12:15], s39 offen sc1 lds
    buffer_load_dwordx4 v2, s[12:15], s39 offen offset:1024 sc1 lds
    s_add_u32 m0, m0, 2048
    s_add_u32 s39, s39, 65536
    buffer_load_dwordx4 v2, s[12:15], s39 offen sc1 lds
    buffer_load_dwordx4 v2, s[12:15], s39 offen offset:1024 sc1 lds
    s_add_u32 m0, m0, 2048
    s_add_u32 s39, s39, 65536
    buffer_load_dwordx4 v2, s[12:15], s39 offen sc1 lds
    buffer_load_dwordx4 v2, s[12:15], s39 offen offset:1024 sc1 lds
    s_mov_b32 m0, s19
    s_mov_b32 s39, s16
    s_waitcnt vmcnt(32)
    v_pk_add_f32 v[16:17], v[16:17], v[32:33]
    v_pk_add_f32 v[18:19], v[18:19], v[34:35]
    v_pk_add_f32 v[20:21], v[20:21], v[36:37]
    v_pk_add_f32 v[22:23], v[22:23], v[38:39]
    v_pk_add_f32 v[24:25], v[24:25], v[40:41]
    v_pk_add_f32 v[26:27], v[26:27], v[42:43]
    v_pk_add_f32 v[28:29], v[28:29], v[44:45]
    v_pk_add_f32 v[30:31], v[30:31], v[46:47]
    v_pk_add_f32 v[16:17], v[16:17], v[24:25]
    v_pk_add_f32 v[18:19], v[18:19], v[26:27]
    v_pk_add_f32 v[20:21], v[20:21], v[28:29]
    v_pk_add_f32 v[22:23], v[22:23], v[30:31]
    s_waitcnt vmcnt(8)
    s_barrier
    buffer_load_dwordx4 v2, s[12:15], s39 offen sc1 lds
    buffer_load_dwordx4 v2, s[12:15], s39 offen offset:1024 sc1 lds
    s_add_u32 s19, s41, s42
    v_readlane_b32 s16, v248, s44
    s_nop 0
    s_add_u32 s16, s16, s38
    s_add_u32 s44, s44, 1
    s_and_b32 s44, s44, 15
    s_add_u32 s42, s42, 16384
    s_cmp_eq_u32 s42, 49152
    s_cselect_b32 s42, 0, s42
    s_add_u32 m0, m0, 2048
    s_add_u32 s39, s39, 65536
    buffer_load_dwordx4 v2, s[12:15], s39 offen sc1 lds
    buffer_load_dwordx4 v2, s[12:15], s39 offen offset:1024 sc1 lds
    s_add_u32 m0, m0, 2048
    s_add_u32 s39, s39, 65536
    buffer_load_dwordx4 v2, s[12:15], s39 offen sc1 lds
    buffer_load_dwordx4 v2, s[12:15], s39 offen offset:1024 sc1 lds
    s_add_u32 m0, m0, 2048
    s_add_u32 s39, s39, 65536
    buffer_load_dwordx4 v2, s[12:15], s39 offen sc1 lds
    buffer_load_dwordx4 v2, s[12:15], s39 offen offset:1024 sc1 lds
    s_mov_b32 m0, s19
    s_mov_b32 s39, s16
    v_pk_add_f32 v[16:17], v[16:17], v[20:21]
    v_pk_add_f32 v[18:19], v[18:19], v[22:23]
    v_pk_add_f32 v[16:17], v[16:17], v[18:19]
    v_mul_f32 v178, 0x3a800000, v16
    v_mul_f32 v177, 0x3a800000, v17
    v_fma_f32 v177, -v178, v178, v177
    v_max_f32 v177, 0, v177
    v_cvt_pk_bf16_f32 v178, v178, v178
    v_lshlrev_b32 v178, 16, v178
    v_cvt_pk_bf16_f32 v177, v177, v177
    v_lshlrev_b32 v177, 16, v177
    s_waitcnt vmcnt(8)
    s_barrier
    buffer_load_dwordx4 v2, s[12:15], s39 offen sc1 lds
    buffer_load_dwordx4 v2, s[12:15], s39 offen offset:1024 sc1 lds
    s_add_u32 m0, m0, 2048
    s_add_u32 s39, s39, 65536
    buffer_load_dwordx4 v2, s[12:15], s39 offen sc1 lds
    buffer_load_dwordx4 v2, s[12:15], s39 offen offset:1024 sc1 lds
    s_add_u32 m0, m0, 2048
    s_add_u32 s39, s39, 65536
    buffer_load_dwordx4 v2, s[12:15], s39 offen sc1 lds
    buffer_load_dwordx4 v2, s[12:15], s39 offen offset:1024 sc1 lds
    s_add_u32 m0, m0, 2048
    s_add_u32 s39, s39, 65536
    buffer_load_dwordx4 v2, s[12:15], s39 offen sc1 lds
    buffer_load_dwordx4 v2, s[12:15], s39 offen offset:1024 sc1 lds
    v_add_f32 v177, 0x3727c5ac, v177
    v_cvt_pk_bf16_f32 v177, v177, v177
    v_lshlrev_b32 v177, 16, v177
    v_sqrt_f32 v177, v177
    s_nop 0
    v_cvt_pk_bf16_f32 v177, v177, v177
    v_lshlrev_b32 v177, 16, v177
    v_rcp_f32 v179, v177
    s_add_u32 s35, s35, 160768
    v_add_u32 v180, s35, v181
    ds_write_b64 v180, v[178:179]
    s_waitcnt lgkmcnt(0)
    s_waitcnt vmcnt(8)
    s_barrier
    s_waitcnt vmcnt(0)
    s_barrier
    s_cmp_lg_u32 s60, 0
    s_cbranch_scc1 tw4_71
    s_load_dwordx2 s[48:49], s[0:1], 80
    s_lshl_b32 s45, s2, 1
    s_and_b32 s50, s30, 1
    s_add_u32 s45, s45, s50
    s_mul_i32 s45, s45, 14336
    s_mov_b32 s50, 7340032
    s_mov_b32 s51, 0x20000
    s_waitcnt lgkmcnt(0)
    buffer_load_dwordx4 v[232:235], v2, s[48:51], s45 offen offset:0
    buffer_load_dwordx4 v[232:235], v2, s[48:51], s45 offen offset:1024
    buffer_load_dwordx4 v[232:235], v2, s[48:51], s45 offen offset:2048
    buffer_load_dwordx4 v[232:235], v2, s[48:51], s45 offen offset:3072
    s_add_u32 s45, s45, 4096
    buffer_load_dwordx4 v[232:235], v2, s[48:51], s45 offen offset:0
    buffer_load_dwordx4 v[232:235], v2, s[48:51], s45 offen offset:1024
    buffer_load_dwordx4 v[232:235], v2, s[48:51], s45 offen offset:2048
    buffer_load_dwordx4 v[232:235], v2, s[48:51], s45 offen offset:3072
    s_add_u32 s45, s45, 4096
    buffer_load_dwordx4 v[232:235], v2, s[48:51], s45 offen offset:0
    buffer_load_dwordx4 v[232:235], v2, s[48:51], s45 offen offset:1024
    buffer_load_dwordx4 v[232:235], v2, s[48:51], s45 offen offset:2048
    buffer_load_dwordx4 v[232:235], v2, s[48:51], s45 offen offset:3072
    s_add_u32 s45, s45, 4096
    buffer_load_dwordx4 v[232:235], v2, s[48:51], s45 offen offset:0
    buffer_load_dwordx4 v[232:235], v2, s[48:51], s45 offen offset:1024
tw4_71:
    s_barrier
    s_and_b32 s35, s30, 1
    s_mov_b32 s12, s62
    s_mov_b32 s13, s63
    s_mov_b32 s14, 0x1be000
    s_mov_b32 s15, 0x20000
    s_mul_i32 s38, s35, 917504
    s_mul_i32 s36, s31, 114688
    s_add_u32 s38, s38, s36
    s_lshl_b32 s41, s35, 13
    s_mov_b32 s42, 0
    s_mov_b32 s44, 0
    s_add_u32 s54, s55, 0x700
    s_lshl_b32 s53, s31, 7
    s_add_u32 s54, s54, s53
    v_mov_b32 v9, s54
    s_add_u32 s54, s55, 0x600
    s_lshl_b32 s53, s31, 7
    s_add_u32 s54, s54, s53
    v_mov_b32 v10, s54
    s_add_u32 s54, s55, 0x300
    s_lshl_b32 s53, s31, 7
    s_add_u32 s54, s54, s53
    v_mov_b32 v12, s54
    s_lshl_b32 s54, s60, 2
    s_add_u32 s54, s54, 3
    v_mov_b32 v14, 162872
spin_72:
    s_sleep 8
    ds_read_b32 v15, v14
    s_waitcnt lgkmcnt(0)
    v_readfirstlane_b32 s53, v15
    s_nop 0
    s_cmp_ge_u32 s53, s54
    s_cbranch_scc0 spin_72
    s_mov_b32 s53, 0
    s_add_u32 s54, s52, 8
    s_bfm_b64 exec, 1, 0
poll_73:
    buffer_load_dword v8, v9, s[56:59], 0 offen sc1
    s_waitcnt vmcnt(0)
    v_xor_b32 v8, s54, v8
    v_cmp_eq_u32 vcc, 0, v8
    s_nop 0
    s_cmp_eq_u64 vcc, exec
    s_cbranch_scc1 pok_74
    s_sleep 5
    s_add_u32 s53, s53, 1
    s_cmp_lt_u32 s53, s61
    s_cbranch_scc1 poll_73
    s_mov_b32 s61, 0
pok_74:
    s_mov_b64 exec, -1
    s_mov_b32 s44, 3
    s_call_b64 s[76:77], PREP_a_issue_4
    s_mov_b32 m0, s19
    s_mov_b32 s39, s16
    s_mov_b32 s40, s17
    s_waitcnt vmcnt(16)
    s_barrier
    s_waitcnt vmcnt(8)
    s_barrier
    buffer_load_dwordx4 v2, s[12:15], s39 offen sc1 lds
    s_add_u32 m0, m0, 1024
    s_nop 0
    buffer_load_dwordx4 v2, s[12:15], s40 offen sc1 lds
    s_mov_b32 s43, 1
ld_75:
    s_add_u32 s19, s41, s42
    v_readlane_b32 s16, v249, s44
    v_readlane_b32 s17, v250, s44
    s_add_u32 s16, s16, s38
    s_add_u32 s17, s17, s38
    s_add_u32 s44, s44, 1
    s_add_u32 s42, s42, 16384
    s_cmp_eq_u32 s42, 49152
    s_cselect_b32 s42, 0, s42
    s_add_u32 m0, m0, 1024
    s_add_u32 s39, s39, 229376
    buffer_load_dwordx4 v2, s[12:15], s39 offen sc1 lds
    s_add_u32 m0, m0, 1024
    s_add_u32 s40, s40, 229376
    buffer_load_dwordx4 v2, s[12:15], s40 offen sc1 lds
    s_add_u32 m0, m0, 1024
    s_add_u32 s39, s39, 229376
    buffer_load_dwordx4 v2, s[12:15], s39 offen sc1 lds
    s_add_u32 m0, m0, 1024
    s_add_u32 s40, s40, 229376
    buffer_load_dwordx4 v2, s[12:15], s40 offen sc1 lds
    s_add_u32 m0, m0, 1024
    s_add_u32 s39, s39, 229376
    buffer_load_dwordx4 v2, s[12:15], s39 offen sc1 lds
    s_add_u32 m0, m0, 1024
    s_add_u32 s40, s40, 229376
    buffer_load_dwordx4 v2, s[12:15], s40 offen sc1 lds
    s_mov_b32 m0, s19
    s_mov_b32 s39, s16
    s_mov_b32 s40, s17
    s_waitcnt vmcnt(8)
    s_barrier
    buffer_load_dwordx4 v2, s[12:15], s39 offen sc1 lds
    s_add_u32 m0, m0, 1024
    s_nop 0
    buffer_load_dwordx4 v2, s[12:15], s40 offen sc1 lds
    s_add_u32 s43, s43, 1
    s_cmp_lt_u32 s43, 4
    s_cbranch_scc1 ld_75
    s_call_b64 s[76:77], PREP_a_issue_4
    s_add_u32 m0, m0, 1024
    s_add_u32 s39, s39, 229376
    buffer_load_dwordx4 v2, s[12:15], s39 offen sc1 lds
    s_add_u32 m0, m0, 1024
    s_add_u32 s40, s40, 229376
    buffer_load_dwordx4 v2, s[12:15], s40 offen sc1 lds
    s_add_u32 m0, m0, 1024
    s_add_u32 s39, s39, 229376
    buffer_load_dwordx4 v2, s[12:15], s39 offen sc1 lds
    s_add_u32 m0, m0, 1024
    s_add_u32 s40, s40, 229376
    buffer_load_dwordx4 v2, s[12:15], s40 offen sc1 lds
    s_add_u32 m0, m0, 1024
    s_add_u32 s39, s39, 229376
    buffer_load_dwordx4 v2, s[12:15], s39 offen sc1 lds
    s_add_u32 m0, m0, 1024
    s_add_u32 s40, s40, 229376
    buffer_load_dwordx4 v2, s[12:15], s40 offen sc1 lds
    s_mov_b32 m0, s19
    s_mov_b32 s39, s16
    s_mov_b32 s40, s17
    s_waitcnt vmcnt(8)
    s_barrier
    buffer_load_dwordx4 v2, s[12:15], s39 offen sc1 lds
    s_add_u32 m0, m0, 1024
    s_nop 0
    buffer_load_dwordx4 v2, s[12:15], s40 offen sc1 lds
    s_mov_b64 exec, 1
    buffer_load_dword v11, v10, s[56:59], 0 offen sc1
    s_mov_b64 exec, -1
    s_call_b64 s[76:77], PREP_a_issue_4
    s_add_u32 m0, m0, 1024
    s_add_u32 s39, s39, 229376
    buffer_load_dwordx4 v2, s[12:15], s39 offen sc1 lds
    s_add_u32 m0, m0, 1024
    s_add_u32 s40, s40, 229376
    buffer_load_dwordx4 v2, s[12:15], s40 offen sc1 lds
    s_add_u32 m0, m0, 1024
    s_add_u32 s39, s39, 229376
    buffer_load_dwordx4 v2, s[12:15], s39 offen sc1 lds
    s_add_u32 m0, m0, 1024
    s_add_u32 s40, s40, 229376
    buffer_load_dwordx4 v2, s[12:15], s40 offen sc1 lds
    s_add_u32 m0, m0, 1024
    s_add_u32 s39, s39, 229376
    buffer_load_dwordx4 v2, s[12:15], s39 offen sc1 lds
    s_add_u32 m0, m0, 1024
    s_add_u32 s40, s40, 229376
    buffer_load_dwordx4 v2, s[12:15], s40 offen sc1 lds
    s_mov_b32 m0, s19
    s_mov_b32 s39, s16
    s_mov_b32 s40, s17
    s_waitcnt vmcnt(9)
    s_barrier
    buffer_load_dwordx4 v2, s[12:15], s39 offen sc1 lds
    s_add_u32 m0, m0, 1024
    s_nop 0
    buffer_load_dwordx4 v2, s[12:15], s40 offen sc1 lds
    s_call_b64 s[76:77], PREP_a_issue_4
    s_add_u32 m0, m0, 1024
    s_add_u32 s39, s39, 229376
    buffer_load_dwordx4 v2, s[12:15], s39 offen sc1 lds
    s_add_u32 m0, m0, 1024
    s_add_u32 s40, s40, 229376
    buffer_load_dwordx4 v2, s[12:15], s40 offen sc1 lds
    s_add_u32 m0, m0, 1024
    s_add_u32 s39, s39, 229376
    buffer_load_dwordx4 v2, s[12:15], s39 offen sc1 lds
    s_add_u32 m0, m0, 1024
    s_add_u32 s40, s40, 229376
    buffer_load_dwordx4 v2, s[12:15], s40 offen sc1 lds
    s_add_u32 m0, m0, 1024
    s_add_u32 s39, s39, 229376
    buffer_load_dwordx4 v2, s[12:15], s39 offen sc1 lds
    s_add_u32 m0, m0, 1024
    s_add_u32 s40, s40, 229376
    buffer_load_dwordx4 v2, s[12:15], s40 offen sc1 lds
    s_mov_b32 m0, s19
    s_mov_b32 s39, s16
    s_mov_b32 s40, s17
    s_waitcnt vmcnt(8)
    s_barrier
    buffer_load_dwordx4 v2, s[12:15], s39 offen sc1 lds
    s_add_u32 m0, m0, 1024
    s_nop 0
    buffer_load_dwordx4 v2, s[12:15], s40 offen sc1 lds
    s_waitcnt vmcnt(16)
    v_readfirstlane_b32 s53, v11
    s_add_u32 s54, s52, 8
    s_cmp_eq_u32 s53, s54
    s_cbranch_scc1 fok_76
    s_mov_b32 s53, 0
    s_add_u32 s54, s52, 8
    s_bfm_b64 exec, 1, 0
poll_77:
    buffer_load_dword v11, v10, s[56:59], 0 offen sc1
    s_waitcnt vmcnt(0)
    v_xor_b32 v11, s54, v11
    v_cmp_eq_u32 vcc, 0, v11
    s_nop 0
    s_cmp_eq_u64 vcc, exec
    s_cbranch_scc1 pok_78
    s_sleep 5
    s_add_u32 s53, s53, 1
    s_cmp_lt_u32 s53, s61
    s_cbranch_scc1 poll_77
    s_mov_b32 s61, 0
pok_78:
    s_mov_b64 exec, -1
fok_76:
    s_call_b64 s[76:77], PREP_a_issue_4
    s_add_u32 m0, m0, 1024
    s_add_u32 s39, s39, 229376
    buffer_load_dwordx4 v2, s[12:15], s39 offen sc1 lds
    s_add_u32 m0, m0, 1024
    s_add_u32 s40, s40, 229376
    buffer_load_dwordx4 v2, s[12:15], s40 offen sc1 lds
    s_add_u32 m0, m0, 1024
    s_add_u32 s39, s39, 229376
    buffer_load_dwordx4 v2, s[12:15], s39 offen sc1 lds
    s_add_u32 m0, m0, 1024
    s_add_u32 s40, s40, 229376
    buffer_load_dwordx4 v2, s[12:15], s40 offen sc1 lds
    s_add_u32 m0, m0, 1024
    s_add_u32 s39, s39, 229376
    buffer_load_dwordx4 v2, s[12:15], s39 offen sc1 lds
    s_add_u32 m0, m0, 1024
    s_add_u32 s40, s40, 229376
    buffer_load_dwordx4 v2, s[12:15], s40 offen sc1 lds
    s_mov_b32 m0, s19
    s_mov_b32 s39, s16
    s_mov_b32 s40, s17
    s_waitcnt vmcnt(8)
    s_barrier
    buffer_load_dwordx4 v2, s[12:15], s39 offen sc1 lds
    s_add_u32 m0, m0, 1024
    s_nop 0
    buffer_load_dwordx4 v2, s[12:15], s40 offen sc1 lds
    s_mov_b32 s43, 1
ld_79:
    s_add_u32 s19, s41, s42
    v_readlane_b32 s16, v249, s44
    v_readlane_b32 s17, v250, s44
    s_add_u32 s16, s16, s38
    s_add_u32 s17, s17, s38
    s_add_u32 s44, s44, 1
    s_add_u32 s42, s42, 16384
    s_cmp_eq_u32 s42, 49152
    s_cselect_b32 s42, 0, s42
    s_add_u32 m0, m0, 1024
    s_add_u32 s39, s39, 229376
    buffer_load_dwordx4 v2, s[12:15], s39 offen sc1 lds
    s_add_u32 m0, m0, 1024
    s_add_u32 s40, s40, 229376
    buffer_load_dwordx4 v2, s[12:15], s40 offen sc1 lds
    s_add_u32 m0, m0, 1024
    s_add_u32 s39, s39, 229376
    buffer_load_dwordx4 v2, s[12:15], s39 offen sc1 lds
    s_add_u32 m0, m0, 1024
    s_add_u32 s40, s40, 229376
    buffer_load_dwordx4 v2, s[12:15], s40 offen sc1 lds
    s_add_u32 m0, m0, 1024
    s_add_u32 s39, s39, 229376
    buffer_load_dwordx4 v2, s[12:15], s39 offen sc1 lds
    s_add_u32 m0, m0, 1024
    s_add_u32 s40, s40, 229376
    buffer_load_dwordx4 v2, s[12:15], s40 offen sc1 lds
    s_mov_b32 m0, s19
    s_mov_b32 s39, s16
    s_mov_b32 s40, s17
    s_waitcnt vmcnt(8)
    s_barrier
    buffer_load_dwordx4 v2, s[12:15], s39 offen sc1 lds
    s_add_u32 m0, m0, 1024
    s_nop 0
    buffer_load_dwordx4 v2, s[12:15], s40 offen sc1 lds
    s_add_u32 s43, s43, 1
    s_cmp_lt_u32 s43, 4
    s_cbranch_scc1 ld_79
    s_call_b64 s[76:77], PREP_a_issue_4
    s_add_u32 m0, m0, 1024
    s_add_u32 s39, s39, 229376
    buffer_load_dwordx4 v2, s[12:15], s39 offen sc1 lds
    s_add_u32 m0, m0, 1024
    s_add_u32 s40, s40, 229376
    buffer_load_dwordx4 v2, s[12:15], s40 offen sc1 lds
    s_add_u32 m0, m0, 1024
    s_add_u32 s39, s39, 229376
    buffer_load_dwordx4 v2, s[12:15], s39 offen sc1 lds
    s_add_u32 m0, m0, 1024
    s_add_u32 s40, s40, 229376
    buffer_load_dwordx4 v2, s[12:15], s40 offen sc1 lds
    s_add_u32 m0, m0, 1024
    s_add_u32 s39, s39, 229376
    buffer_load_dwordx4 v2, s[12:15], s39 offen sc1 lds
    s_add_u32 m0, m0, 1024
    s_add_u32 s40, s40, 229376
    buffer_load_dwordx4 v2, s[12:15], s40 offen sc1 lds
    s_mov_b32 m0, s19
    s_mov_b32 s39, s16
    s_mov_b32 s40, s17
    s_waitcnt vmcnt(8)
    s_barrier
    buffer_load_dwordx4 v2, s[12:15], s39 offen sc1 lds
    s_add_u32 m0, m0, 1024
    s_nop 0
    buffer_load_dwordx4 v2, s[12:15], s40 offen sc1 lds
    s_mov_b64 exec, 1
    buffer_load_dword v11, v12, s[56:59], 0 offen sc1
    s_mov_b64 exec, -1
    s_call_b64 s[76:77], PREP_a_issue_4
    s_add_u32 m0, m0, 1024
    s_add_u32 s39, s39, 229376
    buffer_load_dwordx4 v2, s[12:15], s39 offen sc1 lds
    s_add_u32 m0, m0, 1024
    s_add_u32 s40, s40, 229376
    buffer_load_dwordx4 v2, s[12:15], s40 offen sc1 lds
    s_add_u32 m0, m0, 1024
    s_add_u32 s39, s39, 229376
    buffer_load_dwordx4 v2, s[12:15], s39 offen sc1 lds
    s_add_u32 m0, m0, 1024
    s_add_u32 s40, s40, 229376
    buffer_load_dwordx4 v2, s[12:15], s40 offen sc1 lds
    s_add_u32 m0, m0, 1024
    s_add_u32 s39, s39, 229376
    buffer_load_dwordx4 v2, s[12:15], s39 offen sc1 lds
    s_add_u32 m0, m0, 1024
    s_add_u32 s40, s40, 229376
    buffer_load_dwordx4 v2, s[12:15], s40 offen sc1 lds
    s_mov_b32 m0, s19
    s_mov_b32 s39, s16
    s_mov_b32 s40, s17
    s_waitcnt vmcnt(9)
    s_barrier
    buffer_load_dwordx4 v2, s[12:15], s39 offen sc1 lds
    s_add_u32 m0, m0, 1024
    s_nop 0
    buffer_load_dwordx4 v2, s[12:15], s40 offen sc1 lds
    s_call_b64 s[76:77], PREP_a_issue_4
    s_add_u32 m0, m0, 1024
    s_add_u32 s39, s39, 229376
    buffer_load_dwordx4 v2, s[12:15], s39 offen sc1 lds
    s_add_u32 m0, m0, 1024
    s_add_u32 s40, s40, 229376
    buffer_load_dwordx4 v2, s[12:15], s40 offen sc1 lds
    s_add_u32 m0, m0, 1024
    s_add_u32 s39, s39, 229376
    buffer_load_dwordx4 v2, s[12:15], s39 offen sc1 lds
    s_add_u32 m0, m0, 1024
    s_add_u32 s40, s40, 229376
    buffer_load_dwordx4 v2, s[12:15], s40 offen sc1 lds
    s_add_u32 m0, m0, 1024
    s_add_u32 s39, s39, 229376
    buffer_load_dwordx4 v2, s[12:15], s39 offen sc1 lds
    s_add_u32 m0, m0, 1024
    s_add_u32 s40, s40, 229376
    buffer_load_dwordx4 v2, s[12:15], s40 offen sc1 lds
    s_mov_b32 m0, s19
    s_mov_b32 s39, s16
    s_mov_b32 s40, s17
    s_waitcnt vmcnt(8)
    s_barrier
    buffer_load_dwordx4 v2, s[12:15], s39 offen sc1 lds
    s_add_u32 m0, m0, 1024
    s_nop 0
    buffer_load_dwordx4 v2, s[12:15], s40 offen sc1 lds
    s_waitcnt vmcnt(16)
    v_readfirstlane_b32 s53, v11
    s_add_u32 s54, s52, 8
    s_cmp_eq_u32 s53, s54
    s_cbranch_scc1 fok_80
    s_mov_b32 s53, 0
    s_add_u32 s54, s52, 8
    s_bfm_b64 exec, 1, 0
poll_81:
    buffer_load_dword v11, v12, s[56:59], 0 offen sc1
    s_waitcnt vmcnt(0)
    v_xor_b32 v11, s54, v11
    v_cmp_eq_u32 vcc, 0, v11
    s_nop 0
    s_cmp_eq_u64 vcc, exec
    s_cbranch_scc1 pok_82
    s_sleep 5
    s_add_u32 s53, s53, 1
    s_cmp_lt_u32 s53, s61
    s_cbranch_scc1 poll_81
    s_mov_b32 s61, 0
pok_82:
    s_mov_b64 exec, -1
fok_80:
    s_call_b64 s[76:77], PREP_a_issue_4
    s_add_u32 m0, m0, 1024
    s_add_u32 s39, s39, 229376
    buffer_load_dwordx4 v2, s[12:15], s39 offen sc1 lds
    s_add_u32 m0, m0, 1024
    s_add_u32 s40, s40, 229376
    buffer_load_dwordx4 v2, s[12:15], s40 offen sc1 lds
    s_add_u32 m0, m0, 1024
    s_add_u32 s39, s39, 229376
    buffer_load_dwordx4 v2, s[12:15], s39 offen sc1 lds
    s_add_u32 m0, m0, 1024
    s_add_u32 s40, s40, 229376
    buffer_load_dwordx4 v2, s[12:15], s40 offen sc1 lds
    s_add_u32 m0, m0, 1024
    s_add_u32 s39, s39, 229376
    buffer_load_dwordx4 v2, s[12:15], s39 offen sc1 lds
    s_add_u32 m0, m0, 1024
    s_add_u32 s40, s40, 229376
    buffer_load_dwordx4 v2, s[12:15], s40 offen sc1 lds
    s_mov_b32 m0, s19
    s_mov_b32 s39, s16
    s_mov_b32 s40, s17
    s_waitcnt vmcnt(8)
    s_barrier
    buffer_load_dwordx4 v2, s[12:15], s39 offen sc1 lds
    s_add_u32 m0, m0, 1024
    s_nop 0
    buffer_load_dwordx4 v2, s[12:15], s40 offen sc1 lds
    s_mov_b32 s43, 1
ld_83:
    s_add_u32 s19, s41, s42
    v_readlane_b32 s16, v249, s44
    v_readlane_b32 s17, v250, s44
    s_add_u32 s16, s16, s38
    s_add_u32 s17, s17, s38
    s_add_u32 s44, s44, 1
    s_add_u32 s42, s42, 16384
    s_cmp_eq_u32 s42, 49152
    s_cselect_b32 s42, 0, s42
    s_add_u32 m0, m0, 1024
    s_add_u32 s39, s39, 229376
    buffer_load_dwordx4 v2, s[12:15], s39 offen sc1 lds
    s_add_u32 m0, m0, 1024
    s_add_u32 s40, s40, 229376
    buffer_load_dwordx4 v2, s[12:15], s40 offen sc1 lds
    s_add_u32 m0, m0, 1024
    s_add_u32 s39, s39, 229376
    buffer_load_dwordx4 v2, s[12:15], s39 offen sc1 lds
    s_add_u32 m0, m0, 1024
    s_add_u32 s40, s40, 229376
    buffer_load_dwordx4 v2, s[12:15], s40 offen sc1 lds
    s_add_u32 m0, m0, 1024
    s_add_u32 s39, s39, 229376
    buffer_load_dwordx4 v2, s[12:15], s39 offen sc1 lds
    s_add_u32 m0, m0, 1024
    s_add_u32 s40, s40, 229376
    buffer_load_dwordx4 v2, s[12:15], s40 offen sc1 lds
    s_mov_b32 m0, s19
    s_mov_b32 s39, s16
    s_mov_b32 s40, s17
    s_waitcnt vmcnt(8)
    s_barrier
    buffer_load_dwordx4 v2, s[12:15], s39 offen sc1 lds
    s_add_u32 m0, m0, 1024
    s_nop 0
    buffer_load_dwordx4 v2, s[12:15], s40 offen sc1 lds
    s_add_u32 s43, s43, 1
    s_cmp_lt_u32 s43, 10
    s_cbranch_scc1 ld_83
    s_call_b64 s[76:77], PREP_a_issue_4
    s_add_u32 m0, m0, 1024
    s_add_u32 s39, s39, 229376
    buffer_load_dwordx4 v2, s[12:15], s39 offen sc1 lds
    s_add_u32 m0, m0, 1024
    s_add_u32 s40, s40, 229376
    buffer_load_dwordx4 v2, s[12:15], s40 offen sc1 lds
    s_add_u32 m0, m0, 1024
    s_add_u32 s39, s39, 229376
    buffer_load_dwordx4 v2, s[12:15], s39 offen sc1 lds
    s_add_u32 m0, m0, 1024
    s_add_u32 s40, s40, 229376
    buffer_load_dwordx4 v2, s[12:15], s40 offen sc1 lds
    s_add_u32 m0, m0, 1024
    s_add_u32 s39, s39, 229376
    buffer_load_dwordx4 v2, s[12:15], s39 offen sc1 lds
    s_add_u32 m0, m0, 1024
    s_add_u32 s40, s40, 229376
    buffer_load_dwordx4 v2, s[12:15], s40 offen sc1 lds
    s_mov_b32 m0, s19
    s_mov_b32 s39, s16
    s_mov_b32 s40, s17
    s_waitcnt vmcnt(8)
    s_barrier
    buffer_load_dwordx4 v2, s[12:15], s39 offen sc1 lds
    s_add_u32 m0, m0, 1024
    s_nop 0
    buffer_load_dwordx4 v2, s[12:15], s40 offen sc1 lds
    s_add_u32 m0, m0, 1024
    s_add_u32 s39, s39, 229376
    buffer_load_dwordx4 v2, s[12:15], s39 offen sc1 lds
    s_add_u32 m0, m0, 1024
    s_add_u32 s40, s40, 229376
    buffer_load_dwordx4 v2, s[12:15], s40 offen sc1 lds
    s_add_u32 m0, m0, 1024
    s_add_u32 s39, s39, 229376
    buffer_load_dwordx4 v2, s[12:15], s39 offen sc1 lds
    s_add_u32 m0, m0, 1024
    s_add_u32 s40, s40, 229376
    buffer_load_dwordx4 v2, s[12:15], s40 offen sc1 lds
    s_add_u32 m0, m0, 1024
    s_add_u32 s39, s39, 229376
    buffer_load_dwordx4 v2, s[12:15], s39 offen sc1 lds
    s_add_u32 m0, m0, 1024
    s_add_u32 s40, s40, 229376
    buffer_load_dwordx4 v2, s[12:15], s40 offen sc1 lds
    s_waitcnt vmcnt(8)
    s_barrier
    s_waitcnt vmcnt(0)
    s_barrier
    s_cmp_eq_u32 s60, 1
    s_cbranch_scc1 K_fin
    v_and_b32 v179, 7, v0
    v_lshrrev_b32 v204, 6, v0
    v_lshlrev_b32 v204, 4, v204
    v_bfe_u32 v205, v0, 3, 3
    v_add_u32 v204, v204, v205
    s_lshr_b32 s78, s29, 1
    s_lshl_b32 s78, s78, 16
    s_and_b32 s79, s29, 1
    s_lshl_b32 s79, s79, 7
    s_add_u32 s78, s78, s79
    s_lshr_b32 s79, s30, 1
    s_lshl_b32 s79, s79, 13
    s_add_u32 s78, s78, s79
    v_lshlrev_b32 v176, 8, v204
    v_lshl_add_u32 v176, v179, 4, v176
    v_add_u32 v176, s78, v176
    s_lshl_b32 s78, s28, 7
    s_lshl_b32 s79, s29, 3
    s_add_u32 s78, s78, s79
    v_add_u32 v177, s78, v179
    v_lshlrev_b32 v178, 11, v177
    v_lshrrev_b32 v205, 2, v204
    v_lshlrev_b32 v205, 3, v205
    v_and_b32 v204, 3, v204
    v_add_u32 v204, v204, v205
    v_lshl_add_u32 v178, v204, 3, v178
    v_lshlrev_b32 v177, 3, v177
    v_lshl_add_u32 v177, v204, 14, v177
    s_add_u32 s84, s62, 0x400000
    s_addc_u32 s85, s63, 0
    s_mov_b32 s86, 0x7e000
    s_mov_b32 s87, 0x20000
    s_add_u32 s88, s62, 0x480000
    s_addc_u32 s89, s63, 0
    s_mov_b32 s90, 0x7e000
    s_mov_b32 s91, 0x20000
    buffer_load_dwordx4 v[180:183], v176, s[84:87], 0 offen offset:0 sc1
    buffer_load_dwordx4 v[188:191], v176, s[88:91], 0 offen offset:0 sc1
    buffer_load_dwordx4 v[184:187], v176, s[84:87], 0 offen offset:2048 sc1
    buffer_load_dwordx4 v[192:195], v176, s[88:91], 0 offen offset:2048 sc1
    s_add_u32 s80, s4, 0x1c00000
    s_addc_u32 s81, s5, 0
    s_mov_b32 s82, 0x400000
    s_mov_b32 s83, 0x20000
    s_mov_b32 s78, 0
    buffer_load_dwordx2 v[196:197], v177, s[80:83], s78 offen sc1
    s_mov_b32 s78, 65536
    buffer_load_dwordx2 v[198:199], v177, s[80:83], s78 offen sc1
    s_mov_b32 s78, 262144
    buffer_load_dwordx2 v[200:201], v177, s[80:83], s78 offen sc1
    s_mov_b32 s78, 327680
    buffer_load_dwordx2 v[202:203], v177, s[80:83], s78 offen sc1
    s_barrier
    s_branch NEXT
WLOAD:
    s_cmp_eq_u32 s60, 1
    s_cbranch_scc1 WL_1
    s_mov_b64 s[12:13], s[68:69]
    s_mov_b32 s14, 2097152
    s_mov_b32 s15, 0x20000
    s_and_b32 s35, s30, 1
    s_mul_i32 s38, s29, 128
    s_mul_i32 s41, s35, 65536
    s_add_u32 s38, s38, s41
    s_mul_i32 s41, s35, 4096
    s_add_u32 s41, s41, 24576
    s_mov_b32 s42, 0
    s_mov_b32 s44, s67
    s_branch WL_2
WL_1:
    s_mov_b64 s[12:13], s[68:69]
    s_mov_b32 s14, 2097152
    s_mov_b32 s15, 0x20000
    s_and_b32 s35, s30, 1
    s_mul_i32 s38, s29, 128
    s_mul_i32 s41, s35, 65536
    s_add_u32 s38, s38, s41
    s_mul_i32 s41, s35, 4096
    s_add_u32 s41, s41, 24576
    s_mov_b32 s42, 0
    s_mov_b32 s44, s67
WL_2:
    s_waitcnt vmcnt(0)
    s_barrier
    s_barrier
    s_call_b64 s[76:77], SUB_after_g1
    s_barrier
    s_barrier
    s_call_b64 s[76:77], SUB_after_g2
    s_mov_b64 s[12:13], s[72:73]
    s_mov_b32 s14, 7340032
    s_mov_b32 s15, 0x20000
    s_and_b32 s35, s30, 1
    s_mul_i32 s38, s29, 448
    s_mul_i32 s41, s35, 229376
    s_add_u32 s38, s38, s41
    s_mul_i32 s41, s35, 14336
    s_add_u32 s41, s41, 73728
    s_mov_b32 s42, 0
    s_mov_b32 s44, 0
    s_mov_b32 s42, 28672
    s_mov_b32 s44, 2
    s_add_u32 s19, s41, s42
    v_readlane_b32 s16, v248, s44
    s_nop 0
    s_add_u32 s16, s16, s38
    s_add_u32 s44, s44, 1
    s_and_b32 s44, s44, 15
    s_add_u32 s42, s42, 28672
    s_cmp_eq_u32 s42, 86016
    s_cselect_b32 s42, 0, s42
    s_mov_b32 m0, s19
    s_mov_b32 s39, s16
    s_waitcnt vmcnt(0)
    s_barrier
    buffer_load_dwordx4 v241, s[12:15], s39 offen lds
    s_add_u32 m0, m0, 1024
    s_nop 0
    buffer_load_dwordx4 v242, s[12:15], s39 offen lds
    s_add_u32 m0, m0, 1024
    s_nop 0
    buffer_load_dwordx4 v243, s[12:15], s39 offen lds
    s_mov_b32 s43, 1
ld_84:
    s_add_u32 s19, s41, s42
    v_readlane_b32 s16, v248, s44
    s_nop 0
    s_add_u32 s16, s16, s38
    s_add_u32 s44, s44, 1
    s_and_b32 s44, s44, 15
    s_add_u32 s42, s42, 28672
    s_cmp_eq_u32 s42, 86016
    s_cselect_b32 s42, 0, s42
    s_add_u32 m0, m0, 1024
    s_nop 0
    buffer_load_dwordx4 v244, s[12:15], s39 offen lds
    s_add_u32 m0, m0, 1024
    s_nop 0
    buffer_load_dwordx4 v245, s[12:15], s39 offen lds
    s_add_u32 m0, m0, 1024
    s_nop 0
    buffer_load_dwordx4 v246, s[12:15], s39 offen lds
    s_add_u32 m0, m0, 1024
    s_nop 0
    buffer_load_dwordx4 v247, s[12:15], s39 offen lds
    s_add_u32 m0, m0, 1024
    s_add_u32 s39, s39, 114688
    buffer_load_dwordx4 v241, s[12:15], s39 offen lds
    s_add_u32 m0, m0, 1024
    s_nop 0
    buffer_load_dwordx4 v242, s[12:15], s39 offen lds
    s_add_u32 m0, m0, 1024
    s_nop 0
    buffer_load_dwordx4 v243, s[12:15], s39 offen lds
    s_add_u32 m0, m0, 1024
    s_nop 0
    buffer_load_dwordx4 v244, s[12:15], s39 offen lds
    s_add_u32 m0, m0, 1024
    s_nop 0
    buffer_load_dwordx4 v245, s[12:15], s39 offen lds
    s_add_u32 m0, m0, 1024
    s_nop 0
    buffer_load_dwordx4 v246, s[12:15], s39 offen lds
    s_add_u32 m0, m0, 1024
    s_nop 0
    buffer_load_dwordx4 v247, s[12:15], s39 offen lds
    s_mov_b32 m0, s19
    s_mov_b32 s39, s16
    s_waitcnt vmcnt(14)
    s_barrier
    buffer_load_dwordx4 v241, s[12:15], s39 offen lds
    s_add_u32 m0, m0, 1024
    s_nop 0
    buffer_load_dwordx4 v242, s[12:15], s39 offen lds
    s_add_u32 m0, m0, 1024
    s_nop 0
    buffer_load_dwordx4 v243, s[12:15], s39 offen lds
    s_add_u32 s43, s43, 1
    s_cmp_lt_u32 s43, 13
    s_cbranch_scc1 ld_84
    s_add_u32 s19, s41, s42
    v_readlane_b32 s16, v248, s44
    s_nop 0
    s_add_u32 s16, s16, s38
    s_add_u32 s44, s44, 1
    s_and_b32 s44, s44, 15
    s_add_u32 s42, s42, 28672
    s_cmp_eq_u32 s42, 86016
    s_cselect_b32 s42, 0, s42
    s_add_u32 m0, m0, 1024
    s_nop 0
    buffer_load_dwordx4 v244, s[12:15], s39 offen lds
    s_add_u32 m0, m0, 1024
    s_nop 0
    buffer_load_dwordx4 v245, s[12:15], s39 offen lds
    s_add_u32 m0, m0, 1024
    s_nop 0
    buffer_load_dwordx4 v246, s[12:15], s39 offen lds
    s_add_u32 m0, m0, 1024
    s_nop 0
    buffer_load_dwordx4 v247, s[12:15], s39 offen lds
    s_add_u32 m0, m0, 1024
    s_add_u32 s39, s39, 114688
    buffer_load_dwordx4 v241, s[12:15], s39 offen lds
    s_add_u32 m0, m0, 1024
    s_nop 0
    buffer_load_dwordx4 v242, s[12:15], s39 offen lds
    s_add_u32 m0, m0, 1024
    s_nop 0
    buffer_load_dwordx4 v243, s[12:15], s39 offen lds
    s_add_u32 m0, m0, 1024
    s_nop 0
    buffer_load_dwordx4 v244, s[12:15], s39 offen lds
    s_add_u32 m0, m0, 1024
    s_nop 0
    buffer_load_dwordx4 v245, s[12:15], s39 offen lds
    s_add_u32 m0, m0, 1024
    s_nop 0
    buffer_load_dwordx4 v246, s[12:15], s39 offen lds
    s_add_u32 m0, m0, 1024
    s_nop 0
    buffer_load_dwordx4 v247, s[12:15], s39 offen lds
    s_mov_b32 m0, s19
    s_mov_b32 s39, s16
    s_waitcnt vmcnt(14)
    s_barrier
    buffer_load_dwordx4 v241, s[12:15], s39 offen lds
    s_add_u32 m0, m0, 1024
    s_nop 0
    buffer_load_dwordx4 v242, s[12:15], s39 offen lds
    s_add_u32 m0, m0, 1024
    s_nop 0
    buffer_load_dwordx4 v243, s[12:15], s39 offen lds
    s_add_u32 m0, m0, 1024
    s_nop 0
    buffer_load_dwordx4 v244, s[12:15], s39 offen lds
    s_add_u32 m0, m0, 1024
    s_nop 0
    buffer_load_dwordx4 v245, s[12:15], s39 offen lds
    s_add_u32 m0, m0, 1024
    s_nop 0
    buffer_load_dwordx4 v246, s[12:15], s39 offen lds
    s_add_u32 m0, m0, 1024
    s_nop 0
    buffer_load_dwordx4 v247, s[12:15], s39 offen lds
    s_add_u32 m0, m0, 1024
    s_add_u32 s39, s39, 114688
    buffer_load_dwordx4 v241, s[12:15], s39 offen lds
    s_add_u32 m0, m0, 1024
    s_nop 0
    buffer_load_dwordx4 v242, s[12:15], s39 offen lds
    s_add_u32 m0, m0, 1024
    s_nop 0
    buffer_load_dwordx4 v243, s[12:15], s39 offen lds
    s_add_u32 m0, m0, 1024
    s_nop 0
    buffer_load_dwordx4 v244, s[12:15], s39 offen lds
    s_add_u32 m0, m0, 1024
    s_nop 0
    buffer_load_dwordx4 v245, s[12:15], s39 offen lds
    s_add_u32 m0, m0, 1024
    s_nop 0
    buffer_load_dwordx4 v246, s[12:15], s39 offen lds
    s_add_u32 m0, m0, 1024
    s_nop 0
    buffer_load_dwordx4 v247, s[12:15], s39 offen lds
    s_waitcnt vmcnt(14)
    s_barrier
    s_waitcnt vmcnt(0)
    s_barrier
    s_barrier
    s_mov_b64 s[12:13], s[74:75]
    s_mov_b32 s14, 7340032
    s_mov_b32 s15, 0x20000
    s_and_b32 s35, s30, 1
    s_mul_i32 s38, s33, 256
    s_mul_i32 s41, s31, 3670016
    s_add_u32 s38, s38, s41
    s_mul_i32 s41, s35, 8192
    s_add_u32 s41, s41, 49152
    s_mov_b32 s42, 0
    s_mov_b32 s44, 0
    s_mov_b32 s49, s44
    s_and_b32 s43, s28, 3
    s_mul_i32 s43, s43, 6
    s_lshr_b32 s43, s43, 2
    s_mov_b32 s50, 0
wpre_85:
    s_mul_i32 s42, s43, 16384
    s_add_u32 s44, s49, s43
    s_mov_b32 s45, 8192
    s_add_u32 s19, s41, s42
    v_readlane_b32 s16, v249, s44
    s_nop 0
    s_bitcmp1_b32 s16, 0
    s_cselect_b32 s17, 16384, s45
    s_cselect_b32 s18, -40960, s45
    s_andn2_b32 s16, s16, 1
    s_add_u32 s16, s16, s38
    s_add_u32 s44, s44, 1
    s_add_u32 s42, s42, 16384
    s_cmp_eq_u32 s42, 98304
    s_cselect_b32 s42, 0, s42
    s_mov_b32 m0, s19
    s_mov_b32 s39, s16
    s_mov_b32 s32, s17
    s_mov_b32 s3, s18
    buffer_load_dwordx4 v239, s[12:15], s39 offen lds
    s_add_u32 m0, m0, 1024
    s_add_u32 s39, s39, s32
    buffer_load_dwordx4 v240, s[12:15], s39 offen lds
    s_add_u32 m0, m0, 1024
    s_add_u32 s39, s39, s32
    buffer_load_dwordx4 v239, s[12:15], s39 offen lds
    s_add_u32 m0, m0, 1024
    s_add_u32 s39, s39, s32
    buffer_load_dwordx4 v240, s[12:15], s39 offen lds
    s_waitcnt vmcnt(4)
    s_add_u32 m0, m0, 1024
    s_add_u32 s39, s39, s3
    buffer_load_dwordx4 v239, s[12:15], s39 offen lds
    s_add_u32 m0, m0, 1024
    s_add_u32 s39, s39, s32
    buffer_load_dwordx4 v240, s[12:15], s39 offen lds
    s_add_u32 m0, m0, 1024
    s_add_u32 s39, s39, s32
    buffer_load_dwordx4 v239, s[12:15], s39 offen lds
    s_add_u32 m0, m0, 1024
    s_add_u32 s39, s39, s32
    buffer_load_dwordx4 v240, s[12:15], s39 offen lds
    s_waitcnt vmcnt(4)
    s_add_u32 s43, s43, 1
    s_cmp_eq_u32 s43, 6
    s_cselect_b32 s43, 0, s43
    s_add_u32 s50, s50, 1
    s_cmp_lt_u32 s50, 6
    s_cbranch_scc1 wpre_85
    s_mov_b32 s42, 0
    s_add_u32 s44, s49, 6
    s_cmp_eq_u32 s60, 1
    s_cbranch_scc1 WL_t1
    s_call_b64 s[76:77], PREP_w_issue_4
    s_mov_b32 m0, s19
    s_mov_b32 s39, s16
    s_mov_b32 s32, s17
    s_mov_b32 s3, s18
    s_waitcnt vmcnt(0)
    s_barrier
    s_waitcnt vmcnt(0)
    s_barrier
    buffer_load_dwordx4 v239, s[12:15], s39 offen lds
    s_add_u32 m0, m0, 1024
    s_add_u32 s39, s39, s32
    buffer_load_dwordx4 v240, s[12:15], s39 offen lds
    s_call_b64 s[76:77], PREP_w_issue_4
    s_add_u32 m0, m0, 1024
    s_add_u32 s39, s39, s32
    buffer_load_dwordx4 v239, s[12:15], s39 offen lds
    s_add_u32 m0, m0, 1024
    s_add_u32 s39, s39, s32
    buffer_load_dwordx4 v240, s[12:15], s39 offen lds
    s_add_u32 m0, m0, 1024
    s_add_u32 s39, s39, s3
    buffer_load_dwordx4 v239, s[12:15], s39 offen lds
    s_add_u32 m0, m0, 1024
    s_add_u32 s39, s39, s32
    buffer_load_dwordx4 v240, s[12:15], s39 offen lds
    s_add_u32 m0, m0, 1024
    s_add_u32 s39, s39, s32
    buffer_load_dwordx4 v239, s[12:15], s39 offen lds
    s_add_u32 m0, m0, 1024
    s_add_u32 s39, s39, s32
    buffer_load_dwordx4 v240, s[12:15], s39 offen lds
    s_mov_b32 m0, s19
    s_mov_b32 s39, s16
    s_mov_b32 s32, s17
    s_mov_b32 s3, s18
    s_waitcnt vmcnt(8)
    s_barrier
    buffer_load_dwordx4 v239, s[12:15], s39 offen lds
    s_add_u32 m0, m0, 1024
    s_add_u32 s39, s39, s32
    buffer_load_dwordx4 v240, s[12:15], s39 offen lds
    s_call_b64 s[76:77], PREP_w_issue_4
    s_add_u32 m0, m0, 1024
    s_add_u32 s39, s39, s32
    buffer_load_dwordx4 v239, s[12:15], s39 offen lds
    s_add_u32 m0, m0, 1024
    s_add_u32 s39, s39, s32
    buffer_load_dwordx4 v240, s[12:15], s39 offen lds
    s_add_u32 m0, m0, 1024
    s_add_u32 s39, s39, s3
    buffer_load_dwordx4 v239, s[12:15], s39 offen lds
    s_add_u32 m0, m0, 1024
    s_add_u32 s39, s39, s32
    buffer_load_dwordx4 v240, s[12:15], s39 offen lds
    s_add_u32 m0, m0, 1024
    s_add_u32 s39, s39, s32
    buffer_load_dwordx4 v239, s[12:15], s39 offen lds
    s_add_u32 m0, m0, 1024
    s_add_u32 s39, s39, s32
    buffer_load_dwordx4 v240, s[12:15], s39 offen lds
    s_mov_b32 m0, s19
    s_mov_b32 s39, s16
    s_mov_b32 s32, s17
    s_mov_b32 s3, s18
    s_waitcnt vmcnt(16)
    s_barrier
    buffer_load_dwordx4 v239, s[12:15], s39 offen lds
    s_add_u32 m0, m0, 1024
    s_add_u32 s39, s39, s32
    buffer_load_dwordx4 v240, s[12:15], s39 offen lds
    s_call_b64 s[76:77], PREP_w_issue_4
    s_add_u32 m0, m0, 1024
    s_add_u32 s39, s39, s32
    buffer_load_dwordx4 v239, s[12:15], s39 offen lds
    s_add_u32 m0, m0, 1024
    s_add_u32 s39, s39, s32
    buffer_load_dwordx4 v240, s[12:15], s39 offen lds
    s_add_u32 m0, m0, 1024
    s_add_u32 s39, s39, s3
    buffer_load_dwordx4 v239, s[12:15], s39 offen lds
    s_add_u32 m0, m0, 1024
    s_add_u32 s39, s39, s32
    buffer_load_dwordx4 v240, s[12:15], s39 offen lds
    s_add_u32 m0, m0, 1024
    s_add_u32 s39, s39, s32
    buffer_load_dwordx4 v239, s[12:15], s39 offen lds
    s_add_u32 m0, m0, 1024
    s_add_u32 s39, s39, s32
    buffer_load_dwordx4 v240, s[12:15], s39 offen lds
    s_mov_b32 m0, s19
    s_mov_b32 s39, s16
    s_mov_b32 s32, s17
    s_mov_b32 s3, s18
    s_waitcnt vmcnt(24)
    s_barrier
    buffer_load_dwordx4 v239, s[12:15], s39 offen lds
    s_add_u32 m0, m0, 1024
    s_add_u32 s39, s39, s32
    buffer_load_dwordx4 v240, s[12:15], s39 offen lds
    s_mov_b32 s43, 1
ld_86:
    s_mov_b32 s45, 8192
    s_add_u32 s19, s41, s42
    v_readlane_b32 s16, v249, s44
    s_nop 0
    s_bitcmp1_b32 s16, 0
    s_cselect_b32 s17, 16384, s45
    s_cselect_b32 s18, -40960, s45
    s_andn2_b32 s16, s16, 1
    s_add_u32 s16, s16, s38
    s_add_u32 s44, s44, 1
    s_add_u32 s42, s42, 16384
    s_cmp_eq_u32 s42, 98304
    s_cselect_b32 s42, 0, s42
    s_add_u32 m0, m0, 1024
    s_add_u32 s39, s39, s32
    buffer_load_dwordx4 v239, s[12:15], s39 offen lds
    s_add_u32 m0, m0, 1024
    s_add_u32 s39, s39, s32
    buffer_load_dwordx4 v240, s[12:15], s39 offen lds
    s_add_u32 m0, m0, 1024
    s_add_u32 s39, s39, s3
    buffer_load_dwordx4 v239, s[12:15], s39 offen lds
    s_add_u32 m0, m0, 1024
    s_add_u32 s39, s39, s32
    buffer_load_dwordx4 v240, s[12:15], s39 offen lds
    s_add_u32 m0, m0, 1024
    s_add_u32 s39, s39, s32
    buffer_load_dwordx4 v239, s[12:15], s39 offen lds
    s_add_u32 m0, m0, 1024
    s_add_u32 s39, s39, s32
    buffer_load_dwordx4 v240, s[12:15], s39 offen lds
    s_mov_b32 m0, s19
    s_mov_b32 s39, s16
    s_mov_b32 s32, s17
    s_mov_b32 s3, s18
    s_waitcnt vmcnt(32)
    s_barrier
    buffer_load_dwordx4 v239, s[12:15], s39 offen lds
    s_add_u32 m0, m0, 1024
    s_add_u32 s39, s39, s32
    buffer_load_dwordx4 v240, s[12:15], s39 offen lds
    s_add_u32 s43, s43, 1
    s_cmp_lt_u32 s43, 18
    s_cbranch_scc1 ld_86
    s_call_b64 s[76:77], PREP_w_issue_4
    s_add_u32 m0, m0, 1024
    s_add_u32 s39, s39, s32
    buffer_load_dwordx4 v239, s[12:15], s39 offen lds
    s_add_u32 m0, m0, 1024
    s_add_u32 s39, s39, s32
    buffer_load_dwordx4 v240, s[12:15], s39 offen lds
    s_add_u32 m0, m0, 1024
    s_add_u32 s39, s39, s3
    buffer_load_dwordx4 v239, s[12:15], s39 offen lds
    s_add_u32 m0, m0, 1024
    s_add_u32 s39, s39, s32
    buffer_load_dwordx4 v240, s[12:15], s39 offen lds
    s_add_u32 m0, m0, 1024
    s_add_u32 s39, s39, s32
    buffer_load_dwordx4 v239, s[12:15], s39 offen lds
    s_add_u32 m0, m0, 1024
    s_add_u32 s39, s39, s32
    buffer_load_dwordx4 v240, s[12:15], s39 offen lds
    s_mov_b32 m0, s19
    s_mov_b32 s39, s16
    s_mov_b32 s32, s17
    s_mov_b32 s3, s18
    s_waitcnt vmcnt(32)
    s_barrier
    buffer_load_dwordx4 v239, s[12:15], s39 offen lds
    s_add_u32 m0, m0, 1024
    s_add_u32 s39, s39, s32
    buffer_load_dwordx4 v240, s[12:15], s39 offen lds
    s_add_u32 m0, m0, 1024
    s_add_u32 s39, s39, s32
    buffer_load_dwordx4 v239, s[12:15], s39 offen lds
    s_add_u32 m0, m0, 1024
    s_add_u32 s39, s39, s32
    buffer_load_dwordx4 v240, s[12:15], s39 offen lds
    s_add_u32 m0, m0, 1024
    s_add_u32 s39, s39, s3
    buffer_load_dwordx4 v239, s[12:15], s39 offen lds
    s_add_u32 m0, m0, 1024
    s_add_u32 s39, s39, s32
    buffer_load_dwordx4 v240, s[12:15], s39 offen lds
    s_add_u32 m0, m0, 1024
    s_add_u32 s39, s39, s32
    buffer_load_dwordx4 v239, s[12:15], s39 offen lds
    s_add_u32 m0, m0, 1024
    s_add_u32 s39, s39, s32
    buffer_load_dwordx4 v240, s[12:15], s39 offen lds
    s_waitcnt vmcnt(32)
    s_barrier
    s_mov_b64 s[12:13], s[68:69]
    s_mov_b32 s14, 2097152
    s_mov_b32 s15, 0x20000
    s_and_b32 s35, s30, 1
    s_mul_i32 s38, s29, 128
    s_mul_i32 s41, s35, 65536
    s_add_u32 s38, s38, s41
    s_mul_i32 s41, s35, 4096
    s_add_u32 s41, s41, 24576
    s_mov_b32 s42, 0
    s_mov_b32 s44, s67
    s_mov_b32 s42, 90112
    s_mov_b32 s44, s67
    s_add_u32 s44, s44, 11
    s_and_b32 s44, s44, 15
    s_call_b64 s[76:77], SUB_w_issue_1
    s_mov_b32 s42, 98304
    s_mov_b32 s44, s67
    s_add_u32 s44, s44, 12
    s_and_b32 s44, s44, 15
    s_call_b64 s[76:77], SUB_w_issue_1
    s_mov_b32 s42, 122880
    s_mov_b32 s44, s67
    s_add_u32 s44, s44, 15
    s_and_b32 s44, s44, 15
    s_call_b64 s[76:77], SUB_w_issue_1
    s_waitcnt vmcnt(36)
    s_barrier
    s_mov_b32 s42, 106496
    s_mov_b32 s44, s67
    s_add_u32 s44, s44, 13
    s_and_b32 s44, s44, 15
    s_call_b64 s[76:77], SUB_w_issue_1
    s_mov_b32 s42, 114688
    s_mov_b32 s44, s67
    s_add_u32 s44, s44, 14
    s_and_b32 s44, s44, 15
    s_call_b64 s[76:77], SUB_w_issue_1
    s_waitcnt vmcnt(36)
    s_barrier
    s_mov_b32 s42, 24576
    s_mov_b32 s44, s67
    s_add_u32 s44, s44, 3
    s_and_b32 s44, s44, 15
    s_call_b64 s[76:77], SUB_w_issue_1
    s_mov_b32 s42, 32768
    s_mov_b32 s44, s67
    s_add_u32 s44, s44, 4
    s_and_b32 s44, s44, 15
    s_call_b64 s[76:77], SUB_w_issue_1
    s_waitcnt vmcnt(36)
    s_barrier
    s_mov_b32 s42, 40960
    s_mov_b32 s44, s67
    s_add_u32 s44, s44, 5
    s_and_b32 s44, s44, 15
    s_call_b64 s[76:77], SUB_w_issue_1
    s_mov_b32 s42, 49152
    s_mov_b32 s44, s67
    s_add_u32 s44, s44, 6
    s_and_b32 s44, s44, 15
    s_call_b64 s[76:77], SUB_w_issue_1
    s_waitcnt vmcnt(36)
    s_barrier
    v_and_b32 v179, 7, v0
    v_lshrrev_b32 v204, 6, v0
    v_lshlrev_b32 v204, 4, v204
    v_bfe_u32 v205, v0, 3, 3
    v_add_u32 v204, v204, v205
    s_lshr_b32 s78, s29, 1
    s_lshl_b32 s78, s78, 16
    s_and_b32 s79, s29, 1
    s_lshl_b32 s79, s79, 7
    s_add_u32 s78, s78, s79
    s_lshr_b32 s79, s30, 1
    s_lshl_b32 s79, s79, 13
    s_add_u32 s78, s78, s79
    v_lshlrev_b32 v176, 8, v204
    v_lshl_add_u32 v176, v179, 4, v176
    v_add_u32 v176, s78, v176
    s_lshl_b32 s78, s28, 7
    s_lshl_b32 s79, s29, 3
    s_add_u32 s78, s78, s79
    v_add_u32 v177, s78, v179
    v_lshlrev_b32 v178, 11, v177
    v_lshrrev_b32 v205, 2, v204
    v_lshlrev_b32 v205, 3, v205
    v_and_b32 v204, 3, v204
    v_add_u32 v204, v204, v205
    v_lshl_add_u32 v178, v204, 3, v178
    v_lshlrev_b32 v177, 3, v177
    v_lshl_add_u32 v177, v204, 14, v177
    s_add_u32 s84, s62, 0x400000
    s_addc_u32 s85, s63, 0
    s_mov_b32 s86, 0x7e000
    s_mov_b32 s87, 0x20000
    s_add_u32 s88, s62, 0x480000
    s_addc_u32 s89, s63, 0
    s_mov_b32 s90, 0x7e000
    s_mov_b32 s91, 0x20000
    buffer_load_dwordx4 v[180:183], v176, s[84:87], 0 offen offset:0 sc1
    buffer_load_dwordx4 v[188:191], v176, s[88:91], 0 offen offset:0 sc1
    buffer_load_dwordx4 v[184:187], v176, s[84:87], 0 offen offset:2048 sc1
    buffer_load_dwordx4 v[192:195], v176, s[88:91], 0 offen offset:2048 sc1
    s_add_u32 s80, s4, 0x1c00000
    s_addc_u32 s81, s5, 0
    s_mov_b32 s82, 0x400000
    s_mov_b32 s83, 0x20000
    s_mov_b32 s78, 0
    buffer_load_dwordx2 v[196:197], v177, s[80:83], s78 offen sc1
    s_mov_b32 s78, 65536
    buffer_load_dwordx2 v[198:199], v177, s[80:83], s78 offen sc1
    s_mov_b32 s78, 262144
    buffer_load_dwordx2 v[200:201], v177, s[80:83], s78 offen sc1
    s_mov_b32 s78, 327680
    buffer_load_dwordx2 v[202:203], v177, s[80:83], s78 offen sc1
    s_mov_b32 s42, 57344
    s_mov_b32 s44, s67
    s_add_u32 s44, s44, 7
    s_and_b32 s44, s44, 15
    s_call_b64 s[76:77], SUB_w_issue_1
    s_mov_b32 s42, 65536
    s_mov_b32 s44, s67
    s_add_u32 s44, s44, 8
    s_and_b32 s44, s44, 15
    s_call_b64 s[76:77], SUB_w_issue_1
    s_barrier
    s_mov_b32 s42, 73728
    s_mov_b32 s44, s67
    s_add_u32 s44, s44, 9
    s_and_b32 s44, s44, 15
    s_call_b64 s[76:77], SUB_w_issue_1
    s_mov_b32 s42, 81920
    s_mov_b32 s44, s67
    s_add_u32 s44, s44, 10
    s_and_b32 s44, s44, 15
    s_call_b64 s[76:77], SUB_w_issue_1
    s_mov_b32 s42, 0
    s_mov_b32 s44, s67
    s_add_u32 s44, s44, 0
    s_and_b32 s44, s44, 15
    s_call_b64 s[76:77], SUB_w_issue_1
    s_waitcnt vmcnt(8)
    s_mov_b32 s42, 8192
    s_mov_b32 s44, s67
    s_add_u32 s44, s44, 1
    s_and_b32 s44, s44, 15
    s_call_b64 s[76:77], SUB_w_issue_1
    s_waitcnt vmcnt(8)
    s_mov_b32 s42, 16384
    s_mov_b32 s44, s67
    s_add_u32 s44, s44, 2
    s_and_b32 s44, s44, 15
    s_call_b64 s[76:77], SUB_w_issue_1
    s_waitcnt vmcnt(8)
    s_branch NEXT
WL_t1:
    s_call_b64 s[76:77], PREP_w_issue_4
    s_mov_b32 m0, s19
    s_mov_b32 s39, s16
    s_mov_b32 s32, s17
    s_mov_b32 s3, s18
    s_waitcnt vmcnt(0)
    s_barrier
    s_waitcnt vmcnt(0)
    s_barrier
    s_waitcnt vmcnt(0)
    s_barrier
    s_waitcnt vmcnt(0)
    s_barrier
    s_waitcnt vmcnt(0)
    s_barrier
    buffer_load_dwordx4 v239, s[12:15], s39 offen lds
    s_add_u32 m0, m0, 1024
    s_add_u32 s39, s39, s32
    buffer_load_dwordx4 v240, s[12:15], s39 offen lds
    s_mov_b32 s43, 1
ld_87:
    s_mov_b32 s45, 8192
    s_add_u32 s19, s41, s42
    v_readlane_b32 s16, v249, s44
    s_nop 0
    s_bitcmp1_b32 s16, 0
    s_cselect_b32 s17, 16384, s45
    s_cselect_b32 s18, -40960, s45
    s_andn2_b32 s16, s16, 1
    s_add_u32 s16, s16, s38
    s_add_u32 s44, s44, 1
    s_add_u32 s42, s42, 16384
    s_cmp_eq_u32 s42, 98304
    s_cselect_b32 s42, 0, s42
    s_add_u32 m0, m0, 1024
    s_add_u32 s39, s39, s32
    buffer_load_dwordx4 v239, s[12:15], s39 offen lds
    s_add_u32 m0, m0, 1024
    s_add_u32 s39, s39, s32
    buffer_load_dwordx4 v240, s[12:15], s39 offen lds
    s_add_u32 m0, m0, 1024
    s_add_u32 s39, s39, s3
    buffer_load_dwordx4 v239, s[12:15], s39 offen lds
    s_add_u32 m0, m0, 1024
    s_add_u32 s39, s39, s32
    buffer_load_dwordx4 v240, s[12:15], s39 offen lds
    s_add_u32 m0, m0, 1024
    s_add_u32 s39, s39, s32
    buffer_load_dwordx4 v239, s[12:15], s39 offen lds
    s_add_u32 m0, m0, 1024
    s_add_u32 s39, s39, s32
    buffer_load_dwordx4 v240, s[12:15], s39 offen lds
    s_mov_b32 m0, s19
    s_mov_b32 s39, s16
    s_mov_b32 s32, s17
    s_mov_b32 s3, s18
    s_waitcnt vmcnt(8)
    s_barrier
    buffer_load_dwordx4 v239, s[12:15], s39 offen lds
    s_add_u32 m0, m0, 1024
    s_add_u32 s39, s39, s32
    buffer_load_dwordx4 v240, s[12:15], s39 offen lds
    s_add_u32 s43, s43, 1
    s_cmp_lt_u32 s43, 21
    s_cbranch_scc1 ld_87
    s_call_b64 s[76:77], PREP_w_issue_4
    s_add_u32 m0, m0, 1024
    s_add_u32 s39, s39, s32
    buffer_load_dwordx4 v239, s[12:15], s39 offen lds
    s_add_u32 m0, m0, 1024
    s_add_u32 s39, s39, s32
    buffer_load_dwordx4 v240, s[12:15], s39 offen lds
    s_add_u32 m0, m0, 1024
    s_add_u32 s39, s39, s3
    buffer_load_dwordx4 v239, s[12:15], s39 offen lds
    s_add_u32 m0, m0, 1024
    s_add_u32 s39, s39, s32
    buffer_load_dwordx4 v240, s[12:15], s39 offen lds
    s_add_u32 m0, m0, 1024
    s_add_u32 s39, s39, s32
    buffer_load_dwordx4 v239, s[12:15], s39 offen lds
    s_add_u32 m0, m0, 1024
    s_add_u32 s39, s39, s32
    buffer_load_dwordx4 v240, s[12:15], s39 offen lds
    s_mov_b32 m0, s19
    s_mov_b32 s39, s16
    s_mov_b32 s32, s17
    s_mov_b32 s3, s18
    s_waitcnt vmcnt(8)
    s_barrier
    buffer_load_dwordx4 v239, s[12:15], s39 offen lds
    s_add_u32 m0, m0, 1024
    s_add_u32 s39, s39, s32
    buffer_load_dwordx4 v240, s[12:15], s39 offen lds
    s_add_u32 m0, m0, 1024
    s_add_u32 s39, s39, s32
    buffer_load_dwordx4 v239, s[12:15], s39 offen lds
    s_add_u32 m0, m0, 1024
    s_add_u32 s39, s39, s32
    buffer_load_dwordx4 v240, s[12:15], s39 offen lds
    s_add_u32 m0, m0, 1024
    s_add_u32 s39, s39, s3
    buffer_load_dwordx4 v239, s[12:15], s39 offen lds
    s_add_u32 m0, m0, 1024
    s_add_u32 s39, s39, s32
    buffer_load_dwordx4 v240, s[12:15], s39 offen lds
    s_add_u32 m0, m0, 1024
    s_add_u32 s39, s39, s32
    buffer_load_dwordx4 v239, s[12:15], s39 offen lds
    s_add_u32 m0, m0, 1024
    s_add_u32 s39, s39, s32
    buffer_load_dwordx4 v240, s[12:15], s39 offen lds
    s_waitcnt vmcnt(8)
    s_barrier
    s_waitcnt vmcnt(0)
    s_barrier
    s_branch K_fin
NEXT:
    s_setprio 0
    s_add_u32 s60, s60, 1
    s_add_u32 s55, s55, 67108864
    s_add_u32 s62, s62, 67108864
    s_addc_u32 s63, s63, 0
    s_branch LAYER
K_fin:
    s_endpgm
SUB_park:
    s_mov_b64 s[12:13], s[70:71]
    s_mov_b32 s14, 2097152
    s_mov_b32 s15, 0x20000
    s_and_b32 s35, s30, 3
    s_lshl_b32 s35, s35, 19
    s_lshl_b32 s39, s29, 7
    s_add_u32 s39, s39, s35
    buffer_load_dwordx4 v[48:51], v238, s[12:15], s39 offen
    s_add_u32 s39, s39, 16384
    buffer_load_dwordx4 v[52:55], v238, s[12:15], s39 offen
    s_add_u32 s39, s39, 16384
    buffer_load_dwordx4 v[56:59], v238, s[12:15], s39 offen
    s_add_u32 s39, s39, 16384
    buffer_load_dwordx4 v[60:63], v238, s[12:15], s39 offen
    s_add_u32 s39, s39, 16384
    s_waitcnt vmcnt(8)
    buffer_load_dwordx4 v[64:67], v238, s[12:15], s39 offen
    s_add_u32 s39, s39, 16384
    buffer_load_dwordx4 v[68:71], v238, s[12:15], s39 offen
    s_add_u32 s39, s39, 16384
    buffer_load_dwordx4 v[72:75], v238, s[12:15], s39 offen
    s_add_u32 s39, s39, 16384
    buffer_load_dwordx4 v[76:79], v238, s[12:15], s39 offen
    s_add_u32 s39, s39, 16384
    s_waitcnt vmcnt(8)
    buffer_load_dwordx4 v[80:83], v238, s[12:15], s39 offen
    s_add_u32 s39, s39, 16384
    buffer_load_dwordx4 v[84:87], v238, s[12:15], s39 offen
    s_add_u32 s39, s39, 16384
    buffer_load_dwordx4 v[88:91], v238, s[12:15], s39 offen
    s_add_u32 s39, s39, 16384
    buffer_load_dwordx4 v[92:95], v238, s[12:15], s39 offen
    s_add_u32 s39, s39, 16384
    s_waitcnt vmcnt(8)
    buffer_load_dwordx4 v[96:99], v238, s[12:15], s39 offen
    s_add_u32 s39, s39, 16384
    buffer_load_dwordx4 v[100:103], v238, s[12:15], s39 offen
    s_add_u32 s39, s39, 16384
    buffer_load_dwordx4 v[104:107], v238, s[12:15], s39 offen
    s_add_u32 s39, s39, 16384
    buffer_load_dwordx4 v[108:111], v238, s[12:15], s39 offen
    s_add_u32 s39, s39, 16384
    s_waitcnt vmcnt(8)
    buffer_load_dwordx4 v[112:115], v238, s[12:15], s39 offen
    s_add_u32 s39, s39, 16384
    buffer_load_dwordx4 v[116:119], v238, s[12:15], s39 offen
    s_add_u32 s39, s39, 16384
    buffer_load_dwordx4 v[120:123], v238, s[12:15], s39 offen
    s_add_u32 s39, s39, 16384
    buffer_load_dwordx4 v[124:127], v238, s[12:15], s39 offen
    s_add_u32 s39, s39, 16384
    s_waitcnt vmcnt(8)
    buffer_load_dwordx4 v[128:131], v238, s[12:15], s39 offen
    s_add_u32 s39, s39, 16384
    buffer_load_dwordx4 v[132:135], v238, s[12:15], s39 offen
    s_add_u32 s39, s39, 16384
    buffer_load_dwordx4 v[136:139], v238, s[12:15], s39 offen
    s_add_u32 s39, s39, 16384
    buffer_load_dwordx4 v[140:143], v238, s[12:15], s39 offen
    s_add_u32 s39, s39, 16384
    s_waitcnt vmcnt(8)
    buffer_load_dwordx4 v[144:147], v238, s[12:15], s39 offen
    s_add_u32 s39, s39, 16384
    buffer_load_dwordx4 v[148:151], v238, s[12:15], s39 offen
    s_add_u32 s39, s39, 16384
    buffer_load_dwordx4 v[152:155], v238, s[12:15], s39 offen
    s_add_u32 s39, s39, 16384
    buffer_load_dwordx4 v[156:159], v238, s[12:15], s39 offen
    s_add_u32 s39, s39, 16384
    s_waitcnt vmcnt(8)
    buffer_load_dwordx4 v[160:163], v238, s[12:15], s39 offen
    s_add_u32 s39, s39, 16384
    buffer_load_dwordx4 v[164:167], v238, s[12:15], s39 offen
    s_add_u32 s39, s39, 16384
    buffer_load_dwordx4 v[168:171], v238, s[12:15], s39 offen
    s_add_u32 s39, s39, 16384
    buffer_load_dwordx4 v[172:175], v238, s[12:15], s39 offen
    s_add_u32 s39, s39, 16384
    s_waitcnt vmcnt(8)
    s_setpc_b64 s[76:77]
SUB_after_g1:
    s_mov_b64 s[12:13], s[72:73]
    s_mov_b32 s14, 7340032
    s_mov_b32 s15, 0x20000
    v_readlane_b32 s36, v251, 0
    v_readlane_b32 s37, v251, 1
    s_and_b32 s35, s30, 3
    s_mul_i32 s38, s35, 114688
    s_mul_i32 s39, s29, 448
    s_add_u32 s38, s38, s39
    s_and_b32 s36, s36, 15
    s_mul_i32 s36, s36, 458752
    s_add_u32 s36, s36, s38
    s_and_b32 s37, s37, 15
    s_mul_i32 s37, s37, 458752
    s_add_u32 s37, s37, s38
    s_mul_i32 s39, s35, 7168
    s_add_u32 m0, s39, 131072
    s_nop 0
    buffer_load_dwordx4 v241, s[12:15], s36 offen lds
    s_add_u32 m0, m0, 1024
    s_nop 0
    buffer_load_dwordx4 v242, s[12:15], s36 offen lds
    s_add_u32 m0, m0, 1024
    s_nop 0
    buffer_load_dwordx4 v243, s[12:15], s36 offen lds
    s_add_u32 m0, m0, 1024
    s_nop 0
    buffer_load_dwordx4 v244, s[12:15], s36 offen lds
    s_add_u32 m0, m0, 1024
    s_nop 0
    buffer_load_dwordx4 v245, s[12:15], s36 offen lds
    s_add_u32 m0, m0, 1024
    s_nop 0
    buffer_load_dwordx4 v246, s[12:15], s36 offen lds
    s_add_u32 m0, m0, 1024
    s_nop 0
    buffer_load_dwordx4 v247, s[12:15], s36 offen lds
    buffer_load_dwordx4 v[208:211], v241, s[12:15], s37 offen
    buffer_load_dwordx4 v[212:215], v242, s[12:15], s37 offen
    buffer_load_dwordx4 v[216:219], v243, s[12:15], s37 offen
    buffer_load_dwordx4 v[220:223], v244, s[12:15], s37 offen
    buffer_load_dwordx4 v[224:227], v245, s[12:15], s37 offen
    buffer_load_dwordx4 v[228:231], v246, s[12:15], s37 offen
    buffer_load_dwordx4 v[232:235], v247, s[12:15], s37 offen
    s_lshr_b32 s36, s67, 2
    s_sub_u32 s36, s35, s36
    s_and_b32 s36, s36, 3
    s_lshl_b32 s36, s36, 15
    v_add_u32 v6, s36, v2
    ds_write_b128 v6, v[48:51] offset:0
    ds_write_b128 v6, v[52:55] offset:1024
    ds_write_b128 v6, v[56:59] offset:2048
    ds_write_b128 v6, v[60:63] offset:3072
    ds_write_b128 v6, v[64:67] offset:4096
    ds_write_b128 v6, v[68:71] offset:5120
    ds_write_b128 v6, v[72:75] offset:6144
    ds_write_b128 v6, v[76:79] offset:7168
    ds_write_b128 v6, v[80:83] offset:8192
    ds_write_b128 v6, v[84:87] offset:9216
    ds_write_b128 v6, v[88:91] offset:10240
    ds_write_b128 v6, v[92:95] offset:11264
    ds_write_b128 v6, v[96:99] offset:12288
    ds_write_b128 v6, v[100:103] offset:13312
    ds_write_b128 v6, v[104:107] offset:14336
    ds_write_b128 v6, v[108:111] offset:15360
    ds_write_b128 v6, v[112:115] offset:16384
    ds_write_b128 v6, v[116:119] offset:17408
    ds_write_b128 v6, v[120:123] offset:18432
    ds_write_b128 v6, v[124:127] offset:19456
    ds_write_b128 v6, v[128:131] offset:20480
    ds_write_b128 v6, v[132:135] offset:21504
    ds_write_b128 v6, v[136:139] offset:22528
    ds_write_b128 v6, v[140:143] offset:23552
    ds_write_b128 v6, v[144:147] offset:24576
    ds_write_b128 v6, v[148:151] offset:25600
    ds_write_b128 v6, v[152:155] offset:26624
    ds_write_b128 v6, v[156:159] offset:27648
    ds_write_b128 v6, v[160:163] offset:28672
    ds_write_b128 v6, v[164:167] offset:29696
    ds_write_b128 v6, v[168:171] offset:30720
    ds_write_b128 v6, v[172:175] offset:31744
    s_waitcnt vmcnt(0) lgkmcnt(0)
    s_setpc_b64 s[76:77]
SUB_after_g2:
    s_and_b32 s35, s30, 3
    s_mul_i32 s39, s35, 7168
    s_add_u32 s39, s39, 73728
    v_add_u32 v6, s39, v2
    ds_write_b128 v6, v[208:211] offset:0
    ds_write_b128 v6, v[212:215] offset:1024
    ds_write_b128 v6, v[216:219] offset:2048
    ds_write_b128 v6, v[220:223] offset:3072
    ds_write_b128 v6, v[224:227] offset:4096
    ds_write_b128 v6, v[228:231] offset:5120
    ds_write_b128 v6, v[232:235] offset:6144
    s_waitcnt lgkmcnt(0)
    s_setpc_b64 s[76:77]
SUB_w_issue_1:
    s_add_u32 s19, s41, s42
    s_mul_i32 s16, s44, 131072
    s_add_u32 s16, s16, s38
    s_add_u32 s44, s44, 1
    s_and_b32 s44, s44, 15
    s_add_u32 s42, s42, 8192
    s_cmp_eq_u32 s42, 131072
    s_cselect_b32 s42, 0, s42
    s_mov_b32 m0, s19
    s_mov_b32 s39, s16
    buffer_load_dwordx4 v238, s[12:15], s39 offen lds
    s_add_u32 m0, m0, 1024
    s_add_u32 s39, s39, 16384
    buffer_load_dwordx4 v238, s[12:15], s39 offen lds
    s_add_u32 m0, m0, 1024
    s_add_u32 s39, s39, 16384
    buffer_load_dwordx4 v238, s[12:15], s39 offen lds
    s_add_u32 m0, m0, 1024
    s_add_u32 s39, s39, 16384
    buffer_load_dwordx4 v238, s[12:15], s39 offen lds
    s_setpc_b64 s[76:77]
PREP_a_issue_4:
    s_add_u32 s19, s41, s42
    v_readlane_b32 s16, v249, s44
    v_readlane_b32 s17, v250, s44
    s_add_u32 s16, s16, s38
    s_add_u32 s17, s17, s38
    s_add_u32 s44, s44, 1
    s_add_u32 s42, s42, 16384
    s_cmp_eq_u32 s42, 49152
    s_cselect_b32 s42, 0, s42
    s_setpc_b64 s[76:77]
PREP_w_issue_4:
    s_mov_b32 s45, 8192
    s_add_u32 s19, s41, s42
    v_readlane_b32 s16, v249, s44
    s_nop 0
    s_bitcmp1_b32 s16, 0
    s_cselect_b32 s17, 16384, s45
    s_cselect_b32 s18, -40960, s45
    s_andn2_b32 s16, s16, 1
    s_add_u32 s16, s16, s38
    s_add_u32 s44, s44, 1
    s_add_u32 s42, s42, 16384
    s_cmp_eq_u32 s42, 98304
    s_cselect_b32 s42, 0, s42
    s_setpc_b64 s[76:77]
K_end:
    s_endpgm
.p2align 6
K_tab:
.short 4096,5137,6178,11379,18660,25941,33222,40503,47784,55065,12426,19707,26988,34269,41550,48831,56096,9264,10448,20736,23824,25008,35296,38384,39568,49856,52944,54128,0,0,0,0
.short 4096,5137,6178,11379,18660,25941,33222,40503,47784,55065,12426,19707,26988,34269,41550,48831,56096,9264,10448,20736,23824,25008,35296,38384,39568,49856,52944,54128,0,0,0,0
.short 4096,5137,6178,11379,18660,25941,33222,40503,47784,55065,12426,19707,26988,34269,41550,48831,56096,9264,10448,20736,23824,25008,35296,38384,39568,49856,52944,54128,0,0,0,0
.short 4096,5137,6178,11379,18660,25941,33222,40503,47784,55065,12426,19707,26988,34269,41550,48831,56096,9264,10448,20736,23824,25008,35296,38384,39568,49856,52944,54128,0,0,0,0
.short 11377,12418,13459,18660,25941,33222,40503,47784,55065,4106,19707,26988,34269,41550,48831,56096,5136,16544,17728,28016,31104,32288,42576,45664,46848,57136,2880,3168,0,0,0,0
.short 11377,12418,13459,18660,25941,33222,40503,47784,55065,4106,19707,26988,34269,41550,48831,56096,5136,16544,17728,28016,31104,32288,42576,45664,46848,57136,2880,3168,0,0,0,0
.short 11377,12418,13459,18660,25941,33222,40503,47784,55065,4106,19707,26988,34269,41550,48831,56096,5136,16544,17728,28016,31104,32288,42576,45664,46848,57136,2880,3168,0,0,0,0
.short 11377,12418,13459,18660,25941,33222,40503,47784,55065,4106,19707,26988,34269,41550,48831,56096,5136,16544,17728,28016,31104,32288,42576,45664,46848,57136,2880,3168,0,0,0,0
.short 18658,19699,20740,25941,33222,40503,47784,55065,4106,11387,26988,34269,41550,48831,56096,5137,12416,23824,25008,35296,38384,39568,49856,52944,54128,6176,9264,10448,0,0,0,0
.short 18658,19699,20740,25941,33222,40503,47784,55065,4106,11387,26988,34269,41550,48831,56096,5137,12416,23824,25008,35296,38384,39568,49856,52944,54128,6176,9264,10448,0,0,0,0
.short 18658,19699,20740,25941,33222,40503,47784,55065,4106,11387,26988,34269,41550,48831,56096,5137,12416,23824,25008,35296,38384,39568,49856,52944,54128,6176,9264,10448,0,0,0,0
.short 18658,19699,20740,25941,33222,40503,47784,55065,4106,11387,26988,34269,41550,48831,56096,5137,12416,23824,25008,35296,38384,39568,49856,52944,54128,6176,9264,10448,0,0,0,0
.short 25939,26980,28021,33222,40503,47784,55065,4106,11387,18668,34269,41550,48831,56096,5137,12418,19696,31104,32288,42576,45664,46848,57136,2880,3168,13456,16544,17728,0,0,0,0
.short 25939,26980,28021,33222,40503,47784,55065,4106,11387,18668,34269,41550,48831,56096,5137,12418,19696,31104,32288,42576,45664,46848,57136,2880,3168,13456,16544,17728,0,0,0,0
.short 25939,26980,28021,33222,40503,47784,55065,4106,11387,18668,34269,41550,48831,56096,5137,12418,19696,31104,32288,42576,45664,46848,57136,2880,3168,13456,16544,17728,0,0,0,0
.short 25939,26980,28021,33222,40503,47784,55065,4106,11387,18668,34269,41550,48831,56096,5137,12418,19696,31104,32288,42576,45664,46848,57136,2880,3168,13456,16544,17728,0,0,0,0
.short 33220,34261,35302,40503,47784,55065,4106,11387,18668,25949,41550,48831,56096,5137,12418,19699,26976,38384,39568,49856,52944,54128,6176,9264,10448,20736,23824,25008,0,0,0,0
.short 33220,34261,35302,40503,47784,55065,4106,11387,18668,25949,41550,48831,56096,5137,12418,19699,26976,38384,39568,49856,52944,54128,6176,9264,10448,20736,23824,25008,0,0,0,0
.short 33220,34261,35302,40503,47784,55065,4106,11387,18668,25949,41550,48831,56096,5137,12418,19699,26976,38384,39568,49856,52944,54128,6176,9264,10448,20736,23824,25008,0,0,0,0
.short 33220,34261,35302,40503,47784,55065,4106,11387,18668,25949,41550,48831,56096,5137,12418,19699,26976,38384,39568,49856,52944,54128,6176,9264,10448,20736,23824,25008,0,0,0,0
.short 40501,41542,42583,47784,55065,4106,11387,18668,25949,33230,48831,56096,5137,12418,19699,26980,34256,45664,46848,57136,2880,3168,13456,16544,17728,28016,31104,32288,0,0,0,0
.short 40501,41542,42583,47784,55065,4106,11387,18668,25949,33230,48831,56096,5137,12418,19699,26980,34256,45664,46848,57136,2880,3168,13456,16544,17728,28016,31104,32288,0,0,0,0
.short 40501,41542,42583,47784,55065,4106,11387,18668,25949,33230,48831,56096,5137,12418,19699,26980,34256,45664,46848,57136,2880,3168,13456,16544,17728,28016,31104,32288,0,0,0,0
.short 40501,41542,42583,47784,55065,4106,11387,18668,25949,33230,48831,56096,5137,12418,19699,26980,34256,45664,46848,57136,2880,3168,13456,16544,17728,28016,31104,32288,0,0,0,0
.short 47782,48823,49864,55065,4106,11387,18668,25949,33230,40511,56096,5137,12418,19699,26980,34261,41536,52944,54128,6176,9264,10448,20736,23824,25008,35296,38384,39568,0,0,0,0
.short 47782,48823,49864,55065,4106,11387,18668,25949,33230,40511,56096,5137,12418,19699,26980,34261,41536,52944,54128,6176,9264,10448,20736,23824,25008,35296,38384,39568,0,0,0,0
.short 47782,48823,49864,55065,4106,11387,18668,25949,33230,40511,56096,5137,12418,19699,26980,34261,41536,52944,54128,6176,9264,10448,20736,23824,25008,35296,38384,39568,0,0,0,0
.short 47782,48823,49864,55065,4106,11387,18668,25949,33230,40511,56096,5137,12418,19699,26980,34261,41536,52944,54128,6176,9264,10448,20736,23824,25008,35296,38384,39568,0,0,0,0
.short 55063,56104,57145,4106,11387,18668,25949,33230,40511,47776,5137,12418,19699,26980,34261,41542,48816,2880,3168,13456,16544,17728,28016,31104,32288,42576,45664,46848,0,0,0,0
.short 55063,56104,57145,4106,11387,18668,25949,33230,40511,47776,5137,12418,19699,26980,34261,41542,48816,2880,3168,13456,16544,17728,28016,31104,32288,42576,45664,46848,0,0,0,0
.short 55063,56104,57145,4106,11387,18668,25949,33230,40511,47776,5137,12418,19699,26980,34261,41542,48816,2880,3168,13456,16544,17728,28016,31104,32288,42576,45664,46848,0,0,0,0
.short 55063,56104,57145,4106,11387,18668,25949,33230,40511,47776,5137,12418,19699,26980,34261,41542,48816,2880,3168,13456,16544,17728,28016,31104,32288,42576,45664,46848,0,0,0,0
.short 4104,5145,6186,11387,18668,25949,33230,40511,47776,55057,12418,19699,26980,34261,41542,48823,56096,9264,10448,20736,23824,25008,35296,38384,39568,49856,52944,54128,0,0,0,0
.short 4104,5145,6186,11387,18668,25949,33230,40511,47776,55057,12418,19699,26980,34261,41542,48823,56096,9264,10448,20736,23824,25008,35296,38384,39568,49856,52944,54128,0,0,0,0
.short 4104,5145,6186,11387,18668,25949,33230,40511,47776,55057,12418,19699,26980,34261,41542,48823,56096,9264,10448,20736,23824,25008,35296,38384,39568,49856,52944,54128,0,0,0,0
.short 4104,5145,6186,11387,18668,25949,33230,40511,47776,55057,12418,19699,26980,34261,41542,48823,56096,9264,10448,20736,23824,25008,35296,38384,39568,49856,52944,54128,0,0,0,0
.short 11385,12426,13467,18668,25949,33230,40511,47776,55057,4098,19699,26980,34261,41542,48823,56104,5136,16544,17728,28016,31104,32288,42576,45664,46848,57136,2880,3168,0,0,0,0
.short 11385,12426,13467,18668,25949,33230,40511,47776,55057,4098,19699,26980,34261,41542,48823,56104,5136,16544,17728,28016,31104,32288,42576,45664,46848,57136,2880,3168,0,0,0,0
.short 11385,12426,13467,18668,25949,33230,40511,47776,55057,4098,19699,26980,34261,41542,48823,56104,5136,16544,17728,28016,31104,32288,42576,45664,46848,57136,2880,3168,0,0,0,0
.short 11385,12426,13467,18668,25949,33230,40511,47776,55057,4098,19699,26980,34261,41542,48823,56104,5136,16544,17728,28016,31104,32288,42576,45664,46848,57136,2880,3168,0,0,0,0
.short 18666,19707,20748,25949,33230,40511,47776,55057,4098,11379,26980,34261,41542,48823,56104,5145,12416,23824,25008,35296,38384,39568,49856,52944,54128,6176,9264,10448,0,0,0,0
.short 18666,19707,20748,25949,33230,40511,47776,55057,4098,11379,26980,34261,41542,48823,56104,5145,12416,23824,25008,35296,38384,39568,49856,52944,54128,6176,9264,10448,0,0,0,0
.short 18666,19707,20748,25949,33230,40511,47776,55057,4098,11379,26980,34261,41542,48823,56104,5145,12416,23824,25008,35296,38384,39568,49856,52944,54128,6176,9264,10448,0,0,0,0
.short 18666,19707,20748,25949,33230,40511,47776,55057,4098,11379,26980,34261,41542,48823,56104,5145,12416,23824,25008,35296,38384,39568,49856,52944,54128,6176,9264,10448,0,0,0,0
.short 25947,26988,28029,33230,40511,47776,55057,4098,11379,18660,34261,41542,48823,56104,5145,12426,19696,31104,32288,42576,45664,46848,57136,2880,3168,13456,16544,17728,0,0,0,0
.short 25947,26988,28029,33230,40511,47776,55057,4098,11379,18660,34261,41542,48823,56104,5145,12426,19696,31104,32288,42576,45664,46848,57136,2880,3168,13456,16544,17728,0,0,0,0
.short 25947,26988,28029,33230,40511,47776,55057,4098,11379,18660,34261,41542,48823,56104,5145,12426,19696,31104,32288,42576,45664,46848,57136,2880,3168,13456,16544,17728,0,0,0,0
.short 25947,26988,28029,33230,40511,47776,55057,4098,11379,18660,34261,41542,48823,56104,5145,12426,19696,31104,32288,42576,45664,46848,57136,2880,3168,13456,16544,17728,0,0,0,0
.short 33228,34269,35310,40511,47776,55057,4098,11379,18660,25941,41542,48823,56104,5145,12426,19707,26976,38384,39568,49856,52944,54128,6176,9264,10448,20736,23824,25008,0,0,0,0
.short 33228,34269,35310,40511,47776,55057,4098,11379,18660,25941,41542,48823,56104,5145,12426,19707,26976,38384,39568,49856,52944,54128,6176,9264,10448,20736,23824,25008,0,0,0,0
.short 33228,34269,35310,40511,47776,55057,4098,11379,18660,25941,41542,48823,56104,5145,12426,19707,26976,38384,39568,49856,52944,54128,6176,9264,10448,20736,23824,25008,0,0,0,0
.short 33228,34269,35310,40511,47776,55057,4098,11379,18660,25941,41542,48823,56104,5145,12426,19707,26976,38384,39568,49856,52944,54128,6176,9264,10448,20736,23824,25008,0,0,0,0
.short 40509,41550,42591,47776,55057,4098,11379,18660,25941,33222,48823,56104,5145,12426,19707,26988,34256,45664,46848,57136,2880,3168,13456,16544,17728,28016,31104,32288,0,0,0,0
.short 40509,41550,42591,47776,55057,4098,11379,18660,25941,33222,48823,56104,5145,12426,19707,26988,34256,45664,46848,57136,2880,3168,13456,16544,17728,28016,31104,32288,0,0,0,0
.short 40509,41550,42591,47776,55057,4098,11379,18660,25941,33222,48823,56104,5145,12426,19707,26988,34256,45664,46848,57136,2880,3168,13456,16544,17728,28016,31104,32288,0,0,0,0
.short 40509,41550,42591,47776,55057,4098,11379,18660,25941,33222,48823,56104,5145,12426,19707,26988,34256,45664,46848,57136,2880,3168,13456,16544,17728,28016,31104,32288,0,0,0,0
.short 47790,48831,49856,55057,4098,11379,18660,25941,33222,40503,56104,5145,12426,19707,26988,34269,41536,52944,54128,6176,9264,10448,20736,23824,25008,35296,38384,39568,0,0,0,0
.short 47790,48831,49856,55057,4098,11379,18660,25941,33222,40503,56104,5145,12426,19707,26988,34269,41536,52944,54128,6176,9264,10448,20736,23824,25008,35296,38384,39568,0,0,0,0
.short 47790,48831,49856,55057,4098,11379,18660,25941,33222,40503,56104,5145,12426,19707,26988,34269,41536,52944,54128,6176,9264,10448,20736,23824,25008,35296,38384,39568,0,0,0,0
.short 47790,48831,49856,55057,4098,11379,18660,25941,33222,40503,56104,5145,12426,19707,26988,34269,41536,52944,54128,6176,9264,10448,20736,23824,25008,35296,38384,39568,0,0,0,0
.short 55071,56096,57137,4098,11379,18660,25941,33222,40503,47784,5145,12426,19707,26988,34269,41550,48816,2880,3168,13456,16544,17728,28016,31104,32288,42576,45664,46848,0,0,0,0
.short 55071,56096,57137,4098,11379,18660,25941,33222,40503,47784,5145,12426,19707,26988,34269,41550,48816,2880,3168,13456,16544,17728,28016,31104,32288,42576,45664,46848,0,0,0,0
.short 55071,56096,57137,4098,11379,18660,25941,33222,40503,47784,5145,12426,19707,26988,34269,41550,48816,2880,3168,13456,16544,17728,28016,31104,32288,42576,45664,46848,0,0,0,0
.short 55071,56096,57137,4098,11379,18660,25941,33222,40503,47784,5145,12426,19707,26988,34269,41550,48816,2880,3168,13456,16544,17728,28016,31104,32288,42576,45664,46848,0,0,0,0
.section .rodata,"a"
.p2align 6
.amdhsa_kernel interleave_layers__ssm_conv_h3__mixer_s_mlp__prompt_kernel
  .amdhsa_next_free_vgpr 256
  .amdhsa_next_free_sgpr 102
  .amdhsa_accum_offset 256
  .amdhsa_group_segment_fixed_size 0
  .amdhsa_kernarg_size 112
  .amdhsa_user_sgpr_count 2
  .amdhsa_user_sgpr_kernarg_segment_ptr 1
  .amdhsa_system_sgpr_workgroup_id_x 1
  .amdhsa_float_denorm_mode_32 3
.end_amdhsa_kernel
```

```asm
; @launch grid=(256,1,1) block=(512,1,1) lds=163840
.amdgcn_target "amdgcn-amd-amdhsa--gfx950"
.text
.globl interleave_layers__ssm_conv_h3__mixer_s_mlp__prompt_kernel
.p2align 8
.type interleave_layers__ssm_conv_h3__mixer_s_mlp__prompt_kernel,@function
interleave_layers__ssm_conv_h3__mixer_s_mlp__prompt_kernel:
    s_cmp_ge_u32 s2, 256
    s_cbranch_scc1 K_end
    s_load_dwordx8 s[8:15], s[0:1], 8
    s_load_dwordx2 s[6:7], s[0:1], 0
    s_load_dwordx8 s[68:75], s[0:1], 56
    s_load_dwordx2 s[4:5], s[0:1], 104
    s_load_dwordx2 s[84:85], s[0:1], 96
    s_memrealtime s[46:47]
    s_load_dwordx2 s[96:97], s[0:1], 40
    v_lshrrev_b32 v1, 6, v0
    s_nop 0
    v_readfirstlane_b32 s30, v1
    s_getpc_b64 s[48:49]
K_pc:
    s_lshr_b32 s36, s2, 3
    s_lshl_b32 s36, s36, 11
    v_lshlrev_b32 v4, 2, v0
    v_add_u32 v4, s36, v4
    v_cmp_gt_u32 vcc, K_end-K_pc-8, v4
    s_nop 0
    s_and_saveexec_b64 s[36:37], vcc
    s_cbranch_execz K_3
    v_mov_b32 v5, s49
    v_add_co_u32 v4, vcc, s48, v4
    s_nop 1
    v_addc_co_u32 v5, vcc, 0, v5, vcc
    global_load_dword v250, v[4:5], off
K_3:
    s_mov_b64 exec, -1
    v_and_b32 v6, 31, v0
    v_lshrrev_b32 v7, 5, v0
    s_and_b32 s34, s2, 7
    s_lshr_b32 s35, s2, 3
    s_lshl_b32 s36, s35, 17
    s_lshl_b32 s37, s34, 8
    s_add_u32 s36, s36, s37
    v_lshlrev_b32 v8, 13, v7
    v_lshl_add_u32 v8, v6, 3, v8
    v_add_u32 v12, s36, v8
    v_add_u32 v14, 4096, v12
    s_mov_b32 s18, 4194304
    s_mov_b32 s19, 0x20000
    s_mov_b32 s22, s18
    s_mov_b32 s23, s19
    s_waitcnt lgkmcnt(0)
    s_mov_b32 s86, 256
    s_mov_b32 s87, 0x20000
    v_mov_b32 v78, 0
    s_lshl_b32 s45, s2, 3
    s_add_u32 s45, s45, s30
    s_cmp_lg_u32 s45, 4
    s_cbranch_scc1 KV_t0
    s_lshl_b32 s44, s46, 6
    s_or_b32 s44, s44, 1
    v_mov_b32 v76, s44
    s_mov_b64 exec, 1
    buffer_store_dword v76, v78, s[84:87], 0 offen sc1
    s_mov_b64 exec, -1
KV_t0:
    s_mov_b64 s[16:17], s[8:9]
    s_mov_b64 s[20:21], s[10:11]
    buffer_load_dwordx2 v[28:29], v12, s[16:19], 0 offen offset:0 nt
    buffer_load_dwordx2 v[30:31], v12, s[16:19], 0 offen offset:2048 nt
    buffer_load_dwordx2 v[32:33], v14, s[16:19], 0 offen offset:0 nt
    buffer_load_dwordx2 v[34:35], v14, s[16:19], 0 offen offset:2048 nt
    buffer_load_dwordx2 v[36:37], v12, s[20:23], 0 offen offset:0 nt
    buffer_load_dwordx2 v[38:39], v12, s[20:23], 0 offen offset:2048 nt
    buffer_load_dwordx2 v[40:41], v14, s[20:23], 0 offen offset:0 nt
    buffer_load_dwordx2 v[42:43], v14, s[20:23], 0 offen offset:2048 nt
    v_subrev_u32 v9, 6144, v12
    v_subrev_u32 v10, 4096, v12
    v_subrev_u32 v11, 2048, v12
    s_lshl_b32 s37, s34, 10
    v_lshlrev_b32 v16, 5, v6
    v_add_u32 v16, s37, v16
    s_mov_b32 s24, s12
    s_mov_b32 s25, s13
    s_mov_b32 s26, 0x2000
    s_mov_b32 s27, 0x20000
    buffer_load_dwordx4 v[44:47], v16, s[24:27], 0 offen offset:0
    buffer_load_dwordx4 v[48:51], v16, s[24:27], 0 offen offset:16
    s_cmp_lg_u32 s30, 4
    s_cbranch_scc1 KV_t2
    buffer_load_dword v76, v78, s[84:87], 0 offen sc1
KV_t2:
    buffer_load_dwordx2 v[22:23], v9, s[16:19], 0 offen nt
    buffer_load_dwordx2 v[24:25], v10, s[16:19], 0 offen nt
    buffer_load_dwordx2 v[26:27], v11, s[16:19], 0 offen nt
    v_and_b32 v1, 63, v0
    v_lshlrev_b32 v2, 4, v1
    v_lshlrev_b32 v3, 2, v1
    s_and_b32 s32, s2, 7
    s_lshr_b32 s33, s2, 3
    s_and_b32 s28, s32, 2
    s_lshr_b32 s34, s32, 2
    s_or_b32 s28, s28, s34
    s_lshl_b32 s28, s28, 2
    s_and_b32 s34, s33, 3
    s_add_u32 s28, s28, s34
    s_and_b32 s31, s32, 1
    s_lshr_b32 s33, s33, 2
    s_lshl_b32 s29, s31, 3
    s_add_u32 s29, s29, s33
    s_lshl_b32 s67, s33, 1
    s_and_b32 s67, s67, 0
    s_mov_b32 s60, 0
    s_mov_b32 s61, 40000
    s_mov_b32 s52, 0
    s_mov_b32 s55, 0
    s_mov_b32 s92, 0
    s_mov_b32 s93, 0
    s_mov_b32 s94, 0
    s_mov_b32 s56, s4
    s_mov_b32 s57, s5
    s_mov_b32 s58, 0xa000000
    s_mov_b32 s59, 0x20000
    v_and_b32 v179, 7, v0
    v_lshrrev_b32 v196, 6, v0
    v_lshlrev_b32 v196, 4, v196
    v_bfe_u32 v197, v0, 3, 3
    v_add_u32 v196, v196, v197
    s_lshr_b32 s78, s29, 1
    s_lshl_b32 s78, s78, 16
    s_and_b32 s79, s29, 1
    s_lshl_b32 s79, s79, 7
    s_add_u32 s78, s78, s79
    s_lshr_b32 s79, s30, 1
    s_lshl_b32 s79, s79, 13
    s_add_u32 s78, s78, s79
    v_lshlrev_b32 v176, 8, v196
    v_lshl_add_u32 v176, v179, 4, v176
    v_add_u32 v176, s78, v176
    s_lshl_b32 s78, s28, 7
    s_lshl_b32 s79, s29, 3
    s_add_u32 s78, s78, s79
    v_add_u32 v177, s78, v179
    v_lshlrev_b32 v178, 11, v177
    v_lshrrev_b32 v197, 2, v196
    v_lshlrev_b32 v197, 3, v197
    v_and_b32 v196, 3, v196
    v_add_u32 v196, v196, v197
    v_lshl_add_u32 v178, v196, 3, v178
    v_lshlrev_b32 v177, 3, v177
    v_lshl_add_u32 v177, v196, 14, v177
    s_add_u32 s62, s4, 33554432
    s_addc_u32 s63, s5, 0
    s_and_b32 s41, s30, 3
    s_and_b32 s38, s2, 7
    s_lshl_b32 s38, s38, 5
    s_lshr_b32 s39, s2, 3
    s_add_u32 s38, s38, s39
    s_lshl_b32 s39, s38, 2
    s_add_u32 s39, s39, s41
    s_mul_i32 s40, s41, 24576
    s_lshr_b32 s36, s39, 1
    s_lshl_b32 s36, s36, 2
    s_load_dword s98, s[96:97], s36
    s_lshl_b32 s36, s39, 12
    s_add_u32 s12, s14, s36
    s_addc_u32 s13, s15, 0
    s_mov_b32 s14, 4096
    s_mov_b32 s15, 0x20000
    s_lshr_b32 s45, s30, 2
    s_lshl_b32 s45, s45, 11
    s_add_u32 s36, s45, 0xffffffc0
    v_add_u32 v70, s36, v2
    v_add_u32 v71, 16, v70
    s_add_u32 s36, s45, 0x3c0
    v_add_u32 v72, s36, v2
    v_add_u32 v73, 16, v72
    s_mov_b32 s36, 4032
    v_add_u32 v74, s36, v2
    v_add_u32 v75, 16, v74
    s_and_b32 s34, s2, 7
    s_lshr_b32 s35, s2, 3
    v_mov_b32 v80, 0
    v_mov_b32 v81, 0
    v_mov_b32 v82, 0
    v_mov_b32 v83, 0
    v_add_u32 v86, s40, v2
    ds_write_b128 v86, v[80:83] offset:22784
    s_bfm_b64 exec, 26, 0
    ds_write_b128 v86, v[80:83] offset:23808
    s_mov_b64 exec, -1
    v_lshlrev_b32 v8, 2, v7
    v_sub_u32 v8, 60, v8
    v_lshrrev_b32 v85, 3, v8
    v_bfe_u32 v84, v6, 1, 3
    v_xor_b32 v85, v85, v84
    v_lshlrev_b32 v85, 4, v85
    v_and_b32 v8, 7, v8
    v_lshl_add_u32 v85, v8, 1, v85
    v_lshl_add_u32 v84, v6, 9, v85
    v_add_u32 v84, 98304, v84
    s_waitcnt vmcnt(0)
    s_cmp_lg_u32 s30, 4
    s_cbranch_scc1 KV_t1
KV_t1:
    buffer_load_dwordx4 v[52:55], v70, s[12:15], 0 offen nt
    buffer_load_dwordx2 v[56:57], v71, s[12:15], 0 offen nt
    buffer_load_dwordx4 v[58:61], v72, s[12:15], 0 offen nt
    buffer_load_dwordx2 v[62:63], v73, s[12:15], 0 offen nt
    buffer_load_dwordx4 v[64:67], v74, s[12:15], 0 offen nt
    buffer_load_dwordx2 v[68:69], v75, s[12:15], 0 offen nt
    v_lshlrev_b32 v88, 16, v44
    v_and_b32 v90, 0xffff0000, v44
    v_lshlrev_b32 v92, 16, v45
    v_and_b32 v94, 0xffff0000, v45
    v_lshlrev_b32 v89, 16, v46
    v_and_b32 v91, 0xffff0000, v46
    v_lshlrev_b32 v93, 16, v47
    v_and_b32 v95, 0xffff0000, v47
    v_lshlrev_b32 v96, 16, v22
    v_and_b32 v97, 0xffff0000, v22
    v_lshlrev_b32 v98, 16, v24
    v_and_b32 v99, 0xffff0000, v24
    v_lshlrev_b32 v100, 16, v26
    v_and_b32 v101, 0xffff0000, v26
    v_lshlrev_b32 v102, 16, v28
    v_and_b32 v103, 0xffff0000, v28
    v_lshlrev_b32 v104, 16, v30
    v_and_b32 v105, 0xffff0000, v30
    v_lshlrev_b32 v106, 16, v32
    v_and_b32 v107, 0xffff0000, v32
    v_lshlrev_b32 v108, 16, v34
    v_and_b32 v109, 0xffff0000, v34
    v_lshlrev_b32 v110, 16, v36
    v_and_b32 v111, 0xffff0000, v36
    v_lshlrev_b32 v112, 16, v38
    v_and_b32 v113, 0xffff0000, v38
    v_lshlrev_b32 v114, 16, v40
    v_and_b32 v115, 0xffff0000, v40
    v_lshlrev_b32 v116, 16, v42
    v_and_b32 v117, 0xffff0000, v42
    v_pk_mul_f32 v[118:119], v[96:97], v[94:95]
    v_pk_mul_f32 v[120:121], v[98:99], v[94:95]
    v_pk_mul_f32 v[122:123], v[100:101], v[94:95]
    v_pk_mul_f32 v[124:125], v[102:103], v[94:95]
    v_pk_fma_f32 v[118:119], v[98:99], v[92:93], v[118:119]
    v_pk_fma_f32 v[120:121], v[100:101], v[92:93], v[120:121]
    v_pk_fma_f32 v[122:123], v[102:103], v[92:93], v[122:123]
    v_pk_fma_f32 v[124:125], v[104:105], v[92:93], v[124:125]
    v_pk_fma_f32 v[118:119], v[100:101], v[90:91], v[118:119]
    v_pk_fma_f32 v[120:121], v[102:103], v[90:91], v[120:121]
    v_pk_fma_f32 v[122:123], v[104:105], v[90:91], v[122:123]
    v_pk_fma_f32 v[124:125], v[106:107], v[90:91], v[124:125]
    v_pk_fma_f32 v[118:119], v[102:103], v[88:89], v[118:119]
    v_pk_fma_f32 v[120:121], v[104:105], v[88:89], v[120:121]
    v_pk_fma_f32 v[122:123], v[106:107], v[88:89], v[122:123]
    v_pk_fma_f32 v[124:125], v[108:109], v[88:89], v[124:125]
    v_pk_mul_f32 v[118:119], v[118:119], v[110:111]
    v_pk_mul_f32 v[120:121], v[120:121], v[112:113]
    v_pk_mul_f32 v[122:123], v[122:123], v[114:115]
    v_pk_mul_f32 v[124:125], v[124:125], v[116:117]
    v_cvt_pk_bf16_f32 v136, v124, v122
    v_cvt_pk_bf16_f32 v137, v120, v118
    ds_write_b64 v84, v[136:137] offset:0
    v_cvt_pk_bf16_f32 v138, v125, v123
    v_cvt_pk_bf16_f32 v139, v121, v119
    ds_write_b64 v84, v[138:139] offset:128
    v_lshlrev_b32 v88, 16, v48
    v_and_b32 v90, 0xffff0000, v48
    v_lshlrev_b32 v92, 16, v49
    v_and_b32 v94, 0xffff0000, v49
    v_lshlrev_b32 v89, 16, v50
    v_and_b32 v91, 0xffff0000, v50
    v_lshlrev_b32 v93, 16, v51
    v_and_b32 v95, 0xffff0000, v51
    v_lshlrev_b32 v96, 16, v23
    v_and_b32 v97, 0xffff0000, v23
    v_lshlrev_b32 v98, 16, v25
    v_and_b32 v99, 0xffff0000, v25
    v_lshlrev_b32 v100, 16, v27
    v_and_b32 v101, 0xffff0000, v27
    v_lshlrev_b32 v102, 16, v29
    v_and_b32 v103, 0xffff0000, v29
    v_lshlrev_b32 v104, 16, v31
    v_and_b32 v105, 0xffff0000, v31
    v_lshlrev_b32 v106, 16, v33
    v_and_b32 v107, 0xffff0000, v33
    v_lshlrev_b32 v108, 16, v35
    v_and_b32 v109, 0xffff0000, v35
    v_lshlrev_b32 v110, 16, v37
    v_and_b32 v111, 0xffff0000, v37
    v_lshlrev_b32 v112, 16, v39
    v_and_b32 v113, 0xffff0000, v39
    v_lshlrev_b32 v114, 16, v41
    v_and_b32 v115, 0xffff0000, v41
    v_lshlrev_b32 v116, 16, v43
    v_and_b32 v117, 0xffff0000, v43
    v_pk_mul_f32 v[118:119], v[96:97], v[94:95]
    v_pk_mul_f32 v[120:121], v[98:99], v[94:95]
    v_pk_mul_f32 v[122:123], v[100:101], v[94:95]
    v_pk_mul_f32 v[124:125], v[102:103], v[94:95]
    v_pk_fma_f32 v[118:119], v[98:99], v[92:93], v[118:119]
    v_pk_fma_f32 v[120:121], v[100:101], v[92:93], v[120:121]
    v_pk_fma_f32 v[122:123], v[102:103], v[92:93], v[122:123]
    v_pk_fma_f32 v[124:125], v[104:105], v[92:93], v[124:125]
    v_pk_fma_f32 v[118:119], v[100:101], v[90:91], v[118:119]
    v_pk_fma_f32 v[120:121], v[102:103], v[90:91], v[120:121]
    v_pk_fma_f32 v[122:123], v[104:105], v[90:91], v[122:123]
    v_pk_fma_f32 v[124:125], v[106:107], v[90:91], v[124:125]
    v_pk_fma_f32 v[118:119], v[102:103], v[88:89], v[118:119]
    v_pk_fma_f32 v[120:121], v[104:105], v[88:89], v[120:121]
    v_pk_fma_f32 v[122:123], v[106:107], v[88:89], v[122:123]
    v_pk_fma_f32 v[124:125], v[108:109], v[88:89], v[124:125]
    v_pk_mul_f32 v[118:119], v[118:119], v[110:111]
    v_pk_mul_f32 v[120:121], v[120:121], v[112:113]
    v_pk_mul_f32 v[122:123], v[122:123], v[114:115]
    v_pk_mul_f32 v[124:125], v[124:125], v[116:117]
    v_cvt_pk_bf16_f32 v140, v124, v122
    v_cvt_pk_bf16_f32 v141, v120, v118
    ds_write_b64 v84, v[140:141] offset:256
    v_cvt_pk_bf16_f32 v142, v125, v123
    v_cvt_pk_bf16_f32 v143, v121, v119
    ds_write_b64 v84, v[142:143] offset:384
    s_cmp_lg_u32 s30, 4
    s_cbranch_scc1 HB_2
    v_add_u32 v18, 162816, v3
    ds_write_b32 v18, v78
    s_mov_b32 s53, 0
    s_waitcnt vmcnt(6)
HB_p:
    v_readfirstlane_b32 s52, v76
    s_nop 0
    s_cmp_lg_u32 s52, 0
    s_cbranch_scc1 HB_q
    buffer_load_dword v76, v78, s[84:87], 0 offen sc1
    s_waitcnt vmcnt(0)
    s_add_u32 s53, s53, 1
    s_cmp_lt_u32 s53, s61
    s_cbranch_scc1 HB_p
    s_mov_b32 s52, 1
    s_mov_b32 s61, 0
HB_q:
    v_mov_b32 v18, 162828
    v_mov_b32 v19, s52
    s_waitcnt lgkmcnt(0)
    ds_write_b32 v18, v19
HB_2:
    s_add_u32 s16, s4, 0x1800000
    s_addc_u32 s17, s5, 0
    s_mov_b32 s18, 0x400000
    s_mov_b32 s19, 0x20000
    v_lshrrev_b32 v8, 3, v0
    v_and_b32 v85, 7, v0
    v_lshlrev_b32 v149, 12, v8
    v_lshl_add_u32 v149, v85, 4, v149
    s_lshl_b32 s36, s34, 19
    s_sub_u32 s37, 31, s35
    s_lshl_b32 s37, s37, 7
    s_add_u32 s36, s36, s37
    s_add_u32 s37, s36, 262144
    v_lshrrev_b32 v148, 3, v8
    v_xor_b32 v148, v148, v85
    v_lshlrev_b32 v148, 4, v148
    v_lshl_add_u32 v148, v8, 7, v148
    v_add_u32 v148, 98304, v148
    v_mov_b32 v18, 162828
    s_waitcnt lgkmcnt(0)
    s_barrier
    ds_read_b128 v[152:155], v148 offset:0
    ds_read_b128 v[156:159], v148 offset:8192
    ds_read_b32 v19, v18
    s_waitcnt lgkmcnt(2)
    buffer_store_dwordx4 v[152:155], v149, s[16:19], s36 offen sc1
    s_waitcnt lgkmcnt(1)
    buffer_store_dwordx4 v[156:159], v149, s[16:19], s37 offen sc1
    s_waitcnt lgkmcnt(0)
    v_readfirstlane_b32 s52, v19
    s_cmp_lg_u32 s30, 0
    s_cbranch_scc1 KV_ni
    s_cmp_ge_u32 s35, 16
    s_cbranch_scc1 KV_ni
    v_mov_b32 v8, s52
    s_lshl_b32 s37, s34, 7
    s_lshl_b32 s53, s35, 10
    s_add_u32 s37, s37, s53
    s_add_u32 s37, s37, 23101440
    s_mov_b64 exec, 1
    buffer_store_dword v8, v78, s[56:59], s37 offen sc1
    s_mov_b64 exec, -1
KV_ni:
    s_cmp_ge_u32 s2, 255
    s_cbranch_scc1 KV_n3
    s_cmp_lg_u32 s30, 5
    s_cbranch_scc1 KV_n3
    s_and_b32 s42, s2, 31
    s_lshl_b32 s42, s42, 8
    s_lshr_b32 s43, s2, 5
    s_lshl_b32 s43, s43, 14
    s_add_u32 s42, s42, s43
    s_add_u32 s42, s42, 35520512
    v_and_b32 v8, 1, v1
    v_lshlrev_b32 v8, 13, v8
    v_lshrrev_b32 v85, 1, v1
    v_lshl_add_u32 v8, v85, 7, v8
    s_mov_b64 exec, 0xf
    buffer_store_dword v8, v8, s[56:59], s42 offen sc1
    s_mov_b64 exec, -1
KV_n3:
    s_lshl_b32 s36, s34, 5
    s_add_u32 s36, s36, s35
    s_lshl_b32 s36, s36, 7
    s_add_u32 s36, s36, 23068672
    v_mov_b32 v18, 1
    v_mov_b32 v19, 162820
    v_mov_b32 v21, 0
    s_mov_b64 exec, 1
    s_waitcnt vmcnt(0)
    ds_add_rtn_u32 v20, v19, v18
    v_mov_b32 v19, s52
    s_waitcnt lgkmcnt(0)
    v_readfirstlane_b32 s54, v20
    s_nop 0
    s_and_b32 s54, s54, 7
    s_cmp_lg_u32 s54, 7
    s_cbranch_scc1 pub_1
    buffer_store_dword v19, v21, s[56:59], s36 offen sc1
pub_1:
    s_mov_b64 exec, -1
    v_add_u32 v160, s45, v86
    v_alignbit_b32 v88, v53, v52, 16
    v_mov_b32 v92, v53
    v_alignbit_b32 v96, v54, v53, 16
    v_alignbit_b32 v89, v54, v53, 16
    v_mov_b32 v93, v54
    v_alignbit_b32 v97, v55, v54, 16
    v_alignbit_b32 v90, v55, v54, 16
    v_mov_b32 v94, v55
    v_alignbit_b32 v98, v56, v55, 16
    v_alignbit_b32 v91, v56, v55, 16
    v_mov_b32 v95, v56
    v_alignbit_b32 v99, v57, v56, 16
    ds_write_b128 v160, v[88:91] offset:0
    ds_write_b128 v160, v[92:95] offset:4160
    ds_write_b128 v160, v[96:99] offset:8320
    ds_write_b128 v160, v[54:57] offset:12480
    v_alignbit_b32 v100, v59, v58, 16
    v_mov_b32 v104, v59
    v_alignbit_b32 v108, v60, v59, 16
    v_alignbit_b32 v101, v60, v59, 16
    v_mov_b32 v105, v60
    v_alignbit_b32 v109, v61, v60, 16
    v_alignbit_b32 v102, v61, v60, 16
    v_mov_b32 v106, v61
    v_alignbit_b32 v110, v62, v61, 16
    v_alignbit_b32 v103, v62, v61, 16
    v_mov_b32 v107, v62
    v_alignbit_b32 v111, v63, v62, 16
    ds_write_b128 v160, v[100:103] offset:1024
    ds_write_b128 v160, v[104:107] offset:5184
    ds_write_b128 v160, v[108:111] offset:9344
    ds_write_b128 v160, v[60:63] offset:13504
    v_alignbit_b32 v112, v65, v64, 16
    v_mov_b32 v116, v65
    v_alignbit_b32 v120, v66, v65, 16
    v_alignbit_b32 v113, v66, v65, 16
    v_mov_b32 v117, v66
    v_alignbit_b32 v121, v67, v66, 16
    v_alignbit_b32 v114, v67, v66, 16
    v_mov_b32 v118, v67
    v_alignbit_b32 v122, v68, v67, 16
    v_alignbit_b32 v115, v68, v67, 16
    v_mov_b32 v119, v68
    v_alignbit_b32 v123, v69, v68, 16
    s_mov_b64 exec, 0xf
    ds_write_b128 v86, v[112:115] offset:4096
    ds_write_b128 v86, v[116:119] offset:8256
    ds_write_b128 v86, v[120:123] offset:12416
    ds_write_b128 v86, v[66:69] offset:16576
    s_mov_b64 exec, -1
    s_waitcnt lgkmcnt(0)
    s_barrier
    v_mov_b32 v238, 0
    v_mov_b32 v239, 0
    v_mov_b32 v240, 0
    v_mov_b32 v241, 0
    v_mov_b32 v242, 0
    v_mov_b32 v243, 0
    v_mov_b32 v244, 0
    v_mov_b32 v245, 0
    v_mov_b32 v246, 0
    v_mov_b32 v247, 0
    s_cmp_ge_u32 s30, 4
    s_cbranch_scc1 FR_b
    s_and_b32 s38, s2, 7
    s_lshl_b32 s38, s38, 5
    s_lshr_b32 s39, s2, 3
    s_add_u32 s38, s38, s39
    s_lshl_b32 s39, s38, 2
    s_add_u32 s39, s39, s30
    s_mul_i32 s40, s30, 24576
    s_lshl_b32 s36, s39, 12
    s_add_u32 s36, s36, 25165824
    s_add_u32 s16, s4, s36
    s_addc_u32 s17, s5, 0
    s_mov_b32 s18, 4096
    s_mov_b32 s19, 0x20000
    v_lshrrev_b32 v6, 2, v1
    v_mul_u32_u24 v12, 96, v6
    v_and_b32 v6, 3, v1
    v_lshl_add_u32 v12, v6, 4, v12
    v_add_u32 v12, s40, v12
    v_and_b32 v35, 15, v1
    v_lshrrev_b32 v36, 4, v1
    v_and_b32 v6, 3, v35
    v_mul_u32_u24 v32, 4160, v6
    v_lshl_add_u32 v32, v36, 4, v32
    v_lshrrev_b32 v6, 2, v35
    v_lshl_add_u32 v32, v6, 3, v32
    v_add_u32 v32, s40, v32
    v_sub_u32 v6, 15, v35
    v_mul_u32_u24 v34, 96, v6
    v_add_u32 v34, s40, v34
    v_lshl_add_u32 v33, v36, 4, v34
    ds_read_b64 v[72:73], v32 offset:0
    ds_read_b64 v[74:75], v32 offset:8
    ds_read_b64 v[76:77], v32 offset:32
    ds_read_b64 v[78:79], v32 offset:40
    ds_read_b64 v[80:81], v32 offset:1024
    ds_read_b64 v[82:83], v32 offset:1032
    ds_read_b64 v[84:85], v32 offset:1056
    ds_read_b64 v[86:87], v32 offset:1064
    ds_read_b64 v[88:89], v32 offset:2048
    ds_read_b64 v[90:91], v32 offset:2056
    ds_read_b64 v[92:93], v32 offset:2080
    ds_read_b64 v[94:95], v32 offset:2088
    ds_read_b64 v[96:97], v32 offset:3072
    ds_read_b64 v[98:99], v32 offset:3080
    ds_read_b64 v[100:101], v32 offset:3104
    ds_read_b64 v[102:103], v32 offset:3112
    s_bitcmp1_b32 s39, 0
    s_cselect_b32 s36, 0, 16
    s_lshl_b32 s41, s98, s36
    s_and_b32 s41, s41, 0xffff0000
    s_lshr_b32 s36, s41, 16
    v_lshl_add_u32 v6, v36, 3, v35
    v_sub_u32 v6, 31, v6
    v_mov_b32 v10, s36
    v_mov_b32 v11, s41
    v_and_b32 v8, 1, v6
    v_cmp_eq_u32 vcc, 1, v8
    s_nop 1
    v_cndmask_b32 v10, v10, v11, vcc
    v_ashrrev_i32 v6, 1, v6
    v_cmp_eq_u32 vcc, 0, v6
    s_nop 1
    v_cndmask_b32 v152, 0, v10, vcc
    v_cmp_eq_u32 vcc, 1, v6
    s_nop 1
    v_cndmask_b32 v153, 0, v10, vcc
    v_cmp_eq_u32 vcc, 2, v6
    s_nop 1
    v_cndmask_b32 v154, 0, v10, vcc
    v_cmp_eq_u32 vcc, 3, v6
    s_nop 1
    v_cndmask_b32 v155, 0, v10, vcc
    v_cmp_eq_u32 vcc, 8, v6
    s_nop 1
    v_cndmask_b32 v156, 0, v10, vcc
    v_cmp_eq_u32 vcc, 9, v6
    s_nop 1
    v_cndmask_b32 v157, 0, v10, vcc
    v_cmp_eq_u32 vcc, 10, v6
    s_nop 1
    v_cndmask_b32 v158, 0, v10, vcc
    v_cmp_eq_u32 vcc, 11, v6
    s_nop 1
    v_cndmask_b32 v159, 0, v10, vcc
    s_add_u32 s12, s4, 0x1c00000
    s_addc_u32 s13, s5, 0
    s_mov_b32 s14, 0x400000
    s_mov_b32 s15, 0x20000
    v_bfe_u32 v6, v1, 2, 2
    v_mul_u32_u24 v168, 24640, v6
    v_lshrrev_b32 v6, 1, v36
    v_mul_u32_u24 v6, 72, v6
    v_add_u32 v168, v168, v6
    v_and_b32 v6, 1, v36
    v_lshl_add_u32 v168, v6, 5, v168
    v_and_b32 v6, 3, v1
    v_lshl_add_u32 v168, v6, 3, v168
    s_mul_i32 s36, s30, 1152
    v_add_u32 v168, s36, v168
    v_lshlrev_b32 v169, 3, v1
    s_lshl_b32 s44, s38, 14
    s_lshl_b32 s37, s30, 12
    s_add_u32 s44, s44, s37
    s_mul_i32 s36, s30, 24640
    v_mul_u32_u24 v170, 72, v35
    v_lshl_add_u32 v170, v36, 3, v170
    v_add_u32 v170, s36, v170
    s_cmp_lg_u32 s30, 0
    s_cbranch_scc1 CV_w
    s_and_b32 s36, s2, 7
    s_lshl_b32 s36, s36, 12
    s_add_u32 s36, s36, 23068672
    v_lshlrev_b32 v9, 7, v1
    v_add_u32 v9, s36, v9
    s_mov_b32 s53, 0
    s_add_u32 s54, s52, 0
    s_bfm_b64 exec, 32, 0
poll_2:
    buffer_load_dword v8, v9, s[56:59], 0 offen sc1
    s_waitcnt vmcnt(0)
    v_xor_b32 v8, s54, v8
    v_cmp_eq_u32 vcc, 0, v8
    s_nop 0
    s_cmp_eq_u64 vcc, exec
    s_cbranch_scc1 pok_3
    s_sleep 5
    s_add_u32 s53, s53, 1
    s_cmp_lt_u32 s53, s61
    s_cbranch_scc1 poll_2
    s_mov_b32 s61, 0
pok_3:
    s_mov_b64 exec, -1
    v_mov_b32 v8, 162832
    v_mov_b32 v9, 1
    s_waitcnt lgkmcnt(0)
    ds_write_b32 v8, v9
CV_w:
    v_mov_b32 v8, 162832
spin_4:
    ds_read_b32 v9, v8
    s_waitcnt lgkmcnt(0)
    v_readfirstlane_b32 s53, v9
    s_nop 0
    s_cmp_ge_u32 s53, 1
    s_cbranch_scc0 spin_4
    buffer_load_dwordx4 v[16:19], v2, s[16:19], 0 offen offset:0 sc1
    buffer_load_dwordx4 v[20:23], v2, s[16:19], 0 offen offset:1024 sc1
    buffer_load_dwordx4 v[24:27], v2, s[16:19], 0 offen offset:2048 sc1
    buffer_load_dwordx4 v[28:31], v2, s[16:19], 0 offen offset:3072 sc1
    s_mov_b32 s8, s6
    s_mov_b32 s9, s7
    s_mov_b32 s10, 0x400000
    s_mov_b32 s11, 0x20000
    buffer_load_dwordx2 v[180:181], v178, s[8:11], 0 offen offset:0 nt
    buffer_load_dwordx2 v[182:183], v178, s[8:11], 0 offen offset:32 nt
    buffer_load_dwordx2 v[184:185], v178, s[8:11], 0 offen offset:128 nt
    buffer_load_dwordx2 v[186:187], v178, s[8:11], 0 offen offset:160 nt
    s_waitcnt vmcnt(7)
    ds_write_b128 v12, v[16:19] offset:16640
    s_waitcnt vmcnt(6)
    ds_write_b128 v12, v[20:23] offset:18176
    s_waitcnt vmcnt(5)
    ds_write_b128 v12, v[24:27] offset:19712
    s_waitcnt vmcnt(4)
    ds_write_b128 v12, v[28:31] offset:21248
    v_mov_b32 v8, 162836
    v_mov_b32 v9, 1
    s_mov_b64 exec, 1
    ds_add_u32 v8, v9
    s_mov_b64 exec, -1
    s_waitcnt lgkmcnt(0)
    ds_read_b128 v[136:139], v33 offset:21248
    ds_read_b128 v[140:143], v33 offset:19712
    ds_read_b128 v[144:147], v33 offset:18176
    ds_read_b128 v[148:151], v33 offset:16640
    s_waitcnt lgkmcnt(3)
    v_mfma_f32_16x16x32_bf16 v[40:43], v[152:155], v[136:139], 0
    v_mfma_f32_16x16x32_bf16 v[44:47], v[156:159], v[136:139], 0
    s_waitcnt lgkmcnt(2)
    v_mfma_f32_16x16x32_bf16 v[48:51], v[152:155], v[140:143], 0
    v_mfma_f32_16x16x32_bf16 v[52:55], v[156:159], v[140:143], 0
    s_waitcnt lgkmcnt(1)
    v_mfma_f32_16x16x32_bf16 v[56:59], v[152:155], v[144:147], 0
    v_mfma_f32_16x16x32_bf16 v[60:63], v[156:159], v[144:147], 0
    s_waitcnt lgkmcnt(0)
    v_mfma_f32_16x16x32_bf16 v[64:67], v[152:155], v[148:151], 0
    v_mfma_f32_16x16x32_bf16 v[68:71], v[156:159], v[148:151], 0
    s_mov_b32 s43, 0
CV_r:
    s_waitcnt lgkmcnt(0)
    v_mfma_f32_16x16x32_bf16 v[40:43], v[72:75], v[136:139], v[40:43]
    v_mfma_f32_16x16x32_bf16 v[48:51], v[72:75], v[140:143], v[48:51]
    v_mfma_f32_16x16x32_bf16 v[56:59], v[72:75], v[144:147], v[56:59]
    v_mfma_f32_16x16x32_bf16 v[64:67], v[72:75], v[148:151], v[64:67]
    v_mfma_f32_16x16x32_bf16 v[44:47], v[76:79], v[136:139], v[44:47]
    v_mfma_f32_16x16x32_bf16 v[52:55], v[76:79], v[140:143], v[52:55]
    v_mfma_f32_16x16x32_bf16 v[60:63], v[76:79], v[144:147], v[60:63]
    v_mfma_f32_16x16x32_bf16 v[68:71], v[76:79], v[148:151], v[68:71]
    v_mfma_f32_16x16x32_bf16 v[48:51], v[80:83], v[136:139], v[48:51]
    v_mfma_f32_16x16x32_bf16 v[56:59], v[80:83], v[140:143], v[56:59]
    v_mfma_f32_16x16x32_bf16 v[64:67], v[80:83], v[144:147], v[64:67]
    v_mfma_f32_16x16x32_bf16 v[52:55], v[84:87], v[136:139], v[52:55]
    v_mfma_f32_16x16x32_bf16 v[60:63], v[84:87], v[140:143], v[60:63]
    v_mfma_f32_16x16x32_bf16 v[68:71], v[84:87], v[144:147], v[68:71]
    v_mfma_f32_16x16x32_bf16 v[56:59], v[88:91], v[136:139], v[56:59]
    v_mfma_f32_16x16x32_bf16 v[64:67], v[88:91], v[140:143], v[64:67]
    v_mfma_f32_16x16x32_bf16 v[60:63], v[92:95], v[136:139], v[60:63]
    v_mfma_f32_16x16x32_bf16 v[68:71], v[92:95], v[140:143], v[68:71]
    v_mfma_f32_16x16x32_bf16 v[64:67], v[96:99], v[136:139], v[64:67]
    v_mfma_f32_16x16x32_bf16 v[68:71], v[100:103], v[136:139], v[68:71]
    ds_read_b128 v[152:155], v33 offset:21344
    ds_read_b128 v[156:159], v33 offset:19808
    ds_read_b128 v[160:163], v33 offset:18272
    ds_read_b128 v[164:167], v33 offset:16736
    ds_read_b64 v[104:105], v32 offset:64
    ds_read_b64 v[106:107], v32 offset:72
    ds_read_b64 v[108:109], v32 offset:96
    ds_read_b64 v[110:111], v32 offset:104
    ds_read_b64 v[112:113], v32 offset:1088
    ds_read_b64 v[114:115], v32 offset:1096
    ds_read_b64 v[116:117], v32 offset:1120
    ds_read_b64 v[118:119], v32 offset:1128
    ds_read_b64 v[120:121], v32 offset:2112
    ds_read_b64 v[122:123], v32 offset:2120
    ds_read_b64 v[124:125], v32 offset:2144
    ds_read_b64 v[126:127], v32 offset:2152
    ds_read_b64 v[128:129], v32 offset:3136
    ds_read_b64 v[130:131], v32 offset:3144
    ds_read_b64 v[132:133], v32 offset:3168
    ds_read_b64 v[134:135], v32 offset:3176
    s_waitcnt lgkmcnt(0)
    v_mfma_f32_16x16x32_bf16 v[40:43], v[104:107], v[152:155], v[40:43]
    v_mfma_f32_16x16x32_bf16 v[48:51], v[104:107], v[156:159], v[48:51]
    v_mfma_f32_16x16x32_bf16 v[56:59], v[104:107], v[160:163], v[56:59]
    v_mfma_f32_16x16x32_bf16 v[64:67], v[104:107], v[164:167], v[64:67]
    v_mfma_f32_16x16x32_bf16 v[44:47], v[108:111], v[152:155], v[44:47]
    v_mfma_f32_16x16x32_bf16 v[52:55], v[108:111], v[156:159], v[52:55]
    v_mfma_f32_16x16x32_bf16 v[60:63], v[108:111], v[160:163], v[60:63]
    v_mfma_f32_16x16x32_bf16 v[68:71], v[108:111], v[164:167], v[68:71]
    v_mfma_f32_16x16x32_bf16 v[48:51], v[112:115], v[152:155], v[48:51]
    v_mfma_f32_16x16x32_bf16 v[56:59], v[112:115], v[156:159], v[56:59]
    v_mfma_f32_16x16x32_bf16 v[64:67], v[112:115], v[160:163], v[64:67]
    v_mfma_f32_16x16x32_bf16 v[52:55], v[116:119], v[152:155], v[52:55]
    v_mfma_f32_16x16x32_bf16 v[60:63], v[116:119], v[156:159], v[60:63]
    v_mfma_f32_16x16x32_bf16 v[68:71], v[116:119], v[160:163], v[68:71]
    v_mfma_f32_16x16x32_bf16 v[56:59], v[120:123], v[152:155], v[56:59]
    v_mfma_f32_16x16x32_bf16 v[64:67], v[120:123], v[156:159], v[64:67]
    v_mfma_f32_16x16x32_bf16 v[60:63], v[124:127], v[152:155], v[60:63]
    v_mfma_f32_16x16x32_bf16 v[68:71], v[124:127], v[156:159], v[68:71]
    v_mfma_f32_16x16x32_bf16 v[64:67], v[128:131], v[152:155], v[64:67]
    v_mfma_f32_16x16x32_bf16 v[68:71], v[132:135], v[152:155], v[68:71]
    ds_read_b128 v[136:139], v33 offset:21440
    ds_read_b128 v[140:143], v33 offset:19904
    ds_read_b128 v[144:147], v33 offset:18368
    ds_read_b128 v[148:151], v33 offset:16832
    ds_read_b64 v[72:73], v32 offset:128
    ds_read_b64 v[74:75], v32 offset:136
    ds_read_b64 v[76:77], v32 offset:160
    ds_read_b64 v[78:79], v32 offset:168
    ds_read_b64 v[80:81], v32 offset:1152
    ds_read_b64 v[82:83], v32 offset:1160
    ds_read_b64 v[84:85], v32 offset:1184
    ds_read_b64 v[86:87], v32 offset:1192
    ds_read_b64 v[88:89], v32 offset:2176
    ds_read_b64 v[90:91], v32 offset:2184
    ds_read_b64 v[92:93], v32 offset:2208
    ds_read_b64 v[94:95], v32 offset:2216
    ds_read_b64 v[96:97], v32 offset:3200
    ds_read_b64 v[98:99], v32 offset:3208
    ds_read_b64 v[100:101], v32 offset:3232
    ds_read_b64 v[102:103], v32 offset:3240
    v_add_u32 v32, 128, v32
    v_add_u32 v33, 192, v33
    s_add_u32 s43, s43, 1
    s_cmp_lt_u32 s43, 3
    s_cbranch_scc1 CV_r
CV_l:
    s_waitcnt lgkmcnt(10)
    v_mfma_f32_16x16x32_bf16 v[40:43], v[72:75], v[136:139], v[40:43]
    ds_read_b128 v[152:155], v33 offset:21344
    v_mfma_f32_16x16x32_bf16 v[48:51], v[72:75], v[140:143], v[48:51]
    ds_read_b128 v[156:159], v33 offset:19808
    v_mfma_f32_16x16x32_bf16 v[56:59], v[72:75], v[144:147], v[56:59]
    ds_read_b128 v[160:163], v33 offset:18272
    v_mfma_f32_16x16x32_bf16 v[64:67], v[72:75], v[148:151], v[64:67]
    ds_read_b128 v[164:167], v33 offset:16736
    v_mfma_f32_16x16x32_bf16 v[44:47], v[76:79], v[136:139], v[44:47]
    ds_read_b64 v[104:105], v32 offset:64
    v_mfma_f32_16x16x32_bf16 v[52:55], v[76:79], v[140:143], v[52:55]
    ds_read_b64 v[106:107], v32 offset:72
    v_mfma_f32_16x16x32_bf16 v[60:63], v[76:79], v[144:147], v[60:63]
    ds_read_b64 v[108:109], v32 offset:96
    v_mfma_f32_16x16x32_bf16 v[68:71], v[76:79], v[148:151], v[68:71]
    ds_read_b64 v[110:111], v32 offset:104
    v_mfma_f32_16x16x32_bf16 v[48:51], v[80:83], v[136:139], v[48:51]
    ds_read_b64 v[112:113], v32 offset:1088
    v_mfma_f32_16x16x32_bf16 v[56:59], v[80:83], v[140:143], v[56:59]
    ds_read_b64 v[114:115], v32 offset:1096
    s_waitcnt lgkmcnt(10)
    v_mfma_f32_16x16x32_bf16 v[64:67], v[80:83], v[144:147], v[64:67]
    ds_read_b64 v[116:117], v32 offset:1120
    v_mfma_f32_16x16x32_bf16 v[52:55], v[84:87], v[136:139], v[52:55]
    ds_read_b64 v[118:119], v32 offset:1128
    v_mfma_f32_16x16x32_bf16 v[60:63], v[84:87], v[140:143], v[60:63]
    ds_read_b64 v[120:121], v32 offset:2112
    v_mfma_f32_16x16x32_bf16 v[68:71], v[84:87], v[144:147], v[68:71]
    ds_read_b64 v[122:123], v32 offset:2120
    v_mfma_f32_16x16x32_bf16 v[56:59], v[88:91], v[136:139], v[56:59]
    ds_read_b64 v[124:125], v32 offset:2144
    v_mfma_f32_16x16x32_bf16 v[64:67], v[88:91], v[140:143], v[64:67]
    ds_read_b64 v[126:127], v32 offset:2152
    v_mfma_f32_16x16x32_bf16 v[60:63], v[92:95], v[136:139], v[60:63]
    ds_read_b64 v[128:129], v32 offset:3136
    v_mfma_f32_16x16x32_bf16 v[68:71], v[92:95], v[140:143], v[68:71]
    ds_read_b64 v[130:131], v32 offset:3144
    v_mfma_f32_16x16x32_bf16 v[64:67], v[96:99], v[136:139], v[64:67]
    ds_read_b64 v[132:133], v32 offset:3168
    v_mfma_f32_16x16x32_bf16 v[68:71], v[100:103], v[136:139], v[68:71]
    ds_read_b64 v[134:135], v32 offset:3176
    s_waitcnt lgkmcnt(10)
    v_mfma_f32_16x16x32_bf16 v[40:43], v[104:107], v[152:155], v[40:43]
    ds_read_b128 v[136:139], v33 offset:21440
    v_mfma_f32_16x16x32_bf16 v[48:51], v[104:107], v[156:159], v[48:51]
    ds_read_b128 v[140:143], v33 offset:19904
    v_mfma_f32_16x16x32_bf16 v[56:59], v[104:107], v[160:163], v[56:59]
    ds_read_b128 v[144:147], v33 offset:18368
    v_mfma_f32_16x16x32_bf16 v[64:67], v[104:107], v[164:167], v[64:67]
    ds_read_b128 v[148:151], v33 offset:16832
    v_mfma_f32_16x16x32_bf16 v[44:47], v[108:111], v[152:155], v[44:47]
    ds_read_b64 v[72:73], v32 offset:128
    v_mfma_f32_16x16x32_bf16 v[52:55], v[108:111], v[156:159], v[52:55]
    ds_read_b64 v[74:75], v32 offset:136
    v_add_u32 v33, 192, v33
    v_mfma_f32_16x16x32_bf16 v[60:63], v[108:111], v[160:163], v[60:63]
    ds_read_b64 v[76:77], v32 offset:160
    s_add_u32 s43, s43, 1
    v_mfma_f32_16x16x32_bf16 v[68:71], v[108:111], v[164:167], v[68:71]
    ds_read_b64 v[78:79], v32 offset:168
    s_cmp_lt_u32 s43, 8
    v_mfma_f32_16x16x32_bf16 v[48:51], v[112:115], v[152:155], v[48:51]
    ds_read_b64 v[80:81], v32 offset:1152
    v_mfma_f32_16x16x32_bf16 v[56:59], v[112:115], v[156:159], v[56:59]
    ds_read_b64 v[82:83], v32 offset:1160
    s_waitcnt lgkmcnt(10)
    v_mfma_f32_16x16x32_bf16 v[64:67], v[112:115], v[160:163], v[64:67]
    ds_read_b64 v[84:85], v32 offset:1184
    v_mfma_f32_16x16x32_bf16 v[52:55], v[116:119], v[152:155], v[52:55]
    ds_read_b64 v[86:87], v32 offset:1192
    v_mfma_f32_16x16x32_bf16 v[60:63], v[116:119], v[156:159], v[60:63]
    ds_read_b64 v[88:89], v32 offset:2176
    v_mfma_f32_16x16x32_bf16 v[68:71], v[116:119], v[160:163], v[68:71]
    ds_read_b64 v[90:91], v32 offset:2184
    v_mfma_f32_16x16x32_bf16 v[56:59], v[120:123], v[152:155], v[56:59]
    ds_read_b64 v[92:93], v32 offset:2208
    v_mfma_f32_16x16x32_bf16 v[64:67], v[120:123], v[156:159], v[64:67]
    ds_read_b64 v[94:95], v32 offset:2216
    v_mfma_f32_16x16x32_bf16 v[60:63], v[124:127], v[152:155], v[60:63]
    ds_read_b64 v[96:97], v32 offset:3200
    v_mfma_f32_16x16x32_bf16 v[68:71], v[124:127], v[156:159], v[68:71]
    ds_read_b64 v[98:99], v32 offset:3208
    v_mfma_f32_16x16x32_bf16 v[64:67], v[128:131], v[152:155], v[64:67]
    ds_read_b64 v[100:101], v32 offset:3232
    v_mfma_f32_16x16x32_bf16 v[68:71], v[132:135], v[152:155], v[68:71]
    ds_read_b64 v[102:103], v32 offset:3240
    v_add_u32 v32, 128, v32
    s_cbranch_scc1 CV_l
    s_waitcnt lgkmcnt(0)
    v_cvt_pk_bf16_f32 v16, v40, v41
    v_cvt_pk_bf16_f32 v17, v42, v43
    ds_write_b64 v170, v[16:17] offset:0
    v_cvt_pk_bf16_f32 v18, v44, v45
    v_cvt_pk_bf16_f32 v19, v46, v47
    ds_write_b64 v170, v[18:19] offset:32
    v_cvt_pk_bf16_f32 v20, v48, v49
    v_cvt_pk_bf16_f32 v21, v50, v51
    ds_write_b64 v170, v[20:21] offset:1152
    v_cvt_pk_bf16_f32 v22, v52, v53
    v_cvt_pk_bf16_f32 v23, v54, v55
    ds_write_b64 v170, v[22:23] offset:1184
    v_cvt_pk_bf16_f32 v24, v56, v57
    v_cvt_pk_bf16_f32 v25, v58, v59
    ds_write_b64 v170, v[24:25] offset:2304
    v_cvt_pk_bf16_f32 v26, v60, v61
    v_cvt_pk_bf16_f32 v27, v62, v63
    ds_write_b64 v170, v[26:27] offset:2336
    v_cvt_pk_bf16_f32 v28, v64, v65
    v_cvt_pk_bf16_f32 v29, v66, v67
    ds_write_b64 v170, v[28:29] offset:3456
    v_cvt_pk_bf16_f32 v30, v68, v69
    v_cvt_pk_bf16_f32 v31, v70, v71
    ds_write_b64 v170, v[30:31] offset:3488
    v_mov_b32 v8, 162824
    v_mov_b32 v9, 1
    s_waitcnt lgkmcnt(0)
    s_mov_b64 exec, 1
    ds_add_u32 v8, v9
    s_mov_b64 exec, -1
    v_mov_b32 v8, 162824
spin_5:
    ds_read_b32 v9, v8
    s_waitcnt lgkmcnt(0)
    v_readfirstlane_b32 s53, v9
    s_nop 0
    s_cmp_ge_u32 s53, 4
    s_cbranch_scc0 spin_5
    ds_read_b64_tr_b16 v[104:105], v168 offset:0
    ds_read_b64_tr_b16 v[106:107], v168 offset:144
    ds_read_b64_tr_b16 v[108:109], v168 offset:288
    ds_read_b64_tr_b16 v[110:111], v168 offset:432
    ds_read_b64_tr_b16 v[112:113], v168 offset:576
    ds_read_b64_tr_b16 v[114:115], v168 offset:720
    ds_read_b64_tr_b16 v[116:117], v168 offset:864
    ds_read_b64_tr_b16 v[118:119], v168 offset:1008
    s_waitcnt lgkmcnt(7)
    buffer_store_dwordx2 v[104:105], v169, s[12:15], s44 offen offset:0 sc1
    s_waitcnt lgkmcnt(6)
    buffer_store_dwordx2 v[106:107], v169, s[12:15], s44 offen offset:512 sc1
    s_waitcnt lgkmcnt(5)
    buffer_store_dwordx2 v[108:109], v169, s[12:15], s44 offen offset:1024 sc1
    s_waitcnt lgkmcnt(4)
    buffer_store_dwordx2 v[110:111], v169, s[12:15], s44 offen offset:1536 sc1
    s_waitcnt lgkmcnt(3)
    buffer_store_dwordx2 v[112:113], v169, s[12:15], s44 offen offset:2048 sc1
    s_waitcnt lgkmcnt(2)
    buffer_store_dwordx2 v[114:115], v169, s[12:15], s44 offen offset:2560 sc1
    s_waitcnt lgkmcnt(1)
    buffer_store_dwordx2 v[116:117], v169, s[12:15], s44 offen offset:3072 sc1
    s_waitcnt lgkmcnt(0)
    buffer_store_dwordx2 v[118:119], v169, s[12:15], s44 offen offset:3584 sc1
    s_and_b32 s36, s2, 7
    s_lshl_b32 s36, s36, 7
    s_add_u32 s36, s36, 23101440
    v_mov_b32 v6, 1
    v_mov_b32 v7, 162820
    v_lshlrev_b32 v9, 10, v1
    s_mov_b64 exec, 1
    s_waitcnt vmcnt(0)
    s_waitcnt lgkmcnt(0)
    ds_add_rtn_u32 v8, v7, v6
    ds_read_b32 v10, v7 offset:28
    s_waitcnt lgkmcnt(0)
    v_readfirstlane_b32 s54, v8
    v_readfirstlane_b32 s53, v10
    s_cmp_lg_u32 s54, 15
    s_cbranch_scc1 fa_6
    s_mov_b64 exec, 0xffff
    s_or_b32 s53, s53, 1
    v_mov_b32 v6, s53
    buffer_atomic_add v6, v9, s[56:59], s36 offen sc1
fa_6:
    s_mov_b64 exec, -1
    s_branch FR_end
FR_b:
    s_getpc_b64 s[34:35]
K_tpc:
    s_lshl_b32 s36, s29, 2
    s_and_b32 s37, s28, 3
    s_add_u32 s36, s36, s37
    s_lshl_b32 s36, s36, 6
    s_add_u32 s36, s36, K_tab-K_tpc
    s_add_u32 s34, s34, s36
    s_addc_u32 s35, s35, 0
    v_and_b32 v248, 31, v1
    v_lshlrev_b32 v248, 1, v248
    global_load_ushort v251, v248, s[34:35]
    v_lshrrev_b32 v253, 3, v1
    v_lshlrev_b32 v238, 11, v253
    v_and_b32 v253, 6, v253
    v_and_b32 v254, 7, v1
    v_xor_b32 v253, v253, v254
    v_lshl_add_u32 v238, v253, 4, v238
    v_lshrrev_b32 v253, 4, v1
    v_lshlrev_b32 v239, 11, v253
    v_add_u32 v253, 0, v253
    v_lshlrev_b32 v253, 1, v253
    v_and_b32 v254, 15, v1
    v_xor_b32 v253, v253, v254
    v_lshl_add_u32 v239, v253, 4, v239
    v_lshrrev_b32 v253, 4, v1
    v_lshlrev_b32 v240, 11, v253
    v_add_u32 v253, 4, v253
    v_lshlrev_b32 v253, 1, v253
    v_and_b32 v254, 15, v1
    v_xor_b32 v253, v253, v254
    v_lshl_add_u32 v240, v253, 4, v240
    v_add_u32 v254, 0, v1
    v_mul_u32_u24 v253, 2341, v254
    v_lshrrev_b32 v253, 16, v253
    v_mul_u32_u24 v241, 28, v253
    v_sub_u32 v254, v254, v241
    v_mul_u32_u24 v241, 7168, v253
    v_lshrrev_b32 v253, 1, v253
    v_and_b32 v253, 2, v253
    v_xor_b32 v254, v254, v253
    v_lshl_add_u32 v241, v254, 4, v241
    v_add_u32 v254, 64, v1
    v_mul_u32_u24 v253, 2341, v254
    v_lshrrev_b32 v253, 16, v253
    v_mul_u32_u24 v242, 28, v253
    v_sub_u32 v254, v254, v242
    v_mul_u32_u24 v242, 7168, v253
    v_lshrrev_b32 v253, 1, v253
    v_and_b32 v253, 2, v253
    v_xor_b32 v254, v254, v253
    v_lshl_add_u32 v242, v254, 4, v242
    v_add_u32 v254, 128, v1
    v_mul_u32_u24 v253, 2341, v254
    v_lshrrev_b32 v253, 16, v253
    v_mul_u32_u24 v243, 28, v253
    v_sub_u32 v254, v254, v243
    v_mul_u32_u24 v243, 7168, v253
    v_lshrrev_b32 v253, 1, v253
    v_and_b32 v253, 2, v253
    v_xor_b32 v254, v254, v253
    v_lshl_add_u32 v243, v254, 4, v243
    v_add_u32 v254, 192, v1
    v_mul_u32_u24 v253, 2341, v254
    v_lshrrev_b32 v253, 16, v253
    v_mul_u32_u24 v244, 28, v253
    v_sub_u32 v254, v254, v244
    v_mul_u32_u24 v244, 7168, v253
    v_lshrrev_b32 v253, 1, v253
    v_and_b32 v253, 2, v253
    v_xor_b32 v254, v254, v253
    v_lshl_add_u32 v244, v254, 4, v244
    v_add_u32 v254, 256, v1
    v_mul_u32_u24 v253, 2341, v254
    v_lshrrev_b32 v253, 16, v253
    v_mul_u32_u24 v245, 28, v253
    v_sub_u32 v254, v254, v245
    v_mul_u32_u24 v245, 7168, v253
    v_lshrrev_b32 v253, 1, v253
    v_and_b32 v253, 2, v253
    v_xor_b32 v254, v254, v253
    v_lshl_add_u32 v245, v254, 4, v245
    v_add_u32 v254, 320, v1
    v_mul_u32_u24 v253, 2341, v254
    v_lshrrev_b32 v253, 16, v253
    v_mul_u32_u24 v246, 28, v253
    v_sub_u32 v254, v254, v246
    v_mul_u32_u24 v246, 7168, v253
    v_lshrrev_b32 v253, 1, v253
    v_and_b32 v253, 2, v253
    v_xor_b32 v254, v254, v253
    v_lshl_add_u32 v246, v254, 4, v246
    v_add_u32 v254, 384, v1
    v_mul_u32_u24 v253, 2341, v254
    v_lshrrev_b32 v253, 16, v253
    v_mul_u32_u24 v247, 28, v253
    v_sub_u32 v254, v254, v247
    v_mul_u32_u24 v247, 7168, v253
    v_lshrrev_b32 v253, 1, v253
    v_and_b32 v253, 2, v253
    v_xor_b32 v254, v254, v253
    v_lshl_add_u32 v247, v254, 4, v247
    s_mul_i32 s36, s2, 28672
    s_and_b32 s37, s30, 3
    s_mul_i32 s37, s37, 7168
    s_add_u32 s36, s36, s37
    s_add_u32 s90, s72, s36
    s_addc_u32 s91, s73, 0
    s_cmp_ge_u32 s30, 6
    s_cbranch_scc1 FB_cs
    s_cmp_ge_u32 s2, 255
    s_cbranch_scc1 FB_np
    s_cmp_lg_u32 s30, 5
    s_cbranch_scc1 FB_np
    s_and_b32 s42, s2, 31
    s_lshl_b32 s42, s42, 8
    s_lshr_b32 s43, s2, 5
    s_lshl_b32 s43, s43, 14
    s_add_u32 s42, s42, s43
    s_add_u32 s42, s42, 35520512
    v_mov_b32 v14, 0
    s_mov_b64 exec, 1
    s_mov_b32 s46, -1
    s_mov_b32 s47, -1
    s_mov_b32 s43, 0
FB_ml:
    s_add_u32 s45, s42, 0
    s_memtime s[34:35]
    s_waitcnt lgkmcnt(0)
    buffer_load_dword v13, v14, s[56:59], s45 offen sc1
    s_waitcnt vmcnt(0)
    s_memtime s[36:37]
    s_waitcnt lgkmcnt(0)
    s_sub_u32 s36, s36, s34
    s_min_u32 s46, s46, s36
    s_add_u32 s45, s42, 8192
    s_memtime s[34:35]
    s_waitcnt lgkmcnt(0)
    buffer_load_dword v13, v14, s[56:59], s45 offen sc1
    s_waitcnt vmcnt(0)
    s_memtime s[36:37]
    s_waitcnt lgkmcnt(0)
    s_sub_u32 s36, s36, s34
    s_min_u32 s47, s47, s36
    s_add_u32 s42, s42, 128
    s_add_u32 s43, s43, 1
    s_cmp_lt_u32 s43, 2
    s_cbranch_scc1 FB_ml
    s_cmp_lt_u32 s47, s46
    s_cselect_b32 s45, 1, 0
    s_lshr_b32 s46, s28, 2
    s_xor_b32 s45, s45, s46
    s_and_b32 s45, s45, 1
    s_lshl_b32 s45, s45, 8
    s_mov_b64 exec, -1
    v_mov_b32 v6, 162848
    v_mov_b32 v7, s45
    s_waitcnt lgkmcnt(0)
    ds_write_b32 v6, v7
FB_np:
    s_cmp_lg_u32 s30, 4
    s_cbranch_scc1 FB_ni
    v_mov_b32 v12, s52
    s_lshr_b32 s53, s28, 3
    s_lshl_b32 s53, s53, 2
    s_and_b32 s54, s28, 3
    s_add_u32 s53, s53, s54
    s_lshl_b32 s53, s53, 23
    s_lshr_b32 s54, s28, 2
    s_xor_b32 s54, s54, s94
    s_and_b32 s54, s54, 1
    s_lshl_b32 s54, s54, 13
    s_add_u32 s37, s53, s54
    s_add_u32 s37, s37, 33554432
    s_andn2_b32 s37, s37, 0x2000
    s_lshl_b32 s53, s29, 7
    s_add_u32 s37, s37, s53
    s_add_u32 s37, s37, 1835008
    v_and_b32 v13, 1, v1
    v_lshlrev_b32 v13, 13, v13
    v_lshrrev_b32 v14, 1, v1
    v_lshl_add_u32 v13, v14, 26, v13
    s_mov_b64 exec, 0xf
    buffer_store_dword v12, v13, s[56:59], s37 offen sc1
    s_cmp_lg_u32 s28, 0
    s_cbranch_scc1 FB_n2
    s_add_u32 s37, s53, 23117824
    s_mov_b64 exec, 1
    buffer_store_dword v12, v13, s[56:59], s37 offen sc1
FB_n2:
    s_mov_b64 exec, -1
    v_mov_b32 v16, 0
    v_mov_b32 v17, 0
    v_mov_b32 v18, 0
    v_mov_b32 v19, 0
    s_lshr_b32 s36, s2, 7
    s_lshl_b32 s36, s36, 24
    s_add_u32 s36, s36, 167772160
    s_add_u32 s20, s4, s36
    s_addc_u32 s21, s5, 0
    s_mov_b32 s22, 8388608
    s_mov_b32 s23, 0x20000
    s_and_b32 s36, s2, 127
    s_mul_i32 s36, s36, 65536
    s_add_u32 s36, s36, 16352
    v_and_b32 v13, 1, v1
    v_lshlrev_b32 v13, 4, v13
    v_bfe_u32 v14, v1, 1, 1
    v_lshl_add_u32 v13, v14, 13, v13
    v_bfe_u32 v14, v1, 2, 1
    v_mul_u32_u24 v14, 32800, v14
    v_add_u32 v13, v13, v14
    s_mov_b64 exec, 0xff
    buffer_store_dwordx4 v[16:19], v13, s[20:23], s36 offen sc1
    s_mov_b64 exec, -1
FB_ni:
    v_mov_b32 v6, 162832
spin_7:
    s_sleep 2
    ds_read_b32 v7, v6
    s_waitcnt lgkmcnt(0)
    v_readfirstlane_b32 s53, v7
    s_nop 0
    s_cmp_ge_u32 s53, 1
    s_cbranch_scc0 spin_7
    s_load_dwordx2 s[48:49], s[0:1], 64
    s_lshl_b32 s45, s2, 1
    s_and_b32 s50, s30, 1
    s_add_u32 s45, s45, s50
    s_mul_i32 s45, s45, 4096
    s_mov_b32 s50, 2097152
    s_mov_b32 s51, 0x20000
    s_waitcnt lgkmcnt(0)
    buffer_load_dwordx4 v[20:23], v2, s[48:51], s45 offen offset:0
    buffer_load_dwordx4 v[20:23], v2, s[48:51], s45 offen offset:1024
    buffer_load_dwordx4 v[20:23], v2, s[48:51], s45 offen offset:2048
    buffer_load_dwordx4 v[20:23], v2, s[48:51], s45 offen offset:3072
    s_mov_b32 s8, s6
    s_mov_b32 s9, s7
    s_mov_b32 s10, 0x400000
    s_mov_b32 s11, 0x20000
    buffer_load_dwordx2 v[180:181], v178, s[8:11], 0 offen offset:0 nt
    buffer_load_dwordx2 v[182:183], v178, s[8:11], 0 offen offset:32 nt
    buffer_load_dwordx2 v[184:185], v178, s[8:11], 0 offen offset:128 nt
    buffer_load_dwordx2 v[186:187], v178, s[8:11], 0 offen offset:160 nt
    s_and_b32 s36, s2, 7
    s_lshl_b32 s36, s36, 7
    s_add_u32 s36, s36, 23101440
    v_mov_b32 v6, 1
    v_mov_b32 v7, 162820
    v_lshlrev_b32 v9, 10, v1
    s_mov_b64 exec, 1
    s_waitcnt vmcnt(0)
    s_waitcnt lgkmcnt(0)
    ds_add_rtn_u32 v8, v7, v6
    ds_read_b32 v10, v7 offset:28
    s_waitcnt lgkmcnt(0)
    v_readfirstlane_b32 s54, v8
    v_readfirstlane_b32 s53, v10
    s_cmp_lg_u32 s54, 15
    s_cbranch_scc1 fa_8
    s_mov_b64 exec, 0xffff
    s_or_b32 s53, s53, 1
    v_mov_b32 v6, s53
    buffer_atomic_add v6, v9, s[56:59], s36 offen sc1
fa_8:
    s_mov_b64 exec, -1
    v_bfe_u32 v252, v251, 2, 2
    v_lshlrev_b32 v248, 14, v252
    v_and_b32 v252, 3, v251
    v_lshl_add_u32 v248, v252, 11, v248
    v_bfe_u32 v252, v251, 7, 3
    v_lshlrev_b32 v249, 14, v252
    v_bfe_u32 v252, v251, 4, 3
    v_lshl_add_u32 v249, v252, 10, v249
    v_bfe_u32 v252, v251, 13, 3
    v_lshlrev_b32 v250, 14, v252
    v_bfe_u32 v252, v251, 10, 3
    v_lshl_add_u32 v250, v252, 10, v250
    v_mov_b32 v6, 162840
spin_9:
    s_sleep 4
    ds_read_b32 v7, v6
    s_waitcnt lgkmcnt(0)
    v_readfirstlane_b32 s53, v7
    s_nop 0
    s_cmp_ge_u32 s53, 2
    s_cbranch_scc0 spin_9
    s_call_b64 s[76:77], SUB_w1_regs
    s_call_b64 s[76:77], SUB_park
    v_mov_b32 v6, 162840
spin_10:
    s_sleep 3
    ds_read_b32 v7, v6
    s_waitcnt lgkmcnt(0)
    v_readfirstlane_b32 s53, v7
    s_nop 0
    s_cmp_ge_u32 s53, 4
    s_cbranch_scc0 spin_10
    s_mov_b64 s[12:13], s[68:69]
    s_mov_b32 s14, 2097152
    s_mov_b32 s15, 0x20000
    s_and_b32 s35, s30, 1
    s_mul_i32 s38, s29, 128
    s_mul_i32 s41, s35, 65536
    s_add_u32 s38, s38, s41
    s_mul_i32 s41, s35, 4096
    s_add_u32 s41, s41, 24576
    s_mov_b32 s42, 0
    s_mov_b32 s44, s67
    s_mov_b32 s42, 73728
    s_mov_b32 s44, s67
    s_add_u32 s44, s44, 9
    s_and_b32 s44, s44, 15
    s_call_b64 s[76:77], SUB_w_issue_1
    s_waitcnt vmcnt(8)
    s_mov_b32 s42, 81920
    s_mov_b32 s44, s67
    s_add_u32 s44, s44, 10
    s_and_b32 s44, s44, 15
    s_call_b64 s[76:77], SUB_w_issue_1
    s_waitcnt vmcnt(8)
    s_mov_b32 s42, 90112
    s_mov_b32 s44, s67
    s_add_u32 s44, s44, 11
    s_and_b32 s44, s44, 15
    s_call_b64 s[76:77], SUB_w_issue_1
    s_waitcnt vmcnt(8)
    s_call_b64 s[76:77], SUB_w1_put
    s_branch FR_end
FB_cs:
    v_and_b32 v164, 15, v1
    v_mov_b32 v165, 0x3f803f80
    v_cmp_eq_u32 vcc, 0, v164
    s_nop 1
    v_cndmask_b32 v16, 0, v165, vcc
    v_cndmask_b32 v17, 0, v165, vcc
    v_cndmask_b32 v18, 0, v165, vcc
    v_cndmask_b32 v19, 0, v165, vcc
    v_cmp_eq_u32 vcc, 1, v164
    s_nop 1
    v_cndmask_b32 v20, 0, v165, vcc
    v_cndmask_b32 v21, 0, v165, vcc
    v_cndmask_b32 v22, 0, v165, vcc
    v_cndmask_b32 v23, 0, v165, vcc
    v_cmp_eq_u32 vcc, 2, v164
    s_nop 1
    v_cndmask_b32 v24, 0, v165, vcc
    v_cndmask_b32 v25, 0, v165, vcc
    v_cndmask_b32 v26, 0, v165, vcc
    v_cndmask_b32 v27, 0, v165, vcc
    v_cmp_eq_u32 vcc, 3, v164
    s_nop 1
    v_cndmask_b32 v28, 0, v165, vcc
    v_cndmask_b32 v29, 0, v165, vcc
    v_cndmask_b32 v30, 0, v165, vcc
    v_cndmask_b32 v31, 0, v165, vcc
    v_cmp_eq_u32 vcc, 4, v164
    s_nop 1
    v_cndmask_b32 v32, 0, v165, vcc
    v_cndmask_b32 v33, 0, v165, vcc
    v_cndmask_b32 v34, 0, v165, vcc
    v_cndmask_b32 v35, 0, v165, vcc
    v_cmp_eq_u32 vcc, 5, v164
    s_nop 1
    v_cndmask_b32 v36, 0, v165, vcc
    v_cndmask_b32 v37, 0, v165, vcc
    v_cndmask_b32 v38, 0, v165, vcc
    v_cndmask_b32 v39, 0, v165, vcc
    v_cmp_eq_u32 vcc, 6, v164
    s_nop 1
    v_cndmask_b32 v40, 0, v165, vcc
    v_cndmask_b32 v41, 0, v165, vcc
    v_cndmask_b32 v42, 0, v165, vcc
    v_cndmask_b32 v43, 0, v165, vcc
    v_cmp_eq_u32 vcc, 7, v164
    s_nop 1
    v_cndmask_b32 v44, 0, v165, vcc
    v_cndmask_b32 v45, 0, v165, vcc
    v_cndmask_b32 v46, 0, v165, vcc
    v_cndmask_b32 v47, 0, v165, vcc
    v_cmp_eq_u32 vcc, 8, v164
    s_nop 1
    v_cndmask_b32 v48, 0, v165, vcc
    v_cndmask_b32 v49, 0, v165, vcc
    v_cndmask_b32 v50, 0, v165, vcc
    v_cndmask_b32 v51, 0, v165, vcc
    v_cmp_eq_u32 vcc, 9, v164
    s_nop 1
    v_cndmask_b32 v52, 0, v165, vcc
    v_cndmask_b32 v53, 0, v165, vcc
    v_cndmask_b32 v54, 0, v165, vcc
    v_cndmask_b32 v55, 0, v165, vcc
    v_cmp_eq_u32 vcc, 10, v164
    s_nop 1
    v_cndmask_b32 v56, 0, v165, vcc
    v_cndmask_b32 v57, 0, v165, vcc
    v_cndmask_b32 v58, 0, v165, vcc
    v_cndmask_b32 v59, 0, v165, vcc
    v_cmp_eq_u32 vcc, 11, v164
    s_nop 1
    v_cndmask_b32 v60, 0, v165, vcc
    v_cndmask_b32 v61, 0, v165, vcc
    v_cndmask_b32 v62, 0, v165, vcc
    v_cndmask_b32 v63, 0, v165, vcc
    v_cmp_eq_u32 vcc, 12, v164
    s_nop 1
    v_cndmask_b32 v64, 0, v165, vcc
    v_cndmask_b32 v65, 0, v165, vcc
    v_cndmask_b32 v66, 0, v165, vcc
    v_cndmask_b32 v67, 0, v165, vcc
    v_cmp_eq_u32 vcc, 13, v164
    s_nop 1
    v_cndmask_b32 v68, 0, v165, vcc
    v_cndmask_b32 v69, 0, v165, vcc
    v_cndmask_b32 v70, 0, v165, vcc
    v_cndmask_b32 v71, 0, v165, vcc
    s_mov_b32 s35, 0
    v_lshrrev_b32 v253, 2, v1
    v_mul_u32_u24 v144, 128, v253
    v_and_b32 v254, 3, v1
    v_lshl_add_u32 v144, v254, 3, v144
    v_add_u32 v144, 24576, v144
    v_bfe_u32 v253, v253, 1, 2
    s_mul_i32 s36, s35, 4
    s_add_u32 s36, s36, 3
    v_xor_b32 v254, s36, v253
    v_lshl_add_u32 v147, v254, 5, v144
    s_mul_i32 s36, s35, 4
    s_add_u32 s36, s36, 2
    v_xor_b32 v254, s36, v253
    v_lshl_add_u32 v146, v254, 5, v144
    s_mul_i32 s36, s35, 4
    s_add_u32 s36, s36, 1
    v_xor_b32 v254, s36, v253
    v_lshl_add_u32 v145, v254, 5, v144
    s_mul_i32 s36, s35, 4
    s_add_u32 s36, s36, 0
    v_xor_b32 v254, s36, v253
    v_lshl_add_u32 v144, v254, 5, v144
    s_and_b32 s35, s30, 1
    s_mul_i32 s35, s35, 4096
    s_add_u32 s35, s35, 73728
    v_add_u32 v144, s35, v144
    v_add_u32 v145, s35, v145
    v_add_u32 v146, s35, v146
    v_add_u32 v147, s35, v147
    s_mov_b32 s35, 0
    v_lshrrev_b32 v253, 2, v1
    v_mul_u32_u24 v148, 448, v253
    v_and_b32 v254, 3, v1
    v_lshl_add_u32 v148, v254, 3, v148
    v_add_u32 v148, 73728, v148
    s_mul_i32 s36, s35, 224
    v_add_u32 v148, s36, v148
    v_bfe_u32 v253, v1, 4, 1
    v_lshlrev_b32 v253, 5, v253
    s_cmp_eq_u32 s35, 0
    s_cselect_b32 s36, 1, -1
    v_mul_lo_u32 v253, v253, s36
    v_sub_u32 v149, v148, v253
    v_add_u32 v148, v148, v253
    s_and_b32 s35, s30, 1
    s_mul_i32 s35, s35, 14336
    s_add_u32 s35, s35, 32768
    v_add_u32 v148, s35, v148
    v_add_u32 v149, s35, v149
    s_mov_b32 s35, 1
    v_lshrrev_b32 v253, 2, v1
    v_mul_u32_u24 v150, 448, v253
    v_and_b32 v254, 3, v1
    v_lshl_add_u32 v150, v254, 3, v150
    v_add_u32 v150, 73728, v150
    s_mul_i32 s36, s35, 224
    v_add_u32 v150, s36, v150
    v_bfe_u32 v253, v1, 4, 1
    v_lshlrev_b32 v253, 5, v253
    s_cmp_eq_u32 s35, 0
    s_cselect_b32 s36, 1, -1
    v_mul_lo_u32 v253, v253, s36
    v_sub_u32 v151, v150, v253
    v_add_u32 v150, v150, v253
    s_and_b32 s35, s30, 1
    s_mul_i32 s35, s35, 14336
    s_add_u32 s35, s35, 32768
    v_add_u32 v150, s35, v150
    v_add_u32 v151, s35, v151
    v_mov_b32 v156, 0
    v_mov_b32 v157, 0
    v_mov_b32 v158, 0
    v_mov_b32 v159, 0
    v_mov_b32 v160, 0
    v_mov_b32 v161, 0
    v_mov_b32 v162, 0
    v_mov_b32 v163, 0
    v_lshrrev_b32 v166, 4, v1
    v_lshlrev_b32 v166, 4, v166
    v_lshl_add_u32 v166, v164, 6, v166
    v_mov_b32 v165, 0x7f000000
    v_cmp_gt_u32 vcc, 4, v164
    s_nop 1
    v_cndmask_b32 v167, v165, v166, vcc
    v_cmp_gt_u32 vcc, 14, v164
    s_nop 1
    v_cndmask_b32 v168, v165, v166, vcc
    v_mov_b32 v6, 162832
spin_11:
    s_sleep 2
    ds_read_b32 v7, v6
    s_waitcnt lgkmcnt(0)
    v_readfirstlane_b32 s53, v7
    s_nop 0
    s_cmp_ge_u32 s53, 1
    s_cbranch_scc0 spin_11
    s_mov_b32 s8, s6
    s_mov_b32 s9, s7
    s_mov_b32 s10, 0x400000
    s_mov_b32 s11, 0x20000
    buffer_load_dwordx2 v[180:181], v178, s[8:11], 0 offen offset:0 nt
    buffer_load_dwordx2 v[182:183], v178, s[8:11], 0 offen offset:32 nt
    buffer_load_dwordx2 v[184:185], v178, s[8:11], 0 offen offset:128 nt
    buffer_load_dwordx2 v[186:187], v178, s[8:11], 0 offen offset:160 nt
    s_mov_b64 s[12:13], s[68:69]
    s_mov_b32 s14, 2097152
    s_mov_b32 s15, 0x20000
    s_and_b32 s35, s30, 1
    s_mul_i32 s38, s29, 128
    s_mul_i32 s41, s35, 65536
    s_add_u32 s38, s38, s41
    s_mul_i32 s41, s35, 4096
    s_add_u32 s41, s41, 24576
    s_mov_b32 s42, 0
    s_mov_b32 s44, s67
    s_mov_b32 s42, 73728
    s_mov_b32 s44, s28
    s_add_u32 s19, s41, s42
    s_mul_i32 s16, s44, 131072
    s_add_u32 s16, s16, s38
    s_add_u32 s44, s44, 1
    s_and_b32 s44, s44, 15
    s_add_u32 s42, s42, 8192
    s_cmp_eq_u32 s42, 131072
    s_cselect_b32 s42, 0, s42
    s_mov_b32 m0, s19
    s_mov_b32 s39, s16
    buffer_load_dwordx4 v238, s[12:15], s39 offen lds
    s_add_u32 m0, m0, 1024
    s_add_u32 s39, s39, 16384
    buffer_load_dwordx4 v238, s[12:15], s39 offen lds
    s_add_u32 m0, m0, 1024
    s_add_u32 s39, s39, 16384
    buffer_load_dwordx4 v238, s[12:15], s39 offen lds
    s_add_u32 m0, m0, 1024
    s_add_u32 s39, s39, 16384
    buffer_load_dwordx4 v238, s[12:15], s39 offen lds
    s_mov_b64 s[12:13], s[72:73]
    s_mov_b32 s14, 7340032
    s_mov_b32 s15, 0x20000
    s_and_b32 s35, s30, 1
    s_mul_i32 s38, s29, 448
    s_mul_i32 s41, s35, 229376
    s_add_u32 s38, s38, s41
    s_mul_i32 s41, s35, 14336
    s_add_u32 s41, s41, 73728
    s_mov_b32 s42, 0
    s_mov_b32 s44, 0
    s_mov_b32 s42, 32768
    s_mov_b32 s44, s28
    s_add_u32 s19, s41, s42
    s_mul_i32 s16, s44, 458752
    s_add_u32 s16, s16, s38
    s_add_u32 s44, s44, 1
    s_and_b32 s44, s44, 15
    s_add_u32 s42, s42, 28672
    s_cmp_eq_u32 s42, 86016
    s_cselect_b32 s42, 0, s42
    s_mov_b32 m0, s19
    s_mov_b32 s39, s16
    buffer_load_dwordx4 v241, s[12:15], s39 offen lds
    s_add_u32 m0, m0, 1024
    s_nop 0
    buffer_load_dwordx4 v242, s[12:15], s39 offen lds
    s_add_u32 m0, m0, 1024
    s_nop 0
    buffer_load_dwordx4 v243, s[12:15], s39 offen lds
    s_add_u32 m0, m0, 1024
    s_nop 0
    buffer_load_dwordx4 v244, s[12:15], s39 offen lds
    s_add_u32 m0, m0, 1024
    s_nop 0
    buffer_load_dwordx4 v245, s[12:15], s39 offen lds
    s_add_u32 m0, m0, 1024
    s_nop 0
    buffer_load_dwordx4 v246, s[12:15], s39 offen lds
    s_add_u32 m0, m0, 1024
    s_nop 0
    buffer_load_dwordx4 v247, s[12:15], s39 offen lds
    s_add_u32 m0, m0, 1024
    s_add_u32 s39, s39, 114688
    buffer_load_dwordx4 v241, s[12:15], s39 offen lds
    s_add_u32 m0, m0, 1024
    s_nop 0
    buffer_load_dwordx4 v242, s[12:15], s39 offen lds
    s_add_u32 m0, m0, 1024
    s_nop 0
    buffer_load_dwordx4 v243, s[12:15], s39 offen lds
    s_add_u32 m0, m0, 1024
    s_nop 0
    buffer_load_dwordx4 v244, s[12:15], s39 offen lds
    s_add_u32 m0, m0, 1024
    s_nop 0
    buffer_load_dwordx4 v245, s[12:15], s39 offen lds
    s_add_u32 m0, m0, 1024
    s_nop 0
    buffer_load_dwordx4 v246, s[12:15], s39 offen lds
    s_add_u32 m0, m0, 1024
    s_nop 0
    buffer_load_dwordx4 v247, s[12:15], s39 offen lds
    s_waitcnt vmcnt(14)
    s_setprio 1
    ds_read_b64_tr_b16 v[128:129], v144 offset:0
    ds_read_b64_tr_b16 v[130:131], v144 offset:2048
    ds_read_b64_tr_b16 v[132:133], v145 offset:0
    ds_read_b64_tr_b16 v[134:135], v145 offset:2048
    ds_read_b64_tr_b16 v[136:137], v146 offset:0
    ds_read_b64_tr_b16 v[138:139], v146 offset:2048
    ds_read_b64_tr_b16 v[140:141], v147 offset:0
    ds_read_b64_tr_b16 v[142:143], v147 offset:2048
    s_add_u32 s20, s4, 0x1400000
    s_addc_u32 s21, s5, 0
    s_mov_b32 s22, 0x20000
    s_mov_b32 s23, 0x20000
    s_lshl_b32 s35, s28, 1
    s_and_b32 s36, s30, 1
    s_add_u32 s35, s35, s36
    s_mul_i32 s35, s35, 4096
    s_mul_i32 s36, s29, 256
    s_add_u32 s35, s35, s36
    s_waitcnt lgkmcnt(0)
    v_mfma_f32_16x16x32_bf16 v[160:163], v[128:131], v[16:19], v[160:163]
    v_mfma_f32_16x16x32_bf16 v[160:163], v[132:135], v[20:23], v[160:163]
    v_mfma_f32_16x16x32_bf16 v[160:163], v[136:139], v[24:27], v[160:163]
    v_mfma_f32_16x16x32_bf16 v[160:163], v[140:143], v[28:31], v[160:163]
    s_nop 7
    buffer_store_dwordx4 v[160:163], v167, s[20:23], s35 offen sc1
    s_waitcnt vmcnt(1)
    v_mov_b32 v6, 162840
    v_mov_b32 v7, 1
    s_mov_b64 exec, 1
    ds_add_u32 v6, v7
    s_mov_b64 exec, -1
    ds_read_b64_tr_b16 v[72:73], v148 offset:0
    ds_read_b64_tr_b16 v[74:75], v148 offset:7168
    ds_read_b64_tr_b16 v[76:77], v149 offset:32
    ds_read_b64_tr_b16 v[78:79], v149 offset:7200
    ds_read_b64_tr_b16 v[80:81], v148 offset:64
    ds_read_b64_tr_b16 v[82:83], v148 offset:7232
    ds_read_b64_tr_b16 v[84:85], v149 offset:96
    ds_read_b64_tr_b16 v[86:87], v149 offset:7264
    ds_read_b64_tr_b16 v[88:89], v148 offset:128
    ds_read_b64_tr_b16 v[90:91], v148 offset:7296
    ds_read_b64_tr_b16 v[92:93], v149 offset:160
    ds_read_b64_tr_b16 v[94:95], v149 offset:7328
    ds_read_b64_tr_b16 v[96:97], v148 offset:192
    ds_read_b64_tr_b16 v[98:99], v148 offset:7360
    ds_read_b64_tr_b16 v[100:101], v150 offset:0
    ds_read_b64_tr_b16 v[102:103], v150 offset:7168
    ds_read_b64_tr_b16 v[104:105], v151 offset:32
    ds_read_b64_tr_b16 v[106:107], v151 offset:7200
    ds_read_b64_tr_b16 v[108:109], v150 offset:64
    ds_read_b64_tr_b16 v[110:111], v150 offset:7232
    ds_read_b64_tr_b16 v[112:113], v151 offset:96
    ds_read_b64_tr_b16 v[114:115], v151 offset:7264
    ds_read_b64_tr_b16 v[116:117], v150 offset:128
    ds_read_b64_tr_b16 v[118:119], v150 offset:7296
    ds_read_b64_tr_b16 v[120:121], v151 offset:160
    ds_read_b64_tr_b16 v[122:123], v151 offset:7328
    ds_read_b64_tr_b16 v[124:125], v150 offset:192
    ds_read_b64_tr_b16 v[126:127], v150 offset:7360
    s_add_u32 s20, s4, 0x1420000
    s_addc_u32 s21, s5, 0
    s_mov_b32 s22, 0x70000
    s_mov_b32 s23, 0x20000
    s_lshl_b32 s35, s28, 1
    s_and_b32 s36, s30, 1
    s_add_u32 s35, s35, s36
    s_mul_i32 s35, s35, 14336
    s_mul_i32 s36, s29, 896
    s_add_u32 s35, s35, s36
    s_waitcnt lgkmcnt(0)
    v_mfma_f32_16x16x32_bf16 v[156:159], v[72:75], v[16:19], v[156:159]
    v_mfma_f32_16x16x32_bf16 v[156:159], v[76:79], v[20:23], v[156:159]
    v_mfma_f32_16x16x32_bf16 v[156:159], v[80:83], v[24:27], v[156:159]
    v_mfma_f32_16x16x32_bf16 v[156:159], v[84:87], v[28:31], v[156:159]
    v_mfma_f32_16x16x32_bf16 v[156:159], v[88:91], v[32:35], v[156:159]
    v_mfma_f32_16x16x32_bf16 v[156:159], v[92:95], v[36:39], v[156:159]
    v_mfma_f32_16x16x32_bf16 v[156:159], v[96:99], v[40:43], v[156:159]
    v_mfma_f32_16x16x32_bf16 v[156:159], v[100:103], v[44:47], v[156:159]
    v_mfma_f32_16x16x32_bf16 v[156:159], v[104:107], v[48:51], v[156:159]
    v_mfma_f32_16x16x32_bf16 v[156:159], v[108:111], v[52:55], v[156:159]
    v_mfma_f32_16x16x32_bf16 v[156:159], v[112:115], v[56:59], v[156:159]
    v_mfma_f32_16x16x32_bf16 v[156:159], v[116:119], v[60:63], v[156:159]
    v_mfma_f32_16x16x32_bf16 v[156:159], v[120:123], v[64:67], v[156:159]
    v_mfma_f32_16x16x32_bf16 v[156:159], v[124:127], v[68:71], v[156:159]
    s_nop 7
    buffer_store_dwordx4 v[156:159], v168, s[20:23], s35 offen sc1
    s_and_b32 s36, s2, 7
    s_lshl_b32 s36, s36, 7
    s_add_u32 s36, s36, 23101440
    v_mov_b32 v6, 1
    v_mov_b32 v7, 162820
    v_lshlrev_b32 v9, 10, v1
    s_mov_b64 exec, 1
    s_waitcnt lgkmcnt(0)
    ds_add_rtn_u32 v8, v7, v6
    ds_read_b32 v10, v7 offset:28
    s_waitcnt lgkmcnt(0)
    v_readfirstlane_b32 s54, v8
    v_readfirstlane_b32 s53, v10
    s_cmp_lg_u32 s54, 15
    s_cbranch_scc1 fa_12
    s_mov_b64 exec, 0xffff
    s_or_b32 s53, s53, 1
    v_mov_b32 v6, s53
    buffer_atomic_add v6, v9, s[56:59], s36 offen sc1
fa_12:
    s_mov_b64 exec, -1
    v_and_b32 v252, 15, v251
    v_mul_u32_u24 v248, 458752, v252
    s_and_b32 s36, s30, 1
    s_mul_i32 s36, s36, 6
    s_add_u32 s36, s36, 4
    v_bfe_u32 v252, v251, s36, 6
    v_mul_u32_u24 v250, 37, v252
    v_lshrrev_b32 v250, 8, v250
    v_mul_u32_u24 v250, 7, v250
    v_sub_u32 v250, v252, v250
    v_cmp_eq_u32 vcc, 3, v250
    s_nop 1
    v_cndmask_b32 v250, 0, 1, vcc
    v_lshl_add_u32 v249, v252, 16, v250
    v_mov_b32 v6, 162840
    v_mov_b32 v7, 1
    s_mov_b64 exec, 1
    ds_add_u32 v6, v7
    s_mov_b64 exec, -1
    s_setprio 0
    s_call_b64 s[76:77], SUB_w1_regs
    s_call_b64 s[76:77], SUB_park
    v_mov_b32 v6, 162840
spin_13:
    s_sleep 3
    ds_read_b32 v7, v6
    s_waitcnt lgkmcnt(0)
    v_readfirstlane_b32 s53, v7
    s_nop 0
    s_cmp_ge_u32 s53, 4
    s_cbranch_scc0 spin_13
    s_mov_b64 s[12:13], s[68:69]
    s_mov_b32 s14, 2097152
    s_mov_b32 s15, 0x20000
    s_and_b32 s35, s30, 1
    s_mul_i32 s38, s29, 128
    s_mul_i32 s41, s35, 65536
    s_add_u32 s38, s38, s41
    s_mul_i32 s41, s35, 4096
    s_add_u32 s41, s41, 24576
    s_mov_b32 s42, 0
    s_mov_b32 s44, s67
    s_mov_b32 s42, 98304
    s_mov_b32 s44, s67
    s_add_u32 s44, s44, 12
    s_and_b32 s44, s44, 15
    s_call_b64 s[76:77], SUB_w_issue_1
    s_waitcnt vmcnt(8)
    s_mov_b32 s42, 106496
    s_mov_b32 s44, s67
    s_add_u32 s44, s44, 13
    s_and_b32 s44, s44, 15
    s_call_b64 s[76:77], SUB_w_issue_1
    s_waitcnt vmcnt(8)
    s_mov_b32 s42, 114688
    s_mov_b32 s44, s67
    s_add_u32 s44, s44, 14
    s_and_b32 s44, s44, 15
    s_call_b64 s[76:77], SUB_w_issue_1
    s_waitcnt vmcnt(8)
    s_mov_b32 s42, 122880
    s_mov_b32 s44, s67
    s_add_u32 s44, s44, 15
    s_and_b32 s44, s44, 15
    s_call_b64 s[76:77], SUB_w_issue_1
    s_waitcnt vmcnt(8)
    s_call_b64 s[76:77], SUB_w1_put
FR_end:
LAYER:
    v_lshlrev_b32 v40, 6, v179
    v_add_u32 v40, 161792, v40
    s_lshl_b32 s35, s30, 3
    v_add_u32 v39, s35, v40
    s_cmp_eq_u32 s60, 0
    s_cbranch_scc1 R_l0
    s_sub_u32 s8, s62, 0x3b00000
    s_subb_u32 s9, s63, 0
    s_mov_b32 s10, 0x7e000
    s_mov_b32 s11, 0x20000
    s_sub_u32 s12, s62, 0x3a80000
    s_subb_u32 s13, s63, 0
    s_mov_b32 s14, 0x7e000
    s_mov_b32 s15, 0x20000
    s_waitcnt vmcnt(0)
    v_lshlrev_b32 v222, 16, v230
    v_and_b32 v223, 0xffff0000, v230
    v_lshlrev_b32 v206, 16, v180
    v_and_b32 v207, 0xffff0000, v180
    v_lshlrev_b32 v12, 16, v188
    v_and_b32 v13, 0xffff0000, v188
    v_pk_add_f32 v[206:207], v[206:207], v[12:13]
    v_lshlrev_b32 v224, 16, v231
    v_and_b32 v225, 0xffff0000, v231
    v_lshlrev_b32 v208, 16, v181
    v_and_b32 v209, 0xffff0000, v181
    v_lshlrev_b32 v14, 16, v189
    v_and_b32 v15, 0xffff0000, v189
    v_pk_add_f32 v[208:209], v[208:209], v[14:15]
    v_lshlrev_b32 v226, 16, v232
    v_and_b32 v227, 0xffff0000, v232
    v_lshlrev_b32 v210, 16, v182
    v_and_b32 v211, 0xffff0000, v182
    v_lshlrev_b32 v16, 16, v190
    v_and_b32 v17, 0xffff0000, v190
    v_pk_add_f32 v[210:211], v[210:211], v[16:17]
    v_lshlrev_b32 v228, 16, v233
    v_and_b32 v229, 0xffff0000, v233
    v_lshlrev_b32 v212, 16, v183
    v_and_b32 v213, 0xffff0000, v183
    v_lshlrev_b32 v18, 16, v191
    v_and_b32 v19, 0xffff0000, v191
    v_pk_add_f32 v[212:213], v[212:213], v[18:19]
    v_lshlrev_b32 v230, 16, v234
    v_and_b32 v231, 0xffff0000, v234
    v_lshlrev_b32 v214, 16, v184
    v_and_b32 v215, 0xffff0000, v184
    v_lshlrev_b32 v20, 16, v192
    v_and_b32 v21, 0xffff0000, v192
    v_pk_add_f32 v[214:215], v[214:215], v[20:21]
    v_lshlrev_b32 v232, 16, v235
    v_and_b32 v233, 0xffff0000, v235
    v_lshlrev_b32 v216, 16, v185
    v_and_b32 v217, 0xffff0000, v185
    v_lshlrev_b32 v22, 16, v193
    v_and_b32 v23, 0xffff0000, v193
    v_pk_add_f32 v[216:217], v[216:217], v[22:23]
    v_lshlrev_b32 v234, 16, v236
    v_and_b32 v235, 0xffff0000, v236
    v_lshlrev_b32 v218, 16, v186
    v_and_b32 v219, 0xffff0000, v186
    v_lshlrev_b32 v24, 16, v194
    v_and_b32 v25, 0xffff0000, v194
    v_pk_add_f32 v[218:219], v[218:219], v[24:25]
    v_lshlrev_b32 v236, 16, v237
    v_and_b32 v237, 0xffff0000, v237
    v_lshlrev_b32 v220, 16, v187
    v_and_b32 v221, 0xffff0000, v187
    v_lshlrev_b32 v26, 16, v195
    v_and_b32 v27, 0xffff0000, v195
    v_pk_add_f32 v[220:221], v[220:221], v[26:27]
    s_cmp_lg_u32 s30, 4
    s_cbranch_scc1 pdone_14
    s_lshl_b32 s54, s60, 2
    s_add_u32 s54, s54, 0
    v_mov_b32 v8, 162872
spin_15:
    s_sleep 8
    ds_read_b32 v9, v8
    s_waitcnt lgkmcnt(0)
    v_readfirstlane_b32 s53, v9
    s_nop 0
    s_cmp_ge_u32 s53, s54
    s_cbranch_scc0 spin_15
    s_add_u32 s54, s55, 0xfc000400
    v_mov_b32 v9, s54
    s_mov_b32 s53, 0
    s_add_u32 s54, s52, 16
    s_bfm_b64 exec, 1, 0
poll_16:
    buffer_load_dword v8, v9, s[56:59], 0 offen sc1
    s_waitcnt vmcnt(0)
    v_xor_b32 v8, s54, v8
    v_cmp_eq_u32 vcc, 0, v8
    s_nop 0
    s_cmp_eq_u64 vcc, exec
    s_cbranch_scc1 pok_17
    s_sleep 5
    s_add_u32 s53, s53, 1
    s_cmp_lt_u32 s53, s61
    s_cbranch_scc1 poll_16
    s_mov_b32 s61, 0
pok_17:
    s_mov_b64 exec, -1
pdone_14:
    s_barrier
    buffer_load_dwordx4 v[180:183], v176, s[8:11], 0 offen offset:0 sc1
    buffer_load_dwordx4 v[188:191], v176, s[12:15], 0 offen offset:0 sc1
    buffer_load_dwordx4 v[184:187], v176, s[8:11], 0 offen offset:2048 sc1
    buffer_load_dwordx4 v[192:195], v176, s[12:15], 0 offen offset:2048 sc1
    s_waitcnt vmcnt(2)
    v_lshlrev_b32 v12, 16, v180
    v_and_b32 v13, 0xffff0000, v180
    v_lshlrev_b32 v14, 16, v188
    v_and_b32 v15, 0xffff0000, v188
    v_pk_add_f32 v[12:13], v[12:13], v[14:15]
    v_pk_add_f32 v[206:207], v[206:207], v[12:13]
    v_lshlrev_b32 v16, 16, v181
    v_and_b32 v17, 0xffff0000, v181
    v_lshlrev_b32 v18, 16, v189
    v_and_b32 v19, 0xffff0000, v189
    v_pk_add_f32 v[16:17], v[16:17], v[18:19]
    v_pk_add_f32 v[208:209], v[208:209], v[16:17]
    v_lshlrev_b32 v20, 16, v182
    v_and_b32 v21, 0xffff0000, v182
    v_lshlrev_b32 v22, 16, v190
    v_and_b32 v23, 0xffff0000, v190
    v_pk_add_f32 v[20:21], v[20:21], v[22:23]
    v_pk_add_f32 v[210:211], v[210:211], v[20:21]
    v_lshlrev_b32 v24, 16, v183
    v_and_b32 v25, 0xffff0000, v183
    v_lshlrev_b32 v26, 16, v191
    v_and_b32 v27, 0xffff0000, v191
    v_pk_add_f32 v[24:25], v[24:25], v[26:27]
    v_pk_add_f32 v[212:213], v[212:213], v[24:25]
    s_waitcnt vmcnt(0)
    v_lshlrev_b32 v12, 16, v184
    v_and_b32 v13, 0xffff0000, v184
    v_lshlrev_b32 v14, 16, v192
    v_and_b32 v15, 0xffff0000, v192
    v_pk_add_f32 v[12:13], v[12:13], v[14:15]
    v_pk_add_f32 v[214:215], v[214:215], v[12:13]
    v_lshlrev_b32 v16, 16, v185
    v_and_b32 v17, 0xffff0000, v185
    v_lshlrev_b32 v18, 16, v193
    v_and_b32 v19, 0xffff0000, v193
    v_pk_add_f32 v[16:17], v[16:17], v[18:19]
    v_pk_add_f32 v[216:217], v[216:217], v[16:17]
    v_lshlrev_b32 v20, 16, v186
    v_and_b32 v21, 0xffff0000, v186
    v_lshlrev_b32 v22, 16, v194
    v_and_b32 v23, 0xffff0000, v194
    v_pk_add_f32 v[20:21], v[20:21], v[22:23]
    v_pk_add_f32 v[218:219], v[218:219], v[20:21]
    v_lshlrev_b32 v24, 16, v187
    v_and_b32 v25, 0xffff0000, v187
    v_lshlrev_b32 v26, 16, v195
    v_and_b32 v27, 0xffff0000, v195
    v_pk_add_f32 v[24:25], v[24:25], v[26:27]
    v_pk_add_f32 v[220:221], v[220:221], v[24:25]
    v_pk_add_f32 v[32:33], v[206:207], v[208:209]
    v_pk_mul_f32 v[34:35], v[206:207], v[206:207]
    v_pk_fma_f32 v[34:35], v[208:209], v[208:209], v[34:35]
    v_pk_add_f32 v[32:33], v[32:33], v[210:211]
    v_pk_fma_f32 v[34:35], v[210:211], v[210:211], v[34:35]
    v_pk_add_f32 v[32:33], v[32:33], v[212:213]
    v_pk_fma_f32 v[34:35], v[212:213], v[212:213], v[34:35]
    v_pk_add_f32 v[32:33], v[32:33], v[214:215]
    v_pk_fma_f32 v[34:35], v[214:215], v[214:215], v[34:35]
    v_pk_add_f32 v[32:33], v[32:33], v[216:217]
    v_pk_fma_f32 v[34:35], v[216:217], v[216:217], v[34:35]
    v_pk_add_f32 v[32:33], v[32:33], v[218:219]
    v_pk_fma_f32 v[34:35], v[218:219], v[218:219], v[34:35]
    v_pk_add_f32 v[32:33], v[32:33], v[220:221]
    v_pk_fma_f32 v[34:35], v[220:221], v[220:221], v[34:35]
    v_add_f32 v30, v32, v33
    v_add_f32 v31, v34, v35
    s_nop 0
    v_add_f32_dpp v30, v30, v30 row_ror:8 row_mask:0xf bank_mask:0xf
    v_add_f32_dpp v31, v31, v31 row_ror:8 row_mask:0xf bank_mask:0xf
    v_mov_b32 v32, v30
    v_mov_b32 v33, v31
    s_nop 0
    v_permlane16_swap_b32 v30, v32
    v_permlane16_swap_b32 v31, v33
    v_pk_add_f32 v[30:31], v[30:31], v[32:33]
    v_mov_b32 v32, v30
    v_mov_b32 v33, v31
    s_nop 0
    v_permlane32_swap_b32 v30, v32
    v_permlane32_swap_b32 v31, v33
    v_pk_add_f32 v[30:31], v[30:31], v[32:33]
    ds_write_b64 v39, v[30:31] offset:0
    s_waitcnt lgkmcnt(0)
    s_barrier
    ds_read_b128 v[12:15], v40 offset:0
    ds_read_b128 v[16:19], v40 offset:16
    ds_read_b128 v[20:23], v40 offset:32
    ds_read_b128 v[24:27], v40 offset:48
    s_waitcnt lgkmcnt(0)
    v_pk_add_f32 v[12:13], v[12:13], v[14:15]
    v_pk_add_f32 v[16:17], v[16:17], v[18:19]
    v_pk_add_f32 v[20:21], v[20:21], v[22:23]
    v_pk_add_f32 v[24:25], v[24:25], v[26:27]
    v_pk_add_f32 v[12:13], v[12:13], v[16:17]
    v_pk_add_f32 v[20:21], v[20:21], v[24:25]
    v_pk_add_f32 v[12:13], v[12:13], v[20:21]
    v_mul_f32 v36, 0x3a800000, v12
    v_mul_f32 v38, 0x3a800000, v13
    v_fma_f32 v38, -v36, v36, v38
    v_max_f32 v38, 0, v38
    v_add_f32 v38, 0x3727c5ac, v38
    v_rsq_f32 v37, v38
    s_add_u32 s20, s62, 0x400000
    s_addc_u32 s21, s63, 0
    s_mov_b32 s22, 0x7e000
    s_mov_b32 s23, 0x20000
    v_pk_add_f32 v[12:13], v[206:207], v[36:37] op_sel_hi:[1,0] neg_lo:[0,1] neg_hi:[0,1]
    v_pk_mul_f32 v[12:13], v[12:13], v[36:37] op_sel:[0,1] op_sel_hi:[1,1]
    v_pk_fma_f32 v[206:207], v[12:13], v[222:223], v[206:207]
    v_cvt_pk_bf16_f32 v180, v206, v207
    v_pk_add_f32 v[14:15], v[208:209], v[36:37] op_sel_hi:[1,0] neg_lo:[0,1] neg_hi:[0,1]
    v_pk_mul_f32 v[14:15], v[14:15], v[36:37] op_sel:[0,1] op_sel_hi:[1,1]
    v_pk_fma_f32 v[208:209], v[14:15], v[224:225], v[208:209]
    v_cvt_pk_bf16_f32 v181, v208, v209
    v_pk_add_f32 v[16:17], v[210:211], v[36:37] op_sel_hi:[1,0] neg_lo:[0,1] neg_hi:[0,1]
    v_pk_mul_f32 v[16:17], v[16:17], v[36:37] op_sel:[0,1] op_sel_hi:[1,1]
    v_pk_fma_f32 v[210:211], v[16:17], v[226:227], v[210:211]
    v_cvt_pk_bf16_f32 v182, v210, v211
    v_pk_add_f32 v[18:19], v[212:213], v[36:37] op_sel_hi:[1,0] neg_lo:[0,1] neg_hi:[0,1]
    v_pk_mul_f32 v[18:19], v[18:19], v[36:37] op_sel:[0,1] op_sel_hi:[1,1]
    v_pk_fma_f32 v[212:213], v[18:19], v[228:229], v[212:213]
    v_cvt_pk_bf16_f32 v183, v212, v213
    buffer_store_dwordx4 v[180:183], v176, s[20:23], 0 offen offset:0 sc1
    v_pk_add_f32 v[20:21], v[214:215], v[36:37] op_sel_hi:[1,0] neg_lo:[0,1] neg_hi:[0,1]
    v_pk_mul_f32 v[20:21], v[20:21], v[36:37] op_sel:[0,1] op_sel_hi:[1,1]
    v_pk_fma_f32 v[214:215], v[20:21], v[230:231], v[214:215]
    v_cvt_pk_bf16_f32 v184, v214, v215
    v_pk_add_f32 v[22:23], v[216:217], v[36:37] op_sel_hi:[1,0] neg_lo:[0,1] neg_hi:[0,1]
    v_pk_mul_f32 v[22:23], v[22:23], v[36:37] op_sel:[0,1] op_sel_hi:[1,1]
    v_pk_fma_f32 v[216:217], v[22:23], v[232:233], v[216:217]
    v_cvt_pk_bf16_f32 v185, v216, v217
    v_pk_add_f32 v[24:25], v[218:219], v[36:37] op_sel_hi:[1,0] neg_lo:[0,1] neg_hi:[0,1]
    v_pk_mul_f32 v[24:25], v[24:25], v[36:37] op_sel:[0,1] op_sel_hi:[1,1]
    v_pk_fma_f32 v[218:219], v[24:25], v[234:235], v[218:219]
    v_cvt_pk_bf16_f32 v186, v218, v219
    v_pk_add_f32 v[26:27], v[220:221], v[36:37] op_sel_hi:[1,0] neg_lo:[0,1] neg_hi:[0,1]
    v_pk_mul_f32 v[26:27], v[26:27], v[36:37] op_sel:[0,1] op_sel_hi:[1,1]
    v_pk_fma_f32 v[220:221], v[26:27], v[236:237], v[220:221]
    v_cvt_pk_bf16_f32 v187, v220, v221
    buffer_store_dwordx4 v[184:187], v176, s[20:23], 0 offen offset:2048 sc1
    s_branch R_s2
R_l0:
    v_lshlrev_b32 v206, 16, v180
    v_and_b32 v207, 0xffff0000, v180
    v_lshlrev_b32 v208, 16, v181
    v_and_b32 v209, 0xffff0000, v181
    v_lshlrev_b32 v210, 16, v182
    v_and_b32 v211, 0xffff0000, v182
    v_lshlrev_b32 v212, 16, v183
    v_and_b32 v213, 0xffff0000, v183
    v_lshlrev_b32 v214, 16, v184
    v_and_b32 v215, 0xffff0000, v184
    v_lshlrev_b32 v216, 16, v185
    v_and_b32 v217, 0xffff0000, v185
    v_lshlrev_b32 v218, 16, v186
    v_and_b32 v219, 0xffff0000, v186
    v_lshlrev_b32 v220, 16, v187
    v_and_b32 v221, 0xffff0000, v187
    v_pk_add_f32 v[32:33], v[206:207], v[208:209]
    v_pk_mul_f32 v[34:35], v[206:207], v[206:207]
    v_pk_fma_f32 v[34:35], v[208:209], v[208:209], v[34:35]
    v_pk_add_f32 v[32:33], v[32:33], v[210:211]
    v_pk_fma_f32 v[34:35], v[210:211], v[210:211], v[34:35]
    v_pk_add_f32 v[32:33], v[32:33], v[212:213]
    v_pk_fma_f32 v[34:35], v[212:213], v[212:213], v[34:35]
    v_pk_add_f32 v[32:33], v[32:33], v[214:215]
    v_pk_fma_f32 v[34:35], v[214:215], v[214:215], v[34:35]
    v_pk_add_f32 v[32:33], v[32:33], v[216:217]
    v_pk_fma_f32 v[34:35], v[216:217], v[216:217], v[34:35]
    v_pk_add_f32 v[32:33], v[32:33], v[218:219]
    v_pk_fma_f32 v[34:35], v[218:219], v[218:219], v[34:35]
    v_pk_add_f32 v[32:33], v[32:33], v[220:221]
    v_pk_fma_f32 v[34:35], v[220:221], v[220:221], v[34:35]
    v_add_f32 v30, v32, v33
    v_add_f32 v31, v34, v35
    s_nop 0
    v_add_f32_dpp v30, v30, v30 row_ror:8 row_mask:0xf bank_mask:0xf
    v_add_f32_dpp v31, v31, v31 row_ror:8 row_mask:0xf bank_mask:0xf
    v_mov_b32 v32, v30
    v_mov_b32 v33, v31
    s_nop 0
    v_permlane16_swap_b32 v30, v32
    v_permlane16_swap_b32 v31, v33
    v_pk_add_f32 v[30:31], v[30:31], v[32:33]
    v_mov_b32 v32, v30
    v_mov_b32 v33, v31
    s_nop 0
    v_permlane32_swap_b32 v30, v32
    v_permlane32_swap_b32 v31, v33
    v_pk_add_f32 v[30:31], v[30:31], v[32:33]
    ds_write_b64 v39, v[30:31] offset:0
    s_waitcnt lgkmcnt(0)
    s_cmp_lg_u32 s30, 4
    s_cbranch_scc1 R_fw
    v_mov_b32 v222, 162820
spin_18:
    s_sleep 4
    ds_read_b32 v223, v222
    s_waitcnt lgkmcnt(0)
    v_readfirstlane_b32 s53, v223
    s_nop 0
    s_cmp_ge_u32 s53, 16
    s_cbranch_scc0 spin_18
    s_lshl_b32 s36, s28, 10
    s_add_u32 s36, s36, 23101440
    v_lshlrev_b32 v226, 7, v1
    v_add_u32 v226, s36, v226
    s_mov_b32 s53, 0
    s_mov_b64 exec, 0xff
R_fp:
    buffer_load_dword v222, v226, s[56:59], 0 offen sc1
    s_waitcnt vmcnt(0)
    v_subrev_u32 v222, s52, v222
    v_and_b32 v223, 0xffffc0ff, v222
    v_cmp_eq_u32 vcc, 32, v223
    s_nop 0
    s_cmp_eq_u64 vcc, exec
    s_cbranch_scc1 R_fq
    s_sleep 3
    s_add_u32 s53, s53, 1
    s_cmp_lt_u32 s53, s61
    s_cbranch_scc1 R_fp
    s_mov_b32 s61, 0
R_fq:
    v_lshrrev_b32 v222, 8, v222
    v_mov_b32 v223, 162844
    ds_add_u32 v223, v222
    s_mov_b64 exec, -1
    s_waitcnt lgkmcnt(0)
R_fw:
    s_barrier
    s_add_u32 s80, s4, 0x1c00000
    s_addc_u32 s81, s5, 0
    s_mov_b32 s82, 0x400000
    s_mov_b32 s83, 0x20000
    s_mov_b32 s78, 0
    buffer_load_dwordx2 v[230:231], v177, s[80:83], s78 offen sc1
    s_mov_b32 s78, 65536
    buffer_load_dwordx2 v[232:233], v177, s[80:83], s78 offen sc1
    s_mov_b32 s78, 262144
    buffer_load_dwordx2 v[234:235], v177, s[80:83], s78 offen sc1
    s_mov_b32 s78, 327680
    buffer_load_dwordx2 v[236:237], v177, s[80:83], s78 offen sc1
    v_mov_b32 v222, 162844
    ds_read_b32 v223, v222
    s_waitcnt lgkmcnt(0)
    v_readfirstlane_b32 s94, v223
    s_nop 0
    s_cmp_gt_u32 s94, 127
    s_cselect_b32 s94, 1, 0
    s_lshr_b32 s53, s28, 3
    s_lshl_b32 s53, s53, 2
    s_and_b32 s54, s28, 3
    s_add_u32 s53, s53, s54
    s_lshl_b32 s53, s53, 23
    s_lshr_b32 s54, s28, 2
    s_xor_b32 s54, s54, s94
    s_and_b32 s54, s54, 1
    s_lshl_b32 s54, s54, 13
    s_add_u32 s55, s53, s54
    s_add_u32 s55, s55, 33554432
    s_add_u32 s62, s4, s55
    s_addc_u32 s63, s5, 0
    s_sub_u32 s36, s28, 1
    s_max_i32 s36, s36, 0
    s_lshr_b32 s53, s36, 3
    s_lshl_b32 s53, s53, 2
    s_and_b32 s54, s36, 3
    s_add_u32 s53, s53, s54
    s_lshl_b32 s53, s53, 23
    s_lshr_b32 s54, s36, 2
    s_xor_b32 s54, s54, s94
    s_and_b32 s54, s54, 1
    s_lshl_b32 s54, s54, 13
    s_add_u32 s92, s53, s54
    s_add_u32 s92, s92, 33554432
    s_sub_u32 s92, s92, s55
    s_add_u32 s36, s28, 1
    s_min_u32 s36, s36, 15
    s_lshr_b32 s53, s36, 3
    s_lshl_b32 s53, s53, 2
    s_and_b32 s54, s36, 3
    s_add_u32 s53, s53, s54
    s_lshl_b32 s53, s53, 23
    s_lshr_b32 s54, s36, 2
    s_xor_b32 s54, s54, s94
    s_and_b32 s54, s54, 1
    s_lshl_b32 s54, s54, 13
    s_add_u32 s93, s53, s54
    s_add_u32 s93, s93, 33554432
    s_sub_u32 s93, s93, s55
    s_add_u32 s55, s55, 1835008
    s_add_u32 s20, s62, 0x400000
    s_addc_u32 s21, s63, 0
    s_mov_b32 s22, 0x7e000
    s_mov_b32 s23, 0x20000
    ds_read_b128 v[12:15], v40 offset:0
    ds_read_b128 v[16:19], v40 offset:16
    ds_read_b128 v[20:23], v40 offset:32
    ds_read_b128 v[24:27], v40 offset:48
    s_waitcnt lgkmcnt(0)
    v_pk_add_f32 v[12:13], v[12:13], v[14:15]
    v_pk_add_f32 v[16:17], v[16:17], v[18:19]
    v_pk_add_f32 v[20:21], v[20:21], v[22:23]
    v_pk_add_f32 v[24:25], v[24:25], v[26:27]
    v_pk_add_f32 v[12:13], v[12:13], v[16:17]
    v_pk_add_f32 v[20:21], v[20:21], v[24:25]
    v_pk_add_f32 v[12:13], v[12:13], v[20:21]
    v_mul_f32 v36, 0x3a800000, v12
    v_mul_f32 v38, 0x3a800000, v13
    v_fma_f32 v38, -v36, v36, v38
    v_max_f32 v38, 0, v38
    v_add_f32 v38, 0x3727c5ac, v38
    v_rsq_f32 v37, v38
    s_nop 0
    v_pk_add_f32 v[12:13], v[206:207], v[36:37] op_sel_hi:[1,0] neg_lo:[0,1] neg_hi:[0,1]
    v_pk_mul_f32 v[12:13], v[12:13], v[36:37] op_sel:[0,1] op_sel_hi:[1,1]
    v_pk_add_f32 v[14:15], v[208:209], v[36:37] op_sel_hi:[1,0] neg_lo:[0,1] neg_hi:[0,1]
    v_pk_mul_f32 v[14:15], v[14:15], v[36:37] op_sel:[0,1] op_sel_hi:[1,1]
    v_pk_add_f32 v[16:17], v[210:211], v[36:37] op_sel_hi:[1,0] neg_lo:[0,1] neg_hi:[0,1]
    v_pk_mul_f32 v[16:17], v[16:17], v[36:37] op_sel:[0,1] op_sel_hi:[1,1]
    v_pk_add_f32 v[18:19], v[212:213], v[36:37] op_sel_hi:[1,0] neg_lo:[0,1] neg_hi:[0,1]
    v_pk_mul_f32 v[18:19], v[18:19], v[36:37] op_sel:[0,1] op_sel_hi:[1,1]
    v_pk_add_f32 v[20:21], v[214:215], v[36:37] op_sel_hi:[1,0] neg_lo:[0,1] neg_hi:[0,1]
    v_pk_mul_f32 v[20:21], v[20:21], v[36:37] op_sel:[0,1] op_sel_hi:[1,1]
    v_pk_add_f32 v[22:23], v[216:217], v[36:37] op_sel_hi:[1,0] neg_lo:[0,1] neg_hi:[0,1]
    v_pk_mul_f32 v[22:23], v[22:23], v[36:37] op_sel:[0,1] op_sel_hi:[1,1]
    v_pk_add_f32 v[24:25], v[218:219], v[36:37] op_sel_hi:[1,0] neg_lo:[0,1] neg_hi:[0,1]
    v_pk_mul_f32 v[24:25], v[24:25], v[36:37] op_sel:[0,1] op_sel_hi:[1,1]
    v_pk_add_f32 v[26:27], v[220:221], v[36:37] op_sel_hi:[1,0] neg_lo:[0,1] neg_hi:[0,1]
    v_pk_mul_f32 v[26:27], v[26:27], v[36:37] op_sel:[0,1] op_sel_hi:[1,1]
    s_waitcnt vmcnt(0)
    v_lshlrev_b32 v222, 16, v230
    v_and_b32 v223, 0xffff0000, v230
    v_pk_fma_f32 v[206:207], v[12:13], v[222:223], v[206:207]
    v_cvt_pk_bf16_f32 v180, v206, v207
    v_lshlrev_b32 v222, 16, v231
    v_and_b32 v223, 0xffff0000, v231
    v_pk_fma_f32 v[208:209], v[14:15], v[222:223], v[208:209]
    v_cvt_pk_bf16_f32 v181, v208, v209
    v_lshlrev_b32 v222, 16, v232
    v_and_b32 v223, 0xffff0000, v232
    v_pk_fma_f32 v[210:211], v[16:17], v[222:223], v[210:211]
    v_cvt_pk_bf16_f32 v182, v210, v211
    v_lshlrev_b32 v222, 16, v233
    v_and_b32 v223, 0xffff0000, v233
    v_pk_fma_f32 v[212:213], v[18:19], v[222:223], v[212:213]
    v_cvt_pk_bf16_f32 v183, v212, v213
    buffer_store_dwordx4 v[180:183], v176, s[20:23], 0 offen offset:0 sc1
    v_lshlrev_b32 v222, 16, v234
    v_and_b32 v223, 0xffff0000, v234
    v_pk_fma_f32 v[214:215], v[20:21], v[222:223], v[214:215]
    v_cvt_pk_bf16_f32 v184, v214, v215
    v_lshlrev_b32 v222, 16, v235
    v_and_b32 v223, 0xffff0000, v235
    v_pk_fma_f32 v[216:217], v[22:23], v[222:223], v[216:217]
    v_cvt_pk_bf16_f32 v185, v216, v217
    v_lshlrev_b32 v222, 16, v236
    v_and_b32 v223, 0xffff0000, v236
    v_pk_fma_f32 v[218:219], v[24:25], v[222:223], v[218:219]
    v_cvt_pk_bf16_f32 v186, v218, v219
    v_lshlrev_b32 v222, 16, v237
    v_and_b32 v223, 0xffff0000, v237
    v_pk_fma_f32 v[220:221], v[26:27], v[222:223], v[220:221]
    v_cvt_pk_bf16_f32 v187, v220, v221
    buffer_store_dwordx4 v[184:187], v176, s[20:23], 0 offen offset:2048 sc1
R_s2:
    v_lshlrev_b32 v206, 16, v180
    v_and_b32 v207, 0xffff0000, v180
    v_lshlrev_b32 v208, 16, v181
    v_and_b32 v209, 0xffff0000, v181
    v_lshlrev_b32 v210, 16, v182
    v_and_b32 v211, 0xffff0000, v182
    v_lshlrev_b32 v212, 16, v183
    v_and_b32 v213, 0xffff0000, v183
    v_lshlrev_b32 v214, 16, v184
    v_and_b32 v215, 0xffff0000, v184
    v_lshlrev_b32 v216, 16, v185
    v_and_b32 v217, 0xffff0000, v185
    v_lshlrev_b32 v218, 16, v186
    v_and_b32 v219, 0xffff0000, v186
    v_lshlrev_b32 v220, 16, v187
    v_and_b32 v221, 0xffff0000, v187
    v_pk_add_f32 v[32:33], v[206:207], v[208:209]
    v_pk_mul_f32 v[34:35], v[206:207], v[206:207]
    v_pk_fma_f32 v[34:35], v[208:209], v[208:209], v[34:35]
    v_pk_add_f32 v[32:33], v[32:33], v[210:211]
    v_pk_fma_f32 v[34:35], v[210:211], v[210:211], v[34:35]
    v_pk_add_f32 v[32:33], v[32:33], v[212:213]
    v_pk_fma_f32 v[34:35], v[212:213], v[212:213], v[34:35]
    v_pk_add_f32 v[32:33], v[32:33], v[214:215]
    v_pk_fma_f32 v[34:35], v[214:215], v[214:215], v[34:35]
    v_pk_add_f32 v[32:33], v[32:33], v[216:217]
    v_pk_fma_f32 v[34:35], v[216:217], v[216:217], v[34:35]
    v_pk_add_f32 v[32:33], v[32:33], v[218:219]
    v_pk_fma_f32 v[34:35], v[218:219], v[218:219], v[34:35]
    v_pk_add_f32 v[32:33], v[32:33], v[220:221]
    v_pk_fma_f32 v[34:35], v[220:221], v[220:221], v[34:35]
    v_add_f32 v30, v32, v33
    v_add_f32 v31, v34, v35
    s_nop 0
    v_add_f32_dpp v30, v30, v30 row_ror:8 row_mask:0xf bank_mask:0xf
    v_add_f32_dpp v31, v31, v31 row_ror:8 row_mask:0xf bank_mask:0xf
    v_mov_b32 v32, v30
    v_mov_b32 v33, v31
    s_nop 0
    v_permlane16_swap_b32 v30, v32
    v_permlane16_swap_b32 v31, v33
    v_pk_add_f32 v[30:31], v[30:31], v[32:33]
    v_mov_b32 v32, v30
    v_mov_b32 v33, v31
    s_nop 0
    v_permlane32_swap_b32 v30, v32
    v_permlane32_swap_b32 v31, v33
    v_pk_add_f32 v[30:31], v[30:31], v[32:33]
    ds_write_b64 v39, v[30:31] offset:512
    s_add_u32 s53, s55, 0
    v_mov_b32 v8, 1
    v_mov_b32 v9, 162820
    v_mov_b32 v11, 0
    s_mov_b64 exec, 1
    s_waitcnt vmcnt(0)
    ds_add_rtn_u32 v10, v9, v8
    s_waitcnt lgkmcnt(0)
    v_readfirstlane_b32 s54, v10
    s_nop 0
    s_and_b32 s54, s54, 7
    s_cmp_lg_u32 s54, 7
    s_cbranch_scc1 pub_19
    buffer_atomic_add v8, v11, s[56:59], s53 offen sc1
    s_cmp_lg_u32 s60, 0
    s_cbranch_scc1 pub_19
    s_lshl_b32 s53, s29, 7
    s_add_u32 s53, s53, 23117824
    buffer_atomic_add v8, v11, s[56:59], s53 offen sc1
pub_19:
    s_mov_b64 exec, -1
    s_barrier
    s_cmp_lg_u32 s30, 0
    s_cbranch_scc1 R_nl
    ds_read_b128 v[12:15], v40 offset:512
    ds_read_b128 v[16:19], v40 offset:528
    ds_read_b128 v[20:23], v40 offset:544
    ds_read_b128 v[24:27], v40 offset:560
    s_waitcnt lgkmcnt(0)
    v_pk_add_f32 v[12:13], v[12:13], v[14:15]
    v_pk_add_f32 v[16:17], v[16:17], v[18:19]
    v_pk_add_f32 v[20:21], v[20:21], v[22:23]
    v_pk_add_f32 v[24:25], v[24:25], v[26:27]
    v_pk_add_f32 v[12:13], v[12:13], v[16:17]
    v_pk_add_f32 v[20:21], v[20:21], v[24:25]
    v_pk_add_f32 v[12:13], v[12:13], v[20:21]
    v_mul_f32 v36, 0x3a800000, v12
    v_mul_f32 v38, 0x3a800000, v13
    v_fma_f32 v38, -v36, v36, v38
    v_max_f32 v38, 0, v38
    v_mov_b32 v42, v36
    v_mov_b32 v43, v38
    v_add_f32 v38, 0x3727c5ac, v38
    v_sqrt_f32 v38, v38
    s_nop 0
    v_mov_b32 v41, v38
    v_rcp_f32 v37, v38
    v_sub_f32 v42, v42, v36
    v_mul_f32 v42, v42, v37
    v_mul_f32 v43, v43, v37
    v_mul_f32 v43, v43, v37
    v_add_f32 v43, 0x3727c5ac, v43
    v_rsq_f32 v44, v43
    v_mov_b32 v224, v36
    v_mov_b32 v225, v37
    v_fma_f32 v226, v42, v41, v36
    v_mul_f32 v227, v37, v44
    s_add_u32 s24, s62, 0x1d0000
    s_addc_u32 s25, s63, 0
    s_mov_b32 s26, 0x800
    s_mov_b32 s27, 0x20000
    s_lshl_b32 s36, s29, 3
    v_add_u32 v6, s36, v179
    v_lshlrev_b32 v6, 4, v6
    s_mov_b64 exec, 0xff
    buffer_store_dwordx4 v[224:227], v6, s[24:27], 0 offen sc1
    s_mov_b64 exec, -1
    s_add_u32 s53, s55, 1280
    v_mov_b32 v8, 1
    v_mov_b32 v9, 162816
    v_mov_b32 v11, 0
    s_mov_b64 exec, 1
    s_waitcnt vmcnt(0)
    buffer_atomic_add v8, v11, s[56:59], s53 offen sc1
pub_20:
    s_mov_b64 exec, -1
R_nl:
    s_cmp_ge_u32 s30, 4
    s_cbranch_scc1 LOADERS
    s_mov_b32 s34, s30
    s_mov_b32 s35, 0
    v_and_b32 v22, 15, v1
    v_lshrrev_b32 v23, 4, v1
    s_mul_i32 s37, s34, 2
    s_mul_i32 s38, s29, 4
    s_mul_i32 s36, s35, 4
    s_add_u32 s38, s38, s36
    s_add_u32 s8, s62, 0x400000
    s_addc_u32 s9, s63, 0
    s_mov_b32 s10, 0x7e000
    s_mov_b32 s11, 0x20000
    v_add_u32 v126, 0, v2
    v_add_u32 v127, 65536, v2
    v_add_u32 v128, 4096, v2
    v_add_u32 v129, 69632, v2
    s_lshr_b32 s36, s67, 2
    s_add_u32 s36, s36, 0
    s_and_b32 s36, s36, 3
    s_lshl_b32 s44, s36, 14
    s_lshl_b32 s36, s34, 17
    s_add_u32 s44, s44, s36
    s_lshr_b32 s36, s67, 2
    s_add_u32 s36, s36, 1
    s_and_b32 s36, s36, 3
    s_lshl_b32 s45, s36, 14
    s_lshl_b32 s36, s34, 17
    s_add_u32 s45, s45, s36
    s_lshr_b32 s36, s67, 2
    s_add_u32 s36, s36, 2
    s_and_b32 s36, s36, 3
    s_lshl_b32 s46, s36, 14
    s_lshl_b32 s36, s34, 17
    s_add_u32 s46, s46, s36
    s_lshr_b32 s36, s67, 2
    s_add_u32 s36, s36, 3
    s_and_b32 s36, s36, 3
    s_lshl_b32 s47, s36, 14
    s_lshl_b32 s36, s34, 17
    s_add_u32 s47, s47, s36
    v_lshrrev_b32 v6, 2, v1
    v_mul_u32_u24 v13, 128, v6
    v_and_b32 v7, 3, v1
    v_lshl_add_u32 v13, v7, 3, v13
    v_add_u32 v13, 24576, v13
    v_bfe_u32 v6, v6, 1, 2
    s_mul_i32 s36, s35, 4
    s_add_u32 s36, s36, 3
    v_xor_b32 v7, s36, v6
    v_lshl_add_u32 v16, v7, 5, v13
    s_mul_i32 s36, s35, 4
    s_add_u32 s36, s36, 2
    v_xor_b32 v7, s36, v6
    v_lshl_add_u32 v15, v7, 5, v13
    s_mul_i32 s36, s35, 4
    s_add_u32 s36, s36, 1
    v_xor_b32 v7, s36, v6
    v_lshl_add_u32 v14, v7, 5, v13
    s_mul_i32 s36, s35, 4
    s_add_u32 s36, s36, 0
    v_xor_b32 v7, s36, v6
    v_lshl_add_u32 v13, v7, 5, v13
    v_pk_mov_b32 v[24:25], 0, 0
    v_pk_mov_b32 v[26:27], 0, 0
    v_pk_mov_b32 v[28:29], 0, 0
    v_pk_mov_b32 v[30:31], 0, 0
    v_pk_mov_b32 v[32:33], 0, 0
    v_pk_mov_b32 v[34:35], 0, 0
    v_pk_mov_b32 v[36:37], 0, 0
    v_pk_mov_b32 v[38:39], 0, 0
    v_pk_mov_b32 v[40:41], 0, 0
    v_pk_mov_b32 v[42:43], 0, 0
    v_pk_mov_b32 v[44:45], 0, 0
    v_pk_mov_b32 v[46:47], 0, 0
    v_pk_mov_b32 v[48:49], 0, 0
    v_pk_mov_b32 v[50:51], 0, 0
    v_pk_mov_b32 v[52:53], 0, 0
    v_pk_mov_b32 v[54:55], 0, 0
    s_mov_b32 s43, 0
    s_waitcnt lgkmcnt(0)
    s_barrier
    buffer_load_dwordx4 v[176:179], v126, s[8:11], s44 offen offset:0
    buffer_load_dwordx4 v[180:183], v127, s[8:11], s44 offen offset:0
    buffer_load_dwordx4 v[184:187], v126, s[8:11], s44 offen offset:1024
    buffer_load_dwordx4 v[188:191], v127, s[8:11], s44 offen offset:1024
    buffer_load_dwordx4 v[192:195], v126, s[8:11], s44 offen offset:2048
    buffer_load_dwordx4 v[196:199], v127, s[8:11], s44 offen offset:2048
    buffer_load_dwordx4 v[200:203], v126, s[8:11], s44 offen offset:3072
    buffer_load_dwordx4 v[204:207], v127, s[8:11], s44 offen offset:3072
    ds_read_b64_tr_b16 v[56:57], v13 offset:0
    ds_read_b64_tr_b16 v[58:59], v13 offset:2048
    ds_read_b64_tr_b16 v[60:61], v14 offset:0
    ds_read_b64_tr_b16 v[62:63], v14 offset:2048
    ds_read_b64_tr_b16 v[64:65], v15 offset:0
    ds_read_b64_tr_b16 v[66:67], v15 offset:2048
    ds_read_b64_tr_b16 v[68:69], v16 offset:0
    ds_read_b64_tr_b16 v[70:71], v16 offset:2048
    ds_read_b64_tr_b16 v[72:73], v13 offset:4096
    ds_read_b64_tr_b16 v[74:75], v13 offset:6144
    ds_read_b64_tr_b16 v[76:77], v14 offset:4096
    ds_read_b64_tr_b16 v[78:79], v14 offset:6144
    ds_read_b64_tr_b16 v[80:81], v15 offset:4096
    ds_read_b64_tr_b16 v[82:83], v15 offset:6144
    ds_read_b64_tr_b16 v[84:85], v16 offset:4096
    ds_read_b64_tr_b16 v[86:87], v16 offset:6144
    buffer_load_dwordx4 v[208:211], v128, s[8:11], s44 offen offset:0
    buffer_load_dwordx4 v[212:215], v129, s[8:11], s44 offen offset:0
    buffer_load_dwordx4 v[216:219], v128, s[8:11], s44 offen offset:1024
    buffer_load_dwordx4 v[220:223], v129, s[8:11], s44 offen offset:1024
    buffer_load_dwordx4 v[224:227], v128, s[8:11], s44 offen offset:2048
    buffer_load_dwordx4 v[228:231], v129, s[8:11], s44 offen offset:2048
    s_waitcnt vmcnt(10) lgkmcnt(0)
dm_21:
    v_mfma_f32_16x16x32_bf16 v[24:27], v[56:59], v[176:179], v[24:27]
    ds_read_b64_tr_b16 v[88:89], v13 offset:8192
    buffer_load_dwordx4 v[232:235], v128, s[8:11], s44 offen offset:3072
    v_mfma_f32_16x16x32_bf16 v[40:43], v[56:59], v[180:183], v[40:43]
    ds_read_b64_tr_b16 v[90:91], v13 offset:10240
    buffer_load_dwordx4 v[236:239], v129, s[8:11], s44 offen offset:3072
    v_mfma_f32_16x16x32_bf16 v[44:47], v[60:63], v[180:183], v[44:47]
    ds_read_b64_tr_b16 v[92:93], v14 offset:8192
    s_mov_b32 s44, s45
    v_mfma_f32_16x16x32_bf16 v[28:31], v[60:63], v[176:179], v[28:31]
    ds_read_b64_tr_b16 v[94:95], v14 offset:10240
    s_mov_b32 s45, s46
    v_mfma_f32_16x16x32_bf16 v[32:35], v[64:67], v[176:179], v[32:35]
    ds_read_b64_tr_b16 v[96:97], v15 offset:8192
    s_mov_b32 s46, s47
    v_mfma_f32_16x16x32_bf16 v[48:51], v[64:67], v[180:183], v[48:51]
    ds_read_b64_tr_b16 v[98:99], v15 offset:10240
    s_mov_b32 s47, 1048576
    v_mfma_f32_16x16x32_bf16 v[52:55], v[68:71], v[180:183], v[52:55]
    ds_read_b64_tr_b16 v[100:101], v16 offset:8192
    v_mfma_f32_16x16x32_bf16 v[36:39], v[68:71], v[176:179], v[36:39]
    ds_read_b64_tr_b16 v[102:103], v16 offset:10240
    s_waitcnt lgkmcnt(8)
    v_mfma_f32_16x16x32_bf16 v[24:27], v[72:75], v[184:187], v[24:27]
    ds_read_b64_tr_b16 v[104:105], v13 offset:12288
    buffer_load_dwordx4 v[176:179], v126, s[8:11], s44 offen offset:0
    v_mfma_f32_16x16x32_bf16 v[40:43], v[72:75], v[188:191], v[40:43]
    ds_read_b64_tr_b16 v[106:107], v13 offset:14336
    buffer_load_dwordx4 v[180:183], v127, s[8:11], s44 offen offset:0
    v_mfma_f32_16x16x32_bf16 v[44:47], v[76:79], v[188:191], v[44:47]
    ds_read_b64_tr_b16 v[108:109], v14 offset:12288
    s_waitcnt vmcnt(10)
    v_mfma_f32_16x16x32_bf16 v[28:31], v[76:79], v[184:187], v[28:31]
    ds_read_b64_tr_b16 v[110:111], v14 offset:14336
    v_mfma_f32_16x16x32_bf16 v[32:35], v[80:83], v[184:187], v[32:35]
    ds_read_b64_tr_b16 v[112:113], v15 offset:12288
    v_mfma_f32_16x16x32_bf16 v[48:51], v[80:83], v[188:191], v[48:51]
    ds_read_b64_tr_b16 v[114:115], v15 offset:14336
    v_mfma_f32_16x16x32_bf16 v[52:55], v[84:87], v[188:191], v[52:55]
    ds_read_b64_tr_b16 v[116:117], v16 offset:12288
    ds_read_b64_tr_b16 v[118:119], v16 offset:14336
    v_mfma_f32_16x16x32_bf16 v[36:39], v[84:87], v[184:187], v[36:39]
    s_waitcnt lgkmcnt(8)
    v_mfma_f32_16x16x32_bf16 v[24:27], v[88:91], v[192:195], v[24:27]
    ds_read_b64_tr_b16 v[56:57], v13 offset:16384
    buffer_load_dwordx4 v[184:187], v126, s[8:11], s44 offen offset:1024
    v_mfma_f32_16x16x32_bf16 v[40:43], v[88:91], v[196:199], v[40:43]
    ds_read_b64_tr_b16 v[58:59], v13 offset:18432
    buffer_load_dwordx4 v[188:191], v127, s[8:11], s44 offen offset:1024
    v_mfma_f32_16x16x32_bf16 v[44:47], v[92:95], v[196:199], v[44:47]
    ds_read_b64_tr_b16 v[60:61], v14 offset:16384
    v_mfma_f32_16x16x32_bf16 v[28:31], v[92:95], v[192:195], v[28:31]
    ds_read_b64_tr_b16 v[62:63], v14 offset:18432
    v_mfma_f32_16x16x32_bf16 v[32:35], v[96:99], v[192:195], v[32:35]
    ds_read_b64_tr_b16 v[64:65], v15 offset:16384
    v_mfma_f32_16x16x32_bf16 v[48:51], v[96:99], v[196:199], v[48:51]
    ds_read_b64_tr_b16 v[66:67], v15 offset:18432
    v_mfma_f32_16x16x32_bf16 v[52:55], v[100:103], v[196:199], v[52:55]
    ds_read_b64_tr_b16 v[68:69], v16 offset:16384
    v_mfma_f32_16x16x32_bf16 v[36:39], v[100:103], v[192:195], v[36:39]
    ds_read_b64_tr_b16 v[70:71], v16 offset:18432
    s_waitcnt lgkmcnt(8)
    v_mfma_f32_16x16x32_bf16 v[24:27], v[104:107], v[200:203], v[24:27]
    ds_read_b64_tr_b16 v[72:73], v13 offset:20480
    buffer_load_dwordx4 v[192:195], v126, s[8:11], s44 offen offset:2048
    v_mfma_f32_16x16x32_bf16 v[40:43], v[104:107], v[204:207], v[40:43]
    ds_read_b64_tr_b16 v[74:75], v13 offset:22528
    buffer_load_dwordx4 v[196:199], v127, s[8:11], s44 offen offset:2048
    v_mfma_f32_16x16x32_bf16 v[44:47], v[108:111], v[204:207], v[44:47]
    ds_read_b64_tr_b16 v[76:77], v14 offset:20480
    s_waitcnt vmcnt(10)
    v_mfma_f32_16x16x32_bf16 v[28:31], v[108:111], v[200:203], v[28:31]
    ds_read_b64_tr_b16 v[78:79], v14 offset:22528
    v_mfma_f32_16x16x32_bf16 v[32:35], v[112:115], v[200:203], v[32:35]
    ds_read_b64_tr_b16 v[80:81], v15 offset:20480
    v_mfma_f32_16x16x32_bf16 v[48:51], v[112:115], v[204:207], v[48:51]
    ds_read_b64_tr_b16 v[82:83], v15 offset:22528
    v_mfma_f32_16x16x32_bf16 v[52:55], v[116:119], v[204:207], v[52:55]
    ds_read_b64_tr_b16 v[84:85], v16 offset:20480
    ds_read_b64_tr_b16 v[86:87], v16 offset:22528
    v_mfma_f32_16x16x32_bf16 v[36:39], v[116:119], v[200:203], v[36:39]
    s_waitcnt lgkmcnt(8)
    v_mfma_f32_16x16x32_bf16 v[24:27], v[56:59], v[208:211], v[24:27]
    ds_read_b64_tr_b16 v[88:89], v13 offset:24576
    buffer_load_dwordx4 v[200:203], v126, s[8:11], s44 offen offset:3072
    v_mfma_f32_16x16x32_bf16 v[40:43], v[56:59], v[212:215], v[40:43]
    ds_read_b64_tr_b16 v[90:91], v13 offset:26624
    buffer_load_dwordx4 v[204:207], v127, s[8:11], s44 offen offset:3072
    v_mfma_f32_16x16x32_bf16 v[44:47], v[60:63], v[212:215], v[44:47]
    ds_read_b64_tr_b16 v[92:93], v14 offset:24576
    s_add_u32 s43, s43, 1
    v_mfma_f32_16x16x32_bf16 v[28:31], v[60:63], v[208:211], v[28:31]
    ds_read_b64_tr_b16 v[94:95], v14 offset:26624
    s_cmp_eq_u32 s43, 4
    v_mfma_f32_16x16x32_bf16 v[32:35], v[64:67], v[208:211], v[32:35]
    ds_read_b64_tr_b16 v[96:97], v15 offset:24576
    v_mfma_f32_16x16x32_bf16 v[48:51], v[64:67], v[212:215], v[48:51]
    ds_read_b64_tr_b16 v[98:99], v15 offset:26624
    v_mfma_f32_16x16x32_bf16 v[52:55], v[68:71], v[212:215], v[52:55]
    ds_read_b64_tr_b16 v[100:101], v16 offset:24576
    v_mfma_f32_16x16x32_bf16 v[36:39], v[68:71], v[208:211], v[36:39]
    ds_read_b64_tr_b16 v[102:103], v16 offset:26624
    s_waitcnt lgkmcnt(8)
    v_mfma_f32_16x16x32_bf16 v[24:27], v[72:75], v[216:219], v[24:27]
    ds_read_b64_tr_b16 v[104:105], v13 offset:28672
    buffer_load_dwordx4 v[208:211], v128, s[8:11], s44 offen offset:0
    v_mfma_f32_16x16x32_bf16 v[40:43], v[72:75], v[220:223], v[40:43]
    ds_read_b64_tr_b16 v[106:107], v13 offset:30720
    buffer_load_dwordx4 v[212:215], v129, s[8:11], s44 offen offset:0
    v_mfma_f32_16x16x32_bf16 v[44:47], v[76:79], v[220:223], v[44:47]
    ds_read_b64_tr_b16 v[108:109], v14 offset:28672
    s_waitcnt vmcnt(10)
    v_mfma_f32_16x16x32_bf16 v[28:31], v[76:79], v[216:219], v[28:31]
    ds_read_b64_tr_b16 v[110:111], v14 offset:30720
    v_add_u32 v13, 32768, v13
    v_mfma_f32_16x16x32_bf16 v[32:35], v[80:83], v[216:219], v[32:35]
    ds_read_b64_tr_b16 v[112:113], v15 offset:28672
    v_add_u32 v14, 32768, v14
    v_mfma_f32_16x16x32_bf16 v[48:51], v[80:83], v[220:223], v[48:51]
    ds_read_b64_tr_b16 v[114:115], v15 offset:30720
    v_add_u32 v15, 32768, v15
    v_mfma_f32_16x16x32_bf16 v[52:55], v[84:87], v[220:223], v[52:55]
    ds_read_b64_tr_b16 v[116:117], v16 offset:28672
    ds_read_b64_tr_b16 v[118:119], v16 offset:30720
    v_mfma_f32_16x16x32_bf16 v[36:39], v[84:87], v[216:219], v[36:39]
    v_add_u32 v16, 32768, v16
    s_waitcnt lgkmcnt(8)
    s_cbranch_scc1 dm_21x
    v_mfma_f32_16x16x32_bf16 v[24:27], v[88:91], v[224:227], v[24:27]
    ds_read_b64_tr_b16 v[56:57], v13 offset:0
    buffer_load_dwordx4 v[216:219], v128, s[8:11], s44 offen offset:1024
    v_mfma_f32_16x16x32_bf16 v[40:43], v[88:91], v[228:231], v[40:43]
    ds_read_b64_tr_b16 v[58:59], v13 offset:2048
    buffer_load_dwordx4 v[220:223], v129, s[8:11], s44 offen offset:1024
    v_mfma_f32_16x16x32_bf16 v[44:47], v[92:95], v[228:231], v[44:47]
    ds_read_b64_tr_b16 v[60:61], v14 offset:0
    v_mfma_f32_16x16x32_bf16 v[28:31], v[92:95], v[224:227], v[28:31]
    ds_read_b64_tr_b16 v[62:63], v14 offset:2048
    v_mfma_f32_16x16x32_bf16 v[32:35], v[96:99], v[224:227], v[32:35]
    ds_read_b64_tr_b16 v[64:65], v15 offset:0
    v_mfma_f32_16x16x32_bf16 v[48:51], v[96:99], v[228:231], v[48:51]
    ds_read_b64_tr_b16 v[66:67], v15 offset:2048
    v_mfma_f32_16x16x32_bf16 v[52:55], v[100:103], v[228:231], v[52:55]
    ds_read_b64_tr_b16 v[68:69], v16 offset:0
    v_mfma_f32_16x16x32_bf16 v[36:39], v[100:103], v[224:227], v[36:39]
    ds_read_b64_tr_b16 v[70:71], v16 offset:2048
    s_waitcnt lgkmcnt(8)
    v_mfma_f32_16x16x32_bf16 v[24:27], v[104:107], v[232:235], v[24:27]
    ds_read_b64_tr_b16 v[72:73], v13 offset:4096
    buffer_load_dwordx4 v[224:227], v128, s[8:11], s44 offen offset:2048
    v_mfma_f32_16x16x32_bf16 v[40:43], v[104:107], v[236:239], v[40:43]
    ds_read_b64_tr_b16 v[74:75], v13 offset:6144
    buffer_load_dwordx4 v[228:231], v129, s[8:11], s44 offen offset:2048
    v_mfma_f32_16x16x32_bf16 v[44:47], v[108:111], v[236:239], v[44:47]
    ds_read_b64_tr_b16 v[76:77], v14 offset:4096
    s_waitcnt vmcnt(10)
    v_mfma_f32_16x16x32_bf16 v[28:31], v[108:111], v[232:235], v[28:31]
    ds_read_b64_tr_b16 v[78:79], v14 offset:6144
    v_mfma_f32_16x16x32_bf16 v[32:35], v[112:115], v[232:235], v[32:35]
    ds_read_b64_tr_b16 v[80:81], v15 offset:4096
    v_mfma_f32_16x16x32_bf16 v[48:51], v[112:115], v[236:239], v[48:51]
    ds_read_b64_tr_b16 v[82:83], v15 offset:6144
    v_mfma_f32_16x16x32_bf16 v[52:55], v[116:119], v[236:239], v[52:55]
    ds_read_b64_tr_b16 v[84:85], v16 offset:4096
    ds_read_b64_tr_b16 v[86:87], v16 offset:6144
    v_mfma_f32_16x16x32_bf16 v[36:39], v[116:119], v[232:235], v[36:39]
    s_waitcnt lgkmcnt(8)
    s_branch dm_21
dm_21x:
    v_mfma_f32_16x16x32_bf16 v[24:27], v[88:91], v[224:227], v[24:27]
    s_add_u32 s24, s62, 0x400000
    s_addc_u32 s25, s63, 0
    s_mov_b32 s26, 0x7e000
    v_mfma_f32_16x16x32_bf16 v[40:43], v[88:91], v[228:231], v[40:43]
    s_mov_b32 s27, 0x20000
    s_lshr_b32 s36, s38, 1
    v_mfma_f32_16x16x32_bf16 v[44:47], v[92:95], v[228:231], v[44:47]
    s_lshr_b32 s53, s36, 3
    s_lshl_b32 s53, s53, 14
    v_mfma_f32_16x16x32_bf16 v[28:31], v[92:95], v[224:227], v[28:31]
    s_and_b32 s40, s36, 7
    s_lshl_b32 s40, s40, 10
    v_mfma_f32_16x16x32_bf16 v[32:35], v[96:99], v[224:227], v[32:35]
    s_add_u32 s40, s40, s53
    s_lshl_b32 s36, s37, 16
    s_add_u32 s40, s40, s36
    v_mfma_f32_16x16x32_bf16 v[48:51], v[96:99], v[228:231], v[48:51]
    s_add_u32 s36, s40, 0
    buffer_load_dwordx4 v[160:163], v2, s[24:27], s36 offen offset:0 sc1
    v_mfma_f32_16x16x32_bf16 v[52:55], v[100:103], v[228:231], v[52:55]
    buffer_load_dwordx4 v[164:167], v2, s[24:27], s36 offen offset:1024 sc1
    s_add_u32 s36, s40, 65536
    v_mfma_f32_16x16x32_bf16 v[36:39], v[100:103], v[224:227], v[36:39]
    buffer_load_dwordx4 v[168:171], v2, s[24:27], s36 offen offset:0 sc1
    buffer_load_dwordx4 v[172:175], v2, s[24:27], s36 offen offset:1024 sc1
    s_waitcnt lgkmcnt(0)
    s_barrier
    v_mfma_f32_16x16x32_bf16 v[24:27], v[104:107], v[232:235], v[24:27]
    s_mul_i32 s36, s35, 256
    s_add_u32 s36, s36, 163328
    v_lshlrev_b32 v6, 4, v23
    v_add_u32 v6, s36, v6
    ds_read_b128 v[56:59], v6 offset:0
    v_mfma_f32_16x16x32_bf16 v[40:43], v[104:107], v[236:239], v[40:43]
    ds_read_b128 v[60:63], v6 offset:64
    ds_read_b128 v[64:67], v6 offset:128
    ds_read_b128 v[68:71], v6 offset:192
    s_lshl_b32 s36, s37, 8
    s_add_u32 s36, s36, 160776
    v_mfma_f32_16x16x32_bf16 v[44:47], v[108:111], v[236:239], v[44:47]
    v_lshlrev_b32 v7, 4, v22
    v_add_u32 v7, s36, v7
    ds_read_b64 v[72:73], v7 offset:0
    ds_read_b64 v[74:75], v7 offset:256
    s_lshl_b32 s53, s60, 24
    v_mfma_f32_16x16x32_bf16 v[28:31], v[108:111], v[232:235], v[28:31]
    s_add_u32 s53, s53, 167772160
    s_add_u32 s16, s4, s53
    s_addc_u32 s17, s5, 0
    s_mov_b32 s18, 8388608
    s_mov_b32 s19, 0x20000
    v_mfma_f32_16x16x32_bf16 v[32:35], v[112:115], v[232:235], v[32:35]
    v_mul_u32_u24 v12, 65536, v23
    v_lshl_add_u32 v12, v22, 4, v12
    s_mul_i32 s39, s38, 131072
    s_lshl_b32 s36, s37, 8
    s_add_u32 s39, s39, s36
    v_mfma_f32_16x16x32_bf16 v[48:51], v[112:115], v[236:239], v[48:51]
    s_add_u32 s39, s39, 16384
    s_lshl_b32 s36, s28, 11
    s_add_u32 s39, s39, s36
    s_lshr_b32 s36, s29, 2
    s_xor_b32 s36, s36, s94
    v_mfma_f32_16x16x32_bf16 v[52:55], v[116:119], v[236:239], v[52:55]
    s_and_b32 s36, s36, 1
    s_lshl_b32 s36, s36, 13
    s_add_u32 s39, s39, s36
    s_add_u32 s40, s39, 262144
    v_mfma_f32_16x16x32_bf16 v[36:39], v[116:119], v[232:235], v[36:39]
    s_waitcnt lgkmcnt(0)
    v_mul_f32 v134, 0xc0135761, v73
    v_mul_f32 v135, v73, v73
    v_mul_f32 v135, v135, v134
    v_mul_f32 v135, 0x3d372713, v135
    v_rcp_f32 v73, v73
    v_mul_f32 v136, 0xc0135761, v75
    v_mul_f32 v137, v75, v75
    v_mul_f32 v137, v137, v136
    v_mul_f32 v137, 0x3d372713, v137
    v_rcp_f32 v75, v75
    v_pk_fma_f32 v[24:25], v[72:73], v[56:57], v[24:25] op_sel_hi:[0,1,1] neg_lo:[1,0,0] neg_hi:[1,0,0]
    v_pk_fma_f32 v[26:27], v[72:73], v[58:59], v[26:27] op_sel_hi:[0,1,1] neg_lo:[1,0,0] neg_hi:[1,0,0]
    v_pk_mul_f32 v[122:123], v[24:25], v[24:25]
    v_pk_mul_f32 v[124:125], v[26:27], v[26:27]
    v_pk_fma_f32 v[122:123], v[122:123], v[134:135], v[134:135] op_sel:[0,1,0] op_sel_hi:[1,1,0]
    v_pk_fma_f32 v[124:125], v[124:125], v[134:135], v[134:135] op_sel:[0,1,0] op_sel_hi:[1,1,0]
    v_pk_mul_f32 v[122:123], v[122:123], v[24:25]
    v_pk_mul_f32 v[124:125], v[124:125], v[26:27]
    v_exp_f32 v122, v122
    v_exp_f32 v123, v123
    v_exp_f32 v124, v124
    v_exp_f32 v125, v125
    v_pk_fma_f32 v[122:123], v[122:123], v[72:73], v[72:73] op_sel:[0,1,1] op_sel_hi:[1,1,1]
    v_pk_fma_f32 v[124:125], v[124:125], v[72:73], v[72:73] op_sel:[0,1,1] op_sel_hi:[1,1,1]
    v_rcp_f32 v122, v122
    v_rcp_f32 v123, v123
    v_rcp_f32 v124, v124
    v_rcp_f32 v125, v125
    v_pk_mul_f32 v[24:25], v[24:25], v[122:123]
    v_pk_mul_f32 v[26:27], v[26:27], v[124:125]
    v_pk_fma_f32 v[28:29], v[72:73], v[60:61], v[28:29] op_sel_hi:[0,1,1] neg_lo:[1,0,0] neg_hi:[1,0,0]
    v_pk_fma_f32 v[30:31], v[72:73], v[62:63], v[30:31] op_sel_hi:[0,1,1] neg_lo:[1,0,0] neg_hi:[1,0,0]
    v_pk_mul_f32 v[122:123], v[28:29], v[28:29]
    v_pk_mul_f32 v[124:125], v[30:31], v[30:31]
    v_pk_fma_f32 v[122:123], v[122:123], v[134:135], v[134:135] op_sel:[0,1,0] op_sel_hi:[1,1,0]
    v_pk_fma_f32 v[124:125], v[124:125], v[134:135], v[134:135] op_sel:[0,1,0] op_sel_hi:[1,1,0]
    v_pk_mul_f32 v[122:123], v[122:123], v[28:29]
    v_pk_mul_f32 v[124:125], v[124:125], v[30:31]
    v_exp_f32 v122, v122
    v_exp_f32 v123, v123
    v_exp_f32 v124, v124
    v_exp_f32 v125, v125
    v_pk_fma_f32 v[122:123], v[122:123], v[72:73], v[72:73] op_sel:[0,1,1] op_sel_hi:[1,1,1]
    v_pk_fma_f32 v[124:125], v[124:125], v[72:73], v[72:73] op_sel:[0,1,1] op_sel_hi:[1,1,1]
    v_rcp_f32 v122, v122
    v_rcp_f32 v123, v123
    v_rcp_f32 v124, v124
    v_rcp_f32 v125, v125
    v_pk_mul_f32 v[28:29], v[28:29], v[122:123]
    v_pk_mul_f32 v[30:31], v[30:31], v[124:125]
    v_cvt_pk_bf16_f32 v24, v24, v25
    v_cvt_pk_bf16_f32 v25, v26, v27
    v_cvt_pk_bf16_f32 v26, v28, v29
    v_cvt_pk_bf16_f32 v27, v30, v31
    buffer_store_dwordx4 v[24:27], v12, s[16:19], s39 offen offset:0 sc1
    v_pk_fma_f32 v[40:41], v[74:75], v[56:57], v[40:41] op_sel_hi:[0,1,1] neg_lo:[1,0,0] neg_hi:[1,0,0]
    v_pk_fma_f32 v[42:43], v[74:75], v[58:59], v[42:43] op_sel_hi:[0,1,1] neg_lo:[1,0,0] neg_hi:[1,0,0]
    v_pk_mul_f32 v[122:123], v[40:41], v[40:41]
    v_pk_mul_f32 v[124:125], v[42:43], v[42:43]
    v_pk_fma_f32 v[122:123], v[122:123], v[136:137], v[136:137] op_sel:[0,1,0] op_sel_hi:[1,1,0]
    v_pk_fma_f32 v[124:125], v[124:125], v[136:137], v[136:137] op_sel:[0,1,0] op_sel_hi:[1,1,0]
    v_pk_mul_f32 v[122:123], v[122:123], v[40:41]
    v_pk_mul_f32 v[124:125], v[124:125], v[42:43]
    v_exp_f32 v122, v122
    v_exp_f32 v123, v123
    v_exp_f32 v124, v124
    v_exp_f32 v125, v125
    v_pk_fma_f32 v[122:123], v[122:123], v[74:75], v[74:75] op_sel:[0,1,1] op_sel_hi:[1,1,1]
    v_pk_fma_f32 v[124:125], v[124:125], v[74:75], v[74:75] op_sel:[0,1,1] op_sel_hi:[1,1,1]
    v_rcp_f32 v122, v122
    v_rcp_f32 v123, v123
    v_rcp_f32 v124, v124
    v_rcp_f32 v125, v125
    v_pk_mul_f32 v[40:41], v[40:41], v[122:123]
    v_pk_mul_f32 v[42:43], v[42:43], v[124:125]
    v_pk_fma_f32 v[44:45], v[74:75], v[60:61], v[44:45] op_sel_hi:[0,1,1] neg_lo:[1,0,0] neg_hi:[1,0,0]
    v_pk_fma_f32 v[46:47], v[74:75], v[62:63], v[46:47] op_sel_hi:[0,1,1] neg_lo:[1,0,0] neg_hi:[1,0,0]
    v_pk_mul_f32 v[122:123], v[44:45], v[44:45]
    v_pk_mul_f32 v[124:125], v[46:47], v[46:47]
    v_pk_fma_f32 v[122:123], v[122:123], v[136:137], v[136:137] op_sel:[0,1,0] op_sel_hi:[1,1,0]
    v_pk_fma_f32 v[124:125], v[124:125], v[136:137], v[136:137] op_sel:[0,1,0] op_sel_hi:[1,1,0]
    v_pk_mul_f32 v[122:123], v[122:123], v[44:45]
    v_pk_mul_f32 v[124:125], v[124:125], v[46:47]
    v_exp_f32 v122, v122
    v_exp_f32 v123, v123
    v_exp_f32 v124, v124
    v_exp_f32 v125, v125
    v_pk_fma_f32 v[122:123], v[122:123], v[74:75], v[74:75] op_sel:[0,1,1] op_sel_hi:[1,1,1]
    v_pk_fma_f32 v[124:125], v[124:125], v[74:75], v[74:75] op_sel:[0,1,1] op_sel_hi:[1,1,1]
    v_rcp_f32 v122, v122
    v_rcp_f32 v123, v123
    v_rcp_f32 v124, v124
    v_rcp_f32 v125, v125
    v_pk_mul_f32 v[44:45], v[44:45], v[122:123]
    v_pk_mul_f32 v[46:47], v[46:47], v[124:125]
    v_cvt_pk_bf16_f32 v40, v40, v41
    v_cvt_pk_bf16_f32 v41, v42, v43
    v_cvt_pk_bf16_f32 v42, v44, v45
    v_cvt_pk_bf16_f32 v43, v46, v47
    buffer_store_dwordx4 v[40:43], v12, s[16:19], s39 offen offset:256 sc1
    v_pk_fma_f32 v[32:33], v[72:73], v[64:65], v[32:33] op_sel_hi:[0,1,1] neg_lo:[1,0,0] neg_hi:[1,0,0]
    v_pk_fma_f32 v[34:35], v[72:73], v[66:67], v[34:35] op_sel_hi:[0,1,1] neg_lo:[1,0,0] neg_hi:[1,0,0]
    v_pk_mul_f32 v[122:123], v[32:33], v[32:33]
    v_pk_mul_f32 v[124:125], v[34:35], v[34:35]
    v_pk_fma_f32 v[122:123], v[122:123], v[134:135], v[134:135] op_sel:[0,1,0] op_sel_hi:[1,1,0]
    v_pk_fma_f32 v[124:125], v[124:125], v[134:135], v[134:135] op_sel:[0,1,0] op_sel_hi:[1,1,0]
    v_pk_mul_f32 v[122:123], v[122:123], v[32:33]
    v_pk_mul_f32 v[124:125], v[124:125], v[34:35]
    v_exp_f32 v122, v122
    v_exp_f32 v123, v123
    v_exp_f32 v124, v124
    v_exp_f32 v125, v125
    v_pk_fma_f32 v[122:123], v[122:123], v[72:73], v[72:73] op_sel:[0,1,1] op_sel_hi:[1,1,1]
    v_pk_fma_f32 v[124:125], v[124:125], v[72:73], v[72:73] op_sel:[0,1,1] op_sel_hi:[1,1,1]
    v_rcp_f32 v122, v122
    v_rcp_f32 v123, v123
    v_rcp_f32 v124, v124
    v_rcp_f32 v125, v125
    v_pk_mul_f32 v[32:33], v[32:33], v[122:123]
    v_pk_mul_f32 v[34:35], v[34:35], v[124:125]
    v_pk_fma_f32 v[36:37], v[72:73], v[68:69], v[36:37] op_sel_hi:[0,1,1] neg_lo:[1,0,0] neg_hi:[1,0,0]
    v_pk_fma_f32 v[38:39], v[72:73], v[70:71], v[38:39] op_sel_hi:[0,1,1] neg_lo:[1,0,0] neg_hi:[1,0,0]
    v_pk_mul_f32 v[122:123], v[36:37], v[36:37]
    v_pk_mul_f32 v[124:125], v[38:39], v[38:39]
    v_pk_fma_f32 v[122:123], v[122:123], v[134:135], v[134:135] op_sel:[0,1,0] op_sel_hi:[1,1,0]
    v_pk_fma_f32 v[124:125], v[124:125], v[134:135], v[134:135] op_sel:[0,1,0] op_sel_hi:[1,1,0]
    v_pk_mul_f32 v[122:123], v[122:123], v[36:37]
    v_pk_mul_f32 v[124:125], v[124:125], v[38:39]
    v_exp_f32 v122, v122
    v_exp_f32 v123, v123
    v_exp_f32 v124, v124
    v_exp_f32 v125, v125
    v_pk_fma_f32 v[122:123], v[122:123], v[72:73], v[72:73] op_sel:[0,1,1] op_sel_hi:[1,1,1]
    v_pk_fma_f32 v[124:125], v[124:125], v[72:73], v[72:73] op_sel:[0,1,1] op_sel_hi:[1,1,1]
    v_rcp_f32 v122, v122
    v_rcp_f32 v123, v123
    v_rcp_f32 v124, v124
    v_rcp_f32 v125, v125
    v_pk_mul_f32 v[36:37], v[36:37], v[122:123]
    v_pk_mul_f32 v[38:39], v[38:39], v[124:125]
    v_cvt_pk_bf16_f32 v32, v32, v33
    v_cvt_pk_bf16_f32 v33, v34, v35
    v_cvt_pk_bf16_f32 v34, v36, v37
    v_cvt_pk_bf16_f32 v35, v38, v39
    buffer_store_dwordx4 v[32:35], v12, s[16:19], s40 offen offset:0 sc1
    v_pk_fma_f32 v[48:49], v[74:75], v[64:65], v[48:49] op_sel_hi:[0,1,1] neg_lo:[1,0,0] neg_hi:[1,0,0]
    v_pk_fma_f32 v[50:51], v[74:75], v[66:67], v[50:51] op_sel_hi:[0,1,1] neg_lo:[1,0,0] neg_hi:[1,0,0]
    v_pk_mul_f32 v[122:123], v[48:49], v[48:49]
    v_pk_mul_f32 v[124:125], v[50:51], v[50:51]
    v_pk_fma_f32 v[122:123], v[122:123], v[136:137], v[136:137] op_sel:[0,1,0] op_sel_hi:[1,1,0]
    v_pk_fma_f32 v[124:125], v[124:125], v[136:137], v[136:137] op_sel:[0,1,0] op_sel_hi:[1,1,0]
    v_pk_mul_f32 v[122:123], v[122:123], v[48:49]
    v_pk_mul_f32 v[124:125], v[124:125], v[50:51]
    v_exp_f32 v122, v122
    v_exp_f32 v123, v123
    v_exp_f32 v124, v124
    v_exp_f32 v125, v125
    v_pk_fma_f32 v[122:123], v[122:123], v[74:75], v[74:75] op_sel:[0,1,1] op_sel_hi:[1,1,1]
    v_pk_fma_f32 v[124:125], v[124:125], v[74:75], v[74:75] op_sel:[0,1,1] op_sel_hi:[1,1,1]
    v_rcp_f32 v122, v122
    v_rcp_f32 v123, v123
    v_rcp_f32 v124, v124
    v_rcp_f32 v125, v125
    v_pk_mul_f32 v[48:49], v[48:49], v[122:123]
    v_pk_mul_f32 v[50:51], v[50:51], v[124:125]
    v_pk_fma_f32 v[52:53], v[74:75], v[68:69], v[52:53] op_sel_hi:[0,1,1] neg_lo:[1,0,0] neg_hi:[1,0,0]
    v_pk_fma_f32 v[54:55], v[74:75], v[70:71], v[54:55] op_sel_hi:[0,1,1] neg_lo:[1,0,0] neg_hi:[1,0,0]
    v_pk_mul_f32 v[122:123], v[52:53], v[52:53]
    v_pk_mul_f32 v[124:125], v[54:55], v[54:55]
    v_pk_fma_f32 v[122:123], v[122:123], v[136:137], v[136:137] op_sel:[0,1,0] op_sel_hi:[1,1,0]
    v_pk_fma_f32 v[124:125], v[124:125], v[136:137], v[136:137] op_sel:[0,1,0] op_sel_hi:[1,1,0]
    v_pk_mul_f32 v[122:123], v[122:123], v[52:53]
    v_pk_mul_f32 v[124:125], v[124:125], v[54:55]
    v_exp_f32 v122, v122
    v_exp_f32 v123, v123
    v_exp_f32 v124, v124
    v_exp_f32 v125, v125
    v_pk_fma_f32 v[122:123], v[122:123], v[74:75], v[74:75] op_sel:[0,1,1] op_sel_hi:[1,1,1]
    v_pk_fma_f32 v[124:125], v[124:125], v[74:75], v[74:75] op_sel:[0,1,1] op_sel_hi:[1,1,1]
    v_rcp_f32 v122, v122
    v_rcp_f32 v123, v123
    v_rcp_f32 v124, v124
    v_rcp_f32 v125, v125
    v_pk_mul_f32 v[52:53], v[52:53], v[122:123]
    v_pk_mul_f32 v[54:55], v[54:55], v[124:125]
    v_cvt_pk_bf16_f32 v48, v48, v49
    v_cvt_pk_bf16_f32 v49, v50, v51
    v_cvt_pk_bf16_f32 v50, v52, v53
    v_cvt_pk_bf16_f32 v51, v54, v55
    buffer_store_dwordx4 v[48:51], v12, s[16:19], s40 offen offset:256 sc1
    s_add_u32 s53, s55, 256
    s_and_b32 s54, s29, 4
    s_lshl_b32 s54, s54, 5
    s_add_u32 s53, s53, s54
    v_mov_b32 v8, 1
    v_mov_b32 v9, 162816
    v_mov_b32 v11, 0
    s_mov_b64 exec, 1
    s_waitcnt vmcnt(0)
    ds_add_rtn_u32 v10, v9, v8
    s_waitcnt lgkmcnt(0)
    v_readfirstlane_b32 s54, v10
    s_nop 0
    s_and_b32 s54, s54, 3
    s_cmp_lg_u32 s54, 3
    s_cbranch_scc1 pub_22
    buffer_atomic_add v8, v11, s[56:59], s53 offen sc1
    v_mov_b32 v9, 162872
    ds_add_u32 v9, v8
pub_22:
    s_mov_b64 exec, -1
    s_mov_b32 s34, s30
    s_mov_b32 s35, 0
    v_and_b32 v22, 15, v1
    v_lshrrev_b32 v23, 4, v1
    s_mul_i32 s37, s34, 2
    s_mul_i32 s38, s29, 4
    s_mul_i32 s36, s35, 4
    s_add_u32 s38, s38, s36
    s_lshr_b32 s36, s38, 1
    s_lshr_b32 s53, s36, 3
    s_lshl_b32 s53, s53, 14
    s_and_b32 s39, s36, 7
    s_lshl_b32 s39, s39, 10
    s_add_u32 s39, s39, s53
    s_lshl_b32 s36, s37, 16
    s_add_u32 s39, s39, s36
    s_lshl_b32 s53, s60, 24
    s_add_u32 s53, s53, 167772160
    s_add_u32 s8, s4, s53
    s_addc_u32 s9, s5, 0
    s_mov_b32 s10, 8388608
    s_mov_b32 s11, 0x20000
    v_mul_u32_u24 v126, 65536, v23
    v_lshl_add_u32 v126, v22, 4, v126
    v_add_u32 v127, 262144, v126
    v_add_u32 v128, 524288, v126
    v_add_u32 v129, 786432, v126
    v_add_u32 v130, 1048576, v126
    v_add_u32 v131, 1310720, v126
    v_add_u32 v132, 1572864, v126
    v_add_u32 v133, 1835008, v126
    s_lshr_b32 s36, s67, 2
    s_add_u32 s36, s36, 0
    s_and_b32 s36, s36, 3
    s_mul_i32 s44, s36, 2097152
    s_xor_b32 s53, s36, s94
    s_and_b32 s53, s53, 1
    s_lshl_b32 s53, s53, 13
    s_add_u32 s44, s44, s53
    s_lshr_b32 s53, s36, 1
    s_lshl_b32 s53, s53, 4
    s_add_u32 s53, s53, 16
    s_sub_u32 s54, 0, s53
    s_bitcmp1_b32 s36, 0
    s_cselect_b32 s53, s53, s54
    s_add_u32 s44, s44, s53
    s_lshl_b32 s36, s28, 2
    s_add_u32 s36, s36, s34
    s_lshl_b32 s36, s36, 9
    s_add_u32 s36, s36, 16384
    s_add_u32 s44, s44, s36
    s_lshr_b32 s36, s67, 2
    s_add_u32 s36, s36, 1
    s_and_b32 s36, s36, 3
    s_mul_i32 s45, s36, 2097152
    s_xor_b32 s53, s36, s94
    s_and_b32 s53, s53, 1
    s_lshl_b32 s53, s53, 13
    s_add_u32 s45, s45, s53
    s_lshr_b32 s53, s36, 1
    s_lshl_b32 s53, s53, 4
    s_add_u32 s53, s53, 16
    s_sub_u32 s54, 0, s53
    s_bitcmp1_b32 s36, 0
    s_cselect_b32 s53, s53, s54
    s_add_u32 s45, s45, s53
    s_lshl_b32 s36, s28, 2
    s_add_u32 s36, s36, s34
    s_lshl_b32 s36, s36, 9
    s_add_u32 s36, s36, 16384
    s_add_u32 s45, s45, s36
    s_lshr_b32 s36, s67, 2
    s_add_u32 s36, s36, 2
    s_and_b32 s36, s36, 3
    s_mul_i32 s46, s36, 2097152
    s_xor_b32 s53, s36, s94
    s_and_b32 s53, s53, 1
    s_lshl_b32 s53, s53, 13
    s_add_u32 s46, s46, s53
    s_lshr_b32 s53, s36, 1
    s_lshl_b32 s53, s53, 4
    s_add_u32 s53, s53, 16
    s_sub_u32 s54, 0, s53
    s_bitcmp1_b32 s36, 0
    s_cselect_b32 s53, s53, s54
    s_add_u32 s46, s46, s53
    s_lshl_b32 s36, s28, 2
    s_add_u32 s36, s36, s34
    s_lshl_b32 s36, s36, 9
    s_add_u32 s36, s36, 16384
    s_add_u32 s46, s46, s36
    s_lshr_b32 s36, s67, 2
    s_add_u32 s36, s36, 3
    s_and_b32 s36, s36, 3
    s_mul_i32 s47, s36, 2097152
    s_xor_b32 s53, s36, s94
    s_and_b32 s53, s53, 1
    s_lshl_b32 s53, s53, 13
    s_add_u32 s47, s47, s53
    s_lshr_b32 s53, s36, 1
    s_lshl_b32 s53, s53, 4
    s_add_u32 s53, s53, 16
    s_sub_u32 s54, 0, s53
    s_bitcmp1_b32 s36, 0
    s_cselect_b32 s53, s53, s54
    s_add_u32 s47, s47, s53
    s_lshl_b32 s36, s28, 2
    s_add_u32 s36, s36, s34
    s_lshl_b32 s36, s36, 9
    s_add_u32 s36, s36, 16384
    s_add_u32 s47, s47, s36
    v_lshrrev_b32 v6, 2, v1
    v_mul_u32_u24 v13, 128, v6
    v_and_b32 v7, 3, v1
    v_lshl_add_u32 v13, v7, 3, v13
    v_add_u32 v13, 0, v13
    v_bfe_u32 v6, v6, 1, 2
    s_mul_i32 s36, s35, 4
    s_add_u32 s36, s36, 3
    v_xor_b32 v7, s36, v6
    v_lshl_add_u32 v16, v7, 5, v13
    s_mul_i32 s36, s35, 4
    s_add_u32 s36, s36, 2
    v_xor_b32 v7, s36, v6
    v_lshl_add_u32 v15, v7, 5, v13
    s_mul_i32 s36, s35, 4
    s_add_u32 s36, s36, 1
    v_xor_b32 v7, s36, v6
    v_lshl_add_u32 v14, v7, 5, v13
    s_mul_i32 s36, s35, 4
    s_add_u32 s36, s36, 0
    v_xor_b32 v7, s36, v6
    v_lshl_add_u32 v13, v7, 5, v13
    s_lshl_b32 s36, s37, 8
    s_add_u32 s36, s36, 160768
    v_lshlrev_b32 v7, 4, v22
    v_add_u32 v7, s36, v7
    ds_read_b64 v[56:57], v7 offset:0
    ds_read_b64 v[58:59], v7 offset:256
    s_waitcnt lgkmcnt(0)
    v_lshlrev_b32 v24, 16, v160
    v_and_b32 v25, 0xffff0000, v160
    v_pk_add_f32 v[24:25], v[24:25], v[56:57] op_sel_hi:[1,0] neg_lo:[0,1] neg_hi:[0,1]
    v_pk_mul_f32 v[24:25], v[24:25], v[56:57] op_sel:[0,1] op_sel_hi:[1,1]
    v_lshlrev_b32 v26, 16, v161
    v_and_b32 v27, 0xffff0000, v161
    v_pk_add_f32 v[26:27], v[26:27], v[56:57] op_sel_hi:[1,0] neg_lo:[0,1] neg_hi:[0,1]
    v_pk_mul_f32 v[26:27], v[26:27], v[56:57] op_sel:[0,1] op_sel_hi:[1,1]
    v_lshlrev_b32 v28, 16, v162
    v_and_b32 v29, 0xffff0000, v162
    v_pk_add_f32 v[28:29], v[28:29], v[56:57] op_sel_hi:[1,0] neg_lo:[0,1] neg_hi:[0,1]
    v_pk_mul_f32 v[28:29], v[28:29], v[56:57] op_sel:[0,1] op_sel_hi:[1,1]
    v_lshlrev_b32 v30, 16, v163
    v_and_b32 v31, 0xffff0000, v163
    v_pk_add_f32 v[30:31], v[30:31], v[56:57] op_sel_hi:[1,0] neg_lo:[0,1] neg_hi:[0,1]
    v_pk_mul_f32 v[30:31], v[30:31], v[56:57] op_sel:[0,1] op_sel_hi:[1,1]
    v_lshlrev_b32 v32, 16, v164
    v_and_b32 v33, 0xffff0000, v164
    v_pk_add_f32 v[32:33], v[32:33], v[56:57] op_sel_hi:[1,0] neg_lo:[0,1] neg_hi:[0,1]
    v_pk_mul_f32 v[32:33], v[32:33], v[56:57] op_sel:[0,1] op_sel_hi:[1,1]
    v_lshlrev_b32 v34, 16, v165
    v_and_b32 v35, 0xffff0000, v165
    v_pk_add_f32 v[34:35], v[34:35], v[56:57] op_sel_hi:[1,0] neg_lo:[0,1] neg_hi:[0,1]
    v_pk_mul_f32 v[34:35], v[34:35], v[56:57] op_sel:[0,1] op_sel_hi:[1,1]
    v_lshlrev_b32 v36, 16, v166
    v_and_b32 v37, 0xffff0000, v166
    v_pk_add_f32 v[36:37], v[36:37], v[56:57] op_sel_hi:[1,0] neg_lo:[0,1] neg_hi:[0,1]
    v_pk_mul_f32 v[36:37], v[36:37], v[56:57] op_sel:[0,1] op_sel_hi:[1,1]
    v_lshlrev_b32 v38, 16, v167
    v_and_b32 v39, 0xffff0000, v167
    v_pk_add_f32 v[38:39], v[38:39], v[56:57] op_sel_hi:[1,0] neg_lo:[0,1] neg_hi:[0,1]
    v_pk_mul_f32 v[38:39], v[38:39], v[56:57] op_sel:[0,1] op_sel_hi:[1,1]
    v_lshlrev_b32 v40, 16, v168
    v_and_b32 v41, 0xffff0000, v168
    v_pk_add_f32 v[40:41], v[40:41], v[58:59] op_sel_hi:[1,0] neg_lo:[0,1] neg_hi:[0,1]
    v_pk_mul_f32 v[40:41], v[40:41], v[58:59] op_sel:[0,1] op_sel_hi:[1,1]
    v_lshlrev_b32 v42, 16, v169
    v_and_b32 v43, 0xffff0000, v169
    v_pk_add_f32 v[42:43], v[42:43], v[58:59] op_sel_hi:[1,0] neg_lo:[0,1] neg_hi:[0,1]
    v_pk_mul_f32 v[42:43], v[42:43], v[58:59] op_sel:[0,1] op_sel_hi:[1,1]
    v_lshlrev_b32 v44, 16, v170
    v_and_b32 v45, 0xffff0000, v170
    v_pk_add_f32 v[44:45], v[44:45], v[58:59] op_sel_hi:[1,0] neg_lo:[0,1] neg_hi:[0,1]
    v_pk_mul_f32 v[44:45], v[44:45], v[58:59] op_sel:[0,1] op_sel_hi:[1,1]
    v_lshlrev_b32 v46, 16, v171
    v_and_b32 v47, 0xffff0000, v171
    v_pk_add_f32 v[46:47], v[46:47], v[58:59] op_sel_hi:[1,0] neg_lo:[0,1] neg_hi:[0,1]
    v_pk_mul_f32 v[46:47], v[46:47], v[58:59] op_sel:[0,1] op_sel_hi:[1,1]
    v_lshlrev_b32 v48, 16, v172
    v_and_b32 v49, 0xffff0000, v172
    v_pk_add_f32 v[48:49], v[48:49], v[58:59] op_sel_hi:[1,0] neg_lo:[0,1] neg_hi:[0,1]
    v_pk_mul_f32 v[48:49], v[48:49], v[58:59] op_sel:[0,1] op_sel_hi:[1,1]
    v_lshlrev_b32 v50, 16, v173
    v_and_b32 v51, 0xffff0000, v173
    v_pk_add_f32 v[50:51], v[50:51], v[58:59] op_sel_hi:[1,0] neg_lo:[0,1] neg_hi:[0,1]
    v_pk_mul_f32 v[50:51], v[50:51], v[58:59] op_sel:[0,1] op_sel_hi:[1,1]
    v_lshlrev_b32 v52, 16, v174
    v_and_b32 v53, 0xffff0000, v174
    v_pk_add_f32 v[52:53], v[52:53], v[58:59] op_sel_hi:[1,0] neg_lo:[0,1] neg_hi:[0,1]
    v_pk_mul_f32 v[52:53], v[52:53], v[58:59] op_sel:[0,1] op_sel_hi:[1,1]
    v_lshlrev_b32 v54, 16, v175
    v_and_b32 v55, 0xffff0000, v175
    v_pk_add_f32 v[54:55], v[54:55], v[58:59] op_sel_hi:[1,0] neg_lo:[0,1] neg_hi:[0,1]
    v_pk_mul_f32 v[54:55], v[54:55], v[58:59] op_sel:[0,1] op_sel_hi:[1,1]
    s_mov_b32 s43, 0
    s_waitcnt lgkmcnt(0)
    s_barrier
    buffer_load_dwordx4 v[176:179], v126, s[8:11], s44 offen offset:0
    buffer_load_dwordx4 v[180:183], v126, s[8:11], s44 offen offset:256
    buffer_load_dwordx4 v[184:187], v127, s[8:11], s44 offen offset:0
    buffer_load_dwordx4 v[188:191], v127, s[8:11], s44 offen offset:256
    buffer_load_dwordx4 v[192:195], v128, s[8:11], s44 offen offset:0
    buffer_load_dwordx4 v[196:199], v128, s[8:11], s44 offen offset:256
    buffer_load_dwordx4 v[200:203], v129, s[8:11], s44 offen offset:0
    buffer_load_dwordx4 v[204:207], v129, s[8:11], s44 offen offset:256
    ds_read_b64_tr_b16 v[56:57], v13 offset:0
    ds_read_b64_tr_b16 v[58:59], v13 offset:2048
    ds_read_b64_tr_b16 v[60:61], v14 offset:0
    ds_read_b64_tr_b16 v[62:63], v14 offset:2048
    ds_read_b64_tr_b16 v[64:65], v15 offset:0
    ds_read_b64_tr_b16 v[66:67], v15 offset:2048
    ds_read_b64_tr_b16 v[68:69], v16 offset:0
    ds_read_b64_tr_b16 v[70:71], v16 offset:2048
    ds_read_b64_tr_b16 v[72:73], v13 offset:4096
    ds_read_b64_tr_b16 v[74:75], v13 offset:6144
    ds_read_b64_tr_b16 v[76:77], v14 offset:4096
    ds_read_b64_tr_b16 v[78:79], v14 offset:6144
    ds_read_b64_tr_b16 v[80:81], v15 offset:4096
    ds_read_b64_tr_b16 v[82:83], v15 offset:6144
    ds_read_b64_tr_b16 v[84:85], v16 offset:4096
    ds_read_b64_tr_b16 v[86:87], v16 offset:6144
    buffer_load_dwordx4 v[208:211], v130, s[8:11], s44 offen offset:0
    buffer_load_dwordx4 v[212:215], v130, s[8:11], s44 offen offset:256
    buffer_load_dwordx4 v[216:219], v131, s[8:11], s44 offen offset:0
    buffer_load_dwordx4 v[220:223], v131, s[8:11], s44 offen offset:256
    buffer_load_dwordx4 v[224:227], v132, s[8:11], s44 offen offset:0
    buffer_load_dwordx4 v[228:231], v132, s[8:11], s44 offen offset:256
    s_waitcnt vmcnt(10) lgkmcnt(0)
dm_23:
    v_mfma_f32_16x16x32_bf16 v[24:27], v[56:59], v[176:179], v[24:27]
    ds_read_b64_tr_b16 v[88:89], v13 offset:8192
    buffer_load_dwordx4 v[232:235], v133, s[8:11], s44 offen offset:0
    v_mfma_f32_16x16x32_bf16 v[40:43], v[56:59], v[180:183], v[40:43]
    ds_read_b64_tr_b16 v[90:91], v13 offset:10240
    buffer_load_dwordx4 v[236:239], v133, s[8:11], s44 offen offset:256
    v_mfma_f32_16x16x32_bf16 v[44:47], v[60:63], v[180:183], v[44:47]
    ds_read_b64_tr_b16 v[92:93], v14 offset:8192
    s_mov_b32 s44, s45
    v_mfma_f32_16x16x32_bf16 v[28:31], v[60:63], v[176:179], v[28:31]
    ds_read_b64_tr_b16 v[94:95], v14 offset:10240
    s_mov_b32 s45, s46
    v_mfma_f32_16x16x32_bf16 v[32:35], v[64:67], v[176:179], v[32:35]
    ds_read_b64_tr_b16 v[96:97], v15 offset:8192
    s_mov_b32 s46, s47
    v_mfma_f32_16x16x32_bf16 v[48:51], v[64:67], v[180:183], v[48:51]
    ds_read_b64_tr_b16 v[98:99], v15 offset:10240
    s_mov_b32 s47, 8388608
    v_mfma_f32_16x16x32_bf16 v[52:55], v[68:71], v[180:183], v[52:55]
    ds_read_b64_tr_b16 v[100:101], v16 offset:8192
    v_mfma_f32_16x16x32_bf16 v[36:39], v[68:71], v[176:179], v[36:39]
    ds_read_b64_tr_b16 v[102:103], v16 offset:10240
    s_waitcnt lgkmcnt(8)
    v_mfma_f32_16x16x32_bf16 v[24:27], v[72:75], v[184:187], v[24:27]
    ds_read_b64_tr_b16 v[104:105], v13 offset:12288
    buffer_load_dwordx4 v[176:179], v126, s[8:11], s44 offen offset:0
    v_mfma_f32_16x16x32_bf16 v[40:43], v[72:75], v[188:191], v[40:43]
    ds_read_b64_tr_b16 v[106:107], v13 offset:14336
    buffer_load_dwordx4 v[180:183], v126, s[8:11], s44 offen offset:256
    v_mfma_f32_16x16x32_bf16 v[44:47], v[76:79], v[188:191], v[44:47]
    ds_read_b64_tr_b16 v[108:109], v14 offset:12288
    s_waitcnt vmcnt(10)
    v_mfma_f32_16x16x32_bf16 v[28:31], v[76:79], v[184:187], v[28:31]
    ds_read_b64_tr_b16 v[110:111], v14 offset:14336
    v_mfma_f32_16x16x32_bf16 v[32:35], v[80:83], v[184:187], v[32:35]
    ds_read_b64_tr_b16 v[112:113], v15 offset:12288
    v_mfma_f32_16x16x32_bf16 v[48:51], v[80:83], v[188:191], v[48:51]
    ds_read_b64_tr_b16 v[114:115], v15 offset:14336
    v_mfma_f32_16x16x32_bf16 v[52:55], v[84:87], v[188:191], v[52:55]
    ds_read_b64_tr_b16 v[116:117], v16 offset:12288
    ds_read_b64_tr_b16 v[118:119], v16 offset:14336
    v_mfma_f32_16x16x32_bf16 v[36:39], v[84:87], v[184:187], v[36:39]
    s_waitcnt lgkmcnt(8)
    v_mfma_f32_16x16x32_bf16 v[24:27], v[88:91], v[192:195], v[24:27]
    ds_read_b64_tr_b16 v[56:57], v13 offset:16384
    buffer_load_dwordx4 v[184:187], v127, s[8:11], s44 offen offset:0
    v_mfma_f32_16x16x32_bf16 v[40:43], v[88:91], v[196:199], v[40:43]
    ds_read_b64_tr_b16 v[58:59], v13 offset:18432
    buffer_load_dwordx4 v[188:191], v127, s[8:11], s44 offen offset:256
    v_mfma_f32_16x16x32_bf16 v[44:47], v[92:95], v[196:199], v[44:47]
    ds_read_b64_tr_b16 v[60:61], v14 offset:16384
    v_mfma_f32_16x16x32_bf16 v[28:31], v[92:95], v[192:195], v[28:31]
    ds_read_b64_tr_b16 v[62:63], v14 offset:18432
    v_mfma_f32_16x16x32_bf16 v[32:35], v[96:99], v[192:195], v[32:35]
    ds_read_b64_tr_b16 v[64:65], v15 offset:16384
    v_mfma_f32_16x16x32_bf16 v[48:51], v[96:99], v[196:199], v[48:51]
    ds_read_b64_tr_b16 v[66:67], v15 offset:18432
    v_mfma_f32_16x16x32_bf16 v[52:55], v[100:103], v[196:199], v[52:55]
    ds_read_b64_tr_b16 v[68:69], v16 offset:16384
    v_mfma_f32_16x16x32_bf16 v[36:39], v[100:103], v[192:195], v[36:39]
    ds_read_b64_tr_b16 v[70:71], v16 offset:18432
    s_waitcnt lgkmcnt(8)
    v_mfma_f32_16x16x32_bf16 v[24:27], v[104:107], v[200:203], v[24:27]
    ds_read_b64_tr_b16 v[72:73], v13 offset:20480
    buffer_load_dwordx4 v[192:195], v128, s[8:11], s44 offen offset:0
    v_mfma_f32_16x16x32_bf16 v[40:43], v[104:107], v[204:207], v[40:43]
    ds_read_b64_tr_b16 v[74:75], v13 offset:22528
    buffer_load_dwordx4 v[196:199], v128, s[8:11], s44 offen offset:256
    v_mfma_f32_16x16x32_bf16 v[44:47], v[108:111], v[204:207], v[44:47]
    ds_read_b64_tr_b16 v[76:77], v14 offset:20480
    s_waitcnt vmcnt(10)
    v_mfma_f32_16x16x32_bf16 v[28:31], v[108:111], v[200:203], v[28:31]
    ds_read_b64_tr_b16 v[78:79], v14 offset:22528
    v_mfma_f32_16x16x32_bf16 v[32:35], v[112:115], v[200:203], v[32:35]
    ds_read_b64_tr_b16 v[80:81], v15 offset:20480
    v_mfma_f32_16x16x32_bf16 v[48:51], v[112:115], v[204:207], v[48:51]
    ds_read_b64_tr_b16 v[82:83], v15 offset:22528
    v_mfma_f32_16x16x32_bf16 v[52:55], v[116:119], v[204:207], v[52:55]
    ds_read_b64_tr_b16 v[84:85], v16 offset:20480
    ds_read_b64_tr_b16 v[86:87], v16 offset:22528
    v_mfma_f32_16x16x32_bf16 v[36:39], v[116:119], v[200:203], v[36:39]
    s_waitcnt lgkmcnt(8)
    v_mfma_f32_16x16x32_bf16 v[24:27], v[56:59], v[208:211], v[24:27]
    ds_read_b64_tr_b16 v[88:89], v13 offset:24576
    buffer_load_dwordx4 v[200:203], v129, s[8:11], s44 offen offset:0
    v_mfma_f32_16x16x32_bf16 v[40:43], v[56:59], v[212:215], v[40:43]
    ds_read_b64_tr_b16 v[90:91], v13 offset:26624
    buffer_load_dwordx4 v[204:207], v129, s[8:11], s44 offen offset:256
    v_mfma_f32_16x16x32_bf16 v[44:47], v[60:63], v[212:215], v[44:47]
    ds_read_b64_tr_b16 v[92:93], v14 offset:24576
    s_add_u32 s43, s43, 1
    v_mfma_f32_16x16x32_bf16 v[28:31], v[60:63], v[208:211], v[28:31]
    ds_read_b64_tr_b16 v[94:95], v14 offset:26624
    s_cmp_eq_u32 s43, 4
    v_mfma_f32_16x16x32_bf16 v[32:35], v[64:67], v[208:211], v[32:35]
    ds_read_b64_tr_b16 v[96:97], v15 offset:24576
    v_mfma_f32_16x16x32_bf16 v[48:51], v[64:67], v[212:215], v[48:51]
    ds_read_b64_tr_b16 v[98:99], v15 offset:26624
    v_mfma_f32_16x16x32_bf16 v[52:55], v[68:71], v[212:215], v[52:55]
    ds_read_b64_tr_b16 v[100:101], v16 offset:24576
    v_mfma_f32_16x16x32_bf16 v[36:39], v[68:71], v[208:211], v[36:39]
    ds_read_b64_tr_b16 v[102:103], v16 offset:26624
    s_waitcnt lgkmcnt(8)
    v_mfma_f32_16x16x32_bf16 v[24:27], v[72:75], v[216:219], v[24:27]
    ds_read_b64_tr_b16 v[104:105], v13 offset:28672
    buffer_load_dwordx4 v[208:211], v130, s[8:11], s44 offen offset:0
    v_mfma_f32_16x16x32_bf16 v[40:43], v[72:75], v[220:223], v[40:43]
    ds_read_b64_tr_b16 v[106:107], v13 offset:30720
    buffer_load_dwordx4 v[212:215], v130, s[8:11], s44 offen offset:256
    v_mfma_f32_16x16x32_bf16 v[44:47], v[76:79], v[220:223], v[44:47]
    ds_read_b64_tr_b16 v[108:109], v14 offset:28672
    s_waitcnt vmcnt(10)
    v_mfma_f32_16x16x32_bf16 v[28:31], v[76:79], v[216:219], v[28:31]
    ds_read_b64_tr_b16 v[110:111], v14 offset:30720
    v_add_u32 v13, 32768, v13
    v_mfma_f32_16x16x32_bf16 v[32:35], v[80:83], v[216:219], v[32:35]
    ds_read_b64_tr_b16 v[112:113], v15 offset:28672
    v_add_u32 v14, 32768, v14
    v_mfma_f32_16x16x32_bf16 v[48:51], v[80:83], v[220:223], v[48:51]
    ds_read_b64_tr_b16 v[114:115], v15 offset:30720
    v_add_u32 v15, 32768, v15
    v_mfma_f32_16x16x32_bf16 v[52:55], v[84:87], v[220:223], v[52:55]
    ds_read_b64_tr_b16 v[116:117], v16 offset:28672
    ds_read_b64_tr_b16 v[118:119], v16 offset:30720
    v_mfma_f32_16x16x32_bf16 v[36:39], v[84:87], v[216:219], v[36:39]
    v_add_u32 v16, 32768, v16
    s_waitcnt lgkmcnt(8)
    s_cbranch_scc1 dm_23x
    v_mfma_f32_16x16x32_bf16 v[24:27], v[88:91], v[224:227], v[24:27]
    ds_read_b64_tr_b16 v[56:57], v13 offset:0
    buffer_load_dwordx4 v[216:219], v131, s[8:11], s44 offen offset:0
    v_mfma_f32_16x16x32_bf16 v[40:43], v[88:91], v[228:231], v[40:43]
    ds_read_b64_tr_b16 v[58:59], v13 offset:2048
    buffer_load_dwordx4 v[220:223], v131, s[8:11], s44 offen offset:256
    v_mfma_f32_16x16x32_bf16 v[44:47], v[92:95], v[228:231], v[44:47]
    ds_read_b64_tr_b16 v[60:61], v14 offset:0
    v_mfma_f32_16x16x32_bf16 v[28:31], v[92:95], v[224:227], v[28:31]
    ds_read_b64_tr_b16 v[62:63], v14 offset:2048
    v_mfma_f32_16x16x32_bf16 v[32:35], v[96:99], v[224:227], v[32:35]
    ds_read_b64_tr_b16 v[64:65], v15 offset:0
    v_mfma_f32_16x16x32_bf16 v[48:51], v[96:99], v[228:231], v[48:51]
    ds_read_b64_tr_b16 v[66:67], v15 offset:2048
    v_mfma_f32_16x16x32_bf16 v[52:55], v[100:103], v[228:231], v[52:55]
    ds_read_b64_tr_b16 v[68:69], v16 offset:0
    v_mfma_f32_16x16x32_bf16 v[36:39], v[100:103], v[224:227], v[36:39]
    ds_read_b64_tr_b16 v[70:71], v16 offset:2048
    s_waitcnt lgkmcnt(8)
    v_mfma_f32_16x16x32_bf16 v[24:27], v[104:107], v[232:235], v[24:27]
    ds_read_b64_tr_b16 v[72:73], v13 offset:4096
    buffer_load_dwordx4 v[224:227], v132, s[8:11], s44 offen offset:0
    v_mfma_f32_16x16x32_bf16 v[40:43], v[104:107], v[236:239], v[40:43]
    ds_read_b64_tr_b16 v[74:75], v13 offset:6144
    buffer_load_dwordx4 v[228:231], v132, s[8:11], s44 offen offset:256
    v_mfma_f32_16x16x32_bf16 v[44:47], v[108:111], v[236:239], v[44:47]
    ds_read_b64_tr_b16 v[76:77], v14 offset:4096
    s_waitcnt vmcnt(10)
    v_mfma_f32_16x16x32_bf16 v[28:31], v[108:111], v[232:235], v[28:31]
    ds_read_b64_tr_b16 v[78:79], v14 offset:6144
    v_mfma_f32_16x16x32_bf16 v[32:35], v[112:115], v[232:235], v[32:35]
    ds_read_b64_tr_b16 v[80:81], v15 offset:4096
    v_mfma_f32_16x16x32_bf16 v[48:51], v[112:115], v[236:239], v[48:51]
    ds_read_b64_tr_b16 v[82:83], v15 offset:6144
    v_mfma_f32_16x16x32_bf16 v[52:55], v[116:119], v[236:239], v[52:55]
    ds_read_b64_tr_b16 v[84:85], v16 offset:4096
    ds_read_b64_tr_b16 v[86:87], v16 offset:6144
    v_mfma_f32_16x16x32_bf16 v[36:39], v[116:119], v[232:235], v[36:39]
    s_waitcnt lgkmcnt(8)
    s_branch dm_23
dm_23x:
    v_mfma_f32_16x16x32_bf16 v[24:27], v[88:91], v[224:227], v[24:27]
    v_mfma_f32_16x16x32_bf16 v[40:43], v[88:91], v[228:231], v[40:43]
    v_mfma_f32_16x16x32_bf16 v[44:47], v[92:95], v[228:231], v[44:47]
    v_mfma_f32_16x16x32_bf16 v[28:31], v[92:95], v[224:227], v[28:31]
    v_mfma_f32_16x16x32_bf16 v[32:35], v[96:99], v[224:227], v[32:35]
    v_mfma_f32_16x16x32_bf16 v[48:51], v[96:99], v[228:231], v[48:51]
    v_mfma_f32_16x16x32_bf16 v[52:55], v[100:103], v[228:231], v[52:55]
    v_mfma_f32_16x16x32_bf16 v[36:39], v[100:103], v[224:227], v[36:39]
    s_waitcnt lgkmcnt(0)
    v_mfma_f32_16x16x32_bf16 v[24:27], v[104:107], v[232:235], v[24:27]
    s_add_u32 s16, s62, 0x480000
    s_addc_u32 s17, s63, 0
    v_mfma_f32_16x16x32_bf16 v[40:43], v[104:107], v[236:239], v[40:43]
    s_mov_b32 s18, 0x7e000
    v_mfma_f32_16x16x32_bf16 v[44:47], v[108:111], v[236:239], v[44:47]
    s_mov_b32 s19, 0x20000
    v_mfma_f32_16x16x32_bf16 v[28:31], v[108:111], v[232:235], v[28:31]
    s_add_u32 s44, s62, 0x1c8000
    v_mfma_f32_16x16x32_bf16 v[32:35], v[112:115], v[232:235], v[32:35]
    s_addc_u32 s45, s63, 0
    v_mfma_f32_16x16x32_bf16 v[48:51], v[112:115], v[236:239], v[48:51]
    s_mov_b32 s46, 0x6000
    v_mfma_f32_16x16x32_bf16 v[52:55], v[116:119], v[236:239], v[52:55]
    s_mov_b32 s47, 0x20000
    v_mfma_f32_16x16x32_bf16 v[36:39], v[116:119], v[232:235], v[36:39]
    s_add_u32 s36, s39, 0
    v_cvt_pk_bf16_f32 v160, v24, v25
    v_cvt_pk_bf16_f32 v161, v26, v27
    v_cvt_pk_bf16_f32 v162, v28, v29
    v_cvt_pk_bf16_f32 v163, v30, v31
    buffer_store_dwordx4 v[160:163], v2, s[16:19], s36 offen offset:0 sc1
    v_cvt_pk_bf16_f32 v164, v32, v33
    v_cvt_pk_bf16_f32 v165, v34, v35
    v_cvt_pk_bf16_f32 v166, v36, v37
    v_cvt_pk_bf16_f32 v167, v38, v39
    buffer_store_dwordx4 v[164:167], v2, s[16:19], s36 offen offset:1024 sc1
    s_add_u32 s36, s39, 65536
    v_cvt_pk_bf16_f32 v168, v40, v41
    v_cvt_pk_bf16_f32 v169, v42, v43
    v_cvt_pk_bf16_f32 v170, v44, v45
    v_cvt_pk_bf16_f32 v171, v46, v47
    buffer_store_dwordx4 v[168:171], v2, s[16:19], s36 offen offset:0 sc1
    v_cvt_pk_bf16_f32 v172, v48, v49
    v_cvt_pk_bf16_f32 v173, v50, v51
    v_cvt_pk_bf16_f32 v174, v52, v53
    v_cvt_pk_bf16_f32 v175, v54, v55
    buffer_store_dwordx4 v[172:175], v2, s[16:19], s36 offen offset:1024 sc1
    s_barrier
    s_lshl_b32 s36, s37, 11
    v_add_u32 v7, s36, v2
    ds_write_b128 v7, v[160:163] offset:0
    ds_write_b128 v7, v[164:167] offset:1024
    ds_write_b128 v7, v[168:171] offset:2048
    ds_write_b128 v7, v[172:175] offset:3072
    v_lshlrev_b32 v24, 16, v160
    v_and_b32 v25, 0xffff0000, v160
    v_lshlrev_b32 v26, 16, v161
    v_and_b32 v27, 0xffff0000, v161
    v_lshlrev_b32 v28, 16, v162
    v_and_b32 v29, 0xffff0000, v162
    v_lshlrev_b32 v30, 16, v163
    v_and_b32 v31, 0xffff0000, v163
    v_lshlrev_b32 v32, 16, v164
    v_and_b32 v33, 0xffff0000, v164
    v_lshlrev_b32 v34, 16, v165
    v_and_b32 v35, 0xffff0000, v165
    v_lshlrev_b32 v36, 16, v166
    v_and_b32 v37, 0xffff0000, v166
    v_lshlrev_b32 v38, 16, v167
    v_and_b32 v39, 0xffff0000, v167
    v_lshlrev_b32 v40, 16, v168
    v_and_b32 v41, 0xffff0000, v168
    v_lshlrev_b32 v42, 16, v169
    v_and_b32 v43, 0xffff0000, v169
    v_lshlrev_b32 v44, 16, v170
    v_and_b32 v45, 0xffff0000, v170
    v_lshlrev_b32 v46, 16, v171
    v_and_b32 v47, 0xffff0000, v171
    v_lshlrev_b32 v48, 16, v172
    v_and_b32 v49, 0xffff0000, v172
    v_lshlrev_b32 v50, 16, v173
    v_and_b32 v51, 0xffff0000, v173
    v_lshlrev_b32 v52, 16, v174
    v_and_b32 v53, 0xffff0000, v174
    v_lshlrev_b32 v54, 16, v175
    v_and_b32 v55, 0xffff0000, v175
    s_add_u32 s53, s55, 512
    v_mov_b32 v8, 1
    v_mov_b32 v9, 162816
    v_mov_b32 v11, 0
    s_mov_b64 exec, 1
    s_waitcnt vmcnt(0)
    ds_add_rtn_u32 v10, v9, v8
    s_waitcnt lgkmcnt(0)
    v_readfirstlane_b32 s54, v10
    s_nop 0
    s_and_b32 s54, s54, 3
    s_cmp_lg_u32 s54, 3
    s_cbranch_scc1 pub_24
    buffer_atomic_add v8, v11, s[56:59], s53 offen sc1
    v_mov_b32 v9, 162872
    ds_add_u32 v9, v8
pub_24:
    s_mov_b64 exec, -1
    s_waitcnt lgkmcnt(0)
    s_barrier
    v_pk_add_f32 v[140:141], v[24:25], v[26:27]
    v_pk_mul_f32 v[134:135], v[24:25], v[24:25]
    v_pk_fma_f32 v[134:135], v[26:27], v[26:27], v[134:135]
    v_pk_add_f32 v[140:141], v[140:141], v[28:29]
    v_pk_fma_f32 v[134:135], v[28:29], v[28:29], v[134:135]
    v_pk_add_f32 v[140:141], v[140:141], v[30:31]
    v_pk_fma_f32 v[134:135], v[30:31], v[30:31], v[134:135]
    v_pk_add_f32 v[140:141], v[140:141], v[32:33]
    v_pk_fma_f32 v[134:135], v[32:33], v[32:33], v[134:135]
    v_pk_add_f32 v[140:141], v[140:141], v[34:35]
    v_pk_fma_f32 v[134:135], v[34:35], v[34:35], v[134:135]
    v_pk_add_f32 v[140:141], v[140:141], v[36:37]
    v_pk_fma_f32 v[134:135], v[36:37], v[36:37], v[134:135]
    v_pk_add_f32 v[140:141], v[140:141], v[38:39]
    v_pk_fma_f32 v[134:135], v[38:39], v[38:39], v[134:135]
    v_add_f32 v136, v140, v141
    v_add_f32 v137, v134, v135
    v_mov_b32 v140, v136
    v_mov_b32 v141, v137
    s_nop 0
    v_permlane16_swap_b32 v136, v140
    v_permlane16_swap_b32 v137, v141
    v_pk_add_f32 v[136:137], v[136:137], v[140:141]
    v_mov_b32 v140, v136
    v_mov_b32 v141, v137
    s_nop 0
    v_permlane32_swap_b32 v136, v140
    v_permlane32_swap_b32 v137, v141
    v_pk_add_f32 v[136:137], v[136:137], v[140:141]
    v_pk_add_f32 v[140:141], v[40:41], v[42:43]
    v_pk_mul_f32 v[134:135], v[40:41], v[40:41]
    v_pk_fma_f32 v[134:135], v[42:43], v[42:43], v[134:135]
    v_pk_add_f32 v[140:141], v[140:141], v[44:45]
    v_pk_fma_f32 v[134:135], v[44:45], v[44:45], v[134:135]
    v_pk_add_f32 v[140:141], v[140:141], v[46:47]
    v_pk_fma_f32 v[134:135], v[46:47], v[46:47], v[134:135]
    v_pk_add_f32 v[140:141], v[140:141], v[48:49]
    v_pk_fma_f32 v[134:135], v[48:49], v[48:49], v[134:135]
    v_pk_add_f32 v[140:141], v[140:141], v[50:51]
    v_pk_fma_f32 v[134:135], v[50:51], v[50:51], v[134:135]
    v_pk_add_f32 v[140:141], v[140:141], v[52:53]
    v_pk_fma_f32 v[134:135], v[52:53], v[52:53], v[134:135]
    v_pk_add_f32 v[140:141], v[140:141], v[54:55]
    v_pk_fma_f32 v[134:135], v[54:55], v[54:55], v[134:135]
    v_add_f32 v138, v140, v141
    v_add_f32 v139, v134, v135
    v_mov_b32 v140, v138
    v_mov_b32 v141, v139
    s_nop 0
    v_permlane16_swap_b32 v138, v140
    v_permlane16_swap_b32 v139, v141
    v_pk_add_f32 v[138:139], v[138:139], v[140:141]
    v_mov_b32 v140, v138
    v_mov_b32 v141, v139
    s_nop 0
    v_permlane32_swap_b32 v138, v140
    v_permlane32_swap_b32 v139, v141
    v_pk_add_f32 v[138:139], v[138:139], v[140:141]
    v_cmp_eq_u32 vcc, 0, v23
    s_nop 1
    v_cndmask_b32 v136, v138, v136, vcc
    v_cndmask_b32 v137, v139, v137, vcc
    s_lshr_b32 s53, s29, 3
    s_lshl_b32 s53, s53, 14
    s_and_b32 s40, s29, 7
    s_lshl_b32 s40, s40, 10
    s_add_u32 s40, s40, s53
    s_lshl_b32 s36, s34, 8
    s_add_u32 s40, s40, s36
    v_lshlrev_b32 v7, 3, v1
    s_bfm_b64 exec, 32, 0
    buffer_store_dwordx2 v[136:137], v7, s[44:47], s40 offen sc1
    s_mov_b64 exec, -1
    s_lshr_b32 s34, s30, 1
    s_and_b32 s35, s30, 1
    v_and_b32 v22, 15, v1
    v_lshrrev_b32 v23, 4, v1
    s_mul_i32 s37, s34, 4
    s_mul_i32 s38, s29, 14
    s_mul_i32 s36, s35, 7
    s_add_u32 s38, s38, s36
    s_mul_i32 s36, s34, 8192
    v_add_u32 v12, s36, v2
    v_lshrrev_b32 v6, 2, v1
    v_mul_u32_u24 v13, 448, v6
    v_and_b32 v7, 3, v1
    v_lshl_add_u32 v13, v7, 3, v13
    v_add_u32 v13, 73728, v13
    s_mul_i32 s36, s35, 224
    v_add_u32 v13, s36, v13
    v_bfe_u32 v6, v1, 4, 1
    v_lshlrev_b32 v6, 5, v6
    s_cmp_eq_u32 s35, 0
    s_cselect_b32 s36, 1, -1
    v_mul_lo_u32 v6, v6, s36
    v_sub_u32 v14, v13, v6
    v_add_u32 v13, v13, v6
    v_pk_mov_b32 v[24:25], 0, 0
    v_pk_mov_b32 v[26:27], 0, 0
    v_pk_mov_b32 v[28:29], 0, 0
    v_pk_mov_b32 v[30:31], 0, 0
    v_pk_mov_b32 v[32:33], 0, 0
    v_pk_mov_b32 v[34:35], 0, 0
    v_pk_mov_b32 v[36:37], 0, 0
    v_pk_mov_b32 v[38:39], 0, 0
    v_pk_mov_b32 v[40:41], 0, 0
    v_pk_mov_b32 v[42:43], 0, 0
    v_pk_mov_b32 v[44:45], 0, 0
    v_pk_mov_b32 v[46:47], 0, 0
    v_pk_mov_b32 v[48:49], 0, 0
    v_pk_mov_b32 v[50:51], 0, 0
    v_pk_mov_b32 v[52:53], 0, 0
    v_pk_mov_b32 v[54:55], 0, 0
    v_pk_mov_b32 v[56:57], 0, 0
    v_pk_mov_b32 v[58:59], 0, 0
    v_pk_mov_b32 v[60:61], 0, 0
    v_pk_mov_b32 v[62:63], 0, 0
    v_pk_mov_b32 v[64:65], 0, 0
    v_pk_mov_b32 v[66:67], 0, 0
    v_pk_mov_b32 v[68:69], 0, 0
    v_pk_mov_b32 v[70:71], 0, 0
    v_pk_mov_b32 v[72:73], 0, 0
    v_pk_mov_b32 v[74:75], 0, 0
    v_pk_mov_b32 v[76:77], 0, 0
    v_pk_mov_b32 v[78:79], 0, 0
    v_pk_mov_b32 v[80:81], 0, 0
    v_pk_mov_b32 v[82:83], 0, 0
    v_pk_mov_b32 v[84:85], 0, 0
    v_pk_mov_b32 v[86:87], 0, 0
    v_pk_mov_b32 v[88:89], 0, 0
    v_pk_mov_b32 v[90:91], 0, 0
    v_pk_mov_b32 v[92:93], 0, 0
    v_pk_mov_b32 v[94:95], 0, 0
    v_pk_mov_b32 v[96:97], 0, 0
    v_pk_mov_b32 v[98:99], 0, 0
    v_pk_mov_b32 v[100:101], 0, 0
    v_pk_mov_b32 v[102:103], 0, 0
    v_pk_mov_b32 v[104:105], 0, 0
    v_pk_mov_b32 v[106:107], 0, 0
    v_pk_mov_b32 v[108:109], 0, 0
    v_pk_mov_b32 v[110:111], 0, 0
    v_pk_mov_b32 v[112:113], 0, 0
    v_pk_mov_b32 v[114:115], 0, 0
    v_pk_mov_b32 v[116:117], 0, 0
    v_pk_mov_b32 v[118:119], 0, 0
    v_pk_mov_b32 v[120:121], 0, 0
    v_pk_mov_b32 v[122:123], 0, 0
    v_pk_mov_b32 v[124:125], 0, 0
    v_pk_mov_b32 v[126:127], 0, 0
    v_pk_mov_b32 v[128:129], 0, 0
    v_pk_mov_b32 v[130:131], 0, 0
    v_pk_mov_b32 v[132:133], 0, 0
    v_pk_mov_b32 v[134:135], 0, 0
    s_mov_b32 s42, 0
    s_mov_b32 s43, 0
    s_mov_b32 s48, 57344
    v_mov_b32 v17, v12
    v_add_u32 v18, 57344, v13
    v_add_u32 v19, 57344, v14
    ds_read_b128 v[136:139], v17 offset:0
    ds_read_b128 v[140:143], v17 offset:2048
    ds_read_b128 v[144:147], v17 offset:4096
    ds_read_b128 v[148:151], v17 offset:6144
    ds_read_b64_tr_b16 v[152:153], v18 offset:0
    ds_read_b64_tr_b16 v[154:155], v18 offset:7168
    ds_read_b64_tr_b16 v[156:157], v19 offset:32
    ds_read_b64_tr_b16 v[158:159], v19 offset:7200
    ds_read_b64_tr_b16 v[160:161], v18 offset:64
    ds_read_b64_tr_b16 v[162:163], v18 offset:7232
    ds_read_b64_tr_b16 v[164:165], v19 offset:96
    ds_read_b64_tr_b16 v[166:167], v19 offset:7264
    ds_read_b64_tr_b16 v[168:169], v18 offset:128
    ds_read_b64_tr_b16 v[170:171], v18 offset:7296
    ds_read_b64_tr_b16 v[172:173], v19 offset:160
    ds_read_b64_tr_b16 v[174:175], v19 offset:7328
    ds_read_b64_tr_b16 v[176:177], v18 offset:192
    ds_read_b64_tr_b16 v[178:179], v18 offset:7360
    s_waitcnt lgkmcnt(0)
    v_mfma_f32_16x16x32_bf16 v[24:27], v[152:155], v[136:139], v[24:27]
    ds_read_b128 v[180:183], v17 offset:1024
    v_mfma_f32_16x16x32_bf16 v[52:55], v[152:155], v[140:143], v[52:55]
    ds_read_b128 v[184:187], v17 offset:3072
    v_mfma_f32_16x16x32_bf16 v[80:83], v[152:155], v[144:147], v[80:83]
    ds_read_b128 v[188:191], v17 offset:5120
    v_mfma_f32_16x16x32_bf16 v[108:111], v[152:155], v[148:151], v[108:111]
    ds_read_b128 v[192:195], v17 offset:7168
    v_mfma_f32_16x16x32_bf16 v[112:115], v[156:159], v[148:151], v[112:115]
    ds_read_b64_tr_b16 v[196:197], v18 offset:14336
    v_mfma_f32_16x16x32_bf16 v[84:87], v[156:159], v[144:147], v[84:87]
    ds_read_b64_tr_b16 v[198:199], v18 offset:21504
    v_mfma_f32_16x16x32_bf16 v[56:59], v[156:159], v[140:143], v[56:59]
    v_mfma_f32_16x16x32_bf16 v[28:31], v[156:159], v[136:139], v[28:31]
    ds_read_b64_tr_b16 v[200:201], v19 offset:14368
    v_mfma_f32_16x16x32_bf16 v[32:35], v[160:163], v[136:139], v[32:35]
    ds_read_b64_tr_b16 v[202:203], v19 offset:21536
    v_mfma_f32_16x16x32_bf16 v[60:63], v[160:163], v[140:143], v[60:63]
    ds_read_b64_tr_b16 v[204:205], v18 offset:14400
    v_mfma_f32_16x16x32_bf16 v[88:91], v[160:163], v[144:147], v[88:91]
    ds_read_b64_tr_b16 v[206:207], v18 offset:21568
    v_mfma_f32_16x16x32_bf16 v[116:119], v[160:163], v[148:151], v[116:119]
    ds_read_b64_tr_b16 v[208:209], v19 offset:14432
    v_mfma_f32_16x16x32_bf16 v[120:123], v[164:167], v[148:151], v[120:123]
    ds_read_b64_tr_b16 v[210:211], v19 offset:21600
    v_mfma_f32_16x16x32_bf16 v[92:95], v[164:167], v[144:147], v[92:95]
    v_mfma_f32_16x16x32_bf16 v[64:67], v[164:167], v[140:143], v[64:67]
    ds_read_b64_tr_b16 v[212:213], v18 offset:14464
    v_mfma_f32_16x16x32_bf16 v[36:39], v[164:167], v[136:139], v[36:39]
    ds_read_b64_tr_b16 v[214:215], v18 offset:21632
    v_mfma_f32_16x16x32_bf16 v[40:43], v[168:171], v[136:139], v[40:43]
    ds_read_b64_tr_b16 v[216:217], v19 offset:14496
    v_mfma_f32_16x16x32_bf16 v[68:71], v[168:171], v[140:143], v[68:71]
    ds_read_b64_tr_b16 v[218:219], v19 offset:21664
    v_mfma_f32_16x16x32_bf16 v[96:99], v[168:171], v[144:147], v[96:99]
    ds_read_b64_tr_b16 v[220:221], v18 offset:14528
    v_mfma_f32_16x16x32_bf16 v[124:127], v[168:171], v[148:151], v[124:127]
    ds_read_b64_tr_b16 v[222:223], v18 offset:21696
    v_mfma_f32_16x16x32_bf16 v[128:131], v[172:175], v[148:151], v[128:131]
    s_add_u32 s42, s42, 16384
    s_cmp_eq_u32 s42, 49152
    v_mfma_f32_16x16x32_bf16 v[100:103], v[172:175], v[144:147], v[100:103]
    s_cselect_b32 s42, 0, s42
    s_add_u32 s48, s48, 28672
    v_mfma_f32_16x16x32_bf16 v[72:75], v[172:175], v[140:143], v[72:75]
    s_cmp_eq_u32 s48, 86016
    s_cselect_b32 s48, 0, s48
    v_mfma_f32_16x16x32_bf16 v[44:47], v[172:175], v[136:139], v[44:47]
    v_add_u32 v17, s42, v12
    v_add_u32 v18, s48, v13
    v_mfma_f32_16x16x32_bf16 v[48:51], v[176:179], v[136:139], v[48:51]
    v_add_u32 v19, s48, v14
    v_mfma_f32_16x16x32_bf16 v[76:79], v[176:179], v[140:143], v[76:79]
    v_mfma_f32_16x16x32_bf16 v[104:107], v[176:179], v[144:147], v[104:107]
    v_mfma_f32_16x16x32_bf16 v[132:135], v[176:179], v[148:151], v[132:135]
    s_waitcnt lgkmcnt(0)
    v_mfma_f32_16x16x32_bf16 v[24:27], v[196:199], v[180:183], v[24:27]
    v_mfma_f32_16x16x32_bf16 v[52:55], v[196:199], v[184:187], v[52:55]
    v_mfma_f32_16x16x32_bf16 v[80:83], v[196:199], v[188:191], v[80:83]
    v_mfma_f32_16x16x32_bf16 v[108:111], v[196:199], v[192:195], v[108:111]
    v_mfma_f32_16x16x32_bf16 v[112:115], v[200:203], v[192:195], v[112:115]
    v_mfma_f32_16x16x32_bf16 v[84:87], v[200:203], v[188:191], v[84:87]
    v_mfma_f32_16x16x32_bf16 v[56:59], v[200:203], v[184:187], v[56:59]
    v_mfma_f32_16x16x32_bf16 v[28:31], v[200:203], v[180:183], v[28:31]
    v_mfma_f32_16x16x32_bf16 v[32:35], v[204:207], v[180:183], v[32:35]
    v_mfma_f32_16x16x32_bf16 v[60:63], v[204:207], v[184:187], v[60:63]
    v_mfma_f32_16x16x32_bf16 v[88:91], v[204:207], v[188:191], v[88:91]
    v_mfma_f32_16x16x32_bf16 v[116:119], v[204:207], v[192:195], v[116:119]
    v_mfma_f32_16x16x32_bf16 v[120:123], v[208:211], v[192:195], v[120:123]
    v_mfma_f32_16x16x32_bf16 v[92:95], v[208:211], v[188:191], v[92:95]
    v_mfma_f32_16x16x32_bf16 v[64:67], v[208:211], v[184:187], v[64:67]
    v_mfma_f32_16x16x32_bf16 v[36:39], v[208:211], v[180:183], v[36:39]
    v_mfma_f32_16x16x32_bf16 v[40:43], v[212:215], v[180:183], v[40:43]
    v_mfma_f32_16x16x32_bf16 v[68:71], v[212:215], v[184:187], v[68:71]
    v_mfma_f32_16x16x32_bf16 v[96:99], v[212:215], v[188:191], v[96:99]
    v_mfma_f32_16x16x32_bf16 v[124:127], v[212:215], v[192:195], v[124:127]
    v_mfma_f32_16x16x32_bf16 v[128:131], v[216:219], v[192:195], v[128:131]
    s_add_u32 s43, s43, 1
    v_mfma_f32_16x16x32_bf16 v[100:103], v[216:219], v[188:191], v[100:103]
    v_mfma_f32_16x16x32_bf16 v[72:75], v[216:219], v[184:187], v[72:75]
    v_mfma_f32_16x16x32_bf16 v[44:47], v[216:219], v[180:183], v[44:47]
    v_mfma_f32_16x16x32_bf16 v[48:51], v[220:223], v[180:183], v[48:51]
    v_mfma_f32_16x16x32_bf16 v[76:79], v[220:223], v[184:187], v[76:79]
    v_mfma_f32_16x16x32_bf16 v[104:107], v[220:223], v[188:191], v[104:107]
    v_mfma_f32_16x16x32_bf16 v[132:135], v[220:223], v[192:195], v[132:135]
    s_add_u32 s53, s55, 1408
    v_mov_b32 v8, 1
    v_mov_b32 v9, 162864
    v_mov_b32 v11, 0
    s_mov_b64 exec, 1
    s_waitcnt vmcnt(0)
    ds_add_rtn_u32 v10, v9, v8
    s_waitcnt lgkmcnt(0)
    v_readfirstlane_b32 s54, v10
    s_nop 0
    s_and_b32 s54, s54, 3
    s_cmp_lg_u32 s54, 3
    s_cbranch_scc1 pub_25
    buffer_atomic_add v8, v11, s[56:59], s53 offen sc1
pub_25:
    s_mov_b64 exec, -1
    s_barrier
    ds_read_b128 v[136:139], v17 offset:0
    ds_read_b128 v[140:143], v17 offset:2048
    ds_read_b128 v[144:147], v17 offset:4096
    ds_read_b128 v[148:151], v17 offset:6144
    ds_read_b64_tr_b16 v[152:153], v18 offset:0
    ds_read_b64_tr_b16 v[154:155], v18 offset:7168
    ds_read_b64_tr_b16 v[156:157], v19 offset:32
    ds_read_b64_tr_b16 v[158:159], v19 offset:7200
    ds_read_b64_tr_b16 v[160:161], v18 offset:64
    ds_read_b64_tr_b16 v[162:163], v18 offset:7232
    ds_read_b64_tr_b16 v[164:165], v19 offset:96
    ds_read_b64_tr_b16 v[166:167], v19 offset:7264
    ds_read_b64_tr_b16 v[168:169], v18 offset:128
    ds_read_b64_tr_b16 v[170:171], v18 offset:7296
    ds_read_b64_tr_b16 v[172:173], v19 offset:160
    ds_read_b64_tr_b16 v[174:175], v19 offset:7328
    ds_read_b64_tr_b16 v[176:177], v18 offset:192
    ds_read_b64_tr_b16 v[178:179], v18 offset:7360
mm_26:
    s_waitcnt lgkmcnt(0)
    v_mfma_f32_16x16x32_bf16 v[24:27], v[152:155], v[136:139], v[24:27]
    ds_read_b128 v[180:183], v17 offset:1024
    v_mfma_f32_16x16x32_bf16 v[52:55], v[152:155], v[140:143], v[52:55]
    ds_read_b128 v[184:187], v17 offset:3072
    v_mfma_f32_16x16x32_bf16 v[80:83], v[152:155], v[144:147], v[80:83]
    ds_read_b128 v[188:191], v17 offset:5120
    v_mfma_f32_16x16x32_bf16 v[108:111], v[152:155], v[148:151], v[108:111]
    ds_read_b128 v[192:195], v17 offset:7168
    v_mfma_f32_16x16x32_bf16 v[112:115], v[156:159], v[148:151], v[112:115]
    ds_read_b64_tr_b16 v[196:197], v18 offset:14336
    v_mfma_f32_16x16x32_bf16 v[84:87], v[156:159], v[144:147], v[84:87]
    ds_read_b64_tr_b16 v[198:199], v18 offset:21504
    v_mfma_f32_16x16x32_bf16 v[56:59], v[156:159], v[140:143], v[56:59]
    v_mfma_f32_16x16x32_bf16 v[28:31], v[156:159], v[136:139], v[28:31]
    ds_read_b64_tr_b16 v[200:201], v19 offset:14368
    v_mfma_f32_16x16x32_bf16 v[32:35], v[160:163], v[136:139], v[32:35]
    ds_read_b64_tr_b16 v[202:203], v19 offset:21536
    v_mfma_f32_16x16x32_bf16 v[60:63], v[160:163], v[140:143], v[60:63]
    ds_read_b64_tr_b16 v[204:205], v18 offset:14400
    v_mfma_f32_16x16x32_bf16 v[88:91], v[160:163], v[144:147], v[88:91]
    ds_read_b64_tr_b16 v[206:207], v18 offset:21568
    v_mfma_f32_16x16x32_bf16 v[116:119], v[160:163], v[148:151], v[116:119]
    ds_read_b64_tr_b16 v[208:209], v19 offset:14432
    v_mfma_f32_16x16x32_bf16 v[120:123], v[164:167], v[148:151], v[120:123]
    ds_read_b64_tr_b16 v[210:211], v19 offset:21600
    v_mfma_f32_16x16x32_bf16 v[92:95], v[164:167], v[144:147], v[92:95]
    v_mfma_f32_16x16x32_bf16 v[64:67], v[164:167], v[140:143], v[64:67]
    ds_read_b64_tr_b16 v[212:213], v18 offset:14464
    v_mfma_f32_16x16x32_bf16 v[36:39], v[164:167], v[136:139], v[36:39]
    ds_read_b64_tr_b16 v[214:215], v18 offset:21632
    v_mfma_f32_16x16x32_bf16 v[40:43], v[168:171], v[136:139], v[40:43]
    ds_read_b64_tr_b16 v[216:217], v19 offset:14496
    v_mfma_f32_16x16x32_bf16 v[68:71], v[168:171], v[140:143], v[68:71]
    ds_read_b64_tr_b16 v[218:219], v19 offset:21664
    v_mfma_f32_16x16x32_bf16 v[96:99], v[168:171], v[144:147], v[96:99]
    ds_read_b64_tr_b16 v[220:221], v18 offset:14528
    v_mfma_f32_16x16x32_bf16 v[124:127], v[168:171], v[148:151], v[124:127]
    ds_read_b64_tr_b16 v[222:223], v18 offset:21696
    v_mfma_f32_16x16x32_bf16 v[128:131], v[172:175], v[148:151], v[128:131]
    s_add_u32 s42, s42, 16384
    s_cmp_eq_u32 s42, 49152
    v_mfma_f32_16x16x32_bf16 v[100:103], v[172:175], v[144:147], v[100:103]
    s_cselect_b32 s42, 0, s42
    s_add_u32 s48, s48, 28672
    v_mfma_f32_16x16x32_bf16 v[72:75], v[172:175], v[140:143], v[72:75]
    s_cmp_eq_u32 s48, 86016
    s_cselect_b32 s48, 0, s48
    v_mfma_f32_16x16x32_bf16 v[44:47], v[172:175], v[136:139], v[44:47]
    v_add_u32 v17, s42, v12
    v_add_u32 v18, s48, v13
    v_mfma_f32_16x16x32_bf16 v[48:51], v[176:179], v[136:139], v[48:51]
    v_add_u32 v19, s48, v14
    v_mfma_f32_16x16x32_bf16 v[76:79], v[176:179], v[140:143], v[76:79]
    v_mfma_f32_16x16x32_bf16 v[104:107], v[176:179], v[144:147], v[104:107]
    v_mfma_f32_16x16x32_bf16 v[132:135], v[176:179], v[148:151], v[132:135]
    s_waitcnt lgkmcnt(0)
    s_barrier
    v_mfma_f32_16x16x32_bf16 v[24:27], v[196:199], v[180:183], v[24:27]
    ds_read_b128 v[136:139], v17 offset:0
    v_mfma_f32_16x16x32_bf16 v[52:55], v[196:199], v[184:187], v[52:55]
    ds_read_b128 v[140:143], v17 offset:2048
    v_mfma_f32_16x16x32_bf16 v[80:83], v[196:199], v[188:191], v[80:83]
    ds_read_b128 v[144:147], v17 offset:4096
    v_mfma_f32_16x16x32_bf16 v[108:111], v[196:199], v[192:195], v[108:111]
    ds_read_b128 v[148:151], v17 offset:6144
    v_mfma_f32_16x16x32_bf16 v[112:115], v[200:203], v[192:195], v[112:115]
    ds_read_b64_tr_b16 v[152:153], v18 offset:0
    v_mfma_f32_16x16x32_bf16 v[84:87], v[200:203], v[188:191], v[84:87]
    ds_read_b64_tr_b16 v[154:155], v18 offset:7168
    v_mfma_f32_16x16x32_bf16 v[56:59], v[200:203], v[184:187], v[56:59]
    v_mfma_f32_16x16x32_bf16 v[28:31], v[200:203], v[180:183], v[28:31]
    ds_read_b64_tr_b16 v[156:157], v19 offset:32
    v_mfma_f32_16x16x32_bf16 v[32:35], v[204:207], v[180:183], v[32:35]
    ds_read_b64_tr_b16 v[158:159], v19 offset:7200
    v_mfma_f32_16x16x32_bf16 v[60:63], v[204:207], v[184:187], v[60:63]
    ds_read_b64_tr_b16 v[160:161], v18 offset:64
    v_mfma_f32_16x16x32_bf16 v[88:91], v[204:207], v[188:191], v[88:91]
    ds_read_b64_tr_b16 v[162:163], v18 offset:7232
    v_mfma_f32_16x16x32_bf16 v[116:119], v[204:207], v[192:195], v[116:119]
    ds_read_b64_tr_b16 v[164:165], v19 offset:96
    v_mfma_f32_16x16x32_bf16 v[120:123], v[208:211], v[192:195], v[120:123]
    ds_read_b64_tr_b16 v[166:167], v19 offset:7264
    v_mfma_f32_16x16x32_bf16 v[92:95], v[208:211], v[188:191], v[92:95]
    v_mfma_f32_16x16x32_bf16 v[64:67], v[208:211], v[184:187], v[64:67]
    ds_read_b64_tr_b16 v[168:169], v18 offset:128
    v_mfma_f32_16x16x32_bf16 v[36:39], v[208:211], v[180:183], v[36:39]
    ds_read_b64_tr_b16 v[170:171], v18 offset:7296
    v_mfma_f32_16x16x32_bf16 v[40:43], v[212:215], v[180:183], v[40:43]
    ds_read_b64_tr_b16 v[172:173], v19 offset:160
    v_mfma_f32_16x16x32_bf16 v[68:71], v[212:215], v[184:187], v[68:71]
    ds_read_b64_tr_b16 v[174:175], v19 offset:7328
    v_mfma_f32_16x16x32_bf16 v[96:99], v[212:215], v[188:191], v[96:99]
    ds_read_b64_tr_b16 v[176:177], v18 offset:192
    v_mfma_f32_16x16x32_bf16 v[124:127], v[212:215], v[192:195], v[124:127]
    ds_read_b64_tr_b16 v[178:179], v18 offset:7360
    v_mfma_f32_16x16x32_bf16 v[128:131], v[216:219], v[192:195], v[128:131]
    s_add_u32 s43, s43, 1
    v_mfma_f32_16x16x32_bf16 v[100:103], v[216:219], v[188:191], v[100:103]
    s_cmp_lt_u32 s43, 15
    v_mfma_f32_16x16x32_bf16 v[72:75], v[216:219], v[184:187], v[72:75]
    v_mfma_f32_16x16x32_bf16 v[44:47], v[216:219], v[180:183], v[44:47]
    v_mfma_f32_16x16x32_bf16 v[48:51], v[220:223], v[180:183], v[48:51]
    v_mfma_f32_16x16x32_bf16 v[76:79], v[220:223], v[184:187], v[76:79]
    v_mfma_f32_16x16x32_bf16 v[104:107], v[220:223], v[188:191], v[104:107]
    v_mfma_f32_16x16x32_bf16 v[132:135], v[220:223], v[192:195], v[132:135]
    s_cbranch_scc1 mm_26
    s_waitcnt lgkmcnt(0)
    v_mfma_f32_16x16x32_bf16 v[24:27], v[152:155], v[136:139], v[24:27]
    ds_read_b128 v[180:183], v17 offset:1024
    v_mfma_f32_16x16x32_bf16 v[52:55], v[152:155], v[140:143], v[52:55]
    ds_read_b128 v[184:187], v17 offset:3072
    v_mfma_f32_16x16x32_bf16 v[80:83], v[152:155], v[144:147], v[80:83]
    ds_read_b128 v[188:191], v17 offset:5120
    v_mfma_f32_16x16x32_bf16 v[108:111], v[152:155], v[148:151], v[108:111]
    ds_read_b128 v[192:195], v17 offset:7168
    v_mfma_f32_16x16x32_bf16 v[112:115], v[156:159], v[148:151], v[112:115]
    ds_read_b64_tr_b16 v[196:197], v18 offset:14336
    v_mfma_f32_16x16x32_bf16 v[84:87], v[156:159], v[144:147], v[84:87]
    ds_read_b64_tr_b16 v[198:199], v18 offset:21504
    v_mfma_f32_16x16x32_bf16 v[56:59], v[156:159], v[140:143], v[56:59]
    v_mfma_f32_16x16x32_bf16 v[28:31], v[156:159], v[136:139], v[28:31]
    ds_read_b64_tr_b16 v[200:201], v19 offset:14368
    v_mfma_f32_16x16x32_bf16 v[32:35], v[160:163], v[136:139], v[32:35]
    ds_read_b64_tr_b16 v[202:203], v19 offset:21536
    v_mfma_f32_16x16x32_bf16 v[60:63], v[160:163], v[140:143], v[60:63]
    ds_read_b64_tr_b16 v[204:205], v18 offset:14400
    v_mfma_f32_16x16x32_bf16 v[88:91], v[160:163], v[144:147], v[88:91]
    ds_read_b64_tr_b16 v[206:207], v18 offset:21568
    v_mfma_f32_16x16x32_bf16 v[116:119], v[160:163], v[148:151], v[116:119]
    ds_read_b64_tr_b16 v[208:209], v19 offset:14432
    v_mfma_f32_16x16x32_bf16 v[120:123], v[164:167], v[148:151], v[120:123]
    ds_read_b64_tr_b16 v[210:211], v19 offset:21600
    v_mfma_f32_16x16x32_bf16 v[92:95], v[164:167], v[144:147], v[92:95]
    v_mfma_f32_16x16x32_bf16 v[64:67], v[164:167], v[140:143], v[64:67]
    ds_read_b64_tr_b16 v[212:213], v18 offset:14464
    v_mfma_f32_16x16x32_bf16 v[36:39], v[164:167], v[136:139], v[36:39]
    ds_read_b64_tr_b16 v[214:215], v18 offset:21632
    v_mfma_f32_16x16x32_bf16 v[40:43], v[168:171], v[136:139], v[40:43]
    ds_read_b64_tr_b16 v[216:217], v19 offset:14496
    v_mfma_f32_16x16x32_bf16 v[68:71], v[168:171], v[140:143], v[68:71]
    ds_read_b64_tr_b16 v[218:219], v19 offset:21664
    v_mfma_f32_16x16x32_bf16 v[96:99], v[168:171], v[144:147], v[96:99]
    ds_read_b64_tr_b16 v[220:221], v18 offset:14528
    v_mfma_f32_16x16x32_bf16 v[124:127], v[168:171], v[148:151], v[124:127]
    ds_read_b64_tr_b16 v[222:223], v18 offset:21696
    v_mfma_f32_16x16x32_bf16 v[128:131], v[172:175], v[148:151], v[128:131]
    v_mfma_f32_16x16x32_bf16 v[100:103], v[172:175], v[144:147], v[100:103]
    v_mfma_f32_16x16x32_bf16 v[72:75], v[172:175], v[140:143], v[72:75]
    v_mfma_f32_16x16x32_bf16 v[44:47], v[172:175], v[136:139], v[44:47]
    v_mfma_f32_16x16x32_bf16 v[48:51], v[176:179], v[136:139], v[48:51]
    v_mfma_f32_16x16x32_bf16 v[76:79], v[176:179], v[140:143], v[76:79]
    v_mfma_f32_16x16x32_bf16 v[104:107], v[176:179], v[144:147], v[104:107]
    v_mfma_f32_16x16x32_bf16 v[132:135], v[176:179], v[148:151], v[132:135]
    s_waitcnt lgkmcnt(0)
    s_barrier
    v_mfma_f32_16x16x32_bf16 v[24:27], v[196:199], v[180:183], v[24:27]
    s_mul_i32 s36, s35, 448
    s_add_u32 s36, s36, 159744
    v_lshlrev_b32 v6, 4, v23
    v_add_u32 v6, s36, v6
    v_mfma_f32_16x16x32_bf16 v[52:55], v[196:199], v[184:187], v[52:55]
    ds_read_b128 v[136:139], v6 offset:0
    ds_read_b128 v[140:143], v6 offset:64
    ds_read_b128 v[144:147], v6 offset:128
    v_mfma_f32_16x16x32_bf16 v[80:83], v[196:199], v[188:191], v[80:83]
    ds_read_b128 v[148:151], v6 offset:192
    ds_read_b128 v[152:155], v6 offset:256
    ds_read_b128 v[156:159], v6 offset:320
    v_mfma_f32_16x16x32_bf16 v[108:111], v[196:199], v[192:195], v[108:111]
    ds_read_b128 v[160:163], v6 offset:384
    s_lshl_b32 s36, s34, 9
    s_add_u32 s36, s36, 160768
    v_mfma_f32_16x16x32_bf16 v[112:115], v[200:203], v[192:195], v[112:115]
    v_lshlrev_b32 v7, 3, v22
    v_add_u32 v7, s36, v7
    ds_read_b64 v[164:165], v7 offset:0
    v_mfma_f32_16x16x32_bf16 v[84:87], v[200:203], v[188:191], v[84:87]
    ds_read_b64 v[166:167], v7 offset:128
    ds_read_b64 v[168:169], v7 offset:256
    ds_read_b64 v[170:171], v7 offset:384
    v_mfma_f32_16x16x32_bf16 v[56:59], v[200:203], v[184:187], v[56:59]
    s_mov_b32 s16, s62
    s_mov_b32 s17, s63
    s_mov_b32 s18, 0x1be000
    v_mfma_f32_16x16x32_bf16 v[28:31], v[200:203], v[180:183], v[28:31]
    s_mov_b32 s19, 0x20000
    s_mul_i32 s39, s37, 229376
    s_lshr_b32 s36, s38, 1
    v_mfma_f32_16x16x32_bf16 v[32:35], v[204:207], v[180:183], v[32:35]
    s_add_u32 s36, s36, 0
    s_lshr_b32 s53, s36, 3
    s_lshl_b32 s53, s53, 14
    v_mfma_f32_16x16x32_bf16 v[60:63], v[204:207], v[184:187], v[60:63]
    s_and_b32 s44, s36, 7
    s_lshl_b32 s44, s44, 10
    s_add_u32 s44, s44, s53
    v_mfma_f32_16x16x32_bf16 v[88:91], v[204:207], v[188:191], v[88:91]
    s_add_u32 s44, s44, s39
    s_lshr_b32 s36, s38, 1
    s_add_u32 s36, s36, 1
    s_lshr_b32 s53, s36, 3
    v_mfma_f32_16x16x32_bf16 v[116:119], v[204:207], v[192:195], v[116:119]
    s_lshl_b32 s53, s53, 14
    s_and_b32 s45, s36, 7
    s_lshl_b32 s45, s45, 10
    v_mfma_f32_16x16x32_bf16 v[120:123], v[208:211], v[192:195], v[120:123]
    s_add_u32 s45, s45, s53
    s_add_u32 s45, s45, s39
    s_lshr_b32 s36, s38, 1
    v_mfma_f32_16x16x32_bf16 v[92:95], v[208:211], v[188:191], v[92:95]
    s_add_u32 s36, s36, 2
    s_lshr_b32 s53, s36, 3
    s_lshl_b32 s53, s53, 14
    v_mfma_f32_16x16x32_bf16 v[64:67], v[208:211], v[184:187], v[64:67]
    s_and_b32 s46, s36, 7
    s_lshl_b32 s46, s46, 10
    s_add_u32 s46, s46, s53
    v_mfma_f32_16x16x32_bf16 v[36:39], v[208:211], v[180:183], v[36:39]
    s_add_u32 s46, s46, s39
    s_lshr_b32 s36, s38, 1
    s_add_u32 s36, s36, 3
    v_mfma_f32_16x16x32_bf16 v[40:43], v[212:215], v[180:183], v[40:43]
    s_lshr_b32 s53, s36, 3
    s_lshl_b32 s53, s53, 14
    s_and_b32 s47, s36, 7
    v_mfma_f32_16x16x32_bf16 v[68:71], v[212:215], v[184:187], v[68:71]
    s_lshl_b32 s47, s47, 10
    s_add_u32 s47, s47, s53
    s_add_u32 s47, s47, s39
    v_mfma_f32_16x16x32_bf16 v[96:99], v[212:215], v[188:191], v[96:99]
    s_lshl_b32 s36, s37, 1
    s_add_u32 s36, s36, s35
    s_lshl_b32 s36, s36, 10
    v_mfma_f32_16x16x32_bf16 v[124:127], v[212:215], v[192:195], v[124:127]
    v_add_u32 v12, s36, v2
    v_lshrrev_b32 v238, 1, v23
    v_lshlrev_b32 v238, 8, v238
    v_mfma_f32_16x16x32_bf16 v[128:131], v[216:219], v[192:195], v[128:131]
    v_lshl_add_u32 v238, v22, 4, v238
    v_and_b32 v224, 1, v23
    v_lshl_add_u32 v238, v224, 3, v238
    v_mfma_f32_16x16x32_bf16 v[100:103], v[216:219], v[188:191], v[100:103]
    v_mfma_f32_16x16x32_bf16 v[72:75], v[216:219], v[184:187], v[72:75]
    v_mfma_f32_16x16x32_bf16 v[44:47], v[216:219], v[180:183], v[44:47]
    v_mfma_f32_16x16x32_bf16 v[48:51], v[220:223], v[180:183], v[48:51]
    v_mfma_f32_16x16x32_bf16 v[76:79], v[220:223], v[184:187], v[76:79]
    v_mfma_f32_16x16x32_bf16 v[104:107], v[220:223], v[188:191], v[104:107]
    v_mfma_f32_16x16x32_bf16 v[132:135], v[220:223], v[192:195], v[132:135]
    s_waitcnt lgkmcnt(0)
    v_mul_f32 v184, 0xc0135761, v165
    v_mul_f32 v185, v165, v165
    v_mul_f32 v185, v185, v184
    v_mul_f32 v185, 0x3d372713, v185
    v_rcp_f32 v165, v165
    v_mul_f32 v186, 0xc0135761, v167
    v_mul_f32 v187, v167, v167
    v_mul_f32 v187, v187, v186
    v_mul_f32 v187, 0x3d372713, v187
    v_rcp_f32 v167, v167
    v_mul_f32 v188, 0xc0135761, v169
    v_mul_f32 v189, v169, v169
    v_mul_f32 v189, v189, v188
    v_mul_f32 v189, 0x3d372713, v189
    v_rcp_f32 v169, v169
    v_mul_f32 v190, 0xc0135761, v171
    v_mul_f32 v191, v171, v171
    v_mul_f32 v191, v191, v190
    v_mul_f32 v191, 0x3d372713, v191
    v_rcp_f32 v171, v171
    s_cmp_eq_u32 s35, 1
    s_cbranch_scc1 G3_e1
    v_pk_fma_f32 v[24:25], v[164:165], v[136:137], v[24:25] op_sel_hi:[0,1,1] neg_lo:[1,0,0] neg_hi:[1,0,0]
    v_pk_fma_f32 v[26:27], v[164:165], v[138:139], v[26:27] op_sel_hi:[0,1,1] neg_lo:[1,0,0] neg_hi:[1,0,0]
    v_pk_mul_f32 v[226:227], v[24:25], v[24:25]
    v_pk_mul_f32 v[228:229], v[26:27], v[26:27]
    v_pk_fma_f32 v[226:227], v[226:227], v[184:185], v[184:185] op_sel:[0,1,0] op_sel_hi:[1,1,0]
    v_pk_fma_f32 v[228:229], v[228:229], v[184:185], v[184:185] op_sel:[0,1,0] op_sel_hi:[1,1,0]
    v_pk_mul_f32 v[226:227], v[226:227], v[24:25]
    v_pk_mul_f32 v[228:229], v[228:229], v[26:27]
    v_exp_f32 v226, v226
    v_exp_f32 v227, v227
    v_exp_f32 v228, v228
    v_exp_f32 v229, v229
    v_pk_fma_f32 v[226:227], v[226:227], v[164:165], v[164:165] op_sel:[0,1,1] op_sel_hi:[1,1,1]
    v_pk_fma_f32 v[228:229], v[228:229], v[164:165], v[164:165] op_sel:[0,1,1] op_sel_hi:[1,1,1]
    v_rcp_f32 v226, v226
    v_rcp_f32 v227, v227
    v_rcp_f32 v228, v228
    v_rcp_f32 v229, v229
    v_pk_mul_f32 v[24:25], v[24:25], v[226:227]
    v_pk_mul_f32 v[26:27], v[26:27], v[228:229]
    v_pk_fma_f32 v[28:29], v[164:165], v[140:141], v[28:29] op_sel_hi:[0,1,1] neg_lo:[1,0,0] neg_hi:[1,0,0]
    v_pk_fma_f32 v[30:31], v[164:165], v[142:143], v[30:31] op_sel_hi:[0,1,1] neg_lo:[1,0,0] neg_hi:[1,0,0]
    v_pk_mul_f32 v[226:227], v[28:29], v[28:29]
    v_pk_mul_f32 v[228:229], v[30:31], v[30:31]
    v_pk_fma_f32 v[226:227], v[226:227], v[184:185], v[184:185] op_sel:[0,1,0] op_sel_hi:[1,1,0]
    v_pk_fma_f32 v[228:229], v[228:229], v[184:185], v[184:185] op_sel:[0,1,0] op_sel_hi:[1,1,0]
    v_pk_mul_f32 v[226:227], v[226:227], v[28:29]
    v_pk_mul_f32 v[228:229], v[228:229], v[30:31]
    v_exp_f32 v226, v226
    v_exp_f32 v227, v227
    v_exp_f32 v228, v228
    v_exp_f32 v229, v229
    v_pk_fma_f32 v[226:227], v[226:227], v[164:165], v[164:165] op_sel:[0,1,1] op_sel_hi:[1,1,1]
    v_pk_fma_f32 v[228:229], v[228:229], v[164:165], v[164:165] op_sel:[0,1,1] op_sel_hi:[1,1,1]
    v_rcp_f32 v226, v226
    v_rcp_f32 v227, v227
    v_rcp_f32 v228, v228
    v_rcp_f32 v229, v229
    v_pk_mul_f32 v[28:29], v[28:29], v[226:227]
    v_pk_mul_f32 v[30:31], v[30:31], v[228:229]
    v_cvt_pk_bf16_f32 v24, v24, v25
    v_cvt_pk_bf16_f32 v25, v26, v27
    v_cvt_pk_bf16_f32 v26, v28, v29
    v_cvt_pk_bf16_f32 v27, v30, v31
    ds_write_b128 v12, v[24:27] offset:0
    s_add_u32 s36, s44, 0
    buffer_store_dwordx4 v[24:27], v2, s[16:19], s36 offen sc1
    v_pk_fma_f32 v[52:53], v[166:167], v[136:137], v[52:53] op_sel_hi:[0,1,1] neg_lo:[1,0,0] neg_hi:[1,0,0]
    v_pk_fma_f32 v[54:55], v[166:167], v[138:139], v[54:55] op_sel_hi:[0,1,1] neg_lo:[1,0,0] neg_hi:[1,0,0]
    v_pk_mul_f32 v[226:227], v[52:53], v[52:53]
    v_pk_mul_f32 v[228:229], v[54:55], v[54:55]
    v_pk_fma_f32 v[226:227], v[226:227], v[186:187], v[186:187] op_sel:[0,1,0] op_sel_hi:[1,1,0]
    v_pk_fma_f32 v[228:229], v[228:229], v[186:187], v[186:187] op_sel:[0,1,0] op_sel_hi:[1,1,0]
    v_pk_mul_f32 v[226:227], v[226:227], v[52:53]
    v_pk_mul_f32 v[228:229], v[228:229], v[54:55]
    v_exp_f32 v226, v226
    v_exp_f32 v227, v227
    v_exp_f32 v228, v228
    v_exp_f32 v229, v229
    v_pk_fma_f32 v[226:227], v[226:227], v[166:167], v[166:167] op_sel:[0,1,1] op_sel_hi:[1,1,1]
    v_pk_fma_f32 v[228:229], v[228:229], v[166:167], v[166:167] op_sel:[0,1,1] op_sel_hi:[1,1,1]
    v_rcp_f32 v226, v226
    v_rcp_f32 v227, v227
    v_rcp_f32 v228, v228
    v_rcp_f32 v229, v229
    v_pk_mul_f32 v[52:53], v[52:53], v[226:227]
    v_pk_mul_f32 v[54:55], v[54:55], v[228:229]
    v_pk_fma_f32 v[56:57], v[166:167], v[140:141], v[56:57] op_sel_hi:[0,1,1] neg_lo:[1,0,0] neg_hi:[1,0,0]
    v_pk_fma_f32 v[58:59], v[166:167], v[142:143], v[58:59] op_sel_hi:[0,1,1] neg_lo:[1,0,0] neg_hi:[1,0,0]
    v_pk_mul_f32 v[226:227], v[56:57], v[56:57]
    v_pk_mul_f32 v[228:229], v[58:59], v[58:59]
    v_pk_fma_f32 v[226:227], v[226:227], v[186:187], v[186:187] op_sel:[0,1,0] op_sel_hi:[1,1,0]
    v_pk_fma_f32 v[228:229], v[228:229], v[186:187], v[186:187] op_sel:[0,1,0] op_sel_hi:[1,1,0]
    v_pk_mul_f32 v[226:227], v[226:227], v[56:57]
    v_pk_mul_f32 v[228:229], v[228:229], v[58:59]
    v_exp_f32 v226, v226
    v_exp_f32 v227, v227
    v_exp_f32 v228, v228
    v_exp_f32 v229, v229
    v_pk_fma_f32 v[226:227], v[226:227], v[166:167], v[166:167] op_sel:[0,1,1] op_sel_hi:[1,1,1]
    v_pk_fma_f32 v[228:229], v[228:229], v[166:167], v[166:167] op_sel:[0,1,1] op_sel_hi:[1,1,1]
    v_rcp_f32 v226, v226
    v_rcp_f32 v227, v227
    v_rcp_f32 v228, v228
    v_rcp_f32 v229, v229
    v_pk_mul_f32 v[56:57], v[56:57], v[226:227]
    v_pk_mul_f32 v[58:59], v[58:59], v[228:229]
    v_cvt_pk_bf16_f32 v52, v52, v53
    v_cvt_pk_bf16_f32 v53, v54, v55
    v_cvt_pk_bf16_f32 v54, v56, v57
    v_cvt_pk_bf16_f32 v55, v58, v59
    ds_write_b128 v12, v[52:55] offset:2048
    s_add_u32 s36, s44, 229376
    buffer_store_dwordx4 v[52:55], v2, s[16:19], s36 offen sc1
    v_pk_fma_f32 v[80:81], v[168:169], v[136:137], v[80:81] op_sel_hi:[0,1,1] neg_lo:[1,0,0] neg_hi:[1,0,0]
    v_pk_fma_f32 v[82:83], v[168:169], v[138:139], v[82:83] op_sel_hi:[0,1,1] neg_lo:[1,0,0] neg_hi:[1,0,0]
    v_pk_mul_f32 v[226:227], v[80:81], v[80:81]
    v_pk_mul_f32 v[228:229], v[82:83], v[82:83]
    v_pk_fma_f32 v[226:227], v[226:227], v[188:189], v[188:189] op_sel:[0,1,0] op_sel_hi:[1,1,0]
    v_pk_fma_f32 v[228:229], v[228:229], v[188:189], v[188:189] op_sel:[0,1,0] op_sel_hi:[1,1,0]
    v_pk_mul_f32 v[226:227], v[226:227], v[80:81]
    v_pk_mul_f32 v[228:229], v[228:229], v[82:83]
    v_exp_f32 v226, v226
    v_exp_f32 v227, v227
    v_exp_f32 v228, v228
    v_exp_f32 v229, v229
    v_pk_fma_f32 v[226:227], v[226:227], v[168:169], v[168:169] op_sel:[0,1,1] op_sel_hi:[1,1,1]
    v_pk_fma_f32 v[228:229], v[228:229], v[168:169], v[168:169] op_sel:[0,1,1] op_sel_hi:[1,1,1]
    v_rcp_f32 v226, v226
    v_rcp_f32 v227, v227
    v_rcp_f32 v228, v228
    v_rcp_f32 v229, v229
    v_pk_mul_f32 v[80:81], v[80:81], v[226:227]
    v_pk_mul_f32 v[82:83], v[82:83], v[228:229]
    v_pk_fma_f32 v[84:85], v[168:169], v[140:141], v[84:85] op_sel_hi:[0,1,1] neg_lo:[1,0,0] neg_hi:[1,0,0]
    v_pk_fma_f32 v[86:87], v[168:169], v[142:143], v[86:87] op_sel_hi:[0,1,1] neg_lo:[1,0,0] neg_hi:[1,0,0]
    v_pk_mul_f32 v[226:227], v[84:85], v[84:85]
    v_pk_mul_f32 v[228:229], v[86:87], v[86:87]
    v_pk_fma_f32 v[226:227], v[226:227], v[188:189], v[188:189] op_sel:[0,1,0] op_sel_hi:[1,1,0]
    v_pk_fma_f32 v[228:229], v[228:229], v[188:189], v[188:189] op_sel:[0,1,0] op_sel_hi:[1,1,0]
    v_pk_mul_f32 v[226:227], v[226:227], v[84:85]
    v_pk_mul_f32 v[228:229], v[228:229], v[86:87]
    v_exp_f32 v226, v226
    v_exp_f32 v227, v227
    v_exp_f32 v228, v228
    v_exp_f32 v229, v229
    v_pk_fma_f32 v[226:227], v[226:227], v[168:169], v[168:169] op_sel:[0,1,1] op_sel_hi:[1,1,1]
    v_pk_fma_f32 v[228:229], v[228:229], v[168:169], v[168:169] op_sel:[0,1,1] op_sel_hi:[1,1,1]
    v_rcp_f32 v226, v226
    v_rcp_f32 v227, v227
    v_rcp_f32 v228, v228
    v_rcp_f32 v229, v229
    v_pk_mul_f32 v[84:85], v[84:85], v[226:227]
    v_pk_mul_f32 v[86:87], v[86:87], v[228:229]
    v_cvt_pk_bf16_f32 v80, v80, v81
    v_cvt_pk_bf16_f32 v81, v82, v83
    v_cvt_pk_bf16_f32 v82, v84, v85
    v_cvt_pk_bf16_f32 v83, v86, v87
    ds_write_b128 v12, v[80:83] offset:4096
    s_add_u32 s36, s44, 458752
    buffer_store_dwordx4 v[80:83], v2, s[16:19], s36 offen sc1
    v_pk_fma_f32 v[108:109], v[170:171], v[136:137], v[108:109] op_sel_hi:[0,1,1] neg_lo:[1,0,0] neg_hi:[1,0,0]
    v_pk_fma_f32 v[110:111], v[170:171], v[138:139], v[110:111] op_sel_hi:[0,1,1] neg_lo:[1,0,0] neg_hi:[1,0,0]
    v_pk_mul_f32 v[226:227], v[108:109], v[108:109]
    v_pk_mul_f32 v[228:229], v[110:111], v[110:111]
    v_pk_fma_f32 v[226:227], v[226:227], v[190:191], v[190:191] op_sel:[0,1,0] op_sel_hi:[1,1,0]
    v_pk_fma_f32 v[228:229], v[228:229], v[190:191], v[190:191] op_sel:[0,1,0] op_sel_hi:[1,1,0]
    v_pk_mul_f32 v[226:227], v[226:227], v[108:109]
    v_pk_mul_f32 v[228:229], v[228:229], v[110:111]
    v_exp_f32 v226, v226
    v_exp_f32 v227, v227
    v_exp_f32 v228, v228
    v_exp_f32 v229, v229
    v_pk_fma_f32 v[226:227], v[226:227], v[170:171], v[170:171] op_sel:[0,1,1] op_sel_hi:[1,1,1]
    v_pk_fma_f32 v[228:229], v[228:229], v[170:171], v[170:171] op_sel:[0,1,1] op_sel_hi:[1,1,1]
    v_rcp_f32 v226, v226
    v_rcp_f32 v227, v227
    v_rcp_f32 v228, v228
    v_rcp_f32 v229, v229
    v_pk_mul_f32 v[108:109], v[108:109], v[226:227]
    v_pk_mul_f32 v[110:111], v[110:111], v[228:229]
    v_pk_fma_f32 v[112:113], v[170:171], v[140:141], v[112:113] op_sel_hi:[0,1,1] neg_lo:[1,0,0] neg_hi:[1,0,0]
    v_pk_fma_f32 v[114:115], v[170:171], v[142:143], v[114:115] op_sel_hi:[0,1,1] neg_lo:[1,0,0] neg_hi:[1,0,0]
    v_pk_mul_f32 v[226:227], v[112:113], v[112:113]
    v_pk_mul_f32 v[228:229], v[114:115], v[114:115]
    v_pk_fma_f32 v[226:227], v[226:227], v[190:191], v[190:191] op_sel:[0,1,0] op_sel_hi:[1,1,0]
    v_pk_fma_f32 v[228:229], v[228:229], v[190:191], v[190:191] op_sel:[0,1,0] op_sel_hi:[1,1,0]
    v_pk_mul_f32 v[226:227], v[226:227], v[112:113]
    v_pk_mul_f32 v[228:229], v[228:229], v[114:115]
    v_exp_f32 v226, v226
    v_exp_f32 v227, v227
    v_exp_f32 v228, v228
    v_exp_f32 v229, v229
    v_pk_fma_f32 v[226:227], v[226:227], v[170:171], v[170:171] op_sel:[0,1,1] op_sel_hi:[1,1,1]
    v_pk_fma_f32 v[228:229], v[228:229], v[170:171], v[170:171] op_sel:[0,1,1] op_sel_hi:[1,1,1]
    v_rcp_f32 v226, v226
    v_rcp_f32 v227, v227
    v_rcp_f32 v228, v228
    v_rcp_f32 v229, v229
    v_pk_mul_f32 v[112:113], v[112:113], v[226:227]
    v_pk_mul_f32 v[114:115], v[114:115], v[228:229]
    v_cvt_pk_bf16_f32 v108, v108, v109
    v_cvt_pk_bf16_f32 v109, v110, v111
    v_cvt_pk_bf16_f32 v110, v112, v113
    v_cvt_pk_bf16_f32 v111, v114, v115
    ds_write_b128 v12, v[108:111] offset:6144
    s_add_u32 s36, s44, 688128
    buffer_store_dwordx4 v[108:111], v2, s[16:19], s36 offen sc1
    v_pk_fma_f32 v[32:33], v[164:165], v[144:145], v[32:33] op_sel_hi:[0,1,1] neg_lo:[1,0,0] neg_hi:[1,0,0]
    v_pk_fma_f32 v[34:35], v[164:165], v[146:147], v[34:35] op_sel_hi:[0,1,1] neg_lo:[1,0,0] neg_hi:[1,0,0]
    v_pk_mul_f32 v[226:227], v[32:33], v[32:33]
    v_pk_mul_f32 v[228:229], v[34:35], v[34:35]
    v_pk_fma_f32 v[226:227], v[226:227], v[184:185], v[184:185] op_sel:[0,1,0] op_sel_hi:[1,1,0]
    v_pk_fma_f32 v[228:229], v[228:229], v[184:185], v[184:185] op_sel:[0,1,0] op_sel_hi:[1,1,0]
    v_pk_mul_f32 v[226:227], v[226:227], v[32:33]
    v_pk_mul_f32 v[228:229], v[228:229], v[34:35]
    v_exp_f32 v226, v226
    v_exp_f32 v227, v227
    v_exp_f32 v228, v228
    v_exp_f32 v229, v229
    v_pk_fma_f32 v[226:227], v[226:227], v[164:165], v[164:165] op_sel:[0,1,1] op_sel_hi:[1,1,1]
    v_pk_fma_f32 v[228:229], v[228:229], v[164:165], v[164:165] op_sel:[0,1,1] op_sel_hi:[1,1,1]
    v_rcp_f32 v226, v226
    v_rcp_f32 v227, v227
    v_rcp_f32 v228, v228
    v_rcp_f32 v229, v229
    v_pk_mul_f32 v[32:33], v[32:33], v[226:227]
    v_pk_mul_f32 v[34:35], v[34:35], v[228:229]
    v_pk_fma_f32 v[36:37], v[164:165], v[148:149], v[36:37] op_sel_hi:[0,1,1] neg_lo:[1,0,0] neg_hi:[1,0,0]
    v_pk_fma_f32 v[38:39], v[164:165], v[150:151], v[38:39] op_sel_hi:[0,1,1] neg_lo:[1,0,0] neg_hi:[1,0,0]
    v_pk_mul_f32 v[226:227], v[36:37], v[36:37]
    v_pk_mul_f32 v[228:229], v[38:39], v[38:39]
    v_pk_fma_f32 v[226:227], v[226:227], v[184:185], v[184:185] op_sel:[0,1,0] op_sel_hi:[1,1,0]
    v_pk_fma_f32 v[228:229], v[228:229], v[184:185], v[184:185] op_sel:[0,1,0] op_sel_hi:[1,1,0]
    v_pk_mul_f32 v[226:227], v[226:227], v[36:37]
    v_pk_mul_f32 v[228:229], v[228:229], v[38:39]
    v_exp_f32 v226, v226
    v_exp_f32 v227, v227
    v_exp_f32 v228, v228
    v_exp_f32 v229, v229
    v_pk_fma_f32 v[226:227], v[226:227], v[164:165], v[164:165] op_sel:[0,1,1] op_sel_hi:[1,1,1]
    v_pk_fma_f32 v[228:229], v[228:229], v[164:165], v[164:165] op_sel:[0,1,1] op_sel_hi:[1,1,1]
    v_rcp_f32 v226, v226
    v_rcp_f32 v227, v227
    v_rcp_f32 v228, v228
    v_rcp_f32 v229, v229
    v_pk_mul_f32 v[36:37], v[36:37], v[226:227]
    v_pk_mul_f32 v[38:39], v[38:39], v[228:229]
    v_cvt_pk_bf16_f32 v32, v32, v33
    v_cvt_pk_bf16_f32 v33, v34, v35
    v_cvt_pk_bf16_f32 v34, v36, v37
    v_cvt_pk_bf16_f32 v35, v38, v39
    ds_write_b128 v12, v[32:35] offset:16384
    s_add_u32 s53, s55, 1792
    s_lshl_b32 s54, s31, 7
    s_add_u32 s53, s53, s54
    v_mov_b32 v8, 1
    v_mov_b32 v9, 162864
    v_mov_b32 v11, 0
    s_mov_b64 exec, 1
    s_waitcnt vmcnt(0)
    ds_add_rtn_u32 v10, v9, v8
    s_waitcnt lgkmcnt(0)
    v_readfirstlane_b32 s54, v10
    s_nop 0
    s_and_b32 s54, s54, 3
    s_cmp_lg_u32 s54, 3
    s_cbranch_scc1 pub_27
    buffer_atomic_add v8, v11, s[56:59], s53 offen sc1
    v_mov_b32 v9, 162872
    ds_add_u32 v9, v8
pub_27:
    s_mov_b64 exec, -1
    v_pk_fma_f32 v[60:61], v[166:167], v[144:145], v[60:61] op_sel_hi:[0,1,1] neg_lo:[1,0,0] neg_hi:[1,0,0]
    v_pk_fma_f32 v[62:63], v[166:167], v[146:147], v[62:63] op_sel_hi:[0,1,1] neg_lo:[1,0,0] neg_hi:[1,0,0]
    v_pk_mul_f32 v[226:227], v[60:61], v[60:61]
    v_pk_mul_f32 v[228:229], v[62:63], v[62:63]
    v_pk_fma_f32 v[226:227], v[226:227], v[186:187], v[186:187] op_sel:[0,1,0] op_sel_hi:[1,1,0]
    v_pk_fma_f32 v[228:229], v[228:229], v[186:187], v[186:187] op_sel:[0,1,0] op_sel_hi:[1,1,0]
    v_pk_mul_f32 v[226:227], v[226:227], v[60:61]
    v_pk_mul_f32 v[228:229], v[228:229], v[62:63]
    v_exp_f32 v226, v226
    v_exp_f32 v227, v227
    v_exp_f32 v228, v228
    v_exp_f32 v229, v229
    v_pk_fma_f32 v[226:227], v[226:227], v[166:167], v[166:167] op_sel:[0,1,1] op_sel_hi:[1,1,1]
    v_pk_fma_f32 v[228:229], v[228:229], v[166:167], v[166:167] op_sel:[0,1,1] op_sel_hi:[1,1,1]
    v_rcp_f32 v226, v226
    v_rcp_f32 v227, v227
    v_rcp_f32 v228, v228
    v_rcp_f32 v229, v229
    v_pk_mul_f32 v[60:61], v[60:61], v[226:227]
    v_pk_mul_f32 v[62:63], v[62:63], v[228:229]
    v_pk_fma_f32 v[64:65], v[166:167], v[148:149], v[64:65] op_sel_hi:[0,1,1] neg_lo:[1,0,0] neg_hi:[1,0,0]
    v_pk_fma_f32 v[66:67], v[166:167], v[150:151], v[66:67] op_sel_hi:[0,1,1] neg_lo:[1,0,0] neg_hi:[1,0,0]
    v_pk_mul_f32 v[226:227], v[64:65], v[64:65]
    v_pk_mul_f32 v[228:229], v[66:67], v[66:67]
    v_pk_fma_f32 v[226:227], v[226:227], v[186:187], v[186:187] op_sel:[0,1,0] op_sel_hi:[1,1,0]
    v_pk_fma_f32 v[228:229], v[228:229], v[186:187], v[186:187] op_sel:[0,1,0] op_sel_hi:[1,1,0]
    v_pk_mul_f32 v[226:227], v[226:227], v[64:65]
    v_pk_mul_f32 v[228:229], v[228:229], v[66:67]
    v_exp_f32 v226, v226
    v_exp_f32 v227, v227
    v_exp_f32 v228, v228
    v_exp_f32 v229, v229
    v_pk_fma_f32 v[226:227], v[226:227], v[166:167], v[166:167] op_sel:[0,1,1] op_sel_hi:[1,1,1]
    v_pk_fma_f32 v[228:229], v[228:229], v[166:167], v[166:167] op_sel:[0,1,1] op_sel_hi:[1,1,1]
    v_rcp_f32 v226, v226
    v_rcp_f32 v227, v227
    v_rcp_f32 v228, v228
    v_rcp_f32 v229, v229
    v_pk_mul_f32 v[64:65], v[64:65], v[226:227]
    v_pk_mul_f32 v[66:67], v[66:67], v[228:229]
    v_cvt_pk_bf16_f32 v60, v60, v61
    v_cvt_pk_bf16_f32 v61, v62, v63
    v_cvt_pk_bf16_f32 v62, v64, v65
    v_cvt_pk_bf16_f32 v63, v66, v67
    ds_write_b128 v12, v[60:63] offset:18432
    v_pk_fma_f32 v[88:89], v[168:169], v[144:145], v[88:89] op_sel_hi:[0,1,1] neg_lo:[1,0,0] neg_hi:[1,0,0]
    v_pk_fma_f32 v[90:91], v[168:169], v[146:147], v[90:91] op_sel_hi:[0,1,1] neg_lo:[1,0,0] neg_hi:[1,0,0]
    v_pk_mul_f32 v[226:227], v[88:89], v[88:89]
    v_pk_mul_f32 v[228:229], v[90:91], v[90:91]
    v_pk_fma_f32 v[226:227], v[226:227], v[188:189], v[188:189] op_sel:[0,1,0] op_sel_hi:[1,1,0]
    v_pk_fma_f32 v[228:229], v[228:229], v[188:189], v[188:189] op_sel:[0,1,0] op_sel_hi:[1,1,0]
    v_pk_mul_f32 v[226:227], v[226:227], v[88:89]
    v_pk_mul_f32 v[228:229], v[228:229], v[90:91]
    v_exp_f32 v226, v226
    v_exp_f32 v227, v227
    v_exp_f32 v228, v228
    v_exp_f32 v229, v229
    v_pk_fma_f32 v[226:227], v[226:227], v[168:169], v[168:169] op_sel:[0,1,1] op_sel_hi:[1,1,1]
    v_pk_fma_f32 v[228:229], v[228:229], v[168:169], v[168:169] op_sel:[0,1,1] op_sel_hi:[1,1,1]
    v_rcp_f32 v226, v226
    v_rcp_f32 v227, v227
    v_rcp_f32 v228, v228
    v_rcp_f32 v229, v229
    v_pk_mul_f32 v[88:89], v[88:89], v[226:227]
    v_pk_mul_f32 v[90:91], v[90:91], v[228:229]
    v_pk_fma_f32 v[92:93], v[168:169], v[148:149], v[92:93] op_sel_hi:[0,1,1] neg_lo:[1,0,0] neg_hi:[1,0,0]
    v_pk_fma_f32 v[94:95], v[168:169], v[150:151], v[94:95] op_sel_hi:[0,1,1] neg_lo:[1,0,0] neg_hi:[1,0,0]
    v_pk_mul_f32 v[226:227], v[92:93], v[92:93]
    v_pk_mul_f32 v[228:229], v[94:95], v[94:95]
    v_pk_fma_f32 v[226:227], v[226:227], v[188:189], v[188:189] op_sel:[0,1,0] op_sel_hi:[1,1,0]
    v_pk_fma_f32 v[228:229], v[228:229], v[188:189], v[188:189] op_sel:[0,1,0] op_sel_hi:[1,1,0]
    v_pk_mul_f32 v[226:227], v[226:227], v[92:93]
    v_pk_mul_f32 v[228:229], v[228:229], v[94:95]
    v_exp_f32 v226, v226
    v_exp_f32 v227, v227
    v_exp_f32 v228, v228
    v_exp_f32 v229, v229
    v_pk_fma_f32 v[226:227], v[226:227], v[168:169], v[168:169] op_sel:[0,1,1] op_sel_hi:[1,1,1]
    v_pk_fma_f32 v[228:229], v[228:229], v[168:169], v[168:169] op_sel:[0,1,1] op_sel_hi:[1,1,1]
    v_rcp_f32 v226, v226
    v_rcp_f32 v227, v227
    v_rcp_f32 v228, v228
    v_rcp_f32 v229, v229
    v_pk_mul_f32 v[92:93], v[92:93], v[226:227]
    v_pk_mul_f32 v[94:95], v[94:95], v[228:229]
    v_cvt_pk_bf16_f32 v88, v88, v89
    v_cvt_pk_bf16_f32 v89, v90, v91
    v_cvt_pk_bf16_f32 v90, v92, v93
    v_cvt_pk_bf16_f32 v91, v94, v95
    ds_write_b128 v12, v[88:91] offset:20480
    v_pk_fma_f32 v[116:117], v[170:171], v[144:145], v[116:117] op_sel_hi:[0,1,1] neg_lo:[1,0,0] neg_hi:[1,0,0]
    v_pk_fma_f32 v[118:119], v[170:171], v[146:147], v[118:119] op_sel_hi:[0,1,1] neg_lo:[1,0,0] neg_hi:[1,0,0]
    v_pk_mul_f32 v[226:227], v[116:117], v[116:117]
    v_pk_mul_f32 v[228:229], v[118:119], v[118:119]
    v_pk_fma_f32 v[226:227], v[226:227], v[190:191], v[190:191] op_sel:[0,1,0] op_sel_hi:[1,1,0]
    v_pk_fma_f32 v[228:229], v[228:229], v[190:191], v[190:191] op_sel:[0,1,0] op_sel_hi:[1,1,0]
    v_pk_mul_f32 v[226:227], v[226:227], v[116:117]
    v_pk_mul_f32 v[228:229], v[228:229], v[118:119]
    v_exp_f32 v226, v226
    v_exp_f32 v227, v227
    v_exp_f32 v228, v228
    v_exp_f32 v229, v229
    v_pk_fma_f32 v[226:227], v[226:227], v[170:171], v[170:171] op_sel:[0,1,1] op_sel_hi:[1,1,1]
    v_pk_fma_f32 v[228:229], v[228:229], v[170:171], v[170:171] op_sel:[0,1,1] op_sel_hi:[1,1,1]
    v_rcp_f32 v226, v226
    v_rcp_f32 v227, v227
    v_rcp_f32 v228, v228
    v_rcp_f32 v229, v229
    v_pk_mul_f32 v[116:117], v[116:117], v[226:227]
    v_pk_mul_f32 v[118:119], v[118:119], v[228:229]
    v_pk_fma_f32 v[120:121], v[170:171], v[148:149], v[120:121] op_sel_hi:[0,1,1] neg_lo:[1,0,0] neg_hi:[1,0,0]
    v_pk_fma_f32 v[122:123], v[170:171], v[150:151], v[122:123] op_sel_hi:[0,1,1] neg_lo:[1,0,0] neg_hi:[1,0,0]
    v_pk_mul_f32 v[226:227], v[120:121], v[120:121]
    v_pk_mul_f32 v[228:229], v[122:123], v[122:123]
    v_pk_fma_f32 v[226:227], v[226:227], v[190:191], v[190:191] op_sel:[0,1,0] op_sel_hi:[1,1,0]
    v_pk_fma_f32 v[228:229], v[228:229], v[190:191], v[190:191] op_sel:[0,1,0] op_sel_hi:[1,1,0]
    v_pk_mul_f32 v[226:227], v[226:227], v[120:121]
    v_pk_mul_f32 v[228:229], v[228:229], v[122:123]
    v_exp_f32 v226, v226
    v_exp_f32 v227, v227
    v_exp_f32 v228, v228
    v_exp_f32 v229, v229
    v_pk_fma_f32 v[226:227], v[226:227], v[170:171], v[170:171] op_sel:[0,1,1] op_sel_hi:[1,1,1]
    v_pk_fma_f32 v[228:229], v[228:229], v[170:171], v[170:171] op_sel:[0,1,1] op_sel_hi:[1,1,1]
    v_rcp_f32 v226, v226
    v_rcp_f32 v227, v227
    v_rcp_f32 v228, v228
    v_rcp_f32 v229, v229
    v_pk_mul_f32 v[120:121], v[120:121], v[226:227]
    v_pk_mul_f32 v[122:123], v[122:123], v[228:229]
    v_cvt_pk_bf16_f32 v116, v116, v117
    v_cvt_pk_bf16_f32 v117, v118, v119
    v_cvt_pk_bf16_f32 v118, v120, v121
    v_cvt_pk_bf16_f32 v119, v122, v123
    ds_write_b128 v12, v[116:119] offset:22528
    v_pk_fma_f32 v[40:41], v[164:165], v[152:153], v[40:41] op_sel_hi:[0,1,1] neg_lo:[1,0,0] neg_hi:[1,0,0]
    v_pk_fma_f32 v[42:43], v[164:165], v[154:155], v[42:43] op_sel_hi:[0,1,1] neg_lo:[1,0,0] neg_hi:[1,0,0]
    v_pk_mul_f32 v[226:227], v[40:41], v[40:41]
    v_pk_mul_f32 v[228:229], v[42:43], v[42:43]
    v_pk_fma_f32 v[226:227], v[226:227], v[184:185], v[184:185] op_sel:[0,1,0] op_sel_hi:[1,1,0]
    v_pk_fma_f32 v[228:229], v[228:229], v[184:185], v[184:185] op_sel:[0,1,0] op_sel_hi:[1,1,0]
    v_pk_mul_f32 v[226:227], v[226:227], v[40:41]
    v_pk_mul_f32 v[228:229], v[228:229], v[42:43]
    v_exp_f32 v226, v226
    v_exp_f32 v227, v227
    v_exp_f32 v228, v228
    v_exp_f32 v229, v229
    v_pk_fma_f32 v[226:227], v[226:227], v[164:165], v[164:165] op_sel:[0,1,1] op_sel_hi:[1,1,1]
    v_pk_fma_f32 v[228:229], v[228:229], v[164:165], v[164:165] op_sel:[0,1,1] op_sel_hi:[1,1,1]
    v_rcp_f32 v226, v226
    v_rcp_f32 v227, v227
    v_rcp_f32 v228, v228
    v_rcp_f32 v229, v229
    v_pk_mul_f32 v[40:41], v[40:41], v[226:227]
    v_pk_mul_f32 v[42:43], v[42:43], v[228:229]
    v_pk_fma_f32 v[44:45], v[164:165], v[156:157], v[44:45] op_sel_hi:[0,1,1] neg_lo:[1,0,0] neg_hi:[1,0,0]
    v_pk_fma_f32 v[46:47], v[164:165], v[158:159], v[46:47] op_sel_hi:[0,1,1] neg_lo:[1,0,0] neg_hi:[1,0,0]
    v_pk_mul_f32 v[226:227], v[44:45], v[44:45]
    v_pk_mul_f32 v[228:229], v[46:47], v[46:47]
    v_pk_fma_f32 v[226:227], v[226:227], v[184:185], v[184:185] op_sel:[0,1,0] op_sel_hi:[1,1,0]
    v_pk_fma_f32 v[228:229], v[228:229], v[184:185], v[184:185] op_sel:[0,1,0] op_sel_hi:[1,1,0]
    v_pk_mul_f32 v[226:227], v[226:227], v[44:45]
    v_pk_mul_f32 v[228:229], v[228:229], v[46:47]
    v_exp_f32 v226, v226
    v_exp_f32 v227, v227
    v_exp_f32 v228, v228
    v_exp_f32 v229, v229
    v_pk_fma_f32 v[226:227], v[226:227], v[164:165], v[164:165] op_sel:[0,1,1] op_sel_hi:[1,1,1]
    v_pk_fma_f32 v[228:229], v[228:229], v[164:165], v[164:165] op_sel:[0,1,1] op_sel_hi:[1,1,1]
    v_rcp_f32 v226, v226
    v_rcp_f32 v227, v227
    v_rcp_f32 v228, v228
    v_rcp_f32 v229, v229
    v_pk_mul_f32 v[44:45], v[44:45], v[226:227]
    v_pk_mul_f32 v[46:47], v[46:47], v[228:229]
    v_cvt_pk_bf16_f32 v200, v40, v41
    v_cvt_pk_bf16_f32 v201, v42, v43
    v_cvt_pk_bf16_f32 v202, v44, v45
    v_cvt_pk_bf16_f32 v203, v46, v47
    ds_write_b128 v12, v[200:203] offset:32768
    v_pk_fma_f32 v[68:69], v[166:167], v[152:153], v[68:69] op_sel_hi:[0,1,1] neg_lo:[1,0,0] neg_hi:[1,0,0]
    v_pk_fma_f32 v[70:71], v[166:167], v[154:155], v[70:71] op_sel_hi:[0,1,1] neg_lo:[1,0,0] neg_hi:[1,0,0]
    v_pk_mul_f32 v[226:227], v[68:69], v[68:69]
    v_pk_mul_f32 v[228:229], v[70:71], v[70:71]
    v_pk_fma_f32 v[226:227], v[226:227], v[186:187], v[186:187] op_sel:[0,1,0] op_sel_hi:[1,1,0]
    v_pk_fma_f32 v[228:229], v[228:229], v[186:187], v[186:187] op_sel:[0,1,0] op_sel_hi:[1,1,0]
    v_pk_mul_f32 v[226:227], v[226:227], v[68:69]
    v_pk_mul_f32 v[228:229], v[228:229], v[70:71]
    v_exp_f32 v226, v226
    v_exp_f32 v227, v227
    v_exp_f32 v228, v228
    v_exp_f32 v229, v229
    v_pk_fma_f32 v[226:227], v[226:227], v[166:167], v[166:167] op_sel:[0,1,1] op_sel_hi:[1,1,1]
    v_pk_fma_f32 v[228:229], v[228:229], v[166:167], v[166:167] op_sel:[0,1,1] op_sel_hi:[1,1,1]
    v_rcp_f32 v226, v226
    v_rcp_f32 v227, v227
    v_rcp_f32 v228, v228
    v_rcp_f32 v229, v229
    v_pk_mul_f32 v[68:69], v[68:69], v[226:227]
    v_pk_mul_f32 v[70:71], v[70:71], v[228:229]
    v_pk_fma_f32 v[72:73], v[166:167], v[156:157], v[72:73] op_sel_hi:[0,1,1] neg_lo:[1,0,0] neg_hi:[1,0,0]
    v_pk_fma_f32 v[74:75], v[166:167], v[158:159], v[74:75] op_sel_hi:[0,1,1] neg_lo:[1,0,0] neg_hi:[1,0,0]
    v_pk_mul_f32 v[226:227], v[72:73], v[72:73]
    v_pk_mul_f32 v[228:229], v[74:75], v[74:75]
    v_pk_fma_f32 v[226:227], v[226:227], v[186:187], v[186:187] op_sel:[0,1,0] op_sel_hi:[1,1,0]
    v_pk_fma_f32 v[228:229], v[228:229], v[186:187], v[186:187] op_sel:[0,1,0] op_sel_hi:[1,1,0]
    v_pk_mul_f32 v[226:227], v[226:227], v[72:73]
    v_pk_mul_f32 v[228:229], v[228:229], v[74:75]
    v_exp_f32 v226, v226
    v_exp_f32 v227, v227
    v_exp_f32 v228, v228
    v_exp_f32 v229, v229
    v_pk_fma_f32 v[226:227], v[226:227], v[166:167], v[166:167] op_sel:[0,1,1] op_sel_hi:[1,1,1]
    v_pk_fma_f32 v[228:229], v[228:229], v[166:167], v[166:167] op_sel:[0,1,1] op_sel_hi:[1,1,1]
    v_rcp_f32 v226, v226
    v_rcp_f32 v227, v227
    v_rcp_f32 v228, v228
    v_rcp_f32 v229, v229
    v_pk_mul_f32 v[72:73], v[72:73], v[226:227]
    v_pk_mul_f32 v[74:75], v[74:75], v[228:229]
    v_cvt_pk_bf16_f32 v204, v68, v69
    v_cvt_pk_bf16_f32 v205, v70, v71
    v_cvt_pk_bf16_f32 v206, v72, v73
    v_cvt_pk_bf16_f32 v207, v74, v75
    ds_write_b128 v12, v[204:207] offset:34816
    v_pk_fma_f32 v[96:97], v[168:169], v[152:153], v[96:97] op_sel_hi:[0,1,1] neg_lo:[1,0,0] neg_hi:[1,0,0]
    v_pk_fma_f32 v[98:99], v[168:169], v[154:155], v[98:99] op_sel_hi:[0,1,1] neg_lo:[1,0,0] neg_hi:[1,0,0]
    v_pk_mul_f32 v[226:227], v[96:97], v[96:97]
    v_pk_mul_f32 v[228:229], v[98:99], v[98:99]
    v_pk_fma_f32 v[226:227], v[226:227], v[188:189], v[188:189] op_sel:[0,1,0] op_sel_hi:[1,1,0]
    v_pk_fma_f32 v[228:229], v[228:229], v[188:189], v[188:189] op_sel:[0,1,0] op_sel_hi:[1,1,0]
    v_pk_mul_f32 v[226:227], v[226:227], v[96:97]
    v_pk_mul_f32 v[228:229], v[228:229], v[98:99]
    v_exp_f32 v226, v226
    v_exp_f32 v227, v227
    v_exp_f32 v228, v228
    v_exp_f32 v229, v229
    v_pk_fma_f32 v[226:227], v[226:227], v[168:169], v[168:169] op_sel:[0,1,1] op_sel_hi:[1,1,1]
    v_pk_fma_f32 v[228:229], v[228:229], v[168:169], v[168:169] op_sel:[0,1,1] op_sel_hi:[1,1,1]
    v_rcp_f32 v226, v226
    v_rcp_f32 v227, v227
    v_rcp_f32 v228, v228
    v_rcp_f32 v229, v229
    v_pk_mul_f32 v[96:97], v[96:97], v[226:227]
    v_pk_mul_f32 v[98:99], v[98:99], v[228:229]
    v_pk_fma_f32 v[100:101], v[168:169], v[156:157], v[100:101] op_sel_hi:[0,1,1] neg_lo:[1,0,0] neg_hi:[1,0,0]
    v_pk_fma_f32 v[102:103], v[168:169], v[158:159], v[102:103] op_sel_hi:[0,1,1] neg_lo:[1,0,0] neg_hi:[1,0,0]
    v_pk_mul_f32 v[226:227], v[100:101], v[100:101]
    v_pk_mul_f32 v[228:229], v[102:103], v[102:103]
    v_pk_fma_f32 v[226:227], v[226:227], v[188:189], v[188:189] op_sel:[0,1,0] op_sel_hi:[1,1,0]
    v_pk_fma_f32 v[228:229], v[228:229], v[188:189], v[188:189] op_sel:[0,1,0] op_sel_hi:[1,1,0]
    v_pk_mul_f32 v[226:227], v[226:227], v[100:101]
    v_pk_mul_f32 v[228:229], v[228:229], v[102:103]
    v_exp_f32 v226, v226
    v_exp_f32 v227, v227
    v_exp_f32 v228, v228
    v_exp_f32 v229, v229
    v_pk_fma_f32 v[226:227], v[226:227], v[168:169], v[168:169] op_sel:[0,1,1] op_sel_hi:[1,1,1]
    v_pk_fma_f32 v[228:229], v[228:229], v[168:169], v[168:169] op_sel:[0,1,1] op_sel_hi:[1,1,1]
    v_rcp_f32 v226, v226
    v_rcp_f32 v227, v227
    v_rcp_f32 v228, v228
    v_rcp_f32 v229, v229
    v_pk_mul_f32 v[100:101], v[100:101], v[226:227]
    v_pk_mul_f32 v[102:103], v[102:103], v[228:229]
    v_cvt_pk_bf16_f32 v208, v96, v97
    v_cvt_pk_bf16_f32 v209, v98, v99
    v_cvt_pk_bf16_f32 v210, v100, v101
    v_cvt_pk_bf16_f32 v211, v102, v103
    ds_write_b128 v12, v[208:211] offset:36864
    v_pk_fma_f32 v[124:125], v[170:171], v[152:153], v[124:125] op_sel_hi:[0,1,1] neg_lo:[1,0,0] neg_hi:[1,0,0]
    v_pk_fma_f32 v[126:127], v[170:171], v[154:155], v[126:127] op_sel_hi:[0,1,1] neg_lo:[1,0,0] neg_hi:[1,0,0]
    v_pk_mul_f32 v[226:227], v[124:125], v[124:125]
    v_pk_mul_f32 v[228:229], v[126:127], v[126:127]
    v_pk_fma_f32 v[226:227], v[226:227], v[190:191], v[190:191] op_sel:[0,1,0] op_sel_hi:[1,1,0]
    v_pk_fma_f32 v[228:229], v[228:229], v[190:191], v[190:191] op_sel:[0,1,0] op_sel_hi:[1,1,0]
    v_pk_mul_f32 v[226:227], v[226:227], v[124:125]
    v_pk_mul_f32 v[228:229], v[228:229], v[126:127]
    v_exp_f32 v226, v226
    v_exp_f32 v227, v227
    v_exp_f32 v228, v228
    v_exp_f32 v229, v229
    v_pk_fma_f32 v[226:227], v[226:227], v[170:171], v[170:171] op_sel:[0,1,1] op_sel_hi:[1,1,1]
    v_pk_fma_f32 v[228:229], v[228:229], v[170:171], v[170:171] op_sel:[0,1,1] op_sel_hi:[1,1,1]
    v_rcp_f32 v226, v226
    v_rcp_f32 v227, v227
    v_rcp_f32 v228, v228
    v_rcp_f32 v229, v229
    v_pk_mul_f32 v[124:125], v[124:125], v[226:227]
    v_pk_mul_f32 v[126:127], v[126:127], v[228:229]
    v_pk_fma_f32 v[128:129], v[170:171], v[156:157], v[128:129] op_sel_hi:[0,1,1] neg_lo:[1,0,0] neg_hi:[1,0,0]
    v_pk_fma_f32 v[130:131], v[170:171], v[158:159], v[130:131] op_sel_hi:[0,1,1] neg_lo:[1,0,0] neg_hi:[1,0,0]
    v_pk_mul_f32 v[226:227], v[128:129], v[128:129]
    v_pk_mul_f32 v[228:229], v[130:131], v[130:131]
    v_pk_fma_f32 v[226:227], v[226:227], v[190:191], v[190:191] op_sel:[0,1,0] op_sel_hi:[1,1,0]
    v_pk_fma_f32 v[228:229], v[228:229], v[190:191], v[190:191] op_sel:[0,1,0] op_sel_hi:[1,1,0]
    v_pk_mul_f32 v[226:227], v[226:227], v[128:129]
    v_pk_mul_f32 v[228:229], v[228:229], v[130:131]
    v_exp_f32 v226, v226
    v_exp_f32 v227, v227
    v_exp_f32 v228, v228
    v_exp_f32 v229, v229
    v_pk_fma_f32 v[226:227], v[226:227], v[170:171], v[170:171] op_sel:[0,1,1] op_sel_hi:[1,1,1]
    v_pk_fma_f32 v[228:229], v[228:229], v[170:171], v[170:171] op_sel:[0,1,1] op_sel_hi:[1,1,1]
    v_rcp_f32 v226, v226
    v_rcp_f32 v227, v227
    v_rcp_f32 v228, v228
    v_rcp_f32 v229, v229
    v_pk_mul_f32 v[128:129], v[128:129], v[226:227]
    v_pk_mul_f32 v[130:131], v[130:131], v[228:229]
    v_cvt_pk_bf16_f32 v212, v124, v125
    v_cvt_pk_bf16_f32 v213, v126, v127
    v_cvt_pk_bf16_f32 v214, v128, v129
    v_cvt_pk_bf16_f32 v215, v130, v131
    ds_write_b128 v12, v[212:215] offset:38912
    v_pk_fma_f32 v[48:49], v[164:165], v[160:161], v[48:49] op_sel_hi:[0,1,1] neg_lo:[1,0,0] neg_hi:[1,0,0]
    v_pk_fma_f32 v[50:51], v[164:165], v[162:163], v[50:51] op_sel_hi:[0,1,1] neg_lo:[1,0,0] neg_hi:[1,0,0]
    v_pk_mul_f32 v[226:227], v[48:49], v[48:49]
    v_pk_mul_f32 v[228:229], v[50:51], v[50:51]
    v_pk_fma_f32 v[226:227], v[226:227], v[184:185], v[184:185] op_sel:[0,1,0] op_sel_hi:[1,1,0]
    v_pk_fma_f32 v[228:229], v[228:229], v[184:185], v[184:185] op_sel:[0,1,0] op_sel_hi:[1,1,0]
    v_pk_mul_f32 v[226:227], v[226:227], v[48:49]
    v_pk_mul_f32 v[228:229], v[228:229], v[50:51]
    v_exp_f32 v226, v226
    v_exp_f32 v227, v227
    v_exp_f32 v228, v228
    v_exp_f32 v229, v229
    v_pk_fma_f32 v[226:227], v[226:227], v[164:165], v[164:165] op_sel:[0,1,1] op_sel_hi:[1,1,1]
    v_pk_fma_f32 v[228:229], v[228:229], v[164:165], v[164:165] op_sel:[0,1,1] op_sel_hi:[1,1,1]
    v_rcp_f32 v226, v226
    v_rcp_f32 v227, v227
    v_rcp_f32 v228, v228
    v_rcp_f32 v229, v229
    v_pk_mul_f32 v[48:49], v[48:49], v[226:227]
    v_pk_mul_f32 v[50:51], v[50:51], v[228:229]
    v_cvt_pk_bf16_f32 v216, v48, v49
    v_cvt_pk_bf16_f32 v217, v50, v51
    s_add_u32 s36, s45, 0
    buffer_store_dwordx4 v[32:35], v2, s[16:19], s36 offen sc1
    v_pk_fma_f32 v[76:77], v[166:167], v[160:161], v[76:77] op_sel_hi:[0,1,1] neg_lo:[1,0,0] neg_hi:[1,0,0]
    v_pk_fma_f32 v[78:79], v[166:167], v[162:163], v[78:79] op_sel_hi:[0,1,1] neg_lo:[1,0,0] neg_hi:[1,0,0]
    v_pk_mul_f32 v[226:227], v[76:77], v[76:77]
    v_pk_mul_f32 v[228:229], v[78:79], v[78:79]
    v_pk_fma_f32 v[226:227], v[226:227], v[186:187], v[186:187] op_sel:[0,1,0] op_sel_hi:[1,1,0]
    v_pk_fma_f32 v[228:229], v[228:229], v[186:187], v[186:187] op_sel:[0,1,0] op_sel_hi:[1,1,0]
    v_pk_mul_f32 v[226:227], v[226:227], v[76:77]
    v_pk_mul_f32 v[228:229], v[228:229], v[78:79]
    v_exp_f32 v226, v226
    v_exp_f32 v227, v227
    v_exp_f32 v228, v228
    v_exp_f32 v229, v229
    v_pk_fma_f32 v[226:227], v[226:227], v[166:167], v[166:167] op_sel:[0,1,1] op_sel_hi:[1,1,1]
    v_pk_fma_f32 v[228:229], v[228:229], v[166:167], v[166:167] op_sel:[0,1,1] op_sel_hi:[1,1,1]
    v_rcp_f32 v226, v226
    v_rcp_f32 v227, v227
    v_rcp_f32 v228, v228
    v_rcp_f32 v229, v229
    v_pk_mul_f32 v[76:77], v[76:77], v[226:227]
    v_pk_mul_f32 v[78:79], v[78:79], v[228:229]
    v_cvt_pk_bf16_f32 v218, v76, v77
    v_cvt_pk_bf16_f32 v219, v78, v79
    s_add_u32 s36, s45, 229376
    buffer_store_dwordx4 v[60:63], v2, s[16:19], s36 offen sc1
    v_pk_fma_f32 v[104:105], v[168:169], v[160:161], v[104:105] op_sel_hi:[0,1,1] neg_lo:[1,0,0] neg_hi:[1,0,0]
    v_pk_fma_f32 v[106:107], v[168:169], v[162:163], v[106:107] op_sel_hi:[0,1,1] neg_lo:[1,0,0] neg_hi:[1,0,0]
    v_pk_mul_f32 v[226:227], v[104:105], v[104:105]
    v_pk_mul_f32 v[228:229], v[106:107], v[106:107]
    v_pk_fma_f32 v[226:227], v[226:227], v[188:189], v[188:189] op_sel:[0,1,0] op_sel_hi:[1,1,0]
    v_pk_fma_f32 v[228:229], v[228:229], v[188:189], v[188:189] op_sel:[0,1,0] op_sel_hi:[1,1,0]
    v_pk_mul_f32 v[226:227], v[226:227], v[104:105]
    v_pk_mul_f32 v[228:229], v[228:229], v[106:107]
    v_exp_f32 v226, v226
    v_exp_f32 v227, v227
    v_exp_f32 v228, v228
    v_exp_f32 v229, v229
    v_pk_fma_f32 v[226:227], v[226:227], v[168:169], v[168:169] op_sel:[0,1,1] op_sel_hi:[1,1,1]
    v_pk_fma_f32 v[228:229], v[228:229], v[168:169], v[168:169] op_sel:[0,1,1] op_sel_hi:[1,1,1]
    v_rcp_f32 v226, v226
    v_rcp_f32 v227, v227
    v_rcp_f32 v228, v228
    v_rcp_f32 v229, v229
    v_pk_mul_f32 v[104:105], v[104:105], v[226:227]
    v_pk_mul_f32 v[106:107], v[106:107], v[228:229]
    v_cvt_pk_bf16_f32 v220, v104, v105
    v_cvt_pk_bf16_f32 v221, v106, v107
    s_add_u32 s36, s45, 458752
    buffer_store_dwordx4 v[88:91], v2, s[16:19], s36 offen sc1
    v_pk_fma_f32 v[132:133], v[170:171], v[160:161], v[132:133] op_sel_hi:[0,1,1] neg_lo:[1,0,0] neg_hi:[1,0,0]
    v_pk_fma_f32 v[134:135], v[170:171], v[162:163], v[134:135] op_sel_hi:[0,1,1] neg_lo:[1,0,0] neg_hi:[1,0,0]
    v_pk_mul_f32 v[226:227], v[132:133], v[132:133]
    v_pk_mul_f32 v[228:229], v[134:135], v[134:135]
    v_pk_fma_f32 v[226:227], v[226:227], v[190:191], v[190:191] op_sel:[0,1,0] op_sel_hi:[1,1,0]
    v_pk_fma_f32 v[228:229], v[228:229], v[190:191], v[190:191] op_sel:[0,1,0] op_sel_hi:[1,1,0]
    v_pk_mul_f32 v[226:227], v[226:227], v[132:133]
    v_pk_mul_f32 v[228:229], v[228:229], v[134:135]
    v_exp_f32 v226, v226
    v_exp_f32 v227, v227
    v_exp_f32 v228, v228
    v_exp_f32 v229, v229
    v_pk_fma_f32 v[226:227], v[226:227], v[170:171], v[170:171] op_sel:[0,1,1] op_sel_hi:[1,1,1]
    v_pk_fma_f32 v[228:229], v[228:229], v[170:171], v[170:171] op_sel:[0,1,1] op_sel_hi:[1,1,1]
    v_rcp_f32 v226, v226
    v_rcp_f32 v227, v227
    v_rcp_f32 v228, v228
    v_rcp_f32 v229, v229
    v_pk_mul_f32 v[132:133], v[132:133], v[226:227]
    v_pk_mul_f32 v[134:135], v[134:135], v[228:229]
    v_cvt_pk_bf16_f32 v222, v132, v133
    v_cvt_pk_bf16_f32 v223, v134, v135
    s_add_u32 s36, s45, 688128
    buffer_store_dwordx4 v[116:119], v2, s[16:19], s36 offen sc1
    s_waitcnt lgkmcnt(0)
    s_mov_b32 s44, s46
    s_mov_b32 s45, s47
    s_branch G3_e2
G3_e1:
    v_pk_fma_f32 v[28:29], v[164:165], v[140:141], v[28:29] op_sel_hi:[0,1,1] neg_lo:[1,0,0] neg_hi:[1,0,0]
    v_pk_fma_f32 v[30:31], v[164:165], v[142:143], v[30:31] op_sel_hi:[0,1,1] neg_lo:[1,0,0] neg_hi:[1,0,0]
    v_pk_mul_f32 v[226:227], v[28:29], v[28:29]
    v_pk_mul_f32 v[228:229], v[30:31], v[30:31]
    v_pk_fma_f32 v[226:227], v[226:227], v[184:185], v[184:185] op_sel:[0,1,0] op_sel_hi:[1,1,0]
    v_pk_fma_f32 v[228:229], v[228:229], v[184:185], v[184:185] op_sel:[0,1,0] op_sel_hi:[1,1,0]
    v_pk_mul_f32 v[226:227], v[226:227], v[28:29]
    v_pk_mul_f32 v[228:229], v[228:229], v[30:31]
    v_exp_f32 v226, v226
    v_exp_f32 v227, v227
    v_exp_f32 v228, v228
    v_exp_f32 v229, v229
    v_pk_fma_f32 v[226:227], v[226:227], v[164:165], v[164:165] op_sel:[0,1,1] op_sel_hi:[1,1,1]
    v_pk_fma_f32 v[228:229], v[228:229], v[164:165], v[164:165] op_sel:[0,1,1] op_sel_hi:[1,1,1]
    v_rcp_f32 v226, v226
    v_rcp_f32 v227, v227
    v_rcp_f32 v228, v228
    v_rcp_f32 v229, v229
    v_pk_mul_f32 v[28:29], v[28:29], v[226:227]
    v_pk_mul_f32 v[30:31], v[30:31], v[228:229]
    v_pk_fma_f32 v[32:33], v[164:165], v[144:145], v[32:33] op_sel_hi:[0,1,1] neg_lo:[1,0,0] neg_hi:[1,0,0]
    v_pk_fma_f32 v[34:35], v[164:165], v[146:147], v[34:35] op_sel_hi:[0,1,1] neg_lo:[1,0,0] neg_hi:[1,0,0]
    v_pk_mul_f32 v[226:227], v[32:33], v[32:33]
    v_pk_mul_f32 v[228:229], v[34:35], v[34:35]
    v_pk_fma_f32 v[226:227], v[226:227], v[184:185], v[184:185] op_sel:[0,1,0] op_sel_hi:[1,1,0]
    v_pk_fma_f32 v[228:229], v[228:229], v[184:185], v[184:185] op_sel:[0,1,0] op_sel_hi:[1,1,0]
    v_pk_mul_f32 v[226:227], v[226:227], v[32:33]
    v_pk_mul_f32 v[228:229], v[228:229], v[34:35]
    v_exp_f32 v226, v226
    v_exp_f32 v227, v227
    v_exp_f32 v228, v228
    v_exp_f32 v229, v229
    v_pk_fma_f32 v[226:227], v[226:227], v[164:165], v[164:165] op_sel:[0,1,1] op_sel_hi:[1,1,1]
    v_pk_fma_f32 v[228:229], v[228:229], v[164:165], v[164:165] op_sel:[0,1,1] op_sel_hi:[1,1,1]
    v_rcp_f32 v226, v226
    v_rcp_f32 v227, v227
    v_rcp_f32 v228, v228
    v_rcp_f32 v229, v229
    v_pk_mul_f32 v[32:33], v[32:33], v[226:227]
    v_pk_mul_f32 v[34:35], v[34:35], v[228:229]
    v_cvt_pk_bf16_f32 v28, v28, v29
    v_cvt_pk_bf16_f32 v29, v30, v31
    v_cvt_pk_bf16_f32 v30, v32, v33
    v_cvt_pk_bf16_f32 v31, v34, v35
    ds_write_b128 v12, v[28:31] offset:0
    s_add_u32 s36, s45, 0
    buffer_store_dwordx4 v[28:31], v2, s[16:19], s36 offen sc1
    v_pk_fma_f32 v[56:57], v[166:167], v[140:141], v[56:57] op_sel_hi:[0,1,1] neg_lo:[1,0,0] neg_hi:[1,0,0]
    v_pk_fma_f32 v[58:59], v[166:167], v[142:143], v[58:59] op_sel_hi:[0,1,1] neg_lo:[1,0,0] neg_hi:[1,0,0]
    v_pk_mul_f32 v[226:227], v[56:57], v[56:57]
    v_pk_mul_f32 v[228:229], v[58:59], v[58:59]
    v_pk_fma_f32 v[226:227], v[226:227], v[186:187], v[186:187] op_sel:[0,1,0] op_sel_hi:[1,1,0]
    v_pk_fma_f32 v[228:229], v[228:229], v[186:187], v[186:187] op_sel:[0,1,0] op_sel_hi:[1,1,0]
    v_pk_mul_f32 v[226:227], v[226:227], v[56:57]
    v_pk_mul_f32 v[228:229], v[228:229], v[58:59]
    v_exp_f32 v226, v226
    v_exp_f32 v227, v227
    v_exp_f32 v228, v228
    v_exp_f32 v229, v229
    v_pk_fma_f32 v[226:227], v[226:227], v[166:167], v[166:167] op_sel:[0,1,1] op_sel_hi:[1,1,1]
    v_pk_fma_f32 v[228:229], v[228:229], v[166:167], v[166:167] op_sel:[0,1,1] op_sel_hi:[1,1,1]
    v_rcp_f32 v226, v226
    v_rcp_f32 v227, v227
    v_rcp_f32 v228, v228
    v_rcp_f32 v229, v229
    v_pk_mul_f32 v[56:57], v[56:57], v[226:227]
    v_pk_mul_f32 v[58:59], v[58:59], v[228:229]
    v_pk_fma_f32 v[60:61], v[166:167], v[144:145], v[60:61] op_sel_hi:[0,1,1] neg_lo:[1,0,0] neg_hi:[1,0,0]
    v_pk_fma_f32 v[62:63], v[166:167], v[146:147], v[62:63] op_sel_hi:[0,1,1] neg_lo:[1,0,0] neg_hi:[1,0,0]
    v_pk_mul_f32 v[226:227], v[60:61], v[60:61]
    v_pk_mul_f32 v[228:229], v[62:63], v[62:63]
    v_pk_fma_f32 v[226:227], v[226:227], v[186:187], v[186:187] op_sel:[0,1,0] op_sel_hi:[1,1,0]
    v_pk_fma_f32 v[228:229], v[228:229], v[186:187], v[186:187] op_sel:[0,1,0] op_sel_hi:[1,1,0]
    v_pk_mul_f32 v[226:227], v[226:227], v[60:61]
    v_pk_mul_f32 v[228:229], v[228:229], v[62:63]
    v_exp_f32 v226, v226
    v_exp_f32 v227, v227
    v_exp_f32 v228, v228
    v_exp_f32 v229, v229
    v_pk_fma_f32 v[226:227], v[226:227], v[166:167], v[166:167] op_sel:[0,1,1] op_sel_hi:[1,1,1]
    v_pk_fma_f32 v[228:229], v[228:229], v[166:167], v[166:167] op_sel:[0,1,1] op_sel_hi:[1,1,1]
    v_rcp_f32 v226, v226
    v_rcp_f32 v227, v227
    v_rcp_f32 v228, v228
    v_rcp_f32 v229, v229
    v_pk_mul_f32 v[60:61], v[60:61], v[226:227]
    v_pk_mul_f32 v[62:63], v[62:63], v[228:229]
    v_cvt_pk_bf16_f32 v56, v56, v57
    v_cvt_pk_bf16_f32 v57, v58, v59
    v_cvt_pk_bf16_f32 v58, v60, v61
    v_cvt_pk_bf16_f32 v59, v62, v63
    ds_write_b128 v12, v[56:59] offset:2048
    s_add_u32 s36, s45, 229376
    buffer_store_dwordx4 v[56:59], v2, s[16:19], s36 offen sc1
    v_pk_fma_f32 v[84:85], v[168:169], v[140:141], v[84:85] op_sel_hi:[0,1,1] neg_lo:[1,0,0] neg_hi:[1,0,0]
    v_pk_fma_f32 v[86:87], v[168:169], v[142:143], v[86:87] op_sel_hi:[0,1,1] neg_lo:[1,0,0] neg_hi:[1,0,0]
    v_pk_mul_f32 v[226:227], v[84:85], v[84:85]
    v_pk_mul_f32 v[228:229], v[86:87], v[86:87]
    v_pk_fma_f32 v[226:227], v[226:227], v[188:189], v[188:189] op_sel:[0,1,0] op_sel_hi:[1,1,0]
    v_pk_fma_f32 v[228:229], v[228:229], v[188:189], v[188:189] op_sel:[0,1,0] op_sel_hi:[1,1,0]
    v_pk_mul_f32 v[226:227], v[226:227], v[84:85]
    v_pk_mul_f32 v[228:229], v[228:229], v[86:87]
    v_exp_f32 v226, v226
    v_exp_f32 v227, v227
    v_exp_f32 v228, v228
    v_exp_f32 v229, v229
    v_pk_fma_f32 v[226:227], v[226:227], v[168:169], v[168:169] op_sel:[0,1,1] op_sel_hi:[1,1,1]
    v_pk_fma_f32 v[228:229], v[228:229], v[168:169], v[168:169] op_sel:[0,1,1] op_sel_hi:[1,1,1]
    v_rcp_f32 v226, v226
    v_rcp_f32 v227, v227
    v_rcp_f32 v228, v228
    v_rcp_f32 v229, v229
    v_pk_mul_f32 v[84:85], v[84:85], v[226:227]
    v_pk_mul_f32 v[86:87], v[86:87], v[228:229]
    v_pk_fma_f32 v[88:89], v[168:169], v[144:145], v[88:89] op_sel_hi:[0,1,1] neg_lo:[1,0,0] neg_hi:[1,0,0]
    v_pk_fma_f32 v[90:91], v[168:169], v[146:147], v[90:91] op_sel_hi:[0,1,1] neg_lo:[1,0,0] neg_hi:[1,0,0]
    v_pk_mul_f32 v[226:227], v[88:89], v[88:89]
    v_pk_mul_f32 v[228:229], v[90:91], v[90:91]
    v_pk_fma_f32 v[226:227], v[226:227], v[188:189], v[188:189] op_sel:[0,1,0] op_sel_hi:[1,1,0]
    v_pk_fma_f32 v[228:229], v[228:229], v[188:189], v[188:189] op_sel:[0,1,0] op_sel_hi:[1,1,0]
    v_pk_mul_f32 v[226:227], v[226:227], v[88:89]
    v_pk_mul_f32 v[228:229], v[228:229], v[90:91]
    v_exp_f32 v226, v226
    v_exp_f32 v227, v227
    v_exp_f32 v228, v228
    v_exp_f32 v229, v229
    v_pk_fma_f32 v[226:227], v[226:227], v[168:169], v[168:169] op_sel:[0,1,1] op_sel_hi:[1,1,1]
    v_pk_fma_f32 v[228:229], v[228:229], v[168:169], v[168:169] op_sel:[0,1,1] op_sel_hi:[1,1,1]
    v_rcp_f32 v226, v226
    v_rcp_f32 v227, v227
    v_rcp_f32 v228, v228
    v_rcp_f32 v229, v229
    v_pk_mul_f32 v[88:89], v[88:89], v[226:227]
    v_pk_mul_f32 v[90:91], v[90:91], v[228:229]
    v_cvt_pk_bf16_f32 v84, v84, v85
    v_cvt_pk_bf16_f32 v85, v86, v87
    v_cvt_pk_bf16_f32 v86, v88, v89
    v_cvt_pk_bf16_f32 v87, v90, v91
    ds_write_b128 v12, v[84:87] offset:4096
    s_add_u32 s36, s45, 458752
    buffer_store_dwordx4 v[84:87], v2, s[16:19], s36 offen sc1
    v_pk_fma_f32 v[112:113], v[170:171], v[140:141], v[112:113] op_sel_hi:[0,1,1] neg_lo:[1,0,0] neg_hi:[1,0,0]
    v_pk_fma_f32 v[114:115], v[170:171], v[142:143], v[114:115] op_sel_hi:[0,1,1] neg_lo:[1,0,0] neg_hi:[1,0,0]
    v_pk_mul_f32 v[226:227], v[112:113], v[112:113]
    v_pk_mul_f32 v[228:229], v[114:115], v[114:115]
    v_pk_fma_f32 v[226:227], v[226:227], v[190:191], v[190:191] op_sel:[0,1,0] op_sel_hi:[1,1,0]
    v_pk_fma_f32 v[228:229], v[228:229], v[190:191], v[190:191] op_sel:[0,1,0] op_sel_hi:[1,1,0]
    v_pk_mul_f32 v[226:227], v[226:227], v[112:113]
    v_pk_mul_f32 v[228:229], v[228:229], v[114:115]
    v_exp_f32 v226, v226
    v_exp_f32 v227, v227
    v_exp_f32 v228, v228
    v_exp_f32 v229, v229
    v_pk_fma_f32 v[226:227], v[226:227], v[170:171], v[170:171] op_sel:[0,1,1] op_sel_hi:[1,1,1]
    v_pk_fma_f32 v[228:229], v[228:229], v[170:171], v[170:171] op_sel:[0,1,1] op_sel_hi:[1,1,1]
    v_rcp_f32 v226, v226
    v_rcp_f32 v227, v227
    v_rcp_f32 v228, v228
    v_rcp_f32 v229, v229
    v_pk_mul_f32 v[112:113], v[112:113], v[226:227]
    v_pk_mul_f32 v[114:115], v[114:115], v[228:229]
    v_pk_fma_f32 v[116:117], v[170:171], v[144:145], v[116:117] op_sel_hi:[0,1,1] neg_lo:[1,0,0] neg_hi:[1,0,0]
    v_pk_fma_f32 v[118:119], v[170:171], v[146:147], v[118:119] op_sel_hi:[0,1,1] neg_lo:[1,0,0] neg_hi:[1,0,0]
    v_pk_mul_f32 v[226:227], v[116:117], v[116:117]
    v_pk_mul_f32 v[228:229], v[118:119], v[118:119]
    v_pk_fma_f32 v[226:227], v[226:227], v[190:191], v[190:191] op_sel:[0,1,0] op_sel_hi:[1,1,0]
    v_pk_fma_f32 v[228:229], v[228:229], v[190:191], v[190:191] op_sel:[0,1,0] op_sel_hi:[1,1,0]
    v_pk_mul_f32 v[226:227], v[226:227], v[116:117]
    v_pk_mul_f32 v[228:229], v[228:229], v[118:119]
    v_exp_f32 v226, v226
    v_exp_f32 v227, v227
    v_exp_f32 v228, v228
    v_exp_f32 v229, v229
    v_pk_fma_f32 v[226:227], v[226:227], v[170:171], v[170:171] op_sel:[0,1,1] op_sel_hi:[1,1,1]
    v_pk_fma_f32 v[228:229], v[228:229], v[170:171], v[170:171] op_sel:[0,1,1] op_sel_hi:[1,1,1]
    v_rcp_f32 v226, v226
    v_rcp_f32 v227, v227
    v_rcp_f32 v228, v228
    v_rcp_f32 v229, v229
    v_pk_mul_f32 v[116:117], v[116:117], v[226:227]
    v_pk_mul_f32 v[118:119], v[118:119], v[228:229]
    v_cvt_pk_bf16_f32 v112, v112, v113
    v_cvt_pk_bf16_f32 v113, v114, v115
    v_cvt_pk_bf16_f32 v114, v116, v117
    v_cvt_pk_bf16_f32 v115, v118, v119
    ds_write_b128 v12, v[112:115] offset:6144
    s_add_u32 s36, s45, 688128
    buffer_store_dwordx4 v[112:115], v2, s[16:19], s36 offen sc1
    v_pk_fma_f32 v[36:37], v[164:165], v[148:149], v[36:37] op_sel_hi:[0,1,1] neg_lo:[1,0,0] neg_hi:[1,0,0]
    v_pk_fma_f32 v[38:39], v[164:165], v[150:151], v[38:39] op_sel_hi:[0,1,1] neg_lo:[1,0,0] neg_hi:[1,0,0]
    v_pk_mul_f32 v[226:227], v[36:37], v[36:37]
    v_pk_mul_f32 v[228:229], v[38:39], v[38:39]
    v_pk_fma_f32 v[226:227], v[226:227], v[184:185], v[184:185] op_sel:[0,1,0] op_sel_hi:[1,1,0]
    v_pk_fma_f32 v[228:229], v[228:229], v[184:185], v[184:185] op_sel:[0,1,0] op_sel_hi:[1,1,0]
    v_pk_mul_f32 v[226:227], v[226:227], v[36:37]
    v_pk_mul_f32 v[228:229], v[228:229], v[38:39]
    v_exp_f32 v226, v226
    v_exp_f32 v227, v227
    v_exp_f32 v228, v228
    v_exp_f32 v229, v229
    v_pk_fma_f32 v[226:227], v[226:227], v[164:165], v[164:165] op_sel:[0,1,1] op_sel_hi:[1,1,1]
    v_pk_fma_f32 v[228:229], v[228:229], v[164:165], v[164:165] op_sel:[0,1,1] op_sel_hi:[1,1,1]
    v_rcp_f32 v226, v226
    v_rcp_f32 v227, v227
    v_rcp_f32 v228, v228
    v_rcp_f32 v229, v229
    v_pk_mul_f32 v[36:37], v[36:37], v[226:227]
    v_pk_mul_f32 v[38:39], v[38:39], v[228:229]
    v_pk_fma_f32 v[40:41], v[164:165], v[152:153], v[40:41] op_sel_hi:[0,1,1] neg_lo:[1,0,0] neg_hi:[1,0,0]
    v_pk_fma_f32 v[42:43], v[164:165], v[154:155], v[42:43] op_sel_hi:[0,1,1] neg_lo:[1,0,0] neg_hi:[1,0,0]
    v_pk_mul_f32 v[226:227], v[40:41], v[40:41]
    v_pk_mul_f32 v[228:229], v[42:43], v[42:43]
    v_pk_fma_f32 v[226:227], v[226:227], v[184:185], v[184:185] op_sel:[0,1,0] op_sel_hi:[1,1,0]
    v_pk_fma_f32 v[228:229], v[228:229], v[184:185], v[184:185] op_sel:[0,1,0] op_sel_hi:[1,1,0]
    v_pk_mul_f32 v[226:227], v[226:227], v[40:41]
    v_pk_mul_f32 v[228:229], v[228:229], v[42:43]
    v_exp_f32 v226, v226
    v_exp_f32 v227, v227
    v_exp_f32 v228, v228
    v_exp_f32 v229, v229
    v_pk_fma_f32 v[226:227], v[226:227], v[164:165], v[164:165] op_sel:[0,1,1] op_sel_hi:[1,1,1]
    v_pk_fma_f32 v[228:229], v[228:229], v[164:165], v[164:165] op_sel:[0,1,1] op_sel_hi:[1,1,1]
    v_rcp_f32 v226, v226
    v_rcp_f32 v227, v227
    v_rcp_f32 v228, v228
    v_rcp_f32 v229, v229
    v_pk_mul_f32 v[40:41], v[40:41], v[226:227]
    v_pk_mul_f32 v[42:43], v[42:43], v[228:229]
    v_cvt_pk_bf16_f32 v36, v36, v37
    v_cvt_pk_bf16_f32 v37, v38, v39
    v_cvt_pk_bf16_f32 v38, v40, v41
    v_cvt_pk_bf16_f32 v39, v42, v43
    ds_write_b128 v12, v[36:39] offset:16384
    s_add_u32 s53, s55, 1792
    s_lshl_b32 s54, s31, 7
    s_add_u32 s53, s53, s54
    v_mov_b32 v8, 1
    v_mov_b32 v9, 162864
    v_mov_b32 v11, 0
    s_mov_b64 exec, 1
    s_waitcnt vmcnt(0)
    ds_add_rtn_u32 v10, v9, v8
    s_waitcnt lgkmcnt(0)
    v_readfirstlane_b32 s54, v10
    s_nop 0
    s_and_b32 s54, s54, 3
    s_cmp_lg_u32 s54, 3
    s_cbranch_scc1 pub_28
    buffer_atomic_add v8, v11, s[56:59], s53 offen sc1
    v_mov_b32 v9, 162872
    ds_add_u32 v9, v8
pub_28:
    s_mov_b64 exec, -1
    v_pk_fma_f32 v[64:65], v[166:167], v[148:149], v[64:65] op_sel_hi:[0,1,1] neg_lo:[1,0,0] neg_hi:[1,0,0]
    v_pk_fma_f32 v[66:67], v[166:167], v[150:151], v[66:67] op_sel_hi:[0,1,1] neg_lo:[1,0,0] neg_hi:[1,0,0]
    v_pk_mul_f32 v[226:227], v[64:65], v[64:65]
    v_pk_mul_f32 v[228:229], v[66:67], v[66:67]
    v_pk_fma_f32 v[226:227], v[226:227], v[186:187], v[186:187] op_sel:[0,1,0] op_sel_hi:[1,1,0]
    v_pk_fma_f32 v[228:229], v[228:229], v[186:187], v[186:187] op_sel:[0,1,0] op_sel_hi:[1,1,0]
    v_pk_mul_f32 v[226:227], v[226:227], v[64:65]
    v_pk_mul_f32 v[228:229], v[228:229], v[66:67]
    v_exp_f32 v226, v226
    v_exp_f32 v227, v227
    v_exp_f32 v228, v228
    v_exp_f32 v229, v229
    v_pk_fma_f32 v[226:227], v[226:227], v[166:167], v[166:167] op_sel:[0,1,1] op_sel_hi:[1,1,1]
    v_pk_fma_f32 v[228:229], v[228:229], v[166:167], v[166:167] op_sel:[0,1,1] op_sel_hi:[1,1,1]
    v_rcp_f32 v226, v226
    v_rcp_f32 v227, v227
    v_rcp_f32 v228, v228
    v_rcp_f32 v229, v229
    v_pk_mul_f32 v[64:65], v[64:65], v[226:227]
    v_pk_mul_f32 v[66:67], v[66:67], v[228:229]
    v_pk_fma_f32 v[68:69], v[166:167], v[152:153], v[68:69] op_sel_hi:[0,1,1] neg_lo:[1,0,0] neg_hi:[1,0,0]
    v_pk_fma_f32 v[70:71], v[166:167], v[154:155], v[70:71] op_sel_hi:[0,1,1] neg_lo:[1,0,0] neg_hi:[1,0,0]
    v_pk_mul_f32 v[226:227], v[68:69], v[68:69]
    v_pk_mul_f32 v[228:229], v[70:71], v[70:71]
    v_pk_fma_f32 v[226:227], v[226:227], v[186:187], v[186:187] op_sel:[0,1,0] op_sel_hi:[1,1,0]
    v_pk_fma_f32 v[228:229], v[228:229], v[186:187], v[186:187] op_sel:[0,1,0] op_sel_hi:[1,1,0]
    v_pk_mul_f32 v[226:227], v[226:227], v[68:69]
    v_pk_mul_f32 v[228:229], v[228:229], v[70:71]
    v_exp_f32 v226, v226
    v_exp_f32 v227, v227
    v_exp_f32 v228, v228
    v_exp_f32 v229, v229
    v_pk_fma_f32 v[226:227], v[226:227], v[166:167], v[166:167] op_sel:[0,1,1] op_sel_hi:[1,1,1]
    v_pk_fma_f32 v[228:229], v[228:229], v[166:167], v[166:167] op_sel:[0,1,1] op_sel_hi:[1,1,1]
    v_rcp_f32 v226, v226
    v_rcp_f32 v227, v227
    v_rcp_f32 v228, v228
    v_rcp_f32 v229, v229
    v_pk_mul_f32 v[68:69], v[68:69], v[226:227]
    v_pk_mul_f32 v[70:71], v[70:71], v[228:229]
    v_cvt_pk_bf16_f32 v64, v64, v65
    v_cvt_pk_bf16_f32 v65, v66, v67
    v_cvt_pk_bf16_f32 v66, v68, v69
    v_cvt_pk_bf16_f32 v67, v70, v71
    ds_write_b128 v12, v[64:67] offset:18432
    v_pk_fma_f32 v[92:93], v[168:169], v[148:149], v[92:93] op_sel_hi:[0,1,1] neg_lo:[1,0,0] neg_hi:[1,0,0]
    v_pk_fma_f32 v[94:95], v[168:169], v[150:151], v[94:95] op_sel_hi:[0,1,1] neg_lo:[1,0,0] neg_hi:[1,0,0]
    v_pk_mul_f32 v[226:227], v[92:93], v[92:93]
    v_pk_mul_f32 v[228:229], v[94:95], v[94:95]
    v_pk_fma_f32 v[226:227], v[226:227], v[188:189], v[188:189] op_sel:[0,1,0] op_sel_hi:[1,1,0]
    v_pk_fma_f32 v[228:229], v[228:229], v[188:189], v[188:189] op_sel:[0,1,0] op_sel_hi:[1,1,0]
    v_pk_mul_f32 v[226:227], v[226:227], v[92:93]
    v_pk_mul_f32 v[228:229], v[228:229], v[94:95]
    v_exp_f32 v226, v226
    v_exp_f32 v227, v227
    v_exp_f32 v228, v228
    v_exp_f32 v229, v229
    v_pk_fma_f32 v[226:227], v[226:227], v[168:169], v[168:169] op_sel:[0,1,1] op_sel_hi:[1,1,1]
    v_pk_fma_f32 v[228:229], v[228:229], v[168:169], v[168:169] op_sel:[0,1,1] op_sel_hi:[1,1,1]
    v_rcp_f32 v226, v226
    v_rcp_f32 v227, v227
    v_rcp_f32 v228, v228
    v_rcp_f32 v229, v229
    v_pk_mul_f32 v[92:93], v[92:93], v[226:227]
    v_pk_mul_f32 v[94:95], v[94:95], v[228:229]
    v_pk_fma_f32 v[96:97], v[168:169], v[152:153], v[96:97] op_sel_hi:[0,1,1] neg_lo:[1,0,0] neg_hi:[1,0,0]
    v_pk_fma_f32 v[98:99], v[168:169], v[154:155], v[98:99] op_sel_hi:[0,1,1] neg_lo:[1,0,0] neg_hi:[1,0,0]
    v_pk_mul_f32 v[226:227], v[96:97], v[96:97]
    v_pk_mul_f32 v[228:229], v[98:99], v[98:99]
    v_pk_fma_f32 v[226:227], v[226:227], v[188:189], v[188:189] op_sel:[0,1,0] op_sel_hi:[1,1,0]
    v_pk_fma_f32 v[228:229], v[228:229], v[188:189], v[188:189] op_sel:[0,1,0] op_sel_hi:[1,1,0]
    v_pk_mul_f32 v[226:227], v[226:227], v[96:97]
    v_pk_mul_f32 v[228:229], v[228:229], v[98:99]
    v_exp_f32 v226, v226
    v_exp_f32 v227, v227
    v_exp_f32 v228, v228
    v_exp_f32 v229, v229
    v_pk_fma_f32 v[226:227], v[226:227], v[168:169], v[168:169] op_sel:[0,1,1] op_sel_hi:[1,1,1]
    v_pk_fma_f32 v[228:229], v[228:229], v[168:169], v[168:169] op_sel:[0,1,1] op_sel_hi:[1,1,1]
    v_rcp_f32 v226, v226
    v_rcp_f32 v227, v227
    v_rcp_f32 v228, v228
    v_rcp_f32 v229, v229
    v_pk_mul_f32 v[96:97], v[96:97], v[226:227]
    v_pk_mul_f32 v[98:99], v[98:99], v[228:229]
    v_cvt_pk_bf16_f32 v92, v92, v93
    v_cvt_pk_bf16_f32 v93, v94, v95
    v_cvt_pk_bf16_f32 v94, v96, v97
    v_cvt_pk_bf16_f32 v95, v98, v99
    ds_write_b128 v12, v[92:95] offset:20480
    v_pk_fma_f32 v[120:121], v[170:171], v[148:149], v[120:121] op_sel_hi:[0,1,1] neg_lo:[1,0,0] neg_hi:[1,0,0]
    v_pk_fma_f32 v[122:123], v[170:171], v[150:151], v[122:123] op_sel_hi:[0,1,1] neg_lo:[1,0,0] neg_hi:[1,0,0]
    v_pk_mul_f32 v[226:227], v[120:121], v[120:121]
    v_pk_mul_f32 v[228:229], v[122:123], v[122:123]
    v_pk_fma_f32 v[226:227], v[226:227], v[190:191], v[190:191] op_sel:[0,1,0] op_sel_hi:[1,1,0]
    v_pk_fma_f32 v[228:229], v[228:229], v[190:191], v[190:191] op_sel:[0,1,0] op_sel_hi:[1,1,0]
    v_pk_mul_f32 v[226:227], v[226:227], v[120:121]
    v_pk_mul_f32 v[228:229], v[228:229], v[122:123]
    v_exp_f32 v226, v226
    v_exp_f32 v227, v227
    v_exp_f32 v228, v228
    v_exp_f32 v229, v229
    v_pk_fma_f32 v[226:227], v[226:227], v[170:171], v[170:171] op_sel:[0,1,1] op_sel_hi:[1,1,1]
    v_pk_fma_f32 v[228:229], v[228:229], v[170:171], v[170:171] op_sel:[0,1,1] op_sel_hi:[1,1,1]
    v_rcp_f32 v226, v226
    v_rcp_f32 v227, v227
    v_rcp_f32 v228, v228
    v_rcp_f32 v229, v229
    v_pk_mul_f32 v[120:121], v[120:121], v[226:227]
    v_pk_mul_f32 v[122:123], v[122:123], v[228:229]
    v_pk_fma_f32 v[124:125], v[170:171], v[152:153], v[124:125] op_sel_hi:[0,1,1] neg_lo:[1,0,0] neg_hi:[1,0,0]
    v_pk_fma_f32 v[126:127], v[170:171], v[154:155], v[126:127] op_sel_hi:[0,1,1] neg_lo:[1,0,0] neg_hi:[1,0,0]
    v_pk_mul_f32 v[226:227], v[124:125], v[124:125]
    v_pk_mul_f32 v[228:229], v[126:127], v[126:127]
    v_pk_fma_f32 v[226:227], v[226:227], v[190:191], v[190:191] op_sel:[0,1,0] op_sel_hi:[1,1,0]
    v_pk_fma_f32 v[228:229], v[228:229], v[190:191], v[190:191] op_sel:[0,1,0] op_sel_hi:[1,1,0]
    v_pk_mul_f32 v[226:227], v[226:227], v[124:125]
    v_pk_mul_f32 v[228:229], v[228:229], v[126:127]
    v_exp_f32 v226, v226
    v_exp_f32 v227, v227
    v_exp_f32 v228, v228
    v_exp_f32 v229, v229
    v_pk_fma_f32 v[226:227], v[226:227], v[170:171], v[170:171] op_sel:[0,1,1] op_sel_hi:[1,1,1]
    v_pk_fma_f32 v[228:229], v[228:229], v[170:171], v[170:171] op_sel:[0,1,1] op_sel_hi:[1,1,1]
    v_rcp_f32 v226, v226
    v_rcp_f32 v227, v227
    v_rcp_f32 v228, v228
    v_rcp_f32 v229, v229
    v_pk_mul_f32 v[124:125], v[124:125], v[226:227]
    v_pk_mul_f32 v[126:127], v[126:127], v[228:229]
    v_cvt_pk_bf16_f32 v120, v120, v121
    v_cvt_pk_bf16_f32 v121, v122, v123
    v_cvt_pk_bf16_f32 v122, v124, v125
    v_cvt_pk_bf16_f32 v123, v126, v127
    ds_write_b128 v12, v[120:123] offset:22528
    v_pk_fma_f32 v[44:45], v[164:165], v[156:157], v[44:45] op_sel_hi:[0,1,1] neg_lo:[1,0,0] neg_hi:[1,0,0]
    v_pk_fma_f32 v[46:47], v[164:165], v[158:159], v[46:47] op_sel_hi:[0,1,1] neg_lo:[1,0,0] neg_hi:[1,0,0]
    v_pk_mul_f32 v[226:227], v[44:45], v[44:45]
    v_pk_mul_f32 v[228:229], v[46:47], v[46:47]
    v_pk_fma_f32 v[226:227], v[226:227], v[184:185], v[184:185] op_sel:[0,1,0] op_sel_hi:[1,1,0]
    v_pk_fma_f32 v[228:229], v[228:229], v[184:185], v[184:185] op_sel:[0,1,0] op_sel_hi:[1,1,0]
    v_pk_mul_f32 v[226:227], v[226:227], v[44:45]
    v_pk_mul_f32 v[228:229], v[228:229], v[46:47]
    v_exp_f32 v226, v226
    v_exp_f32 v227, v227
    v_exp_f32 v228, v228
    v_exp_f32 v229, v229
    v_pk_fma_f32 v[226:227], v[226:227], v[164:165], v[164:165] op_sel:[0,1,1] op_sel_hi:[1,1,1]
    v_pk_fma_f32 v[228:229], v[228:229], v[164:165], v[164:165] op_sel:[0,1,1] op_sel_hi:[1,1,1]
    v_rcp_f32 v226, v226
    v_rcp_f32 v227, v227
    v_rcp_f32 v228, v228
    v_rcp_f32 v229, v229
    v_pk_mul_f32 v[44:45], v[44:45], v[226:227]
    v_pk_mul_f32 v[46:47], v[46:47], v[228:229]
    v_pk_fma_f32 v[48:49], v[164:165], v[160:161], v[48:49] op_sel_hi:[0,1,1] neg_lo:[1,0,0] neg_hi:[1,0,0]
    v_pk_fma_f32 v[50:51], v[164:165], v[162:163], v[50:51] op_sel_hi:[0,1,1] neg_lo:[1,0,0] neg_hi:[1,0,0]
    v_pk_mul_f32 v[226:227], v[48:49], v[48:49]
    v_pk_mul_f32 v[228:229], v[50:51], v[50:51]
    v_pk_fma_f32 v[226:227], v[226:227], v[184:185], v[184:185] op_sel:[0,1,0] op_sel_hi:[1,1,0]
    v_pk_fma_f32 v[228:229], v[228:229], v[184:185], v[184:185] op_sel:[0,1,0] op_sel_hi:[1,1,0]
    v_pk_mul_f32 v[226:227], v[226:227], v[48:49]
    v_pk_mul_f32 v[228:229], v[228:229], v[50:51]
    v_exp_f32 v226, v226
    v_exp_f32 v227, v227
    v_exp_f32 v228, v228
    v_exp_f32 v229, v229
    v_pk_fma_f32 v[226:227], v[226:227], v[164:165], v[164:165] op_sel:[0,1,1] op_sel_hi:[1,1,1]
    v_pk_fma_f32 v[228:229], v[228:229], v[164:165], v[164:165] op_sel:[0,1,1] op_sel_hi:[1,1,1]
    v_rcp_f32 v226, v226
    v_rcp_f32 v227, v227
    v_rcp_f32 v228, v228
    v_rcp_f32 v229, v229
    v_pk_mul_f32 v[48:49], v[48:49], v[226:227]
    v_pk_mul_f32 v[50:51], v[50:51], v[228:229]
    v_cvt_pk_bf16_f32 v200, v44, v45
    v_cvt_pk_bf16_f32 v201, v46, v47
    v_cvt_pk_bf16_f32 v202, v48, v49
    v_cvt_pk_bf16_f32 v203, v50, v51
    ds_write_b128 v12, v[200:203] offset:32768
    v_pk_fma_f32 v[72:73], v[166:167], v[156:157], v[72:73] op_sel_hi:[0,1,1] neg_lo:[1,0,0] neg_hi:[1,0,0]
    v_pk_fma_f32 v[74:75], v[166:167], v[158:159], v[74:75] op_sel_hi:[0,1,1] neg_lo:[1,0,0] neg_hi:[1,0,0]
    v_pk_mul_f32 v[226:227], v[72:73], v[72:73]
    v_pk_mul_f32 v[228:229], v[74:75], v[74:75]
    v_pk_fma_f32 v[226:227], v[226:227], v[186:187], v[186:187] op_sel:[0,1,0] op_sel_hi:[1,1,0]
    v_pk_fma_f32 v[228:229], v[228:229], v[186:187], v[186:187] op_sel:[0,1,0] op_sel_hi:[1,1,0]
    v_pk_mul_f32 v[226:227], v[226:227], v[72:73]
    v_pk_mul_f32 v[228:229], v[228:229], v[74:75]
    v_exp_f32 v226, v226
    v_exp_f32 v227, v227
    v_exp_f32 v228, v228
    v_exp_f32 v229, v229
    v_pk_fma_f32 v[226:227], v[226:227], v[166:167], v[166:167] op_sel:[0,1,1] op_sel_hi:[1,1,1]
    v_pk_fma_f32 v[228:229], v[228:229], v[166:167], v[166:167] op_sel:[0,1,1] op_sel_hi:[1,1,1]
    v_rcp_f32 v226, v226
    v_rcp_f32 v227, v227
    v_rcp_f32 v228, v228
    v_rcp_f32 v229, v229
    v_pk_mul_f32 v[72:73], v[72:73], v[226:227]
    v_pk_mul_f32 v[74:75], v[74:75], v[228:229]
    v_pk_fma_f32 v[76:77], v[166:167], v[160:161], v[76:77] op_sel_hi:[0,1,1] neg_lo:[1,0,0] neg_hi:[1,0,0]
    v_pk_fma_f32 v[78:79], v[166:167], v[162:163], v[78:79] op_sel_hi:[0,1,1] neg_lo:[1,0,0] neg_hi:[1,0,0]
    v_pk_mul_f32 v[226:227], v[76:77], v[76:77]
    v_pk_mul_f32 v[228:229], v[78:79], v[78:79]
    v_pk_fma_f32 v[226:227], v[226:227], v[186:187], v[186:187] op_sel:[0,1,0] op_sel_hi:[1,1,0]
    v_pk_fma_f32 v[228:229], v[228:229], v[186:187], v[186:187] op_sel:[0,1,0] op_sel_hi:[1,1,0]
    v_pk_mul_f32 v[226:227], v[226:227], v[76:77]
    v_pk_mul_f32 v[228:229], v[228:229], v[78:79]
    v_exp_f32 v226, v226
    v_exp_f32 v227, v227
    v_exp_f32 v228, v228
    v_exp_f32 v229, v229
    v_pk_fma_f32 v[226:227], v[226:227], v[166:167], v[166:167] op_sel:[0,1,1] op_sel_hi:[1,1,1]
    v_pk_fma_f32 v[228:229], v[228:229], v[166:167], v[166:167] op_sel:[0,1,1] op_sel_hi:[1,1,1]
    v_rcp_f32 v226, v226
    v_rcp_f32 v227, v227
    v_rcp_f32 v228, v228
    v_rcp_f32 v229, v229
    v_pk_mul_f32 v[76:77], v[76:77], v[226:227]
    v_pk_mul_f32 v[78:79], v[78:79], v[228:229]
    v_cvt_pk_bf16_f32 v204, v72, v73
    v_cvt_pk_bf16_f32 v205, v74, v75
    v_cvt_pk_bf16_f32 v206, v76, v77
    v_cvt_pk_bf16_f32 v207, v78, v79
    ds_write_b128 v12, v[204:207] offset:34816
    v_pk_fma_f32 v[100:101], v[168:169], v[156:157], v[100:101] op_sel_hi:[0,1,1] neg_lo:[1,0,0] neg_hi:[1,0,0]
    v_pk_fma_f32 v[102:103], v[168:169], v[158:159], v[102:103] op_sel_hi:[0,1,1] neg_lo:[1,0,0] neg_hi:[1,0,0]
    v_pk_mul_f32 v[226:227], v[100:101], v[100:101]
    v_pk_mul_f32 v[228:229], v[102:103], v[102:103]
    v_pk_fma_f32 v[226:227], v[226:227], v[188:189], v[188:189] op_sel:[0,1,0] op_sel_hi:[1,1,0]
    v_pk_fma_f32 v[228:229], v[228:229], v[188:189], v[188:189] op_sel:[0,1,0] op_sel_hi:[1,1,0]
    v_pk_mul_f32 v[226:227], v[226:227], v[100:101]
    v_pk_mul_f32 v[228:229], v[228:229], v[102:103]
    v_exp_f32 v226, v226
    v_exp_f32 v227, v227
    v_exp_f32 v228, v228
    v_exp_f32 v229, v229
    v_pk_fma_f32 v[226:227], v[226:227], v[168:169], v[168:169] op_sel:[0,1,1] op_sel_hi:[1,1,1]
    v_pk_fma_f32 v[228:229], v[228:229], v[168:169], v[168:169] op_sel:[0,1,1] op_sel_hi:[1,1,1]
    v_rcp_f32 v226, v226
    v_rcp_f32 v227, v227
    v_rcp_f32 v228, v228
    v_rcp_f32 v229, v229
    v_pk_mul_f32 v[100:101], v[100:101], v[226:227]
    v_pk_mul_f32 v[102:103], v[102:103], v[228:229]
    v_pk_fma_f32 v[104:105], v[168:169], v[160:161], v[104:105] op_sel_hi:[0,1,1] neg_lo:[1,0,0] neg_hi:[1,0,0]
    v_pk_fma_f32 v[106:107], v[168:169], v[162:163], v[106:107] op_sel_hi:[0,1,1] neg_lo:[1,0,0] neg_hi:[1,0,0]
    v_pk_mul_f32 v[226:227], v[104:105], v[104:105]
    v_pk_mul_f32 v[228:229], v[106:107], v[106:107]
    v_pk_fma_f32 v[226:227], v[226:227], v[188:189], v[188:189] op_sel:[0,1,0] op_sel_hi:[1,1,0]
    v_pk_fma_f32 v[228:229], v[228:229], v[188:189], v[188:189] op_sel:[0,1,0] op_sel_hi:[1,1,0]
    v_pk_mul_f32 v[226:227], v[226:227], v[104:105]
    v_pk_mul_f32 v[228:229], v[228:229], v[106:107]
    v_exp_f32 v226, v226
    v_exp_f32 v227, v227
    v_exp_f32 v228, v228
    v_exp_f32 v229, v229
    v_pk_fma_f32 v[226:227], v[226:227], v[168:169], v[168:169] op_sel:[0,1,1] op_sel_hi:[1,1,1]
    v_pk_fma_f32 v[228:229], v[228:229], v[168:169], v[168:169] op_sel:[0,1,1] op_sel_hi:[1,1,1]
    v_rcp_f32 v226, v226
    v_rcp_f32 v227, v227
    v_rcp_f32 v228, v228
    v_rcp_f32 v229, v229
    v_pk_mul_f32 v[104:105], v[104:105], v[226:227]
    v_pk_mul_f32 v[106:107], v[106:107], v[228:229]
    v_cvt_pk_bf16_f32 v208, v100, v101
    v_cvt_pk_bf16_f32 v209, v102, v103
    v_cvt_pk_bf16_f32 v210, v104, v105
    v_cvt_pk_bf16_f32 v211, v106, v107
    ds_write_b128 v12, v[208:211] offset:36864
    v_pk_fma_f32 v[128:129], v[170:171], v[156:157], v[128:129] op_sel_hi:[0,1,1] neg_lo:[1,0,0] neg_hi:[1,0,0]
    v_pk_fma_f32 v[130:131], v[170:171], v[158:159], v[130:131] op_sel_hi:[0,1,1] neg_lo:[1,0,0] neg_hi:[1,0,0]
    v_pk_mul_f32 v[226:227], v[128:129], v[128:129]
    v_pk_mul_f32 v[228:229], v[130:131], v[130:131]
    v_pk_fma_f32 v[226:227], v[226:227], v[190:191], v[190:191] op_sel:[0,1,0] op_sel_hi:[1,1,0]
    v_pk_fma_f32 v[228:229], v[228:229], v[190:191], v[190:191] op_sel:[0,1,0] op_sel_hi:[1,1,0]
    v_pk_mul_f32 v[226:227], v[226:227], v[128:129]
    v_pk_mul_f32 v[228:229], v[228:229], v[130:131]
    v_exp_f32 v226, v226
    v_exp_f32 v227, v227
    v_exp_f32 v228, v228
    v_exp_f32 v229, v229
    v_pk_fma_f32 v[226:227], v[226:227], v[170:171], v[170:171] op_sel:[0,1,1] op_sel_hi:[1,1,1]
    v_pk_fma_f32 v[228:229], v[228:229], v[170:171], v[170:171] op_sel:[0,1,1] op_sel_hi:[1,1,1]
    v_rcp_f32 v226, v226
    v_rcp_f32 v227, v227
    v_rcp_f32 v228, v228
    v_rcp_f32 v229, v229
    v_pk_mul_f32 v[128:129], v[128:129], v[226:227]
    v_pk_mul_f32 v[130:131], v[130:131], v[228:229]
    v_pk_fma_f32 v[132:133], v[170:171], v[160:161], v[132:133] op_sel_hi:[0,1,1] neg_lo:[1,0,0] neg_hi:[1,0,0]
    v_pk_fma_f32 v[134:135], v[170:171], v[162:163], v[134:135] op_sel_hi:[0,1,1] neg_lo:[1,0,0] neg_hi:[1,0,0]
    v_pk_mul_f32 v[226:227], v[132:133], v[132:133]
    v_pk_mul_f32 v[228:229], v[134:135], v[134:135]
    v_pk_fma_f32 v[226:227], v[226:227], v[190:191], v[190:191] op_sel:[0,1,0] op_sel_hi:[1,1,0]
    v_pk_fma_f32 v[228:229], v[228:229], v[190:191], v[190:191] op_sel:[0,1,0] op_sel_hi:[1,1,0]
    v_pk_mul_f32 v[226:227], v[226:227], v[132:133]
    v_pk_mul_f32 v[228:229], v[228:229], v[134:135]
    v_exp_f32 v226, v226
    v_exp_f32 v227, v227
    v_exp_f32 v228, v228
    v_exp_f32 v229, v229
    v_pk_fma_f32 v[226:227], v[226:227], v[170:171], v[170:171] op_sel:[0,1,1] op_sel_hi:[1,1,1]
    v_pk_fma_f32 v[228:229], v[228:229], v[170:171], v[170:171] op_sel:[0,1,1] op_sel_hi:[1,1,1]
    v_rcp_f32 v226, v226
    v_rcp_f32 v227, v227
    v_rcp_f32 v228, v228
    v_rcp_f32 v229, v229
    v_pk_mul_f32 v[132:133], v[132:133], v[226:227]
    v_pk_mul_f32 v[134:135], v[134:135], v[228:229]
    v_cvt_pk_bf16_f32 v212, v128, v129
    v_cvt_pk_bf16_f32 v213, v130, v131
    v_cvt_pk_bf16_f32 v214, v132, v133
    v_cvt_pk_bf16_f32 v215, v134, v135
    ds_write_b128 v12, v[212:215] offset:38912
    v_pk_fma_f32 v[24:25], v[164:165], v[136:137], v[24:25] op_sel_hi:[0,1,1] neg_lo:[1,0,0] neg_hi:[1,0,0]
    v_pk_fma_f32 v[26:27], v[164:165], v[138:139], v[26:27] op_sel_hi:[0,1,1] neg_lo:[1,0,0] neg_hi:[1,0,0]
    v_pk_mul_f32 v[226:227], v[24:25], v[24:25]
    v_pk_mul_f32 v[228:229], v[26:27], v[26:27]
    v_pk_fma_f32 v[226:227], v[226:227], v[184:185], v[184:185] op_sel:[0,1,0] op_sel_hi:[1,1,0]
    v_pk_fma_f32 v[228:229], v[228:229], v[184:185], v[184:185] op_sel:[0,1,0] op_sel_hi:[1,1,0]
    v_pk_mul_f32 v[226:227], v[226:227], v[24:25]
    v_pk_mul_f32 v[228:229], v[228:229], v[26:27]
    v_exp_f32 v226, v226
    v_exp_f32 v227, v227
    v_exp_f32 v228, v228
    v_exp_f32 v229, v229
    v_pk_fma_f32 v[226:227], v[226:227], v[164:165], v[164:165] op_sel:[0,1,1] op_sel_hi:[1,1,1]
    v_pk_fma_f32 v[228:229], v[228:229], v[164:165], v[164:165] op_sel:[0,1,1] op_sel_hi:[1,1,1]
    v_rcp_f32 v226, v226
    v_rcp_f32 v227, v227
    v_rcp_f32 v228, v228
    v_rcp_f32 v229, v229
    v_pk_mul_f32 v[24:25], v[24:25], v[226:227]
    v_pk_mul_f32 v[26:27], v[26:27], v[228:229]
    v_cvt_pk_bf16_f32 v216, v24, v25
    v_cvt_pk_bf16_f32 v217, v26, v27
    s_add_u32 s36, s46, 0
    buffer_store_dwordx4 v[36:39], v2, s[16:19], s36 offen sc1
    v_pk_fma_f32 v[52:53], v[166:167], v[136:137], v[52:53] op_sel_hi:[0,1,1] neg_lo:[1,0,0] neg_hi:[1,0,0]
    v_pk_fma_f32 v[54:55], v[166:167], v[138:139], v[54:55] op_sel_hi:[0,1,1] neg_lo:[1,0,0] neg_hi:[1,0,0]
    v_pk_mul_f32 v[226:227], v[52:53], v[52:53]
    v_pk_mul_f32 v[228:229], v[54:55], v[54:55]
    v_pk_fma_f32 v[226:227], v[226:227], v[186:187], v[186:187] op_sel:[0,1,0] op_sel_hi:[1,1,0]
    v_pk_fma_f32 v[228:229], v[228:229], v[186:187], v[186:187] op_sel:[0,1,0] op_sel_hi:[1,1,0]
    v_pk_mul_f32 v[226:227], v[226:227], v[52:53]
    v_pk_mul_f32 v[228:229], v[228:229], v[54:55]
    v_exp_f32 v226, v226
    v_exp_f32 v227, v227
    v_exp_f32 v228, v228
    v_exp_f32 v229, v229
    v_pk_fma_f32 v[226:227], v[226:227], v[166:167], v[166:167] op_sel:[0,1,1] op_sel_hi:[1,1,1]
    v_pk_fma_f32 v[228:229], v[228:229], v[166:167], v[166:167] op_sel:[0,1,1] op_sel_hi:[1,1,1]
    v_rcp_f32 v226, v226
    v_rcp_f32 v227, v227
    v_rcp_f32 v228, v228
    v_rcp_f32 v229, v229
    v_pk_mul_f32 v[52:53], v[52:53], v[226:227]
    v_pk_mul_f32 v[54:55], v[54:55], v[228:229]
    v_cvt_pk_bf16_f32 v218, v52, v53
    v_cvt_pk_bf16_f32 v219, v54, v55
    s_add_u32 s36, s46, 229376
    buffer_store_dwordx4 v[64:67], v2, s[16:19], s36 offen sc1
    v_pk_fma_f32 v[80:81], v[168:169], v[136:137], v[80:81] op_sel_hi:[0,1,1] neg_lo:[1,0,0] neg_hi:[1,0,0]
    v_pk_fma_f32 v[82:83], v[168:169], v[138:139], v[82:83] op_sel_hi:[0,1,1] neg_lo:[1,0,0] neg_hi:[1,0,0]
    v_pk_mul_f32 v[226:227], v[80:81], v[80:81]
    v_pk_mul_f32 v[228:229], v[82:83], v[82:83]
    v_pk_fma_f32 v[226:227], v[226:227], v[188:189], v[188:189] op_sel:[0,1,0] op_sel_hi:[1,1,0]
    v_pk_fma_f32 v[228:229], v[228:229], v[188:189], v[188:189] op_sel:[0,1,0] op_sel_hi:[1,1,0]
    v_pk_mul_f32 v[226:227], v[226:227], v[80:81]
    v_pk_mul_f32 v[228:229], v[228:229], v[82:83]
    v_exp_f32 v226, v226
    v_exp_f32 v227, v227
    v_exp_f32 v228, v228
    v_exp_f32 v229, v229
    v_pk_fma_f32 v[226:227], v[226:227], v[168:169], v[168:169] op_sel:[0,1,1] op_sel_hi:[1,1,1]
    v_pk_fma_f32 v[228:229], v[228:229], v[168:169], v[168:169] op_sel:[0,1,1] op_sel_hi:[1,1,1]
    v_rcp_f32 v226, v226
    v_rcp_f32 v227, v227
    v_rcp_f32 v228, v228
    v_rcp_f32 v229, v229
    v_pk_mul_f32 v[80:81], v[80:81], v[226:227]
    v_pk_mul_f32 v[82:83], v[82:83], v[228:229]
    v_cvt_pk_bf16_f32 v220, v80, v81
    v_cvt_pk_bf16_f32 v221, v82, v83
    s_add_u32 s36, s46, 458752
    buffer_store_dwordx4 v[92:95], v2, s[16:19], s36 offen sc1
    v_pk_fma_f32 v[108:109], v[170:171], v[136:137], v[108:109] op_sel_hi:[0,1,1] neg_lo:[1,0,0] neg_hi:[1,0,0]
    v_pk_fma_f32 v[110:111], v[170:171], v[138:139], v[110:111] op_sel_hi:[0,1,1] neg_lo:[1,0,0] neg_hi:[1,0,0]
    v_pk_mul_f32 v[226:227], v[108:109], v[108:109]
    v_pk_mul_f32 v[228:229], v[110:111], v[110:111]
    v_pk_fma_f32 v[226:227], v[226:227], v[190:191], v[190:191] op_sel:[0,1,0] op_sel_hi:[1,1,0]
    v_pk_fma_f32 v[228:229], v[228:229], v[190:191], v[190:191] op_sel:[0,1,0] op_sel_hi:[1,1,0]
    v_pk_mul_f32 v[226:227], v[226:227], v[108:109]
    v_pk_mul_f32 v[228:229], v[228:229], v[110:111]
    v_exp_f32 v226, v226
    v_exp_f32 v227, v227
    v_exp_f32 v228, v228
    v_exp_f32 v229, v229
    v_pk_fma_f32 v[226:227], v[226:227], v[170:171], v[170:171] op_sel:[0,1,1] op_sel_hi:[1,1,1]
    v_pk_fma_f32 v[228:229], v[228:229], v[170:171], v[170:171] op_sel:[0,1,1] op_sel_hi:[1,1,1]
    v_rcp_f32 v226, v226
    v_rcp_f32 v227, v227
    v_rcp_f32 v228, v228
    v_rcp_f32 v229, v229
    v_pk_mul_f32 v[108:109], v[108:109], v[226:227]
    v_pk_mul_f32 v[110:111], v[110:111], v[228:229]
    v_cvt_pk_bf16_f32 v222, v108, v109
    v_cvt_pk_bf16_f32 v223, v110, v111
    s_add_u32 s36, s46, 688128
    buffer_store_dwordx4 v[120:123], v2, s[16:19], s36 offen sc1
    s_waitcnt lgkmcnt(0)
    s_add_u32 s45, s44, 512
    s_mov_b32 s44, s47
G3_e2:
    s_lshr_b32 s34, s30, 1
    s_and_b32 s35, s30, 1
    v_and_b32 v22, 15, v1
    v_lshrrev_b32 v23, 4, v1
    s_mul_i32 s37, s34, 4
    s_mul_i32 s38, s33, 8
    s_mul_i32 s36, s35, 4
    s_add_u32 s38, s38, s36
    s_lshr_b32 s36, s38, 1
    s_lshr_b32 s53, s36, 3
    s_lshl_b32 s53, s53, 14
    s_and_b32 s39, s36, 7
    s_lshl_b32 s39, s39, 10
    s_add_u32 s39, s39, s53
    s_lshl_b32 s36, s37, 16
    s_add_u32 s39, s39, s36
    s_mul_i32 s36, s34, 8192
    v_add_u32 v12, s36, v2
    v_lshrrev_b32 v6, 2, v1
    v_mul_u32_u24 v13, 256, v6
    v_and_b32 v7, 3, v1
    v_lshl_add_u32 v13, v7, 3, v13
    v_add_u32 v13, 49152, v13
    v_and_b32 v6, 7, v6
    s_mul_i32 s36, s35, 4
    s_add_u32 s36, s36, 3
    v_xor_b32 v7, s36, v6
    v_lshl_add_u32 v16, v7, 5, v13
    s_mul_i32 s36, s35, 4
    s_add_u32 s36, s36, 2
    v_xor_b32 v7, s36, v6
    v_lshl_add_u32 v15, v7, 5, v13
    s_mul_i32 s36, s35, 4
    s_add_u32 s36, s36, 1
    v_xor_b32 v7, s36, v6
    v_lshl_add_u32 v14, v7, 5, v13
    s_mul_i32 s36, s35, 4
    s_add_u32 s36, s36, 0
    v_xor_b32 v7, s36, v6
    v_lshl_add_u32 v13, v7, 5, v13
    v_pk_mov_b32 v[24:25], 0, 0
    v_pk_mov_b32 v[26:27], 0, 0
    v_pk_mov_b32 v[28:29], 0, 0
    v_pk_mov_b32 v[30:31], 0, 0
    v_pk_mov_b32 v[32:33], 0, 0
    v_pk_mov_b32 v[34:35], 0, 0
    v_pk_mov_b32 v[36:37], 0, 0
    v_pk_mov_b32 v[38:39], 0, 0
    v_pk_mov_b32 v[40:41], 0, 0
    v_pk_mov_b32 v[42:43], 0, 0
    v_pk_mov_b32 v[44:45], 0, 0
    v_pk_mov_b32 v[46:47], 0, 0
    v_pk_mov_b32 v[48:49], 0, 0
    v_pk_mov_b32 v[50:51], 0, 0
    v_pk_mov_b32 v[52:53], 0, 0
    v_pk_mov_b32 v[54:55], 0, 0
    v_pk_mov_b32 v[56:57], 0, 0
    v_pk_mov_b32 v[58:59], 0, 0
    v_pk_mov_b32 v[60:61], 0, 0
    v_pk_mov_b32 v[62:63], 0, 0
    v_pk_mov_b32 v[64:65], 0, 0
    v_pk_mov_b32 v[66:67], 0, 0
    v_pk_mov_b32 v[68:69], 0, 0
    v_pk_mov_b32 v[70:71], 0, 0
    v_pk_mov_b32 v[72:73], 0, 0
    v_pk_mov_b32 v[74:75], 0, 0
    v_pk_mov_b32 v[76:77], 0, 0
    v_pk_mov_b32 v[78:79], 0, 0
    v_pk_mov_b32 v[80:81], 0, 0
    v_pk_mov_b32 v[82:83], 0, 0
    v_pk_mov_b32 v[84:85], 0, 0
    v_pk_mov_b32 v[86:87], 0, 0
    s_mov_b32 s42, 0
    s_mov_b32 s43, 0
    s_mov_b32 s48, 0
    v_mov_b32 v17, v12
    v_add_u32 v18, 0, v13
    v_add_u32 v19, 0, v14
    v_add_u32 v20, 0, v15
    v_add_u32 v21, 0, v16
    s_cmp_eq_u32 s60, 1
    s_cbranch_scc1 G4_p1
    v_and_b32 v179, 7, v0
    v_lshrrev_b32 v196, 6, v0
    v_lshlrev_b32 v196, 4, v196
    v_bfe_u32 v197, v0, 3, 3
    v_add_u32 v196, v196, v197
    s_lshr_b32 s78, s29, 1
    s_lshl_b32 s78, s78, 16
    s_and_b32 s79, s29, 1
    s_lshl_b32 s79, s79, 7
    s_add_u32 s78, s78, s79
    s_lshr_b32 s79, s30, 1
    s_lshl_b32 s79, s79, 13
    s_add_u32 s78, s78, s79
    v_lshlrev_b32 v176, 8, v196
    v_lshl_add_u32 v176, v179, 4, v176
    v_add_u32 v176, s78, v176
    s_lshl_b32 s78, s28, 7
    s_lshl_b32 s79, s29, 3
    s_add_u32 s78, s78, s79
    v_add_u32 v177, s78, v179
    v_lshlrev_b32 v178, 11, v177
    v_lshrrev_b32 v197, 2, v196
    v_lshlrev_b32 v197, 3, v197
    v_and_b32 v196, 3, v196
    v_add_u32 v196, v196, v197
    v_lshl_add_u32 v178, v196, 3, v178
    v_lshlrev_b32 v177, 3, v177
    v_lshl_add_u32 v177, v196, 14, v177
    s_add_u32 s84, s62, 0x400000
    s_addc_u32 s85, s63, 0
    s_mov_b32 s86, 0x7e000
    s_mov_b32 s87, 0x20000
    s_add_u32 s88, s62, 0x480000
    s_addc_u32 s89, s63, 0
    s_mov_b32 s90, 0x7e000
    s_mov_b32 s91, 0x20000
    buffer_load_dwordx4 v[180:183], v176, s[84:87], 0 offen offset:0 sc1
    buffer_load_dwordx4 v[188:191], v176, s[88:91], 0 offen offset:0 sc1
    buffer_load_dwordx4 v[184:187], v176, s[84:87], 0 offen offset:2048 sc1
    buffer_load_dwordx4 v[192:195], v176, s[88:91], 0 offen offset:2048 sc1
    s_add_u32 s80, s4, 0x1c00000
    s_addc_u32 s81, s5, 0
    s_mov_b32 s82, 0x400000
    s_mov_b32 s83, 0x20000
    s_mov_b32 s78, 0
    buffer_load_dwordx2 v[230:231], v177, s[80:83], s78 offen sc1
    s_mov_b32 s78, 65536
    buffer_load_dwordx2 v[232:233], v177, s[80:83], s78 offen sc1
    s_mov_b32 s78, 262144
    buffer_load_dwordx2 v[234:235], v177, s[80:83], s78 offen sc1
    s_mov_b32 s78, 327680
    buffer_load_dwordx2 v[236:237], v177, s[80:83], s78 offen sc1
    s_branch G4_p2
G4_p1:
    s_add_u32 s84, s62, 0x400000
    s_addc_u32 s85, s63, 0
    s_mov_b32 s86, 0x7e000
    s_mov_b32 s87, 0x20000
    s_add_u32 s88, s62, 0x480000
    s_addc_u32 s89, s63, 0
    s_mov_b32 s90, 0x7e000
    s_mov_b32 s91, 0x20000
    s_lshl_b32 s40, s31, 17
    s_add_u32 s40, s40, s39
    s_xor_b32 s41, s31, 1
    s_lshl_b32 s41, s41, 17
    s_add_u32 s41, s41, s39
    s_add_u32 s36, s40, 0
    buffer_load_dwordx4 v[160:163], v2, s[84:87], s36 offen offset:0 sc1
    buffer_load_dwordx4 v[164:167], v2, s[88:91], s36 offen offset:0 sc1
    buffer_load_dwordx4 v[168:171], v2, s[84:87], s36 offen offset:1024 sc1
    buffer_load_dwordx4 v[172:175], v2, s[88:91], s36 offen offset:1024 sc1
    s_add_u32 s36, s40, 65536
    buffer_load_dwordx4 v[176:179], v2, s[84:87], s36 offen offset:0 sc1
    buffer_load_dwordx4 v[180:183], v2, s[88:91], s36 offen offset:0 sc1
    buffer_load_dwordx4 v[184:187], v2, s[84:87], s36 offen offset:1024 sc1
    buffer_load_dwordx4 v[188:191], v2, s[88:91], s36 offen offset:1024 sc1
G4_p2:
    s_waitcnt lgkmcnt(0)
    s_barrier
    ds_read_b128 v[88:91], v17 offset:0
    ds_read_b128 v[92:95], v17 offset:2048
    ds_read_b128 v[96:99], v17 offset:4096
    ds_read_b128 v[100:103], v17 offset:6144
    ds_read_b64_tr_b16 v[104:105], v18 offset:0
    ds_read_b64_tr_b16 v[106:107], v18 offset:4096
    ds_read_b64_tr_b16 v[108:109], v19 offset:0
    ds_read_b64_tr_b16 v[110:111], v19 offset:4096
    ds_read_b64_tr_b16 v[112:113], v20 offset:0
    ds_read_b64_tr_b16 v[114:115], v20 offset:4096
    ds_read_b64_tr_b16 v[116:117], v21 offset:0
    ds_read_b64_tr_b16 v[118:119], v21 offset:4096
    s_waitcnt lgkmcnt(0)
    v_mfma_f32_16x16x32_bf16 v[24:27], v[104:107], v[88:91], v[24:27]
    ds_read_b128 v[120:123], v17 offset:1024
    ds_read_b128 v[124:127], v17 offset:3072
    v_mfma_f32_16x16x32_bf16 v[40:43], v[104:107], v[92:95], v[40:43]
    ds_read_b128 v[128:131], v17 offset:5120
    v_mfma_f32_16x16x32_bf16 v[56:59], v[104:107], v[96:99], v[56:59]
    ds_read_b128 v[132:135], v17 offset:7168
    v_mfma_f32_16x16x32_bf16 v[72:75], v[104:107], v[100:103], v[72:75]
    s_add_u32 s36, s44, 0
    buffer_store_dwordx4 v[200:203], v2, s[16:19], s36 offen sc1
    v_mfma_f32_16x16x32_bf16 v[76:79], v[108:111], v[100:103], v[76:79]
    ds_read_b64_tr_b16 v[136:137], v18 offset:8192
    v_mfma_f32_16x16x32_bf16 v[60:63], v[108:111], v[96:99], v[60:63]
    ds_read_b64_tr_b16 v[138:139], v18 offset:12288
    v_mfma_f32_16x16x32_bf16 v[44:47], v[108:111], v[92:95], v[44:47]
    ds_read_b64_tr_b16 v[140:141], v19 offset:8192
    s_add_u32 s36, s45, 0
    buffer_store_dwordx2 v[216:217], v238, s[16:19], s36 offen sc1
    v_mfma_f32_16x16x32_bf16 v[28:31], v[108:111], v[88:91], v[28:31]
    ds_read_b64_tr_b16 v[142:143], v19 offset:12288
    v_mfma_f32_16x16x32_bf16 v[32:35], v[112:115], v[88:91], v[32:35]
    ds_read_b64_tr_b16 v[144:145], v20 offset:8192
    v_mfma_f32_16x16x32_bf16 v[48:51], v[112:115], v[92:95], v[48:51]
    ds_read_b64_tr_b16 v[146:147], v20 offset:12288
    v_mfma_f32_16x16x32_bf16 v[64:67], v[112:115], v[96:99], v[64:67]
    ds_read_b64_tr_b16 v[148:149], v21 offset:8192
    v_mfma_f32_16x16x32_bf16 v[80:83], v[112:115], v[100:103], v[80:83]
    ds_read_b64_tr_b16 v[150:151], v21 offset:12288
    s_add_u32 s42, s42, 16384
    s_cmp_eq_u32 s42, 49152
    s_cselect_b32 s42, 0, s42
    v_mfma_f32_16x16x32_bf16 v[84:87], v[116:119], v[100:103], v[84:87]
    s_add_u32 s48, s48, 16384
    s_cmp_eq_u32 s48, 98304
    s_cselect_b32 s48, 0, s48
    v_mfma_f32_16x16x32_bf16 v[68:71], v[116:119], v[96:99], v[68:71]
    v_add_u32 v17, s42, v12
    v_add_u32 v18, s48, v13
    v_add_u32 v19, s48, v14
    v_mfma_f32_16x16x32_bf16 v[52:55], v[116:119], v[92:95], v[52:55]
    v_add_u32 v20, s48, v15
    v_add_u32 v21, s48, v16
    v_mfma_f32_16x16x32_bf16 v[36:39], v[116:119], v[88:91], v[36:39]
    s_waitcnt lgkmcnt(0)
    s_barrier
    v_mfma_f32_16x16x32_bf16 v[24:27], v[136:139], v[120:123], v[24:27]
    ds_read_b128 v[88:91], v17 offset:0
    ds_read_b128 v[92:95], v17 offset:2048
    v_mfma_f32_16x16x32_bf16 v[40:43], v[136:139], v[124:127], v[40:43]
    ds_read_b128 v[96:99], v17 offset:4096
    v_mfma_f32_16x16x32_bf16 v[56:59], v[136:139], v[128:131], v[56:59]
    ds_read_b128 v[100:103], v17 offset:6144
    v_mfma_f32_16x16x32_bf16 v[72:75], v[136:139], v[132:135], v[72:75]
    s_add_u32 s36, s44, 229376
    buffer_store_dwordx4 v[204:207], v2, s[16:19], s36 offen sc1
    v_mfma_f32_16x16x32_bf16 v[76:79], v[140:143], v[132:135], v[76:79]
    ds_read_b64_tr_b16 v[104:105], v18 offset:0
    v_mfma_f32_16x16x32_bf16 v[60:63], v[140:143], v[128:131], v[60:63]
    ds_read_b64_tr_b16 v[106:107], v18 offset:4096
    v_mfma_f32_16x16x32_bf16 v[44:47], v[140:143], v[124:127], v[44:47]
    ds_read_b64_tr_b16 v[108:109], v19 offset:0
    s_add_u32 s36, s45, 229376
    buffer_store_dwordx2 v[218:219], v238, s[16:19], s36 offen sc1
    v_mfma_f32_16x16x32_bf16 v[28:31], v[140:143], v[120:123], v[28:31]
    ds_read_b64_tr_b16 v[110:111], v19 offset:4096
    v_mfma_f32_16x16x32_bf16 v[32:35], v[144:147], v[120:123], v[32:35]
    ds_read_b64_tr_b16 v[112:113], v20 offset:0
    v_mfma_f32_16x16x32_bf16 v[48:51], v[144:147], v[124:127], v[48:51]
    ds_read_b64_tr_b16 v[114:115], v20 offset:4096
    v_mfma_f32_16x16x32_bf16 v[64:67], v[144:147], v[128:131], v[64:67]
    ds_read_b64_tr_b16 v[116:117], v21 offset:0
    v_mfma_f32_16x16x32_bf16 v[80:83], v[144:147], v[132:135], v[80:83]
    ds_read_b64_tr_b16 v[118:119], v21 offset:4096
    s_add_u32 s43, s43, 1
    v_mfma_f32_16x16x32_bf16 v[84:87], v[148:151], v[132:135], v[84:87]
    s_cmp_lt_u32 s43, 27
    v_mfma_f32_16x16x32_bf16 v[68:71], v[148:151], v[128:131], v[68:71]
    v_mfma_f32_16x16x32_bf16 v[52:55], v[148:151], v[124:127], v[52:55]
    v_mfma_f32_16x16x32_bf16 v[36:39], v[148:151], v[120:123], v[36:39]
    s_waitcnt lgkmcnt(0)
    v_mfma_f32_16x16x32_bf16 v[24:27], v[104:107], v[88:91], v[24:27]
    ds_read_b128 v[120:123], v17 offset:1024
    ds_read_b128 v[124:127], v17 offset:3072
    v_mfma_f32_16x16x32_bf16 v[40:43], v[104:107], v[92:95], v[40:43]
    ds_read_b128 v[128:131], v17 offset:5120
    v_mfma_f32_16x16x32_bf16 v[56:59], v[104:107], v[96:99], v[56:59]
    ds_read_b128 v[132:135], v17 offset:7168
    v_mfma_f32_16x16x32_bf16 v[72:75], v[104:107], v[100:103], v[72:75]
    s_add_u32 s36, s44, 458752
    buffer_store_dwordx4 v[208:211], v2, s[16:19], s36 offen sc1
    v_mfma_f32_16x16x32_bf16 v[76:79], v[108:111], v[100:103], v[76:79]
    ds_read_b64_tr_b16 v[136:137], v18 offset:8192
    v_mfma_f32_16x16x32_bf16 v[60:63], v[108:111], v[96:99], v[60:63]
    ds_read_b64_tr_b16 v[138:139], v18 offset:12288
    v_mfma_f32_16x16x32_bf16 v[44:47], v[108:111], v[92:95], v[44:47]
    ds_read_b64_tr_b16 v[140:141], v19 offset:8192
    s_add_u32 s36, s45, 458752
    buffer_store_dwordx2 v[220:221], v238, s[16:19], s36 offen sc1
    v_mfma_f32_16x16x32_bf16 v[28:31], v[108:111], v[88:91], v[28:31]
    ds_read_b64_tr_b16 v[142:143], v19 offset:12288
    v_mfma_f32_16x16x32_bf16 v[32:35], v[112:115], v[88:91], v[32:35]
    ds_read_b64_tr_b16 v[144:145], v20 offset:8192
    v_mfma_f32_16x16x32_bf16 v[48:51], v[112:115], v[92:95], v[48:51]
    ds_read_b64_tr_b16 v[146:147], v20 offset:12288
    v_mfma_f32_16x16x32_bf16 v[64:67], v[112:115], v[96:99], v[64:67]
    ds_read_b64_tr_b16 v[148:149], v21 offset:8192
    v_mfma_f32_16x16x32_bf16 v[80:83], v[112:115], v[100:103], v[80:83]
    ds_read_b64_tr_b16 v[150:151], v21 offset:12288
    s_add_u32 s42, s42, 16384
    s_cmp_eq_u32 s42, 49152
    s_cselect_b32 s42, 0, s42
    v_mfma_f32_16x16x32_bf16 v[84:87], v[116:119], v[100:103], v[84:87]
    s_add_u32 s48, s48, 16384
    s_cmp_eq_u32 s48, 98304
    s_cselect_b32 s48, 0, s48
    v_mfma_f32_16x16x32_bf16 v[68:71], v[116:119], v[96:99], v[68:71]
    v_add_u32 v17, s42, v12
    v_add_u32 v18, s48, v13
    v_add_u32 v19, s48, v14
    v_mfma_f32_16x16x32_bf16 v[52:55], v[116:119], v[92:95], v[52:55]
    v_add_u32 v20, s48, v15
    v_add_u32 v21, s48, v16
    v_mfma_f32_16x16x32_bf16 v[36:39], v[116:119], v[88:91], v[36:39]
    s_waitcnt lgkmcnt(0)
    s_barrier
    v_mfma_f32_16x16x32_bf16 v[24:27], v[136:139], v[120:123], v[24:27]
    ds_read_b128 v[88:91], v17 offset:0
    ds_read_b128 v[92:95], v17 offset:2048
    v_mfma_f32_16x16x32_bf16 v[40:43], v[136:139], v[124:127], v[40:43]
    ds_read_b128 v[96:99], v17 offset:4096
    v_mfma_f32_16x16x32_bf16 v[56:59], v[136:139], v[128:131], v[56:59]
    ds_read_b128 v[100:103], v17 offset:6144
    v_mfma_f32_16x16x32_bf16 v[72:75], v[136:139], v[132:135], v[72:75]
    s_add_u32 s36, s44, 688128
    buffer_store_dwordx4 v[212:215], v2, s[16:19], s36 offen sc1
    v_mfma_f32_16x16x32_bf16 v[76:79], v[140:143], v[132:135], v[76:79]
    ds_read_b64_tr_b16 v[104:105], v18 offset:0
    v_mfma_f32_16x16x32_bf16 v[60:63], v[140:143], v[128:131], v[60:63]
    ds_read_b64_tr_b16 v[106:107], v18 offset:4096
    v_mfma_f32_16x16x32_bf16 v[44:47], v[140:143], v[124:127], v[44:47]
    ds_read_b64_tr_b16 v[108:109], v19 offset:0
    s_add_u32 s36, s45, 688128
    buffer_store_dwordx2 v[222:223], v238, s[16:19], s36 offen sc1
    v_mfma_f32_16x16x32_bf16 v[28:31], v[140:143], v[120:123], v[28:31]
    ds_read_b64_tr_b16 v[110:111], v19 offset:4096
    v_mfma_f32_16x16x32_bf16 v[32:35], v[144:147], v[120:123], v[32:35]
    ds_read_b64_tr_b16 v[112:113], v20 offset:0
    v_mfma_f32_16x16x32_bf16 v[48:51], v[144:147], v[124:127], v[48:51]
    ds_read_b64_tr_b16 v[114:115], v20 offset:4096
    v_mfma_f32_16x16x32_bf16 v[64:67], v[144:147], v[128:131], v[64:67]
    ds_read_b64_tr_b16 v[116:117], v21 offset:0
    v_mfma_f32_16x16x32_bf16 v[80:83], v[144:147], v[132:135], v[80:83]
    ds_read_b64_tr_b16 v[118:119], v21 offset:4096
    s_add_u32 s43, s43, 1
    v_mfma_f32_16x16x32_bf16 v[84:87], v[148:151], v[132:135], v[84:87]
    s_cmp_lt_u32 s43, 27
    v_mfma_f32_16x16x32_bf16 v[68:71], v[148:151], v[128:131], v[68:71]
    v_mfma_f32_16x16x32_bf16 v[52:55], v[148:151], v[124:127], v[52:55]
    v_mfma_f32_16x16x32_bf16 v[36:39], v[148:151], v[120:123], v[36:39]
    s_add_u32 s53, s55, 1536
    s_lshl_b32 s54, s31, 7
    s_add_u32 s53, s53, s54
    v_mov_b32 v8, 1
    v_mov_b32 v9, 162816
    v_mov_b32 v11, 0
    s_mov_b64 exec, 1
    s_waitcnt vmcnt(8)
    ds_add_rtn_u32 v10, v9, v8
    s_waitcnt lgkmcnt(0)
    v_readfirstlane_b32 s54, v10
    s_nop 0
    s_and_b32 s54, s54, 3
    s_cmp_lg_u32 s54, 3
    s_cbranch_scc1 pub_29
    buffer_atomic_add v8, v11, s[56:59], s53 offen sc1
pub_29:
    s_mov_b64 exec, -1
mm_30:
    s_waitcnt lgkmcnt(0)
    v_mfma_f32_16x16x32_bf16 v[24:27], v[104:107], v[88:91], v[24:27]
    ds_read_b128 v[120:123], v17 offset:1024
    v_mfma_f32_16x16x32_bf16 v[40:43], v[104:107], v[92:95], v[40:43]
    ds_read_b128 v[124:127], v17 offset:3072
    v_mfma_f32_16x16x32_bf16 v[56:59], v[104:107], v[96:99], v[56:59]
    ds_read_b128 v[128:131], v17 offset:5120
    v_mfma_f32_16x16x32_bf16 v[72:75], v[104:107], v[100:103], v[72:75]
    ds_read_b128 v[132:135], v17 offset:7168
    v_mfma_f32_16x16x32_bf16 v[76:79], v[108:111], v[100:103], v[76:79]
    ds_read_b64_tr_b16 v[136:137], v18 offset:8192
    v_mfma_f32_16x16x32_bf16 v[60:63], v[108:111], v[96:99], v[60:63]
    ds_read_b64_tr_b16 v[138:139], v18 offset:12288
    v_mfma_f32_16x16x32_bf16 v[44:47], v[108:111], v[92:95], v[44:47]
    ds_read_b64_tr_b16 v[140:141], v19 offset:8192
    v_mfma_f32_16x16x32_bf16 v[28:31], v[108:111], v[88:91], v[28:31]
    ds_read_b64_tr_b16 v[142:143], v19 offset:12288
    v_mfma_f32_16x16x32_bf16 v[32:35], v[112:115], v[88:91], v[32:35]
    ds_read_b64_tr_b16 v[144:145], v20 offset:8192
    v_mfma_f32_16x16x32_bf16 v[48:51], v[112:115], v[92:95], v[48:51]
    ds_read_b64_tr_b16 v[146:147], v20 offset:12288
    v_mfma_f32_16x16x32_bf16 v[64:67], v[112:115], v[96:99], v[64:67]
    ds_read_b64_tr_b16 v[148:149], v21 offset:8192
    v_mfma_f32_16x16x32_bf16 v[80:83], v[112:115], v[100:103], v[80:83]
    ds_read_b64_tr_b16 v[150:151], v21 offset:12288
    s_add_u32 s42, s42, 16384
    s_cmp_eq_u32 s42, 49152
    s_cselect_b32 s42, 0, s42
    v_mfma_f32_16x16x32_bf16 v[84:87], v[116:119], v[100:103], v[84:87]
    s_add_u32 s48, s48, 16384
    s_cmp_eq_u32 s48, 98304
    s_cselect_b32 s48, 0, s48
    v_mfma_f32_16x16x32_bf16 v[68:71], v[116:119], v[96:99], v[68:71]
    v_add_u32 v17, s42, v12
    v_add_u32 v18, s48, v13
    v_add_u32 v19, s48, v14
    v_mfma_f32_16x16x32_bf16 v[52:55], v[116:119], v[92:95], v[52:55]
    v_add_u32 v20, s48, v15
    v_add_u32 v21, s48, v16
    v_mfma_f32_16x16x32_bf16 v[36:39], v[116:119], v[88:91], v[36:39]
    s_waitcnt lgkmcnt(0)
    s_barrier
    v_mfma_f32_16x16x32_bf16 v[24:27], v[136:139], v[120:123], v[24:27]
    ds_read_b128 v[88:91], v17 offset:0
    v_mfma_f32_16x16x32_bf16 v[40:43], v[136:139], v[124:127], v[40:43]
    ds_read_b128 v[92:95], v17 offset:2048
    v_mfma_f32_16x16x32_bf16 v[56:59], v[136:139], v[128:131], v[56:59]
    ds_read_b128 v[96:99], v17 offset:4096
    v_mfma_f32_16x16x32_bf16 v[72:75], v[136:139], v[132:135], v[72:75]
    ds_read_b128 v[100:103], v17 offset:6144
    v_mfma_f32_16x16x32_bf16 v[76:79], v[140:143], v[132:135], v[76:79]
    ds_read_b64_tr_b16 v[104:105], v18 offset:0
    v_mfma_f32_16x16x32_bf16 v[60:63], v[140:143], v[128:131], v[60:63]
    ds_read_b64_tr_b16 v[106:107], v18 offset:4096
    v_mfma_f32_16x16x32_bf16 v[44:47], v[140:143], v[124:127], v[44:47]
    ds_read_b64_tr_b16 v[108:109], v19 offset:0
    v_mfma_f32_16x16x32_bf16 v[28:31], v[140:143], v[120:123], v[28:31]
    ds_read_b64_tr_b16 v[110:111], v19 offset:4096
    v_mfma_f32_16x16x32_bf16 v[32:35], v[144:147], v[120:123], v[32:35]
    ds_read_b64_tr_b16 v[112:113], v20 offset:0
    v_mfma_f32_16x16x32_bf16 v[48:51], v[144:147], v[124:127], v[48:51]
    ds_read_b64_tr_b16 v[114:115], v20 offset:4096
    v_mfma_f32_16x16x32_bf16 v[64:67], v[144:147], v[128:131], v[64:67]
    ds_read_b64_tr_b16 v[116:117], v21 offset:0
    v_mfma_f32_16x16x32_bf16 v[80:83], v[144:147], v[132:135], v[80:83]
    ds_read_b64_tr_b16 v[118:119], v21 offset:4096
    s_add_u32 s43, s43, 1
    v_mfma_f32_16x16x32_bf16 v[84:87], v[148:151], v[132:135], v[84:87]
    s_cmp_lt_u32 s43, 4
    v_mfma_f32_16x16x32_bf16 v[68:71], v[148:151], v[128:131], v[68:71]
    v_mfma_f32_16x16x32_bf16 v[52:55], v[148:151], v[124:127], v[52:55]
    v_mfma_f32_16x16x32_bf16 v[36:39], v[148:151], v[120:123], v[36:39]
    s_cbranch_scc1 mm_30
    s_add_u32 s53, s55, 768
    s_lshl_b32 s54, s31, 7
    s_add_u32 s53, s53, s54
    v_mov_b32 v8, 1
    v_mov_b32 v9, 162816
    v_mov_b32 v11, 0
    s_mov_b64 exec, 1
    s_waitcnt vmcnt(0)
    ds_add_rtn_u32 v10, v9, v8
    s_waitcnt lgkmcnt(0)
    v_readfirstlane_b32 s54, v10
    s_nop 0
    s_and_b32 s54, s54, 3
    s_cmp_lg_u32 s54, 3
    s_cbranch_scc1 pub_31
    buffer_atomic_add v8, v11, s[56:59], s53 offen sc1
pub_31:
    s_mov_b64 exec, -1
mm_32:
    s_waitcnt lgkmcnt(0)
    v_mfma_f32_16x16x32_bf16 v[24:27], v[104:107], v[88:91], v[24:27]
    ds_read_b128 v[120:123], v17 offset:1024
    v_mfma_f32_16x16x32_bf16 v[40:43], v[104:107], v[92:95], v[40:43]
    ds_read_b128 v[124:127], v17 offset:3072
    v_mfma_f32_16x16x32_bf16 v[56:59], v[104:107], v[96:99], v[56:59]
    ds_read_b128 v[128:131], v17 offset:5120
    v_mfma_f32_16x16x32_bf16 v[72:75], v[104:107], v[100:103], v[72:75]
    ds_read_b128 v[132:135], v17 offset:7168
    v_mfma_f32_16x16x32_bf16 v[76:79], v[108:111], v[100:103], v[76:79]
    ds_read_b64_tr_b16 v[136:137], v18 offset:8192
    v_mfma_f32_16x16x32_bf16 v[60:63], v[108:111], v[96:99], v[60:63]
    ds_read_b64_tr_b16 v[138:139], v18 offset:12288
    v_mfma_f32_16x16x32_bf16 v[44:47], v[108:111], v[92:95], v[44:47]
    ds_read_b64_tr_b16 v[140:141], v19 offset:8192
    v_mfma_f32_16x16x32_bf16 v[28:31], v[108:111], v[88:91], v[28:31]
    ds_read_b64_tr_b16 v[142:143], v19 offset:12288
    v_mfma_f32_16x16x32_bf16 v[32:35], v[112:115], v[88:91], v[32:35]
    ds_read_b64_tr_b16 v[144:145], v20 offset:8192
    v_mfma_f32_16x16x32_bf16 v[48:51], v[112:115], v[92:95], v[48:51]
    ds_read_b64_tr_b16 v[146:147], v20 offset:12288
    v_mfma_f32_16x16x32_bf16 v[64:67], v[112:115], v[96:99], v[64:67]
    ds_read_b64_tr_b16 v[148:149], v21 offset:8192
    v_mfma_f32_16x16x32_bf16 v[80:83], v[112:115], v[100:103], v[80:83]
    ds_read_b64_tr_b16 v[150:151], v21 offset:12288
    s_add_u32 s42, s42, 16384
    s_cmp_eq_u32 s42, 49152
    s_cselect_b32 s42, 0, s42
    v_mfma_f32_16x16x32_bf16 v[84:87], v[116:119], v[100:103], v[84:87]
    s_add_u32 s48, s48, 16384
    s_cmp_eq_u32 s48, 98304
    s_cselect_b32 s48, 0, s48
    v_mfma_f32_16x16x32_bf16 v[68:71], v[116:119], v[96:99], v[68:71]
    v_add_u32 v17, s42, v12
    v_add_u32 v18, s48, v13
    v_add_u32 v19, s48, v14
    v_mfma_f32_16x16x32_bf16 v[52:55], v[116:119], v[92:95], v[52:55]
    v_add_u32 v20, s48, v15
    v_add_u32 v21, s48, v16
    v_mfma_f32_16x16x32_bf16 v[36:39], v[116:119], v[88:91], v[36:39]
    s_waitcnt lgkmcnt(0)
    s_barrier
    v_mfma_f32_16x16x32_bf16 v[24:27], v[136:139], v[120:123], v[24:27]
    ds_read_b128 v[88:91], v17 offset:0
    v_mfma_f32_16x16x32_bf16 v[40:43], v[136:139], v[124:127], v[40:43]
    ds_read_b128 v[92:95], v17 offset:2048
    v_mfma_f32_16x16x32_bf16 v[56:59], v[136:139], v[128:131], v[56:59]
    ds_read_b128 v[96:99], v17 offset:4096
    v_mfma_f32_16x16x32_bf16 v[72:75], v[136:139], v[132:135], v[72:75]
    ds_read_b128 v[100:103], v17 offset:6144
    v_mfma_f32_16x16x32_bf16 v[76:79], v[140:143], v[132:135], v[76:79]
    ds_read_b64_tr_b16 v[104:105], v18 offset:0
    v_mfma_f32_16x16x32_bf16 v[60:63], v[140:143], v[128:131], v[60:63]
    ds_read_b64_tr_b16 v[106:107], v18 offset:4096
    v_mfma_f32_16x16x32_bf16 v[44:47], v[140:143], v[124:127], v[44:47]
    ds_read_b64_tr_b16 v[108:109], v19 offset:0
    v_mfma_f32_16x16x32_bf16 v[28:31], v[140:143], v[120:123], v[28:31]
    ds_read_b64_tr_b16 v[110:111], v19 offset:4096
    v_mfma_f32_16x16x32_bf16 v[32:35], v[144:147], v[120:123], v[32:35]
    ds_read_b64_tr_b16 v[112:113], v20 offset:0
    v_mfma_f32_16x16x32_bf16 v[48:51], v[144:147], v[124:127], v[48:51]
    ds_read_b64_tr_b16 v[114:115], v20 offset:4096
    v_mfma_f32_16x16x32_bf16 v[64:67], v[144:147], v[128:131], v[64:67]
    ds_read_b64_tr_b16 v[116:117], v21 offset:0
    v_mfma_f32_16x16x32_bf16 v[80:83], v[144:147], v[132:135], v[80:83]
    ds_read_b64_tr_b16 v[118:119], v21 offset:4096
    s_add_u32 s43, s43, 1
    v_mfma_f32_16x16x32_bf16 v[84:87], v[148:151], v[132:135], v[84:87]
    s_cmp_lt_u32 s43, 27
    v_mfma_f32_16x16x32_bf16 v[68:71], v[148:151], v[128:131], v[68:71]
    v_mfma_f32_16x16x32_bf16 v[52:55], v[148:151], v[124:127], v[52:55]
    v_mfma_f32_16x16x32_bf16 v[36:39], v[148:151], v[120:123], v[36:39]
    s_cbranch_scc1 mm_32
    s_waitcnt lgkmcnt(0)
    s_cmp_eq_u32 s60, 1
    s_cbranch_scc1 G4_last
    v_mfma_f32_16x16x32_bf16 v[24:27], v[104:107], v[88:91], v[24:27]
    ds_read_b128 v[120:123], v17 offset:1024
    v_mfma_f32_16x16x32_bf16 v[40:43], v[104:107], v[92:95], v[40:43]
    ds_read_b128 v[124:127], v17 offset:3072
    v_mfma_f32_16x16x32_bf16 v[56:59], v[104:107], v[96:99], v[56:59]
    ds_read_b128 v[128:131], v17 offset:5120
    v_mfma_f32_16x16x32_bf16 v[72:75], v[104:107], v[100:103], v[72:75]
    ds_read_b128 v[132:135], v17 offset:7168
    v_mfma_f32_16x16x32_bf16 v[76:79], v[108:111], v[100:103], v[76:79]
    ds_read_b64_tr_b16 v[136:137], v18 offset:8192
    v_mfma_f32_16x16x32_bf16 v[60:63], v[108:111], v[96:99], v[60:63]
    ds_read_b64_tr_b16 v[138:139], v18 offset:12288
    v_mfma_f32_16x16x32_bf16 v[44:47], v[108:111], v[92:95], v[44:47]
    ds_read_b64_tr_b16 v[140:141], v19 offset:8192
    v_mfma_f32_16x16x32_bf16 v[28:31], v[108:111], v[88:91], v[28:31]
    ds_read_b64_tr_b16 v[142:143], v19 offset:12288
    v_mfma_f32_16x16x32_bf16 v[32:35], v[112:115], v[88:91], v[32:35]
    ds_read_b64_tr_b16 v[144:145], v20 offset:8192
    v_mfma_f32_16x16x32_bf16 v[48:51], v[112:115], v[92:95], v[48:51]
    ds_read_b64_tr_b16 v[146:147], v20 offset:12288
    v_mfma_f32_16x16x32_bf16 v[64:67], v[112:115], v[96:99], v[64:67]
    ds_read_b64_tr_b16 v[148:149], v21 offset:8192
    v_mfma_f32_16x16x32_bf16 v[80:83], v[112:115], v[100:103], v[80:83]
    ds_read_b64_tr_b16 v[150:151], v21 offset:12288
    v_mfma_f32_16x16x32_bf16 v[84:87], v[116:119], v[100:103], v[84:87]
    v_mfma_f32_16x16x32_bf16 v[68:71], v[116:119], v[96:99], v[68:71]
    v_mfma_f32_16x16x32_bf16 v[52:55], v[116:119], v[92:95], v[52:55]
    v_mfma_f32_16x16x32_bf16 v[36:39], v[116:119], v[88:91], v[36:39]
    s_waitcnt lgkmcnt(0)
    v_mfma_f32_16x16x32_bf16 v[24:27], v[136:139], v[120:123], v[24:27]
    s_mul_i32 s36, s31, 524288
    v_mfma_f32_16x16x32_bf16 v[40:43], v[136:139], v[124:127], v[40:43]
    v_mfma_f32_16x16x32_bf16 v[56:59], v[136:139], v[128:131], v[56:59]
    s_add_u32 s36, s36, 5242880
    v_mfma_f32_16x16x32_bf16 v[72:75], v[136:139], v[132:135], v[72:75]
    v_mfma_f32_16x16x32_bf16 v[76:79], v[140:143], v[132:135], v[76:79]
    s_add_u32 s16, s62, s36
    v_mfma_f32_16x16x32_bf16 v[60:63], v[140:143], v[128:131], v[60:63]
    v_mfma_f32_16x16x32_bf16 v[44:47], v[140:143], v[124:127], v[44:47]
    s_addc_u32 s17, s63, 0
    v_mfma_f32_16x16x32_bf16 v[28:31], v[140:143], v[120:123], v[28:31]
    v_mfma_f32_16x16x32_bf16 v[32:35], v[144:147], v[120:123], v[32:35]
    s_mov_b32 s18, 516096
    v_mfma_f32_16x16x32_bf16 v[48:51], v[144:147], v[124:127], v[48:51]
    v_mfma_f32_16x16x32_bf16 v[64:67], v[144:147], v[128:131], v[64:67]
    s_mov_b32 s19, 0x20000
    v_mfma_f32_16x16x32_bf16 v[80:83], v[144:147], v[132:135], v[80:83]
    v_mfma_f32_16x16x32_bf16 v[84:87], v[148:151], v[132:135], v[84:87]
    v_mfma_f32_16x16x32_bf16 v[68:71], v[148:151], v[128:131], v[68:71]
    v_mfma_f32_16x16x32_bf16 v[52:55], v[148:151], v[124:127], v[52:55]
    v_mfma_f32_16x16x32_bf16 v[36:39], v[148:151], v[120:123], v[36:39]
    s_add_u32 s36, s39, 0
    v_cvt_pk_bf16_f32 v24, v24, v25
    v_cvt_pk_bf16_f32 v25, v26, v27
    v_cvt_pk_bf16_f32 v26, v28, v29
    v_cvt_pk_bf16_f32 v27, v30, v31
    buffer_store_dwordx4 v[24:27], v2, s[16:19], s36 offen offset:0 sc1
    v_cvt_pk_bf16_f32 v32, v32, v33
    v_cvt_pk_bf16_f32 v33, v34, v35
    v_cvt_pk_bf16_f32 v34, v36, v37
    v_cvt_pk_bf16_f32 v35, v38, v39
    buffer_store_dwordx4 v[32:35], v2, s[16:19], s36 offen offset:1024 sc1
    s_add_u32 s36, s39, 65536
    v_cvt_pk_bf16_f32 v40, v40, v41
    v_cvt_pk_bf16_f32 v41, v42, v43
    v_cvt_pk_bf16_f32 v42, v44, v45
    v_cvt_pk_bf16_f32 v43, v46, v47
    buffer_store_dwordx4 v[40:43], v2, s[16:19], s36 offen offset:0 sc1
    v_cvt_pk_bf16_f32 v48, v48, v49
    v_cvt_pk_bf16_f32 v49, v50, v51
    v_cvt_pk_bf16_f32 v50, v52, v53
    v_cvt_pk_bf16_f32 v51, v54, v55
    buffer_store_dwordx4 v[48:51], v2, s[16:19], s36 offen offset:1024 sc1
    s_add_u32 s36, s39, 131072
    v_cvt_pk_bf16_f32 v56, v56, v57
    v_cvt_pk_bf16_f32 v57, v58, v59
    v_cvt_pk_bf16_f32 v58, v60, v61
    v_cvt_pk_bf16_f32 v59, v62, v63
    buffer_store_dwordx4 v[56:59], v2, s[16:19], s36 offen offset:0 sc1
    v_cvt_pk_bf16_f32 v64, v64, v65
    v_cvt_pk_bf16_f32 v65, v66, v67
    v_cvt_pk_bf16_f32 v66, v68, v69
    v_cvt_pk_bf16_f32 v67, v70, v71
    buffer_store_dwordx4 v[64:67], v2, s[16:19], s36 offen offset:1024 sc1
    s_add_u32 s36, s39, 196608
    v_cvt_pk_bf16_f32 v72, v72, v73
    v_cvt_pk_bf16_f32 v73, v74, v75
    v_cvt_pk_bf16_f32 v74, v76, v77
    v_cvt_pk_bf16_f32 v75, v78, v79
    buffer_store_dwordx4 v[72:75], v2, s[16:19], s36 offen offset:0 sc1
    v_cvt_pk_bf16_f32 v80, v80, v81
    v_cvt_pk_bf16_f32 v81, v82, v83
    v_cvt_pk_bf16_f32 v82, v84, v85
    v_cvt_pk_bf16_f32 v83, v86, v87
    buffer_store_dwordx4 v[80:83], v2, s[16:19], s36 offen offset:1024 sc1
    s_barrier
    s_add_u32 s53, s55, 1024
    v_mov_b32 v8, 1
    v_mov_b32 v9, 162816
    v_mov_b32 v11, 0
    s_mov_b64 exec, 1
    s_waitcnt vmcnt(0)
    ds_add_rtn_u32 v10, v9, v8
    s_waitcnt lgkmcnt(0)
    v_readfirstlane_b32 s54, v10
    s_nop 0
    s_and_b32 s54, s54, 3
    s_cmp_lg_u32 s54, 3
    s_cbranch_scc1 pub_33
    buffer_atomic_add v8, v11, s[56:59], s53 offen sc1
    v_mov_b32 v9, 162872
    ds_add_u32 v9, v8
pub_33:
    s_mov_b64 exec, -1
    s_branch NEXT
G4_last:
    v_mfma_f32_16x16x32_bf16 v[24:27], v[104:107], v[88:91], v[24:27]
    ds_read_b128 v[120:123], v17 offset:1024
    ds_read_b128 v[124:127], v17 offset:3072
    v_mfma_f32_16x16x32_bf16 v[40:43], v[104:107], v[92:95], v[40:43]
    ds_read_b128 v[128:131], v17 offset:5120
    v_mfma_f32_16x16x32_bf16 v[56:59], v[104:107], v[96:99], v[56:59]
    ds_read_b128 v[132:135], v17 offset:7168
    v_mfma_f32_16x16x32_bf16 v[72:75], v[104:107], v[100:103], v[72:75]
    ds_read_b64_tr_b16 v[136:137], v18 offset:8192
    v_mfma_f32_16x16x32_bf16 v[76:79], v[108:111], v[100:103], v[76:79]
    ds_read_b64_tr_b16 v[138:139], v18 offset:12288
    v_mfma_f32_16x16x32_bf16 v[60:63], v[108:111], v[96:99], v[60:63]
    ds_read_b64_tr_b16 v[140:141], v19 offset:8192
    v_mfma_f32_16x16x32_bf16 v[44:47], v[108:111], v[92:95], v[44:47]
    ds_read_b64_tr_b16 v[142:143], v19 offset:12288
    v_mfma_f32_16x16x32_bf16 v[28:31], v[108:111], v[88:91], v[28:31]
    ds_read_b64_tr_b16 v[144:145], v20 offset:8192
    v_mfma_f32_16x16x32_bf16 v[32:35], v[112:115], v[88:91], v[32:35]
    ds_read_b64_tr_b16 v[146:147], v20 offset:12288
    v_mfma_f32_16x16x32_bf16 v[48:51], v[112:115], v[92:95], v[48:51]
    ds_read_b64_tr_b16 v[148:149], v21 offset:8192
    v_mfma_f32_16x16x32_bf16 v[64:67], v[112:115], v[96:99], v[64:67]
    ds_read_b64_tr_b16 v[150:151], v21 offset:12288
    v_mfma_f32_16x16x32_bf16 v[80:83], v[112:115], v[100:103], v[80:83]
    s_load_dwordx2 s[6:7], s[0:1], 88
    v_mfma_f32_16x16x32_bf16 v[84:87], v[116:119], v[100:103], v[84:87]
    v_mfma_f32_16x16x32_bf16 v[68:71], v[116:119], v[96:99], v[68:71]
    v_mfma_f32_16x16x32_bf16 v[52:55], v[116:119], v[92:95], v[52:55]
    v_mfma_f32_16x16x32_bf16 v[36:39], v[116:119], v[88:91], v[36:39]
    s_waitcnt lgkmcnt(0)
    v_mfma_f32_16x16x32_bf16 v[24:27], v[136:139], v[120:123], v[24:27]
    s_add_u32 s16, s62, 0x500000
    s_addc_u32 s17, s63, 0
    s_mov_b32 s18, 0x7e000
    s_mov_b32 s19, 0x20000
    v_mfma_f32_16x16x32_bf16 v[40:43], v[136:139], v[124:127], v[40:43]
    s_mov_b32 s20, s6
    s_mov_b32 s21, s7
    s_mov_b32 s22, 0x400000
    v_mfma_f32_16x16x32_bf16 v[56:59], v[136:139], v[128:131], v[56:59]
    s_mov_b32 s23, 0x20000
    s_lshl_b32 s44, s29, 2
    s_add_u32 s44, s44, s30
    v_mfma_f32_16x16x32_bf16 v[72:75], v[136:139], v[132:135], v[72:75]
    s_lshl_b32 s44, s44, 7
    s_xor_b32 s45, s44, 4096
    s_add_u32 s44, s44, s55
    v_mfma_f32_16x16x32_bf16 v[76:79], v[140:143], v[132:135], v[76:79]
    s_add_u32 s44, s44, 16384
    s_add_u32 s45, s45, s55
    s_add_u32 s45, s45, 16384
    v_mfma_f32_16x16x32_bf16 v[60:63], v[140:143], v[128:131], v[60:63]
    v_mov_b32 v9, s45
    v_mov_b32 v10, s52
    v_mov_b32 v11, 0
    v_mfma_f32_16x16x32_bf16 v[44:47], v[140:143], v[124:127], v[44:47]
    s_lshl_b32 s46, s28, 3
    s_add_u32 s46, s46, s37
    s_lshl_b32 s47, s31, 1
    v_mfma_f32_16x16x32_bf16 v[28:31], v[140:143], v[120:123], v[28:31]
    s_add_u32 s46, s46, s47
    s_lshl_b32 s46, s46, 15
    s_lshl_b32 s47, s38, 5
    v_mfma_f32_16x16x32_bf16 v[32:35], v[144:147], v[120:123], v[32:35]
    s_add_u32 s46, s46, s47
    s_add_u32 s47, s46, 32768
    v_and_b32 v225, 1, v23
    v_mfma_f32_16x16x32_bf16 v[48:51], v[144:147], v[124:127], v[48:51]
    v_lshlrev_b32 v224, 11, v22
    v_lshl_add_u32 v224, v225, 5, v224
    v_lshrrev_b32 v225, 1, v23
    v_mfma_f32_16x16x32_bf16 v[64:67], v[144:147], v[128:131], v[64:67]
    v_lshl_add_u32 v224, v225, 4, v224
    v_cmp_gt_u32 s[48:49], 8, v22
    v_lshrrev_b32 v225, 3, v22
    v_mfma_f32_16x16x32_bf16 v[80:83], v[144:147], v[132:135], v[80:83]
    v_mul_u32_u24 v225, 16320, v225
    v_sub_u32 v224, v224, v225
    v_add_u32 v225, 16384, v224
    v_mfma_f32_16x16x32_bf16 v[84:87], v[148:151], v[132:135], v[84:87]
    v_mfma_f32_16x16x32_bf16 v[68:71], v[148:151], v[128:131], v[68:71]
    v_mfma_f32_16x16x32_bf16 v[52:55], v[148:151], v[124:127], v[52:55]
    v_mfma_f32_16x16x32_bf16 v[36:39], v[148:151], v[120:123], v[36:39]
    s_cmp_eq_u32 s31, 0
    s_cbranch_scc1 G4_k0
    v_swap_b32 v24, v56
    v_swap_b32 v25, v57
    v_swap_b32 v26, v58
    v_swap_b32 v27, v59
    v_swap_b32 v28, v60
    v_swap_b32 v29, v61
    v_swap_b32 v30, v62
    v_swap_b32 v31, v63
    v_swap_b32 v32, v64
    v_swap_b32 v33, v65
    v_swap_b32 v34, v66
    v_swap_b32 v35, v67
    v_swap_b32 v36, v68
    v_swap_b32 v37, v69
    v_swap_b32 v38, v70
    v_swap_b32 v39, v71
    v_swap_b32 v40, v72
    v_swap_b32 v41, v73
    v_swap_b32 v42, v74
    v_swap_b32 v43, v75
    v_swap_b32 v44, v76
    v_swap_b32 v45, v77
    v_swap_b32 v46, v78
    v_swap_b32 v47, v79
    v_swap_b32 v48, v80
    v_swap_b32 v49, v81
    v_swap_b32 v50, v82
    v_swap_b32 v51, v83
    v_swap_b32 v52, v84
    v_swap_b32 v53, v85
    v_swap_b32 v54, v86
    v_swap_b32 v55, v87
G4_k0:
    s_add_u32 s36, s41, 0
    v_cvt_pk_bf16_f32 v56, v56, v57
    v_cvt_pk_bf16_f32 v57, v58, v59
    v_cvt_pk_bf16_f32 v58, v60, v61
    v_cvt_pk_bf16_f32 v59, v62, v63
    buffer_store_dwordx4 v[56:59], v2, s[16:19], s36 offen offset:0 sc1
    v_cvt_pk_bf16_f32 v64, v64, v65
    v_cvt_pk_bf16_f32 v65, v66, v67
    v_cvt_pk_bf16_f32 v66, v68, v69
    v_cvt_pk_bf16_f32 v67, v70, v71
    buffer_store_dwordx4 v[64:67], v2, s[16:19], s36 offen offset:1024 sc1
    s_add_u32 s36, s41, 65536
    v_cvt_pk_bf16_f32 v72, v72, v73
    v_cvt_pk_bf16_f32 v73, v74, v75
    v_cvt_pk_bf16_f32 v74, v76, v77
    v_cvt_pk_bf16_f32 v75, v78, v79
    buffer_store_dwordx4 v[72:75], v2, s[16:19], s36 offen offset:0 sc1
    v_cvt_pk_bf16_f32 v80, v80, v81
    v_cvt_pk_bf16_f32 v81, v82, v83
    v_cvt_pk_bf16_f32 v82, v84, v85
    v_cvt_pk_bf16_f32 v83, v86, v87
    buffer_store_dwordx4 v[80:83], v2, s[16:19], s36 offen offset:1024 sc1
    s_waitcnt vmcnt(4)
    v_lshlrev_b32 v226, 16, v160
    v_and_b32 v227, 0xffff0000, v160
    v_pk_add_f32 v[24:25], v[24:25], v[226:227]
    v_lshlrev_b32 v228, 16, v161
    v_and_b32 v229, 0xffff0000, v161
    v_pk_add_f32 v[26:27], v[26:27], v[228:229]
    v_lshlrev_b32 v226, 16, v162
    v_and_b32 v227, 0xffff0000, v162
    v_pk_add_f32 v[28:29], v[28:29], v[226:227]
    v_lshlrev_b32 v228, 16, v163
    v_and_b32 v229, 0xffff0000, v163
    v_pk_add_f32 v[30:31], v[30:31], v[228:229]
    v_lshlrev_b32 v226, 16, v168
    v_and_b32 v227, 0xffff0000, v168
    v_pk_add_f32 v[32:33], v[32:33], v[226:227]
    v_lshlrev_b32 v228, 16, v169
    v_and_b32 v229, 0xffff0000, v169
    v_pk_add_f32 v[34:35], v[34:35], v[228:229]
    v_lshlrev_b32 v226, 16, v170
    v_and_b32 v227, 0xffff0000, v170
    v_pk_add_f32 v[36:37], v[36:37], v[226:227]
    v_lshlrev_b32 v228, 16, v171
    v_and_b32 v229, 0xffff0000, v171
    v_pk_add_f32 v[38:39], v[38:39], v[228:229]
    v_lshlrev_b32 v226, 16, v176
    v_and_b32 v227, 0xffff0000, v176
    v_pk_add_f32 v[40:41], v[40:41], v[226:227]
    v_lshlrev_b32 v228, 16, v177
    v_and_b32 v229, 0xffff0000, v177
    v_pk_add_f32 v[42:43], v[42:43], v[228:229]
    v_lshlrev_b32 v226, 16, v178
    v_and_b32 v227, 0xffff0000, v178
    v_pk_add_f32 v[44:45], v[44:45], v[226:227]
    v_lshlrev_b32 v228, 16, v179
    v_and_b32 v229, 0xffff0000, v179
    v_pk_add_f32 v[46:47], v[46:47], v[228:229]
    v_lshlrev_b32 v226, 16, v184
    v_and_b32 v227, 0xffff0000, v184
    v_pk_add_f32 v[48:49], v[48:49], v[226:227]
    v_lshlrev_b32 v228, 16, v185
    v_and_b32 v229, 0xffff0000, v185
    v_pk_add_f32 v[50:51], v[50:51], v[228:229]
    v_lshlrev_b32 v226, 16, v186
    v_and_b32 v227, 0xffff0000, v186
    v_pk_add_f32 v[52:53], v[52:53], v[226:227]
    v_lshlrev_b32 v228, 16, v187
    v_and_b32 v229, 0xffff0000, v187
    v_pk_add_f32 v[54:55], v[54:55], v[228:229]
    s_waitcnt vmcnt(0)
    s_mov_b64 exec, 1
    buffer_store_dword v10, v11, s[56:59], s44 offen sc1
    s_mov_b64 exec, -1
    v_lshlrev_b32 v226, 16, v164
    v_and_b32 v227, 0xffff0000, v164
    v_pk_add_f32 v[24:25], v[24:25], v[226:227]
    v_lshlrev_b32 v228, 16, v165
    v_and_b32 v229, 0xffff0000, v165
    v_pk_add_f32 v[26:27], v[26:27], v[228:229]
    v_lshlrev_b32 v226, 16, v166
    v_and_b32 v227, 0xffff0000, v166
    v_pk_add_f32 v[28:29], v[28:29], v[226:227]
    v_lshlrev_b32 v228, 16, v167
    v_and_b32 v229, 0xffff0000, v167
    v_pk_add_f32 v[30:31], v[30:31], v[228:229]
    v_lshlrev_b32 v226, 16, v172
    v_and_b32 v227, 0xffff0000, v172
    v_pk_add_f32 v[32:33], v[32:33], v[226:227]
    v_lshlrev_b32 v228, 16, v173
    v_and_b32 v229, 0xffff0000, v173
    v_pk_add_f32 v[34:35], v[34:35], v[228:229]
    v_lshlrev_b32 v226, 16, v174
    v_and_b32 v227, 0xffff0000, v174
    v_pk_add_f32 v[36:37], v[36:37], v[226:227]
    v_lshlrev_b32 v228, 16, v175
    v_and_b32 v229, 0xffff0000, v175
    v_pk_add_f32 v[38:39], v[38:39], v[228:229]
    v_lshlrev_b32 v226, 16, v180
    v_and_b32 v227, 0xffff0000, v180
    v_pk_add_f32 v[40:41], v[40:41], v[226:227]
    v_lshlrev_b32 v228, 16, v181
    v_and_b32 v229, 0xffff0000, v181
    v_pk_add_f32 v[42:43], v[42:43], v[228:229]
    v_lshlrev_b32 v226, 16, v182
    v_and_b32 v227, 0xffff0000, v182
    v_pk_add_f32 v[44:45], v[44:45], v[226:227]
    v_lshlrev_b32 v228, 16, v183
    v_and_b32 v229, 0xffff0000, v183
    v_pk_add_f32 v[46:47], v[46:47], v[228:229]
    v_lshlrev_b32 v226, 16, v188
    v_and_b32 v227, 0xffff0000, v188
    v_pk_add_f32 v[48:49], v[48:49], v[226:227]
    v_lshlrev_b32 v228, 16, v189
    v_and_b32 v229, 0xffff0000, v189
    v_pk_add_f32 v[50:51], v[50:51], v[228:229]
    v_lshlrev_b32 v226, 16, v190
    v_and_b32 v227, 0xffff0000, v190
    v_pk_add_f32 v[52:53], v[52:53], v[226:227]
    v_lshlrev_b32 v228, 16, v191
    v_and_b32 v229, 0xffff0000, v191
    v_pk_add_f32 v[54:55], v[54:55], v[228:229]
    s_mov_b32 s53, 0
    s_add_u32 s54, s52, 0
    s_bfm_b64 exec, 1, 0
poll_34:
    buffer_load_dword v8, v9, s[56:59], 0 offen sc1
    s_waitcnt vmcnt(0)
    v_xor_b32 v8, s54, v8
    v_cmp_eq_u32 vcc, 0, v8
    s_nop 0
    s_cmp_eq_u64 vcc, exec
    s_cbranch_scc1 pok_35
    s_sleep 2
    s_add_u32 s53, s53, 1
    s_cmp_lt_u32 s53, s61
    s_cbranch_scc1 poll_34
    s_mov_b32 s61, 0
pok_35:
    s_mov_b64 exec, -1
    s_add_u32 s36, s40, 0
    buffer_load_dwordx4 v[208:211], v2, s[16:19], s36 offen offset:0 sc1
    buffer_load_dwordx4 v[212:215], v2, s[16:19], s36 offen offset:1024 sc1
    s_add_u32 s36, s40, 65536
    buffer_load_dwordx4 v[216:219], v2, s[16:19], s36 offen offset:0 sc1
    buffer_load_dwordx4 v[220:223], v2, s[16:19], s36 offen offset:1024 sc1
    s_waitcnt vmcnt(3)
    v_lshlrev_b32 v226, 16, v208
    v_and_b32 v227, 0xffff0000, v208
    v_pk_add_f32 v[24:25], v[24:25], v[226:227]
    v_lshlrev_b32 v228, 16, v209
    v_and_b32 v229, 0xffff0000, v209
    v_pk_add_f32 v[26:27], v[26:27], v[228:229]
    v_lshlrev_b32 v226, 16, v210
    v_and_b32 v227, 0xffff0000, v210
    v_pk_add_f32 v[28:29], v[28:29], v[226:227]
    v_lshlrev_b32 v228, 16, v211
    v_and_b32 v229, 0xffff0000, v211
    v_pk_add_f32 v[30:31], v[30:31], v[228:229]
    v_cvt_pk_bf16_f32 v24, v24, v25
    v_cvt_pk_bf16_f32 v25, v26, v27
    v_cvt_pk_bf16_f32 v26, v28, v29
    v_cvt_pk_bf16_f32 v27, v30, v31
    s_nop 0
    v_permlane16_swap_b32 v24, v26
    v_permlane16_swap_b32 v25, v27
    s_waitcnt vmcnt(2)
    v_lshlrev_b32 v226, 16, v212
    v_and_b32 v227, 0xffff0000, v212
    v_pk_add_f32 v[32:33], v[32:33], v[226:227]
    v_lshlrev_b32 v228, 16, v213
    v_and_b32 v229, 0xffff0000, v213
    v_pk_add_f32 v[34:35], v[34:35], v[228:229]
    v_lshlrev_b32 v226, 16, v214
    v_and_b32 v227, 0xffff0000, v214
    v_pk_add_f32 v[36:37], v[36:37], v[226:227]
    v_lshlrev_b32 v228, 16, v215
    v_and_b32 v229, 0xffff0000, v215
    v_pk_add_f32 v[38:39], v[38:39], v[228:229]
    v_cvt_pk_bf16_f32 v32, v32, v33
    v_cvt_pk_bf16_f32 v33, v34, v35
    v_cvt_pk_bf16_f32 v34, v36, v37
    v_cvt_pk_bf16_f32 v35, v38, v39
    s_nop 0
    v_permlane16_swap_b32 v32, v34
    v_permlane16_swap_b32 v33, v35
    v_cndmask_b32 v36, v24, v32, s[48:49]
    v_cndmask_b32 v37, v25, v33, s[48:49]
    v_cndmask_b32 v38, v26, v34, s[48:49]
    v_cndmask_b32 v39, v27, v35, s[48:49]
    v_mov_b32_dpp v28, v36 row_ror:8 row_mask:0xf bank_mask:0xf
    v_mov_b32_dpp v29, v37 row_ror:8 row_mask:0xf bank_mask:0xf
    v_mov_b32_dpp v30, v38 row_ror:8 row_mask:0xf bank_mask:0xf
    v_mov_b32_dpp v31, v39 row_ror:8 row_mask:0xf bank_mask:0xf
    v_cndmask_b32 v24, v28, v24, s[48:49]
    v_cndmask_b32 v32, v32, v28, s[48:49]
    v_cndmask_b32 v25, v29, v25, s[48:49]
    v_cndmask_b32 v33, v33, v29, s[48:49]
    v_cndmask_b32 v26, v30, v26, s[48:49]
    v_cndmask_b32 v34, v34, v30, s[48:49]
    v_cndmask_b32 v27, v31, v27, s[48:49]
    v_cndmask_b32 v35, v35, v31, s[48:49]
    buffer_store_dwordx4 v[24:27], v224, s[20:23], s46 offen sc1
    buffer_store_dwordx4 v[32:35], v225, s[20:23], s46 offen sc1
    s_waitcnt vmcnt(3)
    v_lshlrev_b32 v226, 16, v216
    v_and_b32 v227, 0xffff0000, v216
    v_pk_add_f32 v[40:41], v[40:41], v[226:227]
    v_lshlrev_b32 v228, 16, v217
    v_and_b32 v229, 0xffff0000, v217
    v_pk_add_f32 v[42:43], v[42:43], v[228:229]
    v_lshlrev_b32 v226, 16, v218
    v_and_b32 v227, 0xffff0000, v218
    v_pk_add_f32 v[44:45], v[44:45], v[226:227]
    v_lshlrev_b32 v228, 16, v219
    v_and_b32 v229, 0xffff0000, v219
    v_pk_add_f32 v[46:47], v[46:47], v[228:229]
    v_cvt_pk_bf16_f32 v40, v40, v41
    v_cvt_pk_bf16_f32 v41, v42, v43
    v_cvt_pk_bf16_f32 v42, v44, v45
    v_cvt_pk_bf16_f32 v43, v46, v47
    s_nop 0
    v_permlane16_swap_b32 v40, v42
    v_permlane16_swap_b32 v41, v43
    s_waitcnt vmcnt(2)
    v_lshlrev_b32 v226, 16, v220
    v_and_b32 v227, 0xffff0000, v220
    v_pk_add_f32 v[48:49], v[48:49], v[226:227]
    v_lshlrev_b32 v228, 16, v221
    v_and_b32 v229, 0xffff0000, v221
    v_pk_add_f32 v[50:51], v[50:51], v[228:229]
    v_lshlrev_b32 v226, 16, v222
    v_and_b32 v227, 0xffff0000, v222
    v_pk_add_f32 v[52:53], v[52:53], v[226:227]
    v_lshlrev_b32 v228, 16, v223
    v_and_b32 v229, 0xffff0000, v223
    v_pk_add_f32 v[54:55], v[54:55], v[228:229]
    v_cvt_pk_bf16_f32 v48, v48, v49
    v_cvt_pk_bf16_f32 v49, v50, v51
    v_cvt_pk_bf16_f32 v50, v52, v53
    v_cvt_pk_bf16_f32 v51, v54, v55
    s_nop 0
    v_permlane16_swap_b32 v48, v50
    v_permlane16_swap_b32 v49, v51
    v_cndmask_b32 v52, v40, v48, s[48:49]
    v_cndmask_b32 v53, v41, v49, s[48:49]
    v_cndmask_b32 v54, v42, v50, s[48:49]
    v_cndmask_b32 v55, v43, v51, s[48:49]
    v_mov_b32_dpp v44, v52 row_ror:8 row_mask:0xf bank_mask:0xf
    v_mov_b32_dpp v45, v53 row_ror:8 row_mask:0xf bank_mask:0xf
    v_mov_b32_dpp v46, v54 row_ror:8 row_mask:0xf bank_mask:0xf
    v_mov_b32_dpp v47, v55 row_ror:8 row_mask:0xf bank_mask:0xf
    v_cndmask_b32 v40, v44, v40, s[48:49]
    v_cndmask_b32 v48, v48, v44, s[48:49]
    v_cndmask_b32 v41, v45, v41, s[48:49]
    v_cndmask_b32 v49, v49, v45, s[48:49]
    v_cndmask_b32 v42, v46, v42, s[48:49]
    v_cndmask_b32 v50, v50, v46, s[48:49]
    v_cndmask_b32 v43, v47, v43, s[48:49]
    v_cndmask_b32 v51, v51, v47, s[48:49]
    buffer_store_dwordx4 v[40:43], v224, s[20:23], s47 offen sc1
    buffer_store_dwordx4 v[48:51], v225, s[20:23], s47 offen sc1
    s_branch K_fin
LOADERS:
    s_cmp_ge_u32 s30, 6
    s_cbranch_scc1 WLOAD
    s_add_u32 s54, s55, 0x500
    v_mov_b32 v222, s54
    s_lshl_b32 s53, s29, 7
    s_add_u32 s53, s53, 23117824
    v_mov_b32 v226, s53
    s_cmp_lg_u32 s30, 4
    s_cbranch_scc1 pdone_36
    s_add_u32 s54, s55, 0x0
    v_mov_b32 v9, s54
    s_mov_b32 s53, 0
    s_add_u32 s54, s52, 16
    s_bfm_b64 exec, 1, 0
poll_37:
    buffer_load_dword v8, v9, s[56:59], 0 offen sc1
    s_waitcnt vmcnt(0)
    v_xor_b32 v8, s54, v8
    v_cmp_eq_u32 vcc, 0, v8
    s_nop 0
    s_cmp_eq_u64 vcc, exec
    s_cbranch_scc1 pok_38
    s_sleep 5
    s_add_u32 s53, s53, 1
    s_cmp_lt_u32 s53, s61
    s_cbranch_scc1 poll_37
    s_mov_b32 s61, 0
pok_38:
    s_mov_b64 exec, -1
pdone_36:
    s_barrier
    s_mov_b64 exec, 1
    buffer_load_dword v227, v226, s[56:59], 0 offen sc1
    s_mov_b64 exec, -1
    s_waitcnt vmcnt(0)
    v_readfirstlane_b32 s53, v227
    s_add_u32 s54, s52, 16
    s_cmp_eq_u32 s53, s54
    s_cbranch_scc1 fok_39
    s_mov_b32 s53, 0
    s_add_u32 s54, s52, 16
    s_bfm_b64 exec, 1, 0
poll_40:
    buffer_load_dword v227, v226, s[56:59], 0 offen sc1
    s_waitcnt vmcnt(0)
    v_xor_b32 v227, s54, v227
    v_cmp_eq_u32 vcc, 0, v227
    s_nop 0
    s_cmp_eq_u64 vcc, exec
    s_cbranch_scc1 pok_41
    s_sleep 5
    s_add_u32 s53, s53, 1
    s_cmp_lt_u32 s53, s61
    s_cbranch_scc1 poll_40
    s_mov_b32 s61, 0
pok_41:
    s_mov_b64 exec, -1
fok_39:
    s_add_u32 s24, s4, 0x1400000
    s_addc_u32 s25, s5, 0
    s_mov_b32 s26, 0x20000
    s_mov_b32 s27, 0x20000
    s_cmp_eq_u32 s60, 0
    s_cselect_b32 s26, s26, 0
    s_and_b32 s36, s30, 1
    s_mul_i32 s36, s36, 128
    s_mul_i32 s37, s29, 256
    s_add_u32 s37, s36, s37
    v_lshrrev_b32 v224, 3, v1
    v_mul_u32_u24 v224, 4096, v224
    v_and_b32 v23, 112, v2
    v_add_u32 v224, v224, v23
    buffer_load_dwordx4 v[24:27], v224, s[24:27], s37 offen sc1
    s_add_u32 s37, s37, 32768
    buffer_load_dwordx4 v[28:31], v224, s[24:27], s37 offen sc1
    s_add_u32 s37, s37, 32768
    buffer_load_dwordx4 v[32:35], v224, s[24:27], s37 offen sc1
    s_add_u32 s37, s37, 32768
    buffer_load_dwordx4 v[36:39], v224, s[24:27], s37 offen sc1
    s_add_u32 s37, s37, 32768
    s_mov_b64 exec, 1
    buffer_load_dword v223, v222, s[56:59], 0 offen sc1
    s_mov_b64 exec, -1
    s_waitcnt vmcnt(0)
    v_readfirstlane_b32 s53, v223
    s_add_u32 s54, s52, 16
    s_cmp_eq_u32 s53, s54
    s_cbranch_scc1 fok_42
    s_mov_b32 s53, 0
    s_add_u32 s54, s52, 16
    s_bfm_b64 exec, 1, 0
poll_43:
    buffer_load_dword v223, v222, s[56:59], 0 offen sc1
    s_waitcnt vmcnt(0)
    v_xor_b32 v223, s54, v223
    v_cmp_eq_u32 vcc, 0, v223
    s_nop 0
    s_cmp_eq_u64 vcc, exec
    s_cbranch_scc1 pok_44
    s_sleep 5
    s_add_u32 s53, s53, 1
    s_cmp_lt_u32 s53, s61
    s_cbranch_scc1 poll_43
    s_mov_b32 s61, 0
pok_44:
    s_mov_b64 exec, -1
fok_42:
    s_add_u32 s20, s62, 0x1d0000
    s_addc_u32 s21, s63, 0
    s_mov_b32 s22, 0x800
    s_mov_b32 s23, 0x20000
    s_and_b32 s35, s30, 1
    s_lshl_b32 s35, s35, 10
    buffer_load_dwordx4 v[16:19], v2, s[20:23], s35 offen sc1
    s_cmp_lg_u32 s60, 0
    s_cbranch_scc1 pc_45
    v_pk_add_f32 v[24:25], v[24:25], v[28:29]
    v_pk_add_f32 v[26:27], v[26:27], v[30:31]
    v_pk_add_f32 v[24:25], v[24:25], v[32:33]
    v_pk_add_f32 v[26:27], v[26:27], v[34:35]
    v_pk_add_f32 v[24:25], v[24:25], v[36:37]
pc_45:
    s_cmp_lg_u32 s60, 0
    s_cbranch_scc1 pc_46
    v_pk_add_f32 v[26:27], v[26:27], v[38:39]
    v_add_f32_dpp v24, v24, v24 row_ror:8 row_mask:0xf bank_mask:0xf
    v_add_f32_dpp v25, v25, v25 row_ror:8 row_mask:0xf bank_mask:0xf
    v_add_f32_dpp v26, v26, v26 row_ror:8 row_mask:0xf bank_mask:0xf
    v_add_f32_dpp v27, v27, v27 row_ror:8 row_mask:0xf bank_mask:0xf
pc_46:
    s_cmp_lg_u32 s60, 0
    s_cbranch_scc1 pc_47
    v_mov_b32 v28, v24
    v_mov_b32 v29, v25
    v_mov_b32 v30, v26
    v_mov_b32 v31, v27
    v_permlane16_swap_b32 v24, v28
pc_47:
    s_cmp_lg_u32 s60, 0
    s_cbranch_scc1 pc_48
    v_permlane16_swap_b32 v25, v29
    v_permlane16_swap_b32 v26, v30
    v_permlane16_swap_b32 v27, v31
    v_pk_add_f32 v[24:25], v[24:25], v[28:29]
    v_pk_add_f32 v[26:27], v[26:27], v[30:31]
pc_48:
    s_cmp_lg_u32 s60, 0
    s_cbranch_scc1 pc_49
    v_mov_b32 v28, v24
    v_mov_b32 v29, v25
    v_mov_b32 v30, v26
    v_mov_b32 v31, v27
    v_permlane32_swap_b32 v24, v28
pc_49:
    s_cmp_lg_u32 s60, 0
    s_cbranch_scc1 pc_50
    v_permlane32_swap_b32 v25, v29
    v_permlane32_swap_b32 v26, v30
    v_permlane32_swap_b32 v27, v31
    v_pk_add_f32 v[24:25], v[24:25], v[28:29]
    v_pk_add_f32 v[26:27], v[26:27], v[30:31]
pc_50:
    s_cmp_lg_u32 s60, 0
    s_cbranch_scc1 pc_51
    s_and_b32 s36, s30, 1
    s_mul_i32 s36, s36, 128
    s_add_u32 s36, s36, 163328
    v_add_u32 v23, s36, v2
    s_bfm_b64 exec, 8, 0
    ds_write_b128 v23, v[24:27]
    s_mov_b64 exec, -1
    s_waitcnt lgkmcnt(0)
pc_51:
    s_waitcnt vmcnt(0)
    s_and_b32 s36, s30, 1
    s_lshl_b32 s36, s36, 10
    s_add_u32 s36, s36, 160768
    v_add_u32 v221, s36, v2
    ds_write_b128 v221, v[16:19]
    s_waitcnt lgkmcnt(0)
    s_barrier
    s_call_b64 s[76:77], SUB_after_g1
    s_cmp_lg_u32 s30, 4
    s_cbranch_scc1 pdone_53
    s_lshl_b32 s54, s60, 2
    s_add_u32 s54, s54, 1
    v_mov_b32 v8, 162872
spin_54:
    s_sleep 8
    ds_read_b32 v9, v8
    s_waitcnt lgkmcnt(0)
    v_readfirstlane_b32 s53, v9
    s_nop 0
    s_cmp_ge_u32 s53, s54
    s_cbranch_scc0 spin_54
    s_add_u32 s54, s55, 0x100
    v_mov_b32 v9, s54
    s_add_u32 s53, s54, 128
    v_writelane_b32 v9, s53, 1
    s_add_u32 s53, s53, s93
    v_writelane_b32 v9, s53, 3
    s_add_u32 s53, s54, s92
    v_writelane_b32 v9, s53, 2
    s_mov_b32 s53, 0
    s_add_u32 s54, s52, 8
    s_bfm_b64 exec, 4, 0
poll_55:
    buffer_load_dword v8, v9, s[56:59], 0 offen sc1
    s_waitcnt vmcnt(0)
    v_xor_b32 v8, s54, v8
    v_cmp_eq_u32 vcc, 0, v8
    s_nop 0
    s_cmp_eq_u64 vcc, exec
    s_cbranch_scc1 pok_56
    s_sleep 5
    s_add_u32 s53, s53, 1
    s_cmp_lt_u32 s53, s61
    s_cbranch_scc1 poll_55
    s_mov_b32 s61, 0
pok_56:
    s_mov_b64 exec, -1
pdone_53:
    s_barrier
    s_barrier
    s_call_b64 s[76:77], SUB_after_g2
    s_and_b32 s35, s30, 1
    s_add_u32 s12, s62, 0x480000
    s_addc_u32 s13, s63, 0
    s_mov_b32 s14, 0x7e000
    s_mov_b32 s15, 0x20000
    s_mul_i32 s38, s35, 262144
    s_lshl_b32 s41, s35, 13
    s_mov_b32 s42, 0
    s_mov_b32 s44, 0
    s_add_u32 s54, s55, 0x200
    v_mov_b32 v9, s54
    s_add_u32 s44, s44, 1
    s_and_b32 s44, s44, 15
    s_mov_b32 s42, 16384
    s_add_u32 s54, s55, 0x580
    v_mov_b32 v222, s54
    v_lshlrev_b32 v221, 3, v1
    s_add_u32 s19, s41, s42
    v_readlane_b32 s16, v248, s44
    s_nop 0
    s_add_u32 s16, s16, s38
    s_add_u32 s44, s44, 1
    s_and_b32 s44, s44, 15
    s_add_u32 s42, s42, 16384
    s_cmp_eq_u32 s42, 49152
    s_cselect_b32 s42, 0, s42
    s_mov_b32 m0, s19
    s_mov_b32 s39, s16
    s_waitcnt vmcnt(0)
    s_barrier
    s_sleep 6
    s_mov_b32 s53, 0
    s_add_u32 s54, s52, 16
    s_bfm_b64 exec, 1, 0
poll_57:
    buffer_load_dword v8, v9, s[56:59], 0 offen sc1
    s_waitcnt vmcnt(0)
    v_xor_b32 v8, s54, v8
    v_cmp_eq_u32 vcc, 0, v8
    s_nop 0
    s_cmp_eq_u64 vcc, exec
    s_cbranch_scc1 pok_58
    s_sleep 5
    s_add_u32 s53, s53, 1
    s_cmp_lt_u32 s53, s61
    s_cbranch_scc1 poll_57
    s_mov_b32 s61, 0
pok_58:
    s_mov_b64 exec, -1
    buffer_load_dwordx4 v2, s[12:15], s39 offen sc1 lds
    buffer_load_dwordx4 v2, s[12:15], s39 offen offset:1024 sc1 lds
    s_add_u32 s19, s41, s42
    v_readlane_b32 s16, v248, s44
    s_nop 0
    s_add_u32 s16, s16, s38
    s_add_u32 s44, s44, 1
    s_and_b32 s44, s44, 15
    s_add_u32 s42, s42, 16384
    s_cmp_eq_u32 s42, 49152
    s_cselect_b32 s42, 0, s42
    s_add_u32 m0, m0, 2048
    s_add_u32 s39, s39, 65536
    buffer_load_dwordx4 v2, s[12:15], s39 offen sc1 lds
    buffer_load_dwordx4 v2, s[12:15], s39 offen offset:1024 sc1 lds
    s_add_u32 m0, m0, 2048
    s_add_u32 s39, s39, 65536
    buffer_load_dwordx4 v2, s[12:15], s39 offen sc1 lds
    buffer_load_dwordx4 v2, s[12:15], s39 offen offset:1024 sc1 lds
    s_add_u32 m0, m0, 2048
    s_add_u32 s39, s39, 65536
    buffer_load_dwordx4 v2, s[12:15], s39 offen sc1 lds
    buffer_load_dwordx4 v2, s[12:15], s39 offen offset:1024 sc1 lds
    s_mov_b32 m0, s19
    s_mov_b32 s39, s16
    buffer_load_dwordx4 v2, s[12:15], s39 offen sc1 lds
    buffer_load_dwordx4 v2, s[12:15], s39 offen offset:1024 sc1 lds
    s_add_u32 s19, s41, s42
    v_readlane_b32 s16, v248, s44
    s_nop 0
    s_add_u32 s16, s16, s38
    s_add_u32 s44, s44, 1
    s_and_b32 s44, s44, 15
    s_add_u32 s42, s42, 16384
    s_cmp_eq_u32 s42, 49152
    s_cselect_b32 s42, 0, s42
    s_add_u32 m0, m0, 2048
    s_add_u32 s39, s39, 65536
    buffer_load_dwordx4 v2, s[12:15], s39 offen sc1 lds
    buffer_load_dwordx4 v2, s[12:15], s39 offen offset:1024 sc1 lds
    s_add_u32 m0, m0, 2048
    s_add_u32 s39, s39, 65536
    buffer_load_dwordx4 v2, s[12:15], s39 offen sc1 lds
    buffer_load_dwordx4 v2, s[12:15], s39 offen offset:1024 sc1 lds
    s_add_u32 m0, m0, 2048
    s_add_u32 s39, s39, 65536
    buffer_load_dwordx4 v2, s[12:15], s39 offen sc1 lds
    buffer_load_dwordx4 v2, s[12:15], s39 offen offset:1024 sc1 lds
    s_mov_b32 m0, s19
    s_mov_b32 s39, s16
    s_waitcnt vmcnt(8)
    s_barrier
    buffer_load_dwordx4 v2, s[12:15], s39 offen sc1 lds
    buffer_load_dwordx4 v2, s[12:15], s39 offen offset:1024 sc1 lds
    s_add_u32 s19, s41, s42
    v_readlane_b32 s16, v248, s44
    s_nop 0
    s_add_u32 s16, s16, s38
    s_add_u32 s44, s44, 1
    s_and_b32 s44, s44, 15
    s_add_u32 s42, s42, 16384
    s_cmp_eq_u32 s42, 49152
    s_cselect_b32 s42, 0, s42
    s_add_u32 m0, m0, 2048
    s_add_u32 s39, s39, 65536
    buffer_load_dwordx4 v2, s[12:15], s39 offen sc1 lds
    buffer_load_dwordx4 v2, s[12:15], s39 offen offset:1024 sc1 lds
    s_add_u32 m0, m0, 2048
    s_add_u32 s39, s39, 65536
    buffer_load_dwordx4 v2, s[12:15], s39 offen sc1 lds
    buffer_load_dwordx4 v2, s[12:15], s39 offen offset:1024 sc1 lds
    s_add_u32 m0, m0, 2048
    s_add_u32 s39, s39, 65536
    buffer_load_dwordx4 v2, s[12:15], s39 offen sc1 lds
    buffer_load_dwordx4 v2, s[12:15], s39 offen offset:1024 sc1 lds
    s_mov_b32 m0, s19
    s_mov_b32 s39, s16
    s_add_u32 s24, s4, 0x1420000
    s_addc_u32 s25, s5, 0
    s_mov_b32 s26, 0x70000
    s_mov_b32 s27, 0x20000
    s_cmp_eq_u32 s60, 0
    s_cselect_b32 s26, s26, 0
    s_and_b32 s36, s30, 1
    s_mul_i32 s36, s36, 448
    s_mul_i32 s37, s29, 896
    s_add_u32 s37, s36, s37
    v_lshrrev_b32 v224, 5, v1
    v_mul_u32_u24 v224, 14336, v224
    v_and_b32 v179, 496, v2
    v_add_u32 v224, v224, v179
    buffer_load_dwordx4 v[180:183], v224, s[24:27], s37 offen sc1
    s_add_u32 s37, s37, 28672
    buffer_load_dwordx4 v[184:187], v224, s[24:27], s37 offen sc1
    s_add_u32 s37, s37, 28672
    buffer_load_dwordx4 v[188:191], v224, s[24:27], s37 offen sc1
    s_add_u32 s37, s37, 28672
    buffer_load_dwordx4 v[192:195], v224, s[24:27], s37 offen sc1
    s_add_u32 s37, s37, 28672
    s_waitcnt vmcnt(12)
    s_barrier
    buffer_load_dwordx4 v2, s[12:15], s39 offen sc1 lds
    buffer_load_dwordx4 v2, s[12:15], s39 offen offset:1024 sc1 lds
    s_add_u32 s19, s41, s42
    v_readlane_b32 s16, v248, s44
    s_nop 0
    s_add_u32 s16, s16, s38
    s_add_u32 s44, s44, 1
    s_and_b32 s44, s44, 15
    s_add_u32 s42, s42, 16384
    s_cmp_eq_u32 s42, 49152
    s_cselect_b32 s42, 0, s42
    s_add_u32 m0, m0, 2048
    s_add_u32 s39, s39, 65536
    buffer_load_dwordx4 v2, s[12:15], s39 offen sc1 lds
    buffer_load_dwordx4 v2, s[12:15], s39 offen offset:1024 sc1 lds
    s_add_u32 m0, m0, 2048
    s_add_u32 s39, s39, 65536
    buffer_load_dwordx4 v2, s[12:15], s39 offen sc1 lds
    buffer_load_dwordx4 v2, s[12:15], s39 offen offset:1024 sc1 lds
    s_add_u32 m0, m0, 2048
    s_add_u32 s39, s39, 65536
    buffer_load_dwordx4 v2, s[12:15], s39 offen sc1 lds
    buffer_load_dwordx4 v2, s[12:15], s39 offen offset:1024 sc1 lds
    s_mov_b32 m0, s19
    s_mov_b32 s39, s16
    buffer_load_dwordx4 v[196:199], v224, s[24:27], s37 offen sc1
    s_add_u32 s37, s37, 28672
    buffer_load_dwordx4 v[200:203], v224, s[24:27], s37 offen sc1
    s_add_u32 s37, s37, 28672
    buffer_load_dwordx4 v[204:207], v224, s[24:27], s37 offen sc1
    s_add_u32 s37, s37, 28672
    buffer_load_dwordx4 v[208:211], v224, s[24:27], s37 offen sc1
    s_add_u32 s37, s37, 28672
    buffer_load_dwordx4 v[212:215], v224, s[24:27], s37 offen sc1
    s_add_u32 s37, s37, 28672
    s_waitcnt vmcnt(17)
    s_barrier
    buffer_load_dwordx4 v2, s[12:15], s39 offen sc1 lds
    buffer_load_dwordx4 v2, s[12:15], s39 offen offset:1024 sc1 lds
    s_add_u32 s19, s41, s42
    v_readlane_b32 s16, v248, s44
    s_nop 0
    s_add_u32 s16, s16, s38
    s_add_u32 s44, s44, 1
    s_and_b32 s44, s44, 15
    s_add_u32 s42, s42, 16384
    s_cmp_eq_u32 s42, 49152
    s_cselect_b32 s42, 0, s42
    s_add_u32 m0, m0, 2048
    s_add_u32 s39, s39, 65536
    buffer_load_dwordx4 v2, s[12:15], s39 offen sc1 lds
    buffer_load_dwordx4 v2, s[12:15], s39 offen offset:1024 sc1 lds
    s_add_u32 m0, m0, 2048
    s_add_u32 s39, s39, 65536
    buffer_load_dwordx4 v2, s[12:15], s39 offen sc1 lds
    buffer_load_dwordx4 v2, s[12:15], s39 offen offset:1024 sc1 lds
    s_add_u32 m0, m0, 2048
    s_add_u32 s39, s39, 65536
    buffer_load_dwordx4 v2, s[12:15], s39 offen sc1 lds
    buffer_load_dwordx4 v2, s[12:15], s39 offen offset:1024 sc1 lds
    s_mov_b32 m0, s19
    s_mov_b32 s39, s16
    s_waitcnt vmcnt(13)
    s_barrier
    buffer_load_dwordx4 v2, s[12:15], s39 offen sc1 lds
    buffer_load_dwordx4 v2, s[12:15], s39 offen offset:1024 sc1 lds
    s_add_u32 s19, s41, s42
    v_readlane_b32 s16, v248, s44
    s_nop 0
    s_add_u32 s16, s16, s38
    s_add_u32 s44, s44, 1
    s_and_b32 s44, s44, 15
    s_add_u32 s42, s42, 16384
    s_cmp_eq_u32 s42, 49152
    s_cselect_b32 s42, 0, s42
    s_add_u32 m0, m0, 2048
    s_add_u32 s39, s39, 65536
    buffer_load_dwordx4 v2, s[12:15], s39 offen sc1 lds
    buffer_load_dwordx4 v2, s[12:15], s39 offen offset:1024 sc1 lds
    s_add_u32 m0, m0, 2048
    s_add_u32 s39, s39, 65536
    buffer_load_dwordx4 v2, s[12:15], s39 offen sc1 lds
    buffer_load_dwordx4 v2, s[12:15], s39 offen offset:1024 sc1 lds
    s_add_u32 m0, m0, 2048
    s_add_u32 s39, s39, 65536
    buffer_load_dwordx4 v2, s[12:15], s39 offen sc1 lds
    buffer_load_dwordx4 v2, s[12:15], s39 offen offset:1024 sc1 lds
    s_mov_b32 m0, s19
    s_mov_b32 s39, s16
    s_waitcnt vmcnt(16)
    s_cmp_lg_u32 s60, 0
    s_cbranch_scc1 pc_59
    v_pk_add_f32 v[180:181], v[180:181], v[184:185]
    v_pk_add_f32 v[182:183], v[182:183], v[186:187]
    v_pk_add_f32 v[180:181], v[180:181], v[188:189]
    v_pk_add_f32 v[182:183], v[182:183], v[190:191]
    v_pk_add_f32 v[180:181], v[180:181], v[192:193]
    v_pk_add_f32 v[182:183], v[182:183], v[194:195]
    v_pk_add_f32 v[180:181], v[180:181], v[196:197]
    v_pk_add_f32 v[182:183], v[182:183], v[198:199]
pc_59:
    s_mov_b64 exec, 1
    buffer_load_dword v223, v222, s[56:59], 0 offen sc1
    s_mov_b64 exec, -1
    s_waitcnt vmcnt(9)
    s_barrier
    buffer_load_dwordx4 v2, s[12:15], s39 offen sc1 lds
    buffer_load_dwordx4 v2, s[12:15], s39 offen offset:1024 sc1 lds
    s_add_u32 s19, s41, s42
    v_readlane_b32 s16, v248, s44
    s_nop 0
    s_add_u32 s16, s16, s38
    s_add_u32 s44, s44, 1
    s_and_b32 s44, s44, 15
    s_add_u32 s42, s42, 16384
    s_cmp_eq_u32 s42, 49152
    s_cselect_b32 s42, 0, s42
    s_add_u32 m0, m0, 2048
    s_add_u32 s39, s39, 65536
    buffer_load_dwordx4 v2, s[12:15], s39 offen sc1 lds
    buffer_load_dwordx4 v2, s[12:15], s39 offen offset:1024 sc1 lds
    s_add_u32 m0, m0, 2048
    s_add_u32 s39, s39, 65536
    buffer_load_dwordx4 v2, s[12:15], s39 offen sc1 lds
    buffer_load_dwordx4 v2, s[12:15], s39 offen offset:1024 sc1 lds
    s_add_u32 m0, m0, 2048
    s_add_u32 s39, s39, 65536
    buffer_load_dwordx4 v2, s[12:15], s39 offen sc1 lds
    buffer_load_dwordx4 v2, s[12:15], s39 offen offset:1024 sc1 lds
    s_mov_b32 m0, s19
    s_mov_b32 s39, s16
    s_cmp_lg_u32 s60, 0
    s_cbranch_scc1 pc_60
    v_pk_add_f32 v[180:181], v[180:181], v[200:201]
    v_pk_add_f32 v[182:183], v[182:183], v[202:203]
    v_pk_add_f32 v[180:181], v[180:181], v[204:205]
    v_pk_add_f32 v[182:183], v[182:183], v[206:207]
    v_pk_add_f32 v[180:181], v[180:181], v[208:209]
    v_pk_add_f32 v[182:183], v[182:183], v[210:211]
    v_pk_add_f32 v[180:181], v[180:181], v[212:213]
    v_pk_add_f32 v[182:183], v[182:183], v[214:215]
pc_60:
    buffer_load_dwordx4 v[184:187], v224, s[24:27], s37 offen sc1
    s_add_u32 s37, s37, 28672
    buffer_load_dwordx4 v[188:191], v224, s[24:27], s37 offen sc1
    s_add_u32 s37, s37, 28672
    buffer_load_dwordx4 v[192:195], v224, s[24:27], s37 offen sc1
    s_add_u32 s37, s37, 28672
    buffer_load_dwordx4 v[196:199], v224, s[24:27], s37 offen sc1
    s_add_u32 s37, s37, 28672
    buffer_load_dwordx4 v[200:203], v224, s[24:27], s37 offen sc1
    s_add_u32 s37, s37, 28672
    buffer_load_dwordx4 v[204:207], v224, s[24:27], s37 offen sc1
    s_add_u32 s37, s37, 28672
    buffer_load_dwordx4 v[208:211], v224, s[24:27], s37 offen sc1
    s_add_u32 s37, s37, 28672
    s_waitcnt vmcnt(16)
    s_barrier
    buffer_load_dwordx4 v2, s[12:15], s39 offen sc1 lds
    buffer_load_dwordx4 v2, s[12:15], s39 offen offset:1024 sc1 lds
    s_add_u32 s19, s41, s42
    v_readlane_b32 s16, v248, s44
    s_nop 0
    s_add_u32 s16, s16, s38
    s_add_u32 s44, s44, 1
    s_and_b32 s44, s44, 15
    s_add_u32 s42, s42, 16384
    s_cmp_eq_u32 s42, 49152
    s_cselect_b32 s42, 0, s42
    s_add_u32 m0, m0, 2048
    s_add_u32 s39, s39, 65536
    buffer_load_dwordx4 v2, s[12:15], s39 offen sc1 lds
    buffer_load_dwordx4 v2, s[12:15], s39 offen offset:1024 sc1 lds
    s_add_u32 m0, m0, 2048
    s_add_u32 s39, s39, 65536
    buffer_load_dwordx4 v2, s[12:15], s39 offen sc1 lds
    buffer_load_dwordx4 v2, s[12:15], s39 offen offset:1024 sc1 lds
    s_add_u32 m0, m0, 2048
    s_add_u32 s39, s39, 65536
    buffer_load_dwordx4 v2, s[12:15], s39 offen sc1 lds
    buffer_load_dwordx4 v2, s[12:15], s39 offen offset:1024 sc1 lds
    s_mov_b32 m0, s19
    s_mov_b32 s39, s16
    s_waitcnt vmcnt(23)
    v_readfirstlane_b32 s53, v223
    s_add_u32 s54, s52, 16
    s_cmp_eq_u32 s53, s54
    s_cbranch_scc1 fok_61
    s_mov_b32 s53, 0
    s_add_u32 s54, s52, 16
    s_bfm_b64 exec, 1, 0
poll_62:
    buffer_load_dword v223, v222, s[56:59], 0 offen sc1
    s_waitcnt vmcnt(0)
    v_xor_b32 v223, s54, v223
    v_cmp_eq_u32 vcc, 0, v223
    s_nop 0
    s_cmp_eq_u64 vcc, exec
    s_cbranch_scc1 pok_63
    s_sleep 5
    s_add_u32 s53, s53, 1
    s_cmp_lt_u32 s53, s61
    s_cbranch_scc1 poll_62
    s_mov_b32 s61, 0
pok_63:
    s_mov_b64 exec, -1
fok_61:
    s_add_u32 s20, s62, 0x1c8000
    s_addc_u32 s21, s63, 0
    s_mov_b32 s22, 0x6000
    s_mov_b32 s23, 0x20000
    s_and_b32 s35, s30, 1
    s_lshl_b32 s35, s35, 9
    s_add_u32 s36, s35, 0
    buffer_load_dwordx2 v[16:17], v221, s[20:23], s36 offen offset:0 sc1
    buffer_load_dwordx2 v[18:19], v221, s[20:23], s36 offen offset:1024 sc1
    buffer_load_dwordx2 v[20:21], v221, s[20:23], s36 offen offset:2048 sc1
    buffer_load_dwordx2 v[22:23], v221, s[20:23], s36 offen offset:3072 sc1
    s_add_u32 s36, s36, 4096
    buffer_load_dwordx2 v[24:25], v221, s[20:23], s36 offen offset:0 sc1
    buffer_load_dwordx2 v[26:27], v221, s[20:23], s36 offen offset:1024 sc1
    buffer_load_dwordx2 v[28:29], v221, s[20:23], s36 offen offset:2048 sc1
    buffer_load_dwordx2 v[30:31], v221, s[20:23], s36 offen offset:3072 sc1
    s_waitcnt vmcnt(23)
    s_barrier
    buffer_load_dwordx4 v2, s[12:15], s39 offen sc1 lds
    buffer_load_dwordx4 v2, s[12:15], s39 offen offset:1024 sc1 lds
    s_add_u32 s19, s41, s42
    v_readlane_b32 s16, v248, s44
    s_nop 0
    s_add_u32 s16, s16, s38
    s_add_u32 s44, s44, 1
    s_and_b32 s44, s44, 15
    s_add_u32 s42, s42, 16384
    s_cmp_eq_u32 s42, 49152
    s_cselect_b32 s42, 0, s42
    s_add_u32 m0, m0, 2048
    s_add_u32 s39, s39, 65536
    buffer_load_dwordx4 v2, s[12:15], s39 offen sc1 lds
    buffer_load_dwordx4 v2, s[12:15], s39 offen offset:1024 sc1 lds
    s_add_u32 m0, m0, 2048
    s_add_u32 s39, s39, 65536
    buffer_load_dwordx4 v2, s[12:15], s39 offen sc1 lds
    buffer_load_dwordx4 v2, s[12:15], s39 offen offset:1024 sc1 lds
    s_add_u32 m0, m0, 2048
    s_add_u32 s39, s39, 65536
    buffer_load_dwordx4 v2, s[12:15], s39 offen sc1 lds
    buffer_load_dwordx4 v2, s[12:15], s39 offen offset:1024 sc1 lds
    s_mov_b32 m0, s19
    s_mov_b32 s39, s16
    s_add_u32 s36, s35, 16384
    buffer_load_dwordx2 v[32:33], v221, s[20:23], s36 offen offset:0 sc1
    buffer_load_dwordx2 v[34:35], v221, s[20:23], s36 offen offset:1024 sc1
    buffer_load_dwordx2 v[36:37], v221, s[20:23], s36 offen offset:2048 sc1
    buffer_load_dwordx2 v[38:39], v221, s[20:23], s36 offen offset:3072 sc1
    s_add_u32 s36, s36, 4096
    buffer_load_dwordx2 v[40:41], v221, s[20:23], s36 offen offset:0 sc1
    buffer_load_dwordx2 v[42:43], v221, s[20:23], s36 offen offset:1024 sc1
    buffer_load_dwordx2 v[44:45], v221, s[20:23], s36 offen offset:2048 sc1
    buffer_load_dwordx2 v[46:47], v221, s[20:23], s36 offen offset:3072 sc1
    s_waitcnt vmcnt(24)
    s_barrier
    buffer_load_dwordx4 v2, s[12:15], s39 offen sc1 lds
    buffer_load_dwordx4 v2, s[12:15], s39 offen offset:1024 sc1 lds
    s_add_u32 s19, s41, s42
    v_readlane_b32 s16, v248, s44
    s_nop 0
    s_add_u32 s16, s16, s38
    s_add_u32 s44, s44, 1
    s_and_b32 s44, s44, 15
    s_add_u32 s42, s42, 16384
    s_cmp_eq_u32 s42, 49152
    s_cselect_b32 s42, 0, s42
    s_add_u32 m0, m0, 2048
    s_add_u32 s39, s39, 65536
    buffer_load_dwordx4 v2, s[12:15], s39 offen sc1 lds
    buffer_load_dwordx4 v2, s[12:15], s39 offen offset:1024 sc1 lds
    s_add_u32 m0, m0, 2048
    s_add_u32 s39, s39, 65536
    buffer_load_dwordx4 v2, s[12:15], s39 offen sc1 lds
    buffer_load_dwordx4 v2, s[12:15], s39 offen offset:1024 sc1 lds
    s_add_u32 m0, m0, 2048
    s_add_u32 s39, s39, 65536
    buffer_load_dwordx4 v2, s[12:15], s39 offen sc1 lds
    buffer_load_dwordx4 v2, s[12:15], s39 offen offset:1024 sc1 lds
    s_mov_b32 m0, s19
    s_mov_b32 s39, s16
    s_waitcnt vmcnt(40)
    s_cmp_lg_u32 s60, 0
    s_cbranch_scc1 pc_64
    v_pk_add_f32 v[180:181], v[180:181], v[184:185]
    v_pk_add_f32 v[182:183], v[182:183], v[186:187]
    v_pk_add_f32 v[180:181], v[180:181], v[188:189]
    v_pk_add_f32 v[182:183], v[182:183], v[190:191]
    v_pk_add_f32 v[180:181], v[180:181], v[192:193]
    v_pk_add_f32 v[182:183], v[182:183], v[194:195]
    v_pk_add_f32 v[180:181], v[180:181], v[196:197]
    v_pk_add_f32 v[182:183], v[182:183], v[198:199]
pc_64:
    s_waitcnt vmcnt(16)
    s_barrier
    buffer_load_dwordx4 v2, s[12:15], s39 offen sc1 lds
    buffer_load_dwordx4 v2, s[12:15], s39 offen offset:1024 sc1 lds
    s_add_u32 s19, s41, s42
    v_readlane_b32 s16, v248, s44
    s_nop 0
    s_add_u32 s16, s16, s38
    s_add_u32 s44, s44, 1
    s_and_b32 s44, s44, 15
    s_add_u32 s42, s42, 16384
    s_cmp_eq_u32 s42, 49152
    s_cselect_b32 s42, 0, s42
    s_add_u32 m0, m0, 2048
    s_add_u32 s39, s39, 65536
    buffer_load_dwordx4 v2, s[12:15], s39 offen sc1 lds
    buffer_load_dwordx4 v2, s[12:15], s39 offen offset:1024 sc1 lds
    s_add_u32 m0, m0, 2048
    s_add_u32 s39, s39, 65536
    buffer_load_dwordx4 v2, s[12:15], s39 offen sc1 lds
    buffer_load_dwordx4 v2, s[12:15], s39 offen offset:1024 sc1 lds
    s_add_u32 m0, m0, 2048
    s_add_u32 s39, s39, 65536
    buffer_load_dwordx4 v2, s[12:15], s39 offen sc1 lds
    buffer_load_dwordx4 v2, s[12:15], s39 offen offset:1024 sc1 lds
    s_mov_b32 m0, s19
    s_mov_b32 s39, s16
    s_cmp_lg_u32 s60, 0
    s_cbranch_scc1 pc_65
    v_pk_add_f32 v[180:181], v[180:181], v[200:201]
    v_pk_add_f32 v[182:183], v[182:183], v[202:203]
    v_pk_add_f32 v[180:181], v[180:181], v[204:205]
    v_pk_add_f32 v[182:183], v[182:183], v[206:207]
    v_pk_add_f32 v[180:181], v[180:181], v[208:209]
    v_pk_add_f32 v[182:183], v[182:183], v[210:211]
pc_65:
    s_waitcnt vmcnt(8)
    s_barrier
    buffer_load_dwordx4 v2, s[12:15], s39 offen sc1 lds
    buffer_load_dwordx4 v2, s[12:15], s39 offen offset:1024 sc1 lds
    s_add_u32 s19, s41, s42
    v_readlane_b32 s16, v248, s44
    s_nop 0
    s_add_u32 s16, s16, s38
    s_add_u32 s44, s44, 1
    s_and_b32 s44, s44, 15
    s_add_u32 s42, s42, 16384
    s_cmp_eq_u32 s42, 49152
    s_cselect_b32 s42, 0, s42
    s_add_u32 m0, m0, 2048
    s_add_u32 s39, s39, 65536
    buffer_load_dwordx4 v2, s[12:15], s39 offen sc1 lds
    buffer_load_dwordx4 v2, s[12:15], s39 offen offset:1024 sc1 lds
    s_add_u32 m0, m0, 2048
    s_add_u32 s39, s39, 65536
    buffer_load_dwordx4 v2, s[12:15], s39 offen sc1 lds
    buffer_load_dwordx4 v2, s[12:15], s39 offen offset:1024 sc1 lds
    s_add_u32 m0, m0, 2048
    s_add_u32 s39, s39, 65536
    buffer_load_dwordx4 v2, s[12:15], s39 offen sc1 lds
    buffer_load_dwordx4 v2, s[12:15], s39 offen offset:1024 sc1 lds
    s_mov_b32 m0, s19
    s_mov_b32 s39, s16
    s_cmp_lg_u32 s60, 0
    s_cbranch_scc1 pc_66
    v_mov_b32 v184, v180
    v_mov_b32 v185, v181
    v_mov_b32 v186, v182
    v_mov_b32 v187, v183
    v_permlane32_swap_b32 v180, v184
    v_permlane32_swap_b32 v181, v185
    v_permlane32_swap_b32 v182, v186
    v_permlane32_swap_b32 v183, v187
    v_pk_add_f32 v[180:181], v[180:181], v[184:185]
    v_pk_add_f32 v[182:183], v[182:183], v[186:187]
    s_and_b32 s36, s30, 1
    s_mul_i32 s36, s36, 448
    s_add_u32 s36, s36, 159744
    v_add_u32 v179, s36, v2
    s_bfm_b64 exec, 28, 0
    ds_write_b128 v179, v[180:183]
    s_mov_b64 exec, -1
    s_waitcnt lgkmcnt(0)
pc_66:
    s_waitcnt vmcnt(8)
    s_barrier
    buffer_load_dwordx4 v2, s[12:15], s39 offen sc1 lds
    buffer_load_dwordx4 v2, s[12:15], s39 offen offset:1024 sc1 lds
    s_add_u32 s19, s41, s42
    v_readlane_b32 s16, v248, s44
    s_nop 0
    s_add_u32 s16, s16, s38
    s_add_u32 s44, s44, 1
    s_and_b32 s44, s44, 15
    s_add_u32 s42, s42, 16384
    s_cmp_eq_u32 s42, 49152
    s_cselect_b32 s42, 0, s42
    s_add_u32 m0, m0, 2048
    s_add_u32 s39, s39, 65536
    buffer_load_dwordx4 v2, s[12:15], s39 offen sc1 lds
    buffer_load_dwordx4 v2, s[12:15], s39 offen offset:1024 sc1 lds
    s_add_u32 m0, m0, 2048
    s_add_u32 s39, s39, 65536
    buffer_load_dwordx4 v2, s[12:15], s39 offen sc1 lds
    buffer_load_dwordx4 v2, s[12:15], s39 offen offset:1024 sc1 lds
    s_add_u32 m0, m0, 2048
    s_add_u32 s39, s39, 65536
    buffer_load_dwordx4 v2, s[12:15], s39 offen sc1 lds
    buffer_load_dwordx4 v2, s[12:15], s39 offen offset:1024 sc1 lds
    s_mov_b32 m0, s19
    s_mov_b32 s39, s16
    s_waitcnt vmcnt(32)
    v_pk_add_f32 v[16:17], v[16:17], v[32:33]
    v_pk_add_f32 v[18:19], v[18:19], v[34:35]
    v_pk_add_f32 v[20:21], v[20:21], v[36:37]
    v_pk_add_f32 v[22:23], v[22:23], v[38:39]
    v_pk_add_f32 v[24:25], v[24:25], v[40:41]
    v_pk_add_f32 v[26:27], v[26:27], v[42:43]
    v_pk_add_f32 v[28:29], v[28:29], v[44:45]
    v_pk_add_f32 v[30:31], v[30:31], v[46:47]
    v_pk_add_f32 v[16:17], v[16:17], v[24:25]
    v_pk_add_f32 v[18:19], v[18:19], v[26:27]
    s_waitcnt vmcnt(8)
    s_barrier
    buffer_load_dwordx4 v2, s[12:15], s39 offen sc1 lds
    buffer_load_dwordx4 v2, s[12:15], s39 offen offset:1024 sc1 lds
    s_add_u32 s19, s41, s42
    v_readlane_b32 s16, v248, s44
    s_nop 0
    s_add_u32 s16, s16, s38
    s_add_u32 s44, s44, 1
    s_and_b32 s44, s44, 15
    s_add_u32 s42, s42, 16384
    s_cmp_eq_u32 s42, 49152
    s_cselect_b32 s42, 0, s42
    s_add_u32 m0, m0, 2048
    s_add_u32 s39, s39, 65536
    buffer_load_dwordx4 v2, s[12:15], s39 offen sc1 lds
    buffer_load_dwordx4 v2, s[12:15], s39 offen offset:1024 sc1 lds
    s_add_u32 m0, m0, 2048
    s_add_u32 s39, s39, 65536
    buffer_load_dwordx4 v2, s[12:15], s39 offen sc1 lds
    buffer_load_dwordx4 v2, s[12:15], s39 offen offset:1024 sc1 lds
    s_add_u32 m0, m0, 2048
    s_add_u32 s39, s39, 65536
    buffer_load_dwordx4 v2, s[12:15], s39 offen sc1 lds
    buffer_load_dwordx4 v2, s[12:15], s39 offen offset:1024 sc1 lds
    s_mov_b32 m0, s19
    s_mov_b32 s39, s16
    v_pk_add_f32 v[20:21], v[20:21], v[28:29]
    v_pk_add_f32 v[22:23], v[22:23], v[30:31]
    v_pk_add_f32 v[16:17], v[16:17], v[20:21]
    v_pk_add_f32 v[18:19], v[18:19], v[22:23]
    v_pk_add_f32 v[16:17], v[16:17], v[18:19]
    v_mul_f32 v218, 0x3a800000, v16
    v_mul_f32 v217, 0x3a800000, v17
    v_fma_f32 v217, -v218, v218, v217
    s_waitcnt vmcnt(8)
    s_barrier
    buffer_load_dwordx4 v2, s[12:15], s39 offen sc1 lds
    buffer_load_dwordx4 v2, s[12:15], s39 offen offset:1024 sc1 lds
    s_add_u32 m0, m0, 2048
    s_add_u32 s39, s39, 65536
    buffer_load_dwordx4 v2, s[12:15], s39 offen sc1 lds
    buffer_load_dwordx4 v2, s[12:15], s39 offen offset:1024 sc1 lds
    s_add_u32 m0, m0, 2048
    s_add_u32 s39, s39, 65536
    buffer_load_dwordx4 v2, s[12:15], s39 offen sc1 lds
    buffer_load_dwordx4 v2, s[12:15], s39 offen offset:1024 sc1 lds
    s_add_u32 m0, m0, 2048
    s_add_u32 s39, s39, 65536
    buffer_load_dwordx4 v2, s[12:15], s39 offen sc1 lds
    buffer_load_dwordx4 v2, s[12:15], s39 offen offset:1024 sc1 lds
    v_max_f32 v217, 0, v217
    v_add_f32 v217, 0x3727c5ac, v217
    v_rsq_f32 v219, v217
    s_add_u32 s35, s35, 160768
    v_add_u32 v220, s35, v221
    ds_write_b64 v220, v[218:219]
    s_waitcnt lgkmcnt(0)
    s_waitcnt vmcnt(8)
    s_barrier
    s_call_b64 s[76:77], SUB_r_pre0
    s_waitcnt vmcnt(8)
    s_barrier
    s_cmp_lg_u32 s60, 0
    s_cbranch_scc1 tw4_70
    s_load_dwordx2 s[48:49], s[0:1], 80
    s_lshl_b32 s45, s2, 1
    s_and_b32 s50, s30, 1
    s_add_u32 s45, s45, s50
    s_mul_i32 s45, s45, 14336
    s_mov_b32 s50, 7340032
    s_mov_b32 s51, 0x20000
    s_waitcnt lgkmcnt(0)
    buffer_load_dwordx4 v[20:23], v2, s[48:51], s45 offen offset:0
    buffer_load_dwordx4 v[20:23], v2, s[48:51], s45 offen offset:1024
    buffer_load_dwordx4 v[20:23], v2, s[48:51], s45 offen offset:2048
    buffer_load_dwordx4 v[20:23], v2, s[48:51], s45 offen offset:3072
    s_add_u32 s45, s45, 4096
    buffer_load_dwordx4 v[20:23], v2, s[48:51], s45 offen offset:0
    buffer_load_dwordx4 v[20:23], v2, s[48:51], s45 offen offset:1024
    buffer_load_dwordx4 v[20:23], v2, s[48:51], s45 offen offset:2048
    buffer_load_dwordx4 v[20:23], v2, s[48:51], s45 offen offset:3072
    s_add_u32 s45, s45, 4096
    buffer_load_dwordx4 v[20:23], v2, s[48:51], s45 offen offset:0
    buffer_load_dwordx4 v[20:23], v2, s[48:51], s45 offen offset:1024
    buffer_load_dwordx4 v[20:23], v2, s[48:51], s45 offen offset:2048
    buffer_load_dwordx4 v[20:23], v2, s[48:51], s45 offen offset:3072
    s_add_u32 s45, s45, 4096
    buffer_load_dwordx4 v[20:23], v2, s[48:51], s45 offen offset:0
    buffer_load_dwordx4 v[20:23], v2, s[48:51], s45 offen offset:1024
tw4_70:
    s_barrier
    s_and_b32 s35, s30, 1
    s_mov_b32 s12, s62
    s_mov_b32 s13, s63
    s_mov_b32 s14, 0x1be000
    s_mov_b32 s15, 0x20000
    s_mul_i32 s38, s35, 917504
    s_mul_i32 s36, s31, 114688
    s_add_u32 s38, s38, s36
    s_lshl_b32 s41, s35, 13
    s_mov_b32 s42, 0
    s_mov_b32 s44, 0
    s_add_u32 s54, s55, 0x700
    s_lshl_b32 s53, s31, 7
    s_add_u32 s54, s54, s53
    v_mov_b32 v9, s54
    s_add_u32 s54, s55, 0x600
    s_lshl_b32 s53, s31, 7
    s_add_u32 s54, s54, s53
    v_mov_b32 v10, s54
    s_add_u32 s54, s55, 0x300
    s_lshl_b32 s53, s31, 7
    s_add_u32 s54, s54, s53
    v_mov_b32 v12, s54
    s_lshl_b32 s54, s60, 2
    s_add_u32 s54, s54, 3
    v_mov_b32 v14, 162872
spin_71:
    s_sleep 8
    ds_read_b32 v15, v14
    s_waitcnt lgkmcnt(0)
    v_readfirstlane_b32 s53, v15
    s_nop 0
    s_cmp_ge_u32 s53, s54
    s_cbranch_scc0 spin_71
    s_mov_b32 s53, 0
    s_add_u32 s54, s52, 8
    s_bfm_b64 exec, 1, 0
poll_72:
    buffer_load_dword v8, v9, s[56:59], 0 offen sc1
    s_waitcnt vmcnt(0)
    v_xor_b32 v8, s54, v8
    v_cmp_eq_u32 vcc, 0, v8
    s_nop 0
    s_cmp_eq_u64 vcc, exec
    s_cbranch_scc1 pok_73
    s_sleep 5
    s_add_u32 s53, s53, 1
    s_cmp_lt_u32 s53, s61
    s_cbranch_scc1 poll_72
    s_mov_b32 s61, 0
pok_73:
    s_mov_b64 exec, -1
    s_mov_b32 s44, 3
    s_call_b64 s[76:77], PREP_a_issue_4
    s_mov_b32 m0, s19
    s_mov_b32 s39, s16
    s_mov_b32 s40, s17
    s_waitcnt vmcnt(16)
    s_barrier
    s_waitcnt vmcnt(8)
    s_barrier
    buffer_load_dwordx4 v2, s[12:15], s39 offen sc1 lds
    s_add_u32 m0, m0, 1024
    s_nop 0
    buffer_load_dwordx4 v2, s[12:15], s40 offen sc1 lds
    s_mov_b32 s43, 1
ld_74:
    s_add_u32 s19, s41, s42
    v_readlane_b32 s16, v249, s44
    v_readlane_b32 s17, v250, s44
    s_add_u32 s16, s16, s38
    s_add_u32 s17, s17, s38
    s_add_u32 s44, s44, 1
    s_add_u32 s42, s42, 16384
    s_cmp_eq_u32 s42, 49152
    s_cselect_b32 s42, 0, s42
    s_add_u32 m0, m0, 1024
    s_add_u32 s39, s39, 229376
    buffer_load_dwordx4 v2, s[12:15], s39 offen sc1 lds
    s_add_u32 m0, m0, 1024
    s_add_u32 s40, s40, 229376
    buffer_load_dwordx4 v2, s[12:15], s40 offen sc1 lds
    s_add_u32 m0, m0, 1024
    s_add_u32 s39, s39, 229376
    buffer_load_dwordx4 v2, s[12:15], s39 offen sc1 lds
    s_add_u32 m0, m0, 1024
    s_add_u32 s40, s40, 229376
    buffer_load_dwordx4 v2, s[12:15], s40 offen sc1 lds
    s_add_u32 m0, m0, 1024
    s_add_u32 s39, s39, 229376
    buffer_load_dwordx4 v2, s[12:15], s39 offen sc1 lds
    s_add_u32 m0, m0, 1024
    s_add_u32 s40, s40, 229376
    buffer_load_dwordx4 v2, s[12:15], s40 offen sc1 lds
    s_mov_b32 m0, s19
    s_mov_b32 s39, s16
    s_mov_b32 s40, s17
    s_waitcnt vmcnt(8)
    s_barrier
    buffer_load_dwordx4 v2, s[12:15], s39 offen sc1 lds
    s_add_u32 m0, m0, 1024
    s_nop 0
    buffer_load_dwordx4 v2, s[12:15], s40 offen sc1 lds
    s_add_u32 s43, s43, 1
    s_cmp_lt_u32 s43, 4
    s_cbranch_scc1 ld_74
    s_call_b64 s[76:77], PREP_a_issue_4
    s_add_u32 m0, m0, 1024
    s_add_u32 s39, s39, 229376
    buffer_load_dwordx4 v2, s[12:15], s39 offen sc1 lds
    s_add_u32 m0, m0, 1024
    s_add_u32 s40, s40, 229376
    buffer_load_dwordx4 v2, s[12:15], s40 offen sc1 lds
    s_add_u32 m0, m0, 1024
    s_add_u32 s39, s39, 229376
    buffer_load_dwordx4 v2, s[12:15], s39 offen sc1 lds
    s_add_u32 m0, m0, 1024
    s_add_u32 s40, s40, 229376
    buffer_load_dwordx4 v2, s[12:15], s40 offen sc1 lds
    s_add_u32 m0, m0, 1024
    s_add_u32 s39, s39, 229376
    buffer_load_dwordx4 v2, s[12:15], s39 offen sc1 lds
    s_add_u32 m0, m0, 1024
    s_add_u32 s40, s40, 229376
    buffer_load_dwordx4 v2, s[12:15], s40 offen sc1 lds
    s_mov_b32 m0, s19
    s_mov_b32 s39, s16
    s_mov_b32 s40, s17
    s_waitcnt vmcnt(8)
    s_barrier
    buffer_load_dwordx4 v2, s[12:15], s39 offen sc1 lds
    s_add_u32 m0, m0, 1024
    s_nop 0
    buffer_load_dwordx4 v2, s[12:15], s40 offen sc1 lds
    s_mov_b64 exec, 1
    buffer_load_dword v11, v10, s[56:59], 0 offen sc1
    s_mov_b64 exec, -1
    s_call_b64 s[76:77], PREP_a_issue_4
    s_add_u32 m0, m0, 1024
    s_add_u32 s39, s39, 229376
    buffer_load_dwordx4 v2, s[12:15], s39 offen sc1 lds
    s_add_u32 m0, m0, 1024
    s_add_u32 s40, s40, 229376
    buffer_load_dwordx4 v2, s[12:15], s40 offen sc1 lds
    s_add_u32 m0, m0, 1024
    s_add_u32 s39, s39, 229376
    buffer_load_dwordx4 v2, s[12:15], s39 offen sc1 lds
    s_add_u32 m0, m0, 1024
    s_add_u32 s40, s40, 229376
    buffer_load_dwordx4 v2, s[12:15], s40 offen sc1 lds
    s_add_u32 m0, m0, 1024
    s_add_u32 s39, s39, 229376
    buffer_load_dwordx4 v2, s[12:15], s39 offen sc1 lds
    s_add_u32 m0, m0, 1024
    s_add_u32 s40, s40, 229376
    buffer_load_dwordx4 v2, s[12:15], s40 offen sc1 lds
    s_mov_b32 m0, s19
    s_mov_b32 s39, s16
    s_mov_b32 s40, s17
    s_waitcnt vmcnt(9)
    s_barrier
    buffer_load_dwordx4 v2, s[12:15], s39 offen sc1 lds
    s_add_u32 m0, m0, 1024
    s_nop 0
    buffer_load_dwordx4 v2, s[12:15], s40 offen sc1 lds
    s_call_b64 s[76:77], PREP_a_issue_4
    s_add_u32 m0, m0, 1024
    s_add_u32 s39, s39, 229376
    buffer_load_dwordx4 v2, s[12:15], s39 offen sc1 lds
    s_add_u32 m0, m0, 1024
    s_add_u32 s40, s40, 229376
    buffer_load_dwordx4 v2, s[12:15], s40 offen sc1 lds
    s_add_u32 m0, m0, 1024
    s_add_u32 s39, s39, 229376
    buffer_load_dwordx4 v2, s[12:15], s39 offen sc1 lds
    s_add_u32 m0, m0, 1024
    s_add_u32 s40, s40, 229376
    buffer_load_dwordx4 v2, s[12:15], s40 offen sc1 lds
    s_add_u32 m0, m0, 1024
    s_add_u32 s39, s39, 229376
    buffer_load_dwordx4 v2, s[12:15], s39 offen sc1 lds
    s_add_u32 m0, m0, 1024
    s_add_u32 s40, s40, 229376
    buffer_load_dwordx4 v2, s[12:15], s40 offen sc1 lds
    s_mov_b32 m0, s19
    s_mov_b32 s39, s16
    s_mov_b32 s40, s17
    s_waitcnt vmcnt(8)
    s_barrier
    buffer_load_dwordx4 v2, s[12:15], s39 offen sc1 lds
    s_add_u32 m0, m0, 1024
    s_nop 0
    buffer_load_dwordx4 v2, s[12:15], s40 offen sc1 lds
    s_waitcnt vmcnt(16)
    v_readfirstlane_b32 s53, v11
    s_add_u32 s54, s52, 8
    s_cmp_eq_u32 s53, s54
    s_cbranch_scc1 fok_75
    s_mov_b32 s53, 0
    s_add_u32 s54, s52, 8
    s_bfm_b64 exec, 1, 0
poll_76:
    buffer_load_dword v11, v10, s[56:59], 0 offen sc1
    s_waitcnt vmcnt(0)
    v_xor_b32 v11, s54, v11
    v_cmp_eq_u32 vcc, 0, v11
    s_nop 0
    s_cmp_eq_u64 vcc, exec
    s_cbranch_scc1 pok_77
    s_sleep 5
    s_add_u32 s53, s53, 1
    s_cmp_lt_u32 s53, s61
    s_cbranch_scc1 poll_76
    s_mov_b32 s61, 0
pok_77:
    s_mov_b64 exec, -1
fok_75:
    s_call_b64 s[76:77], PREP_a_issue_4
    s_add_u32 m0, m0, 1024
    s_add_u32 s39, s39, 229376
    buffer_load_dwordx4 v2, s[12:15], s39 offen sc1 lds
    s_add_u32 m0, m0, 1024
    s_add_u32 s40, s40, 229376
    buffer_load_dwordx4 v2, s[12:15], s40 offen sc1 lds
    s_add_u32 m0, m0, 1024
    s_add_u32 s39, s39, 229376
    buffer_load_dwordx4 v2, s[12:15], s39 offen sc1 lds
    s_add_u32 m0, m0, 1024
    s_add_u32 s40, s40, 229376
    buffer_load_dwordx4 v2, s[12:15], s40 offen sc1 lds
    s_add_u32 m0, m0, 1024
    s_add_u32 s39, s39, 229376
    buffer_load_dwordx4 v2, s[12:15], s39 offen sc1 lds
    s_add_u32 m0, m0, 1024
    s_add_u32 s40, s40, 229376
    buffer_load_dwordx4 v2, s[12:15], s40 offen sc1 lds
    s_mov_b32 m0, s19
    s_mov_b32 s39, s16
    s_mov_b32 s40, s17
    s_waitcnt vmcnt(8)
    s_barrier
    buffer_load_dwordx4 v2, s[12:15], s39 offen sc1 lds
    s_add_u32 m0, m0, 1024
    s_nop 0
    buffer_load_dwordx4 v2, s[12:15], s40 offen sc1 lds
    s_mov_b32 s43, 1
ld_78:
    s_add_u32 s19, s41, s42
    v_readlane_b32 s16, v249, s44
    v_readlane_b32 s17, v250, s44
    s_add_u32 s16, s16, s38
    s_add_u32 s17, s17, s38
    s_add_u32 s44, s44, 1
    s_add_u32 s42, s42, 16384
    s_cmp_eq_u32 s42, 49152
    s_cselect_b32 s42, 0, s42
    s_add_u32 m0, m0, 1024
    s_add_u32 s39, s39, 229376
    buffer_load_dwordx4 v2, s[12:15], s39 offen sc1 lds
    s_add_u32 m0, m0, 1024
    s_add_u32 s40, s40, 229376
    buffer_load_dwordx4 v2, s[12:15], s40 offen sc1 lds
    s_add_u32 m0, m0, 1024
    s_add_u32 s39, s39, 229376
    buffer_load_dwordx4 v2, s[12:15], s39 offen sc1 lds
    s_add_u32 m0, m0, 1024
    s_add_u32 s40, s40, 229376
    buffer_load_dwordx4 v2, s[12:15], s40 offen sc1 lds
    s_add_u32 m0, m0, 1024
    s_add_u32 s39, s39, 229376
    buffer_load_dwordx4 v2, s[12:15], s39 offen sc1 lds
    s_add_u32 m0, m0, 1024
    s_add_u32 s40, s40, 229376
    buffer_load_dwordx4 v2, s[12:15], s40 offen sc1 lds
    s_mov_b32 m0, s19
    s_mov_b32 s39, s16
    s_mov_b32 s40, s17
    s_waitcnt vmcnt(8)
    s_barrier
    buffer_load_dwordx4 v2, s[12:15], s39 offen sc1 lds
    s_add_u32 m0, m0, 1024
    s_nop 0
    buffer_load_dwordx4 v2, s[12:15], s40 offen sc1 lds
    s_add_u32 s43, s43, 1
    s_cmp_lt_u32 s43, 4
    s_cbranch_scc1 ld_78
    s_call_b64 s[76:77], PREP_a_issue_4
    s_add_u32 m0, m0, 1024
    s_add_u32 s39, s39, 229376
    buffer_load_dwordx4 v2, s[12:15], s39 offen sc1 lds
    s_add_u32 m0, m0, 1024
    s_add_u32 s40, s40, 229376
    buffer_load_dwordx4 v2, s[12:15], s40 offen sc1 lds
    s_add_u32 m0, m0, 1024
    s_add_u32 s39, s39, 229376
    buffer_load_dwordx4 v2, s[12:15], s39 offen sc1 lds
    s_add_u32 m0, m0, 1024
    s_add_u32 s40, s40, 229376
    buffer_load_dwordx4 v2, s[12:15], s40 offen sc1 lds
    s_add_u32 m0, m0, 1024
    s_add_u32 s39, s39, 229376
    buffer_load_dwordx4 v2, s[12:15], s39 offen sc1 lds
    s_add_u32 m0, m0, 1024
    s_add_u32 s40, s40, 229376
    buffer_load_dwordx4 v2, s[12:15], s40 offen sc1 lds
    s_mov_b32 m0, s19
    s_mov_b32 s39, s16
    s_mov_b32 s40, s17
    s_waitcnt vmcnt(8)
    s_barrier
    buffer_load_dwordx4 v2, s[12:15], s39 offen sc1 lds
    s_add_u32 m0, m0, 1024
    s_nop 0
    buffer_load_dwordx4 v2, s[12:15], s40 offen sc1 lds
    s_mov_b64 exec, 1
    buffer_load_dword v11, v12, s[56:59], 0 offen sc1
    s_mov_b64 exec, -1
    s_call_b64 s[76:77], PREP_a_issue_4
    s_add_u32 m0, m0, 1024
    s_add_u32 s39, s39, 229376
    buffer_load_dwordx4 v2, s[12:15], s39 offen sc1 lds
    s_add_u32 m0, m0, 1024
    s_add_u32 s40, s40, 229376
    buffer_load_dwordx4 v2, s[12:15], s40 offen sc1 lds
    s_add_u32 m0, m0, 1024
    s_add_u32 s39, s39, 229376
    buffer_load_dwordx4 v2, s[12:15], s39 offen sc1 lds
    s_add_u32 m0, m0, 1024
    s_add_u32 s40, s40, 229376
    buffer_load_dwordx4 v2, s[12:15], s40 offen sc1 lds
    s_add_u32 m0, m0, 1024
    s_add_u32 s39, s39, 229376
    buffer_load_dwordx4 v2, s[12:15], s39 offen sc1 lds
    s_add_u32 m0, m0, 1024
    s_add_u32 s40, s40, 229376
    buffer_load_dwordx4 v2, s[12:15], s40 offen sc1 lds
    s_mov_b32 m0, s19
    s_mov_b32 s39, s16
    s_mov_b32 s40, s17
    s_waitcnt vmcnt(9)
    s_barrier
    buffer_load_dwordx4 v2, s[12:15], s39 offen sc1 lds
    s_add_u32 m0, m0, 1024
    s_nop 0
    buffer_load_dwordx4 v2, s[12:15], s40 offen sc1 lds
    s_call_b64 s[76:77], PREP_a_issue_4
    s_add_u32 m0, m0, 1024
    s_add_u32 s39, s39, 229376
    buffer_load_dwordx4 v2, s[12:15], s39 offen sc1 lds
    s_add_u32 m0, m0, 1024
    s_add_u32 s40, s40, 229376
    buffer_load_dwordx4 v2, s[12:15], s40 offen sc1 lds
    s_add_u32 m0, m0, 1024
    s_add_u32 s39, s39, 229376
    buffer_load_dwordx4 v2, s[12:15], s39 offen sc1 lds
    s_add_u32 m0, m0, 1024
    s_add_u32 s40, s40, 229376
    buffer_load_dwordx4 v2, s[12:15], s40 offen sc1 lds
    s_add_u32 m0, m0, 1024
    s_add_u32 s39, s39, 229376
    buffer_load_dwordx4 v2, s[12:15], s39 offen sc1 lds
    s_add_u32 m0, m0, 1024
    s_add_u32 s40, s40, 229376
    buffer_load_dwordx4 v2, s[12:15], s40 offen sc1 lds
    s_mov_b32 m0, s19
    s_mov_b32 s39, s16
    s_mov_b32 s40, s17
    s_waitcnt vmcnt(8)
    s_barrier
    buffer_load_dwordx4 v2, s[12:15], s39 offen sc1 lds
    s_add_u32 m0, m0, 1024
    s_nop 0
    buffer_load_dwordx4 v2, s[12:15], s40 offen sc1 lds
    s_waitcnt vmcnt(16)
    v_readfirstlane_b32 s53, v11
    s_add_u32 s54, s52, 8
    s_cmp_eq_u32 s53, s54
    s_cbranch_scc1 fok_79
    s_mov_b32 s53, 0
    s_add_u32 s54, s52, 8
    s_bfm_b64 exec, 1, 0
poll_80:
    buffer_load_dword v11, v12, s[56:59], 0 offen sc1
    s_waitcnt vmcnt(0)
    v_xor_b32 v11, s54, v11
    v_cmp_eq_u32 vcc, 0, v11
    s_nop 0
    s_cmp_eq_u64 vcc, exec
    s_cbranch_scc1 pok_81
    s_sleep 5
    s_add_u32 s53, s53, 1
    s_cmp_lt_u32 s53, s61
    s_cbranch_scc1 poll_80
    s_mov_b32 s61, 0
pok_81:
    s_mov_b64 exec, -1
fok_79:
    s_call_b64 s[76:77], PREP_a_issue_4
    s_add_u32 m0, m0, 1024
    s_add_u32 s39, s39, 229376
    buffer_load_dwordx4 v2, s[12:15], s39 offen sc1 lds
    s_add_u32 m0, m0, 1024
    s_add_u32 s40, s40, 229376
    buffer_load_dwordx4 v2, s[12:15], s40 offen sc1 lds
    s_add_u32 m0, m0, 1024
    s_add_u32 s39, s39, 229376
    buffer_load_dwordx4 v2, s[12:15], s39 offen sc1 lds
    s_add_u32 m0, m0, 1024
    s_add_u32 s40, s40, 229376
    buffer_load_dwordx4 v2, s[12:15], s40 offen sc1 lds
    s_add_u32 m0, m0, 1024
    s_add_u32 s39, s39, 229376
    buffer_load_dwordx4 v2, s[12:15], s39 offen sc1 lds
    s_add_u32 m0, m0, 1024
    s_add_u32 s40, s40, 229376
    buffer_load_dwordx4 v2, s[12:15], s40 offen sc1 lds
    s_mov_b32 m0, s19
    s_mov_b32 s39, s16
    s_mov_b32 s40, s17
    s_waitcnt vmcnt(8)
    s_barrier
    buffer_load_dwordx4 v2, s[12:15], s39 offen sc1 lds
    s_add_u32 m0, m0, 1024
    s_nop 0
    buffer_load_dwordx4 v2, s[12:15], s40 offen sc1 lds
    s_mov_b32 s43, 1
ld_82:
    s_add_u32 s19, s41, s42
    v_readlane_b32 s16, v249, s44
    v_readlane_b32 s17, v250, s44
    s_add_u32 s16, s16, s38
    s_add_u32 s17, s17, s38
    s_add_u32 s44, s44, 1
    s_add_u32 s42, s42, 16384
    s_cmp_eq_u32 s42, 49152
    s_cselect_b32 s42, 0, s42
    s_add_u32 m0, m0, 1024
    s_add_u32 s39, s39, 229376
    buffer_load_dwordx4 v2, s[12:15], s39 offen sc1 lds
    s_add_u32 m0, m0, 1024
    s_add_u32 s40, s40, 229376
    buffer_load_dwordx4 v2, s[12:15], s40 offen sc1 lds
    s_add_u32 m0, m0, 1024
    s_add_u32 s39, s39, 229376
    buffer_load_dwordx4 v2, s[12:15], s39 offen sc1 lds
    s_add_u32 m0, m0, 1024
    s_add_u32 s40, s40, 229376
    buffer_load_dwordx4 v2, s[12:15], s40 offen sc1 lds
    s_add_u32 m0, m0, 1024
    s_add_u32 s39, s39, 229376
    buffer_load_dwordx4 v2, s[12:15], s39 offen sc1 lds
    s_add_u32 m0, m0, 1024
    s_add_u32 s40, s40, 229376
    buffer_load_dwordx4 v2, s[12:15], s40 offen sc1 lds
    s_mov_b32 m0, s19
    s_mov_b32 s39, s16
    s_mov_b32 s40, s17
    s_waitcnt vmcnt(8)
    s_barrier
    buffer_load_dwordx4 v2, s[12:15], s39 offen sc1 lds
    s_add_u32 m0, m0, 1024
    s_nop 0
    buffer_load_dwordx4 v2, s[12:15], s40 offen sc1 lds
    s_add_u32 s43, s43, 1
    s_cmp_lt_u32 s43, 10
    s_cbranch_scc1 ld_82
    s_call_b64 s[76:77], PREP_a_issue_4
    s_add_u32 m0, m0, 1024
    s_add_u32 s39, s39, 229376
    buffer_load_dwordx4 v2, s[12:15], s39 offen sc1 lds
    s_add_u32 m0, m0, 1024
    s_add_u32 s40, s40, 229376
    buffer_load_dwordx4 v2, s[12:15], s40 offen sc1 lds
    s_add_u32 m0, m0, 1024
    s_add_u32 s39, s39, 229376
    buffer_load_dwordx4 v2, s[12:15], s39 offen sc1 lds
    s_add_u32 m0, m0, 1024
    s_add_u32 s40, s40, 229376
    buffer_load_dwordx4 v2, s[12:15], s40 offen sc1 lds
    s_add_u32 m0, m0, 1024
    s_add_u32 s39, s39, 229376
    buffer_load_dwordx4 v2, s[12:15], s39 offen sc1 lds
    s_add_u32 m0, m0, 1024
    s_add_u32 s40, s40, 229376
    buffer_load_dwordx4 v2, s[12:15], s40 offen sc1 lds
    s_mov_b32 m0, s19
    s_mov_b32 s39, s16
    s_mov_b32 s40, s17
    s_waitcnt vmcnt(8)
    s_barrier
    buffer_load_dwordx4 v2, s[12:15], s39 offen sc1 lds
    s_add_u32 m0, m0, 1024
    s_nop 0
    buffer_load_dwordx4 v2, s[12:15], s40 offen sc1 lds
    s_add_u32 m0, m0, 1024
    s_add_u32 s39, s39, 229376
    buffer_load_dwordx4 v2, s[12:15], s39 offen sc1 lds
    s_add_u32 m0, m0, 1024
    s_add_u32 s40, s40, 229376
    buffer_load_dwordx4 v2, s[12:15], s40 offen sc1 lds
    s_add_u32 m0, m0, 1024
    s_add_u32 s39, s39, 229376
    buffer_load_dwordx4 v2, s[12:15], s39 offen sc1 lds
    s_add_u32 m0, m0, 1024
    s_add_u32 s40, s40, 229376
    buffer_load_dwordx4 v2, s[12:15], s40 offen sc1 lds
    s_add_u32 m0, m0, 1024
    s_add_u32 s39, s39, 229376
    buffer_load_dwordx4 v2, s[12:15], s39 offen sc1 lds
    s_add_u32 m0, m0, 1024
    s_add_u32 s40, s40, 229376
    buffer_load_dwordx4 v2, s[12:15], s40 offen sc1 lds
    s_waitcnt vmcnt(8)
    s_barrier
    s_waitcnt vmcnt(0)
    s_barrier
    s_cmp_eq_u32 s60, 1
    s_cbranch_scc1 K_fin
    s_barrier
    s_branch NEXT
WLOAD:
    s_cmp_eq_u32 s60, 1
    s_cbranch_scc1 WL_1
    s_mov_b64 s[12:13], s[68:69]
    s_mov_b32 s14, 2097152
    s_mov_b32 s15, 0x20000
    s_and_b32 s35, s30, 1
    s_mul_i32 s38, s29, 128
    s_mul_i32 s41, s35, 65536
    s_add_u32 s38, s38, s41
    s_mul_i32 s41, s35, 4096
    s_add_u32 s41, s41, 24576
    s_mov_b32 s42, 0
    s_mov_b32 s44, s67
    s_branch WL_2
WL_1:
    s_mov_b64 s[12:13], s[68:69]
    s_mov_b32 s14, 2097152
    s_mov_b32 s15, 0x20000
    s_and_b32 s35, s30, 1
    s_mul_i32 s38, s29, 128
    s_mul_i32 s41, s35, 65536
    s_add_u32 s38, s38, s41
    s_mul_i32 s41, s35, 4096
    s_add_u32 s41, s41, 24576
    s_mov_b32 s42, 0
    s_mov_b32 s44, s67
WL_2:
    s_waitcnt vmcnt(0)
    s_barrier
    s_barrier
    s_call_b64 s[76:77], SUB_after_g1
    s_barrier
    s_barrier
    s_call_b64 s[76:77], SUB_after_g2
    s_mov_b64 s[12:13], s[72:73]
    s_mov_b32 s14, 7340032
    s_mov_b32 s15, 0x20000
    s_and_b32 s35, s30, 1
    s_mul_i32 s38, s29, 448
    s_mul_i32 s41, s35, 229376
    s_add_u32 s38, s38, s41
    s_mul_i32 s41, s35, 14336
    s_add_u32 s41, s41, 73728
    s_mov_b32 s42, 0
    s_mov_b32 s44, 0
    s_mov_b32 s42, 28672
    s_mov_b32 s44, 2
    s_add_u32 s19, s41, s42
    v_readlane_b32 s16, v248, s44
    s_nop 0
    s_add_u32 s16, s16, s38
    s_add_u32 s44, s44, 1
    s_and_b32 s44, s44, 15
    s_add_u32 s42, s42, 28672
    s_cmp_eq_u32 s42, 86016
    s_cselect_b32 s42, 0, s42
    s_mov_b32 m0, s19
    s_mov_b32 s39, s16
    s_waitcnt vmcnt(0)
    s_barrier
    buffer_load_dwordx4 v241, s[12:15], s39 offen lds
    s_add_u32 m0, m0, 1024
    s_nop 0
    buffer_load_dwordx4 v242, s[12:15], s39 offen lds
    s_add_u32 m0, m0, 1024
    s_nop 0
    buffer_load_dwordx4 v243, s[12:15], s39 offen lds
    s_mov_b32 s43, 1
ld_83:
    s_add_u32 s19, s41, s42
    v_readlane_b32 s16, v248, s44
    s_nop 0
    s_add_u32 s16, s16, s38
    s_add_u32 s44, s44, 1
    s_and_b32 s44, s44, 15
    s_add_u32 s42, s42, 28672
    s_cmp_eq_u32 s42, 86016
    s_cselect_b32 s42, 0, s42
    s_add_u32 m0, m0, 1024
    s_nop 0
    buffer_load_dwordx4 v244, s[12:15], s39 offen lds
    s_add_u32 m0, m0, 1024
    s_nop 0
    buffer_load_dwordx4 v245, s[12:15], s39 offen lds
    s_add_u32 m0, m0, 1024
    s_nop 0
    buffer_load_dwordx4 v246, s[12:15], s39 offen lds
    s_add_u32 m0, m0, 1024
    s_nop 0
    buffer_load_dwordx4 v247, s[12:15], s39 offen lds
    s_add_u32 m0, m0, 1024
    s_add_u32 s39, s39, 114688
    buffer_load_dwordx4 v241, s[12:15], s39 offen lds
    s_add_u32 m0, m0, 1024
    s_nop 0
    buffer_load_dwordx4 v242, s[12:15], s39 offen lds
    s_add_u32 m0, m0, 1024
    s_nop 0
    buffer_load_dwordx4 v243, s[12:15], s39 offen lds
    s_add_u32 m0, m0, 1024
    s_nop 0
    buffer_load_dwordx4 v244, s[12:15], s39 offen lds
    s_add_u32 m0, m0, 1024
    s_nop 0
    buffer_load_dwordx4 v245, s[12:15], s39 offen lds
    s_add_u32 m0, m0, 1024
    s_nop 0
    buffer_load_dwordx4 v246, s[12:15], s39 offen lds
    s_add_u32 m0, m0, 1024
    s_nop 0
    buffer_load_dwordx4 v247, s[12:15], s39 offen lds
    s_mov_b32 m0, s19
    s_mov_b32 s39, s16
    s_waitcnt vmcnt(14)
    s_barrier
    buffer_load_dwordx4 v241, s[12:15], s39 offen lds
    s_add_u32 m0, m0, 1024
    s_nop 0
    buffer_load_dwordx4 v242, s[12:15], s39 offen lds
    s_add_u32 m0, m0, 1024
    s_nop 0
    buffer_load_dwordx4 v243, s[12:15], s39 offen lds
    s_add_u32 s43, s43, 1
    s_cmp_lt_u32 s43, 13
    s_cbranch_scc1 ld_83
    s_add_u32 s19, s41, s42
    v_readlane_b32 s16, v248, s44
    s_nop 0
    s_add_u32 s16, s16, s38
    s_add_u32 s44, s44, 1
    s_and_b32 s44, s44, 15
    s_add_u32 s42, s42, 28672
    s_cmp_eq_u32 s42, 86016
    s_cselect_b32 s42, 0, s42
    s_add_u32 m0, m0, 1024
    s_nop 0
    buffer_load_dwordx4 v244, s[12:15], s39 offen lds
    s_add_u32 m0, m0, 1024
    s_nop 0
    buffer_load_dwordx4 v245, s[12:15], s39 offen lds
    s_add_u32 m0, m0, 1024
    s_nop 0
    buffer_load_dwordx4 v246, s[12:15], s39 offen lds
    s_add_u32 m0, m0, 1024
    s_nop 0
    buffer_load_dwordx4 v247, s[12:15], s39 offen lds
    s_add_u32 m0, m0, 1024
    s_add_u32 s39, s39, 114688
    buffer_load_dwordx4 v241, s[12:15], s39 offen lds
    s_add_u32 m0, m0, 1024
    s_nop 0
    buffer_load_dwordx4 v242, s[12:15], s39 offen lds
    s_add_u32 m0, m0, 1024
    s_nop 0
    buffer_load_dwordx4 v243, s[12:15], s39 offen lds
    s_add_u32 m0, m0, 1024
    s_nop 0
    buffer_load_dwordx4 v244, s[12:15], s39 offen lds
    s_add_u32 m0, m0, 1024
    s_nop 0
    buffer_load_dwordx4 v245, s[12:15], s39 offen lds
    s_add_u32 m0, m0, 1024
    s_nop 0
    buffer_load_dwordx4 v246, s[12:15], s39 offen lds
    s_add_u32 m0, m0, 1024
    s_nop 0
    buffer_load_dwordx4 v247, s[12:15], s39 offen lds
    s_mov_b32 m0, s19
    s_mov_b32 s39, s16
    s_waitcnt vmcnt(14)
    s_barrier
    buffer_load_dwordx4 v241, s[12:15], s39 offen lds
    s_add_u32 m0, m0, 1024
    s_nop 0
    buffer_load_dwordx4 v242, s[12:15], s39 offen lds
    s_add_u32 m0, m0, 1024
    s_nop 0
    buffer_load_dwordx4 v243, s[12:15], s39 offen lds
    s_add_u32 m0, m0, 1024
    s_nop 0
    buffer_load_dwordx4 v244, s[12:15], s39 offen lds
    s_add_u32 m0, m0, 1024
    s_nop 0
    buffer_load_dwordx4 v245, s[12:15], s39 offen lds
    s_add_u32 m0, m0, 1024
    s_nop 0
    buffer_load_dwordx4 v246, s[12:15], s39 offen lds
    s_add_u32 m0, m0, 1024
    s_nop 0
    buffer_load_dwordx4 v247, s[12:15], s39 offen lds
    s_add_u32 m0, m0, 1024
    s_add_u32 s39, s39, 114688
    buffer_load_dwordx4 v241, s[12:15], s39 offen lds
    s_add_u32 m0, m0, 1024
    s_nop 0
    buffer_load_dwordx4 v242, s[12:15], s39 offen lds
    s_add_u32 m0, m0, 1024
    s_nop 0
    buffer_load_dwordx4 v243, s[12:15], s39 offen lds
    s_add_u32 m0, m0, 1024
    s_nop 0
    buffer_load_dwordx4 v244, s[12:15], s39 offen lds
    s_add_u32 m0, m0, 1024
    s_nop 0
    buffer_load_dwordx4 v245, s[12:15], s39 offen lds
    s_add_u32 m0, m0, 1024
    s_nop 0
    buffer_load_dwordx4 v246, s[12:15], s39 offen lds
    s_add_u32 m0, m0, 1024
    s_nop 0
    buffer_load_dwordx4 v247, s[12:15], s39 offen lds
    s_waitcnt vmcnt(14)
    s_barrier
    s_call_b64 s[76:77], SUB_r_pre0
    s_waitcnt vmcnt(8)
    s_barrier
    s_barrier
    s_mov_b64 s[12:13], s[74:75]
    s_mov_b32 s14, 7340032
    s_mov_b32 s15, 0x20000
    s_and_b32 s35, s30, 1
    s_mul_i32 s38, s33, 256
    s_mul_i32 s41, s31, 3670016
    s_add_u32 s38, s38, s41
    s_mul_i32 s41, s35, 8192
    s_add_u32 s41, s41, 49152
    s_mov_b32 s42, 0
    s_mov_b32 s44, 0
    s_mov_b32 s49, s44
    s_and_b32 s43, s28, 3
    s_mul_i32 s43, s43, 6
    s_lshr_b32 s43, s43, 2
    s_mov_b32 s50, 0
wpre_84:
    s_mul_i32 s42, s43, 16384
    s_add_u32 s44, s49, s43
    s_mov_b32 s45, 8192
    s_add_u32 s19, s41, s42
    v_readlane_b32 s16, v249, s44
    s_nop 0
    s_bitcmp1_b32 s16, 0
    s_cselect_b32 s17, 16384, s45
    s_cselect_b32 s18, -40960, s45
    s_andn2_b32 s16, s16, 1
    s_add_u32 s16, s16, s38
    s_add_u32 s44, s44, 1
    s_add_u32 s42, s42, 16384
    s_cmp_eq_u32 s42, 98304
    s_cselect_b32 s42, 0, s42
    s_mov_b32 m0, s19
    s_mov_b32 s39, s16
    s_mov_b32 s32, s17
    s_mov_b32 s3, s18
    buffer_load_dwordx4 v239, s[12:15], s39 offen lds
    s_add_u32 m0, m0, 1024
    s_add_u32 s39, s39, s32
    buffer_load_dwordx4 v240, s[12:15], s39 offen lds
    s_add_u32 m0, m0, 1024
    s_add_u32 s39, s39, s32
    buffer_load_dwordx4 v239, s[12:15], s39 offen lds
    s_add_u32 m0, m0, 1024
    s_add_u32 s39, s39, s32
    buffer_load_dwordx4 v240, s[12:15], s39 offen lds
    s_waitcnt vmcnt(4)
    s_add_u32 m0, m0, 1024
    s_add_u32 s39, s39, s3
    buffer_load_dwordx4 v239, s[12:15], s39 offen lds
    s_add_u32 m0, m0, 1024
    s_add_u32 s39, s39, s32
    buffer_load_dwordx4 v240, s[12:15], s39 offen lds
    s_add_u32 m0, m0, 1024
    s_add_u32 s39, s39, s32
    buffer_load_dwordx4 v239, s[12:15], s39 offen lds
    s_add_u32 m0, m0, 1024
    s_add_u32 s39, s39, s32
    buffer_load_dwordx4 v240, s[12:15], s39 offen lds
    s_waitcnt vmcnt(4)
    s_add_u32 s43, s43, 1
    s_cmp_eq_u32 s43, 6
    s_cselect_b32 s43, 0, s43
    s_add_u32 s50, s50, 1
    s_cmp_lt_u32 s50, 6
    s_cbranch_scc1 wpre_84
    s_mov_b32 s42, 0
    s_add_u32 s44, s49, 6
    s_cmp_eq_u32 s60, 1
    s_cbranch_scc1 WL_t1
    s_call_b64 s[76:77], PREP_w_issue_4
    s_mov_b32 m0, s19
    s_mov_b32 s39, s16
    s_mov_b32 s32, s17
    s_mov_b32 s3, s18
    s_waitcnt vmcnt(0)
    s_barrier
    s_waitcnt vmcnt(0)
    s_barrier
    buffer_load_dwordx4 v239, s[12:15], s39 offen lds
    s_add_u32 m0, m0, 1024
    s_add_u32 s39, s39, s32
    buffer_load_dwordx4 v240, s[12:15], s39 offen lds
    s_call_b64 s[76:77], PREP_w_issue_4
    s_add_u32 m0, m0, 1024
    s_add_u32 s39, s39, s32
    buffer_load_dwordx4 v239, s[12:15], s39 offen lds
    s_add_u32 m0, m0, 1024
    s_add_u32 s39, s39, s32
    buffer_load_dwordx4 v240, s[12:15], s39 offen lds
    s_add_u32 m0, m0, 1024
    s_add_u32 s39, s39, s3
    buffer_load_dwordx4 v239, s[12:15], s39 offen lds
    s_add_u32 m0, m0, 1024
    s_add_u32 s39, s39, s32
    buffer_load_dwordx4 v240, s[12:15], s39 offen lds
    s_add_u32 m0, m0, 1024
    s_add_u32 s39, s39, s32
    buffer_load_dwordx4 v239, s[12:15], s39 offen lds
    s_add_u32 m0, m0, 1024
    s_add_u32 s39, s39, s32
    buffer_load_dwordx4 v240, s[12:15], s39 offen lds
    s_mov_b32 m0, s19
    s_mov_b32 s39, s16
    s_mov_b32 s32, s17
    s_mov_b32 s3, s18
    s_waitcnt vmcnt(8)
    s_barrier
    buffer_load_dwordx4 v239, s[12:15], s39 offen lds
    s_add_u32 m0, m0, 1024
    s_add_u32 s39, s39, s32
    buffer_load_dwordx4 v240, s[12:15], s39 offen lds
    s_call_b64 s[76:77], PREP_w_issue_4
    s_add_u32 m0, m0, 1024
    s_add_u32 s39, s39, s32
    buffer_load_dwordx4 v239, s[12:15], s39 offen lds
    s_add_u32 m0, m0, 1024
    s_add_u32 s39, s39, s32
    buffer_load_dwordx4 v240, s[12:15], s39 offen lds
    s_add_u32 m0, m0, 1024
    s_add_u32 s39, s39, s3
    buffer_load_dwordx4 v239, s[12:15], s39 offen lds
    s_add_u32 m0, m0, 1024
    s_add_u32 s39, s39, s32
    buffer_load_dwordx4 v240, s[12:15], s39 offen lds
    s_add_u32 m0, m0, 1024
    s_add_u32 s39, s39, s32
    buffer_load_dwordx4 v239, s[12:15], s39 offen lds
    s_add_u32 m0, m0, 1024
    s_add_u32 s39, s39, s32
    buffer_load_dwordx4 v240, s[12:15], s39 offen lds
    s_mov_b32 m0, s19
    s_mov_b32 s39, s16
    s_mov_b32 s32, s17
    s_mov_b32 s3, s18
    s_waitcnt vmcnt(16)
    s_barrier
    buffer_load_dwordx4 v239, s[12:15], s39 offen lds
    s_add_u32 m0, m0, 1024
    s_add_u32 s39, s39, s32
    buffer_load_dwordx4 v240, s[12:15], s39 offen lds
    s_call_b64 s[76:77], PREP_w_issue_4
    s_add_u32 m0, m0, 1024
    s_add_u32 s39, s39, s32
    buffer_load_dwordx4 v239, s[12:15], s39 offen lds
    s_add_u32 m0, m0, 1024
    s_add_u32 s39, s39, s32
    buffer_load_dwordx4 v240, s[12:15], s39 offen lds
    s_add_u32 m0, m0, 1024
    s_add_u32 s39, s39, s3
    buffer_load_dwordx4 v239, s[12:15], s39 offen lds
    s_add_u32 m0, m0, 1024
    s_add_u32 s39, s39, s32
    buffer_load_dwordx4 v240, s[12:15], s39 offen lds
    s_add_u32 m0, m0, 1024
    s_add_u32 s39, s39, s32
    buffer_load_dwordx4 v239, s[12:15], s39 offen lds
    s_add_u32 m0, m0, 1024
    s_add_u32 s39, s39, s32
    buffer_load_dwordx4 v240, s[12:15], s39 offen lds
    s_mov_b32 m0, s19
    s_mov_b32 s39, s16
    s_mov_b32 s32, s17
    s_mov_b32 s3, s18
    s_waitcnt vmcnt(24)
    s_barrier
    buffer_load_dwordx4 v239, s[12:15], s39 offen lds
    s_add_u32 m0, m0, 1024
    s_add_u32 s39, s39, s32
    buffer_load_dwordx4 v240, s[12:15], s39 offen lds
    s_mov_b32 s43, 1
ld_85:
    s_mov_b32 s45, 8192
    s_add_u32 s19, s41, s42
    v_readlane_b32 s16, v249, s44
    s_nop 0
    s_bitcmp1_b32 s16, 0
    s_cselect_b32 s17, 16384, s45
    s_cselect_b32 s18, -40960, s45
    s_andn2_b32 s16, s16, 1
    s_add_u32 s16, s16, s38
    s_add_u32 s44, s44, 1
    s_add_u32 s42, s42, 16384
    s_cmp_eq_u32 s42, 98304
    s_cselect_b32 s42, 0, s42
    s_add_u32 m0, m0, 1024
    s_add_u32 s39, s39, s32
    buffer_load_dwordx4 v239, s[12:15], s39 offen lds
    s_add_u32 m0, m0, 1024
    s_add_u32 s39, s39, s32
    buffer_load_dwordx4 v240, s[12:15], s39 offen lds
    s_add_u32 m0, m0, 1024
    s_add_u32 s39, s39, s3
    buffer_load_dwordx4 v239, s[12:15], s39 offen lds
    s_add_u32 m0, m0, 1024
    s_add_u32 s39, s39, s32
    buffer_load_dwordx4 v240, s[12:15], s39 offen lds
    s_add_u32 m0, m0, 1024
    s_add_u32 s39, s39, s32
    buffer_load_dwordx4 v239, s[12:15], s39 offen lds
    s_add_u32 m0, m0, 1024
    s_add_u32 s39, s39, s32
    buffer_load_dwordx4 v240, s[12:15], s39 offen lds
    s_mov_b32 m0, s19
    s_mov_b32 s39, s16
    s_mov_b32 s32, s17
    s_mov_b32 s3, s18
    s_waitcnt vmcnt(32)
    s_barrier
    buffer_load_dwordx4 v239, s[12:15], s39 offen lds
    s_add_u32 m0, m0, 1024
    s_add_u32 s39, s39, s32
    buffer_load_dwordx4 v240, s[12:15], s39 offen lds
    s_add_u32 s43, s43, 1
    s_cmp_lt_u32 s43, 18
    s_cbranch_scc1 ld_85
    s_call_b64 s[76:77], PREP_w_issue_4
    s_add_u32 m0, m0, 1024
    s_add_u32 s39, s39, s32
    buffer_load_dwordx4 v239, s[12:15], s39 offen lds
    s_add_u32 m0, m0, 1024
    s_add_u32 s39, s39, s32
    buffer_load_dwordx4 v240, s[12:15], s39 offen lds
    s_add_u32 m0, m0, 1024
    s_add_u32 s39, s39, s3
    buffer_load_dwordx4 v239, s[12:15], s39 offen lds
    s_add_u32 m0, m0, 1024
    s_add_u32 s39, s39, s32
    buffer_load_dwordx4 v240, s[12:15], s39 offen lds
    s_add_u32 m0, m0, 1024
    s_add_u32 s39, s39, s32
    buffer_load_dwordx4 v239, s[12:15], s39 offen lds
    s_add_u32 m0, m0, 1024
    s_add_u32 s39, s39, s32
    buffer_load_dwordx4 v240, s[12:15], s39 offen lds
    s_mov_b32 m0, s19
    s_mov_b32 s39, s16
    s_mov_b32 s32, s17
    s_mov_b32 s3, s18
    s_waitcnt vmcnt(32)
    s_barrier
    buffer_load_dwordx4 v239, s[12:15], s39 offen lds
    s_add_u32 m0, m0, 1024
    s_add_u32 s39, s39, s32
    buffer_load_dwordx4 v240, s[12:15], s39 offen lds
    s_add_u32 m0, m0, 1024
    s_add_u32 s39, s39, s32
    buffer_load_dwordx4 v239, s[12:15], s39 offen lds
    s_add_u32 m0, m0, 1024
    s_add_u32 s39, s39, s32
    buffer_load_dwordx4 v240, s[12:15], s39 offen lds
    s_add_u32 m0, m0, 1024
    s_add_u32 s39, s39, s3
    buffer_load_dwordx4 v239, s[12:15], s39 offen lds
    s_add_u32 m0, m0, 1024
    s_add_u32 s39, s39, s32
    buffer_load_dwordx4 v240, s[12:15], s39 offen lds
    s_add_u32 m0, m0, 1024
    s_add_u32 s39, s39, s32
    buffer_load_dwordx4 v239, s[12:15], s39 offen lds
    s_add_u32 m0, m0, 1024
    s_add_u32 s39, s39, s32
    buffer_load_dwordx4 v240, s[12:15], s39 offen lds
    s_waitcnt vmcnt(32)
    s_barrier
    s_mov_b64 s[12:13], s[68:69]
    s_mov_b32 s14, 2097152
    s_mov_b32 s15, 0x20000
    s_and_b32 s35, s30, 1
    s_mul_i32 s38, s29, 128
    s_mul_i32 s41, s35, 65536
    s_add_u32 s38, s38, s41
    s_mul_i32 s41, s35, 4096
    s_add_u32 s41, s41, 24576
    s_mov_b32 s42, 0
    s_mov_b32 s44, s67
    s_mov_b32 s42, 90112
    s_mov_b32 s44, s67
    s_add_u32 s44, s44, 11
    s_and_b32 s44, s44, 15
    s_call_b64 s[76:77], SUB_w_issue_1
    s_mov_b32 s42, 98304
    s_mov_b32 s44, s67
    s_add_u32 s44, s44, 12
    s_and_b32 s44, s44, 15
    s_call_b64 s[76:77], SUB_w_issue_1
    s_mov_b32 s42, 122880
    s_mov_b32 s44, s67
    s_add_u32 s44, s44, 15
    s_and_b32 s44, s44, 15
    s_call_b64 s[76:77], SUB_w_issue_1
    s_waitcnt vmcnt(36)
    s_barrier
    s_mov_b32 s42, 106496
    s_mov_b32 s44, s67
    s_add_u32 s44, s44, 13
    s_and_b32 s44, s44, 15
    s_call_b64 s[76:77], SUB_w_issue_1
    s_mov_b32 s42, 114688
    s_mov_b32 s44, s67
    s_add_u32 s44, s44, 14
    s_and_b32 s44, s44, 15
    s_call_b64 s[76:77], SUB_w_issue_1
    s_waitcnt vmcnt(36)
    s_barrier
    s_mov_b32 s42, 24576
    s_mov_b32 s44, s67
    s_add_u32 s44, s44, 3
    s_and_b32 s44, s44, 15
    s_call_b64 s[76:77], SUB_w_issue_1
    s_mov_b32 s42, 32768
    s_mov_b32 s44, s67
    s_add_u32 s44, s44, 4
    s_and_b32 s44, s44, 15
    s_call_b64 s[76:77], SUB_w_issue_1
    s_waitcnt vmcnt(36)
    s_barrier
    s_mov_b32 s42, 40960
    s_mov_b32 s44, s67
    s_add_u32 s44, s44, 5
    s_and_b32 s44, s44, 15
    s_call_b64 s[76:77], SUB_w_issue_1
    s_mov_b32 s42, 49152
    s_mov_b32 s44, s67
    s_add_u32 s44, s44, 6
    s_and_b32 s44, s44, 15
    s_call_b64 s[76:77], SUB_w_issue_1
    s_waitcnt vmcnt(36)
    s_barrier
    s_mov_b32 s42, 57344
    s_mov_b32 s44, s67
    s_add_u32 s44, s44, 7
    s_and_b32 s44, s44, 15
    s_call_b64 s[76:77], SUB_w_issue_1
    s_mov_b32 s42, 65536
    s_mov_b32 s44, s67
    s_add_u32 s44, s44, 8
    s_and_b32 s44, s44, 15
    s_call_b64 s[76:77], SUB_w_issue_1
    s_barrier
    s_mov_b32 s42, 73728
    s_mov_b32 s44, s67
    s_add_u32 s44, s44, 9
    s_and_b32 s44, s44, 15
    s_call_b64 s[76:77], SUB_w_issue_1
    s_mov_b32 s42, 81920
    s_mov_b32 s44, s67
    s_add_u32 s44, s44, 10
    s_and_b32 s44, s44, 15
    s_call_b64 s[76:77], SUB_w_issue_1
    s_mov_b32 s42, 0
    s_mov_b32 s44, s67
    s_add_u32 s44, s44, 0
    s_and_b32 s44, s44, 15
    s_call_b64 s[76:77], SUB_w_issue_1
    s_waitcnt vmcnt(8)
    s_mov_b32 s42, 8192
    s_mov_b32 s44, s67
    s_add_u32 s44, s44, 1
    s_and_b32 s44, s44, 15
    s_call_b64 s[76:77], SUB_w_issue_1
    s_waitcnt vmcnt(8)
    s_mov_b32 s42, 16384
    s_mov_b32 s44, s67
    s_add_u32 s44, s44, 2
    s_and_b32 s44, s44, 15
    s_call_b64 s[76:77], SUB_w_issue_1
    s_waitcnt vmcnt(8)
    s_branch NEXT
WL_t1:
    s_call_b64 s[76:77], PREP_w_issue_4
    s_mov_b32 m0, s19
    s_mov_b32 s39, s16
    s_mov_b32 s32, s17
    s_mov_b32 s3, s18
    s_waitcnt vmcnt(0)
    s_barrier
    s_waitcnt vmcnt(0)
    s_barrier
    s_waitcnt vmcnt(0)
    s_barrier
    s_waitcnt vmcnt(0)
    s_barrier
    s_waitcnt vmcnt(0)
    s_barrier
    buffer_load_dwordx4 v239, s[12:15], s39 offen lds
    s_add_u32 m0, m0, 1024
    s_add_u32 s39, s39, s32
    buffer_load_dwordx4 v240, s[12:15], s39 offen lds
    s_mov_b32 s43, 1
ld_86:
    s_mov_b32 s45, 8192
    s_add_u32 s19, s41, s42
    v_readlane_b32 s16, v249, s44
    s_nop 0
    s_bitcmp1_b32 s16, 0
    s_cselect_b32 s17, 16384, s45
    s_cselect_b32 s18, -40960, s45
    s_andn2_b32 s16, s16, 1
    s_add_u32 s16, s16, s38
    s_add_u32 s44, s44, 1
    s_add_u32 s42, s42, 16384
    s_cmp_eq_u32 s42, 98304
    s_cselect_b32 s42, 0, s42
    s_add_u32 m0, m0, 1024
    s_add_u32 s39, s39, s32
    buffer_load_dwordx4 v239, s[12:15], s39 offen lds
    s_add_u32 m0, m0, 1024
    s_add_u32 s39, s39, s32
    buffer_load_dwordx4 v240, s[12:15], s39 offen lds
    s_add_u32 m0, m0, 1024
    s_add_u32 s39, s39, s3
    buffer_load_dwordx4 v239, s[12:15], s39 offen lds
    s_add_u32 m0, m0, 1024
    s_add_u32 s39, s39, s32
    buffer_load_dwordx4 v240, s[12:15], s39 offen lds
    s_add_u32 m0, m0, 1024
    s_add_u32 s39, s39, s32
    buffer_load_dwordx4 v239, s[12:15], s39 offen lds
    s_add_u32 m0, m0, 1024
    s_add_u32 s39, s39, s32
    buffer_load_dwordx4 v240, s[12:15], s39 offen lds
    s_mov_b32 m0, s19
    s_mov_b32 s39, s16
    s_mov_b32 s32, s17
    s_mov_b32 s3, s18
    s_waitcnt vmcnt(8)
    s_barrier
    buffer_load_dwordx4 v239, s[12:15], s39 offen lds
    s_add_u32 m0, m0, 1024
    s_add_u32 s39, s39, s32
    buffer_load_dwordx4 v240, s[12:15], s39 offen lds
    s_add_u32 s43, s43, 1
    s_cmp_lt_u32 s43, 21
    s_cbranch_scc1 ld_86
    s_call_b64 s[76:77], PREP_w_issue_4
    s_add_u32 m0, m0, 1024
    s_add_u32 s39, s39, s32
    buffer_load_dwordx4 v239, s[12:15], s39 offen lds
    s_add_u32 m0, m0, 1024
    s_add_u32 s39, s39, s32
    buffer_load_dwordx4 v240, s[12:15], s39 offen lds
    s_add_u32 m0, m0, 1024
    s_add_u32 s39, s39, s3
    buffer_load_dwordx4 v239, s[12:15], s39 offen lds
    s_add_u32 m0, m0, 1024
    s_add_u32 s39, s39, s32
    buffer_load_dwordx4 v240, s[12:15], s39 offen lds
    s_add_u32 m0, m0, 1024
    s_add_u32 s39, s39, s32
    buffer_load_dwordx4 v239, s[12:15], s39 offen lds
    s_add_u32 m0, m0, 1024
    s_add_u32 s39, s39, s32
    buffer_load_dwordx4 v240, s[12:15], s39 offen lds
    s_mov_b32 m0, s19
    s_mov_b32 s39, s16
    s_mov_b32 s32, s17
    s_mov_b32 s3, s18
    s_waitcnt vmcnt(8)
    s_barrier
    buffer_load_dwordx4 v239, s[12:15], s39 offen lds
    s_add_u32 m0, m0, 1024
    s_add_u32 s39, s39, s32
    buffer_load_dwordx4 v240, s[12:15], s39 offen lds
    s_add_u32 m0, m0, 1024
    s_add_u32 s39, s39, s32
    buffer_load_dwordx4 v239, s[12:15], s39 offen lds
    s_add_u32 m0, m0, 1024
    s_add_u32 s39, s39, s32
    buffer_load_dwordx4 v240, s[12:15], s39 offen lds
    s_add_u32 m0, m0, 1024
    s_add_u32 s39, s39, s3
    buffer_load_dwordx4 v239, s[12:15], s39 offen lds
    s_add_u32 m0, m0, 1024
    s_add_u32 s39, s39, s32
    buffer_load_dwordx4 v240, s[12:15], s39 offen lds
    s_add_u32 m0, m0, 1024
    s_add_u32 s39, s39, s32
    buffer_load_dwordx4 v239, s[12:15], s39 offen lds
    s_add_u32 m0, m0, 1024
    s_add_u32 s39, s39, s32
    buffer_load_dwordx4 v240, s[12:15], s39 offen lds
    s_waitcnt vmcnt(8)
    s_barrier
    s_waitcnt vmcnt(0)
    s_barrier
    s_branch K_fin
NEXT:
    s_setprio 0
    s_add_u32 s60, s60, 1
    s_add_u32 s55, s55, 67108864
    s_add_u32 s62, s62, 67108864
    s_addc_u32 s63, s63, 0
    s_branch LAYER
K_fin:
    s_endpgm
SUB_w1_regs:
    s_mov_b64 s[12:13], s[68:69]
    s_mov_b32 s14, 2097152
    s_mov_b32 s15, 0x20000
    s_and_b32 s35, s30, 3
    s_mul_i32 s35, s35, 294912
    s_lshl_b32 s39, s29, 7
    s_add_u32 s39, s39, s35
    buffer_load_dwordx4 v[196:199], v238, s[12:15], s39 offen
    s_add_u32 s39, s39, 16384
    buffer_load_dwordx4 v[200:203], v238, s[12:15], s39 offen
    s_add_u32 s39, s39, 16384
    buffer_load_dwordx4 v[204:207], v238, s[12:15], s39 offen
    s_add_u32 s39, s39, 16384
    buffer_load_dwordx4 v[208:211], v238, s[12:15], s39 offen
    s_add_u32 s39, s39, 16384
    s_waitcnt vmcnt(8)
    buffer_load_dwordx4 v[212:215], v238, s[12:15], s39 offen
    s_add_u32 s39, s39, 16384
    buffer_load_dwordx4 v[216:219], v238, s[12:15], s39 offen
    s_add_u32 s39, s39, 16384
    buffer_load_dwordx4 v[220:223], v238, s[12:15], s39 offen
    s_add_u32 s39, s39, 16384
    buffer_load_dwordx4 v[224:227], v238, s[12:15], s39 offen
    s_add_u32 s39, s39, 16384
    s_waitcnt vmcnt(8)
    buffer_load_dwordx4 v[228:231], v238, s[12:15], s39 offen
    s_add_u32 s39, s39, 16384
    buffer_load_dwordx4 v[232:235], v238, s[12:15], s39 offen
    s_add_u32 s39, s39, 16384
    buffer_load_dwordx4 v[16:19], v238, s[12:15], s39 offen
    s_add_u32 s39, s39, 16384
    buffer_load_dwordx4 v[20:23], v238, s[12:15], s39 offen
    s_add_u32 s39, s39, 16384
    s_waitcnt vmcnt(8)
    buffer_load_dwordx4 v[24:27], v238, s[12:15], s39 offen
    s_add_u32 s39, s39, 16384
    buffer_load_dwordx4 v[28:31], v238, s[12:15], s39 offen
    s_add_u32 s39, s39, 16384
    buffer_load_dwordx4 v[32:35], v238, s[12:15], s39 offen
    s_add_u32 s39, s39, 16384
    buffer_load_dwordx4 v[36:39], v238, s[12:15], s39 offen
    s_add_u32 s39, s39, 16384
    s_waitcnt vmcnt(8)
    buffer_load_dwordx4 v[40:43], v238, s[12:15], s39 offen
    s_add_u32 s39, s39, 16384
    buffer_load_dwordx4 v[44:47], v238, s[12:15], s39 offen
    s_add_u32 s39, s39, 16384
    s_setpc_b64 s[76:77]
SUB_park:
    s_mov_b64 s[12:13], s[70:71]
    s_mov_b32 s14, 2097152
    s_mov_b32 s15, 0x20000
    s_and_b32 s35, s30, 3
    s_lshl_b32 s35, s35, 19
    s_lshl_b32 s39, s29, 7
    s_add_u32 s39, s39, s35
    buffer_load_dwordx4 v[48:51], v238, s[12:15], s39 offen
    s_add_u32 s39, s39, 16384
    buffer_load_dwordx4 v[52:55], v238, s[12:15], s39 offen
    s_add_u32 s39, s39, 16384
    buffer_load_dwordx4 v[56:59], v238, s[12:15], s39 offen
    s_add_u32 s39, s39, 16384
    buffer_load_dwordx4 v[60:63], v238, s[12:15], s39 offen
    s_add_u32 s39, s39, 16384
    s_waitcnt vmcnt(8)
    buffer_load_dwordx4 v[64:67], v238, s[12:15], s39 offen
    s_add_u32 s39, s39, 16384
    buffer_load_dwordx4 v[68:71], v238, s[12:15], s39 offen
    s_add_u32 s39, s39, 16384
    buffer_load_dwordx4 v[72:75], v238, s[12:15], s39 offen
    s_add_u32 s39, s39, 16384
    buffer_load_dwordx4 v[76:79], v238, s[12:15], s39 offen
    s_add_u32 s39, s39, 16384
    s_waitcnt vmcnt(8)
    buffer_load_dwordx4 v[80:83], v238, s[12:15], s39 offen
    s_add_u32 s39, s39, 16384
    buffer_load_dwordx4 v[84:87], v238, s[12:15], s39 offen
    s_add_u32 s39, s39, 16384
    buffer_load_dwordx4 v[88:91], v238, s[12:15], s39 offen
    s_add_u32 s39, s39, 16384
    buffer_load_dwordx4 v[92:95], v238, s[12:15], s39 offen
    s_add_u32 s39, s39, 16384
    s_waitcnt vmcnt(8)
    buffer_load_dwordx4 v[96:99], v238, s[12:15], s39 offen
    s_add_u32 s39, s39, 16384
    buffer_load_dwordx4 v[100:103], v238, s[12:15], s39 offen
    s_add_u32 s39, s39, 16384
    buffer_load_dwordx4 v[104:107], v238, s[12:15], s39 offen
    s_add_u32 s39, s39, 16384
    buffer_load_dwordx4 v[108:111], v238, s[12:15], s39 offen
    s_add_u32 s39, s39, 16384
    s_waitcnt vmcnt(8)
    buffer_load_dwordx4 v[112:115], v238, s[12:15], s39 offen
    s_add_u32 s39, s39, 16384
    buffer_load_dwordx4 v[116:119], v238, s[12:15], s39 offen
    s_add_u32 s39, s39, 16384
    buffer_load_dwordx4 v[120:123], v238, s[12:15], s39 offen
    s_add_u32 s39, s39, 16384
    buffer_load_dwordx4 v[124:127], v238, s[12:15], s39 offen
    s_add_u32 s39, s39, 16384
    s_waitcnt vmcnt(8)
    buffer_load_dwordx4 v[128:131], v238, s[12:15], s39 offen
    s_add_u32 s39, s39, 16384
    buffer_load_dwordx4 v[132:135], v238, s[12:15], s39 offen
    s_add_u32 s39, s39, 16384
    buffer_load_dwordx4 v[136:139], v238, s[12:15], s39 offen
    s_add_u32 s39, s39, 16384
    buffer_load_dwordx4 v[140:143], v238, s[12:15], s39 offen
    s_add_u32 s39, s39, 16384
    s_waitcnt vmcnt(8)
    buffer_load_dwordx4 v[144:147], v238, s[12:15], s39 offen
    s_add_u32 s39, s39, 16384
    buffer_load_dwordx4 v[148:151], v238, s[12:15], s39 offen
    s_add_u32 s39, s39, 16384
    buffer_load_dwordx4 v[152:155], v238, s[12:15], s39 offen
    s_add_u32 s39, s39, 16384
    buffer_load_dwordx4 v[156:159], v238, s[12:15], s39 offen
    s_add_u32 s39, s39, 16384
    s_waitcnt vmcnt(8)
    buffer_load_dwordx4 v[160:163], v238, s[12:15], s39 offen
    s_add_u32 s39, s39, 16384
    buffer_load_dwordx4 v[164:167], v238, s[12:15], s39 offen
    s_add_u32 s39, s39, 16384
    buffer_load_dwordx4 v[168:171], v238, s[12:15], s39 offen
    s_add_u32 s39, s39, 16384
    buffer_load_dwordx4 v[172:175], v238, s[12:15], s39 offen
    s_add_u32 s39, s39, 16384
    s_waitcnt vmcnt(8)
    s_setpc_b64 s[76:77]
SUB_w1_put:
    s_and_b32 s35, s30, 3
    s_mul_i32 s35, s35, 18432
    v_add_u32 v8, s35, v2
    v_mov_b32 v6, 162820
spin_87:
    s_sleep 2
    ds_read_b32 v7, v6
    s_waitcnt lgkmcnt(0)
    v_readfirstlane_b32 s53, v7
    s_nop 0
    s_cmp_ge_u32 s53, 16
    s_cbranch_scc0 spin_87
    s_waitcnt vmcnt(0)
    ds_write_b128 v8, v[196:199] offset:24576
    ds_write_b128 v8, v[200:203] offset:25600
    ds_write_b128 v8, v[204:207] offset:26624
    ds_write_b128 v8, v[208:211] offset:27648
    ds_write_b128 v8, v[212:215] offset:28672
    ds_write_b128 v8, v[216:219] offset:29696
    ds_write_b128 v8, v[220:223] offset:30720
    ds_write_b128 v8, v[224:227] offset:31744
    ds_write_b128 v8, v[228:231] offset:32768
    ds_write_b128 v8, v[232:235] offset:33792
    ds_write_b128 v8, v[16:19] offset:34816
    ds_write_b128 v8, v[20:23] offset:35840
    ds_write_b128 v8, v[24:27] offset:36864
    ds_write_b128 v8, v[28:31] offset:37888
    ds_write_b128 v8, v[32:35] offset:38912
    ds_write_b128 v8, v[36:39] offset:39936
    ds_write_b128 v8, v[40:43] offset:40960
    ds_write_b128 v8, v[44:47] offset:41984
    s_waitcnt lgkmcnt(0)
    s_setpc_b64 s[76:77]
SUB_after_g1:
    s_mov_b64 s[12:13], s[72:73]
    s_mov_b32 s14, 7340032
    s_mov_b32 s15, 0x20000
    v_readlane_b32 s36, v251, 0
    v_readlane_b32 s37, v251, 1
    s_and_b32 s35, s30, 3
    s_mul_i32 s38, s35, 114688
    s_mul_i32 s39, s29, 448
    s_add_u32 s38, s38, s39
    s_and_b32 s36, s36, 15
    s_mul_i32 s36, s36, 458752
    s_add_u32 s36, s36, s38
    s_and_b32 s37, s37, 15
    s_mul_i32 s37, s37, 458752
    s_add_u32 s37, s37, s38
    s_mul_i32 s39, s35, 7168
    s_add_u32 m0, s39, 131072
    s_nop 0
    buffer_load_dwordx4 v241, s[12:15], s36 offen lds
    s_add_u32 m0, m0, 1024
    s_nop 0
    buffer_load_dwordx4 v242, s[12:15], s36 offen lds
    s_add_u32 m0, m0, 1024
    s_nop 0
    buffer_load_dwordx4 v243, s[12:15], s36 offen lds
    s_add_u32 m0, m0, 1024
    s_nop 0
    buffer_load_dwordx4 v244, s[12:15], s36 offen lds
    s_add_u32 m0, m0, 1024
    s_nop 0
    buffer_load_dwordx4 v245, s[12:15], s36 offen lds
    s_add_u32 m0, m0, 1024
    s_nop 0
    buffer_load_dwordx4 v246, s[12:15], s36 offen lds
    s_add_u32 m0, m0, 1024
    s_nop 0
    buffer_load_dwordx4 v247, s[12:15], s36 offen lds
    buffer_load_dwordx4 v[208:211], v241, s[12:15], s37 offen
    buffer_load_dwordx4 v[212:215], v242, s[12:15], s37 offen
    buffer_load_dwordx4 v[216:219], v243, s[12:15], s37 offen
    buffer_load_dwordx4 v[220:223], v244, s[12:15], s37 offen
    buffer_load_dwordx4 v[224:227], v245, s[12:15], s37 offen
    buffer_load_dwordx4 v[228:231], v246, s[12:15], s37 offen
    buffer_load_dwordx4 v[232:235], v247, s[12:15], s37 offen
    s_lshr_b32 s36, s67, 2
    s_sub_u32 s36, s35, s36
    s_and_b32 s36, s36, 3
    s_lshl_b32 s36, s36, 15
    v_add_u32 v6, s36, v2
    s_waitcnt vmcnt(14)
    ds_write_b128 v6, v[48:51] offset:0
    ds_write_b128 v6, v[52:55] offset:1024
    ds_write_b128 v6, v[56:59] offset:2048
    ds_write_b128 v6, v[60:63] offset:3072
    ds_write_b128 v6, v[64:67] offset:4096
    ds_write_b128 v6, v[68:71] offset:5120
    ds_write_b128 v6, v[72:75] offset:6144
    ds_write_b128 v6, v[76:79] offset:7168
    ds_write_b128 v6, v[80:83] offset:8192
    ds_write_b128 v6, v[84:87] offset:9216
    ds_write_b128 v6, v[88:91] offset:10240
    ds_write_b128 v6, v[92:95] offset:11264
    ds_write_b128 v6, v[96:99] offset:12288
    ds_write_b128 v6, v[100:103] offset:13312
    ds_write_b128 v6, v[104:107] offset:14336
    ds_write_b128 v6, v[108:111] offset:15360
    ds_write_b128 v6, v[112:115] offset:16384
    ds_write_b128 v6, v[116:119] offset:17408
    ds_write_b128 v6, v[120:123] offset:18432
    ds_write_b128 v6, v[124:127] offset:19456
    ds_write_b128 v6, v[128:131] offset:20480
    ds_write_b128 v6, v[132:135] offset:21504
    ds_write_b128 v6, v[136:139] offset:22528
    ds_write_b128 v6, v[140:143] offset:23552
    ds_write_b128 v6, v[144:147] offset:24576
    ds_write_b128 v6, v[148:151] offset:25600
    ds_write_b128 v6, v[152:155] offset:26624
    ds_write_b128 v6, v[156:159] offset:27648
    ds_write_b128 v6, v[160:163] offset:28672
    ds_write_b128 v6, v[164:167] offset:29696
    ds_write_b128 v6, v[168:171] offset:30720
    ds_write_b128 v6, v[172:175] offset:31744
    s_waitcnt vmcnt(0) lgkmcnt(0)
    s_setpc_b64 s[76:77]
SUB_after_g2:
    s_and_b32 s35, s30, 3
    s_mul_i32 s39, s35, 7168
    s_add_u32 s39, s39, 73728
    v_add_u32 v6, s39, v2
    ds_write_b128 v6, v[208:211] offset:0
    ds_write_b128 v6, v[212:215] offset:1024
    ds_write_b128 v6, v[216:219] offset:2048
    ds_write_b128 v6, v[220:223] offset:3072
    ds_write_b128 v6, v[224:227] offset:4096
    ds_write_b128 v6, v[228:231] offset:5120
    ds_write_b128 v6, v[232:235] offset:6144
    s_waitcnt lgkmcnt(0)
    s_setpc_b64 s[76:77]
SUB_r_pre0:
    v_and_b32 v179, 7, v0
    v_lshrrev_b32 v196, 6, v0
    v_lshlrev_b32 v196, 4, v196
    v_bfe_u32 v197, v0, 3, 3
    v_add_u32 v196, v196, v197
    s_lshr_b32 s78, s29, 1
    s_lshl_b32 s78, s78, 16
    s_and_b32 s79, s29, 1
    s_lshl_b32 s79, s79, 7
    s_add_u32 s78, s78, s79
    s_lshr_b32 s79, s30, 1
    s_lshl_b32 s79, s79, 13
    s_add_u32 s78, s78, s79
    v_lshlrev_b32 v176, 8, v196
    v_lshl_add_u32 v176, v179, 4, v176
    v_add_u32 v176, s78, v176
    s_lshl_b32 s78, s28, 7
    s_lshl_b32 s79, s29, 3
    s_add_u32 s78, s78, s79
    v_add_u32 v177, s78, v179
    v_lshlrev_b32 v178, 11, v177
    v_lshrrev_b32 v197, 2, v196
    v_lshlrev_b32 v197, 3, v197
    v_and_b32 v196, 3, v196
    v_add_u32 v196, v196, v197
    v_lshl_add_u32 v178, v196, 3, v178
    v_lshlrev_b32 v177, 3, v177
    v_lshl_add_u32 v177, v196, 14, v177
    s_add_u32 s84, s62, 0x400000
    s_addc_u32 s85, s63, 0
    s_mov_b32 s86, 0x7e000
    s_mov_b32 s87, 0x20000
    s_add_u32 s88, s62, 0x480000
    s_addc_u32 s89, s63, 0
    s_mov_b32 s90, 0x7e000
    s_mov_b32 s91, 0x20000
    s_cmp_eq_u32 s60, 0
    s_cselect_b32 s86, s86, 0
    s_cselect_b32 s90, s90, 0
    buffer_load_dwordx4 v[180:183], v176, s[84:87], 0 offen offset:0 sc1
    buffer_load_dwordx4 v[188:191], v176, s[88:91], 0 offen offset:0 sc1
    buffer_load_dwordx4 v[184:187], v176, s[84:87], 0 offen offset:2048 sc1
    buffer_load_dwordx4 v[192:195], v176, s[88:91], 0 offen offset:2048 sc1
    s_add_u32 s80, s4, 0x1c00000
    s_addc_u32 s81, s5, 0
    s_mov_b32 s82, 0x400000
    s_mov_b32 s83, 0x20000
    s_cmp_eq_u32 s60, 0
    s_cselect_b32 s82, s82, 0
    s_mov_b32 s78, 0
    buffer_load_dwordx2 v[230:231], v177, s[80:83], s78 offen sc1
    s_mov_b32 s78, 65536
    buffer_load_dwordx2 v[232:233], v177, s[80:83], s78 offen sc1
    s_mov_b32 s78, 262144
    buffer_load_dwordx2 v[234:235], v177, s[80:83], s78 offen sc1
    s_mov_b32 s78, 327680
    buffer_load_dwordx2 v[236:237], v177, s[80:83], s78 offen sc1
    s_setpc_b64 s[76:77]
SUB_w_issue_1:
    s_add_u32 s19, s41, s42
    s_mul_i32 s16, s44, 131072
    s_add_u32 s16, s16, s38
    s_add_u32 s44, s44, 1
    s_and_b32 s44, s44, 15
    s_add_u32 s42, s42, 8192
    s_cmp_eq_u32 s42, 131072
    s_cselect_b32 s42, 0, s42
    s_mov_b32 m0, s19
    s_mov_b32 s39, s16
    buffer_load_dwordx4 v238, s[12:15], s39 offen lds
    s_add_u32 m0, m0, 1024
    s_add_u32 s39, s39, 16384
    buffer_load_dwordx4 v238, s[12:15], s39 offen lds
    s_add_u32 m0, m0, 1024
    s_add_u32 s39, s39, 16384
    buffer_load_dwordx4 v238, s[12:15], s39 offen lds
    s_add_u32 m0, m0, 1024
    s_add_u32 s39, s39, 16384
    buffer_load_dwordx4 v238, s[12:15], s39 offen lds
    s_setpc_b64 s[76:77]
PREP_a_issue_4:
    s_add_u32 s19, s41, s42
    v_readlane_b32 s16, v249, s44
    v_readlane_b32 s17, v250, s44
    s_add_u32 s16, s16, s38
    s_add_u32 s17, s17, s38
    s_add_u32 s44, s44, 1
    s_add_u32 s42, s42, 16384
    s_cmp_eq_u32 s42, 49152
    s_cselect_b32 s42, 0, s42
    s_setpc_b64 s[76:77]
PREP_w_issue_4:
    s_mov_b32 s45, 8192
    s_add_u32 s19, s41, s42
    v_readlane_b32 s16, v249, s44
    s_nop 0
    s_bitcmp1_b32 s16, 0
    s_cselect_b32 s17, 16384, s45
    s_cselect_b32 s18, -40960, s45
    s_andn2_b32 s16, s16, 1
    s_add_u32 s16, s16, s38
    s_add_u32 s44, s44, 1
    s_add_u32 s42, s42, 16384
    s_cmp_eq_u32 s42, 98304
    s_cselect_b32 s42, 0, s42
    s_setpc_b64 s[76:77]
K_end:
    s_endpgm
.p2align 6
K_tab:
.short 4096,5137,6178,11379,18660,25941,33222,40503,47784,55065,12426,19707,26988,34269,41550,48831,56096,9264,10448,20736,23824,25008,35296,38384,39568,49856,52944,54128,0,0,0,0
.short 4096,5137,6178,11379,18660,25941,33222,40503,47784,55065,12426,19707,26988,34269,41550,48831,56096,9264,10448,20736,23824,25008,35296,38384,39568,49856,52944,54128,0,0,0,0
.short 4096,5137,6178,11379,18660,25941,33222,40503,47784,55065,12426,19707,26988,34269,41550,48831,56096,9264,10448,20736,23824,25008,35296,38384,39568,49856,52944,54128,0,0,0,0
.short 4096,5137,6178,11379,18660,25941,33222,40503,47784,55065,12426,19707,26988,34269,41550,48831,56096,9264,10448,20736,23824,25008,35296,38384,39568,49856,52944,54128,0,0,0,0
.short 11377,12418,13459,18660,25941,33222,40503,47784,55065,4106,19707,26988,34269,41550,48831,56096,5136,16544,17728,28016,31104,32288,42576,45664,46848,57136,2880,3168,0,0,0,0
.short 11377,12418,13459,18660,25941,33222,40503,47784,55065,4106,19707,26988,34269,41550,48831,56096,5136,16544,17728,28016,31104,32288,42576,45664,46848,57136,2880,3168,0,0,0,0
.short 11377,12418,13459,18660,25941,33222,40503,47784,55065,4106,19707,26988,34269,41550,48831,56096,5136,16544,17728,28016,31104,32288,42576,45664,46848,57136,2880,3168,0,0,0,0
.short 11377,12418,13459,18660,25941,33222,40503,47784,55065,4106,19707,26988,34269,41550,48831,56096,5136,16544,17728,28016,31104,32288,42576,45664,46848,57136,2880,3168,0,0,0,0
.short 18658,19699,20740,25941,33222,40503,47784,55065,4106,11387,26988,34269,41550,48831,56096,5137,12416,23824,25008,35296,38384,39568,49856,52944,54128,6176,9264,10448,0,0,0,0
.short 18658,19699,20740,25941,33222,40503,47784,55065,4106,11387,26988,34269,41550,48831,56096,5137,12416,23824,25008,35296,38384,39568,49856,52944,54128,6176,9264,10448,0,0,0,0
.short 18658,19699,20740,25941,33222,40503,47784,55065,4106,11387,26988,34269,41550,48831,56096,5137,12416,23824,25008,35296,38384,39568,49856,52944,54128,6176,9264,10448,0,0,0,0
.short 18658,19699,20740,25941,33222,40503,47784,55065,4106,11387,26988,34269,41550,48831,56096,5137,12416,23824,25008,35296,38384,39568,49856,52944,54128,6176,9264,10448,0,0,0,0
.short 25939,26980,28021,33222,40503,47784,55065,4106,11387,18668,34269,41550,48831,56096,5137,12418,19696,31104,32288,42576,45664,46848,57136,2880,3168,13456,16544,17728,0,0,0,0
.short 25939,26980,28021,33222,40503,47784,55065,4106,11387,18668,34269,41550,48831,56096,5137,12418,19696,31104,32288,42576,45664,46848,57136,2880,3168,13456,16544,17728,0,0,0,0
.short 25939,26980,28021,33222,40503,47784,55065,4106,11387,18668,34269,41550,48831,56096,5137,12418,19696,31104,32288,42576,45664,46848,57136,2880,3168,13456,16544,17728,0,0,0,0
.short 25939,26980,28021,33222,40503,47784,55065,4106,11387,18668,34269,41550,48831,56096,5137,12418,19696,31104,32288,42576,45664,46848,57136,2880,3168,13456,16544,17728,0,0,0,0
.short 33220,34261,35302,40503,47784,55065,4106,11387,18668,25949,41550,48831,56096,5137,12418,19699,26976,38384,39568,49856,52944,54128,6176,9264,10448,20736,23824,25008,0,0,0,0
.short 33220,34261,35302,40503,47784,55065,4106,11387,18668,25949,41550,48831,56096,5137,12418,19699,26976,38384,39568,49856,52944,54128,6176,9264,10448,20736,23824,25008,0,0,0,0
.short 33220,34261,35302,40503,47784,55065,4106,11387,18668,25949,41550,48831,56096,5137,12418,19699,26976,38384,39568,49856,52944,54128,6176,9264,10448,20736,23824,25008,0,0,0,0
.short 33220,34261,35302,40503,47784,55065,4106,11387,18668,25949,41550,48831,56096,5137,12418,19699,26976,38384,39568,49856,52944,54128,6176,9264,10448,20736,23824,25008,0,0,0,0
.short 40501,41542,42583,47784,55065,4106,11387,18668,25949,33230,48831,56096,5137,12418,19699,26980,34256,45664,46848,57136,2880,3168,13456,16544,17728,28016,31104,32288,0,0,0,0
.short 40501,41542,42583,47784,55065,4106,11387,18668,25949,33230,48831,56096,5137,12418,19699,26980,34256,45664,46848,57136,2880,3168,13456,16544,17728,28016,31104,32288,0,0,0,0
.short 40501,41542,42583,47784,55065,4106,11387,18668,25949,33230,48831,56096,5137,12418,19699,26980,34256,45664,46848,57136,2880,3168,13456,16544,17728,28016,31104,32288,0,0,0,0
.short 40501,41542,42583,47784,55065,4106,11387,18668,25949,33230,48831,56096,5137,12418,19699,26980,34256,45664,46848,57136,2880,3168,13456,16544,17728,28016,31104,32288,0,0,0,0
.short 47782,48823,49864,55065,4106,11387,18668,25949,33230,40511,56096,5137,12418,19699,26980,34261,41536,52944,54128,6176,9264,10448,20736,23824,25008,35296,38384,39568,0,0,0,0
.short 47782,48823,49864,55065,4106,11387,18668,25949,33230,40511,56096,5137,12418,19699,26980,34261,41536,52944,54128,6176,9264,10448,20736,23824,25008,35296,38384,39568,0,0,0,0
.short 47782,48823,49864,55065,4106,11387,18668,25949,33230,40511,56096,5137,12418,19699,26980,34261,41536,52944,54128,6176,9264,10448,20736,23824,25008,35296,38384,39568,0,0,0,0
.short 47782,48823,49864,55065,4106,11387,18668,25949,33230,40511,56096,5137,12418,19699,26980,34261,41536,52944,54128,6176,9264,10448,20736,23824,25008,35296,38384,39568,0,0,0,0
.short 55063,56104,57145,4106,11387,18668,25949,33230,40511,47776,5137,12418,19699,26980,34261,41542,48816,2880,3168,13456,16544,17728,28016,31104,32288,42576,45664,46848,0,0,0,0
.short 55063,56104,57145,4106,11387,18668,25949,33230,40511,47776,5137,12418,19699,26980,34261,41542,48816,2880,3168,13456,16544,17728,28016,31104,32288,42576,45664,46848,0,0,0,0
.short 55063,56104,57145,4106,11387,18668,25949,33230,40511,47776,5137,12418,19699,26980,34261,41542,48816,2880,3168,13456,16544,17728,28016,31104,32288,42576,45664,46848,0,0,0,0
.short 55063,56104,57145,4106,11387,18668,25949,33230,40511,47776,5137,12418,19699,26980,34261,41542,48816,2880,3168,13456,16544,17728,28016,31104,32288,42576,45664,46848,0,0,0,0
.short 4104,5145,6186,11387,18668,25949,33230,40511,47776,55057,12418,19699,26980,34261,41542,48823,56096,9264,10448,20736,23824,25008,35296,38384,39568,49856,52944,54128,0,0,0,0
.short 4104,5145,6186,11387,18668,25949,33230,40511,47776,55057,12418,19699,26980,34261,41542,48823,56096,9264,10448,20736,23824,25008,35296,38384,39568,49856,52944,54128,0,0,0,0
.short 4104,5145,6186,11387,18668,25949,33230,40511,47776,55057,12418,19699,26980,34261,41542,48823,56096,9264,10448,20736,23824,25008,35296,38384,39568,49856,52944,54128,0,0,0,0
.short 4104,5145,6186,11387,18668,25949,33230,40511,47776,55057,12418,19699,26980,34261,41542,48823,56096,9264,10448,20736,23824,25008,35296,38384,39568,49856,52944,54128,0,0,0,0
.short 11385,12426,13467,18668,25949,33230,40511,47776,55057,4098,19699,26980,34261,41542,48823,56104,5136,16544,17728,28016,31104,32288,42576,45664,46848,57136,2880,3168,0,0,0,0
.short 11385,12426,13467,18668,25949,33230,40511,47776,55057,4098,19699,26980,34261,41542,48823,56104,5136,16544,17728,28016,31104,32288,42576,45664,46848,57136,2880,3168,0,0,0,0
.short 11385,12426,13467,18668,25949,33230,40511,47776,55057,4098,19699,26980,34261,41542,48823,56104,5136,16544,17728,28016,31104,32288,42576,45664,46848,57136,2880,3168,0,0,0,0
.short 11385,12426,13467,18668,25949,33230,40511,47776,55057,4098,19699,26980,34261,41542,48823,56104,5136,16544,17728,28016,31104,32288,42576,45664,46848,57136,2880,3168,0,0,0,0
.short 18666,19707,20748,25949,33230,40511,47776,55057,4098,11379,26980,34261,41542,48823,56104,5145,12416,23824,25008,35296,38384,39568,49856,52944,54128,6176,9264,10448,0,0,0,0
.short 18666,19707,20748,25949,33230,40511,47776,55057,4098,11379,26980,34261,41542,48823,56104,5145,12416,23824,25008,35296,38384,39568,49856,52944,54128,6176,9264,10448,0,0,0,0
.short 18666,19707,20748,25949,33230,40511,47776,55057,4098,11379,26980,34261,41542,48823,56104,5145,12416,23824,25008,35296,38384,39568,49856,52944,54128,6176,9264,10448,0,0,0,0
.short 18666,19707,20748,25949,33230,40511,47776,55057,4098,11379,26980,34261,41542,48823,56104,5145,12416,23824,25008,35296,38384,39568,49856,52944,54128,6176,9264,10448,0,0,0,0
.short 25947,26988,28029,33230,40511,47776,55057,4098,11379,18660,34261,41542,48823,56104,5145,12426,19696,31104,32288,42576,45664,46848,57136,2880,3168,13456,16544,17728,0,0,0,0
.short 25947,26988,28029,33230,40511,47776,55057,4098,11379,18660,34261,41542,48823,56104,5145,12426,19696,31104,32288,42576,45664,46848,57136,2880,3168,13456,16544,17728,0,0,0,0
.short 25947,26988,28029,33230,40511,47776,55057,4098,11379,18660,34261,41542,48823,56104,5145,12426,19696,31104,32288,42576,45664,46848,57136,2880,3168,13456,16544,17728,0,0,0,0
.short 25947,26988,28029,33230,40511,47776,55057,4098,11379,18660,34261,41542,48823,56104,5145,12426,19696,31104,32288,42576,45664,46848,57136,2880,3168,13456,16544,17728,0,0,0,0
.short 33228,34269,35310,40511,47776,55057,4098,11379,18660,25941,41542,48823,56104,5145,12426,19707,26976,38384,39568,49856,52944,54128,6176,9264,10448,20736,23824,25008,0,0,0,0
.short 33228,34269,35310,40511,47776,55057,4098,11379,18660,25941,41542,48823,56104,5145,12426,19707,26976,38384,39568,49856,52944,54128,6176,9264,10448,20736,23824,25008,0,0,0,0
.short 33228,34269,35310,40511,47776,55057,4098,11379,18660,25941,41542,48823,56104,5145,12426,19707,26976,38384,39568,49856,52944,54128,6176,9264,10448,20736,23824,25008,0,0,0,0
.short 33228,34269,35310,40511,47776,55057,4098,11379,18660,25941,41542,48823,56104,5145,12426,19707,26976,38384,39568,49856,52944,54128,6176,9264,10448,20736,23824,25008,0,0,0,0
.short 40509,41550,42591,47776,55057,4098,11379,18660,25941,33222,48823,56104,5145,12426,19707,26988,34256,45664,46848,57136,2880,3168,13456,16544,17728,28016,31104,32288,0,0,0,0
.short 40509,41550,42591,47776,55057,4098,11379,18660,25941,33222,48823,56104,5145,12426,19707,26988,34256,45664,46848,57136,2880,3168,13456,16544,17728,28016,31104,32288,0,0,0,0
.short 40509,41550,42591,47776,55057,4098,11379,18660,25941,33222,48823,56104,5145,12426,19707,26988,34256,45664,46848,57136,2880,3168,13456,16544,17728,28016,31104,32288,0,0,0,0
.short 40509,41550,42591,47776,55057,4098,11379,18660,25941,33222,48823,56104,5145,12426,19707,26988,34256,45664,46848,57136,2880,3168,13456,16544,17728,28016,31104,32288,0,0,0,0
.short 47790,48831,49856,55057,4098,11379,18660,25941,33222,40503,56104,5145,12426,19707,26988,34269,41536,52944,54128,6176,9264,10448,20736,23824,25008,35296,38384,39568,0,0,0,0
.short 47790,48831,49856,55057,4098,11379,18660,25941,33222,40503,56104,5145,12426,19707,26988,34269,41536,52944,54128,6176,9264,10448,20736,23824,25008,35296,38384,39568,0,0,0,0
.short 47790,48831,49856,55057,4098,11379,18660,25941,33222,40503,56104,5145,12426,19707,26988,34269,41536,52944,54128,6176,9264,10448,20736,23824,25008,35296,38384,39568,0,0,0,0
.short 47790,48831,49856,55057,4098,11379,18660,25941,33222,40503,56104,5145,12426,19707,26988,34269,41536,52944,54128,6176,9264,10448,20736,23824,25008,35296,38384,39568,0,0,0,0
.short 55071,56096,57137,4098,11379,18660,25941,33222,40503,47784,5145,12426,19707,26988,34269,41550,48816,2880,3168,13456,16544,17728,28016,31104,32288,42576,45664,46848,0,0,0,0
.short 55071,56096,57137,4098,11379,18660,25941,33222,40503,47784,5145,12426,19707,26988,34269,41550,48816,2880,3168,13456,16544,17728,28016,31104,32288,42576,45664,46848,0,0,0,0
.short 55071,56096,57137,4098,11379,18660,25941,33222,40503,47784,5145,12426,19707,26988,34269,41550,48816,2880,3168,13456,16544,17728,28016,31104,32288,42576,45664,46848,0,0,0,0
.short 55071,56096,57137,4098,11379,18660,25941,33222,40503,47784,5145,12426,19707,26988,34269,41550,48816,2880,3168,13456,16544,17728,28016,31104,32288,42576,45664,46848,0,0,0,0
.section .rodata,"a"
.p2align 6
.amdhsa_kernel interleave_layers__ssm_conv_h3__mixer_s_mlp__prompt_kernel
  .amdhsa_next_free_vgpr 256
  .amdhsa_next_free_sgpr 102
  .amdhsa_accum_offset 256
  .amdhsa_group_segment_fixed_size 0
  .amdhsa_kernarg_size 112
  .amdhsa_user_sgpr_count 2
  .amdhsa_user_sgpr_kernarg_segment_ptr 1
  .amdhsa_system_sgpr_workgroup_id_x 1
  .amdhsa_float_denorm_mode_32 3
.end_amdhsa_kernel
```

```asm
; @launch grid=(256,1,1) block=(512,1,1) lds=163840
.amdgcn_target "amdgcn-amd-amdhsa--gfx950"
.text
.globl interleave_layers__ssm_conv_h3__mixer_s_mlp__prompt_kernel
.p2align 8
.type interleave_layers__ssm_conv_h3__mixer_s_mlp__prompt_kernel,@function
interleave_layers__ssm_conv_h3__mixer_s_mlp__prompt_kernel:
    s_cmp_ge_u32 s2, 256
    s_cbranch_scc1 K_end
    s_load_dwordx8 s[8:15], s[0:1], 8
    s_load_dwordx2 s[6:7], s[0:1], 0
    s_load_dwordx8 s[68:75], s[0:1], 56
    s_load_dwordx2 s[4:5], s[0:1], 104
    s_load_dwordx2 s[84:85], s[0:1], 96
    s_memrealtime s[46:47]
    s_load_dwordx2 s[96:97], s[0:1], 40
    v_lshrrev_b32 v1, 6, v0
    s_nop 0
    v_readfirstlane_b32 s30, v1
    s_getpc_b64 s[48:49]
K_pc:
    s_lshr_b32 s36, s2, 3
    s_lshl_b32 s36, s36, 11
    v_lshlrev_b32 v4, 2, v0
    v_add_u32 v4, s36, v4
    v_cmp_gt_u32 vcc, K_end-K_pc-8, v4
    s_nop 0
    s_and_saveexec_b64 s[36:37], vcc
    s_cbranch_execz K_3
    v_mov_b32 v5, s49
    v_add_co_u32 v4, vcc, s48, v4
    s_nop 1
    v_addc_co_u32 v5, vcc, 0, v5, vcc
    global_load_dword v250, v[4:5], off
K_3:
    s_mov_b64 exec, -1
    v_and_b32 v6, 31, v0
    v_lshrrev_b32 v7, 5, v0
    s_and_b32 s34, s2, 7
    s_lshr_b32 s35, s2, 3
    s_lshl_b32 s36, s35, 17
    s_lshl_b32 s37, s34, 8
    s_add_u32 s36, s36, s37
    v_lshlrev_b32 v8, 13, v7
    v_lshl_add_u32 v8, v6, 3, v8
    v_add_u32 v12, s36, v8
    v_add_u32 v14, 4096, v12
    s_mov_b32 s18, 4194304
    s_mov_b32 s19, 0x20000
    s_mov_b32 s22, s18
    s_mov_b32 s23, s19
    s_waitcnt lgkmcnt(0)
    s_mov_b32 s86, 256
    s_mov_b32 s87, 0x20000
    v_mov_b32 v78, 0
    s_lshl_b32 s45, s2, 3
    s_add_u32 s45, s45, s30
    s_cmp_lg_u32 s45, 4
    s_cbranch_scc1 KV_t0
    s_lshl_b32 s44, s46, 6
    s_or_b32 s44, s44, 1
    v_mov_b32 v76, s44
    s_mov_b64 exec, 1
    buffer_store_dword v76, v78, s[84:87], 0 offen sc1
    s_mov_b64 exec, -1
KV_t0:
    s_mov_b64 s[16:17], s[8:9]
    s_mov_b64 s[20:21], s[10:11]
    buffer_load_dwordx2 v[28:29], v12, s[16:19], 0 offen offset:0 nt
    buffer_load_dwordx2 v[30:31], v12, s[16:19], 0 offen offset:2048 nt
    buffer_load_dwordx2 v[32:33], v14, s[16:19], 0 offen offset:0 nt
    buffer_load_dwordx2 v[34:35], v14, s[16:19], 0 offen offset:2048 nt
    buffer_load_dwordx2 v[36:37], v12, s[20:23], 0 offen offset:0 nt
    buffer_load_dwordx2 v[38:39], v12, s[20:23], 0 offen offset:2048 nt
    buffer_load_dwordx2 v[40:41], v14, s[20:23], 0 offen offset:0 nt
    buffer_load_dwordx2 v[42:43], v14, s[20:23], 0 offen offset:2048 nt
    v_subrev_u32 v9, 6144, v12
    v_subrev_u32 v10, 4096, v12
    v_subrev_u32 v11, 2048, v12
    s_lshl_b32 s37, s34, 10
    v_lshlrev_b32 v16, 5, v6
    v_add_u32 v16, s37, v16
    s_mov_b32 s24, s12
    s_mov_b32 s25, s13
    s_mov_b32 s26, 0x2000
    s_mov_b32 s27, 0x20000
    buffer_load_dwordx4 v[44:47], v16, s[24:27], 0 offen offset:0
    buffer_load_dwordx4 v[48:51], v16, s[24:27], 0 offen offset:16
    s_cmp_lg_u32 s30, 4
    s_cbranch_scc1 KV_t2
    buffer_load_dword v76, v78, s[84:87], 0 offen sc1
KV_t2:
    buffer_load_dwordx2 v[22:23], v9, s[16:19], 0 offen nt
    buffer_load_dwordx2 v[24:25], v10, s[16:19], 0 offen nt
    buffer_load_dwordx2 v[26:27], v11, s[16:19], 0 offen nt
    v_and_b32 v1, 63, v0
    v_lshlrev_b32 v2, 4, v1
    v_lshlrev_b32 v3, 2, v1
    s_and_b32 s32, s2, 7
    s_lshr_b32 s33, s2, 3
    s_and_b32 s28, s32, 2
    s_lshr_b32 s34, s32, 2
    s_or_b32 s28, s28, s34
    s_lshl_b32 s28, s28, 2
    s_and_b32 s34, s33, 3
    s_add_u32 s28, s28, s34
    s_and_b32 s31, s32, 1
    s_lshr_b32 s33, s33, 2
    s_lshl_b32 s29, s31, 3
    s_add_u32 s29, s29, s33
    s_lshl_b32 s67, s33, 1
    s_and_b32 s67, s67, 0
    s_mov_b32 s60, 0
    s_mov_b32 s61, 40000
    s_mov_b32 s52, 0
    s_mov_b32 s55, 0
    s_mov_b32 s92, 0
    s_mov_b32 s93, 0
    s_mov_b32 s94, 0
    s_mov_b32 s56, s4
    s_mov_b32 s57, s5
    s_mov_b32 s58, 0xa000000
    s_mov_b32 s59, 0x20000
    v_and_b32 v199, 7, v0
    v_lshrrev_b32 v236, 6, v0
    v_lshlrev_b32 v236, 4, v236
    v_bfe_u32 v237, v0, 3, 3
    v_add_u32 v236, v236, v237
    s_lshr_b32 s78, s29, 1
    s_lshl_b32 s78, s78, 16
    s_and_b32 s79, s29, 1
    s_lshl_b32 s79, s79, 7
    s_add_u32 s78, s78, s79
    s_lshr_b32 s79, s30, 1
    s_lshl_b32 s79, s79, 13
    s_add_u32 s78, s78, s79
    v_lshlrev_b32 v196, 8, v236
    v_lshl_add_u32 v196, v199, 4, v196
    v_add_u32 v196, s78, v196
    s_lshl_b32 s78, s28, 7
    s_lshl_b32 s79, s29, 3
    s_add_u32 s78, s78, s79
    v_add_u32 v197, s78, v199
    v_lshlrev_b32 v198, 11, v197
    v_lshrrev_b32 v237, 2, v236
    v_lshlrev_b32 v237, 3, v237
    v_and_b32 v236, 3, v236
    v_add_u32 v236, v236, v237
    v_lshl_add_u32 v198, v236, 3, v198
    v_lshlrev_b32 v197, 3, v197
    v_lshl_add_u32 v197, v236, 14, v197
    s_add_u32 s62, s4, 33554432
    s_addc_u32 s63, s5, 0
    s_and_b32 s41, s30, 3
    s_and_b32 s38, s2, 7
    s_lshl_b32 s38, s38, 5
    s_lshr_b32 s39, s2, 3
    s_add_u32 s38, s38, s39
    s_lshl_b32 s39, s38, 2
    s_add_u32 s39, s39, s41
    s_mul_i32 s40, s41, 24576
    s_lshr_b32 s36, s39, 1
    s_lshl_b32 s36, s36, 2
    s_load_dword s98, s[96:97], s36
    s_lshl_b32 s36, s39, 12
    s_add_u32 s12, s14, s36
    s_addc_u32 s13, s15, 0
    s_mov_b32 s14, 4096
    s_mov_b32 s15, 0x20000
    s_lshr_b32 s45, s30, 2
    s_lshl_b32 s45, s45, 11
    s_add_u32 s36, s45, 0xffffffc0
    v_add_u32 v70, s36, v2
    v_add_u32 v71, 16, v70
    s_add_u32 s36, s45, 0x3c0
    v_add_u32 v72, s36, v2
    v_add_u32 v73, 16, v72
    s_mov_b32 s36, 4032
    v_add_u32 v74, s36, v2
    v_add_u32 v75, 16, v74
    s_and_b32 s34, s2, 7
    s_lshr_b32 s35, s2, 3
    v_mov_b32 v80, 0
    v_mov_b32 v81, 0
    v_mov_b32 v82, 0
    v_mov_b32 v83, 0
    v_add_u32 v86, s40, v2
    ds_write_b128 v86, v[80:83] offset:22784
    s_bfm_b64 exec, 26, 0
    ds_write_b128 v86, v[80:83] offset:23808
    s_mov_b64 exec, -1
    v_lshlrev_b32 v8, 2, v7
    v_sub_u32 v8, 60, v8
    v_lshrrev_b32 v85, 3, v8
    v_bfe_u32 v84, v6, 1, 3
    v_xor_b32 v85, v85, v84
    v_lshlrev_b32 v85, 4, v85
    v_and_b32 v8, 7, v8
    v_lshl_add_u32 v85, v8, 1, v85
    v_lshl_add_u32 v84, v6, 9, v85
    v_add_u32 v84, 98304, v84
    s_waitcnt vmcnt(0)
    s_cmp_lg_u32 s30, 4
    s_cbranch_scc1 KV_t1
KV_t1:
    buffer_load_dwordx4 v[52:55], v70, s[12:15], 0 offen nt
    buffer_load_dwordx2 v[56:57], v71, s[12:15], 0 offen nt
    buffer_load_dwordx4 v[58:61], v72, s[12:15], 0 offen nt
    buffer_load_dwordx2 v[62:63], v73, s[12:15], 0 offen nt
    buffer_load_dwordx4 v[64:67], v74, s[12:15], 0 offen nt
    buffer_load_dwordx2 v[68:69], v75, s[12:15], 0 offen nt
    v_lshlrev_b32 v88, 16, v44
    v_and_b32 v90, 0xffff0000, v44
    v_lshlrev_b32 v92, 16, v45
    v_and_b32 v94, 0xffff0000, v45
    v_lshlrev_b32 v89, 16, v46
    v_and_b32 v91, 0xffff0000, v46
    v_lshlrev_b32 v93, 16, v47
    v_and_b32 v95, 0xffff0000, v47
    v_lshlrev_b32 v96, 16, v22
    v_and_b32 v97, 0xffff0000, v22
    v_lshlrev_b32 v98, 16, v24
    v_and_b32 v99, 0xffff0000, v24
    v_lshlrev_b32 v100, 16, v26
    v_and_b32 v101, 0xffff0000, v26
    v_lshlrev_b32 v102, 16, v28
    v_and_b32 v103, 0xffff0000, v28
    v_lshlrev_b32 v104, 16, v30
    v_and_b32 v105, 0xffff0000, v30
    v_lshlrev_b32 v106, 16, v32
    v_and_b32 v107, 0xffff0000, v32
    v_lshlrev_b32 v108, 16, v34
    v_and_b32 v109, 0xffff0000, v34
    v_lshlrev_b32 v110, 16, v36
    v_and_b32 v111, 0xffff0000, v36
    v_lshlrev_b32 v112, 16, v38
    v_and_b32 v113, 0xffff0000, v38
    v_lshlrev_b32 v114, 16, v40
    v_and_b32 v115, 0xffff0000, v40
    v_lshlrev_b32 v116, 16, v42
    v_and_b32 v117, 0xffff0000, v42
    v_pk_mul_f32 v[118:119], v[96:97], v[94:95]
    v_pk_mul_f32 v[120:121], v[98:99], v[94:95]
    v_pk_mul_f32 v[122:123], v[100:101], v[94:95]
    v_pk_mul_f32 v[124:125], v[102:103], v[94:95]
    v_pk_fma_f32 v[118:119], v[98:99], v[92:93], v[118:119]
    v_pk_fma_f32 v[120:121], v[100:101], v[92:93], v[120:121]
    v_pk_fma_f32 v[122:123], v[102:103], v[92:93], v[122:123]
    v_pk_fma_f32 v[124:125], v[104:105], v[92:93], v[124:125]
    v_pk_fma_f32 v[118:119], v[100:101], v[90:91], v[118:119]
    v_pk_fma_f32 v[120:121], v[102:103], v[90:91], v[120:121]
    v_pk_fma_f32 v[122:123], v[104:105], v[90:91], v[122:123]
    v_pk_fma_f32 v[124:125], v[106:107], v[90:91], v[124:125]
    v_pk_fma_f32 v[118:119], v[102:103], v[88:89], v[118:119]
    v_pk_fma_f32 v[120:121], v[104:105], v[88:89], v[120:121]
    v_pk_fma_f32 v[122:123], v[106:107], v[88:89], v[122:123]
    v_pk_fma_f32 v[124:125], v[108:109], v[88:89], v[124:125]
    v_pk_mul_f32 v[118:119], v[118:119], v[110:111]
    v_pk_mul_f32 v[120:121], v[120:121], v[112:113]
    v_pk_mul_f32 v[122:123], v[122:123], v[114:115]
    v_pk_mul_f32 v[124:125], v[124:125], v[116:117]
    v_cvt_pk_bf16_f32 v136, v124, v122
    v_cvt_pk_bf16_f32 v137, v120, v118
    ds_write_b64 v84, v[136:137] offset:0
    v_cvt_pk_bf16_f32 v138, v125, v123
    v_cvt_pk_bf16_f32 v139, v121, v119
    ds_write_b64 v84, v[138:139] offset:128
    v_lshlrev_b32 v88, 16, v48
    v_and_b32 v90, 0xffff0000, v48
    v_lshlrev_b32 v92, 16, v49
    v_and_b32 v94, 0xffff0000, v49
    v_lshlrev_b32 v89, 16, v50
    v_and_b32 v91, 0xffff0000, v50
    v_lshlrev_b32 v93, 16, v51
    v_and_b32 v95, 0xffff0000, v51
    v_lshlrev_b32 v96, 16, v23
    v_and_b32 v97, 0xffff0000, v23
    v_lshlrev_b32 v98, 16, v25
    v_and_b32 v99, 0xffff0000, v25
    v_lshlrev_b32 v100, 16, v27
    v_and_b32 v101, 0xffff0000, v27
    v_lshlrev_b32 v102, 16, v29
    v_and_b32 v103, 0xffff0000, v29
    v_lshlrev_b32 v104, 16, v31
    v_and_b32 v105, 0xffff0000, v31
    v_lshlrev_b32 v106, 16, v33
    v_and_b32 v107, 0xffff0000, v33
    v_lshlrev_b32 v108, 16, v35
    v_and_b32 v109, 0xffff0000, v35
    v_lshlrev_b32 v110, 16, v37
    v_and_b32 v111, 0xffff0000, v37
    v_lshlrev_b32 v112, 16, v39
    v_and_b32 v113, 0xffff0000, v39
    v_lshlrev_b32 v114, 16, v41
    v_and_b32 v115, 0xffff0000, v41
    v_lshlrev_b32 v116, 16, v43
    v_and_b32 v117, 0xffff0000, v43
    v_pk_mul_f32 v[118:119], v[96:97], v[94:95]
    v_pk_mul_f32 v[120:121], v[98:99], v[94:95]
    v_pk_mul_f32 v[122:123], v[100:101], v[94:95]
    v_pk_mul_f32 v[124:125], v[102:103], v[94:95]
    v_pk_fma_f32 v[118:119], v[98:99], v[92:93], v[118:119]
    v_pk_fma_f32 v[120:121], v[100:101], v[92:93], v[120:121]
    v_pk_fma_f32 v[122:123], v[102:103], v[92:93], v[122:123]
    v_pk_fma_f32 v[124:125], v[104:105], v[92:93], v[124:125]
    v_pk_fma_f32 v[118:119], v[100:101], v[90:91], v[118:119]
    v_pk_fma_f32 v[120:121], v[102:103], v[90:91], v[120:121]
    v_pk_fma_f32 v[122:123], v[104:105], v[90:91], v[122:123]
    v_pk_fma_f32 v[124:125], v[106:107], v[90:91], v[124:125]
    v_pk_fma_f32 v[118:119], v[102:103], v[88:89], v[118:119]
    v_pk_fma_f32 v[120:121], v[104:105], v[88:89], v[120:121]
    v_pk_fma_f32 v[122:123], v[106:107], v[88:89], v[122:123]
    v_pk_fma_f32 v[124:125], v[108:109], v[88:89], v[124:125]
    v_pk_mul_f32 v[118:119], v[118:119], v[110:111]
    v_pk_mul_f32 v[120:121], v[120:121], v[112:113]
    v_pk_mul_f32 v[122:123], v[122:123], v[114:115]
    v_pk_mul_f32 v[124:125], v[124:125], v[116:117]
    v_cvt_pk_bf16_f32 v140, v124, v122
    v_cvt_pk_bf16_f32 v141, v120, v118
    ds_write_b64 v84, v[140:141] offset:256
    v_cvt_pk_bf16_f32 v142, v125, v123
    v_cvt_pk_bf16_f32 v143, v121, v119
    ds_write_b64 v84, v[142:143] offset:384
    s_cmp_lg_u32 s30, 4
    s_cbranch_scc1 HB_2
    v_add_u32 v18, 162816, v3
    ds_write_b32 v18, v78
    s_mov_b32 s53, 0
    s_waitcnt vmcnt(6)
HB_p:
    v_readfirstlane_b32 s52, v76
    s_nop 0
    s_cmp_eq_u32 s52, 0
    s_cbranch_scc1 HB_r
    s_cmp_ge_u32 s53, 400
    s_cbranch_scc1 HB_q
    s_add_u32 s54, s46, 8192
    s_lshl_b32 s54, s54, 6
    s_sub_u32 s54, s54, s52
    s_cmp_lt_u32 s54, 786432
    s_cbranch_scc1 HB_q
HB_r:
    buffer_load_dword v76, v78, s[84:87], 0 offen sc1
    s_waitcnt vmcnt(0)
    s_add_u32 s53, s53, 1
    s_cmp_lt_u32 s53, s61
    s_cbranch_scc1 HB_p
    s_mov_b32 s52, 1
    s_mov_b32 s61, 0
HB_q:
    v_mov_b32 v18, 162828
    v_mov_b32 v19, s52
    s_waitcnt lgkmcnt(0)
    ds_write_b32 v18, v19
HB_2:
    s_add_u32 s16, s4, 0x2000000
    s_addc_u32 s17, s5, 0
    s_mov_b32 s18, 0x8000000
    s_mov_b32 s19, 0x20000
    v_lshrrev_b32 v8, 3, v0
    v_and_b32 v85, 7, v0
    v_lshlrev_b32 v149, 12, v8
    v_lshl_add_u32 v149, v85, 4, v149
    s_lshl_b32 s36, s34, 24
    s_sub_u32 s37, 31, s35
    s_lshl_b32 s37, s37, 7
    s_add_u32 s36, s36, s37
    s_add_u32 s37, s36, 262144
    v_lshrrev_b32 v148, 3, v8
    v_xor_b32 v148, v148, v85
    v_lshlrev_b32 v148, 4, v148
    v_lshl_add_u32 v148, v8, 7, v148
    v_add_u32 v148, 98304, v148
    v_mov_b32 v18, 162828
    s_waitcnt lgkmcnt(0)
    s_barrier
    ds_read_b128 v[152:155], v148 offset:0
    ds_read_b128 v[156:159], v148 offset:8192
    ds_read_b32 v19, v18
    s_waitcnt lgkmcnt(2)
    v_or_b32 v152, 1, v152
    buffer_store_dwordx4 v[152:155], v149, s[16:19], s36 offen sc1
    s_waitcnt lgkmcnt(1)
    v_or_b32 v156, 1, v156
    buffer_store_dwordx4 v[156:159], v149, s[16:19], s37 offen sc1
    s_waitcnt lgkmcnt(0)
    v_readfirstlane_b32 s52, v19
    s_cmp_lg_u32 s30, 0
    s_cbranch_scc1 KV_ni
    s_cmp_ge_u32 s35, 16
    s_cbranch_scc1 KV_ni
    v_mov_b32 v8, s52
    s_lshl_b32 s37, s34, 7
    s_lshl_b32 s53, s35, 10
    s_add_u32 s37, s37, s53
    s_add_u32 s37, s37, 23101440
    s_mov_b64 exec, 1
    buffer_store_dword v8, v78, s[56:59], s37 offen sc1
    s_mov_b64 exec, -1
KV_ni:
    s_cmp_ge_u32 s2, 255
    s_cbranch_scc1 KV_n3
    s_cmp_lg_u32 s30, 5
    s_cbranch_scc1 KV_n3
    s_and_b32 s42, s2, 31
    s_lshl_b32 s42, s42, 8
    s_lshr_b32 s43, s2, 5
    s_lshl_b32 s43, s43, 14
    s_add_u32 s42, s42, s43
    s_add_u32 s42, s42, 39714816
    v_and_b32 v8, 1, v1
    v_lshlrev_b32 v8, 13, v8
    v_lshrrev_b32 v85, 1, v1
    v_lshl_add_u32 v8, v85, 7, v8
    s_mov_b64 exec, 0xf
    buffer_store_dword v8, v8, s[56:59], s42 offen sc1
    s_mov_b64 exec, -1
KV_n3:
    s_lshl_b32 s36, s34, 5
    s_add_u32 s36, s36, s35
    s_lshl_b32 s36, s36, 7
    s_add_u32 s36, s36, 23068672
    v_mov_b32 v18, 1
    v_mov_b32 v19, 162820
    v_mov_b32 v21, 0
    s_mov_b64 exec, 1
    s_waitcnt vmcnt(0)
    ds_add_rtn_u32 v20, v19, v18
    v_mov_b32 v19, s52
    s_waitcnt lgkmcnt(0)
    v_readfirstlane_b32 s54, v20
    s_nop 0
    s_and_b32 s54, s54, 7
    s_cmp_lg_u32 s54, 7
    s_cbranch_scc1 pub_1
    buffer_store_dword v19, v21, s[56:59], s36 offen sc1
pub_1:
    s_mov_b64 exec, -1
    v_add_u32 v160, s45, v86
    v_alignbit_b32 v88, v53, v52, 16
    v_mov_b32 v92, v53
    v_alignbit_b32 v96, v54, v53, 16
    v_alignbit_b32 v89, v54, v53, 16
    v_mov_b32 v93, v54
    v_alignbit_b32 v97, v55, v54, 16
    v_alignbit_b32 v90, v55, v54, 16
    v_mov_b32 v94, v55
    v_alignbit_b32 v98, v56, v55, 16
    v_alignbit_b32 v91, v56, v55, 16
    v_mov_b32 v95, v56
    v_alignbit_b32 v99, v57, v56, 16
    ds_write_b128 v160, v[88:91] offset:0
    ds_write_b128 v160, v[92:95] offset:4160
    ds_write_b128 v160, v[96:99] offset:8320
    ds_write_b128 v160, v[54:57] offset:12480
    v_alignbit_b32 v100, v59, v58, 16
    v_mov_b32 v104, v59
    v_alignbit_b32 v108, v60, v59, 16
    v_alignbit_b32 v101, v60, v59, 16
    v_mov_b32 v105, v60
    v_alignbit_b32 v109, v61, v60, 16
    v_alignbit_b32 v102, v61, v60, 16
    v_mov_b32 v106, v61
    v_alignbit_b32 v110, v62, v61, 16
    v_alignbit_b32 v103, v62, v61, 16
    v_mov_b32 v107, v62
    v_alignbit_b32 v111, v63, v62, 16
    ds_write_b128 v160, v[100:103] offset:1024
    ds_write_b128 v160, v[104:107] offset:5184
    ds_write_b128 v160, v[108:111] offset:9344
    ds_write_b128 v160, v[60:63] offset:13504
    v_alignbit_b32 v112, v65, v64, 16
    v_mov_b32 v116, v65
    v_alignbit_b32 v120, v66, v65, 16
    v_alignbit_b32 v113, v66, v65, 16
    v_mov_b32 v117, v66
    v_alignbit_b32 v121, v67, v66, 16
    v_alignbit_b32 v114, v67, v66, 16
    v_mov_b32 v118, v67
    v_alignbit_b32 v122, v68, v67, 16
    v_alignbit_b32 v115, v68, v67, 16
    v_mov_b32 v119, v68
    v_alignbit_b32 v123, v69, v68, 16
    s_mov_b64 exec, 0xf
    ds_write_b128 v86, v[112:115] offset:4096
    ds_write_b128 v86, v[116:119] offset:8256
    ds_write_b128 v86, v[120:123] offset:12416
    ds_write_b128 v86, v[66:69] offset:16576
    s_mov_b64 exec, -1
    s_waitcnt lgkmcnt(0)
    s_barrier
    v_mov_b32 v238, 0
    v_mov_b32 v239, 0
    v_mov_b32 v240, 0
    v_mov_b32 v241, 0
    v_mov_b32 v242, 0
    v_mov_b32 v243, 0
    v_mov_b32 v244, 0
    v_mov_b32 v245, 0
    v_mov_b32 v246, 0
    v_mov_b32 v247, 0
    s_cmp_ge_u32 s30, 4
    s_cbranch_scc1 FR_b
    s_and_b32 s38, s2, 7
    s_lshl_b32 s38, s38, 5
    s_lshr_b32 s39, s2, 3
    s_add_u32 s38, s38, s39
    s_lshl_b32 s39, s38, 2
    s_add_u32 s39, s39, s30
    s_mul_i32 s40, s30, 24576
    s_and_b32 s36, s39, 127
    s_lshl_b32 s36, s36, 12
    s_lshr_b32 s37, s39, 7
    s_lshl_b32 s37, s37, 24
    s_add_u32 s36, s36, s37
    s_add_u32 s36, s36, 33554432
    s_add_u32 s16, s4, s36
    s_addc_u32 s17, s5, 0
    s_mov_b32 s18, 4096
    s_mov_b32 s19, 0x20000
    v_lshrrev_b32 v6, 2, v1
    v_mul_u32_u24 v12, 96, v6
    v_and_b32 v6, 3, v1
    v_lshl_add_u32 v12, v6, 4, v12
    v_add_u32 v12, s40, v12
    v_and_b32 v35, 15, v1
    v_lshrrev_b32 v36, 4, v1
    v_and_b32 v6, 3, v35
    v_mul_u32_u24 v32, 4160, v6
    v_lshl_add_u32 v32, v36, 4, v32
    v_lshrrev_b32 v6, 2, v35
    v_lshl_add_u32 v32, v6, 3, v32
    v_add_u32 v32, s40, v32
    v_sub_u32 v6, 15, v35
    v_mul_u32_u24 v34, 96, v6
    v_add_u32 v34, s40, v34
    v_lshl_add_u32 v33, v36, 4, v34
    ds_read_b64 v[72:73], v32 offset:0
    ds_read_b64 v[74:75], v32 offset:8
    ds_read_b64 v[76:77], v32 offset:32
    ds_read_b64 v[78:79], v32 offset:40
    ds_read_b64 v[80:81], v32 offset:1024
    ds_read_b64 v[82:83], v32 offset:1032
    ds_read_b64 v[84:85], v32 offset:1056
    ds_read_b64 v[86:87], v32 offset:1064
    ds_read_b64 v[88:89], v32 offset:2048
    ds_read_b64 v[90:91], v32 offset:2056
    ds_read_b64 v[92:93], v32 offset:2080
    ds_read_b64 v[94:95], v32 offset:2088
    ds_read_b64 v[96:97], v32 offset:3072
    ds_read_b64 v[98:99], v32 offset:3080
    ds_read_b64 v[100:101], v32 offset:3104
    ds_read_b64 v[102:103], v32 offset:3112
    s_bitcmp1_b32 s39, 0
    s_cselect_b32 s36, 0, 16
    s_lshl_b32 s41, s98, s36
    s_and_b32 s41, s41, 0xffff0000
    s_lshr_b32 s36, s41, 16
    v_lshl_add_u32 v6, v36, 3, v35
    v_sub_u32 v6, 31, v6
    v_mov_b32 v10, s36
    v_mov_b32 v11, s41
    v_and_b32 v8, 1, v6
    v_cmp_eq_u32 vcc, 1, v8
    s_nop 1
    v_cndmask_b32 v10, v10, v11, vcc
    v_ashrrev_i32 v6, 1, v6
    v_cmp_eq_u32 vcc, 0, v6
    s_nop 1
    v_cndmask_b32 v152, 0, v10, vcc
    v_cmp_eq_u32 vcc, 1, v6
    s_nop 1
    v_cndmask_b32 v153, 0, v10, vcc
    v_cmp_eq_u32 vcc, 2, v6
    s_nop 1
    v_cndmask_b32 v154, 0, v10, vcc
    v_cmp_eq_u32 vcc, 3, v6
    s_nop 1
    v_cndmask_b32 v155, 0, v10, vcc
    v_cmp_eq_u32 vcc, 8, v6
    s_nop 1
    v_cndmask_b32 v156, 0, v10, vcc
    v_cmp_eq_u32 vcc, 9, v6
    s_nop 1
    v_cndmask_b32 v157, 0, v10, vcc
    v_cmp_eq_u32 vcc, 10, v6
    s_nop 1
    v_cndmask_b32 v158, 0, v10, vcc
    v_cmp_eq_u32 vcc, 11, v6
    s_nop 1
    v_cndmask_b32 v159, 0, v10, vcc
    s_add_u32 s12, s4, 0x1c00000
    s_addc_u32 s13, s5, 0
    s_mov_b32 s14, 0x400000
    s_mov_b32 s15, 0x20000
    v_bfe_u32 v6, v1, 2, 2
    v_mul_u32_u24 v168, 24640, v6
    v_lshrrev_b32 v6, 1, v36
    v_mul_u32_u24 v6, 72, v6
    v_add_u32 v168, v168, v6
    v_and_b32 v6, 1, v36
    v_lshl_add_u32 v168, v6, 5, v168
    v_and_b32 v6, 3, v1
    v_lshl_add_u32 v168, v6, 3, v168
    s_mul_i32 s36, s30, 1152
    v_add_u32 v168, s36, v168
    v_lshlrev_b32 v169, 3, v1
    s_lshl_b32 s44, s38, 14
    s_lshl_b32 s37, s30, 12
    s_add_u32 s44, s44, s37
    s_mul_i32 s36, s30, 24640
    v_mul_u32_u24 v170, 72, v35
    v_lshl_add_u32 v170, v36, 3, v170
    v_add_u32 v170, s36, v170
    s_cmp_lg_u32 s30, 0
    s_cbranch_scc1 CV_w
    s_and_b32 s36, s2, 7
    s_lshl_b32 s36, s36, 12
    s_add_u32 s36, s36, 23068672
    v_lshlrev_b32 v9, 7, v1
    v_add_u32 v9, s36, v9
    s_mov_b32 s53, 0
    s_add_u32 s54, s52, 0
    s_bfm_b64 exec, 32, 0
poll_2:
    buffer_load_dword v8, v9, s[56:59], 0 offen sc1
    s_waitcnt vmcnt(0)
    v_xor_b32 v8, s54, v8
    v_cmp_eq_u32 vcc, 0, v8
    s_nop 0
    s_cmp_eq_u64 vcc, exec
    s_cbranch_scc1 pok_3
    s_sleep 5
    s_add_u32 s53, s53, 1
    s_cmp_lt_u32 s53, s61
    s_cbranch_scc1 poll_2
    s_mov_b32 s61, 0
pok_3:
    s_mov_b64 exec, -1
    v_mov_b32 v8, 162832
    v_mov_b32 v9, 1
    s_waitcnt lgkmcnt(0)
    ds_write_b32 v8, v9
CV_w:
    v_mov_b32 v8, 162832
spin_4:
    ds_read_b32 v9, v8
    s_waitcnt lgkmcnt(0)
    v_readfirstlane_b32 s53, v9
    s_nop 0
    s_cmp_ge_u32 s53, 1
    s_cbranch_scc0 spin_4
    buffer_load_dwordx4 v[16:19], v2, s[16:19], 0 offen offset:0 sc1
    buffer_load_dwordx4 v[20:23], v2, s[16:19], 0 offen offset:1024 sc1
    buffer_load_dwordx4 v[24:27], v2, s[16:19], 0 offen offset:2048 sc1
    buffer_load_dwordx4 v[28:31], v2, s[16:19], 0 offen offset:3072 sc1
    s_mov_b32 s8, s6
    s_mov_b32 s9, s7
    s_mov_b32 s10, 0x400000
    s_mov_b32 s11, 0x20000
    buffer_load_dwordx2 v[180:181], v198, s[8:11], 0 offen offset:0 nt
    buffer_load_dwordx2 v[182:183], v198, s[8:11], 0 offen offset:32 nt
    buffer_load_dwordx2 v[184:185], v198, s[8:11], 0 offen offset:128 nt
    buffer_load_dwordx2 v[186:187], v198, s[8:11], 0 offen offset:160 nt
    s_waitcnt vmcnt(7)
    ds_write_b128 v12, v[16:19] offset:16640
    s_waitcnt vmcnt(6)
    ds_write_b128 v12, v[20:23] offset:18176
    s_waitcnt vmcnt(5)
    ds_write_b128 v12, v[24:27] offset:19712
    s_waitcnt vmcnt(4)
    ds_write_b128 v12, v[28:31] offset:21248
    v_mov_b32 v8, 162836
    v_mov_b32 v9, 1
    s_mov_b64 exec, 1
    ds_add_u32 v8, v9
    s_mov_b64 exec, -1
    s_waitcnt lgkmcnt(0)
    ds_read_b128 v[136:139], v33 offset:21248
    ds_read_b128 v[140:143], v33 offset:19712
    ds_read_b128 v[144:147], v33 offset:18176
    ds_read_b128 v[148:151], v33 offset:16640
    s_waitcnt lgkmcnt(3)
    v_mfma_f32_16x16x32_bf16 v[40:43], v[152:155], v[136:139], 0
    v_mfma_f32_16x16x32_bf16 v[44:47], v[156:159], v[136:139], 0
    s_waitcnt lgkmcnt(2)
    v_mfma_f32_16x16x32_bf16 v[48:51], v[152:155], v[140:143], 0
    v_mfma_f32_16x16x32_bf16 v[52:55], v[156:159], v[140:143], 0
    s_waitcnt lgkmcnt(1)
    v_mfma_f32_16x16x32_bf16 v[56:59], v[152:155], v[144:147], 0
    v_mfma_f32_16x16x32_bf16 v[60:63], v[156:159], v[144:147], 0
    s_waitcnt lgkmcnt(0)
    v_mfma_f32_16x16x32_bf16 v[64:67], v[152:155], v[148:151], 0
    v_mfma_f32_16x16x32_bf16 v[68:71], v[156:159], v[148:151], 0
    s_mov_b32 s43, 0
CV_r:
    s_waitcnt lgkmcnt(0)
    v_mfma_f32_16x16x32_bf16 v[40:43], v[72:75], v[136:139], v[40:43]
    v_mfma_f32_16x16x32_bf16 v[48:51], v[72:75], v[140:143], v[48:51]
    v_mfma_f32_16x16x32_bf16 v[56:59], v[72:75], v[144:147], v[56:59]
    v_mfma_f32_16x16x32_bf16 v[64:67], v[72:75], v[148:151], v[64:67]
    v_mfma_f32_16x16x32_bf16 v[44:47], v[76:79], v[136:139], v[44:47]
    v_mfma_f32_16x16x32_bf16 v[52:55], v[76:79], v[140:143], v[52:55]
    v_mfma_f32_16x16x32_bf16 v[60:63], v[76:79], v[144:147], v[60:63]
    v_mfma_f32_16x16x32_bf16 v[68:71], v[76:79], v[148:151], v[68:71]
    v_mfma_f32_16x16x32_bf16 v[48:51], v[80:83], v[136:139], v[48:51]
    v_mfma_f32_16x16x32_bf16 v[56:59], v[80:83], v[140:143], v[56:59]
    v_mfma_f32_16x16x32_bf16 v[64:67], v[80:83], v[144:147], v[64:67]
    v_mfma_f32_16x16x32_bf16 v[52:55], v[84:87], v[136:139], v[52:55]
    v_mfma_f32_16x16x32_bf16 v[60:63], v[84:87], v[140:143], v[60:63]
    v_mfma_f32_16x16x32_bf16 v[68:71], v[84:87], v[144:147], v[68:71]
    v_mfma_f32_16x16x32_bf16 v[56:59], v[88:91], v[136:139], v[56:59]
    v_mfma_f32_16x16x32_bf16 v[64:67], v[88:91], v[140:143], v[64:67]
    v_mfma_f32_16x16x32_bf16 v[60:63], v[92:95], v[136:139], v[60:63]
    v_mfma_f32_16x16x32_bf16 v[68:71], v[92:95], v[140:143], v[68:71]
    v_mfma_f32_16x16x32_bf16 v[64:67], v[96:99], v[136:139], v[64:67]
    v_mfma_f32_16x16x32_bf16 v[68:71], v[100:103], v[136:139], v[68:71]
    ds_read_b128 v[152:155], v33 offset:21344
    ds_read_b128 v[156:159], v33 offset:19808
    ds_read_b128 v[160:163], v33 offset:18272
    ds_read_b128 v[164:167], v33 offset:16736
    ds_read_b64 v[104:105], v32 offset:64
    ds_read_b64 v[106:107], v32 offset:72
    ds_read_b64 v[108:109], v32 offset:96
    ds_read_b64 v[110:111], v32 offset:104
    ds_read_b64 v[112:113], v32 offset:1088
    ds_read_b64 v[114:115], v32 offset:1096
    ds_read_b64 v[116:117], v32 offset:1120
    ds_read_b64 v[118:119], v32 offset:1128
    ds_read_b64 v[120:121], v32 offset:2112
    ds_read_b64 v[122:123], v32 offset:2120
    ds_read_b64 v[124:125], v32 offset:2144
    ds_read_b64 v[126:127], v32 offset:2152
    ds_read_b64 v[128:129], v32 offset:3136
    ds_read_b64 v[130:131], v32 offset:3144
    ds_read_b64 v[132:133], v32 offset:3168
    ds_read_b64 v[134:135], v32 offset:3176
    s_waitcnt lgkmcnt(0)
    v_mfma_f32_16x16x32_bf16 v[40:43], v[104:107], v[152:155], v[40:43]
    v_mfma_f32_16x16x32_bf16 v[48:51], v[104:107], v[156:159], v[48:51]
    v_mfma_f32_16x16x32_bf16 v[56:59], v[104:107], v[160:163], v[56:59]
    v_mfma_f32_16x16x32_bf16 v[64:67], v[104:107], v[164:167], v[64:67]
    v_mfma_f32_16x16x32_bf16 v[44:47], v[108:111], v[152:155], v[44:47]
    v_mfma_f32_16x16x32_bf16 v[52:55], v[108:111], v[156:159], v[52:55]
    v_mfma_f32_16x16x32_bf16 v[60:63], v[108:111], v[160:163], v[60:63]
    v_mfma_f32_16x16x32_bf16 v[68:71], v[108:111], v[164:167], v[68:71]
    v_mfma_f32_16x16x32_bf16 v[48:51], v[112:115], v[152:155], v[48:51]
    v_mfma_f32_16x16x32_bf16 v[56:59], v[112:115], v[156:159], v[56:59]
    v_mfma_f32_16x16x32_bf16 v[64:67], v[112:115], v[160:163], v[64:67]
    v_mfma_f32_16x16x32_bf16 v[52:55], v[116:119], v[152:155], v[52:55]
    v_mfma_f32_16x16x32_bf16 v[60:63], v[116:119], v[156:159], v[60:63]
    v_mfma_f32_16x16x32_bf16 v[68:71], v[116:119], v[160:163], v[68:71]
    v_mfma_f32_16x16x32_bf16 v[56:59], v[120:123], v[152:155], v[56:59]
    v_mfma_f32_16x16x32_bf16 v[64:67], v[120:123], v[156:159], v[64:67]
    v_mfma_f32_16x16x32_bf16 v[60:63], v[124:127], v[152:155], v[60:63]
    v_mfma_f32_16x16x32_bf16 v[68:71], v[124:127], v[156:159], v[68:71]
    v_mfma_f32_16x16x32_bf16 v[64:67], v[128:131], v[152:155], v[64:67]
    v_mfma_f32_16x16x32_bf16 v[68:71], v[132:135], v[152:155], v[68:71]
    ds_read_b128 v[136:139], v33 offset:21440
    ds_read_b128 v[140:143], v33 offset:19904
    ds_read_b128 v[144:147], v33 offset:18368
    ds_read_b128 v[148:151], v33 offset:16832
    ds_read_b64 v[72:73], v32 offset:128
    ds_read_b64 v[74:75], v32 offset:136
    ds_read_b64 v[76:77], v32 offset:160
    ds_read_b64 v[78:79], v32 offset:168
    ds_read_b64 v[80:81], v32 offset:1152
    ds_read_b64 v[82:83], v32 offset:1160
    ds_read_b64 v[84:85], v32 offset:1184
    ds_read_b64 v[86:87], v32 offset:1192
    ds_read_b64 v[88:89], v32 offset:2176
    ds_read_b64 v[90:91], v32 offset:2184
    ds_read_b64 v[92:93], v32 offset:2208
    ds_read_b64 v[94:95], v32 offset:2216
    ds_read_b64 v[96:97], v32 offset:3200
    ds_read_b64 v[98:99], v32 offset:3208
    ds_read_b64 v[100:101], v32 offset:3232
    ds_read_b64 v[102:103], v32 offset:3240
    v_add_u32 v32, 128, v32
    v_add_u32 v33, 192, v33
    s_add_u32 s43, s43, 1
    s_cmp_lt_u32 s43, 3
    s_cbranch_scc1 CV_r
CV_l:
    s_waitcnt lgkmcnt(10)
    v_mfma_f32_16x16x32_bf16 v[40:43], v[72:75], v[136:139], v[40:43]
    ds_read_b128 v[152:155], v33 offset:21344
    v_mfma_f32_16x16x32_bf16 v[48:51], v[72:75], v[140:143], v[48:51]
    ds_read_b128 v[156:159], v33 offset:19808
    v_mfma_f32_16x16x32_bf16 v[56:59], v[72:75], v[144:147], v[56:59]
    ds_read_b128 v[160:163], v33 offset:18272
    v_mfma_f32_16x16x32_bf16 v[64:67], v[72:75], v[148:151], v[64:67]
    ds_read_b128 v[164:167], v33 offset:16736
    v_mfma_f32_16x16x32_bf16 v[44:47], v[76:79], v[136:139], v[44:47]
    ds_read_b64 v[104:105], v32 offset:64
    v_mfma_f32_16x16x32_bf16 v[52:55], v[76:79], v[140:143], v[52:55]
    ds_read_b64 v[106:107], v32 offset:72
    v_mfma_f32_16x16x32_bf16 v[60:63], v[76:79], v[144:147], v[60:63]
    ds_read_b64 v[108:109], v32 offset:96
    v_mfma_f32_16x16x32_bf16 v[68:71], v[76:79], v[148:151], v[68:71]
    ds_read_b64 v[110:111], v32 offset:104
    v_mfma_f32_16x16x32_bf16 v[48:51], v[80:83], v[136:139], v[48:51]
    ds_read_b64 v[112:113], v32 offset:1088
    v_mfma_f32_16x16x32_bf16 v[56:59], v[80:83], v[140:143], v[56:59]
    ds_read_b64 v[114:115], v32 offset:1096
    s_waitcnt lgkmcnt(10)
    v_mfma_f32_16x16x32_bf16 v[64:67], v[80:83], v[144:147], v[64:67]
    ds_read_b64 v[116:117], v32 offset:1120
    v_mfma_f32_16x16x32_bf16 v[52:55], v[84:87], v[136:139], v[52:55]
    ds_read_b64 v[118:119], v32 offset:1128
    v_mfma_f32_16x16x32_bf16 v[60:63], v[84:87], v[140:143], v[60:63]
    ds_read_b64 v[120:121], v32 offset:2112
    v_mfma_f32_16x16x32_bf16 v[68:71], v[84:87], v[144:147], v[68:71]
    ds_read_b64 v[122:123], v32 offset:2120
    v_mfma_f32_16x16x32_bf16 v[56:59], v[88:91], v[136:139], v[56:59]
    ds_read_b64 v[124:125], v32 offset:2144
    v_mfma_f32_16x16x32_bf16 v[64:67], v[88:91], v[140:143], v[64:67]
    ds_read_b64 v[126:127], v32 offset:2152
    v_mfma_f32_16x16x32_bf16 v[60:63], v[92:95], v[136:139], v[60:63]
    ds_read_b64 v[128:129], v32 offset:3136
    v_mfma_f32_16x16x32_bf16 v[68:71], v[92:95], v[140:143], v[68:71]
    ds_read_b64 v[130:131], v32 offset:3144
    v_mfma_f32_16x16x32_bf16 v[64:67], v[96:99], v[136:139], v[64:67]
    ds_read_b64 v[132:133], v32 offset:3168
    v_mfma_f32_16x16x32_bf16 v[68:71], v[100:103], v[136:139], v[68:71]
    ds_read_b64 v[134:135], v32 offset:3176
    s_waitcnt lgkmcnt(10)
    v_mfma_f32_16x16x32_bf16 v[40:43], v[104:107], v[152:155], v[40:43]
    ds_read_b128 v[136:139], v33 offset:21440
    v_mfma_f32_16x16x32_bf16 v[48:51], v[104:107], v[156:159], v[48:51]
    ds_read_b128 v[140:143], v33 offset:19904
    v_mfma_f32_16x16x32_bf16 v[56:59], v[104:107], v[160:163], v[56:59]
    ds_read_b128 v[144:147], v33 offset:18368
    v_mfma_f32_16x16x32_bf16 v[64:67], v[104:107], v[164:167], v[64:67]
    ds_read_b128 v[148:151], v33 offset:16832
    v_mfma_f32_16x16x32_bf16 v[44:47], v[108:111], v[152:155], v[44:47]
    ds_read_b64 v[72:73], v32 offset:128
    v_mfma_f32_16x16x32_bf16 v[52:55], v[108:111], v[156:159], v[52:55]
    ds_read_b64 v[74:75], v32 offset:136
    v_add_u32 v33, 192, v33
    v_mfma_f32_16x16x32_bf16 v[60:63], v[108:111], v[160:163], v[60:63]
    ds_read_b64 v[76:77], v32 offset:160
    s_add_u32 s43, s43, 1
    v_mfma_f32_16x16x32_bf16 v[68:71], v[108:111], v[164:167], v[68:71]
    ds_read_b64 v[78:79], v32 offset:168
    s_cmp_lt_u32 s43, 8
    v_mfma_f32_16x16x32_bf16 v[48:51], v[112:115], v[152:155], v[48:51]
    ds_read_b64 v[80:81], v32 offset:1152
    v_mfma_f32_16x16x32_bf16 v[56:59], v[112:115], v[156:159], v[56:59]
    ds_read_b64 v[82:83], v32 offset:1160
    s_waitcnt lgkmcnt(10)
    v_mfma_f32_16x16x32_bf16 v[64:67], v[112:115], v[160:163], v[64:67]
    ds_read_b64 v[84:85], v32 offset:1184
    v_mfma_f32_16x16x32_bf16 v[52:55], v[116:119], v[152:155], v[52:55]
    ds_read_b64 v[86:87], v32 offset:1192
    v_mfma_f32_16x16x32_bf16 v[60:63], v[116:119], v[156:159], v[60:63]
    ds_read_b64 v[88:89], v32 offset:2176
    v_mfma_f32_16x16x32_bf16 v[68:71], v[116:119], v[160:163], v[68:71]
    ds_read_b64 v[90:91], v32 offset:2184
    v_mfma_f32_16x16x32_bf16 v[56:59], v[120:123], v[152:155], v[56:59]
    ds_read_b64 v[92:93], v32 offset:2208
    v_mfma_f32_16x16x32_bf16 v[64:67], v[120:123], v[156:159], v[64:67]
    ds_read_b64 v[94:95], v32 offset:2216
    v_mfma_f32_16x16x32_bf16 v[60:63], v[124:127], v[152:155], v[60:63]
    ds_read_b64 v[96:97], v32 offset:3200
    v_mfma_f32_16x16x32_bf16 v[68:71], v[124:127], v[156:159], v[68:71]
    ds_read_b64 v[98:99], v32 offset:3208
    v_mfma_f32_16x16x32_bf16 v[64:67], v[128:131], v[152:155], v[64:67]
    ds_read_b64 v[100:101], v32 offset:3232
    v_mfma_f32_16x16x32_bf16 v[68:71], v[132:135], v[152:155], v[68:71]
    ds_read_b64 v[102:103], v32 offset:3240
    v_add_u32 v32, 128, v32
    s_cbranch_scc1 CV_l
    s_waitcnt lgkmcnt(0)
    v_cvt_pk_bf16_f32 v16, v40, v41
    v_cvt_pk_bf16_f32 v17, v42, v43
    ds_write_b64 v170, v[16:17] offset:0
    v_cvt_pk_bf16_f32 v18, v44, v45
    v_cvt_pk_bf16_f32 v19, v46, v47
    ds_write_b64 v170, v[18:19] offset:32
    v_cvt_pk_bf16_f32 v20, v48, v49
    v_cvt_pk_bf16_f32 v21, v50, v51
    ds_write_b64 v170, v[20:21] offset:1152
    v_cvt_pk_bf16_f32 v22, v52, v53
    v_cvt_pk_bf16_f32 v23, v54, v55
    ds_write_b64 v170, v[22:23] offset:1184
    v_cvt_pk_bf16_f32 v24, v56, v57
    v_cvt_pk_bf16_f32 v25, v58, v59
    ds_write_b64 v170, v[24:25] offset:2304
    v_cvt_pk_bf16_f32 v26, v60, v61
    v_cvt_pk_bf16_f32 v27, v62, v63
    ds_write_b64 v170, v[26:27] offset:2336
    v_cvt_pk_bf16_f32 v28, v64, v65
    v_cvt_pk_bf16_f32 v29, v66, v67
    ds_write_b64 v170, v[28:29] offset:3456
    v_cvt_pk_bf16_f32 v30, v68, v69
    v_cvt_pk_bf16_f32 v31, v70, v71
    ds_write_b64 v170, v[30:31] offset:3488
    v_mov_b32 v8, 162824
    v_mov_b32 v9, 1
    s_waitcnt lgkmcnt(0)
    s_mov_b64 exec, 1
    ds_add_u32 v8, v9
    s_mov_b64 exec, -1
    v_mov_b32 v8, 162824
spin_5:
    ds_read_b32 v9, v8
    s_waitcnt lgkmcnt(0)
    v_readfirstlane_b32 s53, v9
    s_nop 0
    s_cmp_ge_u32 s53, 4
    s_cbranch_scc0 spin_5
    ds_read_b64_tr_b16 v[104:105], v168 offset:0
    ds_read_b64_tr_b16 v[106:107], v168 offset:144
    ds_read_b64_tr_b16 v[108:109], v168 offset:288
    ds_read_b64_tr_b16 v[110:111], v168 offset:432
    ds_read_b64_tr_b16 v[112:113], v168 offset:576
    ds_read_b64_tr_b16 v[114:115], v168 offset:720
    ds_read_b64_tr_b16 v[116:117], v168 offset:864
    ds_read_b64_tr_b16 v[118:119], v168 offset:1008
    s_waitcnt lgkmcnt(7)
    buffer_store_dwordx2 v[104:105], v169, s[12:15], s44 offen offset:0 sc1
    s_waitcnt lgkmcnt(6)
    buffer_store_dwordx2 v[106:107], v169, s[12:15], s44 offen offset:512 sc1
    s_waitcnt lgkmcnt(5)
    buffer_store_dwordx2 v[108:109], v169, s[12:15], s44 offen offset:1024 sc1
    s_waitcnt lgkmcnt(4)
    buffer_store_dwordx2 v[110:111], v169, s[12:15], s44 offen offset:1536 sc1
    s_waitcnt lgkmcnt(3)
    buffer_store_dwordx2 v[112:113], v169, s[12:15], s44 offen offset:2048 sc1
    s_waitcnt lgkmcnt(2)
    buffer_store_dwordx2 v[114:115], v169, s[12:15], s44 offen offset:2560 sc1
    s_waitcnt lgkmcnt(1)
    buffer_store_dwordx2 v[116:117], v169, s[12:15], s44 offen offset:3072 sc1
    s_waitcnt lgkmcnt(0)
    buffer_store_dwordx2 v[118:119], v169, s[12:15], s44 offen offset:3584 sc1
    s_and_b32 s36, s2, 7
    s_lshl_b32 s36, s36, 7
    s_add_u32 s36, s36, 23101440
    v_mov_b32 v6, 1
    v_mov_b32 v7, 162820
    v_lshlrev_b32 v9, 10, v1
    s_mov_b64 exec, 1
    s_waitcnt vmcnt(0)
    s_waitcnt lgkmcnt(0)
    ds_add_rtn_u32 v8, v7, v6
    ds_read_b32 v10, v7 offset:28
    s_waitcnt lgkmcnt(0)
    v_readfirstlane_b32 s54, v8
    v_readfirstlane_b32 s53, v10
    s_cmp_lg_u32 s54, 15
    s_cbranch_scc1 fa_6
    s_mov_b64 exec, 0xffff
    s_or_b32 s53, s53, 1
    v_mov_b32 v6, s53
    buffer_atomic_add v6, v9, s[56:59], s36 offen sc1
fa_6:
    s_mov_b64 exec, -1
    s_branch FR_end
FR_b:
    s_getpc_b64 s[34:35]
K_tpc:
    s_lshl_b32 s36, s29, 2
    s_and_b32 s37, s28, 3
    s_add_u32 s36, s36, s37
    s_lshl_b32 s36, s36, 6
    s_add_u32 s36, s36, K_tab-K_tpc
    s_add_u32 s34, s34, s36
    s_addc_u32 s35, s35, 0
    v_and_b32 v248, 31, v1
    v_lshlrev_b32 v248, 1, v248
    global_load_ushort v251, v248, s[34:35]
    v_lshrrev_b32 v253, 3, v1
    v_lshlrev_b32 v238, 11, v253
    v_and_b32 v253, 6, v253
    v_and_b32 v254, 7, v1
    v_xor_b32 v253, v253, v254
    v_lshl_add_u32 v238, v253, 4, v238
    v_lshrrev_b32 v253, 4, v1
    v_lshlrev_b32 v239, 11, v253
    v_add_u32 v253, 0, v253
    v_lshlrev_b32 v253, 1, v253
    v_and_b32 v254, 15, v1
    v_xor_b32 v253, v253, v254
    v_lshl_add_u32 v239, v253, 4, v239
    v_lshrrev_b32 v253, 4, v1
    v_lshlrev_b32 v240, 11, v253
    v_add_u32 v253, 4, v253
    v_lshlrev_b32 v253, 1, v253
    v_and_b32 v254, 15, v1
    v_xor_b32 v253, v253, v254
    v_lshl_add_u32 v240, v253, 4, v240
    v_add_u32 v254, 0, v1
    v_mul_u32_u24 v253, 2341, v254
    v_lshrrev_b32 v253, 16, v253
    v_mul_u32_u24 v241, 28, v253
    v_sub_u32 v254, v254, v241
    v_mul_u32_u24 v241, 7168, v253
    v_lshrrev_b32 v253, 1, v253
    v_and_b32 v253, 2, v253
    v_xor_b32 v254, v254, v253
    v_lshl_add_u32 v241, v254, 4, v241
    v_add_u32 v254, 64, v1
    v_mul_u32_u24 v253, 2341, v254
    v_lshrrev_b32 v253, 16, v253
    v_mul_u32_u24 v242, 28, v253
    v_sub_u32 v254, v254, v242
    v_mul_u32_u24 v242, 7168, v253
    v_lshrrev_b32 v253, 1, v253
    v_and_b32 v253, 2, v253
    v_xor_b32 v254, v254, v253
    v_lshl_add_u32 v242, v254, 4, v242
    v_add_u32 v254, 128, v1
    v_mul_u32_u24 v253, 2341, v254
    v_lshrrev_b32 v253, 16, v253
    v_mul_u32_u24 v243, 28, v253
    v_sub_u32 v254, v254, v243
    v_mul_u32_u24 v243, 7168, v253
    v_lshrrev_b32 v253, 1, v253
    v_and_b32 v253, 2, v253
    v_xor_b32 v254, v254, v253
    v_lshl_add_u32 v243, v254, 4, v243
    v_add_u32 v254, 192, v1
    v_mul_u32_u24 v253, 2341, v254
    v_lshrrev_b32 v253, 16, v253
    v_mul_u32_u24 v244, 28, v253
    v_sub_u32 v254, v254, v244
    v_mul_u32_u24 v244, 7168, v253
    v_lshrrev_b32 v253, 1, v253
    v_and_b32 v253, 2, v253
    v_xor_b32 v254, v254, v253
    v_lshl_add_u32 v244, v254, 4, v244
    v_add_u32 v254, 256, v1
    v_mul_u32_u24 v253, 2341, v254
    v_lshrrev_b32 v253, 16, v253
    v_mul_u32_u24 v245, 28, v253
    v_sub_u32 v254, v254, v245
    v_mul_u32_u24 v245, 7168, v253
    v_lshrrev_b32 v253, 1, v253
    v_and_b32 v253, 2, v253
    v_xor_b32 v254, v254, v253
    v_lshl_add_u32 v245, v254, 4, v245
    v_add_u32 v254, 320, v1
    v_mul_u32_u24 v253, 2341, v254
    v_lshrrev_b32 v253, 16, v253
    v_mul_u32_u24 v246, 28, v253
    v_sub_u32 v254, v254, v246
    v_mul_u32_u24 v246, 7168, v253
    v_lshrrev_b32 v253, 1, v253
    v_and_b32 v253, 2, v253
    v_xor_b32 v254, v254, v253
    v_lshl_add_u32 v246, v254, 4, v246
    v_add_u32 v254, 384, v1
    v_mul_u32_u24 v253, 2341, v254
    v_lshrrev_b32 v253, 16, v253
    v_mul_u32_u24 v247, 28, v253
    v_sub_u32 v254, v254, v247
    v_mul_u32_u24 v247, 7168, v253
    v_lshrrev_b32 v253, 1, v253
    v_and_b32 v253, 2, v253
    v_xor_b32 v254, v254, v253
    v_lshl_add_u32 v247, v254, 4, v247
    s_mul_i32 s36, s2, 28672
    s_and_b32 s37, s30, 3
    s_mul_i32 s37, s37, 7168
    s_add_u32 s36, s36, s37
    s_add_u32 s90, s72, s36
    s_addc_u32 s91, s73, 0
    s_cmp_ge_u32 s30, 6
    s_cbranch_scc1 FB_cs
    s_cmp_ge_u32 s2, 255
    s_cbranch_scc1 FB_np
    s_cmp_lg_u32 s30, 5
    s_cbranch_scc1 FB_np
    s_and_b32 s42, s2, 31
    s_lshl_b32 s42, s42, 8
    s_lshr_b32 s43, s2, 5
    s_lshl_b32 s43, s43, 14
    s_add_u32 s42, s42, s43
    s_add_u32 s42, s42, 39714816
    v_mov_b32 v14, 0
    s_mov_b64 exec, 1
    s_mov_b32 s46, -1
    s_mov_b32 s47, -1
    s_mov_b32 s43, 0
FB_ml:
    s_add_u32 s45, s42, 0
    s_memtime s[34:35]
    s_waitcnt lgkmcnt(0)
    buffer_load_dword v13, v14, s[56:59], s45 offen sc1
    s_waitcnt vmcnt(0)
    s_memtime s[36:37]
    s_waitcnt lgkmcnt(0)
    s_sub_u32 s36, s36, s34
    s_min_u32 s46, s46, s36
    s_add_u32 s45, s42, 8192
    s_memtime s[34:35]
    s_waitcnt lgkmcnt(0)
    buffer_load_dword v13, v14, s[56:59], s45 offen sc1
    s_waitcnt vmcnt(0)
    s_memtime s[36:37]
    s_waitcnt lgkmcnt(0)
    s_sub_u32 s36, s36, s34
    s_min_u32 s47, s47, s36
    s_add_u32 s42, s42, 128
    s_add_u32 s43, s43, 1
    s_cmp_lt_u32 s43, 2
    s_cbranch_scc1 FB_ml
    s_cmp_lt_u32 s47, s46
    s_cselect_b32 s45, 1, 0
    s_lshr_b32 s46, s28, 2
    s_xor_b32 s45, s45, s46
    s_and_b32 s45, s45, 1
    s_lshl_b32 s45, s45, 8
    s_mov_b64 exec, -1
    v_mov_b32 v6, 162848
    v_mov_b32 v7, s45
    s_waitcnt lgkmcnt(0)
    ds_write_b32 v6, v7
FB_np:
    s_cmp_lg_u32 s30, 4
    s_cbranch_scc1 FB_ni
    v_mov_b32 v12, s52
    s_lshr_b32 s53, s28, 3
    s_lshl_b32 s53, s53, 2
    s_and_b32 s54, s28, 3
    s_add_u32 s53, s53, s54
    s_lshl_b32 s53, s53, 24
    s_lshr_b32 s54, s28, 2
    s_xor_b32 s54, s54, s94
    s_and_b32 s54, s54, 1
    s_lshl_b32 s54, s54, 13
    s_add_u32 s37, s53, s54
    s_add_u32 s37, s37, 33554432
    s_andn2_b32 s37, s37, 0x2000
    s_lshl_b32 s53, s29, 7
    s_add_u32 s37, s37, s53
    s_add_u32 s37, s37, 6029312
    v_and_b32 v13, 1, v1
    v_lshlrev_b32 v13, 13, v13
    v_lshrrev_b32 v14, 1, v1
    v_lshl_add_u32 v13, v14, 22, v13
    s_mov_b64 exec, 0xf
    buffer_store_dword v12, v13, s[56:59], s37 offen sc1
    s_cmp_lg_u32 s28, 0
    s_cbranch_scc1 FB_n2
    s_add_u32 s37, s53, 23117824
    s_mov_b64 exec, 1
    buffer_store_dword v12, v13, s[56:59], s37 offen sc1
FB_n2:
    s_mov_b64 exec, -1
    v_mov_b32 v16, 1
    v_mov_b32 v17, 0
    v_mov_b32 v18, 0
    v_mov_b32 v19, 0
    s_lshr_b32 s36, s2, 7
    s_lshl_b32 s36, s36, 24
    s_add_u32 s36, s36, 167772160
    s_add_u32 s20, s4, s36
    s_addc_u32 s21, s5, 0
    s_mov_b32 s22, 8388608
    s_mov_b32 s23, 0x20000
    s_and_b32 s36, s2, 127
    s_mul_i32 s36, s36, 65536
    s_add_u32 s36, s36, 16352
    v_and_b32 v13, 1, v1
    v_lshlrev_b32 v13, 4, v13
    v_bfe_u32 v14, v1, 1, 1
    v_lshl_add_u32 v13, v14, 13, v13
    v_bfe_u32 v14, v1, 2, 1
    v_mul_u32_u24 v14, 32800, v14
    v_add_u32 v13, v13, v14
    s_mov_b64 exec, 0xff
    buffer_store_dwordx4 v[16:19], v13, s[20:23], s36 offen sc1
    s_mov_b64 exec, -1
FB_ni:
    v_mov_b32 v6, 162832
spin_7:
    s_sleep 2
    ds_read_b32 v7, v6
    s_waitcnt lgkmcnt(0)
    v_readfirstlane_b32 s53, v7
    s_nop 0
    s_cmp_ge_u32 s53, 1
    s_cbranch_scc0 spin_7
    s_load_dwordx2 s[48:49], s[0:1], 64
    s_lshl_b32 s45, s2, 1
    s_and_b32 s50, s30, 1
    s_add_u32 s45, s45, s50
    s_mul_i32 s45, s45, 4096
    s_mov_b32 s50, 2097152
    s_mov_b32 s51, 0x20000
    s_waitcnt lgkmcnt(0)
    buffer_load_dwordx4 v[20:23], v2, s[48:51], s45 offen offset:0
    buffer_load_dwordx4 v[20:23], v2, s[48:51], s45 offen offset:1024
    buffer_load_dwordx4 v[20:23], v2, s[48:51], s45 offen offset:2048
    buffer_load_dwordx4 v[20:23], v2, s[48:51], s45 offen offset:3072
    s_mov_b32 s8, s6
    s_mov_b32 s9, s7
    s_mov_b32 s10, 0x400000
    s_mov_b32 s11, 0x20000
    buffer_load_dwordx2 v[180:181], v198, s[8:11], 0 offen offset:0 nt
    buffer_load_dwordx2 v[182:183], v198, s[8:11], 0 offen offset:32 nt
    buffer_load_dwordx2 v[184:185], v198, s[8:11], 0 offen offset:128 nt
    buffer_load_dwordx2 v[186:187], v198, s[8:11], 0 offen offset:160 nt
    s_and_b32 s36, s2, 7
    s_lshl_b32 s36, s36, 7
    s_add_u32 s36, s36, 23101440
    v_mov_b32 v6, 1
    v_mov_b32 v7, 162820
    v_lshlrev_b32 v9, 10, v1
    s_mov_b64 exec, 1
    s_waitcnt vmcnt(0)
    s_waitcnt lgkmcnt(0)
    ds_add_rtn_u32 v8, v7, v6
    ds_read_b32 v10, v7 offset:28
    s_waitcnt lgkmcnt(0)
    v_readfirstlane_b32 s54, v8
    v_readfirstlane_b32 s53, v10
    s_cmp_lg_u32 s54, 15
    s_cbranch_scc1 fa_8
    s_mov_b64 exec, 0xffff
    s_or_b32 s53, s53, 1
    v_mov_b32 v6, s53
    buffer_atomic_add v6, v9, s[56:59], s36 offen sc1
fa_8:
    s_mov_b64 exec, -1
    v_bfe_u32 v252, v251, 2, 2
    v_lshlrev_b32 v248, 14, v252
    v_and_b32 v252, 3, v251
    v_lshl_add_u32 v248, v252, 11, v248
    v_bfe_u32 v252, v251, 7, 3
    v_lshlrev_b32 v249, 14, v252
    v_bfe_u32 v252, v251, 4, 3
    v_lshl_add_u32 v249, v252, 10, v249
    v_bfe_u32 v252, v251, 13, 3
    v_lshlrev_b32 v250, 14, v252
    v_bfe_u32 v252, v251, 10, 3
    v_lshl_add_u32 v250, v252, 10, v250
    v_mov_b32 v6, 162840
spin_9:
    s_sleep 4
    ds_read_b32 v7, v6
    s_waitcnt lgkmcnt(0)
    v_readfirstlane_b32 s53, v7
    s_nop 0
    s_cmp_ge_u32 s53, 2
    s_cbranch_scc0 spin_9
    s_call_b64 s[76:77], SUB_w1_regs
    s_call_b64 s[76:77], SUB_park
    v_mov_b32 v6, 162840
spin_10:
    s_sleep 3
    ds_read_b32 v7, v6
    s_waitcnt lgkmcnt(0)
    v_readfirstlane_b32 s53, v7
    s_nop 0
    s_cmp_ge_u32 s53, 4
    s_cbranch_scc0 spin_10
    s_mov_b64 s[12:13], s[68:69]
    s_mov_b32 s14, 2097152
    s_mov_b32 s15, 0x20000
    s_and_b32 s35, s30, 1
    s_mul_i32 s38, s29, 128
    s_mul_i32 s41, s35, 65536
    s_add_u32 s38, s38, s41
    s_mul_i32 s41, s35, 4096
    s_add_u32 s41, s41, 24576
    s_mov_b32 s42, 0
    s_mov_b32 s44, s67
    s_mov_b32 s42, 73728
    s_mov_b32 s44, s67
    s_add_u32 s44, s44, 9
    s_and_b32 s44, s44, 15
    s_call_b64 s[76:77], SUB_w_issue_1
    s_waitcnt vmcnt(8)
    s_mov_b32 s42, 81920
    s_mov_b32 s44, s67
    s_add_u32 s44, s44, 10
    s_and_b32 s44, s44, 15
    s_call_b64 s[76:77], SUB_w_issue_1
    s_waitcnt vmcnt(8)
    s_mov_b32 s42, 90112
    s_mov_b32 s44, s67
    s_add_u32 s44, s44, 11
    s_and_b32 s44, s44, 15
    s_call_b64 s[76:77], SUB_w_issue_1
    s_waitcnt vmcnt(8)
    s_call_b64 s[76:77], SUB_w1_put
    s_branch FR_end
FB_cs:
    v_and_b32 v164, 15, v1
    v_mov_b32 v165, 0x3f803f80
    v_cmp_eq_u32 vcc, 0, v164
    s_nop 1
    v_cndmask_b32 v16, 0, v165, vcc
    v_cndmask_b32 v17, 0, v165, vcc
    v_cndmask_b32 v18, 0, v165, vcc
    v_cndmask_b32 v19, 0, v165, vcc
    v_cmp_eq_u32 vcc, 1, v164
    s_nop 1
    v_cndmask_b32 v20, 0, v165, vcc
    v_cndmask_b32 v21, 0, v165, vcc
    v_cndmask_b32 v22, 0, v165, vcc
    v_cndmask_b32 v23, 0, v165, vcc
    v_cmp_eq_u32 vcc, 2, v164
    s_nop 1
    v_cndmask_b32 v24, 0, v165, vcc
    v_cndmask_b32 v25, 0, v165, vcc
    v_cndmask_b32 v26, 0, v165, vcc
    v_cndmask_b32 v27, 0, v165, vcc
    v_cmp_eq_u32 vcc, 3, v164
    s_nop 1
    v_cndmask_b32 v28, 0, v165, vcc
    v_cndmask_b32 v29, 0, v165, vcc
    v_cndmask_b32 v30, 0, v165, vcc
    v_cndmask_b32 v31, 0, v165, vcc
    v_cmp_eq_u32 vcc, 4, v164
    s_nop 1
    v_cndmask_b32 v32, 0, v165, vcc
    v_cndmask_b32 v33, 0, v165, vcc
    v_cndmask_b32 v34, 0, v165, vcc
    v_cndmask_b32 v35, 0, v165, vcc
    v_cmp_eq_u32 vcc, 5, v164
    s_nop 1
    v_cndmask_b32 v36, 0, v165, vcc
    v_cndmask_b32 v37, 0, v165, vcc
    v_cndmask_b32 v38, 0, v165, vcc
    v_cndmask_b32 v39, 0, v165, vcc
    v_cmp_eq_u32 vcc, 6, v164
    s_nop 1
    v_cndmask_b32 v40, 0, v165, vcc
    v_cndmask_b32 v41, 0, v165, vcc
    v_cndmask_b32 v42, 0, v165, vcc
    v_cndmask_b32 v43, 0, v165, vcc
    v_cmp_eq_u32 vcc, 7, v164
    s_nop 1
    v_cndmask_b32 v44, 0, v165, vcc
    v_cndmask_b32 v45, 0, v165, vcc
    v_cndmask_b32 v46, 0, v165, vcc
    v_cndmask_b32 v47, 0, v165, vcc
    v_cmp_eq_u32 vcc, 8, v164
    s_nop 1
    v_cndmask_b32 v48, 0, v165, vcc
    v_cndmask_b32 v49, 0, v165, vcc
    v_cndmask_b32 v50, 0, v165, vcc
    v_cndmask_b32 v51, 0, v165, vcc
    v_cmp_eq_u32 vcc, 9, v164
    s_nop 1
    v_cndmask_b32 v52, 0, v165, vcc
    v_cndmask_b32 v53, 0, v165, vcc
    v_cndmask_b32 v54, 0, v165, vcc
    v_cndmask_b32 v55, 0, v165, vcc
    v_cmp_eq_u32 vcc, 10, v164
    s_nop 1
    v_cndmask_b32 v56, 0, v165, vcc
    v_cndmask_b32 v57, 0, v165, vcc
    v_cndmask_b32 v58, 0, v165, vcc
    v_cndmask_b32 v59, 0, v165, vcc
    v_cmp_eq_u32 vcc, 11, v164
    s_nop 1
    v_cndmask_b32 v60, 0, v165, vcc
    v_cndmask_b32 v61, 0, v165, vcc
    v_cndmask_b32 v62, 0, v165, vcc
    v_cndmask_b32 v63, 0, v165, vcc
    v_cmp_eq_u32 vcc, 12, v164
    s_nop 1
    v_cndmask_b32 v64, 0, v165, vcc
    v_cndmask_b32 v65, 0, v165, vcc
    v_cndmask_b32 v66, 0, v165, vcc
    v_cndmask_b32 v67, 0, v165, vcc
    v_cmp_eq_u32 vcc, 13, v164
    s_nop 1
    v_cndmask_b32 v68, 0, v165, vcc
    v_cndmask_b32 v69, 0, v165, vcc
    v_cndmask_b32 v70, 0, v165, vcc
    v_cndmask_b32 v71, 0, v165, vcc
    s_mov_b32 s35, 0
    v_lshrrev_b32 v253, 2, v1
    v_mul_u32_u24 v144, 128, v253
    v_and_b32 v254, 3, v1
    v_lshl_add_u32 v144, v254, 3, v144
    v_add_u32 v144, 24576, v144
    v_bfe_u32 v253, v253, 1, 2
    s_mul_i32 s36, s35, 4
    s_add_u32 s36, s36, 3
    v_xor_b32 v254, s36, v253
    v_lshl_add_u32 v147, v254, 5, v144
    s_mul_i32 s36, s35, 4
    s_add_u32 s36, s36, 2
    v_xor_b32 v254, s36, v253
    v_lshl_add_u32 v146, v254, 5, v144
    s_mul_i32 s36, s35, 4
    s_add_u32 s36, s36, 1
    v_xor_b32 v254, s36, v253
    v_lshl_add_u32 v145, v254, 5, v144
    s_mul_i32 s36, s35, 4
    s_add_u32 s36, s36, 0
    v_xor_b32 v254, s36, v253
    v_lshl_add_u32 v144, v254, 5, v144
    s_and_b32 s35, s30, 1
    s_mul_i32 s35, s35, 4096
    s_add_u32 s35, s35, 73728
    v_add_u32 v144, s35, v144
    v_add_u32 v145, s35, v145
    v_add_u32 v146, s35, v146
    v_add_u32 v147, s35, v147
    s_mov_b32 s35, 0
    v_lshrrev_b32 v253, 2, v1
    v_mul_u32_u24 v148, 448, v253
    v_and_b32 v254, 3, v1
    v_lshl_add_u32 v148, v254, 3, v148
    v_add_u32 v148, 73728, v148
    s_mul_i32 s36, s35, 224
    v_add_u32 v148, s36, v148
    v_bfe_u32 v253, v1, 4, 1
    v_lshlrev_b32 v253, 5, v253
    s_cmp_eq_u32 s35, 0
    s_cselect_b32 s36, 1, -1
    v_mul_lo_u32 v253, v253, s36
    v_sub_u32 v149, v148, v253
    v_add_u32 v148, v148, v253
    s_and_b32 s35, s30, 1
    s_mul_i32 s35, s35, 14336
    s_add_u32 s35, s35, 32768
    v_add_u32 v148, s35, v148
    v_add_u32 v149, s35, v149
    s_mov_b32 s35, 1
    v_lshrrev_b32 v253, 2, v1
    v_mul_u32_u24 v150, 448, v253
    v_and_b32 v254, 3, v1
    v_lshl_add_u32 v150, v254, 3, v150
    v_add_u32 v150, 73728, v150
    s_mul_i32 s36, s35, 224
    v_add_u32 v150, s36, v150
    v_bfe_u32 v253, v1, 4, 1
    v_lshlrev_b32 v253, 5, v253
    s_cmp_eq_u32 s35, 0
    s_cselect_b32 s36, 1, -1
    v_mul_lo_u32 v253, v253, s36
    v_sub_u32 v151, v150, v253
    v_add_u32 v150, v150, v253
    s_and_b32 s35, s30, 1
    s_mul_i32 s35, s35, 14336
    s_add_u32 s35, s35, 32768
    v_add_u32 v150, s35, v150
    v_add_u32 v151, s35, v151
    v_mov_b32 v156, 0
    v_mov_b32 v157, 0
    v_mov_b32 v158, 0
    v_mov_b32 v159, 0
    v_mov_b32 v160, 0
    v_mov_b32 v161, 0
    v_mov_b32 v162, 0
    v_mov_b32 v163, 0
    v_lshrrev_b32 v166, 4, v1
    v_lshlrev_b32 v166, 4, v166
    v_lshl_add_u32 v166, v164, 6, v166
    v_mov_b32 v165, 0x7f000000
    v_cmp_gt_u32 vcc, 4, v164
    s_nop 1
    v_cndmask_b32 v167, v165, v166, vcc
    v_cmp_gt_u32 vcc, 14, v164
    s_nop 1
    v_cndmask_b32 v168, v165, v166, vcc
    v_mov_b32 v6, 162832
spin_11:
    s_sleep 2
    ds_read_b32 v7, v6
    s_waitcnt lgkmcnt(0)
    v_readfirstlane_b32 s53, v7
    s_nop 0
    s_cmp_ge_u32 s53, 1
    s_cbranch_scc0 spin_11
    s_mov_b32 s8, s6
    s_mov_b32 s9, s7
    s_mov_b32 s10, 0x400000
    s_mov_b32 s11, 0x20000
    buffer_load_dwordx2 v[180:181], v198, s[8:11], 0 offen offset:0 nt
    buffer_load_dwordx2 v[182:183], v198, s[8:11], 0 offen offset:32 nt
    buffer_load_dwordx2 v[184:185], v198, s[8:11], 0 offen offset:128 nt
    buffer_load_dwordx2 v[186:187], v198, s[8:11], 0 offen offset:160 nt
    s_mov_b64 s[12:13], s[68:69]
    s_mov_b32 s14, 2097152
    s_mov_b32 s15, 0x20000
    s_and_b32 s35, s30, 1
    s_mul_i32 s38, s29, 128
    s_mul_i32 s41, s35, 65536
    s_add_u32 s38, s38, s41
    s_mul_i32 s41, s35, 4096
    s_add_u32 s41, s41, 24576
    s_mov_b32 s42, 0
    s_mov_b32 s44, s67
    s_mov_b32 s42, 73728
    s_mov_b32 s44, s28
    s_add_u32 s19, s41, s42
    s_mul_i32 s16, s44, 131072
    s_add_u32 s16, s16, s38
    s_add_u32 s44, s44, 1
    s_and_b32 s44, s44, 15
    s_add_u32 s42, s42, 8192
    s_cmp_eq_u32 s42, 131072
    s_cselect_b32 s42, 0, s42
    s_mov_b32 m0, s19
    s_mov_b32 s39, s16
    buffer_load_dwordx4 v238, s[12:15], s39 offen lds
    s_add_u32 m0, m0, 1024
    s_add_u32 s39, s39, 16384
    buffer_load_dwordx4 v238, s[12:15], s39 offen lds
    s_add_u32 m0, m0, 1024
    s_add_u32 s39, s39, 16384
    buffer_load_dwordx4 v238, s[12:15], s39 offen lds
    s_add_u32 m0, m0, 1024
    s_add_u32 s39, s39, 16384
    buffer_load_dwordx4 v238, s[12:15], s39 offen lds
    s_mov_b64 s[12:13], s[72:73]
    s_mov_b32 s14, 7340032
    s_mov_b32 s15, 0x20000
    s_and_b32 s35, s30, 1
    s_mul_i32 s38, s29, 448
    s_mul_i32 s41, s35, 229376
    s_add_u32 s38, s38, s41
    s_mul_i32 s41, s35, 14336
    s_add_u32 s41, s41, 73728
    s_mov_b32 s42, 0
    s_mov_b32 s44, 0
    s_mov_b32 s42, 32768
    s_mov_b32 s44, s28
    s_add_u32 s19, s41, s42
    s_mul_i32 s16, s44, 458752
    s_add_u32 s16, s16, s38
    s_add_u32 s44, s44, 1
    s_and_b32 s44, s44, 15
    s_add_u32 s42, s42, 28672
    s_cmp_eq_u32 s42, 86016
    s_cselect_b32 s42, 0, s42
    s_mov_b32 m0, s19
    s_mov_b32 s39, s16
    buffer_load_dwordx4 v241, s[12:15], s39 offen lds
    s_add_u32 m0, m0, 1024
    s_nop 0
    buffer_load_dwordx4 v242, s[12:15], s39 offen lds
    s_add_u32 m0, m0, 1024
    s_nop 0
    buffer_load_dwordx4 v243, s[12:15], s39 offen lds
    s_add_u32 m0, m0, 1024
    s_nop 0
    buffer_load_dwordx4 v244, s[12:15], s39 offen lds
    s_add_u32 m0, m0, 1024
    s_nop 0
    buffer_load_dwordx4 v245, s[12:15], s39 offen lds
    s_add_u32 m0, m0, 1024
    s_nop 0
    buffer_load_dwordx4 v246, s[12:15], s39 offen lds
    s_add_u32 m0, m0, 1024
    s_nop 0
    buffer_load_dwordx4 v247, s[12:15], s39 offen lds
    s_add_u32 m0, m0, 1024
    s_add_u32 s39, s39, 114688
    buffer_load_dwordx4 v241, s[12:15], s39 offen lds
    s_add_u32 m0, m0, 1024
    s_nop 0
    buffer_load_dwordx4 v242, s[12:15], s39 offen lds
    s_add_u32 m0, m0, 1024
    s_nop 0
    buffer_load_dwordx4 v243, s[12:15], s39 offen lds
    s_add_u32 m0, m0, 1024
    s_nop 0
    buffer_load_dwordx4 v244, s[12:15], s39 offen lds
    s_add_u32 m0, m0, 1024
    s_nop 0
    buffer_load_dwordx4 v245, s[12:15], s39 offen lds
    s_add_u32 m0, m0, 1024
    s_nop 0
    buffer_load_dwordx4 v246, s[12:15], s39 offen lds
    s_add_u32 m0, m0, 1024
    s_nop 0
    buffer_load_dwordx4 v247, s[12:15], s39 offen lds
    s_waitcnt vmcnt(14)
    s_setprio 1
    ds_read_b64_tr_b16 v[128:129], v144 offset:0
    ds_read_b64_tr_b16 v[130:131], v144 offset:2048
    ds_read_b64_tr_b16 v[132:133], v145 offset:0
    ds_read_b64_tr_b16 v[134:135], v145 offset:2048
    ds_read_b64_tr_b16 v[136:137], v146 offset:0
    ds_read_b64_tr_b16 v[138:139], v146 offset:2048
    ds_read_b64_tr_b16 v[140:141], v147 offset:0
    ds_read_b64_tr_b16 v[142:143], v147 offset:2048
    s_add_u32 s20, s4, 0x1400000
    s_addc_u32 s21, s5, 0
    s_mov_b32 s22, 0x20000
    s_mov_b32 s23, 0x20000
    s_lshl_b32 s35, s28, 1
    s_and_b32 s36, s30, 1
    s_add_u32 s35, s35, s36
    s_mul_i32 s35, s35, 4096
    s_mul_i32 s36, s29, 256
    s_add_u32 s35, s35, s36
    s_waitcnt lgkmcnt(0)
    v_mfma_f32_16x16x32_bf16 v[160:163], v[128:131], v[16:19], v[160:163]
    v_mfma_f32_16x16x32_bf16 v[160:163], v[132:135], v[20:23], v[160:163]
    v_mfma_f32_16x16x32_bf16 v[160:163], v[136:139], v[24:27], v[160:163]
    v_mfma_f32_16x16x32_bf16 v[160:163], v[140:143], v[28:31], v[160:163]
    s_nop 7
    buffer_store_dwordx4 v[160:163], v167, s[20:23], s35 offen sc1
    s_waitcnt vmcnt(1)
    v_mov_b32 v6, 162840
    v_mov_b32 v7, 1
    s_mov_b64 exec, 1
    ds_add_u32 v6, v7
    s_mov_b64 exec, -1
    ds_read_b64_tr_b16 v[72:73], v148 offset:0
    ds_read_b64_tr_b16 v[74:75], v148 offset:7168
    ds_read_b64_tr_b16 v[76:77], v149 offset:32
    ds_read_b64_tr_b16 v[78:79], v149 offset:7200
    ds_read_b64_tr_b16 v[80:81], v148 offset:64
    ds_read_b64_tr_b16 v[82:83], v148 offset:7232
    ds_read_b64_tr_b16 v[84:85], v149 offset:96
    ds_read_b64_tr_b16 v[86:87], v149 offset:7264
    ds_read_b64_tr_b16 v[88:89], v148 offset:128
    ds_read_b64_tr_b16 v[90:91], v148 offset:7296
    ds_read_b64_tr_b16 v[92:93], v149 offset:160
    ds_read_b64_tr_b16 v[94:95], v149 offset:7328
    ds_read_b64_tr_b16 v[96:97], v148 offset:192
    ds_read_b64_tr_b16 v[98:99], v148 offset:7360
    ds_read_b64_tr_b16 v[100:101], v150 offset:0
    ds_read_b64_tr_b16 v[102:103], v150 offset:7168
    ds_read_b64_tr_b16 v[104:105], v151 offset:32
    ds_read_b64_tr_b16 v[106:107], v151 offset:7200
    ds_read_b64_tr_b16 v[108:109], v150 offset:64
    ds_read_b64_tr_b16 v[110:111], v150 offset:7232
    ds_read_b64_tr_b16 v[112:113], v151 offset:96
    ds_read_b64_tr_b16 v[114:115], v151 offset:7264
    ds_read_b64_tr_b16 v[116:117], v150 offset:128
    ds_read_b64_tr_b16 v[118:119], v150 offset:7296
    ds_read_b64_tr_b16 v[120:121], v151 offset:160
    ds_read_b64_tr_b16 v[122:123], v151 offset:7328
    ds_read_b64_tr_b16 v[124:125], v150 offset:192
    ds_read_b64_tr_b16 v[126:127], v150 offset:7360
    s_add_u32 s20, s4, 0x1420000
    s_addc_u32 s21, s5, 0
    s_mov_b32 s22, 0x70000
    s_mov_b32 s23, 0x20000
    s_lshl_b32 s35, s28, 1
    s_and_b32 s36, s30, 1
    s_add_u32 s35, s35, s36
    s_mul_i32 s35, s35, 14336
    s_mul_i32 s36, s29, 896
    s_add_u32 s35, s35, s36
    s_waitcnt lgkmcnt(0)
    v_mfma_f32_16x16x32_bf16 v[156:159], v[72:75], v[16:19], v[156:159]
    v_mfma_f32_16x16x32_bf16 v[156:159], v[76:79], v[20:23], v[156:159]
    v_mfma_f32_16x16x32_bf16 v[156:159], v[80:83], v[24:27], v[156:159]
    v_mfma_f32_16x16x32_bf16 v[156:159], v[84:87], v[28:31], v[156:159]
    v_mfma_f32_16x16x32_bf16 v[156:159], v[88:91], v[32:35], v[156:159]
    v_mfma_f32_16x16x32_bf16 v[156:159], v[92:95], v[36:39], v[156:159]
    v_mfma_f32_16x16x32_bf16 v[156:159], v[96:99], v[40:43], v[156:159]
    v_mfma_f32_16x16x32_bf16 v[156:159], v[100:103], v[44:47], v[156:159]
    v_mfma_f32_16x16x32_bf16 v[156:159], v[104:107], v[48:51], v[156:159]
    v_mfma_f32_16x16x32_bf16 v[156:159], v[108:111], v[52:55], v[156:159]
    v_mfma_f32_16x16x32_bf16 v[156:159], v[112:115], v[56:59], v[156:159]
    v_mfma_f32_16x16x32_bf16 v[156:159], v[116:119], v[60:63], v[156:159]
    v_mfma_f32_16x16x32_bf16 v[156:159], v[120:123], v[64:67], v[156:159]
    v_mfma_f32_16x16x32_bf16 v[156:159], v[124:127], v[68:71], v[156:159]
    s_nop 7
    buffer_store_dwordx4 v[156:159], v168, s[20:23], s35 offen sc1
    s_and_b32 s36, s2, 7
    s_lshl_b32 s36, s36, 7
    s_add_u32 s36, s36, 23101440
    v_mov_b32 v6, 1
    v_mov_b32 v7, 162820
    v_lshlrev_b32 v9, 10, v1
    s_mov_b64 exec, 1
    s_waitcnt lgkmcnt(0)
    ds_add_rtn_u32 v8, v7, v6
    ds_read_b32 v10, v7 offset:28
    s_waitcnt lgkmcnt(0)
    v_readfirstlane_b32 s54, v8
    v_readfirstlane_b32 s53, v10
    s_cmp_lg_u32 s54, 15
    s_cbranch_scc1 fa_12
    s_mov_b64 exec, 0xffff
    s_or_b32 s53, s53, 1
    v_mov_b32 v6, s53
    buffer_atomic_add v6, v9, s[56:59], s36 offen sc1
fa_12:
    s_mov_b64 exec, -1
    v_and_b32 v252, 15, v251
    v_mul_u32_u24 v248, 458752, v252
    s_and_b32 s36, s30, 1
    s_mul_i32 s36, s36, 6
    s_add_u32 s36, s36, 4
    v_bfe_u32 v252, v251, s36, 6
    v_mul_u32_u24 v250, 37, v252
    v_lshrrev_b32 v250, 8, v250
    v_mul_u32_u24 v250, 7, v250
    v_sub_u32 v250, v252, v250
    v_cmp_eq_u32 vcc, 3, v250
    s_nop 1
    v_cndmask_b32 v250, 0, 1, vcc
    v_lshl_add_u32 v249, v252, 16, v250
    v_mov_b32 v6, 162840
    v_mov_b32 v7, 1
    s_mov_b64 exec, 1
    ds_add_u32 v6, v7
    s_mov_b64 exec, -1
    s_setprio 0
    s_call_b64 s[76:77], SUB_w1_regs
    s_call_b64 s[76:77], SUB_park
    v_mov_b32 v6, 162840
spin_13:
    s_sleep 3
    ds_read_b32 v7, v6
    s_waitcnt lgkmcnt(0)
    v_readfirstlane_b32 s53, v7
    s_nop 0
    s_cmp_ge_u32 s53, 4
    s_cbranch_scc0 spin_13
    s_mov_b64 s[12:13], s[68:69]
    s_mov_b32 s14, 2097152
    s_mov_b32 s15, 0x20000
    s_and_b32 s35, s30, 1
    s_mul_i32 s38, s29, 128
    s_mul_i32 s41, s35, 65536
    s_add_u32 s38, s38, s41
    s_mul_i32 s41, s35, 4096
    s_add_u32 s41, s41, 24576
    s_mov_b32 s42, 0
    s_mov_b32 s44, s67
    s_mov_b32 s42, 98304
    s_mov_b32 s44, s67
    s_add_u32 s44, s44, 12
    s_and_b32 s44, s44, 15
    s_call_b64 s[76:77], SUB_w_issue_1
    s_waitcnt vmcnt(8)
    s_mov_b32 s42, 106496
    s_mov_b32 s44, s67
    s_add_u32 s44, s44, 13
    s_and_b32 s44, s44, 15
    s_call_b64 s[76:77], SUB_w_issue_1
    s_waitcnt vmcnt(8)
    s_mov_b32 s42, 114688
    s_mov_b32 s44, s67
    s_add_u32 s44, s44, 14
    s_and_b32 s44, s44, 15
    s_call_b64 s[76:77], SUB_w_issue_1
    s_waitcnt vmcnt(8)
    s_mov_b32 s42, 122880
    s_mov_b32 s44, s67
    s_add_u32 s44, s44, 15
    s_and_b32 s44, s44, 15
    s_call_b64 s[76:77], SUB_w_issue_1
    s_waitcnt vmcnt(8)
    s_call_b64 s[76:77], SUB_w1_put
FR_end:
LAYER:
    v_lshlrev_b32 v40, 6, v199
    v_add_u32 v40, 161792, v40
    s_lshl_b32 s35, s30, 3
    v_add_u32 v39, s35, v40
    s_cmp_eq_u32 s60, 0
    s_cbranch_scc1 R_l0
    s_sub_u32 s8, s62, 0x400000
    s_subb_u32 s9, s63, 0
    s_mov_b32 s10, 0x7e000
    s_mov_b32 s11, 0x20000
    s_sub_u32 s12, s62, 0x380000
    s_subb_u32 s13, s63, 0
    s_mov_b32 s14, 0x7e000
    s_mov_b32 s15, 0x20000
    v_lshlrev_b32 v222, 16, v230
    v_and_b32 v223, 0xffff0000, v230
    v_lshlrev_b32 v206, 16, v180
    v_and_b32 v207, 0xffff0000, v180
    v_lshlrev_b32 v12, 16, v188
    v_and_b32 v13, 0xffff0000, v188
    v_pk_add_f32 v[206:207], v[206:207], v[12:13]
    v_lshlrev_b32 v224, 16, v231
    v_and_b32 v225, 0xffff0000, v231
    v_lshlrev_b32 v208, 16, v181
    v_and_b32 v209, 0xffff0000, v181
    v_lshlrev_b32 v14, 16, v189
    v_and_b32 v15, 0xffff0000, v189
    v_pk_add_f32 v[208:209], v[208:209], v[14:15]
    v_lshlrev_b32 v226, 16, v232
    v_and_b32 v227, 0xffff0000, v232
    v_lshlrev_b32 v210, 16, v182
    v_and_b32 v211, 0xffff0000, v182
    v_lshlrev_b32 v16, 16, v190
    v_and_b32 v17, 0xffff0000, v190
    v_pk_add_f32 v[210:211], v[210:211], v[16:17]
    v_lshlrev_b32 v228, 16, v233
    v_and_b32 v229, 0xffff0000, v233
    v_lshlrev_b32 v212, 16, v183
    v_and_b32 v213, 0xffff0000, v183
    v_lshlrev_b32 v18, 16, v191
    v_and_b32 v19, 0xffff0000, v191
    v_pk_add_f32 v[212:213], v[212:213], v[18:19]
    v_lshlrev_b32 v230, 16, v234
    v_and_b32 v231, 0xffff0000, v234
    v_lshlrev_b32 v214, 16, v184
    v_and_b32 v215, 0xffff0000, v184
    v_lshlrev_b32 v20, 16, v192
    v_and_b32 v21, 0xffff0000, v192
    v_pk_add_f32 v[214:215], v[214:215], v[20:21]
    v_lshlrev_b32 v232, 16, v235
    v_and_b32 v233, 0xffff0000, v235
    v_lshlrev_b32 v216, 16, v185
    v_and_b32 v217, 0xffff0000, v185
    v_lshlrev_b32 v22, 16, v193
    v_and_b32 v23, 0xffff0000, v193
    v_pk_add_f32 v[216:217], v[216:217], v[22:23]
    v_lshlrev_b32 v234, 16, v236
    v_and_b32 v235, 0xffff0000, v236
    v_lshlrev_b32 v218, 16, v186
    v_and_b32 v219, 0xffff0000, v186
    v_lshlrev_b32 v24, 16, v194
    v_and_b32 v25, 0xffff0000, v194
    v_pk_add_f32 v[218:219], v[218:219], v[24:25]
    v_lshlrev_b32 v236, 16, v237
    v_and_b32 v237, 0xffff0000, v237
    v_lshlrev_b32 v220, 16, v187
    v_and_b32 v221, 0xffff0000, v187
    v_lshlrev_b32 v26, 16, v195
    v_and_b32 v27, 0xffff0000, v195
    v_pk_add_f32 v[220:221], v[220:221], v[26:27]
    s_mov_b32 s53, 0
    s_sleep 24
dp_14:
    buffer_load_dwordx4 v[180:183], v196, s[8:11], 0 offen offset:0 sc1
    buffer_load_dwordx4 v[188:191], v196, s[12:15], 0 offen offset:0 sc1
    buffer_load_dwordx4 v[184:187], v196, s[8:11], 0 offen offset:2048 sc1
    buffer_load_dwordx4 v[192:195], v196, s[12:15], 0 offen offset:2048 sc1
    s_waitcnt vmcnt(0)
    v_bitop3_b32 v6, v180, v184, v188 bitop3:0x80
    v_bitop3_b32 v6, v6, v192, 1 bitop3:0x80
    v_cmp_eq_u32 vcc, 0, v6
    s_cbranch_vccz dq_15
    s_sleep 4
    s_add_u32 s53, s53, 1
    s_cmp_lt_u32 s53, s61
    s_cbranch_scc1 dp_14
    s_mov_b32 s61, 0
dq_15:
    v_lshlrev_b32 v12, 16, v180
    v_and_b32 v13, 0xffff0000, v180
    v_lshlrev_b32 v14, 16, v188
    v_and_b32 v15, 0xffff0000, v188
    v_pk_add_f32 v[12:13], v[12:13], v[14:15]
    v_pk_add_f32 v[206:207], v[206:207], v[12:13]
    v_lshlrev_b32 v16, 16, v181
    v_and_b32 v17, 0xffff0000, v181
    v_lshlrev_b32 v18, 16, v189
    v_and_b32 v19, 0xffff0000, v189
    v_pk_add_f32 v[16:17], v[16:17], v[18:19]
    v_pk_add_f32 v[208:209], v[208:209], v[16:17]
    v_lshlrev_b32 v20, 16, v182
    v_and_b32 v21, 0xffff0000, v182
    v_lshlrev_b32 v22, 16, v190
    v_and_b32 v23, 0xffff0000, v190
    v_pk_add_f32 v[20:21], v[20:21], v[22:23]
    v_pk_add_f32 v[210:211], v[210:211], v[20:21]
    v_lshlrev_b32 v24, 16, v183
    v_and_b32 v25, 0xffff0000, v183
    v_lshlrev_b32 v26, 16, v191
    v_and_b32 v27, 0xffff0000, v191
    v_pk_add_f32 v[24:25], v[24:25], v[26:27]
    v_pk_add_f32 v[212:213], v[212:213], v[24:25]
    v_lshlrev_b32 v12, 16, v184
    v_and_b32 v13, 0xffff0000, v184
    v_lshlrev_b32 v14, 16, v192
    v_and_b32 v15, 0xffff0000, v192
    v_pk_add_f32 v[12:13], v[12:13], v[14:15]
    v_pk_add_f32 v[214:215], v[214:215], v[12:13]
    v_lshlrev_b32 v16, 16, v185
    v_and_b32 v17, 0xffff0000, v185
    v_lshlrev_b32 v18, 16, v193
    v_and_b32 v19, 0xffff0000, v193
    v_pk_add_f32 v[16:17], v[16:17], v[18:19]
    v_pk_add_f32 v[216:217], v[216:217], v[16:17]
    v_lshlrev_b32 v20, 16, v186
    v_and_b32 v21, 0xffff0000, v186
    v_lshlrev_b32 v22, 16, v194
    v_and_b32 v23, 0xffff0000, v194
    v_pk_add_f32 v[20:21], v[20:21], v[22:23]
    v_pk_add_f32 v[218:219], v[218:219], v[20:21]
    v_lshlrev_b32 v24, 16, v187
    v_and_b32 v25, 0xffff0000, v187
    v_lshlrev_b32 v26, 16, v195
    v_and_b32 v27, 0xffff0000, v195
    v_pk_add_f32 v[24:25], v[24:25], v[26:27]
    v_pk_add_f32 v[220:221], v[220:221], v[24:25]
    v_pk_add_f32 v[32:33], v[206:207], v[208:209]
    v_pk_mul_f32 v[34:35], v[206:207], v[206:207]
    v_pk_fma_f32 v[34:35], v[208:209], v[208:209], v[34:35]
    v_pk_add_f32 v[32:33], v[32:33], v[210:211]
    v_pk_fma_f32 v[34:35], v[210:211], v[210:211], v[34:35]
    v_pk_add_f32 v[32:33], v[32:33], v[212:213]
    v_pk_fma_f32 v[34:35], v[212:213], v[212:213], v[34:35]
    v_pk_add_f32 v[32:33], v[32:33], v[214:215]
    v_pk_fma_f32 v[34:35], v[214:215], v[214:215], v[34:35]
    v_pk_add_f32 v[32:33], v[32:33], v[216:217]
    v_pk_fma_f32 v[34:35], v[216:217], v[216:217], v[34:35]
    v_pk_add_f32 v[32:33], v[32:33], v[218:219]
    v_pk_fma_f32 v[34:35], v[218:219], v[218:219], v[34:35]
    v_pk_add_f32 v[32:33], v[32:33], v[220:221]
    v_pk_fma_f32 v[34:35], v[220:221], v[220:221], v[34:35]
    v_add_f32 v30, v32, v33
    v_add_f32 v31, v34, v35
    s_nop 0
    v_add_f32_dpp v30, v30, v30 row_ror:8 row_mask:0xf bank_mask:0xf
    v_add_f32_dpp v31, v31, v31 row_ror:8 row_mask:0xf bank_mask:0xf
    v_mov_b32 v32, v30
    v_mov_b32 v33, v31
    s_nop 0
    v_permlane16_swap_b32 v30, v32
    v_permlane16_swap_b32 v31, v33
    v_pk_add_f32 v[30:31], v[30:31], v[32:33]
    v_mov_b32 v32, v30
    v_mov_b32 v33, v31
    s_nop 0
    v_permlane32_swap_b32 v30, v32
    v_permlane32_swap_b32 v31, v33
    v_pk_add_f32 v[30:31], v[30:31], v[32:33]
    ds_write_b64 v39, v[30:31] offset:0
    s_waitcnt lgkmcnt(0)
    s_barrier
    ds_read_b128 v[12:15], v40 offset:0
    ds_read_b128 v[16:19], v40 offset:16
    ds_read_b128 v[20:23], v40 offset:32
    ds_read_b128 v[24:27], v40 offset:48
    s_waitcnt lgkmcnt(0)
    v_pk_add_f32 v[12:13], v[12:13], v[14:15]
    v_pk_add_f32 v[16:17], v[16:17], v[18:19]
    v_pk_add_f32 v[20:21], v[20:21], v[22:23]
    v_pk_add_f32 v[24:25], v[24:25], v[26:27]
    v_pk_add_f32 v[12:13], v[12:13], v[16:17]
    v_pk_add_f32 v[20:21], v[20:21], v[24:25]
    v_pk_add_f32 v[12:13], v[12:13], v[20:21]
    v_mul_f32 v36, 0x3a800000, v12
    v_mul_f32 v38, 0x3a800000, v13
    v_fma_f32 v38, -v36, v36, v38
    v_max_f32 v38, 0, v38
    v_add_f32 v38, 0x3727c5ac, v38
    v_rsq_f32 v37, v38
    s_mov_b32 s20, s62
    s_mov_b32 s21, s63
    s_mov_b32 s22, 0x7e000
    s_mov_b32 s23, 0x20000
    v_pk_add_f32 v[12:13], v[206:207], v[36:37] op_sel_hi:[1,0] neg_lo:[0,1] neg_hi:[0,1]
    v_pk_mul_f32 v[12:13], v[12:13], v[36:37] op_sel:[0,1] op_sel_hi:[1,1]
    v_pk_fma_f32 v[206:207], v[12:13], v[222:223], v[206:207]
    v_cvt_pk_bf16_f32 v180, v206, v207
    v_pk_add_f32 v[14:15], v[208:209], v[36:37] op_sel_hi:[1,0] neg_lo:[0,1] neg_hi:[0,1]
    v_pk_mul_f32 v[14:15], v[14:15], v[36:37] op_sel:[0,1] op_sel_hi:[1,1]
    v_pk_fma_f32 v[208:209], v[14:15], v[224:225], v[208:209]
    v_cvt_pk_bf16_f32 v181, v208, v209
    v_and_b32 v180, -2, v180
    v_pk_add_f32 v[16:17], v[210:211], v[36:37] op_sel_hi:[1,0] neg_lo:[0,1] neg_hi:[0,1]
    v_pk_mul_f32 v[16:17], v[16:17], v[36:37] op_sel:[0,1] op_sel_hi:[1,1]
    v_pk_fma_f32 v[210:211], v[16:17], v[226:227], v[210:211]
    v_cvt_pk_bf16_f32 v182, v210, v211
    v_pk_add_f32 v[18:19], v[212:213], v[36:37] op_sel_hi:[1,0] neg_lo:[0,1] neg_hi:[0,1]
    v_pk_mul_f32 v[18:19], v[18:19], v[36:37] op_sel:[0,1] op_sel_hi:[1,1]
    v_pk_fma_f32 v[212:213], v[18:19], v[228:229], v[212:213]
    v_cvt_pk_bf16_f32 v183, v212, v213
    buffer_store_dwordx4 v[180:183], v196, s[20:23], 0 offen offset:0 sc1
    v_pk_add_f32 v[20:21], v[214:215], v[36:37] op_sel_hi:[1,0] neg_lo:[0,1] neg_hi:[0,1]
    v_pk_mul_f32 v[20:21], v[20:21], v[36:37] op_sel:[0,1] op_sel_hi:[1,1]
    v_pk_fma_f32 v[214:215], v[20:21], v[230:231], v[214:215]
    v_cvt_pk_bf16_f32 v184, v214, v215
    v_pk_add_f32 v[22:23], v[216:217], v[36:37] op_sel_hi:[1,0] neg_lo:[0,1] neg_hi:[0,1]
    v_pk_mul_f32 v[22:23], v[22:23], v[36:37] op_sel:[0,1] op_sel_hi:[1,1]
    v_pk_fma_f32 v[216:217], v[22:23], v[232:233], v[216:217]
    v_cvt_pk_bf16_f32 v185, v216, v217
    v_and_b32 v184, -2, v184
    v_pk_add_f32 v[24:25], v[218:219], v[36:37] op_sel_hi:[1,0] neg_lo:[0,1] neg_hi:[0,1]
    v_pk_mul_f32 v[24:25], v[24:25], v[36:37] op_sel:[0,1] op_sel_hi:[1,1]
    v_pk_fma_f32 v[218:219], v[24:25], v[234:235], v[218:219]
    v_cvt_pk_bf16_f32 v186, v218, v219
    v_pk_add_f32 v[26:27], v[220:221], v[36:37] op_sel_hi:[1,0] neg_lo:[0,1] neg_hi:[0,1]
    v_pk_mul_f32 v[26:27], v[26:27], v[36:37] op_sel:[0,1] op_sel_hi:[1,1]
    v_pk_fma_f32 v[220:221], v[26:27], v[236:237], v[220:221]
    v_cvt_pk_bf16_f32 v187, v220, v221
    buffer_store_dwordx4 v[184:187], v196, s[20:23], 0 offen offset:2048 sc1
    s_branch R_s2
R_l0:
    v_lshlrev_b32 v206, 16, v180
    v_and_b32 v207, 0xffff0000, v180
    v_lshlrev_b32 v208, 16, v181
    v_and_b32 v209, 0xffff0000, v181
    v_lshlrev_b32 v210, 16, v182
    v_and_b32 v211, 0xffff0000, v182
    v_lshlrev_b32 v212, 16, v183
    v_and_b32 v213, 0xffff0000, v183
    v_lshlrev_b32 v214, 16, v184
    v_and_b32 v215, 0xffff0000, v184
    v_lshlrev_b32 v216, 16, v185
    v_and_b32 v217, 0xffff0000, v185
    v_lshlrev_b32 v218, 16, v186
    v_and_b32 v219, 0xffff0000, v186
    v_lshlrev_b32 v220, 16, v187
    v_and_b32 v221, 0xffff0000, v187
    v_pk_add_f32 v[32:33], v[206:207], v[208:209]
    v_pk_mul_f32 v[34:35], v[206:207], v[206:207]
    v_pk_fma_f32 v[34:35], v[208:209], v[208:209], v[34:35]
    v_pk_add_f32 v[32:33], v[32:33], v[210:211]
    v_pk_fma_f32 v[34:35], v[210:211], v[210:211], v[34:35]
    v_pk_add_f32 v[32:33], v[32:33], v[212:213]
    v_pk_fma_f32 v[34:35], v[212:213], v[212:213], v[34:35]
    v_pk_add_f32 v[32:33], v[32:33], v[214:215]
    v_pk_fma_f32 v[34:35], v[214:215], v[214:215], v[34:35]
    v_pk_add_f32 v[32:33], v[32:33], v[216:217]
    v_pk_fma_f32 v[34:35], v[216:217], v[216:217], v[34:35]
    v_pk_add_f32 v[32:33], v[32:33], v[218:219]
    v_pk_fma_f32 v[34:35], v[218:219], v[218:219], v[34:35]
    v_pk_add_f32 v[32:33], v[32:33], v[220:221]
    v_pk_fma_f32 v[34:35], v[220:221], v[220:221], v[34:35]
    v_add_f32 v30, v32, v33
    v_add_f32 v31, v34, v35
    s_nop 0
    v_add_f32_dpp v30, v30, v30 row_ror:8 row_mask:0xf bank_mask:0xf
    v_add_f32_dpp v31, v31, v31 row_ror:8 row_mask:0xf bank_mask:0xf
    v_mov_b32 v32, v30
    v_mov_b32 v33, v31
    s_nop 0
    v_permlane16_swap_b32 v30, v32
    v_permlane16_swap_b32 v31, v33
    v_pk_add_f32 v[30:31], v[30:31], v[32:33]
    v_mov_b32 v32, v30
    v_mov_b32 v33, v31
    s_nop 0
    v_permlane32_swap_b32 v30, v32
    v_permlane32_swap_b32 v31, v33
    v_pk_add_f32 v[30:31], v[30:31], v[32:33]
    ds_write_b64 v39, v[30:31] offset:0
    s_waitcnt lgkmcnt(0)
    s_cmp_lg_u32 s30, 4
    s_cbranch_scc1 R_fw
    v_mov_b32 v222, 162820
spin_16:
    s_sleep 4
    ds_read_b32 v223, v222
    s_waitcnt lgkmcnt(0)
    v_readfirstlane_b32 s53, v223
    s_nop 0
    s_cmp_ge_u32 s53, 16
    s_cbranch_scc0 spin_16
    s_lshl_b32 s36, s28, 10
    s_add_u32 s36, s36, 23101440
    v_lshlrev_b32 v226, 7, v1
    v_add_u32 v226, s36, v226
    s_mov_b32 s53, 0
    s_mov_b64 exec, 0xff
R_fp:
    buffer_load_dword v222, v226, s[56:59], 0 offen sc1
    s_waitcnt vmcnt(0)
    v_subrev_u32 v222, s52, v222
    v_and_b32 v223, 0xffffc0ff, v222
    v_cmp_eq_u32 vcc, 32, v223
    s_nop 0
    s_cmp_eq_u64 vcc, exec
    s_cbranch_scc1 R_fq
    s_sleep 3
    s_add_u32 s53, s53, 1
    s_cmp_lt_u32 s53, s61
    s_cbranch_scc1 R_fp
    s_mov_b32 s61, 0
R_fq:
    v_lshrrev_b32 v222, 8, v222
    v_mov_b32 v223, 162844
    ds_add_u32 v223, v222
    s_mov_b64 exec, -1
    s_waitcnt lgkmcnt(0)
R_fw:
    s_barrier
    s_add_u32 s80, s4, 0x1c00000
    s_addc_u32 s81, s5, 0
    s_mov_b32 s82, 0x400000
    s_mov_b32 s83, 0x20000
    s_mov_b32 s78, 0
    buffer_load_dwordx2 v[230:231], v197, s[80:83], s78 offen sc1
    s_mov_b32 s78, 65536
    buffer_load_dwordx2 v[232:233], v197, s[80:83], s78 offen sc1
    s_mov_b32 s78, 262144
    buffer_load_dwordx2 v[234:235], v197, s[80:83], s78 offen sc1
    s_mov_b32 s78, 327680
    buffer_load_dwordx2 v[236:237], v197, s[80:83], s78 offen sc1
    v_mov_b32 v222, 162844
    ds_read_b32 v223, v222
    s_waitcnt lgkmcnt(0)
    v_readfirstlane_b32 s94, v223
    s_nop 0
    s_cmp_gt_u32 s94, 127
    s_cselect_b32 s94, 1, 0
    s_lshr_b32 s53, s28, 3
    s_lshl_b32 s53, s53, 2
    s_and_b32 s54, s28, 3
    s_add_u32 s53, s53, s54
    s_lshl_b32 s53, s53, 24
    s_lshr_b32 s54, s28, 2
    s_xor_b32 s54, s54, s94
    s_and_b32 s54, s54, 1
    s_lshl_b32 s54, s54, 13
    s_add_u32 s55, s53, s54
    s_add_u32 s55, s55, 33554432
    s_add_u32 s62, s4, s55
    s_addc_u32 s63, s5, 0
    s_sub_u32 s36, s28, 1
    s_max_i32 s36, s36, 0
    s_lshr_b32 s53, s36, 3
    s_lshl_b32 s53, s53, 2
    s_and_b32 s54, s36, 3
    s_add_u32 s53, s53, s54
    s_lshl_b32 s53, s53, 24
    s_lshr_b32 s54, s36, 2
    s_xor_b32 s54, s54, s94
    s_and_b32 s54, s54, 1
    s_lshl_b32 s54, s54, 13
    s_add_u32 s92, s53, s54
    s_add_u32 s92, s92, 33554432
    s_sub_u32 s92, s92, s55
    s_add_u32 s36, s28, 1
    s_min_u32 s36, s36, 15
    s_lshr_b32 s53, s36, 3
    s_lshl_b32 s53, s53, 2
    s_and_b32 s54, s36, 3
    s_add_u32 s53, s53, s54
    s_lshl_b32 s53, s53, 24
    s_lshr_b32 s54, s36, 2
    s_xor_b32 s54, s54, s94
    s_and_b32 s54, s54, 1
    s_lshl_b32 s54, s54, 13
    s_add_u32 s93, s53, s54
    s_add_u32 s93, s93, 33554432
    s_sub_u32 s93, s93, s55
    s_add_u32 s55, s55, 6029312
    s_mov_b32 s20, s62
    s_mov_b32 s21, s63
    s_mov_b32 s22, 0x7e000
    s_mov_b32 s23, 0x20000
    ds_read_b128 v[12:15], v40 offset:0
    ds_read_b128 v[16:19], v40 offset:16
    ds_read_b128 v[20:23], v40 offset:32
    ds_read_b128 v[24:27], v40 offset:48
    s_waitcnt lgkmcnt(0)
    v_pk_add_f32 v[12:13], v[12:13], v[14:15]
    v_pk_add_f32 v[16:17], v[16:17], v[18:19]
    v_pk_add_f32 v[20:21], v[20:21], v[22:23]
    v_pk_add_f32 v[24:25], v[24:25], v[26:27]
    v_pk_add_f32 v[12:13], v[12:13], v[16:17]
    v_pk_add_f32 v[20:21], v[20:21], v[24:25]
    v_pk_add_f32 v[12:13], v[12:13], v[20:21]
    v_mul_f32 v36, 0x3a800000, v12
    v_mul_f32 v38, 0x3a800000, v13
    v_fma_f32 v38, -v36, v36, v38
    v_max_f32 v38, 0, v38
    v_add_f32 v38, 0x3727c5ac, v38
    v_rsq_f32 v37, v38
    s_nop 0
    v_pk_add_f32 v[12:13], v[206:207], v[36:37] op_sel_hi:[1,0] neg_lo:[0,1] neg_hi:[0,1]
    v_pk_mul_f32 v[12:13], v[12:13], v[36:37] op_sel:[0,1] op_sel_hi:[1,1]
    v_pk_add_f32 v[14:15], v[208:209], v[36:37] op_sel_hi:[1,0] neg_lo:[0,1] neg_hi:[0,1]
    v_pk_mul_f32 v[14:15], v[14:15], v[36:37] op_sel:[0,1] op_sel_hi:[1,1]
    v_pk_add_f32 v[16:17], v[210:211], v[36:37] op_sel_hi:[1,0] neg_lo:[0,1] neg_hi:[0,1]
    v_pk_mul_f32 v[16:17], v[16:17], v[36:37] op_sel:[0,1] op_sel_hi:[1,1]
    v_pk_add_f32 v[18:19], v[212:213], v[36:37] op_sel_hi:[1,0] neg_lo:[0,1] neg_hi:[0,1]
    v_pk_mul_f32 v[18:19], v[18:19], v[36:37] op_sel:[0,1] op_sel_hi:[1,1]
    v_pk_add_f32 v[20:21], v[214:215], v[36:37] op_sel_hi:[1,0] neg_lo:[0,1] neg_hi:[0,1]
    v_pk_mul_f32 v[20:21], v[20:21], v[36:37] op_sel:[0,1] op_sel_hi:[1,1]
    v_pk_add_f32 v[22:23], v[216:217], v[36:37] op_sel_hi:[1,0] neg_lo:[0,1] neg_hi:[0,1]
    v_pk_mul_f32 v[22:23], v[22:23], v[36:37] op_sel:[0,1] op_sel_hi:[1,1]
    v_pk_add_f32 v[24:25], v[218:219], v[36:37] op_sel_hi:[1,0] neg_lo:[0,1] neg_hi:[0,1]
    v_pk_mul_f32 v[24:25], v[24:25], v[36:37] op_sel:[0,1] op_sel_hi:[1,1]
    v_pk_add_f32 v[26:27], v[220:221], v[36:37] op_sel_hi:[1,0] neg_lo:[0,1] neg_hi:[0,1]
    v_pk_mul_f32 v[26:27], v[26:27], v[36:37] op_sel:[0,1] op_sel_hi:[1,1]
    s_waitcnt vmcnt(0)
    v_lshlrev_b32 v222, 16, v230
    v_and_b32 v223, 0xffff0000, v230
    v_pk_fma_f32 v[206:207], v[12:13], v[222:223], v[206:207]
    v_cvt_pk_bf16_f32 v180, v206, v207
    v_lshlrev_b32 v222, 16, v231
    v_and_b32 v223, 0xffff0000, v231
    v_pk_fma_f32 v[208:209], v[14:15], v[222:223], v[208:209]
    v_cvt_pk_bf16_f32 v181, v208, v209
    v_and_b32 v180, -2, v180
    v_lshlrev_b32 v222, 16, v232
    v_and_b32 v223, 0xffff0000, v232
    v_pk_fma_f32 v[210:211], v[16:17], v[222:223], v[210:211]
    v_cvt_pk_bf16_f32 v182, v210, v211
    v_lshlrev_b32 v222, 16, v233
    v_and_b32 v223, 0xffff0000, v233
    v_pk_fma_f32 v[212:213], v[18:19], v[222:223], v[212:213]
    v_cvt_pk_bf16_f32 v183, v212, v213
    buffer_store_dwordx4 v[180:183], v196, s[20:23], 0 offen offset:0 sc1
    v_lshlrev_b32 v222, 16, v234
    v_and_b32 v223, 0xffff0000, v234
    v_pk_fma_f32 v[214:215], v[20:21], v[222:223], v[214:215]
    v_cvt_pk_bf16_f32 v184, v214, v215
    v_lshlrev_b32 v222, 16, v235
    v_and_b32 v223, 0xffff0000, v235
    v_pk_fma_f32 v[216:217], v[22:23], v[222:223], v[216:217]
    v_cvt_pk_bf16_f32 v185, v216, v217
    v_and_b32 v184, -2, v184
    v_lshlrev_b32 v222, 16, v236
    v_and_b32 v223, 0xffff0000, v236
    v_pk_fma_f32 v[218:219], v[24:25], v[222:223], v[218:219]
    v_cvt_pk_bf16_f32 v186, v218, v219
    v_lshlrev_b32 v222, 16, v237
    v_and_b32 v223, 0xffff0000, v237
    v_pk_fma_f32 v[220:221], v[26:27], v[222:223], v[220:221]
    v_cvt_pk_bf16_f32 v187, v220, v221
    buffer_store_dwordx4 v[184:187], v196, s[20:23], 0 offen offset:2048 sc1
R_s2:
    v_lshlrev_b32 v206, 16, v180
    v_and_b32 v207, 0xffff0000, v180
    v_lshlrev_b32 v208, 16, v181
    v_and_b32 v209, 0xffff0000, v181
    v_lshlrev_b32 v210, 16, v182
    v_and_b32 v211, 0xffff0000, v182
    v_lshlrev_b32 v212, 16, v183
    v_and_b32 v213, 0xffff0000, v183
    v_lshlrev_b32 v214, 16, v184
    v_and_b32 v215, 0xffff0000, v184
    v_lshlrev_b32 v216, 16, v185
    v_and_b32 v217, 0xffff0000, v185
    v_lshlrev_b32 v218, 16, v186
    v_and_b32 v219, 0xffff0000, v186
    v_lshlrev_b32 v220, 16, v187
    v_and_b32 v221, 0xffff0000, v187
    v_pk_add_f32 v[32:33], v[206:207], v[208:209]
    v_pk_mul_f32 v[34:35], v[206:207], v[206:207]
    v_pk_fma_f32 v[34:35], v[208:209], v[208:209], v[34:35]
    v_pk_add_f32 v[32:33], v[32:33], v[210:211]
    v_pk_fma_f32 v[34:35], v[210:211], v[210:211], v[34:35]
    v_pk_add_f32 v[32:33], v[32:33], v[212:213]
    v_pk_fma_f32 v[34:35], v[212:213], v[212:213], v[34:35]
    v_pk_add_f32 v[32:33], v[32:33], v[214:215]
    v_pk_fma_f32 v[34:35], v[214:215], v[214:215], v[34:35]
    v_pk_add_f32 v[32:33], v[32:33], v[216:217]
    v_pk_fma_f32 v[34:35], v[216:217], v[216:217], v[34:35]
    v_pk_add_f32 v[32:33], v[32:33], v[218:219]
    v_pk_fma_f32 v[34:35], v[218:219], v[218:219], v[34:35]
    v_pk_add_f32 v[32:33], v[32:33], v[220:221]
    v_pk_fma_f32 v[34:35], v[220:221], v[220:221], v[34:35]
    v_add_f32 v30, v32, v33
    v_add_f32 v31, v34, v35
    s_nop 0
    v_add_f32_dpp v30, v30, v30 row_ror:8 row_mask:0xf bank_mask:0xf
    v_add_f32_dpp v31, v31, v31 row_ror:8 row_mask:0xf bank_mask:0xf
    v_mov_b32 v32, v30
    v_mov_b32 v33, v31
    s_nop 0
    v_permlane16_swap_b32 v30, v32
    v_permlane16_swap_b32 v31, v33
    v_pk_add_f32 v[30:31], v[30:31], v[32:33]
    v_mov_b32 v32, v30
    v_mov_b32 v33, v31
    s_nop 0
    v_permlane32_swap_b32 v30, v32
    v_permlane32_swap_b32 v31, v33
    v_pk_add_f32 v[30:31], v[30:31], v[32:33]
    ds_write_b64 v39, v[30:31] offset:512
    s_waitcnt lgkmcnt(0)
    s_barrier
    s_cmp_lg_u32 s30, 6
    s_cbranch_scc1 R_n6
    s_cmp_lg_u32 s60, 0
    s_cbranch_scc1 R_n6
    s_lshl_b32 s53, s29, 7
    s_add_u32 s53, s53, 23117824
    v_mov_b32 v8, 1
    v_mov_b32 v9, 0
    s_mov_b64 exec, 1
    buffer_atomic_add v8, v9, s[56:59], s53 offen sc1
    s_mov_b64 exec, -1
R_n6:
    s_cmp_lg_u32 s30, 7
    s_cbranch_scc1 R_nl
    ds_read_b128 v[12:15], v40 offset:512
    ds_read_b128 v[16:19], v40 offset:528
    ds_read_b128 v[20:23], v40 offset:544
    ds_read_b128 v[24:27], v40 offset:560
    s_waitcnt lgkmcnt(0)
    v_pk_add_f32 v[12:13], v[12:13], v[14:15]
    v_pk_add_f32 v[16:17], v[16:17], v[18:19]
    v_pk_add_f32 v[20:21], v[20:21], v[22:23]
    v_pk_add_f32 v[24:25], v[24:25], v[26:27]
    v_pk_add_f32 v[12:13], v[12:13], v[16:17]
    v_pk_add_f32 v[20:21], v[20:21], v[24:25]
    v_pk_add_f32 v[12:13], v[12:13], v[20:21]
    v_mul_f32 v36, 0x3a800000, v12
    v_mul_f32 v38, 0x3a800000, v13
    v_fma_f32 v38, -v36, v36, v38
    v_max_f32 v38, 0, v38
    v_mov_b32 v42, v36
    v_mov_b32 v43, v38
    v_add_f32 v38, 0x3727c5ac, v38
    v_sqrt_f32 v38, v38
    s_nop 0
    v_mov_b32 v41, v38
    v_rcp_f32 v37, v38
    v_sub_f32 v42, v42, v36
    v_mul_f32 v42, v42, v37
    v_mul_f32 v43, v43, v37
    v_mul_f32 v43, v43, v37
    v_add_f32 v43, 0x3727c5ac, v43
    v_rsq_f32 v44, v43
    v_mov_b32 v224, v36
    v_mov_b32 v225, v37
    v_fma_f32 v226, v42, v41, v36
    v_mul_f32 v227, v37, v44
    s_add_u32 s24, s62, 0x5d0000
    s_addc_u32 s25, s63, 0
    s_mov_b32 s26, 0x800
    s_mov_b32 s27, 0x20000
    s_lshl_b32 s36, s29, 3
    v_add_u32 v6, s36, v199
    v_lshlrev_b32 v6, 4, v6
    s_mov_b64 exec, 0xff
    buffer_store_dwordx4 v[224:227], v6, s[24:27], 0 offen sc1
    s_mov_b64 exec, -1
    s_add_u32 s53, s55, 1280
    v_mov_b32 v8, 1
    v_mov_b32 v9, 162816
    v_mov_b32 v11, 0
    s_mov_b64 exec, 1
    s_waitcnt vmcnt(0)
    buffer_atomic_add v8, v11, s[56:59], s53 offen sc1
pub_17:
    s_mov_b64 exec, -1
R_nl:
    s_cmp_ge_u32 s30, 4
    s_cbranch_scc1 LOADERS
    s_mov_b32 s34, s30
    s_mov_b32 s35, 0
    v_and_b32 v22, 15, v1
    v_lshrrev_b32 v23, 4, v1
    s_mul_i32 s37, s34, 2
    s_mul_i32 s38, s29, 4
    s_mul_i32 s36, s35, 4
    s_add_u32 s38, s38, s36
    s_mov_b32 s8, s62
    s_mov_b32 s9, s63
    s_mov_b32 s10, 0x7e000
    s_mov_b32 s11, 0x20000
    v_add_u32 v126, 0, v2
    v_add_u32 v127, 65536, v2
    v_add_u32 v128, 4096, v2
    v_add_u32 v129, 69632, v2
    s_lshr_b32 s36, s67, 2
    s_add_u32 s36, s36, 0
    s_and_b32 s36, s36, 3
    s_lshl_b32 s44, s36, 14
    s_lshl_b32 s36, s34, 17
    s_add_u32 s44, s44, s36
    s_lshr_b32 s36, s67, 2
    s_add_u32 s36, s36, 1
    s_and_b32 s36, s36, 3
    s_lshl_b32 s45, s36, 14
    s_lshl_b32 s36, s34, 17
    s_add_u32 s45, s45, s36
    s_lshr_b32 s36, s67, 2
    s_add_u32 s36, s36, 2
    s_and_b32 s36, s36, 3
    s_lshl_b32 s46, s36, 14
    s_lshl_b32 s36, s34, 17
    s_add_u32 s46, s46, s36
    s_lshr_b32 s36, s67, 2
    s_add_u32 s36, s36, 3
    s_and_b32 s36, s36, 3
    s_lshl_b32 s47, s36, 14
    s_lshl_b32 s36, s34, 17
    s_add_u32 s47, s47, s36
    v_lshrrev_b32 v6, 2, v1
    v_mul_u32_u24 v13, 128, v6
    v_and_b32 v7, 3, v1
    v_lshl_add_u32 v13, v7, 3, v13
    v_add_u32 v13, 24576, v13
    v_bfe_u32 v6, v6, 1, 2
    s_mul_i32 s36, s35, 4
    s_add_u32 s36, s36, 3
    v_xor_b32 v7, s36, v6
    v_lshl_add_u32 v16, v7, 5, v13
    s_mul_i32 s36, s35, 4
    s_add_u32 s36, s36, 2
    v_xor_b32 v7, s36, v6
    v_lshl_add_u32 v15, v7, 5, v13
    s_mul_i32 s36, s35, 4
    s_add_u32 s36, s36, 1
    v_xor_b32 v7, s36, v6
    v_lshl_add_u32 v14, v7, 5, v13
    s_mul_i32 s36, s35, 4
    s_add_u32 s36, s36, 0
    v_xor_b32 v7, s36, v6
    v_lshl_add_u32 v13, v7, 5, v13
    v_pk_mov_b32 v[24:25], 0, 0
    v_pk_mov_b32 v[26:27], 0, 0
    v_pk_mov_b32 v[28:29], 0, 0
    v_pk_mov_b32 v[30:31], 0, 0
    v_pk_mov_b32 v[32:33], 0, 0
    v_pk_mov_b32 v[34:35], 0, 0
    v_pk_mov_b32 v[36:37], 0, 0
    v_pk_mov_b32 v[38:39], 0, 0
    v_pk_mov_b32 v[40:41], 0, 0
    v_pk_mov_b32 v[42:43], 0, 0
    v_pk_mov_b32 v[44:45], 0, 0
    v_pk_mov_b32 v[46:47], 0, 0
    v_pk_mov_b32 v[48:49], 0, 0
    v_pk_mov_b32 v[50:51], 0, 0
    v_pk_mov_b32 v[52:53], 0, 0
    v_pk_mov_b32 v[54:55], 0, 0
    s_mov_b32 s43, 0
    s_mul_i32 s36, s35, 256
    s_add_u32 s36, s36, 163328
    v_lshlrev_b32 v6, 4, v23
    v_add_u32 v6, s36, v6
    s_lshl_b32 s36, s37, 8
    s_add_u32 s36, s36, 160776
    v_lshlrev_b32 v7, 4, v22
    v_add_u32 v7, s36, v7
    s_add_u32 s16, s4, 0xa000000
    s_addc_u32 s17, s5, 0
    s_mov_b32 s18, 0x800000
    s_mov_b32 s19, 0x20000
    v_mul_u32_u24 v12, 65536, v23
    v_lshl_add_u32 v12, v22, 4, v12
    s_mul_i32 s39, s38, 131072
    s_lshl_b32 s36, s37, 8
    s_add_u32 s39, s39, s36
    s_add_u32 s39, s39, 16384
    s_lshl_b32 s36, s28, 11
    s_add_u32 s39, s39, s36
    s_lshr_b32 s36, s29, 2
    s_xor_b32 s36, s36, s94
    s_and_b32 s36, s36, 1
    s_lshl_b32 s36, s36, 13
    s_add_u32 s39, s39, s36
    s_add_u32 s40, s39, 262144
    s_lshr_b32 s36, s38, 1
    s_lshr_b32 s53, s36, 3
    s_lshl_b32 s53, s53, 14
    s_and_b32 s41, s36, 7
    s_lshl_b32 s41, s41, 10
    s_add_u32 s41, s41, s53
    s_lshl_b32 s36, s37, 16
    s_add_u32 s41, s41, s36
    s_mov_b32 s53, 0
    s_mov_b32 s49, s44
    ds_read_b64_tr_b16 v[56:57], v13 offset:0
    ds_read_b64_tr_b16 v[58:59], v13 offset:2048
    ds_read_b64_tr_b16 v[60:61], v14 offset:0
    ds_read_b64_tr_b16 v[62:63], v14 offset:2048
    ds_read_b64_tr_b16 v[64:65], v15 offset:0
    ds_read_b64_tr_b16 v[66:67], v15 offset:2048
    ds_read_b64_tr_b16 v[68:69], v16 offset:0
    ds_read_b64_tr_b16 v[70:71], v16 offset:2048
    ds_read_b64_tr_b16 v[72:73], v13 offset:4096
    ds_read_b64_tr_b16 v[74:75], v13 offset:6144
    ds_read_b64_tr_b16 v[76:77], v14 offset:4096
    ds_read_b64_tr_b16 v[78:79], v14 offset:6144
    ds_read_b64_tr_b16 v[80:81], v15 offset:4096
    ds_read_b64_tr_b16 v[82:83], v15 offset:6144
    ds_read_b64_tr_b16 v[84:85], v16 offset:4096
    ds_read_b64_tr_b16 v[86:87], v16 offset:6144
dm_18p:
    buffer_load_dwordx4 v[176:179], v126, s[8:11], s44 offen offset:0 sc1
    buffer_load_dwordx4 v[180:183], v127, s[8:11], s44 offen offset:0 sc1
    buffer_load_dwordx4 v[184:187], v126, s[8:11], s44 offen offset:1024 sc1
    buffer_load_dwordx4 v[188:191], v127, s[8:11], s44 offen offset:1024 sc1
    s_waitcnt vmcnt(0)
    v_or3_b32 v17, v176, v180, v184
    v_bitop3_b32 v17, v17, v188, 1 bitop3:0xa8
    v_cmp_ne_u32 vcc, 0, v17
    s_cbranch_vccz dm_18q
    s_sleep 2
    s_add_u32 s53, s53, 1
    s_cmp_lt_u32 s53, s61
    s_cbranch_scc1 dm_18p
    s_mov_b32 s61, 0
dm_18q:
    buffer_load_dwordx4 v[192:195], v126, s[8:11], s44 offen offset:2048 sc1
    buffer_load_dwordx4 v[196:199], v127, s[8:11], s44 offen offset:2048 sc1
    buffer_load_dwordx4 v[200:203], v126, s[8:11], s44 offen offset:3072 sc1
    buffer_load_dwordx4 v[204:207], v127, s[8:11], s44 offen offset:3072 sc1
    buffer_load_dwordx4 v[208:211], v128, s[8:11], s44 offen offset:0 sc1
    buffer_load_dwordx4 v[212:215], v129, s[8:11], s44 offen offset:0 sc1
    buffer_load_dwordx4 v[216:219], v128, s[8:11], s44 offen offset:1024 sc1
    buffer_load_dwordx4 v[220:223], v129, s[8:11], s44 offen offset:1024 sc1
    buffer_load_dwordx4 v[224:227], v128, s[8:11], s44 offen offset:2048 sc1
    buffer_load_dwordx4 v[228:231], v129, s[8:11], s44 offen offset:2048 sc1
    s_waitcnt lgkmcnt(0)
dm_18:
    v_mfma_f32_16x16x32_bf16 v[24:27], v[56:59], v[176:179], v[24:27]
    ds_read_b64_tr_b16 v[88:89], v13 offset:8192
    buffer_load_dwordx4 v[232:235], v128, s[8:11], s44 offen offset:3072 sc1
    v_mfma_f32_16x16x32_bf16 v[40:43], v[56:59], v[180:183], v[40:43]
    ds_read_b64_tr_b16 v[90:91], v13 offset:10240
    buffer_load_dwordx4 v[236:239], v129, s[8:11], s44 offen offset:3072 sc1
    v_mfma_f32_16x16x32_bf16 v[44:47], v[60:63], v[180:183], v[44:47]
    ds_read_b64_tr_b16 v[92:93], v14 offset:8192
    s_mov_b32 s44, s45
    v_mfma_f32_16x16x32_bf16 v[28:31], v[60:63], v[176:179], v[28:31]
    ds_read_b64_tr_b16 v[94:95], v14 offset:10240
    s_mov_b32 s45, s46
    v_mfma_f32_16x16x32_bf16 v[32:35], v[64:67], v[176:179], v[32:35]
    ds_read_b64_tr_b16 v[96:97], v15 offset:8192
    s_mov_b32 s46, s47
    v_mfma_f32_16x16x32_bf16 v[48:51], v[64:67], v[180:183], v[48:51]
    ds_read_b64_tr_b16 v[98:99], v15 offset:10240
    s_mov_b32 s47, 1048576
    v_mfma_f32_16x16x32_bf16 v[52:55], v[68:71], v[180:183], v[52:55]
    ds_read_b64_tr_b16 v[100:101], v16 offset:8192
    v_mfma_f32_16x16x32_bf16 v[36:39], v[68:71], v[176:179], v[36:39]
    ds_read_b64_tr_b16 v[102:103], v16 offset:10240
    s_waitcnt lgkmcnt(8)
    v_mfma_f32_16x16x32_bf16 v[24:27], v[72:75], v[184:187], v[24:27]
    ds_read_b64_tr_b16 v[104:105], v13 offset:12288
    buffer_load_dwordx4 v[176:179], v126, s[8:11], s44 offen offset:0 sc1
    v_mfma_f32_16x16x32_bf16 v[40:43], v[72:75], v[188:191], v[40:43]
    ds_read_b64_tr_b16 v[106:107], v13 offset:14336
    buffer_load_dwordx4 v[180:183], v127, s[8:11], s44 offen offset:0 sc1
    v_mfma_f32_16x16x32_bf16 v[44:47], v[76:79], v[188:191], v[44:47]
    ds_read_b64_tr_b16 v[108:109], v14 offset:12288
    s_waitcnt vmcnt(10)
    v_mfma_f32_16x16x32_bf16 v[28:31], v[76:79], v[184:187], v[28:31]
    ds_read_b64_tr_b16 v[110:111], v14 offset:14336
    v_or3_b32 v17, v192, v196, v200
    v_mfma_f32_16x16x32_bf16 v[32:35], v[80:83], v[184:187], v[32:35]
    ds_read_b64_tr_b16 v[112:113], v15 offset:12288
    v_bitop3_b32 v17, v17, v204, 1 bitop3:0xa8
    v_mfma_f32_16x16x32_bf16 v[48:51], v[80:83], v[188:191], v[48:51]
    ds_read_b64_tr_b16 v[114:115], v15 offset:14336
    v_cmp_ne_u32 vcc, 0, v17
    v_mfma_f32_16x16x32_bf16 v[52:55], v[84:87], v[188:191], v[52:55]
    ds_read_b64_tr_b16 v[116:117], v16 offset:12288
    ds_read_b64_tr_b16 v[118:119], v16 offset:14336
    v_mfma_f32_16x16x32_bf16 v[36:39], v[84:87], v[184:187], v[36:39]
    s_waitcnt lgkmcnt(8)
    s_cbranch_vccnz dm_18f0
dm_18g0:
    v_mfma_f32_16x16x32_bf16 v[24:27], v[88:91], v[192:195], v[24:27]
    ds_read_b64_tr_b16 v[56:57], v13 offset:16384
    buffer_load_dwordx4 v[184:187], v126, s[8:11], s44 offen offset:1024 sc1
    v_mfma_f32_16x16x32_bf16 v[40:43], v[88:91], v[196:199], v[40:43]
    ds_read_b64_tr_b16 v[58:59], v13 offset:18432
    buffer_load_dwordx4 v[188:191], v127, s[8:11], s44 offen offset:1024 sc1
    v_mfma_f32_16x16x32_bf16 v[44:47], v[92:95], v[196:199], v[44:47]
    ds_read_b64_tr_b16 v[60:61], v14 offset:16384
    v_mfma_f32_16x16x32_bf16 v[28:31], v[92:95], v[192:195], v[28:31]
    ds_read_b64_tr_b16 v[62:63], v14 offset:18432
    v_mfma_f32_16x16x32_bf16 v[32:35], v[96:99], v[192:195], v[32:35]
    ds_read_b64_tr_b16 v[64:65], v15 offset:16384
    v_mfma_f32_16x16x32_bf16 v[48:51], v[96:99], v[196:199], v[48:51]
    ds_read_b64_tr_b16 v[66:67], v15 offset:18432
    v_mfma_f32_16x16x32_bf16 v[52:55], v[100:103], v[196:199], v[52:55]
    ds_read_b64_tr_b16 v[68:69], v16 offset:16384
    v_mfma_f32_16x16x32_bf16 v[36:39], v[100:103], v[192:195], v[36:39]
    ds_read_b64_tr_b16 v[70:71], v16 offset:18432
    s_waitcnt lgkmcnt(8)
    v_mfma_f32_16x16x32_bf16 v[24:27], v[104:107], v[200:203], v[24:27]
    ds_read_b64_tr_b16 v[72:73], v13 offset:20480
    buffer_load_dwordx4 v[192:195], v126, s[8:11], s44 offen offset:2048 sc1
    v_mfma_f32_16x16x32_bf16 v[40:43], v[104:107], v[204:207], v[40:43]
    ds_read_b64_tr_b16 v[74:75], v13 offset:22528
    buffer_load_dwordx4 v[196:199], v127, s[8:11], s44 offen offset:2048 sc1
    v_mfma_f32_16x16x32_bf16 v[44:47], v[108:111], v[204:207], v[44:47]
    ds_read_b64_tr_b16 v[76:77], v14 offset:20480
    s_waitcnt vmcnt(10)
    v_mfma_f32_16x16x32_bf16 v[28:31], v[108:111], v[200:203], v[28:31]
    ds_read_b64_tr_b16 v[78:79], v14 offset:22528
    v_or3_b32 v17, v208, v212, v216
    v_mfma_f32_16x16x32_bf16 v[32:35], v[112:115], v[200:203], v[32:35]
    ds_read_b64_tr_b16 v[80:81], v15 offset:20480
    v_bitop3_b32 v17, v17, v220, 1 bitop3:0xa8
    v_mfma_f32_16x16x32_bf16 v[48:51], v[112:115], v[204:207], v[48:51]
    ds_read_b64_tr_b16 v[82:83], v15 offset:22528
    v_cmp_ne_u32 vcc, 0, v17
    v_mfma_f32_16x16x32_bf16 v[52:55], v[116:119], v[204:207], v[52:55]
    ds_read_b64_tr_b16 v[84:85], v16 offset:20480
    ds_read_b64_tr_b16 v[86:87], v16 offset:22528
    v_mfma_f32_16x16x32_bf16 v[36:39], v[116:119], v[200:203], v[36:39]
    s_waitcnt lgkmcnt(8)
    s_cbranch_vccnz dm_18f1
dm_18g1:
    v_mfma_f32_16x16x32_bf16 v[24:27], v[56:59], v[208:211], v[24:27]
    ds_read_b64_tr_b16 v[88:89], v13 offset:24576
    buffer_load_dwordx4 v[200:203], v126, s[8:11], s44 offen offset:3072 sc1
    v_mfma_f32_16x16x32_bf16 v[40:43], v[56:59], v[212:215], v[40:43]
    ds_read_b64_tr_b16 v[90:91], v13 offset:26624
    buffer_load_dwordx4 v[204:207], v127, s[8:11], s44 offen offset:3072 sc1
    v_mfma_f32_16x16x32_bf16 v[44:47], v[60:63], v[212:215], v[44:47]
    ds_read_b64_tr_b16 v[92:93], v14 offset:24576
    s_add_u32 s43, s43, 1
    v_mfma_f32_16x16x32_bf16 v[28:31], v[60:63], v[208:211], v[28:31]
    ds_read_b64_tr_b16 v[94:95], v14 offset:26624
    s_cmp_eq_u32 s43, 4
    v_mfma_f32_16x16x32_bf16 v[32:35], v[64:67], v[208:211], v[32:35]
    ds_read_b64_tr_b16 v[96:97], v15 offset:24576
    v_mfma_f32_16x16x32_bf16 v[48:51], v[64:67], v[212:215], v[48:51]
    ds_read_b64_tr_b16 v[98:99], v15 offset:26624
    v_mfma_f32_16x16x32_bf16 v[52:55], v[68:71], v[212:215], v[52:55]
    ds_read_b64_tr_b16 v[100:101], v16 offset:24576
    v_mfma_f32_16x16x32_bf16 v[36:39], v[68:71], v[208:211], v[36:39]
    ds_read_b64_tr_b16 v[102:103], v16 offset:26624
    s_waitcnt lgkmcnt(8)
    v_mfma_f32_16x16x32_bf16 v[24:27], v[72:75], v[216:219], v[24:27]
    ds_read_b64_tr_b16 v[104:105], v13 offset:28672
    buffer_load_dwordx4 v[208:211], v128, s[8:11], s44 offen offset:0 sc1
    v_mfma_f32_16x16x32_bf16 v[40:43], v[72:75], v[220:223], v[40:43]
    ds_read_b64_tr_b16 v[106:107], v13 offset:30720
    buffer_load_dwordx4 v[212:215], v129, s[8:11], s44 offen offset:0 sc1
    v_mfma_f32_16x16x32_bf16 v[44:47], v[76:79], v[220:223], v[44:47]
    ds_read_b64_tr_b16 v[108:109], v14 offset:28672
    s_waitcnt vmcnt(10)
    v_mfma_f32_16x16x32_bf16 v[28:31], v[76:79], v[216:219], v[28:31]
    ds_read_b64_tr_b16 v[110:111], v14 offset:30720
    v_add_u32 v13, 32768, v13
    v_or3_b32 v17, v224, v228, v232
    v_mfma_f32_16x16x32_bf16 v[32:35], v[80:83], v[216:219], v[32:35]
    ds_read_b64_tr_b16 v[112:113], v15 offset:28672
    v_add_u32 v14, 32768, v14
    v_bitop3_b32 v17, v17, v236, 1 bitop3:0xa8
    v_mfma_f32_16x16x32_bf16 v[48:51], v[80:83], v[220:223], v[48:51]
    ds_read_b64_tr_b16 v[114:115], v15 offset:30720
    v_add_u32 v15, 32768, v15
    v_cmp_ne_u32 vcc, 0, v17
    v_mfma_f32_16x16x32_bf16 v[52:55], v[84:87], v[220:223], v[52:55]
    ds_read_b64_tr_b16 v[116:117], v16 offset:28672
    ds_read_b64_tr_b16 v[118:119], v16 offset:30720
    v_mfma_f32_16x16x32_bf16 v[36:39], v[84:87], v[216:219], v[36:39]
    v_add_u32 v16, 32768, v16
    s_waitcnt lgkmcnt(8)
    s_cbranch_vccnz dm_18f2
dm_18g2:
    s_cbranch_scc1 dm_18x
    v_mfma_f32_16x16x32_bf16 v[24:27], v[88:91], v[224:227], v[24:27]
    ds_read_b64_tr_b16 v[56:57], v13 offset:0
    buffer_load_dwordx4 v[216:219], v128, s[8:11], s44 offen offset:1024 sc1
    v_mfma_f32_16x16x32_bf16 v[40:43], v[88:91], v[228:231], v[40:43]
    ds_read_b64_tr_b16 v[58:59], v13 offset:2048
    buffer_load_dwordx4 v[220:223], v129, s[8:11], s44 offen offset:1024 sc1
    v_mfma_f32_16x16x32_bf16 v[44:47], v[92:95], v[228:231], v[44:47]
    ds_read_b64_tr_b16 v[60:61], v14 offset:0
    s_mov_b32 s49, s44
    v_mfma_f32_16x16x32_bf16 v[28:31], v[92:95], v[224:227], v[28:31]
    ds_read_b64_tr_b16 v[62:63], v14 offset:2048
    v_mfma_f32_16x16x32_bf16 v[32:35], v[96:99], v[224:227], v[32:35]
    ds_read_b64_tr_b16 v[64:65], v15 offset:0
    v_mfma_f32_16x16x32_bf16 v[48:51], v[96:99], v[228:231], v[48:51]
    ds_read_b64_tr_b16 v[66:67], v15 offset:2048
    v_mfma_f32_16x16x32_bf16 v[52:55], v[100:103], v[228:231], v[52:55]
    ds_read_b64_tr_b16 v[68:69], v16 offset:0
    v_mfma_f32_16x16x32_bf16 v[36:39], v[100:103], v[224:227], v[36:39]
    ds_read_b64_tr_b16 v[70:71], v16 offset:2048
    s_waitcnt lgkmcnt(8)
    v_mfma_f32_16x16x32_bf16 v[24:27], v[104:107], v[232:235], v[24:27]
    ds_read_b64_tr_b16 v[72:73], v13 offset:4096
    buffer_load_dwordx4 v[224:227], v128, s[8:11], s44 offen offset:2048 sc1
    v_mfma_f32_16x16x32_bf16 v[40:43], v[104:107], v[236:239], v[40:43]
    ds_read_b64_tr_b16 v[74:75], v13 offset:6144
    buffer_load_dwordx4 v[228:231], v129, s[8:11], s44 offen offset:2048 sc1
    v_mfma_f32_16x16x32_bf16 v[44:47], v[108:111], v[236:239], v[44:47]
    ds_read_b64_tr_b16 v[76:77], v14 offset:4096
    s_waitcnt vmcnt(10)
    v_mfma_f32_16x16x32_bf16 v[28:31], v[108:111], v[232:235], v[28:31]
    ds_read_b64_tr_b16 v[78:79], v14 offset:6144
    v_or3_b32 v17, v176, v180, v184
    v_mfma_f32_16x16x32_bf16 v[32:35], v[112:115], v[232:235], v[32:35]
    ds_read_b64_tr_b16 v[80:81], v15 offset:4096
    v_bitop3_b32 v17, v17, v188, 1 bitop3:0xa8
    v_mfma_f32_16x16x32_bf16 v[48:51], v[112:115], v[236:239], v[48:51]
    ds_read_b64_tr_b16 v[82:83], v15 offset:6144
    v_cmp_ne_u32 vcc, 0, v17
    v_mfma_f32_16x16x32_bf16 v[52:55], v[116:119], v[236:239], v[52:55]
    ds_read_b64_tr_b16 v[84:85], v16 offset:4096
    ds_read_b64_tr_b16 v[86:87], v16 offset:6144
    v_mfma_f32_16x16x32_bf16 v[36:39], v[116:119], v[232:235], v[36:39]
    s_waitcnt lgkmcnt(8)
    s_cbranch_vccnz dm_18f3
dm_18g3:
    s_branch dm_18
dm_18f0:
    s_cselect_b32 s50, 1, 0
dm_18h0:
    s_sleep 2
    buffer_load_dwordx4 v[192:195], v126, s[8:11], s49 offen offset:2048 sc1
    buffer_load_dwordx4 v[196:199], v127, s[8:11], s49 offen offset:2048 sc1
    buffer_load_dwordx4 v[200:203], v126, s[8:11], s49 offen offset:3072 sc1
    buffer_load_dwordx4 v[204:207], v127, s[8:11], s49 offen offset:3072 sc1
    buffer_load_dwordx4 v[208:211], v128, s[8:11], s49 offen offset:0 sc1
    buffer_load_dwordx4 v[212:215], v129, s[8:11], s49 offen offset:0 sc1
    buffer_load_dwordx4 v[216:219], v128, s[8:11], s49 offen offset:1024 sc1
    buffer_load_dwordx4 v[220:223], v129, s[8:11], s49 offen offset:1024 sc1
    buffer_load_dwordx4 v[224:227], v128, s[8:11], s49 offen offset:2048 sc1
    buffer_load_dwordx4 v[228:231], v129, s[8:11], s49 offen offset:2048 sc1
    buffer_load_dwordx4 v[232:235], v128, s[8:11], s49 offen offset:3072 sc1
    buffer_load_dwordx4 v[236:239], v129, s[8:11], s49 offen offset:3072 sc1
    buffer_load_dwordx4 v[176:179], v126, s[8:11], s44 offen offset:0 sc1
    buffer_load_dwordx4 v[180:183], v127, s[8:11], s44 offen offset:0 sc1
    s_waitcnt vmcnt(10)
    v_or3_b32 v17, v192, v196, v200
    v_bitop3_b32 v17, v17, v204, 1 bitop3:0xa8
    v_cmp_ne_u32 vcc, 0, v17
    s_add_u32 s53, s53, 1
    s_cmp_ge_u32 s53, s61
    s_cselect_b32 s61, 0, s61
    s_cbranch_scc1 dm_18k0
    s_cbranch_vccnz dm_18h0
dm_18k0:
    s_cmp_eq_u32 s50, 1
    s_branch dm_18g0
dm_18f1:
    s_cselect_b32 s50, 1, 0
dm_18h1:
    s_sleep 2
    buffer_load_dwordx4 v[208:211], v128, s[8:11], s49 offen offset:0 sc1
    buffer_load_dwordx4 v[212:215], v129, s[8:11], s49 offen offset:0 sc1
    buffer_load_dwordx4 v[216:219], v128, s[8:11], s49 offen offset:1024 sc1
    buffer_load_dwordx4 v[220:223], v129, s[8:11], s49 offen offset:1024 sc1
    buffer_load_dwordx4 v[224:227], v128, s[8:11], s49 offen offset:2048 sc1
    buffer_load_dwordx4 v[228:231], v129, s[8:11], s49 offen offset:2048 sc1
    buffer_load_dwordx4 v[232:235], v128, s[8:11], s49 offen offset:3072 sc1
    buffer_load_dwordx4 v[236:239], v129, s[8:11], s49 offen offset:3072 sc1
    buffer_load_dwordx4 v[176:179], v126, s[8:11], s44 offen offset:0 sc1
    buffer_load_dwordx4 v[180:183], v127, s[8:11], s44 offen offset:0 sc1
    buffer_load_dwordx4 v[184:187], v126, s[8:11], s44 offen offset:1024 sc1
    buffer_load_dwordx4 v[188:191], v127, s[8:11], s44 offen offset:1024 sc1
    buffer_load_dwordx4 v[192:195], v126, s[8:11], s44 offen offset:2048 sc1
    buffer_load_dwordx4 v[196:199], v127, s[8:11], s44 offen offset:2048 sc1
    s_waitcnt vmcnt(10)
    v_or3_b32 v17, v208, v212, v216
    v_bitop3_b32 v17, v17, v220, 1 bitop3:0xa8
    v_cmp_ne_u32 vcc, 0, v17
    s_add_u32 s53, s53, 1
    s_cmp_ge_u32 s53, s61
    s_cselect_b32 s61, 0, s61
    s_cbranch_scc1 dm_18k1
    s_cbranch_vccnz dm_18h1
dm_18k1:
    s_cmp_eq_u32 s50, 1
    s_branch dm_18g1
dm_18f2:
    s_cselect_b32 s50, 1, 0
dm_18h2:
    s_sleep 2
    buffer_load_dwordx4 v[224:227], v128, s[8:11], s49 offen offset:2048 sc1
    buffer_load_dwordx4 v[228:231], v129, s[8:11], s49 offen offset:2048 sc1
    buffer_load_dwordx4 v[232:235], v128, s[8:11], s49 offen offset:3072 sc1
    buffer_load_dwordx4 v[236:239], v129, s[8:11], s49 offen offset:3072 sc1
    buffer_load_dwordx4 v[176:179], v126, s[8:11], s44 offen offset:0 sc1
    buffer_load_dwordx4 v[180:183], v127, s[8:11], s44 offen offset:0 sc1
    buffer_load_dwordx4 v[184:187], v126, s[8:11], s44 offen offset:1024 sc1
    buffer_load_dwordx4 v[188:191], v127, s[8:11], s44 offen offset:1024 sc1
    buffer_load_dwordx4 v[192:195], v126, s[8:11], s44 offen offset:2048 sc1
    buffer_load_dwordx4 v[196:199], v127, s[8:11], s44 offen offset:2048 sc1
    buffer_load_dwordx4 v[200:203], v126, s[8:11], s44 offen offset:3072 sc1
    buffer_load_dwordx4 v[204:207], v127, s[8:11], s44 offen offset:3072 sc1
    buffer_load_dwordx4 v[208:211], v128, s[8:11], s44 offen offset:0 sc1
    buffer_load_dwordx4 v[212:215], v129, s[8:11], s44 offen offset:0 sc1
    s_waitcnt vmcnt(10)
    v_or3_b32 v17, v224, v228, v232
    v_bitop3_b32 v17, v17, v236, 1 bitop3:0xa8
    v_cmp_ne_u32 vcc, 0, v17
    s_add_u32 s53, s53, 1
    s_cmp_ge_u32 s53, s61
    s_cselect_b32 s61, 0, s61
    s_cbranch_scc1 dm_18k2
    s_cbranch_vccnz dm_18h2
dm_18k2:
    s_cmp_eq_u32 s50, 1
    s_branch dm_18g2
dm_18f3:
    s_cselect_b32 s50, 1, 0
dm_18h3:
    s_sleep 2
    buffer_load_dwordx4 v[176:179], v126, s[8:11], s49 offen offset:0 sc1
    buffer_load_dwordx4 v[180:183], v127, s[8:11], s49 offen offset:0 sc1
    buffer_load_dwordx4 v[184:187], v126, s[8:11], s49 offen offset:1024 sc1
    buffer_load_dwordx4 v[188:191], v127, s[8:11], s49 offen offset:1024 sc1
    buffer_load_dwordx4 v[192:195], v126, s[8:11], s49 offen offset:2048 sc1
    buffer_load_dwordx4 v[196:199], v127, s[8:11], s49 offen offset:2048 sc1
    buffer_load_dwordx4 v[200:203], v126, s[8:11], s49 offen offset:3072 sc1
    buffer_load_dwordx4 v[204:207], v127, s[8:11], s49 offen offset:3072 sc1
    buffer_load_dwordx4 v[208:211], v128, s[8:11], s49 offen offset:0 sc1
    buffer_load_dwordx4 v[212:215], v129, s[8:11], s49 offen offset:0 sc1
    buffer_load_dwordx4 v[216:219], v128, s[8:11], s49 offen offset:1024 sc1
    buffer_load_dwordx4 v[220:223], v129, s[8:11], s49 offen offset:1024 sc1
    buffer_load_dwordx4 v[224:227], v128, s[8:11], s49 offen offset:2048 sc1
    buffer_load_dwordx4 v[228:231], v129, s[8:11], s49 offen offset:2048 sc1
    s_waitcnt vmcnt(10)
    v_or3_b32 v17, v176, v180, v184
    v_bitop3_b32 v17, v17, v188, 1 bitop3:0xa8
    v_cmp_ne_u32 vcc, 0, v17
    s_add_u32 s53, s53, 1
    s_cmp_ge_u32 s53, s61
    s_cselect_b32 s61, 0, s61
    s_cbranch_scc1 dm_18k3
    s_cbranch_vccnz dm_18h3
dm_18k3:
    s_cmp_eq_u32 s50, 1
    s_branch dm_18g3
dm_18x:
    v_mfma_f32_16x16x32_bf16 v[24:27], v[88:91], v[224:227], v[24:27]
    buffer_load_dwordx4 v[160:163], v126, s[8:11], s41 offen offset:0 sc1
    v_mfma_f32_16x16x32_bf16 v[40:43], v[88:91], v[228:231], v[40:43]
    v_mfma_f32_16x16x32_bf16 v[44:47], v[92:95], v[228:231], v[44:47]
    buffer_load_dwordx4 v[164:167], v126, s[8:11], s41 offen offset:1024 sc1
    v_mfma_f32_16x16x32_bf16 v[28:31], v[92:95], v[224:227], v[28:31]
    v_mfma_f32_16x16x32_bf16 v[32:35], v[96:99], v[224:227], v[32:35]
    buffer_load_dwordx4 v[168:171], v127, s[8:11], s41 offen offset:0 sc1
    v_mfma_f32_16x16x32_bf16 v[48:51], v[96:99], v[228:231], v[48:51]
    v_mfma_f32_16x16x32_bf16 v[52:55], v[100:103], v[228:231], v[52:55]
    buffer_load_dwordx4 v[172:175], v127, s[8:11], s41 offen offset:1024 sc1
    v_mfma_f32_16x16x32_bf16 v[36:39], v[100:103], v[224:227], v[36:39]
    s_waitcnt lgkmcnt(0)
    s_barrier
    v_mfma_f32_16x16x32_bf16 v[24:27], v[104:107], v[232:235], v[24:27]
    ds_read_b128 v[56:59], v6 offset:0
    v_mfma_f32_16x16x32_bf16 v[40:43], v[104:107], v[236:239], v[40:43]
    ds_read_b128 v[60:63], v6 offset:64
    v_mfma_f32_16x16x32_bf16 v[44:47], v[108:111], v[236:239], v[44:47]
    ds_read_b128 v[64:67], v6 offset:128
    v_mfma_f32_16x16x32_bf16 v[28:31], v[108:111], v[232:235], v[28:31]
    ds_read_b128 v[68:71], v6 offset:192
    v_mfma_f32_16x16x32_bf16 v[32:35], v[112:115], v[232:235], v[32:35]
    ds_read_b64 v[72:73], v7 offset:0
    v_mfma_f32_16x16x32_bf16 v[48:51], v[112:115], v[236:239], v[48:51]
    ds_read_b64 v[74:75], v7 offset:256
    v_mfma_f32_16x16x32_bf16 v[52:55], v[116:119], v[236:239], v[52:55]
    v_mfma_f32_16x16x32_bf16 v[36:39], v[116:119], v[232:235], v[36:39]
    s_waitcnt lgkmcnt(0)
    v_mul_f32 v134, 0xc0135761, v73
    v_mul_f32 v135, v73, v73
    v_mul_f32 v135, v135, v134
    v_mul_f32 v135, 0x3d372713, v135
    v_rcp_f32 v73, v73
    v_mul_f32 v136, 0xc0135761, v75
    v_mul_f32 v137, v75, v75
    v_mul_f32 v137, v137, v136
    v_mul_f32 v137, 0x3d372713, v137
    v_rcp_f32 v75, v75
    v_pk_fma_f32 v[24:25], v[72:73], v[56:57], v[24:25] op_sel_hi:[0,1,1] neg_lo:[1,0,0] neg_hi:[1,0,0]
    v_pk_fma_f32 v[26:27], v[72:73], v[58:59], v[26:27] op_sel_hi:[0,1,1] neg_lo:[1,0,0] neg_hi:[1,0,0]
    v_pk_mul_f32 v[122:123], v[24:25], v[24:25]
    v_pk_mul_f32 v[124:125], v[26:27], v[26:27]
    v_pk_fma_f32 v[122:123], v[122:123], v[134:135], v[134:135] op_sel:[0,1,0] op_sel_hi:[1,1,0]
    v_pk_fma_f32 v[124:125], v[124:125], v[134:135], v[134:135] op_sel:[0,1,0] op_sel_hi:[1,1,0]
    v_pk_mul_f32 v[122:123], v[122:123], v[24:25]
    v_pk_mul_f32 v[124:125], v[124:125], v[26:27]
    v_exp_f32 v122, v122
    v_exp_f32 v123, v123
    v_exp_f32 v124, v124
    v_exp_f32 v125, v125
    v_pk_fma_f32 v[122:123], v[122:123], v[72:73], v[72:73] op_sel:[0,1,1] op_sel_hi:[1,1,1]
    v_pk_fma_f32 v[124:125], v[124:125], v[72:73], v[72:73] op_sel:[0,1,1] op_sel_hi:[1,1,1]
    v_rcp_f32 v122, v122
    v_rcp_f32 v123, v123
    v_rcp_f32 v124, v124
    v_rcp_f32 v125, v125
    v_pk_mul_f32 v[24:25], v[24:25], v[122:123]
    v_pk_mul_f32 v[26:27], v[26:27], v[124:125]
    v_pk_fma_f32 v[28:29], v[72:73], v[60:61], v[28:29] op_sel_hi:[0,1,1] neg_lo:[1,0,0] neg_hi:[1,0,0]
    v_pk_fma_f32 v[30:31], v[72:73], v[62:63], v[30:31] op_sel_hi:[0,1,1] neg_lo:[1,0,0] neg_hi:[1,0,0]
    v_pk_mul_f32 v[122:123], v[28:29], v[28:29]
    v_pk_mul_f32 v[124:125], v[30:31], v[30:31]
    v_pk_fma_f32 v[122:123], v[122:123], v[134:135], v[134:135] op_sel:[0,1,0] op_sel_hi:[1,1,0]
    v_pk_fma_f32 v[124:125], v[124:125], v[134:135], v[134:135] op_sel:[0,1,0] op_sel_hi:[1,1,0]
    v_pk_mul_f32 v[122:123], v[122:123], v[28:29]
    v_pk_mul_f32 v[124:125], v[124:125], v[30:31]
    v_exp_f32 v122, v122
    v_exp_f32 v123, v123
    v_exp_f32 v124, v124
    v_exp_f32 v125, v125
    v_pk_fma_f32 v[122:123], v[122:123], v[72:73], v[72:73] op_sel:[0,1,1] op_sel_hi:[1,1,1]
    v_pk_fma_f32 v[124:125], v[124:125], v[72:73], v[72:73] op_sel:[0,1,1] op_sel_hi:[1,1,1]
    v_rcp_f32 v122, v122
    v_rcp_f32 v123, v123
    v_rcp_f32 v124, v124
    v_rcp_f32 v125, v125
    v_pk_mul_f32 v[28:29], v[28:29], v[122:123]
    v_pk_mul_f32 v[30:31], v[30:31], v[124:125]
    v_cvt_pk_bf16_f32 v24, v24, v25
    v_cvt_pk_bf16_f32 v25, v26, v27
    v_cvt_pk_bf16_f32 v26, v28, v29
    v_cvt_pk_bf16_f32 v27, v30, v31
    v_and_or_b32 v24, v24, -2, s60
    buffer_store_dwordx4 v[24:27], v12, s[16:19], s39 offen offset:0 sc1
    v_pk_fma_f32 v[40:41], v[74:75], v[56:57], v[40:41] op_sel_hi:[0,1,1] neg_lo:[1,0,0] neg_hi:[1,0,0]
    v_pk_fma_f32 v[42:43], v[74:75], v[58:59], v[42:43] op_sel_hi:[0,1,1] neg_lo:[1,0,0] neg_hi:[1,0,0]
    v_pk_mul_f32 v[122:123], v[40:41], v[40:41]
    v_pk_mul_f32 v[124:125], v[42:43], v[42:43]
    v_pk_fma_f32 v[122:123], v[122:123], v[136:137], v[136:137] op_sel:[0,1,0] op_sel_hi:[1,1,0]
    v_pk_fma_f32 v[124:125], v[124:125], v[136:137], v[136:137] op_sel:[0,1,0] op_sel_hi:[1,1,0]
    v_pk_mul_f32 v[122:123], v[122:123], v[40:41]
    v_pk_mul_f32 v[124:125], v[124:125], v[42:43]
    v_exp_f32 v122, v122
    v_exp_f32 v123, v123
    v_exp_f32 v124, v124
    v_exp_f32 v125, v125
    v_pk_fma_f32 v[122:123], v[122:123], v[74:75], v[74:75] op_sel:[0,1,1] op_sel_hi:[1,1,1]
    v_pk_fma_f32 v[124:125], v[124:125], v[74:75], v[74:75] op_sel:[0,1,1] op_sel_hi:[1,1,1]
    v_rcp_f32 v122, v122
    v_rcp_f32 v123, v123
    v_rcp_f32 v124, v124
    v_rcp_f32 v125, v125
    v_pk_mul_f32 v[40:41], v[40:41], v[122:123]
    v_pk_mul_f32 v[42:43], v[42:43], v[124:125]
    v_pk_fma_f32 v[44:45], v[74:75], v[60:61], v[44:45] op_sel_hi:[0,1,1] neg_lo:[1,0,0] neg_hi:[1,0,0]
    v_pk_fma_f32 v[46:47], v[74:75], v[62:63], v[46:47] op_sel_hi:[0,1,1] neg_lo:[1,0,0] neg_hi:[1,0,0]
    v_pk_mul_f32 v[122:123], v[44:45], v[44:45]
    v_pk_mul_f32 v[124:125], v[46:47], v[46:47]
    v_pk_fma_f32 v[122:123], v[122:123], v[136:137], v[136:137] op_sel:[0,1,0] op_sel_hi:[1,1,0]
    v_pk_fma_f32 v[124:125], v[124:125], v[136:137], v[136:137] op_sel:[0,1,0] op_sel_hi:[1,1,0]
    v_pk_mul_f32 v[122:123], v[122:123], v[44:45]
    v_pk_mul_f32 v[124:125], v[124:125], v[46:47]
    v_exp_f32 v122, v122
    v_exp_f32 v123, v123
    v_exp_f32 v124, v124
    v_exp_f32 v125, v125
    v_pk_fma_f32 v[122:123], v[122:123], v[74:75], v[74:75] op_sel:[0,1,1] op_sel_hi:[1,1,1]
    v_pk_fma_f32 v[124:125], v[124:125], v[74:75], v[74:75] op_sel:[0,1,1] op_sel_hi:[1,1,1]
    v_rcp_f32 v122, v122
    v_rcp_f32 v123, v123
    v_rcp_f32 v124, v124
    v_rcp_f32 v125, v125
    v_pk_mul_f32 v[44:45], v[44:45], v[122:123]
    v_pk_mul_f32 v[46:47], v[46:47], v[124:125]
    v_cvt_pk_bf16_f32 v40, v40, v41
    v_cvt_pk_bf16_f32 v41, v42, v43
    v_cvt_pk_bf16_f32 v42, v44, v45
    v_cvt_pk_bf16_f32 v43, v46, v47
    v_and_or_b32 v40, v40, -2, s60
    buffer_store_dwordx4 v[40:43], v12, s[16:19], s39 offen offset:256 sc1
    v_pk_fma_f32 v[32:33], v[72:73], v[64:65], v[32:33] op_sel_hi:[0,1,1] neg_lo:[1,0,0] neg_hi:[1,0,0]
    v_pk_fma_f32 v[34:35], v[72:73], v[66:67], v[34:35] op_sel_hi:[0,1,1] neg_lo:[1,0,0] neg_hi:[1,0,0]
    v_pk_mul_f32 v[122:123], v[32:33], v[32:33]
    v_pk_mul_f32 v[124:125], v[34:35], v[34:35]
    v_pk_fma_f32 v[122:123], v[122:123], v[134:135], v[134:135] op_sel:[0,1,0] op_sel_hi:[1,1,0]
    v_pk_fma_f32 v[124:125], v[124:125], v[134:135], v[134:135] op_sel:[0,1,0] op_sel_hi:[1,1,0]
    v_pk_mul_f32 v[122:123], v[122:123], v[32:33]
    v_pk_mul_f32 v[124:125], v[124:125], v[34:35]
    v_exp_f32 v122, v122
    v_exp_f32 v123, v123
    v_exp_f32 v124, v124
    v_exp_f32 v125, v125
    v_pk_fma_f32 v[122:123], v[122:123], v[72:73], v[72:73] op_sel:[0,1,1] op_sel_hi:[1,1,1]
    v_pk_fma_f32 v[124:125], v[124:125], v[72:73], v[72:73] op_sel:[0,1,1] op_sel_hi:[1,1,1]
    v_rcp_f32 v122, v122
    v_rcp_f32 v123, v123
    v_rcp_f32 v124, v124
    v_rcp_f32 v125, v125
    v_pk_mul_f32 v[32:33], v[32:33], v[122:123]
    v_pk_mul_f32 v[34:35], v[34:35], v[124:125]
    v_pk_fma_f32 v[36:37], v[72:73], v[68:69], v[36:37] op_sel_hi:[0,1,1] neg_lo:[1,0,0] neg_hi:[1,0,0]
    v_pk_fma_f32 v[38:39], v[72:73], v[70:71], v[38:39] op_sel_hi:[0,1,1] neg_lo:[1,0,0] neg_hi:[1,0,0]
    v_pk_mul_f32 v[122:123], v[36:37], v[36:37]
    v_pk_mul_f32 v[124:125], v[38:39], v[38:39]
    v_pk_fma_f32 v[122:123], v[122:123], v[134:135], v[134:135] op_sel:[0,1,0] op_sel_hi:[1,1,0]
    v_pk_fma_f32 v[124:125], v[124:125], v[134:135], v[134:135] op_sel:[0,1,0] op_sel_hi:[1,1,0]
    v_pk_mul_f32 v[122:123], v[122:123], v[36:37]
    v_pk_mul_f32 v[124:125], v[124:125], v[38:39]
    v_exp_f32 v122, v122
    v_exp_f32 v123, v123
    v_exp_f32 v124, v124
    v_exp_f32 v125, v125
    v_pk_fma_f32 v[122:123], v[122:123], v[72:73], v[72:73] op_sel:[0,1,1] op_sel_hi:[1,1,1]
    v_pk_fma_f32 v[124:125], v[124:125], v[72:73], v[72:73] op_sel:[0,1,1] op_sel_hi:[1,1,1]
    v_rcp_f32 v122, v122
    v_rcp_f32 v123, v123
    v_rcp_f32 v124, v124
    v_rcp_f32 v125, v125
    v_pk_mul_f32 v[36:37], v[36:37], v[122:123]
    v_pk_mul_f32 v[38:39], v[38:39], v[124:125]
    v_cvt_pk_bf16_f32 v32, v32, v33
    v_cvt_pk_bf16_f32 v33, v34, v35
    v_cvt_pk_bf16_f32 v34, v36, v37
    v_cvt_pk_bf16_f32 v35, v38, v39
    v_and_or_b32 v32, v32, -2, s60
    buffer_store_dwordx4 v[32:35], v12, s[16:19], s40 offen offset:0 sc1
    v_pk_fma_f32 v[48:49], v[74:75], v[64:65], v[48:49] op_sel_hi:[0,1,1] neg_lo:[1,0,0] neg_hi:[1,0,0]
    v_pk_fma_f32 v[50:51], v[74:75], v[66:67], v[50:51] op_sel_hi:[0,1,1] neg_lo:[1,0,0] neg_hi:[1,0,0]
    v_pk_mul_f32 v[122:123], v[48:49], v[48:49]
    v_pk_mul_f32 v[124:125], v[50:51], v[50:51]
    v_pk_fma_f32 v[122:123], v[122:123], v[136:137], v[136:137] op_sel:[0,1,0] op_sel_hi:[1,1,0]
    v_pk_fma_f32 v[124:125], v[124:125], v[136:137], v[136:137] op_sel:[0,1,0] op_sel_hi:[1,1,0]
    v_pk_mul_f32 v[122:123], v[122:123], v[48:49]
    v_pk_mul_f32 v[124:125], v[124:125], v[50:51]
    v_exp_f32 v122, v122
    v_exp_f32 v123, v123
    v_exp_f32 v124, v124
    v_exp_f32 v125, v125
    v_pk_fma_f32 v[122:123], v[122:123], v[74:75], v[74:75] op_sel:[0,1,1] op_sel_hi:[1,1,1]
    v_pk_fma_f32 v[124:125], v[124:125], v[74:75], v[74:75] op_sel:[0,1,1] op_sel_hi:[1,1,1]
    v_rcp_f32 v122, v122
    v_rcp_f32 v123, v123
    v_rcp_f32 v124, v124
    v_rcp_f32 v125, v125
    v_pk_mul_f32 v[48:49], v[48:49], v[122:123]
    v_pk_mul_f32 v[50:51], v[50:51], v[124:125]
    v_pk_fma_f32 v[52:53], v[74:75], v[68:69], v[52:53] op_sel_hi:[0,1,1] neg_lo:[1,0,0] neg_hi:[1,0,0]
    v_pk_fma_f32 v[54:55], v[74:75], v[70:71], v[54:55] op_sel_hi:[0,1,1] neg_lo:[1,0,0] neg_hi:[1,0,0]
    v_pk_mul_f32 v[122:123], v[52:53], v[52:53]
    v_pk_mul_f32 v[124:125], v[54:55], v[54:55]
    v_pk_fma_f32 v[122:123], v[122:123], v[136:137], v[136:137] op_sel:[0,1,0] op_sel_hi:[1,1,0]
    v_pk_fma_f32 v[124:125], v[124:125], v[136:137], v[136:137] op_sel:[0,1,0] op_sel_hi:[1,1,0]
    v_pk_mul_f32 v[122:123], v[122:123], v[52:53]
    v_pk_mul_f32 v[124:125], v[124:125], v[54:55]
    v_exp_f32 v122, v122
    v_exp_f32 v123, v123
    v_exp_f32 v124, v124
    v_exp_f32 v125, v125
    v_pk_fma_f32 v[122:123], v[122:123], v[74:75], v[74:75] op_sel:[0,1,1] op_sel_hi:[1,1,1]
    v_pk_fma_f32 v[124:125], v[124:125], v[74:75], v[74:75] op_sel:[0,1,1] op_sel_hi:[1,1,1]
    v_rcp_f32 v122, v122
    v_rcp_f32 v123, v123
    v_rcp_f32 v124, v124
    v_rcp_f32 v125, v125
    v_pk_mul_f32 v[52:53], v[52:53], v[122:123]
    v_pk_mul_f32 v[54:55], v[54:55], v[124:125]
    v_cvt_pk_bf16_f32 v48, v48, v49
    v_cvt_pk_bf16_f32 v49, v50, v51
    v_cvt_pk_bf16_f32 v50, v52, v53
    v_cvt_pk_bf16_f32 v51, v54, v55
    v_and_or_b32 v48, v48, -2, s60
    buffer_store_dwordx4 v[48:51], v12, s[16:19], s40 offen offset:256 sc1
    s_cmp_lg_u32 s60, 0
    s_cbranch_scc1 G1_np
    s_add_u32 s53, s55, 256
    s_and_b32 s54, s29, 4
    s_lshl_b32 s54, s54, 5
    s_add_u32 s53, s53, s54
    v_mov_b32 v8, 1
    v_mov_b32 v9, 162816
    v_mov_b32 v11, 0
    s_mov_b64 exec, 1
    s_waitcnt vmcnt(0)
    ds_add_rtn_u32 v10, v9, v8
    s_waitcnt lgkmcnt(0)
    v_readfirstlane_b32 s54, v10
    s_nop 0
    s_and_b32 s54, s54, 3
    s_cmp_lg_u32 s54, 3
    s_cbranch_scc1 pub_19
    buffer_atomic_add v8, v11, s[56:59], s53 offen sc1
    v_mov_b32 v9, 162872
    ds_add_u32 v9, v8
pub_19:
    s_mov_b64 exec, -1
G1_np:
    s_mov_b32 s34, s30
    s_mov_b32 s35, 0
    v_and_b32 v22, 15, v1
    v_lshrrev_b32 v23, 4, v1
    s_mul_i32 s37, s34, 2
    s_mul_i32 s38, s29, 4
    s_mul_i32 s36, s35, 4
    s_add_u32 s38, s38, s36
    s_lshr_b32 s36, s38, 1
    s_lshr_b32 s53, s36, 3
    s_lshl_b32 s53, s53, 14
    s_and_b32 s39, s36, 7
    s_lshl_b32 s39, s39, 10
    s_add_u32 s39, s39, s53
    s_lshl_b32 s36, s37, 16
    s_add_u32 s39, s39, s36
    s_add_u32 s8, s4, 0xa000000
    s_addc_u32 s9, s5, 0
    s_mov_b32 s10, 0x800000
    s_mov_b32 s11, 0x20000
    v_mul_u32_u24 v126, 65536, v23
    v_lshl_add_u32 v126, v22, 4, v126
    v_add_u32 v127, 262144, v126
    v_add_u32 v128, 524288, v126
    v_add_u32 v129, 786432, v126
    v_add_u32 v130, 1048576, v126
    v_add_u32 v131, 1310720, v126
    v_add_u32 v132, 1572864, v126
    v_add_u32 v133, 1835008, v126
    s_lshr_b32 s36, s67, 2
    s_add_u32 s36, s36, 0
    s_and_b32 s36, s36, 3
    s_mul_i32 s44, s36, 2097152
    s_xor_b32 s53, s36, s94
    s_and_b32 s53, s53, 1
    s_lshl_b32 s53, s53, 13
    s_add_u32 s44, s44, s53
    s_lshr_b32 s53, s36, 1
    s_lshl_b32 s53, s53, 4
    s_add_u32 s53, s53, 16
    s_sub_u32 s54, 0, s53
    s_bitcmp1_b32 s36, 0
    s_cselect_b32 s53, s53, s54
    s_add_u32 s44, s44, s53
    s_lshl_b32 s36, s28, 2
    s_add_u32 s36, s36, s34
    s_lshl_b32 s36, s36, 9
    s_add_u32 s36, s36, 16384
    s_add_u32 s44, s44, s36
    s_lshr_b32 s36, s67, 2
    s_add_u32 s36, s36, 1
    s_and_b32 s36, s36, 3
    s_mul_i32 s45, s36, 2097152
    s_xor_b32 s53, s36, s94
    s_and_b32 s53, s53, 1
    s_lshl_b32 s53, s53, 13
    s_add_u32 s45, s45, s53
    s_lshr_b32 s53, s36, 1
    s_lshl_b32 s53, s53, 4
    s_add_u32 s53, s53, 16
    s_sub_u32 s54, 0, s53
    s_bitcmp1_b32 s36, 0
    s_cselect_b32 s53, s53, s54
    s_add_u32 s45, s45, s53
    s_lshl_b32 s36, s28, 2
    s_add_u32 s36, s36, s34
    s_lshl_b32 s36, s36, 9
    s_add_u32 s36, s36, 16384
    s_add_u32 s45, s45, s36
    s_lshr_b32 s36, s67, 2
    s_add_u32 s36, s36, 2
    s_and_b32 s36, s36, 3
    s_mul_i32 s46, s36, 2097152
    s_xor_b32 s53, s36, s94
    s_and_b32 s53, s53, 1
    s_lshl_b32 s53, s53, 13
    s_add_u32 s46, s46, s53
    s_lshr_b32 s53, s36, 1
    s_lshl_b32 s53, s53, 4
    s_add_u32 s53, s53, 16
    s_sub_u32 s54, 0, s53
    s_bitcmp1_b32 s36, 0
    s_cselect_b32 s53, s53, s54
    s_add_u32 s46, s46, s53
    s_lshl_b32 s36, s28, 2
    s_add_u32 s36, s36, s34
    s_lshl_b32 s36, s36, 9
    s_add_u32 s36, s36, 16384
    s_add_u32 s46, s46, s36
    s_lshr_b32 s36, s67, 2
    s_add_u32 s36, s36, 3
    s_and_b32 s36, s36, 3
    s_mul_i32 s47, s36, 2097152
    s_xor_b32 s53, s36, s94
    s_and_b32 s53, s53, 1
    s_lshl_b32 s53, s53, 13
    s_add_u32 s47, s47, s53
    s_lshr_b32 s53, s36, 1
    s_lshl_b32 s53, s53, 4
    s_add_u32 s53, s53, 16
    s_sub_u32 s54, 0, s53
    s_bitcmp1_b32 s36, 0
    s_cselect_b32 s53, s53, s54
    s_add_u32 s47, s47, s53
    s_lshl_b32 s36, s28, 2
    s_add_u32 s36, s36, s34
    s_lshl_b32 s36, s36, 9
    s_add_u32 s36, s36, 16384
    s_add_u32 s47, s47, s36
    v_lshrrev_b32 v6, 2, v1
    v_mul_u32_u24 v13, 128, v6
    v_and_b32 v7, 3, v1
    v_lshl_add_u32 v13, v7, 3, v13
    v_add_u32 v13, 0, v13
    v_bfe_u32 v6, v6, 1, 2
    s_mul_i32 s36, s35, 4
    s_add_u32 s36, s36, 3
    v_xor_b32 v7, s36, v6
    v_lshl_add_u32 v16, v7, 5, v13
    s_mul_i32 s36, s35, 4
    s_add_u32 s36, s36, 2
    v_xor_b32 v7, s36, v6
    v_lshl_add_u32 v15, v7, 5, v13
    s_mul_i32 s36, s35, 4
    s_add_u32 s36, s36, 1
    v_xor_b32 v7, s36, v6
    v_lshl_add_u32 v14, v7, 5, v13
    s_mul_i32 s36, s35, 4
    s_add_u32 s36, s36, 0
    v_xor_b32 v7, s36, v6
    v_lshl_add_u32 v13, v7, 5, v13
    s_lshl_b32 s36, s37, 8
    s_add_u32 s36, s36, 160768
    v_lshlrev_b32 v7, 4, v22
    v_add_u32 v7, s36, v7
    ds_read_b64 v[56:57], v7 offset:0
    ds_read_b64 v[58:59], v7 offset:256
    s_waitcnt vmcnt(4) lgkmcnt(0)
    v_lshlrev_b32 v24, 16, v160
    v_and_b32 v25, 0xffff0000, v160
    v_pk_add_f32 v[24:25], v[24:25], v[56:57] op_sel_hi:[1,0] neg_lo:[0,1] neg_hi:[0,1]
    v_pk_mul_f32 v[24:25], v[24:25], v[56:57] op_sel:[0,1] op_sel_hi:[1,1]
    v_lshlrev_b32 v26, 16, v161
    v_and_b32 v27, 0xffff0000, v161
    v_pk_add_f32 v[26:27], v[26:27], v[56:57] op_sel_hi:[1,0] neg_lo:[0,1] neg_hi:[0,1]
    v_pk_mul_f32 v[26:27], v[26:27], v[56:57] op_sel:[0,1] op_sel_hi:[1,1]
    v_lshlrev_b32 v28, 16, v162
    v_and_b32 v29, 0xffff0000, v162
    v_pk_add_f32 v[28:29], v[28:29], v[56:57] op_sel_hi:[1,0] neg_lo:[0,1] neg_hi:[0,1]
    v_pk_mul_f32 v[28:29], v[28:29], v[56:57] op_sel:[0,1] op_sel_hi:[1,1]
    v_lshlrev_b32 v30, 16, v163
    v_and_b32 v31, 0xffff0000, v163
    v_pk_add_f32 v[30:31], v[30:31], v[56:57] op_sel_hi:[1,0] neg_lo:[0,1] neg_hi:[0,1]
    v_pk_mul_f32 v[30:31], v[30:31], v[56:57] op_sel:[0,1] op_sel_hi:[1,1]
    v_lshlrev_b32 v32, 16, v164
    v_and_b32 v33, 0xffff0000, v164
    v_pk_add_f32 v[32:33], v[32:33], v[56:57] op_sel_hi:[1,0] neg_lo:[0,1] neg_hi:[0,1]
    v_pk_mul_f32 v[32:33], v[32:33], v[56:57] op_sel:[0,1] op_sel_hi:[1,1]
    v_lshlrev_b32 v34, 16, v165
    v_and_b32 v35, 0xffff0000, v165
    v_pk_add_f32 v[34:35], v[34:35], v[56:57] op_sel_hi:[1,0] neg_lo:[0,1] neg_hi:[0,1]
    v_pk_mul_f32 v[34:35], v[34:35], v[56:57] op_sel:[0,1] op_sel_hi:[1,1]
    v_lshlrev_b32 v36, 16, v166
    v_and_b32 v37, 0xffff0000, v166
    v_pk_add_f32 v[36:37], v[36:37], v[56:57] op_sel_hi:[1,0] neg_lo:[0,1] neg_hi:[0,1]
    v_pk_mul_f32 v[36:37], v[36:37], v[56:57] op_sel:[0,1] op_sel_hi:[1,1]
    v_lshlrev_b32 v38, 16, v167
    v_and_b32 v39, 0xffff0000, v167
    v_pk_add_f32 v[38:39], v[38:39], v[56:57] op_sel_hi:[1,0] neg_lo:[0,1] neg_hi:[0,1]
    v_pk_mul_f32 v[38:39], v[38:39], v[56:57] op_sel:[0,1] op_sel_hi:[1,1]
    v_lshlrev_b32 v40, 16, v168
    v_and_b32 v41, 0xffff0000, v168
    v_pk_add_f32 v[40:41], v[40:41], v[58:59] op_sel_hi:[1,0] neg_lo:[0,1] neg_hi:[0,1]
    v_pk_mul_f32 v[40:41], v[40:41], v[58:59] op_sel:[0,1] op_sel_hi:[1,1]
    v_lshlrev_b32 v42, 16, v169
    v_and_b32 v43, 0xffff0000, v169
    v_pk_add_f32 v[42:43], v[42:43], v[58:59] op_sel_hi:[1,0] neg_lo:[0,1] neg_hi:[0,1]
    v_pk_mul_f32 v[42:43], v[42:43], v[58:59] op_sel:[0,1] op_sel_hi:[1,1]
    v_lshlrev_b32 v44, 16, v170
    v_and_b32 v45, 0xffff0000, v170
    v_pk_add_f32 v[44:45], v[44:45], v[58:59] op_sel_hi:[1,0] neg_lo:[0,1] neg_hi:[0,1]
    v_pk_mul_f32 v[44:45], v[44:45], v[58:59] op_sel:[0,1] op_sel_hi:[1,1]
    v_lshlrev_b32 v46, 16, v171
    v_and_b32 v47, 0xffff0000, v171
    v_pk_add_f32 v[46:47], v[46:47], v[58:59] op_sel_hi:[1,0] neg_lo:[0,1] neg_hi:[0,1]
    v_pk_mul_f32 v[46:47], v[46:47], v[58:59] op_sel:[0,1] op_sel_hi:[1,1]
    v_lshlrev_b32 v48, 16, v172
    v_and_b32 v49, 0xffff0000, v172
    v_pk_add_f32 v[48:49], v[48:49], v[58:59] op_sel_hi:[1,0] neg_lo:[0,1] neg_hi:[0,1]
    v_pk_mul_f32 v[48:49], v[48:49], v[58:59] op_sel:[0,1] op_sel_hi:[1,1]
    v_lshlrev_b32 v50, 16, v173
    v_and_b32 v51, 0xffff0000, v173
    v_pk_add_f32 v[50:51], v[50:51], v[58:59] op_sel_hi:[1,0] neg_lo:[0,1] neg_hi:[0,1]
    v_pk_mul_f32 v[50:51], v[50:51], v[58:59] op_sel:[0,1] op_sel_hi:[1,1]
    v_lshlrev_b32 v52, 16, v174
    v_and_b32 v53, 0xffff0000, v174
    v_pk_add_f32 v[52:53], v[52:53], v[58:59] op_sel_hi:[1,0] neg_lo:[0,1] neg_hi:[0,1]
    v_pk_mul_f32 v[52:53], v[52:53], v[58:59] op_sel:[0,1] op_sel_hi:[1,1]
    v_lshlrev_b32 v54, 16, v175
    v_and_b32 v55, 0xffff0000, v175
    v_pk_add_f32 v[54:55], v[54:55], v[58:59] op_sel_hi:[1,0] neg_lo:[0,1] neg_hi:[0,1]
    v_pk_mul_f32 v[54:55], v[54:55], v[58:59] op_sel:[0,1] op_sel_hi:[1,1]
    s_mov_b32 s43, 0
    s_add_u32 s16, s62, 0x80000
    s_addc_u32 s17, s63, 0
    s_mov_b32 s18, 0x7e000
    s_mov_b32 s19, 0x20000
    s_mov_b32 s53, 0
    s_mov_b32 s49, s44
    s_barrier
    s_cmp_eq_u32 s60, 0
    s_cbranch_scc1 dm_20z
    ds_read_b64_tr_b16 v[56:57], v13 offset:0
    ds_read_b64_tr_b16 v[58:59], v13 offset:2048
    ds_read_b64_tr_b16 v[60:61], v14 offset:0
    ds_read_b64_tr_b16 v[62:63], v14 offset:2048
    ds_read_b64_tr_b16 v[64:65], v15 offset:0
    ds_read_b64_tr_b16 v[66:67], v15 offset:2048
    ds_read_b64_tr_b16 v[68:69], v16 offset:0
    ds_read_b64_tr_b16 v[70:71], v16 offset:2048
    ds_read_b64_tr_b16 v[72:73], v13 offset:4096
    ds_read_b64_tr_b16 v[74:75], v13 offset:6144
    ds_read_b64_tr_b16 v[76:77], v14 offset:4096
    ds_read_b64_tr_b16 v[78:79], v14 offset:6144
    ds_read_b64_tr_b16 v[80:81], v15 offset:4096
    ds_read_b64_tr_b16 v[82:83], v15 offset:6144
    ds_read_b64_tr_b16 v[84:85], v16 offset:4096
    ds_read_b64_tr_b16 v[86:87], v16 offset:6144
dm_20p:
    buffer_load_dwordx4 v[176:179], v126, s[8:11], s44 offen offset:0 sc1
    buffer_load_dwordx4 v[180:183], v126, s[8:11], s44 offen offset:256 sc1
    buffer_load_dwordx4 v[184:187], v127, s[8:11], s44 offen offset:0 sc1
    buffer_load_dwordx4 v[188:191], v127, s[8:11], s44 offen offset:256 sc1
    s_waitcnt vmcnt(0)
    v_bitop3_b32 v17, v176, v180, v184 bitop3:0x80
    v_bitop3_b32 v17, v17, v188, s60 bitop3:0x2a
    v_cmp_ne_u32 vcc, 0, v17
    s_cbranch_vccz dm_20q
    s_sleep 2
    s_add_u32 s53, s53, 1
    s_cmp_lt_u32 s53, s61
    s_cbranch_scc1 dm_20p
    s_mov_b32 s61, 0
dm_20q:
    buffer_load_dwordx4 v[192:195], v128, s[8:11], s44 offen offset:0
    buffer_load_dwordx4 v[196:199], v128, s[8:11], s44 offen offset:256
    buffer_load_dwordx4 v[200:203], v129, s[8:11], s44 offen offset:0
    buffer_load_dwordx4 v[204:207], v129, s[8:11], s44 offen offset:256
    buffer_load_dwordx4 v[208:211], v130, s[8:11], s44 offen offset:0
    buffer_load_dwordx4 v[212:215], v130, s[8:11], s44 offen offset:256
    buffer_load_dwordx4 v[216:219], v131, s[8:11], s44 offen offset:0
    buffer_load_dwordx4 v[220:223], v131, s[8:11], s44 offen offset:256
    buffer_load_dwordx4 v[224:227], v132, s[8:11], s44 offen offset:0
    buffer_load_dwordx4 v[228:231], v132, s[8:11], s44 offen offset:256
    s_waitcnt lgkmcnt(0)
    s_branch dm_20
dm_20z:
    buffer_load_dwordx4 v[176:179], v126, s[8:11], s44 offen offset:0
    buffer_load_dwordx4 v[180:183], v126, s[8:11], s44 offen offset:256
    buffer_load_dwordx4 v[184:187], v127, s[8:11], s44 offen offset:0
    buffer_load_dwordx4 v[188:191], v127, s[8:11], s44 offen offset:256
    buffer_load_dwordx4 v[192:195], v128, s[8:11], s44 offen offset:0
    buffer_load_dwordx4 v[196:199], v128, s[8:11], s44 offen offset:256
    buffer_load_dwordx4 v[200:203], v129, s[8:11], s44 offen offset:0
    buffer_load_dwordx4 v[204:207], v129, s[8:11], s44 offen offset:256
    ds_read_b64_tr_b16 v[56:57], v13 offset:0
    ds_read_b64_tr_b16 v[58:59], v13 offset:2048
    ds_read_b64_tr_b16 v[60:61], v14 offset:0
    ds_read_b64_tr_b16 v[62:63], v14 offset:2048
    ds_read_b64_tr_b16 v[64:65], v15 offset:0
    ds_read_b64_tr_b16 v[66:67], v15 offset:2048
    ds_read_b64_tr_b16 v[68:69], v16 offset:0
    ds_read_b64_tr_b16 v[70:71], v16 offset:2048
    ds_read_b64_tr_b16 v[72:73], v13 offset:4096
    ds_read_b64_tr_b16 v[74:75], v13 offset:6144
    ds_read_b64_tr_b16 v[76:77], v14 offset:4096
    ds_read_b64_tr_b16 v[78:79], v14 offset:6144
    ds_read_b64_tr_b16 v[80:81], v15 offset:4096
    ds_read_b64_tr_b16 v[82:83], v15 offset:6144
    ds_read_b64_tr_b16 v[84:85], v16 offset:4096
    ds_read_b64_tr_b16 v[86:87], v16 offset:6144
    buffer_load_dwordx4 v[208:211], v130, s[8:11], s44 offen offset:0
    buffer_load_dwordx4 v[212:215], v130, s[8:11], s44 offen offset:256
    buffer_load_dwordx4 v[216:219], v131, s[8:11], s44 offen offset:0
    buffer_load_dwordx4 v[220:223], v131, s[8:11], s44 offen offset:256
    buffer_load_dwordx4 v[224:227], v132, s[8:11], s44 offen offset:0
    buffer_load_dwordx4 v[228:231], v132, s[8:11], s44 offen offset:256
    s_waitcnt vmcnt(10) lgkmcnt(0)
dm_20:
    v_mfma_f32_16x16x32_bf16 v[24:27], v[56:59], v[176:179], v[24:27]
    ds_read_b64_tr_b16 v[88:89], v13 offset:8192
    buffer_load_dwordx4 v[232:235], v133, s[8:11], s44 offen offset:0
    v_mfma_f32_16x16x32_bf16 v[40:43], v[56:59], v[180:183], v[40:43]
    ds_read_b64_tr_b16 v[90:91], v13 offset:10240
    buffer_load_dwordx4 v[236:239], v133, s[8:11], s44 offen offset:256
    v_mfma_f32_16x16x32_bf16 v[44:47], v[60:63], v[180:183], v[44:47]
    ds_read_b64_tr_b16 v[92:93], v14 offset:8192
    s_mov_b32 s44, s45
    v_mfma_f32_16x16x32_bf16 v[28:31], v[60:63], v[176:179], v[28:31]
    ds_read_b64_tr_b16 v[94:95], v14 offset:10240
    s_mov_b32 s45, s46
    v_mfma_f32_16x16x32_bf16 v[32:35], v[64:67], v[176:179], v[32:35]
    ds_read_b64_tr_b16 v[96:97], v15 offset:8192
    s_mov_b32 s46, s47
    v_mfma_f32_16x16x32_bf16 v[48:51], v[64:67], v[180:183], v[48:51]
    ds_read_b64_tr_b16 v[98:99], v15 offset:10240
    s_mov_b32 s47, 8388608
    v_mfma_f32_16x16x32_bf16 v[52:55], v[68:71], v[180:183], v[52:55]
    ds_read_b64_tr_b16 v[100:101], v16 offset:8192
    v_mfma_f32_16x16x32_bf16 v[36:39], v[68:71], v[176:179], v[36:39]
    ds_read_b64_tr_b16 v[102:103], v16 offset:10240
    s_waitcnt lgkmcnt(8)
    v_mfma_f32_16x16x32_bf16 v[24:27], v[72:75], v[184:187], v[24:27]
    ds_read_b64_tr_b16 v[104:105], v13 offset:12288
    buffer_load_dwordx4 v[176:179], v126, s[8:11], s44 offen offset:0
    v_mfma_f32_16x16x32_bf16 v[40:43], v[72:75], v[188:191], v[40:43]
    ds_read_b64_tr_b16 v[106:107], v13 offset:14336
    buffer_load_dwordx4 v[180:183], v126, s[8:11], s44 offen offset:256
    v_mfma_f32_16x16x32_bf16 v[44:47], v[76:79], v[188:191], v[44:47]
    ds_read_b64_tr_b16 v[108:109], v14 offset:12288
    s_waitcnt vmcnt(10)
    v_mfma_f32_16x16x32_bf16 v[28:31], v[76:79], v[184:187], v[28:31]
    ds_read_b64_tr_b16 v[110:111], v14 offset:14336
    v_bitop3_b32 v17, v192, v196, v200 bitop3:0x80
    v_mfma_f32_16x16x32_bf16 v[32:35], v[80:83], v[184:187], v[32:35]
    ds_read_b64_tr_b16 v[112:113], v15 offset:12288
    v_bitop3_b32 v17, v17, v204, s60 bitop3:0x2a
    v_mfma_f32_16x16x32_bf16 v[48:51], v[80:83], v[188:191], v[48:51]
    ds_read_b64_tr_b16 v[114:115], v15 offset:14336
    v_cmp_ne_u32 vcc, 0, v17
    v_mfma_f32_16x16x32_bf16 v[52:55], v[84:87], v[188:191], v[52:55]
    ds_read_b64_tr_b16 v[116:117], v16 offset:12288
    ds_read_b64_tr_b16 v[118:119], v16 offset:14336
    v_mfma_f32_16x16x32_bf16 v[36:39], v[84:87], v[184:187], v[36:39]
    s_waitcnt lgkmcnt(8)
    s_cbranch_vccnz dm_20f0
dm_20g0:
    v_mfma_f32_16x16x32_bf16 v[24:27], v[88:91], v[192:195], v[24:27]
    ds_read_b64_tr_b16 v[56:57], v13 offset:16384
    buffer_load_dwordx4 v[184:187], v127, s[8:11], s44 offen offset:0
    v_mfma_f32_16x16x32_bf16 v[40:43], v[88:91], v[196:199], v[40:43]
    ds_read_b64_tr_b16 v[58:59], v13 offset:18432
    buffer_load_dwordx4 v[188:191], v127, s[8:11], s44 offen offset:256
    v_mfma_f32_16x16x32_bf16 v[44:47], v[92:95], v[196:199], v[44:47]
    ds_read_b64_tr_b16 v[60:61], v14 offset:16384
    v_mfma_f32_16x16x32_bf16 v[28:31], v[92:95], v[192:195], v[28:31]
    ds_read_b64_tr_b16 v[62:63], v14 offset:18432
    v_mfma_f32_16x16x32_bf16 v[32:35], v[96:99], v[192:195], v[32:35]
    ds_read_b64_tr_b16 v[64:65], v15 offset:16384
    v_mfma_f32_16x16x32_bf16 v[48:51], v[96:99], v[196:199], v[48:51]
    ds_read_b64_tr_b16 v[66:67], v15 offset:18432
    v_mfma_f32_16x16x32_bf16 v[52:55], v[100:103], v[196:199], v[52:55]
    ds_read_b64_tr_b16 v[68:69], v16 offset:16384
    v_mfma_f32_16x16x32_bf16 v[36:39], v[100:103], v[192:195], v[36:39]
    ds_read_b64_tr_b16 v[70:71], v16 offset:18432
    s_waitcnt lgkmcnt(8)
    v_mfma_f32_16x16x32_bf16 v[24:27], v[104:107], v[200:203], v[24:27]
    ds_read_b64_tr_b16 v[72:73], v13 offset:20480
    buffer_load_dwordx4 v[192:195], v128, s[8:11], s44 offen offset:0
    v_mfma_f32_16x16x32_bf16 v[40:43], v[104:107], v[204:207], v[40:43]
    ds_read_b64_tr_b16 v[74:75], v13 offset:22528
    buffer_load_dwordx4 v[196:199], v128, s[8:11], s44 offen offset:256
    v_mfma_f32_16x16x32_bf16 v[44:47], v[108:111], v[204:207], v[44:47]
    ds_read_b64_tr_b16 v[76:77], v14 offset:20480
    s_waitcnt vmcnt(10)
    v_mfma_f32_16x16x32_bf16 v[28:31], v[108:111], v[200:203], v[28:31]
    ds_read_b64_tr_b16 v[78:79], v14 offset:22528
    v_bitop3_b32 v17, v208, v212, v216 bitop3:0x80
    v_mfma_f32_16x16x32_bf16 v[32:35], v[112:115], v[200:203], v[32:35]
    ds_read_b64_tr_b16 v[80:81], v15 offset:20480
    v_bitop3_b32 v17, v17, v220, s60 bitop3:0x2a
    v_mfma_f32_16x16x32_bf16 v[48:51], v[112:115], v[204:207], v[48:51]
    ds_read_b64_tr_b16 v[82:83], v15 offset:22528
    v_cmp_ne_u32 vcc, 0, v17
    v_mfma_f32_16x16x32_bf16 v[52:55], v[116:119], v[204:207], v[52:55]
    ds_read_b64_tr_b16 v[84:85], v16 offset:20480
    ds_read_b64_tr_b16 v[86:87], v16 offset:22528
    v_mfma_f32_16x16x32_bf16 v[36:39], v[116:119], v[200:203], v[36:39]
    s_waitcnt lgkmcnt(8)
    s_cbranch_vccnz dm_20f1
dm_20g1:
    v_mfma_f32_16x16x32_bf16 v[24:27], v[56:59], v[208:211], v[24:27]
    ds_read_b64_tr_b16 v[88:89], v13 offset:24576
    buffer_load_dwordx4 v[200:203], v129, s[8:11], s44 offen offset:0
    v_mfma_f32_16x16x32_bf16 v[40:43], v[56:59], v[212:215], v[40:43]
    ds_read_b64_tr_b16 v[90:91], v13 offset:26624
    buffer_load_dwordx4 v[204:207], v129, s[8:11], s44 offen offset:256
    v_mfma_f32_16x16x32_bf16 v[44:47], v[60:63], v[212:215], v[44:47]
    ds_read_b64_tr_b16 v[92:93], v14 offset:24576
    s_add_u32 s43, s43, 1
    v_mfma_f32_16x16x32_bf16 v[28:31], v[60:63], v[208:211], v[28:31]
    ds_read_b64_tr_b16 v[94:95], v14 offset:26624
    s_cmp_eq_u32 s43, 4
    v_mfma_f32_16x16x32_bf16 v[32:35], v[64:67], v[208:211], v[32:35]
    ds_read_b64_tr_b16 v[96:97], v15 offset:24576
    v_mfma_f32_16x16x32_bf16 v[48:51], v[64:67], v[212:215], v[48:51]
    ds_read_b64_tr_b16 v[98:99], v15 offset:26624
    v_mfma_f32_16x16x32_bf16 v[52:55], v[68:71], v[212:215], v[52:55]
    ds_read_b64_tr_b16 v[100:101], v16 offset:24576
    v_mfma_f32_16x16x32_bf16 v[36:39], v[68:71], v[208:211], v[36:39]
    ds_read_b64_tr_b16 v[102:103], v16 offset:26624
    s_waitcnt lgkmcnt(8)
    v_mfma_f32_16x16x32_bf16 v[24:27], v[72:75], v[216:219], v[24:27]
    ds_read_b64_tr_b16 v[104:105], v13 offset:28672
    buffer_load_dwordx4 v[208:211], v130, s[8:11], s44 offen offset:0
    v_mfma_f32_16x16x32_bf16 v[40:43], v[72:75], v[220:223], v[40:43]
    ds_read_b64_tr_b16 v[106:107], v13 offset:30720
    buffer_load_dwordx4 v[212:215], v130, s[8:11], s44 offen offset:256
    v_mfma_f32_16x16x32_bf16 v[44:47], v[76:79], v[220:223], v[44:47]
    ds_read_b64_tr_b16 v[108:109], v14 offset:28672
    s_waitcnt vmcnt(10)
    v_mfma_f32_16x16x32_bf16 v[28:31], v[76:79], v[216:219], v[28:31]
    ds_read_b64_tr_b16 v[110:111], v14 offset:30720
    v_add_u32 v13, 32768, v13
    v_bitop3_b32 v17, v224, v228, v232 bitop3:0x80
    v_mfma_f32_16x16x32_bf16 v[32:35], v[80:83], v[216:219], v[32:35]
    ds_read_b64_tr_b16 v[112:113], v15 offset:28672
    v_add_u32 v14, 32768, v14
    v_bitop3_b32 v17, v17, v236, s60 bitop3:0x2a
    v_mfma_f32_16x16x32_bf16 v[48:51], v[80:83], v[220:223], v[48:51]
    ds_read_b64_tr_b16 v[114:115], v15 offset:30720
    v_add_u32 v15, 32768, v15
    v_cmp_ne_u32 vcc, 0, v17
    v_mfma_f32_16x16x32_bf16 v[52:55], v[84:87], v[220:223], v[52:55]
    ds_read_b64_tr_b16 v[116:117], v16 offset:28672
    ds_read_b64_tr_b16 v[118:119], v16 offset:30720
    v_mfma_f32_16x16x32_bf16 v[36:39], v[84:87], v[216:219], v[36:39]
    v_add_u32 v16, 32768, v16
    s_waitcnt lgkmcnt(8)
    s_cbranch_vccnz dm_20f2
dm_20g2:
    s_cbranch_scc1 dm_20x
    v_mfma_f32_16x16x32_bf16 v[24:27], v[88:91], v[224:227], v[24:27]
    ds_read_b64_tr_b16 v[56:57], v13 offset:0
    buffer_load_dwordx4 v[216:219], v131, s[8:11], s44 offen offset:0
    v_mfma_f32_16x16x32_bf16 v[40:43], v[88:91], v[228:231], v[40:43]
    ds_read_b64_tr_b16 v[58:59], v13 offset:2048
    buffer_load_dwordx4 v[220:223], v131, s[8:11], s44 offen offset:256
    v_mfma_f32_16x16x32_bf16 v[44:47], v[92:95], v[228:231], v[44:47]
    ds_read_b64_tr_b16 v[60:61], v14 offset:0
    s_mov_b32 s49, s44
    v_mfma_f32_16x16x32_bf16 v[28:31], v[92:95], v[224:227], v[28:31]
    ds_read_b64_tr_b16 v[62:63], v14 offset:2048
    v_mfma_f32_16x16x32_bf16 v[32:35], v[96:99], v[224:227], v[32:35]
    ds_read_b64_tr_b16 v[64:65], v15 offset:0
    v_mfma_f32_16x16x32_bf16 v[48:51], v[96:99], v[228:231], v[48:51]
    ds_read_b64_tr_b16 v[66:67], v15 offset:2048
    v_mfma_f32_16x16x32_bf16 v[52:55], v[100:103], v[228:231], v[52:55]
    ds_read_b64_tr_b16 v[68:69], v16 offset:0
    v_mfma_f32_16x16x32_bf16 v[36:39], v[100:103], v[224:227], v[36:39]
    ds_read_b64_tr_b16 v[70:71], v16 offset:2048
    s_waitcnt lgkmcnt(8)
    v_mfma_f32_16x16x32_bf16 v[24:27], v[104:107], v[232:235], v[24:27]
    ds_read_b64_tr_b16 v[72:73], v13 offset:4096
    buffer_load_dwordx4 v[224:227], v132, s[8:11], s44 offen offset:0
    v_mfma_f32_16x16x32_bf16 v[40:43], v[104:107], v[236:239], v[40:43]
    ds_read_b64_tr_b16 v[74:75], v13 offset:6144
    buffer_load_dwordx4 v[228:231], v132, s[8:11], s44 offen offset:256
    v_mfma_f32_16x16x32_bf16 v[44:47], v[108:111], v[236:239], v[44:47]
    ds_read_b64_tr_b16 v[76:77], v14 offset:4096
    s_waitcnt vmcnt(10)
    v_mfma_f32_16x16x32_bf16 v[28:31], v[108:111], v[232:235], v[28:31]
    ds_read_b64_tr_b16 v[78:79], v14 offset:6144
    v_bitop3_b32 v17, v176, v180, v184 bitop3:0x80
    v_mfma_f32_16x16x32_bf16 v[32:35], v[112:115], v[232:235], v[32:35]
    ds_read_b64_tr_b16 v[80:81], v15 offset:4096
    v_bitop3_b32 v17, v17, v188, s60 bitop3:0x2a
    v_mfma_f32_16x16x32_bf16 v[48:51], v[112:115], v[236:239], v[48:51]
    ds_read_b64_tr_b16 v[82:83], v15 offset:6144
    v_cmp_ne_u32 vcc, 0, v17
    v_mfma_f32_16x16x32_bf16 v[52:55], v[116:119], v[236:239], v[52:55]
    ds_read_b64_tr_b16 v[84:85], v16 offset:4096
    ds_read_b64_tr_b16 v[86:87], v16 offset:6144
    v_mfma_f32_16x16x32_bf16 v[36:39], v[116:119], v[232:235], v[36:39]
    s_waitcnt lgkmcnt(8)
    s_cbranch_vccnz dm_20f3
dm_20g3:
    s_branch dm_20
dm_20f0:
    s_cselect_b32 s50, 1, 0
dm_20h0:
    s_sleep 2
    buffer_load_dwordx4 v[192:195], v128, s[8:11], s49 offen offset:0 sc1
    buffer_load_dwordx4 v[196:199], v128, s[8:11], s49 offen offset:256 sc1
    buffer_load_dwordx4 v[200:203], v129, s[8:11], s49 offen offset:0 sc1
    buffer_load_dwordx4 v[204:207], v129, s[8:11], s49 offen offset:256 sc1
    buffer_load_dwordx4 v[208:211], v130, s[8:11], s49 offen offset:0 sc1
    buffer_load_dwordx4 v[212:215], v130, s[8:11], s49 offen offset:256 sc1
    buffer_load_dwordx4 v[216:219], v131, s[8:11], s49 offen offset:0 sc1
    buffer_load_dwordx4 v[220:223], v131, s[8:11], s49 offen offset:256 sc1
    buffer_load_dwordx4 v[224:227], v132, s[8:11], s49 offen offset:0 sc1
    buffer_load_dwordx4 v[228:231], v132, s[8:11], s49 offen offset:256 sc1
    buffer_load_dwordx4 v[232:235], v133, s[8:11], s49 offen offset:0 sc1
    buffer_load_dwordx4 v[236:239], v133, s[8:11], s49 offen offset:256 sc1
    buffer_load_dwordx4 v[176:179], v126, s[8:11], s44 offen offset:0 sc1
    buffer_load_dwordx4 v[180:183], v126, s[8:11], s44 offen offset:256 sc1
    s_waitcnt vmcnt(10)
    v_bitop3_b32 v17, v192, v196, v200 bitop3:0x80
    v_bitop3_b32 v17, v17, v204, s60 bitop3:0x2a
    v_cmp_ne_u32 vcc, 0, v17
    s_add_u32 s53, s53, 1
    s_cmp_ge_u32 s53, s61
    s_cselect_b32 s61, 0, s61
    s_cbranch_scc1 dm_20k0
    s_cbranch_vccnz dm_20h0
dm_20k0:
    s_cmp_eq_u32 s50, 1
    s_branch dm_20g0
dm_20f1:
    s_cselect_b32 s50, 1, 0
dm_20h1:
    s_sleep 2
    buffer_load_dwordx4 v[208:211], v130, s[8:11], s49 offen offset:0 sc1
    buffer_load_dwordx4 v[212:215], v130, s[8:11], s49 offen offset:256 sc1
    buffer_load_dwordx4 v[216:219], v131, s[8:11], s49 offen offset:0 sc1
    buffer_load_dwordx4 v[220:223], v131, s[8:11], s49 offen offset:256 sc1
    buffer_load_dwordx4 v[224:227], v132, s[8:11], s49 offen offset:0 sc1
    buffer_load_dwordx4 v[228:231], v132, s[8:11], s49 offen offset:256 sc1
    buffer_load_dwordx4 v[232:235], v133, s[8:11], s49 offen offset:0 sc1
    buffer_load_dwordx4 v[236:239], v133, s[8:11], s49 offen offset:256 sc1
    buffer_load_dwordx4 v[176:179], v126, s[8:11], s44 offen offset:0 sc1
    buffer_load_dwordx4 v[180:183], v126, s[8:11], s44 offen offset:256 sc1
    buffer_load_dwordx4 v[184:187], v127, s[8:11], s44 offen offset:0 sc1
    buffer_load_dwordx4 v[188:191], v127, s[8:11], s44 offen offset:256 sc1
    buffer_load_dwordx4 v[192:195], v128, s[8:11], s44 offen offset:0 sc1
    buffer_load_dwordx4 v[196:199], v128, s[8:11], s44 offen offset:256 sc1
    s_waitcnt vmcnt(10)
    v_bitop3_b32 v17, v208, v212, v216 bitop3:0x80
    v_bitop3_b32 v17, v17, v220, s60 bitop3:0x2a
    v_cmp_ne_u32 vcc, 0, v17
    s_add_u32 s53, s53, 1
    s_cmp_ge_u32 s53, s61
    s_cselect_b32 s61, 0, s61
    s_cbranch_scc1 dm_20k1
    s_cbranch_vccnz dm_20h1
dm_20k1:
    s_cmp_eq_u32 s50, 1
    s_branch dm_20g1
dm_20f2:
    s_cselect_b32 s50, 1, 0
dm_20h2:
    s_sleep 2
    buffer_load_dwordx4 v[224:227], v132, s[8:11], s49 offen offset:0 sc1
    buffer_load_dwordx4 v[228:231], v132, s[8:11], s49 offen offset:256 sc1
    buffer_load_dwordx4 v[232:235], v133, s[8:11], s49 offen offset:0 sc1
    buffer_load_dwordx4 v[236:239], v133, s[8:11], s49 offen offset:256 sc1
    buffer_load_dwordx4 v[176:179], v126, s[8:11], s44 offen offset:0 sc1
    buffer_load_dwordx4 v[180:183], v126, s[8:11], s44 offen offset:256 sc1
    buffer_load_dwordx4 v[184:187], v127, s[8:11], s44 offen offset:0 sc1
    buffer_load_dwordx4 v[188:191], v127, s[8:11], s44 offen offset:256 sc1
    buffer_load_dwordx4 v[192:195], v128, s[8:11], s44 offen offset:0 sc1
    buffer_load_dwordx4 v[196:199], v128, s[8:11], s44 offen offset:256 sc1
    buffer_load_dwordx4 v[200:203], v129, s[8:11], s44 offen offset:0 sc1
    buffer_load_dwordx4 v[204:207], v129, s[8:11], s44 offen offset:256 sc1
    buffer_load_dwordx4 v[208:211], v130, s[8:11], s44 offen offset:0 sc1
    buffer_load_dwordx4 v[212:215], v130, s[8:11], s44 offen offset:256 sc1
    s_waitcnt vmcnt(10)
    v_bitop3_b32 v17, v224, v228, v232 bitop3:0x80
    v_bitop3_b32 v17, v17, v236, s60 bitop3:0x2a
    v_cmp_ne_u32 vcc, 0, v17
    s_add_u32 s53, s53, 1
    s_cmp_ge_u32 s53, s61
    s_cselect_b32 s61, 0, s61
    s_cbranch_scc1 dm_20k2
    s_cbranch_vccnz dm_20h2
dm_20k2:
    s_cmp_eq_u32 s50, 1
    s_branch dm_20g2
dm_20f3:
    s_cselect_b32 s50, 1, 0
dm_20h3:
    s_sleep 2
    buffer_load_dwordx4 v[176:179], v126, s[8:11], s49 offen offset:0 sc1
    buffer_load_dwordx4 v[180:183], v126, s[8:11], s49 offen offset:256 sc1
    buffer_load_dwordx4 v[184:187], v127, s[8:11], s49 offen offset:0 sc1
    buffer_load_dwordx4 v[188:191], v127, s[8:11], s49 offen offset:256 sc1
    buffer_load_dwordx4 v[192:195], v128, s[8:11], s49 offen offset:0 sc1
    buffer_load_dwordx4 v[196:199], v128, s[8:11], s49 offen offset:256 sc1
    buffer_load_dwordx4 v[200:203], v129, s[8:11], s49 offen offset:0 sc1
    buffer_load_dwordx4 v[204:207], v129, s[8:11], s49 offen offset:256 sc1
    buffer_load_dwordx4 v[208:211], v130, s[8:11], s49 offen offset:0 sc1
    buffer_load_dwordx4 v[212:215], v130, s[8:11], s49 offen offset:256 sc1
    buffer_load_dwordx4 v[216:219], v131, s[8:11], s49 offen offset:0 sc1
    buffer_load_dwordx4 v[220:223], v131, s[8:11], s49 offen offset:256 sc1
    buffer_load_dwordx4 v[224:227], v132, s[8:11], s49 offen offset:0 sc1
    buffer_load_dwordx4 v[228:231], v132, s[8:11], s49 offen offset:256 sc1
    s_waitcnt vmcnt(10)
    v_bitop3_b32 v17, v176, v180, v184 bitop3:0x80
    v_bitop3_b32 v17, v17, v188, s60 bitop3:0x2a
    v_cmp_ne_u32 vcc, 0, v17
    s_add_u32 s53, s53, 1
    s_cmp_ge_u32 s53, s61
    s_cselect_b32 s61, 0, s61
    s_cbranch_scc1 dm_20k3
    s_cbranch_vccnz dm_20h3
dm_20k3:
    s_cmp_eq_u32 s50, 1
    s_branch dm_20g3
dm_20x:
    v_mfma_f32_16x16x32_bf16 v[24:27], v[88:91], v[224:227], v[24:27]
    v_mfma_f32_16x16x32_bf16 v[40:43], v[88:91], v[228:231], v[40:43]
    v_mfma_f32_16x16x32_bf16 v[44:47], v[92:95], v[228:231], v[44:47]
    v_mfma_f32_16x16x32_bf16 v[28:31], v[92:95], v[224:227], v[28:31]
    v_mfma_f32_16x16x32_bf16 v[32:35], v[96:99], v[224:227], v[32:35]
    v_mfma_f32_16x16x32_bf16 v[48:51], v[96:99], v[228:231], v[48:51]
    v_mfma_f32_16x16x32_bf16 v[52:55], v[100:103], v[228:231], v[52:55]
    v_mfma_f32_16x16x32_bf16 v[36:39], v[100:103], v[224:227], v[36:39]
    s_waitcnt lgkmcnt(0)
    v_mfma_f32_16x16x32_bf16 v[24:27], v[104:107], v[232:235], v[24:27]
    s_add_u32 s44, s62, 0x5c8000
    v_mfma_f32_16x16x32_bf16 v[40:43], v[104:107], v[236:239], v[40:43]
    s_addc_u32 s45, s63, 0
    v_mfma_f32_16x16x32_bf16 v[44:47], v[108:111], v[236:239], v[44:47]
    v_mfma_f32_16x16x32_bf16 v[28:31], v[108:111], v[232:235], v[28:31]
    s_mov_b32 s46, 0x6000
    v_mfma_f32_16x16x32_bf16 v[32:35], v[112:115], v[232:235], v[32:35]
    v_mfma_f32_16x16x32_bf16 v[48:51], v[112:115], v[236:239], v[48:51]
    s_mov_b32 s47, 0x20000
    v_mfma_f32_16x16x32_bf16 v[52:55], v[116:119], v[236:239], v[52:55]
    v_mfma_f32_16x16x32_bf16 v[36:39], v[116:119], v[232:235], v[36:39]
    s_add_u32 s36, s39, 0
    v_cvt_pk_bf16_f32 v160, v24, v25
    v_cvt_pk_bf16_f32 v161, v26, v27
    v_cvt_pk_bf16_f32 v162, v28, v29
    v_cvt_pk_bf16_f32 v163, v30, v31
    v_and_b32 v160, -2, v160
    buffer_store_dwordx4 v[160:163], v2, s[16:19], s36 offen offset:0 sc1
    v_cvt_pk_bf16_f32 v164, v32, v33
    v_cvt_pk_bf16_f32 v165, v34, v35
    v_cvt_pk_bf16_f32 v166, v36, v37
    v_cvt_pk_bf16_f32 v167, v38, v39
    v_and_b32 v164, -2, v164
    buffer_store_dwordx4 v[164:167], v2, s[16:19], s36 offen offset:1024 sc1
    s_add_u32 s36, s39, 65536
    v_cvt_pk_bf16_f32 v168, v40, v41
    v_cvt_pk_bf16_f32 v169, v42, v43
    v_cvt_pk_bf16_f32 v170, v44, v45
    v_cvt_pk_bf16_f32 v171, v46, v47
    v_and_b32 v168, -2, v168
    buffer_store_dwordx4 v[168:171], v2, s[16:19], s36 offen offset:0 sc1
    v_cvt_pk_bf16_f32 v172, v48, v49
    v_cvt_pk_bf16_f32 v173, v50, v51
    v_cvt_pk_bf16_f32 v174, v52, v53
    v_cvt_pk_bf16_f32 v175, v54, v55
    v_and_b32 v172, -2, v172
    buffer_store_dwordx4 v[172:175], v2, s[16:19], s36 offen offset:1024 sc1
    s_barrier
    s_lshl_b32 s36, s37, 11
    v_add_u32 v7, s36, v2
    ds_write_b128 v7, v[160:163] offset:0
    ds_write_b128 v7, v[164:167] offset:1024
    ds_write_b128 v7, v[168:171] offset:2048
    ds_write_b128 v7, v[172:175] offset:3072
    v_lshlrev_b32 v24, 16, v160
    v_and_b32 v25, 0xffff0000, v160
    v_lshlrev_b32 v26, 16, v161
    v_and_b32 v27, 0xffff0000, v161
    v_lshlrev_b32 v28, 16, v162
    v_and_b32 v29, 0xffff0000, v162
    v_lshlrev_b32 v30, 16, v163
    v_and_b32 v31, 0xffff0000, v163
    v_lshlrev_b32 v32, 16, v164
    v_and_b32 v33, 0xffff0000, v164
    v_lshlrev_b32 v34, 16, v165
    v_and_b32 v35, 0xffff0000, v165
    v_lshlrev_b32 v36, 16, v166
    v_and_b32 v37, 0xffff0000, v166
    v_lshlrev_b32 v38, 16, v167
    v_and_b32 v39, 0xffff0000, v167
    v_lshlrev_b32 v40, 16, v168
    v_and_b32 v41, 0xffff0000, v168
    v_lshlrev_b32 v42, 16, v169
    v_and_b32 v43, 0xffff0000, v169
    v_lshlrev_b32 v44, 16, v170
    v_and_b32 v45, 0xffff0000, v170
    v_lshlrev_b32 v46, 16, v171
    v_and_b32 v47, 0xffff0000, v171
    v_lshlrev_b32 v48, 16, v172
    v_and_b32 v49, 0xffff0000, v172
    v_lshlrev_b32 v50, 16, v173
    v_and_b32 v51, 0xffff0000, v173
    v_lshlrev_b32 v52, 16, v174
    v_and_b32 v53, 0xffff0000, v174
    v_lshlrev_b32 v54, 16, v175
    v_and_b32 v55, 0xffff0000, v175
    s_add_u32 s53, s55, 512
    v_mov_b32 v8, 1
    v_mov_b32 v9, 162816
    v_mov_b32 v11, 0
    s_mov_b64 exec, 1
    s_waitcnt vmcnt(0)
    ds_add_rtn_u32 v10, v9, v8
    s_waitcnt lgkmcnt(0)
    v_readfirstlane_b32 s54, v10
    s_nop 0
    s_and_b32 s54, s54, 3
    s_cmp_lg_u32 s54, 3
    s_cbranch_scc1 pub_21
    buffer_atomic_add v8, v11, s[56:59], s53 offen sc1
    v_mov_b32 v9, 162872
    ds_add_u32 v9, v8
pub_21:
    s_mov_b64 exec, -1
    s_waitcnt lgkmcnt(0)
    s_barrier
    v_pk_add_f32 v[140:141], v[24:25], v[26:27]
    v_pk_mul_f32 v[134:135], v[24:25], v[24:25]
    v_pk_fma_f32 v[134:135], v[26:27], v[26:27], v[134:135]
    v_pk_add_f32 v[140:141], v[140:141], v[28:29]
    v_pk_fma_f32 v[134:135], v[28:29], v[28:29], v[134:135]
    v_pk_add_f32 v[140:141], v[140:141], v[30:31]
    v_pk_fma_f32 v[134:135], v[30:31], v[30:31], v[134:135]
    v_pk_add_f32 v[140:141], v[140:141], v[32:33]
    v_pk_fma_f32 v[134:135], v[32:33], v[32:33], v[134:135]
    v_pk_add_f32 v[140:141], v[140:141], v[34:35]
    v_pk_fma_f32 v[134:135], v[34:35], v[34:35], v[134:135]
    v_pk_add_f32 v[140:141], v[140:141], v[36:37]
    v_pk_fma_f32 v[134:135], v[36:37], v[36:37], v[134:135]
    v_pk_add_f32 v[140:141], v[140:141], v[38:39]
    v_pk_fma_f32 v[134:135], v[38:39], v[38:39], v[134:135]
    v_add_f32 v136, v140, v141
    v_add_f32 v137, v134, v135
    v_mov_b32 v140, v136
    v_mov_b32 v141, v137
    s_nop 0
    v_permlane16_swap_b32 v136, v140
    v_permlane16_swap_b32 v137, v141
    v_pk_add_f32 v[136:137], v[136:137], v[140:141]
    v_mov_b32 v140, v136
    v_mov_b32 v141, v137
    s_nop 0
    v_permlane32_swap_b32 v136, v140
    v_permlane32_swap_b32 v137, v141
    v_pk_add_f32 v[136:137], v[136:137], v[140:141]
    v_pk_add_f32 v[140:141], v[40:41], v[42:43]
    v_pk_mul_f32 v[134:135], v[40:41], v[40:41]
    v_pk_fma_f32 v[134:135], v[42:43], v[42:43], v[134:135]
    v_pk_add_f32 v[140:141], v[140:141], v[44:45]
    v_pk_fma_f32 v[134:135], v[44:45], v[44:45], v[134:135]
    v_pk_add_f32 v[140:141], v[140:141], v[46:47]
    v_pk_fma_f32 v[134:135], v[46:47], v[46:47], v[134:135]
    v_pk_add_f32 v[140:141], v[140:141], v[48:49]
    v_pk_fma_f32 v[134:135], v[48:49], v[48:49], v[134:135]
    v_pk_add_f32 v[140:141], v[140:141], v[50:51]
    v_pk_fma_f32 v[134:135], v[50:51], v[50:51], v[134:135]
    v_pk_add_f32 v[140:141], v[140:141], v[52:53]
    v_pk_fma_f32 v[134:135], v[52:53], v[52:53], v[134:135]
    v_pk_add_f32 v[140:141], v[140:141], v[54:55]
    v_pk_fma_f32 v[134:135], v[54:55], v[54:55], v[134:135]
    v_add_f32 v138, v140, v141
    v_add_f32 v139, v134, v135
    v_mov_b32 v140, v138
    v_mov_b32 v141, v139
    s_nop 0
    v_permlane16_swap_b32 v138, v140
    v_permlane16_swap_b32 v139, v141
    v_pk_add_f32 v[138:139], v[138:139], v[140:141]
    v_mov_b32 v140, v138
    v_mov_b32 v141, v139
    s_nop 0
    v_permlane32_swap_b32 v138, v140
    v_permlane32_swap_b32 v139, v141
    v_pk_add_f32 v[138:139], v[138:139], v[140:141]
    v_cmp_eq_u32 vcc, 0, v23
    s_nop 1
    v_cndmask_b32 v136, v138, v136, vcc
    v_cndmask_b32 v137, v139, v137, vcc
    s_lshr_b32 s53, s29, 3
    s_lshl_b32 s53, s53, 14
    s_and_b32 s40, s29, 7
    s_lshl_b32 s40, s40, 10
    s_add_u32 s40, s40, s53
    s_lshl_b32 s36, s34, 8
    s_add_u32 s40, s40, s36
    v_lshlrev_b32 v7, 3, v1
    s_bfm_b64 exec, 32, 0
    buffer_store_dwordx2 v[136:137], v7, s[44:47], s40 offen sc1
    s_mov_b64 exec, -1
    s_lshr_b32 s34, s30, 1
    s_and_b32 s35, s30, 1
    v_and_b32 v22, 15, v1
    v_lshrrev_b32 v23, 4, v1
    s_mul_i32 s37, s34, 4
    s_mul_i32 s38, s29, 14
    s_mul_i32 s36, s35, 7
    s_add_u32 s38, s38, s36
    s_mul_i32 s36, s34, 8192
    v_add_u32 v12, s36, v2
    v_lshrrev_b32 v6, 2, v1
    v_mul_u32_u24 v13, 448, v6
    v_and_b32 v7, 3, v1
    v_lshl_add_u32 v13, v7, 3, v13
    v_add_u32 v13, 73728, v13
    s_mul_i32 s36, s35, 224
    v_add_u32 v13, s36, v13
    v_bfe_u32 v6, v1, 4, 1
    v_lshlrev_b32 v6, 5, v6
    s_cmp_eq_u32 s35, 0
    s_cselect_b32 s36, 1, -1
    v_mul_lo_u32 v6, v6, s36
    v_sub_u32 v14, v13, v6
    v_add_u32 v13, v13, v6
    v_mov_b32 v17, v12
    s_mov_b32 s42, 0
    s_mov_b32 s43, 0
    s_mov_b32 s48, 57344
    v_add_u32 v18, 57344, v13
    v_add_u32 v19, 57344, v14
    ds_read_b128 v[136:139], v17 offset:0
    ds_read_b128 v[140:143], v17 offset:2048
    ds_read_b128 v[144:147], v17 offset:4096
    ds_read_b128 v[148:151], v17 offset:6144
    ds_read_b64_tr_b16 v[152:153], v18 offset:0
    ds_read_b64_tr_b16 v[154:155], v18 offset:7168
    ds_read_b64_tr_b16 v[156:157], v19 offset:32
    ds_read_b64_tr_b16 v[158:159], v19 offset:7200
    ds_read_b64_tr_b16 v[160:161], v18 offset:64
    ds_read_b64_tr_b16 v[162:163], v18 offset:7232
    ds_read_b64_tr_b16 v[164:165], v19 offset:96
    ds_read_b64_tr_b16 v[166:167], v19 offset:7264
    ds_read_b64_tr_b16 v[168:169], v18 offset:128
    ds_read_b64_tr_b16 v[170:171], v18 offset:7296
    ds_read_b64_tr_b16 v[172:173], v19 offset:160
    ds_read_b64_tr_b16 v[174:175], v19 offset:7328
    ds_read_b64_tr_b16 v[176:177], v18 offset:192
    ds_read_b64_tr_b16 v[178:179], v18 offset:7360
    s_waitcnt lgkmcnt(12)
    v_mfma_f32_16x16x32_bf16 v[24:27], v[152:155], v[136:139], 0
    ds_read_b128 v[180:183], v17 offset:1024
    s_add_u32 s42, s42, 16384
    v_mfma_f32_16x16x32_bf16 v[52:55], v[152:155], v[140:143], 0
    ds_read_b128 v[184:187], v17 offset:3072
    s_cmp_eq_u32 s42, 49152
    v_mfma_f32_16x16x32_bf16 v[80:83], v[152:155], v[144:147], 0
    ds_read_b128 v[188:191], v17 offset:5120
    s_cselect_b32 s42, 0, s42
    v_mfma_f32_16x16x32_bf16 v[108:111], v[152:155], v[148:151], 0
    ds_read_b128 v[192:195], v17 offset:7168
    s_waitcnt lgkmcnt(14)
    v_mfma_f32_16x16x32_bf16 v[112:115], v[156:159], v[148:151], 0
    ds_read_b64_tr_b16 v[196:197], v18 offset:14336
    s_add_u32 s48, s48, 28672
    v_mfma_f32_16x16x32_bf16 v[84:87], v[156:159], v[144:147], 0
    ds_read_b64_tr_b16 v[198:199], v18 offset:21504
    s_cmp_eq_u32 s48, 86016
    v_mfma_f32_16x16x32_bf16 v[56:59], v[156:159], v[140:143], 0
    ds_read_b64_tr_b16 v[200:201], v19 offset:14368
    s_cselect_b32 s48, 0, s48
    v_mfma_f32_16x16x32_bf16 v[28:31], v[156:159], v[136:139], 0
    ds_read_b64_tr_b16 v[202:203], v19 offset:21536
    s_waitcnt lgkmcnt(8)
    v_mfma_f32_16x16x32_bf16 v[32:35], v[160:163], v[136:139], 0
    ds_read_b64_tr_b16 v[204:205], v18 offset:14400
    v_add_u32 v17, s42, v12
    v_mfma_f32_16x16x32_bf16 v[60:63], v[160:163], v[140:143], 0
    ds_read_b64_tr_b16 v[206:207], v18 offset:21568
    v_mfma_f32_16x16x32_bf16 v[88:91], v[160:163], v[144:147], 0
    ds_read_b64_tr_b16 v[208:209], v19 offset:14432
    v_mfma_f32_16x16x32_bf16 v[116:119], v[160:163], v[148:151], 0
    ds_read_b64_tr_b16 v[210:211], v19 offset:21600
    v_mfma_f32_16x16x32_bf16 v[120:123], v[164:167], v[148:151], 0
    ds_read_b64_tr_b16 v[212:213], v18 offset:14464
    v_mfma_f32_16x16x32_bf16 v[92:95], v[164:167], v[144:147], 0
    ds_read_b64_tr_b16 v[214:215], v18 offset:21632
    v_mfma_f32_16x16x32_bf16 v[64:67], v[164:167], v[140:143], 0
    ds_read_b64_tr_b16 v[216:217], v19 offset:14496
    v_mfma_f32_16x16x32_bf16 v[36:39], v[164:167], v[136:139], 0
    ds_read_b64_tr_b16 v[218:219], v19 offset:21664
    v_add_u32 v19, s48, v14
    v_mfma_f32_16x16x32_bf16 v[40:43], v[168:171], v[136:139], 0
    ds_read_b64_tr_b16 v[220:221], v18 offset:14528
    v_mfma_f32_16x16x32_bf16 v[68:71], v[168:171], v[140:143], 0
    ds_read_b64_tr_b16 v[222:223], v18 offset:21696
    v_add_u32 v18, s48, v13
    v_mfma_f32_16x16x32_bf16 v[96:99], v[168:171], v[144:147], 0
    v_mfma_f32_16x16x32_bf16 v[124:127], v[168:171], v[148:151], 0
    v_mfma_f32_16x16x32_bf16 v[128:131], v[172:175], v[148:151], 0
    v_mfma_f32_16x16x32_bf16 v[100:103], v[172:175], v[144:147], 0
    v_mfma_f32_16x16x32_bf16 v[72:75], v[172:175], v[140:143], 0
    v_mfma_f32_16x16x32_bf16 v[44:47], v[172:175], v[136:139], 0
    v_mfma_f32_16x16x32_bf16 v[48:51], v[176:179], v[136:139], 0
    v_mfma_f32_16x16x32_bf16 v[76:79], v[176:179], v[140:143], 0
    v_mfma_f32_16x16x32_bf16 v[104:107], v[176:179], v[144:147], 0
    v_mfma_f32_16x16x32_bf16 v[132:135], v[176:179], v[148:151], 0
    s_waitcnt lgkmcnt(12)
    v_mfma_f32_16x16x32_bf16 v[24:27], v[196:199], v[180:183], v[24:27]
    s_add_u32 s43, s43, 1
    s_mul_i32 s36, s35, 448
    s_add_u32 s36, s36, 159744
    v_lshlrev_b32 v6, 4, v23
    v_mfma_f32_16x16x32_bf16 v[52:55], v[196:199], v[184:187], v[52:55]
    v_add_u32 v6, s36, v6
    s_lshl_b32 s36, s37, 8
    s_add_u32 s36, s36, 160768
    v_lshlrev_b32 v7, 4, v22
    v_mfma_f32_16x16x32_bf16 v[80:83], v[196:199], v[188:191], v[80:83]
    v_add_u32 v7, s36, v7
    s_add_u32 s16, s62, 0x400000
    s_addc_u32 s17, s63, 0
    s_mov_b32 s18, 0x1be000
    v_mfma_f32_16x16x32_bf16 v[108:111], v[196:199], v[192:195], v[108:111]
    s_mov_b32 s19, 0x20000
    s_mul_i32 s39, s37, 229376
    s_lshr_b32 s36, s38, 1
    s_waitcnt lgkmcnt(0)
    v_mfma_f32_16x16x32_bf16 v[112:115], v[200:203], v[192:195], v[112:115]
    s_add_u32 s36, s36, 0
    s_lshr_b32 s53, s36, 3
    s_lshl_b32 s53, s53, 14
    s_and_b32 s44, s36, 7
    v_mfma_f32_16x16x32_bf16 v[84:87], v[200:203], v[188:191], v[84:87]
    s_lshl_b32 s44, s44, 10
    s_add_u32 s44, s44, s53
    s_add_u32 s44, s44, s39
    s_lshr_b32 s36, s38, 1
    v_mfma_f32_16x16x32_bf16 v[56:59], v[200:203], v[184:187], v[56:59]
    s_add_u32 s36, s36, 1
    s_lshr_b32 s53, s36, 3
    s_lshl_b32 s53, s53, 14
    s_and_b32 s45, s36, 7
    v_mfma_f32_16x16x32_bf16 v[28:31], v[200:203], v[180:183], v[28:31]
    s_lshl_b32 s45, s45, 10
    s_add_u32 s45, s45, s53
    s_add_u32 s45, s45, s39
    s_lshr_b32 s36, s38, 1
    v_mfma_f32_16x16x32_bf16 v[32:35], v[204:207], v[180:183], v[32:35]
    s_add_u32 s36, s36, 2
    s_lshr_b32 s53, s36, 3
    s_lshl_b32 s53, s53, 14
    s_and_b32 s46, s36, 7
    v_mfma_f32_16x16x32_bf16 v[60:63], v[204:207], v[184:187], v[60:63]
    s_lshl_b32 s46, s46, 10
    s_add_u32 s46, s46, s53
    s_add_u32 s46, s46, s39
    s_lshr_b32 s36, s38, 1
    v_mfma_f32_16x16x32_bf16 v[88:91], v[204:207], v[188:191], v[88:91]
    s_add_u32 s36, s36, 3
    s_lshr_b32 s53, s36, 3
    s_lshl_b32 s53, s53, 14
    s_and_b32 s47, s36, 7
    v_mfma_f32_16x16x32_bf16 v[116:119], v[204:207], v[192:195], v[116:119]
    s_lshl_b32 s47, s47, 10
    s_add_u32 s47, s47, s53
    s_add_u32 s47, s47, s39
    v_lshrrev_b32 v226, 2, v1
    v_mfma_f32_16x16x32_bf16 v[120:123], v[208:211], v[192:195], v[120:123]
    v_mul_u32_u24 v240, 256, v226
    v_and_b32 v227, 3, v1
    v_lshl_add_u32 v240, v227, 3, v240
    v_add_u32 v240, 49152, v240
    v_mfma_f32_16x16x32_bf16 v[92:95], v[208:211], v[188:191], v[92:95]
    v_and_b32 v226, 7, v226
    s_mul_i32 s36, s35, 4
    s_add_u32 s36, s36, 3
    v_xor_b32 v227, s36, v226
    v_mfma_f32_16x16x32_bf16 v[64:67], v[208:211], v[184:187], v[64:67]
    v_lshl_add_u32 v243, v227, 5, v240
    s_mul_i32 s36, s35, 4
    s_add_u32 s36, s36, 2
    v_xor_b32 v227, s36, v226
    v_mfma_f32_16x16x32_bf16 v[36:39], v[208:211], v[180:183], v[36:39]
    v_lshl_add_u32 v242, v227, 5, v240
    s_mul_i32 s36, s35, 4
    s_add_u32 s36, s36, 1
    v_xor_b32 v227, s36, v226
    v_mfma_f32_16x16x32_bf16 v[40:43], v[212:215], v[180:183], v[40:43]
    v_lshl_add_u32 v241, v227, 5, v240
    s_mul_i32 s36, s35, 4
    s_add_u32 s36, s36, 0
    v_xor_b32 v227, s36, v226
    v_mfma_f32_16x16x32_bf16 v[68:71], v[212:215], v[184:187], v[68:71]
    v_lshl_add_u32 v240, v227, 5, v240
    s_lshl_b32 s38, s33, 3
    s_lshl_b32 s36, s35, 2
    s_add_u32 s38, s38, s36
    v_mfma_f32_16x16x32_bf16 v[96:99], v[212:215], v[188:191], v[96:99]
    s_lshr_b32 s36, s38, 1
    s_lshr_b32 s53, s36, 3
    s_lshl_b32 s53, s53, 14
    s_and_b32 s39, s36, 7
    v_mfma_f32_16x16x32_bf16 v[124:127], v[212:215], v[192:195], v[124:127]
    s_lshl_b32 s39, s39, 10
    s_add_u32 s39, s39, s53
    s_lshl_b32 s36, s37, 16
    s_add_u32 s39, s39, s36
    v_mfma_f32_16x16x32_bf16 v[128:131], v[216:219], v[192:195], v[128:131]
    s_lshl_b32 s40, s31, 17
    s_add_u32 s40, s40, s39
    s_xor_b32 s41, s31, 1
    s_lshl_b32 s41, s41, 17
    v_mfma_f32_16x16x32_bf16 v[100:103], v[216:219], v[188:191], v[100:103]
    s_add_u32 s41, s41, s39
    s_mov_b32 s84, s62
    s_mov_b32 s85, s63
    s_mov_b32 s86, 0x7e000
    v_mfma_f32_16x16x32_bf16 v[72:75], v[216:219], v[184:187], v[72:75]
    s_mov_b32 s87, 0x20000
    s_add_u32 s88, s62, 0x80000
    s_addc_u32 s89, s63, 0
    s_mov_b32 s90, 0x7e000
    v_mfma_f32_16x16x32_bf16 v[44:47], v[216:219], v[180:183], v[44:47]
    s_mov_b32 s91, 0x20000
    s_add_u32 s80, s4, 0x1c00000
    s_addc_u32 s81, s5, 0
    s_mov_b32 s82, 0x400000
    v_mfma_f32_16x16x32_bf16 v[48:51], v[220:223], v[180:183], v[48:51]
    s_mov_b32 s83, 0x20000
    s_lshl_b32 s36, s37, 1
    s_add_u32 s36, s36, s35
    s_lshl_b32 s36, s36, 10
    v_mfma_f32_16x16x32_bf16 v[76:79], v[220:223], v[184:187], v[76:79]
    v_add_u32 v244, s36, v2
    v_mov_b32 v245, 1
    v_mov_b32 v246, 162880
    v_lshrrev_b32 v238, 1, v23
    v_mfma_f32_16x16x32_bf16 v[104:107], v[220:223], v[188:191], v[104:107]
    v_lshlrev_b32 v238, 8, v238
    v_lshl_add_u32 v238, v22, 4, v238
    v_and_b32 v224, 1, v23
    v_lshl_add_u32 v238, v224, 3, v238
    v_mfma_f32_16x16x32_bf16 v[132:135], v[220:223], v[192:195], v[132:135]
    s_add_u32 s53, s55, 1408
    v_mov_b32 v8, 1
    v_mov_b32 v9, 162864
    v_mov_b32 v11, 0
    s_mov_b64 exec, 1
    s_waitcnt vmcnt(0)
    ds_add_rtn_u32 v10, v9, v8
    s_waitcnt lgkmcnt(0)
    v_readfirstlane_b32 s54, v10
    s_nop 0
    s_and_b32 s54, s54, 3
    s_cmp_lg_u32 s54, 3
    s_cbranch_scc1 pub_22
    buffer_atomic_add v8, v11, s[56:59], s53 offen sc1
pub_22:
    s_mov_b64 exec, -1
    s_barrier
    ds_read_b128 v[136:139], v17 offset:0
    ds_read_b128 v[140:143], v17 offset:2048
    ds_read_b128 v[144:147], v17 offset:4096
    ds_read_b128 v[148:151], v17 offset:6144
    ds_read_b64_tr_b16 v[152:153], v18 offset:0
    ds_read_b64_tr_b16 v[154:155], v18 offset:7168
    ds_read_b64_tr_b16 v[156:157], v19 offset:32
    ds_read_b64_tr_b16 v[158:159], v19 offset:7200
    ds_read_b64_tr_b16 v[160:161], v18 offset:64
    ds_read_b64_tr_b16 v[162:163], v18 offset:7232
    ds_read_b64_tr_b16 v[164:165], v19 offset:96
    ds_read_b64_tr_b16 v[166:167], v19 offset:7264
    ds_read_b64_tr_b16 v[168:169], v18 offset:128
    ds_read_b64_tr_b16 v[170:171], v18 offset:7296
    ds_read_b64_tr_b16 v[172:173], v19 offset:160
    ds_read_b64_tr_b16 v[174:175], v19 offset:7328
    ds_read_b64_tr_b16 v[176:177], v18 offset:192
    ds_read_b64_tr_b16 v[178:179], v18 offset:7360
    s_waitcnt lgkmcnt(12)
mm_23:
    v_mfma_f32_16x16x32_bf16 v[24:27], v[152:155], v[136:139], v[24:27]
    ds_read_b128 v[180:183], v17 offset:1024
    s_add_u32 s42, s42, 16384
    v_mfma_f32_16x16x32_bf16 v[52:55], v[152:155], v[140:143], v[52:55]
    ds_read_b128 v[184:187], v17 offset:3072
    s_cmp_eq_u32 s42, 49152
    v_mfma_f32_16x16x32_bf16 v[80:83], v[152:155], v[144:147], v[80:83]
    ds_read_b128 v[188:191], v17 offset:5120
    s_cselect_b32 s42, 0, s42
    v_mfma_f32_16x16x32_bf16 v[108:111], v[152:155], v[148:151], v[108:111]
    ds_read_b128 v[192:195], v17 offset:7168
    s_waitcnt lgkmcnt(14)
    v_mfma_f32_16x16x32_bf16 v[112:115], v[156:159], v[148:151], v[112:115]
    ds_read_b64_tr_b16 v[196:197], v18 offset:14336
    s_add_u32 s48, s48, 28672
    v_mfma_f32_16x16x32_bf16 v[84:87], v[156:159], v[144:147], v[84:87]
    ds_read_b64_tr_b16 v[198:199], v18 offset:21504
    s_cmp_eq_u32 s48, 86016
    v_mfma_f32_16x16x32_bf16 v[56:59], v[156:159], v[140:143], v[56:59]
    ds_read_b64_tr_b16 v[200:201], v19 offset:14368
    s_cselect_b32 s48, 0, s48
    v_mfma_f32_16x16x32_bf16 v[28:31], v[156:159], v[136:139], v[28:31]
    ds_read_b64_tr_b16 v[202:203], v19 offset:21536
    s_waitcnt lgkmcnt(8)
    v_mfma_f32_16x16x32_bf16 v[32:35], v[160:163], v[136:139], v[32:35]
    ds_read_b64_tr_b16 v[204:205], v18 offset:14400
    v_add_u32 v17, s42, v12
    v_mfma_f32_16x16x32_bf16 v[60:63], v[160:163], v[140:143], v[60:63]
    ds_read_b64_tr_b16 v[206:207], v18 offset:21568
    v_mfma_f32_16x16x32_bf16 v[88:91], v[160:163], v[144:147], v[88:91]
    ds_read_b64_tr_b16 v[208:209], v19 offset:14432
    v_mfma_f32_16x16x32_bf16 v[116:119], v[160:163], v[148:151], v[116:119]
    ds_read_b64_tr_b16 v[210:211], v19 offset:21600
    v_mfma_f32_16x16x32_bf16 v[120:123], v[164:167], v[148:151], v[120:123]
    ds_read_b64_tr_b16 v[212:213], v18 offset:14464
    v_mfma_f32_16x16x32_bf16 v[92:95], v[164:167], v[144:147], v[92:95]
    ds_read_b64_tr_b16 v[214:215], v18 offset:21632
    v_mfma_f32_16x16x32_bf16 v[64:67], v[164:167], v[140:143], v[64:67]
    ds_read_b64_tr_b16 v[216:217], v19 offset:14496
    v_mfma_f32_16x16x32_bf16 v[36:39], v[164:167], v[136:139], v[36:39]
    ds_read_b64_tr_b16 v[218:219], v19 offset:21664
    v_add_u32 v19, s48, v14
    v_mfma_f32_16x16x32_bf16 v[40:43], v[168:171], v[136:139], v[40:43]
    ds_read_b64_tr_b16 v[220:221], v18 offset:14528
    v_mfma_f32_16x16x32_bf16 v[68:71], v[168:171], v[140:143], v[68:71]
    ds_read_b64_tr_b16 v[222:223], v18 offset:21696
    v_add_u32 v18, s48, v13
    v_mfma_f32_16x16x32_bf16 v[96:99], v[168:171], v[144:147], v[96:99]
    v_mfma_f32_16x16x32_bf16 v[124:127], v[168:171], v[148:151], v[124:127]
    v_mfma_f32_16x16x32_bf16 v[128:131], v[172:175], v[148:151], v[128:131]
    v_mfma_f32_16x16x32_bf16 v[100:103], v[172:175], v[144:147], v[100:103]
    v_mfma_f32_16x16x32_bf16 v[72:75], v[172:175], v[140:143], v[72:75]
    v_mfma_f32_16x16x32_bf16 v[44:47], v[172:175], v[136:139], v[44:47]
    v_mfma_f32_16x16x32_bf16 v[48:51], v[176:179], v[136:139], v[48:51]
    v_mfma_f32_16x16x32_bf16 v[76:79], v[176:179], v[140:143], v[76:79]
    v_mfma_f32_16x16x32_bf16 v[104:107], v[176:179], v[144:147], v[104:107]
    v_mfma_f32_16x16x32_bf16 v[132:135], v[176:179], v[148:151], v[132:135]
    s_waitcnt lgkmcnt(12)
    v_mfma_f32_16x16x32_bf16 v[24:27], v[196:199], v[180:183], v[24:27]
    s_add_u32 s43, s43, 1
    s_cmp_lt_u32 s43, 15
    v_mfma_f32_16x16x32_bf16 v[52:55], v[196:199], v[184:187], v[52:55]
    v_mfma_f32_16x16x32_bf16 v[80:83], v[196:199], v[188:191], v[80:83]
    v_mfma_f32_16x16x32_bf16 v[108:111], v[196:199], v[192:195], v[108:111]
    s_waitcnt lgkmcnt(0)
    s_barrier
    v_mfma_f32_16x16x32_bf16 v[112:115], v[200:203], v[192:195], v[112:115]
    ds_read_b128 v[136:139], v17 offset:0
    v_mfma_f32_16x16x32_bf16 v[84:87], v[200:203], v[188:191], v[84:87]
    ds_read_b128 v[140:143], v17 offset:2048
    v_mfma_f32_16x16x32_bf16 v[56:59], v[200:203], v[184:187], v[56:59]
    ds_read_b128 v[144:147], v17 offset:4096
    v_mfma_f32_16x16x32_bf16 v[28:31], v[200:203], v[180:183], v[28:31]
    ds_read_b128 v[148:151], v17 offset:6144
    v_mfma_f32_16x16x32_bf16 v[32:35], v[204:207], v[180:183], v[32:35]
    ds_read_b64_tr_b16 v[152:153], v18 offset:0
    v_mfma_f32_16x16x32_bf16 v[60:63], v[204:207], v[184:187], v[60:63]
    ds_read_b64_tr_b16 v[154:155], v18 offset:7168
    v_mfma_f32_16x16x32_bf16 v[88:91], v[204:207], v[188:191], v[88:91]
    ds_read_b64_tr_b16 v[156:157], v19 offset:32
    v_mfma_f32_16x16x32_bf16 v[116:119], v[204:207], v[192:195], v[116:119]
    ds_read_b64_tr_b16 v[158:159], v19 offset:7200
    v_mfma_f32_16x16x32_bf16 v[120:123], v[208:211], v[192:195], v[120:123]
    ds_read_b64_tr_b16 v[160:161], v18 offset:64
    v_mfma_f32_16x16x32_bf16 v[92:95], v[208:211], v[188:191], v[92:95]
    ds_read_b64_tr_b16 v[162:163], v18 offset:7232
    v_mfma_f32_16x16x32_bf16 v[64:67], v[208:211], v[184:187], v[64:67]
    ds_read_b64_tr_b16 v[164:165], v19 offset:96
    v_mfma_f32_16x16x32_bf16 v[36:39], v[208:211], v[180:183], v[36:39]
    ds_read_b64_tr_b16 v[166:167], v19 offset:7264
    v_mfma_f32_16x16x32_bf16 v[40:43], v[212:215], v[180:183], v[40:43]
    ds_read_b64_tr_b16 v[168:169], v18 offset:128
    v_mfma_f32_16x16x32_bf16 v[68:71], v[212:215], v[184:187], v[68:71]
    ds_read_b64_tr_b16 v[170:171], v18 offset:7296
    v_mfma_f32_16x16x32_bf16 v[96:99], v[212:215], v[188:191], v[96:99]
    ds_read_b64_tr_b16 v[172:173], v19 offset:160
    v_mfma_f32_16x16x32_bf16 v[124:127], v[212:215], v[192:195], v[124:127]
    ds_read_b64_tr_b16 v[174:175], v19 offset:7328
    v_mfma_f32_16x16x32_bf16 v[128:131], v[216:219], v[192:195], v[128:131]
    ds_read_b64_tr_b16 v[176:177], v18 offset:192
    v_mfma_f32_16x16x32_bf16 v[100:103], v[216:219], v[188:191], v[100:103]
    ds_read_b64_tr_b16 v[178:179], v18 offset:7360
    v_mfma_f32_16x16x32_bf16 v[72:75], v[216:219], v[184:187], v[72:75]
    v_mfma_f32_16x16x32_bf16 v[44:47], v[216:219], v[180:183], v[44:47]
    v_mfma_f32_16x16x32_bf16 v[48:51], v[220:223], v[180:183], v[48:51]
    v_mfma_f32_16x16x32_bf16 v[76:79], v[220:223], v[184:187], v[76:79]
    v_mfma_f32_16x16x32_bf16 v[104:107], v[220:223], v[188:191], v[104:107]
    v_mfma_f32_16x16x32_bf16 v[132:135], v[220:223], v[192:195], v[132:135]
    s_waitcnt lgkmcnt(12)
    s_cbranch_scc1 mm_23
    v_mfma_f32_16x16x32_bf16 v[24:27], v[152:155], v[136:139], v[24:27]
    ds_read_b128 v[180:183], v17 offset:1024
    v_mfma_f32_16x16x32_bf16 v[52:55], v[152:155], v[140:143], v[52:55]
    ds_read_b128 v[184:187], v17 offset:3072
    v_mfma_f32_16x16x32_bf16 v[80:83], v[152:155], v[144:147], v[80:83]
    ds_read_b128 v[188:191], v17 offset:5120
    v_mfma_f32_16x16x32_bf16 v[108:111], v[152:155], v[148:151], v[108:111]
    ds_read_b128 v[192:195], v17 offset:7168
    s_waitcnt lgkmcnt(14)
    v_mfma_f32_16x16x32_bf16 v[112:115], v[156:159], v[148:151], v[112:115]
    ds_read_b64_tr_b16 v[196:197], v18 offset:14336
    v_mfma_f32_16x16x32_bf16 v[84:87], v[156:159], v[144:147], v[84:87]
    ds_read_b64_tr_b16 v[198:199], v18 offset:21504
    v_mfma_f32_16x16x32_bf16 v[56:59], v[156:159], v[140:143], v[56:59]
    ds_read_b64_tr_b16 v[200:201], v19 offset:14368
    v_mfma_f32_16x16x32_bf16 v[28:31], v[156:159], v[136:139], v[28:31]
    ds_read_b64_tr_b16 v[202:203], v19 offset:21536
    s_waitcnt lgkmcnt(8)
    v_mfma_f32_16x16x32_bf16 v[32:35], v[160:163], v[136:139], v[32:35]
    ds_read_b64_tr_b16 v[204:205], v18 offset:14400
    v_mfma_f32_16x16x32_bf16 v[60:63], v[160:163], v[140:143], v[60:63]
    ds_read_b64_tr_b16 v[206:207], v18 offset:21568
    v_mfma_f32_16x16x32_bf16 v[88:91], v[160:163], v[144:147], v[88:91]
    ds_read_b64_tr_b16 v[208:209], v19 offset:14432
    v_mfma_f32_16x16x32_bf16 v[116:119], v[160:163], v[148:151], v[116:119]
    ds_read_b64_tr_b16 v[210:211], v19 offset:21600
    v_mfma_f32_16x16x32_bf16 v[120:123], v[164:167], v[148:151], v[120:123]
    ds_read_b64_tr_b16 v[212:213], v18 offset:14464
    v_mfma_f32_16x16x32_bf16 v[92:95], v[164:167], v[144:147], v[92:95]
    ds_read_b64_tr_b16 v[214:215], v18 offset:21632
    v_mfma_f32_16x16x32_bf16 v[64:67], v[164:167], v[140:143], v[64:67]
    ds_read_b64_tr_b16 v[216:217], v19 offset:14496
    v_mfma_f32_16x16x32_bf16 v[36:39], v[164:167], v[136:139], v[36:39]
    ds_read_b64_tr_b16 v[218:219], v19 offset:21664
    v_mfma_f32_16x16x32_bf16 v[40:43], v[168:171], v[136:139], v[40:43]
    ds_read_b64_tr_b16 v[220:221], v18 offset:14528
    v_mfma_f32_16x16x32_bf16 v[68:71], v[168:171], v[140:143], v[68:71]
    ds_read_b64_tr_b16 v[222:223], v18 offset:21696
    v_mfma_f32_16x16x32_bf16 v[96:99], v[168:171], v[144:147], v[96:99]
    v_mfma_f32_16x16x32_bf16 v[124:127], v[168:171], v[148:151], v[124:127]
    v_mfma_f32_16x16x32_bf16 v[128:131], v[172:175], v[148:151], v[128:131]
    v_mfma_f32_16x16x32_bf16 v[100:103], v[172:175], v[144:147], v[100:103]
    v_mfma_f32_16x16x32_bf16 v[72:75], v[172:175], v[140:143], v[72:75]
    v_mfma_f32_16x16x32_bf16 v[44:47], v[172:175], v[136:139], v[44:47]
    v_mfma_f32_16x16x32_bf16 v[48:51], v[176:179], v[136:139], v[48:51]
    v_mfma_f32_16x16x32_bf16 v[76:79], v[176:179], v[140:143], v[76:79]
    v_mfma_f32_16x16x32_bf16 v[104:107], v[176:179], v[144:147], v[104:107]
    v_mfma_f32_16x16x32_bf16 v[132:135], v[176:179], v[148:151], v[132:135]
    s_waitcnt lgkmcnt(0)
    s_barrier
    v_mfma_f32_16x16x32_bf16 v[24:27], v[196:199], v[180:183], v[24:27]
    ds_read_b128 v[136:139], v6 offset:0
    v_mfma_f32_16x16x32_bf16 v[52:55], v[196:199], v[184:187], v[52:55]
    ds_read_b128 v[140:143], v6 offset:64
    v_mfma_f32_16x16x32_bf16 v[80:83], v[196:199], v[188:191], v[80:83]
    ds_read_b128 v[144:147], v6 offset:128
    v_mfma_f32_16x16x32_bf16 v[108:111], v[196:199], v[192:195], v[108:111]
    ds_read_b128 v[148:151], v6 offset:192
    v_mfma_f32_16x16x32_bf16 v[112:115], v[200:203], v[192:195], v[112:115]
    ds_read_b128 v[152:155], v6 offset:256
    v_mfma_f32_16x16x32_bf16 v[84:87], v[200:203], v[188:191], v[84:87]
    ds_read_b128 v[156:159], v6 offset:320
    v_mfma_f32_16x16x32_bf16 v[56:59], v[200:203], v[184:187], v[56:59]
    ds_read_b128 v[160:163], v6 offset:384
    v_mfma_f32_16x16x32_bf16 v[28:31], v[200:203], v[180:183], v[28:31]
    ds_read_b128 v[164:167], v7 offset:0
    v_mfma_f32_16x16x32_bf16 v[32:35], v[204:207], v[180:183], v[32:35]
    ds_read_b128 v[168:171], v7 offset:256
    v_mfma_f32_16x16x32_bf16 v[60:63], v[204:207], v[184:187], v[60:63]
    ds_read_b128 v[172:175], v7 offset:512
    v_mfma_f32_16x16x32_bf16 v[88:91], v[204:207], v[188:191], v[88:91]
    ds_read_b128 v[176:179], v7 offset:768
    v_mov_b32 v13, v240
    v_mfma_f32_16x16x32_bf16 v[116:119], v[204:207], v[192:195], v[116:119]
    v_add_u32 v18, 0, v240
    v_mov_b32 v14, v241
    v_mfma_f32_16x16x32_bf16 v[120:123], v[208:211], v[192:195], v[120:123]
    v_add_u32 v19, 0, v241
    v_mov_b32 v15, v242
    v_mfma_f32_16x16x32_bf16 v[92:95], v[208:211], v[188:191], v[92:95]
    v_add_u32 v20, 0, v242
    v_mov_b32 v16, v243
    v_mfma_f32_16x16x32_bf16 v[64:67], v[208:211], v[184:187], v[64:67]
    v_add_u32 v21, 0, v243
    s_mov_b32 s42, 0
    s_mov_b32 s43, 0
    v_mfma_f32_16x16x32_bf16 v[36:39], v[208:211], v[180:183], v[36:39]
    s_mov_b32 s48, 0
    v_mov_b32 v17, v12
    v_and_b32 v199, 7, v0
    v_mfma_f32_16x16x32_bf16 v[40:43], v[212:215], v[180:183], v[40:43]
    v_lshrrev_b32 v236, 6, v0
    v_lshlrev_b32 v236, 4, v236
    v_mfma_f32_16x16x32_bf16 v[68:71], v[212:215], v[184:187], v[68:71]
    v_bfe_u32 v237, v0, 3, 3
    v_add_u32 v236, v236, v237
    s_lshr_b32 s78, s29, 1
    v_mfma_f32_16x16x32_bf16 v[96:99], v[212:215], v[188:191], v[96:99]
    s_lshl_b32 s78, s78, 16
    s_and_b32 s79, s29, 1
    s_lshl_b32 s79, s79, 7
    v_mfma_f32_16x16x32_bf16 v[124:127], v[212:215], v[192:195], v[124:127]
    s_add_u32 s78, s78, s79
    s_lshr_b32 s79, s30, 1
    s_lshl_b32 s79, s79, 13
    v_mfma_f32_16x16x32_bf16 v[128:131], v[216:219], v[192:195], v[128:131]
    s_add_u32 s78, s78, s79
    v_lshlrev_b32 v196, 8, v236
    v_lshl_add_u32 v196, v199, 4, v196
    v_mfma_f32_16x16x32_bf16 v[100:103], v[216:219], v[188:191], v[100:103]
    v_add_u32 v196, s78, v196
    s_lshl_b32 s78, s28, 7
    s_lshl_b32 s79, s29, 3
    v_mfma_f32_16x16x32_bf16 v[72:75], v[216:219], v[184:187], v[72:75]
    s_add_u32 s78, s78, s79
    v_add_u32 v197, s78, v199
    v_lshlrev_b32 v198, 11, v197
    v_mfma_f32_16x16x32_bf16 v[44:47], v[216:219], v[180:183], v[44:47]
    v_lshrrev_b32 v237, 2, v236
    v_lshlrev_b32 v237, 3, v237
    v_mfma_f32_16x16x32_bf16 v[48:51], v[220:223], v[180:183], v[48:51]
    v_and_b32 v236, 3, v236
    v_add_u32 v236, v236, v237
    v_mfma_f32_16x16x32_bf16 v[76:79], v[220:223], v[184:187], v[76:79]
    v_lshl_add_u32 v198, v236, 3, v198
    v_lshlrev_b32 v197, 3, v197
    v_mfma_f32_16x16x32_bf16 v[104:107], v[220:223], v[188:191], v[104:107]
    v_lshl_add_u32 v197, v236, 14, v197
    v_mfma_f32_16x16x32_bf16 v[132:135], v[220:223], v[192:195], v[132:135]
    s_waitcnt lgkmcnt(0)
    s_cmp_eq_u32 s35, 1
    s_cbranch_scc1 G3_e1
    v_pk_fma_f32 v[24:25], v[164:165], v[136:137], v[24:25] op_sel_hi:[0,1,1] neg_lo:[1,0,0] neg_hi:[1,0,0]
    v_pk_fma_f32 v[26:27], v[164:165], v[138:139], v[26:27] op_sel_hi:[0,1,1] neg_lo:[1,0,0] neg_hi:[1,0,0]
    v_pk_mul_f32 v[226:227], v[24:25], v[24:25]
    v_pk_mul_f32 v[228:229], v[26:27], v[26:27]
    v_pk_fma_f32 v[226:227], v[226:227], v[166:167], v[166:167] op_sel:[0,1,0] op_sel_hi:[1,1,0]
    v_pk_fma_f32 v[228:229], v[228:229], v[166:167], v[166:167] op_sel:[0,1,0] op_sel_hi:[1,1,0]
    v_pk_mul_f32 v[226:227], v[226:227], v[24:25]
    v_pk_mul_f32 v[228:229], v[228:229], v[26:27]
    v_exp_f32 v226, v226
    v_exp_f32 v227, v227
    v_exp_f32 v228, v228
    v_exp_f32 v229, v229
    v_pk_fma_f32 v[226:227], v[226:227], v[164:165], v[164:165] op_sel:[0,1,1] op_sel_hi:[1,1,1]
    v_pk_fma_f32 v[228:229], v[228:229], v[164:165], v[164:165] op_sel:[0,1,1] op_sel_hi:[1,1,1]
    v_rcp_f32 v226, v226
    v_rcp_f32 v227, v227
    v_rcp_f32 v228, v228
    v_rcp_f32 v229, v229
    v_pk_mul_f32 v[24:25], v[24:25], v[226:227]
    v_pk_mul_f32 v[26:27], v[26:27], v[228:229]
    v_pk_fma_f32 v[28:29], v[164:165], v[140:141], v[28:29] op_sel_hi:[0,1,1] neg_lo:[1,0,0] neg_hi:[1,0,0]
    v_pk_fma_f32 v[30:31], v[164:165], v[142:143], v[30:31] op_sel_hi:[0,1,1] neg_lo:[1,0,0] neg_hi:[1,0,0]
    v_pk_mul_f32 v[226:227], v[28:29], v[28:29]
    v_pk_mul_f32 v[228:229], v[30:31], v[30:31]
    v_pk_fma_f32 v[226:227], v[226:227], v[166:167], v[166:167] op_sel:[0,1,0] op_sel_hi:[1,1,0]
    v_pk_fma_f32 v[228:229], v[228:229], v[166:167], v[166:167] op_sel:[0,1,0] op_sel_hi:[1,1,0]
    v_pk_mul_f32 v[226:227], v[226:227], v[28:29]
    v_pk_mul_f32 v[228:229], v[228:229], v[30:31]
    v_exp_f32 v226, v226
    v_exp_f32 v227, v227
    v_exp_f32 v228, v228
    v_exp_f32 v229, v229
    v_pk_fma_f32 v[226:227], v[226:227], v[164:165], v[164:165] op_sel:[0,1,1] op_sel_hi:[1,1,1]
    v_pk_fma_f32 v[228:229], v[228:229], v[164:165], v[164:165] op_sel:[0,1,1] op_sel_hi:[1,1,1]
    v_rcp_f32 v226, v226
    v_rcp_f32 v227, v227
    v_rcp_f32 v228, v228
    v_rcp_f32 v229, v229
    v_pk_mul_f32 v[28:29], v[28:29], v[226:227]
    v_pk_mul_f32 v[30:31], v[30:31], v[228:229]
    v_cvt_pk_bf16_f32 v24, v24, v25
    v_cvt_pk_bf16_f32 v25, v26, v27
    v_cvt_pk_bf16_f32 v26, v28, v29
    v_cvt_pk_bf16_f32 v27, v30, v31
    v_or_b32 v24, 1, v24
    ds_write_b128 v244, v[24:27] offset:0
    s_add_u32 s36, s44, 0
    buffer_store_dwordx4 v[24:27], v2, s[16:19], s36 offen sc1
    v_pk_fma_f32 v[52:53], v[168:169], v[136:137], v[52:53] op_sel_hi:[0,1,1] neg_lo:[1,0,0] neg_hi:[1,0,0]
    v_pk_fma_f32 v[54:55], v[168:169], v[138:139], v[54:55] op_sel_hi:[0,1,1] neg_lo:[1,0,0] neg_hi:[1,0,0]
    v_pk_mul_f32 v[226:227], v[52:53], v[52:53]
    v_pk_mul_f32 v[228:229], v[54:55], v[54:55]
    v_pk_fma_f32 v[226:227], v[226:227], v[170:171], v[170:171] op_sel:[0,1,0] op_sel_hi:[1,1,0]
    v_pk_fma_f32 v[228:229], v[228:229], v[170:171], v[170:171] op_sel:[0,1,0] op_sel_hi:[1,1,0]
    v_pk_mul_f32 v[226:227], v[226:227], v[52:53]
    v_pk_mul_f32 v[228:229], v[228:229], v[54:55]
    v_exp_f32 v226, v226
    v_exp_f32 v227, v227
    v_exp_f32 v228, v228
    v_exp_f32 v229, v229
    v_pk_fma_f32 v[226:227], v[226:227], v[168:169], v[168:169] op_sel:[0,1,1] op_sel_hi:[1,1,1]
    v_pk_fma_f32 v[228:229], v[228:229], v[168:169], v[168:169] op_sel:[0,1,1] op_sel_hi:[1,1,1]
    v_rcp_f32 v226, v226
    v_rcp_f32 v227, v227
    v_rcp_f32 v228, v228
    v_rcp_f32 v229, v229
    v_pk_mul_f32 v[52:53], v[52:53], v[226:227]
    v_pk_mul_f32 v[54:55], v[54:55], v[228:229]
    v_pk_fma_f32 v[56:57], v[168:169], v[140:141], v[56:57] op_sel_hi:[0,1,1] neg_lo:[1,0,0] neg_hi:[1,0,0]
    v_pk_fma_f32 v[58:59], v[168:169], v[142:143], v[58:59] op_sel_hi:[0,1,1] neg_lo:[1,0,0] neg_hi:[1,0,0]
    v_pk_mul_f32 v[226:227], v[56:57], v[56:57]
    v_pk_mul_f32 v[228:229], v[58:59], v[58:59]
    v_pk_fma_f32 v[226:227], v[226:227], v[170:171], v[170:171] op_sel:[0,1,0] op_sel_hi:[1,1,0]
    v_pk_fma_f32 v[228:229], v[228:229], v[170:171], v[170:171] op_sel:[0,1,0] op_sel_hi:[1,1,0]
    v_pk_mul_f32 v[226:227], v[226:227], v[56:57]
    v_pk_mul_f32 v[228:229], v[228:229], v[58:59]
    v_exp_f32 v226, v226
    v_exp_f32 v227, v227
    v_exp_f32 v228, v228
    v_exp_f32 v229, v229
    v_pk_fma_f32 v[226:227], v[226:227], v[168:169], v[168:169] op_sel:[0,1,1] op_sel_hi:[1,1,1]
    v_pk_fma_f32 v[228:229], v[228:229], v[168:169], v[168:169] op_sel:[0,1,1] op_sel_hi:[1,1,1]
    v_rcp_f32 v226, v226
    v_rcp_f32 v227, v227
    v_rcp_f32 v228, v228
    v_rcp_f32 v229, v229
    v_pk_mul_f32 v[56:57], v[56:57], v[226:227]
    v_pk_mul_f32 v[58:59], v[58:59], v[228:229]
    v_cvt_pk_bf16_f32 v52, v52, v53
    v_cvt_pk_bf16_f32 v53, v54, v55
    v_cvt_pk_bf16_f32 v54, v56, v57
    v_cvt_pk_bf16_f32 v55, v58, v59
    v_or_b32 v52, 1, v52
    ds_write_b128 v244, v[52:55] offset:2048
    s_add_u32 s36, s44, 229376
    buffer_store_dwordx4 v[52:55], v2, s[16:19], s36 offen sc1
    v_pk_fma_f32 v[80:81], v[172:173], v[136:137], v[80:81] op_sel_hi:[0,1,1] neg_lo:[1,0,0] neg_hi:[1,0,0]
    v_pk_fma_f32 v[82:83], v[172:173], v[138:139], v[82:83] op_sel_hi:[0,1,1] neg_lo:[1,0,0] neg_hi:[1,0,0]
    v_pk_mul_f32 v[226:227], v[80:81], v[80:81]
    v_pk_mul_f32 v[228:229], v[82:83], v[82:83]
    v_pk_fma_f32 v[226:227], v[226:227], v[174:175], v[174:175] op_sel:[0,1,0] op_sel_hi:[1,1,0]
    v_pk_fma_f32 v[228:229], v[228:229], v[174:175], v[174:175] op_sel:[0,1,0] op_sel_hi:[1,1,0]
    v_pk_mul_f32 v[226:227], v[226:227], v[80:81]
    v_pk_mul_f32 v[228:229], v[228:229], v[82:83]
    v_exp_f32 v226, v226
    v_exp_f32 v227, v227
    v_exp_f32 v228, v228
    v_exp_f32 v229, v229
    v_pk_fma_f32 v[226:227], v[226:227], v[172:173], v[172:173] op_sel:[0,1,1] op_sel_hi:[1,1,1]
    v_pk_fma_f32 v[228:229], v[228:229], v[172:173], v[172:173] op_sel:[0,1,1] op_sel_hi:[1,1,1]
    v_rcp_f32 v226, v226
    v_rcp_f32 v227, v227
    v_rcp_f32 v228, v228
    v_rcp_f32 v229, v229
    v_pk_mul_f32 v[80:81], v[80:81], v[226:227]
    v_pk_mul_f32 v[82:83], v[82:83], v[228:229]
    v_pk_fma_f32 v[84:85], v[172:173], v[140:141], v[84:85] op_sel_hi:[0,1,1] neg_lo:[1,0,0] neg_hi:[1,0,0]
    v_pk_fma_f32 v[86:87], v[172:173], v[142:143], v[86:87] op_sel_hi:[0,1,1] neg_lo:[1,0,0] neg_hi:[1,0,0]
    v_pk_mul_f32 v[226:227], v[84:85], v[84:85]
    v_pk_mul_f32 v[228:229], v[86:87], v[86:87]
    v_pk_fma_f32 v[226:227], v[226:227], v[174:175], v[174:175] op_sel:[0,1,0] op_sel_hi:[1,1,0]
    v_pk_fma_f32 v[228:229], v[228:229], v[174:175], v[174:175] op_sel:[0,1,0] op_sel_hi:[1,1,0]
    v_pk_mul_f32 v[226:227], v[226:227], v[84:85]
    v_pk_mul_f32 v[228:229], v[228:229], v[86:87]
    v_exp_f32 v226, v226
    v_exp_f32 v227, v227
    v_exp_f32 v228, v228
    v_exp_f32 v229, v229
    v_pk_fma_f32 v[226:227], v[226:227], v[172:173], v[172:173] op_sel:[0,1,1] op_sel_hi:[1,1,1]
    v_pk_fma_f32 v[228:229], v[228:229], v[172:173], v[172:173] op_sel:[0,1,1] op_sel_hi:[1,1,1]
    v_rcp_f32 v226, v226
    v_rcp_f32 v227, v227
    v_rcp_f32 v228, v228
    v_rcp_f32 v229, v229
    v_pk_mul_f32 v[84:85], v[84:85], v[226:227]
    v_pk_mul_f32 v[86:87], v[86:87], v[228:229]
    v_cvt_pk_bf16_f32 v80, v80, v81
    v_cvt_pk_bf16_f32 v81, v82, v83
    v_cvt_pk_bf16_f32 v82, v84, v85
    v_cvt_pk_bf16_f32 v83, v86, v87
    v_or_b32 v80, 1, v80
    ds_write_b128 v244, v[80:83] offset:4096
    s_add_u32 s36, s44, 458752
    buffer_store_dwordx4 v[80:83], v2, s[16:19], s36 offen sc1
    v_pk_fma_f32 v[108:109], v[176:177], v[136:137], v[108:109] op_sel_hi:[0,1,1] neg_lo:[1,0,0] neg_hi:[1,0,0]
    v_pk_fma_f32 v[110:111], v[176:177], v[138:139], v[110:111] op_sel_hi:[0,1,1] neg_lo:[1,0,0] neg_hi:[1,0,0]
    v_pk_mul_f32 v[226:227], v[108:109], v[108:109]
    v_pk_mul_f32 v[228:229], v[110:111], v[110:111]
    v_pk_fma_f32 v[226:227], v[226:227], v[178:179], v[178:179] op_sel:[0,1,0] op_sel_hi:[1,1,0]
    v_pk_fma_f32 v[228:229], v[228:229], v[178:179], v[178:179] op_sel:[0,1,0] op_sel_hi:[1,1,0]
    v_pk_mul_f32 v[226:227], v[226:227], v[108:109]
    v_pk_mul_f32 v[228:229], v[228:229], v[110:111]
    v_exp_f32 v226, v226
    v_exp_f32 v227, v227
    v_exp_f32 v228, v228
    v_exp_f32 v229, v229
    v_pk_fma_f32 v[226:227], v[226:227], v[176:177], v[176:177] op_sel:[0,1,1] op_sel_hi:[1,1,1]
    v_pk_fma_f32 v[228:229], v[228:229], v[176:177], v[176:177] op_sel:[0,1,1] op_sel_hi:[1,1,1]
    v_rcp_f32 v226, v226
    v_rcp_f32 v227, v227
    v_rcp_f32 v228, v228
    v_rcp_f32 v229, v229
    v_pk_mul_f32 v[108:109], v[108:109], v[226:227]
    v_pk_mul_f32 v[110:111], v[110:111], v[228:229]
    v_pk_fma_f32 v[112:113], v[176:177], v[140:141], v[112:113] op_sel_hi:[0,1,1] neg_lo:[1,0,0] neg_hi:[1,0,0]
    v_pk_fma_f32 v[114:115], v[176:177], v[142:143], v[114:115] op_sel_hi:[0,1,1] neg_lo:[1,0,0] neg_hi:[1,0,0]
    v_pk_mul_f32 v[226:227], v[112:113], v[112:113]
    v_pk_mul_f32 v[228:229], v[114:115], v[114:115]
    v_pk_fma_f32 v[226:227], v[226:227], v[178:179], v[178:179] op_sel:[0,1,0] op_sel_hi:[1,1,0]
    v_pk_fma_f32 v[228:229], v[228:229], v[178:179], v[178:179] op_sel:[0,1,0] op_sel_hi:[1,1,0]
    v_pk_mul_f32 v[226:227], v[226:227], v[112:113]
    v_pk_mul_f32 v[228:229], v[228:229], v[114:115]
    v_exp_f32 v226, v226
    v_exp_f32 v227, v227
    v_exp_f32 v228, v228
    v_exp_f32 v229, v229
    v_pk_fma_f32 v[226:227], v[226:227], v[176:177], v[176:177] op_sel:[0,1,1] op_sel_hi:[1,1,1]
    v_pk_fma_f32 v[228:229], v[228:229], v[176:177], v[176:177] op_sel:[0,1,1] op_sel_hi:[1,1,1]
    v_rcp_f32 v226, v226
    v_rcp_f32 v227, v227
    v_rcp_f32 v228, v228
    v_rcp_f32 v229, v229
    v_pk_mul_f32 v[112:113], v[112:113], v[226:227]
    v_pk_mul_f32 v[114:115], v[114:115], v[228:229]
    v_cvt_pk_bf16_f32 v108, v108, v109
    v_cvt_pk_bf16_f32 v109, v110, v111
    v_cvt_pk_bf16_f32 v110, v112, v113
    v_cvt_pk_bf16_f32 v111, v114, v115
    ds_write_b128 v244, v[108:111] offset:6144
    s_add_u32 s36, s44, 688128
    buffer_store_dwordx4 v[108:111], v2, s[16:19], s36 offen sc1
    v_pk_fma_f32 v[32:33], v[164:165], v[144:145], v[32:33] op_sel_hi:[0,1,1] neg_lo:[1,0,0] neg_hi:[1,0,0]
    v_pk_fma_f32 v[34:35], v[164:165], v[146:147], v[34:35] op_sel_hi:[0,1,1] neg_lo:[1,0,0] neg_hi:[1,0,0]
    v_pk_mul_f32 v[226:227], v[32:33], v[32:33]
    v_pk_mul_f32 v[228:229], v[34:35], v[34:35]
    v_pk_fma_f32 v[226:227], v[226:227], v[166:167], v[166:167] op_sel:[0,1,0] op_sel_hi:[1,1,0]
    v_pk_fma_f32 v[228:229], v[228:229], v[166:167], v[166:167] op_sel:[0,1,0] op_sel_hi:[1,1,0]
    v_pk_mul_f32 v[226:227], v[226:227], v[32:33]
    v_pk_mul_f32 v[228:229], v[228:229], v[34:35]
    v_exp_f32 v226, v226
    v_exp_f32 v227, v227
    v_exp_f32 v228, v228
    v_exp_f32 v229, v229
    v_pk_fma_f32 v[226:227], v[226:227], v[164:165], v[164:165] op_sel:[0,1,1] op_sel_hi:[1,1,1]
    v_pk_fma_f32 v[228:229], v[228:229], v[164:165], v[164:165] op_sel:[0,1,1] op_sel_hi:[1,1,1]
    v_rcp_f32 v226, v226
    v_rcp_f32 v227, v227
    v_rcp_f32 v228, v228
    v_rcp_f32 v229, v229
    v_pk_mul_f32 v[32:33], v[32:33], v[226:227]
    v_pk_mul_f32 v[34:35], v[34:35], v[228:229]
    v_pk_fma_f32 v[36:37], v[164:165], v[148:149], v[36:37] op_sel_hi:[0,1,1] neg_lo:[1,0,0] neg_hi:[1,0,0]
    v_pk_fma_f32 v[38:39], v[164:165], v[150:151], v[38:39] op_sel_hi:[0,1,1] neg_lo:[1,0,0] neg_hi:[1,0,0]
    v_pk_mul_f32 v[226:227], v[36:37], v[36:37]
    v_pk_mul_f32 v[228:229], v[38:39], v[38:39]
    v_pk_fma_f32 v[226:227], v[226:227], v[166:167], v[166:167] op_sel:[0,1,0] op_sel_hi:[1,1,0]
    v_pk_fma_f32 v[228:229], v[228:229], v[166:167], v[166:167] op_sel:[0,1,0] op_sel_hi:[1,1,0]
    v_pk_mul_f32 v[226:227], v[226:227], v[36:37]
    v_pk_mul_f32 v[228:229], v[228:229], v[38:39]
    v_exp_f32 v226, v226
    v_exp_f32 v227, v227
    v_exp_f32 v228, v228
    v_exp_f32 v229, v229
    v_pk_fma_f32 v[226:227], v[226:227], v[164:165], v[164:165] op_sel:[0,1,1] op_sel_hi:[1,1,1]
    v_pk_fma_f32 v[228:229], v[228:229], v[164:165], v[164:165] op_sel:[0,1,1] op_sel_hi:[1,1,1]
    v_rcp_f32 v226, v226
    v_rcp_f32 v227, v227
    v_rcp_f32 v228, v228
    v_rcp_f32 v229, v229
    v_pk_mul_f32 v[36:37], v[36:37], v[226:227]
    v_pk_mul_f32 v[38:39], v[38:39], v[228:229]
    v_cvt_pk_bf16_f32 v32, v32, v33
    v_cvt_pk_bf16_f32 v33, v34, v35
    v_cvt_pk_bf16_f32 v34, v36, v37
    v_cvt_pk_bf16_f32 v35, v38, v39
    v_or_b32 v32, 1, v32
    ds_write_b128 v244, v[32:35] offset:16384
    v_pk_fma_f32 v[60:61], v[168:169], v[144:145], v[60:61] op_sel_hi:[0,1,1] neg_lo:[1,0,0] neg_hi:[1,0,0]
    v_pk_fma_f32 v[62:63], v[168:169], v[146:147], v[62:63] op_sel_hi:[0,1,1] neg_lo:[1,0,0] neg_hi:[1,0,0]
    v_pk_mul_f32 v[226:227], v[60:61], v[60:61]
    v_pk_mul_f32 v[228:229], v[62:63], v[62:63]
    v_pk_fma_f32 v[226:227], v[226:227], v[170:171], v[170:171] op_sel:[0,1,0] op_sel_hi:[1,1,0]
    v_pk_fma_f32 v[228:229], v[228:229], v[170:171], v[170:171] op_sel:[0,1,0] op_sel_hi:[1,1,0]
    v_pk_mul_f32 v[226:227], v[226:227], v[60:61]
    v_pk_mul_f32 v[228:229], v[228:229], v[62:63]
    v_exp_f32 v226, v226
    v_exp_f32 v227, v227
    v_exp_f32 v228, v228
    v_exp_f32 v229, v229
    v_pk_fma_f32 v[226:227], v[226:227], v[168:169], v[168:169] op_sel:[0,1,1] op_sel_hi:[1,1,1]
    v_pk_fma_f32 v[228:229], v[228:229], v[168:169], v[168:169] op_sel:[0,1,1] op_sel_hi:[1,1,1]
    v_rcp_f32 v226, v226
    v_rcp_f32 v227, v227
    v_rcp_f32 v228, v228
    v_rcp_f32 v229, v229
    v_pk_mul_f32 v[60:61], v[60:61], v[226:227]
    v_pk_mul_f32 v[62:63], v[62:63], v[228:229]
    v_pk_fma_f32 v[64:65], v[168:169], v[148:149], v[64:65] op_sel_hi:[0,1,1] neg_lo:[1,0,0] neg_hi:[1,0,0]
    v_pk_fma_f32 v[66:67], v[168:169], v[150:151], v[66:67] op_sel_hi:[0,1,1] neg_lo:[1,0,0] neg_hi:[1,0,0]
    v_pk_mul_f32 v[226:227], v[64:65], v[64:65]
    v_pk_mul_f32 v[228:229], v[66:67], v[66:67]
    v_pk_fma_f32 v[226:227], v[226:227], v[170:171], v[170:171] op_sel:[0,1,0] op_sel_hi:[1,1,0]
    v_pk_fma_f32 v[228:229], v[228:229], v[170:171], v[170:171] op_sel:[0,1,0] op_sel_hi:[1,1,0]
    v_pk_mul_f32 v[226:227], v[226:227], v[64:65]
    v_pk_mul_f32 v[228:229], v[228:229], v[66:67]
    v_exp_f32 v226, v226
    v_exp_f32 v227, v227
    v_exp_f32 v228, v228
    v_exp_f32 v229, v229
    v_pk_fma_f32 v[226:227], v[226:227], v[168:169], v[168:169] op_sel:[0,1,1] op_sel_hi:[1,1,1]
    v_pk_fma_f32 v[228:229], v[228:229], v[168:169], v[168:169] op_sel:[0,1,1] op_sel_hi:[1,1,1]
    v_rcp_f32 v226, v226
    v_rcp_f32 v227, v227
    v_rcp_f32 v228, v228
    v_rcp_f32 v229, v229
    v_pk_mul_f32 v[64:65], v[64:65], v[226:227]
    v_pk_mul_f32 v[66:67], v[66:67], v[228:229]
    v_cvt_pk_bf16_f32 v60, v60, v61
    v_cvt_pk_bf16_f32 v61, v62, v63
    v_cvt_pk_bf16_f32 v62, v64, v65
    v_cvt_pk_bf16_f32 v63, v66, v67
    v_or_b32 v60, 1, v60
    ds_write_b128 v244, v[60:63] offset:18432
    s_waitcnt vmcnt(0)
    s_mov_b64 exec, 1
    ds_add_u32 v246, v245
    s_mov_b64 exec, -1
    v_pk_fma_f32 v[88:89], v[172:173], v[144:145], v[88:89] op_sel_hi:[0,1,1] neg_lo:[1,0,0] neg_hi:[1,0,0]
    v_pk_fma_f32 v[90:91], v[172:173], v[146:147], v[90:91] op_sel_hi:[0,1,1] neg_lo:[1,0,0] neg_hi:[1,0,0]
    v_pk_mul_f32 v[226:227], v[88:89], v[88:89]
    v_pk_mul_f32 v[228:229], v[90:91], v[90:91]
    v_pk_fma_f32 v[226:227], v[226:227], v[174:175], v[174:175] op_sel:[0,1,0] op_sel_hi:[1,1,0]
    v_pk_fma_f32 v[228:229], v[228:229], v[174:175], v[174:175] op_sel:[0,1,0] op_sel_hi:[1,1,0]
    v_pk_mul_f32 v[226:227], v[226:227], v[88:89]
    v_pk_mul_f32 v[228:229], v[228:229], v[90:91]
    v_exp_f32 v226, v226
    v_exp_f32 v227, v227
    v_exp_f32 v228, v228
    v_exp_f32 v229, v229
    v_pk_fma_f32 v[226:227], v[226:227], v[172:173], v[172:173] op_sel:[0,1,1] op_sel_hi:[1,1,1]
    v_pk_fma_f32 v[228:229], v[228:229], v[172:173], v[172:173] op_sel:[0,1,1] op_sel_hi:[1,1,1]
    v_rcp_f32 v226, v226
    v_rcp_f32 v227, v227
    v_rcp_f32 v228, v228
    v_rcp_f32 v229, v229
    v_pk_mul_f32 v[88:89], v[88:89], v[226:227]
    v_pk_mul_f32 v[90:91], v[90:91], v[228:229]
    v_pk_fma_f32 v[92:93], v[172:173], v[148:149], v[92:93] op_sel_hi:[0,1,1] neg_lo:[1,0,0] neg_hi:[1,0,0]
    v_pk_fma_f32 v[94:95], v[172:173], v[150:151], v[94:95] op_sel_hi:[0,1,1] neg_lo:[1,0,0] neg_hi:[1,0,0]
    v_pk_mul_f32 v[226:227], v[92:93], v[92:93]
    v_pk_mul_f32 v[228:229], v[94:95], v[94:95]
    v_pk_fma_f32 v[226:227], v[226:227], v[174:175], v[174:175] op_sel:[0,1,0] op_sel_hi:[1,1,0]
    v_pk_fma_f32 v[228:229], v[228:229], v[174:175], v[174:175] op_sel:[0,1,0] op_sel_hi:[1,1,0]
    v_pk_mul_f32 v[226:227], v[226:227], v[92:93]
    v_pk_mul_f32 v[228:229], v[228:229], v[94:95]
    v_exp_f32 v226, v226
    v_exp_f32 v227, v227
    v_exp_f32 v228, v228
    v_exp_f32 v229, v229
    v_pk_fma_f32 v[226:227], v[226:227], v[172:173], v[172:173] op_sel:[0,1,1] op_sel_hi:[1,1,1]
    v_pk_fma_f32 v[228:229], v[228:229], v[172:173], v[172:173] op_sel:[0,1,1] op_sel_hi:[1,1,1]
    v_rcp_f32 v226, v226
    v_rcp_f32 v227, v227
    v_rcp_f32 v228, v228
    v_rcp_f32 v229, v229
    v_pk_mul_f32 v[92:93], v[92:93], v[226:227]
    v_pk_mul_f32 v[94:95], v[94:95], v[228:229]
    v_cvt_pk_bf16_f32 v88, v88, v89
    v_cvt_pk_bf16_f32 v89, v90, v91
    v_cvt_pk_bf16_f32 v90, v92, v93
    v_cvt_pk_bf16_f32 v91, v94, v95
    v_or_b32 v88, 1, v88
    ds_write_b128 v244, v[88:91] offset:20480
    s_cmp_eq_u32 s60, 1
    s_cbranch_scc1 G4_p10
    buffer_load_dwordx4 v[180:183], v196, s[84:87], 0 offen offset:0 sc1
    buffer_load_dwordx4 v[188:191], v196, s[88:91], 0 offen offset:0 sc1
    buffer_load_dwordx4 v[184:187], v196, s[84:87], 0 offen offset:2048 sc1
    buffer_load_dwordx4 v[192:195], v196, s[88:91], 0 offen offset:2048 sc1
    s_mov_b32 s78, 0
    buffer_load_dwordx2 v[230:231], v197, s[80:83], s78 offen sc1
    s_mov_b32 s78, 65536
    buffer_load_dwordx2 v[232:233], v197, s[80:83], s78 offen sc1
    s_mov_b32 s78, 262144
    buffer_load_dwordx2 v[234:235], v197, s[80:83], s78 offen sc1
    s_mov_b32 s78, 327680
    buffer_load_dwordx2 v[236:237], v197, s[80:83], s78 offen sc1
    s_branch G4_p20
G4_p10:
    s_add_u32 s36, s40, 0
    buffer_load_dwordx4 v[180:183], v2, s[84:87], s36 offen offset:0 sc1
    buffer_load_dwordx4 v[184:187], v2, s[88:91], s36 offen offset:0 sc1
    buffer_load_dwordx4 v[188:191], v2, s[84:87], s36 offen offset:1024 sc1
    buffer_load_dwordx4 v[192:195], v2, s[88:91], s36 offen offset:1024 sc1
    s_add_u32 s36, s40, 65536
    buffer_load_dwordx4 v[196:199], v2, s[84:87], s36 offen offset:0 sc1
    buffer_load_dwordx4 v[230:233], v2, s[88:91], s36 offen offset:0 sc1
    buffer_load_dwordx4 v[234:237], v2, s[84:87], s36 offen offset:1024 sc1
    buffer_load_dwordx4 v[248:251], v2, s[88:91], s36 offen offset:1024 sc1
G4_p20:
    v_pk_fma_f32 v[116:117], v[176:177], v[144:145], v[116:117] op_sel_hi:[0,1,1] neg_lo:[1,0,0] neg_hi:[1,0,0]
    v_pk_fma_f32 v[118:119], v[176:177], v[146:147], v[118:119] op_sel_hi:[0,1,1] neg_lo:[1,0,0] neg_hi:[1,0,0]
    v_pk_mul_f32 v[226:227], v[116:117], v[116:117]
    v_pk_mul_f32 v[228:229], v[118:119], v[118:119]
    v_pk_fma_f32 v[226:227], v[226:227], v[178:179], v[178:179] op_sel:[0,1,0] op_sel_hi:[1,1,0]
    v_pk_fma_f32 v[228:229], v[228:229], v[178:179], v[178:179] op_sel:[0,1,0] op_sel_hi:[1,1,0]
    v_pk_mul_f32 v[226:227], v[226:227], v[116:117]
    v_pk_mul_f32 v[228:229], v[228:229], v[118:119]
    v_exp_f32 v226, v226
    v_exp_f32 v227, v227
    v_exp_f32 v228, v228
    v_exp_f32 v229, v229
    v_pk_fma_f32 v[226:227], v[226:227], v[176:177], v[176:177] op_sel:[0,1,1] op_sel_hi:[1,1,1]
    v_pk_fma_f32 v[228:229], v[228:229], v[176:177], v[176:177] op_sel:[0,1,1] op_sel_hi:[1,1,1]
    v_rcp_f32 v226, v226
    v_rcp_f32 v227, v227
    v_rcp_f32 v228, v228
    v_rcp_f32 v229, v229
    v_pk_mul_f32 v[116:117], v[116:117], v[226:227]
    v_pk_mul_f32 v[118:119], v[118:119], v[228:229]
    v_pk_fma_f32 v[120:121], v[176:177], v[148:149], v[120:121] op_sel_hi:[0,1,1] neg_lo:[1,0,0] neg_hi:[1,0,0]
    v_pk_fma_f32 v[122:123], v[176:177], v[150:151], v[122:123] op_sel_hi:[0,1,1] neg_lo:[1,0,0] neg_hi:[1,0,0]
    v_pk_mul_f32 v[226:227], v[120:121], v[120:121]
    v_pk_mul_f32 v[228:229], v[122:123], v[122:123]
    v_pk_fma_f32 v[226:227], v[226:227], v[178:179], v[178:179] op_sel:[0,1,0] op_sel_hi:[1,1,0]
    v_pk_fma_f32 v[228:229], v[228:229], v[178:179], v[178:179] op_sel:[0,1,0] op_sel_hi:[1,1,0]
    v_pk_mul_f32 v[226:227], v[226:227], v[120:121]
    v_pk_mul_f32 v[228:229], v[228:229], v[122:123]
    v_exp_f32 v226, v226
    v_exp_f32 v227, v227
    v_exp_f32 v228, v228
    v_exp_f32 v229, v229
    v_pk_fma_f32 v[226:227], v[226:227], v[176:177], v[176:177] op_sel:[0,1,1] op_sel_hi:[1,1,1]
    v_pk_fma_f32 v[228:229], v[228:229], v[176:177], v[176:177] op_sel:[0,1,1] op_sel_hi:[1,1,1]
    v_rcp_f32 v226, v226
    v_rcp_f32 v227, v227
    v_rcp_f32 v228, v228
    v_rcp_f32 v229, v229
    v_pk_mul_f32 v[120:121], v[120:121], v[226:227]
    v_pk_mul_f32 v[122:123], v[122:123], v[228:229]
    v_cvt_pk_bf16_f32 v116, v116, v117
    v_cvt_pk_bf16_f32 v117, v118, v119
    v_cvt_pk_bf16_f32 v118, v120, v121
    v_cvt_pk_bf16_f32 v119, v122, v123
    ds_write_b128 v244, v[116:119] offset:22528
    v_pk_fma_f32 v[40:41], v[164:165], v[152:153], v[40:41] op_sel_hi:[0,1,1] neg_lo:[1,0,0] neg_hi:[1,0,0]
    v_pk_fma_f32 v[42:43], v[164:165], v[154:155], v[42:43] op_sel_hi:[0,1,1] neg_lo:[1,0,0] neg_hi:[1,0,0]
    v_pk_mul_f32 v[226:227], v[40:41], v[40:41]
    v_pk_mul_f32 v[228:229], v[42:43], v[42:43]
    v_pk_fma_f32 v[226:227], v[226:227], v[166:167], v[166:167] op_sel:[0,1,0] op_sel_hi:[1,1,0]
    v_pk_fma_f32 v[228:229], v[228:229], v[166:167], v[166:167] op_sel:[0,1,0] op_sel_hi:[1,1,0]
    v_pk_mul_f32 v[226:227], v[226:227], v[40:41]
    v_pk_mul_f32 v[228:229], v[228:229], v[42:43]
    v_exp_f32 v226, v226
    v_exp_f32 v227, v227
    v_exp_f32 v228, v228
    v_exp_f32 v229, v229
    v_pk_fma_f32 v[226:227], v[226:227], v[164:165], v[164:165] op_sel:[0,1,1] op_sel_hi:[1,1,1]
    v_pk_fma_f32 v[228:229], v[228:229], v[164:165], v[164:165] op_sel:[0,1,1] op_sel_hi:[1,1,1]
    v_rcp_f32 v226, v226
    v_rcp_f32 v227, v227
    v_rcp_f32 v228, v228
    v_rcp_f32 v229, v229
    v_pk_mul_f32 v[40:41], v[40:41], v[226:227]
    v_pk_mul_f32 v[42:43], v[42:43], v[228:229]
    v_pk_fma_f32 v[44:45], v[164:165], v[156:157], v[44:45] op_sel_hi:[0,1,1] neg_lo:[1,0,0] neg_hi:[1,0,0]
    v_pk_fma_f32 v[46:47], v[164:165], v[158:159], v[46:47] op_sel_hi:[0,1,1] neg_lo:[1,0,0] neg_hi:[1,0,0]
    v_pk_mul_f32 v[226:227], v[44:45], v[44:45]
    v_pk_mul_f32 v[228:229], v[46:47], v[46:47]
    v_pk_fma_f32 v[226:227], v[226:227], v[166:167], v[166:167] op_sel:[0,1,0] op_sel_hi:[1,1,0]
    v_pk_fma_f32 v[228:229], v[228:229], v[166:167], v[166:167] op_sel:[0,1,0] op_sel_hi:[1,1,0]
    v_pk_mul_f32 v[226:227], v[226:227], v[44:45]
    v_pk_mul_f32 v[228:229], v[228:229], v[46:47]
    v_exp_f32 v226, v226
    v_exp_f32 v227, v227
    v_exp_f32 v228, v228
    v_exp_f32 v229, v229
    v_pk_fma_f32 v[226:227], v[226:227], v[164:165], v[164:165] op_sel:[0,1,1] op_sel_hi:[1,1,1]
    v_pk_fma_f32 v[228:229], v[228:229], v[164:165], v[164:165] op_sel:[0,1,1] op_sel_hi:[1,1,1]
    v_rcp_f32 v226, v226
    v_rcp_f32 v227, v227
    v_rcp_f32 v228, v228
    v_rcp_f32 v229, v229
    v_pk_mul_f32 v[44:45], v[44:45], v[226:227]
    v_pk_mul_f32 v[46:47], v[46:47], v[228:229]
    v_cvt_pk_bf16_f32 v200, v40, v41
    v_cvt_pk_bf16_f32 v201, v42, v43
    v_cvt_pk_bf16_f32 v202, v44, v45
    v_cvt_pk_bf16_f32 v203, v46, v47
    v_or_b32 v200, 1, v200
    ds_write_b128 v244, v[200:203] offset:32768
    v_pk_fma_f32 v[68:69], v[168:169], v[152:153], v[68:69] op_sel_hi:[0,1,1] neg_lo:[1,0,0] neg_hi:[1,0,0]
    v_pk_fma_f32 v[70:71], v[168:169], v[154:155], v[70:71] op_sel_hi:[0,1,1] neg_lo:[1,0,0] neg_hi:[1,0,0]
    v_pk_mul_f32 v[226:227], v[68:69], v[68:69]
    v_pk_mul_f32 v[228:229], v[70:71], v[70:71]
    v_pk_fma_f32 v[226:227], v[226:227], v[170:171], v[170:171] op_sel:[0,1,0] op_sel_hi:[1,1,0]
    v_pk_fma_f32 v[228:229], v[228:229], v[170:171], v[170:171] op_sel:[0,1,0] op_sel_hi:[1,1,0]
    v_pk_mul_f32 v[226:227], v[226:227], v[68:69]
    v_pk_mul_f32 v[228:229], v[228:229], v[70:71]
    v_exp_f32 v226, v226
    v_exp_f32 v227, v227
    v_exp_f32 v228, v228
    v_exp_f32 v229, v229
    v_pk_fma_f32 v[226:227], v[226:227], v[168:169], v[168:169] op_sel:[0,1,1] op_sel_hi:[1,1,1]
    v_pk_fma_f32 v[228:229], v[228:229], v[168:169], v[168:169] op_sel:[0,1,1] op_sel_hi:[1,1,1]
    v_rcp_f32 v226, v226
    v_rcp_f32 v227, v227
    v_rcp_f32 v228, v228
    v_rcp_f32 v229, v229
    v_pk_mul_f32 v[68:69], v[68:69], v[226:227]
    v_pk_mul_f32 v[70:71], v[70:71], v[228:229]
    v_pk_fma_f32 v[72:73], v[168:169], v[156:157], v[72:73] op_sel_hi:[0,1,1] neg_lo:[1,0,0] neg_hi:[1,0,0]
    v_pk_fma_f32 v[74:75], v[168:169], v[158:159], v[74:75] op_sel_hi:[0,1,1] neg_lo:[1,0,0] neg_hi:[1,0,0]
    v_pk_mul_f32 v[226:227], v[72:73], v[72:73]
    v_pk_mul_f32 v[228:229], v[74:75], v[74:75]
    v_pk_fma_f32 v[226:227], v[226:227], v[170:171], v[170:171] op_sel:[0,1,0] op_sel_hi:[1,1,0]
    v_pk_fma_f32 v[228:229], v[228:229], v[170:171], v[170:171] op_sel:[0,1,0] op_sel_hi:[1,1,0]
    v_pk_mul_f32 v[226:227], v[226:227], v[72:73]
    v_pk_mul_f32 v[228:229], v[228:229], v[74:75]
    v_exp_f32 v226, v226
    v_exp_f32 v227, v227
    v_exp_f32 v228, v228
    v_exp_f32 v229, v229
    v_pk_fma_f32 v[226:227], v[226:227], v[168:169], v[168:169] op_sel:[0,1,1] op_sel_hi:[1,1,1]
    v_pk_fma_f32 v[228:229], v[228:229], v[168:169], v[168:169] op_sel:[0,1,1] op_sel_hi:[1,1,1]
    v_rcp_f32 v226, v226
    v_rcp_f32 v227, v227
    v_rcp_f32 v228, v228
    v_rcp_f32 v229, v229
    v_pk_mul_f32 v[72:73], v[72:73], v[226:227]
    v_pk_mul_f32 v[74:75], v[74:75], v[228:229]
    v_cvt_pk_bf16_f32 v204, v68, v69
    v_cvt_pk_bf16_f32 v205, v70, v71
    v_cvt_pk_bf16_f32 v206, v72, v73
    v_cvt_pk_bf16_f32 v207, v74, v75
    v_or_b32 v204, 1, v204
    ds_write_b128 v244, v[204:207] offset:34816
    v_pk_fma_f32 v[96:97], v[172:173], v[152:153], v[96:97] op_sel_hi:[0,1,1] neg_lo:[1,0,0] neg_hi:[1,0,0]
    v_pk_fma_f32 v[98:99], v[172:173], v[154:155], v[98:99] op_sel_hi:[0,1,1] neg_lo:[1,0,0] neg_hi:[1,0,0]
    v_pk_mul_f32 v[226:227], v[96:97], v[96:97]
    v_pk_mul_f32 v[228:229], v[98:99], v[98:99]
    v_pk_fma_f32 v[226:227], v[226:227], v[174:175], v[174:175] op_sel:[0,1,0] op_sel_hi:[1,1,0]
    v_pk_fma_f32 v[228:229], v[228:229], v[174:175], v[174:175] op_sel:[0,1,0] op_sel_hi:[1,1,0]
    v_pk_mul_f32 v[226:227], v[226:227], v[96:97]
    v_pk_mul_f32 v[228:229], v[228:229], v[98:99]
    v_exp_f32 v226, v226
    v_exp_f32 v227, v227
    v_exp_f32 v228, v228
    v_exp_f32 v229, v229
    v_pk_fma_f32 v[226:227], v[226:227], v[172:173], v[172:173] op_sel:[0,1,1] op_sel_hi:[1,1,1]
    v_pk_fma_f32 v[228:229], v[228:229], v[172:173], v[172:173] op_sel:[0,1,1] op_sel_hi:[1,1,1]
    v_rcp_f32 v226, v226
    v_rcp_f32 v227, v227
    v_rcp_f32 v228, v228
    v_rcp_f32 v229, v229
    v_pk_mul_f32 v[96:97], v[96:97], v[226:227]
    v_pk_mul_f32 v[98:99], v[98:99], v[228:229]
    v_pk_fma_f32 v[100:101], v[172:173], v[156:157], v[100:101] op_sel_hi:[0,1,1] neg_lo:[1,0,0] neg_hi:[1,0,0]
    v_pk_fma_f32 v[102:103], v[172:173], v[158:159], v[102:103] op_sel_hi:[0,1,1] neg_lo:[1,0,0] neg_hi:[1,0,0]
    v_pk_mul_f32 v[226:227], v[100:101], v[100:101]
    v_pk_mul_f32 v[228:229], v[102:103], v[102:103]
    v_pk_fma_f32 v[226:227], v[226:227], v[174:175], v[174:175] op_sel:[0,1,0] op_sel_hi:[1,1,0]
    v_pk_fma_f32 v[228:229], v[228:229], v[174:175], v[174:175] op_sel:[0,1,0] op_sel_hi:[1,1,0]
    v_pk_mul_f32 v[226:227], v[226:227], v[100:101]
    v_pk_mul_f32 v[228:229], v[228:229], v[102:103]
    v_exp_f32 v226, v226
    v_exp_f32 v227, v227
    v_exp_f32 v228, v228
    v_exp_f32 v229, v229
    v_pk_fma_f32 v[226:227], v[226:227], v[172:173], v[172:173] op_sel:[0,1,1] op_sel_hi:[1,1,1]
    v_pk_fma_f32 v[228:229], v[228:229], v[172:173], v[172:173] op_sel:[0,1,1] op_sel_hi:[1,1,1]
    v_rcp_f32 v226, v226
    v_rcp_f32 v227, v227
    v_rcp_f32 v228, v228
    v_rcp_f32 v229, v229
    v_pk_mul_f32 v[100:101], v[100:101], v[226:227]
    v_pk_mul_f32 v[102:103], v[102:103], v[228:229]
    v_cvt_pk_bf16_f32 v208, v96, v97
    v_cvt_pk_bf16_f32 v209, v98, v99
    v_cvt_pk_bf16_f32 v210, v100, v101
    v_cvt_pk_bf16_f32 v211, v102, v103
    v_or_b32 v208, 1, v208
    ds_write_b128 v244, v[208:211] offset:36864
    v_pk_fma_f32 v[124:125], v[176:177], v[152:153], v[124:125] op_sel_hi:[0,1,1] neg_lo:[1,0,0] neg_hi:[1,0,0]
    v_pk_fma_f32 v[126:127], v[176:177], v[154:155], v[126:127] op_sel_hi:[0,1,1] neg_lo:[1,0,0] neg_hi:[1,0,0]
    v_pk_mul_f32 v[226:227], v[124:125], v[124:125]
    v_pk_mul_f32 v[228:229], v[126:127], v[126:127]
    v_pk_fma_f32 v[226:227], v[226:227], v[178:179], v[178:179] op_sel:[0,1,0] op_sel_hi:[1,1,0]
    v_pk_fma_f32 v[228:229], v[228:229], v[178:179], v[178:179] op_sel:[0,1,0] op_sel_hi:[1,1,0]
    v_pk_mul_f32 v[226:227], v[226:227], v[124:125]
    v_pk_mul_f32 v[228:229], v[228:229], v[126:127]
    v_exp_f32 v226, v226
    v_exp_f32 v227, v227
    v_exp_f32 v228, v228
    v_exp_f32 v229, v229
    v_pk_fma_f32 v[226:227], v[226:227], v[176:177], v[176:177] op_sel:[0,1,1] op_sel_hi:[1,1,1]
    v_pk_fma_f32 v[228:229], v[228:229], v[176:177], v[176:177] op_sel:[0,1,1] op_sel_hi:[1,1,1]
    v_rcp_f32 v226, v226
    v_rcp_f32 v227, v227
    v_rcp_f32 v228, v228
    v_rcp_f32 v229, v229
    v_pk_mul_f32 v[124:125], v[124:125], v[226:227]
    v_pk_mul_f32 v[126:127], v[126:127], v[228:229]
    v_pk_fma_f32 v[128:129], v[176:177], v[156:157], v[128:129] op_sel_hi:[0,1,1] neg_lo:[1,0,0] neg_hi:[1,0,0]
    v_pk_fma_f32 v[130:131], v[176:177], v[158:159], v[130:131] op_sel_hi:[0,1,1] neg_lo:[1,0,0] neg_hi:[1,0,0]
    v_pk_mul_f32 v[226:227], v[128:129], v[128:129]
    v_pk_mul_f32 v[228:229], v[130:131], v[130:131]
    v_pk_fma_f32 v[226:227], v[226:227], v[178:179], v[178:179] op_sel:[0,1,0] op_sel_hi:[1,1,0]
    v_pk_fma_f32 v[228:229], v[228:229], v[178:179], v[178:179] op_sel:[0,1,0] op_sel_hi:[1,1,0]
    v_pk_mul_f32 v[226:227], v[226:227], v[128:129]
    v_pk_mul_f32 v[228:229], v[228:229], v[130:131]
    v_exp_f32 v226, v226
    v_exp_f32 v227, v227
    v_exp_f32 v228, v228
    v_exp_f32 v229, v229
    v_pk_fma_f32 v[226:227], v[226:227], v[176:177], v[176:177] op_sel:[0,1,1] op_sel_hi:[1,1,1]
    v_pk_fma_f32 v[228:229], v[228:229], v[176:177], v[176:177] op_sel:[0,1,1] op_sel_hi:[1,1,1]
    v_rcp_f32 v226, v226
    v_rcp_f32 v227, v227
    v_rcp_f32 v228, v228
    v_rcp_f32 v229, v229
    v_pk_mul_f32 v[128:129], v[128:129], v[226:227]
    v_pk_mul_f32 v[130:131], v[130:131], v[228:229]
    v_cvt_pk_bf16_f32 v212, v124, v125
    v_cvt_pk_bf16_f32 v213, v126, v127
    v_cvt_pk_bf16_f32 v214, v128, v129
    v_cvt_pk_bf16_f32 v215, v130, v131
    ds_write_b128 v244, v[212:215] offset:38912
    v_pk_fma_f32 v[48:49], v[164:165], v[160:161], v[48:49] op_sel_hi:[0,1,1] neg_lo:[1,0,0] neg_hi:[1,0,0]
    v_pk_fma_f32 v[50:51], v[164:165], v[162:163], v[50:51] op_sel_hi:[0,1,1] neg_lo:[1,0,0] neg_hi:[1,0,0]
    v_pk_mul_f32 v[226:227], v[48:49], v[48:49]
    v_pk_mul_f32 v[228:229], v[50:51], v[50:51]
    v_pk_fma_f32 v[226:227], v[226:227], v[166:167], v[166:167] op_sel:[0,1,0] op_sel_hi:[1,1,0]
    v_pk_fma_f32 v[228:229], v[228:229], v[166:167], v[166:167] op_sel:[0,1,0] op_sel_hi:[1,1,0]
    v_pk_mul_f32 v[226:227], v[226:227], v[48:49]
    v_pk_mul_f32 v[228:229], v[228:229], v[50:51]
    v_exp_f32 v226, v226
    v_exp_f32 v227, v227
    v_exp_f32 v228, v228
    v_exp_f32 v229, v229
    v_pk_fma_f32 v[226:227], v[226:227], v[164:165], v[164:165] op_sel:[0,1,1] op_sel_hi:[1,1,1]
    v_pk_fma_f32 v[228:229], v[228:229], v[164:165], v[164:165] op_sel:[0,1,1] op_sel_hi:[1,1,1]
    v_rcp_f32 v226, v226
    v_rcp_f32 v227, v227
    v_rcp_f32 v228, v228
    v_rcp_f32 v229, v229
    v_pk_mul_f32 v[48:49], v[48:49], v[226:227]
    v_pk_mul_f32 v[50:51], v[50:51], v[228:229]
    v_cvt_pk_bf16_f32 v216, v48, v49
    v_cvt_pk_bf16_f32 v217, v50, v51
    v_or_b32 v216, 1, v216
    s_add_u32 s36, s45, 0
    buffer_store_dwordx4 v[32:35], v2, s[16:19], s36 offen sc1
    v_pk_fma_f32 v[76:77], v[168:169], v[160:161], v[76:77] op_sel_hi:[0,1,1] neg_lo:[1,0,0] neg_hi:[1,0,0]
    v_pk_fma_f32 v[78:79], v[168:169], v[162:163], v[78:79] op_sel_hi:[0,1,1] neg_lo:[1,0,0] neg_hi:[1,0,0]
    v_pk_mul_f32 v[226:227], v[76:77], v[76:77]
    v_pk_mul_f32 v[228:229], v[78:79], v[78:79]
    v_pk_fma_f32 v[226:227], v[226:227], v[170:171], v[170:171] op_sel:[0,1,0] op_sel_hi:[1,1,0]
    v_pk_fma_f32 v[228:229], v[228:229], v[170:171], v[170:171] op_sel:[0,1,0] op_sel_hi:[1,1,0]
    v_pk_mul_f32 v[226:227], v[226:227], v[76:77]
    v_pk_mul_f32 v[228:229], v[228:229], v[78:79]
    v_exp_f32 v226, v226
    v_exp_f32 v227, v227
    v_exp_f32 v228, v228
    v_exp_f32 v229, v229
    v_pk_fma_f32 v[226:227], v[226:227], v[168:169], v[168:169] op_sel:[0,1,1] op_sel_hi:[1,1,1]
    v_pk_fma_f32 v[228:229], v[228:229], v[168:169], v[168:169] op_sel:[0,1,1] op_sel_hi:[1,1,1]
    v_rcp_f32 v226, v226
    v_rcp_f32 v227, v227
    v_rcp_f32 v228, v228
    v_rcp_f32 v229, v229
    v_pk_mul_f32 v[76:77], v[76:77], v[226:227]
    v_pk_mul_f32 v[78:79], v[78:79], v[228:229]
    v_cvt_pk_bf16_f32 v218, v76, v77
    v_cvt_pk_bf16_f32 v219, v78, v79
    v_or_b32 v218, 1, v218
    s_add_u32 s36, s45, 229376
    buffer_store_dwordx4 v[60:63], v2, s[16:19], s36 offen sc1
    v_pk_fma_f32 v[104:105], v[172:173], v[160:161], v[104:105] op_sel_hi:[0,1,1] neg_lo:[1,0,0] neg_hi:[1,0,0]
    v_pk_fma_f32 v[106:107], v[172:173], v[162:163], v[106:107] op_sel_hi:[0,1,1] neg_lo:[1,0,0] neg_hi:[1,0,0]
    v_pk_mul_f32 v[226:227], v[104:105], v[104:105]
    v_pk_mul_f32 v[228:229], v[106:107], v[106:107]
    v_pk_fma_f32 v[226:227], v[226:227], v[174:175], v[174:175] op_sel:[0,1,0] op_sel_hi:[1,1,0]
    v_pk_fma_f32 v[228:229], v[228:229], v[174:175], v[174:175] op_sel:[0,1,0] op_sel_hi:[1,1,0]
    v_pk_mul_f32 v[226:227], v[226:227], v[104:105]
    v_pk_mul_f32 v[228:229], v[228:229], v[106:107]
    v_exp_f32 v226, v226
    v_exp_f32 v227, v227
    v_exp_f32 v228, v228
    v_exp_f32 v229, v229
    v_pk_fma_f32 v[226:227], v[226:227], v[172:173], v[172:173] op_sel:[0,1,1] op_sel_hi:[1,1,1]
    v_pk_fma_f32 v[228:229], v[228:229], v[172:173], v[172:173] op_sel:[0,1,1] op_sel_hi:[1,1,1]
    v_rcp_f32 v226, v226
    v_rcp_f32 v227, v227
    v_rcp_f32 v228, v228
    v_rcp_f32 v229, v229
    v_pk_mul_f32 v[104:105], v[104:105], v[226:227]
    v_pk_mul_f32 v[106:107], v[106:107], v[228:229]
    v_cvt_pk_bf16_f32 v220, v104, v105
    v_cvt_pk_bf16_f32 v221, v106, v107
    v_or_b32 v220, 1, v220
    s_add_u32 s36, s45, 458752
    buffer_store_dwordx4 v[88:91], v2, s[16:19], s36 offen sc1
    v_pk_fma_f32 v[132:133], v[176:177], v[160:161], v[132:133] op_sel_hi:[0,1,1] neg_lo:[1,0,0] neg_hi:[1,0,0]
    v_pk_fma_f32 v[134:135], v[176:177], v[162:163], v[134:135] op_sel_hi:[0,1,1] neg_lo:[1,0,0] neg_hi:[1,0,0]
    v_pk_mul_f32 v[226:227], v[132:133], v[132:133]
    v_pk_mul_f32 v[228:229], v[134:135], v[134:135]
    v_pk_fma_f32 v[226:227], v[226:227], v[178:179], v[178:179] op_sel:[0,1,0] op_sel_hi:[1,1,0]
    v_pk_fma_f32 v[228:229], v[228:229], v[178:179], v[178:179] op_sel:[0,1,0] op_sel_hi:[1,1,0]
    v_pk_mul_f32 v[226:227], v[226:227], v[132:133]
    v_pk_mul_f32 v[228:229], v[228:229], v[134:135]
    v_exp_f32 v226, v226
    v_exp_f32 v227, v227
    v_exp_f32 v228, v228
    v_exp_f32 v229, v229
    v_pk_fma_f32 v[226:227], v[226:227], v[176:177], v[176:177] op_sel:[0,1,1] op_sel_hi:[1,1,1]
    v_pk_fma_f32 v[228:229], v[228:229], v[176:177], v[176:177] op_sel:[0,1,1] op_sel_hi:[1,1,1]
    v_rcp_f32 v226, v226
    v_rcp_f32 v227, v227
    v_rcp_f32 v228, v228
    v_rcp_f32 v229, v229
    v_pk_mul_f32 v[132:133], v[132:133], v[226:227]
    v_pk_mul_f32 v[134:135], v[134:135], v[228:229]
    v_cvt_pk_bf16_f32 v222, v132, v133
    v_cvt_pk_bf16_f32 v223, v134, v135
    s_add_u32 s36, s45, 688128
    buffer_store_dwordx4 v[116:119], v2, s[16:19], s36 offen sc1
    s_waitcnt lgkmcnt(0)
    s_mov_b32 s44, s46
    s_mov_b32 s45, s47
    s_branch G3_e2
G3_e1:
    v_pk_fma_f32 v[28:29], v[164:165], v[140:141], v[28:29] op_sel_hi:[0,1,1] neg_lo:[1,0,0] neg_hi:[1,0,0]
    v_pk_fma_f32 v[30:31], v[164:165], v[142:143], v[30:31] op_sel_hi:[0,1,1] neg_lo:[1,0,0] neg_hi:[1,0,0]
    v_pk_mul_f32 v[226:227], v[28:29], v[28:29]
    v_pk_mul_f32 v[228:229], v[30:31], v[30:31]
    v_pk_fma_f32 v[226:227], v[226:227], v[166:167], v[166:167] op_sel:[0,1,0] op_sel_hi:[1,1,0]
    v_pk_fma_f32 v[228:229], v[228:229], v[166:167], v[166:167] op_sel:[0,1,0] op_sel_hi:[1,1,0]
    v_pk_mul_f32 v[226:227], v[226:227], v[28:29]
    v_pk_mul_f32 v[228:229], v[228:229], v[30:31]
    v_exp_f32 v226, v226
    v_exp_f32 v227, v227
    v_exp_f32 v228, v228
    v_exp_f32 v229, v229
    v_pk_fma_f32 v[226:227], v[226:227], v[164:165], v[164:165] op_sel:[0,1,1] op_sel_hi:[1,1,1]
    v_pk_fma_f32 v[228:229], v[228:229], v[164:165], v[164:165] op_sel:[0,1,1] op_sel_hi:[1,1,1]
    v_rcp_f32 v226, v226
    v_rcp_f32 v227, v227
    v_rcp_f32 v228, v228
    v_rcp_f32 v229, v229
    v_pk_mul_f32 v[28:29], v[28:29], v[226:227]
    v_pk_mul_f32 v[30:31], v[30:31], v[228:229]
    v_pk_fma_f32 v[32:33], v[164:165], v[144:145], v[32:33] op_sel_hi:[0,1,1] neg_lo:[1,0,0] neg_hi:[1,0,0]
    v_pk_fma_f32 v[34:35], v[164:165], v[146:147], v[34:35] op_sel_hi:[0,1,1] neg_lo:[1,0,0] neg_hi:[1,0,0]
    v_pk_mul_f32 v[226:227], v[32:33], v[32:33]
    v_pk_mul_f32 v[228:229], v[34:35], v[34:35]
    v_pk_fma_f32 v[226:227], v[226:227], v[166:167], v[166:167] op_sel:[0,1,0] op_sel_hi:[1,1,0]
    v_pk_fma_f32 v[228:229], v[228:229], v[166:167], v[166:167] op_sel:[0,1,0] op_sel_hi:[1,1,0]
    v_pk_mul_f32 v[226:227], v[226:227], v[32:33]
    v_pk_mul_f32 v[228:229], v[228:229], v[34:35]
    v_exp_f32 v226, v226
    v_exp_f32 v227, v227
    v_exp_f32 v228, v228
    v_exp_f32 v229, v229
    v_pk_fma_f32 v[226:227], v[226:227], v[164:165], v[164:165] op_sel:[0,1,1] op_sel_hi:[1,1,1]
    v_pk_fma_f32 v[228:229], v[228:229], v[164:165], v[164:165] op_sel:[0,1,1] op_sel_hi:[1,1,1]
    v_rcp_f32 v226, v226
    v_rcp_f32 v227, v227
    v_rcp_f32 v228, v228
    v_rcp_f32 v229, v229
    v_pk_mul_f32 v[32:33], v[32:33], v[226:227]
    v_pk_mul_f32 v[34:35], v[34:35], v[228:229]
    v_cvt_pk_bf16_f32 v28, v28, v29
    v_cvt_pk_bf16_f32 v29, v30, v31
    v_cvt_pk_bf16_f32 v30, v32, v33
    v_cvt_pk_bf16_f32 v31, v34, v35
    v_or_b32 v28, 1, v28
    ds_write_b128 v244, v[28:31] offset:0
    s_add_u32 s36, s45, 0
    buffer_store_dwordx4 v[28:31], v2, s[16:19], s36 offen sc1
    v_pk_fma_f32 v[56:57], v[168:169], v[140:141], v[56:57] op_sel_hi:[0,1,1] neg_lo:[1,0,0] neg_hi:[1,0,0]
    v_pk_fma_f32 v[58:59], v[168:169], v[142:143], v[58:59] op_sel_hi:[0,1,1] neg_lo:[1,0,0] neg_hi:[1,0,0]
    v_pk_mul_f32 v[226:227], v[56:57], v[56:57]
    v_pk_mul_f32 v[228:229], v[58:59], v[58:59]
    v_pk_fma_f32 v[226:227], v[226:227], v[170:171], v[170:171] op_sel:[0,1,0] op_sel_hi:[1,1,0]
    v_pk_fma_f32 v[228:229], v[228:229], v[170:171], v[170:171] op_sel:[0,1,0] op_sel_hi:[1,1,0]
    v_pk_mul_f32 v[226:227], v[226:227], v[56:57]
    v_pk_mul_f32 v[228:229], v[228:229], v[58:59]
    v_exp_f32 v226, v226
    v_exp_f32 v227, v227
    v_exp_f32 v228, v228
    v_exp_f32 v229, v229
    v_pk_fma_f32 v[226:227], v[226:227], v[168:169], v[168:169] op_sel:[0,1,1] op_sel_hi:[1,1,1]
    v_pk_fma_f32 v[228:229], v[228:229], v[168:169], v[168:169] op_sel:[0,1,1] op_sel_hi:[1,1,1]
    v_rcp_f32 v226, v226
    v_rcp_f32 v227, v227
    v_rcp_f32 v228, v228
    v_rcp_f32 v229, v229
    v_pk_mul_f32 v[56:57], v[56:57], v[226:227]
    v_pk_mul_f32 v[58:59], v[58:59], v[228:229]
    v_pk_fma_f32 v[60:61], v[168:169], v[144:145], v[60:61] op_sel_hi:[0,1,1] neg_lo:[1,0,0] neg_hi:[1,0,0]
    v_pk_fma_f32 v[62:63], v[168:169], v[146:147], v[62:63] op_sel_hi:[0,1,1] neg_lo:[1,0,0] neg_hi:[1,0,0]
    v_pk_mul_f32 v[226:227], v[60:61], v[60:61]
    v_pk_mul_f32 v[228:229], v[62:63], v[62:63]
    v_pk_fma_f32 v[226:227], v[226:227], v[170:171], v[170:171] op_sel:[0,1,0] op_sel_hi:[1,1,0]
    v_pk_fma_f32 v[228:229], v[228:229], v[170:171], v[170:171] op_sel:[0,1,0] op_sel_hi:[1,1,0]
    v_pk_mul_f32 v[226:227], v[226:227], v[60:61]
    v_pk_mul_f32 v[228:229], v[228:229], v[62:63]
    v_exp_f32 v226, v226
    v_exp_f32 v227, v227
    v_exp_f32 v228, v228
    v_exp_f32 v229, v229
    v_pk_fma_f32 v[226:227], v[226:227], v[168:169], v[168:169] op_sel:[0,1,1] op_sel_hi:[1,1,1]
    v_pk_fma_f32 v[228:229], v[228:229], v[168:169], v[168:169] op_sel:[0,1,1] op_sel_hi:[1,1,1]
    v_rcp_f32 v226, v226
    v_rcp_f32 v227, v227
    v_rcp_f32 v228, v228
    v_rcp_f32 v229, v229
    v_pk_mul_f32 v[60:61], v[60:61], v[226:227]
    v_pk_mul_f32 v[62:63], v[62:63], v[228:229]
    v_cvt_pk_bf16_f32 v56, v56, v57
    v_cvt_pk_bf16_f32 v57, v58, v59
    v_cvt_pk_bf16_f32 v58, v60, v61
    v_cvt_pk_bf16_f32 v59, v62, v63
    v_or_b32 v56, 1, v56
    ds_write_b128 v244, v[56:59] offset:2048
    s_add_u32 s36, s45, 229376
    buffer_store_dwordx4 v[56:59], v2, s[16:19], s36 offen sc1
    v_pk_fma_f32 v[84:85], v[172:173], v[140:141], v[84:85] op_sel_hi:[0,1,1] neg_lo:[1,0,0] neg_hi:[1,0,0]
    v_pk_fma_f32 v[86:87], v[172:173], v[142:143], v[86:87] op_sel_hi:[0,1,1] neg_lo:[1,0,0] neg_hi:[1,0,0]
    v_pk_mul_f32 v[226:227], v[84:85], v[84:85]
    v_pk_mul_f32 v[228:229], v[86:87], v[86:87]
    v_pk_fma_f32 v[226:227], v[226:227], v[174:175], v[174:175] op_sel:[0,1,0] op_sel_hi:[1,1,0]
    v_pk_fma_f32 v[228:229], v[228:229], v[174:175], v[174:175] op_sel:[0,1,0] op_sel_hi:[1,1,0]
    v_pk_mul_f32 v[226:227], v[226:227], v[84:85]
    v_pk_mul_f32 v[228:229], v[228:229], v[86:87]
    v_exp_f32 v226, v226
    v_exp_f32 v227, v227
    v_exp_f32 v228, v228
    v_exp_f32 v229, v229
    v_pk_fma_f32 v[226:227], v[226:227], v[172:173], v[172:173] op_sel:[0,1,1] op_sel_hi:[1,1,1]
    v_pk_fma_f32 v[228:229], v[228:229], v[172:173], v[172:173] op_sel:[0,1,1] op_sel_hi:[1,1,1]
    v_rcp_f32 v226, v226
    v_rcp_f32 v227, v227
    v_rcp_f32 v228, v228
    v_rcp_f32 v229, v229
    v_pk_mul_f32 v[84:85], v[84:85], v[226:227]
    v_pk_mul_f32 v[86:87], v[86:87], v[228:229]
    v_pk_fma_f32 v[88:89], v[172:173], v[144:145], v[88:89] op_sel_hi:[0,1,1] neg_lo:[1,0,0] neg_hi:[1,0,0]
    v_pk_fma_f32 v[90:91], v[172:173], v[146:147], v[90:91] op_sel_hi:[0,1,1] neg_lo:[1,0,0] neg_hi:[1,0,0]
    v_pk_mul_f32 v[226:227], v[88:89], v[88:89]
    v_pk_mul_f32 v[228:229], v[90:91], v[90:91]
    v_pk_fma_f32 v[226:227], v[226:227], v[174:175], v[174:175] op_sel:[0,1,0] op_sel_hi:[1,1,0]
    v_pk_fma_f32 v[228:229], v[228:229], v[174:175], v[174:175] op_sel:[0,1,0] op_sel_hi:[1,1,0]
    v_pk_mul_f32 v[226:227], v[226:227], v[88:89]
    v_pk_mul_f32 v[228:229], v[228:229], v[90:91]
    v_exp_f32 v226, v226
    v_exp_f32 v227, v227
    v_exp_f32 v228, v228
    v_exp_f32 v229, v229
    v_pk_fma_f32 v[226:227], v[226:227], v[172:173], v[172:173] op_sel:[0,1,1] op_sel_hi:[1,1,1]
    v_pk_fma_f32 v[228:229], v[228:229], v[172:173], v[172:173] op_sel:[0,1,1] op_sel_hi:[1,1,1]
    v_rcp_f32 v226, v226
    v_rcp_f32 v227, v227
    v_rcp_f32 v228, v228
    v_rcp_f32 v229, v229
    v_pk_mul_f32 v[88:89], v[88:89], v[226:227]
    v_pk_mul_f32 v[90:91], v[90:91], v[228:229]
    v_cvt_pk_bf16_f32 v84, v84, v85
    v_cvt_pk_bf16_f32 v85, v86, v87
    v_cvt_pk_bf16_f32 v86, v88, v89
    v_cvt_pk_bf16_f32 v87, v90, v91
    v_or_b32 v84, 1, v84
    ds_write_b128 v244, v[84:87] offset:4096
    s_add_u32 s36, s45, 458752
    buffer_store_dwordx4 v[84:87], v2, s[16:19], s36 offen sc1
    v_pk_fma_f32 v[112:113], v[176:177], v[140:141], v[112:113] op_sel_hi:[0,1,1] neg_lo:[1,0,0] neg_hi:[1,0,0]
    v_pk_fma_f32 v[114:115], v[176:177], v[142:143], v[114:115] op_sel_hi:[0,1,1] neg_lo:[1,0,0] neg_hi:[1,0,0]
    v_pk_mul_f32 v[226:227], v[112:113], v[112:113]
    v_pk_mul_f32 v[228:229], v[114:115], v[114:115]
    v_pk_fma_f32 v[226:227], v[226:227], v[178:179], v[178:179] op_sel:[0,1,0] op_sel_hi:[1,1,0]
    v_pk_fma_f32 v[228:229], v[228:229], v[178:179], v[178:179] op_sel:[0,1,0] op_sel_hi:[1,1,0]
    v_pk_mul_f32 v[226:227], v[226:227], v[112:113]
    v_pk_mul_f32 v[228:229], v[228:229], v[114:115]
    v_exp_f32 v226, v226
    v_exp_f32 v227, v227
    v_exp_f32 v228, v228
    v_exp_f32 v229, v229
    v_pk_fma_f32 v[226:227], v[226:227], v[176:177], v[176:177] op_sel:[0,1,1] op_sel_hi:[1,1,1]
    v_pk_fma_f32 v[228:229], v[228:229], v[176:177], v[176:177] op_sel:[0,1,1] op_sel_hi:[1,1,1]
    v_rcp_f32 v226, v226
    v_rcp_f32 v227, v227
    v_rcp_f32 v228, v228
    v_rcp_f32 v229, v229
    v_pk_mul_f32 v[112:113], v[112:113], v[226:227]
    v_pk_mul_f32 v[114:115], v[114:115], v[228:229]
    v_pk_fma_f32 v[116:117], v[176:177], v[144:145], v[116:117] op_sel_hi:[0,1,1] neg_lo:[1,0,0] neg_hi:[1,0,0]
    v_pk_fma_f32 v[118:119], v[176:177], v[146:147], v[118:119] op_sel_hi:[0,1,1] neg_lo:[1,0,0] neg_hi:[1,0,0]
    v_pk_mul_f32 v[226:227], v[116:117], v[116:117]
    v_pk_mul_f32 v[228:229], v[118:119], v[118:119]
    v_pk_fma_f32 v[226:227], v[226:227], v[178:179], v[178:179] op_sel:[0,1,0] op_sel_hi:[1,1,0]
    v_pk_fma_f32 v[228:229], v[228:229], v[178:179], v[178:179] op_sel:[0,1,0] op_sel_hi:[1,1,0]
    v_pk_mul_f32 v[226:227], v[226:227], v[116:117]
    v_pk_mul_f32 v[228:229], v[228:229], v[118:119]
    v_exp_f32 v226, v226
    v_exp_f32 v227, v227
    v_exp_f32 v228, v228
    v_exp_f32 v229, v229
    v_pk_fma_f32 v[226:227], v[226:227], v[176:177], v[176:177] op_sel:[0,1,1] op_sel_hi:[1,1,1]
    v_pk_fma_f32 v[228:229], v[228:229], v[176:177], v[176:177] op_sel:[0,1,1] op_sel_hi:[1,1,1]
    v_rcp_f32 v226, v226
    v_rcp_f32 v227, v227
    v_rcp_f32 v228, v228
    v_rcp_f32 v229, v229
    v_pk_mul_f32 v[116:117], v[116:117], v[226:227]
    v_pk_mul_f32 v[118:119], v[118:119], v[228:229]
    v_cvt_pk_bf16_f32 v112, v112, v113
    v_cvt_pk_bf16_f32 v113, v114, v115
    v_cvt_pk_bf16_f32 v114, v116, v117
    v_cvt_pk_bf16_f32 v115, v118, v119
    ds_write_b128 v244, v[112:115] offset:6144
    s_add_u32 s36, s45, 688128
    buffer_store_dwordx4 v[112:115], v2, s[16:19], s36 offen sc1
    v_pk_fma_f32 v[36:37], v[164:165], v[148:149], v[36:37] op_sel_hi:[0,1,1] neg_lo:[1,0,0] neg_hi:[1,0,0]
    v_pk_fma_f32 v[38:39], v[164:165], v[150:151], v[38:39] op_sel_hi:[0,1,1] neg_lo:[1,0,0] neg_hi:[1,0,0]
    v_pk_mul_f32 v[226:227], v[36:37], v[36:37]
    v_pk_mul_f32 v[228:229], v[38:39], v[38:39]
    v_pk_fma_f32 v[226:227], v[226:227], v[166:167], v[166:167] op_sel:[0,1,0] op_sel_hi:[1,1,0]
    v_pk_fma_f32 v[228:229], v[228:229], v[166:167], v[166:167] op_sel:[0,1,0] op_sel_hi:[1,1,0]
    v_pk_mul_f32 v[226:227], v[226:227], v[36:37]
    v_pk_mul_f32 v[228:229], v[228:229], v[38:39]
    v_exp_f32 v226, v226
    v_exp_f32 v227, v227
    v_exp_f32 v228, v228
    v_exp_f32 v229, v229
    v_pk_fma_f32 v[226:227], v[226:227], v[164:165], v[164:165] op_sel:[0,1,1] op_sel_hi:[1,1,1]
    v_pk_fma_f32 v[228:229], v[228:229], v[164:165], v[164:165] op_sel:[0,1,1] op_sel_hi:[1,1,1]
    v_rcp_f32 v226, v226
    v_rcp_f32 v227, v227
    v_rcp_f32 v228, v228
    v_rcp_f32 v229, v229
    v_pk_mul_f32 v[36:37], v[36:37], v[226:227]
    v_pk_mul_f32 v[38:39], v[38:39], v[228:229]
    v_pk_fma_f32 v[40:41], v[164:165], v[152:153], v[40:41] op_sel_hi:[0,1,1] neg_lo:[1,0,0] neg_hi:[1,0,0]
    v_pk_fma_f32 v[42:43], v[164:165], v[154:155], v[42:43] op_sel_hi:[0,1,1] neg_lo:[1,0,0] neg_hi:[1,0,0]
    v_pk_mul_f32 v[226:227], v[40:41], v[40:41]
    v_pk_mul_f32 v[228:229], v[42:43], v[42:43]
    v_pk_fma_f32 v[226:227], v[226:227], v[166:167], v[166:167] op_sel:[0,1,0] op_sel_hi:[1,1,0]
    v_pk_fma_f32 v[228:229], v[228:229], v[166:167], v[166:167] op_sel:[0,1,0] op_sel_hi:[1,1,0]
    v_pk_mul_f32 v[226:227], v[226:227], v[40:41]
    v_pk_mul_f32 v[228:229], v[228:229], v[42:43]
    v_exp_f32 v226, v226
    v_exp_f32 v227, v227
    v_exp_f32 v228, v228
    v_exp_f32 v229, v229
    v_pk_fma_f32 v[226:227], v[226:227], v[164:165], v[164:165] op_sel:[0,1,1] op_sel_hi:[1,1,1]
    v_pk_fma_f32 v[228:229], v[228:229], v[164:165], v[164:165] op_sel:[0,1,1] op_sel_hi:[1,1,1]
    v_rcp_f32 v226, v226
    v_rcp_f32 v227, v227
    v_rcp_f32 v228, v228
    v_rcp_f32 v229, v229
    v_pk_mul_f32 v[40:41], v[40:41], v[226:227]
    v_pk_mul_f32 v[42:43], v[42:43], v[228:229]
    v_cvt_pk_bf16_f32 v36, v36, v37
    v_cvt_pk_bf16_f32 v37, v38, v39
    v_cvt_pk_bf16_f32 v38, v40, v41
    v_cvt_pk_bf16_f32 v39, v42, v43
    v_or_b32 v36, 1, v36
    ds_write_b128 v244, v[36:39] offset:16384
    v_pk_fma_f32 v[64:65], v[168:169], v[148:149], v[64:65] op_sel_hi:[0,1,1] neg_lo:[1,0,0] neg_hi:[1,0,0]
    v_pk_fma_f32 v[66:67], v[168:169], v[150:151], v[66:67] op_sel_hi:[0,1,1] neg_lo:[1,0,0] neg_hi:[1,0,0]
    v_pk_mul_f32 v[226:227], v[64:65], v[64:65]
    v_pk_mul_f32 v[228:229], v[66:67], v[66:67]
    v_pk_fma_f32 v[226:227], v[226:227], v[170:171], v[170:171] op_sel:[0,1,0] op_sel_hi:[1,1,0]
    v_pk_fma_f32 v[228:229], v[228:229], v[170:171], v[170:171] op_sel:[0,1,0] op_sel_hi:[1,1,0]
    v_pk_mul_f32 v[226:227], v[226:227], v[64:65]
    v_pk_mul_f32 v[228:229], v[228:229], v[66:67]
    v_exp_f32 v226, v226
    v_exp_f32 v227, v227
    v_exp_f32 v228, v228
    v_exp_f32 v229, v229
    v_pk_fma_f32 v[226:227], v[226:227], v[168:169], v[168:169] op_sel:[0,1,1] op_sel_hi:[1,1,1]
    v_pk_fma_f32 v[228:229], v[228:229], v[168:169], v[168:169] op_sel:[0,1,1] op_sel_hi:[1,1,1]
    v_rcp_f32 v226, v226
    v_rcp_f32 v227, v227
    v_rcp_f32 v228, v228
    v_rcp_f32 v229, v229
    v_pk_mul_f32 v[64:65], v[64:65], v[226:227]
    v_pk_mul_f32 v[66:67], v[66:67], v[228:229]
    v_pk_fma_f32 v[68:69], v[168:169], v[152:153], v[68:69] op_sel_hi:[0,1,1] neg_lo:[1,0,0] neg_hi:[1,0,0]
    v_pk_fma_f32 v[70:71], v[168:169], v[154:155], v[70:71] op_sel_hi:[0,1,1] neg_lo:[1,0,0] neg_hi:[1,0,0]
    v_pk_mul_f32 v[226:227], v[68:69], v[68:69]
    v_pk_mul_f32 v[228:229], v[70:71], v[70:71]
    v_pk_fma_f32 v[226:227], v[226:227], v[170:171], v[170:171] op_sel:[0,1,0] op_sel_hi:[1,1,0]
    v_pk_fma_f32 v[228:229], v[228:229], v[170:171], v[170:171] op_sel:[0,1,0] op_sel_hi:[1,1,0]
    v_pk_mul_f32 v[226:227], v[226:227], v[68:69]
    v_pk_mul_f32 v[228:229], v[228:229], v[70:71]
    v_exp_f32 v226, v226
    v_exp_f32 v227, v227
    v_exp_f32 v228, v228
    v_exp_f32 v229, v229
    v_pk_fma_f32 v[226:227], v[226:227], v[168:169], v[168:169] op_sel:[0,1,1] op_sel_hi:[1,1,1]
    v_pk_fma_f32 v[228:229], v[228:229], v[168:169], v[168:169] op_sel:[0,1,1] op_sel_hi:[1,1,1]
    v_rcp_f32 v226, v226
    v_rcp_f32 v227, v227
    v_rcp_f32 v228, v228
    v_rcp_f32 v229, v229
    v_pk_mul_f32 v[68:69], v[68:69], v[226:227]
    v_pk_mul_f32 v[70:71], v[70:71], v[228:229]
    v_cvt_pk_bf16_f32 v64, v64, v65
    v_cvt_pk_bf16_f32 v65, v66, v67
    v_cvt_pk_bf16_f32 v66, v68, v69
    v_cvt_pk_bf16_f32 v67, v70, v71
    v_or_b32 v64, 1, v64
    ds_write_b128 v244, v[64:67] offset:18432
    s_waitcnt vmcnt(0)
    s_mov_b64 exec, 1
    ds_add_u32 v246, v245
    s_mov_b64 exec, -1
    v_pk_fma_f32 v[92:93], v[172:173], v[148:149], v[92:93] op_sel_hi:[0,1,1] neg_lo:[1,0,0] neg_hi:[1,0,0]
    v_pk_fma_f32 v[94:95], v[172:173], v[150:151], v[94:95] op_sel_hi:[0,1,1] neg_lo:[1,0,0] neg_hi:[1,0,0]
    v_pk_mul_f32 v[226:227], v[92:93], v[92:93]
    v_pk_mul_f32 v[228:229], v[94:95], v[94:95]
    v_pk_fma_f32 v[226:227], v[226:227], v[174:175], v[174:175] op_sel:[0,1,0] op_sel_hi:[1,1,0]
    v_pk_fma_f32 v[228:229], v[228:229], v[174:175], v[174:175] op_sel:[0,1,0] op_sel_hi:[1,1,0]
    v_pk_mul_f32 v[226:227], v[226:227], v[92:93]
    v_pk_mul_f32 v[228:229], v[228:229], v[94:95]
    v_exp_f32 v226, v226
    v_exp_f32 v227, v227
    v_exp_f32 v228, v228
    v_exp_f32 v229, v229
    v_pk_fma_f32 v[226:227], v[226:227], v[172:173], v[172:173] op_sel:[0,1,1] op_sel_hi:[1,1,1]
    v_pk_fma_f32 v[228:229], v[228:229], v[172:173], v[172:173] op_sel:[0,1,1] op_sel_hi:[1,1,1]
    v_rcp_f32 v226, v226
    v_rcp_f32 v227, v227
    v_rcp_f32 v228, v228
    v_rcp_f32 v229, v229
    v_pk_mul_f32 v[92:93], v[92:93], v[226:227]
    v_pk_mul_f32 v[94:95], v[94:95], v[228:229]
    v_pk_fma_f32 v[96:97], v[172:173], v[152:153], v[96:97] op_sel_hi:[0,1,1] neg_lo:[1,0,0] neg_hi:[1,0,0]
    v_pk_fma_f32 v[98:99], v[172:173], v[154:155], v[98:99] op_sel_hi:[0,1,1] neg_lo:[1,0,0] neg_hi:[1,0,0]
    v_pk_mul_f32 v[226:227], v[96:97], v[96:97]
    v_pk_mul_f32 v[228:229], v[98:99], v[98:99]
    v_pk_fma_f32 v[226:227], v[226:227], v[174:175], v[174:175] op_sel:[0,1,0] op_sel_hi:[1,1,0]
    v_pk_fma_f32 v[228:229], v[228:229], v[174:175], v[174:175] op_sel:[0,1,0] op_sel_hi:[1,1,0]
    v_pk_mul_f32 v[226:227], v[226:227], v[96:97]
    v_pk_mul_f32 v[228:229], v[228:229], v[98:99]
    v_exp_f32 v226, v226
    v_exp_f32 v227, v227
    v_exp_f32 v228, v228
    v_exp_f32 v229, v229
    v_pk_fma_f32 v[226:227], v[226:227], v[172:173], v[172:173] op_sel:[0,1,1] op_sel_hi:[1,1,1]
    v_pk_fma_f32 v[228:229], v[228:229], v[172:173], v[172:173] op_sel:[0,1,1] op_sel_hi:[1,1,1]
    v_rcp_f32 v226, v226
    v_rcp_f32 v227, v227
    v_rcp_f32 v228, v228
    v_rcp_f32 v229, v229
    v_pk_mul_f32 v[96:97], v[96:97], v[226:227]
    v_pk_mul_f32 v[98:99], v[98:99], v[228:229]
    v_cvt_pk_bf16_f32 v92, v92, v93
    v_cvt_pk_bf16_f32 v93, v94, v95
    v_cvt_pk_bf16_f32 v94, v96, v97
    v_cvt_pk_bf16_f32 v95, v98, v99
    v_or_b32 v92, 1, v92
    ds_write_b128 v244, v[92:95] offset:20480
    s_cmp_eq_u32 s60, 1
    s_cbranch_scc1 G4_p11
    buffer_load_dwordx4 v[180:183], v196, s[84:87], 0 offen offset:0 sc1
    buffer_load_dwordx4 v[188:191], v196, s[88:91], 0 offen offset:0 sc1
    buffer_load_dwordx4 v[184:187], v196, s[84:87], 0 offen offset:2048 sc1
    buffer_load_dwordx4 v[192:195], v196, s[88:91], 0 offen offset:2048 sc1
    s_mov_b32 s78, 0
    buffer_load_dwordx2 v[230:231], v197, s[80:83], s78 offen sc1
    s_mov_b32 s78, 65536
    buffer_load_dwordx2 v[232:233], v197, s[80:83], s78 offen sc1
    s_mov_b32 s78, 262144
    buffer_load_dwordx2 v[234:235], v197, s[80:83], s78 offen sc1
    s_mov_b32 s78, 327680
    buffer_load_dwordx2 v[236:237], v197, s[80:83], s78 offen sc1
    s_branch G4_p21
G4_p11:
    s_add_u32 s36, s40, 0
    buffer_load_dwordx4 v[180:183], v2, s[84:87], s36 offen offset:0 sc1
    buffer_load_dwordx4 v[184:187], v2, s[88:91], s36 offen offset:0 sc1
    buffer_load_dwordx4 v[188:191], v2, s[84:87], s36 offen offset:1024 sc1
    buffer_load_dwordx4 v[192:195], v2, s[88:91], s36 offen offset:1024 sc1
    s_add_u32 s36, s40, 65536
    buffer_load_dwordx4 v[196:199], v2, s[84:87], s36 offen offset:0 sc1
    buffer_load_dwordx4 v[230:233], v2, s[88:91], s36 offen offset:0 sc1
    buffer_load_dwordx4 v[234:237], v2, s[84:87], s36 offen offset:1024 sc1
    buffer_load_dwordx4 v[248:251], v2, s[88:91], s36 offen offset:1024 sc1
G4_p21:
    v_pk_fma_f32 v[120:121], v[176:177], v[148:149], v[120:121] op_sel_hi:[0,1,1] neg_lo:[1,0,0] neg_hi:[1,0,0]
    v_pk_fma_f32 v[122:123], v[176:177], v[150:151], v[122:123] op_sel_hi:[0,1,1] neg_lo:[1,0,0] neg_hi:[1,0,0]
    v_pk_mul_f32 v[226:227], v[120:121], v[120:121]
    v_pk_mul_f32 v[228:229], v[122:123], v[122:123]
    v_pk_fma_f32 v[226:227], v[226:227], v[178:179], v[178:179] op_sel:[0,1,0] op_sel_hi:[1,1,0]
    v_pk_fma_f32 v[228:229], v[228:229], v[178:179], v[178:179] op_sel:[0,1,0] op_sel_hi:[1,1,0]
    v_pk_mul_f32 v[226:227], v[226:227], v[120:121]
    v_pk_mul_f32 v[228:229], v[228:229], v[122:123]
    v_exp_f32 v226, v226
    v_exp_f32 v227, v227
    v_exp_f32 v228, v228
    v_exp_f32 v229, v229
    v_pk_fma_f32 v[226:227], v[226:227], v[176:177], v[176:177] op_sel:[0,1,1] op_sel_hi:[1,1,1]
    v_pk_fma_f32 v[228:229], v[228:229], v[176:177], v[176:177] op_sel:[0,1,1] op_sel_hi:[1,1,1]
    v_rcp_f32 v226, v226
    v_rcp_f32 v227, v227
    v_rcp_f32 v228, v228
    v_rcp_f32 v229, v229
    v_pk_mul_f32 v[120:121], v[120:121], v[226:227]
    v_pk_mul_f32 v[122:123], v[122:123], v[228:229]
    v_pk_fma_f32 v[124:125], v[176:177], v[152:153], v[124:125] op_sel_hi:[0,1,1] neg_lo:[1,0,0] neg_hi:[1,0,0]
    v_pk_fma_f32 v[126:127], v[176:177], v[154:155], v[126:127] op_sel_hi:[0,1,1] neg_lo:[1,0,0] neg_hi:[1,0,0]
    v_pk_mul_f32 v[226:227], v[124:125], v[124:125]
    v_pk_mul_f32 v[228:229], v[126:127], v[126:127]
    v_pk_fma_f32 v[226:227], v[226:227], v[178:179], v[178:179] op_sel:[0,1,0] op_sel_hi:[1,1,0]
    v_pk_fma_f32 v[228:229], v[228:229], v[178:179], v[178:179] op_sel:[0,1,0] op_sel_hi:[1,1,0]
    v_pk_mul_f32 v[226:227], v[226:227], v[124:125]
    v_pk_mul_f32 v[228:229], v[228:229], v[126:127]
    v_exp_f32 v226, v226
    v_exp_f32 v227, v227
    v_exp_f32 v228, v228
    v_exp_f32 v229, v229
    v_pk_fma_f32 v[226:227], v[226:227], v[176:177], v[176:177] op_sel:[0,1,1] op_sel_hi:[1,1,1]
    v_pk_fma_f32 v[228:229], v[228:229], v[176:177], v[176:177] op_sel:[0,1,1] op_sel_hi:[1,1,1]
    v_rcp_f32 v226, v226
    v_rcp_f32 v227, v227
    v_rcp_f32 v228, v228
    v_rcp_f32 v229, v229
    v_pk_mul_f32 v[124:125], v[124:125], v[226:227]
    v_pk_mul_f32 v[126:127], v[126:127], v[228:229]
    v_cvt_pk_bf16_f32 v120, v120, v121
    v_cvt_pk_bf16_f32 v121, v122, v123
    v_cvt_pk_bf16_f32 v122, v124, v125
    v_cvt_pk_bf16_f32 v123, v126, v127
    ds_write_b128 v244, v[120:123] offset:22528
    v_pk_fma_f32 v[44:45], v[164:165], v[156:157], v[44:45] op_sel_hi:[0,1,1] neg_lo:[1,0,0] neg_hi:[1,0,0]
    v_pk_fma_f32 v[46:47], v[164:165], v[158:159], v[46:47] op_sel_hi:[0,1,1] neg_lo:[1,0,0] neg_hi:[1,0,0]
    v_pk_mul_f32 v[226:227], v[44:45], v[44:45]
    v_pk_mul_f32 v[228:229], v[46:47], v[46:47]
    v_pk_fma_f32 v[226:227], v[226:227], v[166:167], v[166:167] op_sel:[0,1,0] op_sel_hi:[1,1,0]
    v_pk_fma_f32 v[228:229], v[228:229], v[166:167], v[166:167] op_sel:[0,1,0] op_sel_hi:[1,1,0]
    v_pk_mul_f32 v[226:227], v[226:227], v[44:45]
    v_pk_mul_f32 v[228:229], v[228:229], v[46:47]
    v_exp_f32 v226, v226
    v_exp_f32 v227, v227
    v_exp_f32 v228, v228
    v_exp_f32 v229, v229
    v_pk_fma_f32 v[226:227], v[226:227], v[164:165], v[164:165] op_sel:[0,1,1] op_sel_hi:[1,1,1]
    v_pk_fma_f32 v[228:229], v[228:229], v[164:165], v[164:165] op_sel:[0,1,1] op_sel_hi:[1,1,1]
    v_rcp_f32 v226, v226
    v_rcp_f32 v227, v227
    v_rcp_f32 v228, v228
    v_rcp_f32 v229, v229
    v_pk_mul_f32 v[44:45], v[44:45], v[226:227]
    v_pk_mul_f32 v[46:47], v[46:47], v[228:229]
    v_pk_fma_f32 v[48:49], v[164:165], v[160:161], v[48:49] op_sel_hi:[0,1,1] neg_lo:[1,0,0] neg_hi:[1,0,0]
    v_pk_fma_f32 v[50:51], v[164:165], v[162:163], v[50:51] op_sel_hi:[0,1,1] neg_lo:[1,0,0] neg_hi:[1,0,0]
    v_pk_mul_f32 v[226:227], v[48:49], v[48:49]
    v_pk_mul_f32 v[228:229], v[50:51], v[50:51]
    v_pk_fma_f32 v[226:227], v[226:227], v[166:167], v[166:167] op_sel:[0,1,0] op_sel_hi:[1,1,0]
    v_pk_fma_f32 v[228:229], v[228:229], v[166:167], v[166:167] op_sel:[0,1,0] op_sel_hi:[1,1,0]
    v_pk_mul_f32 v[226:227], v[226:227], v[48:49]
    v_pk_mul_f32 v[228:229], v[228:229], v[50:51]
    v_exp_f32 v226, v226
    v_exp_f32 v227, v227
    v_exp_f32 v228, v228
    v_exp_f32 v229, v229
    v_pk_fma_f32 v[226:227], v[226:227], v[164:165], v[164:165] op_sel:[0,1,1] op_sel_hi:[1,1,1]
    v_pk_fma_f32 v[228:229], v[228:229], v[164:165], v[164:165] op_sel:[0,1,1] op_sel_hi:[1,1,1]
    v_rcp_f32 v226, v226
    v_rcp_f32 v227, v227
    v_rcp_f32 v228, v228
    v_rcp_f32 v229, v229
    v_pk_mul_f32 v[48:49], v[48:49], v[226:227]
    v_pk_mul_f32 v[50:51], v[50:51], v[228:229]
    v_cvt_pk_bf16_f32 v200, v44, v45
    v_cvt_pk_bf16_f32 v201, v46, v47
    v_cvt_pk_bf16_f32 v202, v48, v49
    v_cvt_pk_bf16_f32 v203, v50, v51
    v_or_b32 v200, 1, v200
    ds_write_b128 v244, v[200:203] offset:32768
    v_pk_fma_f32 v[72:73], v[168:169], v[156:157], v[72:73] op_sel_hi:[0,1,1] neg_lo:[1,0,0] neg_hi:[1,0,0]
    v_pk_fma_f32 v[74:75], v[168:169], v[158:159], v[74:75] op_sel_hi:[0,1,1] neg_lo:[1,0,0] neg_hi:[1,0,0]
    v_pk_mul_f32 v[226:227], v[72:73], v[72:73]
    v_pk_mul_f32 v[228:229], v[74:75], v[74:75]
    v_pk_fma_f32 v[226:227], v[226:227], v[170:171], v[170:171] op_sel:[0,1,0] op_sel_hi:[1,1,0]
    v_pk_fma_f32 v[228:229], v[228:229], v[170:171], v[170:171] op_sel:[0,1,0] op_sel_hi:[1,1,0]
    v_pk_mul_f32 v[226:227], v[226:227], v[72:73]
    v_pk_mul_f32 v[228:229], v[228:229], v[74:75]
    v_exp_f32 v226, v226
    v_exp_f32 v227, v227
    v_exp_f32 v228, v228
    v_exp_f32 v229, v229
    v_pk_fma_f32 v[226:227], v[226:227], v[168:169], v[168:169] op_sel:[0,1,1] op_sel_hi:[1,1,1]
    v_pk_fma_f32 v[228:229], v[228:229], v[168:169], v[168:169] op_sel:[0,1,1] op_sel_hi:[1,1,1]
    v_rcp_f32 v226, v226
    v_rcp_f32 v227, v227
    v_rcp_f32 v228, v228
    v_rcp_f32 v229, v229
    v_pk_mul_f32 v[72:73], v[72:73], v[226:227]
    v_pk_mul_f32 v[74:75], v[74:75], v[228:229]
    v_pk_fma_f32 v[76:77], v[168:169], v[160:161], v[76:77] op_sel_hi:[0,1,1] neg_lo:[1,0,0] neg_hi:[1,0,0]
    v_pk_fma_f32 v[78:79], v[168:169], v[162:163], v[78:79] op_sel_hi:[0,1,1] neg_lo:[1,0,0] neg_hi:[1,0,0]
    v_pk_mul_f32 v[226:227], v[76:77], v[76:77]
    v_pk_mul_f32 v[228:229], v[78:79], v[78:79]
    v_pk_fma_f32 v[226:227], v[226:227], v[170:171], v[170:171] op_sel:[0,1,0] op_sel_hi:[1,1,0]
    v_pk_fma_f32 v[228:229], v[228:229], v[170:171], v[170:171] op_sel:[0,1,0] op_sel_hi:[1,1,0]
    v_pk_mul_f32 v[226:227], v[226:227], v[76:77]
    v_pk_mul_f32 v[228:229], v[228:229], v[78:79]
    v_exp_f32 v226, v226
    v_exp_f32 v227, v227
    v_exp_f32 v228, v228
    v_exp_f32 v229, v229
    v_pk_fma_f32 v[226:227], v[226:227], v[168:169], v[168:169] op_sel:[0,1,1] op_sel_hi:[1,1,1]
    v_pk_fma_f32 v[228:229], v[228:229], v[168:169], v[168:169] op_sel:[0,1,1] op_sel_hi:[1,1,1]
    v_rcp_f32 v226, v226
    v_rcp_f32 v227, v227
    v_rcp_f32 v228, v228
    v_rcp_f32 v229, v229
    v_pk_mul_f32 v[76:77], v[76:77], v[226:227]
    v_pk_mul_f32 v[78:79], v[78:79], v[228:229]
    v_cvt_pk_bf16_f32 v204, v72, v73
    v_cvt_pk_bf16_f32 v205, v74, v75
    v_cvt_pk_bf16_f32 v206, v76, v77
    v_cvt_pk_bf16_f32 v207, v78, v79
    v_or_b32 v204, 1, v204
    ds_write_b128 v244, v[204:207] offset:34816
    v_pk_fma_f32 v[100:101], v[172:173], v[156:157], v[100:101] op_sel_hi:[0,1,1] neg_lo:[1,0,0] neg_hi:[1,0,0]
    v_pk_fma_f32 v[102:103], v[172:173], v[158:159], v[102:103] op_sel_hi:[0,1,1] neg_lo:[1,0,0] neg_hi:[1,0,0]
    v_pk_mul_f32 v[226:227], v[100:101], v[100:101]
    v_pk_mul_f32 v[228:229], v[102:103], v[102:103]
    v_pk_fma_f32 v[226:227], v[226:227], v[174:175], v[174:175] op_sel:[0,1,0] op_sel_hi:[1,1,0]
    v_pk_fma_f32 v[228:229], v[228:229], v[174:175], v[174:175] op_sel:[0,1,0] op_sel_hi:[1,1,0]
    v_pk_mul_f32 v[226:227], v[226:227], v[100:101]
    v_pk_mul_f32 v[228:229], v[228:229], v[102:103]
    v_exp_f32 v226, v226
    v_exp_f32 v227, v227
    v_exp_f32 v228, v228
    v_exp_f32 v229, v229
    v_pk_fma_f32 v[226:227], v[226:227], v[172:173], v[172:173] op_sel:[0,1,1] op_sel_hi:[1,1,1]
    v_pk_fma_f32 v[228:229], v[228:229], v[172:173], v[172:173] op_sel:[0,1,1] op_sel_hi:[1,1,1]
    v_rcp_f32 v226, v226
    v_rcp_f32 v227, v227
    v_rcp_f32 v228, v228
    v_rcp_f32 v229, v229
    v_pk_mul_f32 v[100:101], v[100:101], v[226:227]
    v_pk_mul_f32 v[102:103], v[102:103], v[228:229]
    v_pk_fma_f32 v[104:105], v[172:173], v[160:161], v[104:105] op_sel_hi:[0,1,1] neg_lo:[1,0,0] neg_hi:[1,0,0]
    v_pk_fma_f32 v[106:107], v[172:173], v[162:163], v[106:107] op_sel_hi:[0,1,1] neg_lo:[1,0,0] neg_hi:[1,0,0]
    v_pk_mul_f32 v[226:227], v[104:105], v[104:105]
    v_pk_mul_f32 v[228:229], v[106:107], v[106:107]
    v_pk_fma_f32 v[226:227], v[226:227], v[174:175], v[174:175] op_sel:[0,1,0] op_sel_hi:[1,1,0]
    v_pk_fma_f32 v[228:229], v[228:229], v[174:175], v[174:175] op_sel:[0,1,0] op_sel_hi:[1,1,0]
    v_pk_mul_f32 v[226:227], v[226:227], v[104:105]
    v_pk_mul_f32 v[228:229], v[228:229], v[106:107]
    v_exp_f32 v226, v226
    v_exp_f32 v227, v227
    v_exp_f32 v228, v228
    v_exp_f32 v229, v229
    v_pk_fma_f32 v[226:227], v[226:227], v[172:173], v[172:173] op_sel:[0,1,1] op_sel_hi:[1,1,1]
    v_pk_fma_f32 v[228:229], v[228:229], v[172:173], v[172:173] op_sel:[0,1,1] op_sel_hi:[1,1,1]
    v_rcp_f32 v226, v226
    v_rcp_f32 v227, v227
    v_rcp_f32 v228, v228
    v_rcp_f32 v229, v229
    v_pk_mul_f32 v[104:105], v[104:105], v[226:227]
    v_pk_mul_f32 v[106:107], v[106:107], v[228:229]
    v_cvt_pk_bf16_f32 v208, v100, v101
    v_cvt_pk_bf16_f32 v209, v102, v103
    v_cvt_pk_bf16_f32 v210, v104, v105
    v_cvt_pk_bf16_f32 v211, v106, v107
    v_or_b32 v208, 1, v208
    ds_write_b128 v244, v[208:211] offset:36864
    v_pk_fma_f32 v[128:129], v[176:177], v[156:157], v[128:129] op_sel_hi:[0,1,1] neg_lo:[1,0,0] neg_hi:[1,0,0]
    v_pk_fma_f32 v[130:131], v[176:177], v[158:159], v[130:131] op_sel_hi:[0,1,1] neg_lo:[1,0,0] neg_hi:[1,0,0]
    v_pk_mul_f32 v[226:227], v[128:129], v[128:129]
    v_pk_mul_f32 v[228:229], v[130:131], v[130:131]
    v_pk_fma_f32 v[226:227], v[226:227], v[178:179], v[178:179] op_sel:[0,1,0] op_sel_hi:[1,1,0]
    v_pk_fma_f32 v[228:229], v[228:229], v[178:179], v[178:179] op_sel:[0,1,0] op_sel_hi:[1,1,0]
    v_pk_mul_f32 v[226:227], v[226:227], v[128:129]
    v_pk_mul_f32 v[228:229], v[228:229], v[130:131]
    v_exp_f32 v226, v226
    v_exp_f32 v227, v227
    v_exp_f32 v228, v228
    v_exp_f32 v229, v229
    v_pk_fma_f32 v[226:227], v[226:227], v[176:177], v[176:177] op_sel:[0,1,1] op_sel_hi:[1,1,1]
    v_pk_fma_f32 v[228:229], v[228:229], v[176:177], v[176:177] op_sel:[0,1,1] op_sel_hi:[1,1,1]
    v_rcp_f32 v226, v226
    v_rcp_f32 v227, v227
    v_rcp_f32 v228, v228
    v_rcp_f32 v229, v229
    v_pk_mul_f32 v[128:129], v[128:129], v[226:227]
    v_pk_mul_f32 v[130:131], v[130:131], v[228:229]
    v_pk_fma_f32 v[132:133], v[176:177], v[160:161], v[132:133] op_sel_hi:[0,1,1] neg_lo:[1,0,0] neg_hi:[1,0,0]
    v_pk_fma_f32 v[134:135], v[176:177], v[162:163], v[134:135] op_sel_hi:[0,1,1] neg_lo:[1,0,0] neg_hi:[1,0,0]
    v_pk_mul_f32 v[226:227], v[132:133], v[132:133]
    v_pk_mul_f32 v[228:229], v[134:135], v[134:135]
    v_pk_fma_f32 v[226:227], v[226:227], v[178:179], v[178:179] op_sel:[0,1,0] op_sel_hi:[1,1,0]
    v_pk_fma_f32 v[228:229], v[228:229], v[178:179], v[178:179] op_sel:[0,1,0] op_sel_hi:[1,1,0]
    v_pk_mul_f32 v[226:227], v[226:227], v[132:133]
    v_pk_mul_f32 v[228:229], v[228:229], v[134:135]
    v_exp_f32 v226, v226
    v_exp_f32 v227, v227
    v_exp_f32 v228, v228
    v_exp_f32 v229, v229
    v_pk_fma_f32 v[226:227], v[226:227], v[176:177], v[176:177] op_sel:[0,1,1] op_sel_hi:[1,1,1]
    v_pk_fma_f32 v[228:229], v[228:229], v[176:177], v[176:177] op_sel:[0,1,1] op_sel_hi:[1,1,1]
    v_rcp_f32 v226, v226
    v_rcp_f32 v227, v227
    v_rcp_f32 v228, v228
    v_rcp_f32 v229, v229
    v_pk_mul_f32 v[132:133], v[132:133], v[226:227]
    v_pk_mul_f32 v[134:135], v[134:135], v[228:229]
    v_cvt_pk_bf16_f32 v212, v128, v129
    v_cvt_pk_bf16_f32 v213, v130, v131
    v_cvt_pk_bf16_f32 v214, v132, v133
    v_cvt_pk_bf16_f32 v215, v134, v135
    ds_write_b128 v244, v[212:215] offset:38912
    v_pk_fma_f32 v[24:25], v[164:165], v[136:137], v[24:25] op_sel_hi:[0,1,1] neg_lo:[1,0,0] neg_hi:[1,0,0]
    v_pk_fma_f32 v[26:27], v[164:165], v[138:139], v[26:27] op_sel_hi:[0,1,1] neg_lo:[1,0,0] neg_hi:[1,0,0]
    v_pk_mul_f32 v[226:227], v[24:25], v[24:25]
    v_pk_mul_f32 v[228:229], v[26:27], v[26:27]
    v_pk_fma_f32 v[226:227], v[226:227], v[166:167], v[166:167] op_sel:[0,1,0] op_sel_hi:[1,1,0]
    v_pk_fma_f32 v[228:229], v[228:229], v[166:167], v[166:167] op_sel:[0,1,0] op_sel_hi:[1,1,0]
    v_pk_mul_f32 v[226:227], v[226:227], v[24:25]
    v_pk_mul_f32 v[228:229], v[228:229], v[26:27]
    v_exp_f32 v226, v226
    v_exp_f32 v227, v227
    v_exp_f32 v228, v228
    v_exp_f32 v229, v229
    v_pk_fma_f32 v[226:227], v[226:227], v[164:165], v[164:165] op_sel:[0,1,1] op_sel_hi:[1,1,1]
    v_pk_fma_f32 v[228:229], v[228:229], v[164:165], v[164:165] op_sel:[0,1,1] op_sel_hi:[1,1,1]
    v_rcp_f32 v226, v226
    v_rcp_f32 v227, v227
    v_rcp_f32 v228, v228
    v_rcp_f32 v229, v229
    v_pk_mul_f32 v[24:25], v[24:25], v[226:227]
    v_pk_mul_f32 v[26:27], v[26:27], v[228:229]
    v_cvt_pk_bf16_f32 v216, v24, v25
    v_cvt_pk_bf16_f32 v217, v26, v27
    v_or_b32 v216, 1, v216
    s_add_u32 s36, s46, 0
    buffer_store_dwordx4 v[36:39], v2, s[16:19], s36 offen sc1
    v_pk_fma_f32 v[52:53], v[168:169], v[136:137], v[52:53] op_sel_hi:[0,1,1] neg_lo:[1,0,0] neg_hi:[1,0,0]
    v_pk_fma_f32 v[54:55], v[168:169], v[138:139], v[54:55] op_sel_hi:[0,1,1] neg_lo:[1,0,0] neg_hi:[1,0,0]
    v_pk_mul_f32 v[226:227], v[52:53], v[52:53]
    v_pk_mul_f32 v[228:229], v[54:55], v[54:55]
    v_pk_fma_f32 v[226:227], v[226:227], v[170:171], v[170:171] op_sel:[0,1,0] op_sel_hi:[1,1,0]
    v_pk_fma_f32 v[228:229], v[228:229], v[170:171], v[170:171] op_sel:[0,1,0] op_sel_hi:[1,1,0]
    v_pk_mul_f32 v[226:227], v[226:227], v[52:53]
    v_pk_mul_f32 v[228:229], v[228:229], v[54:55]
    v_exp_f32 v226, v226
    v_exp_f32 v227, v227
    v_exp_f32 v228, v228
    v_exp_f32 v229, v229
    v_pk_fma_f32 v[226:227], v[226:227], v[168:169], v[168:169] op_sel:[0,1,1] op_sel_hi:[1,1,1]
    v_pk_fma_f32 v[228:229], v[228:229], v[168:169], v[168:169] op_sel:[0,1,1] op_sel_hi:[1,1,1]
    v_rcp_f32 v226, v226
    v_rcp_f32 v227, v227
    v_rcp_f32 v228, v228
    v_rcp_f32 v229, v229
    v_pk_mul_f32 v[52:53], v[52:53], v[226:227]
    v_pk_mul_f32 v[54:55], v[54:55], v[228:229]
    v_cvt_pk_bf16_f32 v218, v52, v53
    v_cvt_pk_bf16_f32 v219, v54, v55
    v_or_b32 v218, 1, v218
    s_add_u32 s36, s46, 229376
    buffer_store_dwordx4 v[64:67], v2, s[16:19], s36 offen sc1
    v_pk_fma_f32 v[80:81], v[172:173], v[136:137], v[80:81] op_sel_hi:[0,1,1] neg_lo:[1,0,0] neg_hi:[1,0,0]
    v_pk_fma_f32 v[82:83], v[172:173], v[138:139], v[82:83] op_sel_hi:[0,1,1] neg_lo:[1,0,0] neg_hi:[1,0,0]
    v_pk_mul_f32 v[226:227], v[80:81], v[80:81]
    v_pk_mul_f32 v[228:229], v[82:83], v[82:83]
    v_pk_fma_f32 v[226:227], v[226:227], v[174:175], v[174:175] op_sel:[0,1,0] op_sel_hi:[1,1,0]
    v_pk_fma_f32 v[228:229], v[228:229], v[174:175], v[174:175] op_sel:[0,1,0] op_sel_hi:[1,1,0]
    v_pk_mul_f32 v[226:227], v[226:227], v[80:81]
    v_pk_mul_f32 v[228:229], v[228:229], v[82:83]
    v_exp_f32 v226, v226
    v_exp_f32 v227, v227
    v_exp_f32 v228, v228
    v_exp_f32 v229, v229
    v_pk_fma_f32 v[226:227], v[226:227], v[172:173], v[172:173] op_sel:[0,1,1] op_sel_hi:[1,1,1]
    v_pk_fma_f32 v[228:229], v[228:229], v[172:173], v[172:173] op_sel:[0,1,1] op_sel_hi:[1,1,1]
    v_rcp_f32 v226, v226
    v_rcp_f32 v227, v227
    v_rcp_f32 v228, v228
    v_rcp_f32 v229, v229
    v_pk_mul_f32 v[80:81], v[80:81], v[226:227]
    v_pk_mul_f32 v[82:83], v[82:83], v[228:229]
    v_cvt_pk_bf16_f32 v220, v80, v81
    v_cvt_pk_bf16_f32 v221, v82, v83
    v_or_b32 v220, 1, v220
    s_add_u32 s36, s46, 458752
    buffer_store_dwordx4 v[92:95], v2, s[16:19], s36 offen sc1
    v_pk_fma_f32 v[108:109], v[176:177], v[136:137], v[108:109] op_sel_hi:[0,1,1] neg_lo:[1,0,0] neg_hi:[1,0,0]
    v_pk_fma_f32 v[110:111], v[176:177], v[138:139], v[110:111] op_sel_hi:[0,1,1] neg_lo:[1,0,0] neg_hi:[1,0,0]
    v_pk_mul_f32 v[226:227], v[108:109], v[108:109]
    v_pk_mul_f32 v[228:229], v[110:111], v[110:111]
    v_pk_fma_f32 v[226:227], v[226:227], v[178:179], v[178:179] op_sel:[0,1,0] op_sel_hi:[1,1,0]
    v_pk_fma_f32 v[228:229], v[228:229], v[178:179], v[178:179] op_sel:[0,1,0] op_sel_hi:[1,1,0]
    v_pk_mul_f32 v[226:227], v[226:227], v[108:109]
    v_pk_mul_f32 v[228:229], v[228:229], v[110:111]
    v_exp_f32 v226, v226
    v_exp_f32 v227, v227
    v_exp_f32 v228, v228
    v_exp_f32 v229, v229
    v_pk_fma_f32 v[226:227], v[226:227], v[176:177], v[176:177] op_sel:[0,1,1] op_sel_hi:[1,1,1]
    v_pk_fma_f32 v[228:229], v[228:229], v[176:177], v[176:177] op_sel:[0,1,1] op_sel_hi:[1,1,1]
    v_rcp_f32 v226, v226
    v_rcp_f32 v227, v227
    v_rcp_f32 v228, v228
    v_rcp_f32 v229, v229
    v_pk_mul_f32 v[108:109], v[108:109], v[226:227]
    v_pk_mul_f32 v[110:111], v[110:111], v[228:229]
    v_cvt_pk_bf16_f32 v222, v108, v109
    v_cvt_pk_bf16_f32 v223, v110, v111
    s_add_u32 s36, s46, 688128
    buffer_store_dwordx4 v[120:123], v2, s[16:19], s36 offen sc1
    s_waitcnt lgkmcnt(0)
    s_add_u32 s45, s44, 512
    s_mov_b32 s44, s47
G3_e2:
    s_waitcnt lgkmcnt(0)
    s_barrier
    ds_read_b128 v[88:91], v17 offset:0
    ds_read_b128 v[92:95], v17 offset:2048
    ds_read_b128 v[96:99], v17 offset:4096
    ds_read_b128 v[100:103], v17 offset:6144
    ds_read_b64_tr_b16 v[104:105], v18 offset:0
    ds_read_b64_tr_b16 v[106:107], v18 offset:4096
    ds_read_b64_tr_b16 v[108:109], v19 offset:0
    ds_read_b64_tr_b16 v[110:111], v19 offset:4096
    ds_read_b64_tr_b16 v[112:113], v20 offset:0
    ds_read_b64_tr_b16 v[114:115], v20 offset:4096
    ds_read_b64_tr_b16 v[116:117], v21 offset:0
    ds_read_b64_tr_b16 v[118:119], v21 offset:4096
    s_waitcnt lgkmcnt(6)
    v_mfma_f32_16x16x32_bf16 v[24:27], v[104:107], v[88:91], 0
    ds_read_b128 v[120:123], v17 offset:1024
    s_add_u32 s42, s42, 16384
    v_mfma_f32_16x16x32_bf16 v[40:43], v[104:107], v[92:95], 0
    ds_read_b128 v[124:127], v17 offset:3072
    s_cmp_eq_u32 s42, 49152
    v_mfma_f32_16x16x32_bf16 v[56:59], v[104:107], v[96:99], 0
    ds_read_b128 v[128:131], v17 offset:5120
    s_cselect_b32 s42, 0, s42
    v_mfma_f32_16x16x32_bf16 v[72:75], v[104:107], v[100:103], 0
    ds_read_b128 v[132:135], v17 offset:7168
    s_waitcnt lgkmcnt(8)
    v_mfma_f32_16x16x32_bf16 v[76:79], v[108:111], v[100:103], 0
    ds_read_b64_tr_b16 v[136:137], v18 offset:8192
    s_add_u32 s48, s48, 16384
    v_mfma_f32_16x16x32_bf16 v[60:63], v[108:111], v[96:99], 0
    ds_read_b64_tr_b16 v[138:139], v18 offset:12288
    s_cmp_eq_u32 s48, 98304
    v_mfma_f32_16x16x32_bf16 v[44:47], v[108:111], v[92:95], 0
    ds_read_b64_tr_b16 v[140:141], v19 offset:8192
    s_cselect_b32 s48, 0, s48
    v_mfma_f32_16x16x32_bf16 v[28:31], v[108:111], v[88:91], 0
    ds_read_b64_tr_b16 v[142:143], v19 offset:12288
    s_waitcnt lgkmcnt(8)
    v_mfma_f32_16x16x32_bf16 v[32:35], v[112:115], v[88:91], 0
    ds_read_b64_tr_b16 v[144:145], v20 offset:8192
    v_add_u32 v17, s42, v12
    v_mfma_f32_16x16x32_bf16 v[48:51], v[112:115], v[92:95], 0
    ds_read_b64_tr_b16 v[146:147], v20 offset:12288
    s_add_u32 s36, s44, 0
    v_mfma_f32_16x16x32_bf16 v[64:67], v[112:115], v[96:99], 0
    ds_read_b64_tr_b16 v[148:149], v21 offset:8192
    buffer_store_dwordx4 v[200:203], v2, s[16:19], s36 offen sc1
    v_mfma_f32_16x16x32_bf16 v[80:83], v[112:115], v[100:103], 0
    ds_read_b64_tr_b16 v[150:151], v21 offset:12288
    s_add_u32 s36, s45, 0
    v_mfma_f32_16x16x32_bf16 v[84:87], v[116:119], v[100:103], 0
    buffer_store_dwordx2 v[216:217], v238, s[16:19], s36 offen sc1
    v_add_u32 v18, s48, v13
    v_mfma_f32_16x16x32_bf16 v[68:71], v[116:119], v[96:99], 0
    v_add_u32 v19, s48, v14
    v_mfma_f32_16x16x32_bf16 v[52:55], v[116:119], v[92:95], 0
    v_add_u32 v20, s48, v15
    v_mfma_f32_16x16x32_bf16 v[36:39], v[116:119], v[88:91], 0
    v_add_u32 v21, s48, v16
    s_waitcnt lgkmcnt(6)
    v_mfma_f32_16x16x32_bf16 v[24:27], v[136:139], v[120:123], v[24:27]
    v_mfma_f32_16x16x32_bf16 v[40:43], v[136:139], v[124:127], v[40:43]
    v_mfma_f32_16x16x32_bf16 v[56:59], v[136:139], v[128:131], v[56:59]
    s_waitcnt lgkmcnt(0)
    s_barrier
    v_mfma_f32_16x16x32_bf16 v[72:75], v[136:139], v[132:135], v[72:75]
    ds_read_b128 v[88:91], v17 offset:0
    s_add_u32 s36, s44, 229376
    v_mfma_f32_16x16x32_bf16 v[76:79], v[140:143], v[132:135], v[76:79]
    ds_read_b128 v[92:95], v17 offset:2048
    buffer_store_dwordx4 v[204:207], v2, s[16:19], s36 offen sc1
    v_mfma_f32_16x16x32_bf16 v[60:63], v[140:143], v[128:131], v[60:63]
    ds_read_b128 v[96:99], v17 offset:4096
    s_add_u32 s36, s45, 229376
    v_mfma_f32_16x16x32_bf16 v[44:47], v[140:143], v[124:127], v[44:47]
    ds_read_b128 v[100:103], v17 offset:6144
    buffer_store_dwordx2 v[218:219], v238, s[16:19], s36 offen sc1
    v_mfma_f32_16x16x32_bf16 v[28:31], v[140:143], v[120:123], v[28:31]
    ds_read_b64_tr_b16 v[104:105], v18 offset:0
    s_add_u32 s43, s43, 1
    v_mfma_f32_16x16x32_bf16 v[32:35], v[144:147], v[120:123], v[32:35]
    ds_read_b64_tr_b16 v[106:107], v18 offset:4096
    s_cmp_lt_u32 s43, 27
    v_mfma_f32_16x16x32_bf16 v[48:51], v[144:147], v[124:127], v[48:51]
    ds_read_b64_tr_b16 v[108:109], v19 offset:0
    v_mfma_f32_16x16x32_bf16 v[64:67], v[144:147], v[128:131], v[64:67]
    ds_read_b64_tr_b16 v[110:111], v19 offset:4096
    v_mfma_f32_16x16x32_bf16 v[80:83], v[144:147], v[132:135], v[80:83]
    ds_read_b64_tr_b16 v[112:113], v20 offset:0
    v_mfma_f32_16x16x32_bf16 v[84:87], v[148:151], v[132:135], v[84:87]
    ds_read_b64_tr_b16 v[114:115], v20 offset:4096
    v_mfma_f32_16x16x32_bf16 v[68:71], v[148:151], v[128:131], v[68:71]
    ds_read_b64_tr_b16 v[116:117], v21 offset:0
    v_mfma_f32_16x16x32_bf16 v[52:55], v[148:151], v[124:127], v[52:55]
    ds_read_b64_tr_b16 v[118:119], v21 offset:4096
    v_mfma_f32_16x16x32_bf16 v[36:39], v[148:151], v[120:123], v[36:39]
    s_waitcnt lgkmcnt(6)
    v_mfma_f32_16x16x32_bf16 v[24:27], v[104:107], v[88:91], v[24:27]
    ds_read_b128 v[120:123], v17 offset:1024
    s_add_u32 s42, s42, 16384
    v_mfma_f32_16x16x32_bf16 v[40:43], v[104:107], v[92:95], v[40:43]
    ds_read_b128 v[124:127], v17 offset:3072
    s_cmp_eq_u32 s42, 49152
    v_mfma_f32_16x16x32_bf16 v[56:59], v[104:107], v[96:99], v[56:59]
    ds_read_b128 v[128:131], v17 offset:5120
    s_cselect_b32 s42, 0, s42
    v_mfma_f32_16x16x32_bf16 v[72:75], v[104:107], v[100:103], v[72:75]
    ds_read_b128 v[132:135], v17 offset:7168
    s_waitcnt lgkmcnt(8)
    v_mfma_f32_16x16x32_bf16 v[76:79], v[108:111], v[100:103], v[76:79]
    ds_read_b64_tr_b16 v[136:137], v18 offset:8192
    s_add_u32 s48, s48, 16384
    v_mfma_f32_16x16x32_bf16 v[60:63], v[108:111], v[96:99], v[60:63]
    ds_read_b64_tr_b16 v[138:139], v18 offset:12288
    s_cmp_eq_u32 s48, 98304
    v_mfma_f32_16x16x32_bf16 v[44:47], v[108:111], v[92:95], v[44:47]
    ds_read_b64_tr_b16 v[140:141], v19 offset:8192
    s_cselect_b32 s48, 0, s48
    v_mfma_f32_16x16x32_bf16 v[28:31], v[108:111], v[88:91], v[28:31]
    ds_read_b64_tr_b16 v[142:143], v19 offset:12288
    s_waitcnt lgkmcnt(8)
    v_mfma_f32_16x16x32_bf16 v[32:35], v[112:115], v[88:91], v[32:35]
    ds_read_b64_tr_b16 v[144:145], v20 offset:8192
    v_add_u32 v17, s42, v12
    v_mfma_f32_16x16x32_bf16 v[48:51], v[112:115], v[92:95], v[48:51]
    ds_read_b64_tr_b16 v[146:147], v20 offset:12288
    s_add_u32 s36, s44, 458752
    v_mfma_f32_16x16x32_bf16 v[64:67], v[112:115], v[96:99], v[64:67]
    ds_read_b64_tr_b16 v[148:149], v21 offset:8192
    buffer_store_dwordx4 v[208:211], v2, s[16:19], s36 offen sc1
    v_mfma_f32_16x16x32_bf16 v[80:83], v[112:115], v[100:103], v[80:83]
    ds_read_b64_tr_b16 v[150:151], v21 offset:12288
    s_add_u32 s36, s45, 458752
    v_mfma_f32_16x16x32_bf16 v[84:87], v[116:119], v[100:103], v[84:87]
    buffer_store_dwordx2 v[220:221], v238, s[16:19], s36 offen sc1
    v_add_u32 v18, s48, v13
    v_mfma_f32_16x16x32_bf16 v[68:71], v[116:119], v[96:99], v[68:71]
    v_add_u32 v19, s48, v14
    v_mfma_f32_16x16x32_bf16 v[52:55], v[116:119], v[92:95], v[52:55]
    v_add_u32 v20, s48, v15
    v_mfma_f32_16x16x32_bf16 v[36:39], v[116:119], v[88:91], v[36:39]
    v_add_u32 v21, s48, v16
    s_waitcnt lgkmcnt(6)
    v_mfma_f32_16x16x32_bf16 v[24:27], v[136:139], v[120:123], v[24:27]
    v_mfma_f32_16x16x32_bf16 v[40:43], v[136:139], v[124:127], v[40:43]
    s_waitcnt vmcnt(6)
    v_mfma_f32_16x16x32_bf16 v[56:59], v[136:139], v[128:131], v[56:59]
    s_waitcnt lgkmcnt(0)
    s_barrier
    v_mfma_f32_16x16x32_bf16 v[72:75], v[136:139], v[132:135], v[72:75]
    ds_read_b128 v[88:91], v17 offset:0
    s_add_u32 s36, s44, 688128
    v_mfma_f32_16x16x32_bf16 v[76:79], v[140:143], v[132:135], v[76:79]
    ds_read_b128 v[92:95], v17 offset:2048
    buffer_store_dwordx4 v[212:215], v2, s[16:19], s36 offen sc1
    v_mfma_f32_16x16x32_bf16 v[60:63], v[140:143], v[128:131], v[60:63]
    ds_read_b128 v[96:99], v17 offset:4096
    s_add_u32 s36, s45, 688128
    v_mfma_f32_16x16x32_bf16 v[44:47], v[140:143], v[124:127], v[44:47]
    ds_read_b128 v[100:103], v17 offset:6144
    buffer_store_dwordx2 v[222:223], v238, s[16:19], s36 offen sc1
    v_mfma_f32_16x16x32_bf16 v[28:31], v[140:143], v[120:123], v[28:31]
    ds_read_b64_tr_b16 v[104:105], v18 offset:0
    s_add_u32 s43, s43, 1
    v_mfma_f32_16x16x32_bf16 v[32:35], v[144:147], v[120:123], v[32:35]
    ds_read_b64_tr_b16 v[106:107], v18 offset:4096
    s_cmp_lt_u32 s43, 27
    v_mfma_f32_16x16x32_bf16 v[48:51], v[144:147], v[124:127], v[48:51]
    ds_read_b64_tr_b16 v[108:109], v19 offset:0
    v_mfma_f32_16x16x32_bf16 v[64:67], v[144:147], v[128:131], v[64:67]
    ds_read_b64_tr_b16 v[110:111], v19 offset:4096
    v_mfma_f32_16x16x32_bf16 v[80:83], v[144:147], v[132:135], v[80:83]
    ds_read_b64_tr_b16 v[112:113], v20 offset:0
    v_mfma_f32_16x16x32_bf16 v[84:87], v[148:151], v[132:135], v[84:87]
    ds_read_b64_tr_b16 v[114:115], v20 offset:4096
    v_mfma_f32_16x16x32_bf16 v[68:71], v[148:151], v[128:131], v[68:71]
    ds_read_b64_tr_b16 v[116:117], v21 offset:0
    v_mfma_f32_16x16x32_bf16 v[52:55], v[148:151], v[124:127], v[52:55]
    ds_read_b64_tr_b16 v[118:119], v21 offset:4096
    v_mfma_f32_16x16x32_bf16 v[36:39], v[148:151], v[120:123], v[36:39]
    s_waitcnt lgkmcnt(6)
mm_24:
    v_mfma_f32_16x16x32_bf16 v[24:27], v[104:107], v[88:91], v[24:27]
    ds_read_b128 v[120:123], v17 offset:1024
    s_add_u32 s42, s42, 16384
    v_mfma_f32_16x16x32_bf16 v[40:43], v[104:107], v[92:95], v[40:43]
    ds_read_b128 v[124:127], v17 offset:3072
    s_cmp_eq_u32 s42, 49152
    v_mfma_f32_16x16x32_bf16 v[56:59], v[104:107], v[96:99], v[56:59]
    ds_read_b128 v[128:131], v17 offset:5120
    s_cselect_b32 s42, 0, s42
    v_mfma_f32_16x16x32_bf16 v[72:75], v[104:107], v[100:103], v[72:75]
    ds_read_b128 v[132:135], v17 offset:7168
    s_waitcnt lgkmcnt(8)
    v_mfma_f32_16x16x32_bf16 v[76:79], v[108:111], v[100:103], v[76:79]
    ds_read_b64_tr_b16 v[136:137], v18 offset:8192
    s_add_u32 s48, s48, 16384
    v_mfma_f32_16x16x32_bf16 v[60:63], v[108:111], v[96:99], v[60:63]
    ds_read_b64_tr_b16 v[138:139], v18 offset:12288
    s_cmp_eq_u32 s48, 98304
    v_mfma_f32_16x16x32_bf16 v[44:47], v[108:111], v[92:95], v[44:47]
    ds_read_b64_tr_b16 v[140:141], v19 offset:8192
    s_cselect_b32 s48, 0, s48
    v_mfma_f32_16x16x32_bf16 v[28:31], v[108:111], v[88:91], v[28:31]
    ds_read_b64_tr_b16 v[142:143], v19 offset:12288
    s_waitcnt lgkmcnt(8)
    v_mfma_f32_16x16x32_bf16 v[32:35], v[112:115], v[88:91], v[32:35]
    ds_read_b64_tr_b16 v[144:145], v20 offset:8192
    v_add_u32 v17, s42, v12
    v_mfma_f32_16x16x32_bf16 v[48:51], v[112:115], v[92:95], v[48:51]
    ds_read_b64_tr_b16 v[146:147], v20 offset:12288
    v_add_u32 v18, s48, v13
    v_mfma_f32_16x16x32_bf16 v[64:67], v[112:115], v[96:99], v[64:67]
    ds_read_b64_tr_b16 v[148:149], v21 offset:8192
    v_add_u32 v19, s48, v14
    v_mfma_f32_16x16x32_bf16 v[80:83], v[112:115], v[100:103], v[80:83]
    ds_read_b64_tr_b16 v[150:151], v21 offset:12288
    v_add_u32 v20, s48, v15
    v_mfma_f32_16x16x32_bf16 v[84:87], v[116:119], v[100:103], v[84:87]
    v_add_u32 v21, s48, v16
    v_mfma_f32_16x16x32_bf16 v[68:71], v[116:119], v[96:99], v[68:71]
    v_mfma_f32_16x16x32_bf16 v[52:55], v[116:119], v[92:95], v[52:55]
    v_mfma_f32_16x16x32_bf16 v[36:39], v[116:119], v[88:91], v[36:39]
    s_waitcnt lgkmcnt(6)
    v_mfma_f32_16x16x32_bf16 v[24:27], v[136:139], v[120:123], v[24:27]
    s_add_u32 s43, s43, 1
    s_cmp_lt_u32 s43, 4
    v_mfma_f32_16x16x32_bf16 v[40:43], v[136:139], v[124:127], v[40:43]
    v_mfma_f32_16x16x32_bf16 v[56:59], v[136:139], v[128:131], v[56:59]
    s_waitcnt lgkmcnt(0)
    s_barrier
    v_mfma_f32_16x16x32_bf16 v[72:75], v[136:139], v[132:135], v[72:75]
    ds_read_b128 v[88:91], v17 offset:0
    v_mfma_f32_16x16x32_bf16 v[76:79], v[140:143], v[132:135], v[76:79]
    ds_read_b128 v[92:95], v17 offset:2048
    v_mfma_f32_16x16x32_bf16 v[60:63], v[140:143], v[128:131], v[60:63]
    ds_read_b128 v[96:99], v17 offset:4096
    v_mfma_f32_16x16x32_bf16 v[44:47], v[140:143], v[124:127], v[44:47]
    ds_read_b128 v[100:103], v17 offset:6144
    v_mfma_f32_16x16x32_bf16 v[28:31], v[140:143], v[120:123], v[28:31]
    ds_read_b64_tr_b16 v[104:105], v18 offset:0
    v_mfma_f32_16x16x32_bf16 v[32:35], v[144:147], v[120:123], v[32:35]
    ds_read_b64_tr_b16 v[106:107], v18 offset:4096
    v_mfma_f32_16x16x32_bf16 v[48:51], v[144:147], v[124:127], v[48:51]
    ds_read_b64_tr_b16 v[108:109], v19 offset:0
    v_mfma_f32_16x16x32_bf16 v[64:67], v[144:147], v[128:131], v[64:67]
    ds_read_b64_tr_b16 v[110:111], v19 offset:4096
    v_mfma_f32_16x16x32_bf16 v[80:83], v[144:147], v[132:135], v[80:83]
    ds_read_b64_tr_b16 v[112:113], v20 offset:0
    v_mfma_f32_16x16x32_bf16 v[84:87], v[148:151], v[132:135], v[84:87]
    ds_read_b64_tr_b16 v[114:115], v20 offset:4096
    v_mfma_f32_16x16x32_bf16 v[68:71], v[148:151], v[128:131], v[68:71]
    ds_read_b64_tr_b16 v[116:117], v21 offset:0
    v_mfma_f32_16x16x32_bf16 v[52:55], v[148:151], v[124:127], v[52:55]
    ds_read_b64_tr_b16 v[118:119], v21 offset:4096
    v_mfma_f32_16x16x32_bf16 v[36:39], v[148:151], v[120:123], v[36:39]
    s_waitcnt lgkmcnt(6)
    s_cbranch_scc1 mm_24
mm_25:
    v_mfma_f32_16x16x32_bf16 v[24:27], v[104:107], v[88:91], v[24:27]
    ds_read_b128 v[120:123], v17 offset:1024
    s_add_u32 s42, s42, 16384
    v_mfma_f32_16x16x32_bf16 v[40:43], v[104:107], v[92:95], v[40:43]
    ds_read_b128 v[124:127], v17 offset:3072
    s_cmp_eq_u32 s42, 49152
    v_mfma_f32_16x16x32_bf16 v[56:59], v[104:107], v[96:99], v[56:59]
    ds_read_b128 v[128:131], v17 offset:5120
    s_cselect_b32 s42, 0, s42
    v_mfma_f32_16x16x32_bf16 v[72:75], v[104:107], v[100:103], v[72:75]
    ds_read_b128 v[132:135], v17 offset:7168
    s_waitcnt lgkmcnt(8)
    v_mfma_f32_16x16x32_bf16 v[76:79], v[108:111], v[100:103], v[76:79]
    ds_read_b64_tr_b16 v[136:137], v18 offset:8192
    s_add_u32 s48, s48, 16384
    v_mfma_f32_16x16x32_bf16 v[60:63], v[108:111], v[96:99], v[60:63]
    ds_read_b64_tr_b16 v[138:139], v18 offset:12288
    s_cmp_eq_u32 s48, 98304
    v_mfma_f32_16x16x32_bf16 v[44:47], v[108:111], v[92:95], v[44:47]
    ds_read_b64_tr_b16 v[140:141], v19 offset:8192
    s_cselect_b32 s48, 0, s48
    v_mfma_f32_16x16x32_bf16 v[28:31], v[108:111], v[88:91], v[28:31]
    ds_read_b64_tr_b16 v[142:143], v19 offset:12288
    s_waitcnt lgkmcnt(8)
    v_mfma_f32_16x16x32_bf16 v[32:35], v[112:115], v[88:91], v[32:35]
    ds_read_b64_tr_b16 v[144:145], v20 offset:8192
    v_add_u32 v17, s42, v12
    v_mfma_f32_16x16x32_bf16 v[48:51], v[112:115], v[92:95], v[48:51]
    ds_read_b64_tr_b16 v[146:147], v20 offset:12288
    v_add_u32 v18, s48, v13
    v_mfma_f32_16x16x32_bf16 v[64:67], v[112:115], v[96:99], v[64:67]
    ds_read_b64_tr_b16 v[148:149], v21 offset:8192
    v_add_u32 v19, s48, v14
    v_mfma_f32_16x16x32_bf16 v[80:83], v[112:115], v[100:103], v[80:83]
    ds_read_b64_tr_b16 v[150:151], v21 offset:12288
    v_add_u32 v20, s48, v15
    v_mfma_f32_16x16x32_bf16 v[84:87], v[116:119], v[100:103], v[84:87]
    v_add_u32 v21, s48, v16
    v_mfma_f32_16x16x32_bf16 v[68:71], v[116:119], v[96:99], v[68:71]
    v_mfma_f32_16x16x32_bf16 v[52:55], v[116:119], v[92:95], v[52:55]
    v_mfma_f32_16x16x32_bf16 v[36:39], v[116:119], v[88:91], v[36:39]
    s_waitcnt lgkmcnt(6)
    v_mfma_f32_16x16x32_bf16 v[24:27], v[136:139], v[120:123], v[24:27]
    s_add_u32 s43, s43, 1
    s_cmp_lt_u32 s43, 27
    v_mfma_f32_16x16x32_bf16 v[40:43], v[136:139], v[124:127], v[40:43]
    s_waitcnt vmcnt(0)
    v_mfma_f32_16x16x32_bf16 v[56:59], v[136:139], v[128:131], v[56:59]
    s_waitcnt lgkmcnt(0)
    s_barrier
    v_mfma_f32_16x16x32_bf16 v[72:75], v[136:139], v[132:135], v[72:75]
    ds_read_b128 v[88:91], v17 offset:0
    v_mfma_f32_16x16x32_bf16 v[76:79], v[140:143], v[132:135], v[76:79]
    ds_read_b128 v[92:95], v17 offset:2048
    v_mfma_f32_16x16x32_bf16 v[60:63], v[140:143], v[128:131], v[60:63]
    ds_read_b128 v[96:99], v17 offset:4096
    v_mfma_f32_16x16x32_bf16 v[44:47], v[140:143], v[124:127], v[44:47]
    ds_read_b128 v[100:103], v17 offset:6144
    v_mfma_f32_16x16x32_bf16 v[28:31], v[140:143], v[120:123], v[28:31]
    ds_read_b64_tr_b16 v[104:105], v18 offset:0
    v_mfma_f32_16x16x32_bf16 v[32:35], v[144:147], v[120:123], v[32:35]
    ds_read_b64_tr_b16 v[106:107], v18 offset:4096
    v_mfma_f32_16x16x32_bf16 v[48:51], v[144:147], v[124:127], v[48:51]
    ds_read_b64_tr_b16 v[108:109], v19 offset:0
    v_mfma_f32_16x16x32_bf16 v[64:67], v[144:147], v[128:131], v[64:67]
    ds_read_b64_tr_b16 v[110:111], v19 offset:4096
    v_mfma_f32_16x16x32_bf16 v[80:83], v[144:147], v[132:135], v[80:83]
    ds_read_b64_tr_b16 v[112:113], v20 offset:0
    v_mfma_f32_16x16x32_bf16 v[84:87], v[148:151], v[132:135], v[84:87]
    ds_read_b64_tr_b16 v[114:115], v20 offset:4096
    v_mfma_f32_16x16x32_bf16 v[68:71], v[148:151], v[128:131], v[68:71]
    ds_read_b64_tr_b16 v[116:117], v21 offset:0
    v_mfma_f32_16x16x32_bf16 v[52:55], v[148:151], v[124:127], v[52:55]
    ds_read_b64_tr_b16 v[118:119], v21 offset:4096
    v_mfma_f32_16x16x32_bf16 v[36:39], v[148:151], v[120:123], v[36:39]
    s_waitcnt lgkmcnt(6)
    s_cbranch_scc1 mm_25
    s_cmp_eq_u32 s60, 1
    s_cbranch_scc1 G4_last
    v_mfma_f32_16x16x32_bf16 v[24:27], v[104:107], v[88:91], v[24:27]
    ds_read_b128 v[120:123], v17 offset:1024
    v_mfma_f32_16x16x32_bf16 v[40:43], v[104:107], v[92:95], v[40:43]
    ds_read_b128 v[124:127], v17 offset:3072
    v_mfma_f32_16x16x32_bf16 v[56:59], v[104:107], v[96:99], v[56:59]
    ds_read_b128 v[128:131], v17 offset:5120
    v_mfma_f32_16x16x32_bf16 v[72:75], v[104:107], v[100:103], v[72:75]
    ds_read_b128 v[132:135], v17 offset:7168
    s_waitcnt lgkmcnt(8)
    v_mfma_f32_16x16x32_bf16 v[76:79], v[108:111], v[100:103], v[76:79]
    ds_read_b64_tr_b16 v[136:137], v18 offset:8192
    v_mfma_f32_16x16x32_bf16 v[60:63], v[108:111], v[96:99], v[60:63]
    ds_read_b64_tr_b16 v[138:139], v18 offset:12288
    v_mfma_f32_16x16x32_bf16 v[44:47], v[108:111], v[92:95], v[44:47]
    ds_read_b64_tr_b16 v[140:141], v19 offset:8192
    v_mfma_f32_16x16x32_bf16 v[28:31], v[108:111], v[88:91], v[28:31]
    ds_read_b64_tr_b16 v[142:143], v19 offset:12288
    s_waitcnt lgkmcnt(8)
    v_mfma_f32_16x16x32_bf16 v[32:35], v[112:115], v[88:91], v[32:35]
    ds_read_b64_tr_b16 v[144:145], v20 offset:8192
    v_mfma_f32_16x16x32_bf16 v[48:51], v[112:115], v[92:95], v[48:51]
    ds_read_b64_tr_b16 v[146:147], v20 offset:12288
    v_mfma_f32_16x16x32_bf16 v[64:67], v[112:115], v[96:99], v[64:67]
    ds_read_b64_tr_b16 v[148:149], v21 offset:8192
    v_mfma_f32_16x16x32_bf16 v[80:83], v[112:115], v[100:103], v[80:83]
    ds_read_b64_tr_b16 v[150:151], v21 offset:12288
    v_mfma_f32_16x16x32_bf16 v[84:87], v[116:119], v[100:103], v[84:87]
    v_mfma_f32_16x16x32_bf16 v[68:71], v[116:119], v[96:99], v[68:71]
    v_mfma_f32_16x16x32_bf16 v[52:55], v[116:119], v[92:95], v[52:55]
    v_mfma_f32_16x16x32_bf16 v[36:39], v[116:119], v[88:91], v[36:39]
    s_waitcnt lgkmcnt(0)
    v_mfma_f32_16x16x32_bf16 v[24:27], v[136:139], v[120:123], v[24:27]
    s_mul_i32 s36, s31, 524288
    s_add_u32 s36, s36, 0
    s_add_u32 s16, s62, s36
    v_mfma_f32_16x16x32_bf16 v[40:43], v[136:139], v[124:127], v[40:43]
    s_addc_u32 s17, s63, 0
    s_mov_b32 s18, 516096
    s_mov_b32 s19, 0x20000
    v_mfma_f32_16x16x32_bf16 v[56:59], v[136:139], v[128:131], v[56:59]
    v_mfma_f32_16x16x32_bf16 v[72:75], v[136:139], v[132:135], v[72:75]
    v_mfma_f32_16x16x32_bf16 v[76:79], v[140:143], v[132:135], v[76:79]
    v_mfma_f32_16x16x32_bf16 v[60:63], v[140:143], v[128:131], v[60:63]
    v_mfma_f32_16x16x32_bf16 v[44:47], v[140:143], v[124:127], v[44:47]
    v_mfma_f32_16x16x32_bf16 v[28:31], v[140:143], v[120:123], v[28:31]
    v_mfma_f32_16x16x32_bf16 v[32:35], v[144:147], v[120:123], v[32:35]
    v_mfma_f32_16x16x32_bf16 v[48:51], v[144:147], v[124:127], v[48:51]
    v_mfma_f32_16x16x32_bf16 v[64:67], v[144:147], v[128:131], v[64:67]
    v_mfma_f32_16x16x32_bf16 v[80:83], v[144:147], v[132:135], v[80:83]
    v_mfma_f32_16x16x32_bf16 v[84:87], v[148:151], v[132:135], v[84:87]
    v_mfma_f32_16x16x32_bf16 v[68:71], v[148:151], v[128:131], v[68:71]
    v_mfma_f32_16x16x32_bf16 v[52:55], v[148:151], v[124:127], v[52:55]
    v_mfma_f32_16x16x32_bf16 v[36:39], v[148:151], v[120:123], v[36:39]
    s_add_u32 s36, s39, 0
    v_cvt_pk_bf16_f32 v24, v24, v25
    v_cvt_pk_bf16_f32 v25, v26, v27
    v_cvt_pk_bf16_f32 v26, v28, v29
    v_cvt_pk_bf16_f32 v27, v30, v31
    v_or_b32 v24, 1, v24
    buffer_store_dwordx4 v[24:27], v2, s[16:19], s36 offen offset:0 sc1
    v_cvt_pk_bf16_f32 v32, v32, v33
    v_cvt_pk_bf16_f32 v33, v34, v35
    v_cvt_pk_bf16_f32 v34, v36, v37
    v_cvt_pk_bf16_f32 v35, v38, v39
    v_or_b32 v32, 1, v32
    buffer_store_dwordx4 v[32:35], v2, s[16:19], s36 offen offset:1024 sc1
    s_add_u32 s36, s39, 65536
    v_cvt_pk_bf16_f32 v40, v40, v41
    v_cvt_pk_bf16_f32 v41, v42, v43
    v_cvt_pk_bf16_f32 v42, v44, v45
    v_cvt_pk_bf16_f32 v43, v46, v47
    v_or_b32 v40, 1, v40
    buffer_store_dwordx4 v[40:43], v2, s[16:19], s36 offen offset:0 sc1
    v_cvt_pk_bf16_f32 v48, v48, v49
    v_cvt_pk_bf16_f32 v49, v50, v51
    v_cvt_pk_bf16_f32 v50, v52, v53
    v_cvt_pk_bf16_f32 v51, v54, v55
    v_or_b32 v48, 1, v48
    buffer_store_dwordx4 v[48:51], v2, s[16:19], s36 offen offset:1024 sc1
    s_add_u32 s36, s39, 131072
    v_cvt_pk_bf16_f32 v56, v56, v57
    v_cvt_pk_bf16_f32 v57, v58, v59
    v_cvt_pk_bf16_f32 v58, v60, v61
    v_cvt_pk_bf16_f32 v59, v62, v63
    v_or_b32 v56, 1, v56
    buffer_store_dwordx4 v[56:59], v2, s[16:19], s36 offen offset:0 sc1
    v_cvt_pk_bf16_f32 v64, v64, v65
    v_cvt_pk_bf16_f32 v65, v66, v67
    v_cvt_pk_bf16_f32 v66, v68, v69
    v_cvt_pk_bf16_f32 v67, v70, v71
    v_or_b32 v64, 1, v64
    buffer_store_dwordx4 v[64:67], v2, s[16:19], s36 offen offset:1024 sc1
    s_add_u32 s36, s39, 196608
    v_cvt_pk_bf16_f32 v72, v72, v73
    v_cvt_pk_bf16_f32 v73, v74, v75
    v_cvt_pk_bf16_f32 v74, v76, v77
    v_cvt_pk_bf16_f32 v75, v78, v79
    v_or_b32 v72, 1, v72
    buffer_store_dwordx4 v[72:75], v2, s[16:19], s36 offen offset:0 sc1
    v_cvt_pk_bf16_f32 v80, v80, v81
    v_cvt_pk_bf16_f32 v81, v82, v83
    v_cvt_pk_bf16_f32 v82, v84, v85
    v_cvt_pk_bf16_f32 v83, v86, v87
    v_or_b32 v80, 1, v80
    buffer_store_dwordx4 v[80:83], v2, s[16:19], s36 offen offset:1024 sc1
    s_barrier
    s_branch NEXT
G4_last:
    v_mfma_f32_16x16x32_bf16 v[24:27], v[104:107], v[88:91], v[24:27]
    ds_read_b128 v[120:123], v17 offset:1024
    v_mfma_f32_16x16x32_bf16 v[40:43], v[104:107], v[92:95], v[40:43]
    ds_read_b128 v[124:127], v17 offset:3072
    v_mfma_f32_16x16x32_bf16 v[56:59], v[104:107], v[96:99], v[56:59]
    ds_read_b128 v[128:131], v17 offset:5120
    v_mfma_f32_16x16x32_bf16 v[72:75], v[104:107], v[100:103], v[72:75]
    ds_read_b128 v[132:135], v17 offset:7168
    s_waitcnt lgkmcnt(8)
    v_mfma_f32_16x16x32_bf16 v[76:79], v[108:111], v[100:103], v[76:79]
    ds_read_b64_tr_b16 v[136:137], v18 offset:8192
    v_mfma_f32_16x16x32_bf16 v[60:63], v[108:111], v[96:99], v[60:63]
    ds_read_b64_tr_b16 v[138:139], v18 offset:12288
    v_mfma_f32_16x16x32_bf16 v[44:47], v[108:111], v[92:95], v[44:47]
    ds_read_b64_tr_b16 v[140:141], v19 offset:8192
    v_mfma_f32_16x16x32_bf16 v[28:31], v[108:111], v[88:91], v[28:31]
    ds_read_b64_tr_b16 v[142:143], v19 offset:12288
    s_waitcnt lgkmcnt(8)
    v_mfma_f32_16x16x32_bf16 v[32:35], v[112:115], v[88:91], v[32:35]
    ds_read_b64_tr_b16 v[144:145], v20 offset:8192
    v_mfma_f32_16x16x32_bf16 v[48:51], v[112:115], v[92:95], v[48:51]
    ds_read_b64_tr_b16 v[146:147], v20 offset:12288
    s_load_dwordx2 s[6:7], s[0:1], 88
    v_mfma_f32_16x16x32_bf16 v[64:67], v[112:115], v[96:99], v[64:67]
    ds_read_b64_tr_b16 v[148:149], v21 offset:8192
    v_mfma_f32_16x16x32_bf16 v[80:83], v[112:115], v[100:103], v[80:83]
    ds_read_b64_tr_b16 v[150:151], v21 offset:12288
    v_mfma_f32_16x16x32_bf16 v[84:87], v[116:119], v[100:103], v[84:87]
    v_mfma_f32_16x16x32_bf16 v[68:71], v[116:119], v[96:99], v[68:71]
    v_mfma_f32_16x16x32_bf16 v[52:55], v[116:119], v[92:95], v[52:55]
    v_mfma_f32_16x16x32_bf16 v[36:39], v[116:119], v[88:91], v[36:39]
    s_waitcnt lgkmcnt(0)
    v_mfma_f32_16x16x32_bf16 v[24:27], v[136:139], v[120:123], v[24:27]
    s_add_u32 s16, s62, 0x80000
    s_addc_u32 s17, s63, 0
    s_mov_b32 s18, 0x7e000
    v_mfma_f32_16x16x32_bf16 v[40:43], v[136:139], v[124:127], v[40:43]
    s_mov_b32 s19, 0x20000
    s_mov_b32 s20, s6
    s_mov_b32 s21, s7
    v_mfma_f32_16x16x32_bf16 v[56:59], v[136:139], v[128:131], v[56:59]
    s_mov_b32 s22, 0x400000
    s_mov_b32 s23, 0x20000
    s_add_u32 s44, s40, 65536
    v_mfma_f32_16x16x32_bf16 v[72:75], v[136:139], v[132:135], v[72:75]
    s_lshl_b32 s46, s28, 3
    s_add_u32 s46, s46, s37
    s_lshl_b32 s47, s31, 1
    v_mfma_f32_16x16x32_bf16 v[76:79], v[140:143], v[132:135], v[76:79]
    s_add_u32 s46, s46, s47
    s_lshl_b32 s46, s46, 15
    s_lshl_b32 s47, s38, 5
    v_mfma_f32_16x16x32_bf16 v[60:63], v[140:143], v[128:131], v[60:63]
    s_add_u32 s46, s46, s47
    s_add_u32 s47, s46, 32768
    v_and_b32 v225, 1, v23
    v_mfma_f32_16x16x32_bf16 v[44:47], v[140:143], v[124:127], v[44:47]
    v_lshlrev_b32 v224, 11, v22
    v_lshl_add_u32 v224, v225, 5, v224
    v_mfma_f32_16x16x32_bf16 v[28:31], v[140:143], v[120:123], v[28:31]
    v_lshrrev_b32 v225, 1, v23
    v_lshl_add_u32 v224, v225, 4, v224
    v_mfma_f32_16x16x32_bf16 v[32:35], v[144:147], v[120:123], v[32:35]
    v_cmp_gt_u32 s[48:49], 8, v22
    v_lshrrev_b32 v225, 3, v22
    v_mfma_f32_16x16x32_bf16 v[48:51], v[144:147], v[124:127], v[48:51]
    v_mul_u32_u24 v225, 16320, v225
    v_sub_u32 v224, v224, v225
    v_mfma_f32_16x16x32_bf16 v[64:67], v[144:147], v[128:131], v[64:67]
    v_add_u32 v225, 16384, v224
    v_mfma_f32_16x16x32_bf16 v[80:83], v[144:147], v[132:135], v[80:83]
    v_mfma_f32_16x16x32_bf16 v[84:87], v[148:151], v[132:135], v[84:87]
    v_mfma_f32_16x16x32_bf16 v[68:71], v[148:151], v[128:131], v[68:71]
    v_mfma_f32_16x16x32_bf16 v[52:55], v[148:151], v[124:127], v[52:55]
    v_mfma_f32_16x16x32_bf16 v[36:39], v[148:151], v[120:123], v[36:39]
    s_cmp_eq_u32 s31, 0
    s_cbranch_scc1 G4_k0
    v_swap_b32 v24, v56
    v_swap_b32 v25, v57
    v_swap_b32 v26, v58
    v_swap_b32 v27, v59
    v_swap_b32 v28, v60
    v_swap_b32 v29, v61
    v_swap_b32 v30, v62
    v_swap_b32 v31, v63
    v_swap_b32 v32, v64
    v_swap_b32 v33, v65
    v_swap_b32 v34, v66
    v_swap_b32 v35, v67
    v_swap_b32 v36, v68
    v_swap_b32 v37, v69
    v_swap_b32 v38, v70
    v_swap_b32 v39, v71
    v_swap_b32 v40, v72
    v_swap_b32 v41, v73
    v_swap_b32 v42, v74
    v_swap_b32 v43, v75
    v_swap_b32 v44, v76
    v_swap_b32 v45, v77
    v_swap_b32 v46, v78
    v_swap_b32 v47, v79
    v_swap_b32 v48, v80
    v_swap_b32 v49, v81
    v_swap_b32 v50, v82
    v_swap_b32 v51, v83
    v_swap_b32 v52, v84
    v_swap_b32 v53, v85
    v_swap_b32 v54, v86
    v_swap_b32 v55, v87
G4_k0:
    s_add_u32 s36, s41, 0
    v_cvt_pk_bf16_f32 v56, v56, v57
    v_cvt_pk_bf16_f32 v57, v58, v59
    v_cvt_pk_bf16_f32 v58, v60, v61
    v_cvt_pk_bf16_f32 v59, v62, v63
    v_or_b32 v56, 1, v56
    buffer_store_dwordx4 v[56:59], v2, s[16:19], s36 offen offset:0 sc1
    v_cvt_pk_bf16_f32 v64, v64, v65
    v_cvt_pk_bf16_f32 v65, v66, v67
    v_cvt_pk_bf16_f32 v66, v68, v69
    v_cvt_pk_bf16_f32 v67, v70, v71
    v_or_b32 v64, 1, v64
    buffer_store_dwordx4 v[64:67], v2, s[16:19], s36 offen offset:1024 sc1
    s_add_u32 s36, s41, 65536
    v_cvt_pk_bf16_f32 v72, v72, v73
    v_cvt_pk_bf16_f32 v73, v74, v75
    v_cvt_pk_bf16_f32 v74, v76, v77
    v_cvt_pk_bf16_f32 v75, v78, v79
    v_or_b32 v72, 1, v72
    buffer_store_dwordx4 v[72:75], v2, s[16:19], s36 offen offset:0 sc1
    v_cvt_pk_bf16_f32 v80, v80, v81
    v_cvt_pk_bf16_f32 v81, v82, v83
    v_cvt_pk_bf16_f32 v82, v84, v85
    v_cvt_pk_bf16_f32 v83, v86, v87
    v_or_b32 v80, 1, v80
    buffer_store_dwordx4 v[80:83], v2, s[16:19], s36 offen offset:1024 sc1
    v_lshlrev_b32 v226, 16, v180
    v_and_b32 v227, 0xffff0000, v180
    v_pk_add_f32 v[24:25], v[24:25], v[226:227]
    v_lshlrev_b32 v228, 16, v181
    v_and_b32 v229, 0xffff0000, v181
    v_pk_add_f32 v[26:27], v[26:27], v[228:229]
    v_lshlrev_b32 v226, 16, v182
    v_and_b32 v227, 0xffff0000, v182
    v_pk_add_f32 v[28:29], v[28:29], v[226:227]
    v_lshlrev_b32 v228, 16, v183
    v_and_b32 v229, 0xffff0000, v183
    v_pk_add_f32 v[30:31], v[30:31], v[228:229]
    v_lshlrev_b32 v226, 16, v188
    v_and_b32 v227, 0xffff0000, v188
    v_pk_add_f32 v[32:33], v[32:33], v[226:227]
    v_lshlrev_b32 v228, 16, v189
    v_and_b32 v229, 0xffff0000, v189
    v_pk_add_f32 v[34:35], v[34:35], v[228:229]
    v_lshlrev_b32 v226, 16, v190
    v_and_b32 v227, 0xffff0000, v190
    v_pk_add_f32 v[36:37], v[36:37], v[226:227]
    v_lshlrev_b32 v228, 16, v191
    v_and_b32 v229, 0xffff0000, v191
    v_pk_add_f32 v[38:39], v[38:39], v[228:229]
    v_lshlrev_b32 v226, 16, v196
    v_and_b32 v227, 0xffff0000, v196
    v_pk_add_f32 v[40:41], v[40:41], v[226:227]
    v_lshlrev_b32 v228, 16, v197
    v_and_b32 v229, 0xffff0000, v197
    v_pk_add_f32 v[42:43], v[42:43], v[228:229]
    v_lshlrev_b32 v226, 16, v198
    v_and_b32 v227, 0xffff0000, v198
    v_pk_add_f32 v[44:45], v[44:45], v[226:227]
    v_lshlrev_b32 v228, 16, v199
    v_and_b32 v229, 0xffff0000, v199
    v_pk_add_f32 v[46:47], v[46:47], v[228:229]
    v_lshlrev_b32 v226, 16, v234
    v_and_b32 v227, 0xffff0000, v234
    v_pk_add_f32 v[48:49], v[48:49], v[226:227]
    v_lshlrev_b32 v228, 16, v235
    v_and_b32 v229, 0xffff0000, v235
    v_pk_add_f32 v[50:51], v[50:51], v[228:229]
    v_lshlrev_b32 v226, 16, v236
    v_and_b32 v227, 0xffff0000, v236
    v_pk_add_f32 v[52:53], v[52:53], v[226:227]
    v_lshlrev_b32 v228, 16, v237
    v_and_b32 v229, 0xffff0000, v237
    v_pk_add_f32 v[54:55], v[54:55], v[228:229]
    v_lshlrev_b32 v226, 16, v184
    v_and_b32 v227, 0xffff0000, v184
    v_pk_add_f32 v[24:25], v[24:25], v[226:227]
    v_lshlrev_b32 v228, 16, v185
    v_and_b32 v229, 0xffff0000, v185
    v_pk_add_f32 v[26:27], v[26:27], v[228:229]
    v_lshlrev_b32 v226, 16, v186
    v_and_b32 v227, 0xffff0000, v186
    v_pk_add_f32 v[28:29], v[28:29], v[226:227]
    v_lshlrev_b32 v228, 16, v187
    v_and_b32 v229, 0xffff0000, v187
    v_pk_add_f32 v[30:31], v[30:31], v[228:229]
    v_lshlrev_b32 v226, 16, v192
    v_and_b32 v227, 0xffff0000, v192
    v_pk_add_f32 v[32:33], v[32:33], v[226:227]
    v_lshlrev_b32 v228, 16, v193
    v_and_b32 v229, 0xffff0000, v193
    v_pk_add_f32 v[34:35], v[34:35], v[228:229]
    v_lshlrev_b32 v226, 16, v194
    v_and_b32 v227, 0xffff0000, v194
    v_pk_add_f32 v[36:37], v[36:37], v[226:227]
    v_lshlrev_b32 v228, 16, v195
    v_and_b32 v229, 0xffff0000, v195
    v_pk_add_f32 v[38:39], v[38:39], v[228:229]
    v_lshlrev_b32 v226, 16, v230
    v_and_b32 v227, 0xffff0000, v230
    v_pk_add_f32 v[40:41], v[40:41], v[226:227]
    v_lshlrev_b32 v228, 16, v231
    v_and_b32 v229, 0xffff0000, v231
    v_pk_add_f32 v[42:43], v[42:43], v[228:229]
    v_lshlrev_b32 v226, 16, v232
    v_and_b32 v227, 0xffff0000, v232
    v_pk_add_f32 v[44:45], v[44:45], v[226:227]
    v_lshlrev_b32 v228, 16, v233
    v_and_b32 v229, 0xffff0000, v233
    v_pk_add_f32 v[46:47], v[46:47], v[228:229]
    v_lshlrev_b32 v226, 16, v248
    v_and_b32 v227, 0xffff0000, v248
    v_pk_add_f32 v[48:49], v[48:49], v[226:227]
    v_lshlrev_b32 v228, 16, v249
    v_and_b32 v229, 0xffff0000, v249
    v_pk_add_f32 v[50:51], v[50:51], v[228:229]
    v_lshlrev_b32 v226, 16, v250
    v_and_b32 v227, 0xffff0000, v250
    v_pk_add_f32 v[52:53], v[52:53], v[226:227]
    v_lshlrev_b32 v228, 16, v251
    v_and_b32 v229, 0xffff0000, v251
    v_pk_add_f32 v[54:55], v[54:55], v[228:229]
    s_mov_b32 s53, 0
dp_26:
    buffer_load_dwordx4 v[208:211], v2, s[16:19], s40 offen offset:0 sc1
    buffer_load_dwordx4 v[212:215], v2, s[16:19], s40 offen offset:1024 sc1
    buffer_load_dwordx4 v[216:219], v2, s[16:19], s44 offen offset:0 sc1
    buffer_load_dwordx4 v[220:223], v2, s[16:19], s44 offen offset:1024 sc1
    s_waitcnt vmcnt(0)
    v_bitop3_b32 v6, v208, v212, v216 bitop3:0x80
    v_bitop3_b32 v6, v6, v220, 1 bitop3:0x80
    v_cmp_eq_u32 vcc, 0, v6
    s_cbranch_vccz dq_27
    s_sleep 2
    s_add_u32 s53, s53, 1
    s_cmp_lt_u32 s53, s61
    s_cbranch_scc1 dp_26
    s_mov_b32 s61, 0
dq_27:
    v_lshlrev_b32 v226, 16, v208
    v_and_b32 v227, 0xffff0000, v208
    v_pk_add_f32 v[24:25], v[24:25], v[226:227]
    v_lshlrev_b32 v228, 16, v209
    v_and_b32 v229, 0xffff0000, v209
    v_pk_add_f32 v[26:27], v[26:27], v[228:229]
    v_lshlrev_b32 v226, 16, v210
    v_and_b32 v227, 0xffff0000, v210
    v_pk_add_f32 v[28:29], v[28:29], v[226:227]
    v_lshlrev_b32 v228, 16, v211
    v_and_b32 v229, 0xffff0000, v211
    v_pk_add_f32 v[30:31], v[30:31], v[228:229]
    v_cvt_pk_bf16_f32 v24, v24, v25
    v_cvt_pk_bf16_f32 v25, v26, v27
    v_cvt_pk_bf16_f32 v26, v28, v29
    v_cvt_pk_bf16_f32 v27, v30, v31
    s_nop 0
    v_permlane16_swap_b32 v24, v26
    v_permlane16_swap_b32 v25, v27
    v_lshlrev_b32 v226, 16, v212
    v_and_b32 v227, 0xffff0000, v212
    v_pk_add_f32 v[32:33], v[32:33], v[226:227]
    v_lshlrev_b32 v228, 16, v213
    v_and_b32 v229, 0xffff0000, v213
    v_pk_add_f32 v[34:35], v[34:35], v[228:229]
    v_lshlrev_b32 v226, 16, v214
    v_and_b32 v227, 0xffff0000, v214
    v_pk_add_f32 v[36:37], v[36:37], v[226:227]
    v_lshlrev_b32 v228, 16, v215
    v_and_b32 v229, 0xffff0000, v215
    v_pk_add_f32 v[38:39], v[38:39], v[228:229]
    v_cvt_pk_bf16_f32 v32, v32, v33
    v_cvt_pk_bf16_f32 v33, v34, v35
    v_cvt_pk_bf16_f32 v34, v36, v37
    v_cvt_pk_bf16_f32 v35, v38, v39
    s_nop 0
    v_permlane16_swap_b32 v32, v34
    v_permlane16_swap_b32 v33, v35
    v_cndmask_b32 v36, v24, v32, s[48:49]
    v_cndmask_b32 v37, v25, v33, s[48:49]
    v_cndmask_b32 v38, v26, v34, s[48:49]
    v_cndmask_b32 v39, v27, v35, s[48:49]
    v_mov_b32_dpp v28, v36 row_ror:8 row_mask:0xf bank_mask:0xf
    v_mov_b32_dpp v29, v37 row_ror:8 row_mask:0xf bank_mask:0xf
    v_mov_b32_dpp v30, v38 row_ror:8 row_mask:0xf bank_mask:0xf
    v_mov_b32_dpp v31, v39 row_ror:8 row_mask:0xf bank_mask:0xf
    v_cndmask_b32 v24, v28, v24, s[48:49]
    v_cndmask_b32 v32, v32, v28, s[48:49]
    v_cndmask_b32 v25, v29, v25, s[48:49]
    v_cndmask_b32 v33, v33, v29, s[48:49]
    v_cndmask_b32 v26, v30, v26, s[48:49]
    v_cndmask_b32 v34, v34, v30, s[48:49]
    v_cndmask_b32 v27, v31, v27, s[48:49]
    v_cndmask_b32 v35, v35, v31, s[48:49]
    buffer_store_dwordx4 v[24:27], v224, s[20:23], s46 offen sc1
    buffer_store_dwordx4 v[32:35], v225, s[20:23], s46 offen sc1
    v_lshlrev_b32 v226, 16, v216
    v_and_b32 v227, 0xffff0000, v216
    v_pk_add_f32 v[40:41], v[40:41], v[226:227]
    v_lshlrev_b32 v228, 16, v217
    v_and_b32 v229, 0xffff0000, v217
    v_pk_add_f32 v[42:43], v[42:43], v[228:229]
    v_lshlrev_b32 v226, 16, v218
    v_and_b32 v227, 0xffff0000, v218
    v_pk_add_f32 v[44:45], v[44:45], v[226:227]
    v_lshlrev_b32 v228, 16, v219
    v_and_b32 v229, 0xffff0000, v219
    v_pk_add_f32 v[46:47], v[46:47], v[228:229]
    v_cvt_pk_bf16_f32 v40, v40, v41
    v_cvt_pk_bf16_f32 v41, v42, v43
    v_cvt_pk_bf16_f32 v42, v44, v45
    v_cvt_pk_bf16_f32 v43, v46, v47
    s_nop 0
    v_permlane16_swap_b32 v40, v42
    v_permlane16_swap_b32 v41, v43
    v_lshlrev_b32 v226, 16, v220
    v_and_b32 v227, 0xffff0000, v220
    v_pk_add_f32 v[48:49], v[48:49], v[226:227]
    v_lshlrev_b32 v228, 16, v221
    v_and_b32 v229, 0xffff0000, v221
    v_pk_add_f32 v[50:51], v[50:51], v[228:229]
    v_lshlrev_b32 v226, 16, v222
    v_and_b32 v227, 0xffff0000, v222
    v_pk_add_f32 v[52:53], v[52:53], v[226:227]
    v_lshlrev_b32 v228, 16, v223
    v_and_b32 v229, 0xffff0000, v223
    v_pk_add_f32 v[54:55], v[54:55], v[228:229]
    v_cvt_pk_bf16_f32 v48, v48, v49
    v_cvt_pk_bf16_f32 v49, v50, v51
    v_cvt_pk_bf16_f32 v50, v52, v53
    v_cvt_pk_bf16_f32 v51, v54, v55
    s_nop 0
    v_permlane16_swap_b32 v48, v50
    v_permlane16_swap_b32 v49, v51
    v_cndmask_b32 v52, v40, v48, s[48:49]
    v_cndmask_b32 v53, v41, v49, s[48:49]
    v_cndmask_b32 v54, v42, v50, s[48:49]
    v_cndmask_b32 v55, v43, v51, s[48:49]
    v_mov_b32_dpp v44, v52 row_ror:8 row_mask:0xf bank_mask:0xf
    v_mov_b32_dpp v45, v53 row_ror:8 row_mask:0xf bank_mask:0xf
    v_mov_b32_dpp v46, v54 row_ror:8 row_mask:0xf bank_mask:0xf
    v_mov_b32_dpp v47, v55 row_ror:8 row_mask:0xf bank_mask:0xf
    v_cndmask_b32 v40, v44, v40, s[48:49]
    v_cndmask_b32 v48, v48, v44, s[48:49]
    v_cndmask_b32 v41, v45, v41, s[48:49]
    v_cndmask_b32 v49, v49, v45, s[48:49]
    v_cndmask_b32 v42, v46, v42, s[48:49]
    v_cndmask_b32 v50, v50, v46, s[48:49]
    v_cndmask_b32 v43, v47, v43, s[48:49]
    v_cndmask_b32 v51, v51, v47, s[48:49]
    buffer_store_dwordx4 v[40:43], v224, s[20:23], s47 offen sc1
    buffer_store_dwordx4 v[48:51], v225, s[20:23], s47 offen sc1
    s_branch K_fin
LOADERS:
    s_cmp_ge_u32 s30, 6
    s_cbranch_scc1 WLOAD
    s_add_u32 s54, s55, 0x500
    v_mov_b32 v222, s54
    s_lshl_b32 s53, s29, 7
    s_add_u32 s53, s53, 23117824
    v_mov_b32 v226, s53
    s_sleep 30
    s_mov_b64 exec, 1
    buffer_load_dword v227, v226, s[56:59], 0 offen sc1
    s_mov_b64 exec, -1
    s_waitcnt vmcnt(0)
    v_readfirstlane_b32 s53, v227
    s_add_u32 s54, s52, 16
    s_cmp_eq_u32 s53, s54
    s_cbranch_scc1 fok_28
    s_mov_b32 s53, 0
    s_add_u32 s54, s52, 16
    s_bfm_b64 exec, 1, 0
poll_29:
    buffer_load_dword v227, v226, s[56:59], 0 offen sc1
    s_waitcnt vmcnt(0)
    v_xor_b32 v227, s54, v227
    v_cmp_eq_u32 vcc, 0, v227
    s_nop 0
    s_cmp_eq_u64 vcc, exec
    s_cbranch_scc1 pok_30
    s_sleep 5
    s_add_u32 s53, s53, 1
    s_cmp_lt_u32 s53, s61
    s_cbranch_scc1 poll_29
    s_mov_b32 s61, 0
pok_30:
    s_mov_b64 exec, -1
fok_28:
    s_add_u32 s24, s4, 0x1400000
    s_addc_u32 s25, s5, 0
    s_mov_b32 s26, 0x20000
    s_mov_b32 s27, 0x20000
    s_cmp_eq_u32 s60, 0
    s_cselect_b32 s26, s26, 0
    s_and_b32 s36, s30, 1
    s_mul_i32 s36, s36, 128
    s_mul_i32 s37, s29, 256
    s_add_u32 s37, s36, s37
    v_lshrrev_b32 v224, 3, v1
    v_mul_u32_u24 v224, 4096, v224
    v_and_b32 v23, 112, v2
    v_add_u32 v224, v224, v23
    buffer_load_dwordx4 v[24:27], v224, s[24:27], s37 offen sc1
    s_add_u32 s37, s37, 32768
    buffer_load_dwordx4 v[28:31], v224, s[24:27], s37 offen sc1
    s_add_u32 s37, s37, 32768
    buffer_load_dwordx4 v[32:35], v224, s[24:27], s37 offen sc1
    s_add_u32 s37, s37, 32768
    buffer_load_dwordx4 v[36:39], v224, s[24:27], s37 offen sc1
    s_add_u32 s37, s37, 32768
    s_mov_b64 exec, 1
    buffer_load_dword v223, v222, s[56:59], 0 offen sc1
    s_mov_b64 exec, -1
    s_waitcnt vmcnt(0)
    v_readfirstlane_b32 s53, v223
    s_add_u32 s54, s52, 16
    s_cmp_eq_u32 s53, s54
    s_cbranch_scc1 fok_31
    s_mov_b32 s53, 0
    s_add_u32 s54, s52, 16
    s_bfm_b64 exec, 1, 0
poll_32:
    buffer_load_dword v223, v222, s[56:59], 0 offen sc1
    s_waitcnt vmcnt(0)
    v_xor_b32 v223, s54, v223
    v_cmp_eq_u32 vcc, 0, v223
    s_nop 0
    s_cmp_eq_u64 vcc, exec
    s_cbranch_scc1 pok_33
    s_sleep 5
    s_add_u32 s53, s53, 1
    s_cmp_lt_u32 s53, s61
    s_cbranch_scc1 poll_32
    s_mov_b32 s61, 0
pok_33:
    s_mov_b64 exec, -1
fok_31:
    s_add_u32 s20, s62, 0x5d0000
    s_addc_u32 s21, s63, 0
    s_mov_b32 s22, 0x800
    s_mov_b32 s23, 0x20000
    s_and_b32 s35, s30, 1
    s_lshl_b32 s35, s35, 10
    buffer_load_dwordx4 v[16:19], v2, s[20:23], s35 offen sc1
    s_cmp_lg_u32 s60, 0
    s_cbranch_scc1 pc_34
    v_add_f32 v24, v24, v28
    v_add_f32 v25, v25, v29
    v_add_f32 v26, v26, v30
    v_add_f32 v27, v27, v31
    v_add_f32 v24, v24, v32
    v_add_f32 v25, v25, v33
    v_add_f32 v26, v26, v34
    v_add_f32 v27, v27, v35
    v_add_f32 v24, v24, v36
    v_add_f32 v25, v25, v37
    v_add_f32 v26, v26, v38
    v_add_f32 v27, v27, v39
    v_add_f32_dpp v24, v24, v24 row_ror:8 row_mask:0xf bank_mask:0xf
    v_add_f32_dpp v25, v25, v25 row_ror:8 row_mask:0xf bank_mask:0xf
    v_add_f32_dpp v26, v26, v26 row_ror:8 row_mask:0xf bank_mask:0xf
    v_add_f32_dpp v27, v27, v27 row_ror:8 row_mask:0xf bank_mask:0xf
    v_mov_b32 v28, v24
    v_mov_b32 v29, v25
    v_mov_b32 v30, v26
    v_mov_b32 v31, v27
    v_permlane16_swap_b32 v24, v28
    v_permlane16_swap_b32 v25, v29
    v_permlane16_swap_b32 v26, v30
    v_permlane16_swap_b32 v27, v31
    v_add_f32 v24, v24, v28
    v_add_f32 v25, v25, v29
    v_add_f32 v26, v26, v30
    v_add_f32 v27, v27, v31
    v_mov_b32 v28, v24
    v_mov_b32 v29, v25
    v_mov_b32 v30, v26
    v_mov_b32 v31, v27
    v_permlane32_swap_b32 v24, v28
    v_permlane32_swap_b32 v25, v29
    v_permlane32_swap_b32 v26, v30
    v_permlane32_swap_b32 v27, v31
    v_add_f32 v24, v24, v28
    v_add_f32 v25, v25, v29
    v_add_f32 v26, v26, v30
    v_add_f32 v27, v27, v31
pc_34:
    s_cmp_lg_u32 s60, 0
    s_cbranch_scc1 pc_35
    s_and_b32 s36, s30, 1
    s_mul_i32 s36, s36, 128
    s_add_u32 s36, s36, 163328
    v_add_u32 v23, s36, v2
    s_bfm_b64 exec, 8, 0
    ds_write_b128 v23, v[24:27]
    s_mov_b64 exec, -1
    s_waitcnt lgkmcnt(0)
pc_35:
    s_waitcnt vmcnt(0)
    s_and_b32 s36, s30, 1
    s_lshl_b32 s36, s36, 10
    s_add_u32 s36, s36, 160768
    v_add_u32 v221, s36, v2
    ds_write_b128 v221, v[16:19]
    s_waitcnt lgkmcnt(0)
    s_cmp_eq_u32 s60, 0
    s_cbranch_scc1 AL_nw
    s_cmp_lg_u32 s30, 4
    s_cbranch_scc1 AL_nw
    s_add_u32 s54, s55, 0xffc00200
    s_add_u32 s53, s54, s92
    v_mov_b32 v9, s53
    s_add_u32 s53, s54, s93
    v_writelane_b32 v9, s53, 1
    s_mov_b32 s53, 0
    s_add_u32 s54, s52, 16
    s_bfm_b64 exec, 2, 0
poll_37:
    buffer_load_dword v8, v9, s[56:59], 0 offen sc1
    s_waitcnt vmcnt(0)
    v_xor_b32 v8, s54, v8
    v_cmp_eq_u32 vcc, 0, v8
    s_nop 0
    s_cmp_eq_u64 vcc, exec
    s_cbranch_scc1 pok_38
    s_sleep 5
    s_add_u32 s53, s53, 1
    s_cmp_lt_u32 s53, s61
    s_cbranch_scc1 poll_37
    s_mov_b32 s61, 0
pok_38:
    s_mov_b64 exec, -1
AL_nw:
    s_barrier
    s_call_b64 s[76:77], SUB_after_g1
    s_cmp_lg_u32 s30, 4
    s_cbranch_scc1 pdone_39
    s_cmp_lg_u32 s60, 0
    s_cbranch_scc1 pdone_39
    s_mul_i32 s54, s60, 2
    s_add_u32 s54, s54, 1
    v_mov_b32 v8, 162872
spin_40:
    s_sleep 8
    ds_read_b32 v9, v8
    s_waitcnt lgkmcnt(0)
    v_readfirstlane_b32 s53, v9
    s_nop 0
    s_cmp_ge_u32 s53, s54
    s_cbranch_scc0 spin_40
    s_add_u32 s54, s55, 0x100
    v_mov_b32 v9, s54
    s_add_u32 s53, s54, 128
    v_writelane_b32 v9, s53, 1
    s_add_u32 s53, s53, s93
    v_writelane_b32 v9, s53, 3
    s_add_u32 s53, s54, s92
    v_writelane_b32 v9, s53, 2
    s_mov_b32 s53, 0
    s_add_u32 s54, s52, 8
    s_bfm_b64 exec, 4, 0
poll_41:
    buffer_load_dword v8, v9, s[56:59], 0 offen sc1
    s_waitcnt vmcnt(0)
    v_xor_b32 v8, s54, v8
    v_cmp_eq_u32 vcc, 0, v8
    s_nop 0
    s_cmp_eq_u64 vcc, exec
    s_cbranch_scc1 pok_42
    s_sleep 5
    s_add_u32 s53, s53, 1
    s_cmp_lt_u32 s53, s61
    s_cbranch_scc1 poll_41
    s_mov_b32 s61, 0
pok_42:
    s_mov_b64 exec, -1
pdone_39:
    s_barrier
    s_waitcnt vmcnt(0)
    s_barrier
    s_call_b64 s[76:77], SUB_after_g2
    s_and_b32 s35, s30, 1
    s_add_u32 s12, s62, 0x80000
    s_addc_u32 s13, s63, 0
    s_mov_b32 s14, 0x7e000
    s_mov_b32 s15, 0x20000
    s_mul_i32 s38, s35, 262144
    s_lshl_b32 s41, s35, 13
    s_mov_b32 s42, 0
    s_mov_b32 s44, 0
    s_add_u32 s54, s55, 0x200
    v_mov_b32 v9, s54
    s_add_u32 s44, s44, 1
    s_and_b32 s44, s44, 15
    s_mov_b32 s42, 16384
    s_add_u32 s54, s55, 0x580
    v_mov_b32 v222, s54
    v_lshlrev_b32 v221, 3, v1
    s_add_u32 s19, s41, s42
    v_readlane_b32 s16, v248, s44
    s_nop 0
    s_add_u32 s16, s16, s38
    s_add_u32 s44, s44, 1
    s_and_b32 s44, s44, 15
    s_add_u32 s42, s42, 16384
    s_cmp_eq_u32 s42, 49152
    s_cselect_b32 s42, 0, s42
    s_mov_b32 m0, s19
    s_mov_b32 s39, s16
    s_waitcnt vmcnt(0)
    s_barrier
    s_sleep 6
    s_mov_b32 s53, 0
    s_add_u32 s54, s52, 16
    s_bfm_b64 exec, 1, 0
poll_43:
    buffer_load_dword v8, v9, s[56:59], 0 offen sc1
    s_waitcnt vmcnt(0)
    v_xor_b32 v8, s54, v8
    v_cmp_eq_u32 vcc, 0, v8
    s_nop 0
    s_cmp_eq_u64 vcc, exec
    s_cbranch_scc1 pok_44
    s_sleep 5
    s_add_u32 s53, s53, 1
    s_cmp_lt_u32 s53, s61
    s_cbranch_scc1 poll_43
    s_mov_b32 s61, 0
pok_44:
    s_mov_b64 exec, -1
    buffer_load_dwordx4 v2, s[12:15], s39 offen sc1 lds
    buffer_load_dwordx4 v2, s[12:15], s39 offen offset:1024 sc1 lds
    s_add_u32 s19, s41, s42
    v_readlane_b32 s16, v248, s44
    s_nop 0
    s_add_u32 s16, s16, s38
    s_add_u32 s44, s44, 1
    s_and_b32 s44, s44, 15
    s_add_u32 s42, s42, 16384
    s_cmp_eq_u32 s42, 49152
    s_cselect_b32 s42, 0, s42
    s_add_u32 m0, m0, 2048
    s_add_u32 s39, s39, 65536
    buffer_load_dwordx4 v2, s[12:15], s39 offen sc1 lds
    buffer_load_dwordx4 v2, s[12:15], s39 offen offset:1024 sc1 lds
    s_add_u32 m0, m0, 2048
    s_add_u32 s39, s39, 65536
    buffer_load_dwordx4 v2, s[12:15], s39 offen sc1 lds
    buffer_load_dwordx4 v2, s[12:15], s39 offen offset:1024 sc1 lds
    s_add_u32 m0, m0, 2048
    s_add_u32 s39, s39, 65536
    buffer_load_dwordx4 v2, s[12:15], s39 offen sc1 lds
    buffer_load_dwordx4 v2, s[12:15], s39 offen offset:1024 sc1 lds
    s_mov_b32 m0, s19
    s_mov_b32 s39, s16
    buffer_load_dwordx4 v2, s[12:15], s39 offen sc1 lds
    buffer_load_dwordx4 v2, s[12:15], s39 offen offset:1024 sc1 lds
    s_add_u32 s19, s41, s42
    v_readlane_b32 s16, v248, s44
    s_nop 0
    s_add_u32 s16, s16, s38
    s_add_u32 s44, s44, 1
    s_and_b32 s44, s44, 15
    s_add_u32 s42, s42, 16384
    s_cmp_eq_u32 s42, 49152
    s_cselect_b32 s42, 0, s42
    s_add_u32 m0, m0, 2048
    s_add_u32 s39, s39, 65536
    buffer_load_dwordx4 v2, s[12:15], s39 offen sc1 lds
    buffer_load_dwordx4 v2, s[12:15], s39 offen offset:1024 sc1 lds
    s_add_u32 m0, m0, 2048
    s_add_u32 s39, s39, 65536
    buffer_load_dwordx4 v2, s[12:15], s39 offen sc1 lds
    buffer_load_dwordx4 v2, s[12:15], s39 offen offset:1024 sc1 lds
    s_add_u32 m0, m0, 2048
    s_add_u32 s39, s39, 65536
    buffer_load_dwordx4 v2, s[12:15], s39 offen sc1 lds
    buffer_load_dwordx4 v2, s[12:15], s39 offen offset:1024 sc1 lds
    s_mov_b32 m0, s19
    s_mov_b32 s39, s16
    s_waitcnt vmcnt(8)
    s_barrier
    buffer_load_dwordx4 v2, s[12:15], s39 offen sc1 lds
    buffer_load_dwordx4 v2, s[12:15], s39 offen offset:1024 sc1 lds
    s_add_u32 s19, s41, s42
    v_readlane_b32 s16, v248, s44
    s_nop 0
    s_add_u32 s16, s16, s38
    s_add_u32 s44, s44, 1
    s_and_b32 s44, s44, 15
    s_add_u32 s42, s42, 16384
    s_cmp_eq_u32 s42, 49152
    s_cselect_b32 s42, 0, s42
    s_add_u32 m0, m0, 2048
    s_add_u32 s39, s39, 65536
    buffer_load_dwordx4 v2, s[12:15], s39 offen sc1 lds
    buffer_load_dwordx4 v2, s[12:15], s39 offen offset:1024 sc1 lds
    s_add_u32 m0, m0, 2048
    s_add_u32 s39, s39, 65536
    buffer_load_dwordx4 v2, s[12:15], s39 offen sc1 lds
    buffer_load_dwordx4 v2, s[12:15], s39 offen offset:1024 sc1 lds
    s_add_u32 m0, m0, 2048
    s_add_u32 s39, s39, 65536
    buffer_load_dwordx4 v2, s[12:15], s39 offen sc1 lds
    buffer_load_dwordx4 v2, s[12:15], s39 offen offset:1024 sc1 lds
    s_mov_b32 m0, s19
    s_mov_b32 s39, s16
    s_add_u32 s24, s4, 0x1420000
    s_addc_u32 s25, s5, 0
    s_mov_b32 s26, 0x70000
    s_mov_b32 s27, 0x20000
    s_cmp_eq_u32 s60, 0
    s_cselect_b32 s26, s26, 0
    s_and_b32 s36, s30, 1
    s_mul_i32 s36, s36, 448
    s_mul_i32 s37, s29, 896
    s_add_u32 s37, s36, s37
    v_lshrrev_b32 v224, 5, v1
    v_mul_u32_u24 v224, 14336, v224
    v_and_b32 v179, 496, v2
    v_add_u32 v224, v224, v179
    buffer_load_dwordx4 v[180:183], v224, s[24:27], s37 offen sc1
    s_add_u32 s37, s37, 28672
    buffer_load_dwordx4 v[184:187], v224, s[24:27], s37 offen sc1
    s_add_u32 s37, s37, 28672
    buffer_load_dwordx4 v[188:191], v224, s[24:27], s37 offen sc1
    s_add_u32 s37, s37, 28672
    buffer_load_dwordx4 v[192:195], v224, s[24:27], s37 offen sc1
    s_add_u32 s37, s37, 28672
    s_waitcnt vmcnt(12)
    s_barrier
    buffer_load_dwordx4 v2, s[12:15], s39 offen sc1 lds
    buffer_load_dwordx4 v2, s[12:15], s39 offen offset:1024 sc1 lds
    s_add_u32 s19, s41, s42
    v_readlane_b32 s16, v248, s44
    s_nop 0
    s_add_u32 s16, s16, s38
    s_add_u32 s44, s44, 1
    s_and_b32 s44, s44, 15
    s_add_u32 s42, s42, 16384
    s_cmp_eq_u32 s42, 49152
    s_cselect_b32 s42, 0, s42
    s_add_u32 m0, m0, 2048
    s_add_u32 s39, s39, 65536
    buffer_load_dwordx4 v2, s[12:15], s39 offen sc1 lds
    buffer_load_dwordx4 v2, s[12:15], s39 offen offset:1024 sc1 lds
    s_add_u32 m0, m0, 2048
    s_add_u32 s39, s39, 65536
    buffer_load_dwordx4 v2, s[12:15], s39 offen sc1 lds
    buffer_load_dwordx4 v2, s[12:15], s39 offen offset:1024 sc1 lds
    s_add_u32 m0, m0, 2048
    s_add_u32 s39, s39, 65536
    buffer_load_dwordx4 v2, s[12:15], s39 offen sc1 lds
    buffer_load_dwordx4 v2, s[12:15], s39 offen offset:1024 sc1 lds
    s_mov_b32 m0, s19
    s_mov_b32 s39, s16
    buffer_load_dwordx4 v[196:199], v224, s[24:27], s37 offen sc1
    s_add_u32 s37, s37, 28672
    buffer_load_dwordx4 v[200:203], v224, s[24:27], s37 offen sc1
    s_add_u32 s37, s37, 28672
    buffer_load_dwordx4 v[204:207], v224, s[24:27], s37 offen sc1
    s_add_u32 s37, s37, 28672
    buffer_load_dwordx4 v[208:211], v224, s[24:27], s37 offen sc1
    s_add_u32 s37, s37, 28672
    buffer_load_dwordx4 v[212:215], v224, s[24:27], s37 offen sc1
    s_add_u32 s37, s37, 28672
    s_waitcnt vmcnt(17)
    s_barrier
    buffer_load_dwordx4 v2, s[12:15], s39 offen sc1 lds
    buffer_load_dwordx4 v2, s[12:15], s39 offen offset:1024 sc1 lds
    s_add_u32 s19, s41, s42
    v_readlane_b32 s16, v248, s44
    s_nop 0
    s_add_u32 s16, s16, s38
    s_add_u32 s44, s44, 1
    s_and_b32 s44, s44, 15
    s_add_u32 s42, s42, 16384
    s_cmp_eq_u32 s42, 49152
    s_cselect_b32 s42, 0, s42
    s_add_u32 m0, m0, 2048
    s_add_u32 s39, s39, 65536
    buffer_load_dwordx4 v2, s[12:15], s39 offen sc1 lds
    buffer_load_dwordx4 v2, s[12:15], s39 offen offset:1024 sc1 lds
    s_add_u32 m0, m0, 2048
    s_add_u32 s39, s39, 65536
    buffer_load_dwordx4 v2, s[12:15], s39 offen sc1 lds
    buffer_load_dwordx4 v2, s[12:15], s39 offen offset:1024 sc1 lds
    s_add_u32 m0, m0, 2048
    s_add_u32 s39, s39, 65536
    buffer_load_dwordx4 v2, s[12:15], s39 offen sc1 lds
    buffer_load_dwordx4 v2, s[12:15], s39 offen offset:1024 sc1 lds
    s_mov_b32 m0, s19
    s_mov_b32 s39, s16
    s_waitcnt vmcnt(13)
    s_barrier
    buffer_load_dwordx4 v2, s[12:15], s39 offen sc1 lds
    buffer_load_dwordx4 v2, s[12:15], s39 offen offset:1024 sc1 lds
    s_add_u32 s19, s41, s42
    v_readlane_b32 s16, v248, s44
    s_nop 0
    s_add_u32 s16, s16, s38
    s_add_u32 s44, s44, 1
    s_and_b32 s44, s44, 15
    s_add_u32 s42, s42, 16384
    s_cmp_eq_u32 s42, 49152
    s_cselect_b32 s42, 0, s42
    s_add_u32 m0, m0, 2048
    s_add_u32 s39, s39, 65536
    buffer_load_dwordx4 v2, s[12:15], s39 offen sc1 lds
    buffer_load_dwordx4 v2, s[12:15], s39 offen offset:1024 sc1 lds
    s_add_u32 m0, m0, 2048
    s_add_u32 s39, s39, 65536
    buffer_load_dwordx4 v2, s[12:15], s39 offen sc1 lds
    buffer_load_dwordx4 v2, s[12:15], s39 offen offset:1024 sc1 lds
    s_add_u32 m0, m0, 2048
    s_add_u32 s39, s39, 65536
    buffer_load_dwordx4 v2, s[12:15], s39 offen sc1 lds
    buffer_load_dwordx4 v2, s[12:15], s39 offen offset:1024 sc1 lds
    s_mov_b32 m0, s19
    s_mov_b32 s39, s16
    s_waitcnt vmcnt(16)
    s_cmp_lg_u32 s60, 0
    s_cbranch_scc1 pc_45
    v_add_f32 v180, v180, v184
    v_add_f32 v181, v181, v185
    v_add_f32 v182, v182, v186
    v_add_f32 v183, v183, v187
    v_add_f32 v180, v180, v188
    v_add_f32 v181, v181, v189
    v_add_f32 v182, v182, v190
    v_add_f32 v183, v183, v191
    v_add_f32 v180, v180, v192
    v_add_f32 v181, v181, v193
    v_add_f32 v182, v182, v194
    v_add_f32 v183, v183, v195
    v_add_f32 v180, v180, v196
    v_add_f32 v181, v181, v197
    v_add_f32 v182, v182, v198
    v_add_f32 v183, v183, v199
pc_45:
    s_mov_b64 exec, 1
    buffer_load_dword v223, v222, s[56:59], 0 offen sc1
    s_mov_b64 exec, -1
    s_waitcnt vmcnt(9)
    s_barrier
    buffer_load_dwordx4 v2, s[12:15], s39 offen sc1 lds
    buffer_load_dwordx4 v2, s[12:15], s39 offen offset:1024 sc1 lds
    s_add_u32 s19, s41, s42
    v_readlane_b32 s16, v248, s44
    s_nop 0
    s_add_u32 s16, s16, s38
    s_add_u32 s44, s44, 1
    s_and_b32 s44, s44, 15
    s_add_u32 s42, s42, 16384
    s_cmp_eq_u32 s42, 49152
    s_cselect_b32 s42, 0, s42
    s_add_u32 m0, m0, 2048
    s_add_u32 s39, s39, 65536
    buffer_load_dwordx4 v2, s[12:15], s39 offen sc1 lds
    buffer_load_dwordx4 v2, s[12:15], s39 offen offset:1024 sc1 lds
    s_add_u32 m0, m0, 2048
    s_add_u32 s39, s39, 65536
    buffer_load_dwordx4 v2, s[12:15], s39 offen sc1 lds
    buffer_load_dwordx4 v2, s[12:15], s39 offen offset:1024 sc1 lds
    s_add_u32 m0, m0, 2048
    s_add_u32 s39, s39, 65536
    buffer_load_dwordx4 v2, s[12:15], s39 offen sc1 lds
    buffer_load_dwordx4 v2, s[12:15], s39 offen offset:1024 sc1 lds
    s_mov_b32 m0, s19
    s_mov_b32 s39, s16
    s_cmp_lg_u32 s60, 0
    s_cbranch_scc1 pc_46
    v_add_f32 v180, v180, v200
    v_add_f32 v181, v181, v201
    v_add_f32 v182, v182, v202
    v_add_f32 v183, v183, v203
    v_add_f32 v180, v180, v204
    v_add_f32 v181, v181, v205
    v_add_f32 v182, v182, v206
    v_add_f32 v183, v183, v207
    v_add_f32 v180, v180, v208
    v_add_f32 v181, v181, v209
    v_add_f32 v182, v182, v210
    v_add_f32 v183, v183, v211
    v_add_f32 v180, v180, v212
    v_add_f32 v181, v181, v213
    v_add_f32 v182, v182, v214
    v_add_f32 v183, v183, v215
pc_46:
    buffer_load_dwordx4 v[184:187], v224, s[24:27], s37 offen sc1
    s_add_u32 s37, s37, 28672
    buffer_load_dwordx4 v[188:191], v224, s[24:27], s37 offen sc1
    s_add_u32 s37, s37, 28672
    buffer_load_dwordx4 v[192:195], v224, s[24:27], s37 offen sc1
    s_add_u32 s37, s37, 28672
    buffer_load_dwordx4 v[196:199], v224, s[24:27], s37 offen sc1
    s_add_u32 s37, s37, 28672
    buffer_load_dwordx4 v[200:203], v224, s[24:27], s37 offen sc1
    s_add_u32 s37, s37, 28672
    buffer_load_dwordx4 v[204:207], v224, s[24:27], s37 offen sc1
    s_add_u32 s37, s37, 28672
    buffer_load_dwordx4 v[208:211], v224, s[24:27], s37 offen sc1
    s_add_u32 s37, s37, 28672
    s_waitcnt vmcnt(16)
    s_barrier
    buffer_load_dwordx4 v2, s[12:15], s39 offen sc1 lds
    buffer_load_dwordx4 v2, s[12:15], s39 offen offset:1024 sc1 lds
    s_add_u32 s19, s41, s42
    v_readlane_b32 s16, v248, s44
    s_nop 0
    s_add_u32 s16, s16, s38
    s_add_u32 s44, s44, 1
    s_and_b32 s44, s44, 15
    s_add_u32 s42, s42, 16384
    s_cmp_eq_u32 s42, 49152
    s_cselect_b32 s42, 0, s42
    s_add_u32 m0, m0, 2048
    s_add_u32 s39, s39, 65536
    buffer_load_dwordx4 v2, s[12:15], s39 offen sc1 lds
    buffer_load_dwordx4 v2, s[12:15], s39 offen offset:1024 sc1 lds
    s_add_u32 m0, m0, 2048
    s_add_u32 s39, s39, 65536
    buffer_load_dwordx4 v2, s[12:15], s39 offen sc1 lds
    buffer_load_dwordx4 v2, s[12:15], s39 offen offset:1024 sc1 lds
    s_add_u32 m0, m0, 2048
    s_add_u32 s39, s39, 65536
    buffer_load_dwordx4 v2, s[12:15], s39 offen sc1 lds
    buffer_load_dwordx4 v2, s[12:15], s39 offen offset:1024 sc1 lds
    s_mov_b32 m0, s19
    s_mov_b32 s39, s16
    s_waitcnt vmcnt(23)
    v_readfirstlane_b32 s53, v223
    s_add_u32 s54, s52, 16
    s_cmp_eq_u32 s53, s54
    s_cbranch_scc1 fok_47
    s_mov_b32 s53, 0
    s_add_u32 s54, s52, 16
    s_bfm_b64 exec, 1, 0
poll_48:
    buffer_load_dword v223, v222, s[56:59], 0 offen sc1
    s_waitcnt vmcnt(0)
    v_xor_b32 v223, s54, v223
    v_cmp_eq_u32 vcc, 0, v223
    s_nop 0
    s_cmp_eq_u64 vcc, exec
    s_cbranch_scc1 pok_49
    s_sleep 5
    s_add_u32 s53, s53, 1
    s_cmp_lt_u32 s53, s61
    s_cbranch_scc1 poll_48
    s_mov_b32 s61, 0
pok_49:
    s_mov_b64 exec, -1
fok_47:
    s_add_u32 s20, s62, 0x5c8000
    s_addc_u32 s21, s63, 0
    s_mov_b32 s22, 0x6000
    s_mov_b32 s23, 0x20000
    s_and_b32 s35, s30, 1
    s_lshl_b32 s35, s35, 9
    s_add_u32 s36, s35, 0
    buffer_load_dwordx2 v[16:17], v221, s[20:23], s36 offen offset:0 sc1
    buffer_load_dwordx2 v[18:19], v221, s[20:23], s36 offen offset:1024 sc1
    buffer_load_dwordx2 v[20:21], v221, s[20:23], s36 offen offset:2048 sc1
    buffer_load_dwordx2 v[22:23], v221, s[20:23], s36 offen offset:3072 sc1
    s_add_u32 s36, s36, 4096
    buffer_load_dwordx2 v[24:25], v221, s[20:23], s36 offen offset:0 sc1
    buffer_load_dwordx2 v[26:27], v221, s[20:23], s36 offen offset:1024 sc1
    buffer_load_dwordx2 v[28:29], v221, s[20:23], s36 offen offset:2048 sc1
    buffer_load_dwordx2 v[30:31], v221, s[20:23], s36 offen offset:3072 sc1
    s_waitcnt vmcnt(23)
    s_barrier
    buffer_load_dwordx4 v2, s[12:15], s39 offen sc1 lds
    buffer_load_dwordx4 v2, s[12:15], s39 offen offset:1024 sc1 lds
    s_add_u32 s19, s41, s42
    v_readlane_b32 s16, v248, s44
    s_nop 0
    s_add_u32 s16, s16, s38
    s_add_u32 s44, s44, 1
    s_and_b32 s44, s44, 15
    s_add_u32 s42, s42, 16384
    s_cmp_eq_u32 s42, 49152
    s_cselect_b32 s42, 0, s42
    s_add_u32 m0, m0, 2048
    s_add_u32 s39, s39, 65536
    buffer_load_dwordx4 v2, s[12:15], s39 offen sc1 lds
    buffer_load_dwordx4 v2, s[12:15], s39 offen offset:1024 sc1 lds
    s_add_u32 m0, m0, 2048
    s_add_u32 s39, s39, 65536
    buffer_load_dwordx4 v2, s[12:15], s39 offen sc1 lds
    buffer_load_dwordx4 v2, s[12:15], s39 offen offset:1024 sc1 lds
    s_add_u32 m0, m0, 2048
    s_add_u32 s39, s39, 65536
    buffer_load_dwordx4 v2, s[12:15], s39 offen sc1 lds
    buffer_load_dwordx4 v2, s[12:15], s39 offen offset:1024 sc1 lds
    s_mov_b32 m0, s19
    s_mov_b32 s39, s16
    s_add_u32 s36, s35, 16384
    buffer_load_dwordx2 v[32:33], v221, s[20:23], s36 offen offset:0 sc1
    buffer_load_dwordx2 v[34:35], v221, s[20:23], s36 offen offset:1024 sc1
    buffer_load_dwordx2 v[36:37], v221, s[20:23], s36 offen offset:2048 sc1
    buffer_load_dwordx2 v[38:39], v221, s[20:23], s36 offen offset:3072 sc1
    s_add_u32 s36, s36, 4096
    buffer_load_dwordx2 v[40:41], v221, s[20:23], s36 offen offset:0 sc1
    buffer_load_dwordx2 v[42:43], v221, s[20:23], s36 offen offset:1024 sc1
    buffer_load_dwordx2 v[44:45], v221, s[20:23], s36 offen offset:2048 sc1
    buffer_load_dwordx2 v[46:47], v221, s[20:23], s36 offen offset:3072 sc1
    s_waitcnt vmcnt(24)
    s_barrier
    buffer_load_dwordx4 v2, s[12:15], s39 offen sc1 lds
    buffer_load_dwordx4 v2, s[12:15], s39 offen offset:1024 sc1 lds
    s_add_u32 s19, s41, s42
    v_readlane_b32 s16, v248, s44
    s_nop 0
    s_add_u32 s16, s16, s38
    s_add_u32 s44, s44, 1
    s_and_b32 s44, s44, 15
    s_add_u32 s42, s42, 16384
    s_cmp_eq_u32 s42, 49152
    s_cselect_b32 s42, 0, s42
    s_add_u32 m0, m0, 2048
    s_add_u32 s39, s39, 65536
    buffer_load_dwordx4 v2, s[12:15], s39 offen sc1 lds
    buffer_load_dwordx4 v2, s[12:15], s39 offen offset:1024 sc1 lds
    s_add_u32 m0, m0, 2048
    s_add_u32 s39, s39, 65536
    buffer_load_dwordx4 v2, s[12:15], s39 offen sc1 lds
    buffer_load_dwordx4 v2, s[12:15], s39 offen offset:1024 sc1 lds
    s_add_u32 m0, m0, 2048
    s_add_u32 s39, s39, 65536
    buffer_load_dwordx4 v2, s[12:15], s39 offen sc1 lds
    buffer_load_dwordx4 v2, s[12:15], s39 offen offset:1024 sc1 lds
    s_mov_b32 m0, s19
    s_mov_b32 s39, s16
    s_waitcnt vmcnt(40)
    s_cmp_lg_u32 s60, 0
    s_cbranch_scc1 pc_50
    v_add_f32 v180, v180, v184
    v_add_f32 v181, v181, v185
    v_add_f32 v182, v182, v186
    v_add_f32 v183, v183, v187
    v_add_f32 v180, v180, v188
    v_add_f32 v181, v181, v189
    v_add_f32 v182, v182, v190
    v_add_f32 v183, v183, v191
    v_add_f32 v180, v180, v192
    v_add_f32 v181, v181, v193
    v_add_f32 v182, v182, v194
    v_add_f32 v183, v183, v195
    v_add_f32 v180, v180, v196
    v_add_f32 v181, v181, v197
    v_add_f32 v182, v182, v198
    v_add_f32 v183, v183, v199
pc_50:
    s_waitcnt vmcnt(16)
    s_barrier
    buffer_load_dwordx4 v2, s[12:15], s39 offen sc1 lds
    buffer_load_dwordx4 v2, s[12:15], s39 offen offset:1024 sc1 lds
    s_add_u32 s19, s41, s42
    v_readlane_b32 s16, v248, s44
    s_nop 0
    s_add_u32 s16, s16, s38
    s_add_u32 s44, s44, 1
    s_and_b32 s44, s44, 15
    s_add_u32 s42, s42, 16384
    s_cmp_eq_u32 s42, 49152
    s_cselect_b32 s42, 0, s42
    s_add_u32 m0, m0, 2048
    s_add_u32 s39, s39, 65536
    buffer_load_dwordx4 v2, s[12:15], s39 offen sc1 lds
    buffer_load_dwordx4 v2, s[12:15], s39 offen offset:1024 sc1 lds
    s_add_u32 m0, m0, 2048
    s_add_u32 s39, s39, 65536
    buffer_load_dwordx4 v2, s[12:15], s39 offen sc1 lds
    buffer_load_dwordx4 v2, s[12:15], s39 offen offset:1024 sc1 lds
    s_add_u32 m0, m0, 2048
    s_add_u32 s39, s39, 65536
    buffer_load_dwordx4 v2, s[12:15], s39 offen sc1 lds
    buffer_load_dwordx4 v2, s[12:15], s39 offen offset:1024 sc1 lds
    s_mov_b32 m0, s19
    s_mov_b32 s39, s16
    s_cmp_lg_u32 s60, 0
    s_cbranch_scc1 pc_51
    v_add_f32 v180, v180, v200
    v_add_f32 v181, v181, v201
    v_add_f32 v182, v182, v202
    v_add_f32 v183, v183, v203
    v_add_f32 v180, v180, v204
    v_add_f32 v181, v181, v205
    v_add_f32 v182, v182, v206
    v_add_f32 v183, v183, v207
    v_add_f32 v180, v180, v208
    v_add_f32 v181, v181, v209
    v_add_f32 v182, v182, v210
    v_add_f32 v183, v183, v211
pc_51:
    s_waitcnt vmcnt(8)
    s_barrier
    buffer_load_dwordx4 v2, s[12:15], s39 offen sc1 lds
    buffer_load_dwordx4 v2, s[12:15], s39 offen offset:1024 sc1 lds
    s_add_u32 s19, s41, s42
    v_readlane_b32 s16, v248, s44
    s_nop 0
    s_add_u32 s16, s16, s38
    s_add_u32 s44, s44, 1
    s_and_b32 s44, s44, 15
    s_add_u32 s42, s42, 16384
    s_cmp_eq_u32 s42, 49152
    s_cselect_b32 s42, 0, s42
    s_add_u32 m0, m0, 2048
    s_add_u32 s39, s39, 65536
    buffer_load_dwordx4 v2, s[12:15], s39 offen sc1 lds
    buffer_load_dwordx4 v2, s[12:15], s39 offen offset:1024 sc1 lds
    s_add_u32 m0, m0, 2048
    s_add_u32 s39, s39, 65536
    buffer_load_dwordx4 v2, s[12:15], s39 offen sc1 lds
    buffer_load_dwordx4 v2, s[12:15], s39 offen offset:1024 sc1 lds
    s_add_u32 m0, m0, 2048
    s_add_u32 s39, s39, 65536
    buffer_load_dwordx4 v2, s[12:15], s39 offen sc1 lds
    buffer_load_dwordx4 v2, s[12:15], s39 offen offset:1024 sc1 lds
    s_mov_b32 m0, s19
    s_mov_b32 s39, s16
    s_cmp_lg_u32 s60, 0
    s_cbranch_scc1 pc_52
    v_mov_b32 v184, v180
    v_mov_b32 v185, v181
    v_mov_b32 v186, v182
    v_mov_b32 v187, v183
    v_permlane32_swap_b32 v180, v184
    v_permlane32_swap_b32 v181, v185
    v_permlane32_swap_b32 v182, v186
    v_permlane32_swap_b32 v183, v187
    v_add_f32 v180, v180, v184
    v_add_f32 v181, v181, v185
    v_add_f32 v182, v182, v186
    v_add_f32 v183, v183, v187
    s_and_b32 s36, s30, 1
    s_mul_i32 s36, s36, 448
    s_add_u32 s36, s36, 159744
    v_add_u32 v179, s36, v2
    s_bfm_b64 exec, 28, 0
    ds_write_b128 v179, v[180:183]
    s_mov_b64 exec, -1
    s_waitcnt lgkmcnt(0)
pc_52:
    s_waitcnt vmcnt(8)
    s_barrier
    buffer_load_dwordx4 v2, s[12:15], s39 offen sc1 lds
    buffer_load_dwordx4 v2, s[12:15], s39 offen offset:1024 sc1 lds
    s_add_u32 s19, s41, s42
    v_readlane_b32 s16, v248, s44
    s_nop 0
    s_add_u32 s16, s16, s38
    s_add_u32 s44, s44, 1
    s_and_b32 s44, s44, 15
    s_add_u32 s42, s42, 16384
    s_cmp_eq_u32 s42, 49152
    s_cselect_b32 s42, 0, s42
    s_add_u32 m0, m0, 2048
    s_add_u32 s39, s39, 65536
    buffer_load_dwordx4 v2, s[12:15], s39 offen sc1 lds
    buffer_load_dwordx4 v2, s[12:15], s39 offen offset:1024 sc1 lds
    s_add_u32 m0, m0, 2048
    s_add_u32 s39, s39, 65536
    buffer_load_dwordx4 v2, s[12:15], s39 offen sc1 lds
    buffer_load_dwordx4 v2, s[12:15], s39 offen offset:1024 sc1 lds
    s_add_u32 m0, m0, 2048
    s_add_u32 s39, s39, 65536
    buffer_load_dwordx4 v2, s[12:15], s39 offen sc1 lds
    buffer_load_dwordx4 v2, s[12:15], s39 offen offset:1024 sc1 lds
    s_mov_b32 m0, s19
    s_mov_b32 s39, s16
    s_waitcnt vmcnt(32)
    v_add_f32 v16, v16, v32
    v_add_f32 v17, v17, v33
    v_add_f32 v18, v18, v34
    v_add_f32 v19, v19, v35
    v_add_f32 v20, v20, v36
    v_add_f32 v21, v21, v37
    v_add_f32 v22, v22, v38
    v_add_f32 v23, v23, v39
    v_add_f32 v24, v24, v40
    v_add_f32 v25, v25, v41
    v_add_f32 v26, v26, v42
    v_add_f32 v27, v27, v43
    v_add_f32 v28, v28, v44
    v_add_f32 v29, v29, v45
    v_add_f32 v30, v30, v46
    v_add_f32 v31, v31, v47
    s_waitcnt vmcnt(8)
    s_barrier
    buffer_load_dwordx4 v2, s[12:15], s39 offen sc1 lds
    buffer_load_dwordx4 v2, s[12:15], s39 offen offset:1024 sc1 lds
    s_add_u32 s19, s41, s42
    v_readlane_b32 s16, v248, s44
    s_nop 0
    s_add_u32 s16, s16, s38
    s_add_u32 s44, s44, 1
    s_and_b32 s44, s44, 15
    s_add_u32 s42, s42, 16384
    s_cmp_eq_u32 s42, 49152
    s_cselect_b32 s42, 0, s42
    s_add_u32 m0, m0, 2048
    s_add_u32 s39, s39, 65536
    buffer_load_dwordx4 v2, s[12:15], s39 offen sc1 lds
    buffer_load_dwordx4 v2, s[12:15], s39 offen offset:1024 sc1 lds
    s_add_u32 m0, m0, 2048
    s_add_u32 s39, s39, 65536
    buffer_load_dwordx4 v2, s[12:15], s39 offen sc1 lds
    buffer_load_dwordx4 v2, s[12:15], s39 offen offset:1024 sc1 lds
    s_add_u32 m0, m0, 2048
    s_add_u32 s39, s39, 65536
    buffer_load_dwordx4 v2, s[12:15], s39 offen sc1 lds
    buffer_load_dwordx4 v2, s[12:15], s39 offen offset:1024 sc1 lds
    s_mov_b32 m0, s19
    s_mov_b32 s39, s16
    v_add_f32 v16, v16, v24
    v_add_f32 v17, v17, v25
    v_add_f32 v18, v18, v26
    v_add_f32 v19, v19, v27
    v_add_f32 v20, v20, v28
    v_add_f32 v21, v21, v29
    v_add_f32 v22, v22, v30
    v_add_f32 v23, v23, v31
    v_add_f32 v16, v16, v20
    v_add_f32 v17, v17, v21
    v_add_f32 v18, v18, v22
    v_add_f32 v19, v19, v23
    v_add_f32 v16, v16, v18
    v_add_f32 v17, v17, v19
    v_mul_f32 v20, 0x3a800000, v16
    v_mul_f32 v217, 0x3a800000, v17
    s_waitcnt vmcnt(8)
    s_barrier
    buffer_load_dwordx4 v2, s[12:15], s39 offen sc1 lds
    buffer_load_dwordx4 v2, s[12:15], s39 offen offset:1024 sc1 lds
    s_add_u32 m0, m0, 2048
    s_add_u32 s39, s39, 65536
    buffer_load_dwordx4 v2, s[12:15], s39 offen sc1 lds
    buffer_load_dwordx4 v2, s[12:15], s39 offen offset:1024 sc1 lds
    s_add_u32 m0, m0, 2048
    s_add_u32 s39, s39, 65536
    buffer_load_dwordx4 v2, s[12:15], s39 offen sc1 lds
    buffer_load_dwordx4 v2, s[12:15], s39 offen offset:1024 sc1 lds
    s_add_u32 m0, m0, 2048
    s_add_u32 s39, s39, 65536
    buffer_load_dwordx4 v2, s[12:15], s39 offen sc1 lds
    buffer_load_dwordx4 v2, s[12:15], s39 offen offset:1024 sc1 lds
    v_fma_f32 v217, -v20, v20, v217
    v_max_f32 v217, 0, v217
    v_add_f32 v217, 0x3727c5ac, v217
    v_sqrt_f32 v217, v217
    s_nop 0
    v_mov_b32 v21, v217
    v_rcp_f32 v219, v217
    s_nop 0
    v_mul_f32 v22, 0xc0135761, v219
    v_mul_f32 v23, v219, v219
    v_mul_f32 v23, v23, v22
    v_mul_f32 v23, 0x3d372713, v23
    s_lshl_b32 s35, s35, 1
    s_add_u32 s35, s35, 160768
    v_add_u32 v220, s35, v2
    ds_write_b128 v220, v[20:23]
    s_waitcnt lgkmcnt(0)
    s_waitcnt vmcnt(8)
    s_barrier
    s_call_b64 s[76:77], SUB_r_pre0
    s_waitcnt vmcnt(8)
    s_barrier
    s_cmp_lg_u32 s60, 0
    s_cbranch_scc1 tw4_56
    s_load_dwordx2 s[48:49], s[0:1], 80
    s_lshl_b32 s45, s2, 1
    s_and_b32 s50, s30, 1
    s_add_u32 s45, s45, s50
    s_mul_i32 s45, s45, 14336
    s_mov_b32 s50, 7340032
    s_mov_b32 s51, 0x20000
    s_waitcnt lgkmcnt(0)
    buffer_load_dwordx4 v[20:23], v2, s[48:51], s45 offen offset:0
    buffer_load_dwordx4 v[20:23], v2, s[48:51], s45 offen offset:1024
    buffer_load_dwordx4 v[20:23], v2, s[48:51], s45 offen offset:2048
    buffer_load_dwordx4 v[20:23], v2, s[48:51], s45 offen offset:3072
    s_add_u32 s45, s45, 4096
    buffer_load_dwordx4 v[20:23], v2, s[48:51], s45 offen offset:0
    buffer_load_dwordx4 v[20:23], v2, s[48:51], s45 offen offset:1024
    buffer_load_dwordx4 v[20:23], v2, s[48:51], s45 offen offset:2048
    buffer_load_dwordx4 v[20:23], v2, s[48:51], s45 offen offset:3072
    s_add_u32 s45, s45, 4096
    buffer_load_dwordx4 v[20:23], v2, s[48:51], s45 offen offset:0
    buffer_load_dwordx4 v[20:23], v2, s[48:51], s45 offen offset:1024
    buffer_load_dwordx4 v[20:23], v2, s[48:51], s45 offen offset:2048
    buffer_load_dwordx4 v[20:23], v2, s[48:51], s45 offen offset:3072
    s_add_u32 s45, s45, 4096
    buffer_load_dwordx4 v[20:23], v2, s[48:51], s45 offen offset:0
    buffer_load_dwordx4 v[20:23], v2, s[48:51], s45 offen offset:1024
tw4_56:
    s_barrier
    s_and_b32 s35, s30, 1
    s_add_u32 s12, s62, 0x400000
    s_addc_u32 s13, s63, 0
    s_mov_b32 s14, 0x1be000
    s_mov_b32 s15, 0x20000
    s_mul_i32 s38, s35, 917504
    s_mul_i32 s36, s31, 114688
    s_add_u32 s38, s38, s36
    s_lshl_b32 s41, s35, 13
    s_mov_b32 s42, 0
    s_mov_b32 s44, 0
    s_add_u32 s54, s55, 0x700
    s_lshl_b32 s53, s31, 7
    s_add_u32 s54, s54, s53
    v_mov_b32 v9, s54
    s_add_u32 s54, s55, 0x600
    s_lshl_b32 s53, s31, 7
    s_add_u32 s54, s54, s53
    v_mov_b32 v10, s54
    s_add_u32 s54, s55, 0x300
    s_lshl_b32 s53, s31, 7
    s_add_u32 s54, s54, s53
    v_mov_b32 v12, s54
    v_mov_b32 v13, 1
    s_and_b32 s51, s30, 1
    s_lshl_b32 s51, s51, 30
    s_lshl_b32 s54, s60, 2
    s_add_u32 s54, s54, 4
    v_mov_b32 v14, 162880
spin_57:
    s_sleep 2
    ds_read_b32 v15, v14
    s_waitcnt lgkmcnt(0)
    v_readfirstlane_b32 s53, v15
    s_nop 0
    s_cmp_ge_u32 s53, s54
    s_cbranch_scc0 spin_57
    s_mov_b64 exec, 1
    buffer_atomic_add v13, v9, s[56:59], s51 offen sc1
    s_mov_b64 exec, -1
    v_xor_b32 v15, 128, v12
    s_mov_b32 s44, 3
    s_call_b64 s[76:77], PREP_a_issue_4
    s_mov_b32 m0, s19
    s_mov_b32 s39, s16
    s_mov_b32 s40, s17
    s_waitcnt vmcnt(16)
    s_barrier
    s_mov_b64 exec, 1
    buffer_load_dword v8, v9, s[56:59], 0 offen sc1
    s_mov_b64 exec, -1
    s_waitcnt vmcnt(9)
    s_barrier
    s_waitcnt vmcnt(0)
    v_readfirstlane_b32 s53, v8
    s_add_u32 s54, s52, 8
    s_cmp_eq_u32 s53, s54
    s_cbranch_scc1 fok_58
    s_mov_b32 s53, 0
    s_add_u32 s54, s52, 8
    s_bfm_b64 exec, 1, 0
poll_59:
    buffer_load_dword v8, v9, s[56:59], 0 offen sc1
    s_waitcnt vmcnt(0)
    v_xor_b32 v8, s54, v8
    v_cmp_eq_u32 vcc, 0, v8
    s_nop 0
    s_cmp_eq_u64 vcc, exec
    s_cbranch_scc1 pok_60
    s_sleep 5
    s_add_u32 s53, s53, 1
    s_cmp_lt_u32 s53, s61
    s_cbranch_scc1 poll_59
    s_mov_b32 s61, 0
pok_60:
    s_mov_b64 exec, -1
fok_58:
    buffer_load_dwordx4 v2, s[12:15], s39 offen sc1 lds
    s_add_u32 m0, m0, 1024
    s_nop 0
    buffer_load_dwordx4 v2, s[12:15], s40 offen sc1 lds
    s_call_b64 s[76:77], PREP_a_issue_4
    s_add_u32 m0, m0, 1024
    s_add_u32 s39, s39, 229376
    buffer_load_dwordx4 v2, s[12:15], s39 offen sc1 lds
    s_add_u32 m0, m0, 1024
    s_add_u32 s40, s40, 229376
    buffer_load_dwordx4 v2, s[12:15], s40 offen sc1 lds
    s_add_u32 m0, m0, 1024
    s_add_u32 s39, s39, 229376
    buffer_load_dwordx4 v2, s[12:15], s39 offen sc1 lds
    s_add_u32 m0, m0, 1024
    s_add_u32 s40, s40, 229376
    buffer_load_dwordx4 v2, s[12:15], s40 offen sc1 lds
    s_add_u32 m0, m0, 1024
    s_add_u32 s39, s39, 229376
    buffer_load_dwordx4 v2, s[12:15], s39 offen sc1 lds
    s_add_u32 m0, m0, 1024
    s_add_u32 s40, s40, 229376
    buffer_load_dwordx4 v2, s[12:15], s40 offen sc1 lds
    s_mov_b32 m0, s19
    s_mov_b32 s39, s16
    s_mov_b32 s40, s17
    s_waitcnt vmcnt(9)
    s_barrier
    s_mov_b64 exec, 1
    buffer_atomic_add v13, v10, s[56:59], s51 offen sc1
    s_mov_b64 exec, -1
    buffer_load_dwordx4 v2, s[12:15], s39 offen sc1 lds
    s_add_u32 m0, m0, 1024
    s_nop 0
    buffer_load_dwordx4 v2, s[12:15], s40 offen sc1 lds
    s_call_b64 s[76:77], PREP_a_issue_4
    s_add_u32 m0, m0, 1024
    s_add_u32 s39, s39, 229376
    buffer_load_dwordx4 v2, s[12:15], s39 offen sc1 lds
    s_add_u32 m0, m0, 1024
    s_add_u32 s40, s40, 229376
    buffer_load_dwordx4 v2, s[12:15], s40 offen sc1 lds
    s_add_u32 m0, m0, 1024
    s_add_u32 s39, s39, 229376
    buffer_load_dwordx4 v2, s[12:15], s39 offen sc1 lds
    s_add_u32 m0, m0, 1024
    s_add_u32 s40, s40, 229376
    buffer_load_dwordx4 v2, s[12:15], s40 offen sc1 lds
    s_add_u32 m0, m0, 1024
    s_add_u32 s39, s39, 229376
    buffer_load_dwordx4 v2, s[12:15], s39 offen sc1 lds
    s_add_u32 m0, m0, 1024
    s_add_u32 s40, s40, 229376
    buffer_load_dwordx4 v2, s[12:15], s40 offen sc1 lds
    s_mov_b32 m0, s19
    s_mov_b32 s39, s16
    s_mov_b32 s40, s17
    s_waitcnt vmcnt(9)
    s_barrier
    buffer_load_dwordx4 v2, s[12:15], s39 offen sc1 lds
    s_add_u32 m0, m0, 1024
    s_nop 0
    buffer_load_dwordx4 v2, s[12:15], s40 offen sc1 lds
    s_call_b64 s[76:77], PREP_a_issue_4
    s_add_u32 m0, m0, 1024
    s_add_u32 s39, s39, 229376
    buffer_load_dwordx4 v2, s[12:15], s39 offen sc1 lds
    s_add_u32 m0, m0, 1024
    s_add_u32 s40, s40, 229376
    buffer_load_dwordx4 v2, s[12:15], s40 offen sc1 lds
    s_add_u32 m0, m0, 1024
    s_add_u32 s39, s39, 229376
    buffer_load_dwordx4 v2, s[12:15], s39 offen sc1 lds
    s_add_u32 m0, m0, 1024
    s_add_u32 s40, s40, 229376
    buffer_load_dwordx4 v2, s[12:15], s40 offen sc1 lds
    s_add_u32 m0, m0, 1024
    s_add_u32 s39, s39, 229376
    buffer_load_dwordx4 v2, s[12:15], s39 offen sc1 lds
    s_add_u32 m0, m0, 1024
    s_add_u32 s40, s40, 229376
    buffer_load_dwordx4 v2, s[12:15], s40 offen sc1 lds
    s_mov_b32 m0, s19
    s_mov_b32 s39, s16
    s_mov_b32 s40, s17
    s_waitcnt vmcnt(8)
    s_barrier
    buffer_load_dwordx4 v2, s[12:15], s39 offen sc1 lds
    s_add_u32 m0, m0, 1024
    s_nop 0
    buffer_load_dwordx4 v2, s[12:15], s40 offen sc1 lds
    s_call_b64 s[76:77], PREP_a_issue_4
    s_add_u32 m0, m0, 1024
    s_add_u32 s39, s39, 229376
    buffer_load_dwordx4 v2, s[12:15], s39 offen sc1 lds
    s_add_u32 m0, m0, 1024
    s_add_u32 s40, s40, 229376
    buffer_load_dwordx4 v2, s[12:15], s40 offen sc1 lds
    s_add_u32 m0, m0, 1024
    s_add_u32 s39, s39, 229376
    buffer_load_dwordx4 v2, s[12:15], s39 offen sc1 lds
    s_add_u32 m0, m0, 1024
    s_add_u32 s40, s40, 229376
    buffer_load_dwordx4 v2, s[12:15], s40 offen sc1 lds
    s_add_u32 m0, m0, 1024
    s_add_u32 s39, s39, 229376
    buffer_load_dwordx4 v2, s[12:15], s39 offen sc1 lds
    s_add_u32 m0, m0, 1024
    s_add_u32 s40, s40, 229376
    buffer_load_dwordx4 v2, s[12:15], s40 offen sc1 lds
    s_mov_b32 m0, s19
    s_mov_b32 s39, s16
    s_mov_b32 s40, s17
    s_waitcnt vmcnt(8)
    s_barrier
    s_mov_b64 exec, 1
    buffer_atomic_add v13, v12, s[56:59], s51 offen sc1
    s_mov_b64 exec, -1
    buffer_load_dwordx4 v2, s[12:15], s39 offen sc1 lds
    s_add_u32 m0, m0, 1024
    s_nop 0
    buffer_load_dwordx4 v2, s[12:15], s40 offen sc1 lds
    s_mov_b64 exec, 1
    buffer_load_dword v11, v10, s[56:59], 0 offen sc1
    s_mov_b64 exec, -1
    s_call_b64 s[76:77], PREP_a_issue_4
    s_add_u32 m0, m0, 1024
    s_add_u32 s39, s39, 229376
    buffer_load_dwordx4 v2, s[12:15], s39 offen sc1 lds
    s_add_u32 m0, m0, 1024
    s_add_u32 s40, s40, 229376
    buffer_load_dwordx4 v2, s[12:15], s40 offen sc1 lds
    s_add_u32 m0, m0, 1024
    s_add_u32 s39, s39, 229376
    buffer_load_dwordx4 v2, s[12:15], s39 offen sc1 lds
    s_add_u32 m0, m0, 1024
    s_add_u32 s40, s40, 229376
    buffer_load_dwordx4 v2, s[12:15], s40 offen sc1 lds
    s_add_u32 m0, m0, 1024
    s_add_u32 s39, s39, 229376
    buffer_load_dwordx4 v2, s[12:15], s39 offen sc1 lds
    s_add_u32 m0, m0, 1024
    s_add_u32 s40, s40, 229376
    buffer_load_dwordx4 v2, s[12:15], s40 offen sc1 lds
    s_mov_b32 m0, s19
    s_mov_b32 s39, s16
    s_mov_b32 s40, s17
    s_waitcnt vmcnt(10)
    s_barrier
    buffer_load_dwordx4 v2, s[12:15], s39 offen sc1 lds
    s_add_u32 m0, m0, 1024
    s_nop 0
    buffer_load_dwordx4 v2, s[12:15], s40 offen sc1 lds
    s_call_b64 s[76:77], PREP_a_issue_4
    s_add_u32 m0, m0, 1024
    s_add_u32 s39, s39, 229376
    buffer_load_dwordx4 v2, s[12:15], s39 offen sc1 lds
    s_add_u32 m0, m0, 1024
    s_add_u32 s40, s40, 229376
    buffer_load_dwordx4 v2, s[12:15], s40 offen sc1 lds
    s_add_u32 m0, m0, 1024
    s_add_u32 s39, s39, 229376
    buffer_load_dwordx4 v2, s[12:15], s39 offen sc1 lds
    s_add_u32 m0, m0, 1024
    s_add_u32 s40, s40, 229376
    buffer_load_dwordx4 v2, s[12:15], s40 offen sc1 lds
    s_add_u32 m0, m0, 1024
    s_add_u32 s39, s39, 229376
    buffer_load_dwordx4 v2, s[12:15], s39 offen sc1 lds
    s_add_u32 m0, m0, 1024
    s_add_u32 s40, s40, 229376
    buffer_load_dwordx4 v2, s[12:15], s40 offen sc1 lds
    s_mov_b32 m0, s19
    s_mov_b32 s39, s16
    s_mov_b32 s40, s17
    s_waitcnt vmcnt(8)
    s_barrier
    buffer_load_dwordx4 v2, s[12:15], s39 offen sc1 lds
    s_add_u32 m0, m0, 1024
    s_nop 0
    buffer_load_dwordx4 v2, s[12:15], s40 offen sc1 lds
    s_waitcnt vmcnt(16)
    v_readfirstlane_b32 s53, v11
    s_add_u32 s54, s52, 8
    s_cmp_eq_u32 s53, s54
    s_cbranch_scc1 fok_61
    s_mov_b32 s53, 0
    s_add_u32 s54, s52, 8
    s_bfm_b64 exec, 1, 0
poll_62:
    buffer_load_dword v11, v10, s[56:59], 0 offen sc1
    s_waitcnt vmcnt(0)
    v_xor_b32 v11, s54, v11
    v_cmp_eq_u32 vcc, 0, v11
    s_nop 0
    s_cmp_eq_u64 vcc, exec
    s_cbranch_scc1 pok_63
    s_sleep 5
    s_add_u32 s53, s53, 1
    s_cmp_lt_u32 s53, s61
    s_cbranch_scc1 poll_62
    s_mov_b32 s61, 0
pok_63:
    s_mov_b64 exec, -1
fok_61:
    s_call_b64 s[76:77], PREP_a_issue_4
    s_add_u32 m0, m0, 1024
    s_add_u32 s39, s39, 229376
    buffer_load_dwordx4 v2, s[12:15], s39 offen sc1 lds
    s_add_u32 m0, m0, 1024
    s_add_u32 s40, s40, 229376
    buffer_load_dwordx4 v2, s[12:15], s40 offen sc1 lds
    s_add_u32 m0, m0, 1024
    s_add_u32 s39, s39, 229376
    buffer_load_dwordx4 v2, s[12:15], s39 offen sc1 lds
    s_add_u32 m0, m0, 1024
    s_add_u32 s40, s40, 229376
    buffer_load_dwordx4 v2, s[12:15], s40 offen sc1 lds
    s_add_u32 m0, m0, 1024
    s_add_u32 s39, s39, 229376
    buffer_load_dwordx4 v2, s[12:15], s39 offen sc1 lds
    s_add_u32 m0, m0, 1024
    s_add_u32 s40, s40, 229376
    buffer_load_dwordx4 v2, s[12:15], s40 offen sc1 lds
    s_mov_b32 m0, s19
    s_mov_b32 s39, s16
    s_mov_b32 s40, s17
    s_waitcnt vmcnt(8)
    s_barrier
    buffer_load_dwordx4 v2, s[12:15], s39 offen sc1 lds
    s_add_u32 m0, m0, 1024
    s_nop 0
    buffer_load_dwordx4 v2, s[12:15], s40 offen sc1 lds
    s_mov_b32 s43, 1
ld_64:
    s_add_u32 s19, s41, s42
    v_readlane_b32 s16, v249, s44
    v_readlane_b32 s17, v250, s44
    s_add_u32 s16, s16, s38
    s_add_u32 s17, s17, s38
    s_add_u32 s44, s44, 1
    s_add_u32 s42, s42, 16384
    s_cmp_eq_u32 s42, 49152
    s_cselect_b32 s42, 0, s42
    s_add_u32 m0, m0, 1024
    s_add_u32 s39, s39, 229376
    buffer_load_dwordx4 v2, s[12:15], s39 offen sc1 lds
    s_add_u32 m0, m0, 1024
    s_add_u32 s40, s40, 229376
    buffer_load_dwordx4 v2, s[12:15], s40 offen sc1 lds
    s_add_u32 m0, m0, 1024
    s_add_u32 s39, s39, 229376
    buffer_load_dwordx4 v2, s[12:15], s39 offen sc1 lds
    s_add_u32 m0, m0, 1024
    s_add_u32 s40, s40, 229376
    buffer_load_dwordx4 v2, s[12:15], s40 offen sc1 lds
    s_add_u32 m0, m0, 1024
    s_add_u32 s39, s39, 229376
    buffer_load_dwordx4 v2, s[12:15], s39 offen sc1 lds
    s_add_u32 m0, m0, 1024
    s_add_u32 s40, s40, 229376
    buffer_load_dwordx4 v2, s[12:15], s40 offen sc1 lds
    s_mov_b32 m0, s19
    s_mov_b32 s39, s16
    s_mov_b32 s40, s17
    s_waitcnt vmcnt(8)
    s_barrier
    buffer_load_dwordx4 v2, s[12:15], s39 offen sc1 lds
    s_add_u32 m0, m0, 1024
    s_nop 0
    buffer_load_dwordx4 v2, s[12:15], s40 offen sc1 lds
    s_add_u32 s43, s43, 1
    s_cmp_lt_u32 s43, 4
    s_cbranch_scc1 ld_64
    s_call_b64 s[76:77], PREP_a_issue_4
    s_add_u32 m0, m0, 1024
    s_add_u32 s39, s39, 229376
    buffer_load_dwordx4 v2, s[12:15], s39 offen sc1 lds
    s_add_u32 m0, m0, 1024
    s_add_u32 s40, s40, 229376
    buffer_load_dwordx4 v2, s[12:15], s40 offen sc1 lds
    s_add_u32 m0, m0, 1024
    s_add_u32 s39, s39, 229376
    buffer_load_dwordx4 v2, s[12:15], s39 offen sc1 lds
    s_add_u32 m0, m0, 1024
    s_add_u32 s40, s40, 229376
    buffer_load_dwordx4 v2, s[12:15], s40 offen sc1 lds
    s_add_u32 m0, m0, 1024
    s_add_u32 s39, s39, 229376
    buffer_load_dwordx4 v2, s[12:15], s39 offen sc1 lds
    s_add_u32 m0, m0, 1024
    s_add_u32 s40, s40, 229376
    buffer_load_dwordx4 v2, s[12:15], s40 offen sc1 lds
    s_mov_b32 m0, s19
    s_mov_b32 s39, s16
    s_mov_b32 s40, s17
    s_waitcnt vmcnt(8)
    s_barrier
    buffer_load_dwordx4 v2, s[12:15], s39 offen sc1 lds
    s_add_u32 m0, m0, 1024
    s_nop 0
    buffer_load_dwordx4 v2, s[12:15], s40 offen sc1 lds
    s_mov_b64 exec, 1
    buffer_load_dword v11, v12, s[56:59], 0 offen sc1
    s_mov_b64 exec, -1
    s_call_b64 s[76:77], PREP_a_issue_4
    s_add_u32 m0, m0, 1024
    s_add_u32 s39, s39, 229376
    buffer_load_dwordx4 v2, s[12:15], s39 offen sc1 lds
    s_add_u32 m0, m0, 1024
    s_add_u32 s40, s40, 229376
    buffer_load_dwordx4 v2, s[12:15], s40 offen sc1 lds
    s_add_u32 m0, m0, 1024
    s_add_u32 s39, s39, 229376
    buffer_load_dwordx4 v2, s[12:15], s39 offen sc1 lds
    s_add_u32 m0, m0, 1024
    s_add_u32 s40, s40, 229376
    buffer_load_dwordx4 v2, s[12:15], s40 offen sc1 lds
    s_add_u32 m0, m0, 1024
    s_add_u32 s39, s39, 229376
    buffer_load_dwordx4 v2, s[12:15], s39 offen sc1 lds
    s_add_u32 m0, m0, 1024
    s_add_u32 s40, s40, 229376
    buffer_load_dwordx4 v2, s[12:15], s40 offen sc1 lds
    s_mov_b32 m0, s19
    s_mov_b32 s39, s16
    s_mov_b32 s40, s17
    s_waitcnt vmcnt(9)
    s_barrier
    buffer_load_dwordx4 v2, s[12:15], s39 offen sc1 lds
    s_add_u32 m0, m0, 1024
    s_nop 0
    buffer_load_dwordx4 v2, s[12:15], s40 offen sc1 lds
    s_call_b64 s[76:77], PREP_a_issue_4
    s_add_u32 m0, m0, 1024
    s_add_u32 s39, s39, 229376
    buffer_load_dwordx4 v2, s[12:15], s39 offen sc1 lds
    s_add_u32 m0, m0, 1024
    s_add_u32 s40, s40, 229376
    buffer_load_dwordx4 v2, s[12:15], s40 offen sc1 lds
    s_add_u32 m0, m0, 1024
    s_add_u32 s39, s39, 229376
    buffer_load_dwordx4 v2, s[12:15], s39 offen sc1 lds
    s_add_u32 m0, m0, 1024
    s_add_u32 s40, s40, 229376
    buffer_load_dwordx4 v2, s[12:15], s40 offen sc1 lds
    s_add_u32 m0, m0, 1024
    s_add_u32 s39, s39, 229376
    buffer_load_dwordx4 v2, s[12:15], s39 offen sc1 lds
    s_add_u32 m0, m0, 1024
    s_add_u32 s40, s40, 229376
    buffer_load_dwordx4 v2, s[12:15], s40 offen sc1 lds
    s_mov_b32 m0, s19
    s_mov_b32 s39, s16
    s_mov_b32 s40, s17
    s_waitcnt vmcnt(8)
    s_barrier
    buffer_load_dwordx4 v2, s[12:15], s39 offen sc1 lds
    s_add_u32 m0, m0, 1024
    s_nop 0
    buffer_load_dwordx4 v2, s[12:15], s40 offen sc1 lds
    s_waitcnt vmcnt(16)
    v_readfirstlane_b32 s53, v11
    s_add_u32 s54, s52, 8
    s_cmp_eq_u32 s53, s54
    s_cbranch_scc1 fok_65
    s_mov_b32 s53, 0
    s_add_u32 s54, s52, 8
    s_bfm_b64 exec, 1, 0
poll_66:
    buffer_load_dword v11, v12, s[56:59], 0 offen sc1
    s_waitcnt vmcnt(0)
    v_xor_b32 v11, s54, v11
    v_cmp_eq_u32 vcc, 0, v11
    s_nop 0
    s_cmp_eq_u64 vcc, exec
    s_cbranch_scc1 pok_67
    s_sleep 5
    s_add_u32 s53, s53, 1
    s_cmp_lt_u32 s53, s61
    s_cbranch_scc1 poll_66
    s_mov_b32 s61, 0
pok_67:
    s_mov_b64 exec, -1
fok_65:
    s_call_b64 s[76:77], PREP_a_issue_4
    s_add_u32 m0, m0, 1024
    s_add_u32 s39, s39, 229376
    buffer_load_dwordx4 v2, s[12:15], s39 offen sc1 lds
    s_add_u32 m0, m0, 1024
    s_add_u32 s40, s40, 229376
    buffer_load_dwordx4 v2, s[12:15], s40 offen sc1 lds
    s_add_u32 m0, m0, 1024
    s_add_u32 s39, s39, 229376
    buffer_load_dwordx4 v2, s[12:15], s39 offen sc1 lds
    s_add_u32 m0, m0, 1024
    s_add_u32 s40, s40, 229376
    buffer_load_dwordx4 v2, s[12:15], s40 offen sc1 lds
    s_add_u32 m0, m0, 1024
    s_add_u32 s39, s39, 229376
    buffer_load_dwordx4 v2, s[12:15], s39 offen sc1 lds
    s_add_u32 m0, m0, 1024
    s_add_u32 s40, s40, 229376
    buffer_load_dwordx4 v2, s[12:15], s40 offen sc1 lds
    s_mov_b32 m0, s19
    s_mov_b32 s39, s16
    s_mov_b32 s40, s17
    s_waitcnt vmcnt(8)
    s_barrier
    buffer_load_dwordx4 v2, s[12:15], s39 offen sc1 lds
    s_add_u32 m0, m0, 1024
    s_nop 0
    buffer_load_dwordx4 v2, s[12:15], s40 offen sc1 lds
    s_mov_b32 s43, 1
ld_68:
    s_add_u32 s19, s41, s42
    v_readlane_b32 s16, v249, s44
    v_readlane_b32 s17, v250, s44
    s_add_u32 s16, s16, s38
    s_add_u32 s17, s17, s38
    s_add_u32 s44, s44, 1
    s_add_u32 s42, s42, 16384
    s_cmp_eq_u32 s42, 49152
    s_cselect_b32 s42, 0, s42
    s_add_u32 m0, m0, 1024
    s_add_u32 s39, s39, 229376
    buffer_load_dwordx4 v2, s[12:15], s39 offen sc1 lds
    s_add_u32 m0, m0, 1024
    s_add_u32 s40, s40, 229376
    buffer_load_dwordx4 v2, s[12:15], s40 offen sc1 lds
    s_add_u32 m0, m0, 1024
    s_add_u32 s39, s39, 229376
    buffer_load_dwordx4 v2, s[12:15], s39 offen sc1 lds
    s_add_u32 m0, m0, 1024
    s_add_u32 s40, s40, 229376
    buffer_load_dwordx4 v2, s[12:15], s40 offen sc1 lds
    s_add_u32 m0, m0, 1024
    s_add_u32 s39, s39, 229376
    buffer_load_dwordx4 v2, s[12:15], s39 offen sc1 lds
    s_add_u32 m0, m0, 1024
    s_add_u32 s40, s40, 229376
    buffer_load_dwordx4 v2, s[12:15], s40 offen sc1 lds
    s_mov_b32 m0, s19
    s_mov_b32 s39, s16
    s_mov_b32 s40, s17
    s_waitcnt vmcnt(8)
    s_barrier
    buffer_load_dwordx4 v2, s[12:15], s39 offen sc1 lds
    s_add_u32 m0, m0, 1024
    s_nop 0
    buffer_load_dwordx4 v2, s[12:15], s40 offen sc1 lds
    s_add_u32 s43, s43, 1
    s_cmp_lt_u32 s43, 4
    s_cbranch_scc1 ld_68
    s_call_b64 s[76:77], PREP_a_issue_4
    s_add_u32 m0, m0, 1024
    s_add_u32 s39, s39, 229376
    buffer_load_dwordx4 v2, s[12:15], s39 offen sc1 lds
    s_add_u32 m0, m0, 1024
    s_add_u32 s40, s40, 229376
    buffer_load_dwordx4 v2, s[12:15], s40 offen sc1 lds
    s_add_u32 m0, m0, 1024
    s_add_u32 s39, s39, 229376
    buffer_load_dwordx4 v2, s[12:15], s39 offen sc1 lds
    s_add_u32 m0, m0, 1024
    s_add_u32 s40, s40, 229376
    buffer_load_dwordx4 v2, s[12:15], s40 offen sc1 lds
    s_add_u32 m0, m0, 1024
    s_add_u32 s39, s39, 229376
    buffer_load_dwordx4 v2, s[12:15], s39 offen sc1 lds
    s_add_u32 m0, m0, 1024
    s_add_u32 s40, s40, 229376
    buffer_load_dwordx4 v2, s[12:15], s40 offen sc1 lds
    s_mov_b32 m0, s19
    s_mov_b32 s39, s16
    s_mov_b32 s40, s17
    s_waitcnt vmcnt(8)
    s_barrier
    buffer_load_dwordx4 v2, s[12:15], s39 offen sc1 lds
    s_add_u32 m0, m0, 1024
    s_nop 0
    buffer_load_dwordx4 v2, s[12:15], s40 offen sc1 lds
    s_mov_b64 exec, 1
    buffer_load_dword v11, v15, s[56:59], 0 offen sc1
    s_mov_b64 exec, -1
    s_call_b64 s[76:77], PREP_a_issue_4
    s_add_u32 m0, m0, 1024
    s_add_u32 s39, s39, 229376
    buffer_load_dwordx4 v2, s[12:15], s39 offen sc1 lds
    s_add_u32 m0, m0, 1024
    s_add_u32 s40, s40, 229376
    buffer_load_dwordx4 v2, s[12:15], s40 offen sc1 lds
    s_add_u32 m0, m0, 1024
    s_add_u32 s39, s39, 229376
    buffer_load_dwordx4 v2, s[12:15], s39 offen sc1 lds
    s_add_u32 m0, m0, 1024
    s_add_u32 s40, s40, 229376
    buffer_load_dwordx4 v2, s[12:15], s40 offen sc1 lds
    s_add_u32 m0, m0, 1024
    s_add_u32 s39, s39, 229376
    buffer_load_dwordx4 v2, s[12:15], s39 offen sc1 lds
    s_add_u32 m0, m0, 1024
    s_add_u32 s40, s40, 229376
    buffer_load_dwordx4 v2, s[12:15], s40 offen sc1 lds
    s_mov_b32 m0, s19
    s_mov_b32 s39, s16
    s_mov_b32 s40, s17
    s_waitcnt vmcnt(9)
    s_barrier
    buffer_load_dwordx4 v2, s[12:15], s39 offen sc1 lds
    s_add_u32 m0, m0, 1024
    s_nop 0
    buffer_load_dwordx4 v2, s[12:15], s40 offen sc1 lds
    s_call_b64 s[76:77], PREP_a_issue_4
    s_add_u32 m0, m0, 1024
    s_add_u32 s39, s39, 229376
    buffer_load_dwordx4 v2, s[12:15], s39 offen sc1 lds
    s_add_u32 m0, m0, 1024
    s_add_u32 s40, s40, 229376
    buffer_load_dwordx4 v2, s[12:15], s40 offen sc1 lds
    s_add_u32 m0, m0, 1024
    s_add_u32 s39, s39, 229376
    buffer_load_dwordx4 v2, s[12:15], s39 offen sc1 lds
    s_add_u32 m0, m0, 1024
    s_add_u32 s40, s40, 229376
    buffer_load_dwordx4 v2, s[12:15], s40 offen sc1 lds
    s_add_u32 m0, m0, 1024
    s_add_u32 s39, s39, 229376
    buffer_load_dwordx4 v2, s[12:15], s39 offen sc1 lds
    s_add_u32 m0, m0, 1024
    s_add_u32 s40, s40, 229376
    buffer_load_dwordx4 v2, s[12:15], s40 offen sc1 lds
    s_mov_b32 m0, s19
    s_mov_b32 s39, s16
    s_mov_b32 s40, s17
    s_waitcnt vmcnt(8)
    s_barrier
    buffer_load_dwordx4 v2, s[12:15], s39 offen sc1 lds
    s_add_u32 m0, m0, 1024
    s_nop 0
    buffer_load_dwordx4 v2, s[12:15], s40 offen sc1 lds
    s_waitcnt vmcnt(16)
    v_readfirstlane_b32 s53, v11
    s_add_u32 s54, s52, 8
    s_cmp_eq_u32 s53, s54
    s_cbranch_scc1 fok_69
    s_mov_b32 s53, 0
    s_add_u32 s54, s52, 8
    s_bfm_b64 exec, 1, 0
poll_70:
    buffer_load_dword v11, v15, s[56:59], 0 offen sc1
    s_waitcnt vmcnt(0)
    v_xor_b32 v11, s54, v11
    v_cmp_eq_u32 vcc, 0, v11
    s_nop 0
    s_cmp_eq_u64 vcc, exec
    s_cbranch_scc1 pok_71
    s_sleep 5
    s_add_u32 s53, s53, 1
    s_cmp_lt_u32 s53, s61
    s_cbranch_scc1 poll_70
    s_mov_b32 s61, 0
pok_71:
    s_mov_b64 exec, -1
fok_69:
    s_call_b64 s[76:77], PREP_a_issue_4
    s_add_u32 m0, m0, 1024
    s_add_u32 s39, s39, 229376
    buffer_load_dwordx4 v2, s[12:15], s39 offen sc1 lds
    s_add_u32 m0, m0, 1024
    s_add_u32 s40, s40, 229376
    buffer_load_dwordx4 v2, s[12:15], s40 offen sc1 lds
    s_add_u32 m0, m0, 1024
    s_add_u32 s39, s39, 229376
    buffer_load_dwordx4 v2, s[12:15], s39 offen sc1 lds
    s_add_u32 m0, m0, 1024
    s_add_u32 s40, s40, 229376
    buffer_load_dwordx4 v2, s[12:15], s40 offen sc1 lds
    s_add_u32 m0, m0, 1024
    s_add_u32 s39, s39, 229376
    buffer_load_dwordx4 v2, s[12:15], s39 offen sc1 lds
    s_add_u32 m0, m0, 1024
    s_add_u32 s40, s40, 229376
    buffer_load_dwordx4 v2, s[12:15], s40 offen sc1 lds
    s_mov_b32 m0, s19
    s_mov_b32 s39, s16
    s_mov_b32 s40, s17
    s_waitcnt vmcnt(8)
    s_barrier
    buffer_load_dwordx4 v2, s[12:15], s39 offen sc1 lds
    s_add_u32 m0, m0, 1024
    s_nop 0
    buffer_load_dwordx4 v2, s[12:15], s40 offen sc1 lds
    s_mov_b32 s43, 1
ld_72:
    s_add_u32 s19, s41, s42
    v_readlane_b32 s16, v249, s44
    v_readlane_b32 s17, v250, s44
    s_add_u32 s16, s16, s38
    s_add_u32 s17, s17, s38
    s_add_u32 s44, s44, 1
    s_add_u32 s42, s42, 16384
    s_cmp_eq_u32 s42, 49152
    s_cselect_b32 s42, 0, s42
    s_add_u32 m0, m0, 1024
    s_add_u32 s39, s39, 229376
    buffer_load_dwordx4 v2, s[12:15], s39 offen sc1 lds
    s_add_u32 m0, m0, 1024
    s_add_u32 s40, s40, 229376
    buffer_load_dwordx4 v2, s[12:15], s40 offen sc1 lds
    s_add_u32 m0, m0, 1024
    s_add_u32 s39, s39, 229376
    buffer_load_dwordx4 v2, s[12:15], s39 offen sc1 lds
    s_add_u32 m0, m0, 1024
    s_add_u32 s40, s40, 229376
    buffer_load_dwordx4 v2, s[12:15], s40 offen sc1 lds
    s_add_u32 m0, m0, 1024
    s_add_u32 s39, s39, 229376
    buffer_load_dwordx4 v2, s[12:15], s39 offen sc1 lds
    s_add_u32 m0, m0, 1024
    s_add_u32 s40, s40, 229376
    buffer_load_dwordx4 v2, s[12:15], s40 offen sc1 lds
    s_mov_b32 m0, s19
    s_mov_b32 s39, s16
    s_mov_b32 s40, s17
    s_waitcnt vmcnt(8)
    s_barrier
    buffer_load_dwordx4 v2, s[12:15], s39 offen sc1 lds
    s_add_u32 m0, m0, 1024
    s_nop 0
    buffer_load_dwordx4 v2, s[12:15], s40 offen sc1 lds
    s_add_u32 s43, s43, 1
    s_cmp_lt_u32 s43, 3
    s_cbranch_scc1 ld_72
    s_call_b64 s[76:77], PREP_a_issue_4
    s_add_u32 m0, m0, 1024
    s_add_u32 s39, s39, 229376
    buffer_load_dwordx4 v2, s[12:15], s39 offen sc1 lds
    s_add_u32 m0, m0, 1024
    s_add_u32 s40, s40, 229376
    buffer_load_dwordx4 v2, s[12:15], s40 offen sc1 lds
    s_add_u32 m0, m0, 1024
    s_add_u32 s39, s39, 229376
    buffer_load_dwordx4 v2, s[12:15], s39 offen sc1 lds
    s_add_u32 m0, m0, 1024
    s_add_u32 s40, s40, 229376
    buffer_load_dwordx4 v2, s[12:15], s40 offen sc1 lds
    s_add_u32 m0, m0, 1024
    s_add_u32 s39, s39, 229376
    buffer_load_dwordx4 v2, s[12:15], s39 offen sc1 lds
    s_add_u32 m0, m0, 1024
    s_add_u32 s40, s40, 229376
    buffer_load_dwordx4 v2, s[12:15], s40 offen sc1 lds
    s_mov_b32 m0, s19
    s_mov_b32 s39, s16
    s_mov_b32 s40, s17
    s_waitcnt vmcnt(8)
    s_barrier
    buffer_load_dwordx4 v2, s[12:15], s39 offen sc1 lds
    s_add_u32 m0, m0, 1024
    s_nop 0
    buffer_load_dwordx4 v2, s[12:15], s40 offen sc1 lds
    s_add_u32 m0, m0, 1024
    s_add_u32 s39, s39, 229376
    buffer_load_dwordx4 v2, s[12:15], s39 offen sc1 lds
    s_add_u32 m0, m0, 1024
    s_add_u32 s40, s40, 229376
    buffer_load_dwordx4 v2, s[12:15], s40 offen sc1 lds
    s_add_u32 m0, m0, 1024
    s_add_u32 s39, s39, 229376
    buffer_load_dwordx4 v2, s[12:15], s39 offen sc1 lds
    s_add_u32 m0, m0, 1024
    s_add_u32 s40, s40, 229376
    buffer_load_dwordx4 v2, s[12:15], s40 offen sc1 lds
    s_add_u32 m0, m0, 1024
    s_add_u32 s39, s39, 229376
    buffer_load_dwordx4 v2, s[12:15], s39 offen sc1 lds
    s_add_u32 m0, m0, 1024
    s_add_u32 s40, s40, 229376
    buffer_load_dwordx4 v2, s[12:15], s40 offen sc1 lds
    s_waitcnt vmcnt(8)
    s_barrier
    s_waitcnt vmcnt(0)
    s_barrier
    s_cmp_eq_u32 s60, 1
    s_cbranch_scc1 K_fin
    s_barrier
    s_branch NEXT
WLOAD:
    s_cmp_eq_u32 s60, 1
    s_cbranch_scc1 WL_1
    s_mov_b64 s[12:13], s[68:69]
    s_mov_b32 s14, 2097152
    s_mov_b32 s15, 0x20000
    s_and_b32 s35, s30, 1
    s_mul_i32 s38, s29, 128
    s_mul_i32 s41, s35, 65536
    s_add_u32 s38, s38, s41
    s_mul_i32 s41, s35, 4096
    s_add_u32 s41, s41, 24576
    s_mov_b32 s42, 0
    s_mov_b32 s44, s67
    s_branch WL_2
WL_1:
    s_mov_b64 s[12:13], s[68:69]
    s_mov_b32 s14, 2097152
    s_mov_b32 s15, 0x20000
    s_and_b32 s35, s30, 1
    s_mul_i32 s38, s29, 128
    s_mul_i32 s41, s35, 65536
    s_add_u32 s38, s38, s41
    s_mul_i32 s41, s35, 4096
    s_add_u32 s41, s41, 24576
    s_mov_b32 s42, 0
    s_mov_b32 s44, s67
WL_2:
    s_waitcnt vmcnt(0)
    s_barrier
    s_call_b64 s[76:77], SUB_after_g1
    s_barrier
    s_waitcnt vmcnt(0)
    s_barrier
    s_call_b64 s[76:77], SUB_after_g2
    s_mov_b64 s[12:13], s[72:73]
    s_mov_b32 s14, 7340032
    s_mov_b32 s15, 0x20000
    s_and_b32 s35, s30, 1
    s_mul_i32 s38, s29, 448
    s_mul_i32 s41, s35, 229376
    s_add_u32 s38, s38, s41
    s_mul_i32 s41, s35, 14336
    s_add_u32 s41, s41, 73728
    s_mov_b32 s42, 0
    s_mov_b32 s44, 0
    s_mov_b32 s42, 28672
    s_mov_b32 s44, 2
    s_add_u32 s19, s41, s42
    v_readlane_b32 s16, v248, s44
    s_nop 0
    s_add_u32 s16, s16, s38
    s_add_u32 s44, s44, 1
    s_and_b32 s44, s44, 15
    s_add_u32 s42, s42, 28672
    s_cmp_eq_u32 s42, 86016
    s_cselect_b32 s42, 0, s42
    s_mov_b32 m0, s19
    s_mov_b32 s39, s16
    s_waitcnt vmcnt(0)
    s_barrier
    buffer_load_dwordx4 v241, s[12:15], s39 offen lds
    s_add_u32 m0, m0, 1024
    s_nop 0
    buffer_load_dwordx4 v242, s[12:15], s39 offen lds
    s_add_u32 m0, m0, 1024
    s_nop 0
    buffer_load_dwordx4 v243, s[12:15], s39 offen lds
    s_mov_b32 s43, 1
ld_73:
    s_add_u32 s19, s41, s42
    v_readlane_b32 s16, v248, s44
    s_nop 0
    s_add_u32 s16, s16, s38
    s_add_u32 s44, s44, 1
    s_and_b32 s44, s44, 15
    s_add_u32 s42, s42, 28672
    s_cmp_eq_u32 s42, 86016
    s_cselect_b32 s42, 0, s42
    s_add_u32 m0, m0, 1024
    s_nop 0
    buffer_load_dwordx4 v244, s[12:15], s39 offen lds
    s_add_u32 m0, m0, 1024
    s_nop 0
    buffer_load_dwordx4 v245, s[12:15], s39 offen lds
    s_add_u32 m0, m0, 1024
    s_nop 0
    buffer_load_dwordx4 v246, s[12:15], s39 offen lds
    s_add_u32 m0, m0, 1024
    s_nop 0
    buffer_load_dwordx4 v247, s[12:15], s39 offen lds
    s_add_u32 m0, m0, 1024
    s_add_u32 s39, s39, 114688
    buffer_load_dwordx4 v241, s[12:15], s39 offen lds
    s_add_u32 m0, m0, 1024
    s_nop 0
    buffer_load_dwordx4 v242, s[12:15], s39 offen lds
    s_add_u32 m0, m0, 1024
    s_nop 0
    buffer_load_dwordx4 v243, s[12:15], s39 offen lds
    s_add_u32 m0, m0, 1024
    s_nop 0
    buffer_load_dwordx4 v244, s[12:15], s39 offen lds
    s_add_u32 m0, m0, 1024
    s_nop 0
    buffer_load_dwordx4 v245, s[12:15], s39 offen lds
    s_add_u32 m0, m0, 1024
    s_nop 0
    buffer_load_dwordx4 v246, s[12:15], s39 offen lds
    s_add_u32 m0, m0, 1024
    s_nop 0
    buffer_load_dwordx4 v247, s[12:15], s39 offen lds
    s_mov_b32 m0, s19
    s_mov_b32 s39, s16
    s_waitcnt vmcnt(14)
    s_barrier
    buffer_load_dwordx4 v241, s[12:15], s39 offen lds
    s_add_u32 m0, m0, 1024
    s_nop 0
    buffer_load_dwordx4 v242, s[12:15], s39 offen lds
    s_add_u32 m0, m0, 1024
    s_nop 0
    buffer_load_dwordx4 v243, s[12:15], s39 offen lds
    s_add_u32 s43, s43, 1
    s_cmp_lt_u32 s43, 13
    s_cbranch_scc1 ld_73
    s_add_u32 s19, s41, s42
    v_readlane_b32 s16, v248, s44
    s_nop 0
    s_add_u32 s16, s16, s38
    s_add_u32 s44, s44, 1
    s_and_b32 s44, s44, 15
    s_add_u32 s42, s42, 28672
    s_cmp_eq_u32 s42, 86016
    s_cselect_b32 s42, 0, s42
    s_add_u32 m0, m0, 1024
    s_nop 0
    buffer_load_dwordx4 v244, s[12:15], s39 offen lds
    s_add_u32 m0, m0, 1024
    s_nop 0
    buffer_load_dwordx4 v245, s[12:15], s39 offen lds
    s_add_u32 m0, m0, 1024
    s_nop 0
    buffer_load_dwordx4 v246, s[12:15], s39 offen lds
    s_add_u32 m0, m0, 1024
    s_nop 0
    buffer_load_dwordx4 v247, s[12:15], s39 offen lds
    s_add_u32 m0, m0, 1024
    s_add_u32 s39, s39, 114688
    buffer_load_dwordx4 v241, s[12:15], s39 offen lds
    s_add_u32 m0, m0, 1024
    s_nop 0
    buffer_load_dwordx4 v242, s[12:15], s39 offen lds
    s_add_u32 m0, m0, 1024
    s_nop 0
    buffer_load_dwordx4 v243, s[12:15], s39 offen lds
    s_add_u32 m0, m0, 1024
    s_nop 0
    buffer_load_dwordx4 v244, s[12:15], s39 offen lds
    s_add_u32 m0, m0, 1024
    s_nop 0
    buffer_load_dwordx4 v245, s[12:15], s39 offen lds
    s_add_u32 m0, m0, 1024
    s_nop 0
    buffer_load_dwordx4 v246, s[12:15], s39 offen lds
    s_add_u32 m0, m0, 1024
    s_nop 0
    buffer_load_dwordx4 v247, s[12:15], s39 offen lds
    s_mov_b32 m0, s19
    s_mov_b32 s39, s16
    s_waitcnt vmcnt(14)
    s_barrier
    buffer_load_dwordx4 v241, s[12:15], s39 offen lds
    s_add_u32 m0, m0, 1024
    s_nop 0
    buffer_load_dwordx4 v242, s[12:15], s39 offen lds
    s_add_u32 m0, m0, 1024
    s_nop 0
    buffer_load_dwordx4 v243, s[12:15], s39 offen lds
    s_add_u32 m0, m0, 1024
    s_nop 0
    buffer_load_dwordx4 v244, s[12:15], s39 offen lds
    s_add_u32 m0, m0, 1024
    s_nop 0
    buffer_load_dwordx4 v245, s[12:15], s39 offen lds
    s_add_u32 m0, m0, 1024
    s_nop 0
    buffer_load_dwordx4 v246, s[12:15], s39 offen lds
    s_add_u32 m0, m0, 1024
    s_nop 0
    buffer_load_dwordx4 v247, s[12:15], s39 offen lds
    s_add_u32 m0, m0, 1024
    s_add_u32 s39, s39, 114688
    buffer_load_dwordx4 v241, s[12:15], s39 offen lds
    s_add_u32 m0, m0, 1024
    s_nop 0
    buffer_load_dwordx4 v242, s[12:15], s39 offen lds
    s_add_u32 m0, m0, 1024
    s_nop 0
    buffer_load_dwordx4 v243, s[12:15], s39 offen lds
    s_add_u32 m0, m0, 1024
    s_nop 0
    buffer_load_dwordx4 v244, s[12:15], s39 offen lds
    s_add_u32 m0, m0, 1024
    s_nop 0
    buffer_load_dwordx4 v245, s[12:15], s39 offen lds
    s_add_u32 m0, m0, 1024
    s_nop 0
    buffer_load_dwordx4 v246, s[12:15], s39 offen lds
    s_add_u32 m0, m0, 1024
    s_nop 0
    buffer_load_dwordx4 v247, s[12:15], s39 offen lds
    s_waitcnt vmcnt(14)
    s_barrier
    s_call_b64 s[76:77], SUB_r_pre0
    s_waitcnt vmcnt(8)
    s_barrier
    s_barrier
    s_mov_b64 s[12:13], s[74:75]
    s_mov_b32 s14, 7340032
    s_mov_b32 s15, 0x20000
    s_and_b32 s35, s30, 1
    s_mul_i32 s38, s33, 256
    s_mul_i32 s41, s31, 3670016
    s_add_u32 s38, s38, s41
    s_mul_i32 s41, s35, 8192
    s_add_u32 s41, s41, 49152
    s_mov_b32 s42, 0
    s_mov_b32 s44, 0
    s_mov_b32 s49, s44
    s_and_b32 s43, s28, 3
    s_mul_i32 s43, s43, 6
    s_lshr_b32 s43, s43, 2
    s_mov_b32 s50, 0
wpre_74:
    s_mul_i32 s42, s43, 16384
    s_add_u32 s44, s49, s43
    s_mov_b32 s45, 8192
    s_add_u32 s19, s41, s42
    v_readlane_b32 s16, v249, s44
    s_nop 0
    s_bitcmp1_b32 s16, 0
    s_cselect_b32 s17, 16384, s45
    s_cselect_b32 s18, -40960, s45
    s_andn2_b32 s16, s16, 1
    s_add_u32 s16, s16, s38
    s_add_u32 s44, s44, 1
    s_add_u32 s42, s42, 16384
    s_cmp_eq_u32 s42, 98304
    s_cselect_b32 s42, 0, s42
    s_mov_b32 m0, s19
    s_mov_b32 s39, s16
    s_mov_b32 s32, s17
    s_mov_b32 s3, s18
    buffer_load_dwordx4 v239, s[12:15], s39 offen lds
    s_add_u32 m0, m0, 1024
    s_add_u32 s39, s39, s32
    buffer_load_dwordx4 v240, s[12:15], s39 offen lds
    s_add_u32 m0, m0, 1024
    s_add_u32 s39, s39, s32
    buffer_load_dwordx4 v239, s[12:15], s39 offen lds
    s_add_u32 m0, m0, 1024
    s_add_u32 s39, s39, s32
    buffer_load_dwordx4 v240, s[12:15], s39 offen lds
    s_waitcnt vmcnt(6)
    s_add_u32 m0, m0, 1024
    s_add_u32 s39, s39, s3
    buffer_load_dwordx4 v239, s[12:15], s39 offen lds
    s_add_u32 m0, m0, 1024
    s_add_u32 s39, s39, s32
    buffer_load_dwordx4 v240, s[12:15], s39 offen lds
    s_add_u32 m0, m0, 1024
    s_add_u32 s39, s39, s32
    buffer_load_dwordx4 v239, s[12:15], s39 offen lds
    s_add_u32 m0, m0, 1024
    s_add_u32 s39, s39, s32
    buffer_load_dwordx4 v240, s[12:15], s39 offen lds
    s_waitcnt vmcnt(6)
    s_add_u32 s43, s43, 1
    s_cmp_eq_u32 s43, 6
    s_cselect_b32 s43, 0, s43
    s_add_u32 s50, s50, 1
    s_cmp_lt_u32 s50, 6
    s_cbranch_scc1 wpre_74
    s_mov_b32 s42, 0
    s_add_u32 s44, s49, 6
    s_cmp_eq_u32 s60, 1
    s_cbranch_scc1 WL_t1
    s_call_b64 s[76:77], PREP_w_issue_4
    s_mov_b32 m0, s19
    s_mov_b32 s39, s16
    s_mov_b32 s32, s17
    s_mov_b32 s3, s18
    s_waitcnt vmcnt(0)
    s_barrier
    s_waitcnt vmcnt(0)
    s_barrier
    buffer_load_dwordx4 v239, s[12:15], s39 offen lds
    s_add_u32 m0, m0, 1024
    s_add_u32 s39, s39, s32
    buffer_load_dwordx4 v240, s[12:15], s39 offen lds
    s_call_b64 s[76:77], PREP_w_issue_4
    s_add_u32 m0, m0, 1024
    s_add_u32 s39, s39, s32
    buffer_load_dwordx4 v239, s[12:15], s39 offen lds
    s_add_u32 m0, m0, 1024
    s_add_u32 s39, s39, s32
    buffer_load_dwordx4 v240, s[12:15], s39 offen lds
    s_add_u32 m0, m0, 1024
    s_add_u32 s39, s39, s3
    buffer_load_dwordx4 v239, s[12:15], s39 offen lds
    s_add_u32 m0, m0, 1024
    s_add_u32 s39, s39, s32
    buffer_load_dwordx4 v240, s[12:15], s39 offen lds
    s_add_u32 m0, m0, 1024
    s_add_u32 s39, s39, s32
    buffer_load_dwordx4 v239, s[12:15], s39 offen lds
    s_add_u32 m0, m0, 1024
    s_add_u32 s39, s39, s32
    buffer_load_dwordx4 v240, s[12:15], s39 offen lds
    s_mov_b32 m0, s19
    s_mov_b32 s39, s16
    s_mov_b32 s32, s17
    s_mov_b32 s3, s18
    s_waitcnt vmcnt(8)
    s_barrier
    buffer_load_dwordx4 v239, s[12:15], s39 offen lds
    s_add_u32 m0, m0, 1024
    s_add_u32 s39, s39, s32
    buffer_load_dwordx4 v240, s[12:15], s39 offen lds
    s_call_b64 s[76:77], PREP_w_issue_4
    s_add_u32 m0, m0, 1024
    s_add_u32 s39, s39, s32
    buffer_load_dwordx4 v239, s[12:15], s39 offen lds
    s_add_u32 m0, m0, 1024
    s_add_u32 s39, s39, s32
    buffer_load_dwordx4 v240, s[12:15], s39 offen lds
    s_add_u32 m0, m0, 1024
    s_add_u32 s39, s39, s3
    buffer_load_dwordx4 v239, s[12:15], s39 offen lds
    s_add_u32 m0, m0, 1024
    s_add_u32 s39, s39, s32
    buffer_load_dwordx4 v240, s[12:15], s39 offen lds
    s_add_u32 m0, m0, 1024
    s_add_u32 s39, s39, s32
    buffer_load_dwordx4 v239, s[12:15], s39 offen lds
    s_add_u32 m0, m0, 1024
    s_add_u32 s39, s39, s32
    buffer_load_dwordx4 v240, s[12:15], s39 offen lds
    s_mov_b32 m0, s19
    s_mov_b32 s39, s16
    s_mov_b32 s32, s17
    s_mov_b32 s3, s18
    s_waitcnt vmcnt(16)
    s_barrier
    buffer_load_dwordx4 v239, s[12:15], s39 offen lds
    s_add_u32 m0, m0, 1024
    s_add_u32 s39, s39, s32
    buffer_load_dwordx4 v240, s[12:15], s39 offen lds
    s_call_b64 s[76:77], PREP_w_issue_4
    s_add_u32 m0, m0, 1024
    s_add_u32 s39, s39, s32
    buffer_load_dwordx4 v239, s[12:15], s39 offen lds
    s_add_u32 m0, m0, 1024
    s_add_u32 s39, s39, s32
    buffer_load_dwordx4 v240, s[12:15], s39 offen lds
    s_add_u32 m0, m0, 1024
    s_add_u32 s39, s39, s3
    buffer_load_dwordx4 v239, s[12:15], s39 offen lds
    s_add_u32 m0, m0, 1024
    s_add_u32 s39, s39, s32
    buffer_load_dwordx4 v240, s[12:15], s39 offen lds
    s_add_u32 m0, m0, 1024
    s_add_u32 s39, s39, s32
    buffer_load_dwordx4 v239, s[12:15], s39 offen lds
    s_add_u32 m0, m0, 1024
    s_add_u32 s39, s39, s32
    buffer_load_dwordx4 v240, s[12:15], s39 offen lds
    s_mov_b32 m0, s19
    s_mov_b32 s39, s16
    s_mov_b32 s32, s17
    s_mov_b32 s3, s18
    s_waitcnt vmcnt(24)
    s_barrier
    buffer_load_dwordx4 v239, s[12:15], s39 offen lds
    s_add_u32 m0, m0, 1024
    s_add_u32 s39, s39, s32
    buffer_load_dwordx4 v240, s[12:15], s39 offen lds
    s_mov_b32 s43, 1
ld_75:
    s_mov_b32 s45, 8192
    s_add_u32 s19, s41, s42
    v_readlane_b32 s16, v249, s44
    s_nop 0
    s_bitcmp1_b32 s16, 0
    s_cselect_b32 s17, 16384, s45
    s_cselect_b32 s18, -40960, s45
    s_andn2_b32 s16, s16, 1
    s_add_u32 s16, s16, s38
    s_add_u32 s44, s44, 1
    s_add_u32 s42, s42, 16384
    s_cmp_eq_u32 s42, 98304
    s_cselect_b32 s42, 0, s42
    s_add_u32 m0, m0, 1024
    s_add_u32 s39, s39, s32
    buffer_load_dwordx4 v239, s[12:15], s39 offen lds
    s_add_u32 m0, m0, 1024
    s_add_u32 s39, s39, s32
    buffer_load_dwordx4 v240, s[12:15], s39 offen lds
    s_add_u32 m0, m0, 1024
    s_add_u32 s39, s39, s3
    buffer_load_dwordx4 v239, s[12:15], s39 offen lds
    s_add_u32 m0, m0, 1024
    s_add_u32 s39, s39, s32
    buffer_load_dwordx4 v240, s[12:15], s39 offen lds
    s_add_u32 m0, m0, 1024
    s_add_u32 s39, s39, s32
    buffer_load_dwordx4 v239, s[12:15], s39 offen lds
    s_add_u32 m0, m0, 1024
    s_add_u32 s39, s39, s32
    buffer_load_dwordx4 v240, s[12:15], s39 offen lds
    s_mov_b32 m0, s19
    s_mov_b32 s39, s16
    s_mov_b32 s32, s17
    s_mov_b32 s3, s18
    s_waitcnt vmcnt(32)
    s_barrier
    buffer_load_dwordx4 v239, s[12:15], s39 offen lds
    s_add_u32 m0, m0, 1024
    s_add_u32 s39, s39, s32
    buffer_load_dwordx4 v240, s[12:15], s39 offen lds
    s_add_u32 s43, s43, 1
    s_cmp_lt_u32 s43, 18
    s_cbranch_scc1 ld_75
    s_call_b64 s[76:77], PREP_w_issue_4
    s_add_u32 m0, m0, 1024
    s_add_u32 s39, s39, s32
    buffer_load_dwordx4 v239, s[12:15], s39 offen lds
    s_add_u32 m0, m0, 1024
    s_add_u32 s39, s39, s32
    buffer_load_dwordx4 v240, s[12:15], s39 offen lds
    s_add_u32 m0, m0, 1024
    s_add_u32 s39, s39, s3
    buffer_load_dwordx4 v239, s[12:15], s39 offen lds
    s_add_u32 m0, m0, 1024
    s_add_u32 s39, s39, s32
    buffer_load_dwordx4 v240, s[12:15], s39 offen lds
    s_add_u32 m0, m0, 1024
    s_add_u32 s39, s39, s32
    buffer_load_dwordx4 v239, s[12:15], s39 offen lds
    s_add_u32 m0, m0, 1024
    s_add_u32 s39, s39, s32
    buffer_load_dwordx4 v240, s[12:15], s39 offen lds
    s_mov_b32 m0, s19
    s_mov_b32 s39, s16
    s_mov_b32 s32, s17
    s_mov_b32 s3, s18
    s_waitcnt vmcnt(32)
    s_barrier
    buffer_load_dwordx4 v239, s[12:15], s39 offen lds
    s_add_u32 m0, m0, 1024
    s_add_u32 s39, s39, s32
    buffer_load_dwordx4 v240, s[12:15], s39 offen lds
    s_add_u32 m0, m0, 1024
    s_add_u32 s39, s39, s32
    buffer_load_dwordx4 v239, s[12:15], s39 offen lds
    s_add_u32 m0, m0, 1024
    s_add_u32 s39, s39, s32
    buffer_load_dwordx4 v240, s[12:15], s39 offen lds
    s_add_u32 m0, m0, 1024
    s_add_u32 s39, s39, s3
    buffer_load_dwordx4 v239, s[12:15], s39 offen lds
    s_add_u32 m0, m0, 1024
    s_add_u32 s39, s39, s32
    buffer_load_dwordx4 v240, s[12:15], s39 offen lds
    s_add_u32 m0, m0, 1024
    s_add_u32 s39, s39, s32
    buffer_load_dwordx4 v239, s[12:15], s39 offen lds
    s_add_u32 m0, m0, 1024
    s_add_u32 s39, s39, s32
    buffer_load_dwordx4 v240, s[12:15], s39 offen lds
    s_waitcnt vmcnt(32)
    s_barrier
    s_mov_b64 s[12:13], s[68:69]
    s_mov_b32 s14, 2097152
    s_mov_b32 s15, 0x20000
    s_and_b32 s35, s30, 1
    s_mul_i32 s38, s29, 128
    s_mul_i32 s41, s35, 65536
    s_add_u32 s38, s38, s41
    s_mul_i32 s41, s35, 4096
    s_add_u32 s41, s41, 24576
    s_mov_b32 s42, 0
    s_mov_b32 s44, s67
    s_mov_b32 s42, 90112
    s_mov_b32 s44, s67
    s_add_u32 s44, s44, 11
    s_and_b32 s44, s44, 15
    s_call_b64 s[76:77], SUB_w_issue_1
    s_mov_b32 s42, 98304
    s_mov_b32 s44, s67
    s_add_u32 s44, s44, 12
    s_and_b32 s44, s44, 15
    s_call_b64 s[76:77], SUB_w_issue_1
    s_mov_b32 s42, 122880
    s_mov_b32 s44, s67
    s_add_u32 s44, s44, 15
    s_and_b32 s44, s44, 15
    s_call_b64 s[76:77], SUB_w_issue_1
    s_add_u32 s39, s38, 1179648
    buffer_load_dwordx4 v[16:19], v238, s[12:15], s39 offen
    s_add_u32 s39, s39, 16384
    buffer_load_dwordx4 v[20:23], v238, s[12:15], s39 offen
    s_add_u32 s39, s39, 16384
    buffer_load_dwordx4 v[24:27], v238, s[12:15], s39 offen
    s_add_u32 s39, s39, 16384
    buffer_load_dwordx4 v[28:31], v238, s[12:15], s39 offen
    s_add_u32 s39, s39, 16384
    s_waitcnt vmcnt(40)
    s_barrier
    s_mov_b32 s42, 106496
    s_mov_b32 s44, s67
    s_add_u32 s44, s44, 13
    s_and_b32 s44, s44, 15
    s_call_b64 s[76:77], SUB_w_issue_1
    s_mov_b32 s42, 114688
    s_mov_b32 s44, s67
    s_add_u32 s44, s44, 14
    s_and_b32 s44, s44, 15
    s_call_b64 s[76:77], SUB_w_issue_1
    s_add_u32 s39, s38, 1310720
    buffer_load_dwordx4 v[32:35], v238, s[12:15], s39 offen
    s_add_u32 s39, s39, 16384
    buffer_load_dwordx4 v[36:39], v238, s[12:15], s39 offen
    s_add_u32 s39, s39, 16384
    buffer_load_dwordx4 v[40:43], v238, s[12:15], s39 offen
    s_add_u32 s39, s39, 16384
    buffer_load_dwordx4 v[44:47], v238, s[12:15], s39 offen
    s_add_u32 s39, s39, 16384
    s_waitcnt vmcnt(44)
    s_barrier
    s_mov_b32 s42, 24576
    s_mov_b32 s44, s67
    s_add_u32 s44, s44, 3
    s_and_b32 s44, s44, 15
    s_call_b64 s[76:77], SUB_w_issue_1
    s_mov_b32 s42, 32768
    s_mov_b32 s44, s67
    s_add_u32 s44, s44, 4
    s_and_b32 s44, s44, 15
    s_call_b64 s[76:77], SUB_w_issue_1
    s_waitcnt vmcnt(44)
    s_barrier
    s_mov_b32 s42, 40960
    s_mov_b32 s44, s67
    s_add_u32 s44, s44, 5
    s_and_b32 s44, s44, 15
    s_call_b64 s[76:77], SUB_w_issue_1
    s_mov_b32 s42, 49152
    s_mov_b32 s44, s67
    s_add_u32 s44, s44, 6
    s_and_b32 s44, s44, 15
    s_call_b64 s[76:77], SUB_w_issue_1
    s_mov_b32 s42, 0
    s_mov_b32 s44, s67
    s_add_u32 s44, s44, 0
    s_and_b32 s44, s44, 15
    s_call_b64 s[76:77], SUB_w_issue_1
    s_waitcnt vmcnt(48)
    s_barrier
    s_mov_b32 s42, 57344
    s_mov_b32 s44, s67
    s_add_u32 s44, s44, 7
    s_and_b32 s44, s44, 15
    s_call_b64 s[76:77], SUB_w_issue_1
    s_mov_b32 s42, 65536
    s_mov_b32 s44, s67
    s_add_u32 s44, s44, 8
    s_and_b32 s44, s44, 15
    s_call_b64 s[76:77], SUB_w_issue_1
    s_mov_b32 s42, 8192
    s_mov_b32 s44, s67
    s_add_u32 s44, s44, 1
    s_and_b32 s44, s44, 15
    s_call_b64 s[76:77], SUB_w_issue_1
    s_mov_b32 s42, 16384
    s_mov_b32 s44, s67
    s_add_u32 s44, s44, 2
    s_and_b32 s44, s44, 15
    s_call_b64 s[76:77], SUB_w_issue_1
    s_barrier
    s_add_u32 s36, s41, 73728
    v_add_u32 v6, s36, v2
    s_waitcnt vmcnt(0)
    ds_write_b128 v6, v[16:19] offset:0
    ds_write_b128 v6, v[20:23] offset:1024
    ds_write_b128 v6, v[24:27] offset:2048
    ds_write_b128 v6, v[28:31] offset:3072
    ds_write_b128 v6, v[32:35] offset:8192
    ds_write_b128 v6, v[36:39] offset:9216
    ds_write_b128 v6, v[40:43] offset:10240
    ds_write_b128 v6, v[44:47] offset:11264
    s_waitcnt lgkmcnt(0)
    s_branch NEXT
WL_t1:
    s_call_b64 s[76:77], PREP_w_issue_4
    s_mov_b32 m0, s19
    s_mov_b32 s39, s16
    s_mov_b32 s32, s17
    s_mov_b32 s3, s18
    s_waitcnt vmcnt(0)
    s_barrier
    s_waitcnt vmcnt(0)
    s_barrier
    s_waitcnt vmcnt(0)
    s_barrier
    s_waitcnt vmcnt(0)
    s_barrier
    s_waitcnt vmcnt(0)
    s_barrier
    buffer_load_dwordx4 v239, s[12:15], s39 offen lds
    s_add_u32 m0, m0, 1024
    s_add_u32 s39, s39, s32
    buffer_load_dwordx4 v240, s[12:15], s39 offen lds
    s_mov_b32 s43, 1
ld_76:
    s_mov_b32 s45, 8192
    s_add_u32 s19, s41, s42
    v_readlane_b32 s16, v249, s44
    s_nop 0
    s_bitcmp1_b32 s16, 0
    s_cselect_b32 s17, 16384, s45
    s_cselect_b32 s18, -40960, s45
    s_andn2_b32 s16, s16, 1
    s_add_u32 s16, s16, s38
    s_add_u32 s44, s44, 1
    s_add_u32 s42, s42, 16384
    s_cmp_eq_u32 s42, 98304
    s_cselect_b32 s42, 0, s42
    s_add_u32 m0, m0, 1024
    s_add_u32 s39, s39, s32
    buffer_load_dwordx4 v239, s[12:15], s39 offen lds
    s_add_u32 m0, m0, 1024
    s_add_u32 s39, s39, s32
    buffer_load_dwordx4 v240, s[12:15], s39 offen lds
    s_add_u32 m0, m0, 1024
    s_add_u32 s39, s39, s3
    buffer_load_dwordx4 v239, s[12:15], s39 offen lds
    s_add_u32 m0, m0, 1024
    s_add_u32 s39, s39, s32
    buffer_load_dwordx4 v240, s[12:15], s39 offen lds
    s_add_u32 m0, m0, 1024
    s_add_u32 s39, s39, s32
    buffer_load_dwordx4 v239, s[12:15], s39 offen lds
    s_add_u32 m0, m0, 1024
    s_add_u32 s39, s39, s32
    buffer_load_dwordx4 v240, s[12:15], s39 offen lds
    s_mov_b32 m0, s19
    s_mov_b32 s39, s16
    s_mov_b32 s32, s17
    s_mov_b32 s3, s18
    s_waitcnt vmcnt(8)
    s_barrier
    buffer_load_dwordx4 v239, s[12:15], s39 offen lds
    s_add_u32 m0, m0, 1024
    s_add_u32 s39, s39, s32
    buffer_load_dwordx4 v240, s[12:15], s39 offen lds
    s_add_u32 s43, s43, 1
    s_cmp_lt_u32 s43, 21
    s_cbranch_scc1 ld_76
    s_call_b64 s[76:77], PREP_w_issue_4
    s_add_u32 m0, m0, 1024
    s_add_u32 s39, s39, s32
    buffer_load_dwordx4 v239, s[12:15], s39 offen lds
    s_add_u32 m0, m0, 1024
    s_add_u32 s39, s39, s32
    buffer_load_dwordx4 v240, s[12:15], s39 offen lds
    s_add_u32 m0, m0, 1024
    s_add_u32 s39, s39, s3
    buffer_load_dwordx4 v239, s[12:15], s39 offen lds
    s_add_u32 m0, m0, 1024
    s_add_u32 s39, s39, s32
    buffer_load_dwordx4 v240, s[12:15], s39 offen lds
    s_add_u32 m0, m0, 1024
    s_add_u32 s39, s39, s32
    buffer_load_dwordx4 v239, s[12:15], s39 offen lds
    s_add_u32 m0, m0, 1024
    s_add_u32 s39, s39, s32
    buffer_load_dwordx4 v240, s[12:15], s39 offen lds
    s_mov_b32 m0, s19
    s_mov_b32 s39, s16
    s_mov_b32 s32, s17
    s_mov_b32 s3, s18
    s_waitcnt vmcnt(8)
    s_barrier
    buffer_load_dwordx4 v239, s[12:15], s39 offen lds
    s_add_u32 m0, m0, 1024
    s_add_u32 s39, s39, s32
    buffer_load_dwordx4 v240, s[12:15], s39 offen lds
    s_add_u32 m0, m0, 1024
    s_add_u32 s39, s39, s32
    buffer_load_dwordx4 v239, s[12:15], s39 offen lds
    s_add_u32 m0, m0, 1024
    s_add_u32 s39, s39, s32
    buffer_load_dwordx4 v240, s[12:15], s39 offen lds
    s_add_u32 m0, m0, 1024
    s_add_u32 s39, s39, s3
    buffer_load_dwordx4 v239, s[12:15], s39 offen lds
    s_add_u32 m0, m0, 1024
    s_add_u32 s39, s39, s32
    buffer_load_dwordx4 v240, s[12:15], s39 offen lds
    s_add_u32 m0, m0, 1024
    s_add_u32 s39, s39, s32
    buffer_load_dwordx4 v239, s[12:15], s39 offen lds
    s_add_u32 m0, m0, 1024
    s_add_u32 s39, s39, s32
    buffer_load_dwordx4 v240, s[12:15], s39 offen lds
    s_waitcnt vmcnt(8)
    s_barrier
    s_waitcnt vmcnt(0)
    s_barrier
    s_branch K_fin
NEXT:
    s_setprio 0
    s_add_u32 s60, s60, 1
    s_add_u32 s55, s55, 4194304
    s_add_u32 s62, s62, 4194304
    s_addc_u32 s63, s63, 0
    s_branch LAYER
K_fin:
    s_endpgm
SUB_w1_regs:
    s_mov_b64 s[12:13], s[68:69]
    s_mov_b32 s14, 2097152
    s_mov_b32 s15, 0x20000
    s_and_b32 s35, s30, 3
    s_mul_i32 s35, s35, 294912
    s_lshl_b32 s39, s29, 7
    s_add_u32 s39, s39, s35
    buffer_load_dwordx4 v[176:179], v238, s[12:15], s39 offen
    s_add_u32 s39, s39, 16384
    buffer_load_dwordx4 v[188:191], v238, s[12:15], s39 offen
    s_add_u32 s39, s39, 16384
    buffer_load_dwordx4 v[192:195], v238, s[12:15], s39 offen
    s_add_u32 s39, s39, 16384
    buffer_load_dwordx4 v[200:203], v238, s[12:15], s39 offen
    s_add_u32 s39, s39, 16384
    s_waitcnt vmcnt(8)
    buffer_load_dwordx4 v[204:207], v238, s[12:15], s39 offen
    s_add_u32 s39, s39, 16384
    buffer_load_dwordx4 v[208:211], v238, s[12:15], s39 offen
    s_add_u32 s39, s39, 16384
    buffer_load_dwordx4 v[212:215], v238, s[12:15], s39 offen
    s_add_u32 s39, s39, 16384
    buffer_load_dwordx4 v[216:219], v238, s[12:15], s39 offen
    s_add_u32 s39, s39, 16384
    s_waitcnt vmcnt(8)
    buffer_load_dwordx4 v[220:223], v238, s[12:15], s39 offen
    s_add_u32 s39, s39, 16384
    buffer_load_dwordx4 v[224:227], v238, s[12:15], s39 offen
    s_add_u32 s39, s39, 16384
    buffer_load_dwordx4 v[16:19], v238, s[12:15], s39 offen
    s_add_u32 s39, s39, 16384
    buffer_load_dwordx4 v[20:23], v238, s[12:15], s39 offen
    s_add_u32 s39, s39, 16384
    s_waitcnt vmcnt(8)
    buffer_load_dwordx4 v[24:27], v238, s[12:15], s39 offen
    s_add_u32 s39, s39, 16384
    buffer_load_dwordx4 v[28:31], v238, s[12:15], s39 offen
    s_add_u32 s39, s39, 16384
    buffer_load_dwordx4 v[32:35], v238, s[12:15], s39 offen
    s_add_u32 s39, s39, 16384
    buffer_load_dwordx4 v[36:39], v238, s[12:15], s39 offen
    s_add_u32 s39, s39, 16384
    s_waitcnt vmcnt(8)
    buffer_load_dwordx4 v[40:43], v238, s[12:15], s39 offen
    s_add_u32 s39, s39, 16384
    buffer_load_dwordx4 v[44:47], v238, s[12:15], s39 offen
    s_add_u32 s39, s39, 16384
    s_setpc_b64 s[76:77]
SUB_park:
    s_mov_b64 s[12:13], s[70:71]
    s_mov_b32 s14, 2097152
    s_mov_b32 s15, 0x20000
    s_and_b32 s35, s30, 3
    s_lshl_b32 s35, s35, 19
    s_lshl_b32 s39, s29, 7
    s_add_u32 s39, s39, s35
    buffer_load_dwordx4 v[48:51], v238, s[12:15], s39 offen
    s_add_u32 s39, s39, 16384
    buffer_load_dwordx4 v[52:55], v238, s[12:15], s39 offen
    s_add_u32 s39, s39, 16384
    buffer_load_dwordx4 v[56:59], v238, s[12:15], s39 offen
    s_add_u32 s39, s39, 16384
    buffer_load_dwordx4 v[60:63], v238, s[12:15], s39 offen
    s_add_u32 s39, s39, 16384
    s_waitcnt vmcnt(8)
    buffer_load_dwordx4 v[64:67], v238, s[12:15], s39 offen
    s_add_u32 s39, s39, 16384
    buffer_load_dwordx4 v[68:71], v238, s[12:15], s39 offen
    s_add_u32 s39, s39, 16384
    buffer_load_dwordx4 v[72:75], v238, s[12:15], s39 offen
    s_add_u32 s39, s39, 16384
    buffer_load_dwordx4 v[76:79], v238, s[12:15], s39 offen
    s_add_u32 s39, s39, 16384
    s_waitcnt vmcnt(8)
    buffer_load_dwordx4 v[80:83], v238, s[12:15], s39 offen
    s_add_u32 s39, s39, 16384
    buffer_load_dwordx4 v[84:87], v238, s[12:15], s39 offen
    s_add_u32 s39, s39, 16384
    buffer_load_dwordx4 v[88:91], v238, s[12:15], s39 offen
    s_add_u32 s39, s39, 16384
    buffer_load_dwordx4 v[92:95], v238, s[12:15], s39 offen
    s_add_u32 s39, s39, 16384
    s_waitcnt vmcnt(8)
    buffer_load_dwordx4 v[96:99], v238, s[12:15], s39 offen
    s_add_u32 s39, s39, 16384
    buffer_load_dwordx4 v[100:103], v238, s[12:15], s39 offen
    s_add_u32 s39, s39, 16384
    buffer_load_dwordx4 v[104:107], v238, s[12:15], s39 offen
    s_add_u32 s39, s39, 16384
    buffer_load_dwordx4 v[108:111], v238, s[12:15], s39 offen
    s_add_u32 s39, s39, 16384
    s_waitcnt vmcnt(8)
    buffer_load_dwordx4 v[112:115], v238, s[12:15], s39 offen
    s_add_u32 s39, s39, 16384
    buffer_load_dwordx4 v[116:119], v238, s[12:15], s39 offen
    s_add_u32 s39, s39, 16384
    buffer_load_dwordx4 v[120:123], v238, s[12:15], s39 offen
    s_add_u32 s39, s39, 16384
    buffer_load_dwordx4 v[124:127], v238, s[12:15], s39 offen
    s_add_u32 s39, s39, 16384
    s_waitcnt vmcnt(8)
    buffer_load_dwordx4 v[128:131], v238, s[12:15], s39 offen
    s_add_u32 s39, s39, 16384
    buffer_load_dwordx4 v[132:135], v238, s[12:15], s39 offen
    s_add_u32 s39, s39, 16384
    buffer_load_dwordx4 v[136:139], v238, s[12:15], s39 offen
    s_add_u32 s39, s39, 16384
    buffer_load_dwordx4 v[140:143], v238, s[12:15], s39 offen
    s_add_u32 s39, s39, 16384
    s_waitcnt vmcnt(8)
    buffer_load_dwordx4 v[144:147], v238, s[12:15], s39 offen
    s_add_u32 s39, s39, 16384
    buffer_load_dwordx4 v[148:151], v238, s[12:15], s39 offen
    s_add_u32 s39, s39, 16384
    buffer_load_dwordx4 v[152:155], v238, s[12:15], s39 offen
    s_add_u32 s39, s39, 16384
    buffer_load_dwordx4 v[156:159], v238, s[12:15], s39 offen
    s_add_u32 s39, s39, 16384
    s_waitcnt vmcnt(8)
    buffer_load_dwordx4 v[160:163], v238, s[12:15], s39 offen
    s_add_u32 s39, s39, 16384
    buffer_load_dwordx4 v[164:167], v238, s[12:15], s39 offen
    s_add_u32 s39, s39, 16384
    buffer_load_dwordx4 v[168:171], v238, s[12:15], s39 offen
    s_add_u32 s39, s39, 16384
    buffer_load_dwordx4 v[172:175], v238, s[12:15], s39 offen
    s_add_u32 s39, s39, 16384
    s_waitcnt vmcnt(8)
    s_setpc_b64 s[76:77]
SUB_w1_put:
    s_and_b32 s35, s30, 3
    s_mul_i32 s35, s35, 18432
    v_add_u32 v8, s35, v2
    v_mov_b32 v6, 162820
spin_77:
    s_sleep 2
    ds_read_b32 v7, v6
    s_waitcnt lgkmcnt(0)
    v_readfirstlane_b32 s53, v7
    s_nop 0
    s_cmp_ge_u32 s53, 16
    s_cbranch_scc0 spin_77
    s_waitcnt vmcnt(0)
    ds_write_b128 v8, v[176:179] offset:24576
    ds_write_b128 v8, v[188:191] offset:25600
    ds_write_b128 v8, v[192:195] offset:26624
    ds_write_b128 v8, v[200:203] offset:27648
    ds_write_b128 v8, v[204:207] offset:28672
    ds_write_b128 v8, v[208:211] offset:29696
    ds_write_b128 v8, v[212:215] offset:30720
    ds_write_b128 v8, v[216:219] offset:31744
    ds_write_b128 v8, v[220:223] offset:32768
    ds_write_b128 v8, v[224:227] offset:33792
    ds_write_b128 v8, v[16:19] offset:34816
    ds_write_b128 v8, v[20:23] offset:35840
    ds_write_b128 v8, v[24:27] offset:36864
    ds_write_b128 v8, v[28:31] offset:37888
    ds_write_b128 v8, v[32:35] offset:38912
    ds_write_b128 v8, v[36:39] offset:39936
    ds_write_b128 v8, v[40:43] offset:40960
    ds_write_b128 v8, v[44:47] offset:41984
    s_waitcnt lgkmcnt(0)
    s_setpc_b64 s[76:77]
SUB_after_g1:
    s_mov_b64 s[12:13], s[72:73]
    s_mov_b32 s14, 7340032
    s_mov_b32 s15, 0x20000
    v_readlane_b32 s36, v251, 0
    v_readlane_b32 s37, v251, 1
    s_and_b32 s35, s30, 3
    s_mul_i32 s38, s35, 114688
    s_mul_i32 s39, s29, 448
    s_add_u32 s38, s38, s39
    s_and_b32 s36, s36, 15
    s_mul_i32 s36, s36, 458752
    s_add_u32 s36, s36, s38
    s_and_b32 s37, s37, 15
    s_mul_i32 s37, s37, 458752
    s_add_u32 s37, s37, s38
    s_mul_i32 s39, s35, 7168
    s_add_u32 m0, s39, 131072
    s_nop 0
    buffer_load_dwordx4 v241, s[12:15], s36 offen lds
    s_add_u32 m0, m0, 1024
    s_nop 0
    buffer_load_dwordx4 v242, s[12:15], s36 offen lds
    s_add_u32 m0, m0, 1024
    s_nop 0
    buffer_load_dwordx4 v243, s[12:15], s36 offen lds
    s_add_u32 m0, m0, 1024
    s_nop 0
    buffer_load_dwordx4 v244, s[12:15], s36 offen lds
    s_add_u32 m0, m0, 1024
    s_nop 0
    buffer_load_dwordx4 v245, s[12:15], s36 offen lds
    s_add_u32 m0, m0, 1024
    s_nop 0
    buffer_load_dwordx4 v246, s[12:15], s36 offen lds
    s_add_u32 m0, m0, 1024
    s_nop 0
    buffer_load_dwordx4 v247, s[12:15], s36 offen lds
    buffer_load_dwordx4 v[208:211], v241, s[12:15], s37 offen
    buffer_load_dwordx4 v[212:215], v242, s[12:15], s37 offen
    buffer_load_dwordx4 v[216:219], v243, s[12:15], s37 offen
    buffer_load_dwordx4 v[220:223], v244, s[12:15], s37 offen
    buffer_load_dwordx4 v[224:227], v245, s[12:15], s37 offen
    buffer_load_dwordx4 v[228:231], v246, s[12:15], s37 offen
    buffer_load_dwordx4 v[232:235], v247, s[12:15], s37 offen
    s_lshr_b32 s36, s67, 2
    s_sub_u32 s36, s35, s36
    s_and_b32 s36, s36, 3
    s_lshl_b32 s36, s36, 15
    v_add_u32 v6, s36, v2
    s_waitcnt vmcnt(14)
    ds_write_b128 v6, v[48:51] offset:0
    ds_write_b128 v6, v[52:55] offset:1024
    ds_write_b128 v6, v[56:59] offset:2048
    ds_write_b128 v6, v[60:63] offset:3072
    ds_write_b128 v6, v[64:67] offset:4096
    ds_write_b128 v6, v[68:71] offset:5120
    ds_write_b128 v6, v[72:75] offset:6144
    ds_write_b128 v6, v[76:79] offset:7168
    ds_write_b128 v6, v[80:83] offset:8192
    ds_write_b128 v6, v[84:87] offset:9216
    ds_write_b128 v6, v[88:91] offset:10240
    ds_write_b128 v6, v[92:95] offset:11264
    ds_write_b128 v6, v[96:99] offset:12288
    ds_write_b128 v6, v[100:103] offset:13312
    ds_write_b128 v6, v[104:107] offset:14336
    ds_write_b128 v6, v[108:111] offset:15360
    ds_write_b128 v6, v[112:115] offset:16384
    ds_write_b128 v6, v[116:119] offset:17408
    ds_write_b128 v6, v[120:123] offset:18432
    ds_write_b128 v6, v[124:127] offset:19456
    ds_write_b128 v6, v[128:131] offset:20480
    ds_write_b128 v6, v[132:135] offset:21504
    ds_write_b128 v6, v[136:139] offset:22528
    ds_write_b128 v6, v[140:143] offset:23552
    ds_write_b128 v6, v[144:147] offset:24576
    ds_write_b128 v6, v[148:151] offset:25600
    ds_write_b128 v6, v[152:155] offset:26624
    ds_write_b128 v6, v[156:159] offset:27648
    ds_write_b128 v6, v[160:163] offset:28672
    ds_write_b128 v6, v[164:167] offset:29696
    ds_write_b128 v6, v[168:171] offset:30720
    ds_write_b128 v6, v[172:175] offset:31744
    s_waitcnt lgkmcnt(0)
    s_setpc_b64 s[76:77]
SUB_after_g2:
    s_and_b32 s35, s30, 3
    s_mul_i32 s39, s35, 7168
    s_add_u32 s39, s39, 73728
    v_add_u32 v6, s39, v2
    ds_write_b128 v6, v[208:211] offset:0
    ds_write_b128 v6, v[212:215] offset:1024
    ds_write_b128 v6, v[216:219] offset:2048
    ds_write_b128 v6, v[220:223] offset:3072
    ds_write_b128 v6, v[224:227] offset:4096
    ds_write_b128 v6, v[228:231] offset:5120
    ds_write_b128 v6, v[232:235] offset:6144
    s_waitcnt lgkmcnt(0)
    s_setpc_b64 s[76:77]
SUB_r_pre0:
    s_waitcnt lgkmcnt(0)
    v_and_b32 v199, 7, v0
    v_lshrrev_b32 v236, 6, v0
    v_lshlrev_b32 v236, 4, v236
    v_bfe_u32 v237, v0, 3, 3
    v_add_u32 v236, v236, v237
    s_lshr_b32 s78, s29, 1
    s_lshl_b32 s78, s78, 16
    s_and_b32 s79, s29, 1
    s_lshl_b32 s79, s79, 7
    s_add_u32 s78, s78, s79
    s_lshr_b32 s79, s30, 1
    s_lshl_b32 s79, s79, 13
    s_add_u32 s78, s78, s79
    v_lshlrev_b32 v196, 8, v236
    v_lshl_add_u32 v196, v199, 4, v196
    v_add_u32 v196, s78, v196
    s_lshl_b32 s78, s28, 7
    s_lshl_b32 s79, s29, 3
    s_add_u32 s78, s78, s79
    v_add_u32 v197, s78, v199
    v_lshlrev_b32 v198, 11, v197
    v_lshrrev_b32 v237, 2, v236
    v_lshlrev_b32 v237, 3, v237
    v_and_b32 v236, 3, v236
    v_add_u32 v236, v236, v237
    v_lshl_add_u32 v198, v236, 3, v198
    v_lshlrev_b32 v197, 3, v197
    v_lshl_add_u32 v197, v236, 14, v197
    s_mov_b32 s84, s62
    s_mov_b32 s85, s63
    s_mov_b32 s86, 0x7e000
    s_mov_b32 s87, 0x20000
    s_add_u32 s88, s62, 0x80000
    s_addc_u32 s89, s63, 0
    s_mov_b32 s90, 0x7e000
    s_mov_b32 s91, 0x20000
    s_cmp_eq_u32 s60, 0
    s_cselect_b32 s86, s86, 0
    s_cselect_b32 s90, s90, 0
    buffer_load_dwordx4 v[180:183], v196, s[84:87], 0 offen offset:0 sc1
    buffer_load_dwordx4 v[188:191], v196, s[88:91], 0 offen offset:0 sc1
    buffer_load_dwordx4 v[184:187], v196, s[84:87], 0 offen offset:2048 sc1
    buffer_load_dwordx4 v[192:195], v196, s[88:91], 0 offen offset:2048 sc1
    s_add_u32 s80, s4, 0x1c00000
    s_addc_u32 s81, s5, 0
    s_mov_b32 s82, 0x400000
    s_mov_b32 s83, 0x20000
    s_cmp_eq_u32 s60, 0
    s_cselect_b32 s82, s82, 0
    s_mov_b32 s78, 0
    buffer_load_dwordx2 v[230:231], v197, s[80:83], s78 offen sc1
    s_mov_b32 s78, 65536
    buffer_load_dwordx2 v[232:233], v197, s[80:83], s78 offen sc1
    s_mov_b32 s78, 262144
    buffer_load_dwordx2 v[234:235], v197, s[80:83], s78 offen sc1
    s_mov_b32 s78, 327680
    buffer_load_dwordx2 v[236:237], v197, s[80:83], s78 offen sc1
    s_setpc_b64 s[76:77]
SUB_w_issue_1:
    s_add_u32 s19, s41, s42
    s_mul_i32 s16, s44, 131072
    s_add_u32 s16, s16, s38
    s_add_u32 s44, s44, 1
    s_and_b32 s44, s44, 15
    s_add_u32 s42, s42, 8192
    s_cmp_eq_u32 s42, 131072
    s_cselect_b32 s42, 0, s42
    s_mov_b32 m0, s19
    s_mov_b32 s39, s16
    buffer_load_dwordx4 v238, s[12:15], s39 offen lds
    s_add_u32 m0, m0, 1024
    s_add_u32 s39, s39, 16384
    buffer_load_dwordx4 v238, s[12:15], s39 offen lds
    s_add_u32 m0, m0, 1024
    s_add_u32 s39, s39, 16384
    buffer_load_dwordx4 v238, s[12:15], s39 offen lds
    s_add_u32 m0, m0, 1024
    s_add_u32 s39, s39, 16384
    buffer_load_dwordx4 v238, s[12:15], s39 offen lds
    s_setpc_b64 s[76:77]
PREP_a_issue_4:
    s_add_u32 s19, s41, s42
    v_readlane_b32 s16, v249, s44
    v_readlane_b32 s17, v250, s44
    s_add_u32 s16, s16, s38
    s_add_u32 s17, s17, s38
    s_add_u32 s44, s44, 1
    s_add_u32 s42, s42, 16384
    s_cmp_eq_u32 s42, 49152
    s_cselect_b32 s42, 0, s42
    s_setpc_b64 s[76:77]
PREP_w_issue_4:
    s_mov_b32 s45, 8192
    s_add_u32 s19, s41, s42
    v_readlane_b32 s16, v249, s44
    s_nop 0
    s_bitcmp1_b32 s16, 0
    s_cselect_b32 s17, 16384, s45
    s_cselect_b32 s18, -40960, s45
    s_andn2_b32 s16, s16, 1
    s_add_u32 s16, s16, s38
    s_add_u32 s44, s44, 1
    s_add_u32 s42, s42, 16384
    s_cmp_eq_u32 s42, 98304
    s_cselect_b32 s42, 0, s42
    s_setpc_b64 s[76:77]
K_end:
    s_endpgm
.p2align 6
K_tab:
.short 4096,5137,6178,11379,18660,25941,33222,40503,47784,55065,12426,19707,26988,34269,41550,48831,56096,9264,10448,20736,23824,25008,35296,38384,39568,49856,52944,54128,0,0,0,0
.short 4096,5137,6178,11379,18660,25941,33222,40503,47784,55065,12426,19707,26988,34269,41550,48831,56096,9264,10448,20736,23824,25008,35296,38384,39568,49856,52944,54128,0,0,0,0
.short 4096,5137,6178,11379,18660,25941,33222,40503,47784,55065,12426,19707,26988,34269,41550,48831,56096,9264,10448,20736,23824,25008,35296,38384,39568,49856,52944,54128,0,0,0,0
.short 4096,5137,6178,11379,18660,25941,33222,40503,47784,55065,12426,19707,26988,34269,41550,48831,56096,9264,10448,20736,23824,25008,35296,38384,39568,49856,52944,54128,0,0,0,0
.short 11377,12418,13459,18660,25941,33222,40503,47784,55065,4106,19707,26988,34269,41550,48831,56096,5136,16544,17728,28016,31104,32288,42576,45664,46848,57136,2880,3168,0,0,0,0
.short 11377,12418,13459,18660,25941,33222,40503,47784,55065,4106,19707,26988,34269,41550,48831,56096,5136,16544,17728,28016,31104,32288,42576,45664,46848,57136,2880,3168,0,0,0,0
.short 11377,12418,13459,18660,25941,33222,40503,47784,55065,4106,19707,26988,34269,41550,48831,56096,5136,16544,17728,28016,31104,32288,42576,45664,46848,57136,2880,3168,0,0,0,0
.short 11377,12418,13459,18660,25941,33222,40503,47784,55065,4106,19707,26988,34269,41550,48831,56096,5136,16544,17728,28016,31104,32288,42576,45664,46848,57136,2880,3168,0,0,0,0
.short 18658,19699,20740,25941,33222,40503,47784,55065,4106,11387,26988,34269,41550,48831,56096,5137,12416,23824,25008,35296,38384,39568,49856,52944,54128,6176,9264,10448,0,0,0,0
.short 18658,19699,20740,25941,33222,40503,47784,55065,4106,11387,26988,34269,41550,48831,56096,5137,12416,23824,25008,35296,38384,39568,49856,52944,54128,6176,9264,10448,0,0,0,0
.short 18658,19699,20740,25941,33222,40503,47784,55065,4106,11387,26988,34269,41550,48831,56096,5137,12416,23824,25008,35296,38384,39568,49856,52944,54128,6176,9264,10448,0,0,0,0
.short 18658,19699,20740,25941,33222,40503,47784,55065,4106,11387,26988,34269,41550,48831,56096,5137,12416,23824,25008,35296,38384,39568,49856,52944,54128,6176,9264,10448,0,0,0,0
.short 25939,26980,28021,33222,40503,47784,55065,4106,11387,18668,34269,41550,48831,56096,5137,12418,19696,31104,32288,42576,45664,46848,57136,2880,3168,13456,16544,17728,0,0,0,0
.short 25939,26980,28021,33222,40503,47784,55065,4106,11387,18668,34269,41550,48831,56096,5137,12418,19696,31104,32288,42576,45664,46848,57136,2880,3168,13456,16544,17728,0,0,0,0
.short 25939,26980,28021,33222,40503,47784,55065,4106,11387,18668,34269,41550,48831,56096,5137,12418,19696,31104,32288,42576,45664,46848,57136,2880,3168,13456,16544,17728,0,0,0,0
.short 25939,26980,28021,33222,40503,47784,55065,4106,11387,18668,34269,41550,48831,56096,5137,12418,19696,31104,32288,42576,45664,46848,57136,2880,3168,13456,16544,17728,0,0,0,0
.short 33220,34261,35302,40503,47784,55065,4106,11387,18668,25949,41550,48831,56096,5137,12418,19699,26976,38384,39568,49856,52944,54128,6176,9264,10448,20736,23824,25008,0,0,0,0
.short 33220,34261,35302,40503,47784,55065,4106,11387,18668,25949,41550,48831,56096,5137,12418,19699,26976,38384,39568,49856,52944,54128,6176,9264,10448,20736,23824,25008,0,0,0,0
.short 33220,34261,35302,40503,47784,55065,4106,11387,18668,25949,41550,48831,56096,5137,12418,19699,26976,38384,39568,49856,52944,54128,6176,9264,10448,20736,23824,25008,0,0,0,0
.short 33220,34261,35302,40503,47784,55065,4106,11387,18668,25949,41550,48831,56096,5137,12418,19699,26976,38384,39568,49856,52944,54128,6176,9264,10448,20736,23824,25008,0,0,0,0
.short 40501,41542,42583,47784,55065,4106,11387,18668,25949,33230,48831,56096,5137,12418,19699,26980,34256,45664,46848,57136,2880,3168,13456,16544,17728,28016,31104,32288,0,0,0,0
.short 40501,41542,42583,47784,55065,4106,11387,18668,25949,33230,48831,56096,5137,12418,19699,26980,34256,45664,46848,57136,2880,3168,13456,16544,17728,28016,31104,32288,0,0,0,0
.short 40501,41542,42583,47784,55065,4106,11387,18668,25949,33230,48831,56096,5137,12418,19699,26980,34256,45664,46848,57136,2880,3168,13456,16544,17728,28016,31104,32288,0,0,0,0
.short 40501,41542,42583,47784,55065,4106,11387,18668,25949,33230,48831,56096,5137,12418,19699,26980,34256,45664,46848,57136,2880,3168,13456,16544,17728,28016,31104,32288,0,0,0,0
.short 47782,48823,49864,55065,4106,11387,18668,25949,33230,40511,56096,5137,12418,19699,26980,34261,41536,52944,54128,6176,9264,10448,20736,23824,25008,35296,38384,39568,0,0,0,0
.short 47782,48823,49864,55065,4106,11387,18668,25949,33230,40511,56096,5137,12418,19699,26980,34261,41536,52944,54128,6176,9264,10448,20736,23824,25008,35296,38384,39568,0,0,0,0
.short 47782,48823,49864,55065,4106,11387,18668,25949,33230,40511,56096,5137,12418,19699,26980,34261,41536,52944,54128,6176,9264,10448,20736,23824,25008,35296,38384,39568,0,0,0,0
.short 47782,48823,49864,55065,4106,11387,18668,25949,33230,40511,56096,5137,12418,19699,26980,34261,41536,52944,54128,6176,9264,10448,20736,23824,25008,35296,38384,39568,0,0,0,0
.short 55063,56104,57145,4106,11387,18668,25949,33230,40511,47776,5137,12418,19699,26980,34261,41542,48816,2880,3168,13456,16544,17728,28016,31104,32288,42576,45664,46848,0,0,0,0
.short 55063,56104,57145,4106,11387,18668,25949,33230,40511,47776,5137,12418,19699,26980,34261,41542,48816,2880,3168,13456,16544,17728,28016,31104,32288,42576,45664,46848,0,0,0,0
.short 55063,56104,57145,4106,11387,18668,25949,33230,40511,47776,5137,12418,19699,26980,34261,41542,48816,2880,3168,13456,16544,17728,28016,31104,32288,42576,45664,46848,0,0,0,0
.short 55063,56104,57145,4106,11387,18668,25949,33230,40511,47776,5137,12418,19699,26980,34261,41542,48816,2880,3168,13456,16544,17728,28016,31104,32288,42576,45664,46848,0,0,0,0
.short 4104,5145,6186,11387,18668,25949,33230,40511,47776,55057,12418,19699,26980,34261,41542,48823,56096,9264,10448,20736,23824,25008,35296,38384,39568,49856,52944,54128,0,0,0,0
.short 4104,5145,6186,11387,18668,25949,33230,40511,47776,55057,12418,19699,26980,34261,41542,48823,56096,9264,10448,20736,23824,25008,35296,38384,39568,49856,52944,54128,0,0,0,0
.short 4104,5145,6186,11387,18668,25949,33230,40511,47776,55057,12418,19699,26980,34261,41542,48823,56096,9264,10448,20736,23824,25008,35296,38384,39568,49856,52944,54128,0,0,0,0
.short 4104,5145,6186,11387,18668,25949,33230,40511,47776,55057,12418,19699,26980,34261,41542,48823,56096,9264,10448,20736,23824,25008,35296,38384,39568,49856,52944,54128,0,0,0,0
.short 11385,12426,13467,18668,25949,33230,40511,47776,55057,4098,19699,26980,34261,41542,48823,56104,5136,16544,17728,28016,31104,32288,42576,45664,46848,57136,2880,3168,0,0,0,0
.short 11385,12426,13467,18668,25949,33230,40511,47776,55057,4098,19699,26980,34261,41542,48823,56104,5136,16544,17728,28016,31104,32288,42576,45664,46848,57136,2880,3168,0,0,0,0
.short 11385,12426,13467,18668,25949,33230,40511,47776,55057,4098,19699,26980,34261,41542,48823,56104,5136,16544,17728,28016,31104,32288,42576,45664,46848,57136,2880,3168,0,0,0,0
.short 11385,12426,13467,18668,25949,33230,40511,47776,55057,4098,19699,26980,34261,41542,48823,56104,5136,16544,17728,28016,31104,32288,42576,45664,46848,57136,2880,3168,0,0,0,0
.short 18666,19707,20748,25949,33230,40511,47776,55057,4098,11379,26980,34261,41542,48823,56104,5145,12416,23824,25008,35296,38384,39568,49856,52944,54128,6176,9264,10448,0,0,0,0
.short 18666,19707,20748,25949,33230,40511,47776,55057,4098,11379,26980,34261,41542,48823,56104,5145,12416,23824,25008,35296,38384,39568,49856,52944,54128,6176,9264,10448,0,0,0,0
.short 18666,19707,20748,25949,33230,40511,47776,55057,4098,11379,26980,34261,41542,48823,56104,5145,12416,23824,25008,35296,38384,39568,49856,52944,54128,6176,9264,10448,0,0,0,0
.short 18666,19707,20748,25949,33230,40511,47776,55057,4098,11379,26980,34261,41542,48823,56104,5145,12416,23824,25008,35296,38384,39568,49856,52944,54128,6176,9264,10448,0,0,0,0
.short 25947,26988,28029,33230,40511,47776,55057,4098,11379,18660,34261,41542,48823,56104,5145,12426,19696,31104,32288,42576,45664,46848,57136,2880,3168,13456,16544,17728,0,0,0,0
.short 25947,26988,28029,33230,40511,47776,55057,4098,11379,18660,34261,41542,48823,56104,5145,12426,19696,31104,32288,42576,45664,46848,57136,2880,3168,13456,16544,17728,0,0,0,0
.short 25947,26988,28029,33230,40511,47776,55057,4098,11379,18660,34261,41542,48823,56104,5145,12426,19696,31104,32288,42576,45664,46848,57136,2880,3168,13456,16544,17728,0,0,0,0
.short 25947,26988,28029,33230,40511,47776,55057,4098,11379,18660,34261,41542,48823,56104,5145,12426,19696,31104,32288,42576,45664,46848,57136,2880,3168,13456,16544,17728,0,0,0,0
.short 33228,34269,35310,40511,47776,55057,4098,11379,18660,25941,41542,48823,56104,5145,12426,19707,26976,38384,39568,49856,52944,54128,6176,9264,10448,20736,23824,25008,0,0,0,0
.short 33228,34269,35310,40511,47776,55057,4098,11379,18660,25941,41542,48823,56104,5145,12426,19707,26976,38384,39568,49856,52944,54128,6176,9264,10448,20736,23824,25008,0,0,0,0
.short 33228,34269,35310,40511,47776,55057,4098,11379,18660,25941,41542,48823,56104,5145,12426,19707,26976,38384,39568,49856,52944,54128,6176,9264,10448,20736,23824,25008,0,0,0,0
.short 33228,34269,35310,40511,47776,55057,4098,11379,18660,25941,41542,48823,56104,5145,12426,19707,26976,38384,39568,49856,52944,54128,6176,9264,10448,20736,23824,25008,0,0,0,0
.short 40509,41550,42591,47776,55057,4098,11379,18660,25941,33222,48823,56104,5145,12426,19707,26988,34256,45664,46848,57136,2880,3168,13456,16544,17728,28016,31104,32288,0,0,0,0
.short 40509,41550,42591,47776,55057,4098,11379,18660,25941,33222,48823,56104,5145,12426,19707,26988,34256,45664,46848,57136,2880,3168,13456,16544,17728,28016,31104,32288,0,0,0,0
.short 40509,41550,42591,47776,55057,4098,11379,18660,25941,33222,48823,56104,5145,12426,19707,26988,34256,45664,46848,57136,2880,3168,13456,16544,17728,28016,31104,32288,0,0,0,0
.short 40509,41550,42591,47776,55057,4098,11379,18660,25941,33222,48823,56104,5145,12426,19707,26988,34256,45664,46848,57136,2880,3168,13456,16544,17728,28016,31104,32288,0,0,0,0
.short 47790,48831,49856,55057,4098,11379,18660,25941,33222,40503,56104,5145,12426,19707,26988,34269,41536,52944,54128,6176,9264,10448,20736,23824,25008,35296,38384,39568,0,0,0,0
.short 47790,48831,49856,55057,4098,11379,18660,25941,33222,40503,56104,5145,12426,19707,26988,34269,41536,52944,54128,6176,9264,10448,20736,23824,25008,35296,38384,39568,0,0,0,0
.short 47790,48831,49856,55057,4098,11379,18660,25941,33222,40503,56104,5145,12426,19707,26988,34269,41536,52944,54128,6176,9264,10448,20736,23824,25008,35296,38384,39568,0,0,0,0
.short 47790,48831,49856,55057,4098,11379,18660,25941,33222,40503,56104,5145,12426,19707,26988,34269,41536,52944,54128,6176,9264,10448,20736,23824,25008,35296,38384,39568,0,0,0,0
.short 55071,56096,57137,4098,11379,18660,25941,33222,40503,47784,5145,12426,19707,26988,34269,41550,48816,2880,3168,13456,16544,17728,28016,31104,32288,42576,45664,46848,0,0,0,0
.short 55071,56096,57137,4098,11379,18660,25941,33222,40503,47784,5145,12426,19707,26988,34269,41550,48816,2880,3168,13456,16544,17728,28016,31104,32288,42576,45664,46848,0,0,0,0
.short 55071,56096,57137,4098,11379,18660,25941,33222,40503,47784,5145,12426,19707,26988,34269,41550,48816,2880,3168,13456,16544,17728,28016,31104,32288,42576,45664,46848,0,0,0,0
.short 55071,56096,57137,4098,11379,18660,25941,33222,40503,47784,5145,12426,19707,26988,34269,41550,48816,2880,3168,13456,16544,17728,28016,31104,32288,42576,45664,46848,0,0,0,0
.section .rodata,"a"
.p2align 6
.amdhsa_kernel interleave_layers__ssm_conv_h3__mixer_s_mlp__prompt_kernel
  .amdhsa_next_free_vgpr 256
  .amdhsa_next_free_sgpr 102
  .amdhsa_accum_offset 256
  .amdhsa_group_segment_fixed_size 0
  .amdhsa_kernarg_size 112
  .amdhsa_user_sgpr_count 2
  .amdhsa_user_sgpr_kernarg_segment_ptr 1
  .amdhsa_system_sgpr_workgroup_id_x 1
  .amdhsa_float_denorm_mode_32 3
.end_amdhsa_kernel
```

```asm
; @launch grid=(256,1,1) block=(512,1,1) lds=163840
.amdgcn_target "amdgcn-amd-amdhsa--gfx950"
.text
.globl interleave_layers__ssm_conv_h3__mixer_s_mlp__prompt_kernel
.p2align 8
.type interleave_layers__ssm_conv_h3__mixer_s_mlp__prompt_kernel,@function
interleave_layers__ssm_conv_h3__mixer_s_mlp__prompt_kernel:
    s_cmp_ge_u32 s2, 256
    s_cbranch_scc1 K_end
    s_load_dwordx8 s[8:15], s[0:1], 8
    s_load_dwordx2 s[6:7], s[0:1], 0
    s_load_dwordx8 s[68:75], s[0:1], 56
    s_load_dwordx2 s[4:5], s[0:1], 104
    s_load_dwordx2 s[84:85], s[0:1], 96
    s_memrealtime s[46:47]
    s_load_dwordx2 s[96:97], s[0:1], 40
    v_lshrrev_b32 v1, 6, v0
    s_nop 0
    v_readfirstlane_b32 s30, v1
    s_getpc_b64 s[48:49]
K_pc:
    s_lshr_b32 s36, s2, 3
    s_lshl_b32 s36, s36, 11
    v_lshlrev_b32 v4, 2, v0
    v_add_u32 v4, s36, v4
    v_cmp_gt_u32 vcc, K_end-K_pc-8, v4
    s_nop 0
    s_and_saveexec_b64 s[36:37], vcc
    s_cbranch_execz K_3
    v_mov_b32 v5, s49
    v_add_co_u32 v4, vcc, s48, v4
    s_nop 1
    v_addc_co_u32 v5, vcc, 0, v5, vcc
    global_load_dword v250, v[4:5], off
K_3:
    s_mov_b64 exec, -1
    v_and_b32 v6, 31, v0
    v_lshrrev_b32 v7, 5, v0
    s_and_b32 s34, s2, 7
    s_lshr_b32 s35, s2, 3
    s_lshl_b32 s36, s35, 17
    s_lshl_b32 s37, s34, 8
    s_add_u32 s36, s36, s37
    v_lshlrev_b32 v8, 13, v7
    v_lshl_add_u32 v8, v6, 3, v8
    v_add_u32 v12, s36, v8
    v_add_u32 v14, 4096, v12
    s_mov_b32 s18, 4194304
    s_mov_b32 s19, 0x20000
    s_mov_b32 s22, s18
    s_mov_b32 s23, s19
    s_waitcnt lgkmcnt(0)
    s_mov_b32 s86, 256
    s_mov_b32 s87, 0x20000
    v_mov_b32 v78, 0
    s_lshl_b32 s45, s2, 3
    s_add_u32 s45, s45, s30
    s_cmp_lg_u32 s45, 4
    s_cbranch_scc1 KV_t0
    s_lshl_b32 s44, s46, 6
    s_or_b32 s44, s44, 1
    v_mov_b32 v76, s44
    s_mov_b64 exec, 1
    buffer_store_dword v76, v78, s[84:87], 0 offen sc1
    s_mov_b64 exec, -1
KV_t0:
    s_mov_b64 s[16:17], s[8:9]
    s_mov_b64 s[20:21], s[10:11]
    buffer_load_dwordx2 v[28:29], v12, s[16:19], 0 offen offset:0 nt
    buffer_load_dwordx2 v[30:31], v12, s[16:19], 0 offen offset:2048 nt
    buffer_load_dwordx2 v[32:33], v14, s[16:19], 0 offen offset:0 nt
    buffer_load_dwordx2 v[34:35], v14, s[16:19], 0 offen offset:2048 nt
    buffer_load_dwordx2 v[36:37], v12, s[20:23], 0 offen offset:0 nt
    buffer_load_dwordx2 v[38:39], v12, s[20:23], 0 offen offset:2048 nt
    buffer_load_dwordx2 v[40:41], v14, s[20:23], 0 offen offset:0 nt
    buffer_load_dwordx2 v[42:43], v14, s[20:23], 0 offen offset:2048 nt
    v_subrev_u32 v9, 6144, v12
    v_subrev_u32 v10, 4096, v12
    v_subrev_u32 v11, 2048, v12
    s_lshl_b32 s37, s34, 10
    v_lshlrev_b32 v16, 5, v6
    v_add_u32 v16, s37, v16
    s_mov_b32 s24, s12
    s_mov_b32 s25, s13
    s_mov_b32 s26, 0x2000
    s_mov_b32 s27, 0x20000
    buffer_load_dwordx4 v[44:47], v16, s[24:27], 0 offen offset:0
    buffer_load_dwordx4 v[48:51], v16, s[24:27], 0 offen offset:16
    s_cmp_lg_u32 s30, 4
    s_cbranch_scc1 KV_t2
    buffer_load_dword v76, v78, s[84:87], 0 offen sc1
KV_t2:
    buffer_load_dwordx2 v[22:23], v9, s[16:19], 0 offen nt
    buffer_load_dwordx2 v[24:25], v10, s[16:19], 0 offen nt
    buffer_load_dwordx2 v[26:27], v11, s[16:19], 0 offen nt
    v_and_b32 v1, 63, v0
    v_lshlrev_b32 v2, 4, v1
    v_lshlrev_b32 v3, 2, v1
    s_and_b32 s32, s2, 7
    s_lshr_b32 s33, s2, 3
    s_and_b32 s28, s32, 2
    s_lshr_b32 s34, s32, 2
    s_or_b32 s28, s28, s34
    s_lshl_b32 s28, s28, 2
    s_and_b32 s34, s33, 3
    s_add_u32 s28, s28, s34
    s_and_b32 s31, s32, 1
    s_lshr_b32 s33, s33, 2
    s_lshl_b32 s29, s31, 3
    s_add_u32 s29, s29, s33
    s_lshl_b32 s67, s33, 1
    s_and_b32 s67, s67, 0
    s_xor_b32 s99, s29, 1
    s_mov_b32 s60, 0
    s_mov_b32 s61, 40000
    s_mov_b32 s52, 0
    s_mov_b32 s55, 0
    s_mov_b32 s92, 0
    s_mov_b32 s93, 0
    s_mov_b32 s94, 0
    s_mov_b32 s56, s4
    s_mov_b32 s57, s5
    s_mov_b32 s58, 0xa000000
    s_mov_b32 s59, 0x20000
    v_and_b32 v199, 7, v0
    v_lshrrev_b32 v236, 6, v0
    v_lshlrev_b32 v236, 4, v236
    v_bfe_u32 v237, v0, 3, 3
    v_add_u32 v236, v236, v237
    s_lshr_b32 s78, s29, 1
    s_lshl_b32 s78, s78, 16
    s_and_b32 s79, s29, 1
    s_lshl_b32 s79, s79, 7
    s_add_u32 s78, s78, s79
    s_lshr_b32 s79, s30, 1
    s_lshl_b32 s79, s79, 13
    s_add_u32 s78, s78, s79
    v_lshlrev_b32 v196, 8, v236
    v_lshl_add_u32 v196, v199, 4, v196
    v_add_u32 v196, s78, v196
    s_lshl_b32 s78, s28, 7
    s_lshl_b32 s79, s29, 3
    s_add_u32 s78, s78, s79
    v_add_u32 v197, s78, v199
    v_lshlrev_b32 v198, 11, v197
    v_lshrrev_b32 v237, 2, v236
    v_lshlrev_b32 v237, 3, v237
    v_and_b32 v236, 3, v236
    v_add_u32 v236, v236, v237
    v_lshl_add_u32 v198, v236, 3, v198
    v_lshlrev_b32 v197, 3, v197
    v_lshl_add_u32 v197, v236, 14, v197
    s_add_u32 s62, s4, 33554432
    s_addc_u32 s63, s5, 0
    s_and_b32 s41, s30, 3
    s_and_b32 s38, s2, 7
    s_lshl_b32 s38, s38, 5
    s_lshr_b32 s39, s2, 3
    s_add_u32 s38, s38, s39
    s_lshl_b32 s39, s38, 2
    s_add_u32 s39, s39, s41
    s_mul_i32 s40, s41, 24576
    s_lshr_b32 s36, s39, 1
    s_lshl_b32 s36, s36, 2
    s_load_dword s98, s[96:97], s36
    s_lshl_b32 s36, s39, 12
    s_add_u32 s12, s14, s36
    s_addc_u32 s13, s15, 0
    s_mov_b32 s14, 4096
    s_mov_b32 s15, 0x20000
    s_lshr_b32 s45, s30, 2
    s_lshl_b32 s45, s45, 11
    s_add_u32 s36, s45, 0xffffffc0
    v_add_u32 v70, s36, v2
    v_add_u32 v71, 16, v70
    s_add_u32 s36, s45, 0x3c0
    v_add_u32 v72, s36, v2
    v_add_u32 v73, 16, v72
    s_mov_b32 s36, 4032
    v_add_u32 v74, s36, v2
    v_add_u32 v75, 16, v74
    s_and_b32 s34, s2, 7
    s_lshr_b32 s35, s2, 3
    v_mov_b32 v80, 0
    v_mov_b32 v81, 0
    v_mov_b32 v82, 0
    v_mov_b32 v83, 0
    v_add_u32 v86, s40, v2
    ds_write_b128 v86, v[80:83] offset:22784
    s_bfm_b64 exec, 26, 0
    ds_write_b128 v86, v[80:83] offset:23808
    s_mov_b64 exec, -1
    v_lshlrev_b32 v8, 2, v7
    v_sub_u32 v8, 60, v8
    v_lshrrev_b32 v85, 3, v8
    v_bfe_u32 v84, v6, 1, 3
    v_xor_b32 v85, v85, v84
    v_lshlrev_b32 v85, 4, v85
    v_and_b32 v8, 7, v8
    v_lshl_add_u32 v85, v8, 1, v85
    v_lshl_add_u32 v84, v6, 9, v85
    v_add_u32 v84, 98304, v84
    s_waitcnt vmcnt(0)
    s_cmp_lg_u32 s30, 4
    s_cbranch_scc1 KV_t1
KV_t1:
    buffer_load_dwordx4 v[52:55], v70, s[12:15], 0 offen nt
    buffer_load_dwordx2 v[56:57], v71, s[12:15], 0 offen nt
    buffer_load_dwordx4 v[58:61], v72, s[12:15], 0 offen nt
    buffer_load_dwordx2 v[62:63], v73, s[12:15], 0 offen nt
    buffer_load_dwordx4 v[64:67], v74, s[12:15], 0 offen nt
    buffer_load_dwordx2 v[68:69], v75, s[12:15], 0 offen nt
    v_lshlrev_b32 v88, 16, v44
    v_and_b32 v90, 0xffff0000, v44
    v_lshlrev_b32 v92, 16, v45
    v_and_b32 v94, 0xffff0000, v45
    v_lshlrev_b32 v89, 16, v46
    v_and_b32 v91, 0xffff0000, v46
    v_lshlrev_b32 v93, 16, v47
    v_and_b32 v95, 0xffff0000, v47
    v_lshlrev_b32 v96, 16, v22
    v_and_b32 v97, 0xffff0000, v22
    v_lshlrev_b32 v98, 16, v24
    v_and_b32 v99, 0xffff0000, v24
    v_lshlrev_b32 v100, 16, v26
    v_and_b32 v101, 0xffff0000, v26
    v_lshlrev_b32 v102, 16, v28
    v_and_b32 v103, 0xffff0000, v28
    v_lshlrev_b32 v104, 16, v30
    v_and_b32 v105, 0xffff0000, v30
    v_lshlrev_b32 v106, 16, v32
    v_and_b32 v107, 0xffff0000, v32
    v_lshlrev_b32 v108, 16, v34
    v_and_b32 v109, 0xffff0000, v34
    v_lshlrev_b32 v110, 16, v36
    v_and_b32 v111, 0xffff0000, v36
    v_lshlrev_b32 v112, 16, v38
    v_and_b32 v113, 0xffff0000, v38
    v_lshlrev_b32 v114, 16, v40
    v_and_b32 v115, 0xffff0000, v40
    v_lshlrev_b32 v116, 16, v42
    v_and_b32 v117, 0xffff0000, v42
    v_pk_mul_f32 v[118:119], v[96:97], v[94:95]
    v_pk_mul_f32 v[120:121], v[98:99], v[94:95]
    v_pk_mul_f32 v[122:123], v[100:101], v[94:95]
    v_pk_mul_f32 v[124:125], v[102:103], v[94:95]
    v_pk_fma_f32 v[118:119], v[98:99], v[92:93], v[118:119]
    v_pk_fma_f32 v[120:121], v[100:101], v[92:93], v[120:121]
    v_pk_fma_f32 v[122:123], v[102:103], v[92:93], v[122:123]
    v_pk_fma_f32 v[124:125], v[104:105], v[92:93], v[124:125]
    v_pk_fma_f32 v[118:119], v[100:101], v[90:91], v[118:119]
    v_pk_fma_f32 v[120:121], v[102:103], v[90:91], v[120:121]
    v_pk_fma_f32 v[122:123], v[104:105], v[90:91], v[122:123]
    v_pk_fma_f32 v[124:125], v[106:107], v[90:91], v[124:125]
    v_pk_fma_f32 v[118:119], v[102:103], v[88:89], v[118:119]
    v_pk_fma_f32 v[120:121], v[104:105], v[88:89], v[120:121]
    v_pk_fma_f32 v[122:123], v[106:107], v[88:89], v[122:123]
    v_pk_fma_f32 v[124:125], v[108:109], v[88:89], v[124:125]
    v_pk_mul_f32 v[118:119], v[118:119], v[110:111]
    v_pk_mul_f32 v[120:121], v[120:121], v[112:113]
    v_pk_mul_f32 v[122:123], v[122:123], v[114:115]
    v_pk_mul_f32 v[124:125], v[124:125], v[116:117]
    v_cvt_pk_bf16_f32 v136, v124, v122
    v_cvt_pk_bf16_f32 v137, v120, v118
    ds_write_b64 v84, v[136:137] offset:0
    v_cvt_pk_bf16_f32 v138, v125, v123
    v_cvt_pk_bf16_f32 v139, v121, v119
    ds_write_b64 v84, v[138:139] offset:128
    v_lshlrev_b32 v88, 16, v48
    v_and_b32 v90, 0xffff0000, v48
    v_lshlrev_b32 v92, 16, v49
    v_and_b32 v94, 0xffff0000, v49
    v_lshlrev_b32 v89, 16, v50
    v_and_b32 v91, 0xffff0000, v50
    v_lshlrev_b32 v93, 16, v51
    v_and_b32 v95, 0xffff0000, v51
    v_lshlrev_b32 v96, 16, v23
    v_and_b32 v97, 0xffff0000, v23
    v_lshlrev_b32 v98, 16, v25
    v_and_b32 v99, 0xffff0000, v25
    v_lshlrev_b32 v100, 16, v27
    v_and_b32 v101, 0xffff0000, v27
    v_lshlrev_b32 v102, 16, v29
    v_and_b32 v103, 0xffff0000, v29
    v_lshlrev_b32 v104, 16, v31
    v_and_b32 v105, 0xffff0000, v31
    v_lshlrev_b32 v106, 16, v33
    v_and_b32 v107, 0xffff0000, v33
    v_lshlrev_b32 v108, 16, v35
    v_and_b32 v109, 0xffff0000, v35
    v_lshlrev_b32 v110, 16, v37
    v_and_b32 v111, 0xffff0000, v37
    v_lshlrev_b32 v112, 16, v39
    v_and_b32 v113, 0xffff0000, v39
    v_lshlrev_b32 v114, 16, v41
    v_and_b32 v115, 0xffff0000, v41
    v_lshlrev_b32 v116, 16, v43
    v_and_b32 v117, 0xffff0000, v43
    v_pk_mul_f32 v[118:119], v[96:97], v[94:95]
    v_pk_mul_f32 v[120:121], v[98:99], v[94:95]
    v_pk_mul_f32 v[122:123], v[100:101], v[94:95]
    v_pk_mul_f32 v[124:125], v[102:103], v[94:95]
    v_pk_fma_f32 v[118:119], v[98:99], v[92:93], v[118:119]
    v_pk_fma_f32 v[120:121], v[100:101], v[92:93], v[120:121]
    v_pk_fma_f32 v[122:123], v[102:103], v[92:93], v[122:123]
    v_pk_fma_f32 v[124:125], v[104:105], v[92:93], v[124:125]
    v_pk_fma_f32 v[118:119], v[100:101], v[90:91], v[118:119]
    v_pk_fma_f32 v[120:121], v[102:103], v[90:91], v[120:121]
    v_pk_fma_f32 v[122:123], v[104:105], v[90:91], v[122:123]
    v_pk_fma_f32 v[124:125], v[106:107], v[90:91], v[124:125]
    v_pk_fma_f32 v[118:119], v[102:103], v[88:89], v[118:119]
    v_pk_fma_f32 v[120:121], v[104:105], v[88:89], v[120:121]
    v_pk_fma_f32 v[122:123], v[106:107], v[88:89], v[122:123]
    v_pk_fma_f32 v[124:125], v[108:109], v[88:89], v[124:125]
    v_pk_mul_f32 v[118:119], v[118:119], v[110:111]
    v_pk_mul_f32 v[120:121], v[120:121], v[112:113]
    v_pk_mul_f32 v[122:123], v[122:123], v[114:115]
    v_pk_mul_f32 v[124:125], v[124:125], v[116:117]
    v_cvt_pk_bf16_f32 v140, v124, v122
    v_cvt_pk_bf16_f32 v141, v120, v118
    ds_write_b64 v84, v[140:141] offset:256
    v_cvt_pk_bf16_f32 v142, v125, v123
    v_cvt_pk_bf16_f32 v143, v121, v119
    ds_write_b64 v84, v[142:143] offset:384
    s_cmp_lg_u32 s30, 4
    s_cbranch_scc1 HB_2
    v_add_u32 v18, 162816, v3
    ds_write_b32 v18, v78
    s_mov_b32 s53, 0
    s_waitcnt vmcnt(6)
HB_p:
    v_readfirstlane_b32 s52, v76
    s_nop 0
    s_cmp_eq_u32 s52, 0
    s_cbranch_scc1 HB_r
    s_cmp_ge_u32 s53, 400
    s_cbranch_scc1 HB_q
    s_add_u32 s54, s46, 8192
    s_lshl_b32 s54, s54, 6
    s_sub_u32 s54, s54, s52
    s_cmp_lt_u32 s54, 786432
    s_cbranch_scc1 HB_q
HB_r:
    buffer_load_dword v76, v78, s[84:87], 0 offen sc1
    s_waitcnt vmcnt(0)
    s_add_u32 s53, s53, 1
    s_cmp_lt_u32 s53, s61
    s_cbranch_scc1 HB_p
    s_mov_b32 s52, 1
    s_mov_b32 s61, 0
HB_q:
    v_mov_b32 v18, 162828
    v_mov_b32 v19, s52
    s_waitcnt lgkmcnt(0)
    ds_write_b32 v18, v19
HB_2:
    s_add_u32 s16, s4, 0x2000000
    s_addc_u32 s17, s5, 0
    s_mov_b32 s18, 0x8000000
    s_mov_b32 s19, 0x20000
    v_lshrrev_b32 v8, 3, v0
    v_and_b32 v85, 7, v0
    v_lshlrev_b32 v149, 12, v8
    v_lshl_add_u32 v149, v85, 4, v149
    s_lshl_b32 s36, s34, 24
    s_sub_u32 s37, 31, s35
    s_lshl_b32 s37, s37, 7
    s_add_u32 s36, s36, s37
    s_add_u32 s37, s36, 262144
    v_lshrrev_b32 v148, 3, v8
    v_xor_b32 v148, v148, v85
    v_lshlrev_b32 v148, 4, v148
    v_lshl_add_u32 v148, v8, 7, v148
    v_add_u32 v148, 98304, v148
    v_mov_b32 v18, 162828
    s_waitcnt lgkmcnt(0)
    s_barrier
    ds_read_b128 v[152:155], v148 offset:0
    ds_read_b128 v[156:159], v148 offset:8192
    ds_read_b32 v19, v18
    s_waitcnt lgkmcnt(2)
    v_or_b32 v152, 1, v152
    buffer_store_dwordx4 v[152:155], v149, s[16:19], s36 offen sc1
    s_waitcnt lgkmcnt(1)
    v_or_b32 v156, 1, v156
    buffer_store_dwordx4 v[156:159], v149, s[16:19], s37 offen sc1
    s_waitcnt lgkmcnt(0)
    v_readfirstlane_b32 s52, v19
    s_cmp_lg_u32 s30, 0
    s_cbranch_scc1 KV_ni
    s_cmp_ge_u32 s35, 16
    s_cbranch_scc1 KV_ni
    v_mov_b32 v8, s52
    s_lshl_b32 s37, s34, 7
    s_lshl_b32 s53, s35, 10
    s_add_u32 s37, s37, s53
    s_add_u32 s37, s37, 23101440
    s_mov_b64 exec, 1
    buffer_store_dword v8, v78, s[56:59], s37 offen sc1
    s_mov_b64 exec, -1
KV_ni:
    s_cmp_ge_u32 s2, 255
    s_cbranch_scc1 KV_n3
    s_cmp_lg_u32 s30, 5
    s_cbranch_scc1 KV_n3
    s_and_b32 s42, s2, 31
    s_lshl_b32 s42, s42, 8
    s_lshr_b32 s43, s2, 5
    s_lshl_b32 s43, s43, 14
    s_add_u32 s42, s42, s43
    s_add_u32 s42, s42, 39714816
    v_and_b32 v8, 1, v1
    v_lshlrev_b32 v8, 13, v8
    v_lshrrev_b32 v85, 1, v1
    v_lshl_add_u32 v8, v85, 7, v8
    s_mov_b64 exec, 0xf
    buffer_store_dword v8, v8, s[56:59], s42 offen sc1
    s_mov_b64 exec, -1
KV_n3:
    s_lshl_b32 s36, s34, 5
    s_add_u32 s36, s36, s35
    s_lshl_b32 s36, s36, 7
    s_add_u32 s36, s36, 23068672
    v_mov_b32 v18, 1
    v_mov_b32 v19, 162820
    v_mov_b32 v21, 0
    s_mov_b64 exec, 1
    s_waitcnt vmcnt(0)
    ds_add_rtn_u32 v20, v19, v18
    v_mov_b32 v19, s52
    s_waitcnt lgkmcnt(0)
    v_readfirstlane_b32 s54, v20
    s_nop 0
    s_and_b32 s54, s54, 7
    s_cmp_lg_u32 s54, 7
    s_cbranch_scc1 pub_1
    buffer_store_dword v19, v21, s[56:59], s36 offen sc1
pub_1:
    s_mov_b64 exec, -1
    v_add_u32 v160, s45, v86
    v_alignbit_b32 v88, v53, v52, 16
    v_mov_b32 v92, v53
    v_alignbit_b32 v96, v54, v53, 16
    v_alignbit_b32 v89, v54, v53, 16
    v_mov_b32 v93, v54
    v_alignbit_b32 v97, v55, v54, 16
    v_alignbit_b32 v90, v55, v54, 16
    v_mov_b32 v94, v55
    v_alignbit_b32 v98, v56, v55, 16
    v_alignbit_b32 v91, v56, v55, 16
    v_mov_b32 v95, v56
    v_alignbit_b32 v99, v57, v56, 16
    ds_write_b128 v160, v[88:91] offset:0
    ds_write_b128 v160, v[92:95] offset:4160
    ds_write_b128 v160, v[96:99] offset:8320
    ds_write_b128 v160, v[54:57] offset:12480
    v_alignbit_b32 v100, v59, v58, 16
    v_mov_b32 v104, v59
    v_alignbit_b32 v108, v60, v59, 16
    v_alignbit_b32 v101, v60, v59, 16
    v_mov_b32 v105, v60
    v_alignbit_b32 v109, v61, v60, 16
    v_alignbit_b32 v102, v61, v60, 16
    v_mov_b32 v106, v61
    v_alignbit_b32 v110, v62, v61, 16
    v_alignbit_b32 v103, v62, v61, 16
    v_mov_b32 v107, v62
    v_alignbit_b32 v111, v63, v62, 16
    ds_write_b128 v160, v[100:103] offset:1024
    ds_write_b128 v160, v[104:107] offset:5184
    ds_write_b128 v160, v[108:111] offset:9344
    ds_write_b128 v160, v[60:63] offset:13504
    v_alignbit_b32 v112, v65, v64, 16
    v_mov_b32 v116, v65
    v_alignbit_b32 v120, v66, v65, 16
    v_alignbit_b32 v113, v66, v65, 16
    v_mov_b32 v117, v66
    v_alignbit_b32 v121, v67, v66, 16
    v_alignbit_b32 v114, v67, v66, 16
    v_mov_b32 v118, v67
    v_alignbit_b32 v122, v68, v67, 16
    v_alignbit_b32 v115, v68, v67, 16
    v_mov_b32 v119, v68
    v_alignbit_b32 v123, v69, v68, 16
    s_mov_b64 exec, 0xf
    ds_write_b128 v86, v[112:115] offset:4096
    ds_write_b128 v86, v[116:119] offset:8256
    ds_write_b128 v86, v[120:123] offset:12416
    ds_write_b128 v86, v[66:69] offset:16576
    s_mov_b64 exec, -1
    s_waitcnt lgkmcnt(0)
    s_barrier
    v_mov_b32 v238, 0
    v_mov_b32 v239, 0
    v_mov_b32 v240, 0
    v_mov_b32 v241, 0
    v_mov_b32 v242, 0
    v_mov_b32 v243, 0
    v_mov_b32 v244, 0
    v_mov_b32 v245, 0
    v_mov_b32 v246, 0
    v_mov_b32 v247, 0
    s_cmp_ge_u32 s30, 4
    s_cbranch_scc1 FR_b
    s_and_b32 s38, s2, 7
    s_lshl_b32 s38, s38, 5
    s_lshr_b32 s39, s2, 3
    s_add_u32 s38, s38, s39
    s_lshl_b32 s39, s38, 2
    s_add_u32 s39, s39, s30
    s_mul_i32 s40, s30, 24576
    s_and_b32 s36, s39, 127
    s_lshl_b32 s36, s36, 12
    s_lshr_b32 s37, s39, 7
    s_lshl_b32 s37, s37, 24
    s_add_u32 s36, s36, s37
    s_add_u32 s36, s36, 33554432
    s_add_u32 s16, s4, s36
    s_addc_u32 s17, s5, 0
    s_mov_b32 s18, 4096
    s_mov_b32 s19, 0x20000
    v_lshrrev_b32 v6, 2, v1
    v_mul_u32_u24 v12, 96, v6
    v_and_b32 v6, 3, v1
    v_lshl_add_u32 v12, v6, 4, v12
    v_add_u32 v12, s40, v12
    v_and_b32 v35, 15, v1
    v_lshrrev_b32 v36, 4, v1
    v_and_b32 v6, 3, v35
    v_mul_u32_u24 v32, 4160, v6
    v_lshl_add_u32 v32, v36, 4, v32
    v_lshrrev_b32 v6, 2, v35
    v_lshl_add_u32 v32, v6, 3, v32
    v_add_u32 v32, s40, v32
    v_sub_u32 v6, 15, v35
    v_mul_u32_u24 v34, 96, v6
    v_add_u32 v34, s40, v34
    v_lshl_add_u32 v33, v36, 4, v34
    ds_read_b64 v[72:73], v32 offset:0
    ds_read_b64 v[74:75], v32 offset:8
    ds_read_b64 v[76:77], v32 offset:32
    ds_read_b64 v[78:79], v32 offset:40
    ds_read_b64 v[80:81], v32 offset:1024
    ds_read_b64 v[82:83], v32 offset:1032
    ds_read_b64 v[84:85], v32 offset:1056
    ds_read_b64 v[86:87], v32 offset:1064
    ds_read_b64 v[88:89], v32 offset:2048
    ds_read_b64 v[90:91], v32 offset:2056
    ds_read_b64 v[92:93], v32 offset:2080
    ds_read_b64 v[94:95], v32 offset:2088
    ds_read_b64 v[96:97], v32 offset:3072
    ds_read_b64 v[98:99], v32 offset:3080
    ds_read_b64 v[100:101], v32 offset:3104
    ds_read_b64 v[102:103], v32 offset:3112
    s_bitcmp1_b32 s39, 0
    s_cselect_b32 s36, 0, 16
    s_lshl_b32 s41, s98, s36
    s_and_b32 s41, s41, 0xffff0000
    s_lshr_b32 s36, s41, 16
    v_lshl_add_u32 v6, v36, 3, v35
    v_sub_u32 v6, 31, v6
    v_mov_b32 v10, s36
    v_mov_b32 v11, s41
    v_and_b32 v8, 1, v6
    v_cmp_eq_u32 vcc, 1, v8
    s_nop 1
    v_cndmask_b32 v10, v10, v11, vcc
    v_ashrrev_i32 v6, 1, v6
    v_cmp_eq_u32 vcc, 0, v6
    s_nop 1
    v_cndmask_b32 v152, 0, v10, vcc
    v_cmp_eq_u32 vcc, 1, v6
    s_nop 1
    v_cndmask_b32 v153, 0, v10, vcc
    v_cmp_eq_u32 vcc, 2, v6
    s_nop 1
    v_cndmask_b32 v154, 0, v10, vcc
    v_cmp_eq_u32 vcc, 3, v6
    s_nop 1
    v_cndmask_b32 v155, 0, v10, vcc
    v_cmp_eq_u32 vcc, 8, v6
    s_nop 1
    v_cndmask_b32 v156, 0, v10, vcc
    v_cmp_eq_u32 vcc, 9, v6
    s_nop 1
    v_cndmask_b32 v157, 0, v10, vcc
    v_cmp_eq_u32 vcc, 10, v6
    s_nop 1
    v_cndmask_b32 v158, 0, v10, vcc
    v_cmp_eq_u32 vcc, 11, v6
    s_nop 1
    v_cndmask_b32 v159, 0, v10, vcc
    s_add_u32 s12, s4, 0x1c00000
    s_addc_u32 s13, s5, 0
    s_mov_b32 s14, 0x400000
    s_mov_b32 s15, 0x20000
    v_bfe_u32 v6, v1, 2, 2
    v_mul_u32_u24 v168, 24640, v6
    v_lshrrev_b32 v6, 1, v36
    v_mul_u32_u24 v6, 72, v6
    v_add_u32 v168, v168, v6
    v_and_b32 v6, 1, v36
    v_lshl_add_u32 v168, v6, 5, v168
    v_and_b32 v6, 3, v1
    v_lshl_add_u32 v168, v6, 3, v168
    s_mul_i32 s36, s30, 1152
    v_add_u32 v168, s36, v168
    v_lshlrev_b32 v169, 3, v1
    s_lshl_b32 s44, s38, 14
    s_lshl_b32 s37, s30, 12
    s_add_u32 s44, s44, s37
    s_mul_i32 s36, s30, 24640
    v_mul_u32_u24 v170, 72, v35
    v_lshl_add_u32 v170, v36, 3, v170
    v_add_u32 v170, s36, v170
    s_cmp_lg_u32 s30, 0
    s_cbranch_scc1 CV_w
    s_and_b32 s36, s2, 7
    s_lshl_b32 s36, s36, 12
    s_add_u32 s36, s36, 23068672
    v_lshlrev_b32 v9, 7, v1
    v_add_u32 v9, s36, v9
    s_mov_b32 s53, 0
    s_add_u32 s54, s52, 0
    s_bfm_b64 exec, 32, 0
poll_2:
    buffer_load_dword v8, v9, s[56:59], 0 offen sc1
    s_waitcnt vmcnt(0)
    v_xor_b32 v8, s54, v8
    v_cmp_eq_u32 vcc, 0, v8
    s_nop 0
    s_cmp_eq_u64 vcc, exec
    s_cbranch_scc1 pok_3
    s_sleep 5
    s_add_u32 s53, s53, 1
    s_cmp_lt_u32 s53, s61
    s_cbranch_scc1 poll_2
    s_mov_b32 s61, 0
pok_3:
    s_mov_b64 exec, -1
    v_mov_b32 v8, 162832
    v_mov_b32 v9, 1
    s_waitcnt lgkmcnt(0)
    ds_write_b32 v8, v9
CV_w:
    v_mov_b32 v8, 162832
spin_4:
    ds_read_b32 v9, v8
    s_waitcnt lgkmcnt(0)
    v_readfirstlane_b32 s53, v9
    s_nop 0
    s_cmp_ge_u32 s53, 1
    s_cbranch_scc0 spin_4
    buffer_load_dwordx4 v[16:19], v2, s[16:19], 0 offen offset:0 sc1
    buffer_load_dwordx4 v[20:23], v2, s[16:19], 0 offen offset:1024 sc1
    buffer_load_dwordx4 v[24:27], v2, s[16:19], 0 offen offset:2048 sc1
    buffer_load_dwordx4 v[28:31], v2, s[16:19], 0 offen offset:3072 sc1
    s_mov_b32 s8, s6
    s_mov_b32 s9, s7
    s_mov_b32 s10, 0x400000
    s_mov_b32 s11, 0x20000
    buffer_load_dwordx2 v[180:181], v198, s[8:11], 0 offen offset:0 nt
    buffer_load_dwordx2 v[182:183], v198, s[8:11], 0 offen offset:32 nt
    buffer_load_dwordx2 v[184:185], v198, s[8:11], 0 offen offset:128 nt
    buffer_load_dwordx2 v[186:187], v198, s[8:11], 0 offen offset:160 nt
    s_waitcnt vmcnt(7)
    ds_write_b128 v12, v[16:19] offset:16640
    s_waitcnt vmcnt(6)
    ds_write_b128 v12, v[20:23] offset:18176
    s_waitcnt vmcnt(5)
    ds_write_b128 v12, v[24:27] offset:19712
    s_waitcnt vmcnt(4)
    ds_write_b128 v12, v[28:31] offset:21248
    v_mov_b32 v8, 162836
    v_mov_b32 v9, 1
    s_mov_b64 exec, 1
    ds_add_u32 v8, v9
    s_mov_b64 exec, -1
    s_waitcnt lgkmcnt(0)
    ds_read_b128 v[136:139], v33 offset:21248
    ds_read_b128 v[140:143], v33 offset:19712
    ds_read_b128 v[144:147], v33 offset:18176
    ds_read_b128 v[148:151], v33 offset:16640
    s_waitcnt lgkmcnt(3)
    v_mfma_f32_16x16x32_bf16 v[40:43], v[152:155], v[136:139], 0
    v_mfma_f32_16x16x32_bf16 v[44:47], v[156:159], v[136:139], 0
    s_waitcnt lgkmcnt(2)
    v_mfma_f32_16x16x32_bf16 v[48:51], v[152:155], v[140:143], 0
    v_mfma_f32_16x16x32_bf16 v[52:55], v[156:159], v[140:143], 0
    s_waitcnt lgkmcnt(1)
    v_mfma_f32_16x16x32_bf16 v[56:59], v[152:155], v[144:147], 0
    v_mfma_f32_16x16x32_bf16 v[60:63], v[156:159], v[144:147], 0
    s_waitcnt lgkmcnt(0)
    v_mfma_f32_16x16x32_bf16 v[64:67], v[152:155], v[148:151], 0
    v_mfma_f32_16x16x32_bf16 v[68:71], v[156:159], v[148:151], 0
    s_mov_b32 s43, 0
CV_r:
    s_waitcnt lgkmcnt(0)
    v_mfma_f32_16x16x32_bf16 v[40:43], v[72:75], v[136:139], v[40:43]
    v_mfma_f32_16x16x32_bf16 v[48:51], v[72:75], v[140:143], v[48:51]
    v_mfma_f32_16x16x32_bf16 v[56:59], v[72:75], v[144:147], v[56:59]
    v_mfma_f32_16x16x32_bf16 v[64:67], v[72:75], v[148:151], v[64:67]
    v_mfma_f32_16x16x32_bf16 v[44:47], v[76:79], v[136:139], v[44:47]
    v_mfma_f32_16x16x32_bf16 v[52:55], v[76:79], v[140:143], v[52:55]
    v_mfma_f32_16x16x32_bf16 v[60:63], v[76:79], v[144:147], v[60:63]
    v_mfma_f32_16x16x32_bf16 v[68:71], v[76:79], v[148:151], v[68:71]
    v_mfma_f32_16x16x32_bf16 v[48:51], v[80:83], v[136:139], v[48:51]
    v_mfma_f32_16x16x32_bf16 v[56:59], v[80:83], v[140:143], v[56:59]
    v_mfma_f32_16x16x32_bf16 v[64:67], v[80:83], v[144:147], v[64:67]
    v_mfma_f32_16x16x32_bf16 v[52:55], v[84:87], v[136:139], v[52:55]
    v_mfma_f32_16x16x32_bf16 v[60:63], v[84:87], v[140:143], v[60:63]
    v_mfma_f32_16x16x32_bf16 v[68:71], v[84:87], v[144:147], v[68:71]
    v_mfma_f32_16x16x32_bf16 v[56:59], v[88:91], v[136:139], v[56:59]
    v_mfma_f32_16x16x32_bf16 v[64:67], v[88:91], v[140:143], v[64:67]
    v_mfma_f32_16x16x32_bf16 v[60:63], v[92:95], v[136:139], v[60:63]
    v_mfma_f32_16x16x32_bf16 v[68:71], v[92:95], v[140:143], v[68:71]
    v_mfma_f32_16x16x32_bf16 v[64:67], v[96:99], v[136:139], v[64:67]
    v_mfma_f32_16x16x32_bf16 v[68:71], v[100:103], v[136:139], v[68:71]
    ds_read_b128 v[152:155], v33 offset:21344
    ds_read_b128 v[156:159], v33 offset:19808
    ds_read_b128 v[160:163], v33 offset:18272
    ds_read_b128 v[164:167], v33 offset:16736
    ds_read_b64 v[104:105], v32 offset:64
    ds_read_b64 v[106:107], v32 offset:72
    ds_read_b64 v[108:109], v32 offset:96
    ds_read_b64 v[110:111], v32 offset:104
    ds_read_b64 v[112:113], v32 offset:1088
    ds_read_b64 v[114:115], v32 offset:1096
    ds_read_b64 v[116:117], v32 offset:1120
    ds_read_b64 v[118:119], v32 offset:1128
    ds_read_b64 v[120:121], v32 offset:2112
    ds_read_b64 v[122:123], v32 offset:2120
    ds_read_b64 v[124:125], v32 offset:2144
    ds_read_b64 v[126:127], v32 offset:2152
    ds_read_b64 v[128:129], v32 offset:3136
    ds_read_b64 v[130:131], v32 offset:3144
    ds_read_b64 v[132:133], v32 offset:3168
    ds_read_b64 v[134:135], v32 offset:3176
    s_waitcnt lgkmcnt(0)
    v_mfma_f32_16x16x32_bf16 v[40:43], v[104:107], v[152:155], v[40:43]
    v_mfma_f32_16x16x32_bf16 v[48:51], v[104:107], v[156:159], v[48:51]
    v_mfma_f32_16x16x32_bf16 v[56:59], v[104:107], v[160:163], v[56:59]
    v_mfma_f32_16x16x32_bf16 v[64:67], v[104:107], v[164:167], v[64:67]
    v_mfma_f32_16x16x32_bf16 v[44:47], v[108:111], v[152:155], v[44:47]
    v_mfma_f32_16x16x32_bf16 v[52:55], v[108:111], v[156:159], v[52:55]
    v_mfma_f32_16x16x32_bf16 v[60:63], v[108:111], v[160:163], v[60:63]
    v_mfma_f32_16x16x32_bf16 v[68:71], v[108:111], v[164:167], v[68:71]
    v_mfma_f32_16x16x32_bf16 v[48:51], v[112:115], v[152:155], v[48:51]
    v_mfma_f32_16x16x32_bf16 v[56:59], v[112:115], v[156:159], v[56:59]
    v_mfma_f32_16x16x32_bf16 v[64:67], v[112:115], v[160:163], v[64:67]
    v_mfma_f32_16x16x32_bf16 v[52:55], v[116:119], v[152:155], v[52:55]
    v_mfma_f32_16x16x32_bf16 v[60:63], v[116:119], v[156:159], v[60:63]
    v_mfma_f32_16x16x32_bf16 v[68:71], v[116:119], v[160:163], v[68:71]
    v_mfma_f32_16x16x32_bf16 v[56:59], v[120:123], v[152:155], v[56:59]
    v_mfma_f32_16x16x32_bf16 v[64:67], v[120:123], v[156:159], v[64:67]
    v_mfma_f32_16x16x32_bf16 v[60:63], v[124:127], v[152:155], v[60:63]
    v_mfma_f32_16x16x32_bf16 v[68:71], v[124:127], v[156:159], v[68:71]
    v_mfma_f32_16x16x32_bf16 v[64:67], v[128:131], v[152:155], v[64:67]
    v_mfma_f32_16x16x32_bf16 v[68:71], v[132:135], v[152:155], v[68:71]
    ds_read_b128 v[136:139], v33 offset:21440
    ds_read_b128 v[140:143], v33 offset:19904
    ds_read_b128 v[144:147], v33 offset:18368
    ds_read_b128 v[148:151], v33 offset:16832
    ds_read_b64 v[72:73], v32 offset:128
    ds_read_b64 v[74:75], v32 offset:136
    ds_read_b64 v[76:77], v32 offset:160
    ds_read_b64 v[78:79], v32 offset:168
    ds_read_b64 v[80:81], v32 offset:1152
    ds_read_b64 v[82:83], v32 offset:1160
    ds_read_b64 v[84:85], v32 offset:1184
    ds_read_b64 v[86:87], v32 offset:1192
    ds_read_b64 v[88:89], v32 offset:2176
    ds_read_b64 v[90:91], v32 offset:2184
    ds_read_b64 v[92:93], v32 offset:2208
    ds_read_b64 v[94:95], v32 offset:2216
    ds_read_b64 v[96:97], v32 offset:3200
    ds_read_b64 v[98:99], v32 offset:3208
    ds_read_b64 v[100:101], v32 offset:3232
    ds_read_b64 v[102:103], v32 offset:3240
    v_add_u32 v32, 128, v32
    v_add_u32 v33, 192, v33
    s_add_u32 s43, s43, 1
    s_cmp_lt_u32 s43, 4
    s_cbranch_scc1 CV_r
CV_l:
    s_waitcnt lgkmcnt(10)
    v_mfma_f32_16x16x32_bf16 v[40:43], v[72:75], v[136:139], v[40:43]
    ds_read_b128 v[152:155], v33 offset:21344
    v_mfma_f32_16x16x32_bf16 v[48:51], v[72:75], v[140:143], v[48:51]
    ds_read_b128 v[156:159], v33 offset:19808
    v_mfma_f32_16x16x32_bf16 v[56:59], v[72:75], v[144:147], v[56:59]
    ds_read_b128 v[160:163], v33 offset:18272
    v_mfma_f32_16x16x32_bf16 v[64:67], v[72:75], v[148:151], v[64:67]
    ds_read_b128 v[164:167], v33 offset:16736
    v_mfma_f32_16x16x32_bf16 v[44:47], v[76:79], v[136:139], v[44:47]
    ds_read_b64 v[104:105], v32 offset:64
    v_mfma_f32_16x16x32_bf16 v[52:55], v[76:79], v[140:143], v[52:55]
    ds_read_b64 v[106:107], v32 offset:72
    v_mfma_f32_16x16x32_bf16 v[60:63], v[76:79], v[144:147], v[60:63]
    ds_read_b64 v[108:109], v32 offset:96
    v_mfma_f32_16x16x32_bf16 v[68:71], v[76:79], v[148:151], v[68:71]
    ds_read_b64 v[110:111], v32 offset:104
    v_mfma_f32_16x16x32_bf16 v[48:51], v[80:83], v[136:139], v[48:51]
    ds_read_b64 v[112:113], v32 offset:1088
    v_mfma_f32_16x16x32_bf16 v[56:59], v[80:83], v[140:143], v[56:59]
    ds_read_b64 v[114:115], v32 offset:1096
    s_waitcnt lgkmcnt(10)
    v_mfma_f32_16x16x32_bf16 v[64:67], v[80:83], v[144:147], v[64:67]
    ds_read_b64 v[116:117], v32 offset:1120
    v_mfma_f32_16x16x32_bf16 v[52:55], v[84:87], v[136:139], v[52:55]
    ds_read_b64 v[118:119], v32 offset:1128
    v_mfma_f32_16x16x32_bf16 v[60:63], v[84:87], v[140:143], v[60:63]
    ds_read_b64 v[120:121], v32 offset:2112
    v_mfma_f32_16x16x32_bf16 v[68:71], v[84:87], v[144:147], v[68:71]
    ds_read_b64 v[122:123], v32 offset:2120
    v_mfma_f32_16x16x32_bf16 v[56:59], v[88:91], v[136:139], v[56:59]
    ds_read_b64 v[124:125], v32 offset:2144
    v_mfma_f32_16x16x32_bf16 v[64:67], v[88:91], v[140:143], v[64:67]
    ds_read_b64 v[126:127], v32 offset:2152
    v_mfma_f32_16x16x32_bf16 v[60:63], v[92:95], v[136:139], v[60:63]
    ds_read_b64 v[128:129], v32 offset:3136
    v_mfma_f32_16x16x32_bf16 v[68:71], v[92:95], v[140:143], v[68:71]
    ds_read_b64 v[130:131], v32 offset:3144
    v_mfma_f32_16x16x32_bf16 v[64:67], v[96:99], v[136:139], v[64:67]
    ds_read_b64 v[132:133], v32 offset:3168
    v_mfma_f32_16x16x32_bf16 v[68:71], v[100:103], v[136:139], v[68:71]
    ds_read_b64 v[134:135], v32 offset:3176
    s_waitcnt lgkmcnt(10)
    v_mfma_f32_16x16x32_bf16 v[40:43], v[104:107], v[152:155], v[40:43]
    ds_read_b128 v[136:139], v33 offset:21440
    v_mfma_f32_16x16x32_bf16 v[48:51], v[104:107], v[156:159], v[48:51]
    ds_read_b128 v[140:143], v33 offset:19904
    v_mfma_f32_16x16x32_bf16 v[56:59], v[104:107], v[160:163], v[56:59]
    ds_read_b128 v[144:147], v33 offset:18368
    v_mfma_f32_16x16x32_bf16 v[64:67], v[104:107], v[164:167], v[64:67]
    ds_read_b128 v[148:151], v33 offset:16832
    v_mfma_f32_16x16x32_bf16 v[44:47], v[108:111], v[152:155], v[44:47]
    ds_read_b64 v[72:73], v32 offset:128
    v_mfma_f32_16x16x32_bf16 v[52:55], v[108:111], v[156:159], v[52:55]
    ds_read_b64 v[74:75], v32 offset:136
    v_add_u32 v33, 192, v33
    v_mfma_f32_16x16x32_bf16 v[60:63], v[108:111], v[160:163], v[60:63]
    ds_read_b64 v[76:77], v32 offset:160
    s_add_u32 s43, s43, 1
    v_mfma_f32_16x16x32_bf16 v[68:71], v[108:111], v[164:167], v[68:71]
    ds_read_b64 v[78:79], v32 offset:168
    s_cmp_lt_u32 s43, 8
    v_mfma_f32_16x16x32_bf16 v[48:51], v[112:115], v[152:155], v[48:51]
    ds_read_b64 v[80:81], v32 offset:1152
    v_mfma_f32_16x16x32_bf16 v[56:59], v[112:115], v[156:159], v[56:59]
    ds_read_b64 v[82:83], v32 offset:1160
    s_waitcnt lgkmcnt(10)
    v_mfma_f32_16x16x32_bf16 v[64:67], v[112:115], v[160:163], v[64:67]
    ds_read_b64 v[84:85], v32 offset:1184
    v_mfma_f32_16x16x32_bf16 v[52:55], v[116:119], v[152:155], v[52:55]
    ds_read_b64 v[86:87], v32 offset:1192
    v_mfma_f32_16x16x32_bf16 v[60:63], v[116:119], v[156:159], v[60:63]
    ds_read_b64 v[88:89], v32 offset:2176
    v_mfma_f32_16x16x32_bf16 v[68:71], v[116:119], v[160:163], v[68:71]
    ds_read_b64 v[90:91], v32 offset:2184
    v_mfma_f32_16x16x32_bf16 v[56:59], v[120:123], v[152:155], v[56:59]
    ds_read_b64 v[92:93], v32 offset:2208
    v_mfma_f32_16x16x32_bf16 v[64:67], v[120:123], v[156:159], v[64:67]
    ds_read_b64 v[94:95], v32 offset:2216
    v_mfma_f32_16x16x32_bf16 v[60:63], v[124:127], v[152:155], v[60:63]
    ds_read_b64 v[96:97], v32 offset:3200
    v_mfma_f32_16x16x32_bf16 v[68:71], v[124:127], v[156:159], v[68:71]
    ds_read_b64 v[98:99], v32 offset:3208
    v_mfma_f32_16x16x32_bf16 v[64:67], v[128:131], v[152:155], v[64:67]
    ds_read_b64 v[100:101], v32 offset:3232
    v_mfma_f32_16x16x32_bf16 v[68:71], v[132:135], v[152:155], v[68:71]
    ds_read_b64 v[102:103], v32 offset:3240
    v_add_u32 v32, 128, v32
    s_cbranch_scc1 CV_l
    s_waitcnt lgkmcnt(0)
    v_cvt_pk_bf16_f32 v16, v40, v41
    v_cvt_pk_bf16_f32 v17, v42, v43
    ds_write_b64 v170, v[16:17] offset:0
    v_cvt_pk_bf16_f32 v18, v44, v45
    v_cvt_pk_bf16_f32 v19, v46, v47
    ds_write_b64 v170, v[18:19] offset:32
    v_cvt_pk_bf16_f32 v20, v48, v49
    v_cvt_pk_bf16_f32 v21, v50, v51
    ds_write_b64 v170, v[20:21] offset:1152
    v_cvt_pk_bf16_f32 v22, v52, v53
    v_cvt_pk_bf16_f32 v23, v54, v55
    ds_write_b64 v170, v[22:23] offset:1184
    v_cvt_pk_bf16_f32 v24, v56, v57
    v_cvt_pk_bf16_f32 v25, v58, v59
    ds_write_b64 v170, v[24:25] offset:2304
    v_cvt_pk_bf16_f32 v26, v60, v61
    v_cvt_pk_bf16_f32 v27, v62, v63
    ds_write_b64 v170, v[26:27] offset:2336
    v_cvt_pk_bf16_f32 v28, v64, v65
    v_cvt_pk_bf16_f32 v29, v66, v67
    ds_write_b64 v170, v[28:29] offset:3456
    v_cvt_pk_bf16_f32 v30, v68, v69
    v_cvt_pk_bf16_f32 v31, v70, v71
    ds_write_b64 v170, v[30:31] offset:3488
    v_mov_b32 v8, 162824
    v_mov_b32 v9, 1
    s_waitcnt lgkmcnt(0)
    s_mov_b64 exec, 1
    ds_add_u32 v8, v9
    s_mov_b64 exec, -1
    v_mov_b32 v8, 162824
spin_5:
    ds_read_b32 v9, v8
    s_waitcnt lgkmcnt(0)
    v_readfirstlane_b32 s53, v9
    s_nop 0
    s_cmp_ge_u32 s53, 4
    s_cbranch_scc0 spin_5
    ds_read_b64_tr_b16 v[104:105], v168 offset:0
    ds_read_b64_tr_b16 v[106:107], v168 offset:144
    ds_read_b64_tr_b16 v[108:109], v168 offset:288
    ds_read_b64_tr_b16 v[110:111], v168 offset:432
    ds_read_b64_tr_b16 v[112:113], v168 offset:576
    ds_read_b64_tr_b16 v[114:115], v168 offset:720
    ds_read_b64_tr_b16 v[116:117], v168 offset:864
    ds_read_b64_tr_b16 v[118:119], v168 offset:1008
    s_waitcnt lgkmcnt(7)
    buffer_store_dwordx2 v[104:105], v169, s[12:15], s44 offen offset:0 sc1
    s_waitcnt lgkmcnt(6)
    buffer_store_dwordx2 v[106:107], v169, s[12:15], s44 offen offset:512 sc1
    s_waitcnt lgkmcnt(5)
    buffer_store_dwordx2 v[108:109], v169, s[12:15], s44 offen offset:1024 sc1
    s_waitcnt lgkmcnt(4)
    buffer_store_dwordx2 v[110:111], v169, s[12:15], s44 offen offset:1536 sc1
    s_waitcnt lgkmcnt(3)
    buffer_store_dwordx2 v[112:113], v169, s[12:15], s44 offen offset:2048 sc1
    s_waitcnt lgkmcnt(2)
    buffer_store_dwordx2 v[114:115], v169, s[12:15], s44 offen offset:2560 sc1
    s_waitcnt lgkmcnt(1)
    buffer_store_dwordx2 v[116:117], v169, s[12:15], s44 offen offset:3072 sc1
    s_waitcnt lgkmcnt(0)
    buffer_store_dwordx2 v[118:119], v169, s[12:15], s44 offen offset:3584 sc1
    s_and_b32 s36, s2, 7
    s_lshl_b32 s36, s36, 7
    s_add_u32 s36, s36, 23101440
    v_mov_b32 v6, 1
    v_mov_b32 v7, 162820
    v_lshlrev_b32 v9, 10, v1
    s_mov_b64 exec, 1
    s_waitcnt vmcnt(0)
    s_waitcnt lgkmcnt(0)
    ds_add_rtn_u32 v8, v7, v6
    ds_read_b32 v10, v7 offset:28
    s_waitcnt lgkmcnt(0)
    v_readfirstlane_b32 s54, v8
    v_readfirstlane_b32 s53, v10
    s_cmp_lg_u32 s54, 15
    s_cbranch_scc1 fa_6
    s_mov_b64 exec, 0xffff
    s_or_b32 s53, s53, 1
    v_mov_b32 v6, s53
    buffer_atomic_add v6, v9, s[56:59], s36 offen sc1
fa_6:
    s_mov_b64 exec, -1
    s_branch FR_end
FR_b:
    s_getpc_b64 s[34:35]
K_tpc:
    s_lshl_b32 s36, s29, 2
    s_and_b32 s37, s28, 3
    s_add_u32 s36, s36, s37
    s_lshl_b32 s36, s36, 6
    s_add_u32 s36, s36, K_tab-K_tpc
    s_add_u32 s34, s34, s36
    s_addc_u32 s35, s35, 0
    v_and_b32 v248, 31, v1
    v_lshlrev_b32 v248, 1, v248
    global_load_ushort v251, v248, s[34:35]
    v_lshrrev_b32 v253, 3, v1
    v_lshlrev_b32 v238, 11, v253
    v_and_b32 v253, 6, v253
    v_and_b32 v254, 7, v1
    v_xor_b32 v253, v253, v254
    v_lshl_add_u32 v238, v253, 4, v238
    v_lshrrev_b32 v253, 4, v1
    v_lshlrev_b32 v239, 11, v253
    v_add_u32 v253, 0, v253
    v_lshlrev_b32 v253, 1, v253
    v_and_b32 v254, 15, v1
    v_xor_b32 v253, v253, v254
    v_lshl_add_u32 v239, v253, 4, v239
    v_lshrrev_b32 v253, 4, v1
    v_lshlrev_b32 v240, 11, v253
    v_add_u32 v253, 4, v253
    v_lshlrev_b32 v253, 1, v253
    v_and_b32 v254, 15, v1
    v_xor_b32 v253, v253, v254
    v_lshl_add_u32 v240, v253, 4, v240
    v_add_u32 v254, 0, v1
    v_mul_u32_u24 v253, 2341, v254
    v_lshrrev_b32 v253, 16, v253
    v_mul_u32_u24 v241, 28, v253
    v_sub_u32 v254, v254, v241
    v_mul_u32_u24 v241, 7168, v253
    v_lshrrev_b32 v253, 1, v253
    v_and_b32 v253, 2, v253
    v_xor_b32 v254, v254, v253
    v_lshl_add_u32 v241, v254, 4, v241
    v_add_u32 v254, 64, v1
    v_mul_u32_u24 v253, 2341, v254
    v_lshrrev_b32 v253, 16, v253
    v_mul_u32_u24 v242, 28, v253
    v_sub_u32 v254, v254, v242
    v_mul_u32_u24 v242, 7168, v253
    v_lshrrev_b32 v253, 1, v253
    v_and_b32 v253, 2, v253
    v_xor_b32 v254, v254, v253
    v_lshl_add_u32 v242, v254, 4, v242
    v_add_u32 v254, 128, v1
    v_mul_u32_u24 v253, 2341, v254
    v_lshrrev_b32 v253, 16, v253
    v_mul_u32_u24 v243, 28, v253
    v_sub_u32 v254, v254, v243
    v_mul_u32_u24 v243, 7168, v253
    v_lshrrev_b32 v253, 1, v253
    v_and_b32 v253, 2, v253
    v_xor_b32 v254, v254, v253
    v_lshl_add_u32 v243, v254, 4, v243
    v_add_u32 v254, 192, v1
    v_mul_u32_u24 v253, 2341, v254
    v_lshrrev_b32 v253, 16, v253
    v_mul_u32_u24 v244, 28, v253
    v_sub_u32 v254, v254, v244
    v_mul_u32_u24 v244, 7168, v253
    v_lshrrev_b32 v253, 1, v253
    v_and_b32 v253, 2, v253
    v_xor_b32 v254, v254, v253
    v_lshl_add_u32 v244, v254, 4, v244
    v_add_u32 v254, 256, v1
    v_mul_u32_u24 v253, 2341, v254
    v_lshrrev_b32 v253, 16, v253
    v_mul_u32_u24 v245, 28, v253
    v_sub_u32 v254, v254, v245
    v_mul_u32_u24 v245, 7168, v253
    v_lshrrev_b32 v253, 1, v253
    v_and_b32 v253, 2, v253
    v_xor_b32 v254, v254, v253
    v_lshl_add_u32 v245, v254, 4, v245
    v_add_u32 v254, 320, v1
    v_mul_u32_u24 v253, 2341, v254
    v_lshrrev_b32 v253, 16, v253
    v_mul_u32_u24 v246, 28, v253
    v_sub_u32 v254, v254, v246
    v_mul_u32_u24 v246, 7168, v253
    v_lshrrev_b32 v253, 1, v253
    v_and_b32 v253, 2, v253
    v_xor_b32 v254, v254, v253
    v_lshl_add_u32 v246, v254, 4, v246
    v_add_u32 v254, 384, v1
    v_mul_u32_u24 v253, 2341, v254
    v_lshrrev_b32 v253, 16, v253
    v_mul_u32_u24 v247, 28, v253
    v_sub_u32 v254, v254, v247
    v_mul_u32_u24 v247, 7168, v253
    v_lshrrev_b32 v253, 1, v253
    v_and_b32 v253, 2, v253
    v_xor_b32 v254, v254, v253
    v_lshl_add_u32 v247, v254, 4, v247
    s_cmp_ge_u32 s30, 6
    s_cbranch_scc1 FB_cs
    s_cmp_ge_u32 s2, 255
    s_cbranch_scc1 FB_np
    s_cmp_lg_u32 s30, 5
    s_cbranch_scc1 FB_np
    s_and_b32 s42, s2, 31
    s_lshl_b32 s42, s42, 8
    s_lshr_b32 s43, s2, 5
    s_lshl_b32 s43, s43, 14
    s_add_u32 s42, s42, s43
    s_add_u32 s42, s42, 39714816
    v_mov_b32 v14, 0
    s_mov_b64 exec, 1
    s_mov_b32 s46, -1
    s_mov_b32 s47, -1
    s_mov_b32 s43, 0
FB_ml:
    s_add_u32 s45, s42, 0
    s_memtime s[34:35]
    s_waitcnt lgkmcnt(0)
    buffer_load_dword v13, v14, s[56:59], s45 offen sc1
    s_waitcnt vmcnt(0)
    s_memtime s[36:37]
    s_waitcnt lgkmcnt(0)
    s_sub_u32 s36, s36, s34
    s_min_u32 s46, s46, s36
    s_add_u32 s45, s42, 8192
    s_memtime s[34:35]
    s_waitcnt lgkmcnt(0)
    buffer_load_dword v13, v14, s[56:59], s45 offen sc1
    s_waitcnt vmcnt(0)
    s_memtime s[36:37]
    s_waitcnt lgkmcnt(0)
    s_sub_u32 s36, s36, s34
    s_min_u32 s47, s47, s36
    s_add_u32 s42, s42, 128
    s_add_u32 s43, s43, 1
    s_cmp_lt_u32 s43, 2
    s_cbranch_scc1 FB_ml
    s_cmp_lt_u32 s47, s46
    s_cselect_b32 s45, 1, 0
    s_lshr_b32 s46, s28, 2
    s_xor_b32 s45, s45, s46
    s_and_b32 s45, s45, 1
    s_lshl_b32 s45, s45, 8
    s_mov_b64 exec, -1
    v_mov_b32 v6, 162848
    v_mov_b32 v7, s45
    s_waitcnt lgkmcnt(0)
    ds_write_b32 v6, v7
FB_np:
    s_cmp_lg_u32 s30, 4
    s_cbranch_scc1 FB_ni
    v_mov_b32 v12, s52
    s_lshr_b32 s53, s28, 3
    s_lshl_b32 s53, s53, 2
    s_and_b32 s54, s28, 3
    s_add_u32 s53, s53, s54
    s_lshl_b32 s53, s53, 24
    s_lshr_b32 s54, s28, 2
    s_xor_b32 s54, s54, s94
    s_and_b32 s54, s54, 1
    s_lshl_b32 s54, s54, 13
    s_add_u32 s37, s53, s54
    s_add_u32 s37, s37, 33554432
    s_andn2_b32 s37, s37, 0x2000
    s_lshl_b32 s53, s29, 7
    s_add_u32 s37, s37, s53
    s_add_u32 s37, s37, 6029312
    v_and_b32 v13, 1, v1
    v_lshlrev_b32 v13, 13, v13
    v_lshrrev_b32 v14, 1, v1
    v_lshl_add_u32 v13, v14, 22, v13
    s_mov_b64 exec, 0xf
    buffer_store_dword v12, v13, s[56:59], s37 offen sc1
    s_cmp_lg_u32 s28, 0
    s_cbranch_scc1 FB_n2
    s_add_u32 s37, s53, 23117824
    s_mov_b64 exec, 1
    buffer_store_dword v12, v13, s[56:59], s37 offen sc1
FB_n2:
    s_mov_b64 exec, -1
    v_mov_b32 v16, 1
    v_mov_b32 v17, 0
    v_mov_b32 v18, 0
    v_mov_b32 v19, 0
    s_lshr_b32 s36, s2, 7
    s_lshl_b32 s36, s36, 24
    s_add_u32 s36, s36, 167772160
    s_add_u32 s20, s4, s36
    s_addc_u32 s21, s5, 0
    s_mov_b32 s22, 8388608
    s_mov_b32 s23, 0x20000
    s_and_b32 s36, s2, 127
    s_mul_i32 s36, s36, 65536
    s_add_u32 s36, s36, 16352
    v_and_b32 v13, 1, v1
    v_lshlrev_b32 v13, 4, v13
    v_bfe_u32 v14, v1, 1, 1
    v_lshl_add_u32 v13, v14, 13, v13
    v_bfe_u32 v14, v1, 2, 1
    v_mul_u32_u24 v14, 32800, v14
    v_add_u32 v13, v13, v14
    s_mov_b64 exec, 0xff
    buffer_store_dwordx4 v[16:19], v13, s[20:23], s36 offen sc1
    s_mov_b64 exec, -1
FB_ni:
    v_mov_b32 v6, 162832
spin_7:
    s_sleep 2
    ds_read_b32 v7, v6
    s_waitcnt lgkmcnt(0)
    v_readfirstlane_b32 s53, v7
    s_nop 0
    s_cmp_ge_u32 s53, 1
    s_cbranch_scc0 spin_7
    s_load_dwordx2 s[48:49], s[0:1], 64
    s_lshl_b32 s45, s2, 1
    s_and_b32 s50, s30, 1
    s_add_u32 s45, s45, s50
    s_mul_i32 s45, s45, 4096
    s_mov_b32 s50, 2097152
    s_mov_b32 s51, 0x20000
    s_waitcnt lgkmcnt(0)
    buffer_load_dwordx4 v[20:23], v2, s[48:51], s45 offen offset:0
    buffer_load_dwordx4 v[20:23], v2, s[48:51], s45 offen offset:1024
    buffer_load_dwordx4 v[20:23], v2, s[48:51], s45 offen offset:2048
    buffer_load_dwordx4 v[20:23], v2, s[48:51], s45 offen offset:3072
    s_mov_b32 s8, s6
    s_mov_b32 s9, s7
    s_mov_b32 s10, 0x400000
    s_mov_b32 s11, 0x20000
    buffer_load_dwordx2 v[180:181], v198, s[8:11], 0 offen offset:0 nt
    buffer_load_dwordx2 v[182:183], v198, s[8:11], 0 offen offset:32 nt
    buffer_load_dwordx2 v[184:185], v198, s[8:11], 0 offen offset:128 nt
    buffer_load_dwordx2 v[186:187], v198, s[8:11], 0 offen offset:160 nt
    s_and_b32 s36, s2, 7
    s_lshl_b32 s36, s36, 7
    s_add_u32 s36, s36, 23101440
    v_mov_b32 v6, 1
    v_mov_b32 v7, 162820
    v_lshlrev_b32 v9, 10, v1
    s_mov_b64 exec, 1
    s_waitcnt vmcnt(0)
    s_waitcnt lgkmcnt(0)
    ds_add_rtn_u32 v8, v7, v6
    ds_read_b32 v10, v7 offset:28
    s_waitcnt lgkmcnt(0)
    v_readfirstlane_b32 s54, v8
    v_readfirstlane_b32 s53, v10
    s_cmp_lg_u32 s54, 15
    s_cbranch_scc1 fa_8
    s_mov_b64 exec, 0xffff
    s_or_b32 s53, s53, 1
    v_mov_b32 v6, s53
    buffer_atomic_add v6, v9, s[56:59], s36 offen sc1
fa_8:
    s_mov_b64 exec, -1
    v_bfe_u32 v252, v251, 2, 2
    v_lshlrev_b32 v248, 14, v252
    v_and_b32 v252, 3, v251
    v_lshl_add_u32 v248, v252, 11, v248
    v_bfe_u32 v252, v251, 7, 3
    v_lshlrev_b32 v249, 14, v252
    v_bfe_u32 v252, v251, 4, 3
    v_lshl_add_u32 v249, v252, 10, v249
    v_bfe_u32 v252, v251, 13, 3
    v_lshlrev_b32 v250, 14, v252
    v_bfe_u32 v252, v251, 10, 3
    v_lshl_add_u32 v250, v252, 10, v250
    v_mov_b32 v6, 162840
spin_9:
    s_sleep 4
    ds_read_b32 v7, v6
    s_waitcnt lgkmcnt(0)
    v_readfirstlane_b32 s53, v7
    s_nop 0
    s_cmp_ge_u32 s53, 2
    s_cbranch_scc0 spin_9
    s_call_b64 s[76:77], SUB_w1_regs
    s_call_b64 s[76:77], SUB_park
    v_mov_b32 v6, 162840
spin_10:
    s_sleep 3
    ds_read_b32 v7, v6
    s_waitcnt lgkmcnt(0)
    v_readfirstlane_b32 s53, v7
    s_nop 0
    s_cmp_ge_u32 s53, 4
    s_cbranch_scc0 spin_10
    s_mov_b64 s[12:13], s[68:69]
    s_mov_b32 s14, 2097152
    s_mov_b32 s15, 0x20000
    s_and_b32 s35, s30, 1
    s_mul_i32 s38, s99, 128
    s_mul_i32 s41, s35, 65536
    s_add_u32 s38, s38, s41
    s_mul_i32 s41, s35, 4096
    s_add_u32 s41, s41, 24576
    s_mov_b32 s42, 0
    s_mov_b32 s44, s67
    s_mov_b32 s42, 73728
    s_mov_b32 s44, s67
    s_add_u32 s44, s44, 9
    s_and_b32 s44, s44, 15
    s_call_b64 s[76:77], SUB_w_issue_1
    s_waitcnt vmcnt(8)
    s_mov_b32 s42, 81920
    s_mov_b32 s44, s67
    s_add_u32 s44, s44, 10
    s_and_b32 s44, s44, 15
    s_call_b64 s[76:77], SUB_w_issue_1
    s_waitcnt vmcnt(8)
    s_mov_b32 s42, 90112
    s_mov_b32 s44, s67
    s_add_u32 s44, s44, 11
    s_and_b32 s44, s44, 15
    s_call_b64 s[76:77], SUB_w_issue_1
    s_waitcnt vmcnt(8)
    s_call_b64 s[76:77], SUB_w1_put
    s_branch FR_end
FB_cs:
    v_and_b32 v164, 15, v1
    v_mov_b32 v165, 0x3f803f80
    v_cmp_eq_u32 vcc, 0, v164
    s_nop 1
    v_cndmask_b32 v16, 0, v165, vcc
    v_cndmask_b32 v17, 0, v165, vcc
    v_cndmask_b32 v18, 0, v165, vcc
    v_cndmask_b32 v19, 0, v165, vcc
    v_cmp_eq_u32 vcc, 1, v164
    s_nop 1
    v_cndmask_b32 v20, 0, v165, vcc
    v_cndmask_b32 v21, 0, v165, vcc
    v_cndmask_b32 v22, 0, v165, vcc
    v_cndmask_b32 v23, 0, v165, vcc
    v_cmp_eq_u32 vcc, 2, v164
    s_nop 1
    v_cndmask_b32 v24, 0, v165, vcc
    v_cndmask_b32 v25, 0, v165, vcc
    v_cndmask_b32 v26, 0, v165, vcc
    v_cndmask_b32 v27, 0, v165, vcc
    v_cmp_eq_u32 vcc, 3, v164
    s_nop 1
    v_cndmask_b32 v28, 0, v165, vcc
    v_cndmask_b32 v29, 0, v165, vcc
    v_cndmask_b32 v30, 0, v165, vcc
    v_cndmask_b32 v31, 0, v165, vcc
    v_cmp_eq_u32 vcc, 4, v164
    s_nop 1
    v_cndmask_b32 v32, 0, v165, vcc
    v_cndmask_b32 v33, 0, v165, vcc
    v_cndmask_b32 v34, 0, v165, vcc
    v_cndmask_b32 v35, 0, v165, vcc
    v_cmp_eq_u32 vcc, 5, v164
    s_nop 1
    v_cndmask_b32 v36, 0, v165, vcc
    v_cndmask_b32 v37, 0, v165, vcc
    v_cndmask_b32 v38, 0, v165, vcc
    v_cndmask_b32 v39, 0, v165, vcc
    v_cmp_eq_u32 vcc, 6, v164
    s_nop 1
    v_cndmask_b32 v40, 0, v165, vcc
    v_cndmask_b32 v41, 0, v165, vcc
    v_cndmask_b32 v42, 0, v165, vcc
    v_cndmask_b32 v43, 0, v165, vcc
    v_cmp_eq_u32 vcc, 7, v164
    s_nop 1
    v_cndmask_b32 v44, 0, v165, vcc
    v_cndmask_b32 v45, 0, v165, vcc
    v_cndmask_b32 v46, 0, v165, vcc
    v_cndmask_b32 v47, 0, v165, vcc
    v_cmp_eq_u32 vcc, 8, v164
    s_nop 1
    v_cndmask_b32 v48, 0, v165, vcc
    v_cndmask_b32 v49, 0, v165, vcc
    v_cndmask_b32 v50, 0, v165, vcc
    v_cndmask_b32 v51, 0, v165, vcc
    v_cmp_eq_u32 vcc, 9, v164
    s_nop 1
    v_cndmask_b32 v52, 0, v165, vcc
    v_cndmask_b32 v53, 0, v165, vcc
    v_cndmask_b32 v54, 0, v165, vcc
    v_cndmask_b32 v55, 0, v165, vcc
    v_cmp_eq_u32 vcc, 10, v164
    s_nop 1
    v_cndmask_b32 v56, 0, v165, vcc
    v_cndmask_b32 v57, 0, v165, vcc
    v_cndmask_b32 v58, 0, v165, vcc
    v_cndmask_b32 v59, 0, v165, vcc
    v_cmp_eq_u32 vcc, 11, v164
    s_nop 1
    v_cndmask_b32 v60, 0, v165, vcc
    v_cndmask_b32 v61, 0, v165, vcc
    v_cndmask_b32 v62, 0, v165, vcc
    v_cndmask_b32 v63, 0, v165, vcc
    v_cmp_eq_u32 vcc, 12, v164
    s_nop 1
    v_cndmask_b32 v64, 0, v165, vcc
    v_cndmask_b32 v65, 0, v165, vcc
    v_cndmask_b32 v66, 0, v165, vcc
    v_cndmask_b32 v67, 0, v165, vcc
    v_cmp_eq_u32 vcc, 13, v164
    s_nop 1
    v_cndmask_b32 v68, 0, v165, vcc
    v_cndmask_b32 v69, 0, v165, vcc
    v_cndmask_b32 v70, 0, v165, vcc
    v_cndmask_b32 v71, 0, v165, vcc
    s_mov_b32 s35, 0
    v_lshrrev_b32 v253, 2, v1
    v_mul_u32_u24 v144, 128, v253
    v_and_b32 v254, 3, v1
    v_lshl_add_u32 v144, v254, 3, v144
    v_add_u32 v144, 24576, v144
    v_bfe_u32 v253, v253, 1, 2
    s_mul_i32 s36, s35, 4
    s_add_u32 s36, s36, 3
    v_xor_b32 v254, s36, v253
    v_lshl_add_u32 v147, v254, 5, v144
    s_mul_i32 s36, s35, 4
    s_add_u32 s36, s36, 2
    v_xor_b32 v254, s36, v253
    v_lshl_add_u32 v146, v254, 5, v144
    s_mul_i32 s36, s35, 4
    s_add_u32 s36, s36, 1
    v_xor_b32 v254, s36, v253
    v_lshl_add_u32 v145, v254, 5, v144
    s_mul_i32 s36, s35, 4
    s_add_u32 s36, s36, 0
    v_xor_b32 v254, s36, v253
    v_lshl_add_u32 v144, v254, 5, v144
    s_and_b32 s35, s30, 1
    s_mul_i32 s35, s35, 4096
    s_add_u32 s35, s35, 73728
    v_add_u32 v144, s35, v144
    v_add_u32 v145, s35, v145
    v_add_u32 v146, s35, v146
    v_add_u32 v147, s35, v147
    s_mov_b32 s35, 0
    v_lshrrev_b32 v253, 2, v1
    v_mul_u32_u24 v148, 448, v253
    v_and_b32 v254, 3, v1
    v_lshl_add_u32 v148, v254, 3, v148
    v_add_u32 v148, 73728, v148
    s_mul_i32 s36, s35, 224
    v_add_u32 v148, s36, v148
    v_bfe_u32 v253, v1, 4, 1
    v_lshlrev_b32 v253, 5, v253
    s_cmp_eq_u32 s35, 0
    s_cselect_b32 s36, 1, -1
    v_mul_lo_u32 v253, v253, s36
    v_sub_u32 v149, v148, v253
    v_add_u32 v148, v148, v253
    s_and_b32 s35, s30, 1
    s_mul_i32 s35, s35, 14336
    s_add_u32 s35, s35, 32768
    v_add_u32 v148, s35, v148
    v_add_u32 v149, s35, v149
    s_mov_b32 s35, 1
    v_lshrrev_b32 v253, 2, v1
    v_mul_u32_u24 v150, 448, v253
    v_and_b32 v254, 3, v1
    v_lshl_add_u32 v150, v254, 3, v150
    v_add_u32 v150, 73728, v150
    s_mul_i32 s36, s35, 224
    v_add_u32 v150, s36, v150
    v_bfe_u32 v253, v1, 4, 1
    v_lshlrev_b32 v253, 5, v253
    s_cmp_eq_u32 s35, 0
    s_cselect_b32 s36, 1, -1
    v_mul_lo_u32 v253, v253, s36
    v_sub_u32 v151, v150, v253
    v_add_u32 v150, v150, v253
    s_and_b32 s35, s30, 1
    s_mul_i32 s35, s35, 14336
    s_add_u32 s35, s35, 32768
    v_add_u32 v150, s35, v150
    v_add_u32 v151, s35, v151
    v_mov_b32 v156, 0
    v_mov_b32 v157, 0
    v_mov_b32 v158, 0
    v_mov_b32 v159, 0
    v_mov_b32 v160, 0
    v_mov_b32 v161, 0
    v_mov_b32 v162, 0
    v_mov_b32 v163, 0
    v_lshrrev_b32 v166, 4, v1
    v_lshlrev_b32 v166, 4, v166
    v_lshl_add_u32 v166, v164, 6, v166
    v_mov_b32 v165, 0x7f000000
    v_cmp_gt_u32 vcc, 4, v164
    s_nop 1
    v_cndmask_b32 v167, v165, v166, vcc
    v_cmp_gt_u32 vcc, 14, v164
    s_nop 1
    v_cndmask_b32 v168, v165, v166, vcc
    v_mov_b32 v6, 162832
spin_11:
    s_sleep 2
    ds_read_b32 v7, v6
    s_waitcnt lgkmcnt(0)
    v_readfirstlane_b32 s53, v7
    s_nop 0
    s_cmp_ge_u32 s53, 1
    s_cbranch_scc0 spin_11
    s_mov_b32 s8, s6
    s_mov_b32 s9, s7
    s_mov_b32 s10, 0x400000
    s_mov_b32 s11, 0x20000
    buffer_load_dwordx2 v[180:181], v198, s[8:11], 0 offen offset:0 nt
    buffer_load_dwordx2 v[182:183], v198, s[8:11], 0 offen offset:32 nt
    buffer_load_dwordx2 v[184:185], v198, s[8:11], 0 offen offset:128 nt
    buffer_load_dwordx2 v[186:187], v198, s[8:11], 0 offen offset:160 nt
    s_mov_b64 s[12:13], s[68:69]
    s_mov_b32 s14, 2097152
    s_mov_b32 s15, 0x20000
    s_and_b32 s35, s30, 1
    s_mul_i32 s38, s99, 128
    s_mul_i32 s41, s35, 65536
    s_add_u32 s38, s38, s41
    s_mul_i32 s41, s35, 4096
    s_add_u32 s41, s41, 24576
    s_mov_b32 s42, 0
    s_mov_b32 s44, s67
    s_mov_b32 s42, 73728
    s_mov_b32 s44, s28
    s_add_u32 s19, s41, s42
    s_mul_i32 s16, s44, 131072
    s_add_u32 s16, s16, s38
    s_add_u32 s44, s44, 1
    s_and_b32 s44, s44, 15
    s_add_u32 s42, s42, 8192
    s_cmp_eq_u32 s42, 131072
    s_cselect_b32 s42, 0, s42
    s_mov_b32 m0, s19
    s_mov_b32 s39, s16
    buffer_load_dwordx4 v238, s[12:15], s39 offen lds
    s_add_u32 m0, m0, 1024
    s_add_u32 s39, s39, 16384
    buffer_load_dwordx4 v238, s[12:15], s39 offen lds
    s_add_u32 m0, m0, 1024
    s_add_u32 s39, s39, 16384
    buffer_load_dwordx4 v238, s[12:15], s39 offen lds
    s_add_u32 m0, m0, 1024
    s_add_u32 s39, s39, 16384
    buffer_load_dwordx4 v238, s[12:15], s39 offen lds
    s_mov_b64 s[12:13], s[72:73]
    s_mov_b32 s14, 7340032
    s_mov_b32 s15, 0x20000
    s_and_b32 s35, s30, 1
    s_mul_i32 s38, s29, 448
    s_mul_i32 s41, s35, 229376
    s_add_u32 s38, s38, s41
    s_mul_i32 s41, s35, 14336
    s_add_u32 s41, s41, 73728
    s_mov_b32 s42, 0
    s_mov_b32 s44, 0
    s_mov_b32 s42, 32768
    s_mov_b32 s44, s28
    s_add_u32 s19, s41, s42
    s_mul_i32 s16, s44, 458752
    s_add_u32 s16, s16, s38
    s_add_u32 s44, s44, 1
    s_and_b32 s44, s44, 15
    s_add_u32 s42, s42, 28672
    s_cmp_eq_u32 s42, 86016
    s_cselect_b32 s42, 0, s42
    s_mov_b32 m0, s19
    s_mov_b32 s39, s16
    buffer_load_dwordx4 v241, s[12:15], s39 offen lds
    s_add_u32 m0, m0, 1024
    s_nop 0
    buffer_load_dwordx4 v242, s[12:15], s39 offen lds
    s_add_u32 m0, m0, 1024
    s_nop 0
    buffer_load_dwordx4 v243, s[12:15], s39 offen lds
    s_add_u32 m0, m0, 1024
    s_nop 0
    buffer_load_dwordx4 v244, s[12:15], s39 offen lds
    s_add_u32 m0, m0, 1024
    s_nop 0
    buffer_load_dwordx4 v245, s[12:15], s39 offen lds
    s_add_u32 m0, m0, 1024
    s_nop 0
    buffer_load_dwordx4 v246, s[12:15], s39 offen lds
    s_add_u32 m0, m0, 1024
    s_nop 0
    buffer_load_dwordx4 v247, s[12:15], s39 offen lds
    s_add_u32 m0, m0, 1024
    s_add_u32 s39, s39, 114688
    buffer_load_dwordx4 v241, s[12:15], s39 offen lds
    s_add_u32 m0, m0, 1024
    s_nop 0
    buffer_load_dwordx4 v242, s[12:15], s39 offen lds
    s_add_u32 m0, m0, 1024
    s_nop 0
    buffer_load_dwordx4 v243, s[12:15], s39 offen lds
    s_add_u32 m0, m0, 1024
    s_nop 0
    buffer_load_dwordx4 v244, s[12:15], s39 offen lds
    s_add_u32 m0, m0, 1024
    s_nop 0
    buffer_load_dwordx4 v245, s[12:15], s39 offen lds
    s_add_u32 m0, m0, 1024
    s_nop 0
    buffer_load_dwordx4 v246, s[12:15], s39 offen lds
    s_add_u32 m0, m0, 1024
    s_nop 0
    buffer_load_dwordx4 v247, s[12:15], s39 offen lds
    s_waitcnt vmcnt(14)
    s_setprio 1
    ds_read_b64_tr_b16 v[128:129], v144 offset:0
    ds_read_b64_tr_b16 v[130:131], v144 offset:2048
    ds_read_b64_tr_b16 v[132:133], v145 offset:0
    ds_read_b64_tr_b16 v[134:135], v145 offset:2048
    ds_read_b64_tr_b16 v[136:137], v146 offset:0
    ds_read_b64_tr_b16 v[138:139], v146 offset:2048
    ds_read_b64_tr_b16 v[140:141], v147 offset:0
    ds_read_b64_tr_b16 v[142:143], v147 offset:2048
    s_add_u32 s20, s4, 0x1400000
    s_addc_u32 s21, s5, 0
    s_mov_b32 s22, 0x20000
    s_mov_b32 s23, 0x20000
    s_lshl_b32 s35, s28, 1
    s_and_b32 s36, s30, 1
    s_add_u32 s35, s35, s36
    s_mul_i32 s35, s35, 4096
    s_mul_i32 s36, s29, 256
    s_add_u32 s35, s35, s36
    s_waitcnt lgkmcnt(0)
    v_mfma_f32_16x16x32_bf16 v[160:163], v[128:131], v[16:19], v[160:163]
    v_mfma_f32_16x16x32_bf16 v[160:163], v[132:135], v[20:23], v[160:163]
    v_mfma_f32_16x16x32_bf16 v[160:163], v[136:139], v[24:27], v[160:163]
    v_mfma_f32_16x16x32_bf16 v[160:163], v[140:143], v[28:31], v[160:163]
    s_nop 7
    buffer_store_dwordx4 v[160:163], v167, s[20:23], s35 offen sc1
    s_waitcnt vmcnt(1)
    v_mov_b32 v6, 162840
    v_mov_b32 v7, 1
    s_mov_b64 exec, 1
    ds_add_u32 v6, v7
    s_mov_b64 exec, -1
    ds_read_b64_tr_b16 v[72:73], v148 offset:0
    ds_read_b64_tr_b16 v[74:75], v148 offset:7168
    ds_read_b64_tr_b16 v[76:77], v149 offset:32
    ds_read_b64_tr_b16 v[78:79], v149 offset:7200
    ds_read_b64_tr_b16 v[80:81], v148 offset:64
    ds_read_b64_tr_b16 v[82:83], v148 offset:7232
    ds_read_b64_tr_b16 v[84:85], v149 offset:96
    ds_read_b64_tr_b16 v[86:87], v149 offset:7264
    ds_read_b64_tr_b16 v[88:89], v148 offset:128
    ds_read_b64_tr_b16 v[90:91], v148 offset:7296
    ds_read_b64_tr_b16 v[92:93], v149 offset:160
    ds_read_b64_tr_b16 v[94:95], v149 offset:7328
    ds_read_b64_tr_b16 v[96:97], v148 offset:192
    ds_read_b64_tr_b16 v[98:99], v148 offset:7360
    ds_read_b64_tr_b16 v[100:101], v150 offset:0
    ds_read_b64_tr_b16 v[102:103], v150 offset:7168
    ds_read_b64_tr_b16 v[104:105], v151 offset:32
    ds_read_b64_tr_b16 v[106:107], v151 offset:7200
    ds_read_b64_tr_b16 v[108:109], v150 offset:64
    ds_read_b64_tr_b16 v[110:111], v150 offset:7232
    ds_read_b64_tr_b16 v[112:113], v151 offset:96
    ds_read_b64_tr_b16 v[114:115], v151 offset:7264
    ds_read_b64_tr_b16 v[116:117], v150 offset:128
    ds_read_b64_tr_b16 v[118:119], v150 offset:7296
    ds_read_b64_tr_b16 v[120:121], v151 offset:160
    ds_read_b64_tr_b16 v[122:123], v151 offset:7328
    ds_read_b64_tr_b16 v[124:125], v150 offset:192
    ds_read_b64_tr_b16 v[126:127], v150 offset:7360
    s_add_u32 s20, s4, 0x1420000
    s_addc_u32 s21, s5, 0
    s_mov_b32 s22, 0x70000
    s_mov_b32 s23, 0x20000
    s_lshl_b32 s35, s28, 1
    s_and_b32 s36, s30, 1
    s_add_u32 s35, s35, s36
    s_mul_i32 s35, s35, 14336
    s_mul_i32 s36, s29, 896
    s_add_u32 s35, s35, s36
    s_waitcnt lgkmcnt(0)
    v_mfma_f32_16x16x32_bf16 v[156:159], v[72:75], v[16:19], v[156:159]
    v_mfma_f32_16x16x32_bf16 v[156:159], v[76:79], v[20:23], v[156:159]
    v_mfma_f32_16x16x32_bf16 v[156:159], v[80:83], v[24:27], v[156:159]
    v_mfma_f32_16x16x32_bf16 v[156:159], v[84:87], v[28:31], v[156:159]
    v_mfma_f32_16x16x32_bf16 v[156:159], v[88:91], v[32:35], v[156:159]
    v_mfma_f32_16x16x32_bf16 v[156:159], v[92:95], v[36:39], v[156:159]
    v_mfma_f32_16x16x32_bf16 v[156:159], v[96:99], v[40:43], v[156:159]
    v_mfma_f32_16x16x32_bf16 v[156:159], v[100:103], v[44:47], v[156:159]
    v_mfma_f32_16x16x32_bf16 v[156:159], v[104:107], v[48:51], v[156:159]
    v_mfma_f32_16x16x32_bf16 v[156:159], v[108:111], v[52:55], v[156:159]
    v_mfma_f32_16x16x32_bf16 v[156:159], v[112:115], v[56:59], v[156:159]
    v_mfma_f32_16x16x32_bf16 v[156:159], v[116:119], v[60:63], v[156:159]
    v_mfma_f32_16x16x32_bf16 v[156:159], v[120:123], v[64:67], v[156:159]
    v_mfma_f32_16x16x32_bf16 v[156:159], v[124:127], v[68:71], v[156:159]
    s_nop 7
    buffer_store_dwordx4 v[156:159], v168, s[20:23], s35 offen sc1
    s_and_b32 s36, s2, 7
    s_lshl_b32 s36, s36, 7
    s_add_u32 s36, s36, 23101440
    v_mov_b32 v6, 1
    v_mov_b32 v7, 162820
    v_lshlrev_b32 v9, 10, v1
    s_mov_b64 exec, 1
    s_waitcnt lgkmcnt(0)
    ds_add_rtn_u32 v8, v7, v6
    ds_read_b32 v10, v7 offset:28
    s_waitcnt lgkmcnt(0)
    v_readfirstlane_b32 s54, v8
    v_readfirstlane_b32 s53, v10
    s_cmp_lg_u32 s54, 15
    s_cbranch_scc1 fa_12
    s_mov_b64 exec, 0xffff
    s_or_b32 s53, s53, 1
    v_mov_b32 v6, s53
    buffer_atomic_add v6, v9, s[56:59], s36 offen sc1
fa_12:
    s_mov_b64 exec, -1
    v_and_b32 v252, 15, v251
    v_mul_u32_u24 v248, 458752, v252
    s_and_b32 s36, s30, 1
    s_mul_i32 s36, s36, 6
    s_add_u32 s36, s36, 4
    v_bfe_u32 v252, v251, s36, 6
    v_mul_u32_u24 v250, 37, v252
    v_lshrrev_b32 v250, 8, v250
    v_mul_u32_u24 v250, 7, v250
    v_sub_u32 v250, v252, v250
    v_cmp_eq_u32 vcc, 3, v250
    s_nop 1
    v_cndmask_b32 v250, 0, 1, vcc
    v_lshl_add_u32 v249, v252, 16, v250
    v_mov_b32 v6, 162840
    v_mov_b32 v7, 1
    s_mov_b64 exec, 1
    ds_add_u32 v6, v7
    s_mov_b64 exec, -1
    s_setprio 0
    s_call_b64 s[76:77], SUB_w1_regs
    s_call_b64 s[76:77], SUB_park
    v_mov_b32 v6, 162840
spin_13:
    s_sleep 3
    ds_read_b32 v7, v6
    s_waitcnt lgkmcnt(0)
    v_readfirstlane_b32 s53, v7
    s_nop 0
    s_cmp_ge_u32 s53, 4
    s_cbranch_scc0 spin_13
    s_mov_b64 s[12:13], s[68:69]
    s_mov_b32 s14, 2097152
    s_mov_b32 s15, 0x20000
    s_and_b32 s35, s30, 1
    s_mul_i32 s38, s99, 128
    s_mul_i32 s41, s35, 65536
    s_add_u32 s38, s38, s41
    s_mul_i32 s41, s35, 4096
    s_add_u32 s41, s41, 24576
    s_mov_b32 s42, 0
    s_mov_b32 s44, s67
    s_mov_b32 s42, 98304
    s_mov_b32 s44, s67
    s_add_u32 s44, s44, 12
    s_and_b32 s44, s44, 15
    s_call_b64 s[76:77], SUB_w_issue_1
    s_waitcnt vmcnt(8)
    s_mov_b32 s42, 106496
    s_mov_b32 s44, s67
    s_add_u32 s44, s44, 13
    s_and_b32 s44, s44, 15
    s_call_b64 s[76:77], SUB_w_issue_1
    s_waitcnt vmcnt(8)
    s_mov_b32 s42, 114688
    s_mov_b32 s44, s67
    s_add_u32 s44, s44, 14
    s_and_b32 s44, s44, 15
    s_call_b64 s[76:77], SUB_w_issue_1
    s_waitcnt vmcnt(8)
    s_mov_b32 s42, 122880
    s_mov_b32 s44, s67
    s_add_u32 s44, s44, 15
    s_and_b32 s44, s44, 15
    s_call_b64 s[76:77], SUB_w_issue_1
    s_waitcnt vmcnt(8)
    s_call_b64 s[76:77], SUB_w1_put
FR_end:
LAYER:
    v_lshlrev_b32 v40, 6, v199
    v_add_u32 v40, 161792, v40
    s_lshl_b32 s35, s30, 3
    v_add_u32 v39, s35, v40
    s_cmp_eq_u32 s60, 0
    s_cbranch_scc1 R_l0
    s_sub_u32 s8, s62, 0x400000
    s_subb_u32 s9, s63, 0
    s_mov_b32 s10, 0x7e000
    s_mov_b32 s11, 0x20000
    s_sub_u32 s12, s62, 0x380000
    s_subb_u32 s13, s63, 0
    s_mov_b32 s14, 0x7e000
    s_mov_b32 s15, 0x20000
    v_lshlrev_b32 v222, 16, v230
    v_and_b32 v223, 0xffff0000, v230
    v_lshlrev_b32 v206, 16, v180
    v_and_b32 v207, 0xffff0000, v180
    v_lshlrev_b32 v12, 16, v188
    v_and_b32 v13, 0xffff0000, v188
    v_pk_add_f32 v[206:207], v[206:207], v[12:13]
    v_lshlrev_b32 v224, 16, v231
    v_and_b32 v225, 0xffff0000, v231
    v_lshlrev_b32 v208, 16, v181
    v_and_b32 v209, 0xffff0000, v181
    v_lshlrev_b32 v14, 16, v189
    v_and_b32 v15, 0xffff0000, v189
    v_pk_add_f32 v[208:209], v[208:209], v[14:15]
    v_lshlrev_b32 v226, 16, v232
    v_and_b32 v227, 0xffff0000, v232
    v_lshlrev_b32 v210, 16, v182
    v_and_b32 v211, 0xffff0000, v182
    v_lshlrev_b32 v16, 16, v190
    v_and_b32 v17, 0xffff0000, v190
    v_pk_add_f32 v[210:211], v[210:211], v[16:17]
    v_lshlrev_b32 v228, 16, v233
    v_and_b32 v229, 0xffff0000, v233
    v_lshlrev_b32 v212, 16, v183
    v_and_b32 v213, 0xffff0000, v183
    v_lshlrev_b32 v18, 16, v191
    v_and_b32 v19, 0xffff0000, v191
    v_pk_add_f32 v[212:213], v[212:213], v[18:19]
    v_lshlrev_b32 v230, 16, v234
    v_and_b32 v231, 0xffff0000, v234
    v_lshlrev_b32 v214, 16, v184
    v_and_b32 v215, 0xffff0000, v184
    v_lshlrev_b32 v20, 16, v192
    v_and_b32 v21, 0xffff0000, v192
    v_pk_add_f32 v[214:215], v[214:215], v[20:21]
    v_lshlrev_b32 v232, 16, v235
    v_and_b32 v233, 0xffff0000, v235
    v_lshlrev_b32 v216, 16, v185
    v_and_b32 v217, 0xffff0000, v185
    v_lshlrev_b32 v22, 16, v193
    v_and_b32 v23, 0xffff0000, v193
    v_pk_add_f32 v[216:217], v[216:217], v[22:23]
    v_lshlrev_b32 v234, 16, v236
    v_and_b32 v235, 0xffff0000, v236
    v_lshlrev_b32 v218, 16, v186
    v_and_b32 v219, 0xffff0000, v186
    v_lshlrev_b32 v24, 16, v194
    v_and_b32 v25, 0xffff0000, v194
    v_pk_add_f32 v[218:219], v[218:219], v[24:25]
    v_lshlrev_b32 v236, 16, v237
    v_and_b32 v237, 0xffff0000, v237
    v_lshlrev_b32 v220, 16, v187
    v_and_b32 v221, 0xffff0000, v187
    v_lshlrev_b32 v26, 16, v195
    v_and_b32 v27, 0xffff0000, v195
    v_pk_add_f32 v[220:221], v[220:221], v[26:27]
    s_mov_b32 s53, 0
    s_sleep 24
dp_14:
    buffer_load_dwordx4 v[180:183], v196, s[8:11], 0 offen offset:0 sc1
    buffer_load_dwordx4 v[188:191], v196, s[12:15], 0 offen offset:0 sc1
    buffer_load_dwordx4 v[184:187], v196, s[8:11], 0 offen offset:2048 sc1
    buffer_load_dwordx4 v[192:195], v196, s[12:15], 0 offen offset:2048 sc1
    s_waitcnt vmcnt(0)
    v_bitop3_b32 v6, v180, v184, v188 bitop3:0x80
    v_bitop3_b32 v6, v6, v192, 1 bitop3:0x80
    v_cmp_eq_u32 vcc, 0, v6
    s_cbranch_vccz dq_15
    s_sleep 4
    s_add_u32 s53, s53, 1
    s_cmp_lt_u32 s53, s61
    s_cbranch_scc1 dp_14
    s_mov_b32 s61, 0
dq_15:
    v_lshlrev_b32 v12, 16, v180
    v_and_b32 v13, 0xffff0000, v180
    v_lshlrev_b32 v14, 16, v188
    v_and_b32 v15, 0xffff0000, v188
    v_pk_add_f32 v[12:13], v[12:13], v[14:15]
    v_pk_add_f32 v[206:207], v[206:207], v[12:13]
    v_lshlrev_b32 v16, 16, v181
    v_and_b32 v17, 0xffff0000, v181
    v_lshlrev_b32 v18, 16, v189
    v_and_b32 v19, 0xffff0000, v189
    v_pk_add_f32 v[16:17], v[16:17], v[18:19]
    v_pk_add_f32 v[208:209], v[208:209], v[16:17]
    v_lshlrev_b32 v20, 16, v182
    v_and_b32 v21, 0xffff0000, v182
    v_lshlrev_b32 v22, 16, v190
    v_and_b32 v23, 0xffff0000, v190
    v_pk_add_f32 v[20:21], v[20:21], v[22:23]
    v_pk_add_f32 v[210:211], v[210:211], v[20:21]
    v_lshlrev_b32 v24, 16, v183
    v_and_b32 v25, 0xffff0000, v183
    v_lshlrev_b32 v26, 16, v191
    v_and_b32 v27, 0xffff0000, v191
    v_pk_add_f32 v[24:25], v[24:25], v[26:27]
    v_pk_add_f32 v[212:213], v[212:213], v[24:25]
    v_lshlrev_b32 v12, 16, v184
    v_and_b32 v13, 0xffff0000, v184
    v_lshlrev_b32 v14, 16, v192
    v_and_b32 v15, 0xffff0000, v192
    v_pk_add_f32 v[12:13], v[12:13], v[14:15]
    v_pk_add_f32 v[214:215], v[214:215], v[12:13]
    v_lshlrev_b32 v16, 16, v185
    v_and_b32 v17, 0xffff0000, v185
    v_lshlrev_b32 v18, 16, v193
    v_and_b32 v19, 0xffff0000, v193
    v_pk_add_f32 v[16:17], v[16:17], v[18:19]
    v_pk_add_f32 v[216:217], v[216:217], v[16:17]
    v_lshlrev_b32 v20, 16, v186
    v_and_b32 v21, 0xffff0000, v186
    v_lshlrev_b32 v22, 16, v194
    v_and_b32 v23, 0xffff0000, v194
    v_pk_add_f32 v[20:21], v[20:21], v[22:23]
    v_pk_add_f32 v[218:219], v[218:219], v[20:21]
    v_lshlrev_b32 v24, 16, v187
    v_and_b32 v25, 0xffff0000, v187
    v_lshlrev_b32 v26, 16, v195
    v_and_b32 v27, 0xffff0000, v195
    v_pk_add_f32 v[24:25], v[24:25], v[26:27]
    v_pk_add_f32 v[220:221], v[220:221], v[24:25]
    v_pk_add_f32 v[32:33], v[206:207], v[208:209]
    v_pk_mul_f32 v[34:35], v[206:207], v[206:207]
    v_pk_fma_f32 v[34:35], v[208:209], v[208:209], v[34:35]
    v_pk_add_f32 v[32:33], v[32:33], v[210:211]
    v_pk_fma_f32 v[34:35], v[210:211], v[210:211], v[34:35]
    v_pk_add_f32 v[32:33], v[32:33], v[212:213]
    v_pk_fma_f32 v[34:35], v[212:213], v[212:213], v[34:35]
    v_pk_add_f32 v[32:33], v[32:33], v[214:215]
    v_pk_fma_f32 v[34:35], v[214:215], v[214:215], v[34:35]
    v_pk_add_f32 v[32:33], v[32:33], v[216:217]
    v_pk_fma_f32 v[34:35], v[216:217], v[216:217], v[34:35]
    v_pk_add_f32 v[32:33], v[32:33], v[218:219]
    v_pk_fma_f32 v[34:35], v[218:219], v[218:219], v[34:35]
    v_pk_add_f32 v[32:33], v[32:33], v[220:221]
    v_pk_fma_f32 v[34:35], v[220:221], v[220:221], v[34:35]
    v_add_f32 v30, v32, v33
    v_add_f32 v31, v34, v35
    s_nop 0
    v_add_f32_dpp v30, v30, v30 row_ror:8 row_mask:0xf bank_mask:0xf
    v_add_f32_dpp v31, v31, v31 row_ror:8 row_mask:0xf bank_mask:0xf
    v_mov_b32 v32, v30
    v_mov_b32 v33, v31
    s_nop 0
    v_permlane16_swap_b32 v30, v32
    v_permlane16_swap_b32 v31, v33
    v_pk_add_f32 v[30:31], v[30:31], v[32:33]
    v_mov_b32 v32, v30
    v_mov_b32 v33, v31
    s_nop 0
    v_permlane32_swap_b32 v30, v32
    v_permlane32_swap_b32 v31, v33
    v_pk_add_f32 v[30:31], v[30:31], v[32:33]
    ds_write_b64 v39, v[30:31] offset:0
    s_waitcnt lgkmcnt(0)
    s_barrier
    ds_read_b128 v[12:15], v40 offset:0
    ds_read_b128 v[16:19], v40 offset:16
    ds_read_b128 v[20:23], v40 offset:32
    ds_read_b128 v[24:27], v40 offset:48
    s_waitcnt lgkmcnt(0)
    v_pk_add_f32 v[12:13], v[12:13], v[14:15]
    v_pk_add_f32 v[16:17], v[16:17], v[18:19]
    v_pk_add_f32 v[20:21], v[20:21], v[22:23]
    v_pk_add_f32 v[24:25], v[24:25], v[26:27]
    v_pk_add_f32 v[12:13], v[12:13], v[16:17]
    v_pk_add_f32 v[20:21], v[20:21], v[24:25]
    v_pk_add_f32 v[12:13], v[12:13], v[20:21]
    v_mul_f32 v36, 0x3a800000, v12
    v_mul_f32 v38, 0x3a800000, v13
    v_fma_f32 v38, -v36, v36, v38
    v_max_f32 v38, 0, v38
    v_add_f32 v38, 0x3727c5ac, v38
    v_rsq_f32 v37, v38
    s_mov_b32 s20, s62
    s_mov_b32 s21, s63
    s_mov_b32 s22, 0x7e000
    s_mov_b32 s23, 0x20000
    v_pk_add_f32 v[12:13], v[206:207], v[36:37] op_sel_hi:[1,0] neg_lo:[0,1] neg_hi:[0,1]
    v_pk_mul_f32 v[12:13], v[12:13], v[36:37] op_sel:[0,1] op_sel_hi:[1,1]
    v_pk_fma_f32 v[206:207], v[12:13], v[222:223], v[206:207]
    v_cvt_pk_bf16_f32 v180, v206, v207
    v_pk_add_f32 v[14:15], v[208:209], v[36:37] op_sel_hi:[1,0] neg_lo:[0,1] neg_hi:[0,1]
    v_pk_mul_f32 v[14:15], v[14:15], v[36:37] op_sel:[0,1] op_sel_hi:[1,1]
    v_pk_fma_f32 v[208:209], v[14:15], v[224:225], v[208:209]
    v_cvt_pk_bf16_f32 v181, v208, v209
    v_and_b32 v180, -2, v180
    v_pk_add_f32 v[16:17], v[210:211], v[36:37] op_sel_hi:[1,0] neg_lo:[0,1] neg_hi:[0,1]
    v_pk_mul_f32 v[16:17], v[16:17], v[36:37] op_sel:[0,1] op_sel_hi:[1,1]
    v_pk_fma_f32 v[210:211], v[16:17], v[226:227], v[210:211]
    v_cvt_pk_bf16_f32 v182, v210, v211
    v_pk_add_f32 v[18:19], v[212:213], v[36:37] op_sel_hi:[1,0] neg_lo:[0,1] neg_hi:[0,1]
    v_pk_mul_f32 v[18:19], v[18:19], v[36:37] op_sel:[0,1] op_sel_hi:[1,1]
    v_pk_fma_f32 v[212:213], v[18:19], v[228:229], v[212:213]
    v_cvt_pk_bf16_f32 v183, v212, v213
    buffer_store_dwordx4 v[180:183], v196, s[20:23], 0 offen offset:0 sc1
    v_pk_add_f32 v[20:21], v[214:215], v[36:37] op_sel_hi:[1,0] neg_lo:[0,1] neg_hi:[0,1]
    v_pk_mul_f32 v[20:21], v[20:21], v[36:37] op_sel:[0,1] op_sel_hi:[1,1]
    v_pk_fma_f32 v[214:215], v[20:21], v[230:231], v[214:215]
    v_cvt_pk_bf16_f32 v184, v214, v215
    v_pk_add_f32 v[22:23], v[216:217], v[36:37] op_sel_hi:[1,0] neg_lo:[0,1] neg_hi:[0,1]
    v_pk_mul_f32 v[22:23], v[22:23], v[36:37] op_sel:[0,1] op_sel_hi:[1,1]
    v_pk_fma_f32 v[216:217], v[22:23], v[232:233], v[216:217]
    v_cvt_pk_bf16_f32 v185, v216, v217
    v_and_b32 v184, -2, v184
    v_pk_add_f32 v[24:25], v[218:219], v[36:37] op_sel_hi:[1,0] neg_lo:[0,1] neg_hi:[0,1]
    v_pk_mul_f32 v[24:25], v[24:25], v[36:37] op_sel:[0,1] op_sel_hi:[1,1]
    v_pk_fma_f32 v[218:219], v[24:25], v[234:235], v[218:219]
    v_cvt_pk_bf16_f32 v186, v218, v219
    v_pk_add_f32 v[26:27], v[220:221], v[36:37] op_sel_hi:[1,0] neg_lo:[0,1] neg_hi:[0,1]
    v_pk_mul_f32 v[26:27], v[26:27], v[36:37] op_sel:[0,1] op_sel_hi:[1,1]
    v_pk_fma_f32 v[220:221], v[26:27], v[236:237], v[220:221]
    v_cvt_pk_bf16_f32 v187, v220, v221
    buffer_store_dwordx4 v[184:187], v196, s[20:23], 0 offen offset:2048 sc1
    s_branch R_s2
R_l0:
    v_lshlrev_b32 v206, 16, v180
    v_and_b32 v207, 0xffff0000, v180
    v_lshlrev_b32 v208, 16, v181
    v_and_b32 v209, 0xffff0000, v181
    v_lshlrev_b32 v210, 16, v182
    v_and_b32 v211, 0xffff0000, v182
    v_lshlrev_b32 v212, 16, v183
    v_and_b32 v213, 0xffff0000, v183
    v_lshlrev_b32 v214, 16, v184
    v_and_b32 v215, 0xffff0000, v184
    v_lshlrev_b32 v216, 16, v185
    v_and_b32 v217, 0xffff0000, v185
    v_lshlrev_b32 v218, 16, v186
    v_and_b32 v219, 0xffff0000, v186
    v_lshlrev_b32 v220, 16, v187
    v_and_b32 v221, 0xffff0000, v187
    v_pk_add_f32 v[32:33], v[206:207], v[208:209]
    v_pk_mul_f32 v[34:35], v[206:207], v[206:207]
    v_pk_fma_f32 v[34:35], v[208:209], v[208:209], v[34:35]
    v_pk_add_f32 v[32:33], v[32:33], v[210:211]
    v_pk_fma_f32 v[34:35], v[210:211], v[210:211], v[34:35]
    v_pk_add_f32 v[32:33], v[32:33], v[212:213]
    v_pk_fma_f32 v[34:35], v[212:213], v[212:213], v[34:35]
    v_pk_add_f32 v[32:33], v[32:33], v[214:215]
    v_pk_fma_f32 v[34:35], v[214:215], v[214:215], v[34:35]
    v_pk_add_f32 v[32:33], v[32:33], v[216:217]
    v_pk_fma_f32 v[34:35], v[216:217], v[216:217], v[34:35]
    v_pk_add_f32 v[32:33], v[32:33], v[218:219]
    v_pk_fma_f32 v[34:35], v[218:219], v[218:219], v[34:35]
    v_pk_add_f32 v[32:33], v[32:33], v[220:221]
    v_pk_fma_f32 v[34:35], v[220:221], v[220:221], v[34:35]
    v_add_f32 v30, v32, v33
    v_add_f32 v31, v34, v35
    s_nop 0
    v_add_f32_dpp v30, v30, v30 row_ror:8 row_mask:0xf bank_mask:0xf
    v_add_f32_dpp v31, v31, v31 row_ror:8 row_mask:0xf bank_mask:0xf
    v_mov_b32 v32, v30
    v_mov_b32 v33, v31
    s_nop 0
    v_permlane16_swap_b32 v30, v32
    v_permlane16_swap_b32 v31, v33
    v_pk_add_f32 v[30:31], v[30:31], v[32:33]
    v_mov_b32 v32, v30
    v_mov_b32 v33, v31
    s_nop 0
    v_permlane32_swap_b32 v30, v32
    v_permlane32_swap_b32 v31, v33
    v_pk_add_f32 v[30:31], v[30:31], v[32:33]
    ds_write_b64 v39, v[30:31] offset:0
    s_waitcnt lgkmcnt(0)
    s_cmp_lg_u32 s30, 4
    s_cbranch_scc1 R_fw
    v_mov_b32 v222, 162820
spin_16:
    s_sleep 4
    ds_read_b32 v223, v222
    s_waitcnt lgkmcnt(0)
    v_readfirstlane_b32 s53, v223
    s_nop 0
    s_cmp_ge_u32 s53, 16
    s_cbranch_scc0 spin_16
    s_lshl_b32 s36, s28, 10
    s_add_u32 s36, s36, 23101440
    v_lshlrev_b32 v226, 7, v1
    v_add_u32 v226, s36, v226
    s_mov_b32 s53, 0
    s_mov_b64 exec, 0xff
R_fp:
    buffer_load_dword v222, v226, s[56:59], 0 offen sc1
    s_waitcnt vmcnt(0)
    v_subrev_u32 v222, s52, v222
    v_and_b32 v223, 0xffffc0ff, v222
    v_cmp_eq_u32 vcc, 32, v223
    s_nop 0
    s_cmp_eq_u64 vcc, exec
    s_cbranch_scc1 R_fq
    s_sleep 3
    s_add_u32 s53, s53, 1
    s_cmp_lt_u32 s53, s61
    s_cbranch_scc1 R_fp
    s_mov_b32 s61, 0
R_fq:
    v_lshrrev_b32 v222, 8, v222
    v_mov_b32 v223, 162844
    ds_add_u32 v223, v222
    s_mov_b64 exec, -1
    s_waitcnt lgkmcnt(0)
R_fw:
    s_barrier
    s_add_u32 s80, s4, 0x1c00000
    s_addc_u32 s81, s5, 0
    s_mov_b32 s82, 0x400000
    s_mov_b32 s83, 0x20000
    s_mov_b32 s78, 0
    buffer_load_dwordx2 v[230:231], v197, s[80:83], s78 offen sc1
    s_mov_b32 s78, 65536
    buffer_load_dwordx2 v[232:233], v197, s[80:83], s78 offen sc1
    s_mov_b32 s78, 262144
    buffer_load_dwordx2 v[234:235], v197, s[80:83], s78 offen sc1
    s_mov_b32 s78, 327680
    buffer_load_dwordx2 v[236:237], v197, s[80:83], s78 offen sc1
    v_mov_b32 v222, 162844
    ds_read_b32 v223, v222
    s_waitcnt lgkmcnt(0)
    v_readfirstlane_b32 s94, v223
    s_nop 0
    s_cmp_gt_u32 s94, 127
    s_cselect_b32 s94, 1, 0
    s_lshr_b32 s53, s28, 3
    s_lshl_b32 s53, s53, 2
    s_and_b32 s54, s28, 3
    s_add_u32 s53, s53, s54
    s_lshl_b32 s53, s53, 24
    s_lshr_b32 s54, s28, 2
    s_xor_b32 s54, s54, s94
    s_and_b32 s54, s54, 1
    s_lshl_b32 s54, s54, 13
    s_add_u32 s55, s53, s54
    s_add_u32 s55, s55, 33554432
    s_add_u32 s62, s4, s55
    s_addc_u32 s63, s5, 0
    s_sub_u32 s36, s28, 1
    s_max_i32 s36, s36, 0
    s_lshr_b32 s53, s36, 3
    s_lshl_b32 s53, s53, 2
    s_and_b32 s54, s36, 3
    s_add_u32 s53, s53, s54
    s_lshl_b32 s53, s53, 24
    s_lshr_b32 s54, s36, 2
    s_xor_b32 s54, s54, s94
    s_and_b32 s54, s54, 1
    s_lshl_b32 s54, s54, 13
    s_add_u32 s92, s53, s54
    s_add_u32 s92, s92, 33554432
    s_sub_u32 s92, s92, s55
    s_add_u32 s36, s28, 1
    s_min_u32 s36, s36, 15
    s_lshr_b32 s53, s36, 3
    s_lshl_b32 s53, s53, 2
    s_and_b32 s54, s36, 3
    s_add_u32 s53, s53, s54
    s_lshl_b32 s53, s53, 24
    s_lshr_b32 s54, s36, 2
    s_xor_b32 s54, s54, s94
    s_and_b32 s54, s54, 1
    s_lshl_b32 s54, s54, 13
    s_add_u32 s93, s53, s54
    s_add_u32 s93, s93, 33554432
    s_sub_u32 s93, s93, s55
    s_add_u32 s55, s55, 6029312
    s_mov_b32 s20, s62
    s_mov_b32 s21, s63
    s_mov_b32 s22, 0x7e000
    s_mov_b32 s23, 0x20000
    ds_read_b128 v[12:15], v40 offset:0
    ds_read_b128 v[16:19], v40 offset:16
    ds_read_b128 v[20:23], v40 offset:32
    ds_read_b128 v[24:27], v40 offset:48
    s_waitcnt lgkmcnt(0)
    v_pk_add_f32 v[12:13], v[12:13], v[14:15]
    v_pk_add_f32 v[16:17], v[16:17], v[18:19]
    v_pk_add_f32 v[20:21], v[20:21], v[22:23]
    v_pk_add_f32 v[24:25], v[24:25], v[26:27]
    v_pk_add_f32 v[12:13], v[12:13], v[16:17]
    v_pk_add_f32 v[20:21], v[20:21], v[24:25]
    v_pk_add_f32 v[12:13], v[12:13], v[20:21]
    v_mul_f32 v36, 0x3a800000, v12
    v_mul_f32 v38, 0x3a800000, v13
    v_fma_f32 v38, -v36, v36, v38
    v_max_f32 v38, 0, v38
    v_add_f32 v38, 0x3727c5ac, v38
    v_rsq_f32 v37, v38
    s_nop 0
    v_pk_add_f32 v[12:13], v[206:207], v[36:37] op_sel_hi:[1,0] neg_lo:[0,1] neg_hi:[0,1]
    v_pk_mul_f32 v[12:13], v[12:13], v[36:37] op_sel:[0,1] op_sel_hi:[1,1]
    v_pk_add_f32 v[14:15], v[208:209], v[36:37] op_sel_hi:[1,0] neg_lo:[0,1] neg_hi:[0,1]
    v_pk_mul_f32 v[14:15], v[14:15], v[36:37] op_sel:[0,1] op_sel_hi:[1,1]
    v_pk_add_f32 v[16:17], v[210:211], v[36:37] op_sel_hi:[1,0] neg_lo:[0,1] neg_hi:[0,1]
    v_pk_mul_f32 v[16:17], v[16:17], v[36:37] op_sel:[0,1] op_sel_hi:[1,1]
    v_pk_add_f32 v[18:19], v[212:213], v[36:37] op_sel_hi:[1,0] neg_lo:[0,1] neg_hi:[0,1]
    v_pk_mul_f32 v[18:19], v[18:19], v[36:37] op_sel:[0,1] op_sel_hi:[1,1]
    v_pk_add_f32 v[20:21], v[214:215], v[36:37] op_sel_hi:[1,0] neg_lo:[0,1] neg_hi:[0,1]
    v_pk_mul_f32 v[20:21], v[20:21], v[36:37] op_sel:[0,1] op_sel_hi:[1,1]
    v_pk_add_f32 v[22:23], v[216:217], v[36:37] op_sel_hi:[1,0] neg_lo:[0,1] neg_hi:[0,1]
    v_pk_mul_f32 v[22:23], v[22:23], v[36:37] op_sel:[0,1] op_sel_hi:[1,1]
    v_pk_add_f32 v[24:25], v[218:219], v[36:37] op_sel_hi:[1,0] neg_lo:[0,1] neg_hi:[0,1]
    v_pk_mul_f32 v[24:25], v[24:25], v[36:37] op_sel:[0,1] op_sel_hi:[1,1]
    v_pk_add_f32 v[26:27], v[220:221], v[36:37] op_sel_hi:[1,0] neg_lo:[0,1] neg_hi:[0,1]
    v_pk_mul_f32 v[26:27], v[26:27], v[36:37] op_sel:[0,1] op_sel_hi:[1,1]
    s_waitcnt vmcnt(0)
    v_lshlrev_b32 v222, 16, v230
    v_and_b32 v223, 0xffff0000, v230
    v_pk_fma_f32 v[206:207], v[12:13], v[222:223], v[206:207]
    v_cvt_pk_bf16_f32 v180, v206, v207
    v_lshlrev_b32 v222, 16, v231
    v_and_b32 v223, 0xffff0000, v231
    v_pk_fma_f32 v[208:209], v[14:15], v[222:223], v[208:209]
    v_cvt_pk_bf16_f32 v181, v208, v209
    v_and_b32 v180, -2, v180
    v_lshlrev_b32 v222, 16, v232
    v_and_b32 v223, 0xffff0000, v232
    v_pk_fma_f32 v[210:211], v[16:17], v[222:223], v[210:211]
    v_cvt_pk_bf16_f32 v182, v210, v211
    v_lshlrev_b32 v222, 16, v233
    v_and_b32 v223, 0xffff0000, v233
    v_pk_fma_f32 v[212:213], v[18:19], v[222:223], v[212:213]
    v_cvt_pk_bf16_f32 v183, v212, v213
    buffer_store_dwordx4 v[180:183], v196, s[20:23], 0 offen offset:0 sc1
    v_lshlrev_b32 v222, 16, v234
    v_and_b32 v223, 0xffff0000, v234
    v_pk_fma_f32 v[214:215], v[20:21], v[222:223], v[214:215]
    v_cvt_pk_bf16_f32 v184, v214, v215
    v_lshlrev_b32 v222, 16, v235
    v_and_b32 v223, 0xffff0000, v235
    v_pk_fma_f32 v[216:217], v[22:23], v[222:223], v[216:217]
    v_cvt_pk_bf16_f32 v185, v216, v217
    v_and_b32 v184, -2, v184
    v_lshlrev_b32 v222, 16, v236
    v_and_b32 v223, 0xffff0000, v236
    v_pk_fma_f32 v[218:219], v[24:25], v[222:223], v[218:219]
    v_cvt_pk_bf16_f32 v186, v218, v219
    v_lshlrev_b32 v222, 16, v237
    v_and_b32 v223, 0xffff0000, v237
    v_pk_fma_f32 v[220:221], v[26:27], v[222:223], v[220:221]
    v_cvt_pk_bf16_f32 v187, v220, v221
    buffer_store_dwordx4 v[184:187], v196, s[20:23], 0 offen offset:2048 sc1
R_s2:
    v_lshlrev_b32 v206, 16, v180
    v_and_b32 v207, 0xffff0000, v180
    v_lshlrev_b32 v208, 16, v181
    v_and_b32 v209, 0xffff0000, v181
    v_lshlrev_b32 v210, 16, v182
    v_and_b32 v211, 0xffff0000, v182
    v_lshlrev_b32 v212, 16, v183
    v_and_b32 v213, 0xffff0000, v183
    v_lshlrev_b32 v214, 16, v184
    v_and_b32 v215, 0xffff0000, v184
    v_lshlrev_b32 v216, 16, v185
    v_and_b32 v217, 0xffff0000, v185
    v_lshlrev_b32 v218, 16, v186
    v_and_b32 v219, 0xffff0000, v186
    v_lshlrev_b32 v220, 16, v187
    v_and_b32 v221, 0xffff0000, v187
    v_pk_add_f32 v[32:33], v[206:207], v[208:209]
    v_pk_mul_f32 v[34:35], v[206:207], v[206:207]
    v_pk_fma_f32 v[34:35], v[208:209], v[208:209], v[34:35]
    v_pk_add_f32 v[32:33], v[32:33], v[210:211]
    v_pk_fma_f32 v[34:35], v[210:211], v[210:211], v[34:35]
    v_pk_add_f32 v[32:33], v[32:33], v[212:213]
    v_pk_fma_f32 v[34:35], v[212:213], v[212:213], v[34:35]
    v_pk_add_f32 v[32:33], v[32:33], v[214:215]
    v_pk_fma_f32 v[34:35], v[214:215], v[214:215], v[34:35]
    v_pk_add_f32 v[32:33], v[32:33], v[216:217]
    v_pk_fma_f32 v[34:35], v[216:217], v[216:217], v[34:35]
    v_pk_add_f32 v[32:33], v[32:33], v[218:219]
    v_pk_fma_f32 v[34:35], v[218:219], v[218:219], v[34:35]
    v_pk_add_f32 v[32:33], v[32:33], v[220:221]
    v_pk_fma_f32 v[34:35], v[220:221], v[220:221], v[34:35]
    v_add_f32 v30, v32, v33
    v_add_f32 v31, v34, v35
    s_nop 0
    v_add_f32_dpp v30, v30, v30 row_ror:8 row_mask:0xf bank_mask:0xf
    v_add_f32_dpp v31, v31, v31 row_ror:8 row_mask:0xf bank_mask:0xf
    v_mov_b32 v32, v30
    v_mov_b32 v33, v31
    s_nop 0
    v_permlane16_swap_b32 v30, v32
    v_permlane16_swap_b32 v31, v33
    v_pk_add_f32 v[30:31], v[30:31], v[32:33]
    v_mov_b32 v32, v30
    v_mov_b32 v33, v31
    s_nop 0
    v_permlane32_swap_b32 v30, v32
    v_permlane32_swap_b32 v31, v33
    v_pk_add_f32 v[30:31], v[30:31], v[32:33]
    ds_write_b64 v39, v[30:31] offset:512
    s_waitcnt lgkmcnt(0)
    s_barrier
    s_cmp_lg_u32 s30, 6
    s_cbranch_scc1 R_n6
    s_cmp_lg_u32 s60, 0
    s_cbranch_scc1 R_n6
    s_lshl_b32 s53, s29, 7
    s_add_u32 s53, s53, 23117824
    v_mov_b32 v8, 1
    v_mov_b32 v9, 0
    s_mov_b64 exec, 1
    buffer_atomic_add v8, v9, s[56:59], s53 offen sc1
    s_mov_b64 exec, -1
R_n6:
    s_cmp_lg_u32 s30, 7
    s_cbranch_scc1 R_nl
    ds_read_b128 v[12:15], v40 offset:512
    ds_read_b128 v[16:19], v40 offset:528
    ds_read_b128 v[20:23], v40 offset:544
    ds_read_b128 v[24:27], v40 offset:560
    s_waitcnt lgkmcnt(0)
    v_pk_add_f32 v[12:13], v[12:13], v[14:15]
    v_pk_add_f32 v[16:17], v[16:17], v[18:19]
    v_pk_add_f32 v[20:21], v[20:21], v[22:23]
    v_pk_add_f32 v[24:25], v[24:25], v[26:27]
    v_pk_add_f32 v[12:13], v[12:13], v[16:17]
    v_pk_add_f32 v[20:21], v[20:21], v[24:25]
    v_pk_add_f32 v[12:13], v[12:13], v[20:21]
    v_mul_f32 v36, 0x3a800000, v12
    v_mul_f32 v38, 0x3a800000, v13
    v_fma_f32 v38, -v36, v36, v38
    v_max_f32 v38, 0, v38
    v_mov_b32 v42, v36
    v_mov_b32 v43, v38
    v_add_f32 v38, 0x3727c5ac, v38
    v_sqrt_f32 v38, v38
    s_nop 0
    v_mov_b32 v41, v38
    v_rcp_f32 v37, v38
    v_sub_f32 v42, v42, v36
    v_mul_f32 v42, v42, v37
    v_mul_f32 v43, v43, v37
    v_mul_f32 v43, v43, v37
    v_add_f32 v43, 0x3727c5ac, v43
    v_rsq_f32 v44, v43
    v_mov_b32 v224, v36
    v_mov_b32 v225, v37
    v_fma_f32 v226, v42, v41, v36
    v_mul_f32 v227, v37, v44
    s_add_u32 s24, s62, 0x5d0000
    s_addc_u32 s25, s63, 0
    s_mov_b32 s26, 0x800
    s_mov_b32 s27, 0x20000
    s_lshl_b32 s36, s29, 3
    v_add_u32 v6, s36, v199
    v_lshlrev_b32 v6, 4, v6
    s_mov_b64 exec, 0xff
    buffer_store_dwordx4 v[224:227], v6, s[24:27], 0 offen sc1
    s_mov_b64 exec, -1
    s_add_u32 s53, s55, 1280
    v_mov_b32 v8, 1
    v_mov_b32 v9, 162816
    v_mov_b32 v11, 0
    s_mov_b64 exec, 1
    s_waitcnt vmcnt(0)
    buffer_atomic_add v8, v11, s[56:59], s53 offen sc1
pub_17:
    s_mov_b64 exec, -1
R_nl:
    s_cmp_ge_u32 s30, 4
    s_cbranch_scc1 LOADERS
    s_mov_b32 s34, s30
    s_mov_b32 s35, 0
    v_and_b32 v22, 15, v1
    v_lshrrev_b32 v23, 4, v1
    s_mul_i32 s37, s34, 2
    s_mul_i32 s38, s99, 4
    s_mul_i32 s36, s35, 4
    s_add_u32 s38, s38, s36
    s_mov_b32 s8, s62
    s_mov_b32 s9, s63
    s_mov_b32 s10, 0x7e000
    s_mov_b32 s11, 0x20000
    v_add_u32 v126, 0, v2
    v_add_u32 v127, 65536, v2
    v_add_u32 v128, 4096, v2
    v_add_u32 v129, 69632, v2
    s_lshr_b32 s36, s67, 2
    s_add_u32 s36, s36, 0
    s_and_b32 s36, s36, 3
    s_lshl_b32 s44, s36, 14
    s_lshl_b32 s36, s34, 17
    s_add_u32 s44, s44, s36
    s_lshr_b32 s36, s67, 2
    s_add_u32 s36, s36, 1
    s_and_b32 s36, s36, 3
    s_lshl_b32 s45, s36, 14
    s_lshl_b32 s36, s34, 17
    s_add_u32 s45, s45, s36
    s_lshr_b32 s36, s67, 2
    s_add_u32 s36, s36, 2
    s_and_b32 s36, s36, 3
    s_lshl_b32 s46, s36, 14
    s_lshl_b32 s36, s34, 17
    s_add_u32 s46, s46, s36
    s_lshr_b32 s36, s67, 2
    s_add_u32 s36, s36, 3
    s_and_b32 s36, s36, 3
    s_lshl_b32 s47, s36, 14
    s_lshl_b32 s36, s34, 17
    s_add_u32 s47, s47, s36
    v_lshrrev_b32 v6, 2, v1
    v_mul_u32_u24 v13, 128, v6
    v_and_b32 v7, 3, v1
    v_lshl_add_u32 v13, v7, 3, v13
    v_add_u32 v13, 24576, v13
    v_bfe_u32 v6, v6, 1, 2
    s_mul_i32 s36, s35, 4
    s_add_u32 s36, s36, 3
    v_xor_b32 v7, s36, v6
    v_lshl_add_u32 v16, v7, 5, v13
    s_mul_i32 s36, s35, 4
    s_add_u32 s36, s36, 2
    v_xor_b32 v7, s36, v6
    v_lshl_add_u32 v15, v7, 5, v13
    s_mul_i32 s36, s35, 4
    s_add_u32 s36, s36, 1
    v_xor_b32 v7, s36, v6
    v_lshl_add_u32 v14, v7, 5, v13
    s_mul_i32 s36, s35, 4
    s_add_u32 s36, s36, 0
    v_xor_b32 v7, s36, v6
    v_lshl_add_u32 v13, v7, 5, v13
    v_pk_mov_b32 v[24:25], 0, 0
    v_pk_mov_b32 v[26:27], 0, 0
    v_pk_mov_b32 v[28:29], 0, 0
    v_pk_mov_b32 v[30:31], 0, 0
    v_pk_mov_b32 v[32:33], 0, 0
    v_pk_mov_b32 v[34:35], 0, 0
    v_pk_mov_b32 v[36:37], 0, 0
    v_pk_mov_b32 v[38:39], 0, 0
    v_pk_mov_b32 v[40:41], 0, 0
    v_pk_mov_b32 v[42:43], 0, 0
    v_pk_mov_b32 v[44:45], 0, 0
    v_pk_mov_b32 v[46:47], 0, 0
    v_pk_mov_b32 v[48:49], 0, 0
    v_pk_mov_b32 v[50:51], 0, 0
    v_pk_mov_b32 v[52:53], 0, 0
    v_pk_mov_b32 v[54:55], 0, 0
    s_mov_b32 s43, 0
    s_mul_i32 s36, s35, 256
    s_add_u32 s36, s36, 163328
    v_lshlrev_b32 v6, 4, v23
    v_add_u32 v6, s36, v6
    s_lshl_b32 s36, s37, 8
    s_add_u32 s36, s36, 160776
    v_lshlrev_b32 v7, 4, v22
    v_add_u32 v7, s36, v7
    s_add_u32 s16, s4, 0xa000000
    s_addc_u32 s17, s5, 0
    s_mov_b32 s18, 0x800000
    s_mov_b32 s19, 0x20000
    v_mul_u32_u24 v12, 65536, v23
    v_lshl_add_u32 v12, v22, 4, v12
    s_mul_i32 s39, s38, 131072
    s_lshl_b32 s36, s37, 8
    s_add_u32 s39, s39, s36
    s_add_u32 s39, s39, 16384
    s_lshl_b32 s36, s28, 11
    s_add_u32 s39, s39, s36
    s_lshr_b32 s36, s29, 2
    s_xor_b32 s36, s36, s94
    s_and_b32 s36, s36, 1
    s_lshl_b32 s36, s36, 13
    s_add_u32 s39, s39, s36
    s_add_u32 s40, s39, 262144
    s_lshl_b32 s36, s29, 1
    s_lshr_b32 s53, s36, 3
    s_lshl_b32 s53, s53, 14
    s_and_b32 s41, s36, 7
    s_lshl_b32 s41, s41, 10
    s_add_u32 s41, s41, s53
    s_lshl_b32 s36, s37, 16
    s_add_u32 s41, s41, s36
    s_mov_b32 s53, 0
    s_mov_b32 s49, s44
    ds_read_b64_tr_b16 v[56:57], v13 offset:0
    ds_read_b64_tr_b16 v[58:59], v13 offset:2048
    ds_read_b64_tr_b16 v[60:61], v14 offset:0
    ds_read_b64_tr_b16 v[62:63], v14 offset:2048
    ds_read_b64_tr_b16 v[64:65], v15 offset:0
    ds_read_b64_tr_b16 v[66:67], v15 offset:2048
    ds_read_b64_tr_b16 v[68:69], v16 offset:0
    ds_read_b64_tr_b16 v[70:71], v16 offset:2048
    ds_read_b64_tr_b16 v[72:73], v13 offset:4096
    ds_read_b64_tr_b16 v[74:75], v13 offset:6144
    ds_read_b64_tr_b16 v[76:77], v14 offset:4096
    ds_read_b64_tr_b16 v[78:79], v14 offset:6144
    ds_read_b64_tr_b16 v[80:81], v15 offset:4096
    ds_read_b64_tr_b16 v[82:83], v15 offset:6144
    ds_read_b64_tr_b16 v[84:85], v16 offset:4096
    ds_read_b64_tr_b16 v[86:87], v16 offset:6144
dm_18p:
    buffer_load_dwordx4 v[176:179], v126, s[8:11], s44 offen offset:0 sc1
    buffer_load_dwordx4 v[180:183], v127, s[8:11], s44 offen offset:0 sc1
    buffer_load_dwordx4 v[184:187], v126, s[8:11], s44 offen offset:1024 sc1
    buffer_load_dwordx4 v[188:191], v127, s[8:11], s44 offen offset:1024 sc1
    s_waitcnt vmcnt(0)
    v_or3_b32 v17, v176, v180, v184
    v_bitop3_b32 v17, v17, v188, 1 bitop3:0xa8
    v_cmp_ne_u32 vcc, 0, v17
    s_cbranch_vccz dm_18q
    s_sleep 2
    s_add_u32 s53, s53, 1
    s_cmp_lt_u32 s53, s61
    s_cbranch_scc1 dm_18p
    s_mov_b32 s61, 0
dm_18q:
    buffer_load_dwordx4 v[192:195], v126, s[8:11], s44 offen offset:2048 sc1
    buffer_load_dwordx4 v[196:199], v127, s[8:11], s44 offen offset:2048 sc1
    buffer_load_dwordx4 v[200:203], v126, s[8:11], s44 offen offset:3072 sc1
    buffer_load_dwordx4 v[204:207], v127, s[8:11], s44 offen offset:3072 sc1
    buffer_load_dwordx4 v[208:211], v128, s[8:11], s44 offen offset:0 sc1
    buffer_load_dwordx4 v[212:215], v129, s[8:11], s44 offen offset:0 sc1
    buffer_load_dwordx4 v[216:219], v128, s[8:11], s44 offen offset:1024 sc1
    buffer_load_dwordx4 v[220:223], v129, s[8:11], s44 offen offset:1024 sc1
    buffer_load_dwordx4 v[224:227], v128, s[8:11], s44 offen offset:2048 sc1
    buffer_load_dwordx4 v[228:231], v129, s[8:11], s44 offen offset:2048 sc1
    s_waitcnt lgkmcnt(0)
dm_18:
    v_mfma_f32_16x16x32_bf16 v[24:27], v[56:59], v[176:179], v[24:27]
    ds_read_b64_tr_b16 v[88:89], v13 offset:8192
    buffer_load_dwordx4 v[232:235], v128, s[8:11], s44 offen offset:3072 sc1
    v_mfma_f32_16x16x32_bf16 v[40:43], v[56:59], v[180:183], v[40:43]
    ds_read_b64_tr_b16 v[90:91], v13 offset:10240
    buffer_load_dwordx4 v[236:239], v129, s[8:11], s44 offen offset:3072 sc1
    v_mfma_f32_16x16x32_bf16 v[44:47], v[60:63], v[180:183], v[44:47]
    ds_read_b64_tr_b16 v[92:93], v14 offset:8192
    s_mov_b32 s44, s45
    v_mfma_f32_16x16x32_bf16 v[28:31], v[60:63], v[176:179], v[28:31]
    ds_read_b64_tr_b16 v[94:95], v14 offset:10240
    s_mov_b32 s45, s46
    v_mfma_f32_16x16x32_bf16 v[32:35], v[64:67], v[176:179], v[32:35]
    ds_read_b64_tr_b16 v[96:97], v15 offset:8192
    s_mov_b32 s46, s47
    v_mfma_f32_16x16x32_bf16 v[48:51], v[64:67], v[180:183], v[48:51]
    ds_read_b64_tr_b16 v[98:99], v15 offset:10240
    s_mov_b32 s47, 1048576
    v_mfma_f32_16x16x32_bf16 v[52:55], v[68:71], v[180:183], v[52:55]
    ds_read_b64_tr_b16 v[100:101], v16 offset:8192
    v_mfma_f32_16x16x32_bf16 v[36:39], v[68:71], v[176:179], v[36:39]
    ds_read_b64_tr_b16 v[102:103], v16 offset:10240
    s_waitcnt lgkmcnt(8)
    v_mfma_f32_16x16x32_bf16 v[24:27], v[72:75], v[184:187], v[24:27]
    ds_read_b64_tr_b16 v[104:105], v13 offset:12288
    buffer_load_dwordx4 v[176:179], v126, s[8:11], s44 offen offset:0 sc1
    v_mfma_f32_16x16x32_bf16 v[40:43], v[72:75], v[188:191], v[40:43]
    ds_read_b64_tr_b16 v[106:107], v13 offset:14336
    buffer_load_dwordx4 v[180:183], v127, s[8:11], s44 offen offset:0 sc1
    v_mfma_f32_16x16x32_bf16 v[44:47], v[76:79], v[188:191], v[44:47]
    ds_read_b64_tr_b16 v[108:109], v14 offset:12288
    s_waitcnt vmcnt(10)
    v_mfma_f32_16x16x32_bf16 v[28:31], v[76:79], v[184:187], v[28:31]
    ds_read_b64_tr_b16 v[110:111], v14 offset:14336
    v_or3_b32 v17, v192, v196, v200
    v_mfma_f32_16x16x32_bf16 v[32:35], v[80:83], v[184:187], v[32:35]
    ds_read_b64_tr_b16 v[112:113], v15 offset:12288
    v_bitop3_b32 v17, v17, v204, 1 bitop3:0xa8
    v_mfma_f32_16x16x32_bf16 v[48:51], v[80:83], v[188:191], v[48:51]
    ds_read_b64_tr_b16 v[114:115], v15 offset:14336
    v_cmp_ne_u32 vcc, 0, v17
    v_mfma_f32_16x16x32_bf16 v[52:55], v[84:87], v[188:191], v[52:55]
    ds_read_b64_tr_b16 v[116:117], v16 offset:12288
    ds_read_b64_tr_b16 v[118:119], v16 offset:14336
    v_mfma_f32_16x16x32_bf16 v[36:39], v[84:87], v[184:187], v[36:39]
    s_waitcnt lgkmcnt(8)
    s_cbranch_vccnz dm_18f0
dm_18g0:
    v_mfma_f32_16x16x32_bf16 v[24:27], v[88:91], v[192:195], v[24:27]
    ds_read_b64_tr_b16 v[56:57], v13 offset:16384
    buffer_load_dwordx4 v[184:187], v126, s[8:11], s44 offen offset:1024 sc1
    v_mfma_f32_16x16x32_bf16 v[40:43], v[88:91], v[196:199], v[40:43]
    ds_read_b64_tr_b16 v[58:59], v13 offset:18432
    buffer_load_dwordx4 v[188:191], v127, s[8:11], s44 offen offset:1024 sc1
    v_mfma_f32_16x16x32_bf16 v[44:47], v[92:95], v[196:199], v[44:47]
    ds_read_b64_tr_b16 v[60:61], v14 offset:16384
    v_mfma_f32_16x16x32_bf16 v[28:31], v[92:95], v[192:195], v[28:31]
    ds_read_b64_tr_b16 v[62:63], v14 offset:18432
    v_mfma_f32_16x16x32_bf16 v[32:35], v[96:99], v[192:195], v[32:35]
    ds_read_b64_tr_b16 v[64:65], v15 offset:16384
    v_mfma_f32_16x16x32_bf16 v[48:51], v[96:99], v[196:199], v[48:51]
    ds_read_b64_tr_b16 v[66:67], v15 offset:18432
    v_mfma_f32_16x16x32_bf16 v[52:55], v[100:103], v[196:199], v[52:55]
    ds_read_b64_tr_b16 v[68:69], v16 offset:16384
    v_mfma_f32_16x16x32_bf16 v[36:39], v[100:103], v[192:195], v[36:39]
    ds_read_b64_tr_b16 v[70:71], v16 offset:18432
    s_waitcnt lgkmcnt(8)
    v_mfma_f32_16x16x32_bf16 v[24:27], v[104:107], v[200:203], v[24:27]
    ds_read_b64_tr_b16 v[72:73], v13 offset:20480
    buffer_load_dwordx4 v[192:195], v126, s[8:11], s44 offen offset:2048 sc1
    v_mfma_f32_16x16x32_bf16 v[40:43], v[104:107], v[204:207], v[40:43]
    ds_read_b64_tr_b16 v[74:75], v13 offset:22528
    buffer_load_dwordx4 v[196:199], v127, s[8:11], s44 offen offset:2048 sc1
    v_mfma_f32_16x16x32_bf16 v[44:47], v[108:111], v[204:207], v[44:47]
    ds_read_b64_tr_b16 v[76:77], v14 offset:20480
    s_waitcnt vmcnt(10)
    v_mfma_f32_16x16x32_bf16 v[28:31], v[108:111], v[200:203], v[28:31]
    ds_read_b64_tr_b16 v[78:79], v14 offset:22528
    v_or3_b32 v17, v208, v212, v216
    v_mfma_f32_16x16x32_bf16 v[32:35], v[112:115], v[200:203], v[32:35]
    ds_read_b64_tr_b16 v[80:81], v15 offset:20480
    v_bitop3_b32 v17, v17, v220, 1 bitop3:0xa8
    v_mfma_f32_16x16x32_bf16 v[48:51], v[112:115], v[204:207], v[48:51]
    ds_read_b64_tr_b16 v[82:83], v15 offset:22528
    v_cmp_ne_u32 vcc, 0, v17
    v_mfma_f32_16x16x32_bf16 v[52:55], v[116:119], v[204:207], v[52:55]
    ds_read_b64_tr_b16 v[84:85], v16 offset:20480
    ds_read_b64_tr_b16 v[86:87], v16 offset:22528
    v_mfma_f32_16x16x32_bf16 v[36:39], v[116:119], v[200:203], v[36:39]
    s_waitcnt lgkmcnt(8)
    s_cbranch_vccnz dm_18f1
dm_18g1:
    v_mfma_f32_16x16x32_bf16 v[24:27], v[56:59], v[208:211], v[24:27]
    ds_read_b64_tr_b16 v[88:89], v13 offset:24576
    buffer_load_dwordx4 v[200:203], v126, s[8:11], s44 offen offset:3072 sc1
    v_mfma_f32_16x16x32_bf16 v[40:43], v[56:59], v[212:215], v[40:43]
    ds_read_b64_tr_b16 v[90:91], v13 offset:26624
    buffer_load_dwordx4 v[204:207], v127, s[8:11], s44 offen offset:3072 sc1
    v_mfma_f32_16x16x32_bf16 v[44:47], v[60:63], v[212:215], v[44:47]
    ds_read_b64_tr_b16 v[92:93], v14 offset:24576
    s_add_u32 s43, s43, 1
    v_mfma_f32_16x16x32_bf16 v[28:31], v[60:63], v[208:211], v[28:31]
    ds_read_b64_tr_b16 v[94:95], v14 offset:26624
    s_cmp_eq_u32 s43, 4
    v_mfma_f32_16x16x32_bf16 v[32:35], v[64:67], v[208:211], v[32:35]
    ds_read_b64_tr_b16 v[96:97], v15 offset:24576
    v_mfma_f32_16x16x32_bf16 v[48:51], v[64:67], v[212:215], v[48:51]
    ds_read_b64_tr_b16 v[98:99], v15 offset:26624
    v_mfma_f32_16x16x32_bf16 v[52:55], v[68:71], v[212:215], v[52:55]
    ds_read_b64_tr_b16 v[100:101], v16 offset:24576
    v_mfma_f32_16x16x32_bf16 v[36:39], v[68:71], v[208:211], v[36:39]
    ds_read_b64_tr_b16 v[102:103], v16 offset:26624
    s_waitcnt lgkmcnt(8)
    v_mfma_f32_16x16x32_bf16 v[24:27], v[72:75], v[216:219], v[24:27]
    ds_read_b64_tr_b16 v[104:105], v13 offset:28672
    buffer_load_dwordx4 v[208:211], v128, s[8:11], s44 offen offset:0 sc1
    v_mfma_f32_16x16x32_bf16 v[40:43], v[72:75], v[220:223], v[40:43]
    ds_read_b64_tr_b16 v[106:107], v13 offset:30720
    buffer_load_dwordx4 v[212:215], v129, s[8:11], s44 offen offset:0 sc1
    v_mfma_f32_16x16x32_bf16 v[44:47], v[76:79], v[220:223], v[44:47]
    ds_read_b64_tr_b16 v[108:109], v14 offset:28672
    s_waitcnt vmcnt(10)
    v_mfma_f32_16x16x32_bf16 v[28:31], v[76:79], v[216:219], v[28:31]
    ds_read_b64_tr_b16 v[110:111], v14 offset:30720
    v_add_u32 v13, 32768, v13
    v_or3_b32 v17, v224, v228, v232
    v_mfma_f32_16x16x32_bf16 v[32:35], v[80:83], v[216:219], v[32:35]
    ds_read_b64_tr_b16 v[112:113], v15 offset:28672
    v_add_u32 v14, 32768, v14
    v_bitop3_b32 v17, v17, v236, 1 bitop3:0xa8
    v_mfma_f32_16x16x32_bf16 v[48:51], v[80:83], v[220:223], v[48:51]
    ds_read_b64_tr_b16 v[114:115], v15 offset:30720
    v_add_u32 v15, 32768, v15
    v_cmp_ne_u32 vcc, 0, v17
    v_mfma_f32_16x16x32_bf16 v[52:55], v[84:87], v[220:223], v[52:55]
    ds_read_b64_tr_b16 v[116:117], v16 offset:28672
    ds_read_b64_tr_b16 v[118:119], v16 offset:30720
    v_mfma_f32_16x16x32_bf16 v[36:39], v[84:87], v[216:219], v[36:39]
    v_add_u32 v16, 32768, v16
    s_waitcnt lgkmcnt(8)
    s_cbranch_vccnz dm_18f2
dm_18g2:
    s_cbranch_scc1 dm_18x
    v_mfma_f32_16x16x32_bf16 v[24:27], v[88:91], v[224:227], v[24:27]
    ds_read_b64_tr_b16 v[56:57], v13 offset:0
    buffer_load_dwordx4 v[216:219], v128, s[8:11], s44 offen offset:1024 sc1
    v_mfma_f32_16x16x32_bf16 v[40:43], v[88:91], v[228:231], v[40:43]
    ds_read_b64_tr_b16 v[58:59], v13 offset:2048
    buffer_load_dwordx4 v[220:223], v129, s[8:11], s44 offen offset:1024 sc1
    v_mfma_f32_16x16x32_bf16 v[44:47], v[92:95], v[228:231], v[44:47]
    ds_read_b64_tr_b16 v[60:61], v14 offset:0
    s_mov_b32 s49, s44
    v_mfma_f32_16x16x32_bf16 v[28:31], v[92:95], v[224:227], v[28:31]
    ds_read_b64_tr_b16 v[62:63], v14 offset:2048
    v_mfma_f32_16x16x32_bf16 v[32:35], v[96:99], v[224:227], v[32:35]
    ds_read_b64_tr_b16 v[64:65], v15 offset:0
    v_mfma_f32_16x16x32_bf16 v[48:51], v[96:99], v[228:231], v[48:51]
    ds_read_b64_tr_b16 v[66:67], v15 offset:2048
    v_mfma_f32_16x16x32_bf16 v[52:55], v[100:103], v[228:231], v[52:55]
    ds_read_b64_tr_b16 v[68:69], v16 offset:0
    v_mfma_f32_16x16x32_bf16 v[36:39], v[100:103], v[224:227], v[36:39]
    ds_read_b64_tr_b16 v[70:71], v16 offset:2048
    s_waitcnt lgkmcnt(8)
    v_mfma_f32_16x16x32_bf16 v[24:27], v[104:107], v[232:235], v[24:27]
    ds_read_b64_tr_b16 v[72:73], v13 offset:4096
    buffer_load_dwordx4 v[224:227], v128, s[8:11], s44 offen offset:2048 sc1
    v_mfma_f32_16x16x32_bf16 v[40:43], v[104:107], v[236:239], v[40:43]
    ds_read_b64_tr_b16 v[74:75], v13 offset:6144
    buffer_load_dwordx4 v[228:231], v129, s[8:11], s44 offen offset:2048 sc1
    v_mfma_f32_16x16x32_bf16 v[44:47], v[108:111], v[236:239], v[44:47]
    ds_read_b64_tr_b16 v[76:77], v14 offset:4096
    s_waitcnt vmcnt(10)
    v_mfma_f32_16x16x32_bf16 v[28:31], v[108:111], v[232:235], v[28:31]
    ds_read_b64_tr_b16 v[78:79], v14 offset:6144
    v_or3_b32 v17, v176, v180, v184
    v_mfma_f32_16x16x32_bf16 v[32:35], v[112:115], v[232:235], v[32:35]
    ds_read_b64_tr_b16 v[80:81], v15 offset:4096
    v_bitop3_b32 v17, v17, v188, 1 bitop3:0xa8
    v_mfma_f32_16x16x32_bf16 v[48:51], v[112:115], v[236:239], v[48:51]
    ds_read_b64_tr_b16 v[82:83], v15 offset:6144
    v_cmp_ne_u32 vcc, 0, v17
    v_mfma_f32_16x16x32_bf16 v[52:55], v[116:119], v[236:239], v[52:55]
    ds_read_b64_tr_b16 v[84:85], v16 offset:4096
    ds_read_b64_tr_b16 v[86:87], v16 offset:6144
    v_mfma_f32_16x16x32_bf16 v[36:39], v[116:119], v[232:235], v[36:39]
    s_waitcnt lgkmcnt(8)
    s_cbranch_vccnz dm_18f3
dm_18g3:
    s_branch dm_18
dm_18f0:
    s_cselect_b32 s50, 1, 0
dm_18h0:
    s_sleep 2
    buffer_load_dwordx4 v[192:195], v126, s[8:11], s49 offen offset:2048 sc1
    buffer_load_dwordx4 v[196:199], v127, s[8:11], s49 offen offset:2048 sc1
    buffer_load_dwordx4 v[200:203], v126, s[8:11], s49 offen offset:3072 sc1
    buffer_load_dwordx4 v[204:207], v127, s[8:11], s49 offen offset:3072 sc1
    buffer_load_dwordx4 v[208:211], v128, s[8:11], s49 offen offset:0 sc1
    buffer_load_dwordx4 v[212:215], v129, s[8:11], s49 offen offset:0 sc1
    buffer_load_dwordx4 v[216:219], v128, s[8:11], s49 offen offset:1024 sc1
    buffer_load_dwordx4 v[220:223], v129, s[8:11], s49 offen offset:1024 sc1
    buffer_load_dwordx4 v[224:227], v128, s[8:11], s49 offen offset:2048 sc1
    buffer_load_dwordx4 v[228:231], v129, s[8:11], s49 offen offset:2048 sc1
    buffer_load_dwordx4 v[232:235], v128, s[8:11], s49 offen offset:3072 sc1
    buffer_load_dwordx4 v[236:239], v129, s[8:11], s49 offen offset:3072 sc1
    buffer_load_dwordx4 v[176:179], v126, s[8:11], s44 offen offset:0 sc1
    buffer_load_dwordx4 v[180:183], v127, s[8:11], s44 offen offset:0 sc1
    s_waitcnt vmcnt(10)
    v_or3_b32 v17, v192, v196, v200
    v_bitop3_b32 v17, v17, v204, 1 bitop3:0xa8
    v_cmp_ne_u32 vcc, 0, v17
    s_add_u32 s53, s53, 1
    s_cmp_ge_u32 s53, s61
    s_cselect_b32 s61, 0, s61
    s_cbranch_scc1 dm_18k0
    s_cbranch_vccnz dm_18h0
dm_18k0:
    s_cmp_eq_u32 s50, 1
    s_branch dm_18g0
dm_18f1:
    s_cselect_b32 s50, 1, 0
dm_18h1:
    s_sleep 2
    buffer_load_dwordx4 v[208:211], v128, s[8:11], s49 offen offset:0 sc1
    buffer_load_dwordx4 v[212:215], v129, s[8:11], s49 offen offset:0 sc1
    buffer_load_dwordx4 v[216:219], v128, s[8:11], s49 offen offset:1024 sc1
    buffer_load_dwordx4 v[220:223], v129, s[8:11], s49 offen offset:1024 sc1
    buffer_load_dwordx4 v[224:227], v128, s[8:11], s49 offen offset:2048 sc1
    buffer_load_dwordx4 v[228:231], v129, s[8:11], s49 offen offset:2048 sc1
    buffer_load_dwordx4 v[232:235], v128, s[8:11], s49 offen offset:3072 sc1
    buffer_load_dwordx4 v[236:239], v129, s[8:11], s49 offen offset:3072 sc1
    buffer_load_dwordx4 v[176:179], v126, s[8:11], s44 offen offset:0 sc1
    buffer_load_dwordx4 v[180:183], v127, s[8:11], s44 offen offset:0 sc1
    buffer_load_dwordx4 v[184:187], v126, s[8:11], s44 offen offset:1024 sc1
    buffer_load_dwordx4 v[188:191], v127, s[8:11], s44 offen offset:1024 sc1
    buffer_load_dwordx4 v[192:195], v126, s[8:11], s44 offen offset:2048 sc1
    buffer_load_dwordx4 v[196:199], v127, s[8:11], s44 offen offset:2048 sc1
    s_waitcnt vmcnt(10)
    v_or3_b32 v17, v208, v212, v216
    v_bitop3_b32 v17, v17, v220, 1 bitop3:0xa8
    v_cmp_ne_u32 vcc, 0, v17
    s_add_u32 s53, s53, 1
    s_cmp_ge_u32 s53, s61
    s_cselect_b32 s61, 0, s61
    s_cbranch_scc1 dm_18k1
    s_cbranch_vccnz dm_18h1
dm_18k1:
    s_cmp_eq_u32 s50, 1
    s_branch dm_18g1
dm_18f2:
    s_cselect_b32 s50, 1, 0
dm_18h2:
    s_sleep 2
    buffer_load_dwordx4 v[224:227], v128, s[8:11], s49 offen offset:2048 sc1
    buffer_load_dwordx4 v[228:231], v129, s[8:11], s49 offen offset:2048 sc1
    buffer_load_dwordx4 v[232:235], v128, s[8:11], s49 offen offset:3072 sc1
    buffer_load_dwordx4 v[236:239], v129, s[8:11], s49 offen offset:3072 sc1
    buffer_load_dwordx4 v[176:179], v126, s[8:11], s44 offen offset:0 sc1
    buffer_load_dwordx4 v[180:183], v127, s[8:11], s44 offen offset:0 sc1
    buffer_load_dwordx4 v[184:187], v126, s[8:11], s44 offen offset:1024 sc1
    buffer_load_dwordx4 v[188:191], v127, s[8:11], s44 offen offset:1024 sc1
    buffer_load_dwordx4 v[192:195], v126, s[8:11], s44 offen offset:2048 sc1
    buffer_load_dwordx4 v[196:199], v127, s[8:11], s44 offen offset:2048 sc1
    buffer_load_dwordx4 v[200:203], v126, s[8:11], s44 offen offset:3072 sc1
    buffer_load_dwordx4 v[204:207], v127, s[8:11], s44 offen offset:3072 sc1
    buffer_load_dwordx4 v[208:211], v128, s[8:11], s44 offen offset:0 sc1
    buffer_load_dwordx4 v[212:215], v129, s[8:11], s44 offen offset:0 sc1
    s_waitcnt vmcnt(10)
    v_or3_b32 v17, v224, v228, v232
    v_bitop3_b32 v17, v17, v236, 1 bitop3:0xa8
    v_cmp_ne_u32 vcc, 0, v17
    s_add_u32 s53, s53, 1
    s_cmp_ge_u32 s53, s61
    s_cselect_b32 s61, 0, s61
    s_cbranch_scc1 dm_18k2
    s_cbranch_vccnz dm_18h2
dm_18k2:
    s_cmp_eq_u32 s50, 1
    s_branch dm_18g2
dm_18f3:
    s_cselect_b32 s50, 1, 0
dm_18h3:
    s_sleep 2
    buffer_load_dwordx4 v[176:179], v126, s[8:11], s49 offen offset:0 sc1
    buffer_load_dwordx4 v[180:183], v127, s[8:11], s49 offen offset:0 sc1
    buffer_load_dwordx4 v[184:187], v126, s[8:11], s49 offen offset:1024 sc1
    buffer_load_dwordx4 v[188:191], v127, s[8:11], s49 offen offset:1024 sc1
    buffer_load_dwordx4 v[192:195], v126, s[8:11], s49 offen offset:2048 sc1
    buffer_load_dwordx4 v[196:199], v127, s[8:11], s49 offen offset:2048 sc1
    buffer_load_dwordx4 v[200:203], v126, s[8:11], s49 offen offset:3072 sc1
    buffer_load_dwordx4 v[204:207], v127, s[8:11], s49 offen offset:3072 sc1
    buffer_load_dwordx4 v[208:211], v128, s[8:11], s49 offen offset:0 sc1
    buffer_load_dwordx4 v[212:215], v129, s[8:11], s49 offen offset:0 sc1
    buffer_load_dwordx4 v[216:219], v128, s[8:11], s49 offen offset:1024 sc1
    buffer_load_dwordx4 v[220:223], v129, s[8:11], s49 offen offset:1024 sc1
    buffer_load_dwordx4 v[224:227], v128, s[8:11], s49 offen offset:2048 sc1
    buffer_load_dwordx4 v[228:231], v129, s[8:11], s49 offen offset:2048 sc1
    s_waitcnt vmcnt(10)
    v_or3_b32 v17, v176, v180, v184
    v_bitop3_b32 v17, v17, v188, 1 bitop3:0xa8
    v_cmp_ne_u32 vcc, 0, v17
    s_add_u32 s53, s53, 1
    s_cmp_ge_u32 s53, s61
    s_cselect_b32 s61, 0, s61
    s_cbranch_scc1 dm_18k3
    s_cbranch_vccnz dm_18h3
dm_18k3:
    s_cmp_eq_u32 s50, 1
    s_branch dm_18g3
dm_18x:
    v_mfma_f32_16x16x32_bf16 v[24:27], v[88:91], v[224:227], v[24:27]
    buffer_load_dwordx4 v[160:163], v126, s[8:11], s41 offen offset:0 sc1
    v_mfma_f32_16x16x32_bf16 v[40:43], v[88:91], v[228:231], v[40:43]
    v_mfma_f32_16x16x32_bf16 v[44:47], v[92:95], v[228:231], v[44:47]
    buffer_load_dwordx4 v[164:167], v126, s[8:11], s41 offen offset:1024 sc1
    v_mfma_f32_16x16x32_bf16 v[28:31], v[92:95], v[224:227], v[28:31]
    v_mfma_f32_16x16x32_bf16 v[32:35], v[96:99], v[224:227], v[32:35]
    buffer_load_dwordx4 v[168:171], v127, s[8:11], s41 offen offset:0 sc1
    v_mfma_f32_16x16x32_bf16 v[48:51], v[96:99], v[228:231], v[48:51]
    v_mfma_f32_16x16x32_bf16 v[52:55], v[100:103], v[228:231], v[52:55]
    buffer_load_dwordx4 v[172:175], v127, s[8:11], s41 offen offset:1024 sc1
    v_mfma_f32_16x16x32_bf16 v[36:39], v[100:103], v[224:227], v[36:39]
    s_waitcnt lgkmcnt(0)
    s_barrier
    v_mfma_f32_16x16x32_bf16 v[24:27], v[104:107], v[232:235], v[24:27]
    ds_read_b128 v[56:59], v6 offset:0
    v_mfma_f32_16x16x32_bf16 v[40:43], v[104:107], v[236:239], v[40:43]
    ds_read_b128 v[60:63], v6 offset:64
    v_mfma_f32_16x16x32_bf16 v[44:47], v[108:111], v[236:239], v[44:47]
    ds_read_b128 v[64:67], v6 offset:128
    v_mfma_f32_16x16x32_bf16 v[28:31], v[108:111], v[232:235], v[28:31]
    ds_read_b128 v[68:71], v6 offset:192
    v_mfma_f32_16x16x32_bf16 v[32:35], v[112:115], v[232:235], v[32:35]
    ds_read_b64 v[72:73], v7 offset:0
    v_mfma_f32_16x16x32_bf16 v[48:51], v[112:115], v[236:239], v[48:51]
    ds_read_b64 v[74:75], v7 offset:256
    v_mfma_f32_16x16x32_bf16 v[52:55], v[116:119], v[236:239], v[52:55]
    v_mfma_f32_16x16x32_bf16 v[36:39], v[116:119], v[232:235], v[36:39]
    s_waitcnt lgkmcnt(0)
    v_mul_f32 v134, 0xc0135761, v73
    v_mul_f32 v135, v73, v73
    v_mul_f32 v135, v135, v134
    v_mul_f32 v135, 0x3d372713, v135
    v_rcp_f32 v73, v73
    v_mul_f32 v136, 0xc0135761, v75
    v_mul_f32 v137, v75, v75
    v_mul_f32 v137, v137, v136
    v_mul_f32 v137, 0x3d372713, v137
    v_rcp_f32 v75, v75
    v_pk_fma_f32 v[24:25], v[72:73], v[56:57], v[24:25] op_sel_hi:[0,1,1] neg_lo:[1,0,0] neg_hi:[1,0,0]
    v_pk_fma_f32 v[26:27], v[72:73], v[58:59], v[26:27] op_sel_hi:[0,1,1] neg_lo:[1,0,0] neg_hi:[1,0,0]
    v_pk_mul_f32 v[122:123], v[24:25], v[24:25]
    v_pk_mul_f32 v[124:125], v[26:27], v[26:27]
    v_pk_fma_f32 v[122:123], v[122:123], v[134:135], v[134:135] op_sel:[0,1,0] op_sel_hi:[1,1,0]
    v_pk_fma_f32 v[124:125], v[124:125], v[134:135], v[134:135] op_sel:[0,1,0] op_sel_hi:[1,1,0]
    v_pk_mul_f32 v[122:123], v[122:123], v[24:25]
    v_pk_mul_f32 v[124:125], v[124:125], v[26:27]
    v_exp_f32 v122, v122
    v_exp_f32 v123, v123
    v_exp_f32 v124, v124
    v_exp_f32 v125, v125
    v_pk_fma_f32 v[122:123], v[122:123], v[72:73], v[72:73] op_sel:[0,1,1] op_sel_hi:[1,1,1]
    v_pk_fma_f32 v[124:125], v[124:125], v[72:73], v[72:73] op_sel:[0,1,1] op_sel_hi:[1,1,1]
    v_rcp_f32 v122, v122
    v_rcp_f32 v123, v123
    v_rcp_f32 v124, v124
    v_rcp_f32 v125, v125
    v_pk_mul_f32 v[24:25], v[24:25], v[122:123]
    v_pk_mul_f32 v[26:27], v[26:27], v[124:125]
    v_pk_fma_f32 v[28:29], v[72:73], v[60:61], v[28:29] op_sel_hi:[0,1,1] neg_lo:[1,0,0] neg_hi:[1,0,0]
    v_pk_fma_f32 v[30:31], v[72:73], v[62:63], v[30:31] op_sel_hi:[0,1,1] neg_lo:[1,0,0] neg_hi:[1,0,0]
    v_pk_mul_f32 v[122:123], v[28:29], v[28:29]
    v_pk_mul_f32 v[124:125], v[30:31], v[30:31]
    v_pk_fma_f32 v[122:123], v[122:123], v[134:135], v[134:135] op_sel:[0,1,0] op_sel_hi:[1,1,0]
    v_pk_fma_f32 v[124:125], v[124:125], v[134:135], v[134:135] op_sel:[0,1,0] op_sel_hi:[1,1,0]
    v_pk_mul_f32 v[122:123], v[122:123], v[28:29]
    v_pk_mul_f32 v[124:125], v[124:125], v[30:31]
    v_exp_f32 v122, v122
    v_exp_f32 v123, v123
    v_exp_f32 v124, v124
    v_exp_f32 v125, v125
    v_pk_fma_f32 v[122:123], v[122:123], v[72:73], v[72:73] op_sel:[0,1,1] op_sel_hi:[1,1,1]
    v_pk_fma_f32 v[124:125], v[124:125], v[72:73], v[72:73] op_sel:[0,1,1] op_sel_hi:[1,1,1]
    v_rcp_f32 v122, v122
    v_rcp_f32 v123, v123
    v_rcp_f32 v124, v124
    v_rcp_f32 v125, v125
    v_pk_mul_f32 v[28:29], v[28:29], v[122:123]
    v_pk_mul_f32 v[30:31], v[30:31], v[124:125]
    v_cvt_pk_bf16_f32 v24, v24, v25
    v_cvt_pk_bf16_f32 v25, v26, v27
    v_cvt_pk_bf16_f32 v26, v28, v29
    v_cvt_pk_bf16_f32 v27, v30, v31
    v_and_or_b32 v24, v24, -2, s60
    buffer_store_dwordx4 v[24:27], v12, s[16:19], s39 offen offset:0 sc1
    v_pk_fma_f32 v[40:41], v[74:75], v[56:57], v[40:41] op_sel_hi:[0,1,1] neg_lo:[1,0,0] neg_hi:[1,0,0]
    v_pk_fma_f32 v[42:43], v[74:75], v[58:59], v[42:43] op_sel_hi:[0,1,1] neg_lo:[1,0,0] neg_hi:[1,0,0]
    v_pk_mul_f32 v[122:123], v[40:41], v[40:41]
    v_pk_mul_f32 v[124:125], v[42:43], v[42:43]
    v_pk_fma_f32 v[122:123], v[122:123], v[136:137], v[136:137] op_sel:[0,1,0] op_sel_hi:[1,1,0]
    v_pk_fma_f32 v[124:125], v[124:125], v[136:137], v[136:137] op_sel:[0,1,0] op_sel_hi:[1,1,0]
    v_pk_mul_f32 v[122:123], v[122:123], v[40:41]
    v_pk_mul_f32 v[124:125], v[124:125], v[42:43]
    v_exp_f32 v122, v122
    v_exp_f32 v123, v123
    v_exp_f32 v124, v124
    v_exp_f32 v125, v125
    v_pk_fma_f32 v[122:123], v[122:123], v[74:75], v[74:75] op_sel:[0,1,1] op_sel_hi:[1,1,1]
    v_pk_fma_f32 v[124:125], v[124:125], v[74:75], v[74:75] op_sel:[0,1,1] op_sel_hi:[1,1,1]
    v_rcp_f32 v122, v122
    v_rcp_f32 v123, v123
    v_rcp_f32 v124, v124
    v_rcp_f32 v125, v125
    v_pk_mul_f32 v[40:41], v[40:41], v[122:123]
    v_pk_mul_f32 v[42:43], v[42:43], v[124:125]
    v_pk_fma_f32 v[44:45], v[74:75], v[60:61], v[44:45] op_sel_hi:[0,1,1] neg_lo:[1,0,0] neg_hi:[1,0,0]
    v_pk_fma_f32 v[46:47], v[74:75], v[62:63], v[46:47] op_sel_hi:[0,1,1] neg_lo:[1,0,0] neg_hi:[1,0,0]
    v_pk_mul_f32 v[122:123], v[44:45], v[44:45]
    v_pk_mul_f32 v[124:125], v[46:47], v[46:47]
    v_pk_fma_f32 v[122:123], v[122:123], v[136:137], v[136:137] op_sel:[0,1,0] op_sel_hi:[1,1,0]
    v_pk_fma_f32 v[124:125], v[124:125], v[136:137], v[136:137] op_sel:[0,1,0] op_sel_hi:[1,1,0]
    v_pk_mul_f32 v[122:123], v[122:123], v[44:45]
    v_pk_mul_f32 v[124:125], v[124:125], v[46:47]
    v_exp_f32 v122, v122
    v_exp_f32 v123, v123
    v_exp_f32 v124, v124
    v_exp_f32 v125, v125
    v_pk_fma_f32 v[122:123], v[122:123], v[74:75], v[74:75] op_sel:[0,1,1] op_sel_hi:[1,1,1]
    v_pk_fma_f32 v[124:125], v[124:125], v[74:75], v[74:75] op_sel:[0,1,1] op_sel_hi:[1,1,1]
    v_rcp_f32 v122, v122
    v_rcp_f32 v123, v123
    v_rcp_f32 v124, v124
    v_rcp_f32 v125, v125
    v_pk_mul_f32 v[44:45], v[44:45], v[122:123]
    v_pk_mul_f32 v[46:47], v[46:47], v[124:125]
    v_cvt_pk_bf16_f32 v40, v40, v41
    v_cvt_pk_bf16_f32 v41, v42, v43
    v_cvt_pk_bf16_f32 v42, v44, v45
    v_cvt_pk_bf16_f32 v43, v46, v47
    v_and_or_b32 v40, v40, -2, s60
    buffer_store_dwordx4 v[40:43], v12, s[16:19], s39 offen offset:256 sc1
    v_pk_fma_f32 v[32:33], v[72:73], v[64:65], v[32:33] op_sel_hi:[0,1,1] neg_lo:[1,0,0] neg_hi:[1,0,0]
    v_pk_fma_f32 v[34:35], v[72:73], v[66:67], v[34:35] op_sel_hi:[0,1,1] neg_lo:[1,0,0] neg_hi:[1,0,0]
    v_pk_mul_f32 v[122:123], v[32:33], v[32:33]
    v_pk_mul_f32 v[124:125], v[34:35], v[34:35]
    v_pk_fma_f32 v[122:123], v[122:123], v[134:135], v[134:135] op_sel:[0,1,0] op_sel_hi:[1,1,0]
    v_pk_fma_f32 v[124:125], v[124:125], v[134:135], v[134:135] op_sel:[0,1,0] op_sel_hi:[1,1,0]
    v_pk_mul_f32 v[122:123], v[122:123], v[32:33]
    v_pk_mul_f32 v[124:125], v[124:125], v[34:35]
    v_exp_f32 v122, v122
    v_exp_f32 v123, v123
    v_exp_f32 v124, v124
    v_exp_f32 v125, v125
    v_pk_fma_f32 v[122:123], v[122:123], v[72:73], v[72:73] op_sel:[0,1,1] op_sel_hi:[1,1,1]
    v_pk_fma_f32 v[124:125], v[124:125], v[72:73], v[72:73] op_sel:[0,1,1] op_sel_hi:[1,1,1]
    v_rcp_f32 v122, v122
    v_rcp_f32 v123, v123
    v_rcp_f32 v124, v124
    v_rcp_f32 v125, v125
    v_pk_mul_f32 v[32:33], v[32:33], v[122:123]
    v_pk_mul_f32 v[34:35], v[34:35], v[124:125]
    v_pk_fma_f32 v[36:37], v[72:73], v[68:69], v[36:37] op_sel_hi:[0,1,1] neg_lo:[1,0,0] neg_hi:[1,0,0]
    v_pk_fma_f32 v[38:39], v[72:73], v[70:71], v[38:39] op_sel_hi:[0,1,1] neg_lo:[1,0,0] neg_hi:[1,0,0]
    v_pk_mul_f32 v[122:123], v[36:37], v[36:37]
    v_pk_mul_f32 v[124:125], v[38:39], v[38:39]
    v_pk_fma_f32 v[122:123], v[122:123], v[134:135], v[134:135] op_sel:[0,1,0] op_sel_hi:[1,1,0]
    v_pk_fma_f32 v[124:125], v[124:125], v[134:135], v[134:135] op_sel:[0,1,0] op_sel_hi:[1,1,0]
    v_pk_mul_f32 v[122:123], v[122:123], v[36:37]
    v_pk_mul_f32 v[124:125], v[124:125], v[38:39]
    v_exp_f32 v122, v122
    v_exp_f32 v123, v123
    v_exp_f32 v124, v124
    v_exp_f32 v125, v125
    v_pk_fma_f32 v[122:123], v[122:123], v[72:73], v[72:73] op_sel:[0,1,1] op_sel_hi:[1,1,1]
    v_pk_fma_f32 v[124:125], v[124:125], v[72:73], v[72:73] op_sel:[0,1,1] op_sel_hi:[1,1,1]
    v_rcp_f32 v122, v122
    v_rcp_f32 v123, v123
    v_rcp_f32 v124, v124
    v_rcp_f32 v125, v125
    v_pk_mul_f32 v[36:37], v[36:37], v[122:123]
    v_pk_mul_f32 v[38:39], v[38:39], v[124:125]
    v_cvt_pk_bf16_f32 v32, v32, v33
    v_cvt_pk_bf16_f32 v33, v34, v35
    v_cvt_pk_bf16_f32 v34, v36, v37
    v_cvt_pk_bf16_f32 v35, v38, v39
    v_and_or_b32 v32, v32, -2, s60
    buffer_store_dwordx4 v[32:35], v12, s[16:19], s40 offen offset:0 sc1
    v_pk_fma_f32 v[48:49], v[74:75], v[64:65], v[48:49] op_sel_hi:[0,1,1] neg_lo:[1,0,0] neg_hi:[1,0,0]
    v_pk_fma_f32 v[50:51], v[74:75], v[66:67], v[50:51] op_sel_hi:[0,1,1] neg_lo:[1,0,0] neg_hi:[1,0,0]
    v_pk_mul_f32 v[122:123], v[48:49], v[48:49]
    v_pk_mul_f32 v[124:125], v[50:51], v[50:51]
    v_pk_fma_f32 v[122:123], v[122:123], v[136:137], v[136:137] op_sel:[0,1,0] op_sel_hi:[1,1,0]
    v_pk_fma_f32 v[124:125], v[124:125], v[136:137], v[136:137] op_sel:[0,1,0] op_sel_hi:[1,1,0]
    v_pk_mul_f32 v[122:123], v[122:123], v[48:49]
    v_pk_mul_f32 v[124:125], v[124:125], v[50:51]
    v_exp_f32 v122, v122
    v_exp_f32 v123, v123
    v_exp_f32 v124, v124
    v_exp_f32 v125, v125
    v_pk_fma_f32 v[122:123], v[122:123], v[74:75], v[74:75] op_sel:[0,1,1] op_sel_hi:[1,1,1]
    v_pk_fma_f32 v[124:125], v[124:125], v[74:75], v[74:75] op_sel:[0,1,1] op_sel_hi:[1,1,1]
    v_rcp_f32 v122, v122
    v_rcp_f32 v123, v123
    v_rcp_f32 v124, v124
    v_rcp_f32 v125, v125
    v_pk_mul_f32 v[48:49], v[48:49], v[122:123]
    v_pk_mul_f32 v[50:51], v[50:51], v[124:125]
    v_pk_fma_f32 v[52:53], v[74:75], v[68:69], v[52:53] op_sel_hi:[0,1,1] neg_lo:[1,0,0] neg_hi:[1,0,0]
    v_pk_fma_f32 v[54:55], v[74:75], v[70:71], v[54:55] op_sel_hi:[0,1,1] neg_lo:[1,0,0] neg_hi:[1,0,0]
    v_pk_mul_f32 v[122:123], v[52:53], v[52:53]
    v_pk_mul_f32 v[124:125], v[54:55], v[54:55]
    v_pk_fma_f32 v[122:123], v[122:123], v[136:137], v[136:137] op_sel:[0,1,0] op_sel_hi:[1,1,0]
    v_pk_fma_f32 v[124:125], v[124:125], v[136:137], v[136:137] op_sel:[0,1,0] op_sel_hi:[1,1,0]
    v_pk_mul_f32 v[122:123], v[122:123], v[52:53]
    v_pk_mul_f32 v[124:125], v[124:125], v[54:55]
    v_exp_f32 v122, v122
    v_exp_f32 v123, v123
    v_exp_f32 v124, v124
    v_exp_f32 v125, v125
    v_pk_fma_f32 v[122:123], v[122:123], v[74:75], v[74:75] op_sel:[0,1,1] op_sel_hi:[1,1,1]
    v_pk_fma_f32 v[124:125], v[124:125], v[74:75], v[74:75] op_sel:[0,1,1] op_sel_hi:[1,1,1]
    v_rcp_f32 v122, v122
    v_rcp_f32 v123, v123
    v_rcp_f32 v124, v124
    v_rcp_f32 v125, v125
    v_pk_mul_f32 v[52:53], v[52:53], v[122:123]
    v_pk_mul_f32 v[54:55], v[54:55], v[124:125]
    v_cvt_pk_bf16_f32 v48, v48, v49
    v_cvt_pk_bf16_f32 v49, v50, v51
    v_cvt_pk_bf16_f32 v50, v52, v53
    v_cvt_pk_bf16_f32 v51, v54, v55
    v_and_or_b32 v48, v48, -2, s60
    buffer_store_dwordx4 v[48:51], v12, s[16:19], s40 offen offset:256 sc1
    s_cmp_lg_u32 s60, 0
    s_cbranch_scc1 G1_np
    s_add_u32 s53, s55, 256
    s_and_b32 s54, s29, 4
    s_lshl_b32 s54, s54, 5
    s_add_u32 s53, s53, s54
    v_mov_b32 v8, 1
    v_mov_b32 v9, 162816
    v_mov_b32 v11, 0
    s_mov_b64 exec, 1
    s_waitcnt vmcnt(0)
    ds_add_rtn_u32 v10, v9, v8
    s_waitcnt lgkmcnt(0)
    v_readfirstlane_b32 s54, v10
    s_nop 0
    s_and_b32 s54, s54, 3
    s_cmp_lg_u32 s54, 3
    s_cbranch_scc1 pub_19
    buffer_atomic_add v8, v11, s[56:59], s53 offen sc1
    v_mov_b32 v9, 162872
    ds_add_u32 v9, v8
pub_19:
    s_mov_b64 exec, -1
G1_np:
    s_mov_b32 s34, s30
    s_mov_b32 s35, 0
    v_and_b32 v22, 15, v1
    v_lshrrev_b32 v23, 4, v1
    s_mul_i32 s37, s34, 2
    s_mul_i32 s38, s29, 4
    s_mul_i32 s36, s35, 4
    s_add_u32 s38, s38, s36
    s_lshr_b32 s36, s38, 1
    s_lshr_b32 s53, s36, 3
    s_lshl_b32 s53, s53, 14
    s_and_b32 s39, s36, 7
    s_lshl_b32 s39, s39, 10
    s_add_u32 s39, s39, s53
    s_lshl_b32 s36, s37, 16
    s_add_u32 s39, s39, s36
    s_add_u32 s8, s4, 0xa000000
    s_addc_u32 s9, s5, 0
    s_mov_b32 s10, 0x800000
    s_mov_b32 s11, 0x20000
    v_mul_u32_u24 v126, 65536, v23
    v_lshl_add_u32 v126, v22, 4, v126
    v_add_u32 v127, 262144, v126
    v_add_u32 v128, 524288, v126
    v_add_u32 v129, 786432, v126
    v_add_u32 v130, 1048576, v126
    v_add_u32 v131, 1310720, v126
    v_add_u32 v132, 1572864, v126
    v_add_u32 v133, 1835008, v126
    s_lshr_b32 s36, s67, 2
    s_add_u32 s36, s36, 0
    s_and_b32 s36, s36, 3
    s_mul_i32 s44, s36, 2097152
    s_xor_b32 s53, s36, s94
    s_and_b32 s53, s53, 1
    s_lshl_b32 s53, s53, 13
    s_add_u32 s44, s44, s53
    s_lshr_b32 s53, s36, 1
    s_lshl_b32 s53, s53, 4
    s_add_u32 s53, s53, 16
    s_sub_u32 s54, 0, s53
    s_bitcmp1_b32 s36, 0
    s_cselect_b32 s53, s53, s54
    s_add_u32 s44, s44, s53
    s_lshl_b32 s36, s28, 2
    s_add_u32 s36, s36, s34
    s_lshl_b32 s36, s36, 9
    s_add_u32 s36, s36, 16384
    s_add_u32 s44, s44, s36
    s_lshr_b32 s36, s67, 2
    s_add_u32 s36, s36, 1
    s_and_b32 s36, s36, 3
    s_mul_i32 s45, s36, 2097152
    s_xor_b32 s53, s36, s94
    s_and_b32 s53, s53, 1
    s_lshl_b32 s53, s53, 13
    s_add_u32 s45, s45, s53
    s_lshr_b32 s53, s36, 1
    s_lshl_b32 s53, s53, 4
    s_add_u32 s53, s53, 16
    s_sub_u32 s54, 0, s53
    s_bitcmp1_b32 s36, 0
    s_cselect_b32 s53, s53, s54
    s_add_u32 s45, s45, s53
    s_lshl_b32 s36, s28, 2
    s_add_u32 s36, s36, s34
    s_lshl_b32 s36, s36, 9
    s_add_u32 s36, s36, 16384
    s_add_u32 s45, s45, s36
    s_lshr_b32 s36, s67, 2
    s_add_u32 s36, s36, 2
    s_and_b32 s36, s36, 3
    s_mul_i32 s46, s36, 2097152
    s_xor_b32 s53, s36, s94
    s_and_b32 s53, s53, 1
    s_lshl_b32 s53, s53, 13
    s_add_u32 s46, s46, s53
    s_lshr_b32 s53, s36, 1
    s_lshl_b32 s53, s53, 4
    s_add_u32 s53, s53, 16
    s_sub_u32 s54, 0, s53
    s_bitcmp1_b32 s36, 0
    s_cselect_b32 s53, s53, s54
    s_add_u32 s46, s46, s53
    s_lshl_b32 s36, s28, 2
    s_add_u32 s36, s36, s34
    s_lshl_b32 s36, s36, 9
    s_add_u32 s36, s36, 16384
    s_add_u32 s46, s46, s36
    s_lshr_b32 s36, s67, 2
    s_add_u32 s36, s36, 3
    s_and_b32 s36, s36, 3
    s_mul_i32 s47, s36, 2097152
    s_xor_b32 s53, s36, s94
    s_and_b32 s53, s53, 1
    s_lshl_b32 s53, s53, 13
    s_add_u32 s47, s47, s53
    s_lshr_b32 s53, s36, 1
    s_lshl_b32 s53, s53, 4
    s_add_u32 s53, s53, 16
    s_sub_u32 s54, 0, s53
    s_bitcmp1_b32 s36, 0
    s_cselect_b32 s53, s53, s54
    s_add_u32 s47, s47, s53
    s_lshl_b32 s36, s28, 2
    s_add_u32 s36, s36, s34
    s_lshl_b32 s36, s36, 9
    s_add_u32 s36, s36, 16384
    s_add_u32 s47, s47, s36
    v_lshrrev_b32 v6, 2, v1
    v_mul_u32_u24 v13, 128, v6
    v_and_b32 v7, 3, v1
    v_lshl_add_u32 v13, v7, 3, v13
    v_add_u32 v13, 0, v13
    v_bfe_u32 v6, v6, 1, 2
    s_mul_i32 s36, s35, 4
    s_add_u32 s36, s36, 3
    v_xor_b32 v7, s36, v6
    v_lshl_add_u32 v16, v7, 5, v13
    s_mul_i32 s36, s35, 4
    s_add_u32 s36, s36, 2
    v_xor_b32 v7, s36, v6
    v_lshl_add_u32 v15, v7, 5, v13
    s_mul_i32 s36, s35, 4
    s_add_u32 s36, s36, 1
    v_xor_b32 v7, s36, v6
    v_lshl_add_u32 v14, v7, 5, v13
    s_mul_i32 s36, s35, 4
    s_add_u32 s36, s36, 0
    v_xor_b32 v7, s36, v6
    v_lshl_add_u32 v13, v7, 5, v13
    s_lshl_b32 s36, s37, 8
    s_add_u32 s36, s36, 160768
    v_lshlrev_b32 v7, 4, v22
    v_add_u32 v7, s36, v7
    ds_read_b64 v[56:57], v7 offset:0
    ds_read_b64 v[58:59], v7 offset:256
    s_waitcnt vmcnt(4) lgkmcnt(0)
    v_lshlrev_b32 v24, 16, v160
    v_and_b32 v25, 0xffff0000, v160
    v_pk_add_f32 v[24:25], v[24:25], v[56:57] op_sel_hi:[1,0] neg_lo:[0,1] neg_hi:[0,1]
    v_pk_mul_f32 v[24:25], v[24:25], v[56:57] op_sel:[0,1] op_sel_hi:[1,1]
    v_lshlrev_b32 v26, 16, v161
    v_and_b32 v27, 0xffff0000, v161
    v_pk_add_f32 v[26:27], v[26:27], v[56:57] op_sel_hi:[1,0] neg_lo:[0,1] neg_hi:[0,1]
    v_pk_mul_f32 v[26:27], v[26:27], v[56:57] op_sel:[0,1] op_sel_hi:[1,1]
    v_lshlrev_b32 v28, 16, v162
    v_and_b32 v29, 0xffff0000, v162
    v_pk_add_f32 v[28:29], v[28:29], v[56:57] op_sel_hi:[1,0] neg_lo:[0,1] neg_hi:[0,1]
    v_pk_mul_f32 v[28:29], v[28:29], v[56:57] op_sel:[0,1] op_sel_hi:[1,1]
    v_lshlrev_b32 v30, 16, v163
    v_and_b32 v31, 0xffff0000, v163
    v_pk_add_f32 v[30:31], v[30:31], v[56:57] op_sel_hi:[1,0] neg_lo:[0,1] neg_hi:[0,1]
    v_pk_mul_f32 v[30:31], v[30:31], v[56:57] op_sel:[0,1] op_sel_hi:[1,1]
    v_lshlrev_b32 v32, 16, v164
    v_and_b32 v33, 0xffff0000, v164
    v_pk_add_f32 v[32:33], v[32:33], v[56:57] op_sel_hi:[1,0] neg_lo:[0,1] neg_hi:[0,1]
    v_pk_mul_f32 v[32:33], v[32:33], v[56:57] op_sel:[0,1] op_sel_hi:[1,1]
    v_lshlrev_b32 v34, 16, v165
    v_and_b32 v35, 0xffff0000, v165
    v_pk_add_f32 v[34:35], v[34:35], v[56:57] op_sel_hi:[1,0] neg_lo:[0,1] neg_hi:[0,1]
    v_pk_mul_f32 v[34:35], v[34:35], v[56:57] op_sel:[0,1] op_sel_hi:[1,1]
    v_lshlrev_b32 v36, 16, v166
    v_and_b32 v37, 0xffff0000, v166
    v_pk_add_f32 v[36:37], v[36:37], v[56:57] op_sel_hi:[1,0] neg_lo:[0,1] neg_hi:[0,1]
    v_pk_mul_f32 v[36:37], v[36:37], v[56:57] op_sel:[0,1] op_sel_hi:[1,1]
    v_lshlrev_b32 v38, 16, v167
    v_and_b32 v39, 0xffff0000, v167
    v_pk_add_f32 v[38:39], v[38:39], v[56:57] op_sel_hi:[1,0] neg_lo:[0,1] neg_hi:[0,1]
    v_pk_mul_f32 v[38:39], v[38:39], v[56:57] op_sel:[0,1] op_sel_hi:[1,1]
    v_lshlrev_b32 v40, 16, v168
    v_and_b32 v41, 0xffff0000, v168
    v_pk_add_f32 v[40:41], v[40:41], v[58:59] op_sel_hi:[1,0] neg_lo:[0,1] neg_hi:[0,1]
    v_pk_mul_f32 v[40:41], v[40:41], v[58:59] op_sel:[0,1] op_sel_hi:[1,1]
    v_lshlrev_b32 v42, 16, v169
    v_and_b32 v43, 0xffff0000, v169
    v_pk_add_f32 v[42:43], v[42:43], v[58:59] op_sel_hi:[1,0] neg_lo:[0,1] neg_hi:[0,1]
    v_pk_mul_f32 v[42:43], v[42:43], v[58:59] op_sel:[0,1] op_sel_hi:[1,1]
    v_lshlrev_b32 v44, 16, v170
    v_and_b32 v45, 0xffff0000, v170
    v_pk_add_f32 v[44:45], v[44:45], v[58:59] op_sel_hi:[1,0] neg_lo:[0,1] neg_hi:[0,1]
    v_pk_mul_f32 v[44:45], v[44:45], v[58:59] op_sel:[0,1] op_sel_hi:[1,1]
    v_lshlrev_b32 v46, 16, v171
    v_and_b32 v47, 0xffff0000, v171
    v_pk_add_f32 v[46:47], v[46:47], v[58:59] op_sel_hi:[1,0] neg_lo:[0,1] neg_hi:[0,1]
    v_pk_mul_f32 v[46:47], v[46:47], v[58:59] op_sel:[0,1] op_sel_hi:[1,1]
    v_lshlrev_b32 v48, 16, v172
    v_and_b32 v49, 0xffff0000, v172
    v_pk_add_f32 v[48:49], v[48:49], v[58:59] op_sel_hi:[1,0] neg_lo:[0,1] neg_hi:[0,1]
    v_pk_mul_f32 v[48:49], v[48:49], v[58:59] op_sel:[0,1] op_sel_hi:[1,1]
    v_lshlrev_b32 v50, 16, v173
    v_and_b32 v51, 0xffff0000, v173
    v_pk_add_f32 v[50:51], v[50:51], v[58:59] op_sel_hi:[1,0] neg_lo:[0,1] neg_hi:[0,1]
    v_pk_mul_f32 v[50:51], v[50:51], v[58:59] op_sel:[0,1] op_sel_hi:[1,1]
    v_lshlrev_b32 v52, 16, v174
    v_and_b32 v53, 0xffff0000, v174
    v_pk_add_f32 v[52:53], v[52:53], v[58:59] op_sel_hi:[1,0] neg_lo:[0,1] neg_hi:[0,1]
    v_pk_mul_f32 v[52:53], v[52:53], v[58:59] op_sel:[0,1] op_sel_hi:[1,1]
    v_lshlrev_b32 v54, 16, v175
    v_and_b32 v55, 0xffff0000, v175
    v_pk_add_f32 v[54:55], v[54:55], v[58:59] op_sel_hi:[1,0] neg_lo:[0,1] neg_hi:[0,1]
    v_pk_mul_f32 v[54:55], v[54:55], v[58:59] op_sel:[0,1] op_sel_hi:[1,1]
    s_mov_b32 s43, 0
    s_add_u32 s16, s62, 0x80000
    s_addc_u32 s17, s63, 0
    s_mov_b32 s18, 0x7e000
    s_mov_b32 s19, 0x20000
    s_mov_b32 s53, 0
    s_mov_b32 s49, s44
    s_barrier
    s_cmp_eq_u32 s60, 0
    s_cbranch_scc1 dm_20z
    ds_read_b64_tr_b16 v[56:57], v13 offset:0
    ds_read_b64_tr_b16 v[58:59], v13 offset:2048
    ds_read_b64_tr_b16 v[60:61], v14 offset:0
    ds_read_b64_tr_b16 v[62:63], v14 offset:2048
    ds_read_b64_tr_b16 v[64:65], v15 offset:0
    ds_read_b64_tr_b16 v[66:67], v15 offset:2048
    ds_read_b64_tr_b16 v[68:69], v16 offset:0
    ds_read_b64_tr_b16 v[70:71], v16 offset:2048
    ds_read_b64_tr_b16 v[72:73], v13 offset:4096
    ds_read_b64_tr_b16 v[74:75], v13 offset:6144
    ds_read_b64_tr_b16 v[76:77], v14 offset:4096
    ds_read_b64_tr_b16 v[78:79], v14 offset:6144
    ds_read_b64_tr_b16 v[80:81], v15 offset:4096
    ds_read_b64_tr_b16 v[82:83], v15 offset:6144
    ds_read_b64_tr_b16 v[84:85], v16 offset:4096
    ds_read_b64_tr_b16 v[86:87], v16 offset:6144
dm_20p:
    buffer_load_dwordx4 v[176:179], v126, s[8:11], s44 offen offset:0 sc1
    buffer_load_dwordx4 v[180:183], v126, s[8:11], s44 offen offset:256 sc1
    buffer_load_dwordx4 v[184:187], v127, s[8:11], s44 offen offset:0 sc1
    buffer_load_dwordx4 v[188:191], v127, s[8:11], s44 offen offset:256 sc1
    s_waitcnt vmcnt(0)
    v_bitop3_b32 v17, v176, v180, v184 bitop3:0x80
    v_bitop3_b32 v17, v17, v188, s60 bitop3:0x2a
    v_cmp_ne_u32 vcc, 0, v17
    s_cbranch_vccz dm_20q
    s_sleep 2
    s_add_u32 s53, s53, 1
    s_cmp_lt_u32 s53, s61
    s_cbranch_scc1 dm_20p
    s_mov_b32 s61, 0
dm_20q:
    buffer_load_dwordx4 v[192:195], v128, s[8:11], s44 offen offset:0
    buffer_load_dwordx4 v[196:199], v128, s[8:11], s44 offen offset:256
    buffer_load_dwordx4 v[200:203], v129, s[8:11], s44 offen offset:0
    buffer_load_dwordx4 v[204:207], v129, s[8:11], s44 offen offset:256
    buffer_load_dwordx4 v[208:211], v130, s[8:11], s44 offen offset:0
    buffer_load_dwordx4 v[212:215], v130, s[8:11], s44 offen offset:256
    buffer_load_dwordx4 v[216:219], v131, s[8:11], s44 offen offset:0
    buffer_load_dwordx4 v[220:223], v131, s[8:11], s44 offen offset:256
    buffer_load_dwordx4 v[224:227], v132, s[8:11], s44 offen offset:0
    buffer_load_dwordx4 v[228:231], v132, s[8:11], s44 offen offset:256
    s_waitcnt lgkmcnt(0)
    s_branch dm_20
dm_20z:
    buffer_load_dwordx4 v[176:179], v126, s[8:11], s44 offen offset:0
    buffer_load_dwordx4 v[180:183], v126, s[8:11], s44 offen offset:256
    buffer_load_dwordx4 v[184:187], v127, s[8:11], s44 offen offset:0
    buffer_load_dwordx4 v[188:191], v127, s[8:11], s44 offen offset:256
    buffer_load_dwordx4 v[192:195], v128, s[8:11], s44 offen offset:0
    buffer_load_dwordx4 v[196:199], v128, s[8:11], s44 offen offset:256
    buffer_load_dwordx4 v[200:203], v129, s[8:11], s44 offen offset:0
    buffer_load_dwordx4 v[204:207], v129, s[8:11], s44 offen offset:256
    ds_read_b64_tr_b16 v[56:57], v13 offset:0
    ds_read_b64_tr_b16 v[58:59], v13 offset:2048
    ds_read_b64_tr_b16 v[60:61], v14 offset:0
    ds_read_b64_tr_b16 v[62:63], v14 offset:2048
    ds_read_b64_tr_b16 v[64:65], v15 offset:0
    ds_read_b64_tr_b16 v[66:67], v15 offset:2048
    ds_read_b64_tr_b16 v[68:69], v16 offset:0
    ds_read_b64_tr_b16 v[70:71], v16 offset:2048
    ds_read_b64_tr_b16 v[72:73], v13 offset:4096
    ds_read_b64_tr_b16 v[74:75], v13 offset:6144
    ds_read_b64_tr_b16 v[76:77], v14 offset:4096
    ds_read_b64_tr_b16 v[78:79], v14 offset:6144
    ds_read_b64_tr_b16 v[80:81], v15 offset:4096
    ds_read_b64_tr_b16 v[82:83], v15 offset:6144
    ds_read_b64_tr_b16 v[84:85], v16 offset:4096
    ds_read_b64_tr_b16 v[86:87], v16 offset:6144
    buffer_load_dwordx4 v[208:211], v130, s[8:11], s44 offen offset:0
    buffer_load_dwordx4 v[212:215], v130, s[8:11], s44 offen offset:256
    buffer_load_dwordx4 v[216:219], v131, s[8:11], s44 offen offset:0
    buffer_load_dwordx4 v[220:223], v131, s[8:11], s44 offen offset:256
    buffer_load_dwordx4 v[224:227], v132, s[8:11], s44 offen offset:0
    buffer_load_dwordx4 v[228:231], v132, s[8:11], s44 offen offset:256
    s_waitcnt vmcnt(10) lgkmcnt(0)
dm_20:
    v_mfma_f32_16x16x32_bf16 v[24:27], v[56:59], v[176:179], v[24:27]
    ds_read_b64_tr_b16 v[88:89], v13 offset:8192
    buffer_load_dwordx4 v[232:235], v133, s[8:11], s44 offen offset:0
    v_mfma_f32_16x16x32_bf16 v[40:43], v[56:59], v[180:183], v[40:43]
    ds_read_b64_tr_b16 v[90:91], v13 offset:10240
    buffer_load_dwordx4 v[236:239], v133, s[8:11], s44 offen offset:256
    v_mfma_f32_16x16x32_bf16 v[44:47], v[60:63], v[180:183], v[44:47]
    ds_read_b64_tr_b16 v[92:93], v14 offset:8192
    s_mov_b32 s44, s45
    v_mfma_f32_16x16x32_bf16 v[28:31], v[60:63], v[176:179], v[28:31]
    ds_read_b64_tr_b16 v[94:95], v14 offset:10240
    s_mov_b32 s45, s46
    v_mfma_f32_16x16x32_bf16 v[32:35], v[64:67], v[176:179], v[32:35]
    ds_read_b64_tr_b16 v[96:97], v15 offset:8192
    s_mov_b32 s46, s47
    v_mfma_f32_16x16x32_bf16 v[48:51], v[64:67], v[180:183], v[48:51]
    ds_read_b64_tr_b16 v[98:99], v15 offset:10240
    s_mov_b32 s47, 8388608
    v_mfma_f32_16x16x32_bf16 v[52:55], v[68:71], v[180:183], v[52:55]
    ds_read_b64_tr_b16 v[100:101], v16 offset:8192
    v_mfma_f32_16x16x32_bf16 v[36:39], v[68:71], v[176:179], v[36:39]
    ds_read_b64_tr_b16 v[102:103], v16 offset:10240
    s_waitcnt lgkmcnt(8)
    v_mfma_f32_16x16x32_bf16 v[24:27], v[72:75], v[184:187], v[24:27]
    ds_read_b64_tr_b16 v[104:105], v13 offset:12288
    buffer_load_dwordx4 v[176:179], v126, s[8:11], s44 offen offset:0
    v_mfma_f32_16x16x32_bf16 v[40:43], v[72:75], v[188:191], v[40:43]
    ds_read_b64_tr_b16 v[106:107], v13 offset:14336
    buffer_load_dwordx4 v[180:183], v126, s[8:11], s44 offen offset:256
    v_mfma_f32_16x16x32_bf16 v[44:47], v[76:79], v[188:191], v[44:47]
    ds_read_b64_tr_b16 v[108:109], v14 offset:12288
    s_waitcnt vmcnt(10)
    v_mfma_f32_16x16x32_bf16 v[28:31], v[76:79], v[184:187], v[28:31]
    ds_read_b64_tr_b16 v[110:111], v14 offset:14336
    v_bitop3_b32 v17, v192, v196, v200 bitop3:0x80
    v_mfma_f32_16x16x32_bf16 v[32:35], v[80:83], v[184:187], v[32:35]
    ds_read_b64_tr_b16 v[112:113], v15 offset:12288
    v_bitop3_b32 v17, v17, v204, s60 bitop3:0x2a
    v_mfma_f32_16x16x32_bf16 v[48:51], v[80:83], v[188:191], v[48:51]
    ds_read_b64_tr_b16 v[114:115], v15 offset:14336
    v_cmp_ne_u32 vcc, 0, v17
    v_mfma_f32_16x16x32_bf16 v[52:55], v[84:87], v[188:191], v[52:55]
    ds_read_b64_tr_b16 v[116:117], v16 offset:12288
    ds_read_b64_tr_b16 v[118:119], v16 offset:14336
    v_mfma_f32_16x16x32_bf16 v[36:39], v[84:87], v[184:187], v[36:39]
    s_waitcnt lgkmcnt(8)
    s_cbranch_vccnz dm_20f0
dm_20g0:
    v_mfma_f32_16x16x32_bf16 v[24:27], v[88:91], v[192:195], v[24:27]
    ds_read_b64_tr_b16 v[56:57], v13 offset:16384
    buffer_load_dwordx4 v[184:187], v127, s[8:11], s44 offen offset:0
    v_mfma_f32_16x16x32_bf16 v[40:43], v[88:91], v[196:199], v[40:43]
    ds_read_b64_tr_b16 v[58:59], v13 offset:18432
    buffer_load_dwordx4 v[188:191], v127, s[8:11], s44 offen offset:256
    v_mfma_f32_16x16x32_bf16 v[44:47], v[92:95], v[196:199], v[44:47]
    ds_read_b64_tr_b16 v[60:61], v14 offset:16384
    v_mfma_f32_16x16x32_bf16 v[28:31], v[92:95], v[192:195], v[28:31]
    ds_read_b64_tr_b16 v[62:63], v14 offset:18432
    v_mfma_f32_16x16x32_bf16 v[32:35], v[96:99], v[192:195], v[32:35]
    ds_read_b64_tr_b16 v[64:65], v15 offset:16384
    v_mfma_f32_16x16x32_bf16 v[48:51], v[96:99], v[196:199], v[48:51]
    ds_read_b64_tr_b16 v[66:67], v15 offset:18432
    v_mfma_f32_16x16x32_bf16 v[52:55], v[100:103], v[196:199], v[52:55]
    ds_read_b64_tr_b16 v[68:69], v16 offset:16384
    v_mfma_f32_16x16x32_bf16 v[36:39], v[100:103], v[192:195], v[36:39]
    ds_read_b64_tr_b16 v[70:71], v16 offset:18432
    s_waitcnt lgkmcnt(8)
    v_mfma_f32_16x16x32_bf16 v[24:27], v[104:107], v[200:203], v[24:27]
    ds_read_b64_tr_b16 v[72:73], v13 offset:20480
    buffer_load_dwordx4 v[192:195], v128, s[8:11], s44 offen offset:0
    v_mfma_f32_16x16x32_bf16 v[40:43], v[104:107], v[204:207], v[40:43]
    ds_read_b64_tr_b16 v[74:75], v13 offset:22528
    buffer_load_dwordx4 v[196:199], v128, s[8:11], s44 offen offset:256
    v_mfma_f32_16x16x32_bf16 v[44:47], v[108:111], v[204:207], v[44:47]
    ds_read_b64_tr_b16 v[76:77], v14 offset:20480
    s_waitcnt vmcnt(10)
    v_mfma_f32_16x16x32_bf16 v[28:31], v[108:111], v[200:203], v[28:31]
    ds_read_b64_tr_b16 v[78:79], v14 offset:22528
    v_bitop3_b32 v17, v208, v212, v216 bitop3:0x80
    v_mfma_f32_16x16x32_bf16 v[32:35], v[112:115], v[200:203], v[32:35]
    ds_read_b64_tr_b16 v[80:81], v15 offset:20480
    v_bitop3_b32 v17, v17, v220, s60 bitop3:0x2a
    v_mfma_f32_16x16x32_bf16 v[48:51], v[112:115], v[204:207], v[48:51]
    ds_read_b64_tr_b16 v[82:83], v15 offset:22528
    v_cmp_ne_u32 vcc, 0, v17
    v_mfma_f32_16x16x32_bf16 v[52:55], v[116:119], v[204:207], v[52:55]
    ds_read_b64_tr_b16 v[84:85], v16 offset:20480
    ds_read_b64_tr_b16 v[86:87], v16 offset:22528
    v_mfma_f32_16x16x32_bf16 v[36:39], v[116:119], v[200:203], v[36:39]
    s_waitcnt lgkmcnt(8)
    s_cbranch_vccnz dm_20f1
dm_20g1:
    v_mfma_f32_16x16x32_bf16 v[24:27], v[56:59], v[208:211], v[24:27]
    ds_read_b64_tr_b16 v[88:89], v13 offset:24576
    buffer_load_dwordx4 v[200:203], v129, s[8:11], s44 offen offset:0
    v_mfma_f32_16x16x32_bf16 v[40:43], v[56:59], v[212:215], v[40:43]
    ds_read_b64_tr_b16 v[90:91], v13 offset:26624
    buffer_load_dwordx4 v[204:207], v129, s[8:11], s44 offen offset:256
    v_mfma_f32_16x16x32_bf16 v[44:47], v[60:63], v[212:215], v[44:47]
    ds_read_b64_tr_b16 v[92:93], v14 offset:24576
    s_add_u32 s43, s43, 1
    v_mfma_f32_16x16x32_bf16 v[28:31], v[60:63], v[208:211], v[28:31]
    ds_read_b64_tr_b16 v[94:95], v14 offset:26624
    s_cmp_eq_u32 s43, 4
    v_mfma_f32_16x16x32_bf16 v[32:35], v[64:67], v[208:211], v[32:35]
    ds_read_b64_tr_b16 v[96:97], v15 offset:24576
    v_mfma_f32_16x16x32_bf16 v[48:51], v[64:67], v[212:215], v[48:51]
    ds_read_b64_tr_b16 v[98:99], v15 offset:26624
    v_mfma_f32_16x16x32_bf16 v[52:55], v[68:71], v[212:215], v[52:55]
    ds_read_b64_tr_b16 v[100:101], v16 offset:24576
    v_mfma_f32_16x16x32_bf16 v[36:39], v[68:71], v[208:211], v[36:39]
    ds_read_b64_tr_b16 v[102:103], v16 offset:26624
    s_waitcnt lgkmcnt(8)
    v_mfma_f32_16x16x32_bf16 v[24:27], v[72:75], v[216:219], v[24:27]
    ds_read_b64_tr_b16 v[104:105], v13 offset:28672
    buffer_load_dwordx4 v[208:211], v130, s[8:11], s44 offen offset:0
    v_mfma_f32_16x16x32_bf16 v[40:43], v[72:75], v[220:223], v[40:43]
    ds_read_b64_tr_b16 v[106:107], v13 offset:30720
    buffer_load_dwordx4 v[212:215], v130, s[8:11], s44 offen offset:256
    v_mfma_f32_16x16x32_bf16 v[44:47], v[76:79], v[220:223], v[44:47]
    ds_read_b64_tr_b16 v[108:109], v14 offset:28672
    s_waitcnt vmcnt(10)
    v_mfma_f32_16x16x32_bf16 v[28:31], v[76:79], v[216:219], v[28:31]
    ds_read_b64_tr_b16 v[110:111], v14 offset:30720
    v_add_u32 v13, 32768, v13
    v_bitop3_b32 v17, v224, v228, v232 bitop3:0x80
    v_mfma_f32_16x16x32_bf16 v[32:35], v[80:83], v[216:219], v[32:35]
    ds_read_b64_tr_b16 v[112:113], v15 offset:28672
    v_add_u32 v14, 32768, v14
    v_bitop3_b32 v17, v17, v236, s60 bitop3:0x2a
    v_mfma_f32_16x16x32_bf16 v[48:51], v[80:83], v[220:223], v[48:51]
    ds_read_b64_tr_b16 v[114:115], v15 offset:30720
    v_add_u32 v15, 32768, v15
    v_cmp_ne_u32 vcc, 0, v17
    v_mfma_f32_16x16x32_bf16 v[52:55], v[84:87], v[220:223], v[52:55]
    ds_read_b64_tr_b16 v[116:117], v16 offset:28672
    ds_read_b64_tr_b16 v[118:119], v16 offset:30720
    v_mfma_f32_16x16x32_bf16 v[36:39], v[84:87], v[216:219], v[36:39]
    v_add_u32 v16, 32768, v16
    s_waitcnt lgkmcnt(8)
    s_cbranch_vccnz dm_20f2
dm_20g2:
    s_cbranch_scc1 dm_20x
    v_mfma_f32_16x16x32_bf16 v[24:27], v[88:91], v[224:227], v[24:27]
    ds_read_b64_tr_b16 v[56:57], v13 offset:0
    buffer_load_dwordx4 v[216:219], v131, s[8:11], s44 offen offset:0
    v_mfma_f32_16x16x32_bf16 v[40:43], v[88:91], v[228:231], v[40:43]
    ds_read_b64_tr_b16 v[58:59], v13 offset:2048
    buffer_load_dwordx4 v[220:223], v131, s[8:11], s44 offen offset:256
    v_mfma_f32_16x16x32_bf16 v[44:47], v[92:95], v[228:231], v[44:47]
    ds_read_b64_tr_b16 v[60:61], v14 offset:0
    s_mov_b32 s49, s44
    v_mfma_f32_16x16x32_bf16 v[28:31], v[92:95], v[224:227], v[28:31]
    ds_read_b64_tr_b16 v[62:63], v14 offset:2048
    v_mfma_f32_16x16x32_bf16 v[32:35], v[96:99], v[224:227], v[32:35]
    ds_read_b64_tr_b16 v[64:65], v15 offset:0
    v_mfma_f32_16x16x32_bf16 v[48:51], v[96:99], v[228:231], v[48:51]
    ds_read_b64_tr_b16 v[66:67], v15 offset:2048
    v_mfma_f32_16x16x32_bf16 v[52:55], v[100:103], v[228:231], v[52:55]
    ds_read_b64_tr_b16 v[68:69], v16 offset:0
    v_mfma_f32_16x16x32_bf16 v[36:39], v[100:103], v[224:227], v[36:39]
    ds_read_b64_tr_b16 v[70:71], v16 offset:2048
    s_waitcnt lgkmcnt(8)
    v_mfma_f32_16x16x32_bf16 v[24:27], v[104:107], v[232:235], v[24:27]
    ds_read_b64_tr_b16 v[72:73], v13 offset:4096
    buffer_load_dwordx4 v[224:227], v132, s[8:11], s44 offen offset:0
    v_mfma_f32_16x16x32_bf16 v[40:43], v[104:107], v[236:239], v[40:43]
    ds_read_b64_tr_b16 v[74:75], v13 offset:6144
    buffer_load_dwordx4 v[228:231], v132, s[8:11], s44 offen offset:256
    v_mfma_f32_16x16x32_bf16 v[44:47], v[108:111], v[236:239], v[44:47]
    ds_read_b64_tr_b16 v[76:77], v14 offset:4096
    s_waitcnt vmcnt(10)
    v_mfma_f32_16x16x32_bf16 v[28:31], v[108:111], v[232:235], v[28:31]
    ds_read_b64_tr_b16 v[78:79], v14 offset:6144
    v_bitop3_b32 v17, v176, v180, v184 bitop3:0x80
    v_mfma_f32_16x16x32_bf16 v[32:35], v[112:115], v[232:235], v[32:35]
    ds_read_b64_tr_b16 v[80:81], v15 offset:4096
    v_bitop3_b32 v17, v17, v188, s60 bitop3:0x2a
    v_mfma_f32_16x16x32_bf16 v[48:51], v[112:115], v[236:239], v[48:51]
    ds_read_b64_tr_b16 v[82:83], v15 offset:6144
    v_cmp_ne_u32 vcc, 0, v17
    v_mfma_f32_16x16x32_bf16 v[52:55], v[116:119], v[236:239], v[52:55]
    ds_read_b64_tr_b16 v[84:85], v16 offset:4096
    ds_read_b64_tr_b16 v[86:87], v16 offset:6144
    v_mfma_f32_16x16x32_bf16 v[36:39], v[116:119], v[232:235], v[36:39]
    s_waitcnt lgkmcnt(8)
    s_cbranch_vccnz dm_20f3
dm_20g3:
    s_branch dm_20
dm_20f0:
    s_cselect_b32 s50, 1, 0
dm_20h0:
    s_sleep 2
    buffer_load_dwordx4 v[192:195], v128, s[8:11], s49 offen offset:0 sc1
    buffer_load_dwordx4 v[196:199], v128, s[8:11], s49 offen offset:256 sc1
    buffer_load_dwordx4 v[200:203], v129, s[8:11], s49 offen offset:0 sc1
    buffer_load_dwordx4 v[204:207], v129, s[8:11], s49 offen offset:256 sc1
    buffer_load_dwordx4 v[208:211], v130, s[8:11], s49 offen offset:0 sc1
    buffer_load_dwordx4 v[212:215], v130, s[8:11], s49 offen offset:256 sc1
    buffer_load_dwordx4 v[216:219], v131, s[8:11], s49 offen offset:0 sc1
    buffer_load_dwordx4 v[220:223], v131, s[8:11], s49 offen offset:256 sc1
    buffer_load_dwordx4 v[224:227], v132, s[8:11], s49 offen offset:0 sc1
    buffer_load_dwordx4 v[228:231], v132, s[8:11], s49 offen offset:256 sc1
    buffer_load_dwordx4 v[232:235], v133, s[8:11], s49 offen offset:0 sc1
    buffer_load_dwordx4 v[236:239], v133, s[8:11], s49 offen offset:256 sc1
    buffer_load_dwordx4 v[176:179], v126, s[8:11], s44 offen offset:0 sc1
    buffer_load_dwordx4 v[180:183], v126, s[8:11], s44 offen offset:256 sc1
    s_waitcnt vmcnt(10)
    v_bitop3_b32 v17, v192, v196, v200 bitop3:0x80
    v_bitop3_b32 v17, v17, v204, s60 bitop3:0x2a
    v_cmp_ne_u32 vcc, 0, v17
    s_add_u32 s53, s53, 1
    s_cmp_ge_u32 s53, s61
    s_cselect_b32 s61, 0, s61
    s_cbranch_scc1 dm_20k0
    s_cbranch_vccnz dm_20h0
dm_20k0:
    s_cmp_eq_u32 s50, 1
    s_branch dm_20g0
dm_20f1:
    s_cselect_b32 s50, 1, 0
dm_20h1:
    s_sleep 2
    buffer_load_dwordx4 v[208:211], v130, s[8:11], s49 offen offset:0 sc1
    buffer_load_dwordx4 v[212:215], v130, s[8:11], s49 offen offset:256 sc1
    buffer_load_dwordx4 v[216:219], v131, s[8:11], s49 offen offset:0 sc1
    buffer_load_dwordx4 v[220:223], v131, s[8:11], s49 offen offset:256 sc1
    buffer_load_dwordx4 v[224:227], v132, s[8:11], s49 offen offset:0 sc1
    buffer_load_dwordx4 v[228:231], v132, s[8:11], s49 offen offset:256 sc1
    buffer_load_dwordx4 v[232:235], v133, s[8:11], s49 offen offset:0 sc1
    buffer_load_dwordx4 v[236:239], v133, s[8:11], s49 offen offset:256 sc1
    buffer_load_dwordx4 v[176:179], v126, s[8:11], s44 offen offset:0 sc1
    buffer_load_dwordx4 v[180:183], v126, s[8:11], s44 offen offset:256 sc1
    buffer_load_dwordx4 v[184:187], v127, s[8:11], s44 offen offset:0 sc1
    buffer_load_dwordx4 v[188:191], v127, s[8:11], s44 offen offset:256 sc1
    buffer_load_dwordx4 v[192:195], v128, s[8:11], s44 offen offset:0 sc1
    buffer_load_dwordx4 v[196:199], v128, s[8:11], s44 offen offset:256 sc1
    s_waitcnt vmcnt(10)
    v_bitop3_b32 v17, v208, v212, v216 bitop3:0x80
    v_bitop3_b32 v17, v17, v220, s60 bitop3:0x2a
    v_cmp_ne_u32 vcc, 0, v17
    s_add_u32 s53, s53, 1
    s_cmp_ge_u32 s53, s61
    s_cselect_b32 s61, 0, s61
    s_cbranch_scc1 dm_20k1
    s_cbranch_vccnz dm_20h1
dm_20k1:
    s_cmp_eq_u32 s50, 1
    s_branch dm_20g1
dm_20f2:
    s_cselect_b32 s50, 1, 0
dm_20h2:
    s_sleep 2
    buffer_load_dwordx4 v[224:227], v132, s[8:11], s49 offen offset:0 sc1
    buffer_load_dwordx4 v[228:231], v132, s[8:11], s49 offen offset:256 sc1
    buffer_load_dwordx4 v[232:235], v133, s[8:11], s49 offen offset:0 sc1
    buffer_load_dwordx4 v[236:239], v133, s[8:11], s49 offen offset:256 sc1
    buffer_load_dwordx4 v[176:179], v126, s[8:11], s44 offen offset:0 sc1
    buffer_load_dwordx4 v[180:183], v126, s[8:11], s44 offen offset:256 sc1
    buffer_load_dwordx4 v[184:187], v127, s[8:11], s44 offen offset:0 sc1
    buffer_load_dwordx4 v[188:191], v127, s[8:11], s44 offen offset:256 sc1
    buffer_load_dwordx4 v[192:195], v128, s[8:11], s44 offen offset:0 sc1
    buffer_load_dwordx4 v[196:199], v128, s[8:11], s44 offen offset:256 sc1
    buffer_load_dwordx4 v[200:203], v129, s[8:11], s44 offen offset:0 sc1
    buffer_load_dwordx4 v[204:207], v129, s[8:11], s44 offen offset:256 sc1
    buffer_load_dwordx4 v[208:211], v130, s[8:11], s44 offen offset:0 sc1
    buffer_load_dwordx4 v[212:215], v130, s[8:11], s44 offen offset:256 sc1
    s_waitcnt vmcnt(10)
    v_bitop3_b32 v17, v224, v228, v232 bitop3:0x80
    v_bitop3_b32 v17, v17, v236, s60 bitop3:0x2a
    v_cmp_ne_u32 vcc, 0, v17
    s_add_u32 s53, s53, 1
    s_cmp_ge_u32 s53, s61
    s_cselect_b32 s61, 0, s61
    s_cbranch_scc1 dm_20k2
    s_cbranch_vccnz dm_20h2
dm_20k2:
    s_cmp_eq_u32 s50, 1
    s_branch dm_20g2
dm_20f3:
    s_cselect_b32 s50, 1, 0
dm_20h3:
    s_sleep 2
    buffer_load_dwordx4 v[176:179], v126, s[8:11], s49 offen offset:0 sc1
    buffer_load_dwordx4 v[180:183], v126, s[8:11], s49 offen offset:256 sc1
    buffer_load_dwordx4 v[184:187], v127, s[8:11], s49 offen offset:0 sc1
    buffer_load_dwordx4 v[188:191], v127, s[8:11], s49 offen offset:256 sc1
    buffer_load_dwordx4 v[192:195], v128, s[8:11], s49 offen offset:0 sc1
    buffer_load_dwordx4 v[196:199], v128, s[8:11], s49 offen offset:256 sc1
    buffer_load_dwordx4 v[200:203], v129, s[8:11], s49 offen offset:0 sc1
    buffer_load_dwordx4 v[204:207], v129, s[8:11], s49 offen offset:256 sc1
    buffer_load_dwordx4 v[208:211], v130, s[8:11], s49 offen offset:0 sc1
    buffer_load_dwordx4 v[212:215], v130, s[8:11], s49 offen offset:256 sc1
    buffer_load_dwordx4 v[216:219], v131, s[8:11], s49 offen offset:0 sc1
    buffer_load_dwordx4 v[220:223], v131, s[8:11], s49 offen offset:256 sc1
    buffer_load_dwordx4 v[224:227], v132, s[8:11], s49 offen offset:0 sc1
    buffer_load_dwordx4 v[228:231], v132, s[8:11], s49 offen offset:256 sc1
    s_waitcnt vmcnt(10)
    v_bitop3_b32 v17, v176, v180, v184 bitop3:0x80
    v_bitop3_b32 v17, v17, v188, s60 bitop3:0x2a
    v_cmp_ne_u32 vcc, 0, v17
    s_add_u32 s53, s53, 1
    s_cmp_ge_u32 s53, s61
    s_cselect_b32 s61, 0, s61
    s_cbranch_scc1 dm_20k3
    s_cbranch_vccnz dm_20h3
dm_20k3:
    s_cmp_eq_u32 s50, 1
    s_branch dm_20g3
dm_20x:
    v_mfma_f32_16x16x32_bf16 v[24:27], v[88:91], v[224:227], v[24:27]
    v_mfma_f32_16x16x32_bf16 v[40:43], v[88:91], v[228:231], v[40:43]
    v_mfma_f32_16x16x32_bf16 v[44:47], v[92:95], v[228:231], v[44:47]
    v_mfma_f32_16x16x32_bf16 v[28:31], v[92:95], v[224:227], v[28:31]
    v_mfma_f32_16x16x32_bf16 v[32:35], v[96:99], v[224:227], v[32:35]
    v_mfma_f32_16x16x32_bf16 v[48:51], v[96:99], v[228:231], v[48:51]
    v_mfma_f32_16x16x32_bf16 v[52:55], v[100:103], v[228:231], v[52:55]
    v_mfma_f32_16x16x32_bf16 v[36:39], v[100:103], v[224:227], v[36:39]
    s_waitcnt lgkmcnt(0)
    v_mfma_f32_16x16x32_bf16 v[24:27], v[104:107], v[232:235], v[24:27]
    s_add_u32 s44, s62, 0x5c8000
    v_mfma_f32_16x16x32_bf16 v[40:43], v[104:107], v[236:239], v[40:43]
    s_addc_u32 s45, s63, 0
    v_mfma_f32_16x16x32_bf16 v[44:47], v[108:111], v[236:239], v[44:47]
    v_mfma_f32_16x16x32_bf16 v[28:31], v[108:111], v[232:235], v[28:31]
    s_mov_b32 s46, 0x6000
    v_mfma_f32_16x16x32_bf16 v[32:35], v[112:115], v[232:235], v[32:35]
    v_mfma_f32_16x16x32_bf16 v[48:51], v[112:115], v[236:239], v[48:51]
    s_mov_b32 s47, 0x20000
    v_mfma_f32_16x16x32_bf16 v[52:55], v[116:119], v[236:239], v[52:55]
    v_mfma_f32_16x16x32_bf16 v[36:39], v[116:119], v[232:235], v[36:39]
    s_add_u32 s36, s39, 0
    v_cvt_pk_bf16_f32 v160, v24, v25
    v_cvt_pk_bf16_f32 v161, v26, v27
    v_cvt_pk_bf16_f32 v162, v28, v29
    v_cvt_pk_bf16_f32 v163, v30, v31
    v_and_b32 v160, -2, v160
    buffer_store_dwordx4 v[160:163], v2, s[16:19], s36 offen offset:0 sc1
    v_cvt_pk_bf16_f32 v164, v32, v33
    v_cvt_pk_bf16_f32 v165, v34, v35
    v_cvt_pk_bf16_f32 v166, v36, v37
    v_cvt_pk_bf16_f32 v167, v38, v39
    v_and_b32 v164, -2, v164
    buffer_store_dwordx4 v[164:167], v2, s[16:19], s36 offen offset:1024 sc1
    s_add_u32 s36, s39, 65536
    v_cvt_pk_bf16_f32 v168, v40, v41
    v_cvt_pk_bf16_f32 v169, v42, v43
    v_cvt_pk_bf16_f32 v170, v44, v45
    v_cvt_pk_bf16_f32 v171, v46, v47
    v_and_b32 v168, -2, v168
    buffer_store_dwordx4 v[168:171], v2, s[16:19], s36 offen offset:0 sc1
    v_cvt_pk_bf16_f32 v172, v48, v49
    v_cvt_pk_bf16_f32 v173, v50, v51
    v_cvt_pk_bf16_f32 v174, v52, v53
    v_cvt_pk_bf16_f32 v175, v54, v55
    v_and_b32 v172, -2, v172
    buffer_store_dwordx4 v[172:175], v2, s[16:19], s36 offen offset:1024 sc1
    s_barrier
    s_lshl_b32 s36, s37, 11
    v_add_u32 v7, s36, v2
    ds_write_b128 v7, v[160:163] offset:0
    ds_write_b128 v7, v[164:167] offset:1024
    ds_write_b128 v7, v[168:171] offset:2048
    ds_write_b128 v7, v[172:175] offset:3072
    v_lshlrev_b32 v24, 16, v160
    v_and_b32 v25, 0xffff0000, v160
    v_lshlrev_b32 v26, 16, v161
    v_and_b32 v27, 0xffff0000, v161
    v_lshlrev_b32 v28, 16, v162
    v_and_b32 v29, 0xffff0000, v162
    v_lshlrev_b32 v30, 16, v163
    v_and_b32 v31, 0xffff0000, v163
    v_lshlrev_b32 v32, 16, v164
    v_and_b32 v33, 0xffff0000, v164
    v_lshlrev_b32 v34, 16, v165
    v_and_b32 v35, 0xffff0000, v165
    v_lshlrev_b32 v36, 16, v166
    v_and_b32 v37, 0xffff0000, v166
    v_lshlrev_b32 v38, 16, v167
    v_and_b32 v39, 0xffff0000, v167
    v_lshlrev_b32 v40, 16, v168
    v_and_b32 v41, 0xffff0000, v168
    v_lshlrev_b32 v42, 16, v169
    v_and_b32 v43, 0xffff0000, v169
    v_lshlrev_b32 v44, 16, v170
    v_and_b32 v45, 0xffff0000, v170
    v_lshlrev_b32 v46, 16, v171
    v_and_b32 v47, 0xffff0000, v171
    v_lshlrev_b32 v48, 16, v172
    v_and_b32 v49, 0xffff0000, v172
    v_lshlrev_b32 v50, 16, v173
    v_and_b32 v51, 0xffff0000, v173
    v_lshlrev_b32 v52, 16, v174
    v_and_b32 v53, 0xffff0000, v174
    v_lshlrev_b32 v54, 16, v175
    v_and_b32 v55, 0xffff0000, v175
    s_add_u32 s53, s55, 512
    v_mov_b32 v8, 1
    v_mov_b32 v9, 162816
    v_mov_b32 v11, 0
    s_mov_b64 exec, 1
    s_waitcnt vmcnt(0)
    ds_add_rtn_u32 v10, v9, v8
    s_waitcnt lgkmcnt(0)
    v_readfirstlane_b32 s54, v10
    s_nop 0
    s_and_b32 s54, s54, 3
    s_cmp_lg_u32 s54, 3
    s_cbranch_scc1 pub_21
    buffer_atomic_add v8, v11, s[56:59], s53 offen sc1
    v_mov_b32 v9, 162872
    ds_add_u32 v9, v8
pub_21:
    s_mov_b64 exec, -1
    s_waitcnt lgkmcnt(0)
    s_barrier
    v_pk_add_f32 v[140:141], v[24:25], v[26:27]
    v_pk_mul_f32 v[134:135], v[24:25], v[24:25]
    v_pk_fma_f32 v[134:135], v[26:27], v[26:27], v[134:135]
    v_pk_add_f32 v[140:141], v[140:141], v[28:29]
    v_pk_fma_f32 v[134:135], v[28:29], v[28:29], v[134:135]
    v_pk_add_f32 v[140:141], v[140:141], v[30:31]
    v_pk_fma_f32 v[134:135], v[30:31], v[30:31], v[134:135]
    v_pk_add_f32 v[140:141], v[140:141], v[32:33]
    v_pk_fma_f32 v[134:135], v[32:33], v[32:33], v[134:135]
    v_pk_add_f32 v[140:141], v[140:141], v[34:35]
    v_pk_fma_f32 v[134:135], v[34:35], v[34:35], v[134:135]
    v_pk_add_f32 v[140:141], v[140:141], v[36:37]
    v_pk_fma_f32 v[134:135], v[36:37], v[36:37], v[134:135]
    v_pk_add_f32 v[140:141], v[140:141], v[38:39]
    v_pk_fma_f32 v[134:135], v[38:39], v[38:39], v[134:135]
    v_add_f32 v136, v140, v141
    v_add_f32 v137, v134, v135
    v_mov_b32 v140, v136
    v_mov_b32 v141, v137
    s_nop 0
    v_permlane16_swap_b32 v136, v140
    v_permlane16_swap_b32 v137, v141
    v_pk_add_f32 v[136:137], v[136:137], v[140:141]
    v_mov_b32 v140, v136
    v_mov_b32 v141, v137
    s_nop 0
    v_permlane32_swap_b32 v136, v140
    v_permlane32_swap_b32 v137, v141
    v_pk_add_f32 v[136:137], v[136:137], v[140:141]
    v_pk_add_f32 v[140:141], v[40:41], v[42:43]
    v_pk_mul_f32 v[134:135], v[40:41], v[40:41]
    v_pk_fma_f32 v[134:135], v[42:43], v[42:43], v[134:135]
    v_pk_add_f32 v[140:141], v[140:141], v[44:45]
    v_pk_fma_f32 v[134:135], v[44:45], v[44:45], v[134:135]
    v_pk_add_f32 v[140:141], v[140:141], v[46:47]
    v_pk_fma_f32 v[134:135], v[46:47], v[46:47], v[134:135]
    v_pk_add_f32 v[140:141], v[140:141], v[48:49]
    v_pk_fma_f32 v[134:135], v[48:49], v[48:49], v[134:135]
    v_pk_add_f32 v[140:141], v[140:141], v[50:51]
    v_pk_fma_f32 v[134:135], v[50:51], v[50:51], v[134:135]
    v_pk_add_f32 v[140:141], v[140:141], v[52:53]
    v_pk_fma_f32 v[134:135], v[52:53], v[52:53], v[134:135]
    v_pk_add_f32 v[140:141], v[140:141], v[54:55]
    v_pk_fma_f32 v[134:135], v[54:55], v[54:55], v[134:135]
    v_add_f32 v138, v140, v141
    v_add_f32 v139, v134, v135
    v_mov_b32 v140, v138
    v_mov_b32 v141, v139
    s_nop 0
    v_permlane16_swap_b32 v138, v140
    v_permlane16_swap_b32 v139, v141
    v_pk_add_f32 v[138:139], v[138:139], v[140:141]
    v_mov_b32 v140, v138
    v_mov_b32 v141, v139
    s_nop 0
    v_permlane32_swap_b32 v138, v140
    v_permlane32_swap_b32 v139, v141
    v_pk_add_f32 v[138:139], v[138:139], v[140:141]
    v_cmp_eq_u32 vcc, 0, v23
    s_nop 1
    v_cndmask_b32 v136, v138, v136, vcc
    v_cndmask_b32 v137, v139, v137, vcc
    s_lshr_b32 s53, s29, 3
    s_lshl_b32 s53, s53, 14
    s_and_b32 s40, s29, 7
    s_lshl_b32 s40, s40, 10
    s_add_u32 s40, s40, s53
    s_lshl_b32 s36, s34, 8
    s_add_u32 s40, s40, s36
    v_lshlrev_b32 v7, 3, v1
    s_bfm_b64 exec, 32, 0
    buffer_store_dwordx2 v[136:137], v7, s[44:47], s40 offen sc1
    s_mov_b64 exec, -1
    s_lshr_b32 s34, s30, 1
    s_and_b32 s35, s30, 1
    v_and_b32 v22, 15, v1
    v_lshrrev_b32 v23, 4, v1
    s_mul_i32 s37, s34, 4
    s_mul_i32 s38, s29, 14
    s_mul_i32 s36, s35, 7
    s_add_u32 s38, s38, s36
    s_mul_i32 s36, s34, 8192
    v_add_u32 v12, s36, v2
    v_lshrrev_b32 v6, 2, v1
    v_mul_u32_u24 v13, 448, v6
    v_and_b32 v7, 3, v1
    v_lshl_add_u32 v13, v7, 3, v13
    v_add_u32 v13, 73728, v13
    s_mul_i32 s36, s35, 224
    v_add_u32 v13, s36, v13
    v_bfe_u32 v6, v1, 4, 1
    v_lshlrev_b32 v6, 5, v6
    s_cmp_eq_u32 s35, 0
    s_cselect_b32 s36, 1, -1
    v_mul_lo_u32 v6, v6, s36
    v_sub_u32 v14, v13, v6
    v_add_u32 v13, v13, v6
    v_mov_b32 v17, v12
    s_mov_b32 s42, 0
    s_mov_b32 s43, 0
    s_mov_b32 s48, 57344
    v_add_u32 v18, 57344, v13
    v_add_u32 v19, 57344, v14
    ds_read_b128 v[136:139], v17 offset:0
    ds_read_b128 v[140:143], v17 offset:2048
    ds_read_b128 v[144:147], v17 offset:4096
    ds_read_b128 v[148:151], v17 offset:6144
    ds_read_b64_tr_b16 v[152:153], v18 offset:0
    ds_read_b64_tr_b16 v[154:155], v18 offset:7168
    ds_read_b64_tr_b16 v[156:157], v19 offset:32
    ds_read_b64_tr_b16 v[158:159], v19 offset:7200
    ds_read_b64_tr_b16 v[160:161], v18 offset:64
    ds_read_b64_tr_b16 v[162:163], v18 offset:7232
    ds_read_b64_tr_b16 v[164:165], v19 offset:96
    ds_read_b64_tr_b16 v[166:167], v19 offset:7264
    ds_read_b64_tr_b16 v[168:169], v18 offset:128
    ds_read_b64_tr_b16 v[170:171], v18 offset:7296
    ds_read_b64_tr_b16 v[172:173], v19 offset:160
    ds_read_b64_tr_b16 v[174:175], v19 offset:7328
    ds_read_b64_tr_b16 v[176:177], v18 offset:192
    ds_read_b64_tr_b16 v[178:179], v18 offset:7360
    s_waitcnt lgkmcnt(12)
    v_mfma_f32_16x16x32_bf16 v[24:27], v[152:155], v[136:139], 0
    ds_read_b128 v[180:183], v17 offset:1024
    s_add_u32 s42, s42, 16384
    v_mfma_f32_16x16x32_bf16 v[52:55], v[152:155], v[140:143], 0
    ds_read_b128 v[184:187], v17 offset:3072
    s_cmp_eq_u32 s42, 49152
    v_mfma_f32_16x16x32_bf16 v[80:83], v[152:155], v[144:147], 0
    ds_read_b128 v[188:191], v17 offset:5120
    s_cselect_b32 s42, 0, s42
    v_mfma_f32_16x16x32_bf16 v[108:111], v[152:155], v[148:151], 0
    ds_read_b128 v[192:195], v17 offset:7168
    s_waitcnt lgkmcnt(14)
    v_mfma_f32_16x16x32_bf16 v[112:115], v[156:159], v[148:151], 0
    ds_read_b64_tr_b16 v[196:197], v18 offset:14336
    s_add_u32 s48, s48, 28672
    v_mfma_f32_16x16x32_bf16 v[84:87], v[156:159], v[144:147], 0
    ds_read_b64_tr_b16 v[198:199], v18 offset:21504
    s_cmp_eq_u32 s48, 86016
    v_mfma_f32_16x16x32_bf16 v[56:59], v[156:159], v[140:143], 0
    ds_read_b64_tr_b16 v[200:201], v19 offset:14368
    s_cselect_b32 s48, 0, s48
    v_mfma_f32_16x16x32_bf16 v[28:31], v[156:159], v[136:139], 0
    ds_read_b64_tr_b16 v[202:203], v19 offset:21536
    s_waitcnt lgkmcnt(8)
    v_mfma_f32_16x16x32_bf16 v[32:35], v[160:163], v[136:139], 0
    ds_read_b64_tr_b16 v[204:205], v18 offset:14400
    v_add_u32 v17, s42, v12
    v_mfma_f32_16x16x32_bf16 v[60:63], v[160:163], v[140:143], 0
    ds_read_b64_tr_b16 v[206:207], v18 offset:21568
    v_mfma_f32_16x16x32_bf16 v[88:91], v[160:163], v[144:147], 0
    ds_read_b64_tr_b16 v[208:209], v19 offset:14432
    v_mfma_f32_16x16x32_bf16 v[116:119], v[160:163], v[148:151], 0
    ds_read_b64_tr_b16 v[210:211], v19 offset:21600
    v_mfma_f32_16x16x32_bf16 v[120:123], v[164:167], v[148:151], 0
    ds_read_b64_tr_b16 v[212:213], v18 offset:14464
    v_mfma_f32_16x16x32_bf16 v[92:95], v[164:167], v[144:147], 0
    ds_read_b64_tr_b16 v[214:215], v18 offset:21632
    v_mfma_f32_16x16x32_bf16 v[64:67], v[164:167], v[140:143], 0
    ds_read_b64_tr_b16 v[216:217], v19 offset:14496
    v_mfma_f32_16x16x32_bf16 v[36:39], v[164:167], v[136:139], 0
    ds_read_b64_tr_b16 v[218:219], v19 offset:21664
    v_add_u32 v19, s48, v14
    v_mfma_f32_16x16x32_bf16 v[40:43], v[168:171], v[136:139], 0
    ds_read_b64_tr_b16 v[220:221], v18 offset:14528
    v_mfma_f32_16x16x32_bf16 v[68:71], v[168:171], v[140:143], 0
    ds_read_b64_tr_b16 v[222:223], v18 offset:21696
    v_add_u32 v18, s48, v13
    v_mfma_f32_16x16x32_bf16 v[96:99], v[168:171], v[144:147], 0
    v_mfma_f32_16x16x32_bf16 v[124:127], v[168:171], v[148:151], 0
    v_mfma_f32_16x16x32_bf16 v[128:131], v[172:175], v[148:151], 0
    v_mfma_f32_16x16x32_bf16 v[100:103], v[172:175], v[144:147], 0
    v_mfma_f32_16x16x32_bf16 v[72:75], v[172:175], v[140:143], 0
    v_mfma_f32_16x16x32_bf16 v[44:47], v[172:175], v[136:139], 0
    v_mfma_f32_16x16x32_bf16 v[48:51], v[176:179], v[136:139], 0
    v_mfma_f32_16x16x32_bf16 v[76:79], v[176:179], v[140:143], 0
    v_mfma_f32_16x16x32_bf16 v[104:107], v[176:179], v[144:147], 0
    v_mfma_f32_16x16x32_bf16 v[132:135], v[176:179], v[148:151], 0
    s_waitcnt lgkmcnt(12)
    v_mfma_f32_16x16x32_bf16 v[24:27], v[196:199], v[180:183], v[24:27]
    s_add_u32 s43, s43, 1
    s_mul_i32 s36, s35, 448
    s_add_u32 s36, s36, 159744
    v_lshlrev_b32 v6, 4, v23
    v_mfma_f32_16x16x32_bf16 v[52:55], v[196:199], v[184:187], v[52:55]
    v_add_u32 v6, s36, v6
    s_lshl_b32 s36, s37, 8
    s_add_u32 s36, s36, 160768
    v_lshlrev_b32 v7, 4, v22
    v_mfma_f32_16x16x32_bf16 v[80:83], v[196:199], v[188:191], v[80:83]
    v_add_u32 v7, s36, v7
    s_add_u32 s16, s62, 0x400000
    s_addc_u32 s17, s63, 0
    s_mov_b32 s18, 0x1be000
    v_mfma_f32_16x16x32_bf16 v[108:111], v[196:199], v[192:195], v[108:111]
    s_mov_b32 s19, 0x20000
    s_mul_i32 s39, s37, 229376
    s_lshr_b32 s36, s38, 1
    s_waitcnt lgkmcnt(0)
    v_mfma_f32_16x16x32_bf16 v[112:115], v[200:203], v[192:195], v[112:115]
    s_add_u32 s36, s36, 0
    s_lshr_b32 s53, s36, 3
    s_lshl_b32 s53, s53, 14
    s_and_b32 s44, s36, 7
    v_mfma_f32_16x16x32_bf16 v[84:87], v[200:203], v[188:191], v[84:87]
    s_lshl_b32 s44, s44, 10
    s_add_u32 s44, s44, s53
    s_add_u32 s44, s44, s39
    s_lshr_b32 s36, s38, 1
    v_mfma_f32_16x16x32_bf16 v[56:59], v[200:203], v[184:187], v[56:59]
    s_add_u32 s36, s36, 1
    s_lshr_b32 s53, s36, 3
    s_lshl_b32 s53, s53, 14
    s_and_b32 s45, s36, 7
    v_mfma_f32_16x16x32_bf16 v[28:31], v[200:203], v[180:183], v[28:31]
    s_lshl_b32 s45, s45, 10
    s_add_u32 s45, s45, s53
    s_add_u32 s45, s45, s39
    s_lshr_b32 s36, s38, 1
    v_mfma_f32_16x16x32_bf16 v[32:35], v[204:207], v[180:183], v[32:35]
    s_add_u32 s36, s36, 2
    s_lshr_b32 s53, s36, 3
    s_lshl_b32 s53, s53, 14
    s_and_b32 s46, s36, 7
    v_mfma_f32_16x16x32_bf16 v[60:63], v[204:207], v[184:187], v[60:63]
    s_lshl_b32 s46, s46, 10
    s_add_u32 s46, s46, s53
    s_add_u32 s46, s46, s39
    s_lshr_b32 s36, s38, 1
    v_mfma_f32_16x16x32_bf16 v[88:91], v[204:207], v[188:191], v[88:91]
    s_add_u32 s36, s36, 3
    s_lshr_b32 s53, s36, 3
    s_lshl_b32 s53, s53, 14
    s_and_b32 s47, s36, 7
    v_mfma_f32_16x16x32_bf16 v[116:119], v[204:207], v[192:195], v[116:119]
    s_lshl_b32 s47, s47, 10
    s_add_u32 s47, s47, s53
    s_add_u32 s47, s47, s39
    v_lshrrev_b32 v226, 2, v1
    v_mfma_f32_16x16x32_bf16 v[120:123], v[208:211], v[192:195], v[120:123]
    v_mul_u32_u24 v240, 256, v226
    v_and_b32 v227, 3, v1
    v_lshl_add_u32 v240, v227, 3, v240
    v_add_u32 v240, 49152, v240
    v_mfma_f32_16x16x32_bf16 v[92:95], v[208:211], v[188:191], v[92:95]
    v_and_b32 v226, 7, v226
    s_mul_i32 s36, s35, 4
    s_add_u32 s36, s36, 3
    v_xor_b32 v227, s36, v226
    v_mfma_f32_16x16x32_bf16 v[64:67], v[208:211], v[184:187], v[64:67]
    v_lshl_add_u32 v243, v227, 5, v240
    s_mul_i32 s36, s35, 4
    s_add_u32 s36, s36, 2
    v_xor_b32 v227, s36, v226
    v_mfma_f32_16x16x32_bf16 v[36:39], v[208:211], v[180:183], v[36:39]
    v_lshl_add_u32 v242, v227, 5, v240
    s_mul_i32 s36, s35, 4
    s_add_u32 s36, s36, 1
    v_xor_b32 v227, s36, v226
    v_mfma_f32_16x16x32_bf16 v[40:43], v[212:215], v[180:183], v[40:43]
    v_lshl_add_u32 v241, v227, 5, v240
    s_mul_i32 s36, s35, 4
    s_add_u32 s36, s36, 0
    v_xor_b32 v227, s36, v226
    v_mfma_f32_16x16x32_bf16 v[68:71], v[212:215], v[184:187], v[68:71]
    v_lshl_add_u32 v240, v227, 5, v240
    s_lshl_b32 s38, s33, 3
    s_lshl_b32 s36, s35, 2
    s_add_u32 s38, s38, s36
    v_mfma_f32_16x16x32_bf16 v[96:99], v[212:215], v[188:191], v[96:99]
    s_lshr_b32 s36, s38, 1
    s_lshr_b32 s53, s36, 3
    s_lshl_b32 s53, s53, 14
    s_and_b32 s39, s36, 7
    v_mfma_f32_16x16x32_bf16 v[124:127], v[212:215], v[192:195], v[124:127]
    s_lshl_b32 s39, s39, 10
    s_add_u32 s39, s39, s53
    s_lshl_b32 s36, s37, 16
    s_add_u32 s39, s39, s36
    v_mfma_f32_16x16x32_bf16 v[128:131], v[216:219], v[192:195], v[128:131]
    s_lshl_b32 s40, s31, 17
    s_add_u32 s40, s40, s39
    s_xor_b32 s41, s31, 1
    s_lshl_b32 s41, s41, 17
    v_mfma_f32_16x16x32_bf16 v[100:103], v[216:219], v[188:191], v[100:103]
    s_add_u32 s41, s41, s39
    s_mov_b32 s84, s62
    s_mov_b32 s85, s63
    s_mov_b32 s86, 0x7e000
    v_mfma_f32_16x16x32_bf16 v[72:75], v[216:219], v[184:187], v[72:75]
    s_mov_b32 s87, 0x20000
    s_add_u32 s88, s62, 0x80000
    s_addc_u32 s89, s63, 0
    s_mov_b32 s90, 0x7e000
    v_mfma_f32_16x16x32_bf16 v[44:47], v[216:219], v[180:183], v[44:47]
    s_mov_b32 s91, 0x20000
    s_add_u32 s80, s4, 0x1c00000
    s_addc_u32 s81, s5, 0
    s_mov_b32 s82, 0x400000
    v_mfma_f32_16x16x32_bf16 v[48:51], v[220:223], v[180:183], v[48:51]
    s_mov_b32 s83, 0x20000
    s_lshl_b32 s36, s37, 1
    s_add_u32 s36, s36, s35
    s_lshl_b32 s36, s36, 10
    v_mfma_f32_16x16x32_bf16 v[76:79], v[220:223], v[184:187], v[76:79]
    v_add_u32 v244, s36, v2
    v_mov_b32 v245, 1
    v_mov_b32 v246, 162880
    v_lshrrev_b32 v238, 1, v23
    v_mfma_f32_16x16x32_bf16 v[104:107], v[220:223], v[188:191], v[104:107]
    v_lshlrev_b32 v238, 8, v238
    v_lshl_add_u32 v238, v22, 4, v238
    v_and_b32 v224, 1, v23
    v_lshl_add_u32 v238, v224, 3, v238
    v_mfma_f32_16x16x32_bf16 v[132:135], v[220:223], v[192:195], v[132:135]
    s_add_u32 s53, s55, 1408
    v_mov_b32 v8, 1
    v_mov_b32 v9, 162864
    v_mov_b32 v11, 0
    s_mov_b64 exec, 1
    s_waitcnt vmcnt(0)
    ds_add_rtn_u32 v10, v9, v8
    s_waitcnt lgkmcnt(0)
    v_readfirstlane_b32 s54, v10
    s_nop 0
    s_and_b32 s54, s54, 3
    s_cmp_lg_u32 s54, 3
    s_cbranch_scc1 pub_22
    buffer_atomic_add v8, v11, s[56:59], s53 offen sc1
pub_22:
    s_mov_b64 exec, -1
    s_barrier
    ds_read_b128 v[136:139], v17 offset:0
    ds_read_b128 v[140:143], v17 offset:2048
    ds_read_b128 v[144:147], v17 offset:4096
    ds_read_b128 v[148:151], v17 offset:6144
    ds_read_b64_tr_b16 v[152:153], v18 offset:0
    ds_read_b64_tr_b16 v[154:155], v18 offset:7168
    ds_read_b64_tr_b16 v[156:157], v19 offset:32
    ds_read_b64_tr_b16 v[158:159], v19 offset:7200
    ds_read_b64_tr_b16 v[160:161], v18 offset:64
    ds_read_b64_tr_b16 v[162:163], v18 offset:7232
    ds_read_b64_tr_b16 v[164:165], v19 offset:96
    ds_read_b64_tr_b16 v[166:167], v19 offset:7264
    ds_read_b64_tr_b16 v[168:169], v18 offset:128
    ds_read_b64_tr_b16 v[170:171], v18 offset:7296
    ds_read_b64_tr_b16 v[172:173], v19 offset:160
    ds_read_b64_tr_b16 v[174:175], v19 offset:7328
    ds_read_b64_tr_b16 v[176:177], v18 offset:192
    ds_read_b64_tr_b16 v[178:179], v18 offset:7360
    s_waitcnt lgkmcnt(12)
mm_23:
    v_mfma_f32_16x16x32_bf16 v[24:27], v[152:155], v[136:139], v[24:27]
    ds_read_b128 v[180:183], v17 offset:1024
    s_add_u32 s42, s42, 16384
    v_mfma_f32_16x16x32_bf16 v[52:55], v[152:155], v[140:143], v[52:55]
    ds_read_b128 v[184:187], v17 offset:3072
    s_cmp_eq_u32 s42, 49152
    v_mfma_f32_16x16x32_bf16 v[80:83], v[152:155], v[144:147], v[80:83]
    ds_read_b128 v[188:191], v17 offset:5120
    s_cselect_b32 s42, 0, s42
    v_mfma_f32_16x16x32_bf16 v[108:111], v[152:155], v[148:151], v[108:111]
    ds_read_b128 v[192:195], v17 offset:7168
    s_waitcnt lgkmcnt(14)
    v_mfma_f32_16x16x32_bf16 v[112:115], v[156:159], v[148:151], v[112:115]
    ds_read_b64_tr_b16 v[196:197], v18 offset:14336
    s_add_u32 s48, s48, 28672
    v_mfma_f32_16x16x32_bf16 v[84:87], v[156:159], v[144:147], v[84:87]
    ds_read_b64_tr_b16 v[198:199], v18 offset:21504
    s_cmp_eq_u32 s48, 86016
    v_mfma_f32_16x16x32_bf16 v[56:59], v[156:159], v[140:143], v[56:59]
    ds_read_b64_tr_b16 v[200:201], v19 offset:14368
    s_cselect_b32 s48, 0, s48
    v_mfma_f32_16x16x32_bf16 v[28:31], v[156:159], v[136:139], v[28:31]
    ds_read_b64_tr_b16 v[202:203], v19 offset:21536
    s_waitcnt lgkmcnt(8)
    v_mfma_f32_16x16x32_bf16 v[32:35], v[160:163], v[136:139], v[32:35]
    ds_read_b64_tr_b16 v[204:205], v18 offset:14400
    v_add_u32 v17, s42, v12
    v_mfma_f32_16x16x32_bf16 v[60:63], v[160:163], v[140:143], v[60:63]
    ds_read_b64_tr_b16 v[206:207], v18 offset:21568
    v_mfma_f32_16x16x32_bf16 v[88:91], v[160:163], v[144:147], v[88:91]
    ds_read_b64_tr_b16 v[208:209], v19 offset:14432
    v_mfma_f32_16x16x32_bf16 v[116:119], v[160:163], v[148:151], v[116:119]
    ds_read_b64_tr_b16 v[210:211], v19 offset:21600
    v_mfma_f32_16x16x32_bf16 v[120:123], v[164:167], v[148:151], v[120:123]
    ds_read_b64_tr_b16 v[212:213], v18 offset:14464
    v_mfma_f32_16x16x32_bf16 v[92:95], v[164:167], v[144:147], v[92:95]
    ds_read_b64_tr_b16 v[214:215], v18 offset:21632
    v_mfma_f32_16x16x32_bf16 v[64:67], v[164:167], v[140:143], v[64:67]
    ds_read_b64_tr_b16 v[216:217], v19 offset:14496
    v_mfma_f32_16x16x32_bf16 v[36:39], v[164:167], v[136:139], v[36:39]
    ds_read_b64_tr_b16 v[218:219], v19 offset:21664
    v_add_u32 v19, s48, v14
    v_mfma_f32_16x16x32_bf16 v[40:43], v[168:171], v[136:139], v[40:43]
    ds_read_b64_tr_b16 v[220:221], v18 offset:14528
    v_mfma_f32_16x16x32_bf16 v[68:71], v[168:171], v[140:143], v[68:71]
    ds_read_b64_tr_b16 v[222:223], v18 offset:21696
    v_add_u32 v18, s48, v13
    v_mfma_f32_16x16x32_bf16 v[96:99], v[168:171], v[144:147], v[96:99]
    v_mfma_f32_16x16x32_bf16 v[124:127], v[168:171], v[148:151], v[124:127]
    v_mfma_f32_16x16x32_bf16 v[128:131], v[172:175], v[148:151], v[128:131]
    v_mfma_f32_16x16x32_bf16 v[100:103], v[172:175], v[144:147], v[100:103]
    v_mfma_f32_16x16x32_bf16 v[72:75], v[172:175], v[140:143], v[72:75]
    v_mfma_f32_16x16x32_bf16 v[44:47], v[172:175], v[136:139], v[44:47]
    v_mfma_f32_16x16x32_bf16 v[48:51], v[176:179], v[136:139], v[48:51]
    v_mfma_f32_16x16x32_bf16 v[76:79], v[176:179], v[140:143], v[76:79]
    v_mfma_f32_16x16x32_bf16 v[104:107], v[176:179], v[144:147], v[104:107]
    v_mfma_f32_16x16x32_bf16 v[132:135], v[176:179], v[148:151], v[132:135]
    s_waitcnt lgkmcnt(12)
    v_mfma_f32_16x16x32_bf16 v[24:27], v[196:199], v[180:183], v[24:27]
    s_add_u32 s43, s43, 1
    s_cmp_lt_u32 s43, 15
    v_mfma_f32_16x16x32_bf16 v[52:55], v[196:199], v[184:187], v[52:55]
    v_mfma_f32_16x16x32_bf16 v[80:83], v[196:199], v[188:191], v[80:83]
    v_mfma_f32_16x16x32_bf16 v[108:111], v[196:199], v[192:195], v[108:111]
    s_waitcnt lgkmcnt(0)
    s_barrier
    v_mfma_f32_16x16x32_bf16 v[112:115], v[200:203], v[192:195], v[112:115]
    ds_read_b128 v[136:139], v17 offset:0
    v_mfma_f32_16x16x32_bf16 v[84:87], v[200:203], v[188:191], v[84:87]
    ds_read_b128 v[140:143], v17 offset:2048
    v_mfma_f32_16x16x32_bf16 v[56:59], v[200:203], v[184:187], v[56:59]
    ds_read_b128 v[144:147], v17 offset:4096
    v_mfma_f32_16x16x32_bf16 v[28:31], v[200:203], v[180:183], v[28:31]
    ds_read_b128 v[148:151], v17 offset:6144
    v_mfma_f32_16x16x32_bf16 v[32:35], v[204:207], v[180:183], v[32:35]
    ds_read_b64_tr_b16 v[152:153], v18 offset:0
    v_mfma_f32_16x16x32_bf16 v[60:63], v[204:207], v[184:187], v[60:63]
    ds_read_b64_tr_b16 v[154:155], v18 offset:7168
    v_mfma_f32_16x16x32_bf16 v[88:91], v[204:207], v[188:191], v[88:91]
    ds_read_b64_tr_b16 v[156:157], v19 offset:32
    v_mfma_f32_16x16x32_bf16 v[116:119], v[204:207], v[192:195], v[116:119]
    ds_read_b64_tr_b16 v[158:159], v19 offset:7200
    v_mfma_f32_16x16x32_bf16 v[120:123], v[208:211], v[192:195], v[120:123]
    ds_read_b64_tr_b16 v[160:161], v18 offset:64
    v_mfma_f32_16x16x32_bf16 v[92:95], v[208:211], v[188:191], v[92:95]
    ds_read_b64_tr_b16 v[162:163], v18 offset:7232
    v_mfma_f32_16x16x32_bf16 v[64:67], v[208:211], v[184:187], v[64:67]
    ds_read_b64_tr_b16 v[164:165], v19 offset:96
    v_mfma_f32_16x16x32_bf16 v[36:39], v[208:211], v[180:183], v[36:39]
    ds_read_b64_tr_b16 v[166:167], v19 offset:7264
    v_mfma_f32_16x16x32_bf16 v[40:43], v[212:215], v[180:183], v[40:43]
    ds_read_b64_tr_b16 v[168:169], v18 offset:128
    v_mfma_f32_16x16x32_bf16 v[68:71], v[212:215], v[184:187], v[68:71]
    ds_read_b64_tr_b16 v[170:171], v18 offset:7296
    v_mfma_f32_16x16x32_bf16 v[96:99], v[212:215], v[188:191], v[96:99]
    ds_read_b64_tr_b16 v[172:173], v19 offset:160
    v_mfma_f32_16x16x32_bf16 v[124:127], v[212:215], v[192:195], v[124:127]
    ds_read_b64_tr_b16 v[174:175], v19 offset:7328
    v_mfma_f32_16x16x32_bf16 v[128:131], v[216:219], v[192:195], v[128:131]
    ds_read_b64_tr_b16 v[176:177], v18 offset:192
    v_mfma_f32_16x16x32_bf16 v[100:103], v[216:219], v[188:191], v[100:103]
    ds_read_b64_tr_b16 v[178:179], v18 offset:7360
    v_mfma_f32_16x16x32_bf16 v[72:75], v[216:219], v[184:187], v[72:75]
    v_mfma_f32_16x16x32_bf16 v[44:47], v[216:219], v[180:183], v[44:47]
    v_mfma_f32_16x16x32_bf16 v[48:51], v[220:223], v[180:183], v[48:51]
    v_mfma_f32_16x16x32_bf16 v[76:79], v[220:223], v[184:187], v[76:79]
    v_mfma_f32_16x16x32_bf16 v[104:107], v[220:223], v[188:191], v[104:107]
    v_mfma_f32_16x16x32_bf16 v[132:135], v[220:223], v[192:195], v[132:135]
    s_waitcnt lgkmcnt(12)
    s_cbranch_scc1 mm_23
    v_mfma_f32_16x16x32_bf16 v[24:27], v[152:155], v[136:139], v[24:27]
    ds_read_b128 v[180:183], v17 offset:1024
    v_mfma_f32_16x16x32_bf16 v[52:55], v[152:155], v[140:143], v[52:55]
    ds_read_b128 v[184:187], v17 offset:3072
    v_mfma_f32_16x16x32_bf16 v[80:83], v[152:155], v[144:147], v[80:83]
    ds_read_b128 v[188:191], v17 offset:5120
    v_mfma_f32_16x16x32_bf16 v[108:111], v[152:155], v[148:151], v[108:111]
    ds_read_b128 v[192:195], v17 offset:7168
    s_waitcnt lgkmcnt(14)
    v_mfma_f32_16x16x32_bf16 v[112:115], v[156:159], v[148:151], v[112:115]
    ds_read_b64_tr_b16 v[196:197], v18 offset:14336
    v_mfma_f32_16x16x32_bf16 v[84:87], v[156:159], v[144:147], v[84:87]
    ds_read_b64_tr_b16 v[198:199], v18 offset:21504
    v_mfma_f32_16x16x32_bf16 v[56:59], v[156:159], v[140:143], v[56:59]
    ds_read_b64_tr_b16 v[200:201], v19 offset:14368
    v_mfma_f32_16x16x32_bf16 v[28:31], v[156:159], v[136:139], v[28:31]
    ds_read_b64_tr_b16 v[202:203], v19 offset:21536
    s_waitcnt lgkmcnt(8)
    v_mfma_f32_16x16x32_bf16 v[32:35], v[160:163], v[136:139], v[32:35]
    ds_read_b64_tr_b16 v[204:205], v18 offset:14400
    v_mfma_f32_16x16x32_bf16 v[60:63], v[160:163], v[140:143], v[60:63]
    ds_read_b64_tr_b16 v[206:207], v18 offset:21568
    v_mfma_f32_16x16x32_bf16 v[88:91], v[160:163], v[144:147], v[88:91]
    ds_read_b64_tr_b16 v[208:209], v19 offset:14432
    v_mfma_f32_16x16x32_bf16 v[116:119], v[160:163], v[148:151], v[116:119]
    ds_read_b64_tr_b16 v[210:211], v19 offset:21600
    v_mfma_f32_16x16x32_bf16 v[120:123], v[164:167], v[148:151], v[120:123]
    ds_read_b64_tr_b16 v[212:213], v18 offset:14464
    v_mfma_f32_16x16x32_bf16 v[92:95], v[164:167], v[144:147], v[92:95]
    ds_read_b64_tr_b16 v[214:215], v18 offset:21632
    v_mfma_f32_16x16x32_bf16 v[64:67], v[164:167], v[140:143], v[64:67]
    ds_read_b64_tr_b16 v[216:217], v19 offset:14496
    v_mfma_f32_16x16x32_bf16 v[36:39], v[164:167], v[136:139], v[36:39]
    ds_read_b64_tr_b16 v[218:219], v19 offset:21664
    v_mfma_f32_16x16x32_bf16 v[40:43], v[168:171], v[136:139], v[40:43]
    ds_read_b64_tr_b16 v[220:221], v18 offset:14528
    v_mfma_f32_16x16x32_bf16 v[68:71], v[168:171], v[140:143], v[68:71]
    ds_read_b64_tr_b16 v[222:223], v18 offset:21696
    v_mfma_f32_16x16x32_bf16 v[96:99], v[168:171], v[144:147], v[96:99]
    v_mfma_f32_16x16x32_bf16 v[124:127], v[168:171], v[148:151], v[124:127]
    v_mfma_f32_16x16x32_bf16 v[128:131], v[172:175], v[148:151], v[128:131]
    v_mfma_f32_16x16x32_bf16 v[100:103], v[172:175], v[144:147], v[100:103]
    v_mfma_f32_16x16x32_bf16 v[72:75], v[172:175], v[140:143], v[72:75]
    v_mfma_f32_16x16x32_bf16 v[44:47], v[172:175], v[136:139], v[44:47]
    v_mfma_f32_16x16x32_bf16 v[48:51], v[176:179], v[136:139], v[48:51]
    v_mfma_f32_16x16x32_bf16 v[76:79], v[176:179], v[140:143], v[76:79]
    v_mfma_f32_16x16x32_bf16 v[104:107], v[176:179], v[144:147], v[104:107]
    v_mfma_f32_16x16x32_bf16 v[132:135], v[176:179], v[148:151], v[132:135]
    s_waitcnt lgkmcnt(0)
    s_barrier
    v_mfma_f32_16x16x32_bf16 v[24:27], v[196:199], v[180:183], v[24:27]
    ds_read_b128 v[136:139], v6 offset:0
    v_mfma_f32_16x16x32_bf16 v[52:55], v[196:199], v[184:187], v[52:55]
    ds_read_b128 v[140:143], v6 offset:64
    v_mfma_f32_16x16x32_bf16 v[80:83], v[196:199], v[188:191], v[80:83]
    ds_read_b128 v[144:147], v6 offset:128
    v_mfma_f32_16x16x32_bf16 v[108:111], v[196:199], v[192:195], v[108:111]
    ds_read_b128 v[148:151], v6 offset:192
    v_mfma_f32_16x16x32_bf16 v[112:115], v[200:203], v[192:195], v[112:115]
    ds_read_b128 v[152:155], v6 offset:256
    v_mfma_f32_16x16x32_bf16 v[84:87], v[200:203], v[188:191], v[84:87]
    ds_read_b128 v[156:159], v6 offset:320
    v_mfma_f32_16x16x32_bf16 v[56:59], v[200:203], v[184:187], v[56:59]
    ds_read_b128 v[160:163], v6 offset:384
    v_mfma_f32_16x16x32_bf16 v[28:31], v[200:203], v[180:183], v[28:31]
    ds_read_b128 v[164:167], v7 offset:0
    v_mfma_f32_16x16x32_bf16 v[32:35], v[204:207], v[180:183], v[32:35]
    ds_read_b128 v[168:171], v7 offset:256
    v_mfma_f32_16x16x32_bf16 v[60:63], v[204:207], v[184:187], v[60:63]
    ds_read_b128 v[172:175], v7 offset:512
    v_mfma_f32_16x16x32_bf16 v[88:91], v[204:207], v[188:191], v[88:91]
    ds_read_b128 v[176:179], v7 offset:768
    v_mov_b32 v13, v240
    v_mfma_f32_16x16x32_bf16 v[116:119], v[204:207], v[192:195], v[116:119]
    v_add_u32 v18, 0, v240
    v_mov_b32 v14, v241
    v_mfma_f32_16x16x32_bf16 v[120:123], v[208:211], v[192:195], v[120:123]
    v_add_u32 v19, 0, v241
    v_mov_b32 v15, v242
    v_mfma_f32_16x16x32_bf16 v[92:95], v[208:211], v[188:191], v[92:95]
    v_add_u32 v20, 0, v242
    v_mov_b32 v16, v243
    v_mfma_f32_16x16x32_bf16 v[64:67], v[208:211], v[184:187], v[64:67]
    v_add_u32 v21, 0, v243
    s_mov_b32 s42, 0
    s_mov_b32 s43, 0
    v_mfma_f32_16x16x32_bf16 v[36:39], v[208:211], v[180:183], v[36:39]
    s_mov_b32 s48, 0
    v_mov_b32 v17, v12
    v_and_b32 v199, 7, v0
    v_mfma_f32_16x16x32_bf16 v[40:43], v[212:215], v[180:183], v[40:43]
    v_lshrrev_b32 v236, 6, v0
    v_lshlrev_b32 v236, 4, v236
    v_mfma_f32_16x16x32_bf16 v[68:71], v[212:215], v[184:187], v[68:71]
    v_bfe_u32 v237, v0, 3, 3
    v_add_u32 v236, v236, v237
    s_lshr_b32 s78, s29, 1
    v_mfma_f32_16x16x32_bf16 v[96:99], v[212:215], v[188:191], v[96:99]
    s_lshl_b32 s78, s78, 16
    s_and_b32 s79, s29, 1
    s_lshl_b32 s79, s79, 7
    v_mfma_f32_16x16x32_bf16 v[124:127], v[212:215], v[192:195], v[124:127]
    s_add_u32 s78, s78, s79
    s_lshr_b32 s79, s30, 1
    s_lshl_b32 s79, s79, 13
    v_mfma_f32_16x16x32_bf16 v[128:131], v[216:219], v[192:195], v[128:131]
    s_add_u32 s78, s78, s79
    v_lshlrev_b32 v196, 8, v236
    v_lshl_add_u32 v196, v199, 4, v196
    v_mfma_f32_16x16x32_bf16 v[100:103], v[216:219], v[188:191], v[100:103]
    v_add_u32 v196, s78, v196
    s_lshl_b32 s78, s28, 7
    s_lshl_b32 s79, s29, 3
    v_mfma_f32_16x16x32_bf16 v[72:75], v[216:219], v[184:187], v[72:75]
    s_add_u32 s78, s78, s79
    v_add_u32 v197, s78, v199
    v_lshlrev_b32 v198, 11, v197
    v_mfma_f32_16x16x32_bf16 v[44:47], v[216:219], v[180:183], v[44:47]
    v_lshrrev_b32 v237, 2, v236
    v_lshlrev_b32 v237, 3, v237
    v_mfma_f32_16x16x32_bf16 v[48:51], v[220:223], v[180:183], v[48:51]
    v_and_b32 v236, 3, v236
    v_add_u32 v236, v236, v237
    v_mfma_f32_16x16x32_bf16 v[76:79], v[220:223], v[184:187], v[76:79]
    v_lshl_add_u32 v198, v236, 3, v198
    v_lshlrev_b32 v197, 3, v197
    v_mfma_f32_16x16x32_bf16 v[104:107], v[220:223], v[188:191], v[104:107]
    v_lshl_add_u32 v197, v236, 14, v197
    v_mfma_f32_16x16x32_bf16 v[132:135], v[220:223], v[192:195], v[132:135]
    s_waitcnt lgkmcnt(0)
    s_cmp_eq_u32 s35, 1
    s_cbranch_scc1 G3_e1
    v_pk_fma_f32 v[24:25], v[164:165], v[136:137], v[24:25] op_sel_hi:[0,1,1] neg_lo:[1,0,0] neg_hi:[1,0,0]
    v_pk_fma_f32 v[26:27], v[164:165], v[138:139], v[26:27] op_sel_hi:[0,1,1] neg_lo:[1,0,0] neg_hi:[1,0,0]
    v_pk_mul_f32 v[226:227], v[24:25], v[24:25]
    v_pk_mul_f32 v[228:229], v[26:27], v[26:27]
    v_pk_fma_f32 v[226:227], v[226:227], v[166:167], v[166:167] op_sel:[0,1,0] op_sel_hi:[1,1,0]
    v_pk_fma_f32 v[228:229], v[228:229], v[166:167], v[166:167] op_sel:[0,1,0] op_sel_hi:[1,1,0]
    v_pk_mul_f32 v[226:227], v[226:227], v[24:25]
    v_pk_mul_f32 v[228:229], v[228:229], v[26:27]
    v_exp_f32 v226, v226
    v_exp_f32 v227, v227
    v_exp_f32 v228, v228
    v_exp_f32 v229, v229
    v_pk_fma_f32 v[226:227], v[226:227], v[164:165], v[164:165] op_sel:[0,1,1] op_sel_hi:[1,1,1]
    v_pk_fma_f32 v[228:229], v[228:229], v[164:165], v[164:165] op_sel:[0,1,1] op_sel_hi:[1,1,1]
    v_rcp_f32 v226, v226
    v_rcp_f32 v227, v227
    v_rcp_f32 v228, v228
    v_rcp_f32 v229, v229
    v_pk_mul_f32 v[24:25], v[24:25], v[226:227]
    v_pk_mul_f32 v[26:27], v[26:27], v[228:229]
    v_pk_fma_f32 v[28:29], v[164:165], v[140:141], v[28:29] op_sel_hi:[0,1,1] neg_lo:[1,0,0] neg_hi:[1,0,0]
    v_pk_fma_f32 v[30:31], v[164:165], v[142:143], v[30:31] op_sel_hi:[0,1,1] neg_lo:[1,0,0] neg_hi:[1,0,0]
    v_pk_mul_f32 v[226:227], v[28:29], v[28:29]
    v_pk_mul_f32 v[228:229], v[30:31], v[30:31]
    v_pk_fma_f32 v[226:227], v[226:227], v[166:167], v[166:167] op_sel:[0,1,0] op_sel_hi:[1,1,0]
    v_pk_fma_f32 v[228:229], v[228:229], v[166:167], v[166:167] op_sel:[0,1,0] op_sel_hi:[1,1,0]
    v_pk_mul_f32 v[226:227], v[226:227], v[28:29]
    v_pk_mul_f32 v[228:229], v[228:229], v[30:31]
    v_exp_f32 v226, v226
    v_exp_f32 v227, v227
    v_exp_f32 v228, v228
    v_exp_f32 v229, v229
    v_pk_fma_f32 v[226:227], v[226:227], v[164:165], v[164:165] op_sel:[0,1,1] op_sel_hi:[1,1,1]
    v_pk_fma_f32 v[228:229], v[228:229], v[164:165], v[164:165] op_sel:[0,1,1] op_sel_hi:[1,1,1]
    v_rcp_f32 v226, v226
    v_rcp_f32 v227, v227
    v_rcp_f32 v228, v228
    v_rcp_f32 v229, v229
    v_pk_mul_f32 v[28:29], v[28:29], v[226:227]
    v_pk_mul_f32 v[30:31], v[30:31], v[228:229]
    v_cvt_pk_bf16_f32 v24, v24, v25
    v_cvt_pk_bf16_f32 v25, v26, v27
    v_cvt_pk_bf16_f32 v26, v28, v29
    v_cvt_pk_bf16_f32 v27, v30, v31
    v_or_b32 v24, 1, v24
    ds_write_b128 v244, v[24:27] offset:0
    s_add_u32 s36, s44, 0
    buffer_store_dwordx4 v[24:27], v2, s[16:19], s36 offen sc1
    v_pk_fma_f32 v[52:53], v[168:169], v[136:137], v[52:53] op_sel_hi:[0,1,1] neg_lo:[1,0,0] neg_hi:[1,0,0]
    v_pk_fma_f32 v[54:55], v[168:169], v[138:139], v[54:55] op_sel_hi:[0,1,1] neg_lo:[1,0,0] neg_hi:[1,0,0]
    v_pk_mul_f32 v[226:227], v[52:53], v[52:53]
    v_pk_mul_f32 v[228:229], v[54:55], v[54:55]
    v_pk_fma_f32 v[226:227], v[226:227], v[170:171], v[170:171] op_sel:[0,1,0] op_sel_hi:[1,1,0]
    v_pk_fma_f32 v[228:229], v[228:229], v[170:171], v[170:171] op_sel:[0,1,0] op_sel_hi:[1,1,0]
    v_pk_mul_f32 v[226:227], v[226:227], v[52:53]
    v_pk_mul_f32 v[228:229], v[228:229], v[54:55]
    v_exp_f32 v226, v226
    v_exp_f32 v227, v227
    v_exp_f32 v228, v228
    v_exp_f32 v229, v229
    v_pk_fma_f32 v[226:227], v[226:227], v[168:169], v[168:169] op_sel:[0,1,1] op_sel_hi:[1,1,1]
    v_pk_fma_f32 v[228:229], v[228:229], v[168:169], v[168:169] op_sel:[0,1,1] op_sel_hi:[1,1,1]
    v_rcp_f32 v226, v226
    v_rcp_f32 v227, v227
    v_rcp_f32 v228, v228
    v_rcp_f32 v229, v229
    v_pk_mul_f32 v[52:53], v[52:53], v[226:227]
    v_pk_mul_f32 v[54:55], v[54:55], v[228:229]
    v_pk_fma_f32 v[56:57], v[168:169], v[140:141], v[56:57] op_sel_hi:[0,1,1] neg_lo:[1,0,0] neg_hi:[1,0,0]
    v_pk_fma_f32 v[58:59], v[168:169], v[142:143], v[58:59] op_sel_hi:[0,1,1] neg_lo:[1,0,0] neg_hi:[1,0,0]
    v_pk_mul_f32 v[226:227], v[56:57], v[56:57]
    v_pk_mul_f32 v[228:229], v[58:59], v[58:59]
    v_pk_fma_f32 v[226:227], v[226:227], v[170:171], v[170:171] op_sel:[0,1,0] op_sel_hi:[1,1,0]
    v_pk_fma_f32 v[228:229], v[228:229], v[170:171], v[170:171] op_sel:[0,1,0] op_sel_hi:[1,1,0]
    v_pk_mul_f32 v[226:227], v[226:227], v[56:57]
    v_pk_mul_f32 v[228:229], v[228:229], v[58:59]
    v_exp_f32 v226, v226
    v_exp_f32 v227, v227
    v_exp_f32 v228, v228
    v_exp_f32 v229, v229
    v_pk_fma_f32 v[226:227], v[226:227], v[168:169], v[168:169] op_sel:[0,1,1] op_sel_hi:[1,1,1]
    v_pk_fma_f32 v[228:229], v[228:229], v[168:169], v[168:169] op_sel:[0,1,1] op_sel_hi:[1,1,1]
    v_rcp_f32 v226, v226
    v_rcp_f32 v227, v227
    v_rcp_f32 v228, v228
    v_rcp_f32 v229, v229
    v_pk_mul_f32 v[56:57], v[56:57], v[226:227]
    v_pk_mul_f32 v[58:59], v[58:59], v[228:229]
    v_cvt_pk_bf16_f32 v52, v52, v53
    v_cvt_pk_bf16_f32 v53, v54, v55
    v_cvt_pk_bf16_f32 v54, v56, v57
    v_cvt_pk_bf16_f32 v55, v58, v59
    v_or_b32 v52, 1, v52
    ds_write_b128 v244, v[52:55] offset:2048
    s_add_u32 s36, s44, 229376
    buffer_store_dwordx4 v[52:55], v2, s[16:19], s36 offen sc1
    v_pk_fma_f32 v[80:81], v[172:173], v[136:137], v[80:81] op_sel_hi:[0,1,1] neg_lo:[1,0,0] neg_hi:[1,0,0]
    v_pk_fma_f32 v[82:83], v[172:173], v[138:139], v[82:83] op_sel_hi:[0,1,1] neg_lo:[1,0,0] neg_hi:[1,0,0]
    v_pk_mul_f32 v[226:227], v[80:81], v[80:81]
    v_pk_mul_f32 v[228:229], v[82:83], v[82:83]
    v_pk_fma_f32 v[226:227], v[226:227], v[174:175], v[174:175] op_sel:[0,1,0] op_sel_hi:[1,1,0]
    v_pk_fma_f32 v[228:229], v[228:229], v[174:175], v[174:175] op_sel:[0,1,0] op_sel_hi:[1,1,0]
    v_pk_mul_f32 v[226:227], v[226:227], v[80:81]
    v_pk_mul_f32 v[228:229], v[228:229], v[82:83]
    v_exp_f32 v226, v226
    v_exp_f32 v227, v227
    v_exp_f32 v228, v228
    v_exp_f32 v229, v229
    v_pk_fma_f32 v[226:227], v[226:227], v[172:173], v[172:173] op_sel:[0,1,1] op_sel_hi:[1,1,1]
    v_pk_fma_f32 v[228:229], v[228:229], v[172:173], v[172:173] op_sel:[0,1,1] op_sel_hi:[1,1,1]
    v_rcp_f32 v226, v226
    v_rcp_f32 v227, v227
    v_rcp_f32 v228, v228
    v_rcp_f32 v229, v229
    v_pk_mul_f32 v[80:81], v[80:81], v[226:227]
    v_pk_mul_f32 v[82:83], v[82:83], v[228:229]
    v_pk_fma_f32 v[84:85], v[172:173], v[140:141], v[84:85] op_sel_hi:[0,1,1] neg_lo:[1,0,0] neg_hi:[1,0,0]
    v_pk_fma_f32 v[86:87], v[172:173], v[142:143], v[86:87] op_sel_hi:[0,1,1] neg_lo:[1,0,0] neg_hi:[1,0,0]
    v_pk_mul_f32 v[226:227], v[84:85], v[84:85]
    v_pk_mul_f32 v[228:229], v[86:87], v[86:87]
    v_pk_fma_f32 v[226:227], v[226:227], v[174:175], v[174:175] op_sel:[0,1,0] op_sel_hi:[1,1,0]
    v_pk_fma_f32 v[228:229], v[228:229], v[174:175], v[174:175] op_sel:[0,1,0] op_sel_hi:[1,1,0]
    v_pk_mul_f32 v[226:227], v[226:227], v[84:85]
    v_pk_mul_f32 v[228:229], v[228:229], v[86:87]
    v_exp_f32 v226, v226
    v_exp_f32 v227, v227
    v_exp_f32 v228, v228
    v_exp_f32 v229, v229
    v_pk_fma_f32 v[226:227], v[226:227], v[172:173], v[172:173] op_sel:[0,1,1] op_sel_hi:[1,1,1]
    v_pk_fma_f32 v[228:229], v[228:229], v[172:173], v[172:173] op_sel:[0,1,1] op_sel_hi:[1,1,1]
    v_rcp_f32 v226, v226
    v_rcp_f32 v227, v227
    v_rcp_f32 v228, v228
    v_rcp_f32 v229, v229
    v_pk_mul_f32 v[84:85], v[84:85], v[226:227]
    v_pk_mul_f32 v[86:87], v[86:87], v[228:229]
    v_cvt_pk_bf16_f32 v80, v80, v81
    v_cvt_pk_bf16_f32 v81, v82, v83
    v_cvt_pk_bf16_f32 v82, v84, v85
    v_cvt_pk_bf16_f32 v83, v86, v87
    v_or_b32 v80, 1, v80
    ds_write_b128 v244, v[80:83] offset:4096
    s_add_u32 s36, s44, 458752
    buffer_store_dwordx4 v[80:83], v2, s[16:19], s36 offen sc1
    v_pk_fma_f32 v[108:109], v[176:177], v[136:137], v[108:109] op_sel_hi:[0,1,1] neg_lo:[1,0,0] neg_hi:[1,0,0]
    v_pk_fma_f32 v[110:111], v[176:177], v[138:139], v[110:111] op_sel_hi:[0,1,1] neg_lo:[1,0,0] neg_hi:[1,0,0]
    v_pk_mul_f32 v[226:227], v[108:109], v[108:109]
    v_pk_mul_f32 v[228:229], v[110:111], v[110:111]
    v_pk_fma_f32 v[226:227], v[226:227], v[178:179], v[178:179] op_sel:[0,1,0] op_sel_hi:[1,1,0]
    v_pk_fma_f32 v[228:229], v[228:229], v[178:179], v[178:179] op_sel:[0,1,0] op_sel_hi:[1,1,0]
    v_pk_mul_f32 v[226:227], v[226:227], v[108:109]
    v_pk_mul_f32 v[228:229], v[228:229], v[110:111]
    v_exp_f32 v226, v226
    v_exp_f32 v227, v227
    v_exp_f32 v228, v228
    v_exp_f32 v229, v229
    v_pk_fma_f32 v[226:227], v[226:227], v[176:177], v[176:177] op_sel:[0,1,1] op_sel_hi:[1,1,1]
    v_pk_fma_f32 v[228:229], v[228:229], v[176:177], v[176:177] op_sel:[0,1,1] op_sel_hi:[1,1,1]
    v_rcp_f32 v226, v226
    v_rcp_f32 v227, v227
    v_rcp_f32 v228, v228
    v_rcp_f32 v229, v229
    v_pk_mul_f32 v[108:109], v[108:109], v[226:227]
    v_pk_mul_f32 v[110:111], v[110:111], v[228:229]
    v_pk_fma_f32 v[112:113], v[176:177], v[140:141], v[112:113] op_sel_hi:[0,1,1] neg_lo:[1,0,0] neg_hi:[1,0,0]
    v_pk_fma_f32 v[114:115], v[176:177], v[142:143], v[114:115] op_sel_hi:[0,1,1] neg_lo:[1,0,0] neg_hi:[1,0,0]
    v_pk_mul_f32 v[226:227], v[112:113], v[112:113]
    v_pk_mul_f32 v[228:229], v[114:115], v[114:115]
    v_pk_fma_f32 v[226:227], v[226:227], v[178:179], v[178:179] op_sel:[0,1,0] op_sel_hi:[1,1,0]
    v_pk_fma_f32 v[228:229], v[228:229], v[178:179], v[178:179] op_sel:[0,1,0] op_sel_hi:[1,1,0]
    v_pk_mul_f32 v[226:227], v[226:227], v[112:113]
    v_pk_mul_f32 v[228:229], v[228:229], v[114:115]
    v_exp_f32 v226, v226
    v_exp_f32 v227, v227
    v_exp_f32 v228, v228
    v_exp_f32 v229, v229
    v_pk_fma_f32 v[226:227], v[226:227], v[176:177], v[176:177] op_sel:[0,1,1] op_sel_hi:[1,1,1]
    v_pk_fma_f32 v[228:229], v[228:229], v[176:177], v[176:177] op_sel:[0,1,1] op_sel_hi:[1,1,1]
    v_rcp_f32 v226, v226
    v_rcp_f32 v227, v227
    v_rcp_f32 v228, v228
    v_rcp_f32 v229, v229
    v_pk_mul_f32 v[112:113], v[112:113], v[226:227]
    v_pk_mul_f32 v[114:115], v[114:115], v[228:229]
    v_cvt_pk_bf16_f32 v108, v108, v109
    v_cvt_pk_bf16_f32 v109, v110, v111
    v_cvt_pk_bf16_f32 v110, v112, v113
    v_cvt_pk_bf16_f32 v111, v114, v115
    ds_write_b128 v244, v[108:111] offset:6144
    s_add_u32 s36, s44, 688128
    buffer_store_dwordx4 v[108:111], v2, s[16:19], s36 offen sc1
    v_pk_fma_f32 v[32:33], v[164:165], v[144:145], v[32:33] op_sel_hi:[0,1,1] neg_lo:[1,0,0] neg_hi:[1,0,0]
    v_pk_fma_f32 v[34:35], v[164:165], v[146:147], v[34:35] op_sel_hi:[0,1,1] neg_lo:[1,0,0] neg_hi:[1,0,0]
    v_pk_mul_f32 v[226:227], v[32:33], v[32:33]
    v_pk_mul_f32 v[228:229], v[34:35], v[34:35]
    v_pk_fma_f32 v[226:227], v[226:227], v[166:167], v[166:167] op_sel:[0,1,0] op_sel_hi:[1,1,0]
    v_pk_fma_f32 v[228:229], v[228:229], v[166:167], v[166:167] op_sel:[0,1,0] op_sel_hi:[1,1,0]
    v_pk_mul_f32 v[226:227], v[226:227], v[32:33]
    v_pk_mul_f32 v[228:229], v[228:229], v[34:35]
    v_exp_f32 v226, v226
    v_exp_f32 v227, v227
    v_exp_f32 v228, v228
    v_exp_f32 v229, v229
    v_pk_fma_f32 v[226:227], v[226:227], v[164:165], v[164:165] op_sel:[0,1,1] op_sel_hi:[1,1,1]
    v_pk_fma_f32 v[228:229], v[228:229], v[164:165], v[164:165] op_sel:[0,1,1] op_sel_hi:[1,1,1]
    v_rcp_f32 v226, v226
    v_rcp_f32 v227, v227
    v_rcp_f32 v228, v228
    v_rcp_f32 v229, v229
    v_pk_mul_f32 v[32:33], v[32:33], v[226:227]
    v_pk_mul_f32 v[34:35], v[34:35], v[228:229]
    v_pk_fma_f32 v[36:37], v[164:165], v[148:149], v[36:37] op_sel_hi:[0,1,1] neg_lo:[1,0,0] neg_hi:[1,0,0]
    v_pk_fma_f32 v[38:39], v[164:165], v[150:151], v[38:39] op_sel_hi:[0,1,1] neg_lo:[1,0,0] neg_hi:[1,0,0]
    v_pk_mul_f32 v[226:227], v[36:37], v[36:37]
    v_pk_mul_f32 v[228:229], v[38:39], v[38:39]
    v_pk_fma_f32 v[226:227], v[226:227], v[166:167], v[166:167] op_sel:[0,1,0] op_sel_hi:[1,1,0]
    v_pk_fma_f32 v[228:229], v[228:229], v[166:167], v[166:167] op_sel:[0,1,0] op_sel_hi:[1,1,0]
    v_pk_mul_f32 v[226:227], v[226:227], v[36:37]
    v_pk_mul_f32 v[228:229], v[228:229], v[38:39]
    v_exp_f32 v226, v226
    v_exp_f32 v227, v227
    v_exp_f32 v228, v228
    v_exp_f32 v229, v229
    v_pk_fma_f32 v[226:227], v[226:227], v[164:165], v[164:165] op_sel:[0,1,1] op_sel_hi:[1,1,1]
    v_pk_fma_f32 v[228:229], v[228:229], v[164:165], v[164:165] op_sel:[0,1,1] op_sel_hi:[1,1,1]
    v_rcp_f32 v226, v226
    v_rcp_f32 v227, v227
    v_rcp_f32 v228, v228
    v_rcp_f32 v229, v229
    v_pk_mul_f32 v[36:37], v[36:37], v[226:227]
    v_pk_mul_f32 v[38:39], v[38:39], v[228:229]
    v_cvt_pk_bf16_f32 v32, v32, v33
    v_cvt_pk_bf16_f32 v33, v34, v35
    v_cvt_pk_bf16_f32 v34, v36, v37
    v_cvt_pk_bf16_f32 v35, v38, v39
    v_or_b32 v32, 1, v32
    ds_write_b128 v244, v[32:35] offset:16384
    v_pk_fma_f32 v[60:61], v[168:169], v[144:145], v[60:61] op_sel_hi:[0,1,1] neg_lo:[1,0,0] neg_hi:[1,0,0]
    v_pk_fma_f32 v[62:63], v[168:169], v[146:147], v[62:63] op_sel_hi:[0,1,1] neg_lo:[1,0,0] neg_hi:[1,0,0]
    v_pk_mul_f32 v[226:227], v[60:61], v[60:61]
    v_pk_mul_f32 v[228:229], v[62:63], v[62:63]
    v_pk_fma_f32 v[226:227], v[226:227], v[170:171], v[170:171] op_sel:[0,1,0] op_sel_hi:[1,1,0]
    v_pk_fma_f32 v[228:229], v[228:229], v[170:171], v[170:171] op_sel:[0,1,0] op_sel_hi:[1,1,0]
    v_pk_mul_f32 v[226:227], v[226:227], v[60:61]
    v_pk_mul_f32 v[228:229], v[228:229], v[62:63]
    v_exp_f32 v226, v226
    v_exp_f32 v227, v227
    v_exp_f32 v228, v228
    v_exp_f32 v229, v229
    v_pk_fma_f32 v[226:227], v[226:227], v[168:169], v[168:169] op_sel:[0,1,1] op_sel_hi:[1,1,1]
    v_pk_fma_f32 v[228:229], v[228:229], v[168:169], v[168:169] op_sel:[0,1,1] op_sel_hi:[1,1,1]
    v_rcp_f32 v226, v226
    v_rcp_f32 v227, v227
    v_rcp_f32 v228, v228
    v_rcp_f32 v229, v229
    v_pk_mul_f32 v[60:61], v[60:61], v[226:227]
    v_pk_mul_f32 v[62:63], v[62:63], v[228:229]
    v_pk_fma_f32 v[64:65], v[168:169], v[148:149], v[64:65] op_sel_hi:[0,1,1] neg_lo:[1,0,0] neg_hi:[1,0,0]
    v_pk_fma_f32 v[66:67], v[168:169], v[150:151], v[66:67] op_sel_hi:[0,1,1] neg_lo:[1,0,0] neg_hi:[1,0,0]
    v_pk_mul_f32 v[226:227], v[64:65], v[64:65]
    v_pk_mul_f32 v[228:229], v[66:67], v[66:67]
    v_pk_fma_f32 v[226:227], v[226:227], v[170:171], v[170:171] op_sel:[0,1,0] op_sel_hi:[1,1,0]
    v_pk_fma_f32 v[228:229], v[228:229], v[170:171], v[170:171] op_sel:[0,1,0] op_sel_hi:[1,1,0]
    v_pk_mul_f32 v[226:227], v[226:227], v[64:65]
    v_pk_mul_f32 v[228:229], v[228:229], v[66:67]
    v_exp_f32 v226, v226
    v_exp_f32 v227, v227
    v_exp_f32 v228, v228
    v_exp_f32 v229, v229
    v_pk_fma_f32 v[226:227], v[226:227], v[168:169], v[168:169] op_sel:[0,1,1] op_sel_hi:[1,1,1]
    v_pk_fma_f32 v[228:229], v[228:229], v[168:169], v[168:169] op_sel:[0,1,1] op_sel_hi:[1,1,1]
    v_rcp_f32 v226, v226
    v_rcp_f32 v227, v227
    v_rcp_f32 v228, v228
    v_rcp_f32 v229, v229
    v_pk_mul_f32 v[64:65], v[64:65], v[226:227]
    v_pk_mul_f32 v[66:67], v[66:67], v[228:229]
    v_cvt_pk_bf16_f32 v60, v60, v61
    v_cvt_pk_bf16_f32 v61, v62, v63
    v_cvt_pk_bf16_f32 v62, v64, v65
    v_cvt_pk_bf16_f32 v63, v66, v67
    v_or_b32 v60, 1, v60
    ds_write_b128 v244, v[60:63] offset:18432
    s_waitcnt vmcnt(0)
    s_mov_b64 exec, 1
    ds_add_u32 v246, v245
    s_mov_b64 exec, -1
    v_pk_fma_f32 v[88:89], v[172:173], v[144:145], v[88:89] op_sel_hi:[0,1,1] neg_lo:[1,0,0] neg_hi:[1,0,0]
    v_pk_fma_f32 v[90:91], v[172:173], v[146:147], v[90:91] op_sel_hi:[0,1,1] neg_lo:[1,0,0] neg_hi:[1,0,0]
    v_pk_mul_f32 v[226:227], v[88:89], v[88:89]
    v_pk_mul_f32 v[228:229], v[90:91], v[90:91]
    v_pk_fma_f32 v[226:227], v[226:227], v[174:175], v[174:175] op_sel:[0,1,0] op_sel_hi:[1,1,0]
    v_pk_fma_f32 v[228:229], v[228:229], v[174:175], v[174:175] op_sel:[0,1,0] op_sel_hi:[1,1,0]
    v_pk_mul_f32 v[226:227], v[226:227], v[88:89]
    v_pk_mul_f32 v[228:229], v[228:229], v[90:91]
    v_exp_f32 v226, v226
    v_exp_f32 v227, v227
    v_exp_f32 v228, v228
    v_exp_f32 v229, v229
    v_pk_fma_f32 v[226:227], v[226:227], v[172:173], v[172:173] op_sel:[0,1,1] op_sel_hi:[1,1,1]
    v_pk_fma_f32 v[228:229], v[228:229], v[172:173], v[172:173] op_sel:[0,1,1] op_sel_hi:[1,1,1]
    v_rcp_f32 v226, v226
    v_rcp_f32 v227, v227
    v_rcp_f32 v228, v228
    v_rcp_f32 v229, v229
    v_pk_mul_f32 v[88:89], v[88:89], v[226:227]
    v_pk_mul_f32 v[90:91], v[90:91], v[228:229]
    v_pk_fma_f32 v[92:93], v[172:173], v[148:149], v[92:93] op_sel_hi:[0,1,1] neg_lo:[1,0,0] neg_hi:[1,0,0]
    v_pk_fma_f32 v[94:95], v[172:173], v[150:151], v[94:95] op_sel_hi:[0,1,1] neg_lo:[1,0,0] neg_hi:[1,0,0]
    v_pk_mul_f32 v[226:227], v[92:93], v[92:93]
    v_pk_mul_f32 v[228:229], v[94:95], v[94:95]
    v_pk_fma_f32 v[226:227], v[226:227], v[174:175], v[174:175] op_sel:[0,1,0] op_sel_hi:[1,1,0]
    v_pk_fma_f32 v[228:229], v[228:229], v[174:175], v[174:175] op_sel:[0,1,0] op_sel_hi:[1,1,0]
    v_pk_mul_f32 v[226:227], v[226:227], v[92:93]
    v_pk_mul_f32 v[228:229], v[228:229], v[94:95]
    v_exp_f32 v226, v226
    v_exp_f32 v227, v227
    v_exp_f32 v228, v228
    v_exp_f32 v229, v229
    v_pk_fma_f32 v[226:227], v[226:227], v[172:173], v[172:173] op_sel:[0,1,1] op_sel_hi:[1,1,1]
    v_pk_fma_f32 v[228:229], v[228:229], v[172:173], v[172:173] op_sel:[0,1,1] op_sel_hi:[1,1,1]
    v_rcp_f32 v226, v226
    v_rcp_f32 v227, v227
    v_rcp_f32 v228, v228
    v_rcp_f32 v229, v229
    v_pk_mul_f32 v[92:93], v[92:93], v[226:227]
    v_pk_mul_f32 v[94:95], v[94:95], v[228:229]
    v_cvt_pk_bf16_f32 v88, v88, v89
    v_cvt_pk_bf16_f32 v89, v90, v91
    v_cvt_pk_bf16_f32 v90, v92, v93
    v_cvt_pk_bf16_f32 v91, v94, v95
    v_or_b32 v88, 1, v88
    ds_write_b128 v244, v[88:91] offset:20480
    s_cmp_eq_u32 s60, 1
    s_cbranch_scc1 G4_p10
    buffer_load_dwordx4 v[180:183], v196, s[84:87], 0 offen offset:0 sc1
    buffer_load_dwordx4 v[188:191], v196, s[88:91], 0 offen offset:0 sc1
    buffer_load_dwordx4 v[184:187], v196, s[84:87], 0 offen offset:2048 sc1
    buffer_load_dwordx4 v[192:195], v196, s[88:91], 0 offen offset:2048 sc1
    s_mov_b32 s78, 0
    buffer_load_dwordx2 v[230:231], v197, s[80:83], s78 offen sc1
    s_mov_b32 s78, 65536
    buffer_load_dwordx2 v[232:233], v197, s[80:83], s78 offen sc1
    s_mov_b32 s78, 262144
    buffer_load_dwordx2 v[234:235], v197, s[80:83], s78 offen sc1
    s_mov_b32 s78, 327680
    buffer_load_dwordx2 v[236:237], v197, s[80:83], s78 offen sc1
    s_branch G4_p20
G4_p10:
    s_add_u32 s36, s40, 0
    buffer_load_dwordx4 v[180:183], v2, s[84:87], s36 offen offset:0 sc1
    buffer_load_dwordx4 v[184:187], v2, s[88:91], s36 offen offset:0 sc1
    buffer_load_dwordx4 v[188:191], v2, s[84:87], s36 offen offset:1024 sc1
    buffer_load_dwordx4 v[192:195], v2, s[88:91], s36 offen offset:1024 sc1
    s_add_u32 s36, s40, 65536
    buffer_load_dwordx4 v[196:199], v2, s[84:87], s36 offen offset:0 sc1
    buffer_load_dwordx4 v[230:233], v2, s[88:91], s36 offen offset:0 sc1
    buffer_load_dwordx4 v[234:237], v2, s[84:87], s36 offen offset:1024 sc1
    buffer_load_dwordx4 v[248:251], v2, s[88:91], s36 offen offset:1024 sc1
G4_p20:
    v_pk_fma_f32 v[116:117], v[176:177], v[144:145], v[116:117] op_sel_hi:[0,1,1] neg_lo:[1,0,0] neg_hi:[1,0,0]
    v_pk_fma_f32 v[118:119], v[176:177], v[146:147], v[118:119] op_sel_hi:[0,1,1] neg_lo:[1,0,0] neg_hi:[1,0,0]
    v_pk_mul_f32 v[226:227], v[116:117], v[116:117]
    v_pk_mul_f32 v[228:229], v[118:119], v[118:119]
    v_pk_fma_f32 v[226:227], v[226:227], v[178:179], v[178:179] op_sel:[0,1,0] op_sel_hi:[1,1,0]
    v_pk_fma_f32 v[228:229], v[228:229], v[178:179], v[178:179] op_sel:[0,1,0] op_sel_hi:[1,1,0]
    v_pk_mul_f32 v[226:227], v[226:227], v[116:117]
    v_pk_mul_f32 v[228:229], v[228:229], v[118:119]
    v_exp_f32 v226, v226
    v_exp_f32 v227, v227
    v_exp_f32 v228, v228
    v_exp_f32 v229, v229
    v_pk_fma_f32 v[226:227], v[226:227], v[176:177], v[176:177] op_sel:[0,1,1] op_sel_hi:[1,1,1]
    v_pk_fma_f32 v[228:229], v[228:229], v[176:177], v[176:177] op_sel:[0,1,1] op_sel_hi:[1,1,1]
    v_rcp_f32 v226, v226
    v_rcp_f32 v227, v227
    v_rcp_f32 v228, v228
    v_rcp_f32 v229, v229
    v_pk_mul_f32 v[116:117], v[116:117], v[226:227]
    v_pk_mul_f32 v[118:119], v[118:119], v[228:229]
    v_pk_fma_f32 v[120:121], v[176:177], v[148:149], v[120:121] op_sel_hi:[0,1,1] neg_lo:[1,0,0] neg_hi:[1,0,0]
    v_pk_fma_f32 v[122:123], v[176:177], v[150:151], v[122:123] op_sel_hi:[0,1,1] neg_lo:[1,0,0] neg_hi:[1,0,0]
    v_pk_mul_f32 v[226:227], v[120:121], v[120:121]
    v_pk_mul_f32 v[228:229], v[122:123], v[122:123]
    v_pk_fma_f32 v[226:227], v[226:227], v[178:179], v[178:179] op_sel:[0,1,0] op_sel_hi:[1,1,0]
    v_pk_fma_f32 v[228:229], v[228:229], v[178:179], v[178:179] op_sel:[0,1,0] op_sel_hi:[1,1,0]
    v_pk_mul_f32 v[226:227], v[226:227], v[120:121]
    v_pk_mul_f32 v[228:229], v[228:229], v[122:123]
    v_exp_f32 v226, v226
    v_exp_f32 v227, v227
    v_exp_f32 v228, v228
    v_exp_f32 v229, v229
    v_pk_fma_f32 v[226:227], v[226:227], v[176:177], v[176:177] op_sel:[0,1,1] op_sel_hi:[1,1,1]
    v_pk_fma_f32 v[228:229], v[228:229], v[176:177], v[176:177] op_sel:[0,1,1] op_sel_hi:[1,1,1]
    v_rcp_f32 v226, v226
    v_rcp_f32 v227, v227
    v_rcp_f32 v228, v228
    v_rcp_f32 v229, v229
    v_pk_mul_f32 v[120:121], v[120:121], v[226:227]
    v_pk_mul_f32 v[122:123], v[122:123], v[228:229]
    v_cvt_pk_bf16_f32 v116, v116, v117
    v_cvt_pk_bf16_f32 v117, v118, v119
    v_cvt_pk_bf16_f32 v118, v120, v121
    v_cvt_pk_bf16_f32 v119, v122, v123
    ds_write_b128 v244, v[116:119] offset:22528
    v_pk_fma_f32 v[40:41], v[164:165], v[152:153], v[40:41] op_sel_hi:[0,1,1] neg_lo:[1,0,0] neg_hi:[1,0,0]
    v_pk_fma_f32 v[42:43], v[164:165], v[154:155], v[42:43] op_sel_hi:[0,1,1] neg_lo:[1,0,0] neg_hi:[1,0,0]
    v_pk_mul_f32 v[226:227], v[40:41], v[40:41]
    v_pk_mul_f32 v[228:229], v[42:43], v[42:43]
    v_pk_fma_f32 v[226:227], v[226:227], v[166:167], v[166:167] op_sel:[0,1,0] op_sel_hi:[1,1,0]
    v_pk_fma_f32 v[228:229], v[228:229], v[166:167], v[166:167] op_sel:[0,1,0] op_sel_hi:[1,1,0]
    v_pk_mul_f32 v[226:227], v[226:227], v[40:41]
    v_pk_mul_f32 v[228:229], v[228:229], v[42:43]
    v_exp_f32 v226, v226
    v_exp_f32 v227, v227
    v_exp_f32 v228, v228
    v_exp_f32 v229, v229
    v_pk_fma_f32 v[226:227], v[226:227], v[164:165], v[164:165] op_sel:[0,1,1] op_sel_hi:[1,1,1]
    v_pk_fma_f32 v[228:229], v[228:229], v[164:165], v[164:165] op_sel:[0,1,1] op_sel_hi:[1,1,1]
    v_rcp_f32 v226, v226
    v_rcp_f32 v227, v227
    v_rcp_f32 v228, v228
    v_rcp_f32 v229, v229
    v_pk_mul_f32 v[40:41], v[40:41], v[226:227]
    v_pk_mul_f32 v[42:43], v[42:43], v[228:229]
    v_pk_fma_f32 v[44:45], v[164:165], v[156:157], v[44:45] op_sel_hi:[0,1,1] neg_lo:[1,0,0] neg_hi:[1,0,0]
    v_pk_fma_f32 v[46:47], v[164:165], v[158:159], v[46:47] op_sel_hi:[0,1,1] neg_lo:[1,0,0] neg_hi:[1,0,0]
    v_pk_mul_f32 v[226:227], v[44:45], v[44:45]
    v_pk_mul_f32 v[228:229], v[46:47], v[46:47]
    v_pk_fma_f32 v[226:227], v[226:227], v[166:167], v[166:167] op_sel:[0,1,0] op_sel_hi:[1,1,0]
    v_pk_fma_f32 v[228:229], v[228:229], v[166:167], v[166:167] op_sel:[0,1,0] op_sel_hi:[1,1,0]
    v_pk_mul_f32 v[226:227], v[226:227], v[44:45]
    v_pk_mul_f32 v[228:229], v[228:229], v[46:47]
    v_exp_f32 v226, v226
    v_exp_f32 v227, v227
    v_exp_f32 v228, v228
    v_exp_f32 v229, v229
    v_pk_fma_f32 v[226:227], v[226:227], v[164:165], v[164:165] op_sel:[0,1,1] op_sel_hi:[1,1,1]
    v_pk_fma_f32 v[228:229], v[228:229], v[164:165], v[164:165] op_sel:[0,1,1] op_sel_hi:[1,1,1]
    v_rcp_f32 v226, v226
    v_rcp_f32 v227, v227
    v_rcp_f32 v228, v228
    v_rcp_f32 v229, v229
    v_pk_mul_f32 v[44:45], v[44:45], v[226:227]
    v_pk_mul_f32 v[46:47], v[46:47], v[228:229]
    v_cvt_pk_bf16_f32 v200, v40, v41
    v_cvt_pk_bf16_f32 v201, v42, v43
    v_cvt_pk_bf16_f32 v202, v44, v45
    v_cvt_pk_bf16_f32 v203, v46, v47
    v_or_b32 v200, 1, v200
    ds_write_b128 v244, v[200:203] offset:32768
    v_pk_fma_f32 v[68:69], v[168:169], v[152:153], v[68:69] op_sel_hi:[0,1,1] neg_lo:[1,0,0] neg_hi:[1,0,0]
    v_pk_fma_f32 v[70:71], v[168:169], v[154:155], v[70:71] op_sel_hi:[0,1,1] neg_lo:[1,0,0] neg_hi:[1,0,0]
    v_pk_mul_f32 v[226:227], v[68:69], v[68:69]
    v_pk_mul_f32 v[228:229], v[70:71], v[70:71]
    v_pk_fma_f32 v[226:227], v[226:227], v[170:171], v[170:171] op_sel:[0,1,0] op_sel_hi:[1,1,0]
    v_pk_fma_f32 v[228:229], v[228:229], v[170:171], v[170:171] op_sel:[0,1,0] op_sel_hi:[1,1,0]
    v_pk_mul_f32 v[226:227], v[226:227], v[68:69]
    v_pk_mul_f32 v[228:229], v[228:229], v[70:71]
    v_exp_f32 v226, v226
    v_exp_f32 v227, v227
    v_exp_f32 v228, v228
    v_exp_f32 v229, v229
    v_pk_fma_f32 v[226:227], v[226:227], v[168:169], v[168:169] op_sel:[0,1,1] op_sel_hi:[1,1,1]
    v_pk_fma_f32 v[228:229], v[228:229], v[168:169], v[168:169] op_sel:[0,1,1] op_sel_hi:[1,1,1]
    v_rcp_f32 v226, v226
    v_rcp_f32 v227, v227
    v_rcp_f32 v228, v228
    v_rcp_f32 v229, v229
    v_pk_mul_f32 v[68:69], v[68:69], v[226:227]
    v_pk_mul_f32 v[70:71], v[70:71], v[228:229]
    v_pk_fma_f32 v[72:73], v[168:169], v[156:157], v[72:73] op_sel_hi:[0,1,1] neg_lo:[1,0,0] neg_hi:[1,0,0]
    v_pk_fma_f32 v[74:75], v[168:169], v[158:159], v[74:75] op_sel_hi:[0,1,1] neg_lo:[1,0,0] neg_hi:[1,0,0]
    v_pk_mul_f32 v[226:227], v[72:73], v[72:73]
    v_pk_mul_f32 v[228:229], v[74:75], v[74:75]
    v_pk_fma_f32 v[226:227], v[226:227], v[170:171], v[170:171] op_sel:[0,1,0] op_sel_hi:[1,1,0]
    v_pk_fma_f32 v[228:229], v[228:229], v[170:171], v[170:171] op_sel:[0,1,0] op_sel_hi:[1,1,0]
    v_pk_mul_f32 v[226:227], v[226:227], v[72:73]
    v_pk_mul_f32 v[228:229], v[228:229], v[74:75]
    v_exp_f32 v226, v226
    v_exp_f32 v227, v227
    v_exp_f32 v228, v228
    v_exp_f32 v229, v229
    v_pk_fma_f32 v[226:227], v[226:227], v[168:169], v[168:169] op_sel:[0,1,1] op_sel_hi:[1,1,1]
    v_pk_fma_f32 v[228:229], v[228:229], v[168:169], v[168:169] op_sel:[0,1,1] op_sel_hi:[1,1,1]
    v_rcp_f32 v226, v226
    v_rcp_f32 v227, v227
    v_rcp_f32 v228, v228
    v_rcp_f32 v229, v229
    v_pk_mul_f32 v[72:73], v[72:73], v[226:227]
    v_pk_mul_f32 v[74:75], v[74:75], v[228:229]
    v_cvt_pk_bf16_f32 v204, v68, v69
    v_cvt_pk_bf16_f32 v205, v70, v71
    v_cvt_pk_bf16_f32 v206, v72, v73
    v_cvt_pk_bf16_f32 v207, v74, v75
    v_or_b32 v204, 1, v204
    ds_write_b128 v244, v[204:207] offset:34816
    v_pk_fma_f32 v[96:97], v[172:173], v[152:153], v[96:97] op_sel_hi:[0,1,1] neg_lo:[1,0,0] neg_hi:[1,0,0]
    v_pk_fma_f32 v[98:99], v[172:173], v[154:155], v[98:99] op_sel_hi:[0,1,1] neg_lo:[1,0,0] neg_hi:[1,0,0]
    v_pk_mul_f32 v[226:227], v[96:97], v[96:97]
    v_pk_mul_f32 v[228:229], v[98:99], v[98:99]
    v_pk_fma_f32 v[226:227], v[226:227], v[174:175], v[174:175] op_sel:[0,1,0] op_sel_hi:[1,1,0]
    v_pk_fma_f32 v[228:229], v[228:229], v[174:175], v[174:175] op_sel:[0,1,0] op_sel_hi:[1,1,0]
    v_pk_mul_f32 v[226:227], v[226:227], v[96:97]
    v_pk_mul_f32 v[228:229], v[228:229], v[98:99]
    v_exp_f32 v226, v226
    v_exp_f32 v227, v227
    v_exp_f32 v228, v228
    v_exp_f32 v229, v229
    v_pk_fma_f32 v[226:227], v[226:227], v[172:173], v[172:173] op_sel:[0,1,1] op_sel_hi:[1,1,1]
    v_pk_fma_f32 v[228:229], v[228:229], v[172:173], v[172:173] op_sel:[0,1,1] op_sel_hi:[1,1,1]
    v_rcp_f32 v226, v226
    v_rcp_f32 v227, v227
    v_rcp_f32 v228, v228
    v_rcp_f32 v229, v229
    v_pk_mul_f32 v[96:97], v[96:97], v[226:227]
    v_pk_mul_f32 v[98:99], v[98:99], v[228:229]
    v_pk_fma_f32 v[100:101], v[172:173], v[156:157], v[100:101] op_sel_hi:[0,1,1] neg_lo:[1,0,0] neg_hi:[1,0,0]
    v_pk_fma_f32 v[102:103], v[172:173], v[158:159], v[102:103] op_sel_hi:[0,1,1] neg_lo:[1,0,0] neg_hi:[1,0,0]
    v_pk_mul_f32 v[226:227], v[100:101], v[100:101]
    v_pk_mul_f32 v[228:229], v[102:103], v[102:103]
    v_pk_fma_f32 v[226:227], v[226:227], v[174:175], v[174:175] op_sel:[0,1,0] op_sel_hi:[1,1,0]
    v_pk_fma_f32 v[228:229], v[228:229], v[174:175], v[174:175] op_sel:[0,1,0] op_sel_hi:[1,1,0]
    v_pk_mul_f32 v[226:227], v[226:227], v[100:101]
    v_pk_mul_f32 v[228:229], v[228:229], v[102:103]
    v_exp_f32 v226, v226
    v_exp_f32 v227, v227
    v_exp_f32 v228, v228
    v_exp_f32 v229, v229
    v_pk_fma_f32 v[226:227], v[226:227], v[172:173], v[172:173] op_sel:[0,1,1] op_sel_hi:[1,1,1]
    v_pk_fma_f32 v[228:229], v[228:229], v[172:173], v[172:173] op_sel:[0,1,1] op_sel_hi:[1,1,1]
    v_rcp_f32 v226, v226
    v_rcp_f32 v227, v227
    v_rcp_f32 v228, v228
    v_rcp_f32 v229, v229
    v_pk_mul_f32 v[100:101], v[100:101], v[226:227]
    v_pk_mul_f32 v[102:103], v[102:103], v[228:229]
    v_cvt_pk_bf16_f32 v208, v96, v97
    v_cvt_pk_bf16_f32 v209, v98, v99
    v_cvt_pk_bf16_f32 v210, v100, v101
    v_cvt_pk_bf16_f32 v211, v102, v103
    v_or_b32 v208, 1, v208
    ds_write_b128 v244, v[208:211] offset:36864
    v_pk_fma_f32 v[124:125], v[176:177], v[152:153], v[124:125] op_sel_hi:[0,1,1] neg_lo:[1,0,0] neg_hi:[1,0,0]
    v_pk_fma_f32 v[126:127], v[176:177], v[154:155], v[126:127] op_sel_hi:[0,1,1] neg_lo:[1,0,0] neg_hi:[1,0,0]
    v_pk_mul_f32 v[226:227], v[124:125], v[124:125]
    v_pk_mul_f32 v[228:229], v[126:127], v[126:127]
    v_pk_fma_f32 v[226:227], v[226:227], v[178:179], v[178:179] op_sel:[0,1,0] op_sel_hi:[1,1,0]
    v_pk_fma_f32 v[228:229], v[228:229], v[178:179], v[178:179] op_sel:[0,1,0] op_sel_hi:[1,1,0]
    v_pk_mul_f32 v[226:227], v[226:227], v[124:125]
    v_pk_mul_f32 v[228:229], v[228:229], v[126:127]
    v_exp_f32 v226, v226
    v_exp_f32 v227, v227
    v_exp_f32 v228, v228
    v_exp_f32 v229, v229
    v_pk_fma_f32 v[226:227], v[226:227], v[176:177], v[176:177] op_sel:[0,1,1] op_sel_hi:[1,1,1]
    v_pk_fma_f32 v[228:229], v[228:229], v[176:177], v[176:177] op_sel:[0,1,1] op_sel_hi:[1,1,1]
    v_rcp_f32 v226, v226
    v_rcp_f32 v227, v227
    v_rcp_f32 v228, v228
    v_rcp_f32 v229, v229
    v_pk_mul_f32 v[124:125], v[124:125], v[226:227]
    v_pk_mul_f32 v[126:127], v[126:127], v[228:229]
    v_pk_fma_f32 v[128:129], v[176:177], v[156:157], v[128:129] op_sel_hi:[0,1,1] neg_lo:[1,0,0] neg_hi:[1,0,0]
    v_pk_fma_f32 v[130:131], v[176:177], v[158:159], v[130:131] op_sel_hi:[0,1,1] neg_lo:[1,0,0] neg_hi:[1,0,0]
    v_pk_mul_f32 v[226:227], v[128:129], v[128:129]
    v_pk_mul_f32 v[228:229], v[130:131], v[130:131]
    v_pk_fma_f32 v[226:227], v[226:227], v[178:179], v[178:179] op_sel:[0,1,0] op_sel_hi:[1,1,0]
    v_pk_fma_f32 v[228:229], v[228:229], v[178:179], v[178:179] op_sel:[0,1,0] op_sel_hi:[1,1,0]
    v_pk_mul_f32 v[226:227], v[226:227], v[128:129]
    v_pk_mul_f32 v[228:229], v[228:229], v[130:131]
    v_exp_f32 v226, v226
    v_exp_f32 v227, v227
    v_exp_f32 v228, v228
    v_exp_f32 v229, v229
    v_pk_fma_f32 v[226:227], v[226:227], v[176:177], v[176:177] op_sel:[0,1,1] op_sel_hi:[1,1,1]
    v_pk_fma_f32 v[228:229], v[228:229], v[176:177], v[176:177] op_sel:[0,1,1] op_sel_hi:[1,1,1]
    v_rcp_f32 v226, v226
    v_rcp_f32 v227, v227
    v_rcp_f32 v228, v228
    v_rcp_f32 v229, v229
    v_pk_mul_f32 v[128:129], v[128:129], v[226:227]
    v_pk_mul_f32 v[130:131], v[130:131], v[228:229]
    v_cvt_pk_bf16_f32 v212, v124, v125
    v_cvt_pk_bf16_f32 v213, v126, v127
    v_cvt_pk_bf16_f32 v214, v128, v129
    v_cvt_pk_bf16_f32 v215, v130, v131
    ds_write_b128 v244, v[212:215] offset:38912
    v_pk_fma_f32 v[48:49], v[164:165], v[160:161], v[48:49] op_sel_hi:[0,1,1] neg_lo:[1,0,0] neg_hi:[1,0,0]
    v_pk_fma_f32 v[50:51], v[164:165], v[162:163], v[50:51] op_sel_hi:[0,1,1] neg_lo:[1,0,0] neg_hi:[1,0,0]
    v_pk_mul_f32 v[226:227], v[48:49], v[48:49]
    v_pk_mul_f32 v[228:229], v[50:51], v[50:51]
    v_pk_fma_f32 v[226:227], v[226:227], v[166:167], v[166:167] op_sel:[0,1,0] op_sel_hi:[1,1,0]
    v_pk_fma_f32 v[228:229], v[228:229], v[166:167], v[166:167] op_sel:[0,1,0] op_sel_hi:[1,1,0]
    v_pk_mul_f32 v[226:227], v[226:227], v[48:49]
    v_pk_mul_f32 v[228:229], v[228:229], v[50:51]
    v_exp_f32 v226, v226
    v_exp_f32 v227, v227
    v_exp_f32 v228, v228
    v_exp_f32 v229, v229
    v_pk_fma_f32 v[226:227], v[226:227], v[164:165], v[164:165] op_sel:[0,1,1] op_sel_hi:[1,1,1]
    v_pk_fma_f32 v[228:229], v[228:229], v[164:165], v[164:165] op_sel:[0,1,1] op_sel_hi:[1,1,1]
    v_rcp_f32 v226, v226
    v_rcp_f32 v227, v227
    v_rcp_f32 v228, v228
    v_rcp_f32 v229, v229
    v_pk_mul_f32 v[48:49], v[48:49], v[226:227]
    v_pk_mul_f32 v[50:51], v[50:51], v[228:229]
    v_cvt_pk_bf16_f32 v216, v48, v49
    v_cvt_pk_bf16_f32 v217, v50, v51
    v_or_b32 v216, 1, v216
    s_add_u32 s36, s45, 0
    buffer_store_dwordx4 v[32:35], v2, s[16:19], s36 offen sc1
    v_pk_fma_f32 v[76:77], v[168:169], v[160:161], v[76:77] op_sel_hi:[0,1,1] neg_lo:[1,0,0] neg_hi:[1,0,0]
    v_pk_fma_f32 v[78:79], v[168:169], v[162:163], v[78:79] op_sel_hi:[0,1,1] neg_lo:[1,0,0] neg_hi:[1,0,0]
    v_pk_mul_f32 v[226:227], v[76:77], v[76:77]
    v_pk_mul_f32 v[228:229], v[78:79], v[78:79]
    v_pk_fma_f32 v[226:227], v[226:227], v[170:171], v[170:171] op_sel:[0,1,0] op_sel_hi:[1,1,0]
    v_pk_fma_f32 v[228:229], v[228:229], v[170:171], v[170:171] op_sel:[0,1,0] op_sel_hi:[1,1,0]
    v_pk_mul_f32 v[226:227], v[226:227], v[76:77]
    v_pk_mul_f32 v[228:229], v[228:229], v[78:79]
    v_exp_f32 v226, v226
    v_exp_f32 v227, v227
    v_exp_f32 v228, v228
    v_exp_f32 v229, v229
    v_pk_fma_f32 v[226:227], v[226:227], v[168:169], v[168:169] op_sel:[0,1,1] op_sel_hi:[1,1,1]
    v_pk_fma_f32 v[228:229], v[228:229], v[168:169], v[168:169] op_sel:[0,1,1] op_sel_hi:[1,1,1]
    v_rcp_f32 v226, v226
    v_rcp_f32 v227, v227
    v_rcp_f32 v228, v228
    v_rcp_f32 v229, v229
    v_pk_mul_f32 v[76:77], v[76:77], v[226:227]
    v_pk_mul_f32 v[78:79], v[78:79], v[228:229]
    v_cvt_pk_bf16_f32 v218, v76, v77
    v_cvt_pk_bf16_f32 v219, v78, v79
    v_or_b32 v218, 1, v218
    s_add_u32 s36, s45, 229376
    buffer_store_dwordx4 v[60:63], v2, s[16:19], s36 offen sc1
    v_pk_fma_f32 v[104:105], v[172:173], v[160:161], v[104:105] op_sel_hi:[0,1,1] neg_lo:[1,0,0] neg_hi:[1,0,0]
    v_pk_fma_f32 v[106:107], v[172:173], v[162:163], v[106:107] op_sel_hi:[0,1,1] neg_lo:[1,0,0] neg_hi:[1,0,0]
    v_pk_mul_f32 v[226:227], v[104:105], v[104:105]
    v_pk_mul_f32 v[228:229], v[106:107], v[106:107]
    v_pk_fma_f32 v[226:227], v[226:227], v[174:175], v[174:175] op_sel:[0,1,0] op_sel_hi:[1,1,0]
    v_pk_fma_f32 v[228:229], v[228:229], v[174:175], v[174:175] op_sel:[0,1,0] op_sel_hi:[1,1,0]
    v_pk_mul_f32 v[226:227], v[226:227], v[104:105]
    v_pk_mul_f32 v[228:229], v[228:229], v[106:107]
    v_exp_f32 v226, v226
    v_exp_f32 v227, v227
    v_exp_f32 v228, v228
    v_exp_f32 v229, v229
    v_pk_fma_f32 v[226:227], v[226:227], v[172:173], v[172:173] op_sel:[0,1,1] op_sel_hi:[1,1,1]
    v_pk_fma_f32 v[228:229], v[228:229], v[172:173], v[172:173] op_sel:[0,1,1] op_sel_hi:[1,1,1]
    v_rcp_f32 v226, v226
    v_rcp_f32 v227, v227
    v_rcp_f32 v228, v228
    v_rcp_f32 v229, v229
    v_pk_mul_f32 v[104:105], v[104:105], v[226:227]
    v_pk_mul_f32 v[106:107], v[106:107], v[228:229]
    v_cvt_pk_bf16_f32 v220, v104, v105
    v_cvt_pk_bf16_f32 v221, v106, v107
    v_or_b32 v220, 1, v220
    s_add_u32 s36, s45, 458752
    buffer_store_dwordx4 v[88:91], v2, s[16:19], s36 offen sc1
    v_pk_fma_f32 v[132:133], v[176:177], v[160:161], v[132:133] op_sel_hi:[0,1,1] neg_lo:[1,0,0] neg_hi:[1,0,0]
    v_pk_fma_f32 v[134:135], v[176:177], v[162:163], v[134:135] op_sel_hi:[0,1,1] neg_lo:[1,0,0] neg_hi:[1,0,0]
    v_pk_mul_f32 v[226:227], v[132:133], v[132:133]
    v_pk_mul_f32 v[228:229], v[134:135], v[134:135]
    v_pk_fma_f32 v[226:227], v[226:227], v[178:179], v[178:179] op_sel:[0,1,0] op_sel_hi:[1,1,0]
    v_pk_fma_f32 v[228:229], v[228:229], v[178:179], v[178:179] op_sel:[0,1,0] op_sel_hi:[1,1,0]
    v_pk_mul_f32 v[226:227], v[226:227], v[132:133]
    v_pk_mul_f32 v[228:229], v[228:229], v[134:135]
    v_exp_f32 v226, v226
    v_exp_f32 v227, v227
    v_exp_f32 v228, v228
    v_exp_f32 v229, v229
    v_pk_fma_f32 v[226:227], v[226:227], v[176:177], v[176:177] op_sel:[0,1,1] op_sel_hi:[1,1,1]
    v_pk_fma_f32 v[228:229], v[228:229], v[176:177], v[176:177] op_sel:[0,1,1] op_sel_hi:[1,1,1]
    v_rcp_f32 v226, v226
    v_rcp_f32 v227, v227
    v_rcp_f32 v228, v228
    v_rcp_f32 v229, v229
    v_pk_mul_f32 v[132:133], v[132:133], v[226:227]
    v_pk_mul_f32 v[134:135], v[134:135], v[228:229]
    v_cvt_pk_bf16_f32 v222, v132, v133
    v_cvt_pk_bf16_f32 v223, v134, v135
    s_add_u32 s36, s45, 688128
    buffer_store_dwordx4 v[116:119], v2, s[16:19], s36 offen sc1
    s_waitcnt lgkmcnt(0)
    s_mov_b32 s44, s46
    s_mov_b32 s45, s47
    s_branch G3_e2
G3_e1:
    v_pk_fma_f32 v[28:29], v[164:165], v[140:141], v[28:29] op_sel_hi:[0,1,1] neg_lo:[1,0,0] neg_hi:[1,0,0]
    v_pk_fma_f32 v[30:31], v[164:165], v[142:143], v[30:31] op_sel_hi:[0,1,1] neg_lo:[1,0,0] neg_hi:[1,0,0]
    v_pk_mul_f32 v[226:227], v[28:29], v[28:29]
    v_pk_mul_f32 v[228:229], v[30:31], v[30:31]
    v_pk_fma_f32 v[226:227], v[226:227], v[166:167], v[166:167] op_sel:[0,1,0] op_sel_hi:[1,1,0]
    v_pk_fma_f32 v[228:229], v[228:229], v[166:167], v[166:167] op_sel:[0,1,0] op_sel_hi:[1,1,0]
    v_pk_mul_f32 v[226:227], v[226:227], v[28:29]
    v_pk_mul_f32 v[228:229], v[228:229], v[30:31]
    v_exp_f32 v226, v226
    v_exp_f32 v227, v227
    v_exp_f32 v228, v228
    v_exp_f32 v229, v229
    v_pk_fma_f32 v[226:227], v[226:227], v[164:165], v[164:165] op_sel:[0,1,1] op_sel_hi:[1,1,1]
    v_pk_fma_f32 v[228:229], v[228:229], v[164:165], v[164:165] op_sel:[0,1,1] op_sel_hi:[1,1,1]
    v_rcp_f32 v226, v226
    v_rcp_f32 v227, v227
    v_rcp_f32 v228, v228
    v_rcp_f32 v229, v229
    v_pk_mul_f32 v[28:29], v[28:29], v[226:227]
    v_pk_mul_f32 v[30:31], v[30:31], v[228:229]
    v_pk_fma_f32 v[32:33], v[164:165], v[144:145], v[32:33] op_sel_hi:[0,1,1] neg_lo:[1,0,0] neg_hi:[1,0,0]
    v_pk_fma_f32 v[34:35], v[164:165], v[146:147], v[34:35] op_sel_hi:[0,1,1] neg_lo:[1,0,0] neg_hi:[1,0,0]
    v_pk_mul_f32 v[226:227], v[32:33], v[32:33]
    v_pk_mul_f32 v[228:229], v[34:35], v[34:35]
    v_pk_fma_f32 v[226:227], v[226:227], v[166:167], v[166:167] op_sel:[0,1,0] op_sel_hi:[1,1,0]
    v_pk_fma_f32 v[228:229], v[228:229], v[166:167], v[166:167] op_sel:[0,1,0] op_sel_hi:[1,1,0]
    v_pk_mul_f32 v[226:227], v[226:227], v[32:33]
    v_pk_mul_f32 v[228:229], v[228:229], v[34:35]
    v_exp_f32 v226, v226
    v_exp_f32 v227, v227
    v_exp_f32 v228, v228
    v_exp_f32 v229, v229
    v_pk_fma_f32 v[226:227], v[226:227], v[164:165], v[164:165] op_sel:[0,1,1] op_sel_hi:[1,1,1]
    v_pk_fma_f32 v[228:229], v[228:229], v[164:165], v[164:165] op_sel:[0,1,1] op_sel_hi:[1,1,1]
    v_rcp_f32 v226, v226
    v_rcp_f32 v227, v227
    v_rcp_f32 v228, v228
    v_rcp_f32 v229, v229
    v_pk_mul_f32 v[32:33], v[32:33], v[226:227]
    v_pk_mul_f32 v[34:35], v[34:35], v[228:229]
    v_cvt_pk_bf16_f32 v28, v28, v29
    v_cvt_pk_bf16_f32 v29, v30, v31
    v_cvt_pk_bf16_f32 v30, v32, v33
    v_cvt_pk_bf16_f32 v31, v34, v35
    v_or_b32 v28, 1, v28
    ds_write_b128 v244, v[28:31] offset:0
    s_add_u32 s36, s45, 0
    buffer_store_dwordx4 v[28:31], v2, s[16:19], s36 offen sc1
    v_pk_fma_f32 v[56:57], v[168:169], v[140:141], v[56:57] op_sel_hi:[0,1,1] neg_lo:[1,0,0] neg_hi:[1,0,0]
    v_pk_fma_f32 v[58:59], v[168:169], v[142:143], v[58:59] op_sel_hi:[0,1,1] neg_lo:[1,0,0] neg_hi:[1,0,0]
    v_pk_mul_f32 v[226:227], v[56:57], v[56:57]
    v_pk_mul_f32 v[228:229], v[58:59], v[58:59]
    v_pk_fma_f32 v[226:227], v[226:227], v[170:171], v[170:171] op_sel:[0,1,0] op_sel_hi:[1,1,0]
    v_pk_fma_f32 v[228:229], v[228:229], v[170:171], v[170:171] op_sel:[0,1,0] op_sel_hi:[1,1,0]
    v_pk_mul_f32 v[226:227], v[226:227], v[56:57]
    v_pk_mul_f32 v[228:229], v[228:229], v[58:59]
    v_exp_f32 v226, v226
    v_exp_f32 v227, v227
    v_exp_f32 v228, v228
    v_exp_f32 v229, v229
    v_pk_fma_f32 v[226:227], v[226:227], v[168:169], v[168:169] op_sel:[0,1,1] op_sel_hi:[1,1,1]
    v_pk_fma_f32 v[228:229], v[228:229], v[168:169], v[168:169] op_sel:[0,1,1] op_sel_hi:[1,1,1]
    v_rcp_f32 v226, v226
    v_rcp_f32 v227, v227
    v_rcp_f32 v228, v228
    v_rcp_f32 v229, v229
    v_pk_mul_f32 v[56:57], v[56:57], v[226:227]
    v_pk_mul_f32 v[58:59], v[58:59], v[228:229]
    v_pk_fma_f32 v[60:61], v[168:169], v[144:145], v[60:61] op_sel_hi:[0,1,1] neg_lo:[1,0,0] neg_hi:[1,0,0]
    v_pk_fma_f32 v[62:63], v[168:169], v[146:147], v[62:63] op_sel_hi:[0,1,1] neg_lo:[1,0,0] neg_hi:[1,0,0]
    v_pk_mul_f32 v[226:227], v[60:61], v[60:61]
    v_pk_mul_f32 v[228:229], v[62:63], v[62:63]
    v_pk_fma_f32 v[226:227], v[226:227], v[170:171], v[170:171] op_sel:[0,1,0] op_sel_hi:[1,1,0]
    v_pk_fma_f32 v[228:229], v[228:229], v[170:171], v[170:171] op_sel:[0,1,0] op_sel_hi:[1,1,0]
    v_pk_mul_f32 v[226:227], v[226:227], v[60:61]
    v_pk_mul_f32 v[228:229], v[228:229], v[62:63]
    v_exp_f32 v226, v226
    v_exp_f32 v227, v227
    v_exp_f32 v228, v228
    v_exp_f32 v229, v229
    v_pk_fma_f32 v[226:227], v[226:227], v[168:169], v[168:169] op_sel:[0,1,1] op_sel_hi:[1,1,1]
    v_pk_fma_f32 v[228:229], v[228:229], v[168:169], v[168:169] op_sel:[0,1,1] op_sel_hi:[1,1,1]
    v_rcp_f32 v226, v226
    v_rcp_f32 v227, v227
    v_rcp_f32 v228, v228
    v_rcp_f32 v229, v229
    v_pk_mul_f32 v[60:61], v[60:61], v[226:227]
    v_pk_mul_f32 v[62:63], v[62:63], v[228:229]
    v_cvt_pk_bf16_f32 v56, v56, v57
    v_cvt_pk_bf16_f32 v57, v58, v59
    v_cvt_pk_bf16_f32 v58, v60, v61
    v_cvt_pk_bf16_f32 v59, v62, v63
    v_or_b32 v56, 1, v56
    ds_write_b128 v244, v[56:59] offset:2048
    s_add_u32 s36, s45, 229376
    buffer_store_dwordx4 v[56:59], v2, s[16:19], s36 offen sc1
    v_pk_fma_f32 v[84:85], v[172:173], v[140:141], v[84:85] op_sel_hi:[0,1,1] neg_lo:[1,0,0] neg_hi:[1,0,0]
    v_pk_fma_f32 v[86:87], v[172:173], v[142:143], v[86:87] op_sel_hi:[0,1,1] neg_lo:[1,0,0] neg_hi:[1,0,0]
    v_pk_mul_f32 v[226:227], v[84:85], v[84:85]
    v_pk_mul_f32 v[228:229], v[86:87], v[86:87]
    v_pk_fma_f32 v[226:227], v[226:227], v[174:175], v[174:175] op_sel:[0,1,0] op_sel_hi:[1,1,0]
    v_pk_fma_f32 v[228:229], v[228:229], v[174:175], v[174:175] op_sel:[0,1,0] op_sel_hi:[1,1,0]
    v_pk_mul_f32 v[226:227], v[226:227], v[84:85]
    v_pk_mul_f32 v[228:229], v[228:229], v[86:87]
    v_exp_f32 v226, v226
    v_exp_f32 v227, v227
    v_exp_f32 v228, v228
    v_exp_f32 v229, v229
    v_pk_fma_f32 v[226:227], v[226:227], v[172:173], v[172:173] op_sel:[0,1,1] op_sel_hi:[1,1,1]
    v_pk_fma_f32 v[228:229], v[228:229], v[172:173], v[172:173] op_sel:[0,1,1] op_sel_hi:[1,1,1]
    v_rcp_f32 v226, v226
    v_rcp_f32 v227, v227
    v_rcp_f32 v228, v228
    v_rcp_f32 v229, v229
    v_pk_mul_f32 v[84:85], v[84:85], v[226:227]
    v_pk_mul_f32 v[86:87], v[86:87], v[228:229]
    v_pk_fma_f32 v[88:89], v[172:173], v[144:145], v[88:89] op_sel_hi:[0,1,1] neg_lo:[1,0,0] neg_hi:[1,0,0]
    v_pk_fma_f32 v[90:91], v[172:173], v[146:147], v[90:91] op_sel_hi:[0,1,1] neg_lo:[1,0,0] neg_hi:[1,0,0]
    v_pk_mul_f32 v[226:227], v[88:89], v[88:89]
    v_pk_mul_f32 v[228:229], v[90:91], v[90:91]
    v_pk_fma_f32 v[226:227], v[226:227], v[174:175], v[174:175] op_sel:[0,1,0] op_sel_hi:[1,1,0]
    v_pk_fma_f32 v[228:229], v[228:229], v[174:175], v[174:175] op_sel:[0,1,0] op_sel_hi:[1,1,0]
    v_pk_mul_f32 v[226:227], v[226:227], v[88:89]
    v_pk_mul_f32 v[228:229], v[228:229], v[90:91]
    v_exp_f32 v226, v226
    v_exp_f32 v227, v227
    v_exp_f32 v228, v228
    v_exp_f32 v229, v229
    v_pk_fma_f32 v[226:227], v[226:227], v[172:173], v[172:173] op_sel:[0,1,1] op_sel_hi:[1,1,1]
    v_pk_fma_f32 v[228:229], v[228:229], v[172:173], v[172:173] op_sel:[0,1,1] op_sel_hi:[1,1,1]
    v_rcp_f32 v226, v226
    v_rcp_f32 v227, v227
    v_rcp_f32 v228, v228
    v_rcp_f32 v229, v229
    v_pk_mul_f32 v[88:89], v[88:89], v[226:227]
    v_pk_mul_f32 v[90:91], v[90:91], v[228:229]
    v_cvt_pk_bf16_f32 v84, v84, v85
    v_cvt_pk_bf16_f32 v85, v86, v87
    v_cvt_pk_bf16_f32 v86, v88, v89
    v_cvt_pk_bf16_f32 v87, v90, v91
    v_or_b32 v84, 1, v84
    ds_write_b128 v244, v[84:87] offset:4096
    s_add_u32 s36, s45, 458752
    buffer_store_dwordx4 v[84:87], v2, s[16:19], s36 offen sc1
    v_pk_fma_f32 v[112:113], v[176:177], v[140:141], v[112:113] op_sel_hi:[0,1,1] neg_lo:[1,0,0] neg_hi:[1,0,0]
    v_pk_fma_f32 v[114:115], v[176:177], v[142:143], v[114:115] op_sel_hi:[0,1,1] neg_lo:[1,0,0] neg_hi:[1,0,0]
    v_pk_mul_f32 v[226:227], v[112:113], v[112:113]
    v_pk_mul_f32 v[228:229], v[114:115], v[114:115]
    v_pk_fma_f32 v[226:227], v[226:227], v[178:179], v[178:179] op_sel:[0,1,0] op_sel_hi:[1,1,0]
    v_pk_fma_f32 v[228:229], v[228:229], v[178:179], v[178:179] op_sel:[0,1,0] op_sel_hi:[1,1,0]
    v_pk_mul_f32 v[226:227], v[226:227], v[112:113]
    v_pk_mul_f32 v[228:229], v[228:229], v[114:115]
    v_exp_f32 v226, v226
    v_exp_f32 v227, v227
    v_exp_f32 v228, v228
    v_exp_f32 v229, v229
    v_pk_fma_f32 v[226:227], v[226:227], v[176:177], v[176:177] op_sel:[0,1,1] op_sel_hi:[1,1,1]
    v_pk_fma_f32 v[228:229], v[228:229], v[176:177], v[176:177] op_sel:[0,1,1] op_sel_hi:[1,1,1]
    v_rcp_f32 v226, v226
    v_rcp_f32 v227, v227
    v_rcp_f32 v228, v228
    v_rcp_f32 v229, v229
    v_pk_mul_f32 v[112:113], v[112:113], v[226:227]
    v_pk_mul_f32 v[114:115], v[114:115], v[228:229]
    v_pk_fma_f32 v[116:117], v[176:177], v[144:145], v[116:117] op_sel_hi:[0,1,1] neg_lo:[1,0,0] neg_hi:[1,0,0]
    v_pk_fma_f32 v[118:119], v[176:177], v[146:147], v[118:119] op_sel_hi:[0,1,1] neg_lo:[1,0,0] neg_hi:[1,0,0]
    v_pk_mul_f32 v[226:227], v[116:117], v[116:117]
    v_pk_mul_f32 v[228:229], v[118:119], v[118:119]
    v_pk_fma_f32 v[226:227], v[226:227], v[178:179], v[178:179] op_sel:[0,1,0] op_sel_hi:[1,1,0]
    v_pk_fma_f32 v[228:229], v[228:229], v[178:179], v[178:179] op_sel:[0,1,0] op_sel_hi:[1,1,0]
    v_pk_mul_f32 v[226:227], v[226:227], v[116:117]
    v_pk_mul_f32 v[228:229], v[228:229], v[118:119]
    v_exp_f32 v226, v226
    v_exp_f32 v227, v227
    v_exp_f32 v228, v228
    v_exp_f32 v229, v229
    v_pk_fma_f32 v[226:227], v[226:227], v[176:177], v[176:177] op_sel:[0,1,1] op_sel_hi:[1,1,1]
    v_pk_fma_f32 v[228:229], v[228:229], v[176:177], v[176:177] op_sel:[0,1,1] op_sel_hi:[1,1,1]
    v_rcp_f32 v226, v226
    v_rcp_f32 v227, v227
    v_rcp_f32 v228, v228
    v_rcp_f32 v229, v229
    v_pk_mul_f32 v[116:117], v[116:117], v[226:227]
    v_pk_mul_f32 v[118:119], v[118:119], v[228:229]
    v_cvt_pk_bf16_f32 v112, v112, v113
    v_cvt_pk_bf16_f32 v113, v114, v115
    v_cvt_pk_bf16_f32 v114, v116, v117
    v_cvt_pk_bf16_f32 v115, v118, v119
    ds_write_b128 v244, v[112:115] offset:6144
    s_add_u32 s36, s45, 688128
    buffer_store_dwordx4 v[112:115], v2, s[16:19], s36 offen sc1
    v_pk_fma_f32 v[36:37], v[164:165], v[148:149], v[36:37] op_sel_hi:[0,1,1] neg_lo:[1,0,0] neg_hi:[1,0,0]
    v_pk_fma_f32 v[38:39], v[164:165], v[150:151], v[38:39] op_sel_hi:[0,1,1] neg_lo:[1,0,0] neg_hi:[1,0,0]
    v_pk_mul_f32 v[226:227], v[36:37], v[36:37]
    v_pk_mul_f32 v[228:229], v[38:39], v[38:39]
    v_pk_fma_f32 v[226:227], v[226:227], v[166:167], v[166:167] op_sel:[0,1,0] op_sel_hi:[1,1,0]
    v_pk_fma_f32 v[228:229], v[228:229], v[166:167], v[166:167] op_sel:[0,1,0] op_sel_hi:[1,1,0]
    v_pk_mul_f32 v[226:227], v[226:227], v[36:37]
    v_pk_mul_f32 v[228:229], v[228:229], v[38:39]
    v_exp_f32 v226, v226
    v_exp_f32 v227, v227
    v_exp_f32 v228, v228
    v_exp_f32 v229, v229
    v_pk_fma_f32 v[226:227], v[226:227], v[164:165], v[164:165] op_sel:[0,1,1] op_sel_hi:[1,1,1]
    v_pk_fma_f32 v[228:229], v[228:229], v[164:165], v[164:165] op_sel:[0,1,1] op_sel_hi:[1,1,1]
    v_rcp_f32 v226, v226
    v_rcp_f32 v227, v227
    v_rcp_f32 v228, v228
    v_rcp_f32 v229, v229
    v_pk_mul_f32 v[36:37], v[36:37], v[226:227]
    v_pk_mul_f32 v[38:39], v[38:39], v[228:229]
    v_pk_fma_f32 v[40:41], v[164:165], v[152:153], v[40:41] op_sel_hi:[0,1,1] neg_lo:[1,0,0] neg_hi:[1,0,0]
    v_pk_fma_f32 v[42:43], v[164:165], v[154:155], v[42:43] op_sel_hi:[0,1,1] neg_lo:[1,0,0] neg_hi:[1,0,0]
    v_pk_mul_f32 v[226:227], v[40:41], v[40:41]
    v_pk_mul_f32 v[228:229], v[42:43], v[42:43]
    v_pk_fma_f32 v[226:227], v[226:227], v[166:167], v[166:167] op_sel:[0,1,0] op_sel_hi:[1,1,0]
    v_pk_fma_f32 v[228:229], v[228:229], v[166:167], v[166:167] op_sel:[0,1,0] op_sel_hi:[1,1,0]
    v_pk_mul_f32 v[226:227], v[226:227], v[40:41]
    v_pk_mul_f32 v[228:229], v[228:229], v[42:43]
    v_exp_f32 v226, v226
    v_exp_f32 v227, v227
    v_exp_f32 v228, v228
    v_exp_f32 v229, v229
    v_pk_fma_f32 v[226:227], v[226:227], v[164:165], v[164:165] op_sel:[0,1,1] op_sel_hi:[1,1,1]
    v_pk_fma_f32 v[228:229], v[228:229], v[164:165], v[164:165] op_sel:[0,1,1] op_sel_hi:[1,1,1]
    v_rcp_f32 v226, v226
    v_rcp_f32 v227, v227
    v_rcp_f32 v228, v228
    v_rcp_f32 v229, v229
    v_pk_mul_f32 v[40:41], v[40:41], v[226:227]
    v_pk_mul_f32 v[42:43], v[42:43], v[228:229]
    v_cvt_pk_bf16_f32 v36, v36, v37
    v_cvt_pk_bf16_f32 v37, v38, v39
    v_cvt_pk_bf16_f32 v38, v40, v41
    v_cvt_pk_bf16_f32 v39, v42, v43
    v_or_b32 v36, 1, v36
    ds_write_b128 v244, v[36:39] offset:16384
    v_pk_fma_f32 v[64:65], v[168:169], v[148:149], v[64:65] op_sel_hi:[0,1,1] neg_lo:[1,0,0] neg_hi:[1,0,0]
    v_pk_fma_f32 v[66:67], v[168:169], v[150:151], v[66:67] op_sel_hi:[0,1,1] neg_lo:[1,0,0] neg_hi:[1,0,0]
    v_pk_mul_f32 v[226:227], v[64:65], v[64:65]
    v_pk_mul_f32 v[228:229], v[66:67], v[66:67]
    v_pk_fma_f32 v[226:227], v[226:227], v[170:171], v[170:171] op_sel:[0,1,0] op_sel_hi:[1,1,0]
    v_pk_fma_f32 v[228:229], v[228:229], v[170:171], v[170:171] op_sel:[0,1,0] op_sel_hi:[1,1,0]
    v_pk_mul_f32 v[226:227], v[226:227], v[64:65]
    v_pk_mul_f32 v[228:229], v[228:229], v[66:67]
    v_exp_f32 v226, v226
    v_exp_f32 v227, v227
    v_exp_f32 v228, v228
    v_exp_f32 v229, v229
    v_pk_fma_f32 v[226:227], v[226:227], v[168:169], v[168:169] op_sel:[0,1,1] op_sel_hi:[1,1,1]
    v_pk_fma_f32 v[228:229], v[228:229], v[168:169], v[168:169] op_sel:[0,1,1] op_sel_hi:[1,1,1]
    v_rcp_f32 v226, v226
    v_rcp_f32 v227, v227
    v_rcp_f32 v228, v228
    v_rcp_f32 v229, v229
    v_pk_mul_f32 v[64:65], v[64:65], v[226:227]
    v_pk_mul_f32 v[66:67], v[66:67], v[228:229]
    v_pk_fma_f32 v[68:69], v[168:169], v[152:153], v[68:69] op_sel_hi:[0,1,1] neg_lo:[1,0,0] neg_hi:[1,0,0]
    v_pk_fma_f32 v[70:71], v[168:169], v[154:155], v[70:71] op_sel_hi:[0,1,1] neg_lo:[1,0,0] neg_hi:[1,0,0]
    v_pk_mul_f32 v[226:227], v[68:69], v[68:69]
    v_pk_mul_f32 v[228:229], v[70:71], v[70:71]
    v_pk_fma_f32 v[226:227], v[226:227], v[170:171], v[170:171] op_sel:[0,1,0] op_sel_hi:[1,1,0]
    v_pk_fma_f32 v[228:229], v[228:229], v[170:171], v[170:171] op_sel:[0,1,0] op_sel_hi:[1,1,0]
    v_pk_mul_f32 v[226:227], v[226:227], v[68:69]
    v_pk_mul_f32 v[228:229], v[228:229], v[70:71]
    v_exp_f32 v226, v226
    v_exp_f32 v227, v227
    v_exp_f32 v228, v228
    v_exp_f32 v229, v229
    v_pk_fma_f32 v[226:227], v[226:227], v[168:169], v[168:169] op_sel:[0,1,1] op_sel_hi:[1,1,1]
    v_pk_fma_f32 v[228:229], v[228:229], v[168:169], v[168:169] op_sel:[0,1,1] op_sel_hi:[1,1,1]
    v_rcp_f32 v226, v226
    v_rcp_f32 v227, v227
    v_rcp_f32 v228, v228
    v_rcp_f32 v229, v229
    v_pk_mul_f32 v[68:69], v[68:69], v[226:227]
    v_pk_mul_f32 v[70:71], v[70:71], v[228:229]
    v_cvt_pk_bf16_f32 v64, v64, v65
    v_cvt_pk_bf16_f32 v65, v66, v67
    v_cvt_pk_bf16_f32 v66, v68, v69
    v_cvt_pk_bf16_f32 v67, v70, v71
    v_or_b32 v64, 1, v64
    ds_write_b128 v244, v[64:67] offset:18432
    s_waitcnt vmcnt(0)
    s_mov_b64 exec, 1
    ds_add_u32 v246, v245
    s_mov_b64 exec, -1
    v_pk_fma_f32 v[92:93], v[172:173], v[148:149], v[92:93] op_sel_hi:[0,1,1] neg_lo:[1,0,0] neg_hi:[1,0,0]
    v_pk_fma_f32 v[94:95], v[172:173], v[150:151], v[94:95] op_sel_hi:[0,1,1] neg_lo:[1,0,0] neg_hi:[1,0,0]
    v_pk_mul_f32 v[226:227], v[92:93], v[92:93]
    v_pk_mul_f32 v[228:229], v[94:95], v[94:95]
    v_pk_fma_f32 v[226:227], v[226:227], v[174:175], v[174:175] op_sel:[0,1,0] op_sel_hi:[1,1,0]
    v_pk_fma_f32 v[228:229], v[228:229], v[174:175], v[174:175] op_sel:[0,1,0] op_sel_hi:[1,1,0]
    v_pk_mul_f32 v[226:227], v[226:227], v[92:93]
    v_pk_mul_f32 v[228:229], v[228:229], v[94:95]
    v_exp_f32 v226, v226
    v_exp_f32 v227, v227
    v_exp_f32 v228, v228
    v_exp_f32 v229, v229
    v_pk_fma_f32 v[226:227], v[226:227], v[172:173], v[172:173] op_sel:[0,1,1] op_sel_hi:[1,1,1]
    v_pk_fma_f32 v[228:229], v[228:229], v[172:173], v[172:173] op_sel:[0,1,1] op_sel_hi:[1,1,1]
    v_rcp_f32 v226, v226
    v_rcp_f32 v227, v227
    v_rcp_f32 v228, v228
    v_rcp_f32 v229, v229
    v_pk_mul_f32 v[92:93], v[92:93], v[226:227]
    v_pk_mul_f32 v[94:95], v[94:95], v[228:229]
    v_pk_fma_f32 v[96:97], v[172:173], v[152:153], v[96:97] op_sel_hi:[0,1,1] neg_lo:[1,0,0] neg_hi:[1,0,0]
    v_pk_fma_f32 v[98:99], v[172:173], v[154:155], v[98:99] op_sel_hi:[0,1,1] neg_lo:[1,0,0] neg_hi:[1,0,0]
    v_pk_mul_f32 v[226:227], v[96:97], v[96:97]
    v_pk_mul_f32 v[228:229], v[98:99], v[98:99]
    v_pk_fma_f32 v[226:227], v[226:227], v[174:175], v[174:175] op_sel:[0,1,0] op_sel_hi:[1,1,0]
    v_pk_fma_f32 v[228:229], v[228:229], v[174:175], v[174:175] op_sel:[0,1,0] op_sel_hi:[1,1,0]
    v_pk_mul_f32 v[226:227], v[226:227], v[96:97]
    v_pk_mul_f32 v[228:229], v[228:229], v[98:99]
    v_exp_f32 v226, v226
    v_exp_f32 v227, v227
    v_exp_f32 v228, v228
    v_exp_f32 v229, v229
    v_pk_fma_f32 v[226:227], v[226:227], v[172:173], v[172:173] op_sel:[0,1,1] op_sel_hi:[1,1,1]
    v_pk_fma_f32 v[228:229], v[228:229], v[172:173], v[172:173] op_sel:[0,1,1] op_sel_hi:[1,1,1]
    v_rcp_f32 v226, v226
    v_rcp_f32 v227, v227
    v_rcp_f32 v228, v228
    v_rcp_f32 v229, v229
    v_pk_mul_f32 v[96:97], v[96:97], v[226:227]
    v_pk_mul_f32 v[98:99], v[98:99], v[228:229]
    v_cvt_pk_bf16_f32 v92, v92, v93
    v_cvt_pk_bf16_f32 v93, v94, v95
    v_cvt_pk_bf16_f32 v94, v96, v97
    v_cvt_pk_bf16_f32 v95, v98, v99
    v_or_b32 v92, 1, v92
    ds_write_b128 v244, v[92:95] offset:20480
    s_cmp_eq_u32 s60, 1
    s_cbranch_scc1 G4_p11
    buffer_load_dwordx4 v[180:183], v196, s[84:87], 0 offen offset:0 sc1
    buffer_load_dwordx4 v[188:191], v196, s[88:91], 0 offen offset:0 sc1
    buffer_load_dwordx4 v[184:187], v196, s[84:87], 0 offen offset:2048 sc1
    buffer_load_dwordx4 v[192:195], v196, s[88:91], 0 offen offset:2048 sc1
    s_mov_b32 s78, 0
    buffer_load_dwordx2 v[230:231], v197, s[80:83], s78 offen sc1
    s_mov_b32 s78, 65536
    buffer_load_dwordx2 v[232:233], v197, s[80:83], s78 offen sc1
    s_mov_b32 s78, 262144
    buffer_load_dwordx2 v[234:235], v197, s[80:83], s78 offen sc1
    s_mov_b32 s78, 327680
    buffer_load_dwordx2 v[236:237], v197, s[80:83], s78 offen sc1
    s_branch G4_p21
G4_p11:
    s_add_u32 s36, s40, 0
    buffer_load_dwordx4 v[180:183], v2, s[84:87], s36 offen offset:0 sc1
    buffer_load_dwordx4 v[184:187], v2, s[88:91], s36 offen offset:0 sc1
    buffer_load_dwordx4 v[188:191], v2, s[84:87], s36 offen offset:1024 sc1
    buffer_load_dwordx4 v[192:195], v2, s[88:91], s36 offen offset:1024 sc1
    s_add_u32 s36, s40, 65536
    buffer_load_dwordx4 v[196:199], v2, s[84:87], s36 offen offset:0 sc1
    buffer_load_dwordx4 v[230:233], v2, s[88:91], s36 offen offset:0 sc1
    buffer_load_dwordx4 v[234:237], v2, s[84:87], s36 offen offset:1024 sc1
    buffer_load_dwordx4 v[248:251], v2, s[88:91], s36 offen offset:1024 sc1
G4_p21:
    v_pk_fma_f32 v[120:121], v[176:177], v[148:149], v[120:121] op_sel_hi:[0,1,1] neg_lo:[1,0,0] neg_hi:[1,0,0]
    v_pk_fma_f32 v[122:123], v[176:177], v[150:151], v[122:123] op_sel_hi:[0,1,1] neg_lo:[1,0,0] neg_hi:[1,0,0]
    v_pk_mul_f32 v[226:227], v[120:121], v[120:121]
    v_pk_mul_f32 v[228:229], v[122:123], v[122:123]
    v_pk_fma_f32 v[226:227], v[226:227], v[178:179], v[178:179] op_sel:[0,1,0] op_sel_hi:[1,1,0]
    v_pk_fma_f32 v[228:229], v[228:229], v[178:179], v[178:179] op_sel:[0,1,0] op_sel_hi:[1,1,0]
    v_pk_mul_f32 v[226:227], v[226:227], v[120:121]
    v_pk_mul_f32 v[228:229], v[228:229], v[122:123]
    v_exp_f32 v226, v226
    v_exp_f32 v227, v227
    v_exp_f32 v228, v228
    v_exp_f32 v229, v229
    v_pk_fma_f32 v[226:227], v[226:227], v[176:177], v[176:177] op_sel:[0,1,1] op_sel_hi:[1,1,1]
    v_pk_fma_f32 v[228:229], v[228:229], v[176:177], v[176:177] op_sel:[0,1,1] op_sel_hi:[1,1,1]
    v_rcp_f32 v226, v226
    v_rcp_f32 v227, v227
    v_rcp_f32 v228, v228
    v_rcp_f32 v229, v229
    v_pk_mul_f32 v[120:121], v[120:121], v[226:227]
    v_pk_mul_f32 v[122:123], v[122:123], v[228:229]
    v_pk_fma_f32 v[124:125], v[176:177], v[152:153], v[124:125] op_sel_hi:[0,1,1] neg_lo:[1,0,0] neg_hi:[1,0,0]
    v_pk_fma_f32 v[126:127], v[176:177], v[154:155], v[126:127] op_sel_hi:[0,1,1] neg_lo:[1,0,0] neg_hi:[1,0,0]
    v_pk_mul_f32 v[226:227], v[124:125], v[124:125]
    v_pk_mul_f32 v[228:229], v[126:127], v[126:127]
    v_pk_fma_f32 v[226:227], v[226:227], v[178:179], v[178:179] op_sel:[0,1,0] op_sel_hi:[1,1,0]
    v_pk_fma_f32 v[228:229], v[228:229], v[178:179], v[178:179] op_sel:[0,1,0] op_sel_hi:[1,1,0]
    v_pk_mul_f32 v[226:227], v[226:227], v[124:125]
    v_pk_mul_f32 v[228:229], v[228:229], v[126:127]
    v_exp_f32 v226, v226
    v_exp_f32 v227, v227
    v_exp_f32 v228, v228
    v_exp_f32 v229, v229
    v_pk_fma_f32 v[226:227], v[226:227], v[176:177], v[176:177] op_sel:[0,1,1] op_sel_hi:[1,1,1]
    v_pk_fma_f32 v[228:229], v[228:229], v[176:177], v[176:177] op_sel:[0,1,1] op_sel_hi:[1,1,1]
    v_rcp_f32 v226, v226
    v_rcp_f32 v227, v227
    v_rcp_f32 v228, v228
    v_rcp_f32 v229, v229
    v_pk_mul_f32 v[124:125], v[124:125], v[226:227]
    v_pk_mul_f32 v[126:127], v[126:127], v[228:229]
    v_cvt_pk_bf16_f32 v120, v120, v121
    v_cvt_pk_bf16_f32 v121, v122, v123
    v_cvt_pk_bf16_f32 v122, v124, v125
    v_cvt_pk_bf16_f32 v123, v126, v127
    ds_write_b128 v244, v[120:123] offset:22528
    v_pk_fma_f32 v[44:45], v[164:165], v[156:157], v[44:45] op_sel_hi:[0,1,1] neg_lo:[1,0,0] neg_hi:[1,0,0]
    v_pk_fma_f32 v[46:47], v[164:165], v[158:159], v[46:47] op_sel_hi:[0,1,1] neg_lo:[1,0,0] neg_hi:[1,0,0]
    v_pk_mul_f32 v[226:227], v[44:45], v[44:45]
    v_pk_mul_f32 v[228:229], v[46:47], v[46:47]
    v_pk_fma_f32 v[226:227], v[226:227], v[166:167], v[166:167] op_sel:[0,1,0] op_sel_hi:[1,1,0]
    v_pk_fma_f32 v[228:229], v[228:229], v[166:167], v[166:167] op_sel:[0,1,0] op_sel_hi:[1,1,0]
    v_pk_mul_f32 v[226:227], v[226:227], v[44:45]
    v_pk_mul_f32 v[228:229], v[228:229], v[46:47]
    v_exp_f32 v226, v226
    v_exp_f32 v227, v227
    v_exp_f32 v228, v228
    v_exp_f32 v229, v229
    v_pk_fma_f32 v[226:227], v[226:227], v[164:165], v[164:165] op_sel:[0,1,1] op_sel_hi:[1,1,1]
    v_pk_fma_f32 v[228:229], v[228:229], v[164:165], v[164:165] op_sel:[0,1,1] op_sel_hi:[1,1,1]
    v_rcp_f32 v226, v226
    v_rcp_f32 v227, v227
    v_rcp_f32 v228, v228
    v_rcp_f32 v229, v229
    v_pk_mul_f32 v[44:45], v[44:45], v[226:227]
    v_pk_mul_f32 v[46:47], v[46:47], v[228:229]
    v_pk_fma_f32 v[48:49], v[164:165], v[160:161], v[48:49] op_sel_hi:[0,1,1] neg_lo:[1,0,0] neg_hi:[1,0,0]
    v_pk_fma_f32 v[50:51], v[164:165], v[162:163], v[50:51] op_sel_hi:[0,1,1] neg_lo:[1,0,0] neg_hi:[1,0,0]
    v_pk_mul_f32 v[226:227], v[48:49], v[48:49]
    v_pk_mul_f32 v[228:229], v[50:51], v[50:51]
    v_pk_fma_f32 v[226:227], v[226:227], v[166:167], v[166:167] op_sel:[0,1,0] op_sel_hi:[1,1,0]
    v_pk_fma_f32 v[228:229], v[228:229], v[166:167], v[166:167] op_sel:[0,1,0] op_sel_hi:[1,1,0]
    v_pk_mul_f32 v[226:227], v[226:227], v[48:49]
    v_pk_mul_f32 v[228:229], v[228:229], v[50:51]
    v_exp_f32 v226, v226
    v_exp_f32 v227, v227
    v_exp_f32 v228, v228
    v_exp_f32 v229, v229
    v_pk_fma_f32 v[226:227], v[226:227], v[164:165], v[164:165] op_sel:[0,1,1] op_sel_hi:[1,1,1]
    v_pk_fma_f32 v[228:229], v[228:229], v[164:165], v[164:165] op_sel:[0,1,1] op_sel_hi:[1,1,1]
    v_rcp_f32 v226, v226
    v_rcp_f32 v227, v227
    v_rcp_f32 v228, v228
    v_rcp_f32 v229, v229
    v_pk_mul_f32 v[48:49], v[48:49], v[226:227]
    v_pk_mul_f32 v[50:51], v[50:51], v[228:229]
    v_cvt_pk_bf16_f32 v200, v44, v45
    v_cvt_pk_bf16_f32 v201, v46, v47
    v_cvt_pk_bf16_f32 v202, v48, v49
    v_cvt_pk_bf16_f32 v203, v50, v51
    v_or_b32 v200, 1, v200
    ds_write_b128 v244, v[200:203] offset:32768
    v_pk_fma_f32 v[72:73], v[168:169], v[156:157], v[72:73] op_sel_hi:[0,1,1] neg_lo:[1,0,0] neg_hi:[1,0,0]
    v_pk_fma_f32 v[74:75], v[168:169], v[158:159], v[74:75] op_sel_hi:[0,1,1] neg_lo:[1,0,0] neg_hi:[1,0,0]
    v_pk_mul_f32 v[226:227], v[72:73], v[72:73]
    v_pk_mul_f32 v[228:229], v[74:75], v[74:75]
    v_pk_fma_f32 v[226:227], v[226:227], v[170:171], v[170:171] op_sel:[0,1,0] op_sel_hi:[1,1,0]
    v_pk_fma_f32 v[228:229], v[228:229], v[170:171], v[170:171] op_sel:[0,1,0] op_sel_hi:[1,1,0]
    v_pk_mul_f32 v[226:227], v[226:227], v[72:73]
    v_pk_mul_f32 v[228:229], v[228:229], v[74:75]
    v_exp_f32 v226, v226
    v_exp_f32 v227, v227
    v_exp_f32 v228, v228
    v_exp_f32 v229, v229
    v_pk_fma_f32 v[226:227], v[226:227], v[168:169], v[168:169] op_sel:[0,1,1] op_sel_hi:[1,1,1]
    v_pk_fma_f32 v[228:229], v[228:229], v[168:169], v[168:169] op_sel:[0,1,1] op_sel_hi:[1,1,1]
    v_rcp_f32 v226, v226
    v_rcp_f32 v227, v227
    v_rcp_f32 v228, v228
    v_rcp_f32 v229, v229
    v_pk_mul_f32 v[72:73], v[72:73], v[226:227]
    v_pk_mul_f32 v[74:75], v[74:75], v[228:229]
    v_pk_fma_f32 v[76:77], v[168:169], v[160:161], v[76:77] op_sel_hi:[0,1,1] neg_lo:[1,0,0] neg_hi:[1,0,0]
    v_pk_fma_f32 v[78:79], v[168:169], v[162:163], v[78:79] op_sel_hi:[0,1,1] neg_lo:[1,0,0] neg_hi:[1,0,0]
    v_pk_mul_f32 v[226:227], v[76:77], v[76:77]
    v_pk_mul_f32 v[228:229], v[78:79], v[78:79]
    v_pk_fma_f32 v[226:227], v[226:227], v[170:171], v[170:171] op_sel:[0,1,0] op_sel_hi:[1,1,0]
    v_pk_fma_f32 v[228:229], v[228:229], v[170:171], v[170:171] op_sel:[0,1,0] op_sel_hi:[1,1,0]
    v_pk_mul_f32 v[226:227], v[226:227], v[76:77]
    v_pk_mul_f32 v[228:229], v[228:229], v[78:79]
    v_exp_f32 v226, v226
    v_exp_f32 v227, v227
    v_exp_f32 v228, v228
    v_exp_f32 v229, v229
    v_pk_fma_f32 v[226:227], v[226:227], v[168:169], v[168:169] op_sel:[0,1,1] op_sel_hi:[1,1,1]
    v_pk_fma_f32 v[228:229], v[228:229], v[168:169], v[168:169] op_sel:[0,1,1] op_sel_hi:[1,1,1]
    v_rcp_f32 v226, v226
    v_rcp_f32 v227, v227
    v_rcp_f32 v228, v228
    v_rcp_f32 v229, v229
    v_pk_mul_f32 v[76:77], v[76:77], v[226:227]
    v_pk_mul_f32 v[78:79], v[78:79], v[228:229]
    v_cvt_pk_bf16_f32 v204, v72, v73
    v_cvt_pk_bf16_f32 v205, v74, v75
    v_cvt_pk_bf16_f32 v206, v76, v77
    v_cvt_pk_bf16_f32 v207, v78, v79
    v_or_b32 v204, 1, v204
    ds_write_b128 v244, v[204:207] offset:34816
    v_pk_fma_f32 v[100:101], v[172:173], v[156:157], v[100:101] op_sel_hi:[0,1,1] neg_lo:[1,0,0] neg_hi:[1,0,0]
    v_pk_fma_f32 v[102:103], v[172:173], v[158:159], v[102:103] op_sel_hi:[0,1,1] neg_lo:[1,0,0] neg_hi:[1,0,0]
    v_pk_mul_f32 v[226:227], v[100:101], v[100:101]
    v_pk_mul_f32 v[228:229], v[102:103], v[102:103]
    v_pk_fma_f32 v[226:227], v[226:227], v[174:175], v[174:175] op_sel:[0,1,0] op_sel_hi:[1,1,0]
    v_pk_fma_f32 v[228:229], v[228:229], v[174:175], v[174:175] op_sel:[0,1,0] op_sel_hi:[1,1,0]
    v_pk_mul_f32 v[226:227], v[226:227], v[100:101]
    v_pk_mul_f32 v[228:229], v[228:229], v[102:103]
    v_exp_f32 v226, v226
    v_exp_f32 v227, v227
    v_exp_f32 v228, v228
    v_exp_f32 v229, v229
    v_pk_fma_f32 v[226:227], v[226:227], v[172:173], v[172:173] op_sel:[0,1,1] op_sel_hi:[1,1,1]
    v_pk_fma_f32 v[228:229], v[228:229], v[172:173], v[172:173] op_sel:[0,1,1] op_sel_hi:[1,1,1]
    v_rcp_f32 v226, v226
    v_rcp_f32 v227, v227
    v_rcp_f32 v228, v228
    v_rcp_f32 v229, v229
    v_pk_mul_f32 v[100:101], v[100:101], v[226:227]
    v_pk_mul_f32 v[102:103], v[102:103], v[228:229]
    v_pk_fma_f32 v[104:105], v[172:173], v[160:161], v[104:105] op_sel_hi:[0,1,1] neg_lo:[1,0,0] neg_hi:[1,0,0]
    v_pk_fma_f32 v[106:107], v[172:173], v[162:163], v[106:107] op_sel_hi:[0,1,1] neg_lo:[1,0,0] neg_hi:[1,0,0]
    v_pk_mul_f32 v[226:227], v[104:105], v[104:105]
    v_pk_mul_f32 v[228:229], v[106:107], v[106:107]
    v_pk_fma_f32 v[226:227], v[226:227], v[174:175], v[174:175] op_sel:[0,1,0] op_sel_hi:[1,1,0]
    v_pk_fma_f32 v[228:229], v[228:229], v[174:175], v[174:175] op_sel:[0,1,0] op_sel_hi:[1,1,0]
    v_pk_mul_f32 v[226:227], v[226:227], v[104:105]
    v_pk_mul_f32 v[228:229], v[228:229], v[106:107]
    v_exp_f32 v226, v226
    v_exp_f32 v227, v227
    v_exp_f32 v228, v228
    v_exp_f32 v229, v229
    v_pk_fma_f32 v[226:227], v[226:227], v[172:173], v[172:173] op_sel:[0,1,1] op_sel_hi:[1,1,1]
    v_pk_fma_f32 v[228:229], v[228:229], v[172:173], v[172:173] op_sel:[0,1,1] op_sel_hi:[1,1,1]
    v_rcp_f32 v226, v226
    v_rcp_f32 v227, v227
    v_rcp_f32 v228, v228
    v_rcp_f32 v229, v229
    v_pk_mul_f32 v[104:105], v[104:105], v[226:227]
    v_pk_mul_f32 v[106:107], v[106:107], v[228:229]
    v_cvt_pk_bf16_f32 v208, v100, v101
    v_cvt_pk_bf16_f32 v209, v102, v103
    v_cvt_pk_bf16_f32 v210, v104, v105
    v_cvt_pk_bf16_f32 v211, v106, v107
    v_or_b32 v208, 1, v208
    ds_write_b128 v244, v[208:211] offset:36864
    v_pk_fma_f32 v[128:129], v[176:177], v[156:157], v[128:129] op_sel_hi:[0,1,1] neg_lo:[1,0,0] neg_hi:[1,0,0]
    v_pk_fma_f32 v[130:131], v[176:177], v[158:159], v[130:131] op_sel_hi:[0,1,1] neg_lo:[1,0,0] neg_hi:[1,0,0]
    v_pk_mul_f32 v[226:227], v[128:129], v[128:129]
    v_pk_mul_f32 v[228:229], v[130:131], v[130:131]
    v_pk_fma_f32 v[226:227], v[226:227], v[178:179], v[178:179] op_sel:[0,1,0] op_sel_hi:[1,1,0]
    v_pk_fma_f32 v[228:229], v[228:229], v[178:179], v[178:179] op_sel:[0,1,0] op_sel_hi:[1,1,0]
    v_pk_mul_f32 v[226:227], v[226:227], v[128:129]
    v_pk_mul_f32 v[228:229], v[228:229], v[130:131]
    v_exp_f32 v226, v226
    v_exp_f32 v227, v227
    v_exp_f32 v228, v228
    v_exp_f32 v229, v229
    v_pk_fma_f32 v[226:227], v[226:227], v[176:177], v[176:177] op_sel:[0,1,1] op_sel_hi:[1,1,1]
    v_pk_fma_f32 v[228:229], v[228:229], v[176:177], v[176:177] op_sel:[0,1,1] op_sel_hi:[1,1,1]
    v_rcp_f32 v226, v226
    v_rcp_f32 v227, v227
    v_rcp_f32 v228, v228
    v_rcp_f32 v229, v229
    v_pk_mul_f32 v[128:129], v[128:129], v[226:227]
    v_pk_mul_f32 v[130:131], v[130:131], v[228:229]
    v_pk_fma_f32 v[132:133], v[176:177], v[160:161], v[132:133] op_sel_hi:[0,1,1] neg_lo:[1,0,0] neg_hi:[1,0,0]
    v_pk_fma_f32 v[134:135], v[176:177], v[162:163], v[134:135] op_sel_hi:[0,1,1] neg_lo:[1,0,0] neg_hi:[1,0,0]
    v_pk_mul_f32 v[226:227], v[132:133], v[132:133]
    v_pk_mul_f32 v[228:229], v[134:135], v[134:135]
    v_pk_fma_f32 v[226:227], v[226:227], v[178:179], v[178:179] op_sel:[0,1,0] op_sel_hi:[1,1,0]
    v_pk_fma_f32 v[228:229], v[228:229], v[178:179], v[178:179] op_sel:[0,1,0] op_sel_hi:[1,1,0]
    v_pk_mul_f32 v[226:227], v[226:227], v[132:133]
    v_pk_mul_f32 v[228:229], v[228:229], v[134:135]
    v_exp_f32 v226, v226
    v_exp_f32 v227, v227
    v_exp_f32 v228, v228
    v_exp_f32 v229, v229
    v_pk_fma_f32 v[226:227], v[226:227], v[176:177], v[176:177] op_sel:[0,1,1] op_sel_hi:[1,1,1]
    v_pk_fma_f32 v[228:229], v[228:229], v[176:177], v[176:177] op_sel:[0,1,1] op_sel_hi:[1,1,1]
    v_rcp_f32 v226, v226
    v_rcp_f32 v227, v227
    v_rcp_f32 v228, v228
    v_rcp_f32 v229, v229
    v_pk_mul_f32 v[132:133], v[132:133], v[226:227]
    v_pk_mul_f32 v[134:135], v[134:135], v[228:229]
    v_cvt_pk_bf16_f32 v212, v128, v129
    v_cvt_pk_bf16_f32 v213, v130, v131
    v_cvt_pk_bf16_f32 v214, v132, v133
    v_cvt_pk_bf16_f32 v215, v134, v135
    ds_write_b128 v244, v[212:215] offset:38912
    v_pk_fma_f32 v[24:25], v[164:165], v[136:137], v[24:25] op_sel_hi:[0,1,1] neg_lo:[1,0,0] neg_hi:[1,0,0]
    v_pk_fma_f32 v[26:27], v[164:165], v[138:139], v[26:27] op_sel_hi:[0,1,1] neg_lo:[1,0,0] neg_hi:[1,0,0]
    v_pk_mul_f32 v[226:227], v[24:25], v[24:25]
    v_pk_mul_f32 v[228:229], v[26:27], v[26:27]
    v_pk_fma_f32 v[226:227], v[226:227], v[166:167], v[166:167] op_sel:[0,1,0] op_sel_hi:[1,1,0]
    v_pk_fma_f32 v[228:229], v[228:229], v[166:167], v[166:167] op_sel:[0,1,0] op_sel_hi:[1,1,0]
    v_pk_mul_f32 v[226:227], v[226:227], v[24:25]
    v_pk_mul_f32 v[228:229], v[228:229], v[26:27]
    v_exp_f32 v226, v226
    v_exp_f32 v227, v227
    v_exp_f32 v228, v228
    v_exp_f32 v229, v229
    v_pk_fma_f32 v[226:227], v[226:227], v[164:165], v[164:165] op_sel:[0,1,1] op_sel_hi:[1,1,1]
    v_pk_fma_f32 v[228:229], v[228:229], v[164:165], v[164:165] op_sel:[0,1,1] op_sel_hi:[1,1,1]
    v_rcp_f32 v226, v226
    v_rcp_f32 v227, v227
    v_rcp_f32 v228, v228
    v_rcp_f32 v229, v229
    v_pk_mul_f32 v[24:25], v[24:25], v[226:227]
    v_pk_mul_f32 v[26:27], v[26:27], v[228:229]
    v_cvt_pk_bf16_f32 v216, v24, v25
    v_cvt_pk_bf16_f32 v217, v26, v27
    v_or_b32 v216, 1, v216
    s_add_u32 s36, s46, 0
    buffer_store_dwordx4 v[36:39], v2, s[16:19], s36 offen sc1
    v_pk_fma_f32 v[52:53], v[168:169], v[136:137], v[52:53] op_sel_hi:[0,1,1] neg_lo:[1,0,0] neg_hi:[1,0,0]
    v_pk_fma_f32 v[54:55], v[168:169], v[138:139], v[54:55] op_sel_hi:[0,1,1] neg_lo:[1,0,0] neg_hi:[1,0,0]
    v_pk_mul_f32 v[226:227], v[52:53], v[52:53]
    v_pk_mul_f32 v[228:229], v[54:55], v[54:55]
    v_pk_fma_f32 v[226:227], v[226:227], v[170:171], v[170:171] op_sel:[0,1,0] op_sel_hi:[1,1,0]
    v_pk_fma_f32 v[228:229], v[228:229], v[170:171], v[170:171] op_sel:[0,1,0] op_sel_hi:[1,1,0]
    v_pk_mul_f32 v[226:227], v[226:227], v[52:53]
    v_pk_mul_f32 v[228:229], v[228:229], v[54:55]
    v_exp_f32 v226, v226
    v_exp_f32 v227, v227
    v_exp_f32 v228, v228
    v_exp_f32 v229, v229
    v_pk_fma_f32 v[226:227], v[226:227], v[168:169], v[168:169] op_sel:[0,1,1] op_sel_hi:[1,1,1]
    v_pk_fma_f32 v[228:229], v[228:229], v[168:169], v[168:169] op_sel:[0,1,1] op_sel_hi:[1,1,1]
    v_rcp_f32 v226, v226
    v_rcp_f32 v227, v227
    v_rcp_f32 v228, v228
    v_rcp_f32 v229, v229
    v_pk_mul_f32 v[52:53], v[52:53], v[226:227]
    v_pk_mul_f32 v[54:55], v[54:55], v[228:229]
    v_cvt_pk_bf16_f32 v218, v52, v53
    v_cvt_pk_bf16_f32 v219, v54, v55
    v_or_b32 v218, 1, v218
    s_add_u32 s36, s46, 229376
    buffer_store_dwordx4 v[64:67], v2, s[16:19], s36 offen sc1
    v_pk_fma_f32 v[80:81], v[172:173], v[136:137], v[80:81] op_sel_hi:[0,1,1] neg_lo:[1,0,0] neg_hi:[1,0,0]
    v_pk_fma_f32 v[82:83], v[172:173], v[138:139], v[82:83] op_sel_hi:[0,1,1] neg_lo:[1,0,0] neg_hi:[1,0,0]
    v_pk_mul_f32 v[226:227], v[80:81], v[80:81]
    v_pk_mul_f32 v[228:229], v[82:83], v[82:83]
    v_pk_fma_f32 v[226:227], v[226:227], v[174:175], v[174:175] op_sel:[0,1,0] op_sel_hi:[1,1,0]
    v_pk_fma_f32 v[228:229], v[228:229], v[174:175], v[174:175] op_sel:[0,1,0] op_sel_hi:[1,1,0]
    v_pk_mul_f32 v[226:227], v[226:227], v[80:81]
    v_pk_mul_f32 v[228:229], v[228:229], v[82:83]
    v_exp_f32 v226, v226
    v_exp_f32 v227, v227
    v_exp_f32 v228, v228
    v_exp_f32 v229, v229
    v_pk_fma_f32 v[226:227], v[226:227], v[172:173], v[172:173] op_sel:[0,1,1] op_sel_hi:[1,1,1]
    v_pk_fma_f32 v[228:229], v[228:229], v[172:173], v[172:173] op_sel:[0,1,1] op_sel_hi:[1,1,1]
    v_rcp_f32 v226, v226
    v_rcp_f32 v227, v227
    v_rcp_f32 v228, v228
    v_rcp_f32 v229, v229
    v_pk_mul_f32 v[80:81], v[80:81], v[226:227]
    v_pk_mul_f32 v[82:83], v[82:83], v[228:229]
    v_cvt_pk_bf16_f32 v220, v80, v81
    v_cvt_pk_bf16_f32 v221, v82, v83
    v_or_b32 v220, 1, v220
    s_add_u32 s36, s46, 458752
    buffer_store_dwordx4 v[92:95], v2, s[16:19], s36 offen sc1
    v_pk_fma_f32 v[108:109], v[176:177], v[136:137], v[108:109] op_sel_hi:[0,1,1] neg_lo:[1,0,0] neg_hi:[1,0,0]
    v_pk_fma_f32 v[110:111], v[176:177], v[138:139], v[110:111] op_sel_hi:[0,1,1] neg_lo:[1,0,0] neg_hi:[1,0,0]
    v_pk_mul_f32 v[226:227], v[108:109], v[108:109]
    v_pk_mul_f32 v[228:229], v[110:111], v[110:111]
    v_pk_fma_f32 v[226:227], v[226:227], v[178:179], v[178:179] op_sel:[0,1,0] op_sel_hi:[1,1,0]
    v_pk_fma_f32 v[228:229], v[228:229], v[178:179], v[178:179] op_sel:[0,1,0] op_sel_hi:[1,1,0]
    v_pk_mul_f32 v[226:227], v[226:227], v[108:109]
    v_pk_mul_f32 v[228:229], v[228:229], v[110:111]
    v_exp_f32 v226, v226
    v_exp_f32 v227, v227
    v_exp_f32 v228, v228
    v_exp_f32 v229, v229
    v_pk_fma_f32 v[226:227], v[226:227], v[176:177], v[176:177] op_sel:[0,1,1] op_sel_hi:[1,1,1]
    v_pk_fma_f32 v[228:229], v[228:229], v[176:177], v[176:177] op_sel:[0,1,1] op_sel_hi:[1,1,1]
    v_rcp_f32 v226, v226
    v_rcp_f32 v227, v227
    v_rcp_f32 v228, v228
    v_rcp_f32 v229, v229
    v_pk_mul_f32 v[108:109], v[108:109], v[226:227]
    v_pk_mul_f32 v[110:111], v[110:111], v[228:229]
    v_cvt_pk_bf16_f32 v222, v108, v109
    v_cvt_pk_bf16_f32 v223, v110, v111
    s_add_u32 s36, s46, 688128
    buffer_store_dwordx4 v[120:123], v2, s[16:19], s36 offen sc1
    s_waitcnt lgkmcnt(0)
    s_add_u32 s45, s44, 512
    s_mov_b32 s44, s47
G3_e2:
    s_waitcnt lgkmcnt(0)
    s_barrier
    ds_read_b128 v[88:91], v17 offset:0
    ds_read_b128 v[92:95], v17 offset:2048
    ds_read_b128 v[96:99], v17 offset:4096
    ds_read_b128 v[100:103], v17 offset:6144
    ds_read_b64_tr_b16 v[104:105], v18 offset:0
    ds_read_b64_tr_b16 v[106:107], v18 offset:4096
    ds_read_b64_tr_b16 v[108:109], v19 offset:0
    ds_read_b64_tr_b16 v[110:111], v19 offset:4096
    ds_read_b64_tr_b16 v[112:113], v20 offset:0
    ds_read_b64_tr_b16 v[114:115], v20 offset:4096
    ds_read_b64_tr_b16 v[116:117], v21 offset:0
    ds_read_b64_tr_b16 v[118:119], v21 offset:4096
    s_waitcnt lgkmcnt(6)
    v_mfma_f32_16x16x32_bf16 v[24:27], v[104:107], v[88:91], 0
    ds_read_b128 v[120:123], v17 offset:1024
    s_add_u32 s42, s42, 16384
    v_mfma_f32_16x16x32_bf16 v[40:43], v[104:107], v[92:95], 0
    ds_read_b128 v[124:127], v17 offset:3072
    s_cmp_eq_u32 s42, 49152
    v_mfma_f32_16x16x32_bf16 v[56:59], v[104:107], v[96:99], 0
    ds_read_b128 v[128:131], v17 offset:5120
    s_cselect_b32 s42, 0, s42
    v_mfma_f32_16x16x32_bf16 v[72:75], v[104:107], v[100:103], 0
    ds_read_b128 v[132:135], v17 offset:7168
    s_waitcnt lgkmcnt(8)
    v_mfma_f32_16x16x32_bf16 v[76:79], v[108:111], v[100:103], 0
    ds_read_b64_tr_b16 v[136:137], v18 offset:8192
    s_add_u32 s48, s48, 16384
    v_mfma_f32_16x16x32_bf16 v[60:63], v[108:111], v[96:99], 0
    ds_read_b64_tr_b16 v[138:139], v18 offset:12288
    s_cmp_eq_u32 s48, 98304
    v_mfma_f32_16x16x32_bf16 v[44:47], v[108:111], v[92:95], 0
    ds_read_b64_tr_b16 v[140:141], v19 offset:8192
    s_cselect_b32 s48, 0, s48
    v_mfma_f32_16x16x32_bf16 v[28:31], v[108:111], v[88:91], 0
    ds_read_b64_tr_b16 v[142:143], v19 offset:12288
    s_waitcnt lgkmcnt(8)
    v_mfma_f32_16x16x32_bf16 v[32:35], v[112:115], v[88:91], 0
    ds_read_b64_tr_b16 v[144:145], v20 offset:8192
    v_add_u32 v17, s42, v12
    v_mfma_f32_16x16x32_bf16 v[48:51], v[112:115], v[92:95], 0
    ds_read_b64_tr_b16 v[146:147], v20 offset:12288
    s_add_u32 s36, s44, 0
    v_mfma_f32_16x16x32_bf16 v[64:67], v[112:115], v[96:99], 0
    ds_read_b64_tr_b16 v[148:149], v21 offset:8192
    buffer_store_dwordx4 v[200:203], v2, s[16:19], s36 offen sc1
    v_mfma_f32_16x16x32_bf16 v[80:83], v[112:115], v[100:103], 0
    ds_read_b64_tr_b16 v[150:151], v21 offset:12288
    s_add_u32 s36, s45, 0
    v_mfma_f32_16x16x32_bf16 v[84:87], v[116:119], v[100:103], 0
    buffer_store_dwordx2 v[216:217], v238, s[16:19], s36 offen sc1
    v_add_u32 v18, s48, v13
    v_mfma_f32_16x16x32_bf16 v[68:71], v[116:119], v[96:99], 0
    v_add_u32 v19, s48, v14
    v_mfma_f32_16x16x32_bf16 v[52:55], v[116:119], v[92:95], 0
    v_add_u32 v20, s48, v15
    v_mfma_f32_16x16x32_bf16 v[36:39], v[116:119], v[88:91], 0
    v_add_u32 v21, s48, v16
    s_waitcnt lgkmcnt(6)
    v_mfma_f32_16x16x32_bf16 v[24:27], v[136:139], v[120:123], v[24:27]
    v_mfma_f32_16x16x32_bf16 v[40:43], v[136:139], v[124:127], v[40:43]
    v_mfma_f32_16x16x32_bf16 v[56:59], v[136:139], v[128:131], v[56:59]
    s_waitcnt lgkmcnt(0)
    s_barrier
    v_mfma_f32_16x16x32_bf16 v[72:75], v[136:139], v[132:135], v[72:75]
    ds_read_b128 v[88:91], v17 offset:0
    s_add_u32 s36, s44, 229376
    v_mfma_f32_16x16x32_bf16 v[76:79], v[140:143], v[132:135], v[76:79]
    ds_read_b128 v[92:95], v17 offset:2048
    buffer_store_dwordx4 v[204:207], v2, s[16:19], s36 offen sc1
    v_mfma_f32_16x16x32_bf16 v[60:63], v[140:143], v[128:131], v[60:63]
    ds_read_b128 v[96:99], v17 offset:4096
    s_add_u32 s36, s45, 229376
    v_mfma_f32_16x16x32_bf16 v[44:47], v[140:143], v[124:127], v[44:47]
    ds_read_b128 v[100:103], v17 offset:6144
    buffer_store_dwordx2 v[218:219], v238, s[16:19], s36 offen sc1
    v_mfma_f32_16x16x32_bf16 v[28:31], v[140:143], v[120:123], v[28:31]
    ds_read_b64_tr_b16 v[104:105], v18 offset:0
    s_add_u32 s43, s43, 1
    v_mfma_f32_16x16x32_bf16 v[32:35], v[144:147], v[120:123], v[32:35]
    ds_read_b64_tr_b16 v[106:107], v18 offset:4096
    s_cmp_lt_u32 s43, 27
    v_mfma_f32_16x16x32_bf16 v[48:51], v[144:147], v[124:127], v[48:51]
    ds_read_b64_tr_b16 v[108:109], v19 offset:0
    v_mfma_f32_16x16x32_bf16 v[64:67], v[144:147], v[128:131], v[64:67]
    ds_read_b64_tr_b16 v[110:111], v19 offset:4096
    v_mfma_f32_16x16x32_bf16 v[80:83], v[144:147], v[132:135], v[80:83]
    ds_read_b64_tr_b16 v[112:113], v20 offset:0
    v_mfma_f32_16x16x32_bf16 v[84:87], v[148:151], v[132:135], v[84:87]
    ds_read_b64_tr_b16 v[114:115], v20 offset:4096
    v_mfma_f32_16x16x32_bf16 v[68:71], v[148:151], v[128:131], v[68:71]
    ds_read_b64_tr_b16 v[116:117], v21 offset:0
    v_mfma_f32_16x16x32_bf16 v[52:55], v[148:151], v[124:127], v[52:55]
    ds_read_b64_tr_b16 v[118:119], v21 offset:4096
    v_mfma_f32_16x16x32_bf16 v[36:39], v[148:151], v[120:123], v[36:39]
    s_waitcnt lgkmcnt(6)
    v_mfma_f32_16x16x32_bf16 v[24:27], v[104:107], v[88:91], v[24:27]
    ds_read_b128 v[120:123], v17 offset:1024
    s_add_u32 s42, s42, 16384
    v_mfma_f32_16x16x32_bf16 v[40:43], v[104:107], v[92:95], v[40:43]
    ds_read_b128 v[124:127], v17 offset:3072
    s_cmp_eq_u32 s42, 49152
    v_mfma_f32_16x16x32_bf16 v[56:59], v[104:107], v[96:99], v[56:59]
    ds_read_b128 v[128:131], v17 offset:5120
    s_cselect_b32 s42, 0, s42
    v_mfma_f32_16x16x32_bf16 v[72:75], v[104:107], v[100:103], v[72:75]
    ds_read_b128 v[132:135], v17 offset:7168
    s_waitcnt lgkmcnt(8)
    v_mfma_f32_16x16x32_bf16 v[76:79], v[108:111], v[100:103], v[76:79]
    ds_read_b64_tr_b16 v[136:137], v18 offset:8192
    s_add_u32 s48, s48, 16384
    v_mfma_f32_16x16x32_bf16 v[60:63], v[108:111], v[96:99], v[60:63]
    ds_read_b64_tr_b16 v[138:139], v18 offset:12288
    s_cmp_eq_u32 s48, 98304
    v_mfma_f32_16x16x32_bf16 v[44:47], v[108:111], v[92:95], v[44:47]
    ds_read_b64_tr_b16 v[140:141], v19 offset:8192
    s_cselect_b32 s48, 0, s48
    v_mfma_f32_16x16x32_bf16 v[28:31], v[108:111], v[88:91], v[28:31]
    ds_read_b64_tr_b16 v[142:143], v19 offset:12288
    s_waitcnt lgkmcnt(8)
    v_mfma_f32_16x16x32_bf16 v[32:35], v[112:115], v[88:91], v[32:35]
    ds_read_b64_tr_b16 v[144:145], v20 offset:8192
    v_add_u32 v17, s42, v12
    v_mfma_f32_16x16x32_bf16 v[48:51], v[112:115], v[92:95], v[48:51]
    ds_read_b64_tr_b16 v[146:147], v20 offset:12288
    s_add_u32 s36, s44, 458752
    v_mfma_f32_16x16x32_bf16 v[64:67], v[112:115], v[96:99], v[64:67]
    ds_read_b64_tr_b16 v[148:149], v21 offset:8192
    buffer_store_dwordx4 v[208:211], v2, s[16:19], s36 offen sc1
    v_mfma_f32_16x16x32_bf16 v[80:83], v[112:115], v[100:103], v[80:83]
    ds_read_b64_tr_b16 v[150:151], v21 offset:12288
    s_add_u32 s36, s45, 458752
    v_mfma_f32_16x16x32_bf16 v[84:87], v[116:119], v[100:103], v[84:87]
    buffer_store_dwordx2 v[220:221], v238, s[16:19], s36 offen sc1
    v_add_u32 v18, s48, v13
    v_mfma_f32_16x16x32_bf16 v[68:71], v[116:119], v[96:99], v[68:71]
    v_add_u32 v19, s48, v14
    v_mfma_f32_16x16x32_bf16 v[52:55], v[116:119], v[92:95], v[52:55]
    v_add_u32 v20, s48, v15
    v_mfma_f32_16x16x32_bf16 v[36:39], v[116:119], v[88:91], v[36:39]
    v_add_u32 v21, s48, v16
    s_waitcnt lgkmcnt(6)
    v_mfma_f32_16x16x32_bf16 v[24:27], v[136:139], v[120:123], v[24:27]
    v_mfma_f32_16x16x32_bf16 v[40:43], v[136:139], v[124:127], v[40:43]
    s_waitcnt vmcnt(6)
    v_mfma_f32_16x16x32_bf16 v[56:59], v[136:139], v[128:131], v[56:59]
    s_waitcnt lgkmcnt(0)
    s_barrier
    v_mfma_f32_16x16x32_bf16 v[72:75], v[136:139], v[132:135], v[72:75]
    ds_read_b128 v[88:91], v17 offset:0
    s_add_u32 s36, s44, 688128
    v_mfma_f32_16x16x32_bf16 v[76:79], v[140:143], v[132:135], v[76:79]
    ds_read_b128 v[92:95], v17 offset:2048
    buffer_store_dwordx4 v[212:215], v2, s[16:19], s36 offen sc1
    v_mfma_f32_16x16x32_bf16 v[60:63], v[140:143], v[128:131], v[60:63]
    ds_read_b128 v[96:99], v17 offset:4096
    s_add_u32 s36, s45, 688128
    v_mfma_f32_16x16x32_bf16 v[44:47], v[140:143], v[124:127], v[44:47]
    ds_read_b128 v[100:103], v17 offset:6144
    buffer_store_dwordx2 v[222:223], v238, s[16:19], s36 offen sc1
    v_mfma_f32_16x16x32_bf16 v[28:31], v[140:143], v[120:123], v[28:31]
    ds_read_b64_tr_b16 v[104:105], v18 offset:0
    s_add_u32 s43, s43, 1
    v_mfma_f32_16x16x32_bf16 v[32:35], v[144:147], v[120:123], v[32:35]
    ds_read_b64_tr_b16 v[106:107], v18 offset:4096
    s_cmp_lt_u32 s43, 27
    v_mfma_f32_16x16x32_bf16 v[48:51], v[144:147], v[124:127], v[48:51]
    ds_read_b64_tr_b16 v[108:109], v19 offset:0
    v_mfma_f32_16x16x32_bf16 v[64:67], v[144:147], v[128:131], v[64:67]
    ds_read_b64_tr_b16 v[110:111], v19 offset:4096
    v_mfma_f32_16x16x32_bf16 v[80:83], v[144:147], v[132:135], v[80:83]
    ds_read_b64_tr_b16 v[112:113], v20 offset:0
    v_mfma_f32_16x16x32_bf16 v[84:87], v[148:151], v[132:135], v[84:87]
    ds_read_b64_tr_b16 v[114:115], v20 offset:4096
    v_mfma_f32_16x16x32_bf16 v[68:71], v[148:151], v[128:131], v[68:71]
    ds_read_b64_tr_b16 v[116:117], v21 offset:0
    v_mfma_f32_16x16x32_bf16 v[52:55], v[148:151], v[124:127], v[52:55]
    ds_read_b64_tr_b16 v[118:119], v21 offset:4096
    v_mfma_f32_16x16x32_bf16 v[36:39], v[148:151], v[120:123], v[36:39]
    s_waitcnt lgkmcnt(6)
mm_24:
    v_mfma_f32_16x16x32_bf16 v[24:27], v[104:107], v[88:91], v[24:27]
    ds_read_b128 v[120:123], v17 offset:1024
    s_add_u32 s42, s42, 16384
    v_mfma_f32_16x16x32_bf16 v[40:43], v[104:107], v[92:95], v[40:43]
    ds_read_b128 v[124:127], v17 offset:3072
    s_cmp_eq_u32 s42, 49152
    v_mfma_f32_16x16x32_bf16 v[56:59], v[104:107], v[96:99], v[56:59]
    ds_read_b128 v[128:131], v17 offset:5120
    s_cselect_b32 s42, 0, s42
    v_mfma_f32_16x16x32_bf16 v[72:75], v[104:107], v[100:103], v[72:75]
    ds_read_b128 v[132:135], v17 offset:7168
    s_waitcnt lgkmcnt(8)
    v_mfma_f32_16x16x32_bf16 v[76:79], v[108:111], v[100:103], v[76:79]
    ds_read_b64_tr_b16 v[136:137], v18 offset:8192
    s_add_u32 s48, s48, 16384
    v_mfma_f32_16x16x32_bf16 v[60:63], v[108:111], v[96:99], v[60:63]
    ds_read_b64_tr_b16 v[138:139], v18 offset:12288
    s_cmp_eq_u32 s48, 98304
    v_mfma_f32_16x16x32_bf16 v[44:47], v[108:111], v[92:95], v[44:47]
    ds_read_b64_tr_b16 v[140:141], v19 offset:8192
    s_cselect_b32 s48, 0, s48
    v_mfma_f32_16x16x32_bf16 v[28:31], v[108:111], v[88:91], v[28:31]
    ds_read_b64_tr_b16 v[142:143], v19 offset:12288
    s_waitcnt lgkmcnt(8)
    v_mfma_f32_16x16x32_bf16 v[32:35], v[112:115], v[88:91], v[32:35]
    ds_read_b64_tr_b16 v[144:145], v20 offset:8192
    v_add_u32 v17, s42, v12
    v_mfma_f32_16x16x32_bf16 v[48:51], v[112:115], v[92:95], v[48:51]
    ds_read_b64_tr_b16 v[146:147], v20 offset:12288
    v_add_u32 v18, s48, v13
    v_mfma_f32_16x16x32_bf16 v[64:67], v[112:115], v[96:99], v[64:67]
    ds_read_b64_tr_b16 v[148:149], v21 offset:8192
    v_add_u32 v19, s48, v14
    v_mfma_f32_16x16x32_bf16 v[80:83], v[112:115], v[100:103], v[80:83]
    ds_read_b64_tr_b16 v[150:151], v21 offset:12288
    v_add_u32 v20, s48, v15
    v_mfma_f32_16x16x32_bf16 v[84:87], v[116:119], v[100:103], v[84:87]
    v_add_u32 v21, s48, v16
    v_mfma_f32_16x16x32_bf16 v[68:71], v[116:119], v[96:99], v[68:71]
    v_mfma_f32_16x16x32_bf16 v[52:55], v[116:119], v[92:95], v[52:55]
    v_mfma_f32_16x16x32_bf16 v[36:39], v[116:119], v[88:91], v[36:39]
    s_waitcnt lgkmcnt(6)
    v_mfma_f32_16x16x32_bf16 v[24:27], v[136:139], v[120:123], v[24:27]
    s_add_u32 s43, s43, 1
    s_cmp_lt_u32 s43, 4
    v_mfma_f32_16x16x32_bf16 v[40:43], v[136:139], v[124:127], v[40:43]
    v_mfma_f32_16x16x32_bf16 v[56:59], v[136:139], v[128:131], v[56:59]
    s_waitcnt lgkmcnt(0)
    s_barrier
    v_mfma_f32_16x16x32_bf16 v[72:75], v[136:139], v[132:135], v[72:75]
    ds_read_b128 v[88:91], v17 offset:0
    v_mfma_f32_16x16x32_bf16 v[76:79], v[140:143], v[132:135], v[76:79]
    ds_read_b128 v[92:95], v17 offset:2048
    v_mfma_f32_16x16x32_bf16 v[60:63], v[140:143], v[128:131], v[60:63]
    ds_read_b128 v[96:99], v17 offset:4096
    v_mfma_f32_16x16x32_bf16 v[44:47], v[140:143], v[124:127], v[44:47]
    ds_read_b128 v[100:103], v17 offset:6144
    v_mfma_f32_16x16x32_bf16 v[28:31], v[140:143], v[120:123], v[28:31]
    ds_read_b64_tr_b16 v[104:105], v18 offset:0
    v_mfma_f32_16x16x32_bf16 v[32:35], v[144:147], v[120:123], v[32:35]
    ds_read_b64_tr_b16 v[106:107], v18 offset:4096
    v_mfma_f32_16x16x32_bf16 v[48:51], v[144:147], v[124:127], v[48:51]
    ds_read_b64_tr_b16 v[108:109], v19 offset:0
    v_mfma_f32_16x16x32_bf16 v[64:67], v[144:147], v[128:131], v[64:67]
    ds_read_b64_tr_b16 v[110:111], v19 offset:4096
    v_mfma_f32_16x16x32_bf16 v[80:83], v[144:147], v[132:135], v[80:83]
    ds_read_b64_tr_b16 v[112:113], v20 offset:0
    v_mfma_f32_16x16x32_bf16 v[84:87], v[148:151], v[132:135], v[84:87]
    ds_read_b64_tr_b16 v[114:115], v20 offset:4096
    v_mfma_f32_16x16x32_bf16 v[68:71], v[148:151], v[128:131], v[68:71]
    ds_read_b64_tr_b16 v[116:117], v21 offset:0
    v_mfma_f32_16x16x32_bf16 v[52:55], v[148:151], v[124:127], v[52:55]
    ds_read_b64_tr_b16 v[118:119], v21 offset:4096
    v_mfma_f32_16x16x32_bf16 v[36:39], v[148:151], v[120:123], v[36:39]
    s_waitcnt lgkmcnt(6)
    s_cbranch_scc1 mm_24
mm_25:
    v_mfma_f32_16x16x32_bf16 v[24:27], v[104:107], v[88:91], v[24:27]
    ds_read_b128 v[120:123], v17 offset:1024
    s_add_u32 s42, s42, 16384
    v_mfma_f32_16x16x32_bf16 v[40:43], v[104:107], v[92:95], v[40:43]
    ds_read_b128 v[124:127], v17 offset:3072
    s_cmp_eq_u32 s42, 49152
    v_mfma_f32_16x16x32_bf16 v[56:59], v[104:107], v[96:99], v[56:59]
    ds_read_b128 v[128:131], v17 offset:5120
    s_cselect_b32 s42, 0, s42
    v_mfma_f32_16x16x32_bf16 v[72:75], v[104:107], v[100:103], v[72:75]
    ds_read_b128 v[132:135], v17 offset:7168
    s_waitcnt lgkmcnt(8)
    v_mfma_f32_16x16x32_bf16 v[76:79], v[108:111], v[100:103], v[76:79]
    ds_read_b64_tr_b16 v[136:137], v18 offset:8192
    s_add_u32 s48, s48, 16384
    v_mfma_f32_16x16x32_bf16 v[60:63], v[108:111], v[96:99], v[60:63]
    ds_read_b64_tr_b16 v[138:139], v18 offset:12288
    s_cmp_eq_u32 s48, 98304
    v_mfma_f32_16x16x32_bf16 v[44:47], v[108:111], v[92:95], v[44:47]
    ds_read_b64_tr_b16 v[140:141], v19 offset:8192
    s_cselect_b32 s48, 0, s48
    v_mfma_f32_16x16x32_bf16 v[28:31], v[108:111], v[88:91], v[28:31]
    ds_read_b64_tr_b16 v[142:143], v19 offset:12288
    s_waitcnt lgkmcnt(8)
    v_mfma_f32_16x16x32_bf16 v[32:35], v[112:115], v[88:91], v[32:35]
    ds_read_b64_tr_b16 v[144:145], v20 offset:8192
    v_add_u32 v17, s42, v12
    v_mfma_f32_16x16x32_bf16 v[48:51], v[112:115], v[92:95], v[48:51]
    ds_read_b64_tr_b16 v[146:147], v20 offset:12288
    v_add_u32 v18, s48, v13
    v_mfma_f32_16x16x32_bf16 v[64:67], v[112:115], v[96:99], v[64:67]
    ds_read_b64_tr_b16 v[148:149], v21 offset:8192
    v_add_u32 v19, s48, v14
    v_mfma_f32_16x16x32_bf16 v[80:83], v[112:115], v[100:103], v[80:83]
    ds_read_b64_tr_b16 v[150:151], v21 offset:12288
    v_add_u32 v20, s48, v15
    v_mfma_f32_16x16x32_bf16 v[84:87], v[116:119], v[100:103], v[84:87]
    v_add_u32 v21, s48, v16
    v_mfma_f32_16x16x32_bf16 v[68:71], v[116:119], v[96:99], v[68:71]
    v_mfma_f32_16x16x32_bf16 v[52:55], v[116:119], v[92:95], v[52:55]
    v_mfma_f32_16x16x32_bf16 v[36:39], v[116:119], v[88:91], v[36:39]
    s_waitcnt lgkmcnt(6)
    v_mfma_f32_16x16x32_bf16 v[24:27], v[136:139], v[120:123], v[24:27]
    s_add_u32 s43, s43, 1
    s_cmp_lt_u32 s43, 27
    v_mfma_f32_16x16x32_bf16 v[40:43], v[136:139], v[124:127], v[40:43]
    s_waitcnt vmcnt(0)
    v_mfma_f32_16x16x32_bf16 v[56:59], v[136:139], v[128:131], v[56:59]
    s_waitcnt lgkmcnt(0)
    s_barrier
    v_mfma_f32_16x16x32_bf16 v[72:75], v[136:139], v[132:135], v[72:75]
    ds_read_b128 v[88:91], v17 offset:0
    v_mfma_f32_16x16x32_bf16 v[76:79], v[140:143], v[132:135], v[76:79]
    ds_read_b128 v[92:95], v17 offset:2048
    v_mfma_f32_16x16x32_bf16 v[60:63], v[140:143], v[128:131], v[60:63]
    ds_read_b128 v[96:99], v17 offset:4096
    v_mfma_f32_16x16x32_bf16 v[44:47], v[140:143], v[124:127], v[44:47]
    ds_read_b128 v[100:103], v17 offset:6144
    v_mfma_f32_16x16x32_bf16 v[28:31], v[140:143], v[120:123], v[28:31]
    ds_read_b64_tr_b16 v[104:105], v18 offset:0
    v_mfma_f32_16x16x32_bf16 v[32:35], v[144:147], v[120:123], v[32:35]
    ds_read_b64_tr_b16 v[106:107], v18 offset:4096
    v_mfma_f32_16x16x32_bf16 v[48:51], v[144:147], v[124:127], v[48:51]
    ds_read_b64_tr_b16 v[108:109], v19 offset:0
    v_mfma_f32_16x16x32_bf16 v[64:67], v[144:147], v[128:131], v[64:67]
    ds_read_b64_tr_b16 v[110:111], v19 offset:4096
    v_mfma_f32_16x16x32_bf16 v[80:83], v[144:147], v[132:135], v[80:83]
    ds_read_b64_tr_b16 v[112:113], v20 offset:0
    v_mfma_f32_16x16x32_bf16 v[84:87], v[148:151], v[132:135], v[84:87]
    ds_read_b64_tr_b16 v[114:115], v20 offset:4096
    v_mfma_f32_16x16x32_bf16 v[68:71], v[148:151], v[128:131], v[68:71]
    ds_read_b64_tr_b16 v[116:117], v21 offset:0
    v_mfma_f32_16x16x32_bf16 v[52:55], v[148:151], v[124:127], v[52:55]
    ds_read_b64_tr_b16 v[118:119], v21 offset:4096
    v_mfma_f32_16x16x32_bf16 v[36:39], v[148:151], v[120:123], v[36:39]
    s_waitcnt lgkmcnt(6)
    s_cbranch_scc1 mm_25
    s_cmp_eq_u32 s60, 1
    s_cbranch_scc1 G4_last
    v_mfma_f32_16x16x32_bf16 v[24:27], v[104:107], v[88:91], v[24:27]
    ds_read_b128 v[120:123], v17 offset:1024
    v_mfma_f32_16x16x32_bf16 v[40:43], v[104:107], v[92:95], v[40:43]
    ds_read_b128 v[124:127], v17 offset:3072
    v_mfma_f32_16x16x32_bf16 v[56:59], v[104:107], v[96:99], v[56:59]
    ds_read_b128 v[128:131], v17 offset:5120
    v_mfma_f32_16x16x32_bf16 v[72:75], v[104:107], v[100:103], v[72:75]
    ds_read_b128 v[132:135], v17 offset:7168
    s_waitcnt lgkmcnt(8)
    v_mfma_f32_16x16x32_bf16 v[76:79], v[108:111], v[100:103], v[76:79]
    ds_read_b64_tr_b16 v[136:137], v18 offset:8192
    v_mfma_f32_16x16x32_bf16 v[60:63], v[108:111], v[96:99], v[60:63]
    ds_read_b64_tr_b16 v[138:139], v18 offset:12288
    v_mfma_f32_16x16x32_bf16 v[44:47], v[108:111], v[92:95], v[44:47]
    ds_read_b64_tr_b16 v[140:141], v19 offset:8192
    v_mfma_f32_16x16x32_bf16 v[28:31], v[108:111], v[88:91], v[28:31]
    ds_read_b64_tr_b16 v[142:143], v19 offset:12288
    s_waitcnt lgkmcnt(8)
    v_mfma_f32_16x16x32_bf16 v[32:35], v[112:115], v[88:91], v[32:35]
    ds_read_b64_tr_b16 v[144:145], v20 offset:8192
    v_mfma_f32_16x16x32_bf16 v[48:51], v[112:115], v[92:95], v[48:51]
    ds_read_b64_tr_b16 v[146:147], v20 offset:12288
    v_mfma_f32_16x16x32_bf16 v[64:67], v[112:115], v[96:99], v[64:67]
    ds_read_b64_tr_b16 v[148:149], v21 offset:8192
    v_mfma_f32_16x16x32_bf16 v[80:83], v[112:115], v[100:103], v[80:83]
    ds_read_b64_tr_b16 v[150:151], v21 offset:12288
    v_mfma_f32_16x16x32_bf16 v[84:87], v[116:119], v[100:103], v[84:87]
    v_mfma_f32_16x16x32_bf16 v[68:71], v[116:119], v[96:99], v[68:71]
    v_mfma_f32_16x16x32_bf16 v[52:55], v[116:119], v[92:95], v[52:55]
    v_mfma_f32_16x16x32_bf16 v[36:39], v[116:119], v[88:91], v[36:39]
    s_waitcnt lgkmcnt(0)
    v_mfma_f32_16x16x32_bf16 v[24:27], v[136:139], v[120:123], v[24:27]
    s_mul_i32 s36, s31, 524288
    s_add_u32 s36, s36, 0
    s_add_u32 s16, s62, s36
    v_mfma_f32_16x16x32_bf16 v[40:43], v[136:139], v[124:127], v[40:43]
    s_addc_u32 s17, s63, 0
    s_mov_b32 s18, 516096
    s_mov_b32 s19, 0x20000
    v_mfma_f32_16x16x32_bf16 v[56:59], v[136:139], v[128:131], v[56:59]
    v_mfma_f32_16x16x32_bf16 v[72:75], v[136:139], v[132:135], v[72:75]
    v_mfma_f32_16x16x32_bf16 v[76:79], v[140:143], v[132:135], v[76:79]
    v_mfma_f32_16x16x32_bf16 v[60:63], v[140:143], v[128:131], v[60:63]
    v_mfma_f32_16x16x32_bf16 v[44:47], v[140:143], v[124:127], v[44:47]
    v_mfma_f32_16x16x32_bf16 v[28:31], v[140:143], v[120:123], v[28:31]
    v_mfma_f32_16x16x32_bf16 v[32:35], v[144:147], v[120:123], v[32:35]
    v_mfma_f32_16x16x32_bf16 v[48:51], v[144:147], v[124:127], v[48:51]
    v_mfma_f32_16x16x32_bf16 v[64:67], v[144:147], v[128:131], v[64:67]
    v_mfma_f32_16x16x32_bf16 v[80:83], v[144:147], v[132:135], v[80:83]
    v_mfma_f32_16x16x32_bf16 v[84:87], v[148:151], v[132:135], v[84:87]
    v_mfma_f32_16x16x32_bf16 v[68:71], v[148:151], v[128:131], v[68:71]
    v_mfma_f32_16x16x32_bf16 v[52:55], v[148:151], v[124:127], v[52:55]
    v_mfma_f32_16x16x32_bf16 v[36:39], v[148:151], v[120:123], v[36:39]
    s_add_u32 s36, s39, 0
    v_cvt_pk_bf16_f32 v24, v24, v25
    v_cvt_pk_bf16_f32 v25, v26, v27
    v_cvt_pk_bf16_f32 v26, v28, v29
    v_cvt_pk_bf16_f32 v27, v30, v31
    v_or_b32 v24, 1, v24
    buffer_store_dwordx4 v[24:27], v2, s[16:19], s36 offen offset:0 sc1
    v_cvt_pk_bf16_f32 v32, v32, v33
    v_cvt_pk_bf16_f32 v33, v34, v35
    v_cvt_pk_bf16_f32 v34, v36, v37
    v_cvt_pk_bf16_f32 v35, v38, v39
    v_or_b32 v32, 1, v32
    buffer_store_dwordx4 v[32:35], v2, s[16:19], s36 offen offset:1024 sc1
    s_add_u32 s36, s39, 65536
    v_cvt_pk_bf16_f32 v40, v40, v41
    v_cvt_pk_bf16_f32 v41, v42, v43
    v_cvt_pk_bf16_f32 v42, v44, v45
    v_cvt_pk_bf16_f32 v43, v46, v47
    v_or_b32 v40, 1, v40
    buffer_store_dwordx4 v[40:43], v2, s[16:19], s36 offen offset:0 sc1
    v_cvt_pk_bf16_f32 v48, v48, v49
    v_cvt_pk_bf16_f32 v49, v50, v51
    v_cvt_pk_bf16_f32 v50, v52, v53
    v_cvt_pk_bf16_f32 v51, v54, v55
    v_or_b32 v48, 1, v48
    buffer_store_dwordx4 v[48:51], v2, s[16:19], s36 offen offset:1024 sc1
    s_add_u32 s36, s39, 131072
    v_cvt_pk_bf16_f32 v56, v56, v57
    v_cvt_pk_bf16_f32 v57, v58, v59
    v_cvt_pk_bf16_f32 v58, v60, v61
    v_cvt_pk_bf16_f32 v59, v62, v63
    v_or_b32 v56, 1, v56
    buffer_store_dwordx4 v[56:59], v2, s[16:19], s36 offen offset:0 sc1
    v_cvt_pk_bf16_f32 v64, v64, v65
    v_cvt_pk_bf16_f32 v65, v66, v67
    v_cvt_pk_bf16_f32 v66, v68, v69
    v_cvt_pk_bf16_f32 v67, v70, v71
    v_or_b32 v64, 1, v64
    buffer_store_dwordx4 v[64:67], v2, s[16:19], s36 offen offset:1024 sc1
    s_add_u32 s36, s39, 196608
    v_cvt_pk_bf16_f32 v72, v72, v73
    v_cvt_pk_bf16_f32 v73, v74, v75
    v_cvt_pk_bf16_f32 v74, v76, v77
    v_cvt_pk_bf16_f32 v75, v78, v79
    v_or_b32 v72, 1, v72
    buffer_store_dwordx4 v[72:75], v2, s[16:19], s36 offen offset:0 sc1
    v_cvt_pk_bf16_f32 v80, v80, v81
    v_cvt_pk_bf16_f32 v81, v82, v83
    v_cvt_pk_bf16_f32 v82, v84, v85
    v_cvt_pk_bf16_f32 v83, v86, v87
    v_or_b32 v80, 1, v80
    buffer_store_dwordx4 v[80:83], v2, s[16:19], s36 offen offset:1024 sc1
    s_barrier
    s_branch NEXT
G4_last:
    v_mfma_f32_16x16x32_bf16 v[24:27], v[104:107], v[88:91], v[24:27]
    ds_read_b128 v[120:123], v17 offset:1024
    v_mfma_f32_16x16x32_bf16 v[40:43], v[104:107], v[92:95], v[40:43]
    ds_read_b128 v[124:127], v17 offset:3072
    v_mfma_f32_16x16x32_bf16 v[56:59], v[104:107], v[96:99], v[56:59]
    ds_read_b128 v[128:131], v17 offset:5120
    v_mfma_f32_16x16x32_bf16 v[72:75], v[104:107], v[100:103], v[72:75]
    ds_read_b128 v[132:135], v17 offset:7168
    s_waitcnt lgkmcnt(8)
    v_mfma_f32_16x16x32_bf16 v[76:79], v[108:111], v[100:103], v[76:79]
    ds_read_b64_tr_b16 v[136:137], v18 offset:8192
    v_mfma_f32_16x16x32_bf16 v[60:63], v[108:111], v[96:99], v[60:63]
    ds_read_b64_tr_b16 v[138:139], v18 offset:12288
    v_mfma_f32_16x16x32_bf16 v[44:47], v[108:111], v[92:95], v[44:47]
    ds_read_b64_tr_b16 v[140:141], v19 offset:8192
    v_mfma_f32_16x16x32_bf16 v[28:31], v[108:111], v[88:91], v[28:31]
    ds_read_b64_tr_b16 v[142:143], v19 offset:12288
    s_waitcnt lgkmcnt(8)
    v_mfma_f32_16x16x32_bf16 v[32:35], v[112:115], v[88:91], v[32:35]
    ds_read_b64_tr_b16 v[144:145], v20 offset:8192
    v_mfma_f32_16x16x32_bf16 v[48:51], v[112:115], v[92:95], v[48:51]
    ds_read_b64_tr_b16 v[146:147], v20 offset:12288
    s_load_dwordx2 s[6:7], s[0:1], 88
    v_mfma_f32_16x16x32_bf16 v[64:67], v[112:115], v[96:99], v[64:67]
    ds_read_b64_tr_b16 v[148:149], v21 offset:8192
    v_mfma_f32_16x16x32_bf16 v[80:83], v[112:115], v[100:103], v[80:83]
    ds_read_b64_tr_b16 v[150:151], v21 offset:12288
    v_mfma_f32_16x16x32_bf16 v[84:87], v[116:119], v[100:103], v[84:87]
    v_mfma_f32_16x16x32_bf16 v[68:71], v[116:119], v[96:99], v[68:71]
    v_mfma_f32_16x16x32_bf16 v[52:55], v[116:119], v[92:95], v[52:55]
    v_mfma_f32_16x16x32_bf16 v[36:39], v[116:119], v[88:91], v[36:39]
    s_waitcnt lgkmcnt(0)
    v_mfma_f32_16x16x32_bf16 v[24:27], v[136:139], v[120:123], v[24:27]
    s_add_u32 s16, s62, 0x80000
    s_addc_u32 s17, s63, 0
    s_mov_b32 s18, 0x7e000
    v_mfma_f32_16x16x32_bf16 v[40:43], v[136:139], v[124:127], v[40:43]
    s_mov_b32 s19, 0x20000
    s_mov_b32 s20, s6
    s_mov_b32 s21, s7
    v_mfma_f32_16x16x32_bf16 v[56:59], v[136:139], v[128:131], v[56:59]
    s_mov_b32 s22, 0x400000
    s_mov_b32 s23, 0x20000
    s_add_u32 s44, s40, 65536
    v_mfma_f32_16x16x32_bf16 v[72:75], v[136:139], v[132:135], v[72:75]
    s_lshl_b32 s46, s28, 3
    s_add_u32 s46, s46, s37
    s_lshl_b32 s47, s31, 1
    v_mfma_f32_16x16x32_bf16 v[76:79], v[140:143], v[132:135], v[76:79]
    s_add_u32 s46, s46, s47
    s_lshl_b32 s46, s46, 15
    s_lshl_b32 s47, s38, 5
    v_mfma_f32_16x16x32_bf16 v[60:63], v[140:143], v[128:131], v[60:63]
    s_add_u32 s46, s46, s47
    s_add_u32 s47, s46, 32768
    v_and_b32 v225, 1, v23
    v_mfma_f32_16x16x32_bf16 v[44:47], v[140:143], v[124:127], v[44:47]
    v_lshlrev_b32 v224, 11, v22
    v_lshl_add_u32 v224, v225, 5, v224
    v_mfma_f32_16x16x32_bf16 v[28:31], v[140:143], v[120:123], v[28:31]
    v_lshrrev_b32 v225, 1, v23
    v_lshl_add_u32 v224, v225, 4, v224
    v_mfma_f32_16x16x32_bf16 v[32:35], v[144:147], v[120:123], v[32:35]
    v_cmp_gt_u32 s[48:49], 8, v22
    v_lshrrev_b32 v225, 3, v22
    v_mfma_f32_16x16x32_bf16 v[48:51], v[144:147], v[124:127], v[48:51]
    v_mul_u32_u24 v225, 16320, v225
    v_sub_u32 v224, v224, v225
    v_mfma_f32_16x16x32_bf16 v[64:67], v[144:147], v[128:131], v[64:67]
    v_add_u32 v225, 16384, v224
    v_mfma_f32_16x16x32_bf16 v[80:83], v[144:147], v[132:135], v[80:83]
    v_mfma_f32_16x16x32_bf16 v[84:87], v[148:151], v[132:135], v[84:87]
    v_mfma_f32_16x16x32_bf16 v[68:71], v[148:151], v[128:131], v[68:71]
    v_mfma_f32_16x16x32_bf16 v[52:55], v[148:151], v[124:127], v[52:55]
    v_mfma_f32_16x16x32_bf16 v[36:39], v[148:151], v[120:123], v[36:39]
    s_cmp_eq_u32 s31, 0
    s_cbranch_scc1 G4_k0
    v_swap_b32 v24, v56
    v_swap_b32 v25, v57
    v_swap_b32 v26, v58
    v_swap_b32 v27, v59
    v_swap_b32 v28, v60
    v_swap_b32 v29, v61
    v_swap_b32 v30, v62
    v_swap_b32 v31, v63
    v_swap_b32 v32, v64
    v_swap_b32 v33, v65
    v_swap_b32 v34, v66
    v_swap_b32 v35, v67
    v_swap_b32 v36, v68
    v_swap_b32 v37, v69
    v_swap_b32 v38, v70
    v_swap_b32 v39, v71
    v_swap_b32 v40, v72
    v_swap_b32 v41, v73
    v_swap_b32 v42, v74
    v_swap_b32 v43, v75
    v_swap_b32 v44, v76
    v_swap_b32 v45, v77
    v_swap_b32 v46, v78
    v_swap_b32 v47, v79
    v_swap_b32 v48, v80
    v_swap_b32 v49, v81
    v_swap_b32 v50, v82
    v_swap_b32 v51, v83
    v_swap_b32 v52, v84
    v_swap_b32 v53, v85
    v_swap_b32 v54, v86
    v_swap_b32 v55, v87
G4_k0:
    s_add_u32 s36, s41, 0
    v_cvt_pk_bf16_f32 v56, v56, v57
    v_cvt_pk_bf16_f32 v57, v58, v59
    v_cvt_pk_bf16_f32 v58, v60, v61
    v_cvt_pk_bf16_f32 v59, v62, v63
    v_or_b32 v56, 1, v56
    buffer_store_dwordx4 v[56:59], v2, s[16:19], s36 offen offset:0 sc1
    v_cvt_pk_bf16_f32 v64, v64, v65
    v_cvt_pk_bf16_f32 v65, v66, v67
    v_cvt_pk_bf16_f32 v66, v68, v69
    v_cvt_pk_bf16_f32 v67, v70, v71
    v_or_b32 v64, 1, v64
    buffer_store_dwordx4 v[64:67], v2, s[16:19], s36 offen offset:1024 sc1
    s_add_u32 s36, s41, 65536
    v_cvt_pk_bf16_f32 v72, v72, v73
    v_cvt_pk_bf16_f32 v73, v74, v75
    v_cvt_pk_bf16_f32 v74, v76, v77
    v_cvt_pk_bf16_f32 v75, v78, v79
    v_or_b32 v72, 1, v72
    buffer_store_dwordx4 v[72:75], v2, s[16:19], s36 offen offset:0 sc1
    v_cvt_pk_bf16_f32 v80, v80, v81
    v_cvt_pk_bf16_f32 v81, v82, v83
    v_cvt_pk_bf16_f32 v82, v84, v85
    v_cvt_pk_bf16_f32 v83, v86, v87
    v_or_b32 v80, 1, v80
    buffer_store_dwordx4 v[80:83], v2, s[16:19], s36 offen offset:1024 sc1
    v_lshlrev_b32 v226, 16, v180
    v_and_b32 v227, 0xffff0000, v180
    v_pk_add_f32 v[24:25], v[24:25], v[226:227]
    v_lshlrev_b32 v228, 16, v181
    v_and_b32 v229, 0xffff0000, v181
    v_pk_add_f32 v[26:27], v[26:27], v[228:229]
    v_lshlrev_b32 v226, 16, v182
    v_and_b32 v227, 0xffff0000, v182
    v_pk_add_f32 v[28:29], v[28:29], v[226:227]
    v_lshlrev_b32 v228, 16, v183
    v_and_b32 v229, 0xffff0000, v183
    v_pk_add_f32 v[30:31], v[30:31], v[228:229]
    v_lshlrev_b32 v226, 16, v188
    v_and_b32 v227, 0xffff0000, v188
    v_pk_add_f32 v[32:33], v[32:33], v[226:227]
    v_lshlrev_b32 v228, 16, v189
    v_and_b32 v229, 0xffff0000, v189
    v_pk_add_f32 v[34:35], v[34:35], v[228:229]
    v_lshlrev_b32 v226, 16, v190
    v_and_b32 v227, 0xffff0000, v190
    v_pk_add_f32 v[36:37], v[36:37], v[226:227]
    v_lshlrev_b32 v228, 16, v191
    v_and_b32 v229, 0xffff0000, v191
    v_pk_add_f32 v[38:39], v[38:39], v[228:229]
    v_lshlrev_b32 v226, 16, v196
    v_and_b32 v227, 0xffff0000, v196
    v_pk_add_f32 v[40:41], v[40:41], v[226:227]
    v_lshlrev_b32 v228, 16, v197
    v_and_b32 v229, 0xffff0000, v197
    v_pk_add_f32 v[42:43], v[42:43], v[228:229]
    v_lshlrev_b32 v226, 16, v198
    v_and_b32 v227, 0xffff0000, v198
    v_pk_add_f32 v[44:45], v[44:45], v[226:227]
    v_lshlrev_b32 v228, 16, v199
    v_and_b32 v229, 0xffff0000, v199
    v_pk_add_f32 v[46:47], v[46:47], v[228:229]
    v_lshlrev_b32 v226, 16, v234
    v_and_b32 v227, 0xffff0000, v234
    v_pk_add_f32 v[48:49], v[48:49], v[226:227]
    v_lshlrev_b32 v228, 16, v235
    v_and_b32 v229, 0xffff0000, v235
    v_pk_add_f32 v[50:51], v[50:51], v[228:229]
    v_lshlrev_b32 v226, 16, v236
    v_and_b32 v227, 0xffff0000, v236
    v_pk_add_f32 v[52:53], v[52:53], v[226:227]
    v_lshlrev_b32 v228, 16, v237
    v_and_b32 v229, 0xffff0000, v237
    v_pk_add_f32 v[54:55], v[54:55], v[228:229]
    v_lshlrev_b32 v226, 16, v184
    v_and_b32 v227, 0xffff0000, v184
    v_pk_add_f32 v[24:25], v[24:25], v[226:227]
    v_lshlrev_b32 v228, 16, v185
    v_and_b32 v229, 0xffff0000, v185
    v_pk_add_f32 v[26:27], v[26:27], v[228:229]
    v_lshlrev_b32 v226, 16, v186
    v_and_b32 v227, 0xffff0000, v186
    v_pk_add_f32 v[28:29], v[28:29], v[226:227]
    v_lshlrev_b32 v228, 16, v187
    v_and_b32 v229, 0xffff0000, v187
    v_pk_add_f32 v[30:31], v[30:31], v[228:229]
    v_lshlrev_b32 v226, 16, v192
    v_and_b32 v227, 0xffff0000, v192
    v_pk_add_f32 v[32:33], v[32:33], v[226:227]
    v_lshlrev_b32 v228, 16, v193
    v_and_b32 v229, 0xffff0000, v193
    v_pk_add_f32 v[34:35], v[34:35], v[228:229]
    v_lshlrev_b32 v226, 16, v194
    v_and_b32 v227, 0xffff0000, v194
    v_pk_add_f32 v[36:37], v[36:37], v[226:227]
    v_lshlrev_b32 v228, 16, v195
    v_and_b32 v229, 0xffff0000, v195
    v_pk_add_f32 v[38:39], v[38:39], v[228:229]
    v_lshlrev_b32 v226, 16, v230
    v_and_b32 v227, 0xffff0000, v230
    v_pk_add_f32 v[40:41], v[40:41], v[226:227]
    v_lshlrev_b32 v228, 16, v231
    v_and_b32 v229, 0xffff0000, v231
    v_pk_add_f32 v[42:43], v[42:43], v[228:229]
    v_lshlrev_b32 v226, 16, v232
    v_and_b32 v227, 0xffff0000, v232
    v_pk_add_f32 v[44:45], v[44:45], v[226:227]
    v_lshlrev_b32 v228, 16, v233
    v_and_b32 v229, 0xffff0000, v233
    v_pk_add_f32 v[46:47], v[46:47], v[228:229]
    v_lshlrev_b32 v226, 16, v248
    v_and_b32 v227, 0xffff0000, v248
    v_pk_add_f32 v[48:49], v[48:49], v[226:227]
    v_lshlrev_b32 v228, 16, v249
    v_and_b32 v229, 0xffff0000, v249
    v_pk_add_f32 v[50:51], v[50:51], v[228:229]
    v_lshlrev_b32 v226, 16, v250
    v_and_b32 v227, 0xffff0000, v250
    v_pk_add_f32 v[52:53], v[52:53], v[226:227]
    v_lshlrev_b32 v228, 16, v251
    v_and_b32 v229, 0xffff0000, v251
    v_pk_add_f32 v[54:55], v[54:55], v[228:229]
    s_mov_b32 s53, 0
dp_26:
    buffer_load_dwordx4 v[208:211], v2, s[16:19], s40 offen offset:0 sc1
    buffer_load_dwordx4 v[212:215], v2, s[16:19], s40 offen offset:1024 sc1
    buffer_load_dwordx4 v[216:219], v2, s[16:19], s44 offen offset:0 sc1
    buffer_load_dwordx4 v[220:223], v2, s[16:19], s44 offen offset:1024 sc1
    s_waitcnt vmcnt(0)
    v_bitop3_b32 v6, v208, v212, v216 bitop3:0x80
    v_bitop3_b32 v6, v6, v220, 1 bitop3:0x80
    v_cmp_eq_u32 vcc, 0, v6
    s_cbranch_vccz dq_27
    s_sleep 2
    s_add_u32 s53, s53, 1
    s_cmp_lt_u32 s53, s61
    s_cbranch_scc1 dp_26
    s_mov_b32 s61, 0
dq_27:
    v_lshlrev_b32 v226, 16, v208
    v_and_b32 v227, 0xffff0000, v208
    v_pk_add_f32 v[24:25], v[24:25], v[226:227]
    v_lshlrev_b32 v228, 16, v209
    v_and_b32 v229, 0xffff0000, v209
    v_pk_add_f32 v[26:27], v[26:27], v[228:229]
    v_lshlrev_b32 v226, 16, v210
    v_and_b32 v227, 0xffff0000, v210
    v_pk_add_f32 v[28:29], v[28:29], v[226:227]
    v_lshlrev_b32 v228, 16, v211
    v_and_b32 v229, 0xffff0000, v211
    v_pk_add_f32 v[30:31], v[30:31], v[228:229]
    v_cvt_pk_bf16_f32 v24, v24, v25
    v_cvt_pk_bf16_f32 v25, v26, v27
    v_cvt_pk_bf16_f32 v26, v28, v29
    v_cvt_pk_bf16_f32 v27, v30, v31
    s_nop 0
    v_permlane16_swap_b32 v24, v26
    v_permlane16_swap_b32 v25, v27
    v_lshlrev_b32 v226, 16, v212
    v_and_b32 v227, 0xffff0000, v212
    v_pk_add_f32 v[32:33], v[32:33], v[226:227]
    v_lshlrev_b32 v228, 16, v213
    v_and_b32 v229, 0xffff0000, v213
    v_pk_add_f32 v[34:35], v[34:35], v[228:229]
    v_lshlrev_b32 v226, 16, v214
    v_and_b32 v227, 0xffff0000, v214
    v_pk_add_f32 v[36:37], v[36:37], v[226:227]
    v_lshlrev_b32 v228, 16, v215
    v_and_b32 v229, 0xffff0000, v215
    v_pk_add_f32 v[38:39], v[38:39], v[228:229]
    v_cvt_pk_bf16_f32 v32, v32, v33
    v_cvt_pk_bf16_f32 v33, v34, v35
    v_cvt_pk_bf16_f32 v34, v36, v37
    v_cvt_pk_bf16_f32 v35, v38, v39
    s_nop 0
    v_permlane16_swap_b32 v32, v34
    v_permlane16_swap_b32 v33, v35
    v_cndmask_b32 v36, v24, v32, s[48:49]
    v_cndmask_b32 v37, v25, v33, s[48:49]
    v_cndmask_b32 v38, v26, v34, s[48:49]
    v_cndmask_b32 v39, v27, v35, s[48:49]
    v_mov_b32_dpp v28, v36 row_ror:8 row_mask:0xf bank_mask:0xf
    v_mov_b32_dpp v29, v37 row_ror:8 row_mask:0xf bank_mask:0xf
    v_mov_b32_dpp v30, v38 row_ror:8 row_mask:0xf bank_mask:0xf
    v_mov_b32_dpp v31, v39 row_ror:8 row_mask:0xf bank_mask:0xf
    v_cndmask_b32 v24, v28, v24, s[48:49]
    v_cndmask_b32 v32, v32, v28, s[48:49]
    v_cndmask_b32 v25, v29, v25, s[48:49]
    v_cndmask_b32 v33, v33, v29, s[48:49]
    v_cndmask_b32 v26, v30, v26, s[48:49]
    v_cndmask_b32 v34, v34, v30, s[48:49]
    v_cndmask_b32 v27, v31, v27, s[48:49]
    v_cndmask_b32 v35, v35, v31, s[48:49]
    buffer_store_dwordx4 v[24:27], v224, s[20:23], s46 offen sc1
    buffer_store_dwordx4 v[32:35], v225, s[20:23], s46 offen sc1
    v_lshlrev_b32 v226, 16, v216
    v_and_b32 v227, 0xffff0000, v216
    v_pk_add_f32 v[40:41], v[40:41], v[226:227]
    v_lshlrev_b32 v228, 16, v217
    v_and_b32 v229, 0xffff0000, v217
    v_pk_add_f32 v[42:43], v[42:43], v[228:229]
    v_lshlrev_b32 v226, 16, v218
    v_and_b32 v227, 0xffff0000, v218
    v_pk_add_f32 v[44:45], v[44:45], v[226:227]
    v_lshlrev_b32 v228, 16, v219
    v_and_b32 v229, 0xffff0000, v219
    v_pk_add_f32 v[46:47], v[46:47], v[228:229]
    v_cvt_pk_bf16_f32 v40, v40, v41
    v_cvt_pk_bf16_f32 v41, v42, v43
    v_cvt_pk_bf16_f32 v42, v44, v45
    v_cvt_pk_bf16_f32 v43, v46, v47
    s_nop 0
    v_permlane16_swap_b32 v40, v42
    v_permlane16_swap_b32 v41, v43
    v_lshlrev_b32 v226, 16, v220
    v_and_b32 v227, 0xffff0000, v220
    v_pk_add_f32 v[48:49], v[48:49], v[226:227]
    v_lshlrev_b32 v228, 16, v221
    v_and_b32 v229, 0xffff0000, v221
    v_pk_add_f32 v[50:51], v[50:51], v[228:229]
    v_lshlrev_b32 v226, 16, v222
    v_and_b32 v227, 0xffff0000, v222
    v_pk_add_f32 v[52:53], v[52:53], v[226:227]
    v_lshlrev_b32 v228, 16, v223
    v_and_b32 v229, 0xffff0000, v223
    v_pk_add_f32 v[54:55], v[54:55], v[228:229]
    v_cvt_pk_bf16_f32 v48, v48, v49
    v_cvt_pk_bf16_f32 v49, v50, v51
    v_cvt_pk_bf16_f32 v50, v52, v53
    v_cvt_pk_bf16_f32 v51, v54, v55
    s_nop 0
    v_permlane16_swap_b32 v48, v50
    v_permlane16_swap_b32 v49, v51
    v_cndmask_b32 v52, v40, v48, s[48:49]
    v_cndmask_b32 v53, v41, v49, s[48:49]
    v_cndmask_b32 v54, v42, v50, s[48:49]
    v_cndmask_b32 v55, v43, v51, s[48:49]
    v_mov_b32_dpp v44, v52 row_ror:8 row_mask:0xf bank_mask:0xf
    v_mov_b32_dpp v45, v53 row_ror:8 row_mask:0xf bank_mask:0xf
    v_mov_b32_dpp v46, v54 row_ror:8 row_mask:0xf bank_mask:0xf
    v_mov_b32_dpp v47, v55 row_ror:8 row_mask:0xf bank_mask:0xf
    v_cndmask_b32 v40, v44, v40, s[48:49]
    v_cndmask_b32 v48, v48, v44, s[48:49]
    v_cndmask_b32 v41, v45, v41, s[48:49]
    v_cndmask_b32 v49, v49, v45, s[48:49]
    v_cndmask_b32 v42, v46, v42, s[48:49]
    v_cndmask_b32 v50, v50, v46, s[48:49]
    v_cndmask_b32 v43, v47, v43, s[48:49]
    v_cndmask_b32 v51, v51, v47, s[48:49]
    buffer_store_dwordx4 v[40:43], v224, s[20:23], s47 offen sc1
    buffer_store_dwordx4 v[48:51], v225, s[20:23], s47 offen sc1
    s_branch K_fin
LOADERS:
    s_cmp_ge_u32 s30, 6
    s_cbranch_scc1 WLOAD
    s_add_u32 s54, s55, 0x500
    v_mov_b32 v222, s54
    s_lshl_b32 s53, s29, 7
    s_add_u32 s53, s53, 23117824
    v_mov_b32 v226, s53
    s_sleep 30
    s_mov_b64 exec, 1
    buffer_load_dword v227, v226, s[56:59], 0 offen sc1
    s_mov_b64 exec, -1
    s_waitcnt vmcnt(0)
    v_readfirstlane_b32 s53, v227
    s_add_u32 s54, s52, 16
    s_cmp_eq_u32 s53, s54
    s_cbranch_scc1 fok_28
    s_mov_b32 s53, 0
    s_add_u32 s54, s52, 16
    s_bfm_b64 exec, 1, 0
poll_29:
    buffer_load_dword v227, v226, s[56:59], 0 offen sc1
    s_waitcnt vmcnt(0)
    v_xor_b32 v227, s54, v227
    v_cmp_eq_u32 vcc, 0, v227
    s_nop 0
    s_cmp_eq_u64 vcc, exec
    s_cbranch_scc1 pok_30
    s_sleep 5
    s_add_u32 s53, s53, 1
    s_cmp_lt_u32 s53, s61
    s_cbranch_scc1 poll_29
    s_mov_b32 s61, 0
pok_30:
    s_mov_b64 exec, -1
fok_28:
    s_add_u32 s24, s4, 0x1400000
    s_addc_u32 s25, s5, 0
    s_mov_b32 s26, 0x20000
    s_mov_b32 s27, 0x20000
    s_cmp_eq_u32 s60, 0
    s_cselect_b32 s26, s26, 0
    s_and_b32 s36, s30, 1
    s_mul_i32 s36, s36, 128
    s_mul_i32 s37, s29, 256
    s_add_u32 s37, s36, s37
    v_lshrrev_b32 v224, 3, v1
    v_mul_u32_u24 v224, 4096, v224
    v_and_b32 v23, 112, v2
    v_add_u32 v224, v224, v23
    buffer_load_dwordx4 v[24:27], v224, s[24:27], s37 offen sc1
    s_add_u32 s37, s37, 32768
    buffer_load_dwordx4 v[28:31], v224, s[24:27], s37 offen sc1
    s_add_u32 s37, s37, 32768
    buffer_load_dwordx4 v[32:35], v224, s[24:27], s37 offen sc1
    s_add_u32 s37, s37, 32768
    buffer_load_dwordx4 v[36:39], v224, s[24:27], s37 offen sc1
    s_add_u32 s37, s37, 32768
    s_mov_b64 exec, 1
    buffer_load_dword v223, v222, s[56:59], 0 offen sc1
    s_mov_b64 exec, -1
    s_waitcnt vmcnt(0)
    v_readfirstlane_b32 s53, v223
    s_add_u32 s54, s52, 16
    s_cmp_eq_u32 s53, s54
    s_cbranch_scc1 fok_31
    s_mov_b32 s53, 0
    s_add_u32 s54, s52, 16
    s_bfm_b64 exec, 1, 0
poll_32:
    buffer_load_dword v223, v222, s[56:59], 0 offen sc1
    s_waitcnt vmcnt(0)
    v_xor_b32 v223, s54, v223
    v_cmp_eq_u32 vcc, 0, v223
    s_nop 0
    s_cmp_eq_u64 vcc, exec
    s_cbranch_scc1 pok_33
    s_sleep 5
    s_add_u32 s53, s53, 1
    s_cmp_lt_u32 s53, s61
    s_cbranch_scc1 poll_32
    s_mov_b32 s61, 0
pok_33:
    s_mov_b64 exec, -1
fok_31:
    s_add_u32 s20, s62, 0x5d0000
    s_addc_u32 s21, s63, 0
    s_mov_b32 s22, 0x800
    s_mov_b32 s23, 0x20000
    s_and_b32 s35, s30, 1
    s_lshl_b32 s35, s35, 10
    buffer_load_dwordx4 v[16:19], v2, s[20:23], s35 offen sc1
    s_cmp_lg_u32 s60, 0
    s_cbranch_scc1 pc_34
    v_add_f32 v24, v24, v28
    v_add_f32 v25, v25, v29
    v_add_f32 v26, v26, v30
    v_add_f32 v27, v27, v31
    v_add_f32 v24, v24, v32
    v_add_f32 v25, v25, v33
    v_add_f32 v26, v26, v34
    v_add_f32 v27, v27, v35
    v_add_f32 v24, v24, v36
    v_add_f32 v25, v25, v37
    v_add_f32 v26, v26, v38
    v_add_f32 v27, v27, v39
    v_add_f32_dpp v24, v24, v24 row_ror:8 row_mask:0xf bank_mask:0xf
    v_add_f32_dpp v25, v25, v25 row_ror:8 row_mask:0xf bank_mask:0xf
    v_add_f32_dpp v26, v26, v26 row_ror:8 row_mask:0xf bank_mask:0xf
    v_add_f32_dpp v27, v27, v27 row_ror:8 row_mask:0xf bank_mask:0xf
    v_mov_b32 v28, v24
    v_mov_b32 v29, v25
    v_mov_b32 v30, v26
    v_mov_b32 v31, v27
    v_permlane16_swap_b32 v24, v28
    v_permlane16_swap_b32 v25, v29
    v_permlane16_swap_b32 v26, v30
    v_permlane16_swap_b32 v27, v31
    v_add_f32 v24, v24, v28
    v_add_f32 v25, v25, v29
    v_add_f32 v26, v26, v30
    v_add_f32 v27, v27, v31
    v_mov_b32 v28, v24
    v_mov_b32 v29, v25
    v_mov_b32 v30, v26
    v_mov_b32 v31, v27
    v_permlane32_swap_b32 v24, v28
    v_permlane32_swap_b32 v25, v29
    v_permlane32_swap_b32 v26, v30
    v_permlane32_swap_b32 v27, v31
    v_add_f32 v24, v24, v28
    v_add_f32 v25, v25, v29
    v_add_f32 v26, v26, v30
    v_add_f32 v27, v27, v31
pc_34:
    s_cmp_lg_u32 s60, 0
    s_cbranch_scc1 pc_35
    s_and_b32 s36, s30, 1
    s_mul_i32 s36, s36, 128
    s_add_u32 s36, s36, 163328
    v_add_u32 v23, s36, v2
    s_bfm_b64 exec, 8, 0
    ds_write_b128 v23, v[24:27]
    s_mov_b64 exec, -1
    s_waitcnt lgkmcnt(0)
pc_35:
    s_waitcnt vmcnt(0)
    s_and_b32 s36, s30, 1
    s_lshl_b32 s36, s36, 10
    s_add_u32 s36, s36, 160768
    v_add_u32 v221, s36, v2
    ds_write_b128 v221, v[16:19]
    s_waitcnt lgkmcnt(0)
    s_cmp_eq_u32 s60, 0
    s_cbranch_scc1 AL_nw
    s_cmp_lg_u32 s30, 4
    s_cbranch_scc1 AL_nw
    s_add_u32 s54, s55, 0xffc00200
    s_add_u32 s53, s54, s92
    v_mov_b32 v9, s53
    s_add_u32 s53, s54, s93
    v_writelane_b32 v9, s53, 1
    s_mov_b32 s53, 0
    s_add_u32 s54, s52, 16
    s_bfm_b64 exec, 2, 0
poll_37:
    buffer_load_dword v8, v9, s[56:59], 0 offen sc1
    s_waitcnt vmcnt(0)
    v_xor_b32 v8, s54, v8
    v_cmp_eq_u32 vcc, 0, v8
    s_nop 0
    s_cmp_eq_u64 vcc, exec
    s_cbranch_scc1 pok_38
    s_sleep 5
    s_add_u32 s53, s53, 1
    s_cmp_lt_u32 s53, s61
    s_cbranch_scc1 poll_37
    s_mov_b32 s61, 0
pok_38:
    s_mov_b64 exec, -1
AL_nw:
    s_barrier
    s_call_b64 s[76:77], SUB_after_g1
    s_cmp_lg_u32 s30, 4
    s_cbranch_scc1 pdone_39
    s_cmp_lg_u32 s60, 0
    s_cbranch_scc1 pdone_39
    s_mul_i32 s54, s60, 2
    s_add_u32 s54, s54, 1
    v_mov_b32 v8, 162872
spin_40:
    s_sleep 8
    ds_read_b32 v9, v8
    s_waitcnt lgkmcnt(0)
    v_readfirstlane_b32 s53, v9
    s_nop 0
    s_cmp_ge_u32 s53, s54
    s_cbranch_scc0 spin_40
    s_add_u32 s54, s55, 0x100
    v_mov_b32 v9, s54
    s_add_u32 s53, s54, 128
    v_writelane_b32 v9, s53, 1
    s_add_u32 s53, s53, s93
    v_writelane_b32 v9, s53, 3
    s_add_u32 s53, s54, s92
    v_writelane_b32 v9, s53, 2
    s_mov_b32 s53, 0
    s_add_u32 s54, s52, 8
    s_bfm_b64 exec, 4, 0
poll_41:
    buffer_load_dword v8, v9, s[56:59], 0 offen sc1
    s_waitcnt vmcnt(0)
    v_xor_b32 v8, s54, v8
    v_cmp_eq_u32 vcc, 0, v8
    s_nop 0
    s_cmp_eq_u64 vcc, exec
    s_cbranch_scc1 pok_42
    s_sleep 5
    s_add_u32 s53, s53, 1
    s_cmp_lt_u32 s53, s61
    s_cbranch_scc1 poll_41
    s_mov_b32 s61, 0
pok_42:
    s_mov_b64 exec, -1
pdone_39:
    s_barrier
    s_waitcnt vmcnt(0)
    s_barrier
    s_call_b64 s[76:77], SUB_after_g2
    s_and_b32 s35, s30, 1
    s_add_u32 s12, s62, 0x80000
    s_addc_u32 s13, s63, 0
    s_mov_b32 s14, 0x7e000
    s_mov_b32 s15, 0x20000
    s_mul_i32 s38, s35, 262144
    s_lshl_b32 s41, s35, 13
    s_mov_b32 s42, 0
    s_mov_b32 s44, 0
    s_add_u32 s54, s55, 0x200
    v_mov_b32 v9, s54
    s_add_u32 s44, s44, 1
    s_and_b32 s44, s44, 15
    s_mov_b32 s42, 16384
    s_add_u32 s54, s55, 0x580
    v_mov_b32 v222, s54
    v_lshlrev_b32 v221, 3, v1
    s_add_u32 s19, s41, s42
    v_readlane_b32 s16, v248, s44
    s_nop 0
    s_add_u32 s16, s16, s38
    s_add_u32 s44, s44, 1
    s_and_b32 s44, s44, 15
    s_add_u32 s42, s42, 16384
    s_cmp_eq_u32 s42, 49152
    s_cselect_b32 s42, 0, s42
    s_mov_b32 m0, s19
    s_mov_b32 s39, s16
    s_waitcnt vmcnt(0)
    s_barrier
    s_sleep 6
    s_mov_b32 s53, 0
    s_add_u32 s54, s52, 16
    s_bfm_b64 exec, 1, 0
poll_43:
    buffer_load_dword v8, v9, s[56:59], 0 offen sc1
    s_waitcnt vmcnt(0)
    v_xor_b32 v8, s54, v8
    v_cmp_eq_u32 vcc, 0, v8
    s_nop 0
    s_cmp_eq_u64 vcc, exec
    s_cbranch_scc1 pok_44
    s_sleep 5
    s_add_u32 s53, s53, 1
    s_cmp_lt_u32 s53, s61
    s_cbranch_scc1 poll_43
    s_mov_b32 s61, 0
pok_44:
    s_mov_b64 exec, -1
    buffer_load_dwordx4 v2, s[12:15], s39 offen sc1 lds
    buffer_load_dwordx4 v2, s[12:15], s39 offen offset:1024 sc1 lds
    s_add_u32 s19, s41, s42
    v_readlane_b32 s16, v248, s44
    s_nop 0
    s_add_u32 s16, s16, s38
    s_add_u32 s44, s44, 1
    s_and_b32 s44, s44, 15
    s_add_u32 s42, s42, 16384
    s_cmp_eq_u32 s42, 49152
    s_cselect_b32 s42, 0, s42
    s_add_u32 m0, m0, 2048
    s_add_u32 s39, s39, 65536
    buffer_load_dwordx4 v2, s[12:15], s39 offen sc1 lds
    buffer_load_dwordx4 v2, s[12:15], s39 offen offset:1024 sc1 lds
    s_add_u32 m0, m0, 2048
    s_add_u32 s39, s39, 65536
    buffer_load_dwordx4 v2, s[12:15], s39 offen sc1 lds
    buffer_load_dwordx4 v2, s[12:15], s39 offen offset:1024 sc1 lds
    s_add_u32 m0, m0, 2048
    s_add_u32 s39, s39, 65536
    buffer_load_dwordx4 v2, s[12:15], s39 offen sc1 lds
    buffer_load_dwordx4 v2, s[12:15], s39 offen offset:1024 sc1 lds
    s_mov_b32 m0, s19
    s_mov_b32 s39, s16
    buffer_load_dwordx4 v2, s[12:15], s39 offen sc1 lds
    buffer_load_dwordx4 v2, s[12:15], s39 offen offset:1024 sc1 lds
    s_add_u32 s19, s41, s42
    v_readlane_b32 s16, v248, s44
    s_nop 0
    s_add_u32 s16, s16, s38
    s_add_u32 s44, s44, 1
    s_and_b32 s44, s44, 15
    s_add_u32 s42, s42, 16384
    s_cmp_eq_u32 s42, 49152
    s_cselect_b32 s42, 0, s42
    s_add_u32 m0, m0, 2048
    s_add_u32 s39, s39, 65536
    buffer_load_dwordx4 v2, s[12:15], s39 offen sc1 lds
    buffer_load_dwordx4 v2, s[12:15], s39 offen offset:1024 sc1 lds
    s_add_u32 m0, m0, 2048
    s_add_u32 s39, s39, 65536
    buffer_load_dwordx4 v2, s[12:15], s39 offen sc1 lds
    buffer_load_dwordx4 v2, s[12:15], s39 offen offset:1024 sc1 lds
    s_add_u32 m0, m0, 2048
    s_add_u32 s39, s39, 65536
    buffer_load_dwordx4 v2, s[12:15], s39 offen sc1 lds
    buffer_load_dwordx4 v2, s[12:15], s39 offen offset:1024 sc1 lds
    s_mov_b32 m0, s19
    s_mov_b32 s39, s16
    s_waitcnt vmcnt(8)
    s_barrier
    buffer_load_dwordx4 v2, s[12:15], s39 offen sc1 lds
    buffer_load_dwordx4 v2, s[12:15], s39 offen offset:1024 sc1 lds
    s_add_u32 s19, s41, s42
    v_readlane_b32 s16, v248, s44
    s_nop 0
    s_add_u32 s16, s16, s38
    s_add_u32 s44, s44, 1
    s_and_b32 s44, s44, 15
    s_add_u32 s42, s42, 16384
    s_cmp_eq_u32 s42, 49152
    s_cselect_b32 s42, 0, s42
    s_add_u32 m0, m0, 2048
    s_add_u32 s39, s39, 65536
    buffer_load_dwordx4 v2, s[12:15], s39 offen sc1 lds
    buffer_load_dwordx4 v2, s[12:15], s39 offen offset:1024 sc1 lds
    s_add_u32 m0, m0, 2048
    s_add_u32 s39, s39, 65536
    buffer_load_dwordx4 v2, s[12:15], s39 offen sc1 lds
    buffer_load_dwordx4 v2, s[12:15], s39 offen offset:1024 sc1 lds
    s_add_u32 m0, m0, 2048
    s_add_u32 s39, s39, 65536
    buffer_load_dwordx4 v2, s[12:15], s39 offen sc1 lds
    buffer_load_dwordx4 v2, s[12:15], s39 offen offset:1024 sc1 lds
    s_mov_b32 m0, s19
    s_mov_b32 s39, s16
    s_add_u32 s24, s4, 0x1420000
    s_addc_u32 s25, s5, 0
    s_mov_b32 s26, 0x70000
    s_mov_b32 s27, 0x20000
    s_cmp_eq_u32 s60, 0
    s_cselect_b32 s26, s26, 0
    s_and_b32 s36, s30, 1
    s_mul_i32 s36, s36, 448
    s_mul_i32 s37, s29, 896
    s_add_u32 s37, s36, s37
    v_lshrrev_b32 v224, 5, v1
    v_mul_u32_u24 v224, 14336, v224
    v_and_b32 v179, 496, v2
    v_add_u32 v224, v224, v179
    buffer_load_dwordx4 v[180:183], v224, s[24:27], s37 offen sc1
    s_add_u32 s37, s37, 28672
    buffer_load_dwordx4 v[184:187], v224, s[24:27], s37 offen sc1
    s_add_u32 s37, s37, 28672
    buffer_load_dwordx4 v[188:191], v224, s[24:27], s37 offen sc1
    s_add_u32 s37, s37, 28672
    buffer_load_dwordx4 v[192:195], v224, s[24:27], s37 offen sc1
    s_add_u32 s37, s37, 28672
    s_waitcnt vmcnt(12)
    s_barrier
    buffer_load_dwordx4 v2, s[12:15], s39 offen sc1 lds
    buffer_load_dwordx4 v2, s[12:15], s39 offen offset:1024 sc1 lds
    s_add_u32 s19, s41, s42
    v_readlane_b32 s16, v248, s44
    s_nop 0
    s_add_u32 s16, s16, s38
    s_add_u32 s44, s44, 1
    s_and_b32 s44, s44, 15
    s_add_u32 s42, s42, 16384
    s_cmp_eq_u32 s42, 49152
    s_cselect_b32 s42, 0, s42
    s_add_u32 m0, m0, 2048
    s_add_u32 s39, s39, 65536
    buffer_load_dwordx4 v2, s[12:15], s39 offen sc1 lds
    buffer_load_dwordx4 v2, s[12:15], s39 offen offset:1024 sc1 lds
    s_add_u32 m0, m0, 2048
    s_add_u32 s39, s39, 65536
    buffer_load_dwordx4 v2, s[12:15], s39 offen sc1 lds
    buffer_load_dwordx4 v2, s[12:15], s39 offen offset:1024 sc1 lds
    s_add_u32 m0, m0, 2048
    s_add_u32 s39, s39, 65536
    buffer_load_dwordx4 v2, s[12:15], s39 offen sc1 lds
    buffer_load_dwordx4 v2, s[12:15], s39 offen offset:1024 sc1 lds
    s_mov_b32 m0, s19
    s_mov_b32 s39, s16
    buffer_load_dwordx4 v[196:199], v224, s[24:27], s37 offen sc1
    s_add_u32 s37, s37, 28672
    buffer_load_dwordx4 v[200:203], v224, s[24:27], s37 offen sc1
    s_add_u32 s37, s37, 28672
    buffer_load_dwordx4 v[204:207], v224, s[24:27], s37 offen sc1
    s_add_u32 s37, s37, 28672
    buffer_load_dwordx4 v[208:211], v224, s[24:27], s37 offen sc1
    s_add_u32 s37, s37, 28672
    buffer_load_dwordx4 v[212:215], v224, s[24:27], s37 offen sc1
    s_add_u32 s37, s37, 28672
    s_waitcnt vmcnt(17)
    s_barrier
    buffer_load_dwordx4 v2, s[12:15], s39 offen sc1 lds
    buffer_load_dwordx4 v2, s[12:15], s39 offen offset:1024 sc1 lds
    s_add_u32 s19, s41, s42
    v_readlane_b32 s16, v248, s44
    s_nop 0
    s_add_u32 s16, s16, s38
    s_add_u32 s44, s44, 1
    s_and_b32 s44, s44, 15
    s_add_u32 s42, s42, 16384
    s_cmp_eq_u32 s42, 49152
    s_cselect_b32 s42, 0, s42
    s_add_u32 m0, m0, 2048
    s_add_u32 s39, s39, 65536
    buffer_load_dwordx4 v2, s[12:15], s39 offen sc1 lds
    buffer_load_dwordx4 v2, s[12:15], s39 offen offset:1024 sc1 lds
    s_add_u32 m0, m0, 2048
    s_add_u32 s39, s39, 65536
    buffer_load_dwordx4 v2, s[12:15], s39 offen sc1 lds
    buffer_load_dwordx4 v2, s[12:15], s39 offen offset:1024 sc1 lds
    s_add_u32 m0, m0, 2048
    s_add_u32 s39, s39, 65536
    buffer_load_dwordx4 v2, s[12:15], s39 offen sc1 lds
    buffer_load_dwordx4 v2, s[12:15], s39 offen offset:1024 sc1 lds
    s_mov_b32 m0, s19
    s_mov_b32 s39, s16
    s_waitcnt vmcnt(13)
    s_barrier
    buffer_load_dwordx4 v2, s[12:15], s39 offen sc1 lds
    buffer_load_dwordx4 v2, s[12:15], s39 offen offset:1024 sc1 lds
    s_add_u32 s19, s41, s42
    v_readlane_b32 s16, v248, s44
    s_nop 0
    s_add_u32 s16, s16, s38
    s_add_u32 s44, s44, 1
    s_and_b32 s44, s44, 15
    s_add_u32 s42, s42, 16384
    s_cmp_eq_u32 s42, 49152
    s_cselect_b32 s42, 0, s42
    s_add_u32 m0, m0, 2048
    s_add_u32 s39, s39, 65536
    buffer_load_dwordx4 v2, s[12:15], s39 offen sc1 lds
    buffer_load_dwordx4 v2, s[12:15], s39 offen offset:1024 sc1 lds
    s_add_u32 m0, m0, 2048
    s_add_u32 s39, s39, 65536
    buffer_load_dwordx4 v2, s[12:15], s39 offen sc1 lds
    buffer_load_dwordx4 v2, s[12:15], s39 offen offset:1024 sc1 lds
    s_add_u32 m0, m0, 2048
    s_add_u32 s39, s39, 65536
    buffer_load_dwordx4 v2, s[12:15], s39 offen sc1 lds
    buffer_load_dwordx4 v2, s[12:15], s39 offen offset:1024 sc1 lds
    s_mov_b32 m0, s19
    s_mov_b32 s39, s16
    s_waitcnt vmcnt(16)
    s_cmp_lg_u32 s60, 0
    s_cbranch_scc1 pc_45
    v_add_f32 v180, v180, v184
    v_add_f32 v181, v181, v185
    v_add_f32 v182, v182, v186
    v_add_f32 v183, v183, v187
    v_add_f32 v180, v180, v188
    v_add_f32 v181, v181, v189
    v_add_f32 v182, v182, v190
    v_add_f32 v183, v183, v191
    v_add_f32 v180, v180, v192
    v_add_f32 v181, v181, v193
    v_add_f32 v182, v182, v194
    v_add_f32 v183, v183, v195
    v_add_f32 v180, v180, v196
    v_add_f32 v181, v181, v197
    v_add_f32 v182, v182, v198
    v_add_f32 v183, v183, v199
pc_45:
    s_mov_b64 exec, 1
    buffer_load_dword v223, v222, s[56:59], 0 offen sc1
    s_mov_b64 exec, -1
    s_waitcnt vmcnt(9)
    s_barrier
    buffer_load_dwordx4 v2, s[12:15], s39 offen sc1 lds
    buffer_load_dwordx4 v2, s[12:15], s39 offen offset:1024 sc1 lds
    s_add_u32 s19, s41, s42
    v_readlane_b32 s16, v248, s44
    s_nop 0
    s_add_u32 s16, s16, s38
    s_add_u32 s44, s44, 1
    s_and_b32 s44, s44, 15
    s_add_u32 s42, s42, 16384
    s_cmp_eq_u32 s42, 49152
    s_cselect_b32 s42, 0, s42
    s_add_u32 m0, m0, 2048
    s_add_u32 s39, s39, 65536
    buffer_load_dwordx4 v2, s[12:15], s39 offen sc1 lds
    buffer_load_dwordx4 v2, s[12:15], s39 offen offset:1024 sc1 lds
    s_add_u32 m0, m0, 2048
    s_add_u32 s39, s39, 65536
    buffer_load_dwordx4 v2, s[12:15], s39 offen sc1 lds
    buffer_load_dwordx4 v2, s[12:15], s39 offen offset:1024 sc1 lds
    s_add_u32 m0, m0, 2048
    s_add_u32 s39, s39, 65536
    buffer_load_dwordx4 v2, s[12:15], s39 offen sc1 lds
    buffer_load_dwordx4 v2, s[12:15], s39 offen offset:1024 sc1 lds
    s_mov_b32 m0, s19
    s_mov_b32 s39, s16
    s_cmp_lg_u32 s60, 0
    s_cbranch_scc1 pc_46
    v_add_f32 v180, v180, v200
    v_add_f32 v181, v181, v201
    v_add_f32 v182, v182, v202
    v_add_f32 v183, v183, v203
    v_add_f32 v180, v180, v204
    v_add_f32 v181, v181, v205
    v_add_f32 v182, v182, v206
    v_add_f32 v183, v183, v207
    v_add_f32 v180, v180, v208
    v_add_f32 v181, v181, v209
    v_add_f32 v182, v182, v210
    v_add_f32 v183, v183, v211
    v_add_f32 v180, v180, v212
    v_add_f32 v181, v181, v213
    v_add_f32 v182, v182, v214
    v_add_f32 v183, v183, v215
pc_46:
    buffer_load_dwordx4 v[184:187], v224, s[24:27], s37 offen sc1
    s_add_u32 s37, s37, 28672
    buffer_load_dwordx4 v[188:191], v224, s[24:27], s37 offen sc1
    s_add_u32 s37, s37, 28672
    buffer_load_dwordx4 v[192:195], v224, s[24:27], s37 offen sc1
    s_add_u32 s37, s37, 28672
    buffer_load_dwordx4 v[196:199], v224, s[24:27], s37 offen sc1
    s_add_u32 s37, s37, 28672
    buffer_load_dwordx4 v[200:203], v224, s[24:27], s37 offen sc1
    s_add_u32 s37, s37, 28672
    buffer_load_dwordx4 v[204:207], v224, s[24:27], s37 offen sc1
    s_add_u32 s37, s37, 28672
    buffer_load_dwordx4 v[208:211], v224, s[24:27], s37 offen sc1
    s_add_u32 s37, s37, 28672
    s_waitcnt vmcnt(16)
    s_barrier
    buffer_load_dwordx4 v2, s[12:15], s39 offen sc1 lds
    buffer_load_dwordx4 v2, s[12:15], s39 offen offset:1024 sc1 lds
    s_add_u32 s19, s41, s42
    v_readlane_b32 s16, v248, s44
    s_nop 0
    s_add_u32 s16, s16, s38
    s_add_u32 s44, s44, 1
    s_and_b32 s44, s44, 15
    s_add_u32 s42, s42, 16384
    s_cmp_eq_u32 s42, 49152
    s_cselect_b32 s42, 0, s42
    s_add_u32 m0, m0, 2048
    s_add_u32 s39, s39, 65536
    buffer_load_dwordx4 v2, s[12:15], s39 offen sc1 lds
    buffer_load_dwordx4 v2, s[12:15], s39 offen offset:1024 sc1 lds
    s_add_u32 m0, m0, 2048
    s_add_u32 s39, s39, 65536
    buffer_load_dwordx4 v2, s[12:15], s39 offen sc1 lds
    buffer_load_dwordx4 v2, s[12:15], s39 offen offset:1024 sc1 lds
    s_add_u32 m0, m0, 2048
    s_add_u32 s39, s39, 65536
    buffer_load_dwordx4 v2, s[12:15], s39 offen sc1 lds
    buffer_load_dwordx4 v2, s[12:15], s39 offen offset:1024 sc1 lds
    s_mov_b32 m0, s19
    s_mov_b32 s39, s16
    s_waitcnt vmcnt(23)
    v_readfirstlane_b32 s53, v223
    s_add_u32 s54, s52, 16
    s_cmp_eq_u32 s53, s54
    s_cbranch_scc1 fok_47
    s_mov_b32 s53, 0
    s_add_u32 s54, s52, 16
    s_bfm_b64 exec, 1, 0
poll_48:
    buffer_load_dword v223, v222, s[56:59], 0 offen sc1
    s_waitcnt vmcnt(0)
    v_xor_b32 v223, s54, v223
    v_cmp_eq_u32 vcc, 0, v223
    s_nop 0
    s_cmp_eq_u64 vcc, exec
    s_cbranch_scc1 pok_49
    s_sleep 5
    s_add_u32 s53, s53, 1
    s_cmp_lt_u32 s53, s61
    s_cbranch_scc1 poll_48
    s_mov_b32 s61, 0
pok_49:
    s_mov_b64 exec, -1
fok_47:
    s_add_u32 s20, s62, 0x5c8000
    s_addc_u32 s21, s63, 0
    s_mov_b32 s22, 0x6000
    s_mov_b32 s23, 0x20000
    s_and_b32 s35, s30, 1
    s_lshl_b32 s35, s35, 9
    s_add_u32 s36, s35, 0
    buffer_load_dwordx2 v[16:17], v221, s[20:23], s36 offen offset:0 sc1
    buffer_load_dwordx2 v[18:19], v221, s[20:23], s36 offen offset:1024 sc1
    buffer_load_dwordx2 v[20:21], v221, s[20:23], s36 offen offset:2048 sc1
    buffer_load_dwordx2 v[22:23], v221, s[20:23], s36 offen offset:3072 sc1
    s_add_u32 s36, s36, 4096
    buffer_load_dwordx2 v[24:25], v221, s[20:23], s36 offen offset:0 sc1
    buffer_load_dwordx2 v[26:27], v221, s[20:23], s36 offen offset:1024 sc1
    buffer_load_dwordx2 v[28:29], v221, s[20:23], s36 offen offset:2048 sc1
    buffer_load_dwordx2 v[30:31], v221, s[20:23], s36 offen offset:3072 sc1
    s_waitcnt vmcnt(23)
    s_barrier
    buffer_load_dwordx4 v2, s[12:15], s39 offen sc1 lds
    buffer_load_dwordx4 v2, s[12:15], s39 offen offset:1024 sc1 lds
    s_add_u32 s19, s41, s42
    v_readlane_b32 s16, v248, s44
    s_nop 0
    s_add_u32 s16, s16, s38
    s_add_u32 s44, s44, 1
    s_and_b32 s44, s44, 15
    s_add_u32 s42, s42, 16384
    s_cmp_eq_u32 s42, 49152
    s_cselect_b32 s42, 0, s42
    s_add_u32 m0, m0, 2048
    s_add_u32 s39, s39, 65536
    buffer_load_dwordx4 v2, s[12:15], s39 offen sc1 lds
    buffer_load_dwordx4 v2, s[12:15], s39 offen offset:1024 sc1 lds
    s_add_u32 m0, m0, 2048
    s_add_u32 s39, s39, 65536
    buffer_load_dwordx4 v2, s[12:15], s39 offen sc1 lds
    buffer_load_dwordx4 v2, s[12:15], s39 offen offset:1024 sc1 lds
    s_add_u32 m0, m0, 2048
    s_add_u32 s39, s39, 65536
    buffer_load_dwordx4 v2, s[12:15], s39 offen sc1 lds
    buffer_load_dwordx4 v2, s[12:15], s39 offen offset:1024 sc1 lds
    s_mov_b32 m0, s19
    s_mov_b32 s39, s16
    s_add_u32 s36, s35, 16384
    buffer_load_dwordx2 v[32:33], v221, s[20:23], s36 offen offset:0 sc1
    buffer_load_dwordx2 v[34:35], v221, s[20:23], s36 offen offset:1024 sc1
    buffer_load_dwordx2 v[36:37], v221, s[20:23], s36 offen offset:2048 sc1
    buffer_load_dwordx2 v[38:39], v221, s[20:23], s36 offen offset:3072 sc1
    s_add_u32 s36, s36, 4096
    buffer_load_dwordx2 v[40:41], v221, s[20:23], s36 offen offset:0 sc1
    buffer_load_dwordx2 v[42:43], v221, s[20:23], s36 offen offset:1024 sc1
    buffer_load_dwordx2 v[44:45], v221, s[20:23], s36 offen offset:2048 sc1
    buffer_load_dwordx2 v[46:47], v221, s[20:23], s36 offen offset:3072 sc1
    s_waitcnt vmcnt(24)
    s_barrier
    buffer_load_dwordx4 v2, s[12:15], s39 offen sc1 lds
    buffer_load_dwordx4 v2, s[12:15], s39 offen offset:1024 sc1 lds
    s_add_u32 s19, s41, s42
    v_readlane_b32 s16, v248, s44
    s_nop 0
    s_add_u32 s16, s16, s38
    s_add_u32 s44, s44, 1
    s_and_b32 s44, s44, 15
    s_add_u32 s42, s42, 16384
    s_cmp_eq_u32 s42, 49152
    s_cselect_b32 s42, 0, s42
    s_add_u32 m0, m0, 2048
    s_add_u32 s39, s39, 65536
    buffer_load_dwordx4 v2, s[12:15], s39 offen sc1 lds
    buffer_load_dwordx4 v2, s[12:15], s39 offen offset:1024 sc1 lds
    s_add_u32 m0, m0, 2048
    s_add_u32 s39, s39, 65536
    buffer_load_dwordx4 v2, s[12:15], s39 offen sc1 lds
    buffer_load_dwordx4 v2, s[12:15], s39 offen offset:1024 sc1 lds
    s_add_u32 m0, m0, 2048
    s_add_u32 s39, s39, 65536
    buffer_load_dwordx4 v2, s[12:15], s39 offen sc1 lds
    buffer_load_dwordx4 v2, s[12:15], s39 offen offset:1024 sc1 lds
    s_mov_b32 m0, s19
    s_mov_b32 s39, s16
    s_waitcnt vmcnt(40)
    s_cmp_lg_u32 s60, 0
    s_cbranch_scc1 pc_50
    v_add_f32 v180, v180, v184
    v_add_f32 v181, v181, v185
    v_add_f32 v182, v182, v186
    v_add_f32 v183, v183, v187
    v_add_f32 v180, v180, v188
    v_add_f32 v181, v181, v189
    v_add_f32 v182, v182, v190
    v_add_f32 v183, v183, v191
    v_add_f32 v180, v180, v192
    v_add_f32 v181, v181, v193
    v_add_f32 v182, v182, v194
    v_add_f32 v183, v183, v195
    v_add_f32 v180, v180, v196
    v_add_f32 v181, v181, v197
    v_add_f32 v182, v182, v198
    v_add_f32 v183, v183, v199
pc_50:
    s_waitcnt vmcnt(16)
    s_barrier
    buffer_load_dwordx4 v2, s[12:15], s39 offen sc1 lds
    buffer_load_dwordx4 v2, s[12:15], s39 offen offset:1024 sc1 lds
    s_add_u32 s19, s41, s42
    v_readlane_b32 s16, v248, s44
    s_nop 0
    s_add_u32 s16, s16, s38
    s_add_u32 s44, s44, 1
    s_and_b32 s44, s44, 15
    s_add_u32 s42, s42, 16384
    s_cmp_eq_u32 s42, 49152
    s_cselect_b32 s42, 0, s42
    s_add_u32 m0, m0, 2048
    s_add_u32 s39, s39, 65536
    buffer_load_dwordx4 v2, s[12:15], s39 offen sc1 lds
    buffer_load_dwordx4 v2, s[12:15], s39 offen offset:1024 sc1 lds
    s_add_u32 m0, m0, 2048
    s_add_u32 s39, s39, 65536
    buffer_load_dwordx4 v2, s[12:15], s39 offen sc1 lds
    buffer_load_dwordx4 v2, s[12:15], s39 offen offset:1024 sc1 lds
    s_add_u32 m0, m0, 2048
    s_add_u32 s39, s39, 65536
    buffer_load_dwordx4 v2, s[12:15], s39 offen sc1 lds
    buffer_load_dwordx4 v2, s[12:15], s39 offen offset:1024 sc1 lds
    s_mov_b32 m0, s19
    s_mov_b32 s39, s16
    s_cmp_lg_u32 s60, 0
    s_cbranch_scc1 pc_51
    v_add_f32 v180, v180, v200
    v_add_f32 v181, v181, v201
    v_add_f32 v182, v182, v202
    v_add_f32 v183, v183, v203
    v_add_f32 v180, v180, v204
    v_add_f32 v181, v181, v205
    v_add_f32 v182, v182, v206
    v_add_f32 v183, v183, v207
    v_add_f32 v180, v180, v208
    v_add_f32 v181, v181, v209
    v_add_f32 v182, v182, v210
    v_add_f32 v183, v183, v211
pc_51:
    s_waitcnt vmcnt(8)
    s_barrier
    buffer_load_dwordx4 v2, s[12:15], s39 offen sc1 lds
    buffer_load_dwordx4 v2, s[12:15], s39 offen offset:1024 sc1 lds
    s_add_u32 s19, s41, s42
    v_readlane_b32 s16, v248, s44
    s_nop 0
    s_add_u32 s16, s16, s38
    s_add_u32 s44, s44, 1
    s_and_b32 s44, s44, 15
    s_add_u32 s42, s42, 16384
    s_cmp_eq_u32 s42, 49152
    s_cselect_b32 s42, 0, s42
    s_add_u32 m0, m0, 2048
    s_add_u32 s39, s39, 65536
    buffer_load_dwordx4 v2, s[12:15], s39 offen sc1 lds
    buffer_load_dwordx4 v2, s[12:15], s39 offen offset:1024 sc1 lds
    s_add_u32 m0, m0, 2048
    s_add_u32 s39, s39, 65536
    buffer_load_dwordx4 v2, s[12:15], s39 offen sc1 lds
    buffer_load_dwordx4 v2, s[12:15], s39 offen offset:1024 sc1 lds
    s_add_u32 m0, m0, 2048
    s_add_u32 s39, s39, 65536
    buffer_load_dwordx4 v2, s[12:15], s39 offen sc1 lds
    buffer_load_dwordx4 v2, s[12:15], s39 offen offset:1024 sc1 lds
    s_mov_b32 m0, s19
    s_mov_b32 s39, s16
    s_cmp_lg_u32 s60, 0
    s_cbranch_scc1 pc_52
    v_mov_b32 v184, v180
    v_mov_b32 v185, v181
    v_mov_b32 v186, v182
    v_mov_b32 v187, v183
    v_permlane32_swap_b32 v180, v184
    v_permlane32_swap_b32 v181, v185
    v_permlane32_swap_b32 v182, v186
    v_permlane32_swap_b32 v183, v187
    v_add_f32 v180, v180, v184
    v_add_f32 v181, v181, v185
    v_add_f32 v182, v182, v186
    v_add_f32 v183, v183, v187
    s_and_b32 s36, s30, 1
    s_mul_i32 s36, s36, 448
    s_add_u32 s36, s36, 159744
    v_add_u32 v179, s36, v2
    s_bfm_b64 exec, 28, 0
    ds_write_b128 v179, v[180:183]
    s_mov_b64 exec, -1
    s_waitcnt lgkmcnt(0)
pc_52:
    s_waitcnt vmcnt(8)
    s_barrier
    buffer_load_dwordx4 v2, s[12:15], s39 offen sc1 lds
    buffer_load_dwordx4 v2, s[12:15], s39 offen offset:1024 sc1 lds
    s_add_u32 s19, s41, s42
    v_readlane_b32 s16, v248, s44
    s_nop 0
    s_add_u32 s16, s16, s38
    s_add_u32 s44, s44, 1
    s_and_b32 s44, s44, 15
    s_add_u32 s42, s42, 16384
    s_cmp_eq_u32 s42, 49152
    s_cselect_b32 s42, 0, s42
    s_add_u32 m0, m0, 2048
    s_add_u32 s39, s39, 65536
    buffer_load_dwordx4 v2, s[12:15], s39 offen sc1 lds
    buffer_load_dwordx4 v2, s[12:15], s39 offen offset:1024 sc1 lds
    s_add_u32 m0, m0, 2048
    s_add_u32 s39, s39, 65536
    buffer_load_dwordx4 v2, s[12:15], s39 offen sc1 lds
    buffer_load_dwordx4 v2, s[12:15], s39 offen offset:1024 sc1 lds
    s_add_u32 m0, m0, 2048
    s_add_u32 s39, s39, 65536
    buffer_load_dwordx4 v2, s[12:15], s39 offen sc1 lds
    buffer_load_dwordx4 v2, s[12:15], s39 offen offset:1024 sc1 lds
    s_mov_b32 m0, s19
    s_mov_b32 s39, s16
    s_waitcnt vmcnt(32)
    v_add_f32 v16, v16, v32
    v_add_f32 v17, v17, v33
    v_add_f32 v18, v18, v34
    v_add_f32 v19, v19, v35
    v_add_f32 v20, v20, v36
    v_add_f32 v21, v21, v37
    v_add_f32 v22, v22, v38
    v_add_f32 v23, v23, v39
    v_add_f32 v24, v24, v40
    v_add_f32 v25, v25, v41
    v_add_f32 v26, v26, v42
    v_add_f32 v27, v27, v43
    v_add_f32 v28, v28, v44
    v_add_f32 v29, v29, v45
    v_add_f32 v30, v30, v46
    v_add_f32 v31, v31, v47
    s_waitcnt vmcnt(8)
    s_barrier
    buffer_load_dwordx4 v2, s[12:15], s39 offen sc1 lds
    buffer_load_dwordx4 v2, s[12:15], s39 offen offset:1024 sc1 lds
    s_add_u32 s19, s41, s42
    v_readlane_b32 s16, v248, s44
    s_nop 0
    s_add_u32 s16, s16, s38
    s_add_u32 s44, s44, 1
    s_and_b32 s44, s44, 15
    s_add_u32 s42, s42, 16384
    s_cmp_eq_u32 s42, 49152
    s_cselect_b32 s42, 0, s42
    s_add_u32 m0, m0, 2048
    s_add_u32 s39, s39, 65536
    buffer_load_dwordx4 v2, s[12:15], s39 offen sc1 lds
    buffer_load_dwordx4 v2, s[12:15], s39 offen offset:1024 sc1 lds
    s_add_u32 m0, m0, 2048
    s_add_u32 s39, s39, 65536
    buffer_load_dwordx4 v2, s[12:15], s39 offen sc1 lds
    buffer_load_dwordx4 v2, s[12:15], s39 offen offset:1024 sc1 lds
    s_add_u32 m0, m0, 2048
    s_add_u32 s39, s39, 65536
    buffer_load_dwordx4 v2, s[12:15], s39 offen sc1 lds
    buffer_load_dwordx4 v2, s[12:15], s39 offen offset:1024 sc1 lds
    s_mov_b32 m0, s19
    s_mov_b32 s39, s16
    v_add_f32 v16, v16, v24
    v_add_f32 v17, v17, v25
    v_add_f32 v18, v18, v26
    v_add_f32 v19, v19, v27
    v_add_f32 v20, v20, v28
    v_add_f32 v21, v21, v29
    v_add_f32 v22, v22, v30
    v_add_f32 v23, v23, v31
    v_add_f32 v16, v16, v20
    v_add_f32 v17, v17, v21
    v_add_f32 v18, v18, v22
    v_add_f32 v19, v19, v23
    v_add_f32 v16, v16, v18
    v_add_f32 v17, v17, v19
    v_mul_f32 v20, 0x3a800000, v16
    v_mul_f32 v217, 0x3a800000, v17
    s_waitcnt vmcnt(8)
    s_barrier
    buffer_load_dwordx4 v2, s[12:15], s39 offen sc1 lds
    buffer_load_dwordx4 v2, s[12:15], s39 offen offset:1024 sc1 lds
    s_add_u32 m0, m0, 2048
    s_add_u32 s39, s39, 65536
    buffer_load_dwordx4 v2, s[12:15], s39 offen sc1 lds
    buffer_load_dwordx4 v2, s[12:15], s39 offen offset:1024 sc1 lds
    s_add_u32 m0, m0, 2048
    s_add_u32 s39, s39, 65536
    buffer_load_dwordx4 v2, s[12:15], s39 offen sc1 lds
    buffer_load_dwordx4 v2, s[12:15], s39 offen offset:1024 sc1 lds
    s_add_u32 m0, m0, 2048
    s_add_u32 s39, s39, 65536
    buffer_load_dwordx4 v2, s[12:15], s39 offen sc1 lds
    buffer_load_dwordx4 v2, s[12:15], s39 offen offset:1024 sc1 lds
    v_fma_f32 v217, -v20, v20, v217
    v_max_f32 v217, 0, v217
    v_add_f32 v217, 0x3727c5ac, v217
    v_sqrt_f32 v217, v217
    s_nop 0
    v_mov_b32 v21, v217
    v_rcp_f32 v219, v217
    s_nop 0
    v_mul_f32 v22, 0xc0135761, v219
    v_mul_f32 v23, v219, v219
    v_mul_f32 v23, v23, v22
    v_mul_f32 v23, 0x3d372713, v23
    s_lshl_b32 s35, s35, 1
    s_add_u32 s35, s35, 160768
    v_add_u32 v220, s35, v2
    ds_write_b128 v220, v[20:23]
    s_waitcnt lgkmcnt(0)
    s_waitcnt vmcnt(8)
    s_barrier
    s_call_b64 s[76:77], SUB_r_pre0
    s_waitcnt vmcnt(8)
    s_barrier
    s_cmp_lg_u32 s60, 0
    s_cbranch_scc1 tw4_56
    s_load_dwordx2 s[48:49], s[0:1], 80
    s_lshl_b32 s45, s2, 1
    s_and_b32 s50, s30, 1
    s_add_u32 s45, s45, s50
    s_mul_i32 s45, s45, 14336
    s_mov_b32 s50, 7340032
    s_mov_b32 s51, 0x20000
    s_waitcnt lgkmcnt(0)
    buffer_load_dwordx4 v[20:23], v2, s[48:51], s45 offen offset:0
    buffer_load_dwordx4 v[20:23], v2, s[48:51], s45 offen offset:1024
    buffer_load_dwordx4 v[20:23], v2, s[48:51], s45 offen offset:2048
    buffer_load_dwordx4 v[20:23], v2, s[48:51], s45 offen offset:3072
    s_add_u32 s45, s45, 4096
    buffer_load_dwordx4 v[20:23], v2, s[48:51], s45 offen offset:0
    buffer_load_dwordx4 v[20:23], v2, s[48:51], s45 offen offset:1024
    buffer_load_dwordx4 v[20:23], v2, s[48:51], s45 offen offset:2048
    buffer_load_dwordx4 v[20:23], v2, s[48:51], s45 offen offset:3072
    s_add_u32 s45, s45, 4096
    buffer_load_dwordx4 v[20:23], v2, s[48:51], s45 offen offset:0
    buffer_load_dwordx4 v[20:23], v2, s[48:51], s45 offen offset:1024
    buffer_load_dwordx4 v[20:23], v2, s[48:51], s45 offen offset:2048
    buffer_load_dwordx4 v[20:23], v2, s[48:51], s45 offen offset:3072
    s_add_u32 s45, s45, 4096
    buffer_load_dwordx4 v[20:23], v2, s[48:51], s45 offen offset:0
    buffer_load_dwordx4 v[20:23], v2, s[48:51], s45 offen offset:1024
tw4_56:
    s_barrier
    s_and_b32 s35, s30, 1
    s_add_u32 s12, s62, 0x400000
    s_addc_u32 s13, s63, 0
    s_mov_b32 s14, 0x1be000
    s_mov_b32 s15, 0x20000
    s_mul_i32 s38, s35, 917504
    s_mul_i32 s36, s31, 114688
    s_add_u32 s38, s38, s36
    s_lshl_b32 s41, s35, 13
    s_mov_b32 s42, 0
    s_mov_b32 s44, 0
    s_add_u32 s54, s55, 0x700
    s_lshl_b32 s53, s31, 7
    s_add_u32 s54, s54, s53
    v_mov_b32 v9, s54
    s_add_u32 s54, s55, 0x600
    s_lshl_b32 s53, s31, 7
    s_add_u32 s54, s54, s53
    v_mov_b32 v10, s54
    s_add_u32 s54, s55, 0x300
    s_lshl_b32 s53, s31, 7
    s_add_u32 s54, s54, s53
    v_mov_b32 v12, s54
    v_mov_b32 v13, 1
    s_and_b32 s51, s30, 1
    s_lshl_b32 s51, s51, 30
    s_lshl_b32 s54, s60, 2
    s_add_u32 s54, s54, 4
    v_mov_b32 v14, 162880
spin_57:
    s_sleep 2
    ds_read_b32 v15, v14
    s_waitcnt lgkmcnt(0)
    v_readfirstlane_b32 s53, v15
    s_nop 0
    s_cmp_ge_u32 s53, s54
    s_cbranch_scc0 spin_57
    s_mov_b64 exec, 1
    buffer_atomic_add v13, v9, s[56:59], s51 offen sc1
    s_mov_b64 exec, -1
    v_xor_b32 v15, 128, v12
    s_mov_b32 s44, 3
    s_call_b64 s[76:77], PREP_a_issue_4
    s_mov_b32 m0, s19
    s_mov_b32 s39, s16
    s_mov_b32 s40, s17
    s_waitcnt vmcnt(16)
    s_barrier
    s_mov_b64 exec, 1
    buffer_load_dword v8, v9, s[56:59], 0 offen sc1
    s_mov_b64 exec, -1
    s_waitcnt vmcnt(9)
    s_barrier
    s_waitcnt vmcnt(0)
    v_readfirstlane_b32 s53, v8
    s_add_u32 s54, s52, 8
    s_cmp_eq_u32 s53, s54
    s_cbranch_scc1 fok_58
    s_mov_b32 s53, 0
    s_add_u32 s54, s52, 8
    s_bfm_b64 exec, 1, 0
poll_59:
    buffer_load_dword v8, v9, s[56:59], 0 offen sc1
    s_waitcnt vmcnt(0)
    v_xor_b32 v8, s54, v8
    v_cmp_eq_u32 vcc, 0, v8
    s_nop 0
    s_cmp_eq_u64 vcc, exec
    s_cbranch_scc1 pok_60
    s_sleep 5
    s_add_u32 s53, s53, 1
    s_cmp_lt_u32 s53, s61
    s_cbranch_scc1 poll_59
    s_mov_b32 s61, 0
pok_60:
    s_mov_b64 exec, -1
fok_58:
    buffer_load_dwordx4 v2, s[12:15], s39 offen sc1 lds
    s_add_u32 m0, m0, 1024
    s_nop 0
    buffer_load_dwordx4 v2, s[12:15], s40 offen sc1 lds
    s_call_b64 s[76:77], PREP_a_issue_4
    s_add_u32 m0, m0, 1024
    s_add_u32 s39, s39, 229376
    buffer_load_dwordx4 v2, s[12:15], s39 offen sc1 lds
    s_add_u32 m0, m0, 1024
    s_add_u32 s40, s40, 229376
    buffer_load_dwordx4 v2, s[12:15], s40 offen sc1 lds
    s_add_u32 m0, m0, 1024
    s_add_u32 s39, s39, 229376
    buffer_load_dwordx4 v2, s[12:15], s39 offen sc1 lds
    s_add_u32 m0, m0, 1024
    s_add_u32 s40, s40, 229376
    buffer_load_dwordx4 v2, s[12:15], s40 offen sc1 lds
    s_add_u32 m0, m0, 1024
    s_add_u32 s39, s39, 229376
    buffer_load_dwordx4 v2, s[12:15], s39 offen sc1 lds
    s_add_u32 m0, m0, 1024
    s_add_u32 s40, s40, 229376
    buffer_load_dwordx4 v2, s[12:15], s40 offen sc1 lds
    s_mov_b32 m0, s19
    s_mov_b32 s39, s16
    s_mov_b32 s40, s17
    s_waitcnt vmcnt(9)
    s_barrier
    s_mov_b64 exec, 1
    buffer_atomic_add v13, v10, s[56:59], s51 offen sc1
    s_mov_b64 exec, -1
    buffer_load_dwordx4 v2, s[12:15], s39 offen sc1 lds
    s_add_u32 m0, m0, 1024
    s_nop 0
    buffer_load_dwordx4 v2, s[12:15], s40 offen sc1 lds
    s_call_b64 s[76:77], PREP_a_issue_4
    s_add_u32 m0, m0, 1024
    s_add_u32 s39, s39, 229376
    buffer_load_dwordx4 v2, s[12:15], s39 offen sc1 lds
    s_add_u32 m0, m0, 1024
    s_add_u32 s40, s40, 229376
    buffer_load_dwordx4 v2, s[12:15], s40 offen sc1 lds
    s_add_u32 m0, m0, 1024
    s_add_u32 s39, s39, 229376
    buffer_load_dwordx4 v2, s[12:15], s39 offen sc1 lds
    s_add_u32 m0, m0, 1024
    s_add_u32 s40, s40, 229376
    buffer_load_dwordx4 v2, s[12:15], s40 offen sc1 lds
    s_add_u32 m0, m0, 1024
    s_add_u32 s39, s39, 229376
    buffer_load_dwordx4 v2, s[12:15], s39 offen sc1 lds
    s_add_u32 m0, m0, 1024
    s_add_u32 s40, s40, 229376
    buffer_load_dwordx4 v2, s[12:15], s40 offen sc1 lds
    s_mov_b32 m0, s19
    s_mov_b32 s39, s16
    s_mov_b32 s40, s17
    s_waitcnt vmcnt(9)
    s_barrier
    buffer_load_dwordx4 v2, s[12:15], s39 offen sc1 lds
    s_add_u32 m0, m0, 1024
    s_nop 0
    buffer_load_dwordx4 v2, s[12:15], s40 offen sc1 lds
    s_call_b64 s[76:77], PREP_a_issue_4
    s_add_u32 m0, m0, 1024
    s_add_u32 s39, s39, 229376
    buffer_load_dwordx4 v2, s[12:15], s39 offen sc1 lds
    s_add_u32 m0, m0, 1024
    s_add_u32 s40, s40, 229376
    buffer_load_dwordx4 v2, s[12:15], s40 offen sc1 lds
    s_add_u32 m0, m0, 1024
    s_add_u32 s39, s39, 229376
    buffer_load_dwordx4 v2, s[12:15], s39 offen sc1 lds
    s_add_u32 m0, m0, 1024
    s_add_u32 s40, s40, 229376
    buffer_load_dwordx4 v2, s[12:15], s40 offen sc1 lds
    s_add_u32 m0, m0, 1024
    s_add_u32 s39, s39, 229376
    buffer_load_dwordx4 v2, s[12:15], s39 offen sc1 lds
    s_add_u32 m0, m0, 1024
    s_add_u32 s40, s40, 229376
    buffer_load_dwordx4 v2, s[12:15], s40 offen sc1 lds
    s_mov_b32 m0, s19
    s_mov_b32 s39, s16
    s_mov_b32 s40, s17
    s_waitcnt vmcnt(8)
    s_barrier
    buffer_load_dwordx4 v2, s[12:15], s39 offen sc1 lds
    s_add_u32 m0, m0, 1024
    s_nop 0
    buffer_load_dwordx4 v2, s[12:15], s40 offen sc1 lds
    s_mov_b64 exec, 1
    buffer_load_dword v11, v10, s[56:59], 0 offen sc1
    s_mov_b64 exec, -1
    s_call_b64 s[76:77], PREP_a_issue_4
    s_add_u32 m0, m0, 1024
    s_add_u32 s39, s39, 229376
    buffer_load_dwordx4 v2, s[12:15], s39 offen sc1 lds
    s_add_u32 m0, m0, 1024
    s_add_u32 s40, s40, 229376
    buffer_load_dwordx4 v2, s[12:15], s40 offen sc1 lds
    s_add_u32 m0, m0, 1024
    s_add_u32 s39, s39, 229376
    buffer_load_dwordx4 v2, s[12:15], s39 offen sc1 lds
    s_add_u32 m0, m0, 1024
    s_add_u32 s40, s40, 229376
    buffer_load_dwordx4 v2, s[12:15], s40 offen sc1 lds
    s_add_u32 m0, m0, 1024
    s_add_u32 s39, s39, 229376
    buffer_load_dwordx4 v2, s[12:15], s39 offen sc1 lds
    s_add_u32 m0, m0, 1024
    s_add_u32 s40, s40, 229376
    buffer_load_dwordx4 v2, s[12:15], s40 offen sc1 lds
    s_mov_b32 m0, s19
    s_mov_b32 s39, s16
    s_mov_b32 s40, s17
    s_waitcnt vmcnt(9)
    s_barrier
    s_mov_b64 exec, 1
    buffer_atomic_add v13, v12, s[56:59], s51 offen sc1
    s_mov_b64 exec, -1
    buffer_load_dwordx4 v2, s[12:15], s39 offen sc1 lds
    s_add_u32 m0, m0, 1024
    s_nop 0
    buffer_load_dwordx4 v2, s[12:15], s40 offen sc1 lds
    s_call_b64 s[76:77], PREP_a_issue_4
    s_add_u32 m0, m0, 1024
    s_add_u32 s39, s39, 229376
    buffer_load_dwordx4 v2, s[12:15], s39 offen sc1 lds
    s_add_u32 m0, m0, 1024
    s_add_u32 s40, s40, 229376
    buffer_load_dwordx4 v2, s[12:15], s40 offen sc1 lds
    s_add_u32 m0, m0, 1024
    s_add_u32 s39, s39, 229376
    buffer_load_dwordx4 v2, s[12:15], s39 offen sc1 lds
    s_add_u32 m0, m0, 1024
    s_add_u32 s40, s40, 229376
    buffer_load_dwordx4 v2, s[12:15], s40 offen sc1 lds
    s_add_u32 m0, m0, 1024
    s_add_u32 s39, s39, 229376
    buffer_load_dwordx4 v2, s[12:15], s39 offen sc1 lds
    s_add_u32 m0, m0, 1024
    s_add_u32 s40, s40, 229376
    buffer_load_dwordx4 v2, s[12:15], s40 offen sc1 lds
    s_mov_b32 m0, s19
    s_mov_b32 s39, s16
    s_mov_b32 s40, s17
    s_waitcnt vmcnt(9)
    s_barrier
    buffer_load_dwordx4 v2, s[12:15], s39 offen sc1 lds
    s_add_u32 m0, m0, 1024
    s_nop 0
    buffer_load_dwordx4 v2, s[12:15], s40 offen sc1 lds
    s_waitcnt vmcnt(17)
    v_readfirstlane_b32 s53, v11
    s_add_u32 s54, s52, 8
    s_cmp_eq_u32 s53, s54
    s_cbranch_scc1 fok_61
    s_mov_b32 s53, 0
    s_add_u32 s54, s52, 8
    s_bfm_b64 exec, 1, 0
poll_62:
    buffer_load_dword v11, v10, s[56:59], 0 offen sc1
    s_waitcnt vmcnt(0)
    v_xor_b32 v11, s54, v11
    v_cmp_eq_u32 vcc, 0, v11
    s_nop 0
    s_cmp_eq_u64 vcc, exec
    s_cbranch_scc1 pok_63
    s_sleep 5
    s_add_u32 s53, s53, 1
    s_cmp_lt_u32 s53, s61
    s_cbranch_scc1 poll_62
    s_mov_b32 s61, 0
pok_63:
    s_mov_b64 exec, -1
fok_61:
    s_call_b64 s[76:77], PREP_a_issue_4
    s_add_u32 m0, m0, 1024
    s_add_u32 s39, s39, 229376
    buffer_load_dwordx4 v2, s[12:15], s39 offen sc1 lds
    s_add_u32 m0, m0, 1024
    s_add_u32 s40, s40, 229376
    buffer_load_dwordx4 v2, s[12:15], s40 offen sc1 lds
    s_add_u32 m0, m0, 1024
    s_add_u32 s39, s39, 229376
    buffer_load_dwordx4 v2, s[12:15], s39 offen sc1 lds
    s_add_u32 m0, m0, 1024
    s_add_u32 s40, s40, 229376
    buffer_load_dwordx4 v2, s[12:15], s40 offen sc1 lds
    s_add_u32 m0, m0, 1024
    s_add_u32 s39, s39, 229376
    buffer_load_dwordx4 v2, s[12:15], s39 offen sc1 lds
    s_add_u32 m0, m0, 1024
    s_add_u32 s40, s40, 229376
    buffer_load_dwordx4 v2, s[12:15], s40 offen sc1 lds
    s_mov_b32 m0, s19
    s_mov_b32 s39, s16
    s_mov_b32 s40, s17
    s_waitcnt vmcnt(8)
    s_barrier
    buffer_load_dwordx4 v2, s[12:15], s39 offen sc1 lds
    s_add_u32 m0, m0, 1024
    s_nop 0
    buffer_load_dwordx4 v2, s[12:15], s40 offen sc1 lds
    s_mov_b32 s43, 1
ld_64:
    s_add_u32 s19, s41, s42
    v_readlane_b32 s16, v249, s44
    v_readlane_b32 s17, v250, s44
    s_add_u32 s16, s16, s38
    s_add_u32 s17, s17, s38
    s_add_u32 s44, s44, 1
    s_add_u32 s42, s42, 16384
    s_cmp_eq_u32 s42, 49152
    s_cselect_b32 s42, 0, s42
    s_add_u32 m0, m0, 1024
    s_add_u32 s39, s39, 229376
    buffer_load_dwordx4 v2, s[12:15], s39 offen sc1 lds
    s_add_u32 m0, m0, 1024
    s_add_u32 s40, s40, 229376
    buffer_load_dwordx4 v2, s[12:15], s40 offen sc1 lds
    s_add_u32 m0, m0, 1024
    s_add_u32 s39, s39, 229376
    buffer_load_dwordx4 v2, s[12:15], s39 offen sc1 lds
    s_add_u32 m0, m0, 1024
    s_add_u32 s40, s40, 229376
    buffer_load_dwordx4 v2, s[12:15], s40 offen sc1 lds
    s_add_u32 m0, m0, 1024
    s_add_u32 s39, s39, 229376
    buffer_load_dwordx4 v2, s[12:15], s39 offen sc1 lds
    s_add_u32 m0, m0, 1024
    s_add_u32 s40, s40, 229376
    buffer_load_dwordx4 v2, s[12:15], s40 offen sc1 lds
    s_mov_b32 m0, s19
    s_mov_b32 s39, s16
    s_mov_b32 s40, s17
    s_waitcnt vmcnt(8)
    s_barrier
    buffer_load_dwordx4 v2, s[12:15], s39 offen sc1 lds
    s_add_u32 m0, m0, 1024
    s_nop 0
    buffer_load_dwordx4 v2, s[12:15], s40 offen sc1 lds
    s_add_u32 s43, s43, 1
    s_cmp_lt_u32 s43, 4
    s_cbranch_scc1 ld_64
    s_call_b64 s[76:77], PREP_a_issue_4
    s_add_u32 m0, m0, 1024
    s_add_u32 s39, s39, 229376
    buffer_load_dwordx4 v2, s[12:15], s39 offen sc1 lds
    s_add_u32 m0, m0, 1024
    s_add_u32 s40, s40, 229376
    buffer_load_dwordx4 v2, s[12:15], s40 offen sc1 lds
    s_add_u32 m0, m0, 1024
    s_add_u32 s39, s39, 229376
    buffer_load_dwordx4 v2, s[12:15], s39 offen sc1 lds
    s_add_u32 m0, m0, 1024
    s_add_u32 s40, s40, 229376
    buffer_load_dwordx4 v2, s[12:15], s40 offen sc1 lds
    s_add_u32 m0, m0, 1024
    s_add_u32 s39, s39, 229376
    buffer_load_dwordx4 v2, s[12:15], s39 offen sc1 lds
    s_add_u32 m0, m0, 1024
    s_add_u32 s40, s40, 229376
    buffer_load_dwordx4 v2, s[12:15], s40 offen sc1 lds
    s_mov_b32 m0, s19
    s_mov_b32 s39, s16
    s_mov_b32 s40, s17
    s_waitcnt vmcnt(8)
    s_barrier
    buffer_load_dwordx4 v2, s[12:15], s39 offen sc1 lds
    s_add_u32 m0, m0, 1024
    s_nop 0
    buffer_load_dwordx4 v2, s[12:15], s40 offen sc1 lds
    s_mov_b64 exec, 1
    buffer_load_dword v11, v12, s[56:59], 0 offen sc1
    s_mov_b64 exec, -1
    s_call_b64 s[76:77], PREP_a_issue_4
    s_add_u32 m0, m0, 1024
    s_add_u32 s39, s39, 229376
    buffer_load_dwordx4 v2, s[12:15], s39 offen sc1 lds
    s_add_u32 m0, m0, 1024
    s_add_u32 s40, s40, 229376
    buffer_load_dwordx4 v2, s[12:15], s40 offen sc1 lds
    s_add_u32 m0, m0, 1024
    s_add_u32 s39, s39, 229376
    buffer_load_dwordx4 v2, s[12:15], s39 offen sc1 lds
    s_add_u32 m0, m0, 1024
    s_add_u32 s40, s40, 229376
    buffer_load_dwordx4 v2, s[12:15], s40 offen sc1 lds
    s_add_u32 m0, m0, 1024
    s_add_u32 s39, s39, 229376
    buffer_load_dwordx4 v2, s[12:15], s39 offen sc1 lds
    s_add_u32 m0, m0, 1024
    s_add_u32 s40, s40, 229376
    buffer_load_dwordx4 v2, s[12:15], s40 offen sc1 lds
    s_mov_b32 m0, s19
    s_mov_b32 s39, s16
    s_mov_b32 s40, s17
    s_waitcnt vmcnt(9)
    s_barrier
    buffer_load_dwordx4 v2, s[12:15], s39 offen sc1 lds
    s_add_u32 m0, m0, 1024
    s_nop 0
    buffer_load_dwordx4 v2, s[12:15], s40 offen sc1 lds
    s_call_b64 s[76:77], PREP_a_issue_4
    s_add_u32 m0, m0, 1024
    s_add_u32 s39, s39, 229376
    buffer_load_dwordx4 v2, s[12:15], s39 offen sc1 lds
    s_add_u32 m0, m0, 1024
    s_add_u32 s40, s40, 229376
    buffer_load_dwordx4 v2, s[12:15], s40 offen sc1 lds
    s_add_u32 m0, m0, 1024
    s_add_u32 s39, s39, 229376
    buffer_load_dwordx4 v2, s[12:15], s39 offen sc1 lds
    s_add_u32 m0, m0, 1024
    s_add_u32 s40, s40, 229376
    buffer_load_dwordx4 v2, s[12:15], s40 offen sc1 lds
    s_add_u32 m0, m0, 1024
    s_add_u32 s39, s39, 229376
    buffer_load_dwordx4 v2, s[12:15], s39 offen sc1 lds
    s_add_u32 m0, m0, 1024
    s_add_u32 s40, s40, 229376
    buffer_load_dwordx4 v2, s[12:15], s40 offen sc1 lds
    s_mov_b32 m0, s19
    s_mov_b32 s39, s16
    s_mov_b32 s40, s17
    s_waitcnt vmcnt(8)
    s_barrier
    buffer_load_dwordx4 v2, s[12:15], s39 offen sc1 lds
    s_add_u32 m0, m0, 1024
    s_nop 0
    buffer_load_dwordx4 v2, s[12:15], s40 offen sc1 lds
    s_waitcnt vmcnt(16)
    v_readfirstlane_b32 s53, v11
    s_add_u32 s54, s52, 8
    s_cmp_eq_u32 s53, s54
    s_cbranch_scc1 fok_65
    s_mov_b32 s53, 0
    s_add_u32 s54, s52, 8
    s_bfm_b64 exec, 1, 0
poll_66:
    buffer_load_dword v11, v12, s[56:59], 0 offen sc1
    s_waitcnt vmcnt(0)
    v_xor_b32 v11, s54, v11
    v_cmp_eq_u32 vcc, 0, v11
    s_nop 0
    s_cmp_eq_u64 vcc, exec
    s_cbranch_scc1 pok_67
    s_sleep 5
    s_add_u32 s53, s53, 1
    s_cmp_lt_u32 s53, s61
    s_cbranch_scc1 poll_66
    s_mov_b32 s61, 0
pok_67:
    s_mov_b64 exec, -1
fok_65:
    s_call_b64 s[76:77], PREP_a_issue_4
    s_add_u32 m0, m0, 1024
    s_add_u32 s39, s39, 229376
    buffer_load_dwordx4 v2, s[12:15], s39 offen sc1 lds
    s_add_u32 m0, m0, 1024
    s_add_u32 s40, s40, 229376
    buffer_load_dwordx4 v2, s[12:15], s40 offen sc1 lds
    s_add_u32 m0, m0, 1024
    s_add_u32 s39, s39, 229376
    buffer_load_dwordx4 v2, s[12:15], s39 offen sc1 lds
    s_add_u32 m0, m0, 1024
    s_add_u32 s40, s40, 229376
    buffer_load_dwordx4 v2, s[12:15], s40 offen sc1 lds
    s_add_u32 m0, m0, 1024
    s_add_u32 s39, s39, 229376
    buffer_load_dwordx4 v2, s[12:15], s39 offen sc1 lds
    s_add_u32 m0, m0, 1024
    s_add_u32 s40, s40, 229376
    buffer_load_dwordx4 v2, s[12:15], s40 offen sc1 lds
    s_mov_b32 m0, s19
    s_mov_b32 s39, s16
    s_mov_b32 s40, s17
    s_waitcnt vmcnt(8)
    s_barrier
    buffer_load_dwordx4 v2, s[12:15], s39 offen sc1 lds
    s_add_u32 m0, m0, 1024
    s_nop 0
    buffer_load_dwordx4 v2, s[12:15], s40 offen sc1 lds
    s_mov_b32 s43, 1
ld_68:
    s_add_u32 s19, s41, s42
    v_readlane_b32 s16, v249, s44
    v_readlane_b32 s17, v250, s44
    s_add_u32 s16, s16, s38
    s_add_u32 s17, s17, s38
    s_add_u32 s44, s44, 1
    s_add_u32 s42, s42, 16384
    s_cmp_eq_u32 s42, 49152
    s_cselect_b32 s42, 0, s42
    s_add_u32 m0, m0, 1024
    s_add_u32 s39, s39, 229376
    buffer_load_dwordx4 v2, s[12:15], s39 offen sc1 lds
    s_add_u32 m0, m0, 1024
    s_add_u32 s40, s40, 229376
    buffer_load_dwordx4 v2, s[12:15], s40 offen sc1 lds
    s_add_u32 m0, m0, 1024
    s_add_u32 s39, s39, 229376
    buffer_load_dwordx4 v2, s[12:15], s39 offen sc1 lds
    s_add_u32 m0, m0, 1024
    s_add_u32 s40, s40, 229376
    buffer_load_dwordx4 v2, s[12:15], s40 offen sc1 lds
    s_add_u32 m0, m0, 1024
    s_add_u32 s39, s39, 229376
    buffer_load_dwordx4 v2, s[12:15], s39 offen sc1 lds
    s_add_u32 m0, m0, 1024
    s_add_u32 s40, s40, 229376
    buffer_load_dwordx4 v2, s[12:15], s40 offen sc1 lds
    s_mov_b32 m0, s19
    s_mov_b32 s39, s16
    s_mov_b32 s40, s17
    s_waitcnt vmcnt(8)
    s_barrier
    buffer_load_dwordx4 v2, s[12:15], s39 offen sc1 lds
    s_add_u32 m0, m0, 1024
    s_nop 0
    buffer_load_dwordx4 v2, s[12:15], s40 offen sc1 lds
    s_add_u32 s43, s43, 1
    s_cmp_lt_u32 s43, 5
    s_cbranch_scc1 ld_68
    s_call_b64 s[76:77], PREP_a_issue_4
    s_add_u32 m0, m0, 1024
    s_add_u32 s39, s39, 229376
    buffer_load_dwordx4 v2, s[12:15], s39 offen sc1 lds
    s_add_u32 m0, m0, 1024
    s_add_u32 s40, s40, 229376
    buffer_load_dwordx4 v2, s[12:15], s40 offen sc1 lds
    s_add_u32 m0, m0, 1024
    s_add_u32 s39, s39, 229376
    buffer_load_dwordx4 v2, s[12:15], s39 offen sc1 lds
    s_add_u32 m0, m0, 1024
    s_add_u32 s40, s40, 229376
    buffer_load_dwordx4 v2, s[12:15], s40 offen sc1 lds
    s_add_u32 m0, m0, 1024
    s_add_u32 s39, s39, 229376
    buffer_load_dwordx4 v2, s[12:15], s39 offen sc1 lds
    s_add_u32 m0, m0, 1024
    s_add_u32 s40, s40, 229376
    buffer_load_dwordx4 v2, s[12:15], s40 offen sc1 lds
    s_mov_b32 m0, s19
    s_mov_b32 s39, s16
    s_mov_b32 s40, s17
    s_waitcnt vmcnt(8)
    s_barrier
    buffer_load_dwordx4 v2, s[12:15], s39 offen sc1 lds
    s_add_u32 m0, m0, 1024
    s_nop 0
    buffer_load_dwordx4 v2, s[12:15], s40 offen sc1 lds
    s_mov_b64 exec, 1
    buffer_load_dword v11, v15, s[56:59], 0 offen sc1
    s_mov_b64 exec, -1
    s_call_b64 s[76:77], PREP_a_issue_4
    s_add_u32 m0, m0, 1024
    s_add_u32 s39, s39, 229376
    buffer_load_dwordx4 v2, s[12:15], s39 offen sc1 lds
    s_add_u32 m0, m0, 1024
    s_add_u32 s40, s40, 229376
    buffer_load_dwordx4 v2, s[12:15], s40 offen sc1 lds
    s_add_u32 m0, m0, 1024
    s_add_u32 s39, s39, 229376
    buffer_load_dwordx4 v2, s[12:15], s39 offen sc1 lds
    s_add_u32 m0, m0, 1024
    s_add_u32 s40, s40, 229376
    buffer_load_dwordx4 v2, s[12:15], s40 offen sc1 lds
    s_add_u32 m0, m0, 1024
    s_add_u32 s39, s39, 229376
    buffer_load_dwordx4 v2, s[12:15], s39 offen sc1 lds
    s_add_u32 m0, m0, 1024
    s_add_u32 s40, s40, 229376
    buffer_load_dwordx4 v2, s[12:15], s40 offen sc1 lds
    s_mov_b32 m0, s19
    s_mov_b32 s39, s16
    s_mov_b32 s40, s17
    s_waitcnt vmcnt(9)
    s_barrier
    buffer_load_dwordx4 v2, s[12:15], s39 offen sc1 lds
    s_add_u32 m0, m0, 1024
    s_nop 0
    buffer_load_dwordx4 v2, s[12:15], s40 offen sc1 lds
    s_call_b64 s[76:77], PREP_a_issue_4
    s_add_u32 m0, m0, 1024
    s_add_u32 s39, s39, 229376
    buffer_load_dwordx4 v2, s[12:15], s39 offen sc1 lds
    s_add_u32 m0, m0, 1024
    s_add_u32 s40, s40, 229376
    buffer_load_dwordx4 v2, s[12:15], s40 offen sc1 lds
    s_add_u32 m0, m0, 1024
    s_add_u32 s39, s39, 229376
    buffer_load_dwordx4 v2, s[12:15], s39 offen sc1 lds
    s_add_u32 m0, m0, 1024
    s_add_u32 s40, s40, 229376
    buffer_load_dwordx4 v2, s[12:15], s40 offen sc1 lds
    s_add_u32 m0, m0, 1024
    s_add_u32 s39, s39, 229376
    buffer_load_dwordx4 v2, s[12:15], s39 offen sc1 lds
    s_add_u32 m0, m0, 1024
    s_add_u32 s40, s40, 229376
    buffer_load_dwordx4 v2, s[12:15], s40 offen sc1 lds
    s_mov_b32 m0, s19
    s_mov_b32 s39, s16
    s_mov_b32 s40, s17
    s_waitcnt vmcnt(8)
    s_barrier
    buffer_load_dwordx4 v2, s[12:15], s39 offen sc1 lds
    s_add_u32 m0, m0, 1024
    s_nop 0
    buffer_load_dwordx4 v2, s[12:15], s40 offen sc1 lds
    s_waitcnt vmcnt(16)
    v_readfirstlane_b32 s53, v11
    s_add_u32 s54, s52, 8
    s_cmp_eq_u32 s53, s54
    s_cbranch_scc1 fok_69
    s_mov_b32 s53, 0
    s_add_u32 s54, s52, 8
    s_bfm_b64 exec, 1, 0
poll_70:
    buffer_load_dword v11, v15, s[56:59], 0 offen sc1
    s_waitcnt vmcnt(0)
    v_xor_b32 v11, s54, v11
    v_cmp_eq_u32 vcc, 0, v11
    s_nop 0
    s_cmp_eq_u64 vcc, exec
    s_cbranch_scc1 pok_71
    s_sleep 5
    s_add_u32 s53, s53, 1
    s_cmp_lt_u32 s53, s61
    s_cbranch_scc1 poll_70
    s_mov_b32 s61, 0
pok_71:
    s_mov_b64 exec, -1
fok_69:
    s_call_b64 s[76:77], PREP_a_issue_4
    s_add_u32 m0, m0, 1024
    s_add_u32 s39, s39, 229376
    buffer_load_dwordx4 v2, s[12:15], s39 offen sc1 lds
    s_add_u32 m0, m0, 1024
    s_add_u32 s40, s40, 229376
    buffer_load_dwordx4 v2, s[12:15], s40 offen sc1 lds
    s_add_u32 m0, m0, 1024
    s_add_u32 s39, s39, 229376
    buffer_load_dwordx4 v2, s[12:15], s39 offen sc1 lds
    s_add_u32 m0, m0, 1024
    s_add_u32 s40, s40, 229376
    buffer_load_dwordx4 v2, s[12:15], s40 offen sc1 lds
    s_add_u32 m0, m0, 1024
    s_add_u32 s39, s39, 229376
    buffer_load_dwordx4 v2, s[12:15], s39 offen sc1 lds
    s_add_u32 m0, m0, 1024
    s_add_u32 s40, s40, 229376
    buffer_load_dwordx4 v2, s[12:15], s40 offen sc1 lds
    s_mov_b32 m0, s19
    s_mov_b32 s39, s16
    s_mov_b32 s40, s17
    s_waitcnt vmcnt(8)
    s_barrier
    buffer_load_dwordx4 v2, s[12:15], s39 offen sc1 lds
    s_add_u32 m0, m0, 1024
    s_nop 0
    buffer_load_dwordx4 v2, s[12:15], s40 offen sc1 lds
    s_mov_b32 s43, 1
ld_72:
    s_add_u32 s19, s41, s42
    v_readlane_b32 s16, v249, s44
    v_readlane_b32 s17, v250, s44
    s_add_u32 s16, s16, s38
    s_add_u32 s17, s17, s38
    s_add_u32 s44, s44, 1
    s_add_u32 s42, s42, 16384
    s_cmp_eq_u32 s42, 49152
    s_cselect_b32 s42, 0, s42
    s_add_u32 m0, m0, 1024
    s_add_u32 s39, s39, 229376
    buffer_load_dwordx4 v2, s[12:15], s39 offen sc1 lds
    s_add_u32 m0, m0, 1024
    s_add_u32 s40, s40, 229376
    buffer_load_dwordx4 v2, s[12:15], s40 offen sc1 lds
    s_add_u32 m0, m0, 1024
    s_add_u32 s39, s39, 229376
    buffer_load_dwordx4 v2, s[12:15], s39 offen sc1 lds
    s_add_u32 m0, m0, 1024
    s_add_u32 s40, s40, 229376
    buffer_load_dwordx4 v2, s[12:15], s40 offen sc1 lds
    s_add_u32 m0, m0, 1024
    s_add_u32 s39, s39, 229376
    buffer_load_dwordx4 v2, s[12:15], s39 offen sc1 lds
    s_add_u32 m0, m0, 1024
    s_add_u32 s40, s40, 229376
    buffer_load_dwordx4 v2, s[12:15], s40 offen sc1 lds
    s_mov_b32 m0, s19
    s_mov_b32 s39, s16
    s_mov_b32 s40, s17
    s_waitcnt vmcnt(8)
    s_barrier
    buffer_load_dwordx4 v2, s[12:15], s39 offen sc1 lds
    s_add_u32 m0, m0, 1024
    s_nop 0
    buffer_load_dwordx4 v2, s[12:15], s40 offen sc1 lds
    s_add_u32 s43, s43, 1
    s_cmp_lt_u32 s43, 3
    s_cbranch_scc1 ld_72
    s_call_b64 s[76:77], PREP_a_issue_4
    s_add_u32 m0, m0, 1024
    s_add_u32 s39, s39, 229376
    buffer_load_dwordx4 v2, s[12:15], s39 offen sc1 lds
    s_add_u32 m0, m0, 1024
    s_add_u32 s40, s40, 229376
    buffer_load_dwordx4 v2, s[12:15], s40 offen sc1 lds
    s_add_u32 m0, m0, 1024
    s_add_u32 s39, s39, 229376
    buffer_load_dwordx4 v2, s[12:15], s39 offen sc1 lds
    s_add_u32 m0, m0, 1024
    s_add_u32 s40, s40, 229376
    buffer_load_dwordx4 v2, s[12:15], s40 offen sc1 lds
    s_add_u32 m0, m0, 1024
    s_add_u32 s39, s39, 229376
    buffer_load_dwordx4 v2, s[12:15], s39 offen sc1 lds
    s_add_u32 m0, m0, 1024
    s_add_u32 s40, s40, 229376
    buffer_load_dwordx4 v2, s[12:15], s40 offen sc1 lds
    s_mov_b32 m0, s19
    s_mov_b32 s39, s16
    s_mov_b32 s40, s17
    s_waitcnt vmcnt(8)
    s_barrier
    buffer_load_dwordx4 v2, s[12:15], s39 offen sc1 lds
    s_add_u32 m0, m0, 1024
    s_nop 0
    buffer_load_dwordx4 v2, s[12:15], s40 offen sc1 lds
    s_add_u32 m0, m0, 1024
    s_add_u32 s39, s39, 229376
    buffer_load_dwordx4 v2, s[12:15], s39 offen sc1 lds
    s_add_u32 m0, m0, 1024
    s_add_u32 s40, s40, 229376
    buffer_load_dwordx4 v2, s[12:15], s40 offen sc1 lds
    s_add_u32 m0, m0, 1024
    s_add_u32 s39, s39, 229376
    buffer_load_dwordx4 v2, s[12:15], s39 offen sc1 lds
    s_add_u32 m0, m0, 1024
    s_add_u32 s40, s40, 229376
    buffer_load_dwordx4 v2, s[12:15], s40 offen sc1 lds
    s_add_u32 m0, m0, 1024
    s_add_u32 s39, s39, 229376
    buffer_load_dwordx4 v2, s[12:15], s39 offen sc1 lds
    s_add_u32 m0, m0, 1024
    s_add_u32 s40, s40, 229376
    buffer_load_dwordx4 v2, s[12:15], s40 offen sc1 lds
    s_waitcnt vmcnt(8)
    s_barrier
    s_waitcnt vmcnt(0)
    s_barrier
    s_cmp_eq_u32 s60, 1
    s_cbranch_scc1 K_fin
    s_barrier
    s_branch NEXT
WLOAD:
    s_cmp_eq_u32 s60, 1
    s_cbranch_scc1 WL_1
    s_mov_b64 s[12:13], s[68:69]
    s_mov_b32 s14, 2097152
    s_mov_b32 s15, 0x20000
    s_and_b32 s35, s30, 1
    s_mul_i32 s38, s99, 128
    s_mul_i32 s41, s35, 65536
    s_add_u32 s38, s38, s41
    s_mul_i32 s41, s35, 4096
    s_add_u32 s41, s41, 24576
    s_mov_b32 s42, 0
    s_mov_b32 s44, s67
    s_branch WL_2
WL_1:
    s_mov_b64 s[12:13], s[68:69]
    s_mov_b32 s14, 2097152
    s_mov_b32 s15, 0x20000
    s_and_b32 s35, s30, 1
    s_mul_i32 s38, s99, 128
    s_mul_i32 s41, s35, 65536
    s_add_u32 s38, s38, s41
    s_mul_i32 s41, s35, 4096
    s_add_u32 s41, s41, 24576
    s_mov_b32 s42, 0
    s_mov_b32 s44, s67
WL_2:
    s_waitcnt vmcnt(0)
    s_barrier
    s_call_b64 s[76:77], SUB_after_g1
    s_barrier
    s_waitcnt vmcnt(0)
    s_barrier
    s_call_b64 s[76:77], SUB_after_g2
    s_mov_b64 s[12:13], s[72:73]
    s_mov_b32 s14, 7340032
    s_mov_b32 s15, 0x20000
    s_and_b32 s35, s30, 1
    s_mul_i32 s38, s29, 448
    s_mul_i32 s41, s35, 229376
    s_add_u32 s38, s38, s41
    s_mul_i32 s41, s35, 14336
    s_add_u32 s41, s41, 73728
    s_mov_b32 s42, 0
    s_mov_b32 s44, 0
    s_mov_b32 s42, 28672
    s_mov_b32 s44, 2
    s_add_u32 s19, s41, s42
    v_readlane_b32 s16, v248, s44
    s_nop 0
    s_add_u32 s16, s16, s38
    s_add_u32 s44, s44, 1
    s_and_b32 s44, s44, 15
    s_add_u32 s42, s42, 28672
    s_cmp_eq_u32 s42, 86016
    s_cselect_b32 s42, 0, s42
    s_mov_b32 m0, s19
    s_mov_b32 s39, s16
    s_waitcnt vmcnt(0)
    s_barrier
    buffer_load_dwordx4 v241, s[12:15], s39 offen lds
    s_add_u32 m0, m0, 1024
    s_nop 0
    buffer_load_dwordx4 v242, s[12:15], s39 offen lds
    s_add_u32 m0, m0, 1024
    s_nop 0
    buffer_load_dwordx4 v243, s[12:15], s39 offen lds
    s_mov_b32 s43, 1
ld_73:
    s_add_u32 s19, s41, s42
    v_readlane_b32 s16, v248, s44
    s_nop 0
    s_add_u32 s16, s16, s38
    s_add_u32 s44, s44, 1
    s_and_b32 s44, s44, 15
    s_add_u32 s42, s42, 28672
    s_cmp_eq_u32 s42, 86016
    s_cselect_b32 s42, 0, s42
    s_add_u32 m0, m0, 1024
    s_nop 0
    buffer_load_dwordx4 v244, s[12:15], s39 offen lds
    s_add_u32 m0, m0, 1024
    s_nop 0
    buffer_load_dwordx4 v245, s[12:15], s39 offen lds
    s_add_u32 m0, m0, 1024
    s_nop 0
    buffer_load_dwordx4 v246, s[12:15], s39 offen lds
    s_add_u32 m0, m0, 1024
    s_nop 0
    buffer_load_dwordx4 v247, s[12:15], s39 offen lds
    s_add_u32 m0, m0, 1024
    s_add_u32 s39, s39, 114688
    buffer_load_dwordx4 v241, s[12:15], s39 offen lds
    s_add_u32 m0, m0, 1024
    s_nop 0
    buffer_load_dwordx4 v242, s[12:15], s39 offen lds
    s_add_u32 m0, m0, 1024
    s_nop 0
    buffer_load_dwordx4 v243, s[12:15], s39 offen lds
    s_add_u32 m0, m0, 1024
    s_nop 0
    buffer_load_dwordx4 v244, s[12:15], s39 offen lds
    s_add_u32 m0, m0, 1024
    s_nop 0
    buffer_load_dwordx4 v245, s[12:15], s39 offen lds
    s_add_u32 m0, m0, 1024
    s_nop 0
    buffer_load_dwordx4 v246, s[12:15], s39 offen lds
    s_add_u32 m0, m0, 1024
    s_nop 0
    buffer_load_dwordx4 v247, s[12:15], s39 offen lds
    s_mov_b32 m0, s19
    s_mov_b32 s39, s16
    s_waitcnt vmcnt(14)
    s_barrier
    buffer_load_dwordx4 v241, s[12:15], s39 offen lds
    s_add_u32 m0, m0, 1024
    s_nop 0
    buffer_load_dwordx4 v242, s[12:15], s39 offen lds
    s_add_u32 m0, m0, 1024
    s_nop 0
    buffer_load_dwordx4 v243, s[12:15], s39 offen lds
    s_add_u32 s43, s43, 1
    s_cmp_lt_u32 s43, 13
    s_cbranch_scc1 ld_73
    s_add_u32 s19, s41, s42
    v_readlane_b32 s16, v248, s44
    s_nop 0
    s_add_u32 s16, s16, s38
    s_add_u32 s44, s44, 1
    s_and_b32 s44, s44, 15
    s_add_u32 s42, s42, 28672
    s_cmp_eq_u32 s42, 86016
    s_cselect_b32 s42, 0, s42
    s_add_u32 m0, m0, 1024
    s_nop 0
    buffer_load_dwordx4 v244, s[12:15], s39 offen lds
    s_add_u32 m0, m0, 1024
    s_nop 0
    buffer_load_dwordx4 v245, s[12:15], s39 offen lds
    s_add_u32 m0, m0, 1024
    s_nop 0
    buffer_load_dwordx4 v246, s[12:15], s39 offen lds
    s_add_u32 m0, m0, 1024
    s_nop 0
    buffer_load_dwordx4 v247, s[12:15], s39 offen lds
    s_add_u32 m0, m0, 1024
    s_add_u32 s39, s39, 114688
    buffer_load_dwordx4 v241, s[12:15], s39 offen lds
    s_add_u32 m0, m0, 1024
    s_nop 0
    buffer_load_dwordx4 v242, s[12:15], s39 offen lds
    s_add_u32 m0, m0, 1024
    s_nop 0
    buffer_load_dwordx4 v243, s[12:15], s39 offen lds
    s_add_u32 m0, m0, 1024
    s_nop 0
    buffer_load_dwordx4 v244, s[12:15], s39 offen lds
    s_add_u32 m0, m0, 1024
    s_nop 0
    buffer_load_dwordx4 v245, s[12:15], s39 offen lds
    s_add_u32 m0, m0, 1024
    s_nop 0
    buffer_load_dwordx4 v246, s[12:15], s39 offen lds
    s_add_u32 m0, m0, 1024
    s_nop 0
    buffer_load_dwordx4 v247, s[12:15], s39 offen lds
    s_mov_b32 m0, s19
    s_mov_b32 s39, s16
    s_waitcnt vmcnt(14)
    s_barrier
    buffer_load_dwordx4 v241, s[12:15], s39 offen lds
    s_add_u32 m0, m0, 1024
    s_nop 0
    buffer_load_dwordx4 v242, s[12:15], s39 offen lds
    s_add_u32 m0, m0, 1024
    s_nop 0
    buffer_load_dwordx4 v243, s[12:15], s39 offen lds
    s_add_u32 m0, m0, 1024
    s_nop 0
    buffer_load_dwordx4 v244, s[12:15], s39 offen lds
    s_add_u32 m0, m0, 1024
    s_nop 0
    buffer_load_dwordx4 v245, s[12:15], s39 offen lds
    s_add_u32 m0, m0, 1024
    s_nop 0
    buffer_load_dwordx4 v246, s[12:15], s39 offen lds
    s_add_u32 m0, m0, 1024
    s_nop 0
    buffer_load_dwordx4 v247, s[12:15], s39 offen lds
    s_add_u32 m0, m0, 1024
    s_add_u32 s39, s39, 114688
    buffer_load_dwordx4 v241, s[12:15], s39 offen lds
    s_add_u32 m0, m0, 1024
    s_nop 0
    buffer_load_dwordx4 v242, s[12:15], s39 offen lds
    s_add_u32 m0, m0, 1024
    s_nop 0
    buffer_load_dwordx4 v243, s[12:15], s39 offen lds
    s_add_u32 m0, m0, 1024
    s_nop 0
    buffer_load_dwordx4 v244, s[12:15], s39 offen lds
    s_add_u32 m0, m0, 1024
    s_nop 0
    buffer_load_dwordx4 v245, s[12:15], s39 offen lds
    s_add_u32 m0, m0, 1024
    s_nop 0
    buffer_load_dwordx4 v246, s[12:15], s39 offen lds
    s_add_u32 m0, m0, 1024
    s_nop 0
    buffer_load_dwordx4 v247, s[12:15], s39 offen lds
    s_waitcnt vmcnt(14)
    s_barrier
    s_call_b64 s[76:77], SUB_r_pre0
    s_waitcnt vmcnt(8)
    s_barrier
    s_barrier
    s_mov_b64 s[12:13], s[74:75]
    s_mov_b32 s14, 7340032
    s_mov_b32 s15, 0x20000
    s_and_b32 s35, s30, 1
    s_mul_i32 s38, s33, 256
    s_mul_i32 s41, s31, 3670016
    s_add_u32 s38, s38, s41
    s_mul_i32 s41, s35, 8192
    s_add_u32 s41, s41, 49152
    s_mov_b32 s42, 0
    s_mov_b32 s44, 0
    s_mov_b32 s49, s44
    s_and_b32 s43, s28, 3
    s_mul_i32 s43, s43, 6
    s_lshr_b32 s43, s43, 2
    s_mov_b32 s50, 0
wpre_74:
    s_mul_i32 s42, s43, 16384
    s_add_u32 s44, s49, s43
    s_mov_b32 s45, 8192
    s_add_u32 s19, s41, s42
    v_readlane_b32 s16, v249, s44
    s_nop 0
    s_bitcmp1_b32 s16, 0
    s_cselect_b32 s17, 16384, s45
    s_cselect_b32 s18, -40960, s45
    s_andn2_b32 s16, s16, 1
    s_add_u32 s16, s16, s38
    s_add_u32 s44, s44, 1
    s_add_u32 s42, s42, 16384
    s_cmp_eq_u32 s42, 98304
    s_cselect_b32 s42, 0, s42
    s_mov_b32 m0, s19
    s_mov_b32 s39, s16
    s_mov_b32 s32, s17
    s_mov_b32 s3, s18
    buffer_load_dwordx4 v239, s[12:15], s39 offen lds
    s_add_u32 m0, m0, 1024
    s_add_u32 s39, s39, s32
    buffer_load_dwordx4 v240, s[12:15], s39 offen lds
    s_add_u32 m0, m0, 1024
    s_add_u32 s39, s39, s32
    buffer_load_dwordx4 v239, s[12:15], s39 offen lds
    s_add_u32 m0, m0, 1024
    s_add_u32 s39, s39, s32
    buffer_load_dwordx4 v240, s[12:15], s39 offen lds
    s_waitcnt vmcnt(6)
    s_add_u32 m0, m0, 1024
    s_add_u32 s39, s39, s3
    buffer_load_dwordx4 v239, s[12:15], s39 offen lds
    s_add_u32 m0, m0, 1024
    s_add_u32 s39, s39, s32
    buffer_load_dwordx4 v240, s[12:15], s39 offen lds
    s_add_u32 m0, m0, 1024
    s_add_u32 s39, s39, s32
    buffer_load_dwordx4 v239, s[12:15], s39 offen lds
    s_add_u32 m0, m0, 1024
    s_add_u32 s39, s39, s32
    buffer_load_dwordx4 v240, s[12:15], s39 offen lds
    s_waitcnt vmcnt(6)
    s_add_u32 s43, s43, 1
    s_cmp_eq_u32 s43, 6
    s_cselect_b32 s43, 0, s43
    s_add_u32 s50, s50, 1
    s_cmp_lt_u32 s50, 6
    s_cbranch_scc1 wpre_74
    s_mov_b32 s42, 0
    s_add_u32 s44, s49, 6
    s_cmp_eq_u32 s60, 1
    s_cbranch_scc1 WL_t1
    s_call_b64 s[76:77], PREP_w_issue_4
    s_mov_b32 m0, s19
    s_mov_b32 s39, s16
    s_mov_b32 s32, s17
    s_mov_b32 s3, s18
    s_waitcnt vmcnt(0)
    s_barrier
    s_waitcnt vmcnt(0)
    s_barrier
    buffer_load_dwordx4 v239, s[12:15], s39 offen lds
    s_add_u32 m0, m0, 1024
    s_add_u32 s39, s39, s32
    buffer_load_dwordx4 v240, s[12:15], s39 offen lds
    s_call_b64 s[76:77], PREP_w_issue_4
    s_add_u32 m0, m0, 1024
    s_add_u32 s39, s39, s32
    buffer_load_dwordx4 v239, s[12:15], s39 offen lds
    s_add_u32 m0, m0, 1024
    s_add_u32 s39, s39, s32
    buffer_load_dwordx4 v240, s[12:15], s39 offen lds
    s_add_u32 m0, m0, 1024
    s_add_u32 s39, s39, s3
    buffer_load_dwordx4 v239, s[12:15], s39 offen lds
    s_add_u32 m0, m0, 1024
    s_add_u32 s39, s39, s32
    buffer_load_dwordx4 v240, s[12:15], s39 offen lds
    s_add_u32 m0, m0, 1024
    s_add_u32 s39, s39, s32
    buffer_load_dwordx4 v239, s[12:15], s39 offen lds
    s_add_u32 m0, m0, 1024
    s_add_u32 s39, s39, s32
    buffer_load_dwordx4 v240, s[12:15], s39 offen lds
    s_mov_b32 m0, s19
    s_mov_b32 s39, s16
    s_mov_b32 s32, s17
    s_mov_b32 s3, s18
    s_waitcnt vmcnt(8)
    s_barrier
    buffer_load_dwordx4 v239, s[12:15], s39 offen lds
    s_add_u32 m0, m0, 1024
    s_add_u32 s39, s39, s32
    buffer_load_dwordx4 v240, s[12:15], s39 offen lds
    s_call_b64 s[76:77], PREP_w_issue_4
    s_add_u32 m0, m0, 1024
    s_add_u32 s39, s39, s32
    buffer_load_dwordx4 v239, s[12:15], s39 offen lds
    s_add_u32 m0, m0, 1024
    s_add_u32 s39, s39, s32
    buffer_load_dwordx4 v240, s[12:15], s39 offen lds
    s_add_u32 m0, m0, 1024
    s_add_u32 s39, s39, s3
    buffer_load_dwordx4 v239, s[12:15], s39 offen lds
    s_add_u32 m0, m0, 1024
    s_add_u32 s39, s39, s32
    buffer_load_dwordx4 v240, s[12:15], s39 offen lds
    s_add_u32 m0, m0, 1024
    s_add_u32 s39, s39, s32
    buffer_load_dwordx4 v239, s[12:15], s39 offen lds
    s_add_u32 m0, m0, 1024
    s_add_u32 s39, s39, s32
    buffer_load_dwordx4 v240, s[12:15], s39 offen lds
    s_mov_b32 m0, s19
    s_mov_b32 s39, s16
    s_mov_b32 s32, s17
    s_mov_b32 s3, s18
    s_waitcnt vmcnt(16)
    s_barrier
    buffer_load_dwordx4 v239, s[12:15], s39 offen lds
    s_add_u32 m0, m0, 1024
    s_add_u32 s39, s39, s32
    buffer_load_dwordx4 v240, s[12:15], s39 offen lds
    s_call_b64 s[76:77], PREP_w_issue_4
    s_add_u32 m0, m0, 1024
    s_add_u32 s39, s39, s32
    buffer_load_dwordx4 v239, s[12:15], s39 offen lds
    s_add_u32 m0, m0, 1024
    s_add_u32 s39, s39, s32
    buffer_load_dwordx4 v240, s[12:15], s39 offen lds
    s_add_u32 m0, m0, 1024
    s_add_u32 s39, s39, s3
    buffer_load_dwordx4 v239, s[12:15], s39 offen lds
    s_add_u32 m0, m0, 1024
    s_add_u32 s39, s39, s32
    buffer_load_dwordx4 v240, s[12:15], s39 offen lds
    s_add_u32 m0, m0, 1024
    s_add_u32 s39, s39, s32
    buffer_load_dwordx4 v239, s[12:15], s39 offen lds
    s_add_u32 m0, m0, 1024
    s_add_u32 s39, s39, s32
    buffer_load_dwordx4 v240, s[12:15], s39 offen lds
    s_mov_b32 m0, s19
    s_mov_b32 s39, s16
    s_mov_b32 s32, s17
    s_mov_b32 s3, s18
    s_waitcnt vmcnt(24)
    s_barrier
    buffer_load_dwordx4 v239, s[12:15], s39 offen lds
    s_add_u32 m0, m0, 1024
    s_add_u32 s39, s39, s32
    buffer_load_dwordx4 v240, s[12:15], s39 offen lds
    s_mov_b32 s43, 1
ld_75:
    s_mov_b32 s45, 8192
    s_add_u32 s19, s41, s42
    v_readlane_b32 s16, v249, s44
    s_nop 0
    s_bitcmp1_b32 s16, 0
    s_cselect_b32 s17, 16384, s45
    s_cselect_b32 s18, -40960, s45
    s_andn2_b32 s16, s16, 1
    s_add_u32 s16, s16, s38
    s_add_u32 s44, s44, 1
    s_add_u32 s42, s42, 16384
    s_cmp_eq_u32 s42, 98304
    s_cselect_b32 s42, 0, s42
    s_add_u32 m0, m0, 1024
    s_add_u32 s39, s39, s32
    buffer_load_dwordx4 v239, s[12:15], s39 offen lds
    s_add_u32 m0, m0, 1024
    s_add_u32 s39, s39, s32
    buffer_load_dwordx4 v240, s[12:15], s39 offen lds
    s_add_u32 m0, m0, 1024
    s_add_u32 s39, s39, s3
    buffer_load_dwordx4 v239, s[12:15], s39 offen lds
    s_add_u32 m0, m0, 1024
    s_add_u32 s39, s39, s32
    buffer_load_dwordx4 v240, s[12:15], s39 offen lds
    s_add_u32 m0, m0, 1024
    s_add_u32 s39, s39, s32
    buffer_load_dwordx4 v239, s[12:15], s39 offen lds
    s_add_u32 m0, m0, 1024
    s_add_u32 s39, s39, s32
    buffer_load_dwordx4 v240, s[12:15], s39 offen lds
    s_mov_b32 m0, s19
    s_mov_b32 s39, s16
    s_mov_b32 s32, s17
    s_mov_b32 s3, s18
    s_waitcnt vmcnt(32)
    s_barrier
    buffer_load_dwordx4 v239, s[12:15], s39 offen lds
    s_add_u32 m0, m0, 1024
    s_add_u32 s39, s39, s32
    buffer_load_dwordx4 v240, s[12:15], s39 offen lds
    s_add_u32 s43, s43, 1
    s_cmp_lt_u32 s43, 18
    s_cbranch_scc1 ld_75
    s_call_b64 s[76:77], PREP_w_issue_4
    s_add_u32 m0, m0, 1024
    s_add_u32 s39, s39, s32
    buffer_load_dwordx4 v239, s[12:15], s39 offen lds
    s_add_u32 m0, m0, 1024
    s_add_u32 s39, s39, s32
    buffer_load_dwordx4 v240, s[12:15], s39 offen lds
    s_add_u32 m0, m0, 1024
    s_add_u32 s39, s39, s3
    buffer_load_dwordx4 v239, s[12:15], s39 offen lds
    s_add_u32 m0, m0, 1024
    s_add_u32 s39, s39, s32
    buffer_load_dwordx4 v240, s[12:15], s39 offen lds
    s_add_u32 m0, m0, 1024
    s_add_u32 s39, s39, s32
    buffer_load_dwordx4 v239, s[12:15], s39 offen lds
    s_add_u32 m0, m0, 1024
    s_add_u32 s39, s39, s32
    buffer_load_dwordx4 v240, s[12:15], s39 offen lds
    s_mov_b32 m0, s19
    s_mov_b32 s39, s16
    s_mov_b32 s32, s17
    s_mov_b32 s3, s18
    s_waitcnt vmcnt(32)
    s_barrier
    buffer_load_dwordx4 v239, s[12:15], s39 offen lds
    s_add_u32 m0, m0, 1024
    s_add_u32 s39, s39, s32
    buffer_load_dwordx4 v240, s[12:15], s39 offen lds
    s_add_u32 m0, m0, 1024
    s_add_u32 s39, s39, s32
    buffer_load_dwordx4 v239, s[12:15], s39 offen lds
    s_add_u32 m0, m0, 1024
    s_add_u32 s39, s39, s32
    buffer_load_dwordx4 v240, s[12:15], s39 offen lds
    s_add_u32 m0, m0, 1024
    s_add_u32 s39, s39, s3
    buffer_load_dwordx4 v239, s[12:15], s39 offen lds
    s_add_u32 m0, m0, 1024
    s_add_u32 s39, s39, s32
    buffer_load_dwordx4 v240, s[12:15], s39 offen lds
    s_add_u32 m0, m0, 1024
    s_add_u32 s39, s39, s32
    buffer_load_dwordx4 v239, s[12:15], s39 offen lds
    s_add_u32 m0, m0, 1024
    s_add_u32 s39, s39, s32
    buffer_load_dwordx4 v240, s[12:15], s39 offen lds
    s_waitcnt vmcnt(32)
    s_barrier
    s_mov_b64 s[12:13], s[68:69]
    s_mov_b32 s14, 2097152
    s_mov_b32 s15, 0x20000
    s_and_b32 s35, s30, 1
    s_mul_i32 s38, s99, 128
    s_mul_i32 s41, s35, 65536
    s_add_u32 s38, s38, s41
    s_mul_i32 s41, s35, 4096
    s_add_u32 s41, s41, 24576
    s_mov_b32 s42, 0
    s_mov_b32 s44, s67
    s_mov_b32 s42, 90112
    s_mov_b32 s44, s67
    s_add_u32 s44, s44, 11
    s_and_b32 s44, s44, 15
    s_call_b64 s[76:77], SUB_w_issue_1
    s_mov_b32 s42, 98304
    s_mov_b32 s44, s67
    s_add_u32 s44, s44, 12
    s_and_b32 s44, s44, 15
    s_call_b64 s[76:77], SUB_w_issue_1
    s_mov_b32 s42, 122880
    s_mov_b32 s44, s67
    s_add_u32 s44, s44, 15
    s_and_b32 s44, s44, 15
    s_call_b64 s[76:77], SUB_w_issue_1
    s_add_u32 s39, s38, 1179648
    buffer_load_dwordx4 v[16:19], v238, s[12:15], s39 offen
    s_add_u32 s39, s39, 16384
    buffer_load_dwordx4 v[20:23], v238, s[12:15], s39 offen
    s_add_u32 s39, s39, 16384
    buffer_load_dwordx4 v[24:27], v238, s[12:15], s39 offen
    s_add_u32 s39, s39, 16384
    buffer_load_dwordx4 v[28:31], v238, s[12:15], s39 offen
    s_add_u32 s39, s39, 16384
    s_waitcnt vmcnt(40)
    s_barrier
    s_mov_b32 s42, 106496
    s_mov_b32 s44, s67
    s_add_u32 s44, s44, 13
    s_and_b32 s44, s44, 15
    s_call_b64 s[76:77], SUB_w_issue_1
    s_mov_b32 s42, 114688
    s_mov_b32 s44, s67
    s_add_u32 s44, s44, 14
    s_and_b32 s44, s44, 15
    s_call_b64 s[76:77], SUB_w_issue_1
    s_add_u32 s39, s38, 1310720
    buffer_load_dwordx4 v[32:35], v238, s[12:15], s39 offen
    s_add_u32 s39, s39, 16384
    buffer_load_dwordx4 v[36:39], v238, s[12:15], s39 offen
    s_add_u32 s39, s39, 16384
    buffer_load_dwordx4 v[40:43], v238, s[12:15], s39 offen
    s_add_u32 s39, s39, 16384
    buffer_load_dwordx4 v[44:47], v238, s[12:15], s39 offen
    s_add_u32 s39, s39, 16384
    s_waitcnt vmcnt(44)
    s_barrier
    s_mov_b32 s42, 24576
    s_mov_b32 s44, s67
    s_add_u32 s44, s44, 3
    s_and_b32 s44, s44, 15
    s_call_b64 s[76:77], SUB_w_issue_1
    s_mov_b32 s42, 32768
    s_mov_b32 s44, s67
    s_add_u32 s44, s44, 4
    s_and_b32 s44, s44, 15
    s_call_b64 s[76:77], SUB_w_issue_1
    s_waitcnt vmcnt(44)
    s_barrier
    s_mov_b32 s42, 40960
    s_mov_b32 s44, s67
    s_add_u32 s44, s44, 5
    s_and_b32 s44, s44, 15
    s_call_b64 s[76:77], SUB_w_issue_1
    s_mov_b32 s42, 49152
    s_mov_b32 s44, s67
    s_add_u32 s44, s44, 6
    s_and_b32 s44, s44, 15
    s_call_b64 s[76:77], SUB_w_issue_1
    s_mov_b32 s42, 0
    s_mov_b32 s44, s67
    s_add_u32 s44, s44, 0
    s_and_b32 s44, s44, 15
    s_call_b64 s[76:77], SUB_w_issue_1
    s_waitcnt vmcnt(48)
    s_barrier
    s_mov_b32 s42, 57344
    s_mov_b32 s44, s67
    s_add_u32 s44, s44, 7
    s_and_b32 s44, s44, 15
    s_call_b64 s[76:77], SUB_w_issue_1
    s_mov_b32 s42, 65536
    s_mov_b32 s44, s67
    s_add_u32 s44, s44, 8
    s_and_b32 s44, s44, 15
    s_call_b64 s[76:77], SUB_w_issue_1
    s_mov_b32 s42, 8192
    s_mov_b32 s44, s67
    s_add_u32 s44, s44, 1
    s_and_b32 s44, s44, 15
    s_call_b64 s[76:77], SUB_w_issue_1
    s_mov_b32 s42, 16384
    s_mov_b32 s44, s67
    s_add_u32 s44, s44, 2
    s_and_b32 s44, s44, 15
    s_call_b64 s[76:77], SUB_w_issue_1
    s_barrier
    s_add_u32 s36, s41, 73728
    v_add_u32 v6, s36, v2
    s_waitcnt vmcnt(0)
    ds_write_b128 v6, v[16:19] offset:0
    ds_write_b128 v6, v[20:23] offset:1024
    ds_write_b128 v6, v[24:27] offset:2048
    ds_write_b128 v6, v[28:31] offset:3072
    ds_write_b128 v6, v[32:35] offset:8192
    ds_write_b128 v6, v[36:39] offset:9216
    ds_write_b128 v6, v[40:43] offset:10240
    ds_write_b128 v6, v[44:47] offset:11264
    s_waitcnt lgkmcnt(0)
    s_branch NEXT
WL_t1:
    s_call_b64 s[76:77], PREP_w_issue_4
    s_mov_b32 m0, s19
    s_mov_b32 s39, s16
    s_mov_b32 s32, s17
    s_mov_b32 s3, s18
    s_waitcnt vmcnt(0)
    s_barrier
    s_waitcnt vmcnt(0)
    s_barrier
    s_waitcnt vmcnt(0)
    s_barrier
    s_waitcnt vmcnt(0)
    s_barrier
    s_waitcnt vmcnt(0)
    s_barrier
    buffer_load_dwordx4 v239, s[12:15], s39 offen lds
    s_add_u32 m0, m0, 1024
    s_add_u32 s39, s39, s32
    buffer_load_dwordx4 v240, s[12:15], s39 offen lds
    s_mov_b32 s43, 1
ld_76:
    s_mov_b32 s45, 8192
    s_add_u32 s19, s41, s42
    v_readlane_b32 s16, v249, s44
    s_nop 0
    s_bitcmp1_b32 s16, 0
    s_cselect_b32 s17, 16384, s45
    s_cselect_b32 s18, -40960, s45
    s_andn2_b32 s16, s16, 1
    s_add_u32 s16, s16, s38
    s_add_u32 s44, s44, 1
    s_add_u32 s42, s42, 16384
    s_cmp_eq_u32 s42, 98304
    s_cselect_b32 s42, 0, s42
    s_add_u32 m0, m0, 1024
    s_add_u32 s39, s39, s32
    buffer_load_dwordx4 v239, s[12:15], s39 offen lds
    s_add_u32 m0, m0, 1024
    s_add_u32 s39, s39, s32
    buffer_load_dwordx4 v240, s[12:15], s39 offen lds
    s_add_u32 m0, m0, 1024
    s_add_u32 s39, s39, s3
    buffer_load_dwordx4 v239, s[12:15], s39 offen lds
    s_add_u32 m0, m0, 1024
    s_add_u32 s39, s39, s32
    buffer_load_dwordx4 v240, s[12:15], s39 offen lds
    s_add_u32 m0, m0, 1024
    s_add_u32 s39, s39, s32
    buffer_load_dwordx4 v239, s[12:15], s39 offen lds
    s_add_u32 m0, m0, 1024
    s_add_u32 s39, s39, s32
    buffer_load_dwordx4 v240, s[12:15], s39 offen lds
    s_mov_b32 m0, s19
    s_mov_b32 s39, s16
    s_mov_b32 s32, s17
    s_mov_b32 s3, s18
    s_waitcnt vmcnt(8)
    s_barrier
    buffer_load_dwordx4 v239, s[12:15], s39 offen lds
    s_add_u32 m0, m0, 1024
    s_add_u32 s39, s39, s32
    buffer_load_dwordx4 v240, s[12:15], s39 offen lds
    s_add_u32 s43, s43, 1
    s_cmp_lt_u32 s43, 21
    s_cbranch_scc1 ld_76
    s_call_b64 s[76:77], PREP_w_issue_4
    s_add_u32 m0, m0, 1024
    s_add_u32 s39, s39, s32
    buffer_load_dwordx4 v239, s[12:15], s39 offen lds
    s_add_u32 m0, m0, 1024
    s_add_u32 s39, s39, s32
    buffer_load_dwordx4 v240, s[12:15], s39 offen lds
    s_add_u32 m0, m0, 1024
    s_add_u32 s39, s39, s3
    buffer_load_dwordx4 v239, s[12:15], s39 offen lds
    s_add_u32 m0, m0, 1024
    s_add_u32 s39, s39, s32
    buffer_load_dwordx4 v240, s[12:15], s39 offen lds
    s_add_u32 m0, m0, 1024
    s_add_u32 s39, s39, s32
    buffer_load_dwordx4 v239, s[12:15], s39 offen lds
    s_add_u32 m0, m0, 1024
    s_add_u32 s39, s39, s32
    buffer_load_dwordx4 v240, s[12:15], s39 offen lds
    s_mov_b32 m0, s19
    s_mov_b32 s39, s16
    s_mov_b32 s32, s17
    s_mov_b32 s3, s18
    s_waitcnt vmcnt(8)
    s_barrier
    buffer_load_dwordx4 v239, s[12:15], s39 offen lds
    s_add_u32 m0, m0, 1024
    s_add_u32 s39, s39, s32
    buffer_load_dwordx4 v240, s[12:15], s39 offen lds
    s_add_u32 m0, m0, 1024
    s_add_u32 s39, s39, s32
    buffer_load_dwordx4 v239, s[12:15], s39 offen lds
    s_add_u32 m0, m0, 1024
    s_add_u32 s39, s39, s32
    buffer_load_dwordx4 v240, s[12:15], s39 offen lds
    s_add_u32 m0, m0, 1024
    s_add_u32 s39, s39, s3
    buffer_load_dwordx4 v239, s[12:15], s39 offen lds
    s_add_u32 m0, m0, 1024
    s_add_u32 s39, s39, s32
    buffer_load_dwordx4 v240, s[12:15], s39 offen lds
    s_add_u32 m0, m0, 1024
    s_add_u32 s39, s39, s32
    buffer_load_dwordx4 v239, s[12:15], s39 offen lds
    s_add_u32 m0, m0, 1024
    s_add_u32 s39, s39, s32
    buffer_load_dwordx4 v240, s[12:15], s39 offen lds
    s_waitcnt vmcnt(8)
    s_barrier
    s_waitcnt vmcnt(0)
    s_barrier
    s_branch K_fin
NEXT:
    s_setprio 0
    s_add_u32 s60, s60, 1
    s_add_u32 s55, s55, 4194304
    s_add_u32 s62, s62, 4194304
    s_addc_u32 s63, s63, 0
    s_branch LAYER
K_fin:
    s_endpgm
SUB_w1_regs:
    s_mov_b64 s[12:13], s[68:69]
    s_mov_b32 s14, 2097152
    s_mov_b32 s15, 0x20000
    s_and_b32 s35, s30, 3
    s_mul_i32 s35, s35, 294912
    s_lshl_b32 s39, s99, 7
    s_add_u32 s39, s39, s35
    buffer_load_dwordx4 v[176:179], v238, s[12:15], s39 offen
    s_add_u32 s39, s39, 16384
    buffer_load_dwordx4 v[188:191], v238, s[12:15], s39 offen
    s_add_u32 s39, s39, 16384
    buffer_load_dwordx4 v[192:195], v238, s[12:15], s39 offen
    s_add_u32 s39, s39, 16384
    buffer_load_dwordx4 v[200:203], v238, s[12:15], s39 offen
    s_add_u32 s39, s39, 16384
    s_waitcnt vmcnt(8)
    buffer_load_dwordx4 v[204:207], v238, s[12:15], s39 offen
    s_add_u32 s39, s39, 16384
    buffer_load_dwordx4 v[208:211], v238, s[12:15], s39 offen
    s_add_u32 s39, s39, 16384
    buffer_load_dwordx4 v[212:215], v238, s[12:15], s39 offen
    s_add_u32 s39, s39, 16384
    buffer_load_dwordx4 v[216:219], v238, s[12:15], s39 offen
    s_add_u32 s39, s39, 16384
    s_waitcnt vmcnt(8)
    buffer_load_dwordx4 v[220:223], v238, s[12:15], s39 offen
    s_add_u32 s39, s39, 16384
    buffer_load_dwordx4 v[224:227], v238, s[12:15], s39 offen
    s_add_u32 s39, s39, 16384
    buffer_load_dwordx4 v[16:19], v238, s[12:15], s39 offen
    s_add_u32 s39, s39, 16384
    buffer_load_dwordx4 v[20:23], v238, s[12:15], s39 offen
    s_add_u32 s39, s39, 16384
    s_waitcnt vmcnt(8)
    buffer_load_dwordx4 v[24:27], v238, s[12:15], s39 offen
    s_add_u32 s39, s39, 16384
    buffer_load_dwordx4 v[28:31], v238, s[12:15], s39 offen
    s_add_u32 s39, s39, 16384
    buffer_load_dwordx4 v[32:35], v238, s[12:15], s39 offen
    s_add_u32 s39, s39, 16384
    buffer_load_dwordx4 v[36:39], v238, s[12:15], s39 offen
    s_add_u32 s39, s39, 16384
    s_waitcnt vmcnt(8)
    buffer_load_dwordx4 v[40:43], v238, s[12:15], s39 offen
    s_add_u32 s39, s39, 16384
    buffer_load_dwordx4 v[44:47], v238, s[12:15], s39 offen
    s_add_u32 s39, s39, 16384
    s_setpc_b64 s[76:77]
SUB_park:
    s_mov_b64 s[12:13], s[70:71]
    s_mov_b32 s14, 2097152
    s_mov_b32 s15, 0x20000
    s_and_b32 s35, s30, 3
    s_lshl_b32 s35, s35, 19
    s_lshl_b32 s39, s29, 7
    s_add_u32 s39, s39, s35
    buffer_load_dwordx4 v[48:51], v238, s[12:15], s39 offen
    s_add_u32 s39, s39, 16384
    buffer_load_dwordx4 v[52:55], v238, s[12:15], s39 offen
    s_add_u32 s39, s39, 16384
    buffer_load_dwordx4 v[56:59], v238, s[12:15], s39 offen
    s_add_u32 s39, s39, 16384
    buffer_load_dwordx4 v[60:63], v238, s[12:15], s39 offen
    s_add_u32 s39, s39, 16384
    s_waitcnt vmcnt(8)
    buffer_load_dwordx4 v[64:67], v238, s[12:15], s39 offen
    s_add_u32 s39, s39, 16384
    buffer_load_dwordx4 v[68:71], v238, s[12:15], s39 offen
    s_add_u32 s39, s39, 16384
    buffer_load_dwordx4 v[72:75], v238, s[12:15], s39 offen
    s_add_u32 s39, s39, 16384
    buffer_load_dwordx4 v[76:79], v238, s[12:15], s39 offen
    s_add_u32 s39, s39, 16384
    s_waitcnt vmcnt(8)
    buffer_load_dwordx4 v[80:83], v238, s[12:15], s39 offen
    s_add_u32 s39, s39, 16384
    buffer_load_dwordx4 v[84:87], v238, s[12:15], s39 offen
    s_add_u32 s39, s39, 16384
    buffer_load_dwordx4 v[88:91], v238, s[12:15], s39 offen
    s_add_u32 s39, s39, 16384
    buffer_load_dwordx4 v[92:95], v238, s[12:15], s39 offen
    s_add_u32 s39, s39, 16384
    s_waitcnt vmcnt(8)
    buffer_load_dwordx4 v[96:99], v238, s[12:15], s39 offen
    s_add_u32 s39, s39, 16384
    buffer_load_dwordx4 v[100:103], v238, s[12:15], s39 offen
    s_add_u32 s39, s39, 16384
    buffer_load_dwordx4 v[104:107], v238, s[12:15], s39 offen
    s_add_u32 s39, s39, 16384
    buffer_load_dwordx4 v[108:111], v238, s[12:15], s39 offen
    s_add_u32 s39, s39, 16384
    s_waitcnt vmcnt(8)
    buffer_load_dwordx4 v[112:115], v238, s[12:15], s39 offen
    s_add_u32 s39, s39, 16384
    buffer_load_dwordx4 v[116:119], v238, s[12:15], s39 offen
    s_add_u32 s39, s39, 16384
    buffer_load_dwordx4 v[120:123], v238, s[12:15], s39 offen
    s_add_u32 s39, s39, 16384
    buffer_load_dwordx4 v[124:127], v238, s[12:15], s39 offen
    s_add_u32 s39, s39, 16384
    s_waitcnt vmcnt(8)
    buffer_load_dwordx4 v[128:131], v238, s[12:15], s39 offen
    s_add_u32 s39, s39, 16384
    buffer_load_dwordx4 v[132:135], v238, s[12:15], s39 offen
    s_add_u32 s39, s39, 16384
    buffer_load_dwordx4 v[136:139], v238, s[12:15], s39 offen
    s_add_u32 s39, s39, 16384
    buffer_load_dwordx4 v[140:143], v238, s[12:15], s39 offen
    s_add_u32 s39, s39, 16384
    s_waitcnt vmcnt(8)
    buffer_load_dwordx4 v[144:147], v238, s[12:15], s39 offen
    s_add_u32 s39, s39, 16384
    buffer_load_dwordx4 v[148:151], v238, s[12:15], s39 offen
    s_add_u32 s39, s39, 16384
    buffer_load_dwordx4 v[152:155], v238, s[12:15], s39 offen
    s_add_u32 s39, s39, 16384
    buffer_load_dwordx4 v[156:159], v238, s[12:15], s39 offen
    s_add_u32 s39, s39, 16384
    s_waitcnt vmcnt(8)
    buffer_load_dwordx4 v[160:163], v238, s[12:15], s39 offen
    s_add_u32 s39, s39, 16384
    buffer_load_dwordx4 v[164:167], v238, s[12:15], s39 offen
    s_add_u32 s39, s39, 16384
    buffer_load_dwordx4 v[168:171], v238, s[12:15], s39 offen
    s_add_u32 s39, s39, 16384
    buffer_load_dwordx4 v[172:175], v238, s[12:15], s39 offen
    s_add_u32 s39, s39, 16384
    s_waitcnt vmcnt(8)
    s_setpc_b64 s[76:77]
SUB_w1_put:
    s_and_b32 s35, s30, 3
    s_mul_i32 s35, s35, 18432
    v_add_u32 v8, s35, v2
    v_mov_b32 v6, 162820
spin_77:
    s_sleep 2
    ds_read_b32 v7, v6
    s_waitcnt lgkmcnt(0)
    v_readfirstlane_b32 s53, v7
    s_nop 0
    s_cmp_ge_u32 s53, 16
    s_cbranch_scc0 spin_77
    s_waitcnt vmcnt(0)
    ds_write_b128 v8, v[176:179] offset:24576
    ds_write_b128 v8, v[188:191] offset:25600
    ds_write_b128 v8, v[192:195] offset:26624
    ds_write_b128 v8, v[200:203] offset:27648
    ds_write_b128 v8, v[204:207] offset:28672
    ds_write_b128 v8, v[208:211] offset:29696
    ds_write_b128 v8, v[212:215] offset:30720
    ds_write_b128 v8, v[216:219] offset:31744
    ds_write_b128 v8, v[220:223] offset:32768
    ds_write_b128 v8, v[224:227] offset:33792
    ds_write_b128 v8, v[16:19] offset:34816
    ds_write_b128 v8, v[20:23] offset:35840
    ds_write_b128 v8, v[24:27] offset:36864
    ds_write_b128 v8, v[28:31] offset:37888
    ds_write_b128 v8, v[32:35] offset:38912
    ds_write_b128 v8, v[36:39] offset:39936
    ds_write_b128 v8, v[40:43] offset:40960
    ds_write_b128 v8, v[44:47] offset:41984
    s_waitcnt lgkmcnt(0)
    s_setpc_b64 s[76:77]
SUB_after_g1:
    s_mov_b64 s[12:13], s[72:73]
    s_mov_b32 s14, 7340032
    s_mov_b32 s15, 0x20000
    v_readlane_b32 s36, v251, 0
    v_readlane_b32 s37, v251, 1
    s_and_b32 s35, s30, 3
    s_mul_i32 s38, s35, 114688
    s_mul_i32 s39, s29, 448
    s_add_u32 s38, s38, s39
    s_and_b32 s36, s36, 15
    s_mul_i32 s36, s36, 458752
    s_add_u32 s36, s36, s38
    s_and_b32 s37, s37, 15
    s_mul_i32 s37, s37, 458752
    s_add_u32 s37, s37, s38
    s_mul_i32 s39, s35, 7168
    s_add_u32 m0, s39, 131072
    s_nop 0
    buffer_load_dwordx4 v241, s[12:15], s36 offen lds
    s_add_u32 m0, m0, 1024
    s_nop 0
    buffer_load_dwordx4 v242, s[12:15], s36 offen lds
    s_add_u32 m0, m0, 1024
    s_nop 0
    buffer_load_dwordx4 v243, s[12:15], s36 offen lds
    s_add_u32 m0, m0, 1024
    s_nop 0
    buffer_load_dwordx4 v244, s[12:15], s36 offen lds
    s_add_u32 m0, m0, 1024
    s_nop 0
    buffer_load_dwordx4 v245, s[12:15], s36 offen lds
    s_add_u32 m0, m0, 1024
    s_nop 0
    buffer_load_dwordx4 v246, s[12:15], s36 offen lds
    s_add_u32 m0, m0, 1024
    s_nop 0
    buffer_load_dwordx4 v247, s[12:15], s36 offen lds
    buffer_load_dwordx4 v[208:211], v241, s[12:15], s37 offen
    buffer_load_dwordx4 v[212:215], v242, s[12:15], s37 offen
    buffer_load_dwordx4 v[216:219], v243, s[12:15], s37 offen
    buffer_load_dwordx4 v[220:223], v244, s[12:15], s37 offen
    buffer_load_dwordx4 v[224:227], v245, s[12:15], s37 offen
    buffer_load_dwordx4 v[228:231], v246, s[12:15], s37 offen
    buffer_load_dwordx4 v[232:235], v247, s[12:15], s37 offen
    s_lshr_b32 s36, s67, 2
    s_sub_u32 s36, s35, s36
    s_and_b32 s36, s36, 3
    s_lshl_b32 s36, s36, 15
    v_add_u32 v6, s36, v2
    s_waitcnt vmcnt(14)
    ds_write_b128 v6, v[48:51] offset:0
    ds_write_b128 v6, v[52:55] offset:1024
    ds_write_b128 v6, v[56:59] offset:2048
    ds_write_b128 v6, v[60:63] offset:3072
    ds_write_b128 v6, v[64:67] offset:4096
    ds_write_b128 v6, v[68:71] offset:5120
    ds_write_b128 v6, v[72:75] offset:6144
    ds_write_b128 v6, v[76:79] offset:7168
    ds_write_b128 v6, v[80:83] offset:8192
    ds_write_b128 v6, v[84:87] offset:9216
    ds_write_b128 v6, v[88:91] offset:10240
    ds_write_b128 v6, v[92:95] offset:11264
    ds_write_b128 v6, v[96:99] offset:12288
    ds_write_b128 v6, v[100:103] offset:13312
    ds_write_b128 v6, v[104:107] offset:14336
    ds_write_b128 v6, v[108:111] offset:15360
    ds_write_b128 v6, v[112:115] offset:16384
    ds_write_b128 v6, v[116:119] offset:17408
    ds_write_b128 v6, v[120:123] offset:18432
    ds_write_b128 v6, v[124:127] offset:19456
    ds_write_b128 v6, v[128:131] offset:20480
    ds_write_b128 v6, v[132:135] offset:21504
    ds_write_b128 v6, v[136:139] offset:22528
    ds_write_b128 v6, v[140:143] offset:23552
    ds_write_b128 v6, v[144:147] offset:24576
    ds_write_b128 v6, v[148:151] offset:25600
    ds_write_b128 v6, v[152:155] offset:26624
    ds_write_b128 v6, v[156:159] offset:27648
    ds_write_b128 v6, v[160:163] offset:28672
    ds_write_b128 v6, v[164:167] offset:29696
    ds_write_b128 v6, v[168:171] offset:30720
    ds_write_b128 v6, v[172:175] offset:31744
    s_waitcnt lgkmcnt(0)
    s_setpc_b64 s[76:77]
SUB_after_g2:
    s_and_b32 s35, s30, 3
    s_mul_i32 s39, s35, 7168
    s_add_u32 s39, s39, 73728
    v_add_u32 v6, s39, v2
    ds_write_b128 v6, v[208:211] offset:0
    ds_write_b128 v6, v[212:215] offset:1024
    ds_write_b128 v6, v[216:219] offset:2048
    ds_write_b128 v6, v[220:223] offset:3072
    ds_write_b128 v6, v[224:227] offset:4096
    ds_write_b128 v6, v[228:231] offset:5120
    ds_write_b128 v6, v[232:235] offset:6144
    s_waitcnt lgkmcnt(0)
    s_setpc_b64 s[76:77]
SUB_r_pre0:
    s_waitcnt lgkmcnt(0)
    v_and_b32 v199, 7, v0
    v_lshrrev_b32 v236, 6, v0
    v_lshlrev_b32 v236, 4, v236
    v_bfe_u32 v237, v0, 3, 3
    v_add_u32 v236, v236, v237
    s_lshr_b32 s78, s29, 1
    s_lshl_b32 s78, s78, 16
    s_and_b32 s79, s29, 1
    s_lshl_b32 s79, s79, 7
    s_add_u32 s78, s78, s79
    s_lshr_b32 s79, s30, 1
    s_lshl_b32 s79, s79, 13
    s_add_u32 s78, s78, s79
    v_lshlrev_b32 v196, 8, v236
    v_lshl_add_u32 v196, v199, 4, v196
    v_add_u32 v196, s78, v196
    s_lshl_b32 s78, s28, 7
    s_lshl_b32 s79, s29, 3
    s_add_u32 s78, s78, s79
    v_add_u32 v197, s78, v199
    v_lshlrev_b32 v198, 11, v197
    v_lshrrev_b32 v237, 2, v236
    v_lshlrev_b32 v237, 3, v237
    v_and_b32 v236, 3, v236
    v_add_u32 v236, v236, v237
    v_lshl_add_u32 v198, v236, 3, v198
    v_lshlrev_b32 v197, 3, v197
    v_lshl_add_u32 v197, v236, 14, v197
    s_mov_b32 s84, s62
    s_mov_b32 s85, s63
    s_mov_b32 s86, 0x7e000
    s_mov_b32 s87, 0x20000
    s_add_u32 s88, s62, 0x80000
    s_addc_u32 s89, s63, 0
    s_mov_b32 s90, 0x7e000
    s_mov_b32 s91, 0x20000
    s_cmp_eq_u32 s60, 0
    s_cselect_b32 s86, s86, 0
    s_cselect_b32 s90, s90, 0
    buffer_load_dwordx4 v[180:183], v196, s[84:87], 0 offen offset:0 sc1
    buffer_load_dwordx4 v[188:191], v196, s[88:91], 0 offen offset:0 sc1
    buffer_load_dwordx4 v[184:187], v196, s[84:87], 0 offen offset:2048 sc1
    buffer_load_dwordx4 v[192:195], v196, s[88:91], 0 offen offset:2048 sc1
    s_add_u32 s80, s4, 0x1c00000
    s_addc_u32 s81, s5, 0
    s_mov_b32 s82, 0x400000
    s_mov_b32 s83, 0x20000
    s_cmp_eq_u32 s60, 0
    s_cselect_b32 s82, s82, 0
    s_mov_b32 s78, 0
    buffer_load_dwordx2 v[230:231], v197, s[80:83], s78 offen sc1
    s_mov_b32 s78, 65536
    buffer_load_dwordx2 v[232:233], v197, s[80:83], s78 offen sc1
    s_mov_b32 s78, 262144
    buffer_load_dwordx2 v[234:235], v197, s[80:83], s78 offen sc1
    s_mov_b32 s78, 327680
    buffer_load_dwordx2 v[236:237], v197, s[80:83], s78 offen sc1
    s_setpc_b64 s[76:77]
SUB_w_issue_1:
    s_add_u32 s19, s41, s42
    s_mul_i32 s16, s44, 131072
    s_add_u32 s16, s16, s38
    s_add_u32 s44, s44, 1
    s_and_b32 s44, s44, 15
    s_add_u32 s42, s42, 8192
    s_cmp_eq_u32 s42, 131072
    s_cselect_b32 s42, 0, s42
    s_mov_b32 m0, s19
    s_mov_b32 s39, s16
    buffer_load_dwordx4 v238, s[12:15], s39 offen lds
    s_add_u32 m0, m0, 1024
    s_add_u32 s39, s39, 16384
    buffer_load_dwordx4 v238, s[12:15], s39 offen lds
    s_add_u32 m0, m0, 1024
    s_add_u32 s39, s39, 16384
    buffer_load_dwordx4 v238, s[12:15], s39 offen lds
    s_add_u32 m0, m0, 1024
    s_add_u32 s39, s39, 16384
    buffer_load_dwordx4 v238, s[12:15], s39 offen lds
    s_setpc_b64 s[76:77]
PREP_a_issue_4:
    s_add_u32 s19, s41, s42
    v_readlane_b32 s16, v249, s44
    v_readlane_b32 s17, v250, s44
    s_add_u32 s16, s16, s38
    s_add_u32 s17, s17, s38
    s_add_u32 s44, s44, 1
    s_add_u32 s42, s42, 16384
    s_cmp_eq_u32 s42, 49152
    s_cselect_b32 s42, 0, s42
    s_setpc_b64 s[76:77]
PREP_w_issue_4:
    s_mov_b32 s45, 8192
    s_add_u32 s19, s41, s42
    v_readlane_b32 s16, v249, s44
    s_nop 0
    s_bitcmp1_b32 s16, 0
    s_cselect_b32 s17, 16384, s45
    s_cselect_b32 s18, -40960, s45
    s_andn2_b32 s16, s16, 1
    s_add_u32 s16, s16, s38
    s_add_u32 s44, s44, 1
    s_add_u32 s42, s42, 16384
    s_cmp_eq_u32 s42, 98304
    s_cselect_b32 s42, 0, s42
    s_setpc_b64 s[76:77]
K_end:
    s_endpgm
.p2align 6
K_tab:
.short 4096,5137,6178,11379,18660,25941,40502,33223,47784,55065,19706,12427,26988,34269,48830,41551,56096,9264,20736,10448,23824,25008,38384,35296,39568,49856,54128,52944,0,0,0,0
.short 4096,5137,6178,18659,11380,25941,33222,47783,40504,55065,12426,26987,19708,34269,41550,56111,48816,9264,10448,23824,20736,25008,35296,39568,38384,49856,52944,54128,0,0,0,0
.short 4096,5137,6178,11379,25940,18661,33222,40503,55064,47785,12426,19707,34268,26989,41550,48831,9264,56096,10448,20736,25008,23824,35296,38384,49856,39568,52944,54128,0,0,0,0
.short 4096,5137,6178,11379,18660,33221,25942,40503,47784,12425,55066,19707,26988,41549,34270,48831,56096,10448,9264,20736,23824,35296,25008,38384,39568,52944,49856,54128,0,0,0,0
.short 11377,12418,13459,18660,4101,25942,33223,47784,40505,55066,5147,26988,19709,34270,41551,56096,48816,6176,10288,23824,20736,25008,35296,39568,38384,49856,52944,54128,0,0,0,0
.short 11377,12418,13459,4100,25941,18662,33223,40504,55065,47786,5147,19708,34269,26990,41551,48816,6176,56096,10288,20736,25008,23824,35296,38384,49856,39568,52944,54128,0,0,0,0
.short 11377,12418,13459,4100,18661,33222,25943,40504,47785,5146,55067,19708,26989,41550,34271,48816,56096,10288,6176,20736,23824,35296,25008,38384,39568,52944,49856,54128,0,0,0,0
.short 11377,12418,13459,4100,18661,25942,40503,33224,47785,55066,19707,5148,26989,34270,48831,41536,56096,6176,20736,10288,23824,25008,38384,35296,39568,49856,54128,52944,0,0,0,0
.short 18658,19699,20740,4101,25942,11383,33224,40505,55066,47787,5148,12429,34270,26991,41536,48817,6176,56096,9264,10448,25008,23824,35296,38384,49856,39568,52944,54128,0,0,0,0
.short 18658,19699,20740,4101,11382,33223,25944,40505,47786,5147,55068,12429,26990,41551,34256,48817,56096,9264,6176,10448,23824,35296,25008,38384,39568,52944,49856,54128,0,0,0,0
.short 18658,19699,20740,4101,11382,25943,40504,33225,47786,55067,12428,5149,26990,34271,48816,41537,56096,6176,10448,9264,23824,25008,38384,35296,39568,49856,54128,52944,0,0,0,0
.short 18658,19699,20740,11381,4102,25943,33224,47785,40506,55067,5148,26989,12430,34271,41536,56097,48816,6176,9264,23824,10448,25008,35296,39568,38384,49856,52944,54128,0,0,0,0
.short 25939,26980,28021,4102,11383,33224,18665,40506,47787,5148,55069,12430,19711,41536,34257,48818,56096,9264,6176,10448,20736,35296,24848,38384,39568,52944,49856,54128,0,0,0,0
.short 25939,26980,28021,4102,11383,18664,40505,33226,47787,55068,12429,5150,19711,34256,48817,41538,56096,6176,10448,9264,20736,24848,38384,35296,39568,49856,54128,52944,0,0,0,0
.short 25939,26980,28021,11382,4103,18664,33225,47786,40507,55068,5149,19710,12431,34256,41537,56098,48816,6176,9264,20736,10448,24848,35296,39568,38384,49856,52944,54128,0,0,0,0
.short 25939,26980,28021,4102,18663,11384,33225,40506,55067,47788,5149,12430,34271,19696,41537,48818,6176,56096,9264,10448,24848,20736,35296,38384,49856,39568,52944,54128,0,0,0,0
.short 33220,34261,35302,4103,11384,18665,40506,25947,47788,55069,12430,5151,19696,26977,48818,41539,56096,6176,10448,9264,20736,23824,38384,25008,39568,49856,54128,52944,0,0,0,0
.short 33220,34261,35302,11383,4104,18665,25946,47787,40508,55069,5150,19711,12416,26977,41538,56099,48816,6176,9264,20736,10448,23824,25008,39568,38384,49856,52944,54128,0,0,0,0
.short 33220,34261,35302,4103,18664,11385,25946,40507,55068,47789,5150,12431,26976,19697,41538,48819,6176,56096,9264,10448,23824,20736,25008,38384,49856,39568,52944,54128,0,0,0,0
.short 33220,34261,35302,4103,11384,25945,18666,40507,47788,5149,55070,12431,19696,41537,26978,48819,56096,9264,6176,10448,20736,25008,23824,38384,39568,52944,49856,54128,0,0,0,0
.short 40501,41542,42583,11384,4105,18666,25947,47788,33229,55070,5151,19696,12417,26978,34259,56100,48816,6176,9264,20736,10448,23824,25008,39408,35296,49856,52944,54128,0,0,0,0
.short 40501,41542,42583,4104,18665,11386,25947,33228,55069,47790,5151,12416,26977,19698,34259,48820,6176,56096,9264,10448,23824,20736,25008,35296,49856,39408,52944,54128,0,0,0,0
.short 40501,41542,42583,4104,11385,25946,18667,33228,47789,5150,55071,12416,19697,34258,26979,48820,56096,9264,6176,10448,20736,25008,23824,35296,39408,52944,49856,54128,0,0,0,0
.short 40501,41542,42583,4104,11385,18666,33227,25948,47789,55070,12431,5136,19697,26978,48819,34260,56096,6176,10448,9264,20736,23824,35296,25008,39408,49856,54128,52944,0,0,0,0
.short 47782,48823,49864,4105,18666,11387,25948,33229,55070,40511,5136,12417,26978,19699,34260,41541,6176,56096,9264,10448,23824,20736,25008,35296,39568,38384,52944,54128,0,0,0,0
.short 47782,48823,49864,4105,11386,25947,18668,33229,40510,5151,55056,12417,19698,34259,26980,41541,56096,9264,6176,10448,20736,25008,23824,35296,38384,52944,39568,54128,0,0,0,0
.short 47782,48823,49864,4105,11386,18667,33228,25949,40510,55071,12416,5137,19698,26979,41540,34261,56096,6176,10448,9264,20736,23824,35296,25008,38384,39568,54128,52944,0,0,0,0
.short 47782,48823,49864,11385,4106,18667,25948,40509,33230,55071,5136,19697,12418,26979,34260,56101,41536,6176,9264,20736,10448,23824,25008,38384,35296,39568,52944,54128,0,0,0,0
.short 55063,56104,57145,4106,11387,25948,18669,33230,40511,5136,47777,12418,19699,34260,26981,41542,48816,9264,6176,10448,20736,25008,23824,35296,38384,49856,39568,53968,0,0,0,0
.short 55063,56104,57145,4106,11387,18668,33229,25950,40511,47776,12417,5138,19699,26980,41541,34262,48816,6176,10448,9264,20736,23824,35296,25008,38384,39568,53968,49856,0,0,0,0
.short 55063,56104,57145,11386,4107,18668,25949,40510,33231,47776,5137,19698,12419,26980,34261,48822,41536,6176,9264,20736,10448,23824,25008,38384,35296,39568,49856,53968,0,0,0,0
.short 55063,56104,57145,4106,18667,11388,25949,33230,47791,40496,5137,12418,26979,19700,34261,41542,6176,48816,9264,10448,23824,20736,25008,35296,39568,38384,49856,53968,0,0,0,0
.short 4104,5145,6186,11387,18668,25949,40510,33231,47776,55057,19698,12419,26980,34261,48822,41543,56096,9264,20736,10448,23824,25008,38384,35296,39568,49856,54128,52944,0,0,0,0
.short 4104,5145,6186,18667,11388,25949,33230,47791,40496,55057,12418,26979,19700,34261,41542,56103,48816,9264,10448,23824,20736,25008,35296,39568,38384,49856,52944,54128,0,0,0,0
.short 4104,5145,6186,11387,25948,18669,33230,40511,55056,47777,12418,19699,34260,26981,41542,48823,9264,56096,10448,20736,25008,23824,35296,38384,49856,39568,52944,54128,0,0,0,0
.short 4104,5145,6186,11387,18668,33229,25950,40511,47776,12417,55058,19699,26980,41541,34262,48823,56096,10448,9264,20736,23824,35296,25008,38384,39568,52944,49856,54128,0,0,0,0
.short 11385,12426,13467,18668,4109,25950,33231,47776,40497,55058,5139,26980,19701,34262,41543,56104,48816,6176,10288,23824,20736,25008,35296,39568,38384,49856,52944,54128,0,0,0,0
.short 11385,12426,13467,4108,25949,18670,33231,40496,55057,47778,5139,19700,34261,26982,41543,48824,6176,56096,10288,20736,25008,23824,35296,38384,49856,39568,52944,54128,0,0,0,0
.short 11385,12426,13467,4108,18669,33230,25951,40496,47777,5138,55059,19700,26981,41542,34263,48824,56096,10288,6176,20736,23824,35296,25008,38384,39568,52944,49856,54128,0,0,0,0
.short 11385,12426,13467,4108,18669,25950,40511,33216,47777,55058,19699,5140,26981,34262,48823,41544,56096,6176,20736,10288,23824,25008,38384,35296,39568,49856,54128,52944,0,0,0,0
.short 18666,19707,20748,4109,25950,11391,33216,40497,55058,47779,5140,12421,34262,26983,41544,48825,6176,56096,9264,10448,25008,23824,35296,38384,49856,39568,52944,54128,0,0,0,0
.short 18666,19707,20748,4109,11390,33231,25936,40497,47778,5139,55060,12421,26982,41543,34264,48825,56096,9264,6176,10448,23824,35296,25008,38384,39568,52944,49856,54128,0,0,0,0
.short 18666,19707,20748,4109,11390,25951,40496,33217,47778,55059,12420,5141,26982,34263,48824,41545,56096,6176,10448,9264,23824,25008,38384,35296,39568,49856,54128,52944,0,0,0,0
.short 18666,19707,20748,11389,4110,25951,33216,47777,40498,55059,5140,26981,12422,34263,41544,56105,48816,6176,9264,23824,10448,25008,35296,39568,38384,49856,52944,54128,0,0,0,0
.short 25947,26988,28029,4110,11391,33216,18657,40498,47779,5140,55061,12422,19703,41544,34265,48826,56096,9264,6176,10448,20736,35296,24848,38384,39568,52944,49856,54128,0,0,0,0
.short 25947,26988,28029,4110,11391,18656,40497,33218,47779,55060,12421,5142,19703,34264,48825,41546,56096,6176,10448,9264,20736,24848,38384,35296,39568,49856,54128,52944,0,0,0,0
.short 25947,26988,28029,11390,4111,18656,33217,47778,40499,55060,5141,19702,12423,34264,41545,56106,48816,6176,9264,20736,10448,24848,35296,39568,38384,49856,52944,54128,0,0,0,0
.short 25947,26988,28029,4110,18671,11376,33217,40498,55059,47780,5141,12422,34263,19704,41545,48826,6176,56096,9264,10448,24848,20736,35296,38384,49856,39568,52944,54128,0,0,0,0
.short 33228,34269,35310,4111,11376,18657,40498,25939,47780,55061,12422,5143,19704,26985,48826,41547,56096,6176,10448,9264,20736,23824,38384,25008,39568,49856,54128,52944,0,0,0,0
.short 33228,34269,35310,11391,4096,18657,25938,47779,40500,55061,5142,19703,12424,26985,41546,56107,48816,6176,9264,20736,10448,23824,25008,39568,38384,49856,52944,54128,0,0,0,0
.short 33228,34269,35310,4111,18656,11377,25938,40499,55060,47781,5142,12423,26984,19705,41546,48827,6176,56096,9264,10448,23824,20736,25008,38384,49856,39568,52944,54128,0,0,0,0
.short 33228,34269,35310,4111,11376,25937,18658,40499,47780,5141,55062,12423,19704,41545,26986,48827,56096,9264,6176,10448,20736,25008,23824,38384,39568,52944,49856,54128,0,0,0,0
.short 40509,41550,42591,11376,4097,18658,25939,47780,33221,55062,5143,19704,12425,26986,34267,56108,48816,6176,9264,20736,10448,23824,25008,39408,35296,49856,52944,54128,0,0,0,0
.short 40509,41550,42591,4096,18657,11378,25939,33220,55061,47782,5143,12424,26985,19706,34267,48828,6176,56096,9264,10448,23824,20736,25008,35296,49856,39408,52944,54128,0,0,0,0
.short 40509,41550,42591,4096,11377,25938,18659,33220,47781,5142,55063,12424,19705,34266,26987,48828,56096,9264,6176,10448,20736,25008,23824,35296,39408,52944,49856,54128,0,0,0,0
.short 40509,41550,42591,4096,11377,18658,33219,25940,47781,55062,12423,5144,19705,26986,48827,34268,56096,6176,10448,9264,20736,23824,35296,25008,39408,49856,54128,52944,0,0,0,0
.short 47790,48831,49856,4097,18658,11379,25940,33221,55062,40503,5144,12425,26986,19707,34268,41549,6176,56096,9264,10448,23824,20736,25008,35296,39568,38384,52944,54128,0,0,0,0
.short 47790,48831,49856,4097,11378,25939,18660,33221,40502,5143,55064,12425,19706,34267,26988,41549,56096,9264,6176,10448,20736,25008,23824,35296,38384,52944,39568,54128,0,0,0,0
.short 47790,48831,49856,4097,11378,18659,33220,25941,40502,55063,12424,5145,19706,26987,41548,34269,56096,6176,10448,9264,20736,23824,35296,25008,38384,39568,54128,52944,0,0,0,0
.short 47790,48831,49856,11377,4098,18659,25940,40501,33222,55063,5144,19705,12426,26987,34268,56109,41536,6176,9264,20736,10448,23824,25008,38384,35296,39568,52944,54128,0,0,0,0
.short 55071,56096,57137,4098,11379,25940,18661,33222,40503,5144,47785,12426,19707,34268,26989,41550,48816,9264,6176,10448,20736,25008,23824,35296,38384,49856,39568,53968,0,0,0,0
.short 55071,56096,57137,4098,11379,18660,33221,25942,40503,47784,12425,5146,19707,26988,41549,34270,48816,6176,10448,9264,20736,23824,35296,25008,38384,39568,53968,49856,0,0,0,0
.short 55071,56096,57137,11378,4099,18660,25941,40502,33223,47784,5145,19706,12427,26988,34269,48830,41536,6176,9264,20736,10448,23824,25008,38384,35296,39568,49856,53968,0,0,0,0
.short 55071,56096,57137,4098,18659,11380,25941,33222,47783,40504,5145,12426,26987,19708,34269,41550,6176,48816,9264,10448,23824,20736,25008,35296,39568,38384,49856,53968,0,0,0,0
.section .rodata,"a"
.p2align 6
.amdhsa_kernel interleave_layers__ssm_conv_h3__mixer_s_mlp__prompt_kernel
  .amdhsa_next_free_vgpr 256
  .amdhsa_next_free_sgpr 102
  .amdhsa_accum_offset 256
  .amdhsa_group_segment_fixed_size 0
  .amdhsa_kernarg_size 112
  .amdhsa_user_sgpr_count 2
  .amdhsa_user_sgpr_kernarg_segment_ptr 1
  .amdhsa_system_sgpr_workgroup_id_x 1
  .amdhsa_float_denorm_mode_32 3
.end_amdhsa_kernel
```

```asm
; @launch grid=(256,1,1) block=(512,1,1) lds=163840
.amdgcn_target "amdgcn-amd-amdhsa--gfx950"
.text
.globl interleave_layers__ssm_conv_h3__mixer_s_mlp__prompt_kernel
.p2align 8
.type interleave_layers__ssm_conv_h3__mixer_s_mlp__prompt_kernel,@function
interleave_layers__ssm_conv_h3__mixer_s_mlp__prompt_kernel:
    s_cmp_ge_u32 s2, 256
    s_cbranch_scc1 K_end
    s_load_dwordx8 s[8:15], s[0:1], 8
    s_load_dwordx2 s[6:7], s[0:1], 0
    s_load_dwordx8 s[68:75], s[0:1], 56
    s_load_dwordx2 s[4:5], s[0:1], 104
    s_load_dwordx2 s[84:85], s[0:1], 96
    s_memrealtime s[46:47]
    s_load_dwordx2 s[96:97], s[0:1], 40
    v_lshrrev_b32 v1, 6, v0
    s_nop 0
    v_readfirstlane_b32 s30, v1
    s_getpc_b64 s[48:49]
K_pc:
    s_lshr_b32 s36, s2, 3
    s_lshl_b32 s36, s36, 11
    v_lshlrev_b32 v4, 2, v0
    v_add_u32 v4, s36, v4
    v_cmp_gt_u32 vcc, K_end-K_pc-8, v4
    s_nop 0
    s_and_saveexec_b64 s[36:37], vcc
    s_cbranch_execz K_3
    v_mov_b32 v5, s49
    v_add_co_u32 v4, vcc, s48, v4
    s_nop 1
    v_addc_co_u32 v5, vcc, 0, v5, vcc
    global_load_dword v250, v[4:5], off
K_3:
    s_mov_b64 exec, -1
    v_and_b32 v6, 31, v0
    v_lshrrev_b32 v7, 5, v0
    s_and_b32 s34, s2, 7
    s_lshr_b32 s35, s2, 3
    s_lshl_b32 s36, s35, 17
    s_lshl_b32 s37, s34, 8
    s_add_u32 s36, s36, s37
    v_lshlrev_b32 v8, 13, v7
    v_lshl_add_u32 v8, v6, 3, v8
    v_add_u32 v12, s36, v8
    v_add_u32 v14, 4096, v12
    s_mov_b32 s18, 4194304
    s_mov_b32 s19, 0x20000
    s_mov_b32 s22, s18
    s_mov_b32 s23, s19
    s_waitcnt lgkmcnt(0)
    s_mov_b32 s86, 256
    s_mov_b32 s87, 0x20000
    v_mov_b32 v78, 0
    s_lshl_b32 s45, s2, 3
    s_add_u32 s45, s45, s30
    s_cmp_lg_u32 s45, 4
    s_cbranch_scc1 KV_t0
    s_lshl_b32 s44, s46, 6
    s_or_b32 s44, s44, 1
    v_mov_b32 v76, s44
    s_mov_b64 exec, 1
    buffer_store_dword v76, v78, s[84:87], 0 offen sc1
    s_mov_b64 exec, -1
KV_t0:
    s_mov_b64 s[16:17], s[8:9]
    s_mov_b64 s[20:21], s[10:11]
    buffer_load_dwordx2 v[28:29], v12, s[16:19], 0 offen offset:0 nt
    buffer_load_dwordx2 v[30:31], v12, s[16:19], 0 offen offset:2048 nt
    buffer_load_dwordx2 v[32:33], v14, s[16:19], 0 offen offset:0 nt
    buffer_load_dwordx2 v[34:35], v14, s[16:19], 0 offen offset:2048 nt
    buffer_load_dwordx2 v[36:37], v12, s[20:23], 0 offen offset:0 nt
    buffer_load_dwordx2 v[38:39], v12, s[20:23], 0 offen offset:2048 nt
    buffer_load_dwordx2 v[40:41], v14, s[20:23], 0 offen offset:0 nt
    buffer_load_dwordx2 v[42:43], v14, s[20:23], 0 offen offset:2048 nt
    v_subrev_u32 v9, 6144, v12
    v_subrev_u32 v10, 4096, v12
    v_subrev_u32 v11, 2048, v12
    s_lshl_b32 s37, s34, 10
    v_lshlrev_b32 v16, 5, v6
    v_add_u32 v16, s37, v16
    s_mov_b32 s24, s12
    s_mov_b32 s25, s13
    s_mov_b32 s26, 0x2000
    s_mov_b32 s27, 0x20000
    buffer_load_dwordx4 v[44:47], v16, s[24:27], 0 offen offset:0
    buffer_load_dwordx4 v[48:51], v16, s[24:27], 0 offen offset:16
    s_cmp_lg_u32 s30, 4
    s_cbranch_scc1 KV_t2
    buffer_load_dword v76, v78, s[84:87], 0 offen sc1
KV_t2:
    buffer_load_dwordx2 v[22:23], v9, s[16:19], 0 offen nt
    buffer_load_dwordx2 v[24:25], v10, s[16:19], 0 offen nt
    buffer_load_dwordx2 v[26:27], v11, s[16:19], 0 offen nt
    v_and_b32 v1, 63, v0
    v_lshlrev_b32 v2, 4, v1
    v_lshlrev_b32 v3, 2, v1
    s_and_b32 s32, s2, 7
    s_lshr_b32 s33, s2, 3
    s_and_b32 s28, s32, 2
    s_lshr_b32 s34, s32, 2
    s_or_b32 s28, s28, s34
    s_lshl_b32 s28, s28, 2
    s_and_b32 s34, s33, 3
    s_add_u32 s28, s28, s34
    s_and_b32 s31, s32, 1
    s_lshr_b32 s33, s33, 2
    s_lshl_b32 s29, s31, 3
    s_add_u32 s29, s29, s33
    s_lshl_b32 s67, s33, 1
    s_and_b32 s67, s67, 0
    s_xor_b32 s99, s29, 1
    s_mov_b32 s60, 0
    s_mov_b32 s61, 40000
    s_mov_b32 s52, 0
    s_mov_b32 s55, 0
    s_mov_b32 s92, 0
    s_mov_b32 s93, 0
    s_mov_b32 s94, 0
    s_mov_b32 s56, s4
    s_mov_b32 s57, s5
    s_mov_b32 s58, 0xa000000
    s_mov_b32 s59, 0x20000
    v_and_b32 v199, 7, v0
    v_lshrrev_b32 v236, 6, v0
    v_lshlrev_b32 v236, 4, v236
    v_bfe_u32 v237, v0, 3, 3
    v_add_u32 v236, v236, v237
    s_lshr_b32 s78, s29, 1
    s_lshl_b32 s78, s78, 16
    s_and_b32 s79, s29, 1
    s_lshl_b32 s79, s79, 7
    s_add_u32 s78, s78, s79
    s_lshr_b32 s79, s30, 1
    s_lshl_b32 s79, s79, 13
    s_add_u32 s78, s78, s79
    v_lshlrev_b32 v196, 8, v236
    v_lshl_add_u32 v196, v199, 4, v196
    v_add_u32 v196, s78, v196
    s_lshl_b32 s78, s28, 7
    s_lshl_b32 s79, s29, 3
    s_add_u32 s78, s78, s79
    v_add_u32 v197, s78, v199
    v_lshlrev_b32 v198, 11, v197
    v_lshrrev_b32 v237, 2, v236
    v_lshlrev_b32 v237, 3, v237
    v_and_b32 v236, 3, v236
    v_add_u32 v236, v236, v237
    v_lshl_add_u32 v198, v236, 3, v198
    v_lshlrev_b32 v197, 3, v197
    v_lshl_add_u32 v197, v236, 14, v197
    s_add_u32 s62, s4, 33554432
    s_addc_u32 s63, s5, 0
    s_and_b32 s41, s30, 3
    s_and_b32 s38, s2, 7
    s_lshl_b32 s38, s38, 5
    s_lshr_b32 s39, s2, 3
    s_add_u32 s38, s38, s39
    s_lshl_b32 s39, s38, 2
    s_add_u32 s39, s39, s41
    s_mul_i32 s40, s41, 24576
    s_lshr_b32 s36, s39, 1
    s_lshl_b32 s36, s36, 2
    s_load_dword s98, s[96:97], s36
    s_lshl_b32 s36, s39, 12
    s_add_u32 s12, s14, s36
    s_addc_u32 s13, s15, 0
    s_mov_b32 s14, 4096
    s_mov_b32 s15, 0x20000
    s_lshr_b32 s45, s30, 2
    s_lshl_b32 s45, s45, 11
    s_add_u32 s36, s45, 0xffffffc0
    v_add_u32 v70, s36, v2
    v_add_u32 v71, 16, v70
    s_add_u32 s36, s45, 0x3c0
    v_add_u32 v72, s36, v2
    v_add_u32 v73, 16, v72
    s_mov_b32 s36, 4032
    v_add_u32 v74, s36, v2
    v_add_u32 v75, 16, v74
    s_and_b32 s34, s2, 7
    s_lshr_b32 s35, s2, 3
    v_mov_b32 v80, 0
    v_mov_b32 v81, 0
    v_mov_b32 v82, 0
    v_mov_b32 v83, 0
    v_add_u32 v86, s40, v2
    ds_write_b128 v86, v[80:83] offset:22784
    s_bfm_b64 exec, 26, 0
    ds_write_b128 v86, v[80:83] offset:23808
    s_mov_b64 exec, -1
    v_lshlrev_b32 v8, 2, v7
    v_sub_u32 v8, 60, v8
    v_lshrrev_b32 v85, 3, v8
    v_bfe_u32 v84, v6, 1, 3
    v_xor_b32 v85, v85, v84
    v_lshlrev_b32 v85, 4, v85
    v_and_b32 v8, 7, v8
    v_lshl_add_u32 v85, v8, 1, v85
    v_lshl_add_u32 v84, v6, 9, v85
    v_add_u32 v84, 98304, v84
    s_waitcnt vmcnt(0)
    s_cmp_lg_u32 s30, 4
    s_cbranch_scc1 KV_t1
KV_t1:
    buffer_load_dwordx4 v[52:55], v70, s[12:15], 0 offen nt
    buffer_load_dwordx2 v[56:57], v71, s[12:15], 0 offen nt
    buffer_load_dwordx4 v[58:61], v72, s[12:15], 0 offen nt
    buffer_load_dwordx2 v[62:63], v73, s[12:15], 0 offen nt
    buffer_load_dwordx4 v[64:67], v74, s[12:15], 0 offen nt
    buffer_load_dwordx2 v[68:69], v75, s[12:15], 0 offen nt
    v_lshlrev_b32 v88, 16, v44
    v_and_b32 v90, 0xffff0000, v44
    v_lshlrev_b32 v92, 16, v45
    v_and_b32 v94, 0xffff0000, v45
    v_lshlrev_b32 v89, 16, v46
    v_and_b32 v91, 0xffff0000, v46
    v_lshlrev_b32 v93, 16, v47
    v_and_b32 v95, 0xffff0000, v47
    v_lshlrev_b32 v96, 16, v22
    v_and_b32 v97, 0xffff0000, v22
    v_lshlrev_b32 v98, 16, v24
    v_and_b32 v99, 0xffff0000, v24
    v_lshlrev_b32 v100, 16, v26
    v_and_b32 v101, 0xffff0000, v26
    v_lshlrev_b32 v102, 16, v28
    v_and_b32 v103, 0xffff0000, v28
    v_lshlrev_b32 v104, 16, v30
    v_and_b32 v105, 0xffff0000, v30
    v_lshlrev_b32 v106, 16, v32
    v_and_b32 v107, 0xffff0000, v32
    v_lshlrev_b32 v108, 16, v34
    v_and_b32 v109, 0xffff0000, v34
    v_lshlrev_b32 v110, 16, v36
    v_and_b32 v111, 0xffff0000, v36
    v_lshlrev_b32 v112, 16, v38
    v_and_b32 v113, 0xffff0000, v38
    v_lshlrev_b32 v114, 16, v40
    v_and_b32 v115, 0xffff0000, v40
    v_lshlrev_b32 v116, 16, v42
    v_and_b32 v117, 0xffff0000, v42
    v_pk_mul_f32 v[118:119], v[96:97], v[94:95]
    v_pk_mul_f32 v[120:121], v[98:99], v[94:95]
    v_pk_mul_f32 v[122:123], v[100:101], v[94:95]
    v_pk_mul_f32 v[124:125], v[102:103], v[94:95]
    v_pk_fma_f32 v[118:119], v[98:99], v[92:93], v[118:119]
    v_pk_fma_f32 v[120:121], v[100:101], v[92:93], v[120:121]
    v_pk_fma_f32 v[122:123], v[102:103], v[92:93], v[122:123]
    v_pk_fma_f32 v[124:125], v[104:105], v[92:93], v[124:125]
    v_pk_fma_f32 v[118:119], v[100:101], v[90:91], v[118:119]
    v_pk_fma_f32 v[120:121], v[102:103], v[90:91], v[120:121]
    v_pk_fma_f32 v[122:123], v[104:105], v[90:91], v[122:123]
    v_pk_fma_f32 v[124:125], v[106:107], v[90:91], v[124:125]
    v_pk_fma_f32 v[118:119], v[102:103], v[88:89], v[118:119]
    v_pk_fma_f32 v[120:121], v[104:105], v[88:89], v[120:121]
    v_pk_fma_f32 v[122:123], v[106:107], v[88:89], v[122:123]
    v_pk_fma_f32 v[124:125], v[108:109], v[88:89], v[124:125]
    v_pk_mul_f32 v[118:119], v[118:119], v[110:111]
    v_pk_mul_f32 v[120:121], v[120:121], v[112:113]
    v_pk_mul_f32 v[122:123], v[122:123], v[114:115]
    v_pk_mul_f32 v[124:125], v[124:125], v[116:117]
    v_cvt_pk_bf16_f32 v136, v124, v122
    v_cvt_pk_bf16_f32 v137, v120, v118
    ds_write_b64 v84, v[136:137] offset:0
    v_cvt_pk_bf16_f32 v138, v125, v123
    v_cvt_pk_bf16_f32 v139, v121, v119
    ds_write_b64 v84, v[138:139] offset:128
    v_lshlrev_b32 v88, 16, v48
    v_and_b32 v90, 0xffff0000, v48
    v_lshlrev_b32 v92, 16, v49
    v_and_b32 v94, 0xffff0000, v49
    v_lshlrev_b32 v89, 16, v50
    v_and_b32 v91, 0xffff0000, v50
    v_lshlrev_b32 v93, 16, v51
    v_and_b32 v95, 0xffff0000, v51
    v_lshlrev_b32 v96, 16, v23
    v_and_b32 v97, 0xffff0000, v23
    v_lshlrev_b32 v98, 16, v25
    v_and_b32 v99, 0xffff0000, v25
    v_lshlrev_b32 v100, 16, v27
    v_and_b32 v101, 0xffff0000, v27
    v_lshlrev_b32 v102, 16, v29
    v_and_b32 v103, 0xffff0000, v29
    v_lshlrev_b32 v104, 16, v31
    v_and_b32 v105, 0xffff0000, v31
    v_lshlrev_b32 v106, 16, v33
    v_and_b32 v107, 0xffff0000, v33
    v_lshlrev_b32 v108, 16, v35
    v_and_b32 v109, 0xffff0000, v35
    v_lshlrev_b32 v110, 16, v37
    v_and_b32 v111, 0xffff0000, v37
    v_lshlrev_b32 v112, 16, v39
    v_and_b32 v113, 0xffff0000, v39
    v_lshlrev_b32 v114, 16, v41
    v_and_b32 v115, 0xffff0000, v41
    v_lshlrev_b32 v116, 16, v43
    v_and_b32 v117, 0xffff0000, v43
    v_pk_mul_f32 v[118:119], v[96:97], v[94:95]
    v_pk_mul_f32 v[120:121], v[98:99], v[94:95]
    v_pk_mul_f32 v[122:123], v[100:101], v[94:95]
    v_pk_mul_f32 v[124:125], v[102:103], v[94:95]
    v_pk_fma_f32 v[118:119], v[98:99], v[92:93], v[118:119]
    v_pk_fma_f32 v[120:121], v[100:101], v[92:93], v[120:121]
    v_pk_fma_f32 v[122:123], v[102:103], v[92:93], v[122:123]
    v_pk_fma_f32 v[124:125], v[104:105], v[92:93], v[124:125]
    v_pk_fma_f32 v[118:119], v[100:101], v[90:91], v[118:119]
    v_pk_fma_f32 v[120:121], v[102:103], v[90:91], v[120:121]
    v_pk_fma_f32 v[122:123], v[104:105], v[90:91], v[122:123]
    v_pk_fma_f32 v[124:125], v[106:107], v[90:91], v[124:125]
    v_pk_fma_f32 v[118:119], v[102:103], v[88:89], v[118:119]
    v_pk_fma_f32 v[120:121], v[104:105], v[88:89], v[120:121]
    v_pk_fma_f32 v[122:123], v[106:107], v[88:89], v[122:123]
    v_pk_fma_f32 v[124:125], v[108:109], v[88:89], v[124:125]
    v_pk_mul_f32 v[118:119], v[118:119], v[110:111]
    v_pk_mul_f32 v[120:121], v[120:121], v[112:113]
    v_pk_mul_f32 v[122:123], v[122:123], v[114:115]
    v_pk_mul_f32 v[124:125], v[124:125], v[116:117]
    v_cvt_pk_bf16_f32 v140, v124, v122
    v_cvt_pk_bf16_f32 v141, v120, v118
    ds_write_b64 v84, v[140:141] offset:256
    v_cvt_pk_bf16_f32 v142, v125, v123
    v_cvt_pk_bf16_f32 v143, v121, v119
    ds_write_b64 v84, v[142:143] offset:384
    s_cmp_lg_u32 s30, 4
    s_cbranch_scc1 HB_2
    v_add_u32 v18, 162816, v3
    ds_write_b32 v18, v78
    s_mov_b32 s53, 0
    s_waitcnt vmcnt(6)
HB_p:
    v_readfirstlane_b32 s52, v76
    s_nop 0
    s_cmp_eq_u32 s52, 0
    s_cbranch_scc1 HB_r
    s_cmp_ge_u32 s53, 400
    s_cbranch_scc1 HB_q
    s_add_u32 s54, s46, 8192
    s_lshl_b32 s54, s54, 6
    s_sub_u32 s54, s54, s52
    s_cmp_lt_u32 s54, 786432
    s_cbranch_scc1 HB_q
HB_r:
    buffer_load_dword v76, v78, s[84:87], 0 offen sc1
    s_waitcnt vmcnt(0)
    s_add_u32 s53, s53, 1
    s_cmp_lt_u32 s53, s61
    s_cbranch_scc1 HB_p
    s_mov_b32 s52, 1
    s_mov_b32 s61, 0
HB_q:
    v_mov_b32 v18, 162828
    v_mov_b32 v19, s52
    s_waitcnt lgkmcnt(0)
    ds_write_b32 v18, v19
HB_2:
    s_add_u32 s16, s4, 0x2000000
    s_addc_u32 s17, s5, 0
    s_mov_b32 s18, 0x8000000
    s_mov_b32 s19, 0x20000
    v_lshrrev_b32 v8, 3, v0
    v_and_b32 v85, 7, v0
    v_lshlrev_b32 v149, 12, v8
    v_lshl_add_u32 v149, v85, 4, v149
    s_lshl_b32 s36, s34, 24
    s_sub_u32 s37, 31, s35
    s_lshl_b32 s37, s37, 7
    s_add_u32 s36, s36, s37
    s_add_u32 s37, s36, 262144
    v_lshrrev_b32 v148, 3, v8
    v_xor_b32 v148, v148, v85
    v_lshlrev_b32 v148, 4, v148
    v_lshl_add_u32 v148, v8, 7, v148
    v_add_u32 v148, 98304, v148
    v_mov_b32 v18, 162828
    s_waitcnt lgkmcnt(0)
    s_barrier
    ds_read_b128 v[152:155], v148 offset:0
    ds_read_b128 v[156:159], v148 offset:8192
    ds_read_b32 v19, v18
    s_waitcnt lgkmcnt(2)
    v_or_b32 v152, 1, v152
    buffer_store_dwordx4 v[152:155], v149, s[16:19], s36 offen sc1
    s_waitcnt lgkmcnt(1)
    v_or_b32 v156, 1, v156
    buffer_store_dwordx4 v[156:159], v149, s[16:19], s37 offen sc1
    s_waitcnt lgkmcnt(0)
    v_readfirstlane_b32 s52, v19
    s_cmp_lg_u32 s30, 0
    s_cbranch_scc1 KV_ni
    s_cmp_ge_u32 s35, 16
    s_cbranch_scc1 KV_ni
    v_mov_b32 v8, s52
    s_lshl_b32 s37, s34, 7
    s_lshl_b32 s53, s35, 10
    s_add_u32 s37, s37, s53
    s_add_u32 s37, s37, 23101440
    s_mov_b64 exec, 1
    buffer_store_dword v8, v78, s[56:59], s37 offen sc1
    s_mov_b64 exec, -1
KV_ni:
    s_cmp_ge_u32 s2, 255
    s_cbranch_scc1 KV_n3
    s_cmp_lg_u32 s30, 5
    s_cbranch_scc1 KV_n3
    s_and_b32 s42, s2, 31
    s_lshl_b32 s42, s42, 8
    s_lshr_b32 s43, s2, 5
    s_lshl_b32 s43, s43, 14
    s_add_u32 s42, s42, s43
    s_add_u32 s42, s42, 39714816
    v_and_b32 v8, 1, v1
    v_lshlrev_b32 v8, 13, v8
    v_lshrrev_b32 v85, 1, v1
    v_lshl_add_u32 v8, v85, 7, v8
    s_mov_b64 exec, 0xf
    buffer_store_dword v8, v8, s[56:59], s42 offen sc1
    s_mov_b64 exec, -1
KV_n3:
    s_lshl_b32 s36, s34, 5
    s_add_u32 s36, s36, s35
    s_lshl_b32 s36, s36, 7
    s_add_u32 s36, s36, 23068672
    v_mov_b32 v18, 1
    v_mov_b32 v19, 162820
    v_mov_b32 v21, 0
    s_mov_b64 exec, 1
    s_waitcnt vmcnt(0)
    ds_add_rtn_u32 v20, v19, v18
    v_mov_b32 v19, s52
    s_waitcnt lgkmcnt(0)
    v_readfirstlane_b32 s54, v20
    s_nop 0
    s_and_b32 s54, s54, 7
    s_cmp_lg_u32 s54, 7
    s_cbranch_scc1 pub_1
    buffer_store_dword v19, v21, s[56:59], s36 offen sc1
pub_1:
    s_mov_b64 exec, -1
    s_mov_b32 s8, s6
    s_mov_b32 s9, s7
    s_mov_b32 s10, 0x400000
    s_mov_b32 s11, 0x20000
    buffer_load_dwordx2 v[180:181], v198, s[8:11], 0 offen offset:0 nt
    buffer_load_dwordx2 v[182:183], v198, s[8:11], 0 offen offset:32 nt
    buffer_load_dwordx2 v[184:185], v198, s[8:11], 0 offen offset:128 nt
    buffer_load_dwordx2 v[186:187], v198, s[8:11], 0 offen offset:160 nt
    v_add_u32 v160, s45, v86
    v_alignbit_b32 v88, v53, v52, 16
    v_mov_b32 v92, v53
    v_alignbit_b32 v96, v54, v53, 16
    v_alignbit_b32 v89, v54, v53, 16
    v_mov_b32 v93, v54
    v_alignbit_b32 v97, v55, v54, 16
    v_alignbit_b32 v90, v55, v54, 16
    v_mov_b32 v94, v55
    v_alignbit_b32 v98, v56, v55, 16
    v_alignbit_b32 v91, v56, v55, 16
    v_mov_b32 v95, v56
    v_alignbit_b32 v99, v57, v56, 16
    ds_write_b128 v160, v[88:91] offset:0
    ds_write_b128 v160, v[92:95] offset:4160
    ds_write_b128 v160, v[96:99] offset:8320
    ds_write_b128 v160, v[54:57] offset:12480
    v_alignbit_b32 v100, v59, v58, 16
    v_mov_b32 v104, v59
    v_alignbit_b32 v108, v60, v59, 16
    v_alignbit_b32 v101, v60, v59, 16
    v_mov_b32 v105, v60
    v_alignbit_b32 v109, v61, v60, 16
    v_alignbit_b32 v102, v61, v60, 16
    v_mov_b32 v106, v61
    v_alignbit_b32 v110, v62, v61, 16
    v_alignbit_b32 v103, v62, v61, 16
    v_mov_b32 v107, v62
    v_alignbit_b32 v111, v63, v62, 16
    ds_write_b128 v160, v[100:103] offset:1024
    ds_write_b128 v160, v[104:107] offset:5184
    ds_write_b128 v160, v[108:111] offset:9344
    ds_write_b128 v160, v[60:63] offset:13504
    v_alignbit_b32 v112, v65, v64, 16
    v_mov_b32 v116, v65
    v_alignbit_b32 v120, v66, v65, 16
    v_alignbit_b32 v113, v66, v65, 16
    v_mov_b32 v117, v66
    v_alignbit_b32 v121, v67, v66, 16
    v_alignbit_b32 v114, v67, v66, 16
    v_mov_b32 v118, v67
    v_alignbit_b32 v122, v68, v67, 16
    v_alignbit_b32 v115, v68, v67, 16
    v_mov_b32 v119, v68
    v_alignbit_b32 v123, v69, v68, 16
    s_mov_b64 exec, 0xf
    ds_write_b128 v86, v[112:115] offset:4096
    ds_write_b128 v86, v[116:119] offset:8256
    ds_write_b128 v86, v[120:123] offset:12416
    ds_write_b128 v86, v[66:69] offset:16576
    s_mov_b64 exec, -1
    s_waitcnt lgkmcnt(0)
    s_barrier
    v_mov_b32 v238, 0
    v_mov_b32 v239, 0
    v_mov_b32 v240, 0
    v_mov_b32 v241, 0
    v_mov_b32 v242, 0
    v_mov_b32 v243, 0
    v_mov_b32 v244, 0
    v_mov_b32 v245, 0
    v_mov_b32 v246, 0
    v_mov_b32 v247, 0
    s_cmp_ge_u32 s30, 4
    s_cbranch_scc1 FR_b
    s_and_b32 s38, s2, 7
    s_lshl_b32 s38, s38, 5
    s_lshr_b32 s39, s2, 3
    s_add_u32 s38, s38, s39
    s_lshl_b32 s39, s38, 2
    s_add_u32 s39, s39, s30
    s_mul_i32 s40, s30, 24576
    s_and_b32 s36, s39, 127
    s_lshl_b32 s36, s36, 12
    s_lshr_b32 s37, s39, 7
    s_lshl_b32 s37, s37, 24
    s_add_u32 s36, s36, s37
    s_add_u32 s36, s36, 33554432
    s_add_u32 s16, s4, s36
    s_addc_u32 s17, s5, 0
    s_mov_b32 s18, 4096
    s_mov_b32 s19, 0x20000
    v_lshrrev_b32 v6, 2, v1
    v_mul_u32_u24 v12, 96, v6
    v_and_b32 v6, 3, v1
    v_lshl_add_u32 v12, v6, 4, v12
    v_add_u32 v12, s40, v12
    v_and_b32 v35, 15, v1
    v_lshrrev_b32 v36, 4, v1
    v_and_b32 v6, 3, v35
    v_mul_u32_u24 v32, 4160, v6
    v_lshl_add_u32 v32, v36, 4, v32
    v_lshrrev_b32 v6, 2, v35
    v_lshl_add_u32 v32, v6, 3, v32
    v_add_u32 v32, s40, v32
    v_sub_u32 v6, 15, v35
    v_mul_u32_u24 v34, 96, v6
    v_add_u32 v34, s40, v34
    v_lshl_add_u32 v33, v36, 4, v34
    ds_read_b64 v[72:73], v32 offset:0
    ds_read_b64 v[74:75], v32 offset:8
    ds_read_b64 v[76:77], v32 offset:32
    ds_read_b64 v[78:79], v32 offset:40
    ds_read_b64 v[80:81], v32 offset:1024
    ds_read_b64 v[82:83], v32 offset:1032
    ds_read_b64 v[84:85], v32 offset:1056
    ds_read_b64 v[86:87], v32 offset:1064
    ds_read_b64 v[88:89], v32 offset:2048
    ds_read_b64 v[90:91], v32 offset:2056
    ds_read_b64 v[92:93], v32 offset:2080
    ds_read_b64 v[94:95], v32 offset:2088
    ds_read_b64 v[96:97], v32 offset:3072
    ds_read_b64 v[98:99], v32 offset:3080
    ds_read_b64 v[100:101], v32 offset:3104
    ds_read_b64 v[102:103], v32 offset:3112
    s_bitcmp1_b32 s39, 0
    s_cselect_b32 s36, 0, 16
    s_lshl_b32 s41, s98, s36
    s_and_b32 s41, s41, 0xffff0000
    s_lshr_b32 s36, s41, 16
    v_lshl_add_u32 v6, v36, 3, v35
    v_sub_u32 v6, 31, v6
    v_mov_b32 v10, s36
    v_mov_b32 v11, s41
    v_and_b32 v8, 1, v6
    v_cmp_eq_u32 vcc, 1, v8
    s_nop 1
    v_cndmask_b32 v10, v10, v11, vcc
    v_ashrrev_i32 v6, 1, v6
    v_cmp_eq_u32 vcc, 0, v6
    s_nop 1
    v_cndmask_b32 v152, 0, v10, vcc
    v_cmp_eq_u32 vcc, 1, v6
    s_nop 1
    v_cndmask_b32 v153, 0, v10, vcc
    v_cmp_eq_u32 vcc, 2, v6
    s_nop 1
    v_cndmask_b32 v154, 0, v10, vcc
    v_cmp_eq_u32 vcc, 3, v6
    s_nop 1
    v_cndmask_b32 v155, 0, v10, vcc
    v_cmp_eq_u32 vcc, 8, v6
    s_nop 1
    v_cndmask_b32 v156, 0, v10, vcc
    v_cmp_eq_u32 vcc, 9, v6
    s_nop 1
    v_cndmask_b32 v157, 0, v10, vcc
    v_cmp_eq_u32 vcc, 10, v6
    s_nop 1
    v_cndmask_b32 v158, 0, v10, vcc
    v_cmp_eq_u32 vcc, 11, v6
    s_nop 1
    v_cndmask_b32 v159, 0, v10, vcc
    s_add_u32 s12, s4, 0x1c00000
    s_addc_u32 s13, s5, 0
    s_mov_b32 s14, 0x400000
    s_mov_b32 s15, 0x20000
    v_bfe_u32 v6, v1, 2, 2
    v_mul_u32_u24 v168, 24640, v6
    v_lshrrev_b32 v6, 1, v36
    v_mul_u32_u24 v6, 72, v6
    v_add_u32 v168, v168, v6
    v_and_b32 v6, 1, v36
    v_lshl_add_u32 v168, v6, 5, v168
    v_and_b32 v6, 3, v1
    v_lshl_add_u32 v168, v6, 3, v168
    s_mul_i32 s36, s30, 1152
    v_add_u32 v168, s36, v168
    v_lshlrev_b32 v169, 3, v1
    s_lshl_b32 s44, s38, 14
    s_lshl_b32 s37, s30, 12
    s_add_u32 s44, s44, s37
    s_mul_i32 s36, s30, 24640
    v_mul_u32_u24 v170, 72, v35
    v_lshl_add_u32 v170, v36, 3, v170
    v_add_u32 v170, s36, v170
    s_cmp_lg_u32 s30, 0
    s_cbranch_scc1 CV_w
    s_and_b32 s36, s2, 7
    s_lshl_b32 s36, s36, 12
    s_add_u32 s36, s36, 23068672
    v_lshlrev_b32 v9, 7, v1
    v_add_u32 v9, s36, v9
    s_mov_b32 s53, 0
    s_add_u32 s54, s52, 0
    s_bfm_b64 exec, 32, 0
poll_2:
    buffer_load_dword v8, v9, s[56:59], 0 offen sc1
    s_waitcnt vmcnt(0)
    v_xor_b32 v8, s54, v8
    v_cmp_eq_u32 vcc, 0, v8
    s_nop 0
    s_cmp_eq_u64 vcc, exec
    s_cbranch_scc1 pok_3
    s_sleep 5
    s_add_u32 s53, s53, 1
    s_cmp_lt_u32 s53, s61
    s_cbranch_scc1 poll_2
    s_mov_b32 s61, 0
pok_3:
    s_mov_b64 exec, -1
    v_mov_b32 v8, 162832
    v_mov_b32 v9, 1
    s_waitcnt lgkmcnt(0)
    ds_write_b32 v8, v9
CV_w:
    v_mov_b32 v8, 162832
spin_4:
    ds_read_b32 v9, v8
    s_waitcnt lgkmcnt(0)
    v_readfirstlane_b32 s53, v9
    s_nop 0
    s_cmp_ge_u32 s53, 1
    s_cbranch_scc0 spin_4
    buffer_load_dwordx4 v[16:19], v2, s[16:19], 0 offen offset:0 sc1
    buffer_load_dwordx4 v[20:23], v2, s[16:19], 0 offen offset:1024 sc1
    buffer_load_dwordx4 v[24:27], v2, s[16:19], 0 offen offset:2048 sc1
    buffer_load_dwordx4 v[28:31], v2, s[16:19], 0 offen offset:3072 sc1
    s_waitcnt vmcnt(3)
    ds_write_b128 v12, v[16:19] offset:16640
    s_waitcnt vmcnt(2)
    ds_write_b128 v12, v[20:23] offset:18176
    s_waitcnt vmcnt(1)
    ds_write_b128 v12, v[24:27] offset:19712
    s_waitcnt vmcnt(0)
    ds_write_b128 v12, v[28:31] offset:21248
    v_mov_b32 v8, 162836
    v_mov_b32 v9, 1
    s_mov_b64 exec, 1
    ds_add_u32 v8, v9
    s_mov_b64 exec, -1
    s_waitcnt lgkmcnt(0)
    ds_read_b128 v[136:139], v33 offset:21248
    ds_read_b128 v[140:143], v33 offset:19712
    ds_read_b128 v[144:147], v33 offset:18176
    ds_read_b128 v[148:151], v33 offset:16640
    s_waitcnt lgkmcnt(3)
    v_mfma_f32_16x16x32_bf16 v[40:43], v[152:155], v[136:139], 0
    v_mfma_f32_16x16x32_bf16 v[44:47], v[156:159], v[136:139], 0
    s_waitcnt lgkmcnt(2)
    v_mfma_f32_16x16x32_bf16 v[48:51], v[152:155], v[140:143], 0
    v_mfma_f32_16x16x32_bf16 v[52:55], v[156:159], v[140:143], 0
    s_waitcnt lgkmcnt(1)
    v_mfma_f32_16x16x32_bf16 v[56:59], v[152:155], v[144:147], 0
    v_mfma_f32_16x16x32_bf16 v[60:63], v[156:159], v[144:147], 0
    s_waitcnt lgkmcnt(0)
    v_mfma_f32_16x16x32_bf16 v[64:67], v[152:155], v[148:151], 0
    v_mfma_f32_16x16x32_bf16 v[68:71], v[156:159], v[148:151], 0
    s_mov_b32 s43, 0
CV_r:
    s_waitcnt lgkmcnt(0)
    v_mfma_f32_16x16x32_bf16 v[40:43], v[72:75], v[136:139], v[40:43]
    v_mfma_f32_16x16x32_bf16 v[48:51], v[72:75], v[140:143], v[48:51]
    v_mfma_f32_16x16x32_bf16 v[56:59], v[72:75], v[144:147], v[56:59]
    v_mfma_f32_16x16x32_bf16 v[64:67], v[72:75], v[148:151], v[64:67]
    v_mfma_f32_16x16x32_bf16 v[44:47], v[76:79], v[136:139], v[44:47]
    v_mfma_f32_16x16x32_bf16 v[52:55], v[76:79], v[140:143], v[52:55]
    v_mfma_f32_16x16x32_bf16 v[60:63], v[76:79], v[144:147], v[60:63]
    v_mfma_f32_16x16x32_bf16 v[68:71], v[76:79], v[148:151], v[68:71]
    v_mfma_f32_16x16x32_bf16 v[48:51], v[80:83], v[136:139], v[48:51]
    v_mfma_f32_16x16x32_bf16 v[56:59], v[80:83], v[140:143], v[56:59]
    v_mfma_f32_16x16x32_bf16 v[64:67], v[80:83], v[144:147], v[64:67]
    v_mfma_f32_16x16x32_bf16 v[52:55], v[84:87], v[136:139], v[52:55]
    v_mfma_f32_16x16x32_bf16 v[60:63], v[84:87], v[140:143], v[60:63]
    v_mfma_f32_16x16x32_bf16 v[68:71], v[84:87], v[144:147], v[68:71]
    v_mfma_f32_16x16x32_bf16 v[56:59], v[88:91], v[136:139], v[56:59]
    v_mfma_f32_16x16x32_bf16 v[64:67], v[88:91], v[140:143], v[64:67]
    v_mfma_f32_16x16x32_bf16 v[60:63], v[92:95], v[136:139], v[60:63]
    v_mfma_f32_16x16x32_bf16 v[68:71], v[92:95], v[140:143], v[68:71]
    v_mfma_f32_16x16x32_bf16 v[64:67], v[96:99], v[136:139], v[64:67]
    v_mfma_f32_16x16x32_bf16 v[68:71], v[100:103], v[136:139], v[68:71]
    ds_read_b128 v[152:155], v33 offset:21344
    ds_read_b128 v[156:159], v33 offset:19808
    ds_read_b128 v[160:163], v33 offset:18272
    ds_read_b128 v[164:167], v33 offset:16736
    ds_read_b64 v[104:105], v32 offset:64
    ds_read_b64 v[106:107], v32 offset:72
    ds_read_b64 v[108:109], v32 offset:96
    ds_read_b64 v[110:111], v32 offset:104
    ds_read_b64 v[112:113], v32 offset:1088
    ds_read_b64 v[114:115], v32 offset:1096
    ds_read_b64 v[116:117], v32 offset:1120
    ds_read_b64 v[118:119], v32 offset:1128
    ds_read_b64 v[120:121], v32 offset:2112
    ds_read_b64 v[122:123], v32 offset:2120
    ds_read_b64 v[124:125], v32 offset:2144
    ds_read_b64 v[126:127], v32 offset:2152
    ds_read_b64 v[128:129], v32 offset:3136
    ds_read_b64 v[130:131], v32 offset:3144
    ds_read_b64 v[132:133], v32 offset:3168
    ds_read_b64 v[134:135], v32 offset:3176
    s_waitcnt lgkmcnt(0)
    v_mfma_f32_16x16x32_bf16 v[40:43], v[104:107], v[152:155], v[40:43]
    v_mfma_f32_16x16x32_bf16 v[48:51], v[104:107], v[156:159], v[48:51]
    v_mfma_f32_16x16x32_bf16 v[56:59], v[104:107], v[160:163], v[56:59]
    v_mfma_f32_16x16x32_bf16 v[64:67], v[104:107], v[164:167], v[64:67]
    v_mfma_f32_16x16x32_bf16 v[44:47], v[108:111], v[152:155], v[44:47]
    v_mfma_f32_16x16x32_bf16 v[52:55], v[108:111], v[156:159], v[52:55]
    v_mfma_f32_16x16x32_bf16 v[60:63], v[108:111], v[160:163], v[60:63]
    v_mfma_f32_16x16x32_bf16 v[68:71], v[108:111], v[164:167], v[68:71]
    v_mfma_f32_16x16x32_bf16 v[48:51], v[112:115], v[152:155], v[48:51]
    v_mfma_f32_16x16x32_bf16 v[56:59], v[112:115], v[156:159], v[56:59]
    v_mfma_f32_16x16x32_bf16 v[64:67], v[112:115], v[160:163], v[64:67]
    v_mfma_f32_16x16x32_bf16 v[52:55], v[116:119], v[152:155], v[52:55]
    v_mfma_f32_16x16x32_bf16 v[60:63], v[116:119], v[156:159], v[60:63]
    v_mfma_f32_16x16x32_bf16 v[68:71], v[116:119], v[160:163], v[68:71]
    v_mfma_f32_16x16x32_bf16 v[56:59], v[120:123], v[152:155], v[56:59]
    v_mfma_f32_16x16x32_bf16 v[64:67], v[120:123], v[156:159], v[64:67]
    v_mfma_f32_16x16x32_bf16 v[60:63], v[124:127], v[152:155], v[60:63]
    v_mfma_f32_16x16x32_bf16 v[68:71], v[124:127], v[156:159], v[68:71]
    v_mfma_f32_16x16x32_bf16 v[64:67], v[128:131], v[152:155], v[64:67]
    v_mfma_f32_16x16x32_bf16 v[68:71], v[132:135], v[152:155], v[68:71]
    ds_read_b128 v[136:139], v33 offset:21440
    ds_read_b128 v[140:143], v33 offset:19904
    ds_read_b128 v[144:147], v33 offset:18368
    ds_read_b128 v[148:151], v33 offset:16832
    ds_read_b64 v[72:73], v32 offset:128
    ds_read_b64 v[74:75], v32 offset:136
    ds_read_b64 v[76:77], v32 offset:160
    ds_read_b64 v[78:79], v32 offset:168
    ds_read_b64 v[80:81], v32 offset:1152
    ds_read_b64 v[82:83], v32 offset:1160
    ds_read_b64 v[84:85], v32 offset:1184
    ds_read_b64 v[86:87], v32 offset:1192
    ds_read_b64 v[88:89], v32 offset:2176
    ds_read_b64 v[90:91], v32 offset:2184
    ds_read_b64 v[92:93], v32 offset:2208
    ds_read_b64 v[94:95], v32 offset:2216
    ds_read_b64 v[96:97], v32 offset:3200
    ds_read_b64 v[98:99], v32 offset:3208
    ds_read_b64 v[100:101], v32 offset:3232
    ds_read_b64 v[102:103], v32 offset:3240
    v_add_u32 v32, 128, v32
    v_add_u32 v33, 192, v33
    s_add_u32 s43, s43, 1
    s_cmp_lt_u32 s43, 4
    s_cbranch_scc1 CV_r
CV_l:
    s_waitcnt lgkmcnt(10)
    v_mfma_f32_16x16x32_bf16 v[40:43], v[72:75], v[136:139], v[40:43]
    ds_read_b128 v[152:155], v33 offset:21344
    v_mfma_f32_16x16x32_bf16 v[48:51], v[72:75], v[140:143], v[48:51]
    ds_read_b128 v[156:159], v33 offset:19808
    v_mfma_f32_16x16x32_bf16 v[56:59], v[72:75], v[144:147], v[56:59]
    ds_read_b128 v[160:163], v33 offset:18272
    v_mfma_f32_16x16x32_bf16 v[64:67], v[72:75], v[148:151], v[64:67]
    ds_read_b128 v[164:167], v33 offset:16736
    v_mfma_f32_16x16x32_bf16 v[44:47], v[76:79], v[136:139], v[44:47]
    ds_read_b64 v[104:105], v32 offset:64
    v_mfma_f32_16x16x32_bf16 v[52:55], v[76:79], v[140:143], v[52:55]
    ds_read_b64 v[106:107], v32 offset:72
    v_mfma_f32_16x16x32_bf16 v[60:63], v[76:79], v[144:147], v[60:63]
    ds_read_b64 v[108:109], v32 offset:96
    v_mfma_f32_16x16x32_bf16 v[68:71], v[76:79], v[148:151], v[68:71]
    ds_read_b64 v[110:111], v32 offset:104
    v_mfma_f32_16x16x32_bf16 v[48:51], v[80:83], v[136:139], v[48:51]
    ds_read_b64 v[112:113], v32 offset:1088
    v_mfma_f32_16x16x32_bf16 v[56:59], v[80:83], v[140:143], v[56:59]
    ds_read_b64 v[114:115], v32 offset:1096
    s_waitcnt lgkmcnt(10)
    v_mfma_f32_16x16x32_bf16 v[64:67], v[80:83], v[144:147], v[64:67]
    ds_read_b64 v[116:117], v32 offset:1120
    v_mfma_f32_16x16x32_bf16 v[52:55], v[84:87], v[136:139], v[52:55]
    ds_read_b64 v[118:119], v32 offset:1128
    v_mfma_f32_16x16x32_bf16 v[60:63], v[84:87], v[140:143], v[60:63]
    ds_read_b64 v[120:121], v32 offset:2112
    v_mfma_f32_16x16x32_bf16 v[68:71], v[84:87], v[144:147], v[68:71]
    ds_read_b64 v[122:123], v32 offset:2120
    v_mfma_f32_16x16x32_bf16 v[56:59], v[88:91], v[136:139], v[56:59]
    ds_read_b64 v[124:125], v32 offset:2144
    v_mfma_f32_16x16x32_bf16 v[64:67], v[88:91], v[140:143], v[64:67]
    ds_read_b64 v[126:127], v32 offset:2152
    v_mfma_f32_16x16x32_bf16 v[60:63], v[92:95], v[136:139], v[60:63]
    ds_read_b64 v[128:129], v32 offset:3136
    v_mfma_f32_16x16x32_bf16 v[68:71], v[92:95], v[140:143], v[68:71]
    ds_read_b64 v[130:131], v32 offset:3144
    v_mfma_f32_16x16x32_bf16 v[64:67], v[96:99], v[136:139], v[64:67]
    ds_read_b64 v[132:133], v32 offset:3168
    v_mfma_f32_16x16x32_bf16 v[68:71], v[100:103], v[136:139], v[68:71]
    ds_read_b64 v[134:135], v32 offset:3176
    s_waitcnt lgkmcnt(10)
    v_mfma_f32_16x16x32_bf16 v[40:43], v[104:107], v[152:155], v[40:43]
    ds_read_b128 v[136:139], v33 offset:21440
    v_mfma_f32_16x16x32_bf16 v[48:51], v[104:107], v[156:159], v[48:51]
    ds_read_b128 v[140:143], v33 offset:19904
    v_mfma_f32_16x16x32_bf16 v[56:59], v[104:107], v[160:163], v[56:59]
    ds_read_b128 v[144:147], v33 offset:18368
    v_mfma_f32_16x16x32_bf16 v[64:67], v[104:107], v[164:167], v[64:67]
    ds_read_b128 v[148:151], v33 offset:16832
    v_mfma_f32_16x16x32_bf16 v[44:47], v[108:111], v[152:155], v[44:47]
    ds_read_b64 v[72:73], v32 offset:128
    v_mfma_f32_16x16x32_bf16 v[52:55], v[108:111], v[156:159], v[52:55]
    ds_read_b64 v[74:75], v32 offset:136
    v_add_u32 v33, 192, v33
    v_mfma_f32_16x16x32_bf16 v[60:63], v[108:111], v[160:163], v[60:63]
    ds_read_b64 v[76:77], v32 offset:160
    s_add_u32 s43, s43, 1
    v_mfma_f32_16x16x32_bf16 v[68:71], v[108:111], v[164:167], v[68:71]
    ds_read_b64 v[78:79], v32 offset:168
    s_cmp_lt_u32 s43, 8
    v_mfma_f32_16x16x32_bf16 v[48:51], v[112:115], v[152:155], v[48:51]
    ds_read_b64 v[80:81], v32 offset:1152
    v_mfma_f32_16x16x32_bf16 v[56:59], v[112:115], v[156:159], v[56:59]
    ds_read_b64 v[82:83], v32 offset:1160
    s_waitcnt lgkmcnt(10)
    v_mfma_f32_16x16x32_bf16 v[64:67], v[112:115], v[160:163], v[64:67]
    ds_read_b64 v[84:85], v32 offset:1184
    v_mfma_f32_16x16x32_bf16 v[52:55], v[116:119], v[152:155], v[52:55]
    ds_read_b64 v[86:87], v32 offset:1192
    v_mfma_f32_16x16x32_bf16 v[60:63], v[116:119], v[156:159], v[60:63]
    ds_read_b64 v[88:89], v32 offset:2176
    v_mfma_f32_16x16x32_bf16 v[68:71], v[116:119], v[160:163], v[68:71]
    ds_read_b64 v[90:91], v32 offset:2184
    v_mfma_f32_16x16x32_bf16 v[56:59], v[120:123], v[152:155], v[56:59]
    ds_read_b64 v[92:93], v32 offset:2208
    v_mfma_f32_16x16x32_bf16 v[64:67], v[120:123], v[156:159], v[64:67]
    ds_read_b64 v[94:95], v32 offset:2216
    v_mfma_f32_16x16x32_bf16 v[60:63], v[124:127], v[152:155], v[60:63]
    ds_read_b64 v[96:97], v32 offset:3200
    v_mfma_f32_16x16x32_bf16 v[68:71], v[124:127], v[156:159], v[68:71]
    ds_read_b64 v[98:99], v32 offset:3208
    v_mfma_f32_16x16x32_bf16 v[64:67], v[128:131], v[152:155], v[64:67]
    ds_read_b64 v[100:101], v32 offset:3232
    v_mfma_f32_16x16x32_bf16 v[68:71], v[132:135], v[152:155], v[68:71]
    ds_read_b64 v[102:103], v32 offset:3240
    v_add_u32 v32, 128, v32
    s_cbranch_scc1 CV_l
    s_waitcnt lgkmcnt(0)
    v_cvt_pk_bf16_f32 v16, v40, v41
    v_cvt_pk_bf16_f32 v17, v42, v43
    ds_write_b64 v170, v[16:17] offset:0
    v_cvt_pk_bf16_f32 v18, v44, v45
    v_cvt_pk_bf16_f32 v19, v46, v47
    ds_write_b64 v170, v[18:19] offset:32
    v_cvt_pk_bf16_f32 v20, v48, v49
    v_cvt_pk_bf16_f32 v21, v50, v51
    ds_write_b64 v170, v[20:21] offset:1152
    v_cvt_pk_bf16_f32 v22, v52, v53
    v_cvt_pk_bf16_f32 v23, v54, v55
    ds_write_b64 v170, v[22:23] offset:1184
    v_cvt_pk_bf16_f32 v24, v56, v57
    v_cvt_pk_bf16_f32 v25, v58, v59
    ds_write_b64 v170, v[24:25] offset:2304
    v_cvt_pk_bf16_f32 v26, v60, v61
    v_cvt_pk_bf16_f32 v27, v62, v63
    ds_write_b64 v170, v[26:27] offset:2336
    v_cvt_pk_bf16_f32 v28, v64, v65
    v_cvt_pk_bf16_f32 v29, v66, v67
    ds_write_b64 v170, v[28:29] offset:3456
    v_cvt_pk_bf16_f32 v30, v68, v69
    v_cvt_pk_bf16_f32 v31, v70, v71
    ds_write_b64 v170, v[30:31] offset:3488
    v_mov_b32 v8, 162824
    v_mov_b32 v9, 1
    s_waitcnt lgkmcnt(0)
    s_mov_b64 exec, 1
    ds_add_u32 v8, v9
    s_mov_b64 exec, -1
    v_mov_b32 v8, 162824
spin_5:
    ds_read_b32 v9, v8
    s_waitcnt lgkmcnt(0)
    v_readfirstlane_b32 s53, v9
    s_nop 0
    s_cmp_ge_u32 s53, 4
    s_cbranch_scc0 spin_5
    ds_read_b64_tr_b16 v[104:105], v168 offset:0
    ds_read_b64_tr_b16 v[106:107], v168 offset:144
    ds_read_b64_tr_b16 v[108:109], v168 offset:288
    ds_read_b64_tr_b16 v[110:111], v168 offset:432
    ds_read_b64_tr_b16 v[112:113], v168 offset:576
    ds_read_b64_tr_b16 v[114:115], v168 offset:720
    ds_read_b64_tr_b16 v[116:117], v168 offset:864
    ds_read_b64_tr_b16 v[118:119], v168 offset:1008
    s_waitcnt lgkmcnt(7)
    buffer_store_dwordx2 v[104:105], v169, s[12:15], s44 offen offset:0 sc1
    s_waitcnt lgkmcnt(6)
    buffer_store_dwordx2 v[106:107], v169, s[12:15], s44 offen offset:512 sc1
    s_waitcnt lgkmcnt(5)
    buffer_store_dwordx2 v[108:109], v169, s[12:15], s44 offen offset:1024 sc1
    s_waitcnt lgkmcnt(4)
    buffer_store_dwordx2 v[110:111], v169, s[12:15], s44 offen offset:1536 sc1
    s_waitcnt lgkmcnt(3)
    buffer_store_dwordx2 v[112:113], v169, s[12:15], s44 offen offset:2048 sc1
    s_waitcnt lgkmcnt(2)
    buffer_store_dwordx2 v[114:115], v169, s[12:15], s44 offen offset:2560 sc1
    s_waitcnt lgkmcnt(1)
    buffer_store_dwordx2 v[116:117], v169, s[12:15], s44 offen offset:3072 sc1
    s_waitcnt lgkmcnt(0)
    buffer_store_dwordx2 v[118:119], v169, s[12:15], s44 offen offset:3584 sc1
    v_mov_b32 v8, 162836
    v_mov_b32 v9, 1
    s_mov_b64 exec, 1
    ds_add_u32 v8, v9
    s_mov_b64 exec, -1
    s_and_b32 s36, s2, 7
    s_lshl_b32 s36, s36, 7
    s_add_u32 s36, s36, 23101440
    v_mov_b32 v6, 1
    v_mov_b32 v7, 162820
    v_lshlrev_b32 v9, 10, v1
    s_mov_b64 exec, 1
    s_waitcnt vmcnt(0)
    s_waitcnt lgkmcnt(0)
    ds_add_rtn_u32 v8, v7, v6
    ds_read_b32 v10, v7 offset:28
    s_waitcnt lgkmcnt(0)
    v_readfirstlane_b32 s54, v8
    v_readfirstlane_b32 s53, v10
    s_cmp_lg_u32 s54, 15
    s_cbranch_scc1 fa_6
    s_mov_b64 exec, 0xffff
    s_or_b32 s53, s53, 1
    v_mov_b32 v6, s53
    buffer_atomic_add v6, v9, s[56:59], s36 offen sc1
fa_6:
    s_mov_b64 exec, -1
    s_branch FR_end
FR_b:
    s_getpc_b64 s[34:35]
K_tpc:
    s_lshl_b32 s36, s29, 2
    s_and_b32 s37, s28, 3
    s_add_u32 s36, s36, s37
    s_lshl_b32 s36, s36, 6
    s_add_u32 s36, s36, K_tab-K_tpc
    s_add_u32 s34, s34, s36
    s_addc_u32 s35, s35, 0
    v_and_b32 v248, 31, v1
    v_lshlrev_b32 v248, 1, v248
    global_load_ushort v251, v248, s[34:35]
    v_lshrrev_b32 v253, 3, v1
    v_lshlrev_b32 v238, 11, v253
    v_and_b32 v253, 6, v253
    v_and_b32 v254, 7, v1
    v_xor_b32 v253, v253, v254
    v_lshl_add_u32 v238, v253, 4, v238
    v_lshrrev_b32 v253, 4, v1
    v_lshlrev_b32 v239, 11, v253
    v_add_u32 v253, 0, v253
    v_lshlrev_b32 v253, 1, v253
    v_and_b32 v254, 15, v1
    v_xor_b32 v253, v253, v254
    v_lshl_add_u32 v239, v253, 4, v239
    v_lshrrev_b32 v253, 4, v1
    v_lshlrev_b32 v240, 11, v253
    v_add_u32 v253, 4, v253
    v_lshlrev_b32 v253, 1, v253
    v_and_b32 v254, 15, v1
    v_xor_b32 v253, v253, v254
    v_lshl_add_u32 v240, v253, 4, v240
    v_add_u32 v254, 0, v1
    v_mul_u32_u24 v253, 2341, v254
    v_lshrrev_b32 v253, 16, v253
    v_mul_u32_u24 v241, 28, v253
    v_sub_u32 v254, v254, v241
    v_mul_u32_u24 v241, 7168, v253
    v_lshrrev_b32 v253, 1, v253
    v_and_b32 v253, 2, v253
    v_xor_b32 v254, v254, v253
    v_lshl_add_u32 v241, v254, 4, v241
    v_add_u32 v254, 64, v1
    v_mul_u32_u24 v253, 2341, v254
    v_lshrrev_b32 v253, 16, v253
    v_mul_u32_u24 v242, 28, v253
    v_sub_u32 v254, v254, v242
    v_mul_u32_u24 v242, 7168, v253
    v_lshrrev_b32 v253, 1, v253
    v_and_b32 v253, 2, v253
    v_xor_b32 v254, v254, v253
    v_lshl_add_u32 v242, v254, 4, v242
    v_add_u32 v254, 128, v1
    v_mul_u32_u24 v253, 2341, v254
    v_lshrrev_b32 v253, 16, v253
    v_mul_u32_u24 v243, 28, v253
    v_sub_u32 v254, v254, v243
    v_mul_u32_u24 v243, 7168, v253
    v_lshrrev_b32 v253, 1, v253
    v_and_b32 v253, 2, v253
    v_xor_b32 v254, v254, v253
    v_lshl_add_u32 v243, v254, 4, v243
    v_add_u32 v254, 192, v1
    v_mul_u32_u24 v253, 2341, v254
    v_lshrrev_b32 v253, 16, v253
    v_mul_u32_u24 v244, 28, v253
    v_sub_u32 v254, v254, v244
    v_mul_u32_u24 v244, 7168, v253
    v_lshrrev_b32 v253, 1, v253
    v_and_b32 v253, 2, v253
    v_xor_b32 v254, v254, v253
    v_lshl_add_u32 v244, v254, 4, v244
    v_add_u32 v254, 256, v1
    v_mul_u32_u24 v253, 2341, v254
    v_lshrrev_b32 v253, 16, v253
    v_mul_u32_u24 v245, 28, v253
    v_sub_u32 v254, v254, v245
    v_mul_u32_u24 v245, 7168, v253
    v_lshrrev_b32 v253, 1, v253
    v_and_b32 v253, 2, v253
    v_xor_b32 v254, v254, v253
    v_lshl_add_u32 v245, v254, 4, v245
    v_add_u32 v254, 320, v1
    v_mul_u32_u24 v253, 2341, v254
    v_lshrrev_b32 v253, 16, v253
    v_mul_u32_u24 v246, 28, v253
    v_sub_u32 v254, v254, v246
    v_mul_u32_u24 v246, 7168, v253
    v_lshrrev_b32 v253, 1, v253
    v_and_b32 v253, 2, v253
    v_xor_b32 v254, v254, v253
    v_lshl_add_u32 v246, v254, 4, v246
    v_add_u32 v254, 384, v1
    v_mul_u32_u24 v253, 2341, v254
    v_lshrrev_b32 v253, 16, v253
    v_mul_u32_u24 v247, 28, v253
    v_sub_u32 v254, v254, v247
    v_mul_u32_u24 v247, 7168, v253
    v_lshrrev_b32 v253, 1, v253
    v_and_b32 v253, 2, v253
    v_xor_b32 v254, v254, v253
    v_lshl_add_u32 v247, v254, 4, v247
    s_cmp_ge_u32 s30, 6
    s_cbranch_scc1 FB_cs
    s_cmp_ge_u32 s2, 255
    s_cbranch_scc1 FB_np
    s_cmp_lg_u32 s30, 5
    s_cbranch_scc1 FB_np
    s_and_b32 s42, s2, 31
    s_lshl_b32 s42, s42, 8
    s_lshr_b32 s43, s2, 5
    s_lshl_b32 s43, s43, 14
    s_add_u32 s42, s42, s43
    s_add_u32 s42, s42, 39714816
    v_mov_b32 v14, 0
    s_mov_b64 exec, 1
    s_mov_b32 s46, -1
    s_mov_b32 s47, -1
    s_mov_b32 s43, 0
FB_ml:
    s_add_u32 s45, s42, 0
    s_memtime s[34:35]
    s_waitcnt lgkmcnt(0)
    buffer_load_dword v13, v14, s[56:59], s45 offen sc1
    s_waitcnt vmcnt(0)
    s_memtime s[36:37]
    s_waitcnt lgkmcnt(0)
    s_sub_u32 s36, s36, s34
    s_min_u32 s46, s46, s36
    s_add_u32 s45, s42, 8192
    s_memtime s[34:35]
    s_waitcnt lgkmcnt(0)
    buffer_load_dword v13, v14, s[56:59], s45 offen sc1
    s_waitcnt vmcnt(0)
    s_memtime s[36:37]
    s_waitcnt lgkmcnt(0)
    s_sub_u32 s36, s36, s34
    s_min_u32 s47, s47, s36
    s_add_u32 s42, s42, 128
    s_add_u32 s43, s43, 1
    s_cmp_lt_u32 s43, 2
    s_cbranch_scc1 FB_ml
    s_cmp_lt_u32 s47, s46
    s_cselect_b32 s45, 1, 0
    s_lshr_b32 s46, s28, 2
    s_xor_b32 s45, s45, s46
    s_and_b32 s45, s45, 1
    s_lshl_b32 s45, s45, 8
    s_mov_b64 exec, -1
    v_mov_b32 v6, 162848
    v_mov_b32 v7, s45
    s_waitcnt lgkmcnt(0)
    ds_write_b32 v6, v7
FB_np:
    s_cmp_lg_u32 s30, 4
    s_cbranch_scc1 FB_ni
    v_mov_b32 v12, s52
    s_lshr_b32 s53, s28, 3
    s_lshl_b32 s53, s53, 2
    s_and_b32 s54, s28, 3
    s_add_u32 s53, s53, s54
    s_lshl_b32 s53, s53, 24
    s_lshr_b32 s54, s28, 2
    s_xor_b32 s54, s54, s94
    s_and_b32 s54, s54, 1
    s_lshl_b32 s54, s54, 13
    s_add_u32 s37, s53, s54
    s_add_u32 s37, s37, 33554432
    s_andn2_b32 s37, s37, 0x2000
    s_lshl_b32 s53, s29, 7
    s_add_u32 s37, s37, s53
    s_add_u32 s37, s37, 6029312
    v_and_b32 v13, 1, v1
    v_lshlrev_b32 v13, 13, v13
    v_lshrrev_b32 v14, 1, v1
    v_lshl_add_u32 v13, v14, 22, v13
    s_mov_b64 exec, 0xf
    buffer_store_dword v12, v13, s[56:59], s37 offen sc1
    s_cmp_lg_u32 s28, 0
    s_cbranch_scc1 FB_n2
    s_add_u32 s37, s53, 23117824
    s_mov_b64 exec, 1
    buffer_store_dword v12, v13, s[56:59], s37 offen sc1
FB_n2:
    s_mov_b64 exec, -1
    v_mov_b32 v16, 1
    v_mov_b32 v17, 0
    v_mov_b32 v18, 0
    v_mov_b32 v19, 0
    s_lshr_b32 s36, s2, 7
    s_lshl_b32 s36, s36, 24
    s_add_u32 s36, s36, 167772160
    s_add_u32 s20, s4, s36
    s_addc_u32 s21, s5, 0
    s_mov_b32 s22, 8388608
    s_mov_b32 s23, 0x20000
    s_and_b32 s36, s2, 127
    s_mul_i32 s36, s36, 65536
    s_add_u32 s36, s36, 16352
    v_and_b32 v13, 1, v1
    v_lshlrev_b32 v13, 4, v13
    v_bfe_u32 v14, v1, 1, 1
    v_lshl_add_u32 v13, v14, 13, v13
    v_bfe_u32 v14, v1, 2, 1
    v_mul_u32_u24 v14, 32800, v14
    v_add_u32 v13, v13, v14
    s_mov_b64 exec, 0xff
    buffer_store_dwordx4 v[16:19], v13, s[20:23], s36 offen sc1
    s_mov_b64 exec, -1
FB_ni:
    v_mov_b32 v6, 162836
spin_7:
    s_sleep 2
    ds_read_b32 v7, v6
    s_waitcnt lgkmcnt(0)
    v_readfirstlane_b32 s53, v7
    s_nop 0
    s_cmp_ge_u32 s53, 4
    s_cbranch_scc0 spin_7
    s_load_dwordx2 s[48:49], s[0:1], 64
    s_lshl_b32 s45, s2, 1
    s_and_b32 s50, s30, 1
    s_add_u32 s45, s45, s50
    s_mul_i32 s45, s45, 4096
    s_mov_b32 s50, 2097152
    s_mov_b32 s51, 0x20000
    s_waitcnt lgkmcnt(0)
    buffer_load_dwordx4 v[20:23], v2, s[48:51], s45 offen offset:0
    buffer_load_dwordx4 v[20:23], v2, s[48:51], s45 offen offset:1024
    buffer_load_dwordx4 v[20:23], v2, s[48:51], s45 offen offset:2048
    buffer_load_dwordx4 v[20:23], v2, s[48:51], s45 offen offset:3072
    s_and_b32 s36, s2, 7
    s_lshl_b32 s36, s36, 7
    s_add_u32 s36, s36, 23101440
    v_mov_b32 v6, 1
    v_mov_b32 v7, 162820
    v_lshlrev_b32 v9, 10, v1
    s_mov_b64 exec, 1
    s_waitcnt vmcnt(0)
    s_waitcnt lgkmcnt(0)
    ds_add_rtn_u32 v8, v7, v6
    ds_read_b32 v10, v7 offset:28
    s_waitcnt lgkmcnt(0)
    v_readfirstlane_b32 s54, v8
    v_readfirstlane_b32 s53, v10
    s_cmp_lg_u32 s54, 15
    s_cbranch_scc1 fa_8
    s_mov_b64 exec, 0xffff
    s_or_b32 s53, s53, 1
    v_mov_b32 v6, s53
    buffer_atomic_add v6, v9, s[56:59], s36 offen sc1
fa_8:
    s_mov_b64 exec, -1
    v_bfe_u32 v252, v251, 2, 2
    v_lshlrev_b32 v248, 14, v252
    v_and_b32 v252, 3, v251
    v_lshl_add_u32 v248, v252, 11, v248
    v_bfe_u32 v252, v251, 7, 3
    v_lshlrev_b32 v249, 14, v252
    v_bfe_u32 v252, v251, 4, 3
    v_lshl_add_u32 v249, v252, 10, v249
    v_bfe_u32 v252, v251, 13, 3
    v_lshlrev_b32 v250, 14, v252
    v_bfe_u32 v252, v251, 10, 3
    v_lshl_add_u32 v250, v252, 10, v250
    v_mov_b32 v6, 162840
spin_9:
    s_sleep 4
    ds_read_b32 v7, v6
    s_waitcnt lgkmcnt(0)
    v_readfirstlane_b32 s53, v7
    s_nop 0
    s_cmp_ge_u32 s53, 2
    s_cbranch_scc0 spin_9
    s_call_b64 s[76:77], SUB_w1_regs
    s_call_b64 s[76:77], SUB_park
    v_mov_b32 v6, 162840
spin_10:
    s_sleep 3
    ds_read_b32 v7, v6
    s_waitcnt lgkmcnt(0)
    v_readfirstlane_b32 s53, v7
    s_nop 0
    s_cmp_ge_u32 s53, 4
    s_cbranch_scc0 spin_10
    s_mov_b64 s[12:13], s[68:69]
    s_mov_b32 s14, 2097152
    s_mov_b32 s15, 0x20000
    s_and_b32 s35, s30, 1
    s_mul_i32 s38, s99, 128
    s_mul_i32 s41, s35, 65536
    s_add_u32 s38, s38, s41
    s_mul_i32 s41, s35, 4096
    s_add_u32 s41, s41, 24576
    s_mov_b32 s42, 0
    s_mov_b32 s44, s67
    s_mov_b32 s42, 73728
    s_mov_b32 s44, s67
    s_add_u32 s44, s44, 9
    s_and_b32 s44, s44, 15
    s_call_b64 s[76:77], SUB_w_issue_1
    s_waitcnt vmcnt(8)
    s_mov_b32 s42, 81920
    s_mov_b32 s44, s67
    s_add_u32 s44, s44, 10
    s_and_b32 s44, s44, 15
    s_call_b64 s[76:77], SUB_w_issue_1
    s_waitcnt vmcnt(8)
    s_mov_b32 s42, 90112
    s_mov_b32 s44, s67
    s_add_u32 s44, s44, 11
    s_and_b32 s44, s44, 15
    s_call_b64 s[76:77], SUB_w_issue_1
    s_waitcnt vmcnt(8)
    s_call_b64 s[76:77], SUB_w1_put
    s_branch FR_end
FB_cs:
    v_and_b32 v164, 15, v1
    v_mov_b32 v165, 0x3f803f80
    v_cmp_eq_u32 vcc, 0, v164
    s_nop 1
    v_cndmask_b32 v16, 0, v165, vcc
    v_cndmask_b32 v17, 0, v165, vcc
    v_cndmask_b32 v18, 0, v165, vcc
    v_cndmask_b32 v19, 0, v165, vcc
    v_cmp_eq_u32 vcc, 1, v164
    s_nop 1
    v_cndmask_b32 v20, 0, v165, vcc
    v_cndmask_b32 v21, 0, v165, vcc
    v_cndmask_b32 v22, 0, v165, vcc
    v_cndmask_b32 v23, 0, v165, vcc
    v_cmp_eq_u32 vcc, 2, v164
    s_nop 1
    v_cndmask_b32 v24, 0, v165, vcc
    v_cndmask_b32 v25, 0, v165, vcc
    v_cndmask_b32 v26, 0, v165, vcc
    v_cndmask_b32 v27, 0, v165, vcc
    v_cmp_eq_u32 vcc, 3, v164
    s_nop 1
    v_cndmask_b32 v28, 0, v165, vcc
    v_cndmask_b32 v29, 0, v165, vcc
    v_cndmask_b32 v30, 0, v165, vcc
    v_cndmask_b32 v31, 0, v165, vcc
    v_cmp_eq_u32 vcc, 4, v164
    s_nop 1
    v_cndmask_b32 v32, 0, v165, vcc
    v_cndmask_b32 v33, 0, v165, vcc
    v_cndmask_b32 v34, 0, v165, vcc
    v_cndmask_b32 v35, 0, v165, vcc
    v_cmp_eq_u32 vcc, 5, v164
    s_nop 1
    v_cndmask_b32 v36, 0, v165, vcc
    v_cndmask_b32 v37, 0, v165, vcc
    v_cndmask_b32 v38, 0, v165, vcc
    v_cndmask_b32 v39, 0, v165, vcc
    v_cmp_eq_u32 vcc, 6, v164
    s_nop 1
    v_cndmask_b32 v40, 0, v165, vcc
    v_cndmask_b32 v41, 0, v165, vcc
    v_cndmask_b32 v42, 0, v165, vcc
    v_cndmask_b32 v43, 0, v165, vcc
    v_cmp_eq_u32 vcc, 7, v164
    s_nop 1
    v_cndmask_b32 v44, 0, v165, vcc
    v_cndmask_b32 v45, 0, v165, vcc
    v_cndmask_b32 v46, 0, v165, vcc
    v_cndmask_b32 v47, 0, v165, vcc
    v_cmp_eq_u32 vcc, 8, v164
    s_nop 1
    v_cndmask_b32 v48, 0, v165, vcc
    v_cndmask_b32 v49, 0, v165, vcc
    v_cndmask_b32 v50, 0, v165, vcc
    v_cndmask_b32 v51, 0, v165, vcc
    v_cmp_eq_u32 vcc, 9, v164
    s_nop 1
    v_cndmask_b32 v52, 0, v165, vcc
    v_cndmask_b32 v53, 0, v165, vcc
    v_cndmask_b32 v54, 0, v165, vcc
    v_cndmask_b32 v55, 0, v165, vcc
    v_cmp_eq_u32 vcc, 10, v164
    s_nop 1
    v_cndmask_b32 v56, 0, v165, vcc
    v_cndmask_b32 v57, 0, v165, vcc
    v_cndmask_b32 v58, 0, v165, vcc
    v_cndmask_b32 v59, 0, v165, vcc
    v_cmp_eq_u32 vcc, 11, v164
    s_nop 1
    v_cndmask_b32 v60, 0, v165, vcc
    v_cndmask_b32 v61, 0, v165, vcc
    v_cndmask_b32 v62, 0, v165, vcc
    v_cndmask_b32 v63, 0, v165, vcc
    v_cmp_eq_u32 vcc, 12, v164
    s_nop 1
    v_cndmask_b32 v64, 0, v165, vcc
    v_cndmask_b32 v65, 0, v165, vcc
    v_cndmask_b32 v66, 0, v165, vcc
    v_cndmask_b32 v67, 0, v165, vcc
    v_cmp_eq_u32 vcc, 13, v164
    s_nop 1
    v_cndmask_b32 v68, 0, v165, vcc
    v_cndmask_b32 v69, 0, v165, vcc
    v_cndmask_b32 v70, 0, v165, vcc
    v_cndmask_b32 v71, 0, v165, vcc
    s_mov_b32 s35, 0
    v_lshrrev_b32 v253, 2, v1
    v_mul_u32_u24 v144, 128, v253
    v_and_b32 v254, 3, v1
    v_lshl_add_u32 v144, v254, 3, v144
    v_add_u32 v144, 24576, v144
    v_bfe_u32 v253, v253, 1, 2
    s_mul_i32 s36, s35, 4
    s_add_u32 s36, s36, 3
    v_xor_b32 v254, s36, v253
    v_lshl_add_u32 v147, v254, 5, v144
    s_mul_i32 s36, s35, 4
    s_add_u32 s36, s36, 2
    v_xor_b32 v254, s36, v253
    v_lshl_add_u32 v146, v254, 5, v144
    s_mul_i32 s36, s35, 4
    s_add_u32 s36, s36, 1
    v_xor_b32 v254, s36, v253
    v_lshl_add_u32 v145, v254, 5, v144
    s_mul_i32 s36, s35, 4
    s_add_u32 s36, s36, 0
    v_xor_b32 v254, s36, v253
    v_lshl_add_u32 v144, v254, 5, v144
    s_and_b32 s35, s30, 1
    s_mul_i32 s35, s35, 4096
    s_add_u32 s35, s35, 73728
    v_add_u32 v144, s35, v144
    v_add_u32 v145, s35, v145
    v_add_u32 v146, s35, v146
    v_add_u32 v147, s35, v147
    s_mov_b32 s35, 0
    v_lshrrev_b32 v253, 2, v1
    v_mul_u32_u24 v148, 448, v253
    v_and_b32 v254, 3, v1
    v_lshl_add_u32 v148, v254, 3, v148
    v_add_u32 v148, 73728, v148
    s_mul_i32 s36, s35, 224
    v_add_u32 v148, s36, v148
    v_bfe_u32 v253, v1, 4, 1
    v_lshlrev_b32 v253, 5, v253
    s_cmp_eq_u32 s35, 0
    s_cselect_b32 s36, 1, -1
    v_mul_lo_u32 v253, v253, s36
    v_sub_u32 v149, v148, v253
    v_add_u32 v148, v148, v253
    s_and_b32 s35, s30, 1
    s_mul_i32 s35, s35, 14336
    s_add_u32 s35, s35, 32768
    v_add_u32 v148, s35, v148
    v_add_u32 v149, s35, v149
    s_mov_b32 s35, 1
    v_lshrrev_b32 v253, 2, v1
    v_mul_u32_u24 v150, 448, v253
    v_and_b32 v254, 3, v1
    v_lshl_add_u32 v150, v254, 3, v150
    v_add_u32 v150, 73728, v150
    s_mul_i32 s36, s35, 224
    v_add_u32 v150, s36, v150
    v_bfe_u32 v253, v1, 4, 1
    v_lshlrev_b32 v253, 5, v253
    s_cmp_eq_u32 s35, 0
    s_cselect_b32 s36, 1, -1
    v_mul_lo_u32 v253, v253, s36
    v_sub_u32 v151, v150, v253
    v_add_u32 v150, v150, v253
    s_and_b32 s35, s30, 1
    s_mul_i32 s35, s35, 14336
    s_add_u32 s35, s35, 32768
    v_add_u32 v150, s35, v150
    v_add_u32 v151, s35, v151
    v_mov_b32 v156, 0
    v_mov_b32 v157, 0
    v_mov_b32 v158, 0
    v_mov_b32 v159, 0
    v_mov_b32 v160, 0
    v_mov_b32 v161, 0
    v_mov_b32 v162, 0
    v_mov_b32 v163, 0
    v_lshrrev_b32 v166, 4, v1
    v_lshlrev_b32 v166, 4, v166
    v_lshl_add_u32 v166, v164, 6, v166
    v_mov_b32 v165, 0x7f000000
    v_cmp_gt_u32 vcc, 4, v164
    s_nop 1
    v_cndmask_b32 v167, v165, v166, vcc
    v_cmp_gt_u32 vcc, 14, v164
    s_nop 1
    v_cndmask_b32 v168, v165, v166, vcc
    v_mov_b32 v6, 162836
spin_11:
    s_sleep 2
    ds_read_b32 v7, v6
    s_waitcnt lgkmcnt(0)
    v_readfirstlane_b32 s53, v7
    s_nop 0
    s_cmp_ge_u32 s53, 4
    s_cbranch_scc0 spin_11
    s_mov_b64 s[12:13], s[68:69]
    s_mov_b32 s14, 2097152
    s_mov_b32 s15, 0x20000
    s_and_b32 s35, s30, 1
    s_mul_i32 s38, s99, 128
    s_mul_i32 s41, s35, 65536
    s_add_u32 s38, s38, s41
    s_mul_i32 s41, s35, 4096
    s_add_u32 s41, s41, 24576
    s_mov_b32 s42, 0
    s_mov_b32 s44, s67
    s_mov_b32 s42, 73728
    s_mov_b32 s44, s28
    s_add_u32 s19, s41, s42
    s_mul_i32 s16, s44, 131072
    s_add_u32 s16, s16, s38
    s_add_u32 s44, s44, 1
    s_and_b32 s44, s44, 15
    s_add_u32 s42, s42, 8192
    s_cmp_eq_u32 s42, 131072
    s_cselect_b32 s42, 0, s42
    s_mov_b32 m0, s19
    s_mov_b32 s39, s16
    buffer_load_dwordx4 v238, s[12:15], s39 offen lds
    s_add_u32 m0, m0, 1024
    s_add_u32 s39, s39, 16384
    buffer_load_dwordx4 v238, s[12:15], s39 offen lds
    s_add_u32 m0, m0, 1024
    s_add_u32 s39, s39, 16384
    buffer_load_dwordx4 v238, s[12:15], s39 offen lds
    s_add_u32 m0, m0, 1024
    s_add_u32 s39, s39, 16384
    buffer_load_dwordx4 v238, s[12:15], s39 offen lds
    s_mov_b64 s[12:13], s[72:73]
    s_mov_b32 s14, 7340032
    s_mov_b32 s15, 0x20000
    s_and_b32 s35, s30, 1
    s_mul_i32 s38, s29, 448
    s_mul_i32 s41, s35, 229376
    s_add_u32 s38, s38, s41
    s_mul_i32 s41, s35, 14336
    s_add_u32 s41, s41, 73728
    s_mov_b32 s42, 0
    s_mov_b32 s44, 0
    s_mov_b32 s42, 32768
    s_mov_b32 s44, s28
    s_add_u32 s19, s41, s42
    s_mul_i32 s16, s44, 458752
    s_add_u32 s16, s16, s38
    s_add_u32 s44, s44, 1
    s_and_b32 s44, s44, 15
    s_add_u32 s42, s42, 28672
    s_cmp_eq_u32 s42, 86016
    s_cselect_b32 s42, 0, s42
    s_mov_b32 m0, s19
    s_mov_b32 s39, s16
    buffer_load_dwordx4 v241, s[12:15], s39 offen lds
    s_add_u32 m0, m0, 1024
    s_nop 0
    buffer_load_dwordx4 v242, s[12:15], s39 offen lds
    s_add_u32 m0, m0, 1024
    s_nop 0
    buffer_load_dwordx4 v243, s[12:15], s39 offen lds
    s_add_u32 m0, m0, 1024
    s_nop 0
    buffer_load_dwordx4 v244, s[12:15], s39 offen lds
    s_add_u32 m0, m0, 1024
    s_nop 0
    buffer_load_dwordx4 v245, s[12:15], s39 offen lds
    s_add_u32 m0, m0, 1024
    s_nop 0
    buffer_load_dwordx4 v246, s[12:15], s39 offen lds
    s_add_u32 m0, m0, 1024
    s_nop 0
    buffer_load_dwordx4 v247, s[12:15], s39 offen lds
    s_add_u32 m0, m0, 1024
    s_add_u32 s39, s39, 114688
    buffer_load_dwordx4 v241, s[12:15], s39 offen lds
    s_add_u32 m0, m0, 1024
    s_nop 0
    buffer_load_dwordx4 v242, s[12:15], s39 offen lds
    s_add_u32 m0, m0, 1024
    s_nop 0
    buffer_load_dwordx4 v243, s[12:15], s39 offen lds
    s_add_u32 m0, m0, 1024
    s_nop 0
    buffer_load_dwordx4 v244, s[12:15], s39 offen lds
    s_add_u32 m0, m0, 1024
    s_nop 0
    buffer_load_dwordx4 v245, s[12:15], s39 offen lds
    s_add_u32 m0, m0, 1024
    s_nop 0
    buffer_load_dwordx4 v246, s[12:15], s39 offen lds
    s_add_u32 m0, m0, 1024
    s_nop 0
    buffer_load_dwordx4 v247, s[12:15], s39 offen lds
    s_waitcnt vmcnt(14)
    s_setprio 1
    ds_read_b64_tr_b16 v[128:129], v144 offset:0
    ds_read_b64_tr_b16 v[130:131], v144 offset:2048
    ds_read_b64_tr_b16 v[132:133], v145 offset:0
    ds_read_b64_tr_b16 v[134:135], v145 offset:2048
    ds_read_b64_tr_b16 v[136:137], v146 offset:0
    ds_read_b64_tr_b16 v[138:139], v146 offset:2048
    ds_read_b64_tr_b16 v[140:141], v147 offset:0
    ds_read_b64_tr_b16 v[142:143], v147 offset:2048
    s_add_u32 s20, s4, 0x1400000
    s_addc_u32 s21, s5, 0
    s_mov_b32 s22, 0x20000
    s_mov_b32 s23, 0x20000
    s_lshl_b32 s35, s28, 1
    s_and_b32 s36, s30, 1
    s_add_u32 s35, s35, s36
    s_mul_i32 s35, s35, 4096
    s_mul_i32 s36, s29, 256
    s_add_u32 s35, s35, s36
    s_waitcnt lgkmcnt(0)
    v_mfma_f32_16x16x32_bf16 v[160:163], v[128:131], v[16:19], v[160:163]
    v_mfma_f32_16x16x32_bf16 v[160:163], v[132:135], v[20:23], v[160:163]
    v_mfma_f32_16x16x32_bf16 v[160:163], v[136:139], v[24:27], v[160:163]
    v_mfma_f32_16x16x32_bf16 v[160:163], v[140:143], v[28:31], v[160:163]
    s_nop 7
    buffer_store_dwordx4 v[160:163], v167, s[20:23], s35 offen sc1
    s_waitcnt vmcnt(1)
    v_mov_b32 v6, 162840
    v_mov_b32 v7, 1
    s_mov_b64 exec, 1
    ds_add_u32 v6, v7
    s_mov_b64 exec, -1
    ds_read_b64_tr_b16 v[72:73], v148 offset:0
    ds_read_b64_tr_b16 v[74:75], v148 offset:7168
    ds_read_b64_tr_b16 v[76:77], v149 offset:32
    ds_read_b64_tr_b16 v[78:79], v149 offset:7200
    ds_read_b64_tr_b16 v[80:81], v148 offset:64
    ds_read_b64_tr_b16 v[82:83], v148 offset:7232
    ds_read_b64_tr_b16 v[84:85], v149 offset:96
    ds_read_b64_tr_b16 v[86:87], v149 offset:7264
    ds_read_b64_tr_b16 v[88:89], v148 offset:128
    ds_read_b64_tr_b16 v[90:91], v148 offset:7296
    ds_read_b64_tr_b16 v[92:93], v149 offset:160
    ds_read_b64_tr_b16 v[94:95], v149 offset:7328
    ds_read_b64_tr_b16 v[96:97], v148 offset:192
    ds_read_b64_tr_b16 v[98:99], v148 offset:7360
    ds_read_b64_tr_b16 v[100:101], v150 offset:0
    ds_read_b64_tr_b16 v[102:103], v150 offset:7168
    ds_read_b64_tr_b16 v[104:105], v151 offset:32
    ds_read_b64_tr_b16 v[106:107], v151 offset:7200
    ds_read_b64_tr_b16 v[108:109], v150 offset:64
    ds_read_b64_tr_b16 v[110:111], v150 offset:7232
    ds_read_b64_tr_b16 v[112:113], v151 offset:96
    ds_read_b64_tr_b16 v[114:115], v151 offset:7264
    ds_read_b64_tr_b16 v[116:117], v150 offset:128
    ds_read_b64_tr_b16 v[118:119], v150 offset:7296
    ds_read_b64_tr_b16 v[120:121], v151 offset:160
    ds_read_b64_tr_b16 v[122:123], v151 offset:7328
    ds_read_b64_tr_b16 v[124:125], v150 offset:192
    ds_read_b64_tr_b16 v[126:127], v150 offset:7360
    s_add_u32 s20, s4, 0x1420000
    s_addc_u32 s21, s5, 0
    s_mov_b32 s22, 0x70000
    s_mov_b32 s23, 0x20000
    s_lshl_b32 s35, s28, 1
    s_and_b32 s36, s30, 1
    s_add_u32 s35, s35, s36
    s_mul_i32 s35, s35, 14336
    s_mul_i32 s36, s29, 896
    s_add_u32 s35, s35, s36
    s_waitcnt lgkmcnt(0)
    v_mfma_f32_16x16x32_bf16 v[156:159], v[72:75], v[16:19], v[156:159]
    v_mfma_f32_16x16x32_bf16 v[156:159], v[76:79], v[20:23], v[156:159]
    v_mfma_f32_16x16x32_bf16 v[156:159], v[80:83], v[24:27], v[156:159]
    v_mfma_f32_16x16x32_bf16 v[156:159], v[84:87], v[28:31], v[156:159]
    v_mfma_f32_16x16x32_bf16 v[156:159], v[88:91], v[32:35], v[156:159]
    v_mfma_f32_16x16x32_bf16 v[156:159], v[92:95], v[36:39], v[156:159]
    v_mfma_f32_16x16x32_bf16 v[156:159], v[96:99], v[40:43], v[156:159]
    v_mfma_f32_16x16x32_bf16 v[156:159], v[100:103], v[44:47], v[156:159]
    v_mfma_f32_16x16x32_bf16 v[156:159], v[104:107], v[48:51], v[156:159]
    v_mfma_f32_16x16x32_bf16 v[156:159], v[108:111], v[52:55], v[156:159]
    v_mfma_f32_16x16x32_bf16 v[156:159], v[112:115], v[56:59], v[156:159]
    v_mfma_f32_16x16x32_bf16 v[156:159], v[116:119], v[60:63], v[156:159]
    v_mfma_f32_16x16x32_bf16 v[156:159], v[120:123], v[64:67], v[156:159]
    v_mfma_f32_16x16x32_bf16 v[156:159], v[124:127], v[68:71], v[156:159]
    s_nop 7
    buffer_store_dwordx4 v[156:159], v168, s[20:23], s35 offen sc1
    s_and_b32 s36, s2, 7
    s_lshl_b32 s36, s36, 7
    s_add_u32 s36, s36, 23101440
    v_mov_b32 v6, 1
    v_mov_b32 v7, 162820
    v_lshlrev_b32 v9, 10, v1
    s_mov_b64 exec, 1
    s_waitcnt lgkmcnt(0)
    ds_add_rtn_u32 v8, v7, v6
    ds_read_b32 v10, v7 offset:28
    s_waitcnt lgkmcnt(0)
    v_readfirstlane_b32 s54, v8
    v_readfirstlane_b32 s53, v10
    s_cmp_lg_u32 s54, 15
    s_cbranch_scc1 fa_12
    s_mov_b64 exec, 0xffff
    s_or_b32 s53, s53, 1
    v_mov_b32 v6, s53
    buffer_atomic_add v6, v9, s[56:59], s36 offen sc1
fa_12:
    s_mov_b64 exec, -1
    v_and_b32 v252, 15, v251
    v_mul_u32_u24 v248, 458752, v252
    s_and_b32 s36, s30, 1
    s_mul_i32 s36, s36, 6
    s_add_u32 s36, s36, 4
    v_bfe_u32 v252, v251, s36, 6
    v_mul_u32_u24 v250, 37, v252
    v_lshrrev_b32 v250, 8, v250
    v_mul_u32_u24 v250, 7, v250
    v_sub_u32 v250, v252, v250
    v_cmp_eq_u32 vcc, 3, v250
    s_nop 1
    v_cndmask_b32 v250, 0, 1, vcc
    v_lshl_add_u32 v249, v252, 16, v250
    v_mov_b32 v6, 162840
    v_mov_b32 v7, 1
    s_mov_b64 exec, 1
    ds_add_u32 v6, v7
    s_mov_b64 exec, -1
    s_setprio 0
    s_call_b64 s[76:77], SUB_w1_regs
    s_call_b64 s[76:77], SUB_park
    v_mov_b32 v6, 162840
spin_13:
    s_sleep 3
    ds_read_b32 v7, v6
    s_waitcnt lgkmcnt(0)
    v_readfirstlane_b32 s53, v7
    s_nop 0
    s_cmp_ge_u32 s53, 4
    s_cbranch_scc0 spin_13
    s_mov_b64 s[12:13], s[68:69]
    s_mov_b32 s14, 2097152
    s_mov_b32 s15, 0x20000
    s_and_b32 s35, s30, 1
    s_mul_i32 s38, s99, 128
    s_mul_i32 s41, s35, 65536
    s_add_u32 s38, s38, s41
    s_mul_i32 s41, s35, 4096
    s_add_u32 s41, s41, 24576
    s_mov_b32 s42, 0
    s_mov_b32 s44, s67
    s_mov_b32 s42, 98304
    s_mov_b32 s44, s67
    s_add_u32 s44, s44, 12
    s_and_b32 s44, s44, 15
    s_call_b64 s[76:77], SUB_w_issue_1
    s_waitcnt vmcnt(8)
    s_mov_b32 s42, 106496
    s_mov_b32 s44, s67
    s_add_u32 s44, s44, 13
    s_and_b32 s44, s44, 15
    s_call_b64 s[76:77], SUB_w_issue_1
    s_waitcnt vmcnt(8)
    s_mov_b32 s42, 114688
    s_mov_b32 s44, s67
    s_add_u32 s44, s44, 14
    s_and_b32 s44, s44, 15
    s_call_b64 s[76:77], SUB_w_issue_1
    s_waitcnt vmcnt(8)
    s_mov_b32 s42, 122880
    s_mov_b32 s44, s67
    s_add_u32 s44, s44, 15
    s_and_b32 s44, s44, 15
    s_call_b64 s[76:77], SUB_w_issue_1
    s_waitcnt vmcnt(8)
    s_call_b64 s[76:77], SUB_w1_put
FR_end:
LAYER:
    v_lshlrev_b32 v40, 6, v199
    v_add_u32 v40, 161792, v40
    s_lshl_b32 s35, s30, 3
    v_add_u32 v39, s35, v40
    s_cmp_eq_u32 s60, 0
    s_cbranch_scc1 R_l0
    s_sub_u32 s8, s62, 0x400000
    s_subb_u32 s9, s63, 0
    s_mov_b32 s10, 0x7e000
    s_mov_b32 s11, 0x20000
    s_sub_u32 s12, s62, 0x380000
    s_subb_u32 s13, s63, 0
    s_mov_b32 s14, 0x7e000
    s_mov_b32 s15, 0x20000
    v_lshlrev_b32 v222, 16, v230
    v_and_b32 v223, 0xffff0000, v230
    v_lshlrev_b32 v206, 16, v180
    v_and_b32 v207, 0xffff0000, v180
    v_lshlrev_b32 v12, 16, v188
    v_and_b32 v13, 0xffff0000, v188
    v_pk_add_f32 v[206:207], v[206:207], v[12:13]
    v_lshlrev_b32 v224, 16, v231
    v_and_b32 v225, 0xffff0000, v231
    v_lshlrev_b32 v208, 16, v181
    v_and_b32 v209, 0xffff0000, v181
    v_lshlrev_b32 v14, 16, v189
    v_and_b32 v15, 0xffff0000, v189
    v_pk_add_f32 v[208:209], v[208:209], v[14:15]
    v_lshlrev_b32 v226, 16, v232
    v_and_b32 v227, 0xffff0000, v232
    v_lshlrev_b32 v210, 16, v182
    v_and_b32 v211, 0xffff0000, v182
    v_lshlrev_b32 v16, 16, v190
    v_and_b32 v17, 0xffff0000, v190
    v_pk_add_f32 v[210:211], v[210:211], v[16:17]
    v_lshlrev_b32 v228, 16, v233
    v_and_b32 v229, 0xffff0000, v233
    v_lshlrev_b32 v212, 16, v183
    v_and_b32 v213, 0xffff0000, v183
    v_lshlrev_b32 v18, 16, v191
    v_and_b32 v19, 0xffff0000, v191
    v_pk_add_f32 v[212:213], v[212:213], v[18:19]
    v_lshlrev_b32 v230, 16, v234
    v_and_b32 v231, 0xffff0000, v234
    v_lshlrev_b32 v214, 16, v184
    v_and_b32 v215, 0xffff0000, v184
    v_lshlrev_b32 v20, 16, v192
    v_and_b32 v21, 0xffff0000, v192
    v_pk_add_f32 v[214:215], v[214:215], v[20:21]
    v_lshlrev_b32 v232, 16, v235
    v_and_b32 v233, 0xffff0000, v235
    v_lshlrev_b32 v216, 16, v185
    v_and_b32 v217, 0xffff0000, v185
    v_lshlrev_b32 v22, 16, v193
    v_and_b32 v23, 0xffff0000, v193
    v_pk_add_f32 v[216:217], v[216:217], v[22:23]
    v_lshlrev_b32 v234, 16, v236
    v_and_b32 v235, 0xffff0000, v236
    v_lshlrev_b32 v218, 16, v186
    v_and_b32 v219, 0xffff0000, v186
    v_lshlrev_b32 v24, 16, v194
    v_and_b32 v25, 0xffff0000, v194
    v_pk_add_f32 v[218:219], v[218:219], v[24:25]
    v_lshlrev_b32 v236, 16, v237
    v_and_b32 v237, 0xffff0000, v237
    v_lshlrev_b32 v220, 16, v187
    v_and_b32 v221, 0xffff0000, v187
    v_lshlrev_b32 v26, 16, v195
    v_and_b32 v27, 0xffff0000, v195
    v_pk_add_f32 v[220:221], v[220:221], v[26:27]
    s_mov_b32 s53, 0
    s_sleep 24
dp_14:
    buffer_load_dwordx4 v[180:183], v196, s[8:11], 0 offen offset:0 sc1
    buffer_load_dwordx4 v[188:191], v196, s[12:15], 0 offen offset:0 sc1
    buffer_load_dwordx4 v[184:187], v196, s[8:11], 0 offen offset:2048 sc1
    buffer_load_dwordx4 v[192:195], v196, s[12:15], 0 offen offset:2048 sc1
    s_waitcnt vmcnt(0)
    v_bitop3_b32 v6, v180, v184, v188 bitop3:0x80
    v_bitop3_b32 v6, v6, v192, 1 bitop3:0x80
    v_cmp_eq_u32 vcc, 0, v6
    s_cbranch_vccz dq_15
    s_sleep 4
    s_add_u32 s53, s53, 1
    s_cmp_lt_u32 s53, s61
    s_cbranch_scc1 dp_14
    s_mov_b32 s61, 0
dq_15:
    v_lshlrev_b32 v12, 16, v180
    v_and_b32 v13, 0xffff0000, v180
    v_lshlrev_b32 v14, 16, v188
    v_and_b32 v15, 0xffff0000, v188
    v_pk_add_f32 v[12:13], v[12:13], v[14:15]
    v_pk_add_f32 v[206:207], v[206:207], v[12:13]
    v_lshlrev_b32 v16, 16, v181
    v_and_b32 v17, 0xffff0000, v181
    v_lshlrev_b32 v18, 16, v189
    v_and_b32 v19, 0xffff0000, v189
    v_pk_add_f32 v[16:17], v[16:17], v[18:19]
    v_pk_add_f32 v[208:209], v[208:209], v[16:17]
    v_lshlrev_b32 v20, 16, v182
    v_and_b32 v21, 0xffff0000, v182
    v_lshlrev_b32 v22, 16, v190
    v_and_b32 v23, 0xffff0000, v190
    v_pk_add_f32 v[20:21], v[20:21], v[22:23]
    v_pk_add_f32 v[210:211], v[210:211], v[20:21]
    v_lshlrev_b32 v24, 16, v183
    v_and_b32 v25, 0xffff0000, v183
    v_lshlrev_b32 v26, 16, v191
    v_and_b32 v27, 0xffff0000, v191
    v_pk_add_f32 v[24:25], v[24:25], v[26:27]
    v_pk_add_f32 v[212:213], v[212:213], v[24:25]
    v_lshlrev_b32 v12, 16, v184
    v_and_b32 v13, 0xffff0000, v184
    v_lshlrev_b32 v14, 16, v192
    v_and_b32 v15, 0xffff0000, v192
    v_pk_add_f32 v[12:13], v[12:13], v[14:15]
    v_pk_add_f32 v[214:215], v[214:215], v[12:13]
    v_lshlrev_b32 v16, 16, v185
    v_and_b32 v17, 0xffff0000, v185
    v_lshlrev_b32 v18, 16, v193
    v_and_b32 v19, 0xffff0000, v193
    v_pk_add_f32 v[16:17], v[16:17], v[18:19]
    v_pk_add_f32 v[216:217], v[216:217], v[16:17]
    v_lshlrev_b32 v20, 16, v186
    v_and_b32 v21, 0xffff0000, v186
    v_lshlrev_b32 v22, 16, v194
    v_and_b32 v23, 0xffff0000, v194
    v_pk_add_f32 v[20:21], v[20:21], v[22:23]
    v_pk_add_f32 v[218:219], v[218:219], v[20:21]
    v_lshlrev_b32 v24, 16, v187
    v_and_b32 v25, 0xffff0000, v187
    v_lshlrev_b32 v26, 16, v195
    v_and_b32 v27, 0xffff0000, v195
    v_pk_add_f32 v[24:25], v[24:25], v[26:27]
    v_pk_add_f32 v[220:221], v[220:221], v[24:25]
    v_pk_add_f32 v[32:33], v[206:207], v[208:209]
    v_pk_mul_f32 v[34:35], v[206:207], v[206:207]
    v_pk_fma_f32 v[34:35], v[208:209], v[208:209], v[34:35]
    v_pk_add_f32 v[32:33], v[32:33], v[210:211]
    v_pk_fma_f32 v[34:35], v[210:211], v[210:211], v[34:35]
    v_pk_add_f32 v[32:33], v[32:33], v[212:213]
    v_pk_fma_f32 v[34:35], v[212:213], v[212:213], v[34:35]
    v_pk_add_f32 v[32:33], v[32:33], v[214:215]
    v_pk_fma_f32 v[34:35], v[214:215], v[214:215], v[34:35]
    v_pk_add_f32 v[32:33], v[32:33], v[216:217]
    v_pk_fma_f32 v[34:35], v[216:217], v[216:217], v[34:35]
    v_pk_add_f32 v[32:33], v[32:33], v[218:219]
    v_pk_fma_f32 v[34:35], v[218:219], v[218:219], v[34:35]
    v_pk_add_f32 v[32:33], v[32:33], v[220:221]
    v_pk_fma_f32 v[34:35], v[220:221], v[220:221], v[34:35]
    v_add_f32 v30, v32, v33
    v_add_f32 v31, v34, v35
    s_nop 0
    v_add_f32_dpp v30, v30, v30 row_ror:8 row_mask:0xf bank_mask:0xf
    v_add_f32_dpp v31, v31, v31 row_ror:8 row_mask:0xf bank_mask:0xf
    v_mov_b32 v32, v30
    v_mov_b32 v33, v31
    s_nop 0
    v_permlane16_swap_b32 v30, v32
    v_permlane16_swap_b32 v31, v33
    v_pk_add_f32 v[30:31], v[30:31], v[32:33]
    v_mov_b32 v32, v30
    v_mov_b32 v33, v31
    s_nop 0
    v_permlane32_swap_b32 v30, v32
    v_permlane32_swap_b32 v31, v33
    v_pk_add_f32 v[30:31], v[30:31], v[32:33]
    ds_write_b64 v39, v[30:31] offset:0
    s_waitcnt lgkmcnt(0)
    s_barrier
    ds_read_b128 v[12:15], v40 offset:0
    ds_read_b128 v[16:19], v40 offset:16
    ds_read_b128 v[20:23], v40 offset:32
    ds_read_b128 v[24:27], v40 offset:48
    s_waitcnt lgkmcnt(0)
    v_pk_add_f32 v[12:13], v[12:13], v[14:15]
    v_pk_add_f32 v[16:17], v[16:17], v[18:19]
    v_pk_add_f32 v[20:21], v[20:21], v[22:23]
    v_pk_add_f32 v[24:25], v[24:25], v[26:27]
    v_pk_add_f32 v[12:13], v[12:13], v[16:17]
    v_pk_add_f32 v[20:21], v[20:21], v[24:25]
    v_pk_add_f32 v[12:13], v[12:13], v[20:21]
    v_mul_f32 v36, 0x3a800000, v12
    v_mul_f32 v38, 0x3a800000, v13
    v_fma_f32 v38, -v36, v36, v38
    v_max_f32 v38, 0, v38
    v_add_f32 v38, 0x3727c5ac, v38
    v_rsq_f32 v37, v38
    s_mov_b32 s20, s62
    s_mov_b32 s21, s63
    s_mov_b32 s22, 0x7e000
    s_mov_b32 s23, 0x20000
    v_pk_add_f32 v[12:13], v[206:207], v[36:37] op_sel_hi:[1,0] neg_lo:[0,1] neg_hi:[0,1]
    v_pk_mul_f32 v[12:13], v[12:13], v[36:37] op_sel:[0,1] op_sel_hi:[1,1]
    v_pk_fma_f32 v[206:207], v[12:13], v[222:223], v[206:207]
    v_cvt_pk_bf16_f32 v180, v206, v207
    v_pk_add_f32 v[14:15], v[208:209], v[36:37] op_sel_hi:[1,0] neg_lo:[0,1] neg_hi:[0,1]
    v_pk_mul_f32 v[14:15], v[14:15], v[36:37] op_sel:[0,1] op_sel_hi:[1,1]
    v_pk_fma_f32 v[208:209], v[14:15], v[224:225], v[208:209]
    v_cvt_pk_bf16_f32 v181, v208, v209
    v_and_b32 v180, -2, v180
    v_pk_add_f32 v[16:17], v[210:211], v[36:37] op_sel_hi:[1,0] neg_lo:[0,1] neg_hi:[0,1]
    v_pk_mul_f32 v[16:17], v[16:17], v[36:37] op_sel:[0,1] op_sel_hi:[1,1]
    v_pk_fma_f32 v[210:211], v[16:17], v[226:227], v[210:211]
    v_cvt_pk_bf16_f32 v182, v210, v211
    v_pk_add_f32 v[18:19], v[212:213], v[36:37] op_sel_hi:[1,0] neg_lo:[0,1] neg_hi:[0,1]
    v_pk_mul_f32 v[18:19], v[18:19], v[36:37] op_sel:[0,1] op_sel_hi:[1,1]
    v_pk_fma_f32 v[212:213], v[18:19], v[228:229], v[212:213]
    v_cvt_pk_bf16_f32 v183, v212, v213
    buffer_store_dwordx4 v[180:183], v196, s[20:23], 0 offen offset:0 sc1
    v_pk_add_f32 v[20:21], v[214:215], v[36:37] op_sel_hi:[1,0] neg_lo:[0,1] neg_hi:[0,1]
    v_pk_mul_f32 v[20:21], v[20:21], v[36:37] op_sel:[0,1] op_sel_hi:[1,1]
    v_pk_fma_f32 v[214:215], v[20:21], v[230:231], v[214:215]
    v_cvt_pk_bf16_f32 v184, v214, v215
    v_pk_add_f32 v[22:23], v[216:217], v[36:37] op_sel_hi:[1,0] neg_lo:[0,1] neg_hi:[0,1]
    v_pk_mul_f32 v[22:23], v[22:23], v[36:37] op_sel:[0,1] op_sel_hi:[1,1]
    v_pk_fma_f32 v[216:217], v[22:23], v[232:233], v[216:217]
    v_cvt_pk_bf16_f32 v185, v216, v217
    v_and_b32 v184, -2, v184
    v_pk_add_f32 v[24:25], v[218:219], v[36:37] op_sel_hi:[1,0] neg_lo:[0,1] neg_hi:[0,1]
    v_pk_mul_f32 v[24:25], v[24:25], v[36:37] op_sel:[0,1] op_sel_hi:[1,1]
    v_pk_fma_f32 v[218:219], v[24:25], v[234:235], v[218:219]
    v_cvt_pk_bf16_f32 v186, v218, v219
    v_pk_add_f32 v[26:27], v[220:221], v[36:37] op_sel_hi:[1,0] neg_lo:[0,1] neg_hi:[0,1]
    v_pk_mul_f32 v[26:27], v[26:27], v[36:37] op_sel:[0,1] op_sel_hi:[1,1]
    v_pk_fma_f32 v[220:221], v[26:27], v[236:237], v[220:221]
    v_cvt_pk_bf16_f32 v187, v220, v221
    buffer_store_dwordx4 v[184:187], v196, s[20:23], 0 offen offset:2048 sc1
    s_branch R_s2
R_l0:
    v_lshlrev_b32 v206, 16, v180
    v_and_b32 v207, 0xffff0000, v180
    v_lshlrev_b32 v208, 16, v181
    v_and_b32 v209, 0xffff0000, v181
    v_lshlrev_b32 v210, 16, v182
    v_and_b32 v211, 0xffff0000, v182
    v_lshlrev_b32 v212, 16, v183
    v_and_b32 v213, 0xffff0000, v183
    v_lshlrev_b32 v214, 16, v184
    v_and_b32 v215, 0xffff0000, v184
    v_lshlrev_b32 v216, 16, v185
    v_and_b32 v217, 0xffff0000, v185
    v_lshlrev_b32 v218, 16, v186
    v_and_b32 v219, 0xffff0000, v186
    v_lshlrev_b32 v220, 16, v187
    v_and_b32 v221, 0xffff0000, v187
    v_pk_add_f32 v[32:33], v[206:207], v[208:209]
    v_pk_mul_f32 v[34:35], v[206:207], v[206:207]
    v_pk_fma_f32 v[34:35], v[208:209], v[208:209], v[34:35]
    v_pk_add_f32 v[32:33], v[32:33], v[210:211]
    v_pk_fma_f32 v[34:35], v[210:211], v[210:211], v[34:35]
    v_pk_add_f32 v[32:33], v[32:33], v[212:213]
    v_pk_fma_f32 v[34:35], v[212:213], v[212:213], v[34:35]
    v_pk_add_f32 v[32:33], v[32:33], v[214:215]
    v_pk_fma_f32 v[34:35], v[214:215], v[214:215], v[34:35]
    v_pk_add_f32 v[32:33], v[32:33], v[216:217]
    v_pk_fma_f32 v[34:35], v[216:217], v[216:217], v[34:35]
    v_pk_add_f32 v[32:33], v[32:33], v[218:219]
    v_pk_fma_f32 v[34:35], v[218:219], v[218:219], v[34:35]
    v_pk_add_f32 v[32:33], v[32:33], v[220:221]
    v_pk_fma_f32 v[34:35], v[220:221], v[220:221], v[34:35]
    v_add_f32 v30, v32, v33
    v_add_f32 v31, v34, v35
    s_nop 0
    v_add_f32_dpp v30, v30, v30 row_ror:8 row_mask:0xf bank_mask:0xf
    v_add_f32_dpp v31, v31, v31 row_ror:8 row_mask:0xf bank_mask:0xf
    v_mov_b32 v32, v30
    v_mov_b32 v33, v31
    s_nop 0
    v_permlane16_swap_b32 v30, v32
    v_permlane16_swap_b32 v31, v33
    v_pk_add_f32 v[30:31], v[30:31], v[32:33]
    v_mov_b32 v32, v30
    v_mov_b32 v33, v31
    s_nop 0
    v_permlane32_swap_b32 v30, v32
    v_permlane32_swap_b32 v31, v33
    v_pk_add_f32 v[30:31], v[30:31], v[32:33]
    ds_write_b64 v39, v[30:31] offset:0
    s_waitcnt lgkmcnt(0)
    s_cmp_lg_u32 s30, 4
    s_cbranch_scc1 R_fw
    v_mov_b32 v222, 162820
spin_16:
    s_sleep 4
    ds_read_b32 v223, v222
    s_waitcnt lgkmcnt(0)
    v_readfirstlane_b32 s53, v223
    s_nop 0
    s_cmp_ge_u32 s53, 16
    s_cbranch_scc0 spin_16
    s_lshl_b32 s36, s28, 10
    s_add_u32 s36, s36, 23101440
    v_lshlrev_b32 v226, 7, v1
    v_add_u32 v226, s36, v226
    s_mov_b32 s53, 0
    s_mov_b64 exec, 0xff
R_fp:
    buffer_load_dword v222, v226, s[56:59], 0 offen sc1
    s_waitcnt vmcnt(0)
    v_subrev_u32 v222, s52, v222
    v_and_b32 v223, 0xffffc0ff, v222
    v_cmp_eq_u32 vcc, 32, v223
    s_nop 0
    s_cmp_eq_u64 vcc, exec
    s_cbranch_scc1 R_fq
    s_sleep 3
    s_add_u32 s53, s53, 1
    s_cmp_lt_u32 s53, s61
    s_cbranch_scc1 R_fp
    s_mov_b32 s61, 0
R_fq:
    v_lshrrev_b32 v222, 8, v222
    v_mov_b32 v223, 162844
    ds_add_u32 v223, v222
    s_mov_b64 exec, -1
    s_waitcnt lgkmcnt(0)
R_fw:
    s_barrier
    s_add_u32 s80, s4, 0x1c00000
    s_addc_u32 s81, s5, 0
    s_mov_b32 s82, 0x400000
    s_mov_b32 s83, 0x20000
    s_mov_b32 s78, 0
    buffer_load_dwordx2 v[230:231], v197, s[80:83], s78 offen sc1
    s_mov_b32 s78, 65536
    buffer_load_dwordx2 v[232:233], v197, s[80:83], s78 offen sc1
    s_mov_b32 s78, 262144
    buffer_load_dwordx2 v[234:235], v197, s[80:83], s78 offen sc1
    s_mov_b32 s78, 327680
    buffer_load_dwordx2 v[236:237], v197, s[80:83], s78 offen sc1
    v_mov_b32 v222, 162844
    ds_read_b32 v223, v222
    s_waitcnt lgkmcnt(0)
    v_readfirstlane_b32 s94, v223
    s_nop 0
    s_cmp_gt_u32 s94, 127
    s_cselect_b32 s94, 1, 0
    s_lshr_b32 s53, s28, 3
    s_lshl_b32 s53, s53, 2
    s_and_b32 s54, s28, 3
    s_add_u32 s53, s53, s54
    s_lshl_b32 s53, s53, 24
    s_lshr_b32 s54, s28, 2
    s_xor_b32 s54, s54, s94
    s_and_b32 s54, s54, 1
    s_lshl_b32 s54, s54, 13
    s_add_u32 s55, s53, s54
    s_add_u32 s55, s55, 33554432
    s_add_u32 s62, s4, s55
    s_addc_u32 s63, s5, 0
    s_sub_u32 s36, s28, 1
    s_max_i32 s36, s36, 0
    s_lshr_b32 s53, s36, 3
    s_lshl_b32 s53, s53, 2
    s_and_b32 s54, s36, 3
    s_add_u32 s53, s53, s54
    s_lshl_b32 s53, s53, 24
    s_lshr_b32 s54, s36, 2
    s_xor_b32 s54, s54, s94
    s_and_b32 s54, s54, 1
    s_lshl_b32 s54, s54, 13
    s_add_u32 s92, s53, s54
    s_add_u32 s92, s92, 33554432
    s_sub_u32 s92, s92, s55
    s_add_u32 s36, s28, 1
    s_min_u32 s36, s36, 15
    s_lshr_b32 s53, s36, 3
    s_lshl_b32 s53, s53, 2
    s_and_b32 s54, s36, 3
    s_add_u32 s53, s53, s54
    s_lshl_b32 s53, s53, 24
    s_lshr_b32 s54, s36, 2
    s_xor_b32 s54, s54, s94
    s_and_b32 s54, s54, 1
    s_lshl_b32 s54, s54, 13
    s_add_u32 s93, s53, s54
    s_add_u32 s93, s93, 33554432
    s_sub_u32 s93, s93, s55
    s_add_u32 s55, s55, 6029312
    s_mov_b32 s20, s62
    s_mov_b32 s21, s63
    s_mov_b32 s22, 0x7e000
    s_mov_b32 s23, 0x20000
    ds_read_b128 v[12:15], v40 offset:0
    ds_read_b128 v[16:19], v40 offset:16
    ds_read_b128 v[20:23], v40 offset:32
    ds_read_b128 v[24:27], v40 offset:48
    s_waitcnt lgkmcnt(0)
    v_pk_add_f32 v[12:13], v[12:13], v[14:15]
    v_pk_add_f32 v[16:17], v[16:17], v[18:19]
    v_pk_add_f32 v[20:21], v[20:21], v[22:23]
    v_pk_add_f32 v[24:25], v[24:25], v[26:27]
    v_pk_add_f32 v[12:13], v[12:13], v[16:17]
    v_pk_add_f32 v[20:21], v[20:21], v[24:25]
    v_pk_add_f32 v[12:13], v[12:13], v[20:21]
    v_mul_f32 v36, 0x3a800000, v12
    v_mul_f32 v38, 0x3a800000, v13
    v_fma_f32 v38, -v36, v36, v38
    v_max_f32 v38, 0, v38
    v_add_f32 v38, 0x3727c5ac, v38
    v_rsq_f32 v37, v38
    s_nop 0
    v_pk_add_f32 v[12:13], v[206:207], v[36:37] op_sel_hi:[1,0] neg_lo:[0,1] neg_hi:[0,1]
    v_pk_mul_f32 v[12:13], v[12:13], v[36:37] op_sel:[0,1] op_sel_hi:[1,1]
    v_pk_add_f32 v[14:15], v[208:209], v[36:37] op_sel_hi:[1,0] neg_lo:[0,1] neg_hi:[0,1]
    v_pk_mul_f32 v[14:15], v[14:15], v[36:37] op_sel:[0,1] op_sel_hi:[1,1]
    v_pk_add_f32 v[16:17], v[210:211], v[36:37] op_sel_hi:[1,0] neg_lo:[0,1] neg_hi:[0,1]
    v_pk_mul_f32 v[16:17], v[16:17], v[36:37] op_sel:[0,1] op_sel_hi:[1,1]
    v_pk_add_f32 v[18:19], v[212:213], v[36:37] op_sel_hi:[1,0] neg_lo:[0,1] neg_hi:[0,1]
    v_pk_mul_f32 v[18:19], v[18:19], v[36:37] op_sel:[0,1] op_sel_hi:[1,1]
    v_pk_add_f32 v[20:21], v[214:215], v[36:37] op_sel_hi:[1,0] neg_lo:[0,1] neg_hi:[0,1]
    v_pk_mul_f32 v[20:21], v[20:21], v[36:37] op_sel:[0,1] op_sel_hi:[1,1]
    v_pk_add_f32 v[22:23], v[216:217], v[36:37] op_sel_hi:[1,0] neg_lo:[0,1] neg_hi:[0,1]
    v_pk_mul_f32 v[22:23], v[22:23], v[36:37] op_sel:[0,1] op_sel_hi:[1,1]
    v_pk_add_f32 v[24:25], v[218:219], v[36:37] op_sel_hi:[1,0] neg_lo:[0,1] neg_hi:[0,1]
    v_pk_mul_f32 v[24:25], v[24:25], v[36:37] op_sel:[0,1] op_sel_hi:[1,1]
    v_pk_add_f32 v[26:27], v[220:221], v[36:37] op_sel_hi:[1,0] neg_lo:[0,1] neg_hi:[0,1]
    v_pk_mul_f32 v[26:27], v[26:27], v[36:37] op_sel:[0,1] op_sel_hi:[1,1]
    s_waitcnt vmcnt(0)
    v_lshlrev_b32 v222, 16, v230
    v_and_b32 v223, 0xffff0000, v230
    v_pk_fma_f32 v[206:207], v[12:13], v[222:223], v[206:207]
    v_cvt_pk_bf16_f32 v180, v206, v207
    v_lshlrev_b32 v222, 16, v231
    v_and_b32 v223, 0xffff0000, v231
    v_pk_fma_f32 v[208:209], v[14:15], v[222:223], v[208:209]
    v_cvt_pk_bf16_f32 v181, v208, v209
    v_and_b32 v180, -2, v180
    v_lshlrev_b32 v222, 16, v232
    v_and_b32 v223, 0xffff0000, v232
    v_pk_fma_f32 v[210:211], v[16:17], v[222:223], v[210:211]
    v_cvt_pk_bf16_f32 v182, v210, v211
    v_lshlrev_b32 v222, 16, v233
    v_and_b32 v223, 0xffff0000, v233
    v_pk_fma_f32 v[212:213], v[18:19], v[222:223], v[212:213]
    v_cvt_pk_bf16_f32 v183, v212, v213
    buffer_store_dwordx4 v[180:183], v196, s[20:23], 0 offen offset:0 sc1
    v_lshlrev_b32 v222, 16, v234
    v_and_b32 v223, 0xffff0000, v234
    v_pk_fma_f32 v[214:215], v[20:21], v[222:223], v[214:215]
    v_cvt_pk_bf16_f32 v184, v214, v215
    v_lshlrev_b32 v222, 16, v235
    v_and_b32 v223, 0xffff0000, v235
    v_pk_fma_f32 v[216:217], v[22:23], v[222:223], v[216:217]
    v_cvt_pk_bf16_f32 v185, v216, v217
    v_and_b32 v184, -2, v184
    v_lshlrev_b32 v222, 16, v236
    v_and_b32 v223, 0xffff0000, v236
    v_pk_fma_f32 v[218:219], v[24:25], v[222:223], v[218:219]
    v_cvt_pk_bf16_f32 v186, v218, v219
    v_lshlrev_b32 v222, 16, v237
    v_and_b32 v223, 0xffff0000, v237
    v_pk_fma_f32 v[220:221], v[26:27], v[222:223], v[220:221]
    v_cvt_pk_bf16_f32 v187, v220, v221
    buffer_store_dwordx4 v[184:187], v196, s[20:23], 0 offen offset:2048 sc1
R_s2:
    v_lshlrev_b32 v206, 16, v180
    v_and_b32 v207, 0xffff0000, v180
    v_lshlrev_b32 v208, 16, v181
    v_and_b32 v209, 0xffff0000, v181
    v_lshlrev_b32 v210, 16, v182
    v_and_b32 v211, 0xffff0000, v182
    v_lshlrev_b32 v212, 16, v183
    v_and_b32 v213, 0xffff0000, v183
    v_lshlrev_b32 v214, 16, v184
    v_and_b32 v215, 0xffff0000, v184
    v_lshlrev_b32 v216, 16, v185
    v_and_b32 v217, 0xffff0000, v185
    v_lshlrev_b32 v218, 16, v186
    v_and_b32 v219, 0xffff0000, v186
    v_lshlrev_b32 v220, 16, v187
    v_and_b32 v221, 0xffff0000, v187
    v_pk_add_f32 v[32:33], v[206:207], v[208:209]
    v_pk_mul_f32 v[34:35], v[206:207], v[206:207]
    v_pk_fma_f32 v[34:35], v[208:209], v[208:209], v[34:35]
    v_pk_add_f32 v[32:33], v[32:33], v[210:211]
    v_pk_fma_f32 v[34:35], v[210:211], v[210:211], v[34:35]
    v_pk_add_f32 v[32:33], v[32:33], v[212:213]
    v_pk_fma_f32 v[34:35], v[212:213], v[212:213], v[34:35]
    v_pk_add_f32 v[32:33], v[32:33], v[214:215]
    v_pk_fma_f32 v[34:35], v[214:215], v[214:215], v[34:35]
    v_pk_add_f32 v[32:33], v[32:33], v[216:217]
    v_pk_fma_f32 v[34:35], v[216:217], v[216:217], v[34:35]
    v_pk_add_f32 v[32:33], v[32:33], v[218:219]
    v_pk_fma_f32 v[34:35], v[218:219], v[218:219], v[34:35]
    v_pk_add_f32 v[32:33], v[32:33], v[220:221]
    v_pk_fma_f32 v[34:35], v[220:221], v[220:221], v[34:35]
    v_add_f32 v30, v32, v33
    v_add_f32 v31, v34, v35
    s_nop 0
    v_add_f32_dpp v30, v30, v30 row_ror:8 row_mask:0xf bank_mask:0xf
    v_add_f32_dpp v31, v31, v31 row_ror:8 row_mask:0xf bank_mask:0xf
    v_mov_b32 v32, v30
    v_mov_b32 v33, v31
    s_nop 0
    v_permlane16_swap_b32 v30, v32
    v_permlane16_swap_b32 v31, v33
    v_pk_add_f32 v[30:31], v[30:31], v[32:33]
    v_mov_b32 v32, v30
    v_mov_b32 v33, v31
    s_nop 0
    v_permlane32_swap_b32 v30, v32
    v_permlane32_swap_b32 v31, v33
    v_pk_add_f32 v[30:31], v[30:31], v[32:33]
    ds_write_b64 v39, v[30:31] offset:512
    s_waitcnt lgkmcnt(0)
    s_barrier
    s_cmp_lg_u32 s30, 6
    s_cbranch_scc1 R_n6
    s_cmp_lg_u32 s60, 0
    s_cbranch_scc1 R_n6
    s_lshl_b32 s53, s29, 7
    s_add_u32 s53, s53, 23117824
    v_mov_b32 v8, 1
    v_mov_b32 v9, 0
    s_mov_b64 exec, 1
    buffer_atomic_add v8, v9, s[56:59], s53 offen sc1
    s_mov_b64 exec, -1
R_n6:
    s_cmp_lg_u32 s30, 7
    s_cbranch_scc1 R_nl
    ds_read_b128 v[12:15], v40 offset:512
    ds_read_b128 v[16:19], v40 offset:528
    ds_read_b128 v[20:23], v40 offset:544
    ds_read_b128 v[24:27], v40 offset:560
    s_waitcnt lgkmcnt(0)
    v_pk_add_f32 v[12:13], v[12:13], v[14:15]
    v_pk_add_f32 v[16:17], v[16:17], v[18:19]
    v_pk_add_f32 v[20:21], v[20:21], v[22:23]
    v_pk_add_f32 v[24:25], v[24:25], v[26:27]
    v_pk_add_f32 v[12:13], v[12:13], v[16:17]
    v_pk_add_f32 v[20:21], v[20:21], v[24:25]
    v_pk_add_f32 v[12:13], v[12:13], v[20:21]
    v_mul_f32 v36, 0x3a800000, v12
    v_mul_f32 v38, 0x3a800000, v13
    v_fma_f32 v38, -v36, v36, v38
    v_max_f32 v38, 0, v38
    v_mov_b32 v42, v36
    v_mov_b32 v43, v38
    v_add_f32 v38, 0x3727c5ac, v38
    v_sqrt_f32 v38, v38
    s_nop 0
    v_mov_b32 v41, v38
    v_rcp_f32 v37, v38
    v_sub_f32 v42, v42, v36
    v_mul_f32 v42, v42, v37
    v_mul_f32 v43, v43, v37
    v_mul_f32 v43, v43, v37
    v_add_f32 v43, 0x3727c5ac, v43
    v_rsq_f32 v44, v43
    v_mov_b32 v224, v36
    v_mov_b32 v225, v37
    v_fma_f32 v226, v42, v41, v36
    v_mul_f32 v227, v37, v44
    s_add_u32 s24, s62, 0x5d0000
    s_addc_u32 s25, s63, 0
    s_mov_b32 s26, 0x800
    s_mov_b32 s27, 0x20000
    s_lshl_b32 s36, s29, 3
    v_add_u32 v6, s36, v199
    v_lshlrev_b32 v6, 4, v6
    s_mov_b64 exec, 0xff
    buffer_store_dwordx4 v[224:227], v6, s[24:27], 0 offen sc1
    s_mov_b64 exec, -1
    s_add_u32 s53, s55, 1280
    v_mov_b32 v8, 1
    v_mov_b32 v9, 162816
    v_mov_b32 v11, 0
    s_mov_b64 exec, 1
    s_waitcnt vmcnt(0)
    buffer_atomic_add v8, v11, s[56:59], s53 offen sc1
pub_17:
    s_mov_b64 exec, -1
R_nl:
    s_cmp_ge_u32 s30, 4
    s_cbranch_scc1 LOADERS
    s_mov_b32 s34, s30
    s_mov_b32 s35, 0
    v_and_b32 v22, 15, v1
    v_lshrrev_b32 v23, 4, v1
    s_mul_i32 s37, s34, 2
    s_mul_i32 s38, s99, 4
    s_mul_i32 s36, s35, 4
    s_add_u32 s38, s38, s36
    s_mov_b32 s8, s62
    s_mov_b32 s9, s63
    s_mov_b32 s10, 0x7e000
    s_mov_b32 s11, 0x20000
    v_add_u32 v126, 0, v2
    v_add_u32 v127, 65536, v2
    v_add_u32 v128, 4096, v2
    v_add_u32 v129, 69632, v2
    s_lshr_b32 s36, s67, 2
    s_add_u32 s36, s36, 0
    s_and_b32 s36, s36, 3
    s_lshl_b32 s44, s36, 14
    s_lshl_b32 s36, s34, 17
    s_add_u32 s44, s44, s36
    s_lshr_b32 s36, s67, 2
    s_add_u32 s36, s36, 1
    s_and_b32 s36, s36, 3
    s_lshl_b32 s45, s36, 14
    s_lshl_b32 s36, s34, 17
    s_add_u32 s45, s45, s36
    s_lshr_b32 s36, s67, 2
    s_add_u32 s36, s36, 2
    s_and_b32 s36, s36, 3
    s_lshl_b32 s46, s36, 14
    s_lshl_b32 s36, s34, 17
    s_add_u32 s46, s46, s36
    s_lshr_b32 s36, s67, 2
    s_add_u32 s36, s36, 3
    s_and_b32 s36, s36, 3
    s_lshl_b32 s47, s36, 14
    s_lshl_b32 s36, s34, 17
    s_add_u32 s47, s47, s36
    v_lshrrev_b32 v6, 2, v1
    v_mul_u32_u24 v13, 128, v6
    v_and_b32 v7, 3, v1
    v_lshl_add_u32 v13, v7, 3, v13
    v_add_u32 v13, 24576, v13
    v_bfe_u32 v6, v6, 1, 2
    s_mul_i32 s36, s35, 4
    s_add_u32 s36, s36, 3
    v_xor_b32 v7, s36, v6
    v_lshl_add_u32 v16, v7, 5, v13
    s_mul_i32 s36, s35, 4
    s_add_u32 s36, s36, 2
    v_xor_b32 v7, s36, v6
    v_lshl_add_u32 v15, v7, 5, v13
    s_mul_i32 s36, s35, 4
    s_add_u32 s36, s36, 1
    v_xor_b32 v7, s36, v6
    v_lshl_add_u32 v14, v7, 5, v13
    s_mul_i32 s36, s35, 4
    s_add_u32 s36, s36, 0
    v_xor_b32 v7, s36, v6
    v_lshl_add_u32 v13, v7, 5, v13
    v_pk_mov_b32 v[24:25], 0, 0
    v_pk_mov_b32 v[26:27], 0, 0
    v_pk_mov_b32 v[28:29], 0, 0
    v_pk_mov_b32 v[30:31], 0, 0
    v_pk_mov_b32 v[32:33], 0, 0
    v_pk_mov_b32 v[34:35], 0, 0
    v_pk_mov_b32 v[36:37], 0, 0
    v_pk_mov_b32 v[38:39], 0, 0
    v_pk_mov_b32 v[40:41], 0, 0
    v_pk_mov_b32 v[42:43], 0, 0
    v_pk_mov_b32 v[44:45], 0, 0
    v_pk_mov_b32 v[46:47], 0, 0
    v_pk_mov_b32 v[48:49], 0, 0
    v_pk_mov_b32 v[50:51], 0, 0
    v_pk_mov_b32 v[52:53], 0, 0
    v_pk_mov_b32 v[54:55], 0, 0
    s_mov_b32 s43, 0
    s_mul_i32 s36, s35, 256
    s_add_u32 s36, s36, 163328
    v_lshlrev_b32 v6, 4, v23
    v_add_u32 v6, s36, v6
    s_lshl_b32 s36, s37, 8
    s_add_u32 s36, s36, 160776
    v_lshlrev_b32 v7, 4, v22
    v_add_u32 v7, s36, v7
    s_add_u32 s16, s4, 0xa000000
    s_addc_u32 s17, s5, 0
    s_mov_b32 s18, 0x800000
    s_mov_b32 s19, 0x20000
    v_mul_u32_u24 v12, 65536, v23
    v_lshl_add_u32 v12, v22, 4, v12
    s_mul_i32 s39, s38, 131072
    s_lshl_b32 s36, s37, 8
    s_add_u32 s39, s39, s36
    s_add_u32 s39, s39, 16384
    s_lshl_b32 s36, s28, 11
    s_add_u32 s39, s39, s36
    s_lshr_b32 s36, s29, 2
    s_xor_b32 s36, s36, s94
    s_and_b32 s36, s36, 1
    s_lshl_b32 s36, s36, 13
    s_add_u32 s39, s39, s36
    s_add_u32 s40, s39, 262144
    s_lshl_b32 s36, s29, 1
    s_lshr_b32 s53, s36, 3
    s_lshl_b32 s53, s53, 14
    s_and_b32 s41, s36, 7
    s_lshl_b32 s41, s41, 10
    s_add_u32 s41, s41, s53
    s_lshl_b32 s36, s37, 16
    s_add_u32 s41, s41, s36
    s_mov_b32 s53, 0
    s_mov_b32 s49, s44
    ds_read_b64_tr_b16 v[56:57], v13 offset:0
    ds_read_b64_tr_b16 v[58:59], v13 offset:2048
    ds_read_b64_tr_b16 v[60:61], v14 offset:0
    ds_read_b64_tr_b16 v[62:63], v14 offset:2048
    ds_read_b64_tr_b16 v[64:65], v15 offset:0
    ds_read_b64_tr_b16 v[66:67], v15 offset:2048
    ds_read_b64_tr_b16 v[68:69], v16 offset:0
    ds_read_b64_tr_b16 v[70:71], v16 offset:2048
    ds_read_b64_tr_b16 v[72:73], v13 offset:4096
    ds_read_b64_tr_b16 v[74:75], v13 offset:6144
    ds_read_b64_tr_b16 v[76:77], v14 offset:4096
    ds_read_b64_tr_b16 v[78:79], v14 offset:6144
    ds_read_b64_tr_b16 v[80:81], v15 offset:4096
    ds_read_b64_tr_b16 v[82:83], v15 offset:6144
    ds_read_b64_tr_b16 v[84:85], v16 offset:4096
    ds_read_b64_tr_b16 v[86:87], v16 offset:6144
dm_18p:
    buffer_load_dwordx4 v[176:179], v126, s[8:11], s44 offen offset:0 sc1
    buffer_load_dwordx4 v[180:183], v127, s[8:11], s44 offen offset:0 sc1
    buffer_load_dwordx4 v[184:187], v126, s[8:11], s44 offen offset:1024 sc1
    buffer_load_dwordx4 v[188:191], v127, s[8:11], s44 offen offset:1024 sc1
    s_waitcnt vmcnt(0)
    v_or3_b32 v17, v176, v180, v184
    v_bitop3_b32 v17, v17, v188, 1 bitop3:0xa8
    v_cmp_ne_u32 vcc, 0, v17
    s_cbranch_vccz dm_18q
    s_sleep 2
    s_add_u32 s53, s53, 1
    s_cmp_lt_u32 s53, s61
    s_cbranch_scc1 dm_18p
    s_mov_b32 s61, 0
dm_18q:
    buffer_load_dwordx4 v[192:195], v126, s[8:11], s44 offen offset:2048 sc1
    buffer_load_dwordx4 v[196:199], v127, s[8:11], s44 offen offset:2048 sc1
    buffer_load_dwordx4 v[200:203], v126, s[8:11], s44 offen offset:3072 sc1
    buffer_load_dwordx4 v[204:207], v127, s[8:11], s44 offen offset:3072 sc1
    buffer_load_dwordx4 v[208:211], v128, s[8:11], s44 offen offset:0 sc1
    buffer_load_dwordx4 v[212:215], v129, s[8:11], s44 offen offset:0 sc1
    buffer_load_dwordx4 v[216:219], v128, s[8:11], s44 offen offset:1024 sc1
    buffer_load_dwordx4 v[220:223], v129, s[8:11], s44 offen offset:1024 sc1
    buffer_load_dwordx4 v[224:227], v128, s[8:11], s44 offen offset:2048 sc1
    buffer_load_dwordx4 v[228:231], v129, s[8:11], s44 offen offset:2048 sc1
    s_waitcnt lgkmcnt(0)
dm_18:
    v_mfma_f32_16x16x32_bf16 v[24:27], v[56:59], v[176:179], v[24:27]
    ds_read_b64_tr_b16 v[88:89], v13 offset:8192
    buffer_load_dwordx4 v[232:235], v128, s[8:11], s44 offen offset:3072 sc1
    v_mfma_f32_16x16x32_bf16 v[40:43], v[56:59], v[180:183], v[40:43]
    ds_read_b64_tr_b16 v[90:91], v13 offset:10240
    buffer_load_dwordx4 v[236:239], v129, s[8:11], s44 offen offset:3072 sc1
    v_mfma_f32_16x16x32_bf16 v[44:47], v[60:63], v[180:183], v[44:47]
    ds_read_b64_tr_b16 v[92:93], v14 offset:8192
    s_mov_b32 s44, s45
    v_mfma_f32_16x16x32_bf16 v[28:31], v[60:63], v[176:179], v[28:31]
    ds_read_b64_tr_b16 v[94:95], v14 offset:10240
    s_mov_b32 s45, s46
    v_mfma_f32_16x16x32_bf16 v[32:35], v[64:67], v[176:179], v[32:35]
    ds_read_b64_tr_b16 v[96:97], v15 offset:8192
    s_mov_b32 s46, s47
    v_mfma_f32_16x16x32_bf16 v[48:51], v[64:67], v[180:183], v[48:51]
    ds_read_b64_tr_b16 v[98:99], v15 offset:10240
    s_mov_b32 s47, 1048576
    v_mfma_f32_16x16x32_bf16 v[52:55], v[68:71], v[180:183], v[52:55]
    ds_read_b64_tr_b16 v[100:101], v16 offset:8192
    v_mfma_f32_16x16x32_bf16 v[36:39], v[68:71], v[176:179], v[36:39]
    ds_read_b64_tr_b16 v[102:103], v16 offset:10240
    s_waitcnt lgkmcnt(8)
    v_mfma_f32_16x16x32_bf16 v[24:27], v[72:75], v[184:187], v[24:27]
    ds_read_b64_tr_b16 v[104:105], v13 offset:12288
    buffer_load_dwordx4 v[176:179], v126, s[8:11], s44 offen offset:0 sc1
    v_mfma_f32_16x16x32_bf16 v[40:43], v[72:75], v[188:191], v[40:43]
    ds_read_b64_tr_b16 v[106:107], v13 offset:14336
    buffer_load_dwordx4 v[180:183], v127, s[8:11], s44 offen offset:0 sc1
    v_mfma_f32_16x16x32_bf16 v[44:47], v[76:79], v[188:191], v[44:47]
    ds_read_b64_tr_b16 v[108:109], v14 offset:12288
    s_waitcnt vmcnt(10)
    v_mfma_f32_16x16x32_bf16 v[28:31], v[76:79], v[184:187], v[28:31]
    ds_read_b64_tr_b16 v[110:111], v14 offset:14336
    v_or3_b32 v17, v192, v196, v200
    v_mfma_f32_16x16x32_bf16 v[32:35], v[80:83], v[184:187], v[32:35]
    ds_read_b64_tr_b16 v[112:113], v15 offset:12288
    v_bitop3_b32 v17, v17, v204, 1 bitop3:0xa8
    v_mfma_f32_16x16x32_bf16 v[48:51], v[80:83], v[188:191], v[48:51]
    ds_read_b64_tr_b16 v[114:115], v15 offset:14336
    v_cmp_ne_u32 vcc, 0, v17
    v_mfma_f32_16x16x32_bf16 v[52:55], v[84:87], v[188:191], v[52:55]
    ds_read_b64_tr_b16 v[116:117], v16 offset:12288
    ds_read_b64_tr_b16 v[118:119], v16 offset:14336
    v_mfma_f32_16x16x32_bf16 v[36:39], v[84:87], v[184:187], v[36:39]
    s_waitcnt lgkmcnt(8)
    s_cbranch_vccnz dm_18f0
dm_18g0:
    v_mfma_f32_16x16x32_bf16 v[24:27], v[88:91], v[192:195], v[24:27]
    ds_read_b64_tr_b16 v[56:57], v13 offset:16384
    buffer_load_dwordx4 v[184:187], v126, s[8:11], s44 offen offset:1024 sc1
    v_mfma_f32_16x16x32_bf16 v[40:43], v[88:91], v[196:199], v[40:43]
    ds_read_b64_tr_b16 v[58:59], v13 offset:18432
    buffer_load_dwordx4 v[188:191], v127, s[8:11], s44 offen offset:1024 sc1
    v_mfma_f32_16x16x32_bf16 v[44:47], v[92:95], v[196:199], v[44:47]
    ds_read_b64_tr_b16 v[60:61], v14 offset:16384
    v_mfma_f32_16x16x32_bf16 v[28:31], v[92:95], v[192:195], v[28:31]
    ds_read_b64_tr_b16 v[62:63], v14 offset:18432
    v_mfma_f32_16x16x32_bf16 v[32:35], v[96:99], v[192:195], v[32:35]
    ds_read_b64_tr_b16 v[64:65], v15 offset:16384
    v_mfma_f32_16x16x32_bf16 v[48:51], v[96:99], v[196:199], v[48:51]
    ds_read_b64_tr_b16 v[66:67], v15 offset:18432
    v_mfma_f32_16x16x32_bf16 v[52:55], v[100:103], v[196:199], v[52:55]
    ds_read_b64_tr_b16 v[68:69], v16 offset:16384
    v_mfma_f32_16x16x32_bf16 v[36:39], v[100:103], v[192:195], v[36:39]
    ds_read_b64_tr_b16 v[70:71], v16 offset:18432
    s_waitcnt lgkmcnt(8)
    v_mfma_f32_16x16x32_bf16 v[24:27], v[104:107], v[200:203], v[24:27]
    ds_read_b64_tr_b16 v[72:73], v13 offset:20480
    buffer_load_dwordx4 v[192:195], v126, s[8:11], s44 offen offset:2048 sc1
    v_mfma_f32_16x16x32_bf16 v[40:43], v[104:107], v[204:207], v[40:43]
    ds_read_b64_tr_b16 v[74:75], v13 offset:22528
    buffer_load_dwordx4 v[196:199], v127, s[8:11], s44 offen offset:2048 sc1
    v_mfma_f32_16x16x32_bf16 v[44:47], v[108:111], v[204:207], v[44:47]
    ds_read_b64_tr_b16 v[76:77], v14 offset:20480
    s_waitcnt vmcnt(10)
    v_mfma_f32_16x16x32_bf16 v[28:31], v[108:111], v[200:203], v[28:31]
    ds_read_b64_tr_b16 v[78:79], v14 offset:22528
    v_or3_b32 v17, v208, v212, v216
    v_mfma_f32_16x16x32_bf16 v[32:35], v[112:115], v[200:203], v[32:35]
    ds_read_b64_tr_b16 v[80:81], v15 offset:20480
    v_bitop3_b32 v17, v17, v220, 1 bitop3:0xa8
    v_mfma_f32_16x16x32_bf16 v[48:51], v[112:115], v[204:207], v[48:51]
    ds_read_b64_tr_b16 v[82:83], v15 offset:22528
    v_cmp_ne_u32 vcc, 0, v17
    v_mfma_f32_16x16x32_bf16 v[52:55], v[116:119], v[204:207], v[52:55]
    ds_read_b64_tr_b16 v[84:85], v16 offset:20480
    ds_read_b64_tr_b16 v[86:87], v16 offset:22528
    v_mfma_f32_16x16x32_bf16 v[36:39], v[116:119], v[200:203], v[36:39]
    s_waitcnt lgkmcnt(8)
    s_cbranch_vccnz dm_18f1
dm_18g1:
    v_mfma_f32_16x16x32_bf16 v[24:27], v[56:59], v[208:211], v[24:27]
    ds_read_b64_tr_b16 v[88:89], v13 offset:24576
    buffer_load_dwordx4 v[200:203], v126, s[8:11], s44 offen offset:3072 sc1
    v_mfma_f32_16x16x32_bf16 v[40:43], v[56:59], v[212:215], v[40:43]
    ds_read_b64_tr_b16 v[90:91], v13 offset:26624
    buffer_load_dwordx4 v[204:207], v127, s[8:11], s44 offen offset:3072 sc1
    v_mfma_f32_16x16x32_bf16 v[44:47], v[60:63], v[212:215], v[44:47]
    ds_read_b64_tr_b16 v[92:93], v14 offset:24576
    s_add_u32 s43, s43, 1
    v_mfma_f32_16x16x32_bf16 v[28:31], v[60:63], v[208:211], v[28:31]
    ds_read_b64_tr_b16 v[94:95], v14 offset:26624
    s_cmp_eq_u32 s43, 4
    v_mfma_f32_16x16x32_bf16 v[32:35], v[64:67], v[208:211], v[32:35]
    ds_read_b64_tr_b16 v[96:97], v15 offset:24576
    v_mfma_f32_16x16x32_bf16 v[48:51], v[64:67], v[212:215], v[48:51]
    ds_read_b64_tr_b16 v[98:99], v15 offset:26624
    v_mfma_f32_16x16x32_bf16 v[52:55], v[68:71], v[212:215], v[52:55]
    ds_read_b64_tr_b16 v[100:101], v16 offset:24576
    v_mfma_f32_16x16x32_bf16 v[36:39], v[68:71], v[208:211], v[36:39]
    ds_read_b64_tr_b16 v[102:103], v16 offset:26624
    s_waitcnt lgkmcnt(8)
    v_mfma_f32_16x16x32_bf16 v[24:27], v[72:75], v[216:219], v[24:27]
    ds_read_b64_tr_b16 v[104:105], v13 offset:28672
    buffer_load_dwordx4 v[208:211], v128, s[8:11], s44 offen offset:0 sc1
    v_mfma_f32_16x16x32_bf16 v[40:43], v[72:75], v[220:223], v[40:43]
    ds_read_b64_tr_b16 v[106:107], v13 offset:30720
    buffer_load_dwordx4 v[212:215], v129, s[8:11], s44 offen offset:0 sc1
    v_mfma_f32_16x16x32_bf16 v[44:47], v[76:79], v[220:223], v[44:47]
    ds_read_b64_tr_b16 v[108:109], v14 offset:28672
    s_waitcnt vmcnt(10)
    v_mfma_f32_16x16x32_bf16 v[28:31], v[76:79], v[216:219], v[28:31]
    ds_read_b64_tr_b16 v[110:111], v14 offset:30720
    v_add_u32 v13, 32768, v13
    v_or3_b32 v17, v224, v228, v232
    v_mfma_f32_16x16x32_bf16 v[32:35], v[80:83], v[216:219], v[32:35]
    ds_read_b64_tr_b16 v[112:113], v15 offset:28672
    v_add_u32 v14, 32768, v14
    v_bitop3_b32 v17, v17, v236, 1 bitop3:0xa8
    v_mfma_f32_16x16x32_bf16 v[48:51], v[80:83], v[220:223], v[48:51]
    ds_read_b64_tr_b16 v[114:115], v15 offset:30720
    v_add_u32 v15, 32768, v15
    v_cmp_ne_u32 vcc, 0, v17
    v_mfma_f32_16x16x32_bf16 v[52:55], v[84:87], v[220:223], v[52:55]
    ds_read_b64_tr_b16 v[116:117], v16 offset:28672
    ds_read_b64_tr_b16 v[118:119], v16 offset:30720
    v_mfma_f32_16x16x32_bf16 v[36:39], v[84:87], v[216:219], v[36:39]
    v_add_u32 v16, 32768, v16
    s_waitcnt lgkmcnt(8)
    s_cbranch_vccnz dm_18f2
dm_18g2:
    s_cbranch_scc1 dm_18x
    v_mfma_f32_16x16x32_bf16 v[24:27], v[88:91], v[224:227], v[24:27]
    ds_read_b64_tr_b16 v[56:57], v13 offset:0
    buffer_load_dwordx4 v[216:219], v128, s[8:11], s44 offen offset:1024 sc1
    v_mfma_f32_16x16x32_bf16 v[40:43], v[88:91], v[228:231], v[40:43]
    ds_read_b64_tr_b16 v[58:59], v13 offset:2048
    buffer_load_dwordx4 v[220:223], v129, s[8:11], s44 offen offset:1024 sc1
    v_mfma_f32_16x16x32_bf16 v[44:47], v[92:95], v[228:231], v[44:47]
    ds_read_b64_tr_b16 v[60:61], v14 offset:0
    s_mov_b32 s49, s44
    v_mfma_f32_16x16x32_bf16 v[28:31], v[92:95], v[224:227], v[28:31]
    ds_read_b64_tr_b16 v[62:63], v14 offset:2048
    v_mfma_f32_16x16x32_bf16 v[32:35], v[96:99], v[224:227], v[32:35]
    ds_read_b64_tr_b16 v[64:65], v15 offset:0
    v_mfma_f32_16x16x32_bf16 v[48:51], v[96:99], v[228:231], v[48:51]
    ds_read_b64_tr_b16 v[66:67], v15 offset:2048
    v_mfma_f32_16x16x32_bf16 v[52:55], v[100:103], v[228:231], v[52:55]
    ds_read_b64_tr_b16 v[68:69], v16 offset:0
    v_mfma_f32_16x16x32_bf16 v[36:39], v[100:103], v[224:227], v[36:39]
    ds_read_b64_tr_b16 v[70:71], v16 offset:2048
    s_waitcnt lgkmcnt(8)
    v_mfma_f32_16x16x32_bf16 v[24:27], v[104:107], v[232:235], v[24:27]
    ds_read_b64_tr_b16 v[72:73], v13 offset:4096
    buffer_load_dwordx4 v[224:227], v128, s[8:11], s44 offen offset:2048 sc1
    v_mfma_f32_16x16x32_bf16 v[40:43], v[104:107], v[236:239], v[40:43]
    ds_read_b64_tr_b16 v[74:75], v13 offset:6144
    buffer_load_dwordx4 v[228:231], v129, s[8:11], s44 offen offset:2048 sc1
    v_mfma_f32_16x16x32_bf16 v[44:47], v[108:111], v[236:239], v[44:47]
    ds_read_b64_tr_b16 v[76:77], v14 offset:4096
    s_waitcnt vmcnt(10)
    v_mfma_f32_16x16x32_bf16 v[28:31], v[108:111], v[232:235], v[28:31]
    ds_read_b64_tr_b16 v[78:79], v14 offset:6144
    v_or3_b32 v17, v176, v180, v184
    v_mfma_f32_16x16x32_bf16 v[32:35], v[112:115], v[232:235], v[32:35]
    ds_read_b64_tr_b16 v[80:81], v15 offset:4096
    v_bitop3_b32 v17, v17, v188, 1 bitop3:0xa8
    v_mfma_f32_16x16x32_bf16 v[48:51], v[112:115], v[236:239], v[48:51]
    ds_read_b64_tr_b16 v[82:83], v15 offset:6144
    v_cmp_ne_u32 vcc, 0, v17
    v_mfma_f32_16x16x32_bf16 v[52:55], v[116:119], v[236:239], v[52:55]
    ds_read_b64_tr_b16 v[84:85], v16 offset:4096
    ds_read_b64_tr_b16 v[86:87], v16 offset:6144
    v_mfma_f32_16x16x32_bf16 v[36:39], v[116:119], v[232:235], v[36:39]
    s_waitcnt lgkmcnt(8)
    s_cbranch_vccnz dm_18f3
dm_18g3:
    s_branch dm_18
dm_18f0:
    s_cselect_b32 s50, 1, 0
dm_18h0:
    s_sleep 2
    buffer_load_dwordx4 v[192:195], v126, s[8:11], s49 offen offset:2048 sc1
    buffer_load_dwordx4 v[196:199], v127, s[8:11], s49 offen offset:2048 sc1
    buffer_load_dwordx4 v[200:203], v126, s[8:11], s49 offen offset:3072 sc1
    buffer_load_dwordx4 v[204:207], v127, s[8:11], s49 offen offset:3072 sc1
    buffer_load_dwordx4 v[208:211], v128, s[8:11], s49 offen offset:0 sc1
    buffer_load_dwordx4 v[212:215], v129, s[8:11], s49 offen offset:0 sc1
    buffer_load_dwordx4 v[216:219], v128, s[8:11], s49 offen offset:1024 sc1
    buffer_load_dwordx4 v[220:223], v129, s[8:11], s49 offen offset:1024 sc1
    buffer_load_dwordx4 v[224:227], v128, s[8:11], s49 offen offset:2048 sc1
    buffer_load_dwordx4 v[228:231], v129, s[8:11], s49 offen offset:2048 sc1
    buffer_load_dwordx4 v[232:235], v128, s[8:11], s49 offen offset:3072 sc1
    buffer_load_dwordx4 v[236:239], v129, s[8:11], s49 offen offset:3072 sc1
    buffer_load_dwordx4 v[176:179], v126, s[8:11], s44 offen offset:0 sc1
    buffer_load_dwordx4 v[180:183], v127, s[8:11], s44 offen offset:0 sc1
    s_waitcnt vmcnt(10)
    v_or3_b32 v17, v192, v196, v200
    v_bitop3_b32 v17, v17, v204, 1 bitop3:0xa8
    v_cmp_ne_u32 vcc, 0, v17
    s_add_u32 s53, s53, 1
    s_cmp_ge_u32 s53, s61
    s_cselect_b32 s61, 0, s61
    s_cbranch_scc1 dm_18k0
    s_cbranch_vccnz dm_18h0
dm_18k0:
    s_cmp_eq_u32 s50, 1
    s_branch dm_18g0
dm_18f1:
    s_cselect_b32 s50, 1, 0
dm_18h1:
    s_sleep 2
    buffer_load_dwordx4 v[208:211], v128, s[8:11], s49 offen offset:0 sc1
    buffer_load_dwordx4 v[212:215], v129, s[8:11], s49 offen offset:0 sc1
    buffer_load_dwordx4 v[216:219], v128, s[8:11], s49 offen offset:1024 sc1
    buffer_load_dwordx4 v[220:223], v129, s[8:11], s49 offen offset:1024 sc1
    buffer_load_dwordx4 v[224:227], v128, s[8:11], s49 offen offset:2048 sc1
    buffer_load_dwordx4 v[228:231], v129, s[8:11], s49 offen offset:2048 sc1
    buffer_load_dwordx4 v[232:235], v128, s[8:11], s49 offen offset:3072 sc1
    buffer_load_dwordx4 v[236:239], v129, s[8:11], s49 offen offset:3072 sc1
    buffer_load_dwordx4 v[176:179], v126, s[8:11], s44 offen offset:0 sc1
    buffer_load_dwordx4 v[180:183], v127, s[8:11], s44 offen offset:0 sc1
    buffer_load_dwordx4 v[184:187], v126, s[8:11], s44 offen offset:1024 sc1
    buffer_load_dwordx4 v[188:191], v127, s[8:11], s44 offen offset:1024 sc1
    buffer_load_dwordx4 v[192:195], v126, s[8:11], s44 offen offset:2048 sc1
    buffer_load_dwordx4 v[196:199], v127, s[8:11], s44 offen offset:2048 sc1
    s_waitcnt vmcnt(10)
    v_or3_b32 v17, v208, v212, v216
    v_bitop3_b32 v17, v17, v220, 1 bitop3:0xa8
    v_cmp_ne_u32 vcc, 0, v17
    s_add_u32 s53, s53, 1
    s_cmp_ge_u32 s53, s61
    s_cselect_b32 s61, 0, s61
    s_cbranch_scc1 dm_18k1
    s_cbranch_vccnz dm_18h1
dm_18k1:
    s_cmp_eq_u32 s50, 1
    s_branch dm_18g1
dm_18f2:
    s_cselect_b32 s50, 1, 0
dm_18h2:
    s_sleep 2
    buffer_load_dwordx4 v[224:227], v128, s[8:11], s49 offen offset:2048 sc1
    buffer_load_dwordx4 v[228:231], v129, s[8:11], s49 offen offset:2048 sc1
    buffer_load_dwordx4 v[232:235], v128, s[8:11], s49 offen offset:3072 sc1
    buffer_load_dwordx4 v[236:239], v129, s[8:11], s49 offen offset:3072 sc1
    buffer_load_dwordx4 v[176:179], v126, s[8:11], s44 offen offset:0 sc1
    buffer_load_dwordx4 v[180:183], v127, s[8:11], s44 offen offset:0 sc1
    buffer_load_dwordx4 v[184:187], v126, s[8:11], s44 offen offset:1024 sc1
    buffer_load_dwordx4 v[188:191], v127, s[8:11], s44 offen offset:1024 sc1
    buffer_load_dwordx4 v[192:195], v126, s[8:11], s44 offen offset:2048 sc1
    buffer_load_dwordx4 v[196:199], v127, s[8:11], s44 offen offset:2048 sc1
    buffer_load_dwordx4 v[200:203], v126, s[8:11], s44 offen offset:3072 sc1
    buffer_load_dwordx4 v[204:207], v127, s[8:11], s44 offen offset:3072 sc1
    buffer_load_dwordx4 v[208:211], v128, s[8:11], s44 offen offset:0 sc1
    buffer_load_dwordx4 v[212:215], v129, s[8:11], s44 offen offset:0 sc1
    s_waitcnt vmcnt(10)
    v_or3_b32 v17, v224, v228, v232
    v_bitop3_b32 v17, v17, v236, 1 bitop3:0xa8
    v_cmp_ne_u32 vcc, 0, v17
    s_add_u32 s53, s53, 1
    s_cmp_ge_u32 s53, s61
    s_cselect_b32 s61, 0, s61
    s_cbranch_scc1 dm_18k2
    s_cbranch_vccnz dm_18h2
dm_18k2:
    s_cmp_eq_u32 s50, 1
    s_branch dm_18g2
dm_18f3:
    s_cselect_b32 s50, 1, 0
dm_18h3:
    s_sleep 2
    buffer_load_dwordx4 v[176:179], v126, s[8:11], s49 offen offset:0 sc1
    buffer_load_dwordx4 v[180:183], v127, s[8:11], s49 offen offset:0 sc1
    buffer_load_dwordx4 v[184:187], v126, s[8:11], s49 offen offset:1024 sc1
    buffer_load_dwordx4 v[188:191], v127, s[8:11], s49 offen offset:1024 sc1
    buffer_load_dwordx4 v[192:195], v126, s[8:11], s49 offen offset:2048 sc1
    buffer_load_dwordx4 v[196:199], v127, s[8:11], s49 offen offset:2048 sc1
    buffer_load_dwordx4 v[200:203], v126, s[8:11], s49 offen offset:3072 sc1
    buffer_load_dwordx4 v[204:207], v127, s[8:11], s49 offen offset:3072 sc1
    buffer_load_dwordx4 v[208:211], v128, s[8:11], s49 offen offset:0 sc1
    buffer_load_dwordx4 v[212:215], v129, s[8:11], s49 offen offset:0 sc1
    buffer_load_dwordx4 v[216:219], v128, s[8:11], s49 offen offset:1024 sc1
    buffer_load_dwordx4 v[220:223], v129, s[8:11], s49 offen offset:1024 sc1
    buffer_load_dwordx4 v[224:227], v128, s[8:11], s49 offen offset:2048 sc1
    buffer_load_dwordx4 v[228:231], v129, s[8:11], s49 offen offset:2048 sc1
    s_waitcnt vmcnt(10)
    v_or3_b32 v17, v176, v180, v184
    v_bitop3_b32 v17, v17, v188, 1 bitop3:0xa8
    v_cmp_ne_u32 vcc, 0, v17
    s_add_u32 s53, s53, 1
    s_cmp_ge_u32 s53, s61
    s_cselect_b32 s61, 0, s61
    s_cbranch_scc1 dm_18k3
    s_cbranch_vccnz dm_18h3
dm_18k3:
    s_cmp_eq_u32 s50, 1
    s_branch dm_18g3
dm_18x:
    v_mfma_f32_16x16x32_bf16 v[24:27], v[88:91], v[224:227], v[24:27]
    buffer_load_dwordx4 v[160:163], v126, s[8:11], s41 offen offset:0 sc1
    v_mfma_f32_16x16x32_bf16 v[40:43], v[88:91], v[228:231], v[40:43]
    v_mfma_f32_16x16x32_bf16 v[44:47], v[92:95], v[228:231], v[44:47]
    buffer_load_dwordx4 v[164:167], v126, s[8:11], s41 offen offset:1024 sc1
    v_mfma_f32_16x16x32_bf16 v[28:31], v[92:95], v[224:227], v[28:31]
    v_mfma_f32_16x16x32_bf16 v[32:35], v[96:99], v[224:227], v[32:35]
    buffer_load_dwordx4 v[168:171], v127, s[8:11], s41 offen offset:0 sc1
    v_mfma_f32_16x16x32_bf16 v[48:51], v[96:99], v[228:231], v[48:51]
    v_mfma_f32_16x16x32_bf16 v[52:55], v[100:103], v[228:231], v[52:55]
    buffer_load_dwordx4 v[172:175], v127, s[8:11], s41 offen offset:1024 sc1
    v_mfma_f32_16x16x32_bf16 v[36:39], v[100:103], v[224:227], v[36:39]
    s_waitcnt lgkmcnt(0)
    s_barrier
    v_mfma_f32_16x16x32_bf16 v[24:27], v[104:107], v[232:235], v[24:27]
    ds_read_b128 v[56:59], v6 offset:0
    v_mfma_f32_16x16x32_bf16 v[40:43], v[104:107], v[236:239], v[40:43]
    ds_read_b128 v[60:63], v6 offset:64
    v_mfma_f32_16x16x32_bf16 v[44:47], v[108:111], v[236:239], v[44:47]
    ds_read_b128 v[64:67], v6 offset:128
    v_mfma_f32_16x16x32_bf16 v[28:31], v[108:111], v[232:235], v[28:31]
    ds_read_b128 v[68:71], v6 offset:192
    v_mfma_f32_16x16x32_bf16 v[32:35], v[112:115], v[232:235], v[32:35]
    ds_read_b64 v[72:73], v7 offset:0
    v_mfma_f32_16x16x32_bf16 v[48:51], v[112:115], v[236:239], v[48:51]
    ds_read_b64 v[74:75], v7 offset:256
    v_mfma_f32_16x16x32_bf16 v[52:55], v[116:119], v[236:239], v[52:55]
    v_mfma_f32_16x16x32_bf16 v[36:39], v[116:119], v[232:235], v[36:39]
    s_waitcnt lgkmcnt(0)
    v_mul_f32 v134, 0xc0135761, v73
    v_mul_f32 v135, v73, v73
    v_mul_f32 v135, v135, v134
    v_mul_f32 v135, 0x3d372713, v135
    v_rcp_f32 v73, v73
    v_mul_f32 v136, 0xc0135761, v75
    v_mul_f32 v137, v75, v75
    v_mul_f32 v137, v137, v136
    v_mul_f32 v137, 0x3d372713, v137
    v_rcp_f32 v75, v75
    v_pk_fma_f32 v[24:25], v[72:73], v[56:57], v[24:25] op_sel_hi:[0,1,1] neg_lo:[1,0,0] neg_hi:[1,0,0]
    v_pk_fma_f32 v[26:27], v[72:73], v[58:59], v[26:27] op_sel_hi:[0,1,1] neg_lo:[1,0,0] neg_hi:[1,0,0]
    v_pk_mul_f32 v[122:123], v[24:25], v[24:25]
    v_pk_mul_f32 v[124:125], v[26:27], v[26:27]
    v_pk_fma_f32 v[122:123], v[122:123], v[134:135], v[134:135] op_sel:[0,1,0] op_sel_hi:[1,1,0]
    v_pk_fma_f32 v[124:125], v[124:125], v[134:135], v[134:135] op_sel:[0,1,0] op_sel_hi:[1,1,0]
    v_pk_mul_f32 v[122:123], v[122:123], v[24:25]
    v_pk_mul_f32 v[124:125], v[124:125], v[26:27]
    v_exp_f32 v122, v122
    v_exp_f32 v123, v123
    v_exp_f32 v124, v124
    v_exp_f32 v125, v125
    v_pk_fma_f32 v[122:123], v[122:123], v[72:73], v[72:73] op_sel:[0,1,1] op_sel_hi:[1,1,1]
    v_pk_fma_f32 v[124:125], v[124:125], v[72:73], v[72:73] op_sel:[0,1,1] op_sel_hi:[1,1,1]
    v_rcp_f32 v122, v122
    v_rcp_f32 v123, v123
    v_rcp_f32 v124, v124
    v_rcp_f32 v125, v125
    v_pk_mul_f32 v[24:25], v[24:25], v[122:123]
    v_pk_mul_f32 v[26:27], v[26:27], v[124:125]
    v_pk_fma_f32 v[28:29], v[72:73], v[60:61], v[28:29] op_sel_hi:[0,1,1] neg_lo:[1,0,0] neg_hi:[1,0,0]
    v_pk_fma_f32 v[30:31], v[72:73], v[62:63], v[30:31] op_sel_hi:[0,1,1] neg_lo:[1,0,0] neg_hi:[1,0,0]
    v_pk_mul_f32 v[122:123], v[28:29], v[28:29]
    v_pk_mul_f32 v[124:125], v[30:31], v[30:31]
    v_pk_fma_f32 v[122:123], v[122:123], v[134:135], v[134:135] op_sel:[0,1,0] op_sel_hi:[1,1,0]
    v_pk_fma_f32 v[124:125], v[124:125], v[134:135], v[134:135] op_sel:[0,1,0] op_sel_hi:[1,1,0]
    v_pk_mul_f32 v[122:123], v[122:123], v[28:29]
    v_pk_mul_f32 v[124:125], v[124:125], v[30:31]
    v_exp_f32 v122, v122
    v_exp_f32 v123, v123
    v_exp_f32 v124, v124
    v_exp_f32 v125, v125
    v_pk_fma_f32 v[122:123], v[122:123], v[72:73], v[72:73] op_sel:[0,1,1] op_sel_hi:[1,1,1]
    v_pk_fma_f32 v[124:125], v[124:125], v[72:73], v[72:73] op_sel:[0,1,1] op_sel_hi:[1,1,1]
    v_rcp_f32 v122, v122
    v_rcp_f32 v123, v123
    v_rcp_f32 v124, v124
    v_rcp_f32 v125, v125
    v_pk_mul_f32 v[28:29], v[28:29], v[122:123]
    v_pk_mul_f32 v[30:31], v[30:31], v[124:125]
    v_cvt_pk_bf16_f32 v24, v24, v25
    v_cvt_pk_bf16_f32 v25, v26, v27
    v_cvt_pk_bf16_f32 v26, v28, v29
    v_cvt_pk_bf16_f32 v27, v30, v31
    v_and_or_b32 v24, v24, -2, s60
    buffer_store_dwordx4 v[24:27], v12, s[16:19], s39 offen offset:0 sc1
    v_pk_fma_f32 v[40:41], v[74:75], v[56:57], v[40:41] op_sel_hi:[0,1,1] neg_lo:[1,0,0] neg_hi:[1,0,0]
    v_pk_fma_f32 v[42:43], v[74:75], v[58:59], v[42:43] op_sel_hi:[0,1,1] neg_lo:[1,0,0] neg_hi:[1,0,0]
    v_pk_mul_f32 v[122:123], v[40:41], v[40:41]
    v_pk_mul_f32 v[124:125], v[42:43], v[42:43]
    v_pk_fma_f32 v[122:123], v[122:123], v[136:137], v[136:137] op_sel:[0,1,0] op_sel_hi:[1,1,0]
    v_pk_fma_f32 v[124:125], v[124:125], v[136:137], v[136:137] op_sel:[0,1,0] op_sel_hi:[1,1,0]
    v_pk_mul_f32 v[122:123], v[122:123], v[40:41]
    v_pk_mul_f32 v[124:125], v[124:125], v[42:43]
    v_exp_f32 v122, v122
    v_exp_f32 v123, v123
    v_exp_f32 v124, v124
    v_exp_f32 v125, v125
    v_pk_fma_f32 v[122:123], v[122:123], v[74:75], v[74:75] op_sel:[0,1,1] op_sel_hi:[1,1,1]
    v_pk_fma_f32 v[124:125], v[124:125], v[74:75], v[74:75] op_sel:[0,1,1] op_sel_hi:[1,1,1]
    v_rcp_f32 v122, v122
    v_rcp_f32 v123, v123
    v_rcp_f32 v124, v124
    v_rcp_f32 v125, v125
    v_pk_mul_f32 v[40:41], v[40:41], v[122:123]
    v_pk_mul_f32 v[42:43], v[42:43], v[124:125]
    v_pk_fma_f32 v[44:45], v[74:75], v[60:61], v[44:45] op_sel_hi:[0,1,1] neg_lo:[1,0,0] neg_hi:[1,0,0]
    v_pk_fma_f32 v[46:47], v[74:75], v[62:63], v[46:47] op_sel_hi:[0,1,1] neg_lo:[1,0,0] neg_hi:[1,0,0]
    v_pk_mul_f32 v[122:123], v[44:45], v[44:45]
    v_pk_mul_f32 v[124:125], v[46:47], v[46:47]
    v_pk_fma_f32 v[122:123], v[122:123], v[136:137], v[136:137] op_sel:[0,1,0] op_sel_hi:[1,1,0]
    v_pk_fma_f32 v[124:125], v[124:125], v[136:137], v[136:137] op_sel:[0,1,0] op_sel_hi:[1,1,0]
    v_pk_mul_f32 v[122:123], v[122:123], v[44:45]
    v_pk_mul_f32 v[124:125], v[124:125], v[46:47]
    v_exp_f32 v122, v122
    v_exp_f32 v123, v123
    v_exp_f32 v124, v124
    v_exp_f32 v125, v125
    v_pk_fma_f32 v[122:123], v[122:123], v[74:75], v[74:75] op_sel:[0,1,1] op_sel_hi:[1,1,1]
    v_pk_fma_f32 v[124:125], v[124:125], v[74:75], v[74:75] op_sel:[0,1,1] op_sel_hi:[1,1,1]
    v_rcp_f32 v122, v122
    v_rcp_f32 v123, v123
    v_rcp_f32 v124, v124
    v_rcp_f32 v125, v125
    v_pk_mul_f32 v[44:45], v[44:45], v[122:123]
    v_pk_mul_f32 v[46:47], v[46:47], v[124:125]
    v_cvt_pk_bf16_f32 v40, v40, v41
    v_cvt_pk_bf16_f32 v41, v42, v43
    v_cvt_pk_bf16_f32 v42, v44, v45
    v_cvt_pk_bf16_f32 v43, v46, v47
    v_and_or_b32 v40, v40, -2, s60
    buffer_store_dwordx4 v[40:43], v12, s[16:19], s39 offen offset:256 sc1
    v_pk_fma_f32 v[32:33], v[72:73], v[64:65], v[32:33] op_sel_hi:[0,1,1] neg_lo:[1,0,0] neg_hi:[1,0,0]
    v_pk_fma_f32 v[34:35], v[72:73], v[66:67], v[34:35] op_sel_hi:[0,1,1] neg_lo:[1,0,0] neg_hi:[1,0,0]
    v_pk_mul_f32 v[122:123], v[32:33], v[32:33]
    v_pk_mul_f32 v[124:125], v[34:35], v[34:35]
    v_pk_fma_f32 v[122:123], v[122:123], v[134:135], v[134:135] op_sel:[0,1,0] op_sel_hi:[1,1,0]
    v_pk_fma_f32 v[124:125], v[124:125], v[134:135], v[134:135] op_sel:[0,1,0] op_sel_hi:[1,1,0]
    v_pk_mul_f32 v[122:123], v[122:123], v[32:33]
    v_pk_mul_f32 v[124:125], v[124:125], v[34:35]
    v_exp_f32 v122, v122
    v_exp_f32 v123, v123
    v_exp_f32 v124, v124
    v_exp_f32 v125, v125
    v_pk_fma_f32 v[122:123], v[122:123], v[72:73], v[72:73] op_sel:[0,1,1] op_sel_hi:[1,1,1]
    v_pk_fma_f32 v[124:125], v[124:125], v[72:73], v[72:73] op_sel:[0,1,1] op_sel_hi:[1,1,1]
    v_rcp_f32 v122, v122
    v_rcp_f32 v123, v123
    v_rcp_f32 v124, v124
    v_rcp_f32 v125, v125
    v_pk_mul_f32 v[32:33], v[32:33], v[122:123]
    v_pk_mul_f32 v[34:35], v[34:35], v[124:125]
    v_pk_fma_f32 v[36:37], v[72:73], v[68:69], v[36:37] op_sel_hi:[0,1,1] neg_lo:[1,0,0] neg_hi:[1,0,0]
    v_pk_fma_f32 v[38:39], v[72:73], v[70:71], v[38:39] op_sel_hi:[0,1,1] neg_lo:[1,0,0] neg_hi:[1,0,0]
    v_pk_mul_f32 v[122:123], v[36:37], v[36:37]
    v_pk_mul_f32 v[124:125], v[38:39], v[38:39]
    v_pk_fma_f32 v[122:123], v[122:123], v[134:135], v[134:135] op_sel:[0,1,0] op_sel_hi:[1,1,0]
    v_pk_fma_f32 v[124:125], v[124:125], v[134:135], v[134:135] op_sel:[0,1,0] op_sel_hi:[1,1,0]
    v_pk_mul_f32 v[122:123], v[122:123], v[36:37]
    v_pk_mul_f32 v[124:125], v[124:125], v[38:39]
    v_exp_f32 v122, v122
    v_exp_f32 v123, v123
    v_exp_f32 v124, v124
    v_exp_f32 v125, v125
    v_pk_fma_f32 v[122:123], v[122:123], v[72:73], v[72:73] op_sel:[0,1,1] op_sel_hi:[1,1,1]
    v_pk_fma_f32 v[124:125], v[124:125], v[72:73], v[72:73] op_sel:[0,1,1] op_sel_hi:[1,1,1]
    v_rcp_f32 v122, v122
    v_rcp_f32 v123, v123
    v_rcp_f32 v124, v124
    v_rcp_f32 v125, v125
    v_pk_mul_f32 v[36:37], v[36:37], v[122:123]
    v_pk_mul_f32 v[38:39], v[38:39], v[124:125]
    v_cvt_pk_bf16_f32 v32, v32, v33
    v_cvt_pk_bf16_f32 v33, v34, v35
    v_cvt_pk_bf16_f32 v34, v36, v37
    v_cvt_pk_bf16_f32 v35, v38, v39
    v_and_or_b32 v32, v32, -2, s60
    buffer_store_dwordx4 v[32:35], v12, s[16:19], s40 offen offset:0 sc1
    v_pk_fma_f32 v[48:49], v[74:75], v[64:65], v[48:49] op_sel_hi:[0,1,1] neg_lo:[1,0,0] neg_hi:[1,0,0]
    v_pk_fma_f32 v[50:51], v[74:75], v[66:67], v[50:51] op_sel_hi:[0,1,1] neg_lo:[1,0,0] neg_hi:[1,0,0]
    v_pk_mul_f32 v[122:123], v[48:49], v[48:49]
    v_pk_mul_f32 v[124:125], v[50:51], v[50:51]
    v_pk_fma_f32 v[122:123], v[122:123], v[136:137], v[136:137] op_sel:[0,1,0] op_sel_hi:[1,1,0]
    v_pk_fma_f32 v[124:125], v[124:125], v[136:137], v[136:137] op_sel:[0,1,0] op_sel_hi:[1,1,0]
    v_pk_mul_f32 v[122:123], v[122:123], v[48:49]
    v_pk_mul_f32 v[124:125], v[124:125], v[50:51]
    v_exp_f32 v122, v122
    v_exp_f32 v123, v123
    v_exp_f32 v124, v124
    v_exp_f32 v125, v125
    v_pk_fma_f32 v[122:123], v[122:123], v[74:75], v[74:75] op_sel:[0,1,1] op_sel_hi:[1,1,1]
    v_pk_fma_f32 v[124:125], v[124:125], v[74:75], v[74:75] op_sel:[0,1,1] op_sel_hi:[1,1,1]
    v_rcp_f32 v122, v122
    v_rcp_f32 v123, v123
    v_rcp_f32 v124, v124
    v_rcp_f32 v125, v125
    v_pk_mul_f32 v[48:49], v[48:49], v[122:123]
    v_pk_mul_f32 v[50:51], v[50:51], v[124:125]
    v_pk_fma_f32 v[52:53], v[74:75], v[68:69], v[52:53] op_sel_hi:[0,1,1] neg_lo:[1,0,0] neg_hi:[1,0,0]
    v_pk_fma_f32 v[54:55], v[74:75], v[70:71], v[54:55] op_sel_hi:[0,1,1] neg_lo:[1,0,0] neg_hi:[1,0,0]
    v_pk_mul_f32 v[122:123], v[52:53], v[52:53]
    v_pk_mul_f32 v[124:125], v[54:55], v[54:55]
    v_pk_fma_f32 v[122:123], v[122:123], v[136:137], v[136:137] op_sel:[0,1,0] op_sel_hi:[1,1,0]
    v_pk_fma_f32 v[124:125], v[124:125], v[136:137], v[136:137] op_sel:[0,1,0] op_sel_hi:[1,1,0]
    v_pk_mul_f32 v[122:123], v[122:123], v[52:53]
    v_pk_mul_f32 v[124:125], v[124:125], v[54:55]
    v_exp_f32 v122, v122
    v_exp_f32 v123, v123
    v_exp_f32 v124, v124
    v_exp_f32 v125, v125
    v_pk_fma_f32 v[122:123], v[122:123], v[74:75], v[74:75] op_sel:[0,1,1] op_sel_hi:[1,1,1]
    v_pk_fma_f32 v[124:125], v[124:125], v[74:75], v[74:75] op_sel:[0,1,1] op_sel_hi:[1,1,1]
    v_rcp_f32 v122, v122
    v_rcp_f32 v123, v123
    v_rcp_f32 v124, v124
    v_rcp_f32 v125, v125
    v_pk_mul_f32 v[52:53], v[52:53], v[122:123]
    v_pk_mul_f32 v[54:55], v[54:55], v[124:125]
    v_cvt_pk_bf16_f32 v48, v48, v49
    v_cvt_pk_bf16_f32 v49, v50, v51
    v_cvt_pk_bf16_f32 v50, v52, v53
    v_cvt_pk_bf16_f32 v51, v54, v55
    v_and_or_b32 v48, v48, -2, s60
    buffer_store_dwordx4 v[48:51], v12, s[16:19], s40 offen offset:256 sc1
    s_cmp_lg_u32 s60, 0
    s_cbranch_scc1 G1_np
    s_add_u32 s53, s55, 256
    s_and_b32 s54, s29, 4
    s_lshl_b32 s54, s54, 5
    s_add_u32 s53, s53, s54
    v_mov_b32 v8, 1
    v_mov_b32 v9, 162816
    v_mov_b32 v11, 0
    s_mov_b64 exec, 1
    s_waitcnt vmcnt(0)
    ds_add_rtn_u32 v10, v9, v8
    s_waitcnt lgkmcnt(0)
    v_readfirstlane_b32 s54, v10
    s_nop 0
    s_and_b32 s54, s54, 3
    s_cmp_lg_u32 s54, 3
    s_cbranch_scc1 pub_19
    buffer_atomic_add v8, v11, s[56:59], s53 offen sc1
    v_mov_b32 v9, 162872
    ds_add_u32 v9, v8
pub_19:
    s_mov_b64 exec, -1
G1_np:
    s_mov_b32 s34, s30
    s_mov_b32 s35, 0
    v_and_b32 v22, 15, v1
    v_lshrrev_b32 v23, 4, v1
    s_mul_i32 s37, s34, 2
    s_mul_i32 s38, s29, 4
    s_mul_i32 s36, s35, 4
    s_add_u32 s38, s38, s36
    s_lshr_b32 s36, s38, 1
    s_lshr_b32 s53, s36, 3
    s_lshl_b32 s53, s53, 14
    s_and_b32 s39, s36, 7
    s_lshl_b32 s39, s39, 10
    s_add_u32 s39, s39, s53
    s_lshl_b32 s36, s37, 16
    s_add_u32 s39, s39, s36
    s_add_u32 s8, s4, 0xa000000
    s_addc_u32 s9, s5, 0
    s_mov_b32 s10, 0x800000
    s_mov_b32 s11, 0x20000
    v_mul_u32_u24 v126, 65536, v23
    v_lshl_add_u32 v126, v22, 4, v126
    v_add_u32 v127, 262144, v126
    v_add_u32 v128, 524288, v126
    v_add_u32 v129, 786432, v126
    v_add_u32 v130, 1048576, v126
    v_add_u32 v131, 1310720, v126
    v_add_u32 v132, 1572864, v126
    v_add_u32 v133, 1835008, v126
    s_lshr_b32 s36, s67, 2
    s_add_u32 s36, s36, 0
    s_and_b32 s36, s36, 3
    s_mul_i32 s44, s36, 2097152
    s_xor_b32 s53, s36, s94
    s_and_b32 s53, s53, 1
    s_lshl_b32 s53, s53, 13
    s_add_u32 s44, s44, s53
    s_lshr_b32 s53, s36, 1
    s_lshl_b32 s53, s53, 4
    s_add_u32 s53, s53, 16
    s_sub_u32 s54, 0, s53
    s_bitcmp1_b32 s36, 0
    s_cselect_b32 s53, s53, s54
    s_add_u32 s44, s44, s53
    s_lshl_b32 s36, s28, 2
    s_add_u32 s36, s36, s34
    s_lshl_b32 s36, s36, 9
    s_add_u32 s36, s36, 16384
    s_add_u32 s44, s44, s36
    s_lshr_b32 s36, s67, 2
    s_add_u32 s36, s36, 1
    s_and_b32 s36, s36, 3
    s_mul_i32 s45, s36, 2097152
    s_xor_b32 s53, s36, s94
    s_and_b32 s53, s53, 1
    s_lshl_b32 s53, s53, 13
    s_add_u32 s45, s45, s53
    s_lshr_b32 s53, s36, 1
    s_lshl_b32 s53, s53, 4
    s_add_u32 s53, s53, 16
    s_sub_u32 s54, 0, s53
    s_bitcmp1_b32 s36, 0
    s_cselect_b32 s53, s53, s54
    s_add_u32 s45, s45, s53
    s_lshl_b32 s36, s28, 2
    s_add_u32 s36, s36, s34
    s_lshl_b32 s36, s36, 9
    s_add_u32 s36, s36, 16384
    s_add_u32 s45, s45, s36
    s_lshr_b32 s36, s67, 2
    s_add_u32 s36, s36, 2
    s_and_b32 s36, s36, 3
    s_mul_i32 s46, s36, 2097152
    s_xor_b32 s53, s36, s94
    s_and_b32 s53, s53, 1
    s_lshl_b32 s53, s53, 13
    s_add_u32 s46, s46, s53
    s_lshr_b32 s53, s36, 1
    s_lshl_b32 s53, s53, 4
    s_add_u32 s53, s53, 16
    s_sub_u32 s54, 0, s53
    s_bitcmp1_b32 s36, 0
    s_cselect_b32 s53, s53, s54
    s_add_u32 s46, s46, s53
    s_lshl_b32 s36, s28, 2
    s_add_u32 s36, s36, s34
    s_lshl_b32 s36, s36, 9
    s_add_u32 s36, s36, 16384
    s_add_u32 s46, s46, s36
    s_lshr_b32 s36, s67, 2
    s_add_u32 s36, s36, 3
    s_and_b32 s36, s36, 3
    s_mul_i32 s47, s36, 2097152
    s_xor_b32 s53, s36, s94
    s_and_b32 s53, s53, 1
    s_lshl_b32 s53, s53, 13
    s_add_u32 s47, s47, s53
    s_lshr_b32 s53, s36, 1
    s_lshl_b32 s53, s53, 4
    s_add_u32 s53, s53, 16
    s_sub_u32 s54, 0, s53
    s_bitcmp1_b32 s36, 0
    s_cselect_b32 s53, s53, s54
    s_add_u32 s47, s47, s53
    s_lshl_b32 s36, s28, 2
    s_add_u32 s36, s36, s34
    s_lshl_b32 s36, s36, 9
    s_add_u32 s36, s36, 16384
    s_add_u32 s47, s47, s36
    v_lshrrev_b32 v6, 2, v1
    v_mul_u32_u24 v13, 128, v6
    v_and_b32 v7, 3, v1
    v_lshl_add_u32 v13, v7, 3, v13
    v_add_u32 v13, 0, v13
    v_bfe_u32 v6, v6, 1, 2
    s_mul_i32 s36, s35, 4
    s_add_u32 s36, s36, 3
    v_xor_b32 v7, s36, v6
    v_lshl_add_u32 v16, v7, 5, v13
    s_mul_i32 s36, s35, 4
    s_add_u32 s36, s36, 2
    v_xor_b32 v7, s36, v6
    v_lshl_add_u32 v15, v7, 5, v13
    s_mul_i32 s36, s35, 4
    s_add_u32 s36, s36, 1
    v_xor_b32 v7, s36, v6
    v_lshl_add_u32 v14, v7, 5, v13
    s_mul_i32 s36, s35, 4
    s_add_u32 s36, s36, 0
    v_xor_b32 v7, s36, v6
    v_lshl_add_u32 v13, v7, 5, v13
    s_lshl_b32 s36, s37, 8
    s_add_u32 s36, s36, 160768
    v_lshlrev_b32 v7, 4, v22
    v_add_u32 v7, s36, v7
    ds_read_b64 v[56:57], v7 offset:0
    ds_read_b64 v[58:59], v7 offset:256
    s_waitcnt vmcnt(4) lgkmcnt(0)
    v_lshlrev_b32 v24, 16, v160
    v_and_b32 v25, 0xffff0000, v160
    v_pk_add_f32 v[24:25], v[24:25], v[56:57] op_sel_hi:[1,0] neg_lo:[0,1] neg_hi:[0,1]
    v_pk_mul_f32 v[24:25], v[24:25], v[56:57] op_sel:[0,1] op_sel_hi:[1,1]
    v_lshlrev_b32 v26, 16, v161
    v_and_b32 v27, 0xffff0000, v161
    v_pk_add_f32 v[26:27], v[26:27], v[56:57] op_sel_hi:[1,0] neg_lo:[0,1] neg_hi:[0,1]
    v_pk_mul_f32 v[26:27], v[26:27], v[56:57] op_sel:[0,1] op_sel_hi:[1,1]
    v_lshlrev_b32 v28, 16, v162
    v_and_b32 v29, 0xffff0000, v162
    v_pk_add_f32 v[28:29], v[28:29], v[56:57] op_sel_hi:[1,0] neg_lo:[0,1] neg_hi:[0,1]
    v_pk_mul_f32 v[28:29], v[28:29], v[56:57] op_sel:[0,1] op_sel_hi:[1,1]
    v_lshlrev_b32 v30, 16, v163
    v_and_b32 v31, 0xffff0000, v163
    v_pk_add_f32 v[30:31], v[30:31], v[56:57] op_sel_hi:[1,0] neg_lo:[0,1] neg_hi:[0,1]
    v_pk_mul_f32 v[30:31], v[30:31], v[56:57] op_sel:[0,1] op_sel_hi:[1,1]
    v_lshlrev_b32 v32, 16, v164
    v_and_b32 v33, 0xffff0000, v164
    v_pk_add_f32 v[32:33], v[32:33], v[56:57] op_sel_hi:[1,0] neg_lo:[0,1] neg_hi:[0,1]
    v_pk_mul_f32 v[32:33], v[32:33], v[56:57] op_sel:[0,1] op_sel_hi:[1,1]
    v_lshlrev_b32 v34, 16, v165
    v_and_b32 v35, 0xffff0000, v165
    v_pk_add_f32 v[34:35], v[34:35], v[56:57] op_sel_hi:[1,0] neg_lo:[0,1] neg_hi:[0,1]
    v_pk_mul_f32 v[34:35], v[34:35], v[56:57] op_sel:[0,1] op_sel_hi:[1,1]
    v_lshlrev_b32 v36, 16, v166
    v_and_b32 v37, 0xffff0000, v166
    v_pk_add_f32 v[36:37], v[36:37], v[56:57] op_sel_hi:[1,0] neg_lo:[0,1] neg_hi:[0,1]
    v_pk_mul_f32 v[36:37], v[36:37], v[56:57] op_sel:[0,1] op_sel_hi:[1,1]
    v_lshlrev_b32 v38, 16, v167
    v_and_b32 v39, 0xffff0000, v167
    v_pk_add_f32 v[38:39], v[38:39], v[56:57] op_sel_hi:[1,0] neg_lo:[0,1] neg_hi:[0,1]
    v_pk_mul_f32 v[38:39], v[38:39], v[56:57] op_sel:[0,1] op_sel_hi:[1,1]
    v_lshlrev_b32 v40, 16, v168
    v_and_b32 v41, 0xffff0000, v168
    v_pk_add_f32 v[40:41], v[40:41], v[58:59] op_sel_hi:[1,0] neg_lo:[0,1] neg_hi:[0,1]
    v_pk_mul_f32 v[40:41], v[40:41], v[58:59] op_sel:[0,1] op_sel_hi:[1,1]
    v_lshlrev_b32 v42, 16, v169
    v_and_b32 v43, 0xffff0000, v169
    v_pk_add_f32 v[42:43], v[42:43], v[58:59] op_sel_hi:[1,0] neg_lo:[0,1] neg_hi:[0,1]
    v_pk_mul_f32 v[42:43], v[42:43], v[58:59] op_sel:[0,1] op_sel_hi:[1,1]
    v_lshlrev_b32 v44, 16, v170
    v_and_b32 v45, 0xffff0000, v170
    v_pk_add_f32 v[44:45], v[44:45], v[58:59] op_sel_hi:[1,0] neg_lo:[0,1] neg_hi:[0,1]
    v_pk_mul_f32 v[44:45], v[44:45], v[58:59] op_sel:[0,1] op_sel_hi:[1,1]
    v_lshlrev_b32 v46, 16, v171
    v_and_b32 v47, 0xffff0000, v171
    v_pk_add_f32 v[46:47], v[46:47], v[58:59] op_sel_hi:[1,0] neg_lo:[0,1] neg_hi:[0,1]
    v_pk_mul_f32 v[46:47], v[46:47], v[58:59] op_sel:[0,1] op_sel_hi:[1,1]
    v_lshlrev_b32 v48, 16, v172
    v_and_b32 v49, 0xffff0000, v172
    v_pk_add_f32 v[48:49], v[48:49], v[58:59] op_sel_hi:[1,0] neg_lo:[0,1] neg_hi:[0,1]
    v_pk_mul_f32 v[48:49], v[48:49], v[58:59] op_sel:[0,1] op_sel_hi:[1,1]
    v_lshlrev_b32 v50, 16, v173
    v_and_b32 v51, 0xffff0000, v173
    v_pk_add_f32 v[50:51], v[50:51], v[58:59] op_sel_hi:[1,0] neg_lo:[0,1] neg_hi:[0,1]
    v_pk_mul_f32 v[50:51], v[50:51], v[58:59] op_sel:[0,1] op_sel_hi:[1,1]
    v_lshlrev_b32 v52, 16, v174
    v_and_b32 v53, 0xffff0000, v174
    v_pk_add_f32 v[52:53], v[52:53], v[58:59] op_sel_hi:[1,0] neg_lo:[0,1] neg_hi:[0,1]
    v_pk_mul_f32 v[52:53], v[52:53], v[58:59] op_sel:[0,1] op_sel_hi:[1,1]
    v_lshlrev_b32 v54, 16, v175
    v_and_b32 v55, 0xffff0000, v175
    v_pk_add_f32 v[54:55], v[54:55], v[58:59] op_sel_hi:[1,0] neg_lo:[0,1] neg_hi:[0,1]
    v_pk_mul_f32 v[54:55], v[54:55], v[58:59] op_sel:[0,1] op_sel_hi:[1,1]
    s_mov_b32 s43, 0
    s_add_u32 s16, s62, 0x80000
    s_addc_u32 s17, s63, 0
    s_mov_b32 s18, 0x7e000
    s_mov_b32 s19, 0x20000
    s_mov_b32 s53, 0
    s_mov_b32 s49, s44
    s_barrier
    s_cmp_eq_u32 s60, 0
    s_cbranch_scc1 dm_20z
    ds_read_b64_tr_b16 v[56:57], v13 offset:0
    ds_read_b64_tr_b16 v[58:59], v13 offset:2048
    ds_read_b64_tr_b16 v[60:61], v14 offset:0
    ds_read_b64_tr_b16 v[62:63], v14 offset:2048
    ds_read_b64_tr_b16 v[64:65], v15 offset:0
    ds_read_b64_tr_b16 v[66:67], v15 offset:2048
    ds_read_b64_tr_b16 v[68:69], v16 offset:0
    ds_read_b64_tr_b16 v[70:71], v16 offset:2048
    ds_read_b64_tr_b16 v[72:73], v13 offset:4096
    ds_read_b64_tr_b16 v[74:75], v13 offset:6144
    ds_read_b64_tr_b16 v[76:77], v14 offset:4096
    ds_read_b64_tr_b16 v[78:79], v14 offset:6144
    ds_read_b64_tr_b16 v[80:81], v15 offset:4096
    ds_read_b64_tr_b16 v[82:83], v15 offset:6144
    ds_read_b64_tr_b16 v[84:85], v16 offset:4096
    ds_read_b64_tr_b16 v[86:87], v16 offset:6144
dm_20p:
    buffer_load_dwordx4 v[176:179], v126, s[8:11], s44 offen offset:0 sc1
    buffer_load_dwordx4 v[180:183], v126, s[8:11], s44 offen offset:256 sc1
    buffer_load_dwordx4 v[184:187], v127, s[8:11], s44 offen offset:0 sc1
    buffer_load_dwordx4 v[188:191], v127, s[8:11], s44 offen offset:256 sc1
    s_waitcnt vmcnt(0)
    v_bitop3_b32 v17, v176, v180, v184 bitop3:0x80
    v_bitop3_b32 v17, v17, v188, s60 bitop3:0x2a
    v_cmp_ne_u32 vcc, 0, v17
    s_cbranch_vccz dm_20q
    s_sleep 2
    s_add_u32 s53, s53, 1
    s_cmp_lt_u32 s53, s61
    s_cbranch_scc1 dm_20p
    s_mov_b32 s61, 0
dm_20q:
    buffer_load_dwordx4 v[192:195], v128, s[8:11], s44 offen offset:0
    buffer_load_dwordx4 v[196:199], v128, s[8:11], s44 offen offset:256
    buffer_load_dwordx4 v[200:203], v129, s[8:11], s44 offen offset:0
    buffer_load_dwordx4 v[204:207], v129, s[8:11], s44 offen offset:256
    buffer_load_dwordx4 v[208:211], v130, s[8:11], s44 offen offset:0
    buffer_load_dwordx4 v[212:215], v130, s[8:11], s44 offen offset:256
    buffer_load_dwordx4 v[216:219], v131, s[8:11], s44 offen offset:0
    buffer_load_dwordx4 v[220:223], v131, s[8:11], s44 offen offset:256
    buffer_load_dwordx4 v[224:227], v132, s[8:11], s44 offen offset:0
    buffer_load_dwordx4 v[228:231], v132, s[8:11], s44 offen offset:256
    s_waitcnt lgkmcnt(0)
    s_branch dm_20
dm_20z:
    buffer_load_dwordx4 v[176:179], v126, s[8:11], s44 offen offset:0
    buffer_load_dwordx4 v[180:183], v126, s[8:11], s44 offen offset:256
    buffer_load_dwordx4 v[184:187], v127, s[8:11], s44 offen offset:0
    buffer_load_dwordx4 v[188:191], v127, s[8:11], s44 offen offset:256
    buffer_load_dwordx4 v[192:195], v128, s[8:11], s44 offen offset:0
    buffer_load_dwordx4 v[196:199], v128, s[8:11], s44 offen offset:256
    buffer_load_dwordx4 v[200:203], v129, s[8:11], s44 offen offset:0
    buffer_load_dwordx4 v[204:207], v129, s[8:11], s44 offen offset:256
    ds_read_b64_tr_b16 v[56:57], v13 offset:0
    ds_read_b64_tr_b16 v[58:59], v13 offset:2048
    ds_read_b64_tr_b16 v[60:61], v14 offset:0
    ds_read_b64_tr_b16 v[62:63], v14 offset:2048
    ds_read_b64_tr_b16 v[64:65], v15 offset:0
    ds_read_b64_tr_b16 v[66:67], v15 offset:2048
    ds_read_b64_tr_b16 v[68:69], v16 offset:0
    ds_read_b64_tr_b16 v[70:71], v16 offset:2048
    ds_read_b64_tr_b16 v[72:73], v13 offset:4096
    ds_read_b64_tr_b16 v[74:75], v13 offset:6144
    ds_read_b64_tr_b16 v[76:77], v14 offset:4096
    ds_read_b64_tr_b16 v[78:79], v14 offset:6144
    ds_read_b64_tr_b16 v[80:81], v15 offset:4096
    ds_read_b64_tr_b16 v[82:83], v15 offset:6144
    ds_read_b64_tr_b16 v[84:85], v16 offset:4096
    ds_read_b64_tr_b16 v[86:87], v16 offset:6144
    buffer_load_dwordx4 v[208:211], v130, s[8:11], s44 offen offset:0
    buffer_load_dwordx4 v[212:215], v130, s[8:11], s44 offen offset:256
    buffer_load_dwordx4 v[216:219], v131, s[8:11], s44 offen offset:0
    buffer_load_dwordx4 v[220:223], v131, s[8:11], s44 offen offset:256
    buffer_load_dwordx4 v[224:227], v132, s[8:11], s44 offen offset:0
    buffer_load_dwordx4 v[228:231], v132, s[8:11], s44 offen offset:256
    s_waitcnt vmcnt(10) lgkmcnt(0)
dm_20:
    v_mfma_f32_16x16x32_bf16 v[24:27], v[56:59], v[176:179], v[24:27]
    ds_read_b64_tr_b16 v[88:89], v13 offset:8192
    buffer_load_dwordx4 v[232:235], v133, s[8:11], s44 offen offset:0
    v_mfma_f32_16x16x32_bf16 v[40:43], v[56:59], v[180:183], v[40:43]
    ds_read_b64_tr_b16 v[90:91], v13 offset:10240
    buffer_load_dwordx4 v[236:239], v133, s[8:11], s44 offen offset:256
    v_mfma_f32_16x16x32_bf16 v[44:47], v[60:63], v[180:183], v[44:47]
    ds_read_b64_tr_b16 v[92:93], v14 offset:8192
    s_mov_b32 s44, s45
    v_mfma_f32_16x16x32_bf16 v[28:31], v[60:63], v[176:179], v[28:31]
    ds_read_b64_tr_b16 v[94:95], v14 offset:10240
    s_mov_b32 s45, s46
    v_mfma_f32_16x16x32_bf16 v[32:35], v[64:67], v[176:179], v[32:35]
    ds_read_b64_tr_b16 v[96:97], v15 offset:8192
    s_mov_b32 s46, s47
    v_mfma_f32_16x16x32_bf16 v[48:51], v[64:67], v[180:183], v[48:51]
    ds_read_b64_tr_b16 v[98:99], v15 offset:10240
    s_mov_b32 s47, 8388608
    v_mfma_f32_16x16x32_bf16 v[52:55], v[68:71], v[180:183], v[52:55]
    ds_read_b64_tr_b16 v[100:101], v16 offset:8192
    v_mfma_f32_16x16x32_bf16 v[36:39], v[68:71], v[176:179], v[36:39]
    ds_read_b64_tr_b16 v[102:103], v16 offset:10240
    s_waitcnt lgkmcnt(8)
    v_mfma_f32_16x16x32_bf16 v[24:27], v[72:75], v[184:187], v[24:27]
    ds_read_b64_tr_b16 v[104:105], v13 offset:12288
    buffer_load_dwordx4 v[176:179], v126, s[8:11], s44 offen offset:0
    v_mfma_f32_16x16x32_bf16 v[40:43], v[72:75], v[188:191], v[40:43]
    ds_read_b64_tr_b16 v[106:107], v13 offset:14336
    buffer_load_dwordx4 v[180:183], v126, s[8:11], s44 offen offset:256
    v_mfma_f32_16x16x32_bf16 v[44:47], v[76:79], v[188:191], v[44:47]
    ds_read_b64_tr_b16 v[108:109], v14 offset:12288
    s_waitcnt vmcnt(10)
    v_mfma_f32_16x16x32_bf16 v[28:31], v[76:79], v[184:187], v[28:31]
    ds_read_b64_tr_b16 v[110:111], v14 offset:14336
    v_bitop3_b32 v17, v192, v196, v200 bitop3:0x80
    v_mfma_f32_16x16x32_bf16 v[32:35], v[80:83], v[184:187], v[32:35]
    ds_read_b64_tr_b16 v[112:113], v15 offset:12288
    v_bitop3_b32 v17, v17, v204, s60 bitop3:0x2a
    v_mfma_f32_16x16x32_bf16 v[48:51], v[80:83], v[188:191], v[48:51]
    ds_read_b64_tr_b16 v[114:115], v15 offset:14336
    v_cmp_ne_u32 vcc, 0, v17
    v_mfma_f32_16x16x32_bf16 v[52:55], v[84:87], v[188:191], v[52:55]
    ds_read_b64_tr_b16 v[116:117], v16 offset:12288
    ds_read_b64_tr_b16 v[118:119], v16 offset:14336
    v_mfma_f32_16x16x32_bf16 v[36:39], v[84:87], v[184:187], v[36:39]
    s_waitcnt lgkmcnt(8)
    s_cbranch_vccnz dm_20f0
dm_20g0:
    v_mfma_f32_16x16x32_bf16 v[24:27], v[88:91], v[192:195], v[24:27]
    ds_read_b64_tr_b16 v[56:57], v13 offset:16384
    buffer_load_dwordx4 v[184:187], v127, s[8:11], s44 offen offset:0
    v_mfma_f32_16x16x32_bf16 v[40:43], v[88:91], v[196:199], v[40:43]
    ds_read_b64_tr_b16 v[58:59], v13 offset:18432
    buffer_load_dwordx4 v[188:191], v127, s[8:11], s44 offen offset:256
    v_mfma_f32_16x16x32_bf16 v[44:47], v[92:95], v[196:199], v[44:47]
    ds_read_b64_tr_b16 v[60:61], v14 offset:16384
    v_mfma_f32_16x16x32_bf16 v[28:31], v[92:95], v[192:195], v[28:31]
    ds_read_b64_tr_b16 v[62:63], v14 offset:18432
    v_mfma_f32_16x16x32_bf16 v[32:35], v[96:99], v[192:195], v[32:35]
    ds_read_b64_tr_b16 v[64:65], v15 offset:16384
    v_mfma_f32_16x16x32_bf16 v[48:51], v[96:99], v[196:199], v[48:51]
    ds_read_b64_tr_b16 v[66:67], v15 offset:18432
    v_mfma_f32_16x16x32_bf16 v[52:55], v[100:103], v[196:199], v[52:55]
    ds_read_b64_tr_b16 v[68:69], v16 offset:16384
    v_mfma_f32_16x16x32_bf16 v[36:39], v[100:103], v[192:195], v[36:39]
    ds_read_b64_tr_b16 v[70:71], v16 offset:18432
    s_waitcnt lgkmcnt(8)
    v_mfma_f32_16x16x32_bf16 v[24:27], v[104:107], v[200:203], v[24:27]
    ds_read_b64_tr_b16 v[72:73], v13 offset:20480
    buffer_load_dwordx4 v[192:195], v128, s[8:11], s44 offen offset:0
    v_mfma_f32_16x16x32_bf16 v[40:43], v[104:107], v[204:207], v[40:43]
    ds_read_b64_tr_b16 v[74:75], v13 offset:22528
    buffer_load_dwordx4 v[196:199], v128, s[8:11], s44 offen offset:256
    v_mfma_f32_16x16x32_bf16 v[44:47], v[108:111], v[204:207], v[44:47]
    ds_read_b64_tr_b16 v[76:77], v14 offset:20480
    s_waitcnt vmcnt(10)
    v_mfma_f32_16x16x32_bf16 v[28:31], v[108:111], v[200:203], v[28:31]
    ds_read_b64_tr_b16 v[78:79], v14 offset:22528
    v_bitop3_b32 v17, v208, v212, v216 bitop3:0x80
    v_mfma_f32_16x16x32_bf16 v[32:35], v[112:115], v[200:203], v[32:35]
    ds_read_b64_tr_b16 v[80:81], v15 offset:20480
    v_bitop3_b32 v17, v17, v220, s60 bitop3:0x2a
    v_mfma_f32_16x16x32_bf16 v[48:51], v[112:115], v[204:207], v[48:51]
    ds_read_b64_tr_b16 v[82:83], v15 offset:22528
    v_cmp_ne_u32 vcc, 0, v17
    v_mfma_f32_16x16x32_bf16 v[52:55], v[116:119], v[204:207], v[52:55]
    ds_read_b64_tr_b16 v[84:85], v16 offset:20480
    ds_read_b64_tr_b16 v[86:87], v16 offset:22528
    v_mfma_f32_16x16x32_bf16 v[36:39], v[116:119], v[200:203], v[36:39]
    s_waitcnt lgkmcnt(8)
    s_cbranch_vccnz dm_20f1
dm_20g1:
    v_mfma_f32_16x16x32_bf16 v[24:27], v[56:59], v[208:211], v[24:27]
    ds_read_b64_tr_b16 v[88:89], v13 offset:24576
    buffer_load_dwordx4 v[200:203], v129, s[8:11], s44 offen offset:0
    v_mfma_f32_16x16x32_bf16 v[40:43], v[56:59], v[212:215], v[40:43]
    ds_read_b64_tr_b16 v[90:91], v13 offset:26624
    buffer_load_dwordx4 v[204:207], v129, s[8:11], s44 offen offset:256
    v_mfma_f32_16x16x32_bf16 v[44:47], v[60:63], v[212:215], v[44:47]
    ds_read_b64_tr_b16 v[92:93], v14 offset:24576
    s_add_u32 s43, s43, 1
    v_mfma_f32_16x16x32_bf16 v[28:31], v[60:63], v[208:211], v[28:31]
    ds_read_b64_tr_b16 v[94:95], v14 offset:26624
    s_cmp_eq_u32 s43, 4
    v_mfma_f32_16x16x32_bf16 v[32:35], v[64:67], v[208:211], v[32:35]
    ds_read_b64_tr_b16 v[96:97], v15 offset:24576
    v_mfma_f32_16x16x32_bf16 v[48:51], v[64:67], v[212:215], v[48:51]
    ds_read_b64_tr_b16 v[98:99], v15 offset:26624
    v_mfma_f32_16x16x32_bf16 v[52:55], v[68:71], v[212:215], v[52:55]
    ds_read_b64_tr_b16 v[100:101], v16 offset:24576
    v_mfma_f32_16x16x32_bf16 v[36:39], v[68:71], v[208:211], v[36:39]
    ds_read_b64_tr_b16 v[102:103], v16 offset:26624
    s_waitcnt lgkmcnt(8)
    v_mfma_f32_16x16x32_bf16 v[24:27], v[72:75], v[216:219], v[24:27]
    ds_read_b64_tr_b16 v[104:105], v13 offset:28672
    buffer_load_dwordx4 v[208:211], v130, s[8:11], s44 offen offset:0
    v_mfma_f32_16x16x32_bf16 v[40:43], v[72:75], v[220:223], v[40:43]
    ds_read_b64_tr_b16 v[106:107], v13 offset:30720
    buffer_load_dwordx4 v[212:215], v130, s[8:11], s44 offen offset:256
    v_mfma_f32_16x16x32_bf16 v[44:47], v[76:79], v[220:223], v[44:47]
    ds_read_b64_tr_b16 v[108:109], v14 offset:28672
    s_waitcnt vmcnt(10)
    v_mfma_f32_16x16x32_bf16 v[28:31], v[76:79], v[216:219], v[28:31]
    ds_read_b64_tr_b16 v[110:111], v14 offset:30720
    v_add_u32 v13, 32768, v13
    v_bitop3_b32 v17, v224, v228, v232 bitop3:0x80
    v_mfma_f32_16x16x32_bf16 v[32:35], v[80:83], v[216:219], v[32:35]
    ds_read_b64_tr_b16 v[112:113], v15 offset:28672
    v_add_u32 v14, 32768, v14
    v_bitop3_b32 v17, v17, v236, s60 bitop3:0x2a
    v_mfma_f32_16x16x32_bf16 v[48:51], v[80:83], v[220:223], v[48:51]
    ds_read_b64_tr_b16 v[114:115], v15 offset:30720
    v_add_u32 v15, 32768, v15
    v_cmp_ne_u32 vcc, 0, v17
    v_mfma_f32_16x16x32_bf16 v[52:55], v[84:87], v[220:223], v[52:55]
    ds_read_b64_tr_b16 v[116:117], v16 offset:28672
    ds_read_b64_tr_b16 v[118:119], v16 offset:30720
    v_mfma_f32_16x16x32_bf16 v[36:39], v[84:87], v[216:219], v[36:39]
    v_add_u32 v16, 32768, v16
    s_waitcnt lgkmcnt(8)
    s_cbranch_vccnz dm_20f2
dm_20g2:
    s_cbranch_scc1 dm_20x
    v_mfma_f32_16x16x32_bf16 v[24:27], v[88:91], v[224:227], v[24:27]
    ds_read_b64_tr_b16 v[56:57], v13 offset:0
    buffer_load_dwordx4 v[216:219], v131, s[8:11], s44 offen offset:0
    v_mfma_f32_16x16x32_bf16 v[40:43], v[88:91], v[228:231], v[40:43]
    ds_read_b64_tr_b16 v[58:59], v13 offset:2048
    buffer_load_dwordx4 v[220:223], v131, s[8:11], s44 offen offset:256
    v_mfma_f32_16x16x32_bf16 v[44:47], v[92:95], v[228:231], v[44:47]
    ds_read_b64_tr_b16 v[60:61], v14 offset:0
    s_mov_b32 s49, s44
    v_mfma_f32_16x16x32_bf16 v[28:31], v[92:95], v[224:227], v[28:31]
    ds_read_b64_tr_b16 v[62:63], v14 offset:2048
    v_mfma_f32_16x16x32_bf16 v[32:35], v[96:99], v[224:227], v[32:35]
    ds_read_b64_tr_b16 v[64:65], v15 offset:0
    v_mfma_f32_16x16x32_bf16 v[48:51], v[96:99], v[228:231], v[48:51]
    ds_read_b64_tr_b16 v[66:67], v15 offset:2048
    v_mfma_f32_16x16x32_bf16 v[52:55], v[100:103], v[228:231], v[52:55]
    ds_read_b64_tr_b16 v[68:69], v16 offset:0
    v_mfma_f32_16x16x32_bf16 v[36:39], v[100:103], v[224:227], v[36:39]
    ds_read_b64_tr_b16 v[70:71], v16 offset:2048
    s_waitcnt lgkmcnt(8)
    v_mfma_f32_16x16x32_bf16 v[24:27], v[104:107], v[232:235], v[24:27]
    ds_read_b64_tr_b16 v[72:73], v13 offset:4096
    buffer_load_dwordx4 v[224:227], v132, s[8:11], s44 offen offset:0
    v_mfma_f32_16x16x32_bf16 v[40:43], v[104:107], v[236:239], v[40:43]
    ds_read_b64_tr_b16 v[74:75], v13 offset:6144
    buffer_load_dwordx4 v[228:231], v132, s[8:11], s44 offen offset:256
    v_mfma_f32_16x16x32_bf16 v[44:47], v[108:111], v[236:239], v[44:47]
    ds_read_b64_tr_b16 v[76:77], v14 offset:4096
    s_waitcnt vmcnt(10)
    v_mfma_f32_16x16x32_bf16 v[28:31], v[108:111], v[232:235], v[28:31]
    ds_read_b64_tr_b16 v[78:79], v14 offset:6144
    v_bitop3_b32 v17, v176, v180, v184 bitop3:0x80
    v_mfma_f32_16x16x32_bf16 v[32:35], v[112:115], v[232:235], v[32:35]
    ds_read_b64_tr_b16 v[80:81], v15 offset:4096
    v_bitop3_b32 v17, v17, v188, s60 bitop3:0x2a
    v_mfma_f32_16x16x32_bf16 v[48:51], v[112:115], v[236:239], v[48:51]
    ds_read_b64_tr_b16 v[82:83], v15 offset:6144
    v_cmp_ne_u32 vcc, 0, v17
    v_mfma_f32_16x16x32_bf16 v[52:55], v[116:119], v[236:239], v[52:55]
    ds_read_b64_tr_b16 v[84:85], v16 offset:4096
    ds_read_b64_tr_b16 v[86:87], v16 offset:6144
    v_mfma_f32_16x16x32_bf16 v[36:39], v[116:119], v[232:235], v[36:39]
    s_waitcnt lgkmcnt(8)
    s_cbranch_vccnz dm_20f3
dm_20g3:
    s_branch dm_20
dm_20f0:
    s_cselect_b32 s50, 1, 0
dm_20h0:
    s_sleep 2
    buffer_load_dwordx4 v[192:195], v128, s[8:11], s49 offen offset:0 sc1
    buffer_load_dwordx4 v[196:199], v128, s[8:11], s49 offen offset:256 sc1
    buffer_load_dwordx4 v[200:203], v129, s[8:11], s49 offen offset:0 sc1
    buffer_load_dwordx4 v[204:207], v129, s[8:11], s49 offen offset:256 sc1
    buffer_load_dwordx4 v[208:211], v130, s[8:11], s49 offen offset:0 sc1
    buffer_load_dwordx4 v[212:215], v130, s[8:11], s49 offen offset:256 sc1
    buffer_load_dwordx4 v[216:219], v131, s[8:11], s49 offen offset:0 sc1
    buffer_load_dwordx4 v[220:223], v131, s[8:11], s49 offen offset:256 sc1
    buffer_load_dwordx4 v[224:227], v132, s[8:11], s49 offen offset:0 sc1
    buffer_load_dwordx4 v[228:231], v132, s[8:11], s49 offen offset:256 sc1
    buffer_load_dwordx4 v[232:235], v133, s[8:11], s49 offen offset:0 sc1
    buffer_load_dwordx4 v[236:239], v133, s[8:11], s49 offen offset:256 sc1
    buffer_load_dwordx4 v[176:179], v126, s[8:11], s44 offen offset:0 sc1
    buffer_load_dwordx4 v[180:183], v126, s[8:11], s44 offen offset:256 sc1
    s_waitcnt vmcnt(10)
    v_bitop3_b32 v17, v192, v196, v200 bitop3:0x80
    v_bitop3_b32 v17, v17, v204, s60 bitop3:0x2a
    v_cmp_ne_u32 vcc, 0, v17
    s_add_u32 s53, s53, 1
    s_cmp_ge_u32 s53, s61
    s_cselect_b32 s61, 0, s61
    s_cbranch_scc1 dm_20k0
    s_cbranch_vccnz dm_20h0
dm_20k0:
    s_cmp_eq_u32 s50, 1
    s_branch dm_20g0
dm_20f1:
    s_cselect_b32 s50, 1, 0
dm_20h1:
    s_sleep 2
    buffer_load_dwordx4 v[208:211], v130, s[8:11], s49 offen offset:0 sc1
    buffer_load_dwordx4 v[212:215], v130, s[8:11], s49 offen offset:256 sc1
    buffer_load_dwordx4 v[216:219], v131, s[8:11], s49 offen offset:0 sc1
    buffer_load_dwordx4 v[220:223], v131, s[8:11], s49 offen offset:256 sc1
    buffer_load_dwordx4 v[224:227], v132, s[8:11], s49 offen offset:0 sc1
    buffer_load_dwordx4 v[228:231], v132, s[8:11], s49 offen offset:256 sc1
    buffer_load_dwordx4 v[232:235], v133, s[8:11], s49 offen offset:0 sc1
    buffer_load_dwordx4 v[236:239], v133, s[8:11], s49 offen offset:256 sc1
    buffer_load_dwordx4 v[176:179], v126, s[8:11], s44 offen offset:0 sc1
    buffer_load_dwordx4 v[180:183], v126, s[8:11], s44 offen offset:256 sc1
    buffer_load_dwordx4 v[184:187], v127, s[8:11], s44 offen offset:0 sc1
    buffer_load_dwordx4 v[188:191], v127, s[8:11], s44 offen offset:256 sc1
    buffer_load_dwordx4 v[192:195], v128, s[8:11], s44 offen offset:0 sc1
    buffer_load_dwordx4 v[196:199], v128, s[8:11], s44 offen offset:256 sc1
    s_waitcnt vmcnt(10)
    v_bitop3_b32 v17, v208, v212, v216 bitop3:0x80
    v_bitop3_b32 v17, v17, v220, s60 bitop3:0x2a
    v_cmp_ne_u32 vcc, 0, v17
    s_add_u32 s53, s53, 1
    s_cmp_ge_u32 s53, s61
    s_cselect_b32 s61, 0, s61
    s_cbranch_scc1 dm_20k1
    s_cbranch_vccnz dm_20h1
dm_20k1:
    s_cmp_eq_u32 s50, 1
    s_branch dm_20g1
dm_20f2:
    s_cselect_b32 s50, 1, 0
dm_20h2:
    s_sleep 2
    buffer_load_dwordx4 v[224:227], v132, s[8:11], s49 offen offset:0 sc1
    buffer_load_dwordx4 v[228:231], v132, s[8:11], s49 offen offset:256 sc1
    buffer_load_dwordx4 v[232:235], v133, s[8:11], s49 offen offset:0 sc1
    buffer_load_dwordx4 v[236:239], v133, s[8:11], s49 offen offset:256 sc1
    buffer_load_dwordx4 v[176:179], v126, s[8:11], s44 offen offset:0 sc1
    buffer_load_dwordx4 v[180:183], v126, s[8:11], s44 offen offset:256 sc1
    buffer_load_dwordx4 v[184:187], v127, s[8:11], s44 offen offset:0 sc1
    buffer_load_dwordx4 v[188:191], v127, s[8:11], s44 offen offset:256 sc1
    buffer_load_dwordx4 v[192:195], v128, s[8:11], s44 offen offset:0 sc1
    buffer_load_dwordx4 v[196:199], v128, s[8:11], s44 offen offset:256 sc1
    buffer_load_dwordx4 v[200:203], v129, s[8:11], s44 offen offset:0 sc1
    buffer_load_dwordx4 v[204:207], v129, s[8:11], s44 offen offset:256 sc1
    buffer_load_dwordx4 v[208:211], v130, s[8:11], s44 offen offset:0 sc1
    buffer_load_dwordx4 v[212:215], v130, s[8:11], s44 offen offset:256 sc1
    s_waitcnt vmcnt(10)
    v_bitop3_b32 v17, v224, v228, v232 bitop3:0x80
    v_bitop3_b32 v17, v17, v236, s60 bitop3:0x2a
    v_cmp_ne_u32 vcc, 0, v17
    s_add_u32 s53, s53, 1
    s_cmp_ge_u32 s53, s61
    s_cselect_b32 s61, 0, s61
    s_cbranch_scc1 dm_20k2
    s_cbranch_vccnz dm_20h2
dm_20k2:
    s_cmp_eq_u32 s50, 1
    s_branch dm_20g2
dm_20f3:
    s_cselect_b32 s50, 1, 0
dm_20h3:
    s_sleep 2
    buffer_load_dwordx4 v[176:179], v126, s[8:11], s49 offen offset:0 sc1
    buffer_load_dwordx4 v[180:183], v126, s[8:11], s49 offen offset:256 sc1
    buffer_load_dwordx4 v[184:187], v127, s[8:11], s49 offen offset:0 sc1
    buffer_load_dwordx4 v[188:191], v127, s[8:11], s49 offen offset:256 sc1
    buffer_load_dwordx4 v[192:195], v128, s[8:11], s49 offen offset:0 sc1
    buffer_load_dwordx4 v[196:199], v128, s[8:11], s49 offen offset:256 sc1
    buffer_load_dwordx4 v[200:203], v129, s[8:11], s49 offen offset:0 sc1
    buffer_load_dwordx4 v[204:207], v129, s[8:11], s49 offen offset:256 sc1
    buffer_load_dwordx4 v[208:211], v130, s[8:11], s49 offen offset:0 sc1
    buffer_load_dwordx4 v[212:215], v130, s[8:11], s49 offen offset:256 sc1
    buffer_load_dwordx4 v[216:219], v131, s[8:11], s49 offen offset:0 sc1
    buffer_load_dwordx4 v[220:223], v131, s[8:11], s49 offen offset:256 sc1
    buffer_load_dwordx4 v[224:227], v132, s[8:11], s49 offen offset:0 sc1
    buffer_load_dwordx4 v[228:231], v132, s[8:11], s49 offen offset:256 sc1
    s_waitcnt vmcnt(10)
    v_bitop3_b32 v17, v176, v180, v184 bitop3:0x80
    v_bitop3_b32 v17, v17, v188, s60 bitop3:0x2a
    v_cmp_ne_u32 vcc, 0, v17
    s_add_u32 s53, s53, 1
    s_cmp_ge_u32 s53, s61
    s_cselect_b32 s61, 0, s61
    s_cbranch_scc1 dm_20k3
    s_cbranch_vccnz dm_20h3
dm_20k3:
    s_cmp_eq_u32 s50, 1
    s_branch dm_20g3
dm_20x:
    v_mfma_f32_16x16x32_bf16 v[24:27], v[88:91], v[224:227], v[24:27]
    v_mfma_f32_16x16x32_bf16 v[40:43], v[88:91], v[228:231], v[40:43]
    v_mfma_f32_16x16x32_bf16 v[44:47], v[92:95], v[228:231], v[44:47]
    v_mfma_f32_16x16x32_bf16 v[28:31], v[92:95], v[224:227], v[28:31]
    v_mfma_f32_16x16x32_bf16 v[32:35], v[96:99], v[224:227], v[32:35]
    v_mfma_f32_16x16x32_bf16 v[48:51], v[96:99], v[228:231], v[48:51]
    v_mfma_f32_16x16x32_bf16 v[52:55], v[100:103], v[228:231], v[52:55]
    v_mfma_f32_16x16x32_bf16 v[36:39], v[100:103], v[224:227], v[36:39]
    s_waitcnt lgkmcnt(0)
    v_mfma_f32_16x16x32_bf16 v[24:27], v[104:107], v[232:235], v[24:27]
    s_add_u32 s44, s62, 0x5c8000
    v_mfma_f32_16x16x32_bf16 v[40:43], v[104:107], v[236:239], v[40:43]
    s_addc_u32 s45, s63, 0
    v_mfma_f32_16x16x32_bf16 v[44:47], v[108:111], v[236:239], v[44:47]
    v_mfma_f32_16x16x32_bf16 v[28:31], v[108:111], v[232:235], v[28:31]
    s_mov_b32 s46, 0x6000
    v_mfma_f32_16x16x32_bf16 v[32:35], v[112:115], v[232:235], v[32:35]
    v_mfma_f32_16x16x32_bf16 v[48:51], v[112:115], v[236:239], v[48:51]
    s_mov_b32 s47, 0x20000
    v_mfma_f32_16x16x32_bf16 v[52:55], v[116:119], v[236:239], v[52:55]
    v_mfma_f32_16x16x32_bf16 v[36:39], v[116:119], v[232:235], v[36:39]
    s_add_u32 s36, s39, 0
    v_cvt_pk_bf16_f32 v160, v24, v25
    v_cvt_pk_bf16_f32 v161, v26, v27
    v_cvt_pk_bf16_f32 v162, v28, v29
    v_cvt_pk_bf16_f32 v163, v30, v31
    v_and_b32 v160, -2, v160
    buffer_store_dwordx4 v[160:163], v2, s[16:19], s36 offen offset:0 sc1
    v_cvt_pk_bf16_f32 v164, v32, v33
    v_cvt_pk_bf16_f32 v165, v34, v35
    v_cvt_pk_bf16_f32 v166, v36, v37
    v_cvt_pk_bf16_f32 v167, v38, v39
    v_and_b32 v164, -2, v164
    buffer_store_dwordx4 v[164:167], v2, s[16:19], s36 offen offset:1024 sc1
    s_add_u32 s36, s39, 65536
    v_cvt_pk_bf16_f32 v168, v40, v41
    v_cvt_pk_bf16_f32 v169, v42, v43
    v_cvt_pk_bf16_f32 v170, v44, v45
    v_cvt_pk_bf16_f32 v171, v46, v47
    v_and_b32 v168, -2, v168
    buffer_store_dwordx4 v[168:171], v2, s[16:19], s36 offen offset:0 sc1
    v_cvt_pk_bf16_f32 v172, v48, v49
    v_cvt_pk_bf16_f32 v173, v50, v51
    v_cvt_pk_bf16_f32 v174, v52, v53
    v_cvt_pk_bf16_f32 v175, v54, v55
    v_and_b32 v172, -2, v172
    buffer_store_dwordx4 v[172:175], v2, s[16:19], s36 offen offset:1024 sc1
    s_barrier
    s_lshl_b32 s36, s37, 11
    v_add_u32 v7, s36, v2
    ds_write_b128 v7, v[160:163] offset:0
    ds_write_b128 v7, v[164:167] offset:1024
    ds_write_b128 v7, v[168:171] offset:2048
    ds_write_b128 v7, v[172:175] offset:3072
    v_lshlrev_b32 v24, 16, v160
    v_and_b32 v25, 0xffff0000, v160
    v_lshlrev_b32 v26, 16, v161
    v_and_b32 v27, 0xffff0000, v161
    v_lshlrev_b32 v28, 16, v162
    v_and_b32 v29, 0xffff0000, v162
    v_lshlrev_b32 v30, 16, v163
    v_and_b32 v31, 0xffff0000, v163
    v_lshlrev_b32 v32, 16, v164
    v_and_b32 v33, 0xffff0000, v164
    v_lshlrev_b32 v34, 16, v165
    v_and_b32 v35, 0xffff0000, v165
    v_lshlrev_b32 v36, 16, v166
    v_and_b32 v37, 0xffff0000, v166
    v_lshlrev_b32 v38, 16, v167
    v_and_b32 v39, 0xffff0000, v167
    v_lshlrev_b32 v40, 16, v168
    v_and_b32 v41, 0xffff0000, v168
    v_lshlrev_b32 v42, 16, v169
    v_and_b32 v43, 0xffff0000, v169
    v_lshlrev_b32 v44, 16, v170
    v_and_b32 v45, 0xffff0000, v170
    v_lshlrev_b32 v46, 16, v171
    v_and_b32 v47, 0xffff0000, v171
    v_lshlrev_b32 v48, 16, v172
    v_and_b32 v49, 0xffff0000, v172
    v_lshlrev_b32 v50, 16, v173
    v_and_b32 v51, 0xffff0000, v173
    v_lshlrev_b32 v52, 16, v174
    v_and_b32 v53, 0xffff0000, v174
    v_lshlrev_b32 v54, 16, v175
    v_and_b32 v55, 0xffff0000, v175
    s_add_u32 s53, s55, 512
    v_mov_b32 v8, 1
    v_mov_b32 v9, 162816
    v_mov_b32 v11, 0
    s_mov_b64 exec, 1
    s_waitcnt vmcnt(0)
    ds_add_rtn_u32 v10, v9, v8
    s_waitcnt lgkmcnt(0)
    v_readfirstlane_b32 s54, v10
    s_nop 0
    s_and_b32 s54, s54, 3
    s_cmp_lg_u32 s54, 3
    s_cbranch_scc1 pub_21
    buffer_atomic_add v8, v11, s[56:59], s53 offen sc1
    v_mov_b32 v9, 162872
    ds_add_u32 v9, v8
pub_21:
    s_mov_b64 exec, -1
    s_waitcnt lgkmcnt(0)
    s_barrier
    v_pk_add_f32 v[140:141], v[24:25], v[26:27]
    v_pk_mul_f32 v[134:135], v[24:25], v[24:25]
    v_pk_fma_f32 v[134:135], v[26:27], v[26:27], v[134:135]
    v_pk_add_f32 v[140:141], v[140:141], v[28:29]
    v_pk_fma_f32 v[134:135], v[28:29], v[28:29], v[134:135]
    v_pk_add_f32 v[140:141], v[140:141], v[30:31]
    v_pk_fma_f32 v[134:135], v[30:31], v[30:31], v[134:135]
    v_pk_add_f32 v[140:141], v[140:141], v[32:33]
    v_pk_fma_f32 v[134:135], v[32:33], v[32:33], v[134:135]
    v_pk_add_f32 v[140:141], v[140:141], v[34:35]
    v_pk_fma_f32 v[134:135], v[34:35], v[34:35], v[134:135]
    v_pk_add_f32 v[140:141], v[140:141], v[36:37]
    v_pk_fma_f32 v[134:135], v[36:37], v[36:37], v[134:135]
    v_pk_add_f32 v[140:141], v[140:141], v[38:39]
    v_pk_fma_f32 v[134:135], v[38:39], v[38:39], v[134:135]
    v_add_f32 v136, v140, v141
    v_add_f32 v137, v134, v135
    v_mov_b32 v140, v136
    v_mov_b32 v141, v137
    s_nop 0
    v_permlane16_swap_b32 v136, v140
    v_permlane16_swap_b32 v137, v141
    v_pk_add_f32 v[136:137], v[136:137], v[140:141]
    v_mov_b32 v140, v136
    v_mov_b32 v141, v137
    s_nop 0
    v_permlane32_swap_b32 v136, v140
    v_permlane32_swap_b32 v137, v141
    v_pk_add_f32 v[136:137], v[136:137], v[140:141]
    v_pk_add_f32 v[140:141], v[40:41], v[42:43]
    v_pk_mul_f32 v[134:135], v[40:41], v[40:41]
    v_pk_fma_f32 v[134:135], v[42:43], v[42:43], v[134:135]
    v_pk_add_f32 v[140:141], v[140:141], v[44:45]
    v_pk_fma_f32 v[134:135], v[44:45], v[44:45], v[134:135]
    v_pk_add_f32 v[140:141], v[140:141], v[46:47]
    v_pk_fma_f32 v[134:135], v[46:47], v[46:47], v[134:135]
    v_pk_add_f32 v[140:141], v[140:141], v[48:49]
    v_pk_fma_f32 v[134:135], v[48:49], v[48:49], v[134:135]
    v_pk_add_f32 v[140:141], v[140:141], v[50:51]
    v_pk_fma_f32 v[134:135], v[50:51], v[50:51], v[134:135]
    v_pk_add_f32 v[140:141], v[140:141], v[52:53]
    v_pk_fma_f32 v[134:135], v[52:53], v[52:53], v[134:135]
    v_pk_add_f32 v[140:141], v[140:141], v[54:55]
    v_pk_fma_f32 v[134:135], v[54:55], v[54:55], v[134:135]
    v_add_f32 v138, v140, v141
    v_add_f32 v139, v134, v135
    v_mov_b32 v140, v138
    v_mov_b32 v141, v139
    s_nop 0
    v_permlane16_swap_b32 v138, v140
    v_permlane16_swap_b32 v139, v141
    v_pk_add_f32 v[138:139], v[138:139], v[140:141]
    v_mov_b32 v140, v138
    v_mov_b32 v141, v139
    s_nop 0
    v_permlane32_swap_b32 v138, v140
    v_permlane32_swap_b32 v139, v141
    v_pk_add_f32 v[138:139], v[138:139], v[140:141]
    v_cmp_eq_u32 vcc, 0, v23
    s_nop 1
    v_cndmask_b32 v136, v138, v136, vcc
    v_cndmask_b32 v137, v139, v137, vcc
    s_lshr_b32 s53, s29, 3
    s_lshl_b32 s53, s53, 14
    s_and_b32 s40, s29, 7
    s_lshl_b32 s40, s40, 10
    s_add_u32 s40, s40, s53
    s_lshl_b32 s36, s34, 8
    s_add_u32 s40, s40, s36
    v_lshlrev_b32 v7, 3, v1
    s_bfm_b64 exec, 32, 0
    buffer_store_dwordx2 v[136:137], v7, s[44:47], s40 offen sc1
    s_mov_b64 exec, -1
    s_lshr_b32 s34, s30, 1
    s_and_b32 s35, s30, 1
    v_and_b32 v22, 15, v1
    v_lshrrev_b32 v23, 4, v1
    s_mul_i32 s37, s34, 4
    s_mul_i32 s38, s29, 14
    s_mul_i32 s36, s35, 7
    s_add_u32 s38, s38, s36
    s_mul_i32 s36, s34, 8192
    v_add_u32 v12, s36, v2
    v_lshrrev_b32 v6, 2, v1
    v_mul_u32_u24 v13, 448, v6
    v_and_b32 v7, 3, v1
    v_lshl_add_u32 v13, v7, 3, v13
    v_add_u32 v13, 73728, v13
    s_mul_i32 s36, s35, 224
    v_add_u32 v13, s36, v13
    v_bfe_u32 v6, v1, 4, 1
    v_lshlrev_b32 v6, 5, v6
    s_cmp_eq_u32 s35, 0
    s_cselect_b32 s36, 1, -1
    v_mul_lo_u32 v6, v6, s36
    v_sub_u32 v14, v13, v6
    v_add_u32 v13, v13, v6
    v_mov_b32 v17, v12
    s_mov_b32 s42, 0
    s_mov_b32 s43, 0
    s_mov_b32 s48, 57344
    v_add_u32 v18, 57344, v13
    v_add_u32 v19, 57344, v14
    ds_read_b128 v[136:139], v17 offset:0
    ds_read_b128 v[140:143], v17 offset:2048
    ds_read_b128 v[144:147], v17 offset:4096
    ds_read_b128 v[148:151], v17 offset:6144
    ds_read_b64_tr_b16 v[152:153], v18 offset:0
    ds_read_b64_tr_b16 v[154:155], v18 offset:7168
    ds_read_b64_tr_b16 v[156:157], v19 offset:32
    ds_read_b64_tr_b16 v[158:159], v19 offset:7200
    ds_read_b64_tr_b16 v[160:161], v18 offset:64
    ds_read_b64_tr_b16 v[162:163], v18 offset:7232
    ds_read_b64_tr_b16 v[164:165], v19 offset:96
    ds_read_b64_tr_b16 v[166:167], v19 offset:7264
    ds_read_b64_tr_b16 v[168:169], v18 offset:128
    ds_read_b64_tr_b16 v[170:171], v18 offset:7296
    ds_read_b64_tr_b16 v[172:173], v19 offset:160
    ds_read_b64_tr_b16 v[174:175], v19 offset:7328
    ds_read_b64_tr_b16 v[176:177], v18 offset:192
    ds_read_b64_tr_b16 v[178:179], v18 offset:7360
    s_waitcnt lgkmcnt(12)
    v_mfma_f32_16x16x32_bf16 v[24:27], v[152:155], v[136:139], 0
    ds_read_b128 v[180:183], v17 offset:1024
    s_add_u32 s42, s42, 16384
    v_mfma_f32_16x16x32_bf16 v[52:55], v[152:155], v[140:143], 0
    ds_read_b128 v[184:187], v17 offset:3072
    s_cmp_eq_u32 s42, 49152
    v_mfma_f32_16x16x32_bf16 v[80:83], v[152:155], v[144:147], 0
    ds_read_b128 v[188:191], v17 offset:5120
    s_cselect_b32 s42, 0, s42
    v_mfma_f32_16x16x32_bf16 v[108:111], v[152:155], v[148:151], 0
    ds_read_b128 v[192:195], v17 offset:7168
    s_waitcnt lgkmcnt(14)
    v_mfma_f32_16x16x32_bf16 v[112:115], v[156:159], v[148:151], 0
    ds_read_b64_tr_b16 v[196:197], v18 offset:14336
    s_add_u32 s48, s48, 28672
    v_mfma_f32_16x16x32_bf16 v[84:87], v[156:159], v[144:147], 0
    ds_read_b64_tr_b16 v[198:199], v18 offset:21504
    s_cmp_eq_u32 s48, 86016
    v_mfma_f32_16x16x32_bf16 v[56:59], v[156:159], v[140:143], 0
    ds_read_b64_tr_b16 v[200:201], v19 offset:14368
    s_cselect_b32 s48, 0, s48
    v_mfma_f32_16x16x32_bf16 v[28:31], v[156:159], v[136:139], 0
    ds_read_b64_tr_b16 v[202:203], v19 offset:21536
    s_waitcnt lgkmcnt(8)
    v_mfma_f32_16x16x32_bf16 v[32:35], v[160:163], v[136:139], 0
    ds_read_b64_tr_b16 v[204:205], v18 offset:14400
    v_add_u32 v17, s42, v12
    v_mfma_f32_16x16x32_bf16 v[60:63], v[160:163], v[140:143], 0
    ds_read_b64_tr_b16 v[206:207], v18 offset:21568
    v_mfma_f32_16x16x32_bf16 v[88:91], v[160:163], v[144:147], 0
    ds_read_b64_tr_b16 v[208:209], v19 offset:14432
    v_mfma_f32_16x16x32_bf16 v[116:119], v[160:163], v[148:151], 0
    ds_read_b64_tr_b16 v[210:211], v19 offset:21600
    v_mfma_f32_16x16x32_bf16 v[120:123], v[164:167], v[148:151], 0
    ds_read_b64_tr_b16 v[212:213], v18 offset:14464
    v_mfma_f32_16x16x32_bf16 v[92:95], v[164:167], v[144:147], 0
    ds_read_b64_tr_b16 v[214:215], v18 offset:21632
    v_mfma_f32_16x16x32_bf16 v[64:67], v[164:167], v[140:143], 0
    ds_read_b64_tr_b16 v[216:217], v19 offset:14496
    v_mfma_f32_16x16x32_bf16 v[36:39], v[164:167], v[136:139], 0
    ds_read_b64_tr_b16 v[218:219], v19 offset:21664
    v_add_u32 v19, s48, v14
    v_mfma_f32_16x16x32_bf16 v[40:43], v[168:171], v[136:139], 0
    ds_read_b64_tr_b16 v[220:221], v18 offset:14528
    v_mfma_f32_16x16x32_bf16 v[68:71], v[168:171], v[140:143], 0
    ds_read_b64_tr_b16 v[222:223], v18 offset:21696
    v_add_u32 v18, s48, v13
    v_mfma_f32_16x16x32_bf16 v[96:99], v[168:171], v[144:147], 0
    v_mfma_f32_16x16x32_bf16 v[124:127], v[168:171], v[148:151], 0
    v_mfma_f32_16x16x32_bf16 v[128:131], v[172:175], v[148:151], 0
    v_mfma_f32_16x16x32_bf16 v[100:103], v[172:175], v[144:147], 0
    v_mfma_f32_16x16x32_bf16 v[72:75], v[172:175], v[140:143], 0
    v_mfma_f32_16x16x32_bf16 v[44:47], v[172:175], v[136:139], 0
    v_mfma_f32_16x16x32_bf16 v[48:51], v[176:179], v[136:139], 0
    v_mfma_f32_16x16x32_bf16 v[76:79], v[176:179], v[140:143], 0
    v_mfma_f32_16x16x32_bf16 v[104:107], v[176:179], v[144:147], 0
    v_mfma_f32_16x16x32_bf16 v[132:135], v[176:179], v[148:151], 0
    s_waitcnt lgkmcnt(12)
    v_mfma_f32_16x16x32_bf16 v[24:27], v[196:199], v[180:183], v[24:27]
    s_add_u32 s43, s43, 1
    s_mul_i32 s36, s35, 448
    s_add_u32 s36, s36, 159744
    v_lshlrev_b32 v6, 4, v23
    v_mfma_f32_16x16x32_bf16 v[52:55], v[196:199], v[184:187], v[52:55]
    v_add_u32 v6, s36, v6
    s_lshl_b32 s36, s37, 8
    s_add_u32 s36, s36, 160768
    v_lshlrev_b32 v7, 4, v22
    v_mfma_f32_16x16x32_bf16 v[80:83], v[196:199], v[188:191], v[80:83]
    v_add_u32 v7, s36, v7
    s_add_u32 s16, s62, 0x400000
    s_addc_u32 s17, s63, 0
    s_mov_b32 s18, 0x1be000
    v_mfma_f32_16x16x32_bf16 v[108:111], v[196:199], v[192:195], v[108:111]
    s_mov_b32 s19, 0x20000
    s_mul_i32 s39, s37, 229376
    s_lshr_b32 s36, s38, 1
    s_waitcnt lgkmcnt(0)
    v_mfma_f32_16x16x32_bf16 v[112:115], v[200:203], v[192:195], v[112:115]
    s_add_u32 s36, s36, 0
    s_lshr_b32 s53, s36, 3
    s_lshl_b32 s53, s53, 14
    s_and_b32 s44, s36, 7
    v_mfma_f32_16x16x32_bf16 v[84:87], v[200:203], v[188:191], v[84:87]
    s_lshl_b32 s44, s44, 10
    s_add_u32 s44, s44, s53
    s_add_u32 s44, s44, s39
    s_lshr_b32 s36, s38, 1
    v_mfma_f32_16x16x32_bf16 v[56:59], v[200:203], v[184:187], v[56:59]
    s_add_u32 s36, s36, 1
    s_lshr_b32 s53, s36, 3
    s_lshl_b32 s53, s53, 14
    s_and_b32 s45, s36, 7
    v_mfma_f32_16x16x32_bf16 v[28:31], v[200:203], v[180:183], v[28:31]
    s_lshl_b32 s45, s45, 10
    s_add_u32 s45, s45, s53
    s_add_u32 s45, s45, s39
    s_lshr_b32 s36, s38, 1
    v_mfma_f32_16x16x32_bf16 v[32:35], v[204:207], v[180:183], v[32:35]
    s_add_u32 s36, s36, 2
    s_lshr_b32 s53, s36, 3
    s_lshl_b32 s53, s53, 14
    s_and_b32 s46, s36, 7
    v_mfma_f32_16x16x32_bf16 v[60:63], v[204:207], v[184:187], v[60:63]
    s_lshl_b32 s46, s46, 10
    s_add_u32 s46, s46, s53
    s_add_u32 s46, s46, s39
    s_lshr_b32 s36, s38, 1
    v_mfma_f32_16x16x32_bf16 v[88:91], v[204:207], v[188:191], v[88:91]
    s_add_u32 s36, s36, 3
    s_lshr_b32 s53, s36, 3
    s_lshl_b32 s53, s53, 14
    s_and_b32 s47, s36, 7
    v_mfma_f32_16x16x32_bf16 v[116:119], v[204:207], v[192:195], v[116:119]
    s_lshl_b32 s47, s47, 10
    s_add_u32 s47, s47, s53
    s_add_u32 s47, s47, s39
    v_lshrrev_b32 v226, 2, v1
    v_mfma_f32_16x16x32_bf16 v[120:123], v[208:211], v[192:195], v[120:123]
    v_mul_u32_u24 v240, 256, v226
    v_and_b32 v227, 3, v1
    v_lshl_add_u32 v240, v227, 3, v240
    v_add_u32 v240, 49152, v240
    v_mfma_f32_16x16x32_bf16 v[92:95], v[208:211], v[188:191], v[92:95]
    v_and_b32 v226, 7, v226
    s_mul_i32 s36, s35, 4
    s_add_u32 s36, s36, 3
    v_xor_b32 v227, s36, v226
    v_mfma_f32_16x16x32_bf16 v[64:67], v[208:211], v[184:187], v[64:67]
    v_lshl_add_u32 v243, v227, 5, v240
    s_mul_i32 s36, s35, 4
    s_add_u32 s36, s36, 2
    v_xor_b32 v227, s36, v226
    v_mfma_f32_16x16x32_bf16 v[36:39], v[208:211], v[180:183], v[36:39]
    v_lshl_add_u32 v242, v227, 5, v240
    s_mul_i32 s36, s35, 4
    s_add_u32 s36, s36, 1
    v_xor_b32 v227, s36, v226
    v_mfma_f32_16x16x32_bf16 v[40:43], v[212:215], v[180:183], v[40:43]
    v_lshl_add_u32 v241, v227, 5, v240
    s_mul_i32 s36, s35, 4
    s_add_u32 s36, s36, 0
    v_xor_b32 v227, s36, v226
    v_mfma_f32_16x16x32_bf16 v[68:71], v[212:215], v[184:187], v[68:71]
    v_lshl_add_u32 v240, v227, 5, v240
    s_lshl_b32 s38, s33, 3
    s_lshl_b32 s36, s35, 2
    s_add_u32 s38, s38, s36
    v_mfma_f32_16x16x32_bf16 v[96:99], v[212:215], v[188:191], v[96:99]
    s_lshr_b32 s36, s38, 1
    s_lshr_b32 s53, s36, 3
    s_lshl_b32 s53, s53, 14
    s_and_b32 s39, s36, 7
    v_mfma_f32_16x16x32_bf16 v[124:127], v[212:215], v[192:195], v[124:127]
    s_lshl_b32 s39, s39, 10
    s_add_u32 s39, s39, s53
    s_lshl_b32 s36, s37, 16
    s_add_u32 s39, s39, s36
    v_mfma_f32_16x16x32_bf16 v[128:131], v[216:219], v[192:195], v[128:131]
    s_lshl_b32 s40, s31, 17
    s_add_u32 s40, s40, s39
    s_xor_b32 s41, s31, 1
    s_lshl_b32 s41, s41, 17
    v_mfma_f32_16x16x32_bf16 v[100:103], v[216:219], v[188:191], v[100:103]
    s_add_u32 s41, s41, s39
    s_mov_b32 s84, s62
    s_mov_b32 s85, s63
    s_mov_b32 s86, 0x7e000
    v_mfma_f32_16x16x32_bf16 v[72:75], v[216:219], v[184:187], v[72:75]
    s_mov_b32 s87, 0x20000
    s_add_u32 s88, s62, 0x80000
    s_addc_u32 s89, s63, 0
    s_mov_b32 s90, 0x7e000
    v_mfma_f32_16x16x32_bf16 v[44:47], v[216:219], v[180:183], v[44:47]
    s_mov_b32 s91, 0x20000
    s_add_u32 s80, s4, 0x1c00000
    s_addc_u32 s81, s5, 0
    s_mov_b32 s82, 0x400000
    v_mfma_f32_16x16x32_bf16 v[48:51], v[220:223], v[180:183], v[48:51]
    s_mov_b32 s83, 0x20000
    s_lshl_b32 s36, s37, 1
    s_add_u32 s36, s36, s35
    s_lshl_b32 s36, s36, 10
    v_mfma_f32_16x16x32_bf16 v[76:79], v[220:223], v[184:187], v[76:79]
    v_add_u32 v244, s36, v2
    v_mov_b32 v245, 1
    v_mov_b32 v246, 162880
    v_lshrrev_b32 v238, 1, v23
    v_mfma_f32_16x16x32_bf16 v[104:107], v[220:223], v[188:191], v[104:107]
    v_lshlrev_b32 v238, 8, v238
    v_lshl_add_u32 v238, v22, 4, v238
    v_and_b32 v224, 1, v23
    v_lshl_add_u32 v238, v224, 3, v238
    v_mfma_f32_16x16x32_bf16 v[132:135], v[220:223], v[192:195], v[132:135]
    s_add_u32 s53, s55, 1408
    v_mov_b32 v8, 1
    v_mov_b32 v9, 162864
    v_mov_b32 v11, 0
    s_mov_b64 exec, 1
    s_waitcnt vmcnt(0)
    ds_add_rtn_u32 v10, v9, v8
    s_waitcnt lgkmcnt(0)
    v_readfirstlane_b32 s54, v10
    s_nop 0
    s_and_b32 s54, s54, 3
    s_cmp_lg_u32 s54, 3
    s_cbranch_scc1 pub_22
    buffer_atomic_add v8, v11, s[56:59], s53 offen sc1
pub_22:
    s_mov_b64 exec, -1
    s_barrier
    ds_read_b128 v[136:139], v17 offset:0
    ds_read_b128 v[140:143], v17 offset:2048
    ds_read_b128 v[144:147], v17 offset:4096
    ds_read_b128 v[148:151], v17 offset:6144
    ds_read_b64_tr_b16 v[152:153], v18 offset:0
    ds_read_b64_tr_b16 v[154:155], v18 offset:7168
    ds_read_b64_tr_b16 v[156:157], v19 offset:32
    ds_read_b64_tr_b16 v[158:159], v19 offset:7200
    ds_read_b64_tr_b16 v[160:161], v18 offset:64
    ds_read_b64_tr_b16 v[162:163], v18 offset:7232
    ds_read_b64_tr_b16 v[164:165], v19 offset:96
    ds_read_b64_tr_b16 v[166:167], v19 offset:7264
    ds_read_b64_tr_b16 v[168:169], v18 offset:128
    ds_read_b64_tr_b16 v[170:171], v18 offset:7296
    ds_read_b64_tr_b16 v[172:173], v19 offset:160
    ds_read_b64_tr_b16 v[174:175], v19 offset:7328
    ds_read_b64_tr_b16 v[176:177], v18 offset:192
    ds_read_b64_tr_b16 v[178:179], v18 offset:7360
    s_waitcnt lgkmcnt(12)
mm_23:
    v_mfma_f32_16x16x32_bf16 v[24:27], v[152:155], v[136:139], v[24:27]
    ds_read_b128 v[180:183], v17 offset:1024
    s_add_u32 s42, s42, 16384
    v_mfma_f32_16x16x32_bf16 v[52:55], v[152:155], v[140:143], v[52:55]
    ds_read_b128 v[184:187], v17 offset:3072
    s_cmp_eq_u32 s42, 49152
    v_mfma_f32_16x16x32_bf16 v[80:83], v[152:155], v[144:147], v[80:83]
    ds_read_b128 v[188:191], v17 offset:5120
    s_cselect_b32 s42, 0, s42
    v_mfma_f32_16x16x32_bf16 v[108:111], v[152:155], v[148:151], v[108:111]
    ds_read_b128 v[192:195], v17 offset:7168
    s_waitcnt lgkmcnt(14)
    v_mfma_f32_16x16x32_bf16 v[112:115], v[156:159], v[148:151], v[112:115]
    ds_read_b64_tr_b16 v[196:197], v18 offset:14336
    s_add_u32 s48, s48, 28672
    v_mfma_f32_16x16x32_bf16 v[84:87], v[156:159], v[144:147], v[84:87]
    ds_read_b64_tr_b16 v[198:199], v18 offset:21504
    s_cmp_eq_u32 s48, 86016
    v_mfma_f32_16x16x32_bf16 v[56:59], v[156:159], v[140:143], v[56:59]
    ds_read_b64_tr_b16 v[200:201], v19 offset:14368
    s_cselect_b32 s48, 0, s48
    v_mfma_f32_16x16x32_bf16 v[28:31], v[156:159], v[136:139], v[28:31]
    ds_read_b64_tr_b16 v[202:203], v19 offset:21536
    s_waitcnt lgkmcnt(8)
    v_mfma_f32_16x16x32_bf16 v[32:35], v[160:163], v[136:139], v[32:35]
    ds_read_b64_tr_b16 v[204:205], v18 offset:14400
    v_add_u32 v17, s42, v12
    v_mfma_f32_16x16x32_bf16 v[60:63], v[160:163], v[140:143], v[60:63]
    ds_read_b64_tr_b16 v[206:207], v18 offset:21568
    v_mfma_f32_16x16x32_bf16 v[88:91], v[160:163], v[144:147], v[88:91]
    ds_read_b64_tr_b16 v[208:209], v19 offset:14432
    v_mfma_f32_16x16x32_bf16 v[116:119], v[160:163], v[148:151], v[116:119]
    ds_read_b64_tr_b16 v[210:211], v19 offset:21600
    v_mfma_f32_16x16x32_bf16 v[120:123], v[164:167], v[148:151], v[120:123]
    ds_read_b64_tr_b16 v[212:213], v18 offset:14464
    v_mfma_f32_16x16x32_bf16 v[92:95], v[164:167], v[144:147], v[92:95]
    ds_read_b64_tr_b16 v[214:215], v18 offset:21632
    v_mfma_f32_16x16x32_bf16 v[64:67], v[164:167], v[140:143], v[64:67]
    ds_read_b64_tr_b16 v[216:217], v19 offset:14496
    v_mfma_f32_16x16x32_bf16 v[36:39], v[164:167], v[136:139], v[36:39]
    ds_read_b64_tr_b16 v[218:219], v19 offset:21664
    v_add_u32 v19, s48, v14
    v_mfma_f32_16x16x32_bf16 v[40:43], v[168:171], v[136:139], v[40:43]
    ds_read_b64_tr_b16 v[220:221], v18 offset:14528
    v_mfma_f32_16x16x32_bf16 v[68:71], v[168:171], v[140:143], v[68:71]
    ds_read_b64_tr_b16 v[222:223], v18 offset:21696
    v_add_u32 v18, s48, v13
    v_mfma_f32_16x16x32_bf16 v[96:99], v[168:171], v[144:147], v[96:99]
    v_mfma_f32_16x16x32_bf16 v[124:127], v[168:171], v[148:151], v[124:127]
    v_mfma_f32_16x16x32_bf16 v[128:131], v[172:175], v[148:151], v[128:131]
    v_mfma_f32_16x16x32_bf16 v[100:103], v[172:175], v[144:147], v[100:103]
    v_mfma_f32_16x16x32_bf16 v[72:75], v[172:175], v[140:143], v[72:75]
    v_mfma_f32_16x16x32_bf16 v[44:47], v[172:175], v[136:139], v[44:47]
    v_mfma_f32_16x16x32_bf16 v[48:51], v[176:179], v[136:139], v[48:51]
    v_mfma_f32_16x16x32_bf16 v[76:79], v[176:179], v[140:143], v[76:79]
    v_mfma_f32_16x16x32_bf16 v[104:107], v[176:179], v[144:147], v[104:107]
    v_mfma_f32_16x16x32_bf16 v[132:135], v[176:179], v[148:151], v[132:135]
    s_waitcnt lgkmcnt(12)
    v_mfma_f32_16x16x32_bf16 v[24:27], v[196:199], v[180:183], v[24:27]
    s_add_u32 s43, s43, 1
    s_cmp_lt_u32 s43, 15
    v_mfma_f32_16x16x32_bf16 v[52:55], v[196:199], v[184:187], v[52:55]
    v_mfma_f32_16x16x32_bf16 v[80:83], v[196:199], v[188:191], v[80:83]
    v_mfma_f32_16x16x32_bf16 v[108:111], v[196:199], v[192:195], v[108:111]
    s_waitcnt lgkmcnt(0)
    s_barrier
    v_mfma_f32_16x16x32_bf16 v[112:115], v[200:203], v[192:195], v[112:115]
    ds_read_b128 v[136:139], v17 offset:0
    v_mfma_f32_16x16x32_bf16 v[84:87], v[200:203], v[188:191], v[84:87]
    ds_read_b128 v[140:143], v17 offset:2048
    v_mfma_f32_16x16x32_bf16 v[56:59], v[200:203], v[184:187], v[56:59]
    ds_read_b128 v[144:147], v17 offset:4096
    v_mfma_f32_16x16x32_bf16 v[28:31], v[200:203], v[180:183], v[28:31]
    ds_read_b128 v[148:151], v17 offset:6144
    v_mfma_f32_16x16x32_bf16 v[32:35], v[204:207], v[180:183], v[32:35]
    ds_read_b64_tr_b16 v[152:153], v18 offset:0
    v_mfma_f32_16x16x32_bf16 v[60:63], v[204:207], v[184:187], v[60:63]
    ds_read_b64_tr_b16 v[154:155], v18 offset:7168
    v_mfma_f32_16x16x32_bf16 v[88:91], v[204:207], v[188:191], v[88:91]
    ds_read_b64_tr_b16 v[156:157], v19 offset:32
    v_mfma_f32_16x16x32_bf16 v[116:119], v[204:207], v[192:195], v[116:119]
    ds_read_b64_tr_b16 v[158:159], v19 offset:7200
    v_mfma_f32_16x16x32_bf16 v[120:123], v[208:211], v[192:195], v[120:123]
    ds_read_b64_tr_b16 v[160:161], v18 offset:64
    v_mfma_f32_16x16x32_bf16 v[92:95], v[208:211], v[188:191], v[92:95]
    ds_read_b64_tr_b16 v[162:163], v18 offset:7232
    v_mfma_f32_16x16x32_bf16 v[64:67], v[208:211], v[184:187], v[64:67]
    ds_read_b64_tr_b16 v[164:165], v19 offset:96
    v_mfma_f32_16x16x32_bf16 v[36:39], v[208:211], v[180:183], v[36:39]
    ds_read_b64_tr_b16 v[166:167], v19 offset:7264
    v_mfma_f32_16x16x32_bf16 v[40:43], v[212:215], v[180:183], v[40:43]
    ds_read_b64_tr_b16 v[168:169], v18 offset:128
    v_mfma_f32_16x16x32_bf16 v[68:71], v[212:215], v[184:187], v[68:71]
    ds_read_b64_tr_b16 v[170:171], v18 offset:7296
    v_mfma_f32_16x16x32_bf16 v[96:99], v[212:215], v[188:191], v[96:99]
    ds_read_b64_tr_b16 v[172:173], v19 offset:160
    v_mfma_f32_16x16x32_bf16 v[124:127], v[212:215], v[192:195], v[124:127]
    ds_read_b64_tr_b16 v[174:175], v19 offset:7328
    v_mfma_f32_16x16x32_bf16 v[128:131], v[216:219], v[192:195], v[128:131]
    ds_read_b64_tr_b16 v[176:177], v18 offset:192
    v_mfma_f32_16x16x32_bf16 v[100:103], v[216:219], v[188:191], v[100:103]
    ds_read_b64_tr_b16 v[178:179], v18 offset:7360
    v_mfma_f32_16x16x32_bf16 v[72:75], v[216:219], v[184:187], v[72:75]
    v_mfma_f32_16x16x32_bf16 v[44:47], v[216:219], v[180:183], v[44:47]
    v_mfma_f32_16x16x32_bf16 v[48:51], v[220:223], v[180:183], v[48:51]
    v_mfma_f32_16x16x32_bf16 v[76:79], v[220:223], v[184:187], v[76:79]
    v_mfma_f32_16x16x32_bf16 v[104:107], v[220:223], v[188:191], v[104:107]
    v_mfma_f32_16x16x32_bf16 v[132:135], v[220:223], v[192:195], v[132:135]
    s_waitcnt lgkmcnt(12)
    s_cbranch_scc1 mm_23
    v_mfma_f32_16x16x32_bf16 v[24:27], v[152:155], v[136:139], v[24:27]
    ds_read_b128 v[180:183], v17 offset:1024
    v_mfma_f32_16x16x32_bf16 v[52:55], v[152:155], v[140:143], v[52:55]
    ds_read_b128 v[184:187], v17 offset:3072
    v_mfma_f32_16x16x32_bf16 v[80:83], v[152:155], v[144:147], v[80:83]
    ds_read_b128 v[188:191], v17 offset:5120
    v_mfma_f32_16x16x32_bf16 v[108:111], v[152:155], v[148:151], v[108:111]
    ds_read_b128 v[192:195], v17 offset:7168
    s_waitcnt lgkmcnt(14)
    v_mfma_f32_16x16x32_bf16 v[112:115], v[156:159], v[148:151], v[112:115]
    ds_read_b64_tr_b16 v[196:197], v18 offset:14336
    v_mfma_f32_16x16x32_bf16 v[84:87], v[156:159], v[144:147], v[84:87]
    ds_read_b64_tr_b16 v[198:199], v18 offset:21504
    v_mfma_f32_16x16x32_bf16 v[56:59], v[156:159], v[140:143], v[56:59]
    ds_read_b64_tr_b16 v[200:201], v19 offset:14368
    v_mfma_f32_16x16x32_bf16 v[28:31], v[156:159], v[136:139], v[28:31]
    ds_read_b64_tr_b16 v[202:203], v19 offset:21536
    s_waitcnt lgkmcnt(8)
    v_mfma_f32_16x16x32_bf16 v[32:35], v[160:163], v[136:139], v[32:35]
    ds_read_b64_tr_b16 v[204:205], v18 offset:14400
    v_mfma_f32_16x16x32_bf16 v[60:63], v[160:163], v[140:143], v[60:63]
    ds_read_b64_tr_b16 v[206:207], v18 offset:21568
    v_mfma_f32_16x16x32_bf16 v[88:91], v[160:163], v[144:147], v[88:91]
    ds_read_b64_tr_b16 v[208:209], v19 offset:14432
    v_mfma_f32_16x16x32_bf16 v[116:119], v[160:163], v[148:151], v[116:119]
    ds_read_b64_tr_b16 v[210:211], v19 offset:21600
    v_mfma_f32_16x16x32_bf16 v[120:123], v[164:167], v[148:151], v[120:123]
    ds_read_b64_tr_b16 v[212:213], v18 offset:14464
    v_mfma_f32_16x16x32_bf16 v[92:95], v[164:167], v[144:147], v[92:95]
    ds_read_b64_tr_b16 v[214:215], v18 offset:21632
    v_mfma_f32_16x16x32_bf16 v[64:67], v[164:167], v[140:143], v[64:67]
    ds_read_b64_tr_b16 v[216:217], v19 offset:14496
    v_mfma_f32_16x16x32_bf16 v[36:39], v[164:167], v[136:139], v[36:39]
    ds_read_b64_tr_b16 v[218:219], v19 offset:21664
    v_mfma_f32_16x16x32_bf16 v[40:43], v[168:171], v[136:139], v[40:43]
    ds_read_b64_tr_b16 v[220:221], v18 offset:14528
    v_mfma_f32_16x16x32_bf16 v[68:71], v[168:171], v[140:143], v[68:71]
    ds_read_b64_tr_b16 v[222:223], v18 offset:21696
    v_mfma_f32_16x16x32_bf16 v[96:99], v[168:171], v[144:147], v[96:99]
    v_mfma_f32_16x16x32_bf16 v[124:127], v[168:171], v[148:151], v[124:127]
    v_mfma_f32_16x16x32_bf16 v[128:131], v[172:175], v[148:151], v[128:131]
    v_mfma_f32_16x16x32_bf16 v[100:103], v[172:175], v[144:147], v[100:103]
    v_mfma_f32_16x16x32_bf16 v[72:75], v[172:175], v[140:143], v[72:75]
    v_mfma_f32_16x16x32_bf16 v[44:47], v[172:175], v[136:139], v[44:47]
    v_mfma_f32_16x16x32_bf16 v[48:51], v[176:179], v[136:139], v[48:51]
    v_mfma_f32_16x16x32_bf16 v[76:79], v[176:179], v[140:143], v[76:79]
    v_mfma_f32_16x16x32_bf16 v[104:107], v[176:179], v[144:147], v[104:107]
    v_mfma_f32_16x16x32_bf16 v[132:135], v[176:179], v[148:151], v[132:135]
    s_waitcnt lgkmcnt(0)
    s_barrier
    v_mfma_f32_16x16x32_bf16 v[24:27], v[196:199], v[180:183], v[24:27]
    ds_read_b128 v[136:139], v6 offset:0
    v_mfma_f32_16x16x32_bf16 v[52:55], v[196:199], v[184:187], v[52:55]
    ds_read_b128 v[140:143], v6 offset:64
    v_mfma_f32_16x16x32_bf16 v[80:83], v[196:199], v[188:191], v[80:83]
    ds_read_b128 v[144:147], v6 offset:128
    v_mfma_f32_16x16x32_bf16 v[108:111], v[196:199], v[192:195], v[108:111]
    ds_read_b128 v[148:151], v6 offset:192
    v_mfma_f32_16x16x32_bf16 v[112:115], v[200:203], v[192:195], v[112:115]
    ds_read_b128 v[152:155], v6 offset:256
    v_mfma_f32_16x16x32_bf16 v[84:87], v[200:203], v[188:191], v[84:87]
    ds_read_b128 v[156:159], v6 offset:320
    v_mfma_f32_16x16x32_bf16 v[56:59], v[200:203], v[184:187], v[56:59]
    ds_read_b128 v[160:163], v6 offset:384
    v_mfma_f32_16x16x32_bf16 v[28:31], v[200:203], v[180:183], v[28:31]
    ds_read_b128 v[164:167], v7 offset:0
    v_mfma_f32_16x16x32_bf16 v[32:35], v[204:207], v[180:183], v[32:35]
    ds_read_b128 v[168:171], v7 offset:256
    v_mfma_f32_16x16x32_bf16 v[60:63], v[204:207], v[184:187], v[60:63]
    ds_read_b128 v[172:175], v7 offset:512
    v_mfma_f32_16x16x32_bf16 v[88:91], v[204:207], v[188:191], v[88:91]
    ds_read_b128 v[176:179], v7 offset:768
    v_mov_b32 v13, v240
    v_mfma_f32_16x16x32_bf16 v[116:119], v[204:207], v[192:195], v[116:119]
    v_add_u32 v18, 0, v240
    v_mov_b32 v14, v241
    v_mfma_f32_16x16x32_bf16 v[120:123], v[208:211], v[192:195], v[120:123]
    v_add_u32 v19, 0, v241
    v_mov_b32 v15, v242
    v_mfma_f32_16x16x32_bf16 v[92:95], v[208:211], v[188:191], v[92:95]
    v_add_u32 v20, 0, v242
    v_mov_b32 v16, v243
    v_mfma_f32_16x16x32_bf16 v[64:67], v[208:211], v[184:187], v[64:67]
    v_add_u32 v21, 0, v243
    s_mov_b32 s42, 0
    s_mov_b32 s43, 0
    v_mfma_f32_16x16x32_bf16 v[36:39], v[208:211], v[180:183], v[36:39]
    s_mov_b32 s48, 0
    v_mov_b32 v17, v12
    v_and_b32 v199, 7, v0
    v_mfma_f32_16x16x32_bf16 v[40:43], v[212:215], v[180:183], v[40:43]
    v_lshrrev_b32 v236, 6, v0
    v_lshlrev_b32 v236, 4, v236
    v_mfma_f32_16x16x32_bf16 v[68:71], v[212:215], v[184:187], v[68:71]
    v_bfe_u32 v237, v0, 3, 3
    v_add_u32 v236, v236, v237
    s_lshr_b32 s78, s29, 1
    v_mfma_f32_16x16x32_bf16 v[96:99], v[212:215], v[188:191], v[96:99]
    s_lshl_b32 s78, s78, 16
    s_and_b32 s79, s29, 1
    s_lshl_b32 s79, s79, 7
    v_mfma_f32_16x16x32_bf16 v[124:127], v[212:215], v[192:195], v[124:127]
    s_add_u32 s78, s78, s79
    s_lshr_b32 s79, s30, 1
    s_lshl_b32 s79, s79, 13
    v_mfma_f32_16x16x32_bf16 v[128:131], v[216:219], v[192:195], v[128:131]
    s_add_u32 s78, s78, s79
    v_lshlrev_b32 v196, 8, v236
    v_lshl_add_u32 v196, v199, 4, v196
    v_mfma_f32_16x16x32_bf16 v[100:103], v[216:219], v[188:191], v[100:103]
    v_add_u32 v196, s78, v196
    s_lshl_b32 s78, s28, 7
    s_lshl_b32 s79, s29, 3
    v_mfma_f32_16x16x32_bf16 v[72:75], v[216:219], v[184:187], v[72:75]
    s_add_u32 s78, s78, s79
    v_add_u32 v197, s78, v199
    v_lshlrev_b32 v198, 11, v197
    v_mfma_f32_16x16x32_bf16 v[44:47], v[216:219], v[180:183], v[44:47]
    v_lshrrev_b32 v237, 2, v236
    v_lshlrev_b32 v237, 3, v237
    v_mfma_f32_16x16x32_bf16 v[48:51], v[220:223], v[180:183], v[48:51]
    v_and_b32 v236, 3, v236
    v_add_u32 v236, v236, v237
    v_mfma_f32_16x16x32_bf16 v[76:79], v[220:223], v[184:187], v[76:79]
    v_lshl_add_u32 v198, v236, 3, v198
    v_lshlrev_b32 v197, 3, v197
    v_mfma_f32_16x16x32_bf16 v[104:107], v[220:223], v[188:191], v[104:107]
    v_lshl_add_u32 v197, v236, 14, v197
    v_mfma_f32_16x16x32_bf16 v[132:135], v[220:223], v[192:195], v[132:135]
    s_waitcnt lgkmcnt(0)
    s_cmp_eq_u32 s35, 1
    s_cbranch_scc1 G3_e1
    v_pk_fma_f32 v[24:25], v[164:165], v[136:137], v[24:25] op_sel_hi:[0,1,1] neg_lo:[1,0,0] neg_hi:[1,0,0]
    v_pk_fma_f32 v[26:27], v[164:165], v[138:139], v[26:27] op_sel_hi:[0,1,1] neg_lo:[1,0,0] neg_hi:[1,0,0]
    v_pk_mul_f32 v[226:227], v[24:25], v[24:25]
    v_pk_mul_f32 v[228:229], v[26:27], v[26:27]
    v_pk_fma_f32 v[226:227], v[226:227], v[166:167], v[166:167] op_sel:[0,1,0] op_sel_hi:[1,1,0]
    v_pk_fma_f32 v[228:229], v[228:229], v[166:167], v[166:167] op_sel:[0,1,0] op_sel_hi:[1,1,0]
    v_pk_mul_f32 v[226:227], v[226:227], v[24:25]
    v_pk_mul_f32 v[228:229], v[228:229], v[26:27]
    v_exp_f32 v226, v226
    v_exp_f32 v227, v227
    v_exp_f32 v228, v228
    v_exp_f32 v229, v229
    v_pk_fma_f32 v[226:227], v[226:227], v[164:165], v[164:165] op_sel:[0,1,1] op_sel_hi:[1,1,1]
    v_pk_fma_f32 v[228:229], v[228:229], v[164:165], v[164:165] op_sel:[0,1,1] op_sel_hi:[1,1,1]
    v_rcp_f32 v226, v226
    v_rcp_f32 v227, v227
    v_rcp_f32 v228, v228
    v_rcp_f32 v229, v229
    v_pk_mul_f32 v[24:25], v[24:25], v[226:227]
    v_pk_mul_f32 v[26:27], v[26:27], v[228:229]
    v_pk_fma_f32 v[28:29], v[164:165], v[140:141], v[28:29] op_sel_hi:[0,1,1] neg_lo:[1,0,0] neg_hi:[1,0,0]
    v_pk_fma_f32 v[30:31], v[164:165], v[142:143], v[30:31] op_sel_hi:[0,1,1] neg_lo:[1,0,0] neg_hi:[1,0,0]
    v_pk_mul_f32 v[226:227], v[28:29], v[28:29]
    v_pk_mul_f32 v[228:229], v[30:31], v[30:31]
    v_pk_fma_f32 v[226:227], v[226:227], v[166:167], v[166:167] op_sel:[0,1,0] op_sel_hi:[1,1,0]
    v_pk_fma_f32 v[228:229], v[228:229], v[166:167], v[166:167] op_sel:[0,1,0] op_sel_hi:[1,1,0]
    v_pk_mul_f32 v[226:227], v[226:227], v[28:29]
    v_pk_mul_f32 v[228:229], v[228:229], v[30:31]
    v_exp_f32 v226, v226
    v_exp_f32 v227, v227
    v_exp_f32 v228, v228
    v_exp_f32 v229, v229
    v_pk_fma_f32 v[226:227], v[226:227], v[164:165], v[164:165] op_sel:[0,1,1] op_sel_hi:[1,1,1]
    v_pk_fma_f32 v[228:229], v[228:229], v[164:165], v[164:165] op_sel:[0,1,1] op_sel_hi:[1,1,1]
    v_rcp_f32 v226, v226
    v_rcp_f32 v227, v227
    v_rcp_f32 v228, v228
    v_rcp_f32 v229, v229
    v_pk_mul_f32 v[28:29], v[28:29], v[226:227]
    v_pk_mul_f32 v[30:31], v[30:31], v[228:229]
    v_cvt_pk_bf16_f32 v24, v24, v25
    v_cvt_pk_bf16_f32 v25, v26, v27
    v_cvt_pk_bf16_f32 v26, v28, v29
    v_cvt_pk_bf16_f32 v27, v30, v31
    v_or_b32 v24, 1, v24
    ds_write_b128 v244, v[24:27] offset:0
    s_add_u32 s36, s44, 0
    buffer_store_dwordx4 v[24:27], v2, s[16:19], s36 offen sc1
    v_pk_fma_f32 v[52:53], v[168:169], v[136:137], v[52:53] op_sel_hi:[0,1,1] neg_lo:[1,0,0] neg_hi:[1,0,0]
    v_pk_fma_f32 v[54:55], v[168:169], v[138:139], v[54:55] op_sel_hi:[0,1,1] neg_lo:[1,0,0] neg_hi:[1,0,0]
    v_pk_mul_f32 v[226:227], v[52:53], v[52:53]
    v_pk_mul_f32 v[228:229], v[54:55], v[54:55]
    v_pk_fma_f32 v[226:227], v[226:227], v[170:171], v[170:171] op_sel:[0,1,0] op_sel_hi:[1,1,0]
    v_pk_fma_f32 v[228:229], v[228:229], v[170:171], v[170:171] op_sel:[0,1,0] op_sel_hi:[1,1,0]
    v_pk_mul_f32 v[226:227], v[226:227], v[52:53]
    v_pk_mul_f32 v[228:229], v[228:229], v[54:55]
    v_exp_f32 v226, v226
    v_exp_f32 v227, v227
    v_exp_f32 v228, v228
    v_exp_f32 v229, v229
    v_pk_fma_f32 v[226:227], v[226:227], v[168:169], v[168:169] op_sel:[0,1,1] op_sel_hi:[1,1,1]
    v_pk_fma_f32 v[228:229], v[228:229], v[168:169], v[168:169] op_sel:[0,1,1] op_sel_hi:[1,1,1]
    v_rcp_f32 v226, v226
    v_rcp_f32 v227, v227
    v_rcp_f32 v228, v228
    v_rcp_f32 v229, v229
    v_pk_mul_f32 v[52:53], v[52:53], v[226:227]
    v_pk_mul_f32 v[54:55], v[54:55], v[228:229]
    v_pk_fma_f32 v[56:57], v[168:169], v[140:141], v[56:57] op_sel_hi:[0,1,1] neg_lo:[1,0,0] neg_hi:[1,0,0]
    v_pk_fma_f32 v[58:59], v[168:169], v[142:143], v[58:59] op_sel_hi:[0,1,1] neg_lo:[1,0,0] neg_hi:[1,0,0]
    v_pk_mul_f32 v[226:227], v[56:57], v[56:57]
    v_pk_mul_f32 v[228:229], v[58:59], v[58:59]
    v_pk_fma_f32 v[226:227], v[226:227], v[170:171], v[170:171] op_sel:[0,1,0] op_sel_hi:[1,1,0]
    v_pk_fma_f32 v[228:229], v[228:229], v[170:171], v[170:171] op_sel:[0,1,0] op_sel_hi:[1,1,0]
    v_pk_mul_f32 v[226:227], v[226:227], v[56:57]
    v_pk_mul_f32 v[228:229], v[228:229], v[58:59]
    v_exp_f32 v226, v226
    v_exp_f32 v227, v227
    v_exp_f32 v228, v228
    v_exp_f32 v229, v229
    v_pk_fma_f32 v[226:227], v[226:227], v[168:169], v[168:169] op_sel:[0,1,1] op_sel_hi:[1,1,1]
    v_pk_fma_f32 v[228:229], v[228:229], v[168:169], v[168:169] op_sel:[0,1,1] op_sel_hi:[1,1,1]
    v_rcp_f32 v226, v226
    v_rcp_f32 v227, v227
    v_rcp_f32 v228, v228
    v_rcp_f32 v229, v229
    v_pk_mul_f32 v[56:57], v[56:57], v[226:227]
    v_pk_mul_f32 v[58:59], v[58:59], v[228:229]
    v_cvt_pk_bf16_f32 v52, v52, v53
    v_cvt_pk_bf16_f32 v53, v54, v55
    v_cvt_pk_bf16_f32 v54, v56, v57
    v_cvt_pk_bf16_f32 v55, v58, v59
    v_or_b32 v52, 1, v52
    ds_write_b128 v244, v[52:55] offset:2048
    s_add_u32 s36, s44, 229376
    buffer_store_dwordx4 v[52:55], v2, s[16:19], s36 offen sc1
    v_pk_fma_f32 v[80:81], v[172:173], v[136:137], v[80:81] op_sel_hi:[0,1,1] neg_lo:[1,0,0] neg_hi:[1,0,0]
    v_pk_fma_f32 v[82:83], v[172:173], v[138:139], v[82:83] op_sel_hi:[0,1,1] neg_lo:[1,0,0] neg_hi:[1,0,0]
    v_pk_mul_f32 v[226:227], v[80:81], v[80:81]
    v_pk_mul_f32 v[228:229], v[82:83], v[82:83]
    v_pk_fma_f32 v[226:227], v[226:227], v[174:175], v[174:175] op_sel:[0,1,0] op_sel_hi:[1,1,0]
    v_pk_fma_f32 v[228:229], v[228:229], v[174:175], v[174:175] op_sel:[0,1,0] op_sel_hi:[1,1,0]
    v_pk_mul_f32 v[226:227], v[226:227], v[80:81]
    v_pk_mul_f32 v[228:229], v[228:229], v[82:83]
    v_exp_f32 v226, v226
    v_exp_f32 v227, v227
    v_exp_f32 v228, v228
    v_exp_f32 v229, v229
    v_pk_fma_f32 v[226:227], v[226:227], v[172:173], v[172:173] op_sel:[0,1,1] op_sel_hi:[1,1,1]
    v_pk_fma_f32 v[228:229], v[228:229], v[172:173], v[172:173] op_sel:[0,1,1] op_sel_hi:[1,1,1]
    v_rcp_f32 v226, v226
    v_rcp_f32 v227, v227
    v_rcp_f32 v228, v228
    v_rcp_f32 v229, v229
    v_pk_mul_f32 v[80:81], v[80:81], v[226:227]
    v_pk_mul_f32 v[82:83], v[82:83], v[228:229]
    v_pk_fma_f32 v[84:85], v[172:173], v[140:141], v[84:85] op_sel_hi:[0,1,1] neg_lo:[1,0,0] neg_hi:[1,0,0]
    v_pk_fma_f32 v[86:87], v[172:173], v[142:143], v[86:87] op_sel_hi:[0,1,1] neg_lo:[1,0,0] neg_hi:[1,0,0]
    v_pk_mul_f32 v[226:227], v[84:85], v[84:85]
    v_pk_mul_f32 v[228:229], v[86:87], v[86:87]
    v_pk_fma_f32 v[226:227], v[226:227], v[174:175], v[174:175] op_sel:[0,1,0] op_sel_hi:[1,1,0]
    v_pk_fma_f32 v[228:229], v[228:229], v[174:175], v[174:175] op_sel:[0,1,0] op_sel_hi:[1,1,0]
    v_pk_mul_f32 v[226:227], v[226:227], v[84:85]
    v_pk_mul_f32 v[228:229], v[228:229], v[86:87]
    v_exp_f32 v226, v226
    v_exp_f32 v227, v227
    v_exp_f32 v228, v228
    v_exp_f32 v229, v229
    v_pk_fma_f32 v[226:227], v[226:227], v[172:173], v[172:173] op_sel:[0,1,1] op_sel_hi:[1,1,1]
    v_pk_fma_f32 v[228:229], v[228:229], v[172:173], v[172:173] op_sel:[0,1,1] op_sel_hi:[1,1,1]
    v_rcp_f32 v226, v226
    v_rcp_f32 v227, v227
    v_rcp_f32 v228, v228
    v_rcp_f32 v229, v229
    v_pk_mul_f32 v[84:85], v[84:85], v[226:227]
    v_pk_mul_f32 v[86:87], v[86:87], v[228:229]
    v_cvt_pk_bf16_f32 v80, v80, v81
    v_cvt_pk_bf16_f32 v81, v82, v83
    v_cvt_pk_bf16_f32 v82, v84, v85
    v_cvt_pk_bf16_f32 v83, v86, v87
    v_or_b32 v80, 1, v80
    ds_write_b128 v244, v[80:83] offset:4096
    s_add_u32 s36, s44, 458752
    buffer_store_dwordx4 v[80:83], v2, s[16:19], s36 offen sc1
    v_pk_fma_f32 v[108:109], v[176:177], v[136:137], v[108:109] op_sel_hi:[0,1,1] neg_lo:[1,0,0] neg_hi:[1,0,0]
    v_pk_fma_f32 v[110:111], v[176:177], v[138:139], v[110:111] op_sel_hi:[0,1,1] neg_lo:[1,0,0] neg_hi:[1,0,0]
    v_pk_mul_f32 v[226:227], v[108:109], v[108:109]
    v_pk_mul_f32 v[228:229], v[110:111], v[110:111]
    v_pk_fma_f32 v[226:227], v[226:227], v[178:179], v[178:179] op_sel:[0,1,0] op_sel_hi:[1,1,0]
    v_pk_fma_f32 v[228:229], v[228:229], v[178:179], v[178:179] op_sel:[0,1,0] op_sel_hi:[1,1,0]
    v_pk_mul_f32 v[226:227], v[226:227], v[108:109]
    v_pk_mul_f32 v[228:229], v[228:229], v[110:111]
    v_exp_f32 v226, v226
    v_exp_f32 v227, v227
    v_exp_f32 v228, v228
    v_exp_f32 v229, v229
    v_pk_fma_f32 v[226:227], v[226:227], v[176:177], v[176:177] op_sel:[0,1,1] op_sel_hi:[1,1,1]
    v_pk_fma_f32 v[228:229], v[228:229], v[176:177], v[176:177] op_sel:[0,1,1] op_sel_hi:[1,1,1]
    v_rcp_f32 v226, v226
    v_rcp_f32 v227, v227
    v_rcp_f32 v228, v228
    v_rcp_f32 v229, v229
    v_pk_mul_f32 v[108:109], v[108:109], v[226:227]
    v_pk_mul_f32 v[110:111], v[110:111], v[228:229]
    v_pk_fma_f32 v[112:113], v[176:177], v[140:141], v[112:113] op_sel_hi:[0,1,1] neg_lo:[1,0,0] neg_hi:[1,0,0]
    v_pk_fma_f32 v[114:115], v[176:177], v[142:143], v[114:115] op_sel_hi:[0,1,1] neg_lo:[1,0,0] neg_hi:[1,0,0]
    v_pk_mul_f32 v[226:227], v[112:113], v[112:113]
    v_pk_mul_f32 v[228:229], v[114:115], v[114:115]
    v_pk_fma_f32 v[226:227], v[226:227], v[178:179], v[178:179] op_sel:[0,1,0] op_sel_hi:[1,1,0]
    v_pk_fma_f32 v[228:229], v[228:229], v[178:179], v[178:179] op_sel:[0,1,0] op_sel_hi:[1,1,0]
    v_pk_mul_f32 v[226:227], v[226:227], v[112:113]
    v_pk_mul_f32 v[228:229], v[228:229], v[114:115]
    v_exp_f32 v226, v226
    v_exp_f32 v227, v227
    v_exp_f32 v228, v228
    v_exp_f32 v229, v229
    v_pk_fma_f32 v[226:227], v[226:227], v[176:177], v[176:177] op_sel:[0,1,1] op_sel_hi:[1,1,1]
    v_pk_fma_f32 v[228:229], v[228:229], v[176:177], v[176:177] op_sel:[0,1,1] op_sel_hi:[1,1,1]
    v_rcp_f32 v226, v226
    v_rcp_f32 v227, v227
    v_rcp_f32 v228, v228
    v_rcp_f32 v229, v229
    v_pk_mul_f32 v[112:113], v[112:113], v[226:227]
    v_pk_mul_f32 v[114:115], v[114:115], v[228:229]
    v_cvt_pk_bf16_f32 v108, v108, v109
    v_cvt_pk_bf16_f32 v109, v110, v111
    v_cvt_pk_bf16_f32 v110, v112, v113
    v_cvt_pk_bf16_f32 v111, v114, v115
    ds_write_b128 v244, v[108:111] offset:6144
    s_add_u32 s36, s44, 688128
    buffer_store_dwordx4 v[108:111], v2, s[16:19], s36 offen sc1
    v_pk_fma_f32 v[32:33], v[164:165], v[144:145], v[32:33] op_sel_hi:[0,1,1] neg_lo:[1,0,0] neg_hi:[1,0,0]
    v_pk_fma_f32 v[34:35], v[164:165], v[146:147], v[34:35] op_sel_hi:[0,1,1] neg_lo:[1,0,0] neg_hi:[1,0,0]
    v_pk_mul_f32 v[226:227], v[32:33], v[32:33]
    v_pk_mul_f32 v[228:229], v[34:35], v[34:35]
    v_pk_fma_f32 v[226:227], v[226:227], v[166:167], v[166:167] op_sel:[0,1,0] op_sel_hi:[1,1,0]
    v_pk_fma_f32 v[228:229], v[228:229], v[166:167], v[166:167] op_sel:[0,1,0] op_sel_hi:[1,1,0]
    v_pk_mul_f32 v[226:227], v[226:227], v[32:33]
    v_pk_mul_f32 v[228:229], v[228:229], v[34:35]
    v_exp_f32 v226, v226
    v_exp_f32 v227, v227
    v_exp_f32 v228, v228
    v_exp_f32 v229, v229
    v_pk_fma_f32 v[226:227], v[226:227], v[164:165], v[164:165] op_sel:[0,1,1] op_sel_hi:[1,1,1]
    v_pk_fma_f32 v[228:229], v[228:229], v[164:165], v[164:165] op_sel:[0,1,1] op_sel_hi:[1,1,1]
    v_rcp_f32 v226, v226
    v_rcp_f32 v227, v227
    v_rcp_f32 v228, v228
    v_rcp_f32 v229, v229
    v_pk_mul_f32 v[32:33], v[32:33], v[226:227]
    v_pk_mul_f32 v[34:35], v[34:35], v[228:229]
    v_pk_fma_f32 v[36:37], v[164:165], v[148:149], v[36:37] op_sel_hi:[0,1,1] neg_lo:[1,0,0] neg_hi:[1,0,0]
    v_pk_fma_f32 v[38:39], v[164:165], v[150:151], v[38:39] op_sel_hi:[0,1,1] neg_lo:[1,0,0] neg_hi:[1,0,0]
    v_pk_mul_f32 v[226:227], v[36:37], v[36:37]
    v_pk_mul_f32 v[228:229], v[38:39], v[38:39]
    v_pk_fma_f32 v[226:227], v[226:227], v[166:167], v[166:167] op_sel:[0,1,0] op_sel_hi:[1,1,0]
    v_pk_fma_f32 v[228:229], v[228:229], v[166:167], v[166:167] op_sel:[0,1,0] op_sel_hi:[1,1,0]
    v_pk_mul_f32 v[226:227], v[226:227], v[36:37]
    v_pk_mul_f32 v[228:229], v[228:229], v[38:39]
    v_exp_f32 v226, v226
    v_exp_f32 v227, v227
    v_exp_f32 v228, v228
    v_exp_f32 v229, v229
    v_pk_fma_f32 v[226:227], v[226:227], v[164:165], v[164:165] op_sel:[0,1,1] op_sel_hi:[1,1,1]
    v_pk_fma_f32 v[228:229], v[228:229], v[164:165], v[164:165] op_sel:[0,1,1] op_sel_hi:[1,1,1]
    v_rcp_f32 v226, v226
    v_rcp_f32 v227, v227
    v_rcp_f32 v228, v228
    v_rcp_f32 v229, v229
    v_pk_mul_f32 v[36:37], v[36:37], v[226:227]
    v_pk_mul_f32 v[38:39], v[38:39], v[228:229]
    v_cvt_pk_bf16_f32 v32, v32, v33
    v_cvt_pk_bf16_f32 v33, v34, v35
    v_cvt_pk_bf16_f32 v34, v36, v37
    v_cvt_pk_bf16_f32 v35, v38, v39
    v_or_b32 v32, 1, v32
    ds_write_b128 v244, v[32:35] offset:16384
    v_pk_fma_f32 v[60:61], v[168:169], v[144:145], v[60:61] op_sel_hi:[0,1,1] neg_lo:[1,0,0] neg_hi:[1,0,0]
    v_pk_fma_f32 v[62:63], v[168:169], v[146:147], v[62:63] op_sel_hi:[0,1,1] neg_lo:[1,0,0] neg_hi:[1,0,0]
    v_pk_mul_f32 v[226:227], v[60:61], v[60:61]
    v_pk_mul_f32 v[228:229], v[62:63], v[62:63]
    v_pk_fma_f32 v[226:227], v[226:227], v[170:171], v[170:171] op_sel:[0,1,0] op_sel_hi:[1,1,0]
    v_pk_fma_f32 v[228:229], v[228:229], v[170:171], v[170:171] op_sel:[0,1,0] op_sel_hi:[1,1,0]
    v_pk_mul_f32 v[226:227], v[226:227], v[60:61]
    v_pk_mul_f32 v[228:229], v[228:229], v[62:63]
    v_exp_f32 v226, v226
    v_exp_f32 v227, v227
    v_exp_f32 v228, v228
    v_exp_f32 v229, v229
    v_pk_fma_f32 v[226:227], v[226:227], v[168:169], v[168:169] op_sel:[0,1,1] op_sel_hi:[1,1,1]
    v_pk_fma_f32 v[228:229], v[228:229], v[168:169], v[168:169] op_sel:[0,1,1] op_sel_hi:[1,1,1]
    v_rcp_f32 v226, v226
    v_rcp_f32 v227, v227
    v_rcp_f32 v228, v228
    v_rcp_f32 v229, v229
    v_pk_mul_f32 v[60:61], v[60:61], v[226:227]
    v_pk_mul_f32 v[62:63], v[62:63], v[228:229]
    v_pk_fma_f32 v[64:65], v[168:169], v[148:149], v[64:65] op_sel_hi:[0,1,1] neg_lo:[1,0,0] neg_hi:[1,0,0]
    v_pk_fma_f32 v[66:67], v[168:169], v[150:151], v[66:67] op_sel_hi:[0,1,1] neg_lo:[1,0,0] neg_hi:[1,0,0]
    v_pk_mul_f32 v[226:227], v[64:65], v[64:65]
    v_pk_mul_f32 v[228:229], v[66:67], v[66:67]
    v_pk_fma_f32 v[226:227], v[226:227], v[170:171], v[170:171] op_sel:[0,1,0] op_sel_hi:[1,1,0]
    v_pk_fma_f32 v[228:229], v[228:229], v[170:171], v[170:171] op_sel:[0,1,0] op_sel_hi:[1,1,0]
    v_pk_mul_f32 v[226:227], v[226:227], v[64:65]
    v_pk_mul_f32 v[228:229], v[228:229], v[66:67]
    v_exp_f32 v226, v226
    v_exp_f32 v227, v227
    v_exp_f32 v228, v228
    v_exp_f32 v229, v229
    v_pk_fma_f32 v[226:227], v[226:227], v[168:169], v[168:169] op_sel:[0,1,1] op_sel_hi:[1,1,1]
    v_pk_fma_f32 v[228:229], v[228:229], v[168:169], v[168:169] op_sel:[0,1,1] op_sel_hi:[1,1,1]
    v_rcp_f32 v226, v226
    v_rcp_f32 v227, v227
    v_rcp_f32 v228, v228
    v_rcp_f32 v229, v229
    v_pk_mul_f32 v[64:65], v[64:65], v[226:227]
    v_pk_mul_f32 v[66:67], v[66:67], v[228:229]
    v_cvt_pk_bf16_f32 v60, v60, v61
    v_cvt_pk_bf16_f32 v61, v62, v63
    v_cvt_pk_bf16_f32 v62, v64, v65
    v_cvt_pk_bf16_f32 v63, v66, v67
    v_or_b32 v60, 1, v60
    ds_write_b128 v244, v[60:63] offset:18432
    s_waitcnt vmcnt(0)
    s_mov_b64 exec, 1
    ds_add_u32 v246, v245
    s_mov_b64 exec, -1
    v_pk_fma_f32 v[88:89], v[172:173], v[144:145], v[88:89] op_sel_hi:[0,1,1] neg_lo:[1,0,0] neg_hi:[1,0,0]
    v_pk_fma_f32 v[90:91], v[172:173], v[146:147], v[90:91] op_sel_hi:[0,1,1] neg_lo:[1,0,0] neg_hi:[1,0,0]
    v_pk_mul_f32 v[226:227], v[88:89], v[88:89]
    v_pk_mul_f32 v[228:229], v[90:91], v[90:91]
    v_pk_fma_f32 v[226:227], v[226:227], v[174:175], v[174:175] op_sel:[0,1,0] op_sel_hi:[1,1,0]
    v_pk_fma_f32 v[228:229], v[228:229], v[174:175], v[174:175] op_sel:[0,1,0] op_sel_hi:[1,1,0]
    v_pk_mul_f32 v[226:227], v[226:227], v[88:89]
    v_pk_mul_f32 v[228:229], v[228:229], v[90:91]
    v_exp_f32 v226, v226
    v_exp_f32 v227, v227
    v_exp_f32 v228, v228
    v_exp_f32 v229, v229
    v_pk_fma_f32 v[226:227], v[226:227], v[172:173], v[172:173] op_sel:[0,1,1] op_sel_hi:[1,1,1]
    v_pk_fma_f32 v[228:229], v[228:229], v[172:173], v[172:173] op_sel:[0,1,1] op_sel_hi:[1,1,1]
    v_rcp_f32 v226, v226
    v_rcp_f32 v227, v227
    v_rcp_f32 v228, v228
    v_rcp_f32 v229, v229
    v_pk_mul_f32 v[88:89], v[88:89], v[226:227]
    v_pk_mul_f32 v[90:91], v[90:91], v[228:229]
    v_pk_fma_f32 v[92:93], v[172:173], v[148:149], v[92:93] op_sel_hi:[0,1,1] neg_lo:[1,0,0] neg_hi:[1,0,0]
    v_pk_fma_f32 v[94:95], v[172:173], v[150:151], v[94:95] op_sel_hi:[0,1,1] neg_lo:[1,0,0] neg_hi:[1,0,0]
    v_pk_mul_f32 v[226:227], v[92:93], v[92:93]
    v_pk_mul_f32 v[228:229], v[94:95], v[94:95]
    v_pk_fma_f32 v[226:227], v[226:227], v[174:175], v[174:175] op_sel:[0,1,0] op_sel_hi:[1,1,0]
    v_pk_fma_f32 v[228:229], v[228:229], v[174:175], v[174:175] op_sel:[0,1,0] op_sel_hi:[1,1,0]
    v_pk_mul_f32 v[226:227], v[226:227], v[92:93]
    v_pk_mul_f32 v[228:229], v[228:229], v[94:95]
    v_exp_f32 v226, v226
    v_exp_f32 v227, v227
    v_exp_f32 v228, v228
    v_exp_f32 v229, v229
    v_pk_fma_f32 v[226:227], v[226:227], v[172:173], v[172:173] op_sel:[0,1,1] op_sel_hi:[1,1,1]
    v_pk_fma_f32 v[228:229], v[228:229], v[172:173], v[172:173] op_sel:[0,1,1] op_sel_hi:[1,1,1]
    v_rcp_f32 v226, v226
    v_rcp_f32 v227, v227
    v_rcp_f32 v228, v228
    v_rcp_f32 v229, v229
    v_pk_mul_f32 v[92:93], v[92:93], v[226:227]
    v_pk_mul_f32 v[94:95], v[94:95], v[228:229]
    v_cvt_pk_bf16_f32 v88, v88, v89
    v_cvt_pk_bf16_f32 v89, v90, v91
    v_cvt_pk_bf16_f32 v90, v92, v93
    v_cvt_pk_bf16_f32 v91, v94, v95
    v_or_b32 v88, 1, v88
    ds_write_b128 v244, v[88:91] offset:20480
    s_cmp_eq_u32 s60, 1
    s_cbranch_scc1 G4_p10
    buffer_load_dwordx4 v[180:183], v196, s[84:87], 0 offen offset:0 sc1
    buffer_load_dwordx4 v[188:191], v196, s[88:91], 0 offen offset:0 sc1
    buffer_load_dwordx4 v[184:187], v196, s[84:87], 0 offen offset:2048 sc1
    buffer_load_dwordx4 v[192:195], v196, s[88:91], 0 offen offset:2048 sc1
    s_mov_b32 s78, 0
    buffer_load_dwordx2 v[230:231], v197, s[80:83], s78 offen sc1
    s_mov_b32 s78, 65536
    buffer_load_dwordx2 v[232:233], v197, s[80:83], s78 offen sc1
    s_mov_b32 s78, 262144
    buffer_load_dwordx2 v[234:235], v197, s[80:83], s78 offen sc1
    s_mov_b32 s78, 327680
    buffer_load_dwordx2 v[236:237], v197, s[80:83], s78 offen sc1
    s_branch G4_p20
G4_p10:
    s_add_u32 s36, s40, 0
    buffer_load_dwordx4 v[180:183], v2, s[84:87], s36 offen offset:0 sc1
    buffer_load_dwordx4 v[184:187], v2, s[88:91], s36 offen offset:0 sc1
    buffer_load_dwordx4 v[188:191], v2, s[84:87], s36 offen offset:1024 sc1
    buffer_load_dwordx4 v[192:195], v2, s[88:91], s36 offen offset:1024 sc1
    s_add_u32 s36, s40, 65536
    buffer_load_dwordx4 v[196:199], v2, s[84:87], s36 offen offset:0 sc1
    buffer_load_dwordx4 v[230:233], v2, s[88:91], s36 offen offset:0 sc1
    buffer_load_dwordx4 v[234:237], v2, s[84:87], s36 offen offset:1024 sc1
    buffer_load_dwordx4 v[248:251], v2, s[88:91], s36 offen offset:1024 sc1
G4_p20:
    v_pk_fma_f32 v[116:117], v[176:177], v[144:145], v[116:117] op_sel_hi:[0,1,1] neg_lo:[1,0,0] neg_hi:[1,0,0]
    v_pk_fma_f32 v[118:119], v[176:177], v[146:147], v[118:119] op_sel_hi:[0,1,1] neg_lo:[1,0,0] neg_hi:[1,0,0]
    v_pk_mul_f32 v[226:227], v[116:117], v[116:117]
    v_pk_mul_f32 v[228:229], v[118:119], v[118:119]
    v_pk_fma_f32 v[226:227], v[226:227], v[178:179], v[178:179] op_sel:[0,1,0] op_sel_hi:[1,1,0]
    v_pk_fma_f32 v[228:229], v[228:229], v[178:179], v[178:179] op_sel:[0,1,0] op_sel_hi:[1,1,0]
    v_pk_mul_f32 v[226:227], v[226:227], v[116:117]
    v_pk_mul_f32 v[228:229], v[228:229], v[118:119]
    v_exp_f32 v226, v226
    v_exp_f32 v227, v227
    v_exp_f32 v228, v228
    v_exp_f32 v229, v229
    v_pk_fma_f32 v[226:227], v[226:227], v[176:177], v[176:177] op_sel:[0,1,1] op_sel_hi:[1,1,1]
    v_pk_fma_f32 v[228:229], v[228:229], v[176:177], v[176:177] op_sel:[0,1,1] op_sel_hi:[1,1,1]
    v_rcp_f32 v226, v226
    v_rcp_f32 v227, v227
    v_rcp_f32 v228, v228
    v_rcp_f32 v229, v229
    v_pk_mul_f32 v[116:117], v[116:117], v[226:227]
    v_pk_mul_f32 v[118:119], v[118:119], v[228:229]
    v_pk_fma_f32 v[120:121], v[176:177], v[148:149], v[120:121] op_sel_hi:[0,1,1] neg_lo:[1,0,0] neg_hi:[1,0,0]
    v_pk_fma_f32 v[122:123], v[176:177], v[150:151], v[122:123] op_sel_hi:[0,1,1] neg_lo:[1,0,0] neg_hi:[1,0,0]
    v_pk_mul_f32 v[226:227], v[120:121], v[120:121]
    v_pk_mul_f32 v[228:229], v[122:123], v[122:123]
    v_pk_fma_f32 v[226:227], v[226:227], v[178:179], v[178:179] op_sel:[0,1,0] op_sel_hi:[1,1,0]
    v_pk_fma_f32 v[228:229], v[228:229], v[178:179], v[178:179] op_sel:[0,1,0] op_sel_hi:[1,1,0]
    v_pk_mul_f32 v[226:227], v[226:227], v[120:121]
    v_pk_mul_f32 v[228:229], v[228:229], v[122:123]
    v_exp_f32 v226, v226
    v_exp_f32 v227, v227
    v_exp_f32 v228, v228
    v_exp_f32 v229, v229
    v_pk_fma_f32 v[226:227], v[226:227], v[176:177], v[176:177] op_sel:[0,1,1] op_sel_hi:[1,1,1]
    v_pk_fma_f32 v[228:229], v[228:229], v[176:177], v[176:177] op_sel:[0,1,1] op_sel_hi:[1,1,1]
    v_rcp_f32 v226, v226
    v_rcp_f32 v227, v227
    v_rcp_f32 v228, v228
    v_rcp_f32 v229, v229
    v_pk_mul_f32 v[120:121], v[120:121], v[226:227]
    v_pk_mul_f32 v[122:123], v[122:123], v[228:229]
    v_cvt_pk_bf16_f32 v116, v116, v117
    v_cvt_pk_bf16_f32 v117, v118, v119
    v_cvt_pk_bf16_f32 v118, v120, v121
    v_cvt_pk_bf16_f32 v119, v122, v123
    ds_write_b128 v244, v[116:119] offset:22528
    v_pk_fma_f32 v[40:41], v[164:165], v[152:153], v[40:41] op_sel_hi:[0,1,1] neg_lo:[1,0,0] neg_hi:[1,0,0]
    v_pk_fma_f32 v[42:43], v[164:165], v[154:155], v[42:43] op_sel_hi:[0,1,1] neg_lo:[1,0,0] neg_hi:[1,0,0]
    v_pk_mul_f32 v[226:227], v[40:41], v[40:41]
    v_pk_mul_f32 v[228:229], v[42:43], v[42:43]
    v_pk_fma_f32 v[226:227], v[226:227], v[166:167], v[166:167] op_sel:[0,1,0] op_sel_hi:[1,1,0]
    v_pk_fma_f32 v[228:229], v[228:229], v[166:167], v[166:167] op_sel:[0,1,0] op_sel_hi:[1,1,0]
    v_pk_mul_f32 v[226:227], v[226:227], v[40:41]
    v_pk_mul_f32 v[228:229], v[228:229], v[42:43]
    v_exp_f32 v226, v226
    v_exp_f32 v227, v227
    v_exp_f32 v228, v228
    v_exp_f32 v229, v229
    v_pk_fma_f32 v[226:227], v[226:227], v[164:165], v[164:165] op_sel:[0,1,1] op_sel_hi:[1,1,1]
    v_pk_fma_f32 v[228:229], v[228:229], v[164:165], v[164:165] op_sel:[0,1,1] op_sel_hi:[1,1,1]
    v_rcp_f32 v226, v226
    v_rcp_f32 v227, v227
    v_rcp_f32 v228, v228
    v_rcp_f32 v229, v229
    v_pk_mul_f32 v[40:41], v[40:41], v[226:227]
    v_pk_mul_f32 v[42:43], v[42:43], v[228:229]
    v_pk_fma_f32 v[44:45], v[164:165], v[156:157], v[44:45] op_sel_hi:[0,1,1] neg_lo:[1,0,0] neg_hi:[1,0,0]
    v_pk_fma_f32 v[46:47], v[164:165], v[158:159], v[46:47] op_sel_hi:[0,1,1] neg_lo:[1,0,0] neg_hi:[1,0,0]
    v_pk_mul_f32 v[226:227], v[44:45], v[44:45]
    v_pk_mul_f32 v[228:229], v[46:47], v[46:47]
    v_pk_fma_f32 v[226:227], v[226:227], v[166:167], v[166:167] op_sel:[0,1,0] op_sel_hi:[1,1,0]
    v_pk_fma_f32 v[228:229], v[228:229], v[166:167], v[166:167] op_sel:[0,1,0] op_sel_hi:[1,1,0]
    v_pk_mul_f32 v[226:227], v[226:227], v[44:45]
    v_pk_mul_f32 v[228:229], v[228:229], v[46:47]
    v_exp_f32 v226, v226
    v_exp_f32 v227, v227
    v_exp_f32 v228, v228
    v_exp_f32 v229, v229
    v_pk_fma_f32 v[226:227], v[226:227], v[164:165], v[164:165] op_sel:[0,1,1] op_sel_hi:[1,1,1]
    v_pk_fma_f32 v[228:229], v[228:229], v[164:165], v[164:165] op_sel:[0,1,1] op_sel_hi:[1,1,1]
    v_rcp_f32 v226, v226
    v_rcp_f32 v227, v227
    v_rcp_f32 v228, v228
    v_rcp_f32 v229, v229
    v_pk_mul_f32 v[44:45], v[44:45], v[226:227]
    v_pk_mul_f32 v[46:47], v[46:47], v[228:229]
    v_cvt_pk_bf16_f32 v200, v40, v41
    v_cvt_pk_bf16_f32 v201, v42, v43
    v_cvt_pk_bf16_f32 v202, v44, v45
    v_cvt_pk_bf16_f32 v203, v46, v47
    v_or_b32 v200, 1, v200
    ds_write_b128 v244, v[200:203] offset:32768
    v_pk_fma_f32 v[68:69], v[168:169], v[152:153], v[68:69] op_sel_hi:[0,1,1] neg_lo:[1,0,0] neg_hi:[1,0,0]
    v_pk_fma_f32 v[70:71], v[168:169], v[154:155], v[70:71] op_sel_hi:[0,1,1] neg_lo:[1,0,0] neg_hi:[1,0,0]
    v_pk_mul_f32 v[226:227], v[68:69], v[68:69]
    v_pk_mul_f32 v[228:229], v[70:71], v[70:71]
    v_pk_fma_f32 v[226:227], v[226:227], v[170:171], v[170:171] op_sel:[0,1,0] op_sel_hi:[1,1,0]
    v_pk_fma_f32 v[228:229], v[228:229], v[170:171], v[170:171] op_sel:[0,1,0] op_sel_hi:[1,1,0]
    v_pk_mul_f32 v[226:227], v[226:227], v[68:69]
    v_pk_mul_f32 v[228:229], v[228:229], v[70:71]
    v_exp_f32 v226, v226
    v_exp_f32 v227, v227
    v_exp_f32 v228, v228
    v_exp_f32 v229, v229
    v_pk_fma_f32 v[226:227], v[226:227], v[168:169], v[168:169] op_sel:[0,1,1] op_sel_hi:[1,1,1]
    v_pk_fma_f32 v[228:229], v[228:229], v[168:169], v[168:169] op_sel:[0,1,1] op_sel_hi:[1,1,1]
    v_rcp_f32 v226, v226
    v_rcp_f32 v227, v227
    v_rcp_f32 v228, v228
    v_rcp_f32 v229, v229
    v_pk_mul_f32 v[68:69], v[68:69], v[226:227]
    v_pk_mul_f32 v[70:71], v[70:71], v[228:229]
    v_pk_fma_f32 v[72:73], v[168:169], v[156:157], v[72:73] op_sel_hi:[0,1,1] neg_lo:[1,0,0] neg_hi:[1,0,0]
    v_pk_fma_f32 v[74:75], v[168:169], v[158:159], v[74:75] op_sel_hi:[0,1,1] neg_lo:[1,0,0] neg_hi:[1,0,0]
    v_pk_mul_f32 v[226:227], v[72:73], v[72:73]
    v_pk_mul_f32 v[228:229], v[74:75], v[74:75]
    v_pk_fma_f32 v[226:227], v[226:227], v[170:171], v[170:171] op_sel:[0,1,0] op_sel_hi:[1,1,0]
    v_pk_fma_f32 v[228:229], v[228:229], v[170:171], v[170:171] op_sel:[0,1,0] op_sel_hi:[1,1,0]
    v_pk_mul_f32 v[226:227], v[226:227], v[72:73]
    v_pk_mul_f32 v[228:229], v[228:229], v[74:75]
    v_exp_f32 v226, v226
    v_exp_f32 v227, v227
    v_exp_f32 v228, v228
    v_exp_f32 v229, v229
    v_pk_fma_f32 v[226:227], v[226:227], v[168:169], v[168:169] op_sel:[0,1,1] op_sel_hi:[1,1,1]
    v_pk_fma_f32 v[228:229], v[228:229], v[168:169], v[168:169] op_sel:[0,1,1] op_sel_hi:[1,1,1]
    v_rcp_f32 v226, v226
    v_rcp_f32 v227, v227
    v_rcp_f32 v228, v228
    v_rcp_f32 v229, v229
    v_pk_mul_f32 v[72:73], v[72:73], v[226:227]
    v_pk_mul_f32 v[74:75], v[74:75], v[228:229]
    v_cvt_pk_bf16_f32 v204, v68, v69
    v_cvt_pk_bf16_f32 v205, v70, v71
    v_cvt_pk_bf16_f32 v206, v72, v73
    v_cvt_pk_bf16_f32 v207, v74, v75
    v_or_b32 v204, 1, v204
    ds_write_b128 v244, v[204:207] offset:34816
    v_pk_fma_f32 v[96:97], v[172:173], v[152:153], v[96:97] op_sel_hi:[0,1,1] neg_lo:[1,0,0] neg_hi:[1,0,0]
    v_pk_fma_f32 v[98:99], v[172:173], v[154:155], v[98:99] op_sel_hi:[0,1,1] neg_lo:[1,0,0] neg_hi:[1,0,0]
    v_pk_mul_f32 v[226:227], v[96:97], v[96:97]
    v_pk_mul_f32 v[228:229], v[98:99], v[98:99]
    v_pk_fma_f32 v[226:227], v[226:227], v[174:175], v[174:175] op_sel:[0,1,0] op_sel_hi:[1,1,0]
    v_pk_fma_f32 v[228:229], v[228:229], v[174:175], v[174:175] op_sel:[0,1,0] op_sel_hi:[1,1,0]
    v_pk_mul_f32 v[226:227], v[226:227], v[96:97]
    v_pk_mul_f32 v[228:229], v[228:229], v[98:99]
    v_exp_f32 v226, v226
    v_exp_f32 v227, v227
    v_exp_f32 v228, v228
    v_exp_f32 v229, v229
    v_pk_fma_f32 v[226:227], v[226:227], v[172:173], v[172:173] op_sel:[0,1,1] op_sel_hi:[1,1,1]
    v_pk_fma_f32 v[228:229], v[228:229], v[172:173], v[172:173] op_sel:[0,1,1] op_sel_hi:[1,1,1]
    v_rcp_f32 v226, v226
    v_rcp_f32 v227, v227
    v_rcp_f32 v228, v228
    v_rcp_f32 v229, v229
    v_pk_mul_f32 v[96:97], v[96:97], v[226:227]
    v_pk_mul_f32 v[98:99], v[98:99], v[228:229]
    v_pk_fma_f32 v[100:101], v[172:173], v[156:157], v[100:101] op_sel_hi:[0,1,1] neg_lo:[1,0,0] neg_hi:[1,0,0]
    v_pk_fma_f32 v[102:103], v[172:173], v[158:159], v[102:103] op_sel_hi:[0,1,1] neg_lo:[1,0,0] neg_hi:[1,0,0]
    v_pk_mul_f32 v[226:227], v[100:101], v[100:101]
    v_pk_mul_f32 v[228:229], v[102:103], v[102:103]
    v_pk_fma_f32 v[226:227], v[226:227], v[174:175], v[174:175] op_sel:[0,1,0] op_sel_hi:[1,1,0]
    v_pk_fma_f32 v[228:229], v[228:229], v[174:175], v[174:175] op_sel:[0,1,0] op_sel_hi:[1,1,0]
    v_pk_mul_f32 v[226:227], v[226:227], v[100:101]
    v_pk_mul_f32 v[228:229], v[228:229], v[102:103]
    v_exp_f32 v226, v226
    v_exp_f32 v227, v227
    v_exp_f32 v228, v228
    v_exp_f32 v229, v229
    v_pk_fma_f32 v[226:227], v[226:227], v[172:173], v[172:173] op_sel:[0,1,1] op_sel_hi:[1,1,1]
    v_pk_fma_f32 v[228:229], v[228:229], v[172:173], v[172:173] op_sel:[0,1,1] op_sel_hi:[1,1,1]
    v_rcp_f32 v226, v226
    v_rcp_f32 v227, v227
    v_rcp_f32 v228, v228
    v_rcp_f32 v229, v229
    v_pk_mul_f32 v[100:101], v[100:101], v[226:227]
    v_pk_mul_f32 v[102:103], v[102:103], v[228:229]
    v_cvt_pk_bf16_f32 v208, v96, v97
    v_cvt_pk_bf16_f32 v209, v98, v99
    v_cvt_pk_bf16_f32 v210, v100, v101
    v_cvt_pk_bf16_f32 v211, v102, v103
    v_or_b32 v208, 1, v208
    ds_write_b128 v244, v[208:211] offset:36864
    v_pk_fma_f32 v[124:125], v[176:177], v[152:153], v[124:125] op_sel_hi:[0,1,1] neg_lo:[1,0,0] neg_hi:[1,0,0]
    v_pk_fma_f32 v[126:127], v[176:177], v[154:155], v[126:127] op_sel_hi:[0,1,1] neg_lo:[1,0,0] neg_hi:[1,0,0]
    v_pk_mul_f32 v[226:227], v[124:125], v[124:125]
    v_pk_mul_f32 v[228:229], v[126:127], v[126:127]
    v_pk_fma_f32 v[226:227], v[226:227], v[178:179], v[178:179] op_sel:[0,1,0] op_sel_hi:[1,1,0]
    v_pk_fma_f32 v[228:229], v[228:229], v[178:179], v[178:179] op_sel:[0,1,0] op_sel_hi:[1,1,0]
    v_pk_mul_f32 v[226:227], v[226:227], v[124:125]
    v_pk_mul_f32 v[228:229], v[228:229], v[126:127]
    v_exp_f32 v226, v226
    v_exp_f32 v227, v227
    v_exp_f32 v228, v228
    v_exp_f32 v229, v229
    v_pk_fma_f32 v[226:227], v[226:227], v[176:177], v[176:177] op_sel:[0,1,1] op_sel_hi:[1,1,1]
    v_pk_fma_f32 v[228:229], v[228:229], v[176:177], v[176:177] op_sel:[0,1,1] op_sel_hi:[1,1,1]
    v_rcp_f32 v226, v226
    v_rcp_f32 v227, v227
    v_rcp_f32 v228, v228
    v_rcp_f32 v229, v229
    v_pk_mul_f32 v[124:125], v[124:125], v[226:227]
    v_pk_mul_f32 v[126:127], v[126:127], v[228:229]
    v_pk_fma_f32 v[128:129], v[176:177], v[156:157], v[128:129] op_sel_hi:[0,1,1] neg_lo:[1,0,0] neg_hi:[1,0,0]
    v_pk_fma_f32 v[130:131], v[176:177], v[158:159], v[130:131] op_sel_hi:[0,1,1] neg_lo:[1,0,0] neg_hi:[1,0,0]
    v_pk_mul_f32 v[226:227], v[128:129], v[128:129]
    v_pk_mul_f32 v[228:229], v[130:131], v[130:131]
    v_pk_fma_f32 v[226:227], v[226:227], v[178:179], v[178:179] op_sel:[0,1,0] op_sel_hi:[1,1,0]
    v_pk_fma_f32 v[228:229], v[228:229], v[178:179], v[178:179] op_sel:[0,1,0] op_sel_hi:[1,1,0]
    v_pk_mul_f32 v[226:227], v[226:227], v[128:129]
    v_pk_mul_f32 v[228:229], v[228:229], v[130:131]
    v_exp_f32 v226, v226
    v_exp_f32 v227, v227
    v_exp_f32 v228, v228
    v_exp_f32 v229, v229
    v_pk_fma_f32 v[226:227], v[226:227], v[176:177], v[176:177] op_sel:[0,1,1] op_sel_hi:[1,1,1]
    v_pk_fma_f32 v[228:229], v[228:229], v[176:177], v[176:177] op_sel:[0,1,1] op_sel_hi:[1,1,1]
    v_rcp_f32 v226, v226
    v_rcp_f32 v227, v227
    v_rcp_f32 v228, v228
    v_rcp_f32 v229, v229
    v_pk_mul_f32 v[128:129], v[128:129], v[226:227]
    v_pk_mul_f32 v[130:131], v[130:131], v[228:229]
    v_cvt_pk_bf16_f32 v212, v124, v125
    v_cvt_pk_bf16_f32 v213, v126, v127
    v_cvt_pk_bf16_f32 v214, v128, v129
    v_cvt_pk_bf16_f32 v215, v130, v131
    ds_write_b128 v244, v[212:215] offset:38912
    v_pk_fma_f32 v[48:49], v[164:165], v[160:161], v[48:49] op_sel_hi:[0,1,1] neg_lo:[1,0,0] neg_hi:[1,0,0]
    v_pk_fma_f32 v[50:51], v[164:165], v[162:163], v[50:51] op_sel_hi:[0,1,1] neg_lo:[1,0,0] neg_hi:[1,0,0]
    v_pk_mul_f32 v[226:227], v[48:49], v[48:49]
    v_pk_mul_f32 v[228:229], v[50:51], v[50:51]
    v_pk_fma_f32 v[226:227], v[226:227], v[166:167], v[166:167] op_sel:[0,1,0] op_sel_hi:[1,1,0]
    v_pk_fma_f32 v[228:229], v[228:229], v[166:167], v[166:167] op_sel:[0,1,0] op_sel_hi:[1,1,0]
    v_pk_mul_f32 v[226:227], v[226:227], v[48:49]
    v_pk_mul_f32 v[228:229], v[228:229], v[50:51]
    v_exp_f32 v226, v226
    v_exp_f32 v227, v227
    v_exp_f32 v228, v228
    v_exp_f32 v229, v229
    v_pk_fma_f32 v[226:227], v[226:227], v[164:165], v[164:165] op_sel:[0,1,1] op_sel_hi:[1,1,1]
    v_pk_fma_f32 v[228:229], v[228:229], v[164:165], v[164:165] op_sel:[0,1,1] op_sel_hi:[1,1,1]
    v_rcp_f32 v226, v226
    v_rcp_f32 v227, v227
    v_rcp_f32 v228, v228
    v_rcp_f32 v229, v229
    v_pk_mul_f32 v[48:49], v[48:49], v[226:227]
    v_pk_mul_f32 v[50:51], v[50:51], v[228:229]
    v_cvt_pk_bf16_f32 v216, v48, v49
    v_cvt_pk_bf16_f32 v217, v50, v51
    v_or_b32 v216, 1, v216
    s_add_u32 s36, s45, 0
    buffer_store_dwordx4 v[32:35], v2, s[16:19], s36 offen sc1
    v_pk_fma_f32 v[76:77], v[168:169], v[160:161], v[76:77] op_sel_hi:[0,1,1] neg_lo:[1,0,0] neg_hi:[1,0,0]
    v_pk_fma_f32 v[78:79], v[168:169], v[162:163], v[78:79] op_sel_hi:[0,1,1] neg_lo:[1,0,0] neg_hi:[1,0,0]
    v_pk_mul_f32 v[226:227], v[76:77], v[76:77]
    v_pk_mul_f32 v[228:229], v[78:79], v[78:79]
    v_pk_fma_f32 v[226:227], v[226:227], v[170:171], v[170:171] op_sel:[0,1,0] op_sel_hi:[1,1,0]
    v_pk_fma_f32 v[228:229], v[228:229], v[170:171], v[170:171] op_sel:[0,1,0] op_sel_hi:[1,1,0]
    v_pk_mul_f32 v[226:227], v[226:227], v[76:77]
    v_pk_mul_f32 v[228:229], v[228:229], v[78:79]
    v_exp_f32 v226, v226
    v_exp_f32 v227, v227
    v_exp_f32 v228, v228
    v_exp_f32 v229, v229
    v_pk_fma_f32 v[226:227], v[226:227], v[168:169], v[168:169] op_sel:[0,1,1] op_sel_hi:[1,1,1]
    v_pk_fma_f32 v[228:229], v[228:229], v[168:169], v[168:169] op_sel:[0,1,1] op_sel_hi:[1,1,1]
    v_rcp_f32 v226, v226
    v_rcp_f32 v227, v227
    v_rcp_f32 v228, v228
    v_rcp_f32 v229, v229
    v_pk_mul_f32 v[76:77], v[76:77], v[226:227]
    v_pk_mul_f32 v[78:79], v[78:79], v[228:229]
    v_cvt_pk_bf16_f32 v218, v76, v77
    v_cvt_pk_bf16_f32 v219, v78, v79
    v_or_b32 v218, 1, v218
    s_add_u32 s36, s45, 229376
    buffer_store_dwordx4 v[60:63], v2, s[16:19], s36 offen sc1
    v_pk_fma_f32 v[104:105], v[172:173], v[160:161], v[104:105] op_sel_hi:[0,1,1] neg_lo:[1,0,0] neg_hi:[1,0,0]
    v_pk_fma_f32 v[106:107], v[172:173], v[162:163], v[106:107] op_sel_hi:[0,1,1] neg_lo:[1,0,0] neg_hi:[1,0,0]
    v_pk_mul_f32 v[226:227], v[104:105], v[104:105]
    v_pk_mul_f32 v[228:229], v[106:107], v[106:107]
    v_pk_fma_f32 v[226:227], v[226:227], v[174:175], v[174:175] op_sel:[0,1,0] op_sel_hi:[1,1,0]
    v_pk_fma_f32 v[228:229], v[228:229], v[174:175], v[174:175] op_sel:[0,1,0] op_sel_hi:[1,1,0]
    v_pk_mul_f32 v[226:227], v[226:227], v[104:105]
    v_pk_mul_f32 v[228:229], v[228:229], v[106:107]
    v_exp_f32 v226, v226
    v_exp_f32 v227, v227
    v_exp_f32 v228, v228
    v_exp_f32 v229, v229
    v_pk_fma_f32 v[226:227], v[226:227], v[172:173], v[172:173] op_sel:[0,1,1] op_sel_hi:[1,1,1]
    v_pk_fma_f32 v[228:229], v[228:229], v[172:173], v[172:173] op_sel:[0,1,1] op_sel_hi:[1,1,1]
    v_rcp_f32 v226, v226
    v_rcp_f32 v227, v227
    v_rcp_f32 v228, v228
    v_rcp_f32 v229, v229
    v_pk_mul_f32 v[104:105], v[104:105], v[226:227]
    v_pk_mul_f32 v[106:107], v[106:107], v[228:229]
    v_cvt_pk_bf16_f32 v220, v104, v105
    v_cvt_pk_bf16_f32 v221, v106, v107
    v_or_b32 v220, 1, v220
    s_add_u32 s36, s45, 458752
    buffer_store_dwordx4 v[88:91], v2, s[16:19], s36 offen sc1
    v_pk_fma_f32 v[132:133], v[176:177], v[160:161], v[132:133] op_sel_hi:[0,1,1] neg_lo:[1,0,0] neg_hi:[1,0,0]
    v_pk_fma_f32 v[134:135], v[176:177], v[162:163], v[134:135] op_sel_hi:[0,1,1] neg_lo:[1,0,0] neg_hi:[1,0,0]
    v_pk_mul_f32 v[226:227], v[132:133], v[132:133]
    v_pk_mul_f32 v[228:229], v[134:135], v[134:135]
    v_pk_fma_f32 v[226:227], v[226:227], v[178:179], v[178:179] op_sel:[0,1,0] op_sel_hi:[1,1,0]
    v_pk_fma_f32 v[228:229], v[228:229], v[178:179], v[178:179] op_sel:[0,1,0] op_sel_hi:[1,1,0]
    v_pk_mul_f32 v[226:227], v[226:227], v[132:133]
    v_pk_mul_f32 v[228:229], v[228:229], v[134:135]
    v_exp_f32 v226, v226
    v_exp_f32 v227, v227
    v_exp_f32 v228, v228
    v_exp_f32 v229, v229
    v_pk_fma_f32 v[226:227], v[226:227], v[176:177], v[176:177] op_sel:[0,1,1] op_sel_hi:[1,1,1]
    v_pk_fma_f32 v[228:229], v[228:229], v[176:177], v[176:177] op_sel:[0,1,1] op_sel_hi:[1,1,1]
    v_rcp_f32 v226, v226
    v_rcp_f32 v227, v227
    v_rcp_f32 v228, v228
    v_rcp_f32 v229, v229
    v_pk_mul_f32 v[132:133], v[132:133], v[226:227]
    v_pk_mul_f32 v[134:135], v[134:135], v[228:229]
    v_cvt_pk_bf16_f32 v222, v132, v133
    v_cvt_pk_bf16_f32 v223, v134, v135
    s_add_u32 s36, s45, 688128
    buffer_store_dwordx4 v[116:119], v2, s[16:19], s36 offen sc1
    s_waitcnt lgkmcnt(0)
    s_mov_b32 s44, s46
    s_mov_b32 s45, s47
    s_branch G3_e2
G3_e1:
    v_pk_fma_f32 v[28:29], v[164:165], v[140:141], v[28:29] op_sel_hi:[0,1,1] neg_lo:[1,0,0] neg_hi:[1,0,0]
    v_pk_fma_f32 v[30:31], v[164:165], v[142:143], v[30:31] op_sel_hi:[0,1,1] neg_lo:[1,0,0] neg_hi:[1,0,0]
    v_pk_mul_f32 v[226:227], v[28:29], v[28:29]
    v_pk_mul_f32 v[228:229], v[30:31], v[30:31]
    v_pk_fma_f32 v[226:227], v[226:227], v[166:167], v[166:167] op_sel:[0,1,0] op_sel_hi:[1,1,0]
    v_pk_fma_f32 v[228:229], v[228:229], v[166:167], v[166:167] op_sel:[0,1,0] op_sel_hi:[1,1,0]
    v_pk_mul_f32 v[226:227], v[226:227], v[28:29]
    v_pk_mul_f32 v[228:229], v[228:229], v[30:31]
    v_exp_f32 v226, v226
    v_exp_f32 v227, v227
    v_exp_f32 v228, v228
    v_exp_f32 v229, v229
    v_pk_fma_f32 v[226:227], v[226:227], v[164:165], v[164:165] op_sel:[0,1,1] op_sel_hi:[1,1,1]
    v_pk_fma_f32 v[228:229], v[228:229], v[164:165], v[164:165] op_sel:[0,1,1] op_sel_hi:[1,1,1]
    v_rcp_f32 v226, v226
    v_rcp_f32 v227, v227
    v_rcp_f32 v228, v228
    v_rcp_f32 v229, v229
    v_pk_mul_f32 v[28:29], v[28:29], v[226:227]
    v_pk_mul_f32 v[30:31], v[30:31], v[228:229]
    v_pk_fma_f32 v[32:33], v[164:165], v[144:145], v[32:33] op_sel_hi:[0,1,1] neg_lo:[1,0,0] neg_hi:[1,0,0]
    v_pk_fma_f32 v[34:35], v[164:165], v[146:147], v[34:35] op_sel_hi:[0,1,1] neg_lo:[1,0,0] neg_hi:[1,0,0]
    v_pk_mul_f32 v[226:227], v[32:33], v[32:33]
    v_pk_mul_f32 v[228:229], v[34:35], v[34:35]
    v_pk_fma_f32 v[226:227], v[226:227], v[166:167], v[166:167] op_sel:[0,1,0] op_sel_hi:[1,1,0]
    v_pk_fma_f32 v[228:229], v[228:229], v[166:167], v[166:167] op_sel:[0,1,0] op_sel_hi:[1,1,0]
    v_pk_mul_f32 v[226:227], v[226:227], v[32:33]
    v_pk_mul_f32 v[228:229], v[228:229], v[34:35]
    v_exp_f32 v226, v226
    v_exp_f32 v227, v227
    v_exp_f32 v228, v228
    v_exp_f32 v229, v229
    v_pk_fma_f32 v[226:227], v[226:227], v[164:165], v[164:165] op_sel:[0,1,1] op_sel_hi:[1,1,1]
    v_pk_fma_f32 v[228:229], v[228:229], v[164:165], v[164:165] op_sel:[0,1,1] op_sel_hi:[1,1,1]
    v_rcp_f32 v226, v226
    v_rcp_f32 v227, v227
    v_rcp_f32 v228, v228
    v_rcp_f32 v229, v229
    v_pk_mul_f32 v[32:33], v[32:33], v[226:227]
    v_pk_mul_f32 v[34:35], v[34:35], v[228:229]
    v_cvt_pk_bf16_f32 v28, v28, v29
    v_cvt_pk_bf16_f32 v29, v30, v31
    v_cvt_pk_bf16_f32 v30, v32, v33
    v_cvt_pk_bf16_f32 v31, v34, v35
    v_or_b32 v28, 1, v28
    ds_write_b128 v244, v[28:31] offset:0
    s_add_u32 s36, s45, 0
    buffer_store_dwordx4 v[28:31], v2, s[16:19], s36 offen sc1
    v_pk_fma_f32 v[56:57], v[168:169], v[140:141], v[56:57] op_sel_hi:[0,1,1] neg_lo:[1,0,0] neg_hi:[1,0,0]
    v_pk_fma_f32 v[58:59], v[168:169], v[142:143], v[58:59] op_sel_hi:[0,1,1] neg_lo:[1,0,0] neg_hi:[1,0,0]
    v_pk_mul_f32 v[226:227], v[56:57], v[56:57]
    v_pk_mul_f32 v[228:229], v[58:59], v[58:59]
    v_pk_fma_f32 v[226:227], v[226:227], v[170:171], v[170:171] op_sel:[0,1,0] op_sel_hi:[1,1,0]
    v_pk_fma_f32 v[228:229], v[228:229], v[170:171], v[170:171] op_sel:[0,1,0] op_sel_hi:[1,1,0]
    v_pk_mul_f32 v[226:227], v[226:227], v[56:57]
    v_pk_mul_f32 v[228:229], v[228:229], v[58:59]
    v_exp_f32 v226, v226
    v_exp_f32 v227, v227
    v_exp_f32 v228, v228
    v_exp_f32 v229, v229
    v_pk_fma_f32 v[226:227], v[226:227], v[168:169], v[168:169] op_sel:[0,1,1] op_sel_hi:[1,1,1]
    v_pk_fma_f32 v[228:229], v[228:229], v[168:169], v[168:169] op_sel:[0,1,1] op_sel_hi:[1,1,1]
    v_rcp_f32 v226, v226
    v_rcp_f32 v227, v227
    v_rcp_f32 v228, v228
    v_rcp_f32 v229, v229
    v_pk_mul_f32 v[56:57], v[56:57], v[226:227]
    v_pk_mul_f32 v[58:59], v[58:59], v[228:229]
    v_pk_fma_f32 v[60:61], v[168:169], v[144:145], v[60:61] op_sel_hi:[0,1,1] neg_lo:[1,0,0] neg_hi:[1,0,0]
    v_pk_fma_f32 v[62:63], v[168:169], v[146:147], v[62:63] op_sel_hi:[0,1,1] neg_lo:[1,0,0] neg_hi:[1,0,0]
    v_pk_mul_f32 v[226:227], v[60:61], v[60:61]
    v_pk_mul_f32 v[228:229], v[62:63], v[62:63]
    v_pk_fma_f32 v[226:227], v[226:227], v[170:171], v[170:171] op_sel:[0,1,0] op_sel_hi:[1,1,0]
    v_pk_fma_f32 v[228:229], v[228:229], v[170:171], v[170:171] op_sel:[0,1,0] op_sel_hi:[1,1,0]
    v_pk_mul_f32 v[226:227], v[226:227], v[60:61]
    v_pk_mul_f32 v[228:229], v[228:229], v[62:63]
    v_exp_f32 v226, v226
    v_exp_f32 v227, v227
    v_exp_f32 v228, v228
    v_exp_f32 v229, v229
    v_pk_fma_f32 v[226:227], v[226:227], v[168:169], v[168:169] op_sel:[0,1,1] op_sel_hi:[1,1,1]
    v_pk_fma_f32 v[228:229], v[228:229], v[168:169], v[168:169] op_sel:[0,1,1] op_sel_hi:[1,1,1]
    v_rcp_f32 v226, v226
    v_rcp_f32 v227, v227
    v_rcp_f32 v228, v228
    v_rcp_f32 v229, v229
    v_pk_mul_f32 v[60:61], v[60:61], v[226:227]
    v_pk_mul_f32 v[62:63], v[62:63], v[228:229]
    v_cvt_pk_bf16_f32 v56, v56, v57
    v_cvt_pk_bf16_f32 v57, v58, v59
    v_cvt_pk_bf16_f32 v58, v60, v61
    v_cvt_pk_bf16_f32 v59, v62, v63
    v_or_b32 v56, 1, v56
    ds_write_b128 v244, v[56:59] offset:2048
    s_add_u32 s36, s45, 229376
    buffer_store_dwordx4 v[56:59], v2, s[16:19], s36 offen sc1
    v_pk_fma_f32 v[84:85], v[172:173], v[140:141], v[84:85] op_sel_hi:[0,1,1] neg_lo:[1,0,0] neg_hi:[1,0,0]
    v_pk_fma_f32 v[86:87], v[172:173], v[142:143], v[86:87] op_sel_hi:[0,1,1] neg_lo:[1,0,0] neg_hi:[1,0,0]
    v_pk_mul_f32 v[226:227], v[84:85], v[84:85]
    v_pk_mul_f32 v[228:229], v[86:87], v[86:87]
    v_pk_fma_f32 v[226:227], v[226:227], v[174:175], v[174:175] op_sel:[0,1,0] op_sel_hi:[1,1,0]
    v_pk_fma_f32 v[228:229], v[228:229], v[174:175], v[174:175] op_sel:[0,1,0] op_sel_hi:[1,1,0]
    v_pk_mul_f32 v[226:227], v[226:227], v[84:85]
    v_pk_mul_f32 v[228:229], v[228:229], v[86:87]
    v_exp_f32 v226, v226
    v_exp_f32 v227, v227
    v_exp_f32 v228, v228
    v_exp_f32 v229, v229
    v_pk_fma_f32 v[226:227], v[226:227], v[172:173], v[172:173] op_sel:[0,1,1] op_sel_hi:[1,1,1]
    v_pk_fma_f32 v[228:229], v[228:229], v[172:173], v[172:173] op_sel:[0,1,1] op_sel_hi:[1,1,1]
    v_rcp_f32 v226, v226
    v_rcp_f32 v227, v227
    v_rcp_f32 v228, v228
    v_rcp_f32 v229, v229
    v_pk_mul_f32 v[84:85], v[84:85], v[226:227]
    v_pk_mul_f32 v[86:87], v[86:87], v[228:229]
    v_pk_fma_f32 v[88:89], v[172:173], v[144:145], v[88:89] op_sel_hi:[0,1,1] neg_lo:[1,0,0] neg_hi:[1,0,0]
    v_pk_fma_f32 v[90:91], v[172:173], v[146:147], v[90:91] op_sel_hi:[0,1,1] neg_lo:[1,0,0] neg_hi:[1,0,0]
    v_pk_mul_f32 v[226:227], v[88:89], v[88:89]
    v_pk_mul_f32 v[228:229], v[90:91], v[90:91]
    v_pk_fma_f32 v[226:227], v[226:227], v[174:175], v[174:175] op_sel:[0,1,0] op_sel_hi:[1,1,0]
    v_pk_fma_f32 v[228:229], v[228:229], v[174:175], v[174:175] op_sel:[0,1,0] op_sel_hi:[1,1,0]
    v_pk_mul_f32 v[226:227], v[226:227], v[88:89]
    v_pk_mul_f32 v[228:229], v[228:229], v[90:91]
    v_exp_f32 v226, v226
    v_exp_f32 v227, v227
    v_exp_f32 v228, v228
    v_exp_f32 v229, v229
    v_pk_fma_f32 v[226:227], v[226:227], v[172:173], v[172:173] op_sel:[0,1,1] op_sel_hi:[1,1,1]
    v_pk_fma_f32 v[228:229], v[228:229], v[172:173], v[172:173] op_sel:[0,1,1] op_sel_hi:[1,1,1]
    v_rcp_f32 v226, v226
    v_rcp_f32 v227, v227
    v_rcp_f32 v228, v228
    v_rcp_f32 v229, v229
    v_pk_mul_f32 v[88:89], v[88:89], v[226:227]
    v_pk_mul_f32 v[90:91], v[90:91], v[228:229]
    v_cvt_pk_bf16_f32 v84, v84, v85
    v_cvt_pk_bf16_f32 v85, v86, v87
    v_cvt_pk_bf16_f32 v86, v88, v89
    v_cvt_pk_bf16_f32 v87, v90, v91
    v_or_b32 v84, 1, v84
    ds_write_b128 v244, v[84:87] offset:4096
    s_add_u32 s36, s45, 458752
    buffer_store_dwordx4 v[84:87], v2, s[16:19], s36 offen sc1
    v_pk_fma_f32 v[112:113], v[176:177], v[140:141], v[112:113] op_sel_hi:[0,1,1] neg_lo:[1,0,0] neg_hi:[1,0,0]
    v_pk_fma_f32 v[114:115], v[176:177], v[142:143], v[114:115] op_sel_hi:[0,1,1] neg_lo:[1,0,0] neg_hi:[1,0,0]
    v_pk_mul_f32 v[226:227], v[112:113], v[112:113]
    v_pk_mul_f32 v[228:229], v[114:115], v[114:115]
    v_pk_fma_f32 v[226:227], v[226:227], v[178:179], v[178:179] op_sel:[0,1,0] op_sel_hi:[1,1,0]
    v_pk_fma_f32 v[228:229], v[228:229], v[178:179], v[178:179] op_sel:[0,1,0] op_sel_hi:[1,1,0]
    v_pk_mul_f32 v[226:227], v[226:227], v[112:113]
    v_pk_mul_f32 v[228:229], v[228:229], v[114:115]
    v_exp_f32 v226, v226
    v_exp_f32 v227, v227
    v_exp_f32 v228, v228
    v_exp_f32 v229, v229
    v_pk_fma_f32 v[226:227], v[226:227], v[176:177], v[176:177] op_sel:[0,1,1] op_sel_hi:[1,1,1]
    v_pk_fma_f32 v[228:229], v[228:229], v[176:177], v[176:177] op_sel:[0,1,1] op_sel_hi:[1,1,1]
    v_rcp_f32 v226, v226
    v_rcp_f32 v227, v227
    v_rcp_f32 v228, v228
    v_rcp_f32 v229, v229
    v_pk_mul_f32 v[112:113], v[112:113], v[226:227]
    v_pk_mul_f32 v[114:115], v[114:115], v[228:229]
    v_pk_fma_f32 v[116:117], v[176:177], v[144:145], v[116:117] op_sel_hi:[0,1,1] neg_lo:[1,0,0] neg_hi:[1,0,0]
    v_pk_fma_f32 v[118:119], v[176:177], v[146:147], v[118:119] op_sel_hi:[0,1,1] neg_lo:[1,0,0] neg_hi:[1,0,0]
    v_pk_mul_f32 v[226:227], v[116:117], v[116:117]
    v_pk_mul_f32 v[228:229], v[118:119], v[118:119]
    v_pk_fma_f32 v[226:227], v[226:227], v[178:179], v[178:179] op_sel:[0,1,0] op_sel_hi:[1,1,0]
    v_pk_fma_f32 v[228:229], v[228:229], v[178:179], v[178:179] op_sel:[0,1,0] op_sel_hi:[1,1,0]
    v_pk_mul_f32 v[226:227], v[226:227], v[116:117]
    v_pk_mul_f32 v[228:229], v[228:229], v[118:119]
    v_exp_f32 v226, v226
    v_exp_f32 v227, v227
    v_exp_f32 v228, v228
    v_exp_f32 v229, v229
    v_pk_fma_f32 v[226:227], v[226:227], v[176:177], v[176:177] op_sel:[0,1,1] op_sel_hi:[1,1,1]
    v_pk_fma_f32 v[228:229], v[228:229], v[176:177], v[176:177] op_sel:[0,1,1] op_sel_hi:[1,1,1]
    v_rcp_f32 v226, v226
    v_rcp_f32 v227, v227
    v_rcp_f32 v228, v228
    v_rcp_f32 v229, v229
    v_pk_mul_f32 v[116:117], v[116:117], v[226:227]
    v_pk_mul_f32 v[118:119], v[118:119], v[228:229]
    v_cvt_pk_bf16_f32 v112, v112, v113
    v_cvt_pk_bf16_f32 v113, v114, v115
    v_cvt_pk_bf16_f32 v114, v116, v117
    v_cvt_pk_bf16_f32 v115, v118, v119
    ds_write_b128 v244, v[112:115] offset:6144
    s_add_u32 s36, s45, 688128
    buffer_store_dwordx4 v[112:115], v2, s[16:19], s36 offen sc1
    v_pk_fma_f32 v[36:37], v[164:165], v[148:149], v[36:37] op_sel_hi:[0,1,1] neg_lo:[1,0,0] neg_hi:[1,0,0]
    v_pk_fma_f32 v[38:39], v[164:165], v[150:151], v[38:39] op_sel_hi:[0,1,1] neg_lo:[1,0,0] neg_hi:[1,0,0]
    v_pk_mul_f32 v[226:227], v[36:37], v[36:37]
    v_pk_mul_f32 v[228:229], v[38:39], v[38:39]
    v_pk_fma_f32 v[226:227], v[226:227], v[166:167], v[166:167] op_sel:[0,1,0] op_sel_hi:[1,1,0]
    v_pk_fma_f32 v[228:229], v[228:229], v[166:167], v[166:167] op_sel:[0,1,0] op_sel_hi:[1,1,0]
    v_pk_mul_f32 v[226:227], v[226:227], v[36:37]
    v_pk_mul_f32 v[228:229], v[228:229], v[38:39]
    v_exp_f32 v226, v226
    v_exp_f32 v227, v227
    v_exp_f32 v228, v228
    v_exp_f32 v229, v229
    v_pk_fma_f32 v[226:227], v[226:227], v[164:165], v[164:165] op_sel:[0,1,1] op_sel_hi:[1,1,1]
    v_pk_fma_f32 v[228:229], v[228:229], v[164:165], v[164:165] op_sel:[0,1,1] op_sel_hi:[1,1,1]
    v_rcp_f32 v226, v226
    v_rcp_f32 v227, v227
    v_rcp_f32 v228, v228
    v_rcp_f32 v229, v229
    v_pk_mul_f32 v[36:37], v[36:37], v[226:227]
    v_pk_mul_f32 v[38:39], v[38:39], v[228:229]
    v_pk_fma_f32 v[40:41], v[164:165], v[152:153], v[40:41] op_sel_hi:[0,1,1] neg_lo:[1,0,0] neg_hi:[1,0,0]
    v_pk_fma_f32 v[42:43], v[164:165], v[154:155], v[42:43] op_sel_hi:[0,1,1] neg_lo:[1,0,0] neg_hi:[1,0,0]
    v_pk_mul_f32 v[226:227], v[40:41], v[40:41]
    v_pk_mul_f32 v[228:229], v[42:43], v[42:43]
    v_pk_fma_f32 v[226:227], v[226:227], v[166:167], v[166:167] op_sel:[0,1,0] op_sel_hi:[1,1,0]
    v_pk_fma_f32 v[228:229], v[228:229], v[166:167], v[166:167] op_sel:[0,1,0] op_sel_hi:[1,1,0]
    v_pk_mul_f32 v[226:227], v[226:227], v[40:41]
    v_pk_mul_f32 v[228:229], v[228:229], v[42:43]
    v_exp_f32 v226, v226
    v_exp_f32 v227, v227
    v_exp_f32 v228, v228
    v_exp_f32 v229, v229
    v_pk_fma_f32 v[226:227], v[226:227], v[164:165], v[164:165] op_sel:[0,1,1] op_sel_hi:[1,1,1]
    v_pk_fma_f32 v[228:229], v[228:229], v[164:165], v[164:165] op_sel:[0,1,1] op_sel_hi:[1,1,1]
    v_rcp_f32 v226, v226
    v_rcp_f32 v227, v227
    v_rcp_f32 v228, v228
    v_rcp_f32 v229, v229
    v_pk_mul_f32 v[40:41], v[40:41], v[226:227]
    v_pk_mul_f32 v[42:43], v[42:43], v[228:229]
    v_cvt_pk_bf16_f32 v36, v36, v37
    v_cvt_pk_bf16_f32 v37, v38, v39
    v_cvt_pk_bf16_f32 v38, v40, v41
    v_cvt_pk_bf16_f32 v39, v42, v43
    v_or_b32 v36, 1, v36
    ds_write_b128 v244, v[36:39] offset:16384
    v_pk_fma_f32 v[64:65], v[168:169], v[148:149], v[64:65] op_sel_hi:[0,1,1] neg_lo:[1,0,0] neg_hi:[1,0,0]
    v_pk_fma_f32 v[66:67], v[168:169], v[150:151], v[66:67] op_sel_hi:[0,1,1] neg_lo:[1,0,0] neg_hi:[1,0,0]
    v_pk_mul_f32 v[226:227], v[64:65], v[64:65]
    v_pk_mul_f32 v[228:229], v[66:67], v[66:67]
    v_pk_fma_f32 v[226:227], v[226:227], v[170:171], v[170:171] op_sel:[0,1,0] op_sel_hi:[1,1,0]
    v_pk_fma_f32 v[228:229], v[228:229], v[170:171], v[170:171] op_sel:[0,1,0] op_sel_hi:[1,1,0]
    v_pk_mul_f32 v[226:227], v[226:227], v[64:65]
    v_pk_mul_f32 v[228:229], v[228:229], v[66:67]
    v_exp_f32 v226, v226
    v_exp_f32 v227, v227
    v_exp_f32 v228, v228
    v_exp_f32 v229, v229
    v_pk_fma_f32 v[226:227], v[226:227], v[168:169], v[168:169] op_sel:[0,1,1] op_sel_hi:[1,1,1]
    v_pk_fma_f32 v[228:229], v[228:229], v[168:169], v[168:169] op_sel:[0,1,1] op_sel_hi:[1,1,1]
    v_rcp_f32 v226, v226
    v_rcp_f32 v227, v227
    v_rcp_f32 v228, v228
    v_rcp_f32 v229, v229
    v_pk_mul_f32 v[64:65], v[64:65], v[226:227]
    v_pk_mul_f32 v[66:67], v[66:67], v[228:229]
    v_pk_fma_f32 v[68:69], v[168:169], v[152:153], v[68:69] op_sel_hi:[0,1,1] neg_lo:[1,0,0] neg_hi:[1,0,0]
    v_pk_fma_f32 v[70:71], v[168:169], v[154:155], v[70:71] op_sel_hi:[0,1,1] neg_lo:[1,0,0] neg_hi:[1,0,0]
    v_pk_mul_f32 v[226:227], v[68:69], v[68:69]
    v_pk_mul_f32 v[228:229], v[70:71], v[70:71]
    v_pk_fma_f32 v[226:227], v[226:227], v[170:171], v[170:171] op_sel:[0,1,0] op_sel_hi:[1,1,0]
    v_pk_fma_f32 v[228:229], v[228:229], v[170:171], v[170:171] op_sel:[0,1,0] op_sel_hi:[1,1,0]
    v_pk_mul_f32 v[226:227], v[226:227], v[68:69]
    v_pk_mul_f32 v[228:229], v[228:229], v[70:71]
    v_exp_f32 v226, v226
    v_exp_f32 v227, v227
    v_exp_f32 v228, v228
    v_exp_f32 v229, v229
    v_pk_fma_f32 v[226:227], v[226:227], v[168:169], v[168:169] op_sel:[0,1,1] op_sel_hi:[1,1,1]
    v_pk_fma_f32 v[228:229], v[228:229], v[168:169], v[168:169] op_sel:[0,1,1] op_sel_hi:[1,1,1]
    v_rcp_f32 v226, v226
    v_rcp_f32 v227, v227
    v_rcp_f32 v228, v228
    v_rcp_f32 v229, v229
    v_pk_mul_f32 v[68:69], v[68:69], v[226:227]
    v_pk_mul_f32 v[70:71], v[70:71], v[228:229]
    v_cvt_pk_bf16_f32 v64, v64, v65
    v_cvt_pk_bf16_f32 v65, v66, v67
    v_cvt_pk_bf16_f32 v66, v68, v69
    v_cvt_pk_bf16_f32 v67, v70, v71
    v_or_b32 v64, 1, v64
    ds_write_b128 v244, v[64:67] offset:18432
    s_waitcnt vmcnt(0)
    s_mov_b64 exec, 1
    ds_add_u32 v246, v245
    s_mov_b64 exec, -1
    v_pk_fma_f32 v[92:93], v[172:173], v[148:149], v[92:93] op_sel_hi:[0,1,1] neg_lo:[1,0,0] neg_hi:[1,0,0]
    v_pk_fma_f32 v[94:95], v[172:173], v[150:151], v[94:95] op_sel_hi:[0,1,1] neg_lo:[1,0,0] neg_hi:[1,0,0]
    v_pk_mul_f32 v[226:227], v[92:93], v[92:93]
    v_pk_mul_f32 v[228:229], v[94:95], v[94:95]
    v_pk_fma_f32 v[226:227], v[226:227], v[174:175], v[174:175] op_sel:[0,1,0] op_sel_hi:[1,1,0]
    v_pk_fma_f32 v[228:229], v[228:229], v[174:175], v[174:175] op_sel:[0,1,0] op_sel_hi:[1,1,0]
    v_pk_mul_f32 v[226:227], v[226:227], v[92:93]
    v_pk_mul_f32 v[228:229], v[228:229], v[94:95]
    v_exp_f32 v226, v226
    v_exp_f32 v227, v227
    v_exp_f32 v228, v228
    v_exp_f32 v229, v229
    v_pk_fma_f32 v[226:227], v[226:227], v[172:173], v[172:173] op_sel:[0,1,1] op_sel_hi:[1,1,1]
    v_pk_fma_f32 v[228:229], v[228:229], v[172:173], v[172:173] op_sel:[0,1,1] op_sel_hi:[1,1,1]
    v_rcp_f32 v226, v226
    v_rcp_f32 v227, v227
    v_rcp_f32 v228, v228
    v_rcp_f32 v229, v229
    v_pk_mul_f32 v[92:93], v[92:93], v[226:227]
    v_pk_mul_f32 v[94:95], v[94:95], v[228:229]
    v_pk_fma_f32 v[96:97], v[172:173], v[152:153], v[96:97] op_sel_hi:[0,1,1] neg_lo:[1,0,0] neg_hi:[1,0,0]
    v_pk_fma_f32 v[98:99], v[172:173], v[154:155], v[98:99] op_sel_hi:[0,1,1] neg_lo:[1,0,0] neg_hi:[1,0,0]
    v_pk_mul_f32 v[226:227], v[96:97], v[96:97]
    v_pk_mul_f32 v[228:229], v[98:99], v[98:99]
    v_pk_fma_f32 v[226:227], v[226:227], v[174:175], v[174:175] op_sel:[0,1,0] op_sel_hi:[1,1,0]
    v_pk_fma_f32 v[228:229], v[228:229], v[174:175], v[174:175] op_sel:[0,1,0] op_sel_hi:[1,1,0]
    v_pk_mul_f32 v[226:227], v[226:227], v[96:97]
    v_pk_mul_f32 v[228:229], v[228:229], v[98:99]
    v_exp_f32 v226, v226
    v_exp_f32 v227, v227
    v_exp_f32 v228, v228
    v_exp_f32 v229, v229
    v_pk_fma_f32 v[226:227], v[226:227], v[172:173], v[172:173] op_sel:[0,1,1] op_sel_hi:[1,1,1]
    v_pk_fma_f32 v[228:229], v[228:229], v[172:173], v[172:173] op_sel:[0,1,1] op_sel_hi:[1,1,1]
    v_rcp_f32 v226, v226
    v_rcp_f32 v227, v227
    v_rcp_f32 v228, v228
    v_rcp_f32 v229, v229
    v_pk_mul_f32 v[96:97], v[96:97], v[226:227]
    v_pk_mul_f32 v[98:99], v[98:99], v[228:229]
    v_cvt_pk_bf16_f32 v92, v92, v93
    v_cvt_pk_bf16_f32 v93, v94, v95
    v_cvt_pk_bf16_f32 v94, v96, v97
    v_cvt_pk_bf16_f32 v95, v98, v99
    v_or_b32 v92, 1, v92
    ds_write_b128 v244, v[92:95] offset:20480
    s_cmp_eq_u32 s60, 1
    s_cbranch_scc1 G4_p11
    buffer_load_dwordx4 v[180:183], v196, s[84:87], 0 offen offset:0 sc1
    buffer_load_dwordx4 v[188:191], v196, s[88:91], 0 offen offset:0 sc1
    buffer_load_dwordx4 v[184:187], v196, s[84:87], 0 offen offset:2048 sc1
    buffer_load_dwordx4 v[192:195], v196, s[88:91], 0 offen offset:2048 sc1
    s_mov_b32 s78, 0
    buffer_load_dwordx2 v[230:231], v197, s[80:83], s78 offen sc1
    s_mov_b32 s78, 65536
    buffer_load_dwordx2 v[232:233], v197, s[80:83], s78 offen sc1
    s_mov_b32 s78, 262144
    buffer_load_dwordx2 v[234:235], v197, s[80:83], s78 offen sc1
    s_mov_b32 s78, 327680
    buffer_load_dwordx2 v[236:237], v197, s[80:83], s78 offen sc1
    s_branch G4_p21
G4_p11:
    s_add_u32 s36, s40, 0
    buffer_load_dwordx4 v[180:183], v2, s[84:87], s36 offen offset:0 sc1
    buffer_load_dwordx4 v[184:187], v2, s[88:91], s36 offen offset:0 sc1
    buffer_load_dwordx4 v[188:191], v2, s[84:87], s36 offen offset:1024 sc1
    buffer_load_dwordx4 v[192:195], v2, s[88:91], s36 offen offset:1024 sc1
    s_add_u32 s36, s40, 65536
    buffer_load_dwordx4 v[196:199], v2, s[84:87], s36 offen offset:0 sc1
    buffer_load_dwordx4 v[230:233], v2, s[88:91], s36 offen offset:0 sc1
    buffer_load_dwordx4 v[234:237], v2, s[84:87], s36 offen offset:1024 sc1
    buffer_load_dwordx4 v[248:251], v2, s[88:91], s36 offen offset:1024 sc1
G4_p21:
    v_pk_fma_f32 v[120:121], v[176:177], v[148:149], v[120:121] op_sel_hi:[0,1,1] neg_lo:[1,0,0] neg_hi:[1,0,0]
    v_pk_fma_f32 v[122:123], v[176:177], v[150:151], v[122:123] op_sel_hi:[0,1,1] neg_lo:[1,0,0] neg_hi:[1,0,0]
    v_pk_mul_f32 v[226:227], v[120:121], v[120:121]
    v_pk_mul_f32 v[228:229], v[122:123], v[122:123]
    v_pk_fma_f32 v[226:227], v[226:227], v[178:179], v[178:179] op_sel:[0,1,0] op_sel_hi:[1,1,0]
    v_pk_fma_f32 v[228:229], v[228:229], v[178:179], v[178:179] op_sel:[0,1,0] op_sel_hi:[1,1,0]
    v_pk_mul_f32 v[226:227], v[226:227], v[120:121]
    v_pk_mul_f32 v[228:229], v[228:229], v[122:123]
    v_exp_f32 v226, v226
    v_exp_f32 v227, v227
    v_exp_f32 v228, v228
    v_exp_f32 v229, v229
    v_pk_fma_f32 v[226:227], v[226:227], v[176:177], v[176:177] op_sel:[0,1,1] op_sel_hi:[1,1,1]
    v_pk_fma_f32 v[228:229], v[228:229], v[176:177], v[176:177] op_sel:[0,1,1] op_sel_hi:[1,1,1]
    v_rcp_f32 v226, v226
    v_rcp_f32 v227, v227
    v_rcp_f32 v228, v228
    v_rcp_f32 v229, v229
    v_pk_mul_f32 v[120:121], v[120:121], v[226:227]
    v_pk_mul_f32 v[122:123], v[122:123], v[228:229]
    v_pk_fma_f32 v[124:125], v[176:177], v[152:153], v[124:125] op_sel_hi:[0,1,1] neg_lo:[1,0,0] neg_hi:[1,0,0]
    v_pk_fma_f32 v[126:127], v[176:177], v[154:155], v[126:127] op_sel_hi:[0,1,1] neg_lo:[1,0,0] neg_hi:[1,0,0]
    v_pk_mul_f32 v[226:227], v[124:125], v[124:125]
    v_pk_mul_f32 v[228:229], v[126:127], v[126:127]
    v_pk_fma_f32 v[226:227], v[226:227], v[178:179], v[178:179] op_sel:[0,1,0] op_sel_hi:[1,1,0]
    v_pk_fma_f32 v[228:229], v[228:229], v[178:179], v[178:179] op_sel:[0,1,0] op_sel_hi:[1,1,0]
    v_pk_mul_f32 v[226:227], v[226:227], v[124:125]
    v_pk_mul_f32 v[228:229], v[228:229], v[126:127]
    v_exp_f32 v226, v226
    v_exp_f32 v227, v227
    v_exp_f32 v228, v228
    v_exp_f32 v229, v229
    v_pk_fma_f32 v[226:227], v[226:227], v[176:177], v[176:177] op_sel:[0,1,1] op_sel_hi:[1,1,1]
    v_pk_fma_f32 v[228:229], v[228:229], v[176:177], v[176:177] op_sel:[0,1,1] op_sel_hi:[1,1,1]
    v_rcp_f32 v226, v226
    v_rcp_f32 v227, v227
    v_rcp_f32 v228, v228
    v_rcp_f32 v229, v229
    v_pk_mul_f32 v[124:125], v[124:125], v[226:227]
    v_pk_mul_f32 v[126:127], v[126:127], v[228:229]
    v_cvt_pk_bf16_f32 v120, v120, v121
    v_cvt_pk_bf16_f32 v121, v122, v123
    v_cvt_pk_bf16_f32 v122, v124, v125
    v_cvt_pk_bf16_f32 v123, v126, v127
    ds_write_b128 v244, v[120:123] offset:22528
    v_pk_fma_f32 v[44:45], v[164:165], v[156:157], v[44:45] op_sel_hi:[0,1,1] neg_lo:[1,0,0] neg_hi:[1,0,0]
    v_pk_fma_f32 v[46:47], v[164:165], v[158:159], v[46:47] op_sel_hi:[0,1,1] neg_lo:[1,0,0] neg_hi:[1,0,0]
    v_pk_mul_f32 v[226:227], v[44:45], v[44:45]
    v_pk_mul_f32 v[228:229], v[46:47], v[46:47]
    v_pk_fma_f32 v[226:227], v[226:227], v[166:167], v[166:167] op_sel:[0,1,0] op_sel_hi:[1,1,0]
    v_pk_fma_f32 v[228:229], v[228:229], v[166:167], v[166:167] op_sel:[0,1,0] op_sel_hi:[1,1,0]
    v_pk_mul_f32 v[226:227], v[226:227], v[44:45]
    v_pk_mul_f32 v[228:229], v[228:229], v[46:47]
    v_exp_f32 v226, v226
    v_exp_f32 v227, v227
    v_exp_f32 v228, v228
    v_exp_f32 v229, v229
    v_pk_fma_f32 v[226:227], v[226:227], v[164:165], v[164:165] op_sel:[0,1,1] op_sel_hi:[1,1,1]
    v_pk_fma_f32 v[228:229], v[228:229], v[164:165], v[164:165] op_sel:[0,1,1] op_sel_hi:[1,1,1]
    v_rcp_f32 v226, v226
    v_rcp_f32 v227, v227
    v_rcp_f32 v228, v228
    v_rcp_f32 v229, v229
    v_pk_mul_f32 v[44:45], v[44:45], v[226:227]
    v_pk_mul_f32 v[46:47], v[46:47], v[228:229]
    v_pk_fma_f32 v[48:49], v[164:165], v[160:161], v[48:49] op_sel_hi:[0,1,1] neg_lo:[1,0,0] neg_hi:[1,0,0]
    v_pk_fma_f32 v[50:51], v[164:165], v[162:163], v[50:51] op_sel_hi:[0,1,1] neg_lo:[1,0,0] neg_hi:[1,0,0]
    v_pk_mul_f32 v[226:227], v[48:49], v[48:49]
    v_pk_mul_f32 v[228:229], v[50:51], v[50:51]
    v_pk_fma_f32 v[226:227], v[226:227], v[166:167], v[166:167] op_sel:[0,1,0] op_sel_hi:[1,1,0]
    v_pk_fma_f32 v[228:229], v[228:229], v[166:167], v[166:167] op_sel:[0,1,0] op_sel_hi:[1,1,0]
    v_pk_mul_f32 v[226:227], v[226:227], v[48:49]
    v_pk_mul_f32 v[228:229], v[228:229], v[50:51]
    v_exp_f32 v226, v226
    v_exp_f32 v227, v227
    v_exp_f32 v228, v228
    v_exp_f32 v229, v229
    v_pk_fma_f32 v[226:227], v[226:227], v[164:165], v[164:165] op_sel:[0,1,1] op_sel_hi:[1,1,1]
    v_pk_fma_f32 v[228:229], v[228:229], v[164:165], v[164:165] op_sel:[0,1,1] op_sel_hi:[1,1,1]
    v_rcp_f32 v226, v226
    v_rcp_f32 v227, v227
    v_rcp_f32 v228, v228
    v_rcp_f32 v229, v229
    v_pk_mul_f32 v[48:49], v[48:49], v[226:227]
    v_pk_mul_f32 v[50:51], v[50:51], v[228:229]
    v_cvt_pk_bf16_f32 v200, v44, v45
    v_cvt_pk_bf16_f32 v201, v46, v47
    v_cvt_pk_bf16_f32 v202, v48, v49
    v_cvt_pk_bf16_f32 v203, v50, v51
    v_or_b32 v200, 1, v200
    ds_write_b128 v244, v[200:203] offset:32768
    v_pk_fma_f32 v[72:73], v[168:169], v[156:157], v[72:73] op_sel_hi:[0,1,1] neg_lo:[1,0,0] neg_hi:[1,0,0]
    v_pk_fma_f32 v[74:75], v[168:169], v[158:159], v[74:75] op_sel_hi:[0,1,1] neg_lo:[1,0,0] neg_hi:[1,0,0]
    v_pk_mul_f32 v[226:227], v[72:73], v[72:73]
    v_pk_mul_f32 v[228:229], v[74:75], v[74:75]
    v_pk_fma_f32 v[226:227], v[226:227], v[170:171], v[170:171] op_sel:[0,1,0] op_sel_hi:[1,1,0]
    v_pk_fma_f32 v[228:229], v[228:229], v[170:171], v[170:171] op_sel:[0,1,0] op_sel_hi:[1,1,0]
    v_pk_mul_f32 v[226:227], v[226:227], v[72:73]
    v_pk_mul_f32 v[228:229], v[228:229], v[74:75]
    v_exp_f32 v226, v226
    v_exp_f32 v227, v227
    v_exp_f32 v228, v228
    v_exp_f32 v229, v229
    v_pk_fma_f32 v[226:227], v[226:227], v[168:169], v[168:169] op_sel:[0,1,1] op_sel_hi:[1,1,1]
    v_pk_fma_f32 v[228:229], v[228:229], v[168:169], v[168:169] op_sel:[0,1,1] op_sel_hi:[1,1,1]
    v_rcp_f32 v226, v226
    v_rcp_f32 v227, v227
    v_rcp_f32 v228, v228
    v_rcp_f32 v229, v229
    v_pk_mul_f32 v[72:73], v[72:73], v[226:227]
    v_pk_mul_f32 v[74:75], v[74:75], v[228:229]
    v_pk_fma_f32 v[76:77], v[168:169], v[160:161], v[76:77] op_sel_hi:[0,1,1] neg_lo:[1,0,0] neg_hi:[1,0,0]
    v_pk_fma_f32 v[78:79], v[168:169], v[162:163], v[78:79] op_sel_hi:[0,1,1] neg_lo:[1,0,0] neg_hi:[1,0,0]
    v_pk_mul_f32 v[226:227], v[76:77], v[76:77]
    v_pk_mul_f32 v[228:229], v[78:79], v[78:79]
    v_pk_fma_f32 v[226:227], v[226:227], v[170:171], v[170:171] op_sel:[0,1,0] op_sel_hi:[1,1,0]
    v_pk_fma_f32 v[228:229], v[228:229], v[170:171], v[170:171] op_sel:[0,1,0] op_sel_hi:[1,1,0]
    v_pk_mul_f32 v[226:227], v[226:227], v[76:77]
    v_pk_mul_f32 v[228:229], v[228:229], v[78:79]
    v_exp_f32 v226, v226
    v_exp_f32 v227, v227
    v_exp_f32 v228, v228
    v_exp_f32 v229, v229
    v_pk_fma_f32 v[226:227], v[226:227], v[168:169], v[168:169] op_sel:[0,1,1] op_sel_hi:[1,1,1]
    v_pk_fma_f32 v[228:229], v[228:229], v[168:169], v[168:169] op_sel:[0,1,1] op_sel_hi:[1,1,1]
    v_rcp_f32 v226, v226
    v_rcp_f32 v227, v227
    v_rcp_f32 v228, v228
    v_rcp_f32 v229, v229
    v_pk_mul_f32 v[76:77], v[76:77], v[226:227]
    v_pk_mul_f32 v[78:79], v[78:79], v[228:229]
    v_cvt_pk_bf16_f32 v204, v72, v73
    v_cvt_pk_bf16_f32 v205, v74, v75
    v_cvt_pk_bf16_f32 v206, v76, v77
    v_cvt_pk_bf16_f32 v207, v78, v79
    v_or_b32 v204, 1, v204
    ds_write_b128 v244, v[204:207] offset:34816
    v_pk_fma_f32 v[100:101], v[172:173], v[156:157], v[100:101] op_sel_hi:[0,1,1] neg_lo:[1,0,0] neg_hi:[1,0,0]
    v_pk_fma_f32 v[102:103], v[172:173], v[158:159], v[102:103] op_sel_hi:[0,1,1] neg_lo:[1,0,0] neg_hi:[1,0,0]
    v_pk_mul_f32 v[226:227], v[100:101], v[100:101]
    v_pk_mul_f32 v[228:229], v[102:103], v[102:103]
    v_pk_fma_f32 v[226:227], v[226:227], v[174:175], v[174:175] op_sel:[0,1,0] op_sel_hi:[1,1,0]
    v_pk_fma_f32 v[228:229], v[228:229], v[174:175], v[174:175] op_sel:[0,1,0] op_sel_hi:[1,1,0]
    v_pk_mul_f32 v[226:227], v[226:227], v[100:101]
    v_pk_mul_f32 v[228:229], v[228:229], v[102:103]
    v_exp_f32 v226, v226
    v_exp_f32 v227, v227
    v_exp_f32 v228, v228
    v_exp_f32 v229, v229
    v_pk_fma_f32 v[226:227], v[226:227], v[172:173], v[172:173] op_sel:[0,1,1] op_sel_hi:[1,1,1]
    v_pk_fma_f32 v[228:229], v[228:229], v[172:173], v[172:173] op_sel:[0,1,1] op_sel_hi:[1,1,1]
    v_rcp_f32 v226, v226
    v_rcp_f32 v227, v227
    v_rcp_f32 v228, v228
    v_rcp_f32 v229, v229
    v_pk_mul_f32 v[100:101], v[100:101], v[226:227]
    v_pk_mul_f32 v[102:103], v[102:103], v[228:229]
    v_pk_fma_f32 v[104:105], v[172:173], v[160:161], v[104:105] op_sel_hi:[0,1,1] neg_lo:[1,0,0] neg_hi:[1,0,0]
    v_pk_fma_f32 v[106:107], v[172:173], v[162:163], v[106:107] op_sel_hi:[0,1,1] neg_lo:[1,0,0] neg_hi:[1,0,0]
    v_pk_mul_f32 v[226:227], v[104:105], v[104:105]
    v_pk_mul_f32 v[228:229], v[106:107], v[106:107]
    v_pk_fma_f32 v[226:227], v[226:227], v[174:175], v[174:175] op_sel:[0,1,0] op_sel_hi:[1,1,0]
    v_pk_fma_f32 v[228:229], v[228:229], v[174:175], v[174:175] op_sel:[0,1,0] op_sel_hi:[1,1,0]
    v_pk_mul_f32 v[226:227], v[226:227], v[104:105]
    v_pk_mul_f32 v[228:229], v[228:229], v[106:107]
    v_exp_f32 v226, v226
    v_exp_f32 v227, v227
    v_exp_f32 v228, v228
    v_exp_f32 v229, v229
    v_pk_fma_f32 v[226:227], v[226:227], v[172:173], v[172:173] op_sel:[0,1,1] op_sel_hi:[1,1,1]
    v_pk_fma_f32 v[228:229], v[228:229], v[172:173], v[172:173] op_sel:[0,1,1] op_sel_hi:[1,1,1]
    v_rcp_f32 v226, v226
    v_rcp_f32 v227, v227
    v_rcp_f32 v228, v228
    v_rcp_f32 v229, v229
    v_pk_mul_f32 v[104:105], v[104:105], v[226:227]
    v_pk_mul_f32 v[106:107], v[106:107], v[228:229]
    v_cvt_pk_bf16_f32 v208, v100, v101
    v_cvt_pk_bf16_f32 v209, v102, v103
    v_cvt_pk_bf16_f32 v210, v104, v105
    v_cvt_pk_bf16_f32 v211, v106, v107
    v_or_b32 v208, 1, v208
    ds_write_b128 v244, v[208:211] offset:36864
    v_pk_fma_f32 v[128:129], v[176:177], v[156:157], v[128:129] op_sel_hi:[0,1,1] neg_lo:[1,0,0] neg_hi:[1,0,0]
    v_pk_fma_f32 v[130:131], v[176:177], v[158:159], v[130:131] op_sel_hi:[0,1,1] neg_lo:[1,0,0] neg_hi:[1,0,0]
    v_pk_mul_f32 v[226:227], v[128:129], v[128:129]
    v_pk_mul_f32 v[228:229], v[130:131], v[130:131]
    v_pk_fma_f32 v[226:227], v[226:227], v[178:179], v[178:179] op_sel:[0,1,0] op_sel_hi:[1,1,0]
    v_pk_fma_f32 v[228:229], v[228:229], v[178:179], v[178:179] op_sel:[0,1,0] op_sel_hi:[1,1,0]
    v_pk_mul_f32 v[226:227], v[226:227], v[128:129]
    v_pk_mul_f32 v[228:229], v[228:229], v[130:131]
    v_exp_f32 v226, v226
    v_exp_f32 v227, v227
    v_exp_f32 v228, v228
    v_exp_f32 v229, v229
    v_pk_fma_f32 v[226:227], v[226:227], v[176:177], v[176:177] op_sel:[0,1,1] op_sel_hi:[1,1,1]
    v_pk_fma_f32 v[228:229], v[228:229], v[176:177], v[176:177] op_sel:[0,1,1] op_sel_hi:[1,1,1]
    v_rcp_f32 v226, v226
    v_rcp_f32 v227, v227
    v_rcp_f32 v228, v228
    v_rcp_f32 v229, v229
    v_pk_mul_f32 v[128:129], v[128:129], v[226:227]
    v_pk_mul_f32 v[130:131], v[130:131], v[228:229]
    v_pk_fma_f32 v[132:133], v[176:177], v[160:161], v[132:133] op_sel_hi:[0,1,1] neg_lo:[1,0,0] neg_hi:[1,0,0]
    v_pk_fma_f32 v[134:135], v[176:177], v[162:163], v[134:135] op_sel_hi:[0,1,1] neg_lo:[1,0,0] neg_hi:[1,0,0]
    v_pk_mul_f32 v[226:227], v[132:133], v[132:133]
    v_pk_mul_f32 v[228:229], v[134:135], v[134:135]
    v_pk_fma_f32 v[226:227], v[226:227], v[178:179], v[178:179] op_sel:[0,1,0] op_sel_hi:[1,1,0]
    v_pk_fma_f32 v[228:229], v[228:229], v[178:179], v[178:179] op_sel:[0,1,0] op_sel_hi:[1,1,0]
    v_pk_mul_f32 v[226:227], v[226:227], v[132:133]
    v_pk_mul_f32 v[228:229], v[228:229], v[134:135]
    v_exp_f32 v226, v226
    v_exp_f32 v227, v227
    v_exp_f32 v228, v228
    v_exp_f32 v229, v229
    v_pk_fma_f32 v[226:227], v[226:227], v[176:177], v[176:177] op_sel:[0,1,1] op_sel_hi:[1,1,1]
    v_pk_fma_f32 v[228:229], v[228:229], v[176:177], v[176:177] op_sel:[0,1,1] op_sel_hi:[1,1,1]
    v_rcp_f32 v226, v226
    v_rcp_f32 v227, v227
    v_rcp_f32 v228, v228
    v_rcp_f32 v229, v229
    v_pk_mul_f32 v[132:133], v[132:133], v[226:227]
    v_pk_mul_f32 v[134:135], v[134:135], v[228:229]
    v_cvt_pk_bf16_f32 v212, v128, v129
    v_cvt_pk_bf16_f32 v213, v130, v131
    v_cvt_pk_bf16_f32 v214, v132, v133
    v_cvt_pk_bf16_f32 v215, v134, v135
    ds_write_b128 v244, v[212:215] offset:38912
    v_pk_fma_f32 v[24:25], v[164:165], v[136:137], v[24:25] op_sel_hi:[0,1,1] neg_lo:[1,0,0] neg_hi:[1,0,0]
    v_pk_fma_f32 v[26:27], v[164:165], v[138:139], v[26:27] op_sel_hi:[0,1,1] neg_lo:[1,0,0] neg_hi:[1,0,0]
    v_pk_mul_f32 v[226:227], v[24:25], v[24:25]
    v_pk_mul_f32 v[228:229], v[26:27], v[26:27]
    v_pk_fma_f32 v[226:227], v[226:227], v[166:167], v[166:167] op_sel:[0,1,0] op_sel_hi:[1,1,0]
    v_pk_fma_f32 v[228:229], v[228:229], v[166:167], v[166:167] op_sel:[0,1,0] op_sel_hi:[1,1,0]
    v_pk_mul_f32 v[226:227], v[226:227], v[24:25]
    v_pk_mul_f32 v[228:229], v[228:229], v[26:27]
    v_exp_f32 v226, v226
    v_exp_f32 v227, v227
    v_exp_f32 v228, v228
    v_exp_f32 v229, v229
    v_pk_fma_f32 v[226:227], v[226:227], v[164:165], v[164:165] op_sel:[0,1,1] op_sel_hi:[1,1,1]
    v_pk_fma_f32 v[228:229], v[228:229], v[164:165], v[164:165] op_sel:[0,1,1] op_sel_hi:[1,1,1]
    v_rcp_f32 v226, v226
    v_rcp_f32 v227, v227
    v_rcp_f32 v228, v228
    v_rcp_f32 v229, v229
    v_pk_mul_f32 v[24:25], v[24:25], v[226:227]
    v_pk_mul_f32 v[26:27], v[26:27], v[228:229]
    v_cvt_pk_bf16_f32 v216, v24, v25
    v_cvt_pk_bf16_f32 v217, v26, v27
    v_or_b32 v216, 1, v216
    s_add_u32 s36, s46, 0
    buffer_store_dwordx4 v[36:39], v2, s[16:19], s36 offen sc1
    v_pk_fma_f32 v[52:53], v[168:169], v[136:137], v[52:53] op_sel_hi:[0,1,1] neg_lo:[1,0,0] neg_hi:[1,0,0]
    v_pk_fma_f32 v[54:55], v[168:169], v[138:139], v[54:55] op_sel_hi:[0,1,1] neg_lo:[1,0,0] neg_hi:[1,0,0]
    v_pk_mul_f32 v[226:227], v[52:53], v[52:53]
    v_pk_mul_f32 v[228:229], v[54:55], v[54:55]
    v_pk_fma_f32 v[226:227], v[226:227], v[170:171], v[170:171] op_sel:[0,1,0] op_sel_hi:[1,1,0]
    v_pk_fma_f32 v[228:229], v[228:229], v[170:171], v[170:171] op_sel:[0,1,0] op_sel_hi:[1,1,0]
    v_pk_mul_f32 v[226:227], v[226:227], v[52:53]
    v_pk_mul_f32 v[228:229], v[228:229], v[54:55]
    v_exp_f32 v226, v226
    v_exp_f32 v227, v227
    v_exp_f32 v228, v228
    v_exp_f32 v229, v229
    v_pk_fma_f32 v[226:227], v[226:227], v[168:169], v[168:169] op_sel:[0,1,1] op_sel_hi:[1,1,1]
    v_pk_fma_f32 v[228:229], v[228:229], v[168:169], v[168:169] op_sel:[0,1,1] op_sel_hi:[1,1,1]
    v_rcp_f32 v226, v226
    v_rcp_f32 v227, v227
    v_rcp_f32 v228, v228
    v_rcp_f32 v229, v229
    v_pk_mul_f32 v[52:53], v[52:53], v[226:227]
    v_pk_mul_f32 v[54:55], v[54:55], v[228:229]
    v_cvt_pk_bf16_f32 v218, v52, v53
    v_cvt_pk_bf16_f32 v219, v54, v55
    v_or_b32 v218, 1, v218
    s_add_u32 s36, s46, 229376
    buffer_store_dwordx4 v[64:67], v2, s[16:19], s36 offen sc1
    v_pk_fma_f32 v[80:81], v[172:173], v[136:137], v[80:81] op_sel_hi:[0,1,1] neg_lo:[1,0,0] neg_hi:[1,0,0]
    v_pk_fma_f32 v[82:83], v[172:173], v[138:139], v[82:83] op_sel_hi:[0,1,1] neg_lo:[1,0,0] neg_hi:[1,0,0]
    v_pk_mul_f32 v[226:227], v[80:81], v[80:81]
    v_pk_mul_f32 v[228:229], v[82:83], v[82:83]
    v_pk_fma_f32 v[226:227], v[226:227], v[174:175], v[174:175] op_sel:[0,1,0] op_sel_hi:[1,1,0]
    v_pk_fma_f32 v[228:229], v[228:229], v[174:175], v[174:175] op_sel:[0,1,0] op_sel_hi:[1,1,0]
    v_pk_mul_f32 v[226:227], v[226:227], v[80:81]
    v_pk_mul_f32 v[228:229], v[228:229], v[82:83]
    v_exp_f32 v226, v226
    v_exp_f32 v227, v227
    v_exp_f32 v228, v228
    v_exp_f32 v229, v229
    v_pk_fma_f32 v[226:227], v[226:227], v[172:173], v[172:173] op_sel:[0,1,1] op_sel_hi:[1,1,1]
    v_pk_fma_f32 v[228:229], v[228:229], v[172:173], v[172:173] op_sel:[0,1,1] op_sel_hi:[1,1,1]
    v_rcp_f32 v226, v226
    v_rcp_f32 v227, v227
    v_rcp_f32 v228, v228
    v_rcp_f32 v229, v229
    v_pk_mul_f32 v[80:81], v[80:81], v[226:227]
    v_pk_mul_f32 v[82:83], v[82:83], v[228:229]
    v_cvt_pk_bf16_f32 v220, v80, v81
    v_cvt_pk_bf16_f32 v221, v82, v83
    v_or_b32 v220, 1, v220
    s_add_u32 s36, s46, 458752
    buffer_store_dwordx4 v[92:95], v2, s[16:19], s36 offen sc1
    v_pk_fma_f32 v[108:109], v[176:177], v[136:137], v[108:109] op_sel_hi:[0,1,1] neg_lo:[1,0,0] neg_hi:[1,0,0]
    v_pk_fma_f32 v[110:111], v[176:177], v[138:139], v[110:111] op_sel_hi:[0,1,1] neg_lo:[1,0,0] neg_hi:[1,0,0]
    v_pk_mul_f32 v[226:227], v[108:109], v[108:109]
    v_pk_mul_f32 v[228:229], v[110:111], v[110:111]
    v_pk_fma_f32 v[226:227], v[226:227], v[178:179], v[178:179] op_sel:[0,1,0] op_sel_hi:[1,1,0]
    v_pk_fma_f32 v[228:229], v[228:229], v[178:179], v[178:179] op_sel:[0,1,0] op_sel_hi:[1,1,0]
    v_pk_mul_f32 v[226:227], v[226:227], v[108:109]
    v_pk_mul_f32 v[228:229], v[228:229], v[110:111]
    v_exp_f32 v226, v226
    v_exp_f32 v227, v227
    v_exp_f32 v228, v228
    v_exp_f32 v229, v229
    v_pk_fma_f32 v[226:227], v[226:227], v[176:177], v[176:177] op_sel:[0,1,1] op_sel_hi:[1,1,1]
    v_pk_fma_f32 v[228:229], v[228:229], v[176:177], v[176:177] op_sel:[0,1,1] op_sel_hi:[1,1,1]
    v_rcp_f32 v226, v226
    v_rcp_f32 v227, v227
    v_rcp_f32 v228, v228
    v_rcp_f32 v229, v229
    v_pk_mul_f32 v[108:109], v[108:109], v[226:227]
    v_pk_mul_f32 v[110:111], v[110:111], v[228:229]
    v_cvt_pk_bf16_f32 v222, v108, v109
    v_cvt_pk_bf16_f32 v223, v110, v111
    s_add_u32 s36, s46, 688128
    buffer_store_dwordx4 v[120:123], v2, s[16:19], s36 offen sc1
    s_waitcnt lgkmcnt(0)
    s_add_u32 s45, s44, 512
    s_mov_b32 s44, s47
G3_e2:
    s_waitcnt lgkmcnt(0)
    s_barrier
    ds_read_b128 v[88:91], v17 offset:0
    ds_read_b128 v[92:95], v17 offset:2048
    ds_read_b128 v[96:99], v17 offset:4096
    ds_read_b128 v[100:103], v17 offset:6144
    ds_read_b64_tr_b16 v[104:105], v18 offset:0
    ds_read_b64_tr_b16 v[106:107], v18 offset:4096
    ds_read_b64_tr_b16 v[108:109], v19 offset:0
    ds_read_b64_tr_b16 v[110:111], v19 offset:4096
    ds_read_b64_tr_b16 v[112:113], v20 offset:0
    ds_read_b64_tr_b16 v[114:115], v20 offset:4096
    ds_read_b64_tr_b16 v[116:117], v21 offset:0
    ds_read_b64_tr_b16 v[118:119], v21 offset:4096
    s_waitcnt lgkmcnt(6)
    v_mfma_f32_16x16x32_bf16 v[24:27], v[104:107], v[88:91], 0
    ds_read_b128 v[120:123], v17 offset:1024
    s_add_u32 s42, s42, 16384
    v_mfma_f32_16x16x32_bf16 v[40:43], v[104:107], v[92:95], 0
    ds_read_b128 v[124:127], v17 offset:3072
    s_cmp_eq_u32 s42, 49152
    v_mfma_f32_16x16x32_bf16 v[56:59], v[104:107], v[96:99], 0
    ds_read_b128 v[128:131], v17 offset:5120
    s_cselect_b32 s42, 0, s42
    v_mfma_f32_16x16x32_bf16 v[72:75], v[104:107], v[100:103], 0
    ds_read_b128 v[132:135], v17 offset:7168
    s_waitcnt lgkmcnt(8)
    v_mfma_f32_16x16x32_bf16 v[76:79], v[108:111], v[100:103], 0
    ds_read_b64_tr_b16 v[136:137], v18 offset:8192
    s_add_u32 s48, s48, 16384
    v_mfma_f32_16x16x32_bf16 v[60:63], v[108:111], v[96:99], 0
    ds_read_b64_tr_b16 v[138:139], v18 offset:12288
    s_cmp_eq_u32 s48, 98304
    v_mfma_f32_16x16x32_bf16 v[44:47], v[108:111], v[92:95], 0
    ds_read_b64_tr_b16 v[140:141], v19 offset:8192
    s_cselect_b32 s48, 0, s48
    v_mfma_f32_16x16x32_bf16 v[28:31], v[108:111], v[88:91], 0
    ds_read_b64_tr_b16 v[142:143], v19 offset:12288
    s_waitcnt lgkmcnt(8)
    v_mfma_f32_16x16x32_bf16 v[32:35], v[112:115], v[88:91], 0
    ds_read_b64_tr_b16 v[144:145], v20 offset:8192
    v_add_u32 v17, s42, v12
    v_mfma_f32_16x16x32_bf16 v[48:51], v[112:115], v[92:95], 0
    ds_read_b64_tr_b16 v[146:147], v20 offset:12288
    s_add_u32 s36, s44, 0
    v_mfma_f32_16x16x32_bf16 v[64:67], v[112:115], v[96:99], 0
    ds_read_b64_tr_b16 v[148:149], v21 offset:8192
    buffer_store_dwordx4 v[200:203], v2, s[16:19], s36 offen sc1
    v_mfma_f32_16x16x32_bf16 v[80:83], v[112:115], v[100:103], 0
    ds_read_b64_tr_b16 v[150:151], v21 offset:12288
    s_add_u32 s36, s45, 0
    v_mfma_f32_16x16x32_bf16 v[84:87], v[116:119], v[100:103], 0
    buffer_store_dwordx2 v[216:217], v238, s[16:19], s36 offen sc1
    v_add_u32 v18, s48, v13
    v_mfma_f32_16x16x32_bf16 v[68:71], v[116:119], v[96:99], 0
    v_add_u32 v19, s48, v14
    v_mfma_f32_16x16x32_bf16 v[52:55], v[116:119], v[92:95], 0
    v_add_u32 v20, s48, v15
    v_mfma_f32_16x16x32_bf16 v[36:39], v[116:119], v[88:91], 0
    v_add_u32 v21, s48, v16
    s_waitcnt lgkmcnt(6)
    v_mfma_f32_16x16x32_bf16 v[24:27], v[136:139], v[120:123], v[24:27]
    v_mfma_f32_16x16x32_bf16 v[40:43], v[136:139], v[124:127], v[40:43]
    v_mfma_f32_16x16x32_bf16 v[56:59], v[136:139], v[128:131], v[56:59]
    s_waitcnt lgkmcnt(0)
    s_barrier
    v_mfma_f32_16x16x32_bf16 v[72:75], v[136:139], v[132:135], v[72:75]
    ds_read_b128 v[88:91], v17 offset:0
    s_add_u32 s36, s44, 229376
    v_mfma_f32_16x16x32_bf16 v[76:79], v[140:143], v[132:135], v[76:79]
    ds_read_b128 v[92:95], v17 offset:2048
    buffer_store_dwordx4 v[204:207], v2, s[16:19], s36 offen sc1
    v_mfma_f32_16x16x32_bf16 v[60:63], v[140:143], v[128:131], v[60:63]
    ds_read_b128 v[96:99], v17 offset:4096
    s_add_u32 s36, s45, 229376
    v_mfma_f32_16x16x32_bf16 v[44:47], v[140:143], v[124:127], v[44:47]
    ds_read_b128 v[100:103], v17 offset:6144
    buffer_store_dwordx2 v[218:219], v238, s[16:19], s36 offen sc1
    v_mfma_f32_16x16x32_bf16 v[28:31], v[140:143], v[120:123], v[28:31]
    ds_read_b64_tr_b16 v[104:105], v18 offset:0
    s_add_u32 s43, s43, 1
    v_mfma_f32_16x16x32_bf16 v[32:35], v[144:147], v[120:123], v[32:35]
    ds_read_b64_tr_b16 v[106:107], v18 offset:4096
    s_cmp_lt_u32 s43, 27
    v_mfma_f32_16x16x32_bf16 v[48:51], v[144:147], v[124:127], v[48:51]
    ds_read_b64_tr_b16 v[108:109], v19 offset:0
    v_mfma_f32_16x16x32_bf16 v[64:67], v[144:147], v[128:131], v[64:67]
    ds_read_b64_tr_b16 v[110:111], v19 offset:4096
    v_mfma_f32_16x16x32_bf16 v[80:83], v[144:147], v[132:135], v[80:83]
    ds_read_b64_tr_b16 v[112:113], v20 offset:0
    v_mfma_f32_16x16x32_bf16 v[84:87], v[148:151], v[132:135], v[84:87]
    ds_read_b64_tr_b16 v[114:115], v20 offset:4096
    v_mfma_f32_16x16x32_bf16 v[68:71], v[148:151], v[128:131], v[68:71]
    ds_read_b64_tr_b16 v[116:117], v21 offset:0
    v_mfma_f32_16x16x32_bf16 v[52:55], v[148:151], v[124:127], v[52:55]
    ds_read_b64_tr_b16 v[118:119], v21 offset:4096
    v_mfma_f32_16x16x32_bf16 v[36:39], v[148:151], v[120:123], v[36:39]
    s_waitcnt lgkmcnt(6)
    v_mfma_f32_16x16x32_bf16 v[24:27], v[104:107], v[88:91], v[24:27]
    ds_read_b128 v[120:123], v17 offset:1024
    s_add_u32 s42, s42, 16384
    v_mfma_f32_16x16x32_bf16 v[40:43], v[104:107], v[92:95], v[40:43]
    ds_read_b128 v[124:127], v17 offset:3072
    s_cmp_eq_u32 s42, 49152
    v_mfma_f32_16x16x32_bf16 v[56:59], v[104:107], v[96:99], v[56:59]
    ds_read_b128 v[128:131], v17 offset:5120
    s_cselect_b32 s42, 0, s42
    v_mfma_f32_16x16x32_bf16 v[72:75], v[104:107], v[100:103], v[72:75]
    ds_read_b128 v[132:135], v17 offset:7168
    s_waitcnt lgkmcnt(8)
    v_mfma_f32_16x16x32_bf16 v[76:79], v[108:111], v[100:103], v[76:79]
    ds_read_b64_tr_b16 v[136:137], v18 offset:8192
    s_add_u32 s48, s48, 16384
    v_mfma_f32_16x16x32_bf16 v[60:63], v[108:111], v[96:99], v[60:63]
    ds_read_b64_tr_b16 v[138:139], v18 offset:12288
    s_cmp_eq_u32 s48, 98304
    v_mfma_f32_16x16x32_bf16 v[44:47], v[108:111], v[92:95], v[44:47]
    ds_read_b64_tr_b16 v[140:141], v19 offset:8192
    s_cselect_b32 s48, 0, s48
    v_mfma_f32_16x16x32_bf16 v[28:31], v[108:111], v[88:91], v[28:31]
    ds_read_b64_tr_b16 v[142:143], v19 offset:12288
    s_waitcnt lgkmcnt(8)
    v_mfma_f32_16x16x32_bf16 v[32:35], v[112:115], v[88:91], v[32:35]
    ds_read_b64_tr_b16 v[144:145], v20 offset:8192
    v_add_u32 v17, s42, v12
    v_mfma_f32_16x16x32_bf16 v[48:51], v[112:115], v[92:95], v[48:51]
    ds_read_b64_tr_b16 v[146:147], v20 offset:12288
    s_add_u32 s36, s44, 458752
    v_mfma_f32_16x16x32_bf16 v[64:67], v[112:115], v[96:99], v[64:67]
    ds_read_b64_tr_b16 v[148:149], v21 offset:8192
    buffer_store_dwordx4 v[208:211], v2, s[16:19], s36 offen sc1
    v_mfma_f32_16x16x32_bf16 v[80:83], v[112:115], v[100:103], v[80:83]
    ds_read_b64_tr_b16 v[150:151], v21 offset:12288
    s_add_u32 s36, s45, 458752
    v_mfma_f32_16x16x32_bf16 v[84:87], v[116:119], v[100:103], v[84:87]
    buffer_store_dwordx2 v[220:221], v238, s[16:19], s36 offen sc1
    v_add_u32 v18, s48, v13
    v_mfma_f32_16x16x32_bf16 v[68:71], v[116:119], v[96:99], v[68:71]
    v_add_u32 v19, s48, v14
    v_mfma_f32_16x16x32_bf16 v[52:55], v[116:119], v[92:95], v[52:55]
    v_add_u32 v20, s48, v15
    v_mfma_f32_16x16x32_bf16 v[36:39], v[116:119], v[88:91], v[36:39]
    v_add_u32 v21, s48, v16
    s_waitcnt lgkmcnt(6)
    v_mfma_f32_16x16x32_bf16 v[24:27], v[136:139], v[120:123], v[24:27]
    v_mfma_f32_16x16x32_bf16 v[40:43], v[136:139], v[124:127], v[40:43]
    s_waitcnt vmcnt(6)
    v_mfma_f32_16x16x32_bf16 v[56:59], v[136:139], v[128:131], v[56:59]
    s_waitcnt lgkmcnt(0)
    s_barrier
    v_mfma_f32_16x16x32_bf16 v[72:75], v[136:139], v[132:135], v[72:75]
    ds_read_b128 v[88:91], v17 offset:0
    s_add_u32 s36, s44, 688128
    v_mfma_f32_16x16x32_bf16 v[76:79], v[140:143], v[132:135], v[76:79]
    ds_read_b128 v[92:95], v17 offset:2048
    buffer_store_dwordx4 v[212:215], v2, s[16:19], s36 offen sc1
    v_mfma_f32_16x16x32_bf16 v[60:63], v[140:143], v[128:131], v[60:63]
    ds_read_b128 v[96:99], v17 offset:4096
    s_add_u32 s36, s45, 688128
    v_mfma_f32_16x16x32_bf16 v[44:47], v[140:143], v[124:127], v[44:47]
    ds_read_b128 v[100:103], v17 offset:6144
    buffer_store_dwordx2 v[222:223], v238, s[16:19], s36 offen sc1
    v_mfma_f32_16x16x32_bf16 v[28:31], v[140:143], v[120:123], v[28:31]
    ds_read_b64_tr_b16 v[104:105], v18 offset:0
    s_add_u32 s43, s43, 1
    v_mfma_f32_16x16x32_bf16 v[32:35], v[144:147], v[120:123], v[32:35]
    ds_read_b64_tr_b16 v[106:107], v18 offset:4096
    s_cmp_lt_u32 s43, 27
    v_mfma_f32_16x16x32_bf16 v[48:51], v[144:147], v[124:127], v[48:51]
    ds_read_b64_tr_b16 v[108:109], v19 offset:0
    v_mfma_f32_16x16x32_bf16 v[64:67], v[144:147], v[128:131], v[64:67]
    ds_read_b64_tr_b16 v[110:111], v19 offset:4096
    v_mfma_f32_16x16x32_bf16 v[80:83], v[144:147], v[132:135], v[80:83]
    ds_read_b64_tr_b16 v[112:113], v20 offset:0
    v_mfma_f32_16x16x32_bf16 v[84:87], v[148:151], v[132:135], v[84:87]
    ds_read_b64_tr_b16 v[114:115], v20 offset:4096
    v_mfma_f32_16x16x32_bf16 v[68:71], v[148:151], v[128:131], v[68:71]
    ds_read_b64_tr_b16 v[116:117], v21 offset:0
    v_mfma_f32_16x16x32_bf16 v[52:55], v[148:151], v[124:127], v[52:55]
    ds_read_b64_tr_b16 v[118:119], v21 offset:4096
    v_mfma_f32_16x16x32_bf16 v[36:39], v[148:151], v[120:123], v[36:39]
    s_waitcnt lgkmcnt(6)
mm_24:
    v_mfma_f32_16x16x32_bf16 v[24:27], v[104:107], v[88:91], v[24:27]
    ds_read_b128 v[120:123], v17 offset:1024
    s_add_u32 s42, s42, 16384
    v_mfma_f32_16x16x32_bf16 v[40:43], v[104:107], v[92:95], v[40:43]
    ds_read_b128 v[124:127], v17 offset:3072
    s_cmp_eq_u32 s42, 49152
    v_mfma_f32_16x16x32_bf16 v[56:59], v[104:107], v[96:99], v[56:59]
    ds_read_b128 v[128:131], v17 offset:5120
    s_cselect_b32 s42, 0, s42
    v_mfma_f32_16x16x32_bf16 v[72:75], v[104:107], v[100:103], v[72:75]
    ds_read_b128 v[132:135], v17 offset:7168
    s_waitcnt lgkmcnt(8)
    v_mfma_f32_16x16x32_bf16 v[76:79], v[108:111], v[100:103], v[76:79]
    ds_read_b64_tr_b16 v[136:137], v18 offset:8192
    s_add_u32 s48, s48, 16384
    v_mfma_f32_16x16x32_bf16 v[60:63], v[108:111], v[96:99], v[60:63]
    ds_read_b64_tr_b16 v[138:139], v18 offset:12288
    s_cmp_eq_u32 s48, 98304
    v_mfma_f32_16x16x32_bf16 v[44:47], v[108:111], v[92:95], v[44:47]
    ds_read_b64_tr_b16 v[140:141], v19 offset:8192
    s_cselect_b32 s48, 0, s48
    v_mfma_f32_16x16x32_bf16 v[28:31], v[108:111], v[88:91], v[28:31]
    ds_read_b64_tr_b16 v[142:143], v19 offset:12288
    s_waitcnt lgkmcnt(8)
    v_mfma_f32_16x16x32_bf16 v[32:35], v[112:115], v[88:91], v[32:35]
    ds_read_b64_tr_b16 v[144:145], v20 offset:8192
    v_add_u32 v17, s42, v12
    v_mfma_f32_16x16x32_bf16 v[48:51], v[112:115], v[92:95], v[48:51]
    ds_read_b64_tr_b16 v[146:147], v20 offset:12288
    v_add_u32 v18, s48, v13
    v_mfma_f32_16x16x32_bf16 v[64:67], v[112:115], v[96:99], v[64:67]
    ds_read_b64_tr_b16 v[148:149], v21 offset:8192
    v_add_u32 v19, s48, v14
    v_mfma_f32_16x16x32_bf16 v[80:83], v[112:115], v[100:103], v[80:83]
    ds_read_b64_tr_b16 v[150:151], v21 offset:12288
    v_add_u32 v20, s48, v15
    v_mfma_f32_16x16x32_bf16 v[84:87], v[116:119], v[100:103], v[84:87]
    v_add_u32 v21, s48, v16
    v_mfma_f32_16x16x32_bf16 v[68:71], v[116:119], v[96:99], v[68:71]
    v_mfma_f32_16x16x32_bf16 v[52:55], v[116:119], v[92:95], v[52:55]
    v_mfma_f32_16x16x32_bf16 v[36:39], v[116:119], v[88:91], v[36:39]
    s_waitcnt lgkmcnt(6)
    v_mfma_f32_16x16x32_bf16 v[24:27], v[136:139], v[120:123], v[24:27]
    s_add_u32 s43, s43, 1
    s_cmp_lt_u32 s43, 4
    v_mfma_f32_16x16x32_bf16 v[40:43], v[136:139], v[124:127], v[40:43]
    v_mfma_f32_16x16x32_bf16 v[56:59], v[136:139], v[128:131], v[56:59]
    s_waitcnt lgkmcnt(0)
    s_barrier
    v_mfma_f32_16x16x32_bf16 v[72:75], v[136:139], v[132:135], v[72:75]
    ds_read_b128 v[88:91], v17 offset:0
    v_mfma_f32_16x16x32_bf16 v[76:79], v[140:143], v[132:135], v[76:79]
    ds_read_b128 v[92:95], v17 offset:2048
    v_mfma_f32_16x16x32_bf16 v[60:63], v[140:143], v[128:131], v[60:63]
    ds_read_b128 v[96:99], v17 offset:4096
    v_mfma_f32_16x16x32_bf16 v[44:47], v[140:143], v[124:127], v[44:47]
    ds_read_b128 v[100:103], v17 offset:6144
    v_mfma_f32_16x16x32_bf16 v[28:31], v[140:143], v[120:123], v[28:31]
    ds_read_b64_tr_b16 v[104:105], v18 offset:0
    v_mfma_f32_16x16x32_bf16 v[32:35], v[144:147], v[120:123], v[32:35]
    ds_read_b64_tr_b16 v[106:107], v18 offset:4096
    v_mfma_f32_16x16x32_bf16 v[48:51], v[144:147], v[124:127], v[48:51]
    ds_read_b64_tr_b16 v[108:109], v19 offset:0
    v_mfma_f32_16x16x32_bf16 v[64:67], v[144:147], v[128:131], v[64:67]
    ds_read_b64_tr_b16 v[110:111], v19 offset:4096
    v_mfma_f32_16x16x32_bf16 v[80:83], v[144:147], v[132:135], v[80:83]
    ds_read_b64_tr_b16 v[112:113], v20 offset:0
    v_mfma_f32_16x16x32_bf16 v[84:87], v[148:151], v[132:135], v[84:87]
    ds_read_b64_tr_b16 v[114:115], v20 offset:4096
    v_mfma_f32_16x16x32_bf16 v[68:71], v[148:151], v[128:131], v[68:71]
    ds_read_b64_tr_b16 v[116:117], v21 offset:0
    v_mfma_f32_16x16x32_bf16 v[52:55], v[148:151], v[124:127], v[52:55]
    ds_read_b64_tr_b16 v[118:119], v21 offset:4096
    v_mfma_f32_16x16x32_bf16 v[36:39], v[148:151], v[120:123], v[36:39]
    s_waitcnt lgkmcnt(6)
    s_cbranch_scc1 mm_24
mm_25:
    v_mfma_f32_16x16x32_bf16 v[24:27], v[104:107], v[88:91], v[24:27]
    ds_read_b128 v[120:123], v17 offset:1024
    s_add_u32 s42, s42, 16384
    v_mfma_f32_16x16x32_bf16 v[40:43], v[104:107], v[92:95], v[40:43]
    ds_read_b128 v[124:127], v17 offset:3072
    s_cmp_eq_u32 s42, 49152
    v_mfma_f32_16x16x32_bf16 v[56:59], v[104:107], v[96:99], v[56:59]
    ds_read_b128 v[128:131], v17 offset:5120
    s_cselect_b32 s42, 0, s42
    v_mfma_f32_16x16x32_bf16 v[72:75], v[104:107], v[100:103], v[72:75]
    ds_read_b128 v[132:135], v17 offset:7168
    s_waitcnt lgkmcnt(8)
    v_mfma_f32_16x16x32_bf16 v[76:79], v[108:111], v[100:103], v[76:79]
    ds_read_b64_tr_b16 v[136:137], v18 offset:8192
    s_add_u32 s48, s48, 16384
    v_mfma_f32_16x16x32_bf16 v[60:63], v[108:111], v[96:99], v[60:63]
    ds_read_b64_tr_b16 v[138:139], v18 offset:12288
    s_cmp_eq_u32 s48, 98304
    v_mfma_f32_16x16x32_bf16 v[44:47], v[108:111], v[92:95], v[44:47]
    ds_read_b64_tr_b16 v[140:141], v19 offset:8192
    s_cselect_b32 s48, 0, s48
    v_mfma_f32_16x16x32_bf16 v[28:31], v[108:111], v[88:91], v[28:31]
    ds_read_b64_tr_b16 v[142:143], v19 offset:12288
    s_waitcnt lgkmcnt(8)
    v_mfma_f32_16x16x32_bf16 v[32:35], v[112:115], v[88:91], v[32:35]
    ds_read_b64_tr_b16 v[144:145], v20 offset:8192
    v_add_u32 v17, s42, v12
    v_mfma_f32_16x16x32_bf16 v[48:51], v[112:115], v[92:95], v[48:51]
    ds_read_b64_tr_b16 v[146:147], v20 offset:12288
    v_add_u32 v18, s48, v13
    v_mfma_f32_16x16x32_bf16 v[64:67], v[112:115], v[96:99], v[64:67]
    ds_read_b64_tr_b16 v[148:149], v21 offset:8192
    v_add_u32 v19, s48, v14
    v_mfma_f32_16x16x32_bf16 v[80:83], v[112:115], v[100:103], v[80:83]
    ds_read_b64_tr_b16 v[150:151], v21 offset:12288
    v_add_u32 v20, s48, v15
    v_mfma_f32_16x16x32_bf16 v[84:87], v[116:119], v[100:103], v[84:87]
    v_add_u32 v21, s48, v16
    v_mfma_f32_16x16x32_bf16 v[68:71], v[116:119], v[96:99], v[68:71]
    v_mfma_f32_16x16x32_bf16 v[52:55], v[116:119], v[92:95], v[52:55]
    v_mfma_f32_16x16x32_bf16 v[36:39], v[116:119], v[88:91], v[36:39]
    s_waitcnt lgkmcnt(6)
    v_mfma_f32_16x16x32_bf16 v[24:27], v[136:139], v[120:123], v[24:27]
    s_add_u32 s43, s43, 1
    s_cmp_lt_u32 s43, 27
    v_mfma_f32_16x16x32_bf16 v[40:43], v[136:139], v[124:127], v[40:43]
    s_waitcnt vmcnt(0)
    v_mfma_f32_16x16x32_bf16 v[56:59], v[136:139], v[128:131], v[56:59]
    s_waitcnt lgkmcnt(0)
    s_barrier
    v_mfma_f32_16x16x32_bf16 v[72:75], v[136:139], v[132:135], v[72:75]
    ds_read_b128 v[88:91], v17 offset:0
    v_mfma_f32_16x16x32_bf16 v[76:79], v[140:143], v[132:135], v[76:79]
    ds_read_b128 v[92:95], v17 offset:2048
    v_mfma_f32_16x16x32_bf16 v[60:63], v[140:143], v[128:131], v[60:63]
    ds_read_b128 v[96:99], v17 offset:4096
    v_mfma_f32_16x16x32_bf16 v[44:47], v[140:143], v[124:127], v[44:47]
    ds_read_b128 v[100:103], v17 offset:6144
    v_mfma_f32_16x16x32_bf16 v[28:31], v[140:143], v[120:123], v[28:31]
    ds_read_b64_tr_b16 v[104:105], v18 offset:0
    v_mfma_f32_16x16x32_bf16 v[32:35], v[144:147], v[120:123], v[32:35]
    ds_read_b64_tr_b16 v[106:107], v18 offset:4096
    v_mfma_f32_16x16x32_bf16 v[48:51], v[144:147], v[124:127], v[48:51]
    ds_read_b64_tr_b16 v[108:109], v19 offset:0
    v_mfma_f32_16x16x32_bf16 v[64:67], v[144:147], v[128:131], v[64:67]
    ds_read_b64_tr_b16 v[110:111], v19 offset:4096
    v_mfma_f32_16x16x32_bf16 v[80:83], v[144:147], v[132:135], v[80:83]
    ds_read_b64_tr_b16 v[112:113], v20 offset:0
    v_mfma_f32_16x16x32_bf16 v[84:87], v[148:151], v[132:135], v[84:87]
    ds_read_b64_tr_b16 v[114:115], v20 offset:4096
    v_mfma_f32_16x16x32_bf16 v[68:71], v[148:151], v[128:131], v[68:71]
    ds_read_b64_tr_b16 v[116:117], v21 offset:0
    v_mfma_f32_16x16x32_bf16 v[52:55], v[148:151], v[124:127], v[52:55]
    ds_read_b64_tr_b16 v[118:119], v21 offset:4096
    v_mfma_f32_16x16x32_bf16 v[36:39], v[148:151], v[120:123], v[36:39]
    s_waitcnt lgkmcnt(6)
    s_cbranch_scc1 mm_25
    s_cmp_eq_u32 s60, 1
    s_cbranch_scc1 G4_last
    v_mfma_f32_16x16x32_bf16 v[24:27], v[104:107], v[88:91], v[24:27]
    ds_read_b128 v[120:123], v17 offset:1024
    v_mfma_f32_16x16x32_bf16 v[40:43], v[104:107], v[92:95], v[40:43]
    ds_read_b128 v[124:127], v17 offset:3072
    v_mfma_f32_16x16x32_bf16 v[56:59], v[104:107], v[96:99], v[56:59]
    ds_read_b128 v[128:131], v17 offset:5120
    v_mfma_f32_16x16x32_bf16 v[72:75], v[104:107], v[100:103], v[72:75]
    ds_read_b128 v[132:135], v17 offset:7168
    s_waitcnt lgkmcnt(8)
    v_mfma_f32_16x16x32_bf16 v[76:79], v[108:111], v[100:103], v[76:79]
    ds_read_b64_tr_b16 v[136:137], v18 offset:8192
    v_mfma_f32_16x16x32_bf16 v[60:63], v[108:111], v[96:99], v[60:63]
    ds_read_b64_tr_b16 v[138:139], v18 offset:12288
    v_mfma_f32_16x16x32_bf16 v[44:47], v[108:111], v[92:95], v[44:47]
    ds_read_b64_tr_b16 v[140:141], v19 offset:8192
    v_mfma_f32_16x16x32_bf16 v[28:31], v[108:111], v[88:91], v[28:31]
    ds_read_b64_tr_b16 v[142:143], v19 offset:12288
    s_waitcnt lgkmcnt(8)
    v_mfma_f32_16x16x32_bf16 v[32:35], v[112:115], v[88:91], v[32:35]
    ds_read_b64_tr_b16 v[144:145], v20 offset:8192
    v_mfma_f32_16x16x32_bf16 v[48:51], v[112:115], v[92:95], v[48:51]
    ds_read_b64_tr_b16 v[146:147], v20 offset:12288
    v_mfma_f32_16x16x32_bf16 v[64:67], v[112:115], v[96:99], v[64:67]
    ds_read_b64_tr_b16 v[148:149], v21 offset:8192
    v_mfma_f32_16x16x32_bf16 v[80:83], v[112:115], v[100:103], v[80:83]
    ds_read_b64_tr_b16 v[150:151], v21 offset:12288
    v_mfma_f32_16x16x32_bf16 v[84:87], v[116:119], v[100:103], v[84:87]
    v_mfma_f32_16x16x32_bf16 v[68:71], v[116:119], v[96:99], v[68:71]
    v_mfma_f32_16x16x32_bf16 v[52:55], v[116:119], v[92:95], v[52:55]
    v_mfma_f32_16x16x32_bf16 v[36:39], v[116:119], v[88:91], v[36:39]
    s_waitcnt lgkmcnt(0)
    v_mfma_f32_16x16x32_bf16 v[24:27], v[136:139], v[120:123], v[24:27]
    s_mul_i32 s36, s31, 524288
    s_add_u32 s36, s36, 0
    s_add_u32 s16, s62, s36
    v_mfma_f32_16x16x32_bf16 v[40:43], v[136:139], v[124:127], v[40:43]
    s_addc_u32 s17, s63, 0
    s_mov_b32 s18, 516096
    s_mov_b32 s19, 0x20000
    v_mfma_f32_16x16x32_bf16 v[56:59], v[136:139], v[128:131], v[56:59]
    v_mfma_f32_16x16x32_bf16 v[72:75], v[136:139], v[132:135], v[72:75]
    v_mfma_f32_16x16x32_bf16 v[76:79], v[140:143], v[132:135], v[76:79]
    v_mfma_f32_16x16x32_bf16 v[60:63], v[140:143], v[128:131], v[60:63]
    v_mfma_f32_16x16x32_bf16 v[44:47], v[140:143], v[124:127], v[44:47]
    v_mfma_f32_16x16x32_bf16 v[28:31], v[140:143], v[120:123], v[28:31]
    v_mfma_f32_16x16x32_bf16 v[32:35], v[144:147], v[120:123], v[32:35]
    v_mfma_f32_16x16x32_bf16 v[48:51], v[144:147], v[124:127], v[48:51]
    v_mfma_f32_16x16x32_bf16 v[64:67], v[144:147], v[128:131], v[64:67]
    v_mfma_f32_16x16x32_bf16 v[80:83], v[144:147], v[132:135], v[80:83]
    v_mfma_f32_16x16x32_bf16 v[84:87], v[148:151], v[132:135], v[84:87]
    v_mfma_f32_16x16x32_bf16 v[68:71], v[148:151], v[128:131], v[68:71]
    v_mfma_f32_16x16x32_bf16 v[52:55], v[148:151], v[124:127], v[52:55]
    v_mfma_f32_16x16x32_bf16 v[36:39], v[148:151], v[120:123], v[36:39]
    s_add_u32 s36, s39, 0
    v_cvt_pk_bf16_f32 v24, v24, v25
    v_cvt_pk_bf16_f32 v25, v26, v27
    v_cvt_pk_bf16_f32 v26, v28, v29
    v_cvt_pk_bf16_f32 v27, v30, v31
    v_or_b32 v24, 1, v24
    buffer_store_dwordx4 v[24:27], v2, s[16:19], s36 offen offset:0 sc1
    v_cvt_pk_bf16_f32 v32, v32, v33
    v_cvt_pk_bf16_f32 v33, v34, v35
    v_cvt_pk_bf16_f32 v34, v36, v37
    v_cvt_pk_bf16_f32 v35, v38, v39
    v_or_b32 v32, 1, v32
    buffer_store_dwordx4 v[32:35], v2, s[16:19], s36 offen offset:1024 sc1
    s_add_u32 s36, s39, 65536
    v_cvt_pk_bf16_f32 v40, v40, v41
    v_cvt_pk_bf16_f32 v41, v42, v43
    v_cvt_pk_bf16_f32 v42, v44, v45
    v_cvt_pk_bf16_f32 v43, v46, v47
    v_or_b32 v40, 1, v40
    buffer_store_dwordx4 v[40:43], v2, s[16:19], s36 offen offset:0 sc1
    v_cvt_pk_bf16_f32 v48, v48, v49
    v_cvt_pk_bf16_f32 v49, v50, v51
    v_cvt_pk_bf16_f32 v50, v52, v53
    v_cvt_pk_bf16_f32 v51, v54, v55
    v_or_b32 v48, 1, v48
    buffer_store_dwordx4 v[48:51], v2, s[16:19], s36 offen offset:1024 sc1
    s_add_u32 s36, s39, 131072
    v_cvt_pk_bf16_f32 v56, v56, v57
    v_cvt_pk_bf16_f32 v57, v58, v59
    v_cvt_pk_bf16_f32 v58, v60, v61
    v_cvt_pk_bf16_f32 v59, v62, v63
    v_or_b32 v56, 1, v56
    buffer_store_dwordx4 v[56:59], v2, s[16:19], s36 offen offset:0 sc1
    v_cvt_pk_bf16_f32 v64, v64, v65
    v_cvt_pk_bf16_f32 v65, v66, v67
    v_cvt_pk_bf16_f32 v66, v68, v69
    v_cvt_pk_bf16_f32 v67, v70, v71
    v_or_b32 v64, 1, v64
    buffer_store_dwordx4 v[64:67], v2, s[16:19], s36 offen offset:1024 sc1
    s_add_u32 s36, s39, 196608
    v_cvt_pk_bf16_f32 v72, v72, v73
    v_cvt_pk_bf16_f32 v73, v74, v75
    v_cvt_pk_bf16_f32 v74, v76, v77
    v_cvt_pk_bf16_f32 v75, v78, v79
    v_or_b32 v72, 1, v72
    buffer_store_dwordx4 v[72:75], v2, s[16:19], s36 offen offset:0 sc1
    v_cvt_pk_bf16_f32 v80, v80, v81
    v_cvt_pk_bf16_f32 v81, v82, v83
    v_cvt_pk_bf16_f32 v82, v84, v85
    v_cvt_pk_bf16_f32 v83, v86, v87
    v_or_b32 v80, 1, v80
    buffer_store_dwordx4 v[80:83], v2, s[16:19], s36 offen offset:1024 sc1
    s_barrier
    s_branch NEXT
G4_last:
    v_mfma_f32_16x16x32_bf16 v[24:27], v[104:107], v[88:91], v[24:27]
    ds_read_b128 v[120:123], v17 offset:1024
    v_mfma_f32_16x16x32_bf16 v[40:43], v[104:107], v[92:95], v[40:43]
    ds_read_b128 v[124:127], v17 offset:3072
    v_mfma_f32_16x16x32_bf16 v[56:59], v[104:107], v[96:99], v[56:59]
    ds_read_b128 v[128:131], v17 offset:5120
    v_mfma_f32_16x16x32_bf16 v[72:75], v[104:107], v[100:103], v[72:75]
    ds_read_b128 v[132:135], v17 offset:7168
    s_waitcnt lgkmcnt(8)
    v_mfma_f32_16x16x32_bf16 v[76:79], v[108:111], v[100:103], v[76:79]
    ds_read_b64_tr_b16 v[136:137], v18 offset:8192
    v_mfma_f32_16x16x32_bf16 v[60:63], v[108:111], v[96:99], v[60:63]
    ds_read_b64_tr_b16 v[138:139], v18 offset:12288
    v_mfma_f32_16x16x32_bf16 v[44:47], v[108:111], v[92:95], v[44:47]
    ds_read_b64_tr_b16 v[140:141], v19 offset:8192
    v_mfma_f32_16x16x32_bf16 v[28:31], v[108:111], v[88:91], v[28:31]
    ds_read_b64_tr_b16 v[142:143], v19 offset:12288
    s_waitcnt lgkmcnt(8)
    v_mfma_f32_16x16x32_bf16 v[32:35], v[112:115], v[88:91], v[32:35]
    ds_read_b64_tr_b16 v[144:145], v20 offset:8192
    v_mfma_f32_16x16x32_bf16 v[48:51], v[112:115], v[92:95], v[48:51]
    ds_read_b64_tr_b16 v[146:147], v20 offset:12288
    s_load_dwordx2 s[6:7], s[0:1], 88
    v_mfma_f32_16x16x32_bf16 v[64:67], v[112:115], v[96:99], v[64:67]
    ds_read_b64_tr_b16 v[148:149], v21 offset:8192
    v_mfma_f32_16x16x32_bf16 v[80:83], v[112:115], v[100:103], v[80:83]
    ds_read_b64_tr_b16 v[150:151], v21 offset:12288
    v_mfma_f32_16x16x32_bf16 v[84:87], v[116:119], v[100:103], v[84:87]
    v_mfma_f32_16x16x32_bf16 v[68:71], v[116:119], v[96:99], v[68:71]
    v_mfma_f32_16x16x32_bf16 v[52:55], v[116:119], v[92:95], v[52:55]
    v_mfma_f32_16x16x32_bf16 v[36:39], v[116:119], v[88:91], v[36:39]
    s_waitcnt lgkmcnt(0)
    v_mfma_f32_16x16x32_bf16 v[24:27], v[136:139], v[120:123], v[24:27]
    s_add_u32 s16, s62, 0x80000
    s_addc_u32 s17, s63, 0
    s_mov_b32 s18, 0x7e000
    v_mfma_f32_16x16x32_bf16 v[40:43], v[136:139], v[124:127], v[40:43]
    s_mov_b32 s19, 0x20000
    s_mov_b32 s20, s6
    s_mov_b32 s21, s7
    v_mfma_f32_16x16x32_bf16 v[56:59], v[136:139], v[128:131], v[56:59]
    s_mov_b32 s22, 0x400000
    s_mov_b32 s23, 0x20000
    s_add_u32 s44, s40, 65536
    v_mfma_f32_16x16x32_bf16 v[72:75], v[136:139], v[132:135], v[72:75]
    s_lshl_b32 s46, s28, 3
    s_add_u32 s46, s46, s37
    s_lshl_b32 s47, s31, 1
    v_mfma_f32_16x16x32_bf16 v[76:79], v[140:143], v[132:135], v[76:79]
    s_add_u32 s46, s46, s47
    s_lshl_b32 s46, s46, 15
    s_lshl_b32 s47, s38, 5
    v_mfma_f32_16x16x32_bf16 v[60:63], v[140:143], v[128:131], v[60:63]
    s_add_u32 s46, s46, s47
    s_add_u32 s47, s46, 32768
    v_and_b32 v225, 1, v23
    v_mfma_f32_16x16x32_bf16 v[44:47], v[140:143], v[124:127], v[44:47]
    v_lshlrev_b32 v224, 11, v22
    v_lshl_add_u32 v224, v225, 5, v224
    v_mfma_f32_16x16x32_bf16 v[28:31], v[140:143], v[120:123], v[28:31]
    v_lshrrev_b32 v225, 1, v23
    v_lshl_add_u32 v224, v225, 4, v224
    v_mfma_f32_16x16x32_bf16 v[32:35], v[144:147], v[120:123], v[32:35]
    v_cmp_gt_u32 s[48:49], 8, v22
    v_lshrrev_b32 v225, 3, v22
    v_mfma_f32_16x16x32_bf16 v[48:51], v[144:147], v[124:127], v[48:51]
    v_mul_u32_u24 v225, 16320, v225
    v_sub_u32 v224, v224, v225
    v_mfma_f32_16x16x32_bf16 v[64:67], v[144:147], v[128:131], v[64:67]
    v_add_u32 v225, 16384, v224
    v_mfma_f32_16x16x32_bf16 v[80:83], v[144:147], v[132:135], v[80:83]
    v_mfma_f32_16x16x32_bf16 v[84:87], v[148:151], v[132:135], v[84:87]
    v_mfma_f32_16x16x32_bf16 v[68:71], v[148:151], v[128:131], v[68:71]
    v_mfma_f32_16x16x32_bf16 v[52:55], v[148:151], v[124:127], v[52:55]
    v_mfma_f32_16x16x32_bf16 v[36:39], v[148:151], v[120:123], v[36:39]
    s_cmp_eq_u32 s31, 0
    s_cbranch_scc1 G4_k0
    v_swap_b32 v24, v56
    v_swap_b32 v25, v57
    v_swap_b32 v26, v58
    v_swap_b32 v27, v59
    v_swap_b32 v28, v60
    v_swap_b32 v29, v61
    v_swap_b32 v30, v62
    v_swap_b32 v31, v63
    v_swap_b32 v32, v64
    v_swap_b32 v33, v65
    v_swap_b32 v34, v66
    v_swap_b32 v35, v67
    v_swap_b32 v36, v68
    v_swap_b32 v37, v69
    v_swap_b32 v38, v70
    v_swap_b32 v39, v71
    v_swap_b32 v40, v72
    v_swap_b32 v41, v73
    v_swap_b32 v42, v74
    v_swap_b32 v43, v75
    v_swap_b32 v44, v76
    v_swap_b32 v45, v77
    v_swap_b32 v46, v78
    v_swap_b32 v47, v79
    v_swap_b32 v48, v80
    v_swap_b32 v49, v81
    v_swap_b32 v50, v82
    v_swap_b32 v51, v83
    v_swap_b32 v52, v84
    v_swap_b32 v53, v85
    v_swap_b32 v54, v86
    v_swap_b32 v55, v87
G4_k0:
    s_add_u32 s36, s41, 0
    v_cvt_pk_bf16_f32 v56, v56, v57
    v_cvt_pk_bf16_f32 v57, v58, v59
    v_cvt_pk_bf16_f32 v58, v60, v61
    v_cvt_pk_bf16_f32 v59, v62, v63
    v_or_b32 v56, 1, v56
    buffer_store_dwordx4 v[56:59], v2, s[16:19], s36 offen offset:0 sc1
    v_cvt_pk_bf16_f32 v64, v64, v65
    v_cvt_pk_bf16_f32 v65, v66, v67
    v_cvt_pk_bf16_f32 v66, v68, v69
    v_cvt_pk_bf16_f32 v67, v70, v71
    v_or_b32 v64, 1, v64
    buffer_store_dwordx4 v[64:67], v2, s[16:19], s36 offen offset:1024 sc1
    s_add_u32 s36, s41, 65536
    v_cvt_pk_bf16_f32 v72, v72, v73
    v_cvt_pk_bf16_f32 v73, v74, v75
    v_cvt_pk_bf16_f32 v74, v76, v77
    v_cvt_pk_bf16_f32 v75, v78, v79
    v_or_b32 v72, 1, v72
    buffer_store_dwordx4 v[72:75], v2, s[16:19], s36 offen offset:0 sc1
    v_cvt_pk_bf16_f32 v80, v80, v81
    v_cvt_pk_bf16_f32 v81, v82, v83
    v_cvt_pk_bf16_f32 v82, v84, v85
    v_cvt_pk_bf16_f32 v83, v86, v87
    v_or_b32 v80, 1, v80
    buffer_store_dwordx4 v[80:83], v2, s[16:19], s36 offen offset:1024 sc1
    v_lshlrev_b32 v226, 16, v180
    v_and_b32 v227, 0xffff0000, v180
    v_pk_add_f32 v[24:25], v[24:25], v[226:227]
    v_lshlrev_b32 v228, 16, v181
    v_and_b32 v229, 0xffff0000, v181
    v_pk_add_f32 v[26:27], v[26:27], v[228:229]
    v_lshlrev_b32 v226, 16, v182
    v_and_b32 v227, 0xffff0000, v182
    v_pk_add_f32 v[28:29], v[28:29], v[226:227]
    v_lshlrev_b32 v228, 16, v183
    v_and_b32 v229, 0xffff0000, v183
    v_pk_add_f32 v[30:31], v[30:31], v[228:229]
    v_lshlrev_b32 v226, 16, v188
    v_and_b32 v227, 0xffff0000, v188
    v_pk_add_f32 v[32:33], v[32:33], v[226:227]
    v_lshlrev_b32 v228, 16, v189
    v_and_b32 v229, 0xffff0000, v189
    v_pk_add_f32 v[34:35], v[34:35], v[228:229]
    v_lshlrev_b32 v226, 16, v190
    v_and_b32 v227, 0xffff0000, v190
    v_pk_add_f32 v[36:37], v[36:37], v[226:227]
    v_lshlrev_b32 v228, 16, v191
    v_and_b32 v229, 0xffff0000, v191
    v_pk_add_f32 v[38:39], v[38:39], v[228:229]
    v_lshlrev_b32 v226, 16, v196
    v_and_b32 v227, 0xffff0000, v196
    v_pk_add_f32 v[40:41], v[40:41], v[226:227]
    v_lshlrev_b32 v228, 16, v197
    v_and_b32 v229, 0xffff0000, v197
    v_pk_add_f32 v[42:43], v[42:43], v[228:229]
    v_lshlrev_b32 v226, 16, v198
    v_and_b32 v227, 0xffff0000, v198
    v_pk_add_f32 v[44:45], v[44:45], v[226:227]
    v_lshlrev_b32 v228, 16, v199
    v_and_b32 v229, 0xffff0000, v199
    v_pk_add_f32 v[46:47], v[46:47], v[228:229]
    v_lshlrev_b32 v226, 16, v234
    v_and_b32 v227, 0xffff0000, v234
    v_pk_add_f32 v[48:49], v[48:49], v[226:227]
    v_lshlrev_b32 v228, 16, v235
    v_and_b32 v229, 0xffff0000, v235
    v_pk_add_f32 v[50:51], v[50:51], v[228:229]
    v_lshlrev_b32 v226, 16, v236
    v_and_b32 v227, 0xffff0000, v236
    v_pk_add_f32 v[52:53], v[52:53], v[226:227]
    v_lshlrev_b32 v228, 16, v237
    v_and_b32 v229, 0xffff0000, v237
    v_pk_add_f32 v[54:55], v[54:55], v[228:229]
    v_lshlrev_b32 v226, 16, v184
    v_and_b32 v227, 0xffff0000, v184
    v_pk_add_f32 v[24:25], v[24:25], v[226:227]
    v_lshlrev_b32 v228, 16, v185
    v_and_b32 v229, 0xffff0000, v185
    v_pk_add_f32 v[26:27], v[26:27], v[228:229]
    v_lshlrev_b32 v226, 16, v186
    v_and_b32 v227, 0xffff0000, v186
    v_pk_add_f32 v[28:29], v[28:29], v[226:227]
    v_lshlrev_b32 v228, 16, v187
    v_and_b32 v229, 0xffff0000, v187
    v_pk_add_f32 v[30:31], v[30:31], v[228:229]
    v_lshlrev_b32 v226, 16, v192
    v_and_b32 v227, 0xffff0000, v192
    v_pk_add_f32 v[32:33], v[32:33], v[226:227]
    v_lshlrev_b32 v228, 16, v193
    v_and_b32 v229, 0xffff0000, v193
    v_pk_add_f32 v[34:35], v[34:35], v[228:229]
    v_lshlrev_b32 v226, 16, v194
    v_and_b32 v227, 0xffff0000, v194
    v_pk_add_f32 v[36:37], v[36:37], v[226:227]
    v_lshlrev_b32 v228, 16, v195
    v_and_b32 v229, 0xffff0000, v195
    v_pk_add_f32 v[38:39], v[38:39], v[228:229]
    v_lshlrev_b32 v226, 16, v230
    v_and_b32 v227, 0xffff0000, v230
    v_pk_add_f32 v[40:41], v[40:41], v[226:227]
    v_lshlrev_b32 v228, 16, v231
    v_and_b32 v229, 0xffff0000, v231
    v_pk_add_f32 v[42:43], v[42:43], v[228:229]
    v_lshlrev_b32 v226, 16, v232
    v_and_b32 v227, 0xffff0000, v232
    v_pk_add_f32 v[44:45], v[44:45], v[226:227]
    v_lshlrev_b32 v228, 16, v233
    v_and_b32 v229, 0xffff0000, v233
    v_pk_add_f32 v[46:47], v[46:47], v[228:229]
    v_lshlrev_b32 v226, 16, v248
    v_and_b32 v227, 0xffff0000, v248
    v_pk_add_f32 v[48:49], v[48:49], v[226:227]
    v_lshlrev_b32 v228, 16, v249
    v_and_b32 v229, 0xffff0000, v249
    v_pk_add_f32 v[50:51], v[50:51], v[228:229]
    v_lshlrev_b32 v226, 16, v250
    v_and_b32 v227, 0xffff0000, v250
    v_pk_add_f32 v[52:53], v[52:53], v[226:227]
    v_lshlrev_b32 v228, 16, v251
    v_and_b32 v229, 0xffff0000, v251
    v_pk_add_f32 v[54:55], v[54:55], v[228:229]
    s_mov_b32 s53, 0
dp_26:
    buffer_load_dwordx4 v[208:211], v2, s[16:19], s40 offen offset:0 sc1
    buffer_load_dwordx4 v[212:215], v2, s[16:19], s40 offen offset:1024 sc1
    buffer_load_dwordx4 v[216:219], v2, s[16:19], s44 offen offset:0 sc1
    buffer_load_dwordx4 v[220:223], v2, s[16:19], s44 offen offset:1024 sc1
    s_waitcnt vmcnt(0)
    v_bitop3_b32 v6, v208, v212, v216 bitop3:0x80
    v_bitop3_b32 v6, v6, v220, 1 bitop3:0x80
    v_cmp_eq_u32 vcc, 0, v6
    s_cbranch_vccz dq_27
    s_sleep 2
    s_add_u32 s53, s53, 1
    s_cmp_lt_u32 s53, s61
    s_cbranch_scc1 dp_26
    s_mov_b32 s61, 0
dq_27:
    v_lshlrev_b32 v226, 16, v208
    v_and_b32 v227, 0xffff0000, v208
    v_pk_add_f32 v[24:25], v[24:25], v[226:227]
    v_lshlrev_b32 v228, 16, v209
    v_and_b32 v229, 0xffff0000, v209
    v_pk_add_f32 v[26:27], v[26:27], v[228:229]
    v_lshlrev_b32 v226, 16, v210
    v_and_b32 v227, 0xffff0000, v210
    v_pk_add_f32 v[28:29], v[28:29], v[226:227]
    v_lshlrev_b32 v228, 16, v211
    v_and_b32 v229, 0xffff0000, v211
    v_pk_add_f32 v[30:31], v[30:31], v[228:229]
    v_cvt_pk_bf16_f32 v24, v24, v25
    v_cvt_pk_bf16_f32 v25, v26, v27
    v_cvt_pk_bf16_f32 v26, v28, v29
    v_cvt_pk_bf16_f32 v27, v30, v31
    s_nop 0
    v_permlane16_swap_b32 v24, v26
    v_permlane16_swap_b32 v25, v27
    v_lshlrev_b32 v226, 16, v212
    v_and_b32 v227, 0xffff0000, v212
    v_pk_add_f32 v[32:33], v[32:33], v[226:227]
    v_lshlrev_b32 v228, 16, v213
    v_and_b32 v229, 0xffff0000, v213
    v_pk_add_f32 v[34:35], v[34:35], v[228:229]
    v_lshlrev_b32 v226, 16, v214
    v_and_b32 v227, 0xffff0000, v214
    v_pk_add_f32 v[36:37], v[36:37], v[226:227]
    v_lshlrev_b32 v228, 16, v215
    v_and_b32 v229, 0xffff0000, v215
    v_pk_add_f32 v[38:39], v[38:39], v[228:229]
    v_cvt_pk_bf16_f32 v32, v32, v33
    v_cvt_pk_bf16_f32 v33, v34, v35
    v_cvt_pk_bf16_f32 v34, v36, v37
    v_cvt_pk_bf16_f32 v35, v38, v39
    s_nop 0
    v_permlane16_swap_b32 v32, v34
    v_permlane16_swap_b32 v33, v35
    v_cndmask_b32 v36, v24, v32, s[48:49]
    v_cndmask_b32 v37, v25, v33, s[48:49]
    v_cndmask_b32 v38, v26, v34, s[48:49]
    v_cndmask_b32 v39, v27, v35, s[48:49]
    v_mov_b32_dpp v28, v36 row_ror:8 row_mask:0xf bank_mask:0xf
    v_mov_b32_dpp v29, v37 row_ror:8 row_mask:0xf bank_mask:0xf
    v_mov_b32_dpp v30, v38 row_ror:8 row_mask:0xf bank_mask:0xf
    v_mov_b32_dpp v31, v39 row_ror:8 row_mask:0xf bank_mask:0xf
    v_cndmask_b32 v24, v28, v24, s[48:49]
    v_cndmask_b32 v32, v32, v28, s[48:49]
    v_cndmask_b32 v25, v29, v25, s[48:49]
    v_cndmask_b32 v33, v33, v29, s[48:49]
    v_cndmask_b32 v26, v30, v26, s[48:49]
    v_cndmask_b32 v34, v34, v30, s[48:49]
    v_cndmask_b32 v27, v31, v27, s[48:49]
    v_cndmask_b32 v35, v35, v31, s[48:49]
    buffer_store_dwordx4 v[24:27], v224, s[20:23], s46 offen sc1
    buffer_store_dwordx4 v[32:35], v225, s[20:23], s46 offen sc1
    v_lshlrev_b32 v226, 16, v216
    v_and_b32 v227, 0xffff0000, v216
    v_pk_add_f32 v[40:41], v[40:41], v[226:227]
    v_lshlrev_b32 v228, 16, v217
    v_and_b32 v229, 0xffff0000, v217
    v_pk_add_f32 v[42:43], v[42:43], v[228:229]
    v_lshlrev_b32 v226, 16, v218
    v_and_b32 v227, 0xffff0000, v218
    v_pk_add_f32 v[44:45], v[44:45], v[226:227]
    v_lshlrev_b32 v228, 16, v219
    v_and_b32 v229, 0xffff0000, v219
    v_pk_add_f32 v[46:47], v[46:47], v[228:229]
    v_cvt_pk_bf16_f32 v40, v40, v41
    v_cvt_pk_bf16_f32 v41, v42, v43
    v_cvt_pk_bf16_f32 v42, v44, v45
    v_cvt_pk_bf16_f32 v43, v46, v47
    s_nop 0
    v_permlane16_swap_b32 v40, v42
    v_permlane16_swap_b32 v41, v43
    v_lshlrev_b32 v226, 16, v220
    v_and_b32 v227, 0xffff0000, v220
    v_pk_add_f32 v[48:49], v[48:49], v[226:227]
    v_lshlrev_b32 v228, 16, v221
    v_and_b32 v229, 0xffff0000, v221
    v_pk_add_f32 v[50:51], v[50:51], v[228:229]
    v_lshlrev_b32 v226, 16, v222
    v_and_b32 v227, 0xffff0000, v222
    v_pk_add_f32 v[52:53], v[52:53], v[226:227]
    v_lshlrev_b32 v228, 16, v223
    v_and_b32 v229, 0xffff0000, v223
    v_pk_add_f32 v[54:55], v[54:55], v[228:229]
    v_cvt_pk_bf16_f32 v48, v48, v49
    v_cvt_pk_bf16_f32 v49, v50, v51
    v_cvt_pk_bf16_f32 v50, v52, v53
    v_cvt_pk_bf16_f32 v51, v54, v55
    s_nop 0
    v_permlane16_swap_b32 v48, v50
    v_permlane16_swap_b32 v49, v51
    v_cndmask_b32 v52, v40, v48, s[48:49]
    v_cndmask_b32 v53, v41, v49, s[48:49]
    v_cndmask_b32 v54, v42, v50, s[48:49]
    v_cndmask_b32 v55, v43, v51, s[48:49]
    v_mov_b32_dpp v44, v52 row_ror:8 row_mask:0xf bank_mask:0xf
    v_mov_b32_dpp v45, v53 row_ror:8 row_mask:0xf bank_mask:0xf
    v_mov_b32_dpp v46, v54 row_ror:8 row_mask:0xf bank_mask:0xf
    v_mov_b32_dpp v47, v55 row_ror:8 row_mask:0xf bank_mask:0xf
    v_cndmask_b32 v40, v44, v40, s[48:49]
    v_cndmask_b32 v48, v48, v44, s[48:49]
    v_cndmask_b32 v41, v45, v41, s[48:49]
    v_cndmask_b32 v49, v49, v45, s[48:49]
    v_cndmask_b32 v42, v46, v42, s[48:49]
    v_cndmask_b32 v50, v50, v46, s[48:49]
    v_cndmask_b32 v43, v47, v43, s[48:49]
    v_cndmask_b32 v51, v51, v47, s[48:49]
    buffer_store_dwordx4 v[40:43], v224, s[20:23], s47 offen sc1
    buffer_store_dwordx4 v[48:51], v225, s[20:23], s47 offen sc1
    s_branch K_fin
LOADERS:
    s_cmp_ge_u32 s30, 6
    s_cbranch_scc1 WLOAD
    s_add_u32 s54, s55, 0x500
    v_mov_b32 v222, s54
    s_lshl_b32 s53, s29, 7
    s_add_u32 s53, s53, 23117824
    v_mov_b32 v226, s53
    s_sleep 30
    s_mov_b64 exec, 1
    buffer_load_dword v227, v226, s[56:59], 0 offen sc1
    s_mov_b64 exec, -1
    s_waitcnt vmcnt(0)
    v_readfirstlane_b32 s53, v227
    s_add_u32 s54, s52, 16
    s_cmp_eq_u32 s53, s54
    s_cbranch_scc1 fok_28
    s_mov_b32 s53, 0
    s_add_u32 s54, s52, 16
    s_bfm_b64 exec, 1, 0
poll_29:
    buffer_load_dword v227, v226, s[56:59], 0 offen sc1
    s_waitcnt vmcnt(0)
    v_xor_b32 v227, s54, v227
    v_cmp_eq_u32 vcc, 0, v227
    s_nop 0
    s_cmp_eq_u64 vcc, exec
    s_cbranch_scc1 pok_30
    s_sleep 5
    s_add_u32 s53, s53, 1
    s_cmp_lt_u32 s53, s61
    s_cbranch_scc1 poll_29
    s_mov_b32 s61, 0
pok_30:
    s_mov_b64 exec, -1
fok_28:
    s_add_u32 s24, s4, 0x1400000
    s_addc_u32 s25, s5, 0
    s_mov_b32 s26, 0x20000
    s_mov_b32 s27, 0x20000
    s_cmp_eq_u32 s60, 0
    s_cselect_b32 s26, s26, 0
    s_and_b32 s36, s30, 1
    s_mul_i32 s36, s36, 128
    s_mul_i32 s37, s29, 256
    s_add_u32 s37, s36, s37
    v_lshrrev_b32 v224, 3, v1
    v_mul_u32_u24 v224, 4096, v224
    v_and_b32 v23, 112, v2
    v_add_u32 v224, v224, v23
    buffer_load_dwordx4 v[24:27], v224, s[24:27], s37 offen sc1
    s_add_u32 s37, s37, 32768
    buffer_load_dwordx4 v[28:31], v224, s[24:27], s37 offen sc1
    s_add_u32 s37, s37, 32768
    buffer_load_dwordx4 v[32:35], v224, s[24:27], s37 offen sc1
    s_add_u32 s37, s37, 32768
    buffer_load_dwordx4 v[36:39], v224, s[24:27], s37 offen sc1
    s_add_u32 s37, s37, 32768
    s_mov_b64 exec, 1
    buffer_load_dword v223, v222, s[56:59], 0 offen sc1
    s_mov_b64 exec, -1
    s_waitcnt vmcnt(0)
    v_readfirstlane_b32 s53, v223
    s_add_u32 s54, s52, 16
    s_cmp_eq_u32 s53, s54
    s_cbranch_scc1 fok_31
    s_mov_b32 s53, 0
    s_add_u32 s54, s52, 16
    s_bfm_b64 exec, 1, 0
poll_32:
    buffer_load_dword v223, v222, s[56:59], 0 offen sc1
    s_waitcnt vmcnt(0)
    v_xor_b32 v223, s54, v223
    v_cmp_eq_u32 vcc, 0, v223
    s_nop 0
    s_cmp_eq_u64 vcc, exec
    s_cbranch_scc1 pok_33
    s_sleep 5
    s_add_u32 s53, s53, 1
    s_cmp_lt_u32 s53, s61
    s_cbranch_scc1 poll_32
    s_mov_b32 s61, 0
pok_33:
    s_mov_b64 exec, -1
fok_31:
    s_add_u32 s20, s62, 0x5d0000
    s_addc_u32 s21, s63, 0
    s_mov_b32 s22, 0x800
    s_mov_b32 s23, 0x20000
    s_and_b32 s35, s30, 1
    s_lshl_b32 s35, s35, 10
    buffer_load_dwordx4 v[16:19], v2, s[20:23], s35 offen sc1
    s_cmp_lg_u32 s60, 0
    s_cbranch_scc1 pc_34
    v_add_f32 v24, v24, v28
    v_add_f32 v25, v25, v29
    v_add_f32 v26, v26, v30
    v_add_f32 v27, v27, v31
    v_add_f32 v24, v24, v32
    v_add_f32 v25, v25, v33
    v_add_f32 v26, v26, v34
    v_add_f32 v27, v27, v35
    v_add_f32 v24, v24, v36
    v_add_f32 v25, v25, v37
    v_add_f32 v26, v26, v38
    v_add_f32 v27, v27, v39
    v_add_f32_dpp v24, v24, v24 row_ror:8 row_mask:0xf bank_mask:0xf
    v_add_f32_dpp v25, v25, v25 row_ror:8 row_mask:0xf bank_mask:0xf
    v_add_f32_dpp v26, v26, v26 row_ror:8 row_mask:0xf bank_mask:0xf
    v_add_f32_dpp v27, v27, v27 row_ror:8 row_mask:0xf bank_mask:0xf
    v_mov_b32 v28, v24
    v_mov_b32 v29, v25
    v_mov_b32 v30, v26
    v_mov_b32 v31, v27
    v_permlane16_swap_b32 v24, v28
    v_permlane16_swap_b32 v25, v29
    v_permlane16_swap_b32 v26, v30
    v_permlane16_swap_b32 v27, v31
    v_add_f32 v24, v24, v28
    v_add_f32 v25, v25, v29
    v_add_f32 v26, v26, v30
    v_add_f32 v27, v27, v31
    v_mov_b32 v28, v24
    v_mov_b32 v29, v25
    v_mov_b32 v30, v26
    v_mov_b32 v31, v27
    v_permlane32_swap_b32 v24, v28
    v_permlane32_swap_b32 v25, v29
    v_permlane32_swap_b32 v26, v30
    v_permlane32_swap_b32 v27, v31
    v_add_f32 v24, v24, v28
    v_add_f32 v25, v25, v29
    v_add_f32 v26, v26, v30
    v_add_f32 v27, v27, v31
pc_34:
    s_cmp_lg_u32 s60, 0
    s_cbranch_scc1 pc_35
    s_and_b32 s36, s30, 1
    s_mul_i32 s36, s36, 128
    s_add_u32 s36, s36, 163328
    v_add_u32 v23, s36, v2
    s_bfm_b64 exec, 8, 0
    ds_write_b128 v23, v[24:27]
    s_mov_b64 exec, -1
    s_waitcnt lgkmcnt(0)
pc_35:
    s_waitcnt vmcnt(0)
    s_and_b32 s36, s30, 1
    s_lshl_b32 s36, s36, 10
    s_add_u32 s36, s36, 160768
    v_add_u32 v221, s36, v2
    ds_write_b128 v221, v[16:19]
    s_waitcnt lgkmcnt(0)
    s_cmp_eq_u32 s60, 0
    s_cbranch_scc1 AL_nw
    s_cmp_lg_u32 s30, 4
    s_cbranch_scc1 AL_nw
    s_add_u32 s54, s55, 0xffc00200
    s_add_u32 s53, s54, s92
    v_mov_b32 v9, s53
    s_add_u32 s53, s54, s93
    v_writelane_b32 v9, s53, 1
    s_mov_b32 s53, 0
    s_add_u32 s54, s52, 16
    s_bfm_b64 exec, 2, 0
poll_37:
    buffer_load_dword v8, v9, s[56:59], 0 offen sc1
    s_waitcnt vmcnt(0)
    v_xor_b32 v8, s54, v8
    v_cmp_eq_u32 vcc, 0, v8
    s_nop 0
    s_cmp_eq_u64 vcc, exec
    s_cbranch_scc1 pok_38
    s_sleep 5
    s_add_u32 s53, s53, 1
    s_cmp_lt_u32 s53, s61
    s_cbranch_scc1 poll_37
    s_mov_b32 s61, 0
pok_38:
    s_mov_b64 exec, -1
AL_nw:
    s_barrier
    s_call_b64 s[76:77], SUB_after_g1
    s_cmp_lg_u32 s30, 4
    s_cbranch_scc1 pdone_39
    s_cmp_lg_u32 s60, 0
    s_cbranch_scc1 pdone_39
    s_mul_i32 s54, s60, 2
    s_add_u32 s54, s54, 1
    v_mov_b32 v8, 162872
spin_40:
    s_sleep 8
    ds_read_b32 v9, v8
    s_waitcnt lgkmcnt(0)
    v_readfirstlane_b32 s53, v9
    s_nop 0
    s_cmp_ge_u32 s53, s54
    s_cbranch_scc0 spin_40
    s_add_u32 s54, s55, 0x100
    v_mov_b32 v9, s54
    s_add_u32 s53, s54, 128
    v_writelane_b32 v9, s53, 1
    s_add_u32 s53, s53, s93
    v_writelane_b32 v9, s53, 3
    s_add_u32 s53, s54, s92
    v_writelane_b32 v9, s53, 2
    s_mov_b32 s53, 0
    s_add_u32 s54, s52, 8
    s_bfm_b64 exec, 4, 0
poll_41:
    buffer_load_dword v8, v9, s[56:59], 0 offen sc1
    s_waitcnt vmcnt(0)
    v_xor_b32 v8, s54, v8
    v_cmp_eq_u32 vcc, 0, v8
    s_nop 0
    s_cmp_eq_u64 vcc, exec
    s_cbranch_scc1 pok_42
    s_sleep 5
    s_add_u32 s53, s53, 1
    s_cmp_lt_u32 s53, s61
    s_cbranch_scc1 poll_41
    s_mov_b32 s61, 0
pok_42:
    s_mov_b64 exec, -1
pdone_39:
    s_barrier
    s_waitcnt vmcnt(0)
    s_barrier
    s_call_b64 s[76:77], SUB_after_g2
    s_and_b32 s35, s30, 1
    s_add_u32 s12, s62, 0x80000
    s_addc_u32 s13, s63, 0
    s_mov_b32 s14, 0x7e000
    s_mov_b32 s15, 0x20000
    s_mul_i32 s38, s35, 262144
    s_lshl_b32 s41, s35, 13
    s_mov_b32 s42, 0
    s_mov_b32 s44, 0
    s_add_u32 s54, s55, 0x200
    v_mov_b32 v9, s54
    s_add_u32 s44, s44, 1
    s_and_b32 s44, s44, 15
    s_mov_b32 s42, 16384
    s_add_u32 s54, s55, 0x580
    v_mov_b32 v222, s54
    v_lshlrev_b32 v221, 3, v1
    s_add_u32 s19, s41, s42
    v_readlane_b32 s16, v248, s44
    s_nop 0
    s_add_u32 s16, s16, s38
    s_add_u32 s44, s44, 1
    s_and_b32 s44, s44, 15
    s_add_u32 s42, s42, 16384
    s_cmp_eq_u32 s42, 49152
    s_cselect_b32 s42, 0, s42
    s_mov_b32 m0, s19
    s_mov_b32 s39, s16
    s_waitcnt vmcnt(0)
    s_barrier
    s_sleep 6
    s_mov_b32 s53, 0
    s_add_u32 s54, s52, 16
    s_bfm_b64 exec, 1, 0
poll_43:
    buffer_load_dword v8, v9, s[56:59], 0 offen sc1
    s_waitcnt vmcnt(0)
    v_xor_b32 v8, s54, v8
    v_cmp_eq_u32 vcc, 0, v8
    s_nop 0
    s_cmp_eq_u64 vcc, exec
    s_cbranch_scc1 pok_44
    s_sleep 5
    s_add_u32 s53, s53, 1
    s_cmp_lt_u32 s53, s61
    s_cbranch_scc1 poll_43
    s_mov_b32 s61, 0
pok_44:
    s_mov_b64 exec, -1
    buffer_load_dwordx4 v2, s[12:15], s39 offen sc1 lds
    buffer_load_dwordx4 v2, s[12:15], s39 offen offset:1024 sc1 lds
    s_add_u32 s19, s41, s42
    v_readlane_b32 s16, v248, s44
    s_nop 0
    s_add_u32 s16, s16, s38
    s_add_u32 s44, s44, 1
    s_and_b32 s44, s44, 15
    s_add_u32 s42, s42, 16384
    s_cmp_eq_u32 s42, 49152
    s_cselect_b32 s42, 0, s42
    s_add_u32 m0, m0, 2048
    s_add_u32 s39, s39, 65536
    buffer_load_dwordx4 v2, s[12:15], s39 offen sc1 lds
    buffer_load_dwordx4 v2, s[12:15], s39 offen offset:1024 sc1 lds
    s_add_u32 m0, m0, 2048
    s_add_u32 s39, s39, 65536
    buffer_load_dwordx4 v2, s[12:15], s39 offen sc1 lds
    buffer_load_dwordx4 v2, s[12:15], s39 offen offset:1024 sc1 lds
    s_add_u32 m0, m0, 2048
    s_add_u32 s39, s39, 65536
    buffer_load_dwordx4 v2, s[12:15], s39 offen sc1 lds
    buffer_load_dwordx4 v2, s[12:15], s39 offen offset:1024 sc1 lds
    s_mov_b32 m0, s19
    s_mov_b32 s39, s16
    buffer_load_dwordx4 v2, s[12:15], s39 offen sc1 lds
    buffer_load_dwordx4 v2, s[12:15], s39 offen offset:1024 sc1 lds
    s_add_u32 s19, s41, s42
    v_readlane_b32 s16, v248, s44
    s_nop 0
    s_add_u32 s16, s16, s38
    s_add_u32 s44, s44, 1
    s_and_b32 s44, s44, 15
    s_add_u32 s42, s42, 16384
    s_cmp_eq_u32 s42, 49152
    s_cselect_b32 s42, 0, s42
    s_add_u32 m0, m0, 2048
    s_add_u32 s39, s39, 65536
    buffer_load_dwordx4 v2, s[12:15], s39 offen sc1 lds
    buffer_load_dwordx4 v2, s[12:15], s39 offen offset:1024 sc1 lds
    s_add_u32 m0, m0, 2048
    s_add_u32 s39, s39, 65536
    buffer_load_dwordx4 v2, s[12:15], s39 offen sc1 lds
    buffer_load_dwordx4 v2, s[12:15], s39 offen offset:1024 sc1 lds
    s_add_u32 m0, m0, 2048
    s_add_u32 s39, s39, 65536
    buffer_load_dwordx4 v2, s[12:15], s39 offen sc1 lds
    buffer_load_dwordx4 v2, s[12:15], s39 offen offset:1024 sc1 lds
    s_mov_b32 m0, s19
    s_mov_b32 s39, s16
    s_waitcnt vmcnt(8)
    s_barrier
    buffer_load_dwordx4 v2, s[12:15], s39 offen sc1 lds
    buffer_load_dwordx4 v2, s[12:15], s39 offen offset:1024 sc1 lds
    s_add_u32 s19, s41, s42
    v_readlane_b32 s16, v248, s44
    s_nop 0
    s_add_u32 s16, s16, s38
    s_add_u32 s44, s44, 1
    s_and_b32 s44, s44, 15
    s_add_u32 s42, s42, 16384
    s_cmp_eq_u32 s42, 49152
    s_cselect_b32 s42, 0, s42
    s_add_u32 m0, m0, 2048
    s_add_u32 s39, s39, 65536
    buffer_load_dwordx4 v2, s[12:15], s39 offen sc1 lds
    buffer_load_dwordx4 v2, s[12:15], s39 offen offset:1024 sc1 lds
    s_add_u32 m0, m0, 2048
    s_add_u32 s39, s39, 65536
    buffer_load_dwordx4 v2, s[12:15], s39 offen sc1 lds
    buffer_load_dwordx4 v2, s[12:15], s39 offen offset:1024 sc1 lds
    s_add_u32 m0, m0, 2048
    s_add_u32 s39, s39, 65536
    buffer_load_dwordx4 v2, s[12:15], s39 offen sc1 lds
    buffer_load_dwordx4 v2, s[12:15], s39 offen offset:1024 sc1 lds
    s_mov_b32 m0, s19
    s_mov_b32 s39, s16
    s_add_u32 s24, s4, 0x1420000
    s_addc_u32 s25, s5, 0
    s_mov_b32 s26, 0x70000
    s_mov_b32 s27, 0x20000
    s_cmp_eq_u32 s60, 0
    s_cselect_b32 s26, s26, 0
    s_and_b32 s36, s30, 1
    s_mul_i32 s36, s36, 448
    s_mul_i32 s37, s29, 896
    s_add_u32 s37, s36, s37
    v_lshrrev_b32 v224, 5, v1
    v_mul_u32_u24 v224, 14336, v224
    v_and_b32 v179, 496, v2
    v_add_u32 v224, v224, v179
    buffer_load_dwordx4 v[180:183], v224, s[24:27], s37 offen sc1
    s_add_u32 s37, s37, 28672
    buffer_load_dwordx4 v[184:187], v224, s[24:27], s37 offen sc1
    s_add_u32 s37, s37, 28672
    buffer_load_dwordx4 v[188:191], v224, s[24:27], s37 offen sc1
    s_add_u32 s37, s37, 28672
    buffer_load_dwordx4 v[192:195], v224, s[24:27], s37 offen sc1
    s_add_u32 s37, s37, 28672
    s_waitcnt vmcnt(12)
    s_barrier
    buffer_load_dwordx4 v2, s[12:15], s39 offen sc1 lds
    buffer_load_dwordx4 v2, s[12:15], s39 offen offset:1024 sc1 lds
    s_add_u32 s19, s41, s42
    v_readlane_b32 s16, v248, s44
    s_nop 0
    s_add_u32 s16, s16, s38
    s_add_u32 s44, s44, 1
    s_and_b32 s44, s44, 15
    s_add_u32 s42, s42, 16384
    s_cmp_eq_u32 s42, 49152
    s_cselect_b32 s42, 0, s42
    s_add_u32 m0, m0, 2048
    s_add_u32 s39, s39, 65536
    buffer_load_dwordx4 v2, s[12:15], s39 offen sc1 lds
    buffer_load_dwordx4 v2, s[12:15], s39 offen offset:1024 sc1 lds
    s_add_u32 m0, m0, 2048
    s_add_u32 s39, s39, 65536
    buffer_load_dwordx4 v2, s[12:15], s39 offen sc1 lds
    buffer_load_dwordx4 v2, s[12:15], s39 offen offset:1024 sc1 lds
    s_add_u32 m0, m0, 2048
    s_add_u32 s39, s39, 65536
    buffer_load_dwordx4 v2, s[12:15], s39 offen sc1 lds
    buffer_load_dwordx4 v2, s[12:15], s39 offen offset:1024 sc1 lds
    s_mov_b32 m0, s19
    s_mov_b32 s39, s16
    buffer_load_dwordx4 v[196:199], v224, s[24:27], s37 offen sc1
    s_add_u32 s37, s37, 28672
    buffer_load_dwordx4 v[200:203], v224, s[24:27], s37 offen sc1
    s_add_u32 s37, s37, 28672
    buffer_load_dwordx4 v[204:207], v224, s[24:27], s37 offen sc1
    s_add_u32 s37, s37, 28672
    buffer_load_dwordx4 v[208:211], v224, s[24:27], s37 offen sc1
    s_add_u32 s37, s37, 28672
    buffer_load_dwordx4 v[212:215], v224, s[24:27], s37 offen sc1
    s_add_u32 s37, s37, 28672
    s_waitcnt vmcnt(17)
    s_barrier
    buffer_load_dwordx4 v2, s[12:15], s39 offen sc1 lds
    buffer_load_dwordx4 v2, s[12:15], s39 offen offset:1024 sc1 lds
    s_add_u32 s19, s41, s42
    v_readlane_b32 s16, v248, s44
    s_nop 0
    s_add_u32 s16, s16, s38
    s_add_u32 s44, s44, 1
    s_and_b32 s44, s44, 15
    s_add_u32 s42, s42, 16384
    s_cmp_eq_u32 s42, 49152
    s_cselect_b32 s42, 0, s42
    s_add_u32 m0, m0, 2048
    s_add_u32 s39, s39, 65536
    buffer_load_dwordx4 v2, s[12:15], s39 offen sc1 lds
    buffer_load_dwordx4 v2, s[12:15], s39 offen offset:1024 sc1 lds
    s_add_u32 m0, m0, 2048
    s_add_u32 s39, s39, 65536
    buffer_load_dwordx4 v2, s[12:15], s39 offen sc1 lds
    buffer_load_dwordx4 v2, s[12:15], s39 offen offset:1024 sc1 lds
    s_add_u32 m0, m0, 2048
    s_add_u32 s39, s39, 65536
    buffer_load_dwordx4 v2, s[12:15], s39 offen sc1 lds
    buffer_load_dwordx4 v2, s[12:15], s39 offen offset:1024 sc1 lds
    s_mov_b32 m0, s19
    s_mov_b32 s39, s16
    s_waitcnt vmcnt(13)
    s_barrier
    buffer_load_dwordx4 v2, s[12:15], s39 offen sc1 lds
    buffer_load_dwordx4 v2, s[12:15], s39 offen offset:1024 sc1 lds
    s_add_u32 s19, s41, s42
    v_readlane_b32 s16, v248, s44
    s_nop 0
    s_add_u32 s16, s16, s38
    s_add_u32 s44, s44, 1
    s_and_b32 s44, s44, 15
    s_add_u32 s42, s42, 16384
    s_cmp_eq_u32 s42, 49152
    s_cselect_b32 s42, 0, s42
    s_add_u32 m0, m0, 2048
    s_add_u32 s39, s39, 65536
    buffer_load_dwordx4 v2, s[12:15], s39 offen sc1 lds
    buffer_load_dwordx4 v2, s[12:15], s39 offen offset:1024 sc1 lds
    s_add_u32 m0, m0, 2048
    s_add_u32 s39, s39, 65536
    buffer_load_dwordx4 v2, s[12:15], s39 offen sc1 lds
    buffer_load_dwordx4 v2, s[12:15], s39 offen offset:1024 sc1 lds
    s_add_u32 m0, m0, 2048
    s_add_u32 s39, s39, 65536
    buffer_load_dwordx4 v2, s[12:15], s39 offen sc1 lds
    buffer_load_dwordx4 v2, s[12:15], s39 offen offset:1024 sc1 lds
    s_mov_b32 m0, s19
    s_mov_b32 s39, s16
    s_waitcnt vmcnt(16)
    s_cmp_lg_u32 s60, 0
    s_cbranch_scc1 pc_45
    v_add_f32 v180, v180, v184
    v_add_f32 v181, v181, v185
    v_add_f32 v182, v182, v186
    v_add_f32 v183, v183, v187
    v_add_f32 v180, v180, v188
    v_add_f32 v181, v181, v189
    v_add_f32 v182, v182, v190
    v_add_f32 v183, v183, v191
    v_add_f32 v180, v180, v192
    v_add_f32 v181, v181, v193
    v_add_f32 v182, v182, v194
    v_add_f32 v183, v183, v195
    v_add_f32 v180, v180, v196
    v_add_f32 v181, v181, v197
    v_add_f32 v182, v182, v198
    v_add_f32 v183, v183, v199
pc_45:
    s_mov_b64 exec, 1
    buffer_load_dword v223, v222, s[56:59], 0 offen sc1
    s_mov_b64 exec, -1
    s_waitcnt vmcnt(9)
    s_barrier
    buffer_load_dwordx4 v2, s[12:15], s39 offen sc1 lds
    buffer_load_dwordx4 v2, s[12:15], s39 offen offset:1024 sc1 lds
    s_add_u32 s19, s41, s42
    v_readlane_b32 s16, v248, s44
    s_nop 0
    s_add_u32 s16, s16, s38
    s_add_u32 s44, s44, 1
    s_and_b32 s44, s44, 15
    s_add_u32 s42, s42, 16384
    s_cmp_eq_u32 s42, 49152
    s_cselect_b32 s42, 0, s42
    s_add_u32 m0, m0, 2048
    s_add_u32 s39, s39, 65536
    buffer_load_dwordx4 v2, s[12:15], s39 offen sc1 lds
    buffer_load_dwordx4 v2, s[12:15], s39 offen offset:1024 sc1 lds
    s_add_u32 m0, m0, 2048
    s_add_u32 s39, s39, 65536
    buffer_load_dwordx4 v2, s[12:15], s39 offen sc1 lds
    buffer_load_dwordx4 v2, s[12:15], s39 offen offset:1024 sc1 lds
    s_add_u32 m0, m0, 2048
    s_add_u32 s39, s39, 65536
    buffer_load_dwordx4 v2, s[12:15], s39 offen sc1 lds
    buffer_load_dwordx4 v2, s[12:15], s39 offen offset:1024 sc1 lds
    s_mov_b32 m0, s19
    s_mov_b32 s39, s16
    s_cmp_lg_u32 s60, 0
    s_cbranch_scc1 pc_46
    v_add_f32 v180, v180, v200
    v_add_f32 v181, v181, v201
    v_add_f32 v182, v182, v202
    v_add_f32 v183, v183, v203
    v_add_f32 v180, v180, v204
    v_add_f32 v181, v181, v205
    v_add_f32 v182, v182, v206
    v_add_f32 v183, v183, v207
    v_add_f32 v180, v180, v208
    v_add_f32 v181, v181, v209
    v_add_f32 v182, v182, v210
    v_add_f32 v183, v183, v211
    v_add_f32 v180, v180, v212
    v_add_f32 v181, v181, v213
    v_add_f32 v182, v182, v214
    v_add_f32 v183, v183, v215
pc_46:
    buffer_load_dwordx4 v[184:187], v224, s[24:27], s37 offen sc1
    s_add_u32 s37, s37, 28672
    buffer_load_dwordx4 v[188:191], v224, s[24:27], s37 offen sc1
    s_add_u32 s37, s37, 28672
    buffer_load_dwordx4 v[192:195], v224, s[24:27], s37 offen sc1
    s_add_u32 s37, s37, 28672
    buffer_load_dwordx4 v[196:199], v224, s[24:27], s37 offen sc1
    s_add_u32 s37, s37, 28672
    buffer_load_dwordx4 v[200:203], v224, s[24:27], s37 offen sc1
    s_add_u32 s37, s37, 28672
    buffer_load_dwordx4 v[204:207], v224, s[24:27], s37 offen sc1
    s_add_u32 s37, s37, 28672
    buffer_load_dwordx4 v[208:211], v224, s[24:27], s37 offen sc1
    s_add_u32 s37, s37, 28672
    s_waitcnt vmcnt(16)
    s_barrier
    buffer_load_dwordx4 v2, s[12:15], s39 offen sc1 lds
    buffer_load_dwordx4 v2, s[12:15], s39 offen offset:1024 sc1 lds
    s_add_u32 s19, s41, s42
    v_readlane_b32 s16, v248, s44
    s_nop 0
    s_add_u32 s16, s16, s38
    s_add_u32 s44, s44, 1
    s_and_b32 s44, s44, 15
    s_add_u32 s42, s42, 16384
    s_cmp_eq_u32 s42, 49152
    s_cselect_b32 s42, 0, s42
    s_add_u32 m0, m0, 2048
    s_add_u32 s39, s39, 65536
    buffer_load_dwordx4 v2, s[12:15], s39 offen sc1 lds
    buffer_load_dwordx4 v2, s[12:15], s39 offen offset:1024 sc1 lds
    s_add_u32 m0, m0, 2048
    s_add_u32 s39, s39, 65536
    buffer_load_dwordx4 v2, s[12:15], s39 offen sc1 lds
    buffer_load_dwordx4 v2, s[12:15], s39 offen offset:1024 sc1 lds
    s_add_u32 m0, m0, 2048
    s_add_u32 s39, s39, 65536
    buffer_load_dwordx4 v2, s[12:15], s39 offen sc1 lds
    buffer_load_dwordx4 v2, s[12:15], s39 offen offset:1024 sc1 lds
    s_mov_b32 m0, s19
    s_mov_b32 s39, s16
    s_waitcnt vmcnt(23)
    v_readfirstlane_b32 s53, v223
    s_add_u32 s54, s52, 16
    s_cmp_eq_u32 s53, s54
    s_cbranch_scc1 fok_47
    s_mov_b32 s53, 0
    s_add_u32 s54, s52, 16
    s_bfm_b64 exec, 1, 0
poll_48:
    buffer_load_dword v223, v222, s[56:59], 0 offen sc1
    s_waitcnt vmcnt(0)
    v_xor_b32 v223, s54, v223
    v_cmp_eq_u32 vcc, 0, v223
    s_nop 0
    s_cmp_eq_u64 vcc, exec
    s_cbranch_scc1 pok_49
    s_sleep 5
    s_add_u32 s53, s53, 1
    s_cmp_lt_u32 s53, s61
    s_cbranch_scc1 poll_48
    s_mov_b32 s61, 0
pok_49:
    s_mov_b64 exec, -1
fok_47:
    s_add_u32 s20, s62, 0x5c8000
    s_addc_u32 s21, s63, 0
    s_mov_b32 s22, 0x6000
    s_mov_b32 s23, 0x20000
    s_and_b32 s35, s30, 1
    s_lshl_b32 s35, s35, 9
    s_add_u32 s36, s35, 0
    buffer_load_dwordx2 v[16:17], v221, s[20:23], s36 offen offset:0 sc1
    buffer_load_dwordx2 v[18:19], v221, s[20:23], s36 offen offset:1024 sc1
    buffer_load_dwordx2 v[20:21], v221, s[20:23], s36 offen offset:2048 sc1
    buffer_load_dwordx2 v[22:23], v221, s[20:23], s36 offen offset:3072 sc1
    s_add_u32 s36, s36, 4096
    buffer_load_dwordx2 v[24:25], v221, s[20:23], s36 offen offset:0 sc1
    buffer_load_dwordx2 v[26:27], v221, s[20:23], s36 offen offset:1024 sc1
    buffer_load_dwordx2 v[28:29], v221, s[20:23], s36 offen offset:2048 sc1
    buffer_load_dwordx2 v[30:31], v221, s[20:23], s36 offen offset:3072 sc1
    s_waitcnt vmcnt(23)
    s_barrier
    buffer_load_dwordx4 v2, s[12:15], s39 offen sc1 lds
    buffer_load_dwordx4 v2, s[12:15], s39 offen offset:1024 sc1 lds
    s_add_u32 s19, s41, s42
    v_readlane_b32 s16, v248, s44
    s_nop 0
    s_add_u32 s16, s16, s38
    s_add_u32 s44, s44, 1
    s_and_b32 s44, s44, 15
    s_add_u32 s42, s42, 16384
    s_cmp_eq_u32 s42, 49152
    s_cselect_b32 s42, 0, s42
    s_add_u32 m0, m0, 2048
    s_add_u32 s39, s39, 65536
    buffer_load_dwordx4 v2, s[12:15], s39 offen sc1 lds
    buffer_load_dwordx4 v2, s[12:15], s39 offen offset:1024 sc1 lds
    s_add_u32 m0, m0, 2048
    s_add_u32 s39, s39, 65536
    buffer_load_dwordx4 v2, s[12:15], s39 offen sc1 lds
    buffer_load_dwordx4 v2, s[12:15], s39 offen offset:1024 sc1 lds
    s_add_u32 m0, m0, 2048
    s_add_u32 s39, s39, 65536
    buffer_load_dwordx4 v2, s[12:15], s39 offen sc1 lds
    buffer_load_dwordx4 v2, s[12:15], s39 offen offset:1024 sc1 lds
    s_mov_b32 m0, s19
    s_mov_b32 s39, s16
    s_add_u32 s36, s35, 16384
    buffer_load_dwordx2 v[32:33], v221, s[20:23], s36 offen offset:0 sc1
    buffer_load_dwordx2 v[34:35], v221, s[20:23], s36 offen offset:1024 sc1
    buffer_load_dwordx2 v[36:37], v221, s[20:23], s36 offen offset:2048 sc1
    buffer_load_dwordx2 v[38:39], v221, s[20:23], s36 offen offset:3072 sc1
    s_add_u32 s36, s36, 4096
    buffer_load_dwordx2 v[40:41], v221, s[20:23], s36 offen offset:0 sc1
    buffer_load_dwordx2 v[42:43], v221, s[20:23], s36 offen offset:1024 sc1
    buffer_load_dwordx2 v[44:45], v221, s[20:23], s36 offen offset:2048 sc1
    buffer_load_dwordx2 v[46:47], v221, s[20:23], s36 offen offset:3072 sc1
    s_waitcnt vmcnt(24)
    s_barrier
    buffer_load_dwordx4 v2, s[12:15], s39 offen sc1 lds
    buffer_load_dwordx4 v2, s[12:15], s39 offen offset:1024 sc1 lds
    s_add_u32 s19, s41, s42
    v_readlane_b32 s16, v248, s44
    s_nop 0
    s_add_u32 s16, s16, s38
    s_add_u32 s44, s44, 1
    s_and_b32 s44, s44, 15
    s_add_u32 s42, s42, 16384
    s_cmp_eq_u32 s42, 49152
    s_cselect_b32 s42, 0, s42
    s_add_u32 m0, m0, 2048
    s_add_u32 s39, s39, 65536
    buffer_load_dwordx4 v2, s[12:15], s39 offen sc1 lds
    buffer_load_dwordx4 v2, s[12:15], s39 offen offset:1024 sc1 lds
    s_add_u32 m0, m0, 2048
    s_add_u32 s39, s39, 65536
    buffer_load_dwordx4 v2, s[12:15], s39 offen sc1 lds
    buffer_load_dwordx4 v2, s[12:15], s39 offen offset:1024 sc1 lds
    s_add_u32 m0, m0, 2048
    s_add_u32 s39, s39, 65536
    buffer_load_dwordx4 v2, s[12:15], s39 offen sc1 lds
    buffer_load_dwordx4 v2, s[12:15], s39 offen offset:1024 sc1 lds
    s_mov_b32 m0, s19
    s_mov_b32 s39, s16
    s_waitcnt vmcnt(40)
    s_cmp_lg_u32 s60, 0
    s_cbranch_scc1 pc_50
    v_add_f32 v180, v180, v184
    v_add_f32 v181, v181, v185
    v_add_f32 v182, v182, v186
    v_add_f32 v183, v183, v187
    v_add_f32 v180, v180, v188
    v_add_f32 v181, v181, v189
    v_add_f32 v182, v182, v190
    v_add_f32 v183, v183, v191
    v_add_f32 v180, v180, v192
    v_add_f32 v181, v181, v193
    v_add_f32 v182, v182, v194
    v_add_f32 v183, v183, v195
    v_add_f32 v180, v180, v196
    v_add_f32 v181, v181, v197
    v_add_f32 v182, v182, v198
    v_add_f32 v183, v183, v199
pc_50:
    s_waitcnt vmcnt(16)
    s_barrier
    buffer_load_dwordx4 v2, s[12:15], s39 offen sc1 lds
    buffer_load_dwordx4 v2, s[12:15], s39 offen offset:1024 sc1 lds
    s_add_u32 s19, s41, s42
    v_readlane_b32 s16, v248, s44
    s_nop 0
    s_add_u32 s16, s16, s38
    s_add_u32 s44, s44, 1
    s_and_b32 s44, s44, 15
    s_add_u32 s42, s42, 16384
    s_cmp_eq_u32 s42, 49152
    s_cselect_b32 s42, 0, s42
    s_add_u32 m0, m0, 2048
    s_add_u32 s39, s39, 65536
    buffer_load_dwordx4 v2, s[12:15], s39 offen sc1 lds
    buffer_load_dwordx4 v2, s[12:15], s39 offen offset:1024 sc1 lds
    s_add_u32 m0, m0, 2048
    s_add_u32 s39, s39, 65536
    buffer_load_dwordx4 v2, s[12:15], s39 offen sc1 lds
    buffer_load_dwordx4 v2, s[12:15], s39 offen offset:1024 sc1 lds
    s_add_u32 m0, m0, 2048
    s_add_u32 s39, s39, 65536
    buffer_load_dwordx4 v2, s[12:15], s39 offen sc1 lds
    buffer_load_dwordx4 v2, s[12:15], s39 offen offset:1024 sc1 lds
    s_mov_b32 m0, s19
    s_mov_b32 s39, s16
    s_cmp_lg_u32 s60, 0
    s_cbranch_scc1 pc_51
    v_add_f32 v180, v180, v200
    v_add_f32 v181, v181, v201
    v_add_f32 v182, v182, v202
    v_add_f32 v183, v183, v203
    v_add_f32 v180, v180, v204
    v_add_f32 v181, v181, v205
    v_add_f32 v182, v182, v206
    v_add_f32 v183, v183, v207
    v_add_f32 v180, v180, v208
    v_add_f32 v181, v181, v209
    v_add_f32 v182, v182, v210
    v_add_f32 v183, v183, v211
pc_51:
    s_waitcnt vmcnt(8)
    s_barrier
    buffer_load_dwordx4 v2, s[12:15], s39 offen sc1 lds
    buffer_load_dwordx4 v2, s[12:15], s39 offen offset:1024 sc1 lds
    s_add_u32 s19, s41, s42
    v_readlane_b32 s16, v248, s44
    s_nop 0
    s_add_u32 s16, s16, s38
    s_add_u32 s44, s44, 1
    s_and_b32 s44, s44, 15
    s_add_u32 s42, s42, 16384
    s_cmp_eq_u32 s42, 49152
    s_cselect_b32 s42, 0, s42
    s_add_u32 m0, m0, 2048
    s_add_u32 s39, s39, 65536
    buffer_load_dwordx4 v2, s[12:15], s39 offen sc1 lds
    buffer_load_dwordx4 v2, s[12:15], s39 offen offset:1024 sc1 lds
    s_add_u32 m0, m0, 2048
    s_add_u32 s39, s39, 65536
    buffer_load_dwordx4 v2, s[12:15], s39 offen sc1 lds
    buffer_load_dwordx4 v2, s[12:15], s39 offen offset:1024 sc1 lds
    s_add_u32 m0, m0, 2048
    s_add_u32 s39, s39, 65536
    buffer_load_dwordx4 v2, s[12:15], s39 offen sc1 lds
    buffer_load_dwordx4 v2, s[12:15], s39 offen offset:1024 sc1 lds
    s_mov_b32 m0, s19
    s_mov_b32 s39, s16
    s_cmp_lg_u32 s60, 0
    s_cbranch_scc1 pc_52
    v_mov_b32 v184, v180
    v_mov_b32 v185, v181
    v_mov_b32 v186, v182
    v_mov_b32 v187, v183
    v_permlane32_swap_b32 v180, v184
    v_permlane32_swap_b32 v181, v185
    v_permlane32_swap_b32 v182, v186
    v_permlane32_swap_b32 v183, v187
    v_add_f32 v180, v180, v184
    v_add_f32 v181, v181, v185
    v_add_f32 v182, v182, v186
    v_add_f32 v183, v183, v187
    s_and_b32 s36, s30, 1
    s_mul_i32 s36, s36, 448
    s_add_u32 s36, s36, 159744
    v_add_u32 v179, s36, v2
    s_bfm_b64 exec, 28, 0
    ds_write_b128 v179, v[180:183]
    s_mov_b64 exec, -1
    s_waitcnt lgkmcnt(0)
pc_52:
    s_waitcnt vmcnt(8)
    s_barrier
    buffer_load_dwordx4 v2, s[12:15], s39 offen sc1 lds
    buffer_load_dwordx4 v2, s[12:15], s39 offen offset:1024 sc1 lds
    s_add_u32 s19, s41, s42
    v_readlane_b32 s16, v248, s44
    s_nop 0
    s_add_u32 s16, s16, s38
    s_add_u32 s44, s44, 1
    s_and_b32 s44, s44, 15
    s_add_u32 s42, s42, 16384
    s_cmp_eq_u32 s42, 49152
    s_cselect_b32 s42, 0, s42
    s_add_u32 m0, m0, 2048
    s_add_u32 s39, s39, 65536
    buffer_load_dwordx4 v2, s[12:15], s39 offen sc1 lds
    buffer_load_dwordx4 v2, s[12:15], s39 offen offset:1024 sc1 lds
    s_add_u32 m0, m0, 2048
    s_add_u32 s39, s39, 65536
    buffer_load_dwordx4 v2, s[12:15], s39 offen sc1 lds
    buffer_load_dwordx4 v2, s[12:15], s39 offen offset:1024 sc1 lds
    s_add_u32 m0, m0, 2048
    s_add_u32 s39, s39, 65536
    buffer_load_dwordx4 v2, s[12:15], s39 offen sc1 lds
    buffer_load_dwordx4 v2, s[12:15], s39 offen offset:1024 sc1 lds
    s_mov_b32 m0, s19
    s_mov_b32 s39, s16
    s_waitcnt vmcnt(32)
    v_add_f32 v16, v16, v32
    v_add_f32 v17, v17, v33
    v_add_f32 v18, v18, v34
    v_add_f32 v19, v19, v35
    v_add_f32 v20, v20, v36
    v_add_f32 v21, v21, v37
    v_add_f32 v22, v22, v38
    v_add_f32 v23, v23, v39
    v_add_f32 v24, v24, v40
    v_add_f32 v25, v25, v41
    v_add_f32 v26, v26, v42
    v_add_f32 v27, v27, v43
    v_add_f32 v28, v28, v44
    v_add_f32 v29, v29, v45
    v_add_f32 v30, v30, v46
    v_add_f32 v31, v31, v47
    s_waitcnt vmcnt(8)
    s_barrier
    buffer_load_dwordx4 v2, s[12:15], s39 offen sc1 lds
    buffer_load_dwordx4 v2, s[12:15], s39 offen offset:1024 sc1 lds
    s_add_u32 s19, s41, s42
    v_readlane_b32 s16, v248, s44
    s_nop 0
    s_add_u32 s16, s16, s38
    s_add_u32 s44, s44, 1
    s_and_b32 s44, s44, 15
    s_add_u32 s42, s42, 16384
    s_cmp_eq_u32 s42, 49152
    s_cselect_b32 s42, 0, s42
    s_add_u32 m0, m0, 2048
    s_add_u32 s39, s39, 65536
    buffer_load_dwordx4 v2, s[12:15], s39 offen sc1 lds
    buffer_load_dwordx4 v2, s[12:15], s39 offen offset:1024 sc1 lds
    s_add_u32 m0, m0, 2048
    s_add_u32 s39, s39, 65536
    buffer_load_dwordx4 v2, s[12:15], s39 offen sc1 lds
    buffer_load_dwordx4 v2, s[12:15], s39 offen offset:1024 sc1 lds
    s_add_u32 m0, m0, 2048
    s_add_u32 s39, s39, 65536
    buffer_load_dwordx4 v2, s[12:15], s39 offen sc1 lds
    buffer_load_dwordx4 v2, s[12:15], s39 offen offset:1024 sc1 lds
    s_mov_b32 m0, s19
    s_mov_b32 s39, s16
    v_add_f32 v16, v16, v24
    v_add_f32 v17, v17, v25
    v_add_f32 v18, v18, v26
    v_add_f32 v19, v19, v27
    v_add_f32 v20, v20, v28
    v_add_f32 v21, v21, v29
    v_add_f32 v22, v22, v30
    v_add_f32 v23, v23, v31
    v_add_f32 v16, v16, v20
    v_add_f32 v17, v17, v21
    v_add_f32 v18, v18, v22
    v_add_f32 v19, v19, v23
    v_add_f32 v16, v16, v18
    v_add_f32 v17, v17, v19
    v_mul_f32 v20, 0x3a800000, v16
    v_mul_f32 v217, 0x3a800000, v17
    s_waitcnt vmcnt(8)
    s_barrier
    buffer_load_dwordx4 v2, s[12:15], s39 offen sc1 lds
    buffer_load_dwordx4 v2, s[12:15], s39 offen offset:1024 sc1 lds
    s_add_u32 m0, m0, 2048
    s_add_u32 s39, s39, 65536
    buffer_load_dwordx4 v2, s[12:15], s39 offen sc1 lds
    buffer_load_dwordx4 v2, s[12:15], s39 offen offset:1024 sc1 lds
    s_add_u32 m0, m0, 2048
    s_add_u32 s39, s39, 65536
    buffer_load_dwordx4 v2, s[12:15], s39 offen sc1 lds
    buffer_load_dwordx4 v2, s[12:15], s39 offen offset:1024 sc1 lds
    s_add_u32 m0, m0, 2048
    s_add_u32 s39, s39, 65536
    buffer_load_dwordx4 v2, s[12:15], s39 offen sc1 lds
    buffer_load_dwordx4 v2, s[12:15], s39 offen offset:1024 sc1 lds
    v_fma_f32 v217, -v20, v20, v217
    v_max_f32 v217, 0, v217
    v_add_f32 v217, 0x3727c5ac, v217
    v_sqrt_f32 v217, v217
    s_nop 0
    v_mov_b32 v21, v217
    v_rcp_f32 v219, v217
    s_nop 0
    v_mul_f32 v22, 0xc0135761, v219
    v_mul_f32 v23, v219, v219
    v_mul_f32 v23, v23, v22
    v_mul_f32 v23, 0x3d372713, v23
    s_lshl_b32 s35, s35, 1
    s_add_u32 s35, s35, 160768
    v_add_u32 v220, s35, v2
    ds_write_b128 v220, v[20:23]
    s_waitcnt lgkmcnt(0)
    s_waitcnt vmcnt(8)
    s_barrier
    s_call_b64 s[76:77], SUB_r_pre0
    s_waitcnt vmcnt(8)
    s_barrier
    s_cmp_lg_u32 s60, 0
    s_cbranch_scc1 tw4_56
    s_load_dwordx2 s[48:49], s[0:1], 80
    s_lshl_b32 s45, s2, 1
    s_and_b32 s50, s30, 1
    s_add_u32 s45, s45, s50
    s_mul_i32 s45, s45, 14336
    s_mov_b32 s50, 7340032
    s_mov_b32 s51, 0x20000
    s_waitcnt lgkmcnt(0)
    buffer_load_dwordx4 v[20:23], v2, s[48:51], s45 offen offset:0
    buffer_load_dwordx4 v[20:23], v2, s[48:51], s45 offen offset:1024
    buffer_load_dwordx4 v[20:23], v2, s[48:51], s45 offen offset:2048
    buffer_load_dwordx4 v[20:23], v2, s[48:51], s45 offen offset:3072
    s_add_u32 s45, s45, 4096
    buffer_load_dwordx4 v[20:23], v2, s[48:51], s45 offen offset:0
    buffer_load_dwordx4 v[20:23], v2, s[48:51], s45 offen offset:1024
    buffer_load_dwordx4 v[20:23], v2, s[48:51], s45 offen offset:2048
    buffer_load_dwordx4 v[20:23], v2, s[48:51], s45 offen offset:3072
    s_add_u32 s45, s45, 4096
    buffer_load_dwordx4 v[20:23], v2, s[48:51], s45 offen offset:0
    buffer_load_dwordx4 v[20:23], v2, s[48:51], s45 offen offset:1024
    buffer_load_dwordx4 v[20:23], v2, s[48:51], s45 offen offset:2048
    buffer_load_dwordx4 v[20:23], v2, s[48:51], s45 offen offset:3072
    s_add_u32 s45, s45, 4096
    buffer_load_dwordx4 v[20:23], v2, s[48:51], s45 offen offset:0
    buffer_load_dwordx4 v[20:23], v2, s[48:51], s45 offen offset:1024
tw4_56:
    s_barrier
    s_and_b32 s35, s30, 1
    s_add_u32 s12, s62, 0x400000
    s_addc_u32 s13, s63, 0
    s_mov_b32 s14, 0x1be000
    s_mov_b32 s15, 0x20000
    s_mul_i32 s38, s35, 917504
    s_mul_i32 s36, s31, 114688
    s_add_u32 s38, s38, s36
    s_lshl_b32 s41, s35, 13
    s_mov_b32 s42, 0
    s_mov_b32 s44, 0
    s_add_u32 s54, s55, 0x700
    s_lshl_b32 s53, s31, 7
    s_add_u32 s54, s54, s53
    v_mov_b32 v9, s54
    s_add_u32 s54, s55, 0x600
    s_lshl_b32 s53, s31, 7
    s_add_u32 s54, s54, s53
    v_mov_b32 v10, s54
    s_add_u32 s54, s55, 0x300
    s_lshl_b32 s53, s31, 7
    s_add_u32 s54, s54, s53
    v_mov_b32 v12, s54
    v_mov_b32 v13, 1
    s_and_b32 s51, s30, 1
    s_lshl_b32 s51, s51, 30
    s_lshl_b32 s54, s60, 2
    s_add_u32 s54, s54, 4
    v_mov_b32 v14, 162880
spin_57:
    s_sleep 2
    ds_read_b32 v15, v14
    s_waitcnt lgkmcnt(0)
    v_readfirstlane_b32 s53, v15
    s_nop 0
    s_cmp_ge_u32 s53, s54
    s_cbranch_scc0 spin_57
    s_mov_b64 exec, 1
    buffer_atomic_add v13, v9, s[56:59], s51 offen sc1
    s_mov_b64 exec, -1
    v_xor_b32 v15, 128, v12
    s_mov_b32 s44, 3
    s_call_b64 s[76:77], PREP_a_issue_4
    s_mov_b32 m0, s19
    s_mov_b32 s39, s16
    s_mov_b32 s40, s17
    s_waitcnt vmcnt(16)
    s_barrier
    s_mov_b64 exec, 1
    buffer_load_dword v8, v9, s[56:59], 0 offen sc1
    s_mov_b64 exec, -1
    s_waitcnt vmcnt(9)
    s_barrier
    s_waitcnt vmcnt(0)
    v_readfirstlane_b32 s53, v8
    s_add_u32 s54, s52, 8
    s_cmp_eq_u32 s53, s54
    s_cbranch_scc1 fok_58
    s_mov_b32 s53, 0
    s_add_u32 s54, s52, 8
    s_bfm_b64 exec, 1, 0
poll_59:
    buffer_load_dword v8, v9, s[56:59], 0 offen sc1
    s_waitcnt vmcnt(0)
    v_xor_b32 v8, s54, v8
    v_cmp_eq_u32 vcc, 0, v8
    s_nop 0
    s_cmp_eq_u64 vcc, exec
    s_cbranch_scc1 pok_60
    s_sleep 5
    s_add_u32 s53, s53, 1
    s_cmp_lt_u32 s53, s61
    s_cbranch_scc1 poll_59
    s_mov_b32 s61, 0
pok_60:
    s_mov_b64 exec, -1
fok_58:
    buffer_load_dwordx4 v2, s[12:15], s39 offen sc1 lds
    s_add_u32 m0, m0, 1024
    s_nop 0
    buffer_load_dwordx4 v2, s[12:15], s40 offen sc1 lds
    s_call_b64 s[76:77], PREP_a_issue_4
    s_add_u32 m0, m0, 1024
    s_add_u32 s39, s39, 229376
    buffer_load_dwordx4 v2, s[12:15], s39 offen sc1 lds
    s_add_u32 m0, m0, 1024
    s_add_u32 s40, s40, 229376
    buffer_load_dwordx4 v2, s[12:15], s40 offen sc1 lds
    s_add_u32 m0, m0, 1024
    s_add_u32 s39, s39, 229376
    buffer_load_dwordx4 v2, s[12:15], s39 offen sc1 lds
    s_add_u32 m0, m0, 1024
    s_add_u32 s40, s40, 229376
    buffer_load_dwordx4 v2, s[12:15], s40 offen sc1 lds
    s_add_u32 m0, m0, 1024
    s_add_u32 s39, s39, 229376
    buffer_load_dwordx4 v2, s[12:15], s39 offen sc1 lds
    s_add_u32 m0, m0, 1024
    s_add_u32 s40, s40, 229376
    buffer_load_dwordx4 v2, s[12:15], s40 offen sc1 lds
    s_mov_b32 m0, s19
    s_mov_b32 s39, s16
    s_mov_b32 s40, s17
    s_waitcnt vmcnt(9)
    s_barrier
    s_mov_b64 exec, 1
    buffer_atomic_add v13, v10, s[56:59], s51 offen sc1
    s_mov_b64 exec, -1
    buffer_load_dwordx4 v2, s[12:15], s39 offen sc1 lds
    s_add_u32 m0, m0, 1024
    s_nop 0
    buffer_load_dwordx4 v2, s[12:15], s40 offen sc1 lds
    s_call_b64 s[76:77], PREP_a_issue_4
    s_add_u32 m0, m0, 1024
    s_add_u32 s39, s39, 229376
    buffer_load_dwordx4 v2, s[12:15], s39 offen sc1 lds
    s_add_u32 m0, m0, 1024
    s_add_u32 s40, s40, 229376
    buffer_load_dwordx4 v2, s[12:15], s40 offen sc1 lds
    s_add_u32 m0, m0, 1024
    s_add_u32 s39, s39, 229376
    buffer_load_dwordx4 v2, s[12:15], s39 offen sc1 lds
    s_add_u32 m0, m0, 1024
    s_add_u32 s40, s40, 229376
    buffer_load_dwordx4 v2, s[12:15], s40 offen sc1 lds
    s_add_u32 m0, m0, 1024
    s_add_u32 s39, s39, 229376
    buffer_load_dwordx4 v2, s[12:15], s39 offen sc1 lds
    s_add_u32 m0, m0, 1024
    s_add_u32 s40, s40, 229376
    buffer_load_dwordx4 v2, s[12:15], s40 offen sc1 lds
    s_mov_b32 m0, s19
    s_mov_b32 s39, s16
    s_mov_b32 s40, s17
    s_waitcnt vmcnt(9)
    s_barrier
    buffer_load_dwordx4 v2, s[12:15], s39 offen sc1 lds
    s_add_u32 m0, m0, 1024
    s_nop 0
    buffer_load_dwordx4 v2, s[12:15], s40 offen sc1 lds
    s_call_b64 s[76:77], PREP_a_issue_4
    s_add_u32 m0, m0, 1024
    s_add_u32 s39, s39, 229376
    buffer_load_dwordx4 v2, s[12:15], s39 offen sc1 lds
    s_add_u32 m0, m0, 1024
    s_add_u32 s40, s40, 229376
    buffer_load_dwordx4 v2, s[12:15], s40 offen sc1 lds
    s_add_u32 m0, m0, 1024
    s_add_u32 s39, s39, 229376
    buffer_load_dwordx4 v2, s[12:15], s39 offen sc1 lds
    s_add_u32 m0, m0, 1024
    s_add_u32 s40, s40, 229376
    buffer_load_dwordx4 v2, s[12:15], s40 offen sc1 lds
    s_add_u32 m0, m0, 1024
    s_add_u32 s39, s39, 229376
    buffer_load_dwordx4 v2, s[12:15], s39 offen sc1 lds
    s_add_u32 m0, m0, 1024
    s_add_u32 s40, s40, 229376
    buffer_load_dwordx4 v2, s[12:15], s40 offen sc1 lds
    s_mov_b32 m0, s19
    s_mov_b32 s39, s16
    s_mov_b32 s40, s17
    s_waitcnt vmcnt(8)
    s_barrier
    buffer_load_dwordx4 v2, s[12:15], s39 offen sc1 lds
    s_add_u32 m0, m0, 1024
    s_nop 0
    buffer_load_dwordx4 v2, s[12:15], s40 offen sc1 lds
    s_mov_b64 exec, 1
    buffer_load_dword v11, v10, s[56:59], 0 offen sc1
    s_mov_b64 exec, -1
    s_call_b64 s[76:77], PREP_a_issue_4
    s_add_u32 m0, m0, 1024
    s_add_u32 s39, s39, 229376
    buffer_load_dwordx4 v2, s[12:15], s39 offen sc1 lds
    s_add_u32 m0, m0, 1024
    s_add_u32 s40, s40, 229376
    buffer_load_dwordx4 v2, s[12:15], s40 offen sc1 lds
    s_add_u32 m0, m0, 1024
    s_add_u32 s39, s39, 229376
    buffer_load_dwordx4 v2, s[12:15], s39 offen sc1 lds
    s_add_u32 m0, m0, 1024
    s_add_u32 s40, s40, 229376
    buffer_load_dwordx4 v2, s[12:15], s40 offen sc1 lds
    s_add_u32 m0, m0, 1024
    s_add_u32 s39, s39, 229376
    buffer_load_dwordx4 v2, s[12:15], s39 offen sc1 lds
    s_add_u32 m0, m0, 1024
    s_add_u32 s40, s40, 229376
    buffer_load_dwordx4 v2, s[12:15], s40 offen sc1 lds
    s_mov_b32 m0, s19
    s_mov_b32 s39, s16
    s_mov_b32 s40, s17
    s_waitcnt vmcnt(9)
    s_barrier
    s_mov_b64 exec, 1
    buffer_atomic_add v13, v12, s[56:59], s51 offen sc1
    s_mov_b64 exec, -1
    buffer_load_dwordx4 v2, s[12:15], s39 offen sc1 lds
    s_add_u32 m0, m0, 1024
    s_nop 0
    buffer_load_dwordx4 v2, s[12:15], s40 offen sc1 lds
    s_call_b64 s[76:77], PREP_a_issue_4
    s_add_u32 m0, m0, 1024
    s_add_u32 s39, s39, 229376
    buffer_load_dwordx4 v2, s[12:15], s39 offen sc1 lds
    s_add_u32 m0, m0, 1024
    s_add_u32 s40, s40, 229376
    buffer_load_dwordx4 v2, s[12:15], s40 offen sc1 lds
    s_add_u32 m0, m0, 1024
    s_add_u32 s39, s39, 229376
    buffer_load_dwordx4 v2, s[12:15], s39 offen sc1 lds
    s_add_u32 m0, m0, 1024
    s_add_u32 s40, s40, 229376
    buffer_load_dwordx4 v2, s[12:15], s40 offen sc1 lds
    s_add_u32 m0, m0, 1024
    s_add_u32 s39, s39, 229376
    buffer_load_dwordx4 v2, s[12:15], s39 offen sc1 lds
    s_add_u32 m0, m0, 1024
    s_add_u32 s40, s40, 229376
    buffer_load_dwordx4 v2, s[12:15], s40 offen sc1 lds
    s_mov_b32 m0, s19
    s_mov_b32 s39, s16
    s_mov_b32 s40, s17
    s_waitcnt vmcnt(9)
    s_barrier
    buffer_load_dwordx4 v2, s[12:15], s39 offen sc1 lds
    s_add_u32 m0, m0, 1024
    s_nop 0
    buffer_load_dwordx4 v2, s[12:15], s40 offen sc1 lds
    s_waitcnt vmcnt(17)
    v_readfirstlane_b32 s53, v11
    s_add_u32 s54, s52, 8
    s_cmp_eq_u32 s53, s54
    s_cbranch_scc1 fok_61
    s_mov_b32 s53, 0
    s_add_u32 s54, s52, 8
    s_bfm_b64 exec, 1, 0
poll_62:
    buffer_load_dword v11, v10, s[56:59], 0 offen sc1
    s_waitcnt vmcnt(0)
    v_xor_b32 v11, s54, v11
    v_cmp_eq_u32 vcc, 0, v11
    s_nop 0
    s_cmp_eq_u64 vcc, exec
    s_cbranch_scc1 pok_63
    s_sleep 5
    s_add_u32 s53, s53, 1
    s_cmp_lt_u32 s53, s61
    s_cbranch_scc1 poll_62
    s_mov_b32 s61, 0
pok_63:
    s_mov_b64 exec, -1
fok_61:
    s_call_b64 s[76:77], PREP_a_issue_4
    s_add_u32 m0, m0, 1024
    s_add_u32 s39, s39, 229376
    buffer_load_dwordx4 v2, s[12:15], s39 offen sc1 lds
    s_add_u32 m0, m0, 1024
    s_add_u32 s40, s40, 229376
    buffer_load_dwordx4 v2, s[12:15], s40 offen sc1 lds
    s_add_u32 m0, m0, 1024
    s_add_u32 s39, s39, 229376
    buffer_load_dwordx4 v2, s[12:15], s39 offen sc1 lds
    s_add_u32 m0, m0, 1024
    s_add_u32 s40, s40, 229376
    buffer_load_dwordx4 v2, s[12:15], s40 offen sc1 lds
    s_add_u32 m0, m0, 1024
    s_add_u32 s39, s39, 229376
    buffer_load_dwordx4 v2, s[12:15], s39 offen sc1 lds
    s_add_u32 m0, m0, 1024
    s_add_u32 s40, s40, 229376
    buffer_load_dwordx4 v2, s[12:15], s40 offen sc1 lds
    s_mov_b32 m0, s19
    s_mov_b32 s39, s16
    s_mov_b32 s40, s17
    s_waitcnt vmcnt(8)
    s_barrier
    buffer_load_dwordx4 v2, s[12:15], s39 offen sc1 lds
    s_add_u32 m0, m0, 1024
    s_nop 0
    buffer_load_dwordx4 v2, s[12:15], s40 offen sc1 lds
    s_mov_b32 s43, 1
ld_64:
    s_add_u32 s19, s41, s42
    v_readlane_b32 s16, v249, s44
    v_readlane_b32 s17, v250, s44
    s_add_u32 s16, s16, s38
    s_add_u32 s17, s17, s38
    s_add_u32 s44, s44, 1
    s_add_u32 s42, s42, 16384
    s_cmp_eq_u32 s42, 49152
    s_cselect_b32 s42, 0, s42
    s_add_u32 m0, m0, 1024
    s_add_u32 s39, s39, 229376
    buffer_load_dwordx4 v2, s[12:15], s39 offen sc1 lds
    s_add_u32 m0, m0, 1024
    s_add_u32 s40, s40, 229376
    buffer_load_dwordx4 v2, s[12:15], s40 offen sc1 lds
    s_add_u32 m0, m0, 1024
    s_add_u32 s39, s39, 229376
    buffer_load_dwordx4 v2, s[12:15], s39 offen sc1 lds
    s_add_u32 m0, m0, 1024
    s_add_u32 s40, s40, 229376
    buffer_load_dwordx4 v2, s[12:15], s40 offen sc1 lds
    s_add_u32 m0, m0, 1024
    s_add_u32 s39, s39, 229376
    buffer_load_dwordx4 v2, s[12:15], s39 offen sc1 lds
    s_add_u32 m0, m0, 1024
    s_add_u32 s40, s40, 229376
    buffer_load_dwordx4 v2, s[12:15], s40 offen sc1 lds
    s_mov_b32 m0, s19
    s_mov_b32 s39, s16
    s_mov_b32 s40, s17
    s_waitcnt vmcnt(8)
    s_barrier
    buffer_load_dwordx4 v2, s[12:15], s39 offen sc1 lds
    s_add_u32 m0, m0, 1024
    s_nop 0
    buffer_load_dwordx4 v2, s[12:15], s40 offen sc1 lds
    s_add_u32 s43, s43, 1
    s_cmp_lt_u32 s43, 4
    s_cbranch_scc1 ld_64
    s_call_b64 s[76:77], PREP_a_issue_4
    s_add_u32 m0, m0, 1024
    s_add_u32 s39, s39, 229376
    buffer_load_dwordx4 v2, s[12:15], s39 offen sc1 lds
    s_add_u32 m0, m0, 1024
    s_add_u32 s40, s40, 229376
    buffer_load_dwordx4 v2, s[12:15], s40 offen sc1 lds
    s_add_u32 m0, m0, 1024
    s_add_u32 s39, s39, 229376
    buffer_load_dwordx4 v2, s[12:15], s39 offen sc1 lds
    s_add_u32 m0, m0, 1024
    s_add_u32 s40, s40, 229376
    buffer_load_dwordx4 v2, s[12:15], s40 offen sc1 lds
    s_add_u32 m0, m0, 1024
    s_add_u32 s39, s39, 229376
    buffer_load_dwordx4 v2, s[12:15], s39 offen sc1 lds
    s_add_u32 m0, m0, 1024
    s_add_u32 s40, s40, 229376
    buffer_load_dwordx4 v2, s[12:15], s40 offen sc1 lds
    s_mov_b32 m0, s19
    s_mov_b32 s39, s16
    s_mov_b32 s40, s17
    s_waitcnt vmcnt(8)
    s_barrier
    buffer_load_dwordx4 v2, s[12:15], s39 offen sc1 lds
    s_add_u32 m0, m0, 1024
    s_nop 0
    buffer_load_dwordx4 v2, s[12:15], s40 offen sc1 lds
    s_mov_b64 exec, 1
    buffer_load_dword v11, v12, s[56:59], 0 offen sc1
    s_mov_b64 exec, -1
    s_call_b64 s[76:77], PREP_a_issue_4
    s_add_u32 m0, m0, 1024
    s_add_u32 s39, s39, 229376
    buffer_load_dwordx4 v2, s[12:15], s39 offen sc1 lds
    s_add_u32 m0, m0, 1024
    s_add_u32 s40, s40, 229376
    buffer_load_dwordx4 v2, s[12:15], s40 offen sc1 lds
    s_add_u32 m0, m0, 1024
    s_add_u32 s39, s39, 229376
    buffer_load_dwordx4 v2, s[12:15], s39 offen sc1 lds
    s_add_u32 m0, m0, 1024
    s_add_u32 s40, s40, 229376
    buffer_load_dwordx4 v2, s[12:15], s40 offen sc1 lds
    s_add_u32 m0, m0, 1024
    s_add_u32 s39, s39, 229376
    buffer_load_dwordx4 v2, s[12:15], s39 offen sc1 lds
    s_add_u32 m0, m0, 1024
    s_add_u32 s40, s40, 229376
    buffer_load_dwordx4 v2, s[12:15], s40 offen sc1 lds
    s_mov_b32 m0, s19
    s_mov_b32 s39, s16
    s_mov_b32 s40, s17
    s_waitcnt vmcnt(9)
    s_barrier
    buffer_load_dwordx4 v2, s[12:15], s39 offen sc1 lds
    s_add_u32 m0, m0, 1024
    s_nop 0
    buffer_load_dwordx4 v2, s[12:15], s40 offen sc1 lds
    s_call_b64 s[76:77], PREP_a_issue_4
    s_add_u32 m0, m0, 1024
    s_add_u32 s39, s39, 229376
    buffer_load_dwordx4 v2, s[12:15], s39 offen sc1 lds
    s_add_u32 m0, m0, 1024
    s_add_u32 s40, s40, 229376
    buffer_load_dwordx4 v2, s[12:15], s40 offen sc1 lds
    s_add_u32 m0, m0, 1024
    s_add_u32 s39, s39, 229376
    buffer_load_dwordx4 v2, s[12:15], s39 offen sc1 lds
    s_add_u32 m0, m0, 1024
    s_add_u32 s40, s40, 229376
    buffer_load_dwordx4 v2, s[12:15], s40 offen sc1 lds
    s_add_u32 m0, m0, 1024
    s_add_u32 s39, s39, 229376
    buffer_load_dwordx4 v2, s[12:15], s39 offen sc1 lds
    s_add_u32 m0, m0, 1024
    s_add_u32 s40, s40, 229376
    buffer_load_dwordx4 v2, s[12:15], s40 offen sc1 lds
    s_mov_b32 m0, s19
    s_mov_b32 s39, s16
    s_mov_b32 s40, s17
    s_waitcnt vmcnt(8)
    s_barrier
    buffer_load_dwordx4 v2, s[12:15], s39 offen sc1 lds
    s_add_u32 m0, m0, 1024
    s_nop 0
    buffer_load_dwordx4 v2, s[12:15], s40 offen sc1 lds
    s_waitcnt vmcnt(16)
    v_readfirstlane_b32 s53, v11
    s_add_u32 s54, s52, 8
    s_cmp_eq_u32 s53, s54
    s_cbranch_scc1 fok_65
    s_mov_b32 s53, 0
    s_add_u32 s54, s52, 8
    s_bfm_b64 exec, 1, 0
poll_66:
    buffer_load_dword v11, v12, s[56:59], 0 offen sc1
    s_waitcnt vmcnt(0)
    v_xor_b32 v11, s54, v11
    v_cmp_eq_u32 vcc, 0, v11
    s_nop 0
    s_cmp_eq_u64 vcc, exec
    s_cbranch_scc1 pok_67
    s_sleep 5
    s_add_u32 s53, s53, 1
    s_cmp_lt_u32 s53, s61
    s_cbranch_scc1 poll_66
    s_mov_b32 s61, 0
pok_67:
    s_mov_b64 exec, -1
fok_65:
    s_call_b64 s[76:77], PREP_a_issue_4
    s_add_u32 m0, m0, 1024
    s_add_u32 s39, s39, 229376
    buffer_load_dwordx4 v2, s[12:15], s39 offen sc1 lds
    s_add_u32 m0, m0, 1024
    s_add_u32 s40, s40, 229376
    buffer_load_dwordx4 v2, s[12:15], s40 offen sc1 lds
    s_add_u32 m0, m0, 1024
    s_add_u32 s39, s39, 229376
    buffer_load_dwordx4 v2, s[12:15], s39 offen sc1 lds
    s_add_u32 m0, m0, 1024
    s_add_u32 s40, s40, 229376
    buffer_load_dwordx4 v2, s[12:15], s40 offen sc1 lds
    s_add_u32 m0, m0, 1024
    s_add_u32 s39, s39, 229376
    buffer_load_dwordx4 v2, s[12:15], s39 offen sc1 lds
    s_add_u32 m0, m0, 1024
    s_add_u32 s40, s40, 229376
    buffer_load_dwordx4 v2, s[12:15], s40 offen sc1 lds
    s_mov_b32 m0, s19
    s_mov_b32 s39, s16
    s_mov_b32 s40, s17
    s_waitcnt vmcnt(8)
    s_barrier
    buffer_load_dwordx4 v2, s[12:15], s39 offen sc1 lds
    s_add_u32 m0, m0, 1024
    s_nop 0
    buffer_load_dwordx4 v2, s[12:15], s40 offen sc1 lds
    s_mov_b32 s43, 1
ld_68:
    s_add_u32 s19, s41, s42
    v_readlane_b32 s16, v249, s44
    v_readlane_b32 s17, v250, s44
    s_add_u32 s16, s16, s38
    s_add_u32 s17, s17, s38
    s_add_u32 s44, s44, 1
    s_add_u32 s42, s42, 16384
    s_cmp_eq_u32 s42, 49152
    s_cselect_b32 s42, 0, s42
    s_add_u32 m0, m0, 1024
    s_add_u32 s39, s39, 229376
    buffer_load_dwordx4 v2, s[12:15], s39 offen sc1 lds
    s_add_u32 m0, m0, 1024
    s_add_u32 s40, s40, 229376
    buffer_load_dwordx4 v2, s[12:15], s40 offen sc1 lds
    s_add_u32 m0, m0, 1024
    s_add_u32 s39, s39, 229376
    buffer_load_dwordx4 v2, s[12:15], s39 offen sc1 lds
    s_add_u32 m0, m0, 1024
    s_add_u32 s40, s40, 229376
    buffer_load_dwordx4 v2, s[12:15], s40 offen sc1 lds
    s_add_u32 m0, m0, 1024
    s_add_u32 s39, s39, 229376
    buffer_load_dwordx4 v2, s[12:15], s39 offen sc1 lds
    s_add_u32 m0, m0, 1024
    s_add_u32 s40, s40, 229376
    buffer_load_dwordx4 v2, s[12:15], s40 offen sc1 lds
    s_mov_b32 m0, s19
    s_mov_b32 s39, s16
    s_mov_b32 s40, s17
    s_waitcnt vmcnt(8)
    s_barrier
    buffer_load_dwordx4 v2, s[12:15], s39 offen sc1 lds
    s_add_u32 m0, m0, 1024
    s_nop 0
    buffer_load_dwordx4 v2, s[12:15], s40 offen sc1 lds
    s_add_u32 s43, s43, 1
    s_cmp_lt_u32 s43, 5
    s_cbranch_scc1 ld_68
    s_call_b64 s[76:77], PREP_a_issue_4
    s_add_u32 m0, m0, 1024
    s_add_u32 s39, s39, 229376
    buffer_load_dwordx4 v2, s[12:15], s39 offen sc1 lds
    s_add_u32 m0, m0, 1024
    s_add_u32 s40, s40, 229376
    buffer_load_dwordx4 v2, s[12:15], s40 offen sc1 lds
    s_add_u32 m0, m0, 1024
    s_add_u32 s39, s39, 229376
    buffer_load_dwordx4 v2, s[12:15], s39 offen sc1 lds
    s_add_u32 m0, m0, 1024
    s_add_u32 s40, s40, 229376
    buffer_load_dwordx4 v2, s[12:15], s40 offen sc1 lds
    s_add_u32 m0, m0, 1024
    s_add_u32 s39, s39, 229376
    buffer_load_dwordx4 v2, s[12:15], s39 offen sc1 lds
    s_add_u32 m0, m0, 1024
    s_add_u32 s40, s40, 229376
    buffer_load_dwordx4 v2, s[12:15], s40 offen sc1 lds
    s_mov_b32 m0, s19
    s_mov_b32 s39, s16
    s_mov_b32 s40, s17
    s_waitcnt vmcnt(8)
    s_barrier
    buffer_load_dwordx4 v2, s[12:15], s39 offen sc1 lds
    s_add_u32 m0, m0, 1024
    s_nop 0
    buffer_load_dwordx4 v2, s[12:15], s40 offen sc1 lds
    s_mov_b64 exec, 1
    buffer_load_dword v11, v15, s[56:59], 0 offen sc1
    s_mov_b64 exec, -1
    s_call_b64 s[76:77], PREP_a_issue_4
    s_add_u32 m0, m0, 1024
    s_add_u32 s39, s39, 229376
    buffer_load_dwordx4 v2, s[12:15], s39 offen sc1 lds
    s_add_u32 m0, m0, 1024
    s_add_u32 s40, s40, 229376
    buffer_load_dwordx4 v2, s[12:15], s40 offen sc1 lds
    s_add_u32 m0, m0, 1024
    s_add_u32 s39, s39, 229376
    buffer_load_dwordx4 v2, s[12:15], s39 offen sc1 lds
    s_add_u32 m0, m0, 1024
    s_add_u32 s40, s40, 229376
    buffer_load_dwordx4 v2, s[12:15], s40 offen sc1 lds
    s_add_u32 m0, m0, 1024
    s_add_u32 s39, s39, 229376
    buffer_load_dwordx4 v2, s[12:15], s39 offen sc1 lds
    s_add_u32 m0, m0, 1024
    s_add_u32 s40, s40, 229376
    buffer_load_dwordx4 v2, s[12:15], s40 offen sc1 lds
    s_mov_b32 m0, s19
    s_mov_b32 s39, s16
    s_mov_b32 s40, s17
    s_waitcnt vmcnt(9)
    s_barrier
    buffer_load_dwordx4 v2, s[12:15], s39 offen sc1 lds
    s_add_u32 m0, m0, 1024
    s_nop 0
    buffer_load_dwordx4 v2, s[12:15], s40 offen sc1 lds
    s_call_b64 s[76:77], PREP_a_issue_4
    s_add_u32 m0, m0, 1024
    s_add_u32 s39, s39, 229376
    buffer_load_dwordx4 v2, s[12:15], s39 offen sc1 lds
    s_add_u32 m0, m0, 1024
    s_add_u32 s40, s40, 229376
    buffer_load_dwordx4 v2, s[12:15], s40 offen sc1 lds
    s_add_u32 m0, m0, 1024
    s_add_u32 s39, s39, 229376
    buffer_load_dwordx4 v2, s[12:15], s39 offen sc1 lds
    s_add_u32 m0, m0, 1024
    s_add_u32 s40, s40, 229376
    buffer_load_dwordx4 v2, s[12:15], s40 offen sc1 lds
    s_add_u32 m0, m0, 1024
    s_add_u32 s39, s39, 229376
    buffer_load_dwordx4 v2, s[12:15], s39 offen sc1 lds
    s_add_u32 m0, m0, 1024
    s_add_u32 s40, s40, 229376
    buffer_load_dwordx4 v2, s[12:15], s40 offen sc1 lds
    s_mov_b32 m0, s19
    s_mov_b32 s39, s16
    s_mov_b32 s40, s17
    s_waitcnt vmcnt(8)
    s_barrier
    buffer_load_dwordx4 v2, s[12:15], s39 offen sc1 lds
    s_add_u32 m0, m0, 1024
    s_nop 0
    buffer_load_dwordx4 v2, s[12:15], s40 offen sc1 lds
    s_waitcnt vmcnt(16)
    v_readfirstlane_b32 s53, v11
    s_add_u32 s54, s52, 8
    s_cmp_eq_u32 s53, s54
    s_cbranch_scc1 fok_69
    s_mov_b32 s53, 0
    s_add_u32 s54, s52, 8
    s_bfm_b64 exec, 1, 0
poll_70:
    buffer_load_dword v11, v15, s[56:59], 0 offen sc1
    s_waitcnt vmcnt(0)
    v_xor_b32 v11, s54, v11
    v_cmp_eq_u32 vcc, 0, v11
    s_nop 0
    s_cmp_eq_u64 vcc, exec
    s_cbranch_scc1 pok_71
    s_sleep 5
    s_add_u32 s53, s53, 1
    s_cmp_lt_u32 s53, s61
    s_cbranch_scc1 poll_70
    s_mov_b32 s61, 0
pok_71:
    s_mov_b64 exec, -1
fok_69:
    s_call_b64 s[76:77], PREP_a_issue_4
    s_add_u32 m0, m0, 1024
    s_add_u32 s39, s39, 229376
    buffer_load_dwordx4 v2, s[12:15], s39 offen sc1 lds
    s_add_u32 m0, m0, 1024
    s_add_u32 s40, s40, 229376
    buffer_load_dwordx4 v2, s[12:15], s40 offen sc1 lds
    s_add_u32 m0, m0, 1024
    s_add_u32 s39, s39, 229376
    buffer_load_dwordx4 v2, s[12:15], s39 offen sc1 lds
    s_add_u32 m0, m0, 1024
    s_add_u32 s40, s40, 229376
    buffer_load_dwordx4 v2, s[12:15], s40 offen sc1 lds
    s_add_u32 m0, m0, 1024
    s_add_u32 s39, s39, 229376
    buffer_load_dwordx4 v2, s[12:15], s39 offen sc1 lds
    s_add_u32 m0, m0, 1024
    s_add_u32 s40, s40, 229376
    buffer_load_dwordx4 v2, s[12:15], s40 offen sc1 lds
    s_mov_b32 m0, s19
    s_mov_b32 s39, s16
    s_mov_b32 s40, s17
    s_waitcnt vmcnt(8)
    s_barrier
    buffer_load_dwordx4 v2, s[12:15], s39 offen sc1 lds
    s_add_u32 m0, m0, 1024
    s_nop 0
    buffer_load_dwordx4 v2, s[12:15], s40 offen sc1 lds
    s_mov_b32 s43, 1
ld_72:
    s_add_u32 s19, s41, s42
    v_readlane_b32 s16, v249, s44
    v_readlane_b32 s17, v250, s44
    s_add_u32 s16, s16, s38
    s_add_u32 s17, s17, s38
    s_add_u32 s44, s44, 1
    s_add_u32 s42, s42, 16384
    s_cmp_eq_u32 s42, 49152
    s_cselect_b32 s42, 0, s42
    s_add_u32 m0, m0, 1024
    s_add_u32 s39, s39, 229376
    buffer_load_dwordx4 v2, s[12:15], s39 offen sc1 lds
    s_add_u32 m0, m0, 1024
    s_add_u32 s40, s40, 229376
    buffer_load_dwordx4 v2, s[12:15], s40 offen sc1 lds
    s_add_u32 m0, m0, 1024
    s_add_u32 s39, s39, 229376
    buffer_load_dwordx4 v2, s[12:15], s39 offen sc1 lds
    s_add_u32 m0, m0, 1024
    s_add_u32 s40, s40, 229376
    buffer_load_dwordx4 v2, s[12:15], s40 offen sc1 lds
    s_add_u32 m0, m0, 1024
    s_add_u32 s39, s39, 229376
    buffer_load_dwordx4 v2, s[12:15], s39 offen sc1 lds
    s_add_u32 m0, m0, 1024
    s_add_u32 s40, s40, 229376
    buffer_load_dwordx4 v2, s[12:15], s40 offen sc1 lds
    s_mov_b32 m0, s19
    s_mov_b32 s39, s16
    s_mov_b32 s40, s17
    s_waitcnt vmcnt(8)
    s_barrier
    buffer_load_dwordx4 v2, s[12:15], s39 offen sc1 lds
    s_add_u32 m0, m0, 1024
    s_nop 0
    buffer_load_dwordx4 v2, s[12:15], s40 offen sc1 lds
    s_add_u32 s43, s43, 1
    s_cmp_lt_u32 s43, 3
    s_cbranch_scc1 ld_72
    s_call_b64 s[76:77], PREP_a_issue_4
    s_add_u32 m0, m0, 1024
    s_add_u32 s39, s39, 229376
    buffer_load_dwordx4 v2, s[12:15], s39 offen sc1 lds
    s_add_u32 m0, m0, 1024
    s_add_u32 s40, s40, 229376
    buffer_load_dwordx4 v2, s[12:15], s40 offen sc1 lds
    s_add_u32 m0, m0, 1024
    s_add_u32 s39, s39, 229376
    buffer_load_dwordx4 v2, s[12:15], s39 offen sc1 lds
    s_add_u32 m0, m0, 1024
    s_add_u32 s40, s40, 229376
    buffer_load_dwordx4 v2, s[12:15], s40 offen sc1 lds
    s_add_u32 m0, m0, 1024
    s_add_u32 s39, s39, 229376
    buffer_load_dwordx4 v2, s[12:15], s39 offen sc1 lds
    s_add_u32 m0, m0, 1024
    s_add_u32 s40, s40, 229376
    buffer_load_dwordx4 v2, s[12:15], s40 offen sc1 lds
    s_mov_b32 m0, s19
    s_mov_b32 s39, s16
    s_mov_b32 s40, s17
    s_waitcnt vmcnt(8)
    s_barrier
    buffer_load_dwordx4 v2, s[12:15], s39 offen sc1 lds
    s_add_u32 m0, m0, 1024
    s_nop 0
    buffer_load_dwordx4 v2, s[12:15], s40 offen sc1 lds
    s_add_u32 m0, m0, 1024
    s_add_u32 s39, s39, 229376
    buffer_load_dwordx4 v2, s[12:15], s39 offen sc1 lds
    s_add_u32 m0, m0, 1024
    s_add_u32 s40, s40, 229376
    buffer_load_dwordx4 v2, s[12:15], s40 offen sc1 lds
    s_add_u32 m0, m0, 1024
    s_add_u32 s39, s39, 229376
    buffer_load_dwordx4 v2, s[12:15], s39 offen sc1 lds
    s_add_u32 m0, m0, 1024
    s_add_u32 s40, s40, 229376
    buffer_load_dwordx4 v2, s[12:15], s40 offen sc1 lds
    s_add_u32 m0, m0, 1024
    s_add_u32 s39, s39, 229376
    buffer_load_dwordx4 v2, s[12:15], s39 offen sc1 lds
    s_add_u32 m0, m0, 1024
    s_add_u32 s40, s40, 229376
    buffer_load_dwordx4 v2, s[12:15], s40 offen sc1 lds
    s_waitcnt vmcnt(8)
    s_barrier
    s_waitcnt vmcnt(0)
    s_barrier
    s_cmp_eq_u32 s60, 1
    s_cbranch_scc1 K_fin
    s_barrier
    s_branch NEXT
WLOAD:
    s_cmp_eq_u32 s60, 1
    s_cbranch_scc1 WL_1
    s_mov_b64 s[12:13], s[68:69]
    s_mov_b32 s14, 2097152
    s_mov_b32 s15, 0x20000
    s_and_b32 s35, s30, 1
    s_mul_i32 s38, s99, 128
    s_mul_i32 s41, s35, 65536
    s_add_u32 s38, s38, s41
    s_mul_i32 s41, s35, 4096
    s_add_u32 s41, s41, 24576
    s_mov_b32 s42, 0
    s_mov_b32 s44, s67
    s_branch WL_2
WL_1:
    s_mov_b64 s[12:13], s[68:69]
    s_mov_b32 s14, 2097152
    s_mov_b32 s15, 0x20000
    s_and_b32 s35, s30, 1
    s_mul_i32 s38, s99, 128
    s_mul_i32 s41, s35, 65536
    s_add_u32 s38, s38, s41
    s_mul_i32 s41, s35, 4096
    s_add_u32 s41, s41, 24576
    s_mov_b32 s42, 0
    s_mov_b32 s44, s67
WL_2:
    s_waitcnt vmcnt(0)
    s_barrier
    s_call_b64 s[76:77], SUB_after_g1
    s_barrier
    s_waitcnt vmcnt(0)
    s_barrier
    s_call_b64 s[76:77], SUB_after_g2
    s_mov_b64 s[12:13], s[72:73]
    s_mov_b32 s14, 7340032
    s_mov_b32 s15, 0x20000
    s_and_b32 s35, s30, 1
    s_mul_i32 s38, s29, 448
    s_mul_i32 s41, s35, 229376
    s_add_u32 s38, s38, s41
    s_mul_i32 s41, s35, 14336
    s_add_u32 s41, s41, 73728
    s_mov_b32 s42, 0
    s_mov_b32 s44, 0
    s_mov_b32 s42, 28672
    s_mov_b32 s44, 2
    s_add_u32 s19, s41, s42
    v_readlane_b32 s16, v248, s44
    s_nop 0
    s_add_u32 s16, s16, s38
    s_add_u32 s44, s44, 1
    s_and_b32 s44, s44, 15
    s_add_u32 s42, s42, 28672
    s_cmp_eq_u32 s42, 86016
    s_cselect_b32 s42, 0, s42
    s_mov_b32 m0, s19
    s_mov_b32 s39, s16
    s_waitcnt vmcnt(0)
    s_barrier
    buffer_load_dwordx4 v241, s[12:15], s39 offen lds
    s_add_u32 m0, m0, 1024
    s_nop 0
    buffer_load_dwordx4 v242, s[12:15], s39 offen lds
    s_add_u32 m0, m0, 1024
    s_nop 0
    buffer_load_dwordx4 v243, s[12:15], s39 offen lds
    s_mov_b32 s43, 1
ld_73:
    s_add_u32 s19, s41, s42
    v_readlane_b32 s16, v248, s44
    s_nop 0
    s_add_u32 s16, s16, s38
    s_add_u32 s44, s44, 1
    s_and_b32 s44, s44, 15
    s_add_u32 s42, s42, 28672
    s_cmp_eq_u32 s42, 86016
    s_cselect_b32 s42, 0, s42
    s_add_u32 m0, m0, 1024
    s_nop 0
    buffer_load_dwordx4 v244, s[12:15], s39 offen lds
    s_add_u32 m0, m0, 1024
    s_nop 0
    buffer_load_dwordx4 v245, s[12:15], s39 offen lds
    s_add_u32 m0, m0, 1024
    s_nop 0
    buffer_load_dwordx4 v246, s[12:15], s39 offen lds
    s_add_u32 m0, m0, 1024
    s_nop 0
    buffer_load_dwordx4 v247, s[12:15], s39 offen lds
    s_add_u32 m0, m0, 1024
    s_add_u32 s39, s39, 114688
    buffer_load_dwordx4 v241, s[12:15], s39 offen lds
    s_add_u32 m0, m0, 1024
    s_nop 0
    buffer_load_dwordx4 v242, s[12:15], s39 offen lds
    s_add_u32 m0, m0, 1024
    s_nop 0
    buffer_load_dwordx4 v243, s[12:15], s39 offen lds
    s_add_u32 m0, m0, 1024
    s_nop 0
    buffer_load_dwordx4 v244, s[12:15], s39 offen lds
    s_add_u32 m0, m0, 1024
    s_nop 0
    buffer_load_dwordx4 v245, s[12:15], s39 offen lds
    s_add_u32 m0, m0, 1024
    s_nop 0
    buffer_load_dwordx4 v246, s[12:15], s39 offen lds
    s_add_u32 m0, m0, 1024
    s_nop 0
    buffer_load_dwordx4 v247, s[12:15], s39 offen lds
    s_mov_b32 m0, s19
    s_mov_b32 s39, s16
    s_waitcnt vmcnt(14)
    s_barrier
    buffer_load_dwordx4 v241, s[12:15], s39 offen lds
    s_add_u32 m0, m0, 1024
    s_nop 0
    buffer_load_dwordx4 v242, s[12:15], s39 offen lds
    s_add_u32 m0, m0, 1024
    s_nop 0
    buffer_load_dwordx4 v243, s[12:15], s39 offen lds
    s_add_u32 s43, s43, 1
    s_cmp_lt_u32 s43, 13
    s_cbranch_scc1 ld_73
    s_add_u32 s19, s41, s42
    v_readlane_b32 s16, v248, s44
    s_nop 0
    s_add_u32 s16, s16, s38
    s_add_u32 s44, s44, 1
    s_and_b32 s44, s44, 15
    s_add_u32 s42, s42, 28672
    s_cmp_eq_u32 s42, 86016
    s_cselect_b32 s42, 0, s42
    s_add_u32 m0, m0, 1024
    s_nop 0
    buffer_load_dwordx4 v244, s[12:15], s39 offen lds
    s_add_u32 m0, m0, 1024
    s_nop 0
    buffer_load_dwordx4 v245, s[12:15], s39 offen lds
    s_add_u32 m0, m0, 1024
    s_nop 0
    buffer_load_dwordx4 v246, s[12:15], s39 offen lds
    s_add_u32 m0, m0, 1024
    s_nop 0
    buffer_load_dwordx4 v247, s[12:15], s39 offen lds
    s_add_u32 m0, m0, 1024
    s_add_u32 s39, s39, 114688
    buffer_load_dwordx4 v241, s[12:15], s39 offen lds
    s_add_u32 m0, m0, 1024
    s_nop 0
    buffer_load_dwordx4 v242, s[12:15], s39 offen lds
    s_add_u32 m0, m0, 1024
    s_nop 0
    buffer_load_dwordx4 v243, s[12:15], s39 offen lds
    s_add_u32 m0, m0, 1024
    s_nop 0
    buffer_load_dwordx4 v244, s[12:15], s39 offen lds
    s_add_u32 m0, m0, 1024
    s_nop 0
    buffer_load_dwordx4 v245, s[12:15], s39 offen lds
    s_add_u32 m0, m0, 1024
    s_nop 0
    buffer_load_dwordx4 v246, s[12:15], s39 offen lds
    s_add_u32 m0, m0, 1024
    s_nop 0
    buffer_load_dwordx4 v247, s[12:15], s39 offen lds
    s_mov_b32 m0, s19
    s_mov_b32 s39, s16
    s_waitcnt vmcnt(14)
    s_barrier
    buffer_load_dwordx4 v241, s[12:15], s39 offen lds
    s_add_u32 m0, m0, 1024
    s_nop 0
    buffer_load_dwordx4 v242, s[12:15], s39 offen lds
    s_add_u32 m0, m0, 1024
    s_nop 0
    buffer_load_dwordx4 v243, s[12:15], s39 offen lds
    s_add_u32 m0, m0, 1024
    s_nop 0
    buffer_load_dwordx4 v244, s[12:15], s39 offen lds
    s_add_u32 m0, m0, 1024
    s_nop 0
    buffer_load_dwordx4 v245, s[12:15], s39 offen lds
    s_add_u32 m0, m0, 1024
    s_nop 0
    buffer_load_dwordx4 v246, s[12:15], s39 offen lds
    s_add_u32 m0, m0, 1024
    s_nop 0
    buffer_load_dwordx4 v247, s[12:15], s39 offen lds
    s_add_u32 m0, m0, 1024
    s_add_u32 s39, s39, 114688
    buffer_load_dwordx4 v241, s[12:15], s39 offen lds
    s_add_u32 m0, m0, 1024
    s_nop 0
    buffer_load_dwordx4 v242, s[12:15], s39 offen lds
    s_add_u32 m0, m0, 1024
    s_nop 0
    buffer_load_dwordx4 v243, s[12:15], s39 offen lds
    s_add_u32 m0, m0, 1024
    s_nop 0
    buffer_load_dwordx4 v244, s[12:15], s39 offen lds
    s_add_u32 m0, m0, 1024
    s_nop 0
    buffer_load_dwordx4 v245, s[12:15], s39 offen lds
    s_add_u32 m0, m0, 1024
    s_nop 0
    buffer_load_dwordx4 v246, s[12:15], s39 offen lds
    s_add_u32 m0, m0, 1024
    s_nop 0
    buffer_load_dwordx4 v247, s[12:15], s39 offen lds
    s_waitcnt vmcnt(14)
    s_barrier
    s_call_b64 s[76:77], SUB_r_pre0
    s_waitcnt vmcnt(8)
    s_barrier
    s_barrier
    s_mov_b64 s[12:13], s[74:75]
    s_mov_b32 s14, 7340032
    s_mov_b32 s15, 0x20000
    s_and_b32 s35, s30, 1
    s_mul_i32 s38, s33, 256
    s_mul_i32 s41, s31, 3670016
    s_add_u32 s38, s38, s41
    s_mul_i32 s41, s35, 8192
    s_add_u32 s41, s41, 49152
    s_mov_b32 s42, 0
    s_mov_b32 s44, 0
    s_mov_b32 s49, s44
    s_and_b32 s43, s28, 3
    s_mul_i32 s43, s43, 6
    s_lshr_b32 s43, s43, 2
    s_mov_b32 s50, 0
wpre_74:
    s_mul_i32 s42, s43, 16384
    s_add_u32 s44, s49, s43
    s_mov_b32 s45, 8192
    s_add_u32 s19, s41, s42
    v_readlane_b32 s16, v249, s44
    s_nop 0
    s_bitcmp1_b32 s16, 0
    s_cselect_b32 s17, 16384, s45
    s_cselect_b32 s18, -40960, s45
    s_andn2_b32 s16, s16, 1
    s_add_u32 s16, s16, s38
    s_add_u32 s44, s44, 1
    s_add_u32 s42, s42, 16384
    s_cmp_eq_u32 s42, 98304
    s_cselect_b32 s42, 0, s42
    s_mov_b32 m0, s19
    s_mov_b32 s39, s16
    s_mov_b32 s32, s17
    s_mov_b32 s3, s18
    buffer_load_dwordx4 v239, s[12:15], s39 offen lds
    s_add_u32 m0, m0, 1024
    s_add_u32 s39, s39, s32
    buffer_load_dwordx4 v240, s[12:15], s39 offen lds
    s_add_u32 m0, m0, 1024
    s_add_u32 s39, s39, s32
    buffer_load_dwordx4 v239, s[12:15], s39 offen lds
    s_add_u32 m0, m0, 1024
    s_add_u32 s39, s39, s32
    buffer_load_dwordx4 v240, s[12:15], s39 offen lds
    s_waitcnt vmcnt(6)
    s_add_u32 m0, m0, 1024
    s_add_u32 s39, s39, s3
    buffer_load_dwordx4 v239, s[12:15], s39 offen lds
    s_add_u32 m0, m0, 1024
    s_add_u32 s39, s39, s32
    buffer_load_dwordx4 v240, s[12:15], s39 offen lds
    s_add_u32 m0, m0, 1024
    s_add_u32 s39, s39, s32
    buffer_load_dwordx4 v239, s[12:15], s39 offen lds
    s_add_u32 m0, m0, 1024
    s_add_u32 s39, s39, s32
    buffer_load_dwordx4 v240, s[12:15], s39 offen lds
    s_waitcnt vmcnt(6)
    s_add_u32 s43, s43, 1
    s_cmp_eq_u32 s43, 6
    s_cselect_b32 s43, 0, s43
    s_add_u32 s50, s50, 1
    s_cmp_lt_u32 s50, 6
    s_cbranch_scc1 wpre_74
    s_mov_b32 s42, 0
    s_add_u32 s44, s49, 6
    s_cmp_eq_u32 s60, 1
    s_cbranch_scc1 WL_t1
    s_call_b64 s[76:77], PREP_w_issue_4
    s_mov_b32 m0, s19
    s_mov_b32 s39, s16
    s_mov_b32 s32, s17
    s_mov_b32 s3, s18
    s_waitcnt vmcnt(0)
    s_barrier
    s_waitcnt vmcnt(0)
    s_barrier
    buffer_load_dwordx4 v239, s[12:15], s39 offen lds
    s_add_u32 m0, m0, 1024
    s_add_u32 s39, s39, s32
    buffer_load_dwordx4 v240, s[12:15], s39 offen lds
    s_call_b64 s[76:77], PREP_w_issue_4
    s_add_u32 m0, m0, 1024
    s_add_u32 s39, s39, s32
    buffer_load_dwordx4 v239, s[12:15], s39 offen lds
    s_add_u32 m0, m0, 1024
    s_add_u32 s39, s39, s32
    buffer_load_dwordx4 v240, s[12:15], s39 offen lds
    s_add_u32 m0, m0, 1024
    s_add_u32 s39, s39, s3
    buffer_load_dwordx4 v239, s[12:15], s39 offen lds
    s_add_u32 m0, m0, 1024
    s_add_u32 s39, s39, s32
    buffer_load_dwordx4 v240, s[12:15], s39 offen lds
    s_add_u32 m0, m0, 1024
    s_add_u32 s39, s39, s32
    buffer_load_dwordx4 v239, s[12:15], s39 offen lds
    s_add_u32 m0, m0, 1024
    s_add_u32 s39, s39, s32
    buffer_load_dwordx4 v240, s[12:15], s39 offen lds
    s_mov_b32 m0, s19
    s_mov_b32 s39, s16
    s_mov_b32 s32, s17
    s_mov_b32 s3, s18
    s_waitcnt vmcnt(8)
    s_barrier
    buffer_load_dwordx4 v239, s[12:15], s39 offen lds
    s_add_u32 m0, m0, 1024
    s_add_u32 s39, s39, s32
    buffer_load_dwordx4 v240, s[12:15], s39 offen lds
    s_call_b64 s[76:77], PREP_w_issue_4
    s_add_u32 m0, m0, 1024
    s_add_u32 s39, s39, s32
    buffer_load_dwordx4 v239, s[12:15], s39 offen lds
    s_add_u32 m0, m0, 1024
    s_add_u32 s39, s39, s32
    buffer_load_dwordx4 v240, s[12:15], s39 offen lds
    s_add_u32 m0, m0, 1024
    s_add_u32 s39, s39, s3
    buffer_load_dwordx4 v239, s[12:15], s39 offen lds
    s_add_u32 m0, m0, 1024
    s_add_u32 s39, s39, s32
    buffer_load_dwordx4 v240, s[12:15], s39 offen lds
    s_add_u32 m0, m0, 1024
    s_add_u32 s39, s39, s32
    buffer_load_dwordx4 v239, s[12:15], s39 offen lds
    s_add_u32 m0, m0, 1024
    s_add_u32 s39, s39, s32
    buffer_load_dwordx4 v240, s[12:15], s39 offen lds
    s_mov_b32 m0, s19
    s_mov_b32 s39, s16
    s_mov_b32 s32, s17
    s_mov_b32 s3, s18
    s_waitcnt vmcnt(16)
    s_barrier
    buffer_load_dwordx4 v239, s[12:15], s39 offen lds
    s_add_u32 m0, m0, 1024
    s_add_u32 s39, s39, s32
    buffer_load_dwordx4 v240, s[12:15], s39 offen lds
    s_call_b64 s[76:77], PREP_w_issue_4
    s_add_u32 m0, m0, 1024
    s_add_u32 s39, s39, s32
    buffer_load_dwordx4 v239, s[12:15], s39 offen lds
    s_add_u32 m0, m0, 1024
    s_add_u32 s39, s39, s32
    buffer_load_dwordx4 v240, s[12:15], s39 offen lds
    s_add_u32 m0, m0, 1024
    s_add_u32 s39, s39, s3
    buffer_load_dwordx4 v239, s[12:15], s39 offen lds
    s_add_u32 m0, m0, 1024
    s_add_u32 s39, s39, s32
    buffer_load_dwordx4 v240, s[12:15], s39 offen lds
    s_add_u32 m0, m0, 1024
    s_add_u32 s39, s39, s32
    buffer_load_dwordx4 v239, s[12:15], s39 offen lds
    s_add_u32 m0, m0, 1024
    s_add_u32 s39, s39, s32
    buffer_load_dwordx4 v240, s[12:15], s39 offen lds
    s_mov_b32 m0, s19
    s_mov_b32 s39, s16
    s_mov_b32 s32, s17
    s_mov_b32 s3, s18
    s_waitcnt vmcnt(24)
    s_barrier
    buffer_load_dwordx4 v239, s[12:15], s39 offen lds
    s_add_u32 m0, m0, 1024
    s_add_u32 s39, s39, s32
    buffer_load_dwordx4 v240, s[12:15], s39 offen lds
    s_mov_b32 s43, 1
ld_75:
    s_mov_b32 s45, 8192
    s_add_u32 s19, s41, s42
    v_readlane_b32 s16, v249, s44
    s_nop 0
    s_bitcmp1_b32 s16, 0
    s_cselect_b32 s17, 16384, s45
    s_cselect_b32 s18, -40960, s45
    s_andn2_b32 s16, s16, 1
    s_add_u32 s16, s16, s38
    s_add_u32 s44, s44, 1
    s_add_u32 s42, s42, 16384
    s_cmp_eq_u32 s42, 98304
    s_cselect_b32 s42, 0, s42
    s_add_u32 m0, m0, 1024
    s_add_u32 s39, s39, s32
    buffer_load_dwordx4 v239, s[12:15], s39 offen lds
    s_add_u32 m0, m0, 1024
    s_add_u32 s39, s39, s32
    buffer_load_dwordx4 v240, s[12:15], s39 offen lds
    s_add_u32 m0, m0, 1024
    s_add_u32 s39, s39, s3
    buffer_load_dwordx4 v239, s[12:15], s39 offen lds
    s_add_u32 m0, m0, 1024
    s_add_u32 s39, s39, s32
    buffer_load_dwordx4 v240, s[12:15], s39 offen lds
    s_add_u32 m0, m0, 1024
    s_add_u32 s39, s39, s32
    buffer_load_dwordx4 v239, s[12:15], s39 offen lds
    s_add_u32 m0, m0, 1024
    s_add_u32 s39, s39, s32
    buffer_load_dwordx4 v240, s[12:15], s39 offen lds
    s_mov_b32 m0, s19
    s_mov_b32 s39, s16
    s_mov_b32 s32, s17
    s_mov_b32 s3, s18
    s_waitcnt vmcnt(32)
    s_barrier
    buffer_load_dwordx4 v239, s[12:15], s39 offen lds
    s_add_u32 m0, m0, 1024
    s_add_u32 s39, s39, s32
    buffer_load_dwordx4 v240, s[12:15], s39 offen lds
    s_add_u32 s43, s43, 1
    s_cmp_lt_u32 s43, 18
    s_cbranch_scc1 ld_75
    s_call_b64 s[76:77], PREP_w_issue_4
    s_add_u32 m0, m0, 1024
    s_add_u32 s39, s39, s32
    buffer_load_dwordx4 v239, s[12:15], s39 offen lds
    s_add_u32 m0, m0, 1024
    s_add_u32 s39, s39, s32
    buffer_load_dwordx4 v240, s[12:15], s39 offen lds
    s_add_u32 m0, m0, 1024
    s_add_u32 s39, s39, s3
    buffer_load_dwordx4 v239, s[12:15], s39 offen lds
    s_add_u32 m0, m0, 1024
    s_add_u32 s39, s39, s32
    buffer_load_dwordx4 v240, s[12:15], s39 offen lds
    s_add_u32 m0, m0, 1024
    s_add_u32 s39, s39, s32
    buffer_load_dwordx4 v239, s[12:15], s39 offen lds
    s_add_u32 m0, m0, 1024
    s_add_u32 s39, s39, s32
    buffer_load_dwordx4 v240, s[12:15], s39 offen lds
    s_mov_b32 m0, s19
    s_mov_b32 s39, s16
    s_mov_b32 s32, s17
    s_mov_b32 s3, s18
    s_waitcnt vmcnt(32)
    s_barrier
    buffer_load_dwordx4 v239, s[12:15], s39 offen lds
    s_add_u32 m0, m0, 1024
    s_add_u32 s39, s39, s32
    buffer_load_dwordx4 v240, s[12:15], s39 offen lds
    s_add_u32 m0, m0, 1024
    s_add_u32 s39, s39, s32
    buffer_load_dwordx4 v239, s[12:15], s39 offen lds
    s_add_u32 m0, m0, 1024
    s_add_u32 s39, s39, s32
    buffer_load_dwordx4 v240, s[12:15], s39 offen lds
    s_add_u32 m0, m0, 1024
    s_add_u32 s39, s39, s3
    buffer_load_dwordx4 v239, s[12:15], s39 offen lds
    s_add_u32 m0, m0, 1024
    s_add_u32 s39, s39, s32
    buffer_load_dwordx4 v240, s[12:15], s39 offen lds
    s_add_u32 m0, m0, 1024
    s_add_u32 s39, s39, s32
    buffer_load_dwordx4 v239, s[12:15], s39 offen lds
    s_add_u32 m0, m0, 1024
    s_add_u32 s39, s39, s32
    buffer_load_dwordx4 v240, s[12:15], s39 offen lds
    s_waitcnt vmcnt(32)
    s_barrier
    s_mov_b64 s[12:13], s[68:69]
    s_mov_b32 s14, 2097152
    s_mov_b32 s15, 0x20000
    s_and_b32 s35, s30, 1
    s_mul_i32 s38, s99, 128
    s_mul_i32 s41, s35, 65536
    s_add_u32 s38, s38, s41
    s_mul_i32 s41, s35, 4096
    s_add_u32 s41, s41, 24576
    s_mov_b32 s42, 0
    s_mov_b32 s44, s67
    s_mov_b32 s42, 90112
    s_mov_b32 s44, s67
    s_add_u32 s44, s44, 11
    s_and_b32 s44, s44, 15
    s_call_b64 s[76:77], SUB_w_issue_1
    s_mov_b32 s42, 98304
    s_mov_b32 s44, s67
    s_add_u32 s44, s44, 12
    s_and_b32 s44, s44, 15
    s_call_b64 s[76:77], SUB_w_issue_1
    s_mov_b32 s42, 122880
    s_mov_b32 s44, s67
    s_add_u32 s44, s44, 15
    s_and_b32 s44, s44, 15
    s_call_b64 s[76:77], SUB_w_issue_1
    s_add_u32 s39, s38, 1179648
    buffer_load_dwordx4 v[16:19], v238, s[12:15], s39 offen
    s_add_u32 s39, s39, 16384
    buffer_load_dwordx4 v[20:23], v238, s[12:15], s39 offen
    s_add_u32 s39, s39, 16384
    buffer_load_dwordx4 v[24:27], v238, s[12:15], s39 offen
    s_add_u32 s39, s39, 16384
    buffer_load_dwordx4 v[28:31], v238, s[12:15], s39 offen
    s_add_u32 s39, s39, 16384
    s_waitcnt vmcnt(40)
    s_barrier
    s_mov_b32 s42, 106496
    s_mov_b32 s44, s67
    s_add_u32 s44, s44, 13
    s_and_b32 s44, s44, 15
    s_call_b64 s[76:77], SUB_w_issue_1
    s_mov_b32 s42, 114688
    s_mov_b32 s44, s67
    s_add_u32 s44, s44, 14
    s_and_b32 s44, s44, 15
    s_call_b64 s[76:77], SUB_w_issue_1
    s_add_u32 s39, s38, 1310720
    buffer_load_dwordx4 v[32:35], v238, s[12:15], s39 offen
    s_add_u32 s39, s39, 16384
    buffer_load_dwordx4 v[36:39], v238, s[12:15], s39 offen
    s_add_u32 s39, s39, 16384
    buffer_load_dwordx4 v[40:43], v238, s[12:15], s39 offen
    s_add_u32 s39, s39, 16384
    buffer_load_dwordx4 v[44:47], v238, s[12:15], s39 offen
    s_add_u32 s39, s39, 16384
    s_waitcnt vmcnt(44)
    s_barrier
    s_mov_b32 s42, 24576
    s_mov_b32 s44, s67
    s_add_u32 s44, s44, 3
    s_and_b32 s44, s44, 15
    s_call_b64 s[76:77], SUB_w_issue_1
    s_mov_b32 s42, 32768
    s_mov_b32 s44, s67
    s_add_u32 s44, s44, 4
    s_and_b32 s44, s44, 15
    s_call_b64 s[76:77], SUB_w_issue_1
    s_waitcnt vmcnt(44)
    s_barrier
    s_mov_b32 s42, 40960
    s_mov_b32 s44, s67
    s_add_u32 s44, s44, 5
    s_and_b32 s44, s44, 15
    s_call_b64 s[76:77], SUB_w_issue_1
    s_mov_b32 s42, 49152
    s_mov_b32 s44, s67
    s_add_u32 s44, s44, 6
    s_and_b32 s44, s44, 15
    s_call_b64 s[76:77], SUB_w_issue_1
    s_mov_b32 s42, 0
    s_mov_b32 s44, s67
    s_add_u32 s44, s44, 0
    s_and_b32 s44, s44, 15
    s_call_b64 s[76:77], SUB_w_issue_1
    s_waitcnt vmcnt(48)
    s_barrier
    s_mov_b32 s42, 57344
    s_mov_b32 s44, s67
    s_add_u32 s44, s44, 7
    s_and_b32 s44, s44, 15
    s_call_b64 s[76:77], SUB_w_issue_1
    s_mov_b32 s42, 65536
    s_mov_b32 s44, s67
    s_add_u32 s44, s44, 8
    s_and_b32 s44, s44, 15
    s_call_b64 s[76:77], SUB_w_issue_1
    s_mov_b32 s42, 8192
    s_mov_b32 s44, s67
    s_add_u32 s44, s44, 1
    s_and_b32 s44, s44, 15
    s_call_b64 s[76:77], SUB_w_issue_1
    s_mov_b32 s42, 16384
    s_mov_b32 s44, s67
    s_add_u32 s44, s44, 2
    s_and_b32 s44, s44, 15
    s_call_b64 s[76:77], SUB_w_issue_1
    s_barrier
    s_add_u32 s36, s41, 73728
    v_add_u32 v6, s36, v2
    s_waitcnt vmcnt(0)
    ds_write_b128 v6, v[16:19] offset:0
    ds_write_b128 v6, v[20:23] offset:1024
    ds_write_b128 v6, v[24:27] offset:2048
    ds_write_b128 v6, v[28:31] offset:3072
    ds_write_b128 v6, v[32:35] offset:8192
    ds_write_b128 v6, v[36:39] offset:9216
    ds_write_b128 v6, v[40:43] offset:10240
    ds_write_b128 v6, v[44:47] offset:11264
    s_waitcnt lgkmcnt(0)
    s_branch NEXT
WL_t1:
    s_call_b64 s[76:77], PREP_w_issue_4
    s_mov_b32 m0, s19
    s_mov_b32 s39, s16
    s_mov_b32 s32, s17
    s_mov_b32 s3, s18
    s_waitcnt vmcnt(0)
    s_barrier
    s_waitcnt vmcnt(0)
    s_barrier
    s_waitcnt vmcnt(0)
    s_barrier
    s_waitcnt vmcnt(0)
    s_barrier
    s_waitcnt vmcnt(0)
    s_barrier
    buffer_load_dwordx4 v239, s[12:15], s39 offen lds
    s_add_u32 m0, m0, 1024
    s_add_u32 s39, s39, s32
    buffer_load_dwordx4 v240, s[12:15], s39 offen lds
    s_mov_b32 s43, 1
ld_76:
    s_mov_b32 s45, 8192
    s_add_u32 s19, s41, s42
    v_readlane_b32 s16, v249, s44
    s_nop 0
    s_bitcmp1_b32 s16, 0
    s_cselect_b32 s17, 16384, s45
    s_cselect_b32 s18, -40960, s45
    s_andn2_b32 s16, s16, 1
    s_add_u32 s16, s16, s38
    s_add_u32 s44, s44, 1
    s_add_u32 s42, s42, 16384
    s_cmp_eq_u32 s42, 98304
    s_cselect_b32 s42, 0, s42
    s_add_u32 m0, m0, 1024
    s_add_u32 s39, s39, s32
    buffer_load_dwordx4 v239, s[12:15], s39 offen lds
    s_add_u32 m0, m0, 1024
    s_add_u32 s39, s39, s32
    buffer_load_dwordx4 v240, s[12:15], s39 offen lds
    s_add_u32 m0, m0, 1024
    s_add_u32 s39, s39, s3
    buffer_load_dwordx4 v239, s[12:15], s39 offen lds
    s_add_u32 m0, m0, 1024
    s_add_u32 s39, s39, s32
    buffer_load_dwordx4 v240, s[12:15], s39 offen lds
    s_add_u32 m0, m0, 1024
    s_add_u32 s39, s39, s32
    buffer_load_dwordx4 v239, s[12:15], s39 offen lds
    s_add_u32 m0, m0, 1024
    s_add_u32 s39, s39, s32
    buffer_load_dwordx4 v240, s[12:15], s39 offen lds
    s_mov_b32 m0, s19
    s_mov_b32 s39, s16
    s_mov_b32 s32, s17
    s_mov_b32 s3, s18
    s_waitcnt vmcnt(8)
    s_barrier
    buffer_load_dwordx4 v239, s[12:15], s39 offen lds
    s_add_u32 m0, m0, 1024
    s_add_u32 s39, s39, s32
    buffer_load_dwordx4 v240, s[12:15], s39 offen lds
    s_add_u32 s43, s43, 1
    s_cmp_lt_u32 s43, 21
    s_cbranch_scc1 ld_76
    s_call_b64 s[76:77], PREP_w_issue_4
    s_add_u32 m0, m0, 1024
    s_add_u32 s39, s39, s32
    buffer_load_dwordx4 v239, s[12:15], s39 offen lds
    s_add_u32 m0, m0, 1024
    s_add_u32 s39, s39, s32
    buffer_load_dwordx4 v240, s[12:15], s39 offen lds
    s_add_u32 m0, m0, 1024
    s_add_u32 s39, s39, s3
    buffer_load_dwordx4 v239, s[12:15], s39 offen lds
    s_add_u32 m0, m0, 1024
    s_add_u32 s39, s39, s32
    buffer_load_dwordx4 v240, s[12:15], s39 offen lds
    s_add_u32 m0, m0, 1024
    s_add_u32 s39, s39, s32
    buffer_load_dwordx4 v239, s[12:15], s39 offen lds
    s_add_u32 m0, m0, 1024
    s_add_u32 s39, s39, s32
    buffer_load_dwordx4 v240, s[12:15], s39 offen lds
    s_mov_b32 m0, s19
    s_mov_b32 s39, s16
    s_mov_b32 s32, s17
    s_mov_b32 s3, s18
    s_waitcnt vmcnt(8)
    s_barrier
    buffer_load_dwordx4 v239, s[12:15], s39 offen lds
    s_add_u32 m0, m0, 1024
    s_add_u32 s39, s39, s32
    buffer_load_dwordx4 v240, s[12:15], s39 offen lds
    s_add_u32 m0, m0, 1024
    s_add_u32 s39, s39, s32
    buffer_load_dwordx4 v239, s[12:15], s39 offen lds
    s_add_u32 m0, m0, 1024
    s_add_u32 s39, s39, s32
    buffer_load_dwordx4 v240, s[12:15], s39 offen lds
    s_add_u32 m0, m0, 1024
    s_add_u32 s39, s39, s3
    buffer_load_dwordx4 v239, s[12:15], s39 offen lds
    s_add_u32 m0, m0, 1024
    s_add_u32 s39, s39, s32
    buffer_load_dwordx4 v240, s[12:15], s39 offen lds
    s_add_u32 m0, m0, 1024
    s_add_u32 s39, s39, s32
    buffer_load_dwordx4 v239, s[12:15], s39 offen lds
    s_add_u32 m0, m0, 1024
    s_add_u32 s39, s39, s32
    buffer_load_dwordx4 v240, s[12:15], s39 offen lds
    s_waitcnt vmcnt(8)
    s_barrier
    s_waitcnt vmcnt(0)
    s_barrier
    s_branch K_fin
NEXT:
    s_setprio 0
    s_add_u32 s60, s60, 1
    s_add_u32 s55, s55, 4194304
    s_add_u32 s62, s62, 4194304
    s_addc_u32 s63, s63, 0
    s_branch LAYER
K_fin:
    s_endpgm
SUB_w1_regs:
    s_mov_b64 s[12:13], s[68:69]
    s_mov_b32 s14, 2097152
    s_mov_b32 s15, 0x20000
    s_and_b32 s35, s30, 3
    s_mul_i32 s35, s35, 294912
    s_lshl_b32 s39, s99, 7
    s_add_u32 s39, s39, s35
    buffer_load_dwordx4 v[176:179], v238, s[12:15], s39 offen
    s_add_u32 s39, s39, 16384
    buffer_load_dwordx4 v[188:191], v238, s[12:15], s39 offen
    s_add_u32 s39, s39, 16384
    buffer_load_dwordx4 v[192:195], v238, s[12:15], s39 offen
    s_add_u32 s39, s39, 16384
    buffer_load_dwordx4 v[200:203], v238, s[12:15], s39 offen
    s_add_u32 s39, s39, 16384
    s_waitcnt vmcnt(8)
    buffer_load_dwordx4 v[204:207], v238, s[12:15], s39 offen
    s_add_u32 s39, s39, 16384
    buffer_load_dwordx4 v[208:211], v238, s[12:15], s39 offen
    s_add_u32 s39, s39, 16384
    buffer_load_dwordx4 v[212:215], v238, s[12:15], s39 offen
    s_add_u32 s39, s39, 16384
    buffer_load_dwordx4 v[216:219], v238, s[12:15], s39 offen
    s_add_u32 s39, s39, 16384
    s_waitcnt vmcnt(8)
    buffer_load_dwordx4 v[220:223], v238, s[12:15], s39 offen
    s_add_u32 s39, s39, 16384
    buffer_load_dwordx4 v[224:227], v238, s[12:15], s39 offen
    s_add_u32 s39, s39, 16384
    buffer_load_dwordx4 v[16:19], v238, s[12:15], s39 offen
    s_add_u32 s39, s39, 16384
    buffer_load_dwordx4 v[20:23], v238, s[12:15], s39 offen
    s_add_u32 s39, s39, 16384
    s_waitcnt vmcnt(8)
    buffer_load_dwordx4 v[24:27], v238, s[12:15], s39 offen
    s_add_u32 s39, s39, 16384
    buffer_load_dwordx4 v[28:31], v238, s[12:15], s39 offen
    s_add_u32 s39, s39, 16384
    buffer_load_dwordx4 v[32:35], v238, s[12:15], s39 offen
    s_add_u32 s39, s39, 16384
    buffer_load_dwordx4 v[36:39], v238, s[12:15], s39 offen
    s_add_u32 s39, s39, 16384
    s_waitcnt vmcnt(8)
    buffer_load_dwordx4 v[40:43], v238, s[12:15], s39 offen
    s_add_u32 s39, s39, 16384
    buffer_load_dwordx4 v[44:47], v238, s[12:15], s39 offen
    s_add_u32 s39, s39, 16384
    s_setpc_b64 s[76:77]
SUB_park:
    s_mov_b64 s[12:13], s[70:71]
    s_mov_b32 s14, 2097152
    s_mov_b32 s15, 0x20000
    s_and_b32 s35, s30, 3
    s_lshl_b32 s35, s35, 19
    s_lshl_b32 s39, s29, 7
    s_add_u32 s39, s39, s35
    buffer_load_dwordx4 v[48:51], v238, s[12:15], s39 offen
    s_add_u32 s39, s39, 16384
    buffer_load_dwordx4 v[52:55], v238, s[12:15], s39 offen
    s_add_u32 s39, s39, 16384
    buffer_load_dwordx4 v[56:59], v238, s[12:15], s39 offen
    s_add_u32 s39, s39, 16384
    buffer_load_dwordx4 v[60:63], v238, s[12:15], s39 offen
    s_add_u32 s39, s39, 16384
    s_waitcnt vmcnt(8)
    buffer_load_dwordx4 v[64:67], v238, s[12:15], s39 offen
    s_add_u32 s39, s39, 16384
    buffer_load_dwordx4 v[68:71], v238, s[12:15], s39 offen
    s_add_u32 s39, s39, 16384
    buffer_load_dwordx4 v[72:75], v238, s[12:15], s39 offen
    s_add_u32 s39, s39, 16384
    buffer_load_dwordx4 v[76:79], v238, s[12:15], s39 offen
    s_add_u32 s39, s39, 16384
    s_waitcnt vmcnt(8)
    buffer_load_dwordx4 v[80:83], v238, s[12:15], s39 offen
    s_add_u32 s39, s39, 16384
    buffer_load_dwordx4 v[84:87], v238, s[12:15], s39 offen
    s_add_u32 s39, s39, 16384
    buffer_load_dwordx4 v[88:91], v238, s[12:15], s39 offen
    s_add_u32 s39, s39, 16384
    buffer_load_dwordx4 v[92:95], v238, s[12:15], s39 offen
    s_add_u32 s39, s39, 16384
    s_waitcnt vmcnt(8)
    buffer_load_dwordx4 v[96:99], v238, s[12:15], s39 offen
    s_add_u32 s39, s39, 16384
    buffer_load_dwordx4 v[100:103], v238, s[12:15], s39 offen
    s_add_u32 s39, s39, 16384
    buffer_load_dwordx4 v[104:107], v238, s[12:15], s39 offen
    s_add_u32 s39, s39, 16384
    buffer_load_dwordx4 v[108:111], v238, s[12:15], s39 offen
    s_add_u32 s39, s39, 16384
    s_waitcnt vmcnt(8)
    buffer_load_dwordx4 v[112:115], v238, s[12:15], s39 offen
    s_add_u32 s39, s39, 16384
    buffer_load_dwordx4 v[116:119], v238, s[12:15], s39 offen
    s_add_u32 s39, s39, 16384
    buffer_load_dwordx4 v[120:123], v238, s[12:15], s39 offen
    s_add_u32 s39, s39, 16384
    buffer_load_dwordx4 v[124:127], v238, s[12:15], s39 offen
    s_add_u32 s39, s39, 16384
    s_waitcnt vmcnt(8)
    buffer_load_dwordx4 v[128:131], v238, s[12:15], s39 offen
    s_add_u32 s39, s39, 16384
    buffer_load_dwordx4 v[132:135], v238, s[12:15], s39 offen
    s_add_u32 s39, s39, 16384
    buffer_load_dwordx4 v[136:139], v238, s[12:15], s39 offen
    s_add_u32 s39, s39, 16384
    buffer_load_dwordx4 v[140:143], v238, s[12:15], s39 offen
    s_add_u32 s39, s39, 16384
    s_waitcnt vmcnt(8)
    buffer_load_dwordx4 v[144:147], v238, s[12:15], s39 offen
    s_add_u32 s39, s39, 16384
    buffer_load_dwordx4 v[148:151], v238, s[12:15], s39 offen
    s_add_u32 s39, s39, 16384
    buffer_load_dwordx4 v[152:155], v238, s[12:15], s39 offen
    s_add_u32 s39, s39, 16384
    buffer_load_dwordx4 v[156:159], v238, s[12:15], s39 offen
    s_add_u32 s39, s39, 16384
    s_waitcnt vmcnt(8)
    buffer_load_dwordx4 v[160:163], v238, s[12:15], s39 offen
    s_add_u32 s39, s39, 16384
    buffer_load_dwordx4 v[164:167], v238, s[12:15], s39 offen
    s_add_u32 s39, s39, 16384
    buffer_load_dwordx4 v[168:171], v238, s[12:15], s39 offen
    s_add_u32 s39, s39, 16384
    buffer_load_dwordx4 v[172:175], v238, s[12:15], s39 offen
    s_add_u32 s39, s39, 16384
    s_waitcnt vmcnt(8)
    s_setpc_b64 s[76:77]
SUB_w1_put:
    s_and_b32 s35, s30, 3
    s_mul_i32 s35, s35, 18432
    v_add_u32 v8, s35, v2
    v_mov_b32 v6, 162836
spin_77:
    s_sleep 2
    ds_read_b32 v7, v6
    s_waitcnt lgkmcnt(0)
    v_readfirstlane_b32 s53, v7
    s_nop 0
    s_cmp_ge_u32 s53, 8
    s_cbranch_scc0 spin_77
    s_waitcnt vmcnt(0)
    ds_write_b128 v8, v[176:179] offset:24576
    ds_write_b128 v8, v[188:191] offset:25600
    ds_write_b128 v8, v[192:195] offset:26624
    ds_write_b128 v8, v[200:203] offset:27648
    ds_write_b128 v8, v[204:207] offset:28672
    ds_write_b128 v8, v[208:211] offset:29696
    ds_write_b128 v8, v[212:215] offset:30720
    ds_write_b128 v8, v[216:219] offset:31744
    ds_write_b128 v8, v[220:223] offset:32768
    ds_write_b128 v8, v[224:227] offset:33792
    ds_write_b128 v8, v[16:19] offset:34816
    ds_write_b128 v8, v[20:23] offset:35840
    ds_write_b128 v8, v[24:27] offset:36864
    ds_write_b128 v8, v[28:31] offset:37888
    ds_write_b128 v8, v[32:35] offset:38912
    ds_write_b128 v8, v[36:39] offset:39936
    ds_write_b128 v8, v[40:43] offset:40960
    ds_write_b128 v8, v[44:47] offset:41984
    s_waitcnt lgkmcnt(0)
    s_setpc_b64 s[76:77]
SUB_after_g1:
    s_mov_b64 s[12:13], s[72:73]
    s_mov_b32 s14, 7340032
    s_mov_b32 s15, 0x20000
    v_readlane_b32 s36, v251, 0
    v_readlane_b32 s37, v251, 1
    s_and_b32 s35, s30, 3
    s_mul_i32 s38, s35, 114688
    s_mul_i32 s39, s29, 448
    s_add_u32 s38, s38, s39
    s_and_b32 s36, s36, 15
    s_mul_i32 s36, s36, 458752
    s_add_u32 s36, s36, s38
    s_and_b32 s37, s37, 15
    s_mul_i32 s37, s37, 458752
    s_add_u32 s37, s37, s38
    s_mul_i32 s39, s35, 7168
    s_add_u32 m0, s39, 131072
    s_nop 0
    buffer_load_dwordx4 v241, s[12:15], s36 offen lds
    s_add_u32 m0, m0, 1024
    s_nop 0
    buffer_load_dwordx4 v242, s[12:15], s36 offen lds
    s_add_u32 m0, m0, 1024
    s_nop 0
    buffer_load_dwordx4 v243, s[12:15], s36 offen lds
    s_add_u32 m0, m0, 1024
    s_nop 0
    buffer_load_dwordx4 v244, s[12:15], s36 offen lds
    s_add_u32 m0, m0, 1024
    s_nop 0
    buffer_load_dwordx4 v245, s[12:15], s36 offen lds
    s_add_u32 m0, m0, 1024
    s_nop 0
    buffer_load_dwordx4 v246, s[12:15], s36 offen lds
    s_add_u32 m0, m0, 1024
    s_nop 0
    buffer_load_dwordx4 v247, s[12:15], s36 offen lds
    buffer_load_dwordx4 v[208:211], v241, s[12:15], s37 offen
    buffer_load_dwordx4 v[212:215], v242, s[12:15], s37 offen
    buffer_load_dwordx4 v[216:219], v243, s[12:15], s37 offen
    buffer_load_dwordx4 v[220:223], v244, s[12:15], s37 offen
    buffer_load_dwordx4 v[224:227], v245, s[12:15], s37 offen
    buffer_load_dwordx4 v[228:231], v246, s[12:15], s37 offen
    buffer_load_dwordx4 v[232:235], v247, s[12:15], s37 offen
    s_lshr_b32 s36, s67, 2
    s_sub_u32 s36, s35, s36
    s_and_b32 s36, s36, 3
    s_lshl_b32 s36, s36, 15
    v_add_u32 v6, s36, v2
    s_waitcnt vmcnt(14)
    ds_write_b128 v6, v[48:51] offset:0
    ds_write_b128 v6, v[52:55] offset:1024
    ds_write_b128 v6, v[56:59] offset:2048
    ds_write_b128 v6, v[60:63] offset:3072
    ds_write_b128 v6, v[64:67] offset:4096
    ds_write_b128 v6, v[68:71] offset:5120
    ds_write_b128 v6, v[72:75] offset:6144
    ds_write_b128 v6, v[76:79] offset:7168
    ds_write_b128 v6, v[80:83] offset:8192
    ds_write_b128 v6, v[84:87] offset:9216
    ds_write_b128 v6, v[88:91] offset:10240
    ds_write_b128 v6, v[92:95] offset:11264
    ds_write_b128 v6, v[96:99] offset:12288
    ds_write_b128 v6, v[100:103] offset:13312
    ds_write_b128 v6, v[104:107] offset:14336
    ds_write_b128 v6, v[108:111] offset:15360
    ds_write_b128 v6, v[112:115] offset:16384
    ds_write_b128 v6, v[116:119] offset:17408
    ds_write_b128 v6, v[120:123] offset:18432
    ds_write_b128 v6, v[124:127] offset:19456
    ds_write_b128 v6, v[128:131] offset:20480
    ds_write_b128 v6, v[132:135] offset:21504
    ds_write_b128 v6, v[136:139] offset:22528
    ds_write_b128 v6, v[140:143] offset:23552
    ds_write_b128 v6, v[144:147] offset:24576
    ds_write_b128 v6, v[148:151] offset:25600
    ds_write_b128 v6, v[152:155] offset:26624
    ds_write_b128 v6, v[156:159] offset:27648
    ds_write_b128 v6, v[160:163] offset:28672
    ds_write_b128 v6, v[164:167] offset:29696
    ds_write_b128 v6, v[168:171] offset:30720
    ds_write_b128 v6, v[172:175] offset:31744
    s_waitcnt lgkmcnt(0)
    s_setpc_b64 s[76:77]
SUB_after_g2:
    s_and_b32 s35, s30, 3
    s_mul_i32 s39, s35, 7168
    s_add_u32 s39, s39, 73728
    v_add_u32 v6, s39, v2
    ds_write_b128 v6, v[208:211] offset:0
    ds_write_b128 v6, v[212:215] offset:1024
    ds_write_b128 v6, v[216:219] offset:2048
    ds_write_b128 v6, v[220:223] offset:3072
    ds_write_b128 v6, v[224:227] offset:4096
    ds_write_b128 v6, v[228:231] offset:5120
    ds_write_b128 v6, v[232:235] offset:6144
    s_waitcnt lgkmcnt(0)
    s_setpc_b64 s[76:77]
SUB_r_pre0:
    s_waitcnt lgkmcnt(0)
    v_and_b32 v199, 7, v0
    v_lshrrev_b32 v236, 6, v0
    v_lshlrev_b32 v236, 4, v236
    v_bfe_u32 v237, v0, 3, 3
    v_add_u32 v236, v236, v237
    s_lshr_b32 s78, s29, 1
    s_lshl_b32 s78, s78, 16
    s_and_b32 s79, s29, 1
    s_lshl_b32 s79, s79, 7
    s_add_u32 s78, s78, s79
    s_lshr_b32 s79, s30, 1
    s_lshl_b32 s79, s79, 13
    s_add_u32 s78, s78, s79
    v_lshlrev_b32 v196, 8, v236
    v_lshl_add_u32 v196, v199, 4, v196
    v_add_u32 v196, s78, v196
    s_lshl_b32 s78, s28, 7
    s_lshl_b32 s79, s29, 3
    s_add_u32 s78, s78, s79
    v_add_u32 v197, s78, v199
    v_lshlrev_b32 v198, 11, v197
    v_lshrrev_b32 v237, 2, v236
    v_lshlrev_b32 v237, 3, v237
    v_and_b32 v236, 3, v236
    v_add_u32 v236, v236, v237
    v_lshl_add_u32 v198, v236, 3, v198
    v_lshlrev_b32 v197, 3, v197
    v_lshl_add_u32 v197, v236, 14, v197
    s_mov_b32 s84, s62
    s_mov_b32 s85, s63
    s_mov_b32 s86, 0x7e000
    s_mov_b32 s87, 0x20000
    s_add_u32 s88, s62, 0x80000
    s_addc_u32 s89, s63, 0
    s_mov_b32 s90, 0x7e000
    s_mov_b32 s91, 0x20000
    s_cmp_eq_u32 s60, 0
    s_cselect_b32 s86, s86, 0
    s_cselect_b32 s90, s90, 0
    buffer_load_dwordx4 v[180:183], v196, s[84:87], 0 offen offset:0 sc1
    buffer_load_dwordx4 v[188:191], v196, s[88:91], 0 offen offset:0 sc1
    buffer_load_dwordx4 v[184:187], v196, s[84:87], 0 offen offset:2048 sc1
    buffer_load_dwordx4 v[192:195], v196, s[88:91], 0 offen offset:2048 sc1
    s_add_u32 s80, s4, 0x1c00000
    s_addc_u32 s81, s5, 0
    s_mov_b32 s82, 0x400000
    s_mov_b32 s83, 0x20000
    s_cmp_eq_u32 s60, 0
    s_cselect_b32 s82, s82, 0
    s_mov_b32 s78, 0
    buffer_load_dwordx2 v[230:231], v197, s[80:83], s78 offen sc1
    s_mov_b32 s78, 65536
    buffer_load_dwordx2 v[232:233], v197, s[80:83], s78 offen sc1
    s_mov_b32 s78, 262144
    buffer_load_dwordx2 v[234:235], v197, s[80:83], s78 offen sc1
    s_mov_b32 s78, 327680
    buffer_load_dwordx2 v[236:237], v197, s[80:83], s78 offen sc1
    s_setpc_b64 s[76:77]
SUB_w_issue_1:
    s_add_u32 s19, s41, s42
    s_mul_i32 s16, s44, 131072
    s_add_u32 s16, s16, s38
    s_add_u32 s44, s44, 1
    s_and_b32 s44, s44, 15
    s_add_u32 s42, s42, 8192
    s_cmp_eq_u32 s42, 131072
    s_cselect_b32 s42, 0, s42
    s_mov_b32 m0, s19
    s_mov_b32 s39, s16
    buffer_load_dwordx4 v238, s[12:15], s39 offen lds
    s_add_u32 m0, m0, 1024
    s_add_u32 s39, s39, 16384
    buffer_load_dwordx4 v238, s[12:15], s39 offen lds
    s_add_u32 m0, m0, 1024
    s_add_u32 s39, s39, 16384
    buffer_load_dwordx4 v238, s[12:15], s39 offen lds
    s_add_u32 m0, m0, 1024
    s_add_u32 s39, s39, 16384
    buffer_load_dwordx4 v238, s[12:15], s39 offen lds
    s_setpc_b64 s[76:77]
PREP_a_issue_4:
    s_add_u32 s19, s41, s42
    v_readlane_b32 s16, v249, s44
    v_readlane_b32 s17, v250, s44
    s_add_u32 s16, s16, s38
    s_add_u32 s17, s17, s38
    s_add_u32 s44, s44, 1
    s_add_u32 s42, s42, 16384
    s_cmp_eq_u32 s42, 49152
    s_cselect_b32 s42, 0, s42
    s_setpc_b64 s[76:77]
PREP_w_issue_4:
    s_mov_b32 s45, 8192
    s_add_u32 s19, s41, s42
    v_readlane_b32 s16, v249, s44
    s_nop 0
    s_bitcmp1_b32 s16, 0
    s_cselect_b32 s17, 16384, s45
    s_cselect_b32 s18, -40960, s45
    s_andn2_b32 s16, s16, 1
    s_add_u32 s16, s16, s38
    s_add_u32 s44, s44, 1
    s_add_u32 s42, s42, 16384
    s_cmp_eq_u32 s42, 98304
    s_cselect_b32 s42, 0, s42
    s_setpc_b64 s[76:77]
K_end:
    s_endpgm
.p2align 6
K_tab:
.short 4096,5137,6178,11379,18660,25941,40502,33223,47784,55065,19706,12427,26988,34269,48830,41551,56096,9264,20736,10448,23824,25008,38384,35296,39568,49856,54128,52944,0,0,0,0
.short 4096,5137,6178,18659,11380,25941,33222,47783,40504,55065,12426,26987,19708,34269,41550,56111,48816,9264,10448,23824,20736,25008,35296,39568,38384,49856,52944,54128,0,0,0,0
.short 4096,5137,6178,11379,25940,18661,33222,40503,55064,47785,12426,19707,34268,26989,41550,48831,9264,56096,10448,20736,25008,23824,35296,38384,49856,39568,52944,54128,0,0,0,0
.short 4096,5137,6178,11379,18660,33221,25942,40503,47784,12425,55066,19707,26988,41549,34270,48831,56096,10448,9264,20736,23824,35296,25008,38384,39568,52944,49856,54128,0,0,0,0
.short 11377,12418,13459,18660,4101,25942,33223,47784,40505,55066,5147,26988,19709,34270,41551,56096,48816,6176,10288,23824,20736,25008,35296,39568,38384,49856,52944,54128,0,0,0,0
.short 11377,12418,13459,4100,25941,18662,33223,40504,55065,47786,5147,19708,34269,26990,41551,48816,6176,56096,10288,20736,25008,23824,35296,38384,49856,39568,52944,54128,0,0,0,0
.short 11377,12418,13459,4100,18661,33222,25943,40504,47785,5146,55067,19708,26989,41550,34271,48816,56096,10288,6176,20736,23824,35296,25008,38384,39568,52944,49856,54128,0,0,0,0
.short 11377,12418,13459,4100,18661,25942,40503,33224,47785,55066,19707,5148,26989,34270,48831,41536,56096,6176,20736,10288,23824,25008,38384,35296,39568,49856,54128,52944,0,0,0,0
.short 18658,19699,20740,4101,25942,11383,33224,40505,55066,47787,5148,12429,34270,26991,41536,48817,6176,56096,9264,10448,25008,23824,35296,38384,49856,39568,52944,54128,0,0,0,0
.short 18658,19699,20740,4101,11382,33223,25944,40505,47786,5147,55068,12429,26990,41551,34256,48817,56096,9264,6176,10448,23824,35296,25008,38384,39568,52944,49856,54128,0,0,0,0
.short 18658,19699,20740,4101,11382,25943,40504,33225,47786,55067,12428,5149,26990,34271,48816,41537,56096,6176,10448,9264,23824,25008,38384,35296,39568,49856,54128,52944,0,0,0,0
.short 18658,19699,20740,11381,4102,25943,33224,47785,40506,55067,5148,26989,12430,34271,41536,56097,48816,6176,9264,23824,10448,25008,35296,39568,38384,49856,52944,54128,0,0,0,0
.short 25939,26980,28021,4102,11383,33224,18665,40506,47787,5148,55069,12430,19711,41536,34257,48818,56096,9264,6176,10448,20736,35296,24848,38384,39568,52944,49856,54128,0,0,0,0
.short 25939,26980,28021,4102,11383,18664,40505,33226,47787,55068,12429,5150,19711,34256,48817,41538,56096,6176,10448,9264,20736,24848,38384,35296,39568,49856,54128,52944,0,0,0,0
.short 25939,26980,28021,11382,4103,18664,33225,47786,40507,55068,5149,19710,12431,34256,41537,56098,48816,6176,9264,20736,10448,24848,35296,39568,38384,49856,52944,54128,0,0,0,0
.short 25939,26980,28021,4102,18663,11384,33225,40506,55067,47788,5149,12430,34271,19696,41537,48818,6176,56096,9264,10448,24848,20736,35296,38384,49856,39568,52944,54128,0,0,0,0
.short 33220,34261,35302,4103,11384,18665,40506,25947,47788,55069,12430,5151,19696,26977,48818,41539,56096,6176,10448,9264,20736,23824,38384,25008,39568,49856,54128,52944,0,0,0,0
.short 33220,34261,35302,11383,4104,18665,25946,47787,40508,55069,5150,19711,12416,26977,41538,56099,48816,6176,9264,20736,10448,23824,25008,39568,38384,49856,52944,54128,0,0,0,0
.short 33220,34261,35302,4103,18664,11385,25946,40507,55068,47789,5150,12431,26976,19697,41538,48819,6176,56096,9264,10448,23824,20736,25008,38384,49856,39568,52944,54128,0,0,0,0
.short 33220,34261,35302,4103,11384,25945,18666,40507,47788,5149,55070,12431,19696,41537,26978,48819,56096,9264,6176,10448,20736,25008,23824,38384,39568,52944,49856,54128,0,0,0,0
.short 40501,41542,42583,11384,4105,18666,25947,47788,33229,55070,5151,19696,12417,26978,34259,56100,48816,6176,9264,20736,10448,23824,25008,39408,35296,49856,52944,54128,0,0,0,0
.short 40501,41542,42583,4104,18665,11386,25947,33228,55069,47790,5151,12416,26977,19698,34259,48820,6176,56096,9264,10448,23824,20736,25008,35296,49856,39408,52944,54128,0,0,0,0
.short 40501,41542,42583,4104,11385,25946,18667,33228,47789,5150,55071,12416,19697,34258,26979,48820,56096,9264,6176,10448,20736,25008,23824,35296,39408,52944,49856,54128,0,0,0,0
.short 40501,41542,42583,4104,11385,18666,33227,25948,47789,55070,12431,5136,19697,26978,48819,34260,56096,6176,10448,9264,20736,23824,35296,25008,39408,49856,54128,52944,0,0,0,0
.short 47782,48823,49864,4105,18666,11387,25948,33229,55070,40511,5136,12417,26978,19699,34260,41541,6176,56096,9264,10448,23824,20736,25008,35296,39568,38384,52944,54128,0,0,0,0
.short 47782,48823,49864,4105,11386,25947,18668,33229,40510,5151,55056,12417,19698,34259,26980,41541,56096,9264,6176,10448,20736,25008,23824,35296,38384,52944,39568,54128,0,0,0,0
.short 47782,48823,49864,4105,11386,18667,33228,25949,40510,55071,12416,5137,19698,26979,41540,34261,56096,6176,10448,9264,20736,23824,35296,25008,38384,39568,54128,52944,0,0,0,0
.short 47782,48823,49864,11385,4106,18667,25948,40509,33230,55071,5136,19697,12418,26979,34260,56101,41536,6176,9264,20736,10448,23824,25008,38384,35296,39568,52944,54128,0,0,0,0
.short 55063,56104,57145,4106,11387,25948,18669,33230,40511,5136,47777,12418,19699,34260,26981,41542,48816,9264,6176,10448,20736,25008,23824,35296,38384,49856,39568,53968,0,0,0,0
.short 55063,56104,57145,4106,11387,18668,33229,25950,40511,47776,12417,5138,19699,26980,41541,34262,48816,6176,10448,9264,20736,23824,35296,25008,38384,39568,53968,49856,0,0,0,0
.short 55063,56104,57145,11386,4107,18668,25949,40510,33231,47776,5137,19698,12419,26980,34261,48822,41536,6176,9264,20736,10448,23824,25008,38384,35296,39568,49856,53968,0,0,0,0
.short 55063,56104,57145,4106,18667,11388,25949,33230,47791,40496,5137,12418,26979,19700,34261,41542,6176,48816,9264,10448,23824,20736,25008,35296,39568,38384,49856,53968,0,0,0,0
.short 4104,5145,6186,11387,18668,25949,40510,33231,47776,55057,19698,12419,26980,34261,48822,41543,56096,9264,20736,10448,23824,25008,38384,35296,39568,49856,54128,52944,0,0,0,0
.short 4104,5145,6186,18667,11388,25949,33230,47791,40496,55057,12418,26979,19700,34261,41542,56103,48816,9264,10448,23824,20736,25008,35296,39568,38384,49856,52944,54128,0,0,0,0
.short 4104,5145,6186,11387,25948,18669,33230,40511,55056,47777,12418,19699,34260,26981,41542,48823,9264,56096,10448,20736,25008,23824,35296,38384,49856,39568,52944,54128,0,0,0,0
.short 4104,5145,6186,11387,18668,33229,25950,40511,47776,12417,55058,19699,26980,41541,34262,48823,56096,10448,9264,20736,23824,35296,25008,38384,39568,52944,49856,54128,0,0,0,0
.short 11385,12426,13467,18668,4109,25950,33231,47776,40497,55058,5139,26980,19701,34262,41543,56104,48816,6176,10288,23824,20736,25008,35296,39568,38384,49856,52944,54128,0,0,0,0
.short 11385,12426,13467,4108,25949,18670,33231,40496,55057,47778,5139,19700,34261,26982,41543,48824,6176,56096,10288,20736,25008,23824,35296,38384,49856,39568,52944,54128,0,0,0,0
.short 11385,12426,13467,4108,18669,33230,25951,40496,47777,5138,55059,19700,26981,41542,34263,48824,56096,10288,6176,20736,23824,35296,25008,38384,39568,52944,49856,54128,0,0,0,0
.short 11385,12426,13467,4108,18669,25950,40511,33216,47777,55058,19699,5140,26981,34262,48823,41544,56096,6176,20736,10288,23824,25008,38384,35296,39568,49856,54128,52944,0,0,0,0
.short 18666,19707,20748,4109,25950,11391,33216,40497,55058,47779,5140,12421,34262,26983,41544,48825,6176,56096,9264,10448,25008,23824,35296,38384,49856,39568,52944,54128,0,0,0,0
.short 18666,19707,20748,4109,11390,33231,25936,40497,47778,5139,55060,12421,26982,41543,34264,48825,56096,9264,6176,10448,23824,35296,25008,38384,39568,52944,49856,54128,0,0,0,0
.short 18666,19707,20748,4109,11390,25951,40496,33217,47778,55059,12420,5141,26982,34263,48824,41545,56096,6176,10448,9264,23824,25008,38384,35296,39568,49856,54128,52944,0,0,0,0
.short 18666,19707,20748,11389,4110,25951,33216,47777,40498,55059,5140,26981,12422,34263,41544,56105,48816,6176,9264,23824,10448,25008,35296,39568,38384,49856,52944,54128,0,0,0,0
.short 25947,26988,28029,4110,11391,33216,18657,40498,47779,5140,55061,12422,19703,41544,34265,48826,56096,9264,6176,10448,20736,35296,24848,38384,39568,52944,49856,54128,0,0,0,0
.short 25947,26988,28029,4110,11391,18656,40497,33218,47779,55060,12421,5142,19703,34264,48825,41546,56096,6176,10448,9264,20736,24848,38384,35296,39568,49856,54128,52944,0,0,0,0
.short 25947,26988,28029,11390,4111,18656,33217,47778,40499,55060,5141,19702,12423,34264,41545,56106,48816,6176,9264,20736,10448,24848,35296,39568,38384,49856,52944,54128,0,0,0,0
.short 25947,26988,28029,4110,18671,11376,33217,40498,55059,47780,5141,12422,34263,19704,41545,48826,6176,56096,9264,10448,24848,20736,35296,38384,49856,39568,52944,54128,0,0,0,0
.short 33228,34269,35310,4111,11376,18657,40498,25939,47780,55061,12422,5143,19704,26985,48826,41547,56096,6176,10448,9264,20736,23824,38384,25008,39568,49856,54128,52944,0,0,0,0
.short 33228,34269,35310,11391,4096,18657,25938,47779,40500,55061,5142,19703,12424,26985,41546,56107,48816,6176,9264,20736,10448,23824,25008,39568,38384,49856,52944,54128,0,0,0,0
.short 33228,34269,35310,4111,18656,11377,25938,40499,55060,47781,5142,12423,26984,19705,41546,48827,6176,56096,9264,10448,23824,20736,25008,38384,49856,39568,52944,54128,0,0,0,0
.short 33228,34269,35310,4111,11376,25937,18658,40499,47780,5141,55062,12423,19704,41545,26986,48827,56096,9264,6176,10448,20736,25008,23824,38384,39568,52944,49856,54128,0,0,0,0
.short 40509,41550,42591,11376,4097,18658,25939,47780,33221,55062,5143,19704,12425,26986,34267,56108,48816,6176,9264,20736,10448,23824,25008,39408,35296,49856,52944,54128,0,0,0,0
.short 40509,41550,42591,4096,18657,11378,25939,33220,55061,47782,5143,12424,26985,19706,34267,48828,6176,56096,9264,10448,23824,20736,25008,35296,49856,39408,52944,54128,0,0,0,0
.short 40509,41550,42591,4096,11377,25938,18659,33220,47781,5142,55063,12424,19705,34266,26987,48828,56096,9264,6176,10448,20736,25008,23824,35296,39408,52944,49856,54128,0,0,0,0
.short 40509,41550,42591,4096,11377,18658,33219,25940,47781,55062,12423,5144,19705,26986,48827,34268,56096,6176,10448,9264,20736,23824,35296,25008,39408,49856,54128,52944,0,0,0,0
.short 47790,48831,49856,4097,18658,11379,25940,33221,55062,40503,5144,12425,26986,19707,34268,41549,6176,56096,9264,10448,23824,20736,25008,35296,39568,38384,52944,54128,0,0,0,0
.short 47790,48831,49856,4097,11378,25939,18660,33221,40502,5143,55064,12425,19706,34267,26988,41549,56096,9264,6176,10448,20736,25008,23824,35296,38384,52944,39568,54128,0,0,0,0
.short 47790,48831,49856,4097,11378,18659,33220,25941,40502,55063,12424,5145,19706,26987,41548,34269,56096,6176,10448,9264,20736,23824,35296,25008,38384,39568,54128,52944,0,0,0,0
.short 47790,48831,49856,11377,4098,18659,25940,40501,33222,55063,5144,19705,12426,26987,34268,56109,41536,6176,9264,20736,10448,23824,25008,38384,35296,39568,52944,54128,0,0,0,0
.short 55071,56096,57137,4098,11379,25940,18661,33222,40503,5144,47785,12426,19707,34268,26989,41550,48816,9264,6176,10448,20736,25008,23824,35296,38384,49856,39568,53968,0,0,0,0
.short 55071,56096,57137,4098,11379,18660,33221,25942,40503,47784,12425,5146,19707,26988,41549,34270,48816,6176,10448,9264,20736,23824,35296,25008,38384,39568,53968,49856,0,0,0,0
.short 55071,56096,57137,11378,4099,18660,25941,40502,33223,47784,5145,19706,12427,26988,34269,48830,41536,6176,9264,20736,10448,23824,25008,38384,35296,39568,49856,53968,0,0,0,0
.short 55071,56096,57137,4098,18659,11380,25941,33222,47783,40504,5145,12426,26987,19708,34269,41550,6176,48816,9264,10448,23824,20736,25008,35296,39568,38384,49856,53968,0,0,0,0
.section .rodata,"a"
.p2align 6
.amdhsa_kernel interleave_layers__ssm_conv_h3__mixer_s_mlp__prompt_kernel
  .amdhsa_next_free_vgpr 256
  .amdhsa_next_free_sgpr 102
  .amdhsa_accum_offset 256
  .amdhsa_group_segment_fixed_size 0
  .amdhsa_kernarg_size 112
  .amdhsa_user_sgpr_count 2
  .amdhsa_user_sgpr_kernarg_segment_ptr 1
  .amdhsa_system_sgpr_workgroup_id_x 1
  .amdhsa_float_denorm_mode_32 3
.end_amdhsa_kernel
```

```asm
; @launch grid=(256,1,1) block=(512,1,1) lds=163840
.amdgcn_target "amdgcn-amd-amdhsa--gfx950"
.text
.globl interleave_layers__ssm_conv_h3__mixer_s_mlp__prompt_kernel
.p2align 8
.type interleave_layers__ssm_conv_h3__mixer_s_mlp__prompt_kernel,@function
interleave_layers__ssm_conv_h3__mixer_s_mlp__prompt_kernel:
    s_cmp_ge_u32 s2, 256
    s_cbranch_scc1 K_end
    s_load_dwordx8 s[8:15], s[0:1], 8
    s_load_dwordx2 s[6:7], s[0:1], 0
    s_load_dwordx8 s[68:75], s[0:1], 56
    s_load_dwordx2 s[4:5], s[0:1], 104
    s_load_dwordx2 s[84:85], s[0:1], 96
    s_memrealtime s[46:47]
    s_load_dwordx2 s[96:97], s[0:1], 40
    v_lshrrev_b32 v1, 6, v0
    s_nop 0
    v_readfirstlane_b32 s30, v1
    s_getpc_b64 s[48:49]
K_pc:
    s_lshr_b32 s36, s2, 3
    s_lshl_b32 s36, s36, 11
    v_lshlrev_b32 v4, 2, v0
    v_add_u32 v4, s36, v4
    v_cmp_gt_u32 vcc, K_end-K_pc-8, v4
    s_nop 0
    s_and_saveexec_b64 s[36:37], vcc
    s_cbranch_execz K_3
    v_mov_b32 v5, s49
    v_add_co_u32 v4, vcc, s48, v4
    s_nop 1
    v_addc_co_u32 v5, vcc, 0, v5, vcc
    global_load_dword v250, v[4:5], off
K_3:
    s_mov_b64 exec, -1
    v_and_b32 v6, 31, v0
    v_lshrrev_b32 v7, 5, v0
    s_and_b32 s34, s2, 7
    s_lshr_b32 s35, s2, 3
    s_lshl_b32 s36, s35, 17
    s_lshl_b32 s37, s34, 8
    s_add_u32 s36, s36, s37
    v_lshlrev_b32 v8, 13, v7
    v_lshl_add_u32 v8, v6, 3, v8
    v_add_u32 v12, s36, v8
    v_add_u32 v14, 4096, v12
    s_mov_b32 s18, 4194304
    s_mov_b32 s19, 0x20000
    s_mov_b32 s22, s18
    s_mov_b32 s23, s19
    s_waitcnt lgkmcnt(0)
    s_mov_b32 s86, 256
    s_mov_b32 s87, 0x20000
    v_mov_b32 v78, 0
    s_lshl_b32 s45, s2, 3
    s_add_u32 s45, s45, s30
    s_cmp_lg_u32 s45, 4
    s_cbranch_scc1 KV_t0
    s_lshl_b32 s44, s46, 6
    s_or_b32 s44, s44, 1
    v_mov_b32 v76, s44
    s_mov_b64 exec, 1
    buffer_store_dword v76, v78, s[84:87], 0 offen sc1
    s_mov_b64 exec, -1
KV_t0:
    s_mov_b64 s[16:17], s[8:9]
    s_mov_b64 s[20:21], s[10:11]
    buffer_load_dwordx2 v[28:29], v12, s[16:19], 0 offen offset:0 nt
    buffer_load_dwordx2 v[30:31], v12, s[16:19], 0 offen offset:2048 nt
    buffer_load_dwordx2 v[32:33], v14, s[16:19], 0 offen offset:0 nt
    buffer_load_dwordx2 v[34:35], v14, s[16:19], 0 offen offset:2048 nt
    buffer_load_dwordx2 v[36:37], v12, s[20:23], 0 offen offset:0 nt
    buffer_load_dwordx2 v[38:39], v12, s[20:23], 0 offen offset:2048 nt
    buffer_load_dwordx2 v[40:41], v14, s[20:23], 0 offen offset:0 nt
    buffer_load_dwordx2 v[42:43], v14, s[20:23], 0 offen offset:2048 nt
    v_subrev_u32 v9, 6144, v12
    v_subrev_u32 v10, 4096, v12
    v_subrev_u32 v11, 2048, v12
    s_lshl_b32 s37, s34, 10
    v_lshlrev_b32 v16, 5, v6
    v_add_u32 v16, s37, v16
    s_mov_b32 s24, s12
    s_mov_b32 s25, s13
    s_mov_b32 s26, 0x2000
    s_mov_b32 s27, 0x20000
    v_and_b32 v8, 1, v7
    v_lshl_add_u32 v16, v8, 4, v16
    buffer_load_dwordx4 v[44:47], v16, s[24:27], 0 offen
    s_cmp_lg_u32 s30, 4
    s_cbranch_scc1 KV_t2
    buffer_load_dword v76, v78, s[84:87], 0 offen sc1
KV_t2:
    s_bfm_b64 exec, 32, 0
    buffer_load_dwordx2 v[22:23], v9, s[16:19], 0 offen nt
    buffer_load_dwordx2 v[24:25], v10, s[16:19], 0 offen nt
    buffer_load_dwordx2 v[26:27], v11, s[16:19], 0 offen nt
    s_mov_b64 exec, -1
    v_and_b32 v1, 63, v0
    v_lshlrev_b32 v2, 4, v1
    v_lshlrev_b32 v3, 2, v1
    s_and_b32 s32, s2, 7
    s_lshr_b32 s33, s2, 3
    s_and_b32 s28, s32, 2
    s_lshr_b32 s34, s32, 2
    s_or_b32 s28, s28, s34
    s_lshl_b32 s28, s28, 2
    s_and_b32 s34, s33, 3
    s_add_u32 s28, s28, s34
    s_and_b32 s31, s32, 1
    s_lshr_b32 s33, s33, 2
    s_lshl_b32 s29, s31, 3
    s_add_u32 s29, s29, s33
    s_lshl_b32 s67, s33, 1
    s_and_b32 s67, s67, 0
    s_xor_b32 s99, s29, 1
    s_mov_b32 s60, 0
    s_mov_b32 s61, 40000
    s_mov_b32 s52, 0
    s_mov_b32 s55, 0
    s_mov_b32 s92, 0
    s_mov_b32 s93, 0
    s_mov_b32 s94, 0
    s_mov_b32 s56, s4
    s_mov_b32 s57, s5
    s_mov_b32 s58, 0xa000000
    s_mov_b32 s59, 0x20000
    v_and_b32 v199, 7, v0
    v_lshrrev_b32 v228, 6, v0
    v_lshlrev_b32 v228, 4, v228
    v_bfe_u32 v229, v0, 3, 3
    v_add_u32 v228, v228, v229
    s_lshr_b32 s78, s29, 1
    s_lshl_b32 s78, s78, 16
    s_and_b32 s79, s29, 1
    s_lshl_b32 s79, s79, 7
    s_add_u32 s78, s78, s79
    s_lshr_b32 s79, s30, 1
    s_lshl_b32 s79, s79, 13
    s_add_u32 s78, s78, s79
    v_lshlrev_b32 v196, 8, v228
    v_lshl_add_u32 v196, v199, 4, v196
    v_add_u32 v196, s78, v196
    s_lshl_b32 s78, s28, 7
    s_lshl_b32 s79, s29, 3
    s_add_u32 s78, s78, s79
    v_add_u32 v197, s78, v199
    v_lshlrev_b32 v198, 11, v197
    v_lshrrev_b32 v229, 2, v228
    v_lshlrev_b32 v229, 3, v229
    v_and_b32 v228, 3, v228
    v_add_u32 v228, v228, v229
    v_lshl_add_u32 v198, v228, 3, v198
    v_lshlrev_b32 v197, 3, v197
    v_lshl_add_u32 v197, v228, 14, v197
    s_add_u32 s62, s4, 33554432
    s_addc_u32 s63, s5, 0
    s_and_b32 s41, s30, 3
    s_and_b32 s38, s2, 7
    s_lshl_b32 s38, s38, 5
    s_lshr_b32 s39, s2, 3
    s_add_u32 s38, s38, s39
    s_lshl_b32 s39, s38, 2
    s_add_u32 s39, s39, s41
    s_mul_i32 s40, s41, 24576
    s_lshr_b32 s36, s39, 1
    s_lshl_b32 s36, s36, 2
    s_load_dword s98, s[96:97], s36
    s_lshl_b32 s36, s39, 12
    s_add_u32 s12, s14, s36
    s_addc_u32 s13, s15, 0
    s_mov_b32 s14, 4096
    s_mov_b32 s15, 0x20000
    s_lshr_b32 s45, s30, 2
    s_lshl_b32 s45, s45, 11
    s_add_u32 s36, s45, 0xffffffc0
    v_add_u32 v70, s36, v2
    v_add_u32 v71, 16, v70
    s_add_u32 s36, s45, 0x3c0
    v_add_u32 v72, s36, v2
    v_add_u32 v73, 16, v72
    s_mov_b32 s36, 4032
    v_add_u32 v74, s36, v2
    v_add_u32 v75, 16, v74
    s_and_b32 s34, s2, 7
    s_lshr_b32 s35, s2, 3
    v_mov_b32 v80, 0
    v_mov_b32 v81, 0
    v_mov_b32 v82, 0
    v_mov_b32 v83, 0
    v_add_u32 v86, s40, v2
    ds_write_b128 v86, v[80:83] offset:22784
    s_bfm_b64 exec, 26, 0
    ds_write_b128 v86, v[80:83] offset:23808
    s_mov_b64 exec, -1
    v_lshlrev_b32 v8, 2, v7
    v_sub_u32 v8, 60, v8
    v_lshrrev_b32 v85, 3, v8
    v_bfe_u32 v84, v6, 1, 3
    v_xor_b32 v85, v85, v84
    v_lshlrev_b32 v85, 4, v85
    v_and_b32 v8, 7, v8
    v_lshl_add_u32 v85, v8, 1, v85
    v_lshl_add_u32 v84, v6, 9, v85
    v_add_u32 v84, 98304, v84
    s_waitcnt vmcnt(0)
    s_cmp_lg_u32 s30, 4
    s_cbranch_scc1 KV_t1
KV_t1:
    buffer_load_dwordx4 v[52:55], v70, s[12:15], 0 offen nt
    buffer_load_dwordx2 v[56:57], v71, s[12:15], 0 offen nt
    buffer_load_dwordx4 v[58:61], v72, s[12:15], 0 offen nt
    buffer_load_dwordx2 v[62:63], v73, s[12:15], 0 offen nt
    buffer_load_dwordx4 v[64:67], v74, s[12:15], 0 offen nt
    buffer_load_dwordx2 v[68:69], v75, s[12:15], 0 offen nt
    v_mov_b32 v48, v44
    v_mov_b32 v49, v45
    v_mov_b32 v50, v46
    v_mov_b32 v51, v47
    v_mov_b32 v126, v30
    v_mov_b32 v127, v31
    v_mov_b32 v128, v32
    v_mov_b32 v129, v33
    v_mov_b32 v130, v34
    v_mov_b32 v131, v35
    v_permlane32_swap_b32 v44, v48
    v_permlane32_swap_b32 v45, v49
    v_permlane32_swap_b32 v46, v50
    v_permlane32_swap_b32 v47, v51
    v_permlane32_swap_b32 v22, v126
    v_permlane32_swap_b32 v23, v127
    v_permlane32_swap_b32 v24, v128
    v_permlane32_swap_b32 v25, v129
    v_permlane32_swap_b32 v26, v130
    v_permlane32_swap_b32 v27, v131
    v_lshlrev_b32 v88, 16, v44
    v_and_b32 v90, 0xffff0000, v44
    v_lshlrev_b32 v92, 16, v45
    v_and_b32 v94, 0xffff0000, v45
    v_lshlrev_b32 v89, 16, v46
    v_and_b32 v91, 0xffff0000, v46
    v_lshlrev_b32 v93, 16, v47
    v_and_b32 v95, 0xffff0000, v47
    v_lshlrev_b32 v96, 16, v22
    v_and_b32 v97, 0xffff0000, v22
    v_lshlrev_b32 v98, 16, v24
    v_and_b32 v99, 0xffff0000, v24
    v_lshlrev_b32 v100, 16, v26
    v_and_b32 v101, 0xffff0000, v26
    v_lshlrev_b32 v102, 16, v28
    v_and_b32 v103, 0xffff0000, v28
    v_lshlrev_b32 v104, 16, v30
    v_and_b32 v105, 0xffff0000, v30
    v_lshlrev_b32 v106, 16, v32
    v_and_b32 v107, 0xffff0000, v32
    v_lshlrev_b32 v108, 16, v34
    v_and_b32 v109, 0xffff0000, v34
    v_lshlrev_b32 v110, 16, v36
    v_and_b32 v111, 0xffff0000, v36
    v_lshlrev_b32 v112, 16, v38
    v_and_b32 v113, 0xffff0000, v38
    v_lshlrev_b32 v114, 16, v40
    v_and_b32 v115, 0xffff0000, v40
    v_lshlrev_b32 v116, 16, v42
    v_and_b32 v117, 0xffff0000, v42
    v_pk_mul_f32 v[118:119], v[96:97], v[94:95]
    v_pk_mul_f32 v[120:121], v[98:99], v[94:95]
    v_pk_mul_f32 v[122:123], v[100:101], v[94:95]
    v_pk_mul_f32 v[124:125], v[102:103], v[94:95]
    v_pk_fma_f32 v[118:119], v[98:99], v[92:93], v[118:119]
    v_pk_fma_f32 v[120:121], v[100:101], v[92:93], v[120:121]
    v_pk_fma_f32 v[122:123], v[102:103], v[92:93], v[122:123]
    v_pk_fma_f32 v[124:125], v[104:105], v[92:93], v[124:125]
    v_pk_fma_f32 v[118:119], v[100:101], v[90:91], v[118:119]
    v_pk_fma_f32 v[120:121], v[102:103], v[90:91], v[120:121]
    v_pk_fma_f32 v[122:123], v[104:105], v[90:91], v[122:123]
    v_pk_fma_f32 v[124:125], v[106:107], v[90:91], v[124:125]
    v_pk_fma_f32 v[118:119], v[102:103], v[88:89], v[118:119]
    v_pk_fma_f32 v[120:121], v[104:105], v[88:89], v[120:121]
    v_pk_fma_f32 v[122:123], v[106:107], v[88:89], v[122:123]
    v_pk_fma_f32 v[124:125], v[108:109], v[88:89], v[124:125]
    v_pk_mul_f32 v[118:119], v[118:119], v[110:111]
    v_pk_mul_f32 v[120:121], v[120:121], v[112:113]
    v_pk_mul_f32 v[122:123], v[122:123], v[114:115]
    v_pk_mul_f32 v[124:125], v[124:125], v[116:117]
    v_cvt_pk_bf16_f32 v136, v124, v122
    v_cvt_pk_bf16_f32 v137, v120, v118
    ds_write_b64 v84, v[136:137] offset:0
    v_cvt_pk_bf16_f32 v138, v125, v123
    v_cvt_pk_bf16_f32 v139, v121, v119
    ds_write_b64 v84, v[138:139] offset:128
    v_lshlrev_b32 v88, 16, v48
    v_and_b32 v90, 0xffff0000, v48
    v_lshlrev_b32 v92, 16, v49
    v_and_b32 v94, 0xffff0000, v49
    v_lshlrev_b32 v89, 16, v50
    v_and_b32 v91, 0xffff0000, v50
    v_lshlrev_b32 v93, 16, v51
    v_and_b32 v95, 0xffff0000, v51
    v_lshlrev_b32 v96, 16, v23
    v_and_b32 v97, 0xffff0000, v23
    v_lshlrev_b32 v98, 16, v25
    v_and_b32 v99, 0xffff0000, v25
    v_lshlrev_b32 v100, 16, v27
    v_and_b32 v101, 0xffff0000, v27
    v_lshlrev_b32 v102, 16, v29
    v_and_b32 v103, 0xffff0000, v29
    v_lshlrev_b32 v104, 16, v31
    v_and_b32 v105, 0xffff0000, v31
    v_lshlrev_b32 v106, 16, v33
    v_and_b32 v107, 0xffff0000, v33
    v_lshlrev_b32 v108, 16, v35
    v_and_b32 v109, 0xffff0000, v35
    v_lshlrev_b32 v110, 16, v37
    v_and_b32 v111, 0xffff0000, v37
    v_lshlrev_b32 v112, 16, v39
    v_and_b32 v113, 0xffff0000, v39
    v_lshlrev_b32 v114, 16, v41
    v_and_b32 v115, 0xffff0000, v41
    v_lshlrev_b32 v116, 16, v43
    v_and_b32 v117, 0xffff0000, v43
    v_pk_mul_f32 v[118:119], v[96:97], v[94:95]
    v_pk_mul_f32 v[120:121], v[98:99], v[94:95]
    v_pk_mul_f32 v[122:123], v[100:101], v[94:95]
    v_pk_mul_f32 v[124:125], v[102:103], v[94:95]
    v_pk_fma_f32 v[118:119], v[98:99], v[92:93], v[118:119]
    v_pk_fma_f32 v[120:121], v[100:101], v[92:93], v[120:121]
    v_pk_fma_f32 v[122:123], v[102:103], v[92:93], v[122:123]
    v_pk_fma_f32 v[124:125], v[104:105], v[92:93], v[124:125]
    v_pk_fma_f32 v[118:119], v[100:101], v[90:91], v[118:119]
    v_pk_fma_f32 v[120:121], v[102:103], v[90:91], v[120:121]
    v_pk_fma_f32 v[122:123], v[104:105], v[90:91], v[122:123]
    v_pk_fma_f32 v[124:125], v[106:107], v[90:91], v[124:125]
    v_pk_fma_f32 v[118:119], v[102:103], v[88:89], v[118:119]
    v_pk_fma_f32 v[120:121], v[104:105], v[88:89], v[120:121]
    v_pk_fma_f32 v[122:123], v[106:107], v[88:89], v[122:123]
    v_pk_fma_f32 v[124:125], v[108:109], v[88:89], v[124:125]
    v_pk_mul_f32 v[118:119], v[118:119], v[110:111]
    v_pk_mul_f32 v[120:121], v[120:121], v[112:113]
    v_pk_mul_f32 v[122:123], v[122:123], v[114:115]
    v_pk_mul_f32 v[124:125], v[124:125], v[116:117]
    v_cvt_pk_bf16_f32 v140, v124, v122
    v_cvt_pk_bf16_f32 v141, v120, v118
    ds_write_b64 v84, v[140:141] offset:256
    v_cvt_pk_bf16_f32 v142, v125, v123
    v_cvt_pk_bf16_f32 v143, v121, v119
    ds_write_b64 v84, v[142:143] offset:384
    s_cmp_lg_u32 s30, 4
    s_cbranch_scc1 HB_2
    v_add_u32 v18, 162816, v3
    ds_write_b32 v18, v78
    s_mov_b32 s53, 0
    s_waitcnt vmcnt(6)
HB_p:
    v_readfirstlane_b32 s52, v76
    s_nop 0
    s_cmp_eq_u32 s52, 0
    s_cbranch_scc1 HB_r
    s_cmp_ge_u32 s53, 400
    s_cbranch_scc1 HB_q
    s_add_u32 s54, s46, 8192
    s_lshl_b32 s54, s54, 6
    s_sub_u32 s54, s54, s52
    s_cmp_lt_u32 s54, 786432
    s_cbranch_scc1 HB_q
HB_r:
    buffer_load_dword v76, v78, s[84:87], 0 offen sc1
    s_waitcnt vmcnt(0)
    s_add_u32 s53, s53, 1
    s_cmp_lt_u32 s53, s61
    s_cbranch_scc1 HB_p
    s_mov_b32 s52, 1
    s_mov_b32 s61, 0
HB_q:
    v_mov_b32 v18, 162828
    v_mov_b32 v19, s52
    s_waitcnt lgkmcnt(0)
    ds_write_b32 v18, v19
HB_2:
    s_add_u32 s16, s4, 0x2000000
    s_addc_u32 s17, s5, 0
    s_mov_b32 s18, 0x8000000
    s_mov_b32 s19, 0x20000
    v_lshrrev_b32 v8, 3, v0
    v_and_b32 v85, 7, v0
    v_lshlrev_b32 v149, 12, v8
    v_lshl_add_u32 v149, v85, 4, v149
    s_lshl_b32 s36, s34, 24
    s_sub_u32 s37, 31, s35
    s_lshl_b32 s37, s37, 7
    s_add_u32 s36, s36, s37
    s_add_u32 s37, s36, 262144
    v_lshrrev_b32 v148, 3, v8
    v_xor_b32 v148, v148, v85
    v_lshlrev_b32 v148, 4, v148
    v_lshl_add_u32 v148, v8, 7, v148
    v_add_u32 v148, 98304, v148
    v_mov_b32 v18, 162828
    s_waitcnt lgkmcnt(0)
    s_barrier
    ds_read_b128 v[152:155], v148 offset:0
    ds_read_b128 v[156:159], v148 offset:8192
    ds_read_b32 v19, v18
    s_waitcnt lgkmcnt(2)
    v_or_b32 v152, 1, v152
    buffer_store_dwordx4 v[152:155], v149, s[16:19], s36 offen sc1
    s_waitcnt lgkmcnt(1)
    v_or_b32 v156, 1, v156
    buffer_store_dwordx4 v[156:159], v149, s[16:19], s37 offen sc1
    s_waitcnt lgkmcnt(0)
    v_readfirstlane_b32 s52, v19
    s_cmp_lg_u32 s30, 0
    s_cbranch_scc1 KV_ni
    s_cmp_ge_u32 s35, 16
    s_cbranch_scc1 KV_ni
    v_mov_b32 v8, s52
    s_lshl_b32 s37, s34, 7
    s_lshl_b32 s53, s35, 10
    s_add_u32 s37, s37, s53
    s_add_u32 s37, s37, 23101440
    s_mov_b64 exec, 1
    buffer_store_dword v8, v78, s[56:59], s37 offen sc1
    s_mov_b64 exec, -1
KV_ni:
    s_cmp_ge_u32 s2, 255
    s_cbranch_scc1 KV_n3
    s_cmp_lg_u32 s30, 5
    s_cbranch_scc1 KV_n3
    s_and_b32 s42, s2, 31
    s_lshl_b32 s42, s42, 8
    s_lshr_b32 s43, s2, 5
    s_lshl_b32 s43, s43, 14
    s_add_u32 s42, s42, s43
    s_add_u32 s42, s42, 39714816
    v_and_b32 v8, 1, v1
    v_lshlrev_b32 v8, 13, v8
    v_lshrrev_b32 v85, 1, v1
    v_lshl_add_u32 v8, v85, 7, v8
    s_mov_b64 exec, 0xf
    buffer_store_dword v8, v8, s[56:59], s42 offen sc1
    s_mov_b64 exec, -1
KV_n3:
    s_lshl_b32 s36, s34, 5
    s_add_u32 s36, s36, s35
    s_lshl_b32 s36, s36, 7
    s_add_u32 s36, s36, 23068672
    v_mov_b32 v18, 1
    v_mov_b32 v19, 162820
    v_mov_b32 v21, 0
    s_mov_b64 exec, 1
    s_waitcnt vmcnt(0)
    ds_add_rtn_u32 v20, v19, v18
    v_mov_b32 v19, s52
    s_waitcnt lgkmcnt(0)
    v_readfirstlane_b32 s54, v20
    s_nop 0
    s_and_b32 s54, s54, 7
    s_cmp_lg_u32 s54, 7
    s_cbranch_scc1 pub_1
    buffer_store_dword v19, v21, s[56:59], s36 offen sc1
pub_1:
    s_mov_b64 exec, -1
    s_mov_b32 s8, s6
    s_mov_b32 s9, s7
    s_mov_b32 s10, 0x400000
    s_mov_b32 s11, 0x20000
    buffer_load_dwordx2 v[180:181], v198, s[8:11], 0 offen offset:0 nt
    buffer_load_dwordx2 v[182:183], v198, s[8:11], 0 offen offset:32 nt
    buffer_load_dwordx2 v[184:185], v198, s[8:11], 0 offen offset:128 nt
    buffer_load_dwordx2 v[186:187], v198, s[8:11], 0 offen offset:160 nt
    v_add_u32 v160, s45, v86
    v_alignbit_b32 v88, v53, v52, 16
    v_mov_b32 v92, v53
    v_alignbit_b32 v96, v54, v53, 16
    v_alignbit_b32 v89, v54, v53, 16
    v_mov_b32 v93, v54
    v_alignbit_b32 v97, v55, v54, 16
    v_alignbit_b32 v90, v55, v54, 16
    v_mov_b32 v94, v55
    v_alignbit_b32 v98, v56, v55, 16
    v_alignbit_b32 v91, v56, v55, 16
    v_mov_b32 v95, v56
    v_alignbit_b32 v99, v57, v56, 16
    ds_write_b128 v160, v[88:91] offset:0
    ds_write_b128 v160, v[92:95] offset:4160
    ds_write_b128 v160, v[96:99] offset:8320
    ds_write_b128 v160, v[54:57] offset:12480
    v_alignbit_b32 v100, v59, v58, 16
    v_mov_b32 v104, v59
    v_alignbit_b32 v108, v60, v59, 16
    v_alignbit_b32 v101, v60, v59, 16
    v_mov_b32 v105, v60
    v_alignbit_b32 v109, v61, v60, 16
    v_alignbit_b32 v102, v61, v60, 16
    v_mov_b32 v106, v61
    v_alignbit_b32 v110, v62, v61, 16
    v_alignbit_b32 v103, v62, v61, 16
    v_mov_b32 v107, v62
    v_alignbit_b32 v111, v63, v62, 16
    ds_write_b128 v160, v[100:103] offset:1024
    ds_write_b128 v160, v[104:107] offset:5184
    ds_write_b128 v160, v[108:111] offset:9344
    ds_write_b128 v160, v[60:63] offset:13504
    v_alignbit_b32 v112, v65, v64, 16
    v_mov_b32 v116, v65
    v_alignbit_b32 v120, v66, v65, 16
    v_alignbit_b32 v113, v66, v65, 16
    v_mov_b32 v117, v66
    v_alignbit_b32 v121, v67, v66, 16
    v_alignbit_b32 v114, v67, v66, 16
    v_mov_b32 v118, v67
    v_alignbit_b32 v122, v68, v67, 16
    v_alignbit_b32 v115, v68, v67, 16
    v_mov_b32 v119, v68
    v_alignbit_b32 v123, v69, v68, 16
    s_mov_b64 exec, 0xf
    ds_write_b128 v86, v[112:115] offset:4096
    ds_write_b128 v86, v[116:119] offset:8256
    ds_write_b128 v86, v[120:123] offset:12416
    ds_write_b128 v86, v[66:69] offset:16576
    s_mov_b64 exec, -1
    s_waitcnt lgkmcnt(0)
    s_barrier
    v_mov_b32 v238, 0
    v_mov_b32 v239, 0
    v_mov_b32 v240, 0
    v_mov_b32 v241, 0
    v_mov_b32 v242, 0
    v_mov_b32 v243, 0
    v_mov_b32 v244, 0
    v_mov_b32 v245, 0
    v_mov_b32 v246, 0
    v_mov_b32 v247, 0
    s_cmp_ge_u32 s30, 4
    s_cbranch_scc1 FR_b
    s_and_b32 s38, s2, 7
    s_lshl_b32 s38, s38, 5
    s_lshr_b32 s39, s2, 3
    s_add_u32 s38, s38, s39
    s_lshl_b32 s39, s38, 2
    s_add_u32 s39, s39, s30
    s_mul_i32 s40, s30, 24576
    s_and_b32 s36, s39, 127
    s_lshl_b32 s36, s36, 12
    s_lshr_b32 s37, s39, 7
    s_lshl_b32 s37, s37, 24
    s_add_u32 s36, s36, s37
    s_add_u32 s36, s36, 33554432
    s_add_u32 s16, s4, s36
    s_addc_u32 s17, s5, 0
    s_mov_b32 s18, 4096
    s_mov_b32 s19, 0x20000
    v_lshrrev_b32 v6, 2, v1
    v_mul_u32_u24 v12, 96, v6
    v_and_b32 v6, 3, v1
    v_lshl_add_u32 v12, v6, 4, v12
    v_add_u32 v12, s40, v12
    v_and_b32 v35, 15, v1
    v_lshrrev_b32 v36, 4, v1
    v_and_b32 v6, 3, v35
    v_mul_u32_u24 v32, 4160, v6
    v_lshl_add_u32 v32, v36, 4, v32
    v_lshrrev_b32 v6, 2, v35
    v_lshl_add_u32 v32, v6, 3, v32
    v_add_u32 v32, s40, v32
    v_sub_u32 v6, 15, v35
    v_mul_u32_u24 v34, 96, v6
    v_add_u32 v34, s40, v34
    v_lshl_add_u32 v33, v36, 4, v34
    ds_read_b64 v[72:73], v32 offset:0
    ds_read_b64 v[74:75], v32 offset:8
    ds_read_b64 v[76:77], v32 offset:32
    ds_read_b64 v[78:79], v32 offset:40
    ds_read_b64 v[80:81], v32 offset:1024
    ds_read_b64 v[82:83], v32 offset:1032
    ds_read_b64 v[84:85], v32 offset:1056
    ds_read_b64 v[86:87], v32 offset:1064
    ds_read_b64 v[88:89], v32 offset:2048
    ds_read_b64 v[90:91], v32 offset:2056
    ds_read_b64 v[92:93], v32 offset:2080
    ds_read_b64 v[94:95], v32 offset:2088
    ds_read_b64 v[96:97], v32 offset:3072
    ds_read_b64 v[98:99], v32 offset:3080
    ds_read_b64 v[100:101], v32 offset:3104
    ds_read_b64 v[102:103], v32 offset:3112
    s_bitcmp1_b32 s39, 0
    s_cselect_b32 s36, 0, 16
    s_lshl_b32 s41, s98, s36
    s_and_b32 s41, s41, 0xffff0000
    s_lshr_b32 s36, s41, 16
    v_lshl_add_u32 v6, v36, 3, v35
    v_sub_u32 v6, 31, v6
    v_mov_b32 v10, s36
    v_mov_b32 v11, s41
    v_and_b32 v8, 1, v6
    v_cmp_eq_u32 vcc, 1, v8
    s_nop 1
    v_cndmask_b32 v10, v10, v11, vcc
    v_ashrrev_i32 v6, 1, v6
    v_cmp_eq_u32 vcc, 0, v6
    s_nop 1
    v_cndmask_b32 v152, 0, v10, vcc
    v_cmp_eq_u32 vcc, 1, v6
    s_nop 1
    v_cndmask_b32 v153, 0, v10, vcc
    v_cmp_eq_u32 vcc, 2, v6
    s_nop 1
    v_cndmask_b32 v154, 0, v10, vcc
    v_cmp_eq_u32 vcc, 3, v6
    s_nop 1
    v_cndmask_b32 v155, 0, v10, vcc
    v_cmp_eq_u32 vcc, 8, v6
    s_nop 1
    v_cndmask_b32 v156, 0, v10, vcc
    v_cmp_eq_u32 vcc, 9, v6
    s_nop 1
    v_cndmask_b32 v157, 0, v10, vcc
    v_cmp_eq_u32 vcc, 10, v6
    s_nop 1
    v_cndmask_b32 v158, 0, v10, vcc
    v_cmp_eq_u32 vcc, 11, v6
    s_nop 1
    v_cndmask_b32 v159, 0, v10, vcc
    s_add_u32 s12, s4, 0x1c00000
    s_addc_u32 s13, s5, 0
    s_mov_b32 s14, 0x400000
    s_mov_b32 s15, 0x20000
    v_bfe_u32 v6, v1, 2, 2
    v_mul_u32_u24 v168, 24640, v6
    v_lshrrev_b32 v6, 1, v36
    v_mul_u32_u24 v6, 72, v6
    v_add_u32 v168, v168, v6
    v_and_b32 v6, 1, v36
    v_lshl_add_u32 v168, v6, 5, v168
    v_and_b32 v6, 3, v1
    v_lshl_add_u32 v168, v6, 3, v168
    s_mul_i32 s36, s30, 1152
    v_add_u32 v168, s36, v168
    v_lshlrev_b32 v169, 3, v1
    s_lshl_b32 s44, s38, 14
    s_lshl_b32 s37, s30, 12
    s_add_u32 s44, s44, s37
    s_mul_i32 s36, s30, 24640
    v_mul_u32_u24 v170, 72, v35
    v_lshl_add_u32 v170, v36, 3, v170
    v_add_u32 v170, s36, v170
    s_cmp_lg_u32 s30, 0
    s_cbranch_scc1 CV_w
    s_and_b32 s36, s2, 7
    s_lshl_b32 s36, s36, 12
    s_add_u32 s36, s36, 23068672
    v_lshlrev_b32 v9, 7, v1
    v_add_u32 v9, s36, v9
    s_mov_b32 s53, 0
    s_add_u32 s54, s52, 0
    s_bfm_b64 exec, 32, 0
poll_2:
    buffer_load_dword v8, v9, s[56:59], 0 offen sc1
    s_waitcnt vmcnt(0)
    v_xor_b32 v8, s54, v8
    v_cmp_eq_u32 vcc, 0, v8
    s_nop 0
    s_cmp_eq_u64 vcc, exec
    s_cbranch_scc1 pok_3
    s_sleep 5
    s_add_u32 s53, s53, 1
    s_cmp_lt_u32 s53, s61
    s_cbranch_scc1 poll_2
    s_mov_b32 s61, 0
pok_3:
    s_mov_b64 exec, -1
    v_mov_b32 v8, 162832
    v_mov_b32 v9, 1
    s_waitcnt lgkmcnt(0)
    ds_write_b32 v8, v9
CV_w:
    v_mov_b32 v8, 162832
spin_4:
    ds_read_b32 v9, v8
    s_waitcnt lgkmcnt(0)
    v_readfirstlane_b32 s53, v9
    s_nop 0
    s_cmp_ge_u32 s53, 1
    s_cbranch_scc0 spin_4
    buffer_load_dwordx4 v[16:19], v2, s[16:19], 0 offen offset:0 sc1
    buffer_load_dwordx4 v[20:23], v2, s[16:19], 0 offen offset:1024 sc1
    buffer_load_dwordx4 v[24:27], v2, s[16:19], 0 offen offset:2048 sc1
    buffer_load_dwordx4 v[28:31], v2, s[16:19], 0 offen offset:3072 sc1
    s_waitcnt vmcnt(3)
    ds_write_b128 v12, v[16:19] offset:16640
    s_waitcnt vmcnt(2)
    ds_write_b128 v12, v[20:23] offset:18176
    s_waitcnt vmcnt(1)
    ds_write_b128 v12, v[24:27] offset:19712
    s_waitcnt vmcnt(0)
    ds_write_b128 v12, v[28:31] offset:21248
    v_mov_b32 v8, 162836
    v_mov_b32 v9, 1
    s_mov_b64 exec, 1
    ds_add_u32 v8, v9
    s_mov_b64 exec, -1
    s_waitcnt lgkmcnt(0)
    ds_read_b128 v[136:139], v33 offset:21248
    ds_read_b128 v[140:143], v33 offset:19712
    ds_read_b128 v[144:147], v33 offset:18176
    ds_read_b128 v[148:151], v33 offset:16640
    s_waitcnt lgkmcnt(3)
    v_mfma_f32_16x16x32_bf16 v[40:43], v[152:155], v[136:139], 0
    v_mfma_f32_16x16x32_bf16 v[44:47], v[156:159], v[136:139], 0
    s_waitcnt lgkmcnt(2)
    v_mfma_f32_16x16x32_bf16 v[48:51], v[152:155], v[140:143], 0
    v_mfma_f32_16x16x32_bf16 v[52:55], v[156:159], v[140:143], 0
    s_waitcnt lgkmcnt(1)
    v_mfma_f32_16x16x32_bf16 v[56:59], v[152:155], v[144:147], 0
    v_mfma_f32_16x16x32_bf16 v[60:63], v[156:159], v[144:147], 0
    s_waitcnt lgkmcnt(0)
    v_mfma_f32_16x16x32_bf16 v[64:67], v[152:155], v[148:151], 0
    v_mfma_f32_16x16x32_bf16 v[68:71], v[156:159], v[148:151], 0
    s_mov_b32 s43, 0
CV_r:
    s_waitcnt lgkmcnt(0)
    v_mfma_f32_16x16x32_bf16 v[40:43], v[72:75], v[136:139], v[40:43]
    v_mfma_f32_16x16x32_bf16 v[48:51], v[72:75], v[140:143], v[48:51]
    v_mfma_f32_16x16x32_bf16 v[56:59], v[72:75], v[144:147], v[56:59]
    v_mfma_f32_16x16x32_bf16 v[64:67], v[72:75], v[148:151], v[64:67]
    v_mfma_f32_16x16x32_bf16 v[44:47], v[76:79], v[136:139], v[44:47]
    v_mfma_f32_16x16x32_bf16 v[52:55], v[76:79], v[140:143], v[52:55]
    v_mfma_f32_16x16x32_bf16 v[60:63], v[76:79], v[144:147], v[60:63]
    v_mfma_f32_16x16x32_bf16 v[68:71], v[76:79], v[148:151], v[68:71]
    v_mfma_f32_16x16x32_bf16 v[48:51], v[80:83], v[136:139], v[48:51]
    v_mfma_f32_16x16x32_bf16 v[56:59], v[80:83], v[140:143], v[56:59]
    v_mfma_f32_16x16x32_bf16 v[64:67], v[80:83], v[144:147], v[64:67]
    v_mfma_f32_16x16x32_bf16 v[52:55], v[84:87], v[136:139], v[52:55]
    v_mfma_f32_16x16x32_bf16 v[60:63], v[84:87], v[140:143], v[60:63]
    v_mfma_f32_16x16x32_bf16 v[68:71], v[84:87], v[144:147], v[68:71]
    v_mfma_f32_16x16x32_bf16 v[56:59], v[88:91], v[136:139], v[56:59]
    v_mfma_f32_16x16x32_bf16 v[64:67], v[88:91], v[140:143], v[64:67]
    v_mfma_f32_16x16x32_bf16 v[60:63], v[92:95], v[136:139], v[60:63]
    v_mfma_f32_16x16x32_bf16 v[68:71], v[92:95], v[140:143], v[68:71]
    v_mfma_f32_16x16x32_bf16 v[64:67], v[96:99], v[136:139], v[64:67]
    v_mfma_f32_16x16x32_bf16 v[68:71], v[100:103], v[136:139], v[68:71]
    ds_read_b128 v[152:155], v33 offset:21344
    ds_read_b128 v[156:159], v33 offset:19808
    ds_read_b128 v[160:163], v33 offset:18272
    ds_read_b128 v[164:167], v33 offset:16736
    ds_read_b64 v[104:105], v32 offset:64
    ds_read_b64 v[106:107], v32 offset:72
    ds_read_b64 v[108:109], v32 offset:96
    ds_read_b64 v[110:111], v32 offset:104
    ds_read_b64 v[112:113], v32 offset:1088
    ds_read_b64 v[114:115], v32 offset:1096
    ds_read_b64 v[116:117], v32 offset:1120
    ds_read_b64 v[118:119], v32 offset:1128
    ds_read_b64 v[120:121], v32 offset:2112
    ds_read_b64 v[122:123], v32 offset:2120
    ds_read_b64 v[124:125], v32 offset:2144
    ds_read_b64 v[126:127], v32 offset:2152
    ds_read_b64 v[128:129], v32 offset:3136
    ds_read_b64 v[130:131], v32 offset:3144
    ds_read_b64 v[132:133], v32 offset:3168
    ds_read_b64 v[134:135], v32 offset:3176
    s_waitcnt lgkmcnt(0)
    v_mfma_f32_16x16x32_bf16 v[40:43], v[104:107], v[152:155], v[40:43]
    v_mfma_f32_16x16x32_bf16 v[48:51], v[104:107], v[156:159], v[48:51]
    v_mfma_f32_16x16x32_bf16 v[56:59], v[104:107], v[160:163], v[56:59]
    v_mfma_f32_16x16x32_bf16 v[64:67], v[104:107], v[164:167], v[64:67]
    v_mfma_f32_16x16x32_bf16 v[44:47], v[108:111], v[152:155], v[44:47]
    v_mfma_f32_16x16x32_bf16 v[52:55], v[108:111], v[156:159], v[52:55]
    v_mfma_f32_16x16x32_bf16 v[60:63], v[108:111], v[160:163], v[60:63]
    v_mfma_f32_16x16x32_bf16 v[68:71], v[108:111], v[164:167], v[68:71]
    v_mfma_f32_16x16x32_bf16 v[48:51], v[112:115], v[152:155], v[48:51]
    v_mfma_f32_16x16x32_bf16 v[56:59], v[112:115], v[156:159], v[56:59]
    v_mfma_f32_16x16x32_bf16 v[64:67], v[112:115], v[160:163], v[64:67]
    v_mfma_f32_16x16x32_bf16 v[52:55], v[116:119], v[152:155], v[52:55]
    v_mfma_f32_16x16x32_bf16 v[60:63], v[116:119], v[156:159], v[60:63]
    v_mfma_f32_16x16x32_bf16 v[68:71], v[116:119], v[160:163], v[68:71]
    v_mfma_f32_16x16x32_bf16 v[56:59], v[120:123], v[152:155], v[56:59]
    v_mfma_f32_16x16x32_bf16 v[64:67], v[120:123], v[156:159], v[64:67]
    v_mfma_f32_16x16x32_bf16 v[60:63], v[124:127], v[152:155], v[60:63]
    v_mfma_f32_16x16x32_bf16 v[68:71], v[124:127], v[156:159], v[68:71]
    v_mfma_f32_16x16x32_bf16 v[64:67], v[128:131], v[152:155], v[64:67]
    v_mfma_f32_16x16x32_bf16 v[68:71], v[132:135], v[152:155], v[68:71]
    ds_read_b128 v[136:139], v33 offset:21440
    ds_read_b128 v[140:143], v33 offset:19904
    ds_read_b128 v[144:147], v33 offset:18368
    ds_read_b128 v[148:151], v33 offset:16832
    ds_read_b64 v[72:73], v32 offset:128
    ds_read_b64 v[74:75], v32 offset:136
    ds_read_b64 v[76:77], v32 offset:160
    ds_read_b64 v[78:79], v32 offset:168
    ds_read_b64 v[80:81], v32 offset:1152
    ds_read_b64 v[82:83], v32 offset:1160
    ds_read_b64 v[84:85], v32 offset:1184
    ds_read_b64 v[86:87], v32 offset:1192
    ds_read_b64 v[88:89], v32 offset:2176
    ds_read_b64 v[90:91], v32 offset:2184
    ds_read_b64 v[92:93], v32 offset:2208
    ds_read_b64 v[94:95], v32 offset:2216
    ds_read_b64 v[96:97], v32 offset:3200
    ds_read_b64 v[98:99], v32 offset:3208
    ds_read_b64 v[100:101], v32 offset:3232
    ds_read_b64 v[102:103], v32 offset:3240
    v_add_u32 v32, 128, v32
    v_add_u32 v33, 192, v33
    s_add_u32 s43, s43, 1
    s_cmp_lt_u32 s43, 4
    s_cbranch_scc1 CV_r
CV_l:
    s_waitcnt lgkmcnt(10)
    v_mfma_f32_16x16x32_bf16 v[40:43], v[72:75], v[136:139], v[40:43]
    ds_read_b128 v[152:155], v33 offset:21344
    v_mfma_f32_16x16x32_bf16 v[48:51], v[72:75], v[140:143], v[48:51]
    ds_read_b128 v[156:159], v33 offset:19808
    v_mfma_f32_16x16x32_bf16 v[56:59], v[72:75], v[144:147], v[56:59]
    ds_read_b128 v[160:163], v33 offset:18272
    v_mfma_f32_16x16x32_bf16 v[64:67], v[72:75], v[148:151], v[64:67]
    ds_read_b128 v[164:167], v33 offset:16736
    v_mfma_f32_16x16x32_bf16 v[44:47], v[76:79], v[136:139], v[44:47]
    ds_read_b64 v[104:105], v32 offset:64
    v_mfma_f32_16x16x32_bf16 v[52:55], v[76:79], v[140:143], v[52:55]
    ds_read_b64 v[106:107], v32 offset:72
    v_mfma_f32_16x16x32_bf16 v[60:63], v[76:79], v[144:147], v[60:63]
    ds_read_b64 v[108:109], v32 offset:96
    v_mfma_f32_16x16x32_bf16 v[68:71], v[76:79], v[148:151], v[68:71]
    ds_read_b64 v[110:111], v32 offset:104
    v_mfma_f32_16x16x32_bf16 v[48:51], v[80:83], v[136:139], v[48:51]
    ds_read_b64 v[112:113], v32 offset:1088
    v_mfma_f32_16x16x32_bf16 v[56:59], v[80:83], v[140:143], v[56:59]
    ds_read_b64 v[114:115], v32 offset:1096
    s_waitcnt lgkmcnt(10)
    v_mfma_f32_16x16x32_bf16 v[64:67], v[80:83], v[144:147], v[64:67]
    ds_read_b64 v[116:117], v32 offset:1120
    v_mfma_f32_16x16x32_bf16 v[52:55], v[84:87], v[136:139], v[52:55]
    ds_read_b64 v[118:119], v32 offset:1128
    v_mfma_f32_16x16x32_bf16 v[60:63], v[84:87], v[140:143], v[60:63]
    ds_read_b64 v[120:121], v32 offset:2112
    v_mfma_f32_16x16x32_bf16 v[68:71], v[84:87], v[144:147], v[68:71]
    ds_read_b64 v[122:123], v32 offset:2120
    v_mfma_f32_16x16x32_bf16 v[56:59], v[88:91], v[136:139], v[56:59]
    ds_read_b64 v[124:125], v32 offset:2144
    v_mfma_f32_16x16x32_bf16 v[64:67], v[88:91], v[140:143], v[64:67]
    ds_read_b64 v[126:127], v32 offset:2152
    v_mfma_f32_16x16x32_bf16 v[60:63], v[92:95], v[136:139], v[60:63]
    ds_read_b64 v[128:129], v32 offset:3136
    v_mfma_f32_16x16x32_bf16 v[68:71], v[92:95], v[140:143], v[68:71]
    ds_read_b64 v[130:131], v32 offset:3144
    v_mfma_f32_16x16x32_bf16 v[64:67], v[96:99], v[136:139], v[64:67]
    ds_read_b64 v[132:133], v32 offset:3168
    v_mfma_f32_16x16x32_bf16 v[68:71], v[100:103], v[136:139], v[68:71]
    ds_read_b64 v[134:135], v32 offset:3176
    s_waitcnt lgkmcnt(10)
    v_mfma_f32_16x16x32_bf16 v[40:43], v[104:107], v[152:155], v[40:43]
    ds_read_b128 v[136:139], v33 offset:21440
    v_mfma_f32_16x16x32_bf16 v[48:51], v[104:107], v[156:159], v[48:51]
    ds_read_b128 v[140:143], v33 offset:19904
    v_mfma_f32_16x16x32_bf16 v[56:59], v[104:107], v[160:163], v[56:59]
    ds_read_b128 v[144:147], v33 offset:18368
    v_mfma_f32_16x16x32_bf16 v[64:67], v[104:107], v[164:167], v[64:67]
    ds_read_b128 v[148:151], v33 offset:16832
    v_mfma_f32_16x16x32_bf16 v[44:47], v[108:111], v[152:155], v[44:47]
    ds_read_b64 v[72:73], v32 offset:128
    v_mfma_f32_16x16x32_bf16 v[52:55], v[108:111], v[156:159], v[52:55]
    ds_read_b64 v[74:75], v32 offset:136
    v_add_u32 v33, 192, v33
    v_mfma_f32_16x16x32_bf16 v[60:63], v[108:111], v[160:163], v[60:63]
    ds_read_b64 v[76:77], v32 offset:160
    s_add_u32 s43, s43, 1
    v_mfma_f32_16x16x32_bf16 v[68:71], v[108:111], v[164:167], v[68:71]
    ds_read_b64 v[78:79], v32 offset:168
    s_cmp_lt_u32 s43, 8
    v_mfma_f32_16x16x32_bf16 v[48:51], v[112:115], v[152:155], v[48:51]
    ds_read_b64 v[80:81], v32 offset:1152
    v_mfma_f32_16x16x32_bf16 v[56:59], v[112:115], v[156:159], v[56:59]
    ds_read_b64 v[82:83], v32 offset:1160
    s_waitcnt lgkmcnt(10)
    v_mfma_f32_16x16x32_bf16 v[64:67], v[112:115], v[160:163], v[64:67]
    ds_read_b64 v[84:85], v32 offset:1184
    v_mfma_f32_16x16x32_bf16 v[52:55], v[116:119], v[152:155], v[52:55]
    ds_read_b64 v[86:87], v32 offset:1192
    v_mfma_f32_16x16x32_bf16 v[60:63], v[116:119], v[156:159], v[60:63]
    ds_read_b64 v[88:89], v32 offset:2176
    v_mfma_f32_16x16x32_bf16 v[68:71], v[116:119], v[160:163], v[68:71]
    ds_read_b64 v[90:91], v32 offset:2184
    v_mfma_f32_16x16x32_bf16 v[56:59], v[120:123], v[152:155], v[56:59]
    ds_read_b64 v[92:93], v32 offset:2208
    v_mfma_f32_16x16x32_bf16 v[64:67], v[120:123], v[156:159], v[64:67]
    ds_read_b64 v[94:95], v32 offset:2216
    v_mfma_f32_16x16x32_bf16 v[60:63], v[124:127], v[152:155], v[60:63]
    ds_read_b64 v[96:97], v32 offset:3200
    v_mfma_f32_16x16x32_bf16 v[68:71], v[124:127], v[156:159], v[68:71]
    ds_read_b64 v[98:99], v32 offset:3208
    v_mfma_f32_16x16x32_bf16 v[64:67], v[128:131], v[152:155], v[64:67]
    ds_read_b64 v[100:101], v32 offset:3232
    v_mfma_f32_16x16x32_bf16 v[68:71], v[132:135], v[152:155], v[68:71]
    ds_read_b64 v[102:103], v32 offset:3240
    v_add_u32 v32, 128, v32
    s_cbranch_scc1 CV_l
    s_waitcnt lgkmcnt(0)
    v_cvt_pk_bf16_f32 v16, v40, v41
    v_cvt_pk_bf16_f32 v17, v42, v43
    ds_write_b64 v170, v[16:17] offset:0
    v_cvt_pk_bf16_f32 v18, v44, v45
    v_cvt_pk_bf16_f32 v19, v46, v47
    ds_write_b64 v170, v[18:19] offset:32
    v_cvt_pk_bf16_f32 v20, v48, v49
    v_cvt_pk_bf16_f32 v21, v50, v51
    ds_write_b64 v170, v[20:21] offset:1152
    v_cvt_pk_bf16_f32 v22, v52, v53
    v_cvt_pk_bf16_f32 v23, v54, v55
    ds_write_b64 v170, v[22:23] offset:1184
    v_cvt_pk_bf16_f32 v24, v56, v57
    v_cvt_pk_bf16_f32 v25, v58, v59
    ds_write_b64 v170, v[24:25] offset:2304
    v_cvt_pk_bf16_f32 v26, v60, v61
    v_cvt_pk_bf16_f32 v27, v62, v63
    ds_write_b64 v170, v[26:27] offset:2336
    v_cvt_pk_bf16_f32 v28, v64, v65
    v_cvt_pk_bf16_f32 v29, v66, v67
    ds_write_b64 v170, v[28:29] offset:3456
    v_cvt_pk_bf16_f32 v30, v68, v69
    v_cvt_pk_bf16_f32 v31, v70, v71
    ds_write_b64 v170, v[30:31] offset:3488
    v_mov_b32 v8, 162824
    v_mov_b32 v9, 1
    s_waitcnt lgkmcnt(0)
    s_mov_b64 exec, 1
    ds_add_u32 v8, v9
    s_mov_b64 exec, -1
    v_mov_b32 v8, 162824
spin_5:
    ds_read_b32 v9, v8
    s_waitcnt lgkmcnt(0)
    v_readfirstlane_b32 s53, v9
    s_nop 0
    s_cmp_ge_u32 s53, 4
    s_cbranch_scc0 spin_5
    ds_read_b64_tr_b16 v[104:105], v168 offset:0
    ds_read_b64_tr_b16 v[106:107], v168 offset:144
    ds_read_b64_tr_b16 v[108:109], v168 offset:288
    ds_read_b64_tr_b16 v[110:111], v168 offset:432
    ds_read_b64_tr_b16 v[112:113], v168 offset:576
    ds_read_b64_tr_b16 v[114:115], v168 offset:720
    ds_read_b64_tr_b16 v[116:117], v168 offset:864
    ds_read_b64_tr_b16 v[118:119], v168 offset:1008
    s_waitcnt lgkmcnt(7)
    buffer_store_dwordx2 v[104:105], v169, s[12:15], s44 offen offset:0 sc1
    s_waitcnt lgkmcnt(6)
    buffer_store_dwordx2 v[106:107], v169, s[12:15], s44 offen offset:512 sc1
    s_waitcnt lgkmcnt(5)
    buffer_store_dwordx2 v[108:109], v169, s[12:15], s44 offen offset:1024 sc1
    s_waitcnt lgkmcnt(4)
    buffer_store_dwordx2 v[110:111], v169, s[12:15], s44 offen offset:1536 sc1
    s_waitcnt lgkmcnt(3)
    buffer_store_dwordx2 v[112:113], v169, s[12:15], s44 offen offset:2048 sc1
    s_waitcnt lgkmcnt(2)
    buffer_store_dwordx2 v[114:115], v169, s[12:15], s44 offen offset:2560 sc1
    s_waitcnt lgkmcnt(1)
    buffer_store_dwordx2 v[116:117], v169, s[12:15], s44 offen offset:3072 sc1
    s_waitcnt lgkmcnt(0)
    buffer_store_dwordx2 v[118:119], v169, s[12:15], s44 offen offset:3584 sc1
    v_mov_b32 v8, 162836
    v_mov_b32 v9, 1
    s_mov_b64 exec, 1
    ds_add_u32 v8, v9
    s_mov_b64 exec, -1
    s_and_b32 s36, s2, 7
    s_lshl_b32 s36, s36, 7
    s_add_u32 s36, s36, 23101440
    v_mov_b32 v6, 1
    v_mov_b32 v7, 162820
    v_lshlrev_b32 v9, 10, v1
    s_mov_b64 exec, 1
    s_waitcnt vmcnt(0)
    s_waitcnt lgkmcnt(0)
    ds_add_rtn_u32 v8, v7, v6
    ds_read_b32 v10, v7 offset:28
    s_waitcnt lgkmcnt(0)
    v_readfirstlane_b32 s54, v8
    v_readfirstlane_b32 s53, v10
    s_cmp_lg_u32 s54, 15
    s_cbranch_scc1 fa_6
    s_mov_b64 exec, 0xffff
    s_or_b32 s53, s53, 1
    v_mov_b32 v6, s53
    buffer_atomic_add v6, v9, s[56:59], s36 offen sc1
fa_6:
    s_mov_b64 exec, -1
    s_branch FR_end
FR_b:
    s_getpc_b64 s[34:35]
K_tpc:
    s_lshl_b32 s36, s29, 2
    s_and_b32 s37, s28, 3
    s_add_u32 s36, s36, s37
    s_lshl_b32 s36, s36, 6
    s_add_u32 s36, s36, K_tab-K_tpc
    s_add_u32 s34, s34, s36
    s_addc_u32 s35, s35, 0
    v_and_b32 v248, 31, v1
    v_lshlrev_b32 v248, 1, v248
    global_load_ushort v251, v248, s[34:35]
    v_lshrrev_b32 v253, 3, v1
    v_lshlrev_b32 v238, 11, v253
    v_and_b32 v253, 6, v253
    v_and_b32 v254, 7, v1
    v_xor_b32 v253, v253, v254
    v_lshl_add_u32 v238, v253, 4, v238
    v_lshrrev_b32 v253, 4, v1
    v_lshlrev_b32 v239, 11, v253
    v_add_u32 v253, 0, v253
    v_lshlrev_b32 v253, 1, v253
    v_and_b32 v254, 15, v1
    v_xor_b32 v253, v253, v254
    v_lshl_add_u32 v239, v253, 4, v239
    v_lshrrev_b32 v253, 4, v1
    v_lshlrev_b32 v240, 11, v253
    v_add_u32 v253, 4, v253
    v_lshlrev_b32 v253, 1, v253
    v_and_b32 v254, 15, v1
    v_xor_b32 v253, v253, v254
    v_lshl_add_u32 v240, v253, 4, v240
    v_add_u32 v254, 0, v1
    v_mul_u32_u24 v253, 2341, v254
    v_lshrrev_b32 v253, 16, v253
    v_mul_u32_u24 v241, 28, v253
    v_sub_u32 v254, v254, v241
    v_mul_u32_u24 v241, 7168, v253
    v_lshrrev_b32 v253, 1, v253
    v_and_b32 v253, 2, v253
    v_xor_b32 v254, v254, v253
    v_lshl_add_u32 v241, v254, 4, v241
    v_add_u32 v254, 64, v1
    v_mul_u32_u24 v253, 2341, v254
    v_lshrrev_b32 v253, 16, v253
    v_mul_u32_u24 v242, 28, v253
    v_sub_u32 v254, v254, v242
    v_mul_u32_u24 v242, 7168, v253
    v_lshrrev_b32 v253, 1, v253
    v_and_b32 v253, 2, v253
    v_xor_b32 v254, v254, v253
    v_lshl_add_u32 v242, v254, 4, v242
    v_add_u32 v254, 128, v1
    v_mul_u32_u24 v253, 2341, v254
    v_lshrrev_b32 v253, 16, v253
    v_mul_u32_u24 v243, 28, v253
    v_sub_u32 v254, v254, v243
    v_mul_u32_u24 v243, 7168, v253
    v_lshrrev_b32 v253, 1, v253
    v_and_b32 v253, 2, v253
    v_xor_b32 v254, v254, v253
    v_lshl_add_u32 v243, v254, 4, v243
    v_add_u32 v254, 192, v1
    v_mul_u32_u24 v253, 2341, v254
    v_lshrrev_b32 v253, 16, v253
    v_mul_u32_u24 v244, 28, v253
    v_sub_u32 v254, v254, v244
    v_mul_u32_u24 v244, 7168, v253
    v_lshrrev_b32 v253, 1, v253
    v_and_b32 v253, 2, v253
    v_xor_b32 v254, v254, v253
    v_lshl_add_u32 v244, v254, 4, v244
    v_add_u32 v254, 256, v1
    v_mul_u32_u24 v253, 2341, v254
    v_lshrrev_b32 v253, 16, v253
    v_mul_u32_u24 v245, 28, v253
    v_sub_u32 v254, v254, v245
    v_mul_u32_u24 v245, 7168, v253
    v_lshrrev_b32 v253, 1, v253
    v_and_b32 v253, 2, v253
    v_xor_b32 v254, v254, v253
    v_lshl_add_u32 v245, v254, 4, v245
    v_add_u32 v254, 320, v1
    v_mul_u32_u24 v253, 2341, v254
    v_lshrrev_b32 v253, 16, v253
    v_mul_u32_u24 v246, 28, v253
    v_sub_u32 v254, v254, v246
    v_mul_u32_u24 v246, 7168, v253
    v_lshrrev_b32 v253, 1, v253
    v_and_b32 v253, 2, v253
    v_xor_b32 v254, v254, v253
    v_lshl_add_u32 v246, v254, 4, v246
    v_add_u32 v254, 384, v1
    v_mul_u32_u24 v253, 2341, v254
    v_lshrrev_b32 v253, 16, v253
    v_mul_u32_u24 v247, 28, v253
    v_sub_u32 v254, v254, v247
    v_mul_u32_u24 v247, 7168, v253
    v_lshrrev_b32 v253, 1, v253
    v_and_b32 v253, 2, v253
    v_xor_b32 v254, v254, v253
    v_lshl_add_u32 v247, v254, 4, v247
    s_cmp_ge_u32 s30, 6
    s_cbranch_scc1 FB_cs
    s_cmp_ge_u32 s2, 255
    s_cbranch_scc1 FB_np
    s_cmp_lg_u32 s30, 5
    s_cbranch_scc1 FB_np
    s_and_b32 s42, s2, 31
    s_lshl_b32 s42, s42, 8
    s_lshr_b32 s43, s2, 5
    s_lshl_b32 s43, s43, 14
    s_add_u32 s42, s42, s43
    s_add_u32 s42, s42, 39714816
    v_mov_b32 v14, 0
    s_mov_b64 exec, 1
    s_mov_b32 s46, -1
    s_mov_b32 s47, -1
    s_mov_b32 s43, 0
FB_ml:
    s_add_u32 s45, s42, 0
    s_memtime s[34:35]
    s_waitcnt lgkmcnt(0)
    buffer_load_dword v13, v14, s[56:59], s45 offen sc1
    s_waitcnt vmcnt(0)
    s_memtime s[36:37]
    s_waitcnt lgkmcnt(0)
    s_sub_u32 s36, s36, s34
    s_min_u32 s46, s46, s36
    s_add_u32 s45, s42, 8192
    s_memtime s[34:35]
    s_waitcnt lgkmcnt(0)
    buffer_load_dword v13, v14, s[56:59], s45 offen sc1
    s_waitcnt vmcnt(0)
    s_memtime s[36:37]
    s_waitcnt lgkmcnt(0)
    s_sub_u32 s36, s36, s34
    s_min_u32 s47, s47, s36
    s_add_u32 s42, s42, 128
    s_add_u32 s43, s43, 1
    s_cmp_lt_u32 s43, 2
    s_cbranch_scc1 FB_ml
    s_cmp_lt_u32 s47, s46
    s_cselect_b32 s45, 1, 0
    s_lshr_b32 s46, s28, 2
    s_xor_b32 s45, s45, s46
    s_and_b32 s45, s45, 1
    s_lshl_b32 s45, s45, 8
    s_mov_b64 exec, -1
    v_mov_b32 v6, 162848
    v_mov_b32 v7, s45
    s_waitcnt lgkmcnt(0)
    ds_write_b32 v6, v7
FB_np:
    s_cmp_lg_u32 s30, 4
    s_cbranch_scc1 FB_ni
    v_mov_b32 v12, s52
    s_lshr_b32 s53, s28, 3
    s_lshl_b32 s53, s53, 2
    s_and_b32 s54, s28, 3
    s_add_u32 s53, s53, s54
    s_lshl_b32 s53, s53, 24
    s_lshr_b32 s54, s28, 2
    s_xor_b32 s54, s54, s94
    s_and_b32 s54, s54, 1
    s_lshl_b32 s54, s54, 13
    s_add_u32 s37, s53, s54
    s_add_u32 s37, s37, 33554432
    s_andn2_b32 s37, s37, 0x2000
    s_lshl_b32 s53, s29, 7
    s_add_u32 s37, s37, s53
    s_add_u32 s37, s37, 6029312
    v_and_b32 v13, 1, v1
    v_lshlrev_b32 v13, 13, v13
    v_lshrrev_b32 v14, 1, v1
    v_lshl_add_u32 v13, v14, 22, v13
    s_mov_b64 exec, 0xf
    buffer_store_dword v12, v13, s[56:59], s37 offen sc1
    s_cmp_lg_u32 s28, 0
    s_cbranch_scc1 FB_n2
    s_add_u32 s37, s53, 23117824
    s_mov_b64 exec, 1
    buffer_store_dword v12, v13, s[56:59], s37 offen sc1
FB_n2:
    s_mov_b64 exec, -1
    v_mov_b32 v16, 1
    v_mov_b32 v17, 0
    v_mov_b32 v18, 0
    v_mov_b32 v19, 0
    s_lshr_b32 s36, s2, 7
    s_lshl_b32 s36, s36, 24
    s_add_u32 s36, s36, 167772160
    s_add_u32 s20, s4, s36
    s_addc_u32 s21, s5, 0
    s_mov_b32 s22, 8388608
    s_mov_b32 s23, 0x20000
    s_and_b32 s36, s2, 127
    s_mul_i32 s36, s36, 65536
    s_add_u32 s36, s36, 16352
    v_and_b32 v13, 1, v1
    v_lshlrev_b32 v13, 4, v13
    v_bfe_u32 v14, v1, 1, 1
    v_lshl_add_u32 v13, v14, 13, v13
    v_bfe_u32 v14, v1, 2, 1
    v_mul_u32_u24 v14, 32800, v14
    v_add_u32 v13, v13, v14
    s_mov_b64 exec, 0xff
    buffer_store_dwordx4 v[16:19], v13, s[20:23], s36 offen sc1
    s_mov_b64 exec, -1
FB_ni:
    v_mov_b32 v6, 162836
spin_7:
    s_sleep 2
    ds_read_b32 v7, v6
    s_waitcnt lgkmcnt(0)
    v_readfirstlane_b32 s53, v7
    s_nop 0
    s_cmp_ge_u32 s53, 4
    s_cbranch_scc0 spin_7
    s_load_dwordx2 s[48:49], s[0:1], 64
    s_lshl_b32 s45, s2, 1
    s_and_b32 s50, s30, 1
    s_add_u32 s45, s45, s50
    s_mul_i32 s45, s45, 4096
    s_mov_b32 s50, 2097152
    s_mov_b32 s51, 0x20000
    s_waitcnt lgkmcnt(0)
    buffer_load_dwordx4 v[20:23], v2, s[48:51], s45 offen offset:0
    buffer_load_dwordx4 v[20:23], v2, s[48:51], s45 offen offset:1024
    buffer_load_dwordx4 v[20:23], v2, s[48:51], s45 offen offset:2048
    buffer_load_dwordx4 v[20:23], v2, s[48:51], s45 offen offset:3072
    s_and_b32 s36, s2, 7
    s_lshl_b32 s36, s36, 7
    s_add_u32 s36, s36, 23101440
    v_mov_b32 v6, 1
    v_mov_b32 v7, 162820
    v_lshlrev_b32 v9, 10, v1
    s_mov_b64 exec, 1
    s_waitcnt vmcnt(0)
    s_waitcnt lgkmcnt(0)
    ds_add_rtn_u32 v8, v7, v6
    ds_read_b32 v10, v7 offset:28
    s_waitcnt lgkmcnt(0)
    v_readfirstlane_b32 s54, v8
    v_readfirstlane_b32 s53, v10
    s_cmp_lg_u32 s54, 15
    s_cbranch_scc1 fa_8
    s_mov_b64 exec, 0xffff
    s_or_b32 s53, s53, 1
    v_mov_b32 v6, s53
    buffer_atomic_add v6, v9, s[56:59], s36 offen sc1
fa_8:
    s_mov_b64 exec, -1
    v_bfe_u32 v252, v251, 2, 2
    v_lshlrev_b32 v248, 14, v252
    v_and_b32 v252, 3, v251
    v_lshl_add_u32 v248, v252, 11, v248
    v_bfe_u32 v252, v251, 7, 3
    v_lshlrev_b32 v249, 14, v252
    v_bfe_u32 v252, v251, 4, 3
    v_lshl_add_u32 v249, v252, 10, v249
    v_bfe_u32 v252, v251, 13, 3
    v_lshlrev_b32 v250, 14, v252
    v_bfe_u32 v252, v251, 10, 3
    v_lshl_add_u32 v250, v252, 10, v250
    v_mov_b32 v6, 162840
spin_9:
    s_sleep 4
    ds_read_b32 v7, v6
    s_waitcnt lgkmcnt(0)
    v_readfirstlane_b32 s53, v7
    s_nop 0
    s_cmp_ge_u32 s53, 2
    s_cbranch_scc0 spin_9
    s_call_b64 s[76:77], SUB_w1_regs
    s_call_b64 s[76:77], SUB_park
    v_mov_b32 v6, 162840
spin_10:
    s_sleep 3
    ds_read_b32 v7, v6
    s_waitcnt lgkmcnt(0)
    v_readfirstlane_b32 s53, v7
    s_nop 0
    s_cmp_ge_u32 s53, 4
    s_cbranch_scc0 spin_10
    s_mov_b64 s[12:13], s[68:69]
    s_mov_b32 s14, 2097152
    s_mov_b32 s15, 0x20000
    s_and_b32 s35, s30, 1
    s_mul_i32 s38, s99, 128
    s_mul_i32 s41, s35, 65536
    s_add_u32 s38, s38, s41
    s_mul_i32 s41, s35, 4096
    s_add_u32 s41, s41, 24576
    s_mov_b32 s42, 0
    s_mov_b32 s44, s67
    s_mov_b32 s42, 73728
    s_mov_b32 s44, s67
    s_add_u32 s44, s44, 9
    s_and_b32 s44, s44, 15
    s_call_b64 s[76:77], SUB_w_issue_1
    s_waitcnt vmcnt(8)
    s_mov_b32 s42, 81920
    s_mov_b32 s44, s67
    s_add_u32 s44, s44, 10
    s_and_b32 s44, s44, 15
    s_call_b64 s[76:77], SUB_w_issue_1
    s_waitcnt vmcnt(8)
    s_mov_b32 s42, 90112
    s_mov_b32 s44, s67
    s_add_u32 s44, s44, 11
    s_and_b32 s44, s44, 15
    s_call_b64 s[76:77], SUB_w_issue_1
    s_waitcnt vmcnt(8)
    s_call_b64 s[76:77], SUB_w1_put
    s_branch FR_end
FB_cs:
    v_and_b32 v164, 15, v1
    v_mov_b32 v165, 0x3f803f80
    v_cmp_eq_u32 vcc, 0, v164
    s_nop 1
    v_cndmask_b32 v16, 0, v165, vcc
    v_cndmask_b32 v17, 0, v165, vcc
    v_cndmask_b32 v18, 0, v165, vcc
    v_cndmask_b32 v19, 0, v165, vcc
    v_cmp_eq_u32 vcc, 1, v164
    s_nop 1
    v_cndmask_b32 v20, 0, v165, vcc
    v_cndmask_b32 v21, 0, v165, vcc
    v_cndmask_b32 v22, 0, v165, vcc
    v_cndmask_b32 v23, 0, v165, vcc
    v_cmp_eq_u32 vcc, 2, v164
    s_nop 1
    v_cndmask_b32 v24, 0, v165, vcc
    v_cndmask_b32 v25, 0, v165, vcc
    v_cndmask_b32 v26, 0, v165, vcc
    v_cndmask_b32 v27, 0, v165, vcc
    v_cmp_eq_u32 vcc, 3, v164
    s_nop 1
    v_cndmask_b32 v28, 0, v165, vcc
    v_cndmask_b32 v29, 0, v165, vcc
    v_cndmask_b32 v30, 0, v165, vcc
    v_cndmask_b32 v31, 0, v165, vcc
    v_cmp_eq_u32 vcc, 4, v164
    s_nop 1
    v_cndmask_b32 v32, 0, v165, vcc
    v_cndmask_b32 v33, 0, v165, vcc
    v_cndmask_b32 v34, 0, v165, vcc
    v_cndmask_b32 v35, 0, v165, vcc
    v_cmp_eq_u32 vcc, 5, v164
    s_nop 1
    v_cndmask_b32 v36, 0, v165, vcc
    v_cndmask_b32 v37, 0, v165, vcc
    v_cndmask_b32 v38, 0, v165, vcc
    v_cndmask_b32 v39, 0, v165, vcc
    v_cmp_eq_u32 vcc, 6, v164
    s_nop 1
    v_cndmask_b32 v40, 0, v165, vcc
    v_cndmask_b32 v41, 0, v165, vcc
    v_cndmask_b32 v42, 0, v165, vcc
    v_cndmask_b32 v43, 0, v165, vcc
    v_cmp_eq_u32 vcc, 7, v164
    s_nop 1
    v_cndmask_b32 v44, 0, v165, vcc
    v_cndmask_b32 v45, 0, v165, vcc
    v_cndmask_b32 v46, 0, v165, vcc
    v_cndmask_b32 v47, 0, v165, vcc
    v_cmp_eq_u32 vcc, 8, v164
    s_nop 1
    v_cndmask_b32 v48, 0, v165, vcc
    v_cndmask_b32 v49, 0, v165, vcc
    v_cndmask_b32 v50, 0, v165, vcc
    v_cndmask_b32 v51, 0, v165, vcc
    v_cmp_eq_u32 vcc, 9, v164
    s_nop 1
    v_cndmask_b32 v52, 0, v165, vcc
    v_cndmask_b32 v53, 0, v165, vcc
    v_cndmask_b32 v54, 0, v165, vcc
    v_cndmask_b32 v55, 0, v165, vcc
    v_cmp_eq_u32 vcc, 10, v164
    s_nop 1
    v_cndmask_b32 v56, 0, v165, vcc
    v_cndmask_b32 v57, 0, v165, vcc
    v_cndmask_b32 v58, 0, v165, vcc
    v_cndmask_b32 v59, 0, v165, vcc
    v_cmp_eq_u32 vcc, 11, v164
    s_nop 1
    v_cndmask_b32 v60, 0, v165, vcc
    v_cndmask_b32 v61, 0, v165, vcc
    v_cndmask_b32 v62, 0, v165, vcc
    v_cndmask_b32 v63, 0, v165, vcc
    v_cmp_eq_u32 vcc, 12, v164
    s_nop 1
    v_cndmask_b32 v64, 0, v165, vcc
    v_cndmask_b32 v65, 0, v165, vcc
    v_cndmask_b32 v66, 0, v165, vcc
    v_cndmask_b32 v67, 0, v165, vcc
    v_cmp_eq_u32 vcc, 13, v164
    s_nop 1
    v_cndmask_b32 v68, 0, v165, vcc
    v_cndmask_b32 v69, 0, v165, vcc
    v_cndmask_b32 v70, 0, v165, vcc
    v_cndmask_b32 v71, 0, v165, vcc
    s_mov_b32 s35, 0
    v_lshrrev_b32 v253, 2, v1
    v_mul_u32_u24 v144, 128, v253
    v_and_b32 v254, 3, v1
    v_lshl_add_u32 v144, v254, 3, v144
    v_add_u32 v144, 24576, v144
    v_bfe_u32 v253, v253, 1, 2
    s_mul_i32 s36, s35, 4
    s_add_u32 s36, s36, 3
    v_xor_b32 v254, s36, v253
    v_lshl_add_u32 v147, v254, 5, v144
    s_mul_i32 s36, s35, 4
    s_add_u32 s36, s36, 2
    v_xor_b32 v254, s36, v253
    v_lshl_add_u32 v146, v254, 5, v144
    s_mul_i32 s36, s35, 4
    s_add_u32 s36, s36, 1
    v_xor_b32 v254, s36, v253
    v_lshl_add_u32 v145, v254, 5, v144
    s_mul_i32 s36, s35, 4
    s_add_u32 s36, s36, 0
    v_xor_b32 v254, s36, v253
    v_lshl_add_u32 v144, v254, 5, v144
    s_and_b32 s35, s30, 1
    s_mul_i32 s35, s35, 4096
    s_add_u32 s35, s35, 73728
    v_add_u32 v144, s35, v144
    v_add_u32 v145, s35, v145
    v_add_u32 v146, s35, v146
    v_add_u32 v147, s35, v147
    s_mov_b32 s35, 0
    v_lshrrev_b32 v253, 2, v1
    v_mul_u32_u24 v148, 448, v253
    v_and_b32 v254, 3, v1
    v_lshl_add_u32 v148, v254, 3, v148
    v_add_u32 v148, 73728, v148
    s_mul_i32 s36, s35, 224
    v_add_u32 v148, s36, v148
    v_bfe_u32 v253, v1, 4, 1
    v_lshlrev_b32 v253, 5, v253
    s_cmp_eq_u32 s35, 0
    s_cselect_b32 s36, 1, -1
    v_mul_lo_u32 v253, v253, s36
    v_sub_u32 v149, v148, v253
    v_add_u32 v148, v148, v253
    s_and_b32 s35, s30, 1
    s_mul_i32 s35, s35, 14336
    s_add_u32 s35, s35, 32768
    v_add_u32 v148, s35, v148
    v_add_u32 v149, s35, v149
    s_mov_b32 s35, 1
    v_lshrrev_b32 v253, 2, v1
    v_mul_u32_u24 v150, 448, v253
    v_and_b32 v254, 3, v1
    v_lshl_add_u32 v150, v254, 3, v150
    v_add_u32 v150, 73728, v150
    s_mul_i32 s36, s35, 224
    v_add_u32 v150, s36, v150
    v_bfe_u32 v253, v1, 4, 1
    v_lshlrev_b32 v253, 5, v253
    s_cmp_eq_u32 s35, 0
    s_cselect_b32 s36, 1, -1
    v_mul_lo_u32 v253, v253, s36
    v_sub_u32 v151, v150, v253
    v_add_u32 v150, v150, v253
    s_and_b32 s35, s30, 1
    s_mul_i32 s35, s35, 14336
    s_add_u32 s35, s35, 32768
    v_add_u32 v150, s35, v150
    v_add_u32 v151, s35, v151
    v_mov_b32 v156, 0
    v_mov_b32 v157, 0
    v_mov_b32 v158, 0
    v_mov_b32 v159, 0
    v_mov_b32 v160, 0
    v_mov_b32 v161, 0
    v_mov_b32 v162, 0
    v_mov_b32 v163, 0
    v_lshrrev_b32 v166, 4, v1
    v_lshlrev_b32 v166, 4, v166
    v_lshl_add_u32 v166, v164, 6, v166
    v_mov_b32 v165, 0x7f000000
    v_cmp_gt_u32 vcc, 4, v164
    s_nop 1
    v_cndmask_b32 v167, v165, v166, vcc
    v_cmp_gt_u32 vcc, 14, v164
    s_nop 1
    v_cndmask_b32 v168, v165, v166, vcc
    v_mov_b32 v6, 162836
spin_11:
    s_sleep 2
    ds_read_b32 v7, v6
    s_waitcnt lgkmcnt(0)
    v_readfirstlane_b32 s53, v7
    s_nop 0
    s_cmp_ge_u32 s53, 4
    s_cbranch_scc0 spin_11
    s_mov_b64 s[12:13], s[68:69]
    s_mov_b32 s14, 2097152
    s_mov_b32 s15, 0x20000
    s_and_b32 s35, s30, 1
    s_mul_i32 s38, s99, 128
    s_mul_i32 s41, s35, 65536
    s_add_u32 s38, s38, s41
    s_mul_i32 s41, s35, 4096
    s_add_u32 s41, s41, 24576
    s_mov_b32 s42, 0
    s_mov_b32 s44, s67
    s_mov_b32 s42, 73728
    s_mov_b32 s44, s28
    s_add_u32 s19, s41, s42
    s_mul_i32 s16, s44, 131072
    s_add_u32 s16, s16, s38
    s_add_u32 s44, s44, 1
    s_and_b32 s44, s44, 15
    s_add_u32 s42, s42, 8192
    s_cmp_eq_u32 s42, 131072
    s_cselect_b32 s42, 0, s42
    s_mov_b32 m0, s19
    s_mov_b32 s39, s16
    buffer_load_dwordx4 v238, s[12:15], s39 offen lds
    s_add_u32 m0, m0, 1024
    s_add_u32 s39, s39, 16384
    buffer_load_dwordx4 v238, s[12:15], s39 offen lds
    s_add_u32 m0, m0, 1024
    s_add_u32 s39, s39, 16384
    buffer_load_dwordx4 v238, s[12:15], s39 offen lds
    s_add_u32 m0, m0, 1024
    s_add_u32 s39, s39, 16384
    buffer_load_dwordx4 v238, s[12:15], s39 offen lds
    s_mov_b64 s[12:13], s[72:73]
    s_mov_b32 s14, 7340032
    s_mov_b32 s15, 0x20000
    s_and_b32 s35, s30, 1
    s_mul_i32 s38, s29, 448
    s_mul_i32 s41, s35, 229376
    s_add_u32 s38, s38, s41
    s_mul_i32 s41, s35, 14336
    s_add_u32 s41, s41, 73728
    s_mov_b32 s42, 0
    s_mov_b32 s44, 0
    s_mov_b32 s42, 32768
    s_mov_b32 s44, s28
    s_add_u32 s19, s41, s42
    s_mul_i32 s16, s44, 458752
    s_add_u32 s16, s16, s38
    s_add_u32 s44, s44, 1
    s_and_b32 s44, s44, 15
    s_add_u32 s42, s42, 28672
    s_cmp_eq_u32 s42, 86016
    s_cselect_b32 s42, 0, s42
    s_mov_b32 m0, s19
    s_mov_b32 s39, s16
    buffer_load_dwordx4 v241, s[12:15], s39 offen lds
    s_add_u32 m0, m0, 1024
    s_nop 0
    buffer_load_dwordx4 v242, s[12:15], s39 offen lds
    s_add_u32 m0, m0, 1024
    s_nop 0
    buffer_load_dwordx4 v243, s[12:15], s39 offen lds
    s_add_u32 m0, m0, 1024
    s_nop 0
    buffer_load_dwordx4 v244, s[12:15], s39 offen lds
    s_add_u32 m0, m0, 1024
    s_nop 0
    buffer_load_dwordx4 v245, s[12:15], s39 offen lds
    s_add_u32 m0, m0, 1024
    s_nop 0
    buffer_load_dwordx4 v246, s[12:15], s39 offen lds
    s_add_u32 m0, m0, 1024
    s_nop 0
    buffer_load_dwordx4 v247, s[12:15], s39 offen lds
    s_add_u32 m0, m0, 1024
    s_add_u32 s39, s39, 114688
    buffer_load_dwordx4 v241, s[12:15], s39 offen lds
    s_add_u32 m0, m0, 1024
    s_nop 0
    buffer_load_dwordx4 v242, s[12:15], s39 offen lds
    s_add_u32 m0, m0, 1024
    s_nop 0
    buffer_load_dwordx4 v243, s[12:15], s39 offen lds
    s_add_u32 m0, m0, 1024
    s_nop 0
    buffer_load_dwordx4 v244, s[12:15], s39 offen lds
    s_add_u32 m0, m0, 1024
    s_nop 0
    buffer_load_dwordx4 v245, s[12:15], s39 offen lds
    s_add_u32 m0, m0, 1024
    s_nop 0
    buffer_load_dwordx4 v246, s[12:15], s39 offen lds
    s_add_u32 m0, m0, 1024
    s_nop 0
    buffer_load_dwordx4 v247, s[12:15], s39 offen lds
    s_waitcnt vmcnt(14)
    s_setprio 1
    ds_read_b64_tr_b16 v[128:129], v144 offset:0
    ds_read_b64_tr_b16 v[130:131], v144 offset:2048
    ds_read_b64_tr_b16 v[132:133], v145 offset:0
    ds_read_b64_tr_b16 v[134:135], v145 offset:2048
    ds_read_b64_tr_b16 v[136:137], v146 offset:0
    ds_read_b64_tr_b16 v[138:139], v146 offset:2048
    ds_read_b64_tr_b16 v[140:141], v147 offset:0
    ds_read_b64_tr_b16 v[142:143], v147 offset:2048
    s_add_u32 s20, s4, 0x1400000
    s_addc_u32 s21, s5, 0
    s_mov_b32 s22, 0x20000
    s_mov_b32 s23, 0x20000
    s_lshl_b32 s35, s28, 1
    s_and_b32 s36, s30, 1
    s_add_u32 s35, s35, s36
    s_mul_i32 s35, s35, 4096
    s_mul_i32 s36, s29, 256
    s_add_u32 s35, s35, s36
    s_waitcnt lgkmcnt(0)
    v_mfma_f32_16x16x32_bf16 v[160:163], v[128:131], v[16:19], v[160:163]
    v_mfma_f32_16x16x32_bf16 v[160:163], v[132:135], v[20:23], v[160:163]
    v_mfma_f32_16x16x32_bf16 v[160:163], v[136:139], v[24:27], v[160:163]
    v_mfma_f32_16x16x32_bf16 v[160:163], v[140:143], v[28:31], v[160:163]
    s_nop 7
    buffer_store_dwordx4 v[160:163], v167, s[20:23], s35 offen sc1
    s_waitcnt vmcnt(1)
    v_mov_b32 v6, 162840
    v_mov_b32 v7, 1
    s_mov_b64 exec, 1
    ds_add_u32 v6, v7
    s_mov_b64 exec, -1
    ds_read_b64_tr_b16 v[72:73], v148 offset:0
    ds_read_b64_tr_b16 v[74:75], v148 offset:7168
    ds_read_b64_tr_b16 v[76:77], v149 offset:32
    ds_read_b64_tr_b16 v[78:79], v149 offset:7200
    ds_read_b64_tr_b16 v[80:81], v148 offset:64
    ds_read_b64_tr_b16 v[82:83], v148 offset:7232
    ds_read_b64_tr_b16 v[84:85], v149 offset:96
    ds_read_b64_tr_b16 v[86:87], v149 offset:7264
    ds_read_b64_tr_b16 v[88:89], v148 offset:128
    ds_read_b64_tr_b16 v[90:91], v148 offset:7296
    ds_read_b64_tr_b16 v[92:93], v149 offset:160
    ds_read_b64_tr_b16 v[94:95], v149 offset:7328
    ds_read_b64_tr_b16 v[96:97], v148 offset:192
    ds_read_b64_tr_b16 v[98:99], v148 offset:7360
    ds_read_b64_tr_b16 v[100:101], v150 offset:0
    ds_read_b64_tr_b16 v[102:103], v150 offset:7168
    ds_read_b64_tr_b16 v[104:105], v151 offset:32
    ds_read_b64_tr_b16 v[106:107], v151 offset:7200
    ds_read_b64_tr_b16 v[108:109], v150 offset:64
    ds_read_b64_tr_b16 v[110:111], v150 offset:7232
    ds_read_b64_tr_b16 v[112:113], v151 offset:96
    ds_read_b64_tr_b16 v[114:115], v151 offset:7264
    ds_read_b64_tr_b16 v[116:117], v150 offset:128
    ds_read_b64_tr_b16 v[118:119], v150 offset:7296
    ds_read_b64_tr_b16 v[120:121], v151 offset:160
    ds_read_b64_tr_b16 v[122:123], v151 offset:7328
    ds_read_b64_tr_b16 v[124:125], v150 offset:192
    ds_read_b64_tr_b16 v[126:127], v150 offset:7360
    s_add_u32 s20, s4, 0x1420000
    s_addc_u32 s21, s5, 0
    s_mov_b32 s22, 0x70000
    s_mov_b32 s23, 0x20000
    s_lshl_b32 s35, s28, 1
    s_and_b32 s36, s30, 1
    s_add_u32 s35, s35, s36
    s_mul_i32 s35, s35, 14336
    s_mul_i32 s36, s29, 896
    s_add_u32 s35, s35, s36
    s_waitcnt lgkmcnt(0)
    v_mfma_f32_16x16x32_bf16 v[156:159], v[72:75], v[16:19], v[156:159]
    v_mfma_f32_16x16x32_bf16 v[156:159], v[76:79], v[20:23], v[156:159]
    v_mfma_f32_16x16x32_bf16 v[156:159], v[80:83], v[24:27], v[156:159]
    v_mfma_f32_16x16x32_bf16 v[156:159], v[84:87], v[28:31], v[156:159]
    v_mfma_f32_16x16x32_bf16 v[156:159], v[88:91], v[32:35], v[156:159]
    v_mfma_f32_16x16x32_bf16 v[156:159], v[92:95], v[36:39], v[156:159]
    v_mfma_f32_16x16x32_bf16 v[156:159], v[96:99], v[40:43], v[156:159]
    v_mfma_f32_16x16x32_bf16 v[156:159], v[100:103], v[44:47], v[156:159]
    v_mfma_f32_16x16x32_bf16 v[156:159], v[104:107], v[48:51], v[156:159]
    v_mfma_f32_16x16x32_bf16 v[156:159], v[108:111], v[52:55], v[156:159]
    v_mfma_f32_16x16x32_bf16 v[156:159], v[112:115], v[56:59], v[156:159]
    v_mfma_f32_16x16x32_bf16 v[156:159], v[116:119], v[60:63], v[156:159]
    v_mfma_f32_16x16x32_bf16 v[156:159], v[120:123], v[64:67], v[156:159]
    v_mfma_f32_16x16x32_bf16 v[156:159], v[124:127], v[68:71], v[156:159]
    s_nop 7
    buffer_store_dwordx4 v[156:159], v168, s[20:23], s35 offen sc1
    s_and_b32 s36, s2, 7
    s_lshl_b32 s36, s36, 7
    s_add_u32 s36, s36, 23101440
    v_mov_b32 v6, 1
    v_mov_b32 v7, 162820
    v_lshlrev_b32 v9, 10, v1
    s_mov_b64 exec, 1
    s_waitcnt lgkmcnt(0)
    ds_add_rtn_u32 v8, v7, v6
    ds_read_b32 v10, v7 offset:28
    s_waitcnt lgkmcnt(0)
    v_readfirstlane_b32 s54, v8
    v_readfirstlane_b32 s53, v10
    s_cmp_lg_u32 s54, 15
    s_cbranch_scc1 fa_12
    s_mov_b64 exec, 0xffff
    s_or_b32 s53, s53, 1
    v_mov_b32 v6, s53
    buffer_atomic_add v6, v9, s[56:59], s36 offen sc1
fa_12:
    s_mov_b64 exec, -1
    v_and_b32 v252, 15, v251
    v_mul_u32_u24 v248, 458752, v252
    s_and_b32 s36, s30, 1
    s_mul_i32 s36, s36, 6
    s_add_u32 s36, s36, 4
    v_bfe_u32 v252, v251, s36, 6
    v_mul_u32_u24 v250, 37, v252
    v_lshrrev_b32 v250, 8, v250
    v_mul_u32_u24 v250, 7, v250
    v_sub_u32 v250, v252, v250
    v_cmp_eq_u32 vcc, 3, v250
    s_nop 1
    v_cndmask_b32 v250, 0, 1, vcc
    v_lshl_add_u32 v249, v252, 16, v250
    v_mov_b32 v6, 162840
    v_mov_b32 v7, 1
    s_mov_b64 exec, 1
    ds_add_u32 v6, v7
    s_mov_b64 exec, -1
    s_setprio 0
    s_call_b64 s[76:77], SUB_w1_regs
    s_call_b64 s[76:77], SUB_park
    v_mov_b32 v6, 162840
spin_13:
    s_sleep 3
    ds_read_b32 v7, v6
    s_waitcnt lgkmcnt(0)
    v_readfirstlane_b32 s53, v7
    s_nop 0
    s_cmp_ge_u32 s53, 4
    s_cbranch_scc0 spin_13
    s_mov_b64 s[12:13], s[68:69]
    s_mov_b32 s14, 2097152
    s_mov_b32 s15, 0x20000
    s_and_b32 s35, s30, 1
    s_mul_i32 s38, s99, 128
    s_mul_i32 s41, s35, 65536
    s_add_u32 s38, s38, s41
    s_mul_i32 s41, s35, 4096
    s_add_u32 s41, s41, 24576
    s_mov_b32 s42, 0
    s_mov_b32 s44, s67
    s_mov_b32 s42, 98304
    s_mov_b32 s44, s67
    s_add_u32 s44, s44, 12
    s_and_b32 s44, s44, 15
    s_call_b64 s[76:77], SUB_w_issue_1
    s_waitcnt vmcnt(8)
    s_mov_b32 s42, 106496
    s_mov_b32 s44, s67
    s_add_u32 s44, s44, 13
    s_and_b32 s44, s44, 15
    s_call_b64 s[76:77], SUB_w_issue_1
    s_waitcnt vmcnt(8)
    s_mov_b32 s42, 114688
    s_mov_b32 s44, s67
    s_add_u32 s44, s44, 14
    s_and_b32 s44, s44, 15
    s_call_b64 s[76:77], SUB_w_issue_1
    s_waitcnt vmcnt(8)
    s_mov_b32 s42, 122880
    s_mov_b32 s44, s67
    s_add_u32 s44, s44, 15
    s_and_b32 s44, s44, 15
    s_call_b64 s[76:77], SUB_w_issue_1
    s_waitcnt vmcnt(8)
    s_call_b64 s[76:77], SUB_w1_put
FR_end:
LAYER:
    v_lshlrev_b32 v40, 6, v199
    v_add_u32 v40, 161792, v40
    s_lshl_b32 s35, s30, 3
    v_add_u32 v39, s35, v40
    s_cmp_eq_u32 s60, 0
    s_cbranch_scc1 R_l0
    s_sub_u32 s8, s62, 0x400000
    s_subb_u32 s9, s63, 0
    s_mov_b32 s10, 0x7e000
    s_mov_b32 s11, 0x20000
    s_sub_u32 s12, s62, 0x380000
    s_subb_u32 s13, s63, 0
    s_mov_b32 s14, 0x7e000
    s_mov_b32 s15, 0x20000
    s_mov_b32 s20, s62
    s_mov_b32 s21, s63
    s_mov_b32 s22, 0x7e000
    s_mov_b32 s23, 0x20000
    s_mov_b32 s78, 0x3f80
    s_mov_b32 s79, 0x3f800000
    v_lshlrev_b32 v222, 16, v230
    v_and_b32 v223, 0xffff0000, v230
    v_lshlrev_b32 v206, 16, v180
    v_and_b32 v207, 0xffff0000, v180
    v_lshlrev_b32 v12, 16, v188
    v_and_b32 v13, 0xffff0000, v188
    v_pk_add_f32 v[206:207], v[206:207], v[12:13]
    v_lshlrev_b32 v224, 16, v231
    v_and_b32 v225, 0xffff0000, v231
    v_lshlrev_b32 v208, 16, v181
    v_and_b32 v209, 0xffff0000, v181
    v_lshlrev_b32 v14, 16, v189
    v_and_b32 v15, 0xffff0000, v189
    v_pk_add_f32 v[208:209], v[208:209], v[14:15]
    v_lshlrev_b32 v226, 16, v232
    v_and_b32 v227, 0xffff0000, v232
    v_lshlrev_b32 v210, 16, v182
    v_and_b32 v211, 0xffff0000, v182
    v_lshlrev_b32 v16, 16, v190
    v_and_b32 v17, 0xffff0000, v190
    v_pk_add_f32 v[210:211], v[210:211], v[16:17]
    v_lshlrev_b32 v228, 16, v233
    v_and_b32 v229, 0xffff0000, v233
    v_lshlrev_b32 v212, 16, v183
    v_and_b32 v213, 0xffff0000, v183
    v_lshlrev_b32 v18, 16, v191
    v_and_b32 v19, 0xffff0000, v191
    v_pk_add_f32 v[212:213], v[212:213], v[18:19]
    v_lshlrev_b32 v230, 16, v234
    v_and_b32 v231, 0xffff0000, v234
    v_lshlrev_b32 v214, 16, v184
    v_and_b32 v215, 0xffff0000, v184
    v_lshlrev_b32 v20, 16, v192
    v_and_b32 v21, 0xffff0000, v192
    v_pk_add_f32 v[214:215], v[214:215], v[20:21]
    v_lshlrev_b32 v232, 16, v235
    v_and_b32 v233, 0xffff0000, v235
    v_lshlrev_b32 v216, 16, v185
    v_and_b32 v217, 0xffff0000, v185
    v_lshlrev_b32 v22, 16, v193
    v_and_b32 v23, 0xffff0000, v193
    v_pk_add_f32 v[216:217], v[216:217], v[22:23]
    v_lshlrev_b32 v234, 16, v236
    v_and_b32 v235, 0xffff0000, v236
    v_lshlrev_b32 v218, 16, v186
    v_and_b32 v219, 0xffff0000, v186
    v_lshlrev_b32 v24, 16, v194
    v_and_b32 v25, 0xffff0000, v194
    v_pk_add_f32 v[218:219], v[218:219], v[24:25]
    v_lshlrev_b32 v236, 16, v237
    v_and_b32 v237, 0xffff0000, v237
    v_lshlrev_b32 v220, 16, v187
    v_and_b32 v221, 0xffff0000, v187
    v_lshlrev_b32 v26, 16, v195
    v_and_b32 v27, 0xffff0000, v195
    v_pk_add_f32 v[220:221], v[220:221], v[26:27]
    s_mov_b32 s53, 0
    s_sleep 10
    s_cmp_ge_u32 s30, 6
    s_cbranch_scc1 dp_14
    s_sleep 14
dp_14:
    buffer_load_dwordx4 v[180:183], v196, s[8:11], 0 offen offset:0 sc1
    buffer_load_dwordx4 v[188:191], v196, s[12:15], 0 offen offset:0 sc1
    buffer_load_dwordx4 v[184:187], v196, s[8:11], 0 offen offset:2048 sc1
    buffer_load_dwordx4 v[192:195], v196, s[12:15], 0 offen offset:2048 sc1
    s_waitcnt vmcnt(0)
    v_bitop3_b32 v6, v180, v184, v188 bitop3:0x80
    v_bitop3_b32 v6, v6, v192, 1 bitop3:0x80
    v_cmp_eq_u32 vcc, 0, v6
    s_cbranch_vccz dq_15
    s_sleep 4
    s_add_u32 s53, s53, 1
    s_cmp_lt_u32 s53, s61
    s_cbranch_scc1 dp_14
    s_mov_b32 s61, 0
dq_15:
    v_dot2_f32_bf16 v206, v180, s78, v206
    v_dot2_f32_bf16 v207, v180, s79, v207
    v_dot2_f32_bf16 v208, v181, s78, v208
    v_dot2_f32_bf16 v209, v181, s79, v209
    v_dot2_f32_bf16 v210, v182, s78, v210
    v_dot2_f32_bf16 v211, v182, s79, v211
    v_dot2_f32_bf16 v212, v183, s78, v212
    v_dot2_f32_bf16 v213, v183, s79, v213
    v_dot2_f32_bf16 v214, v184, s78, v214
    v_dot2_f32_bf16 v215, v184, s79, v215
    v_dot2_f32_bf16 v216, v185, s78, v216
    v_dot2_f32_bf16 v217, v185, s79, v217
    v_dot2_f32_bf16 v218, v186, s78, v218
    v_dot2_f32_bf16 v219, v186, s79, v219
    v_dot2_f32_bf16 v220, v187, s78, v220
    v_dot2_f32_bf16 v221, v187, s79, v221
    v_dot2_f32_bf16 v206, v188, s78, v206
    v_dot2_f32_bf16 v207, v188, s79, v207
    v_dot2_f32_bf16 v208, v189, s78, v208
    v_dot2_f32_bf16 v209, v189, s79, v209
    v_dot2_f32_bf16 v210, v190, s78, v210
    v_dot2_f32_bf16 v211, v190, s79, v211
    v_dot2_f32_bf16 v212, v191, s78, v212
    v_dot2_f32_bf16 v213, v191, s79, v213
    v_dot2_f32_bf16 v214, v192, s78, v214
    v_dot2_f32_bf16 v215, v192, s79, v215
    v_dot2_f32_bf16 v216, v193, s78, v216
    v_dot2_f32_bf16 v217, v193, s79, v217
    v_dot2_f32_bf16 v218, v194, s78, v218
    v_dot2_f32_bf16 v219, v194, s79, v219
    v_dot2_f32_bf16 v220, v195, s78, v220
    v_dot2_f32_bf16 v221, v195, s79, v221
    s_nop 2
    v_pk_add_f32 v[32:33], v[206:207], v[208:209]
    v_pk_mul_f32 v[34:35], v[206:207], v[206:207]
    v_pk_fma_f32 v[34:35], v[208:209], v[208:209], v[34:35]
    v_pk_add_f32 v[32:33], v[32:33], v[210:211]
    v_pk_fma_f32 v[34:35], v[210:211], v[210:211], v[34:35]
    v_pk_add_f32 v[32:33], v[32:33], v[212:213]
    v_pk_fma_f32 v[34:35], v[212:213], v[212:213], v[34:35]
    v_pk_add_f32 v[32:33], v[32:33], v[214:215]
    v_pk_fma_f32 v[34:35], v[214:215], v[214:215], v[34:35]
    v_pk_add_f32 v[32:33], v[32:33], v[216:217]
    v_pk_fma_f32 v[34:35], v[216:217], v[216:217], v[34:35]
    v_pk_add_f32 v[32:33], v[32:33], v[218:219]
    v_pk_fma_f32 v[34:35], v[218:219], v[218:219], v[34:35]
    v_pk_add_f32 v[32:33], v[32:33], v[220:221]
    v_pk_fma_f32 v[34:35], v[220:221], v[220:221], v[34:35]
    v_add_f32 v30, v32, v33
    v_add_f32 v31, v34, v35
    s_nop 0
    v_add_f32_dpp v30, v30, v30 row_ror:8 row_mask:0xf bank_mask:0xf
    v_add_f32_dpp v31, v31, v31 row_ror:8 row_mask:0xf bank_mask:0xf
    v_mov_b32 v32, v30
    v_mov_b32 v33, v31
    s_nop 0
    v_permlane16_swap_b32 v30, v32
    v_permlane16_swap_b32 v31, v33
    v_pk_add_f32 v[30:31], v[30:31], v[32:33]
    v_mov_b32 v32, v30
    v_mov_b32 v33, v31
    s_nop 0
    v_permlane32_swap_b32 v30, v32
    v_permlane32_swap_b32 v31, v33
    v_pk_add_f32 v[30:31], v[30:31], v[32:33]
    ds_write_b64 v39, v[30:31] offset:0
    s_waitcnt lgkmcnt(0)
    s_barrier
    ds_read_b128 v[12:15], v40 offset:0
    ds_read_b128 v[16:19], v40 offset:16
    ds_read_b128 v[20:23], v40 offset:32
    ds_read_b128 v[24:27], v40 offset:48
    s_waitcnt lgkmcnt(0)
    v_pk_add_f32 v[12:13], v[12:13], v[14:15]
    v_pk_add_f32 v[16:17], v[16:17], v[18:19]
    v_pk_add_f32 v[20:21], v[20:21], v[22:23]
    v_pk_add_f32 v[24:25], v[24:25], v[26:27]
    v_pk_add_f32 v[12:13], v[12:13], v[16:17]
    v_pk_add_f32 v[20:21], v[20:21], v[24:25]
    v_pk_add_f32 v[12:13], v[12:13], v[20:21]
    v_mul_f32 v36, 0x3a800000, v12
    v_mul_f32 v38, 0x3a800000, v13
    v_fma_f32 v38, -v36, v36, v38
    v_max_f32 v38, 0, v38
    v_add_f32 v38, 0x3727c5ac, v38
    v_rsq_f32 v37, v38
    s_nop 0
    v_mul_f32 v36, v36, v37
    v_pk_fma_f32 v[12:13], v[206:207], v[36:37], v[36:37] op_sel:[0,1,0] op_sel_hi:[1,1,0] neg_lo:[0,0,1] neg_hi:[0,0,1]
    v_pk_fma_f32 v[14:15], v[208:209], v[36:37], v[36:37] op_sel:[0,1,0] op_sel_hi:[1,1,0] neg_lo:[0,0,1] neg_hi:[0,0,1]
    v_pk_fma_f32 v[16:17], v[210:211], v[36:37], v[36:37] op_sel:[0,1,0] op_sel_hi:[1,1,0] neg_lo:[0,0,1] neg_hi:[0,0,1]
    v_pk_fma_f32 v[18:19], v[212:213], v[36:37], v[36:37] op_sel:[0,1,0] op_sel_hi:[1,1,0] neg_lo:[0,0,1] neg_hi:[0,0,1]
    v_pk_fma_f32 v[20:21], v[214:215], v[36:37], v[36:37] op_sel:[0,1,0] op_sel_hi:[1,1,0] neg_lo:[0,0,1] neg_hi:[0,0,1]
    v_pk_fma_f32 v[22:23], v[216:217], v[36:37], v[36:37] op_sel:[0,1,0] op_sel_hi:[1,1,0] neg_lo:[0,0,1] neg_hi:[0,0,1]
    v_pk_fma_f32 v[24:25], v[218:219], v[36:37], v[36:37] op_sel:[0,1,0] op_sel_hi:[1,1,0] neg_lo:[0,0,1] neg_hi:[0,0,1]
    v_pk_fma_f32 v[26:27], v[220:221], v[36:37], v[36:37] op_sel:[0,1,0] op_sel_hi:[1,1,0] neg_lo:[0,0,1] neg_hi:[0,0,1]
    v_pk_fma_f32 v[206:207], v[12:13], v[222:223], v[206:207]
    v_cvt_pk_bf16_f32 v180, v206, v207
    v_pk_fma_f32 v[208:209], v[14:15], v[224:225], v[208:209]
    v_cvt_pk_bf16_f32 v181, v208, v209
    v_and_b32 v180, -2, v180
    v_pk_fma_f32 v[210:211], v[16:17], v[226:227], v[210:211]
    v_cvt_pk_bf16_f32 v182, v210, v211
    v_pk_fma_f32 v[212:213], v[18:19], v[228:229], v[212:213]
    v_cvt_pk_bf16_f32 v183, v212, v213
    buffer_store_dwordx4 v[180:183], v196, s[20:23], 0 offen offset:0 sc1
    v_pk_fma_f32 v[214:215], v[20:21], v[230:231], v[214:215]
    v_cvt_pk_bf16_f32 v184, v214, v215
    v_pk_fma_f32 v[216:217], v[22:23], v[232:233], v[216:217]
    v_cvt_pk_bf16_f32 v185, v216, v217
    v_and_b32 v184, -2, v184
    v_pk_fma_f32 v[218:219], v[24:25], v[234:235], v[218:219]
    v_cvt_pk_bf16_f32 v186, v218, v219
    v_pk_fma_f32 v[220:221], v[26:27], v[236:237], v[220:221]
    v_cvt_pk_bf16_f32 v187, v220, v221
    buffer_store_dwordx4 v[184:187], v196, s[20:23], 0 offen offset:2048 sc1
    s_branch R_s2
R_l0:
    v_lshlrev_b32 v206, 16, v180
    v_and_b32 v207, 0xffff0000, v180
    v_lshlrev_b32 v208, 16, v181
    v_and_b32 v209, 0xffff0000, v181
    v_lshlrev_b32 v210, 16, v182
    v_and_b32 v211, 0xffff0000, v182
    v_lshlrev_b32 v212, 16, v183
    v_and_b32 v213, 0xffff0000, v183
    v_lshlrev_b32 v214, 16, v184
    v_and_b32 v215, 0xffff0000, v184
    v_lshlrev_b32 v216, 16, v185
    v_and_b32 v217, 0xffff0000, v185
    v_lshlrev_b32 v218, 16, v186
    v_and_b32 v219, 0xffff0000, v186
    v_lshlrev_b32 v220, 16, v187
    v_and_b32 v221, 0xffff0000, v187
    v_pk_add_f32 v[32:33], v[206:207], v[208:209]
    v_pk_mul_f32 v[34:35], v[206:207], v[206:207]
    v_pk_fma_f32 v[34:35], v[208:209], v[208:209], v[34:35]
    v_pk_add_f32 v[32:33], v[32:33], v[210:211]
    v_pk_fma_f32 v[34:35], v[210:211], v[210:211], v[34:35]
    v_pk_add_f32 v[32:33], v[32:33], v[212:213]
    v_pk_fma_f32 v[34:35], v[212:213], v[212:213], v[34:35]
    v_pk_add_f32 v[32:33], v[32:33], v[214:215]
    v_pk_fma_f32 v[34:35], v[214:215], v[214:215], v[34:35]
    v_pk_add_f32 v[32:33], v[32:33], v[216:217]
    v_pk_fma_f32 v[34:35], v[216:217], v[216:217], v[34:35]
    v_pk_add_f32 v[32:33], v[32:33], v[218:219]
    v_pk_fma_f32 v[34:35], v[218:219], v[218:219], v[34:35]
    v_pk_add_f32 v[32:33], v[32:33], v[220:221]
    v_pk_fma_f32 v[34:35], v[220:221], v[220:221], v[34:35]
    v_add_f32 v30, v32, v33
    v_add_f32 v31, v34, v35
    s_nop 0
    v_add_f32_dpp v30, v30, v30 row_ror:8 row_mask:0xf bank_mask:0xf
    v_add_f32_dpp v31, v31, v31 row_ror:8 row_mask:0xf bank_mask:0xf
    v_mov_b32 v32, v30
    v_mov_b32 v33, v31
    s_nop 0
    v_permlane16_swap_b32 v30, v32
    v_permlane16_swap_b32 v31, v33
    v_pk_add_f32 v[30:31], v[30:31], v[32:33]
    v_mov_b32 v32, v30
    v_mov_b32 v33, v31
    s_nop 0
    v_permlane32_swap_b32 v30, v32
    v_permlane32_swap_b32 v31, v33
    v_pk_add_f32 v[30:31], v[30:31], v[32:33]
    ds_write_b64 v39, v[30:31] offset:0
    s_waitcnt lgkmcnt(0)
    s_cmp_lg_u32 s30, 4
    s_cbranch_scc1 R_fw
    v_mov_b32 v222, 162820
spin_16:
    s_sleep 4
    ds_read_b32 v223, v222
    s_waitcnt lgkmcnt(0)
    v_readfirstlane_b32 s53, v223
    s_nop 0
    s_cmp_ge_u32 s53, 16
    s_cbranch_scc0 spin_16
    s_lshl_b32 s36, s28, 10
    s_add_u32 s36, s36, 23101440
    v_lshlrev_b32 v226, 7, v1
    v_add_u32 v226, s36, v226
    s_mov_b32 s53, 0
    s_mov_b64 exec, 0xff
R_fp:
    buffer_load_dword v222, v226, s[56:59], 0 offen sc1
    s_waitcnt vmcnt(0)
    v_subrev_u32 v222, s52, v222
    v_and_b32 v223, 0xffffc0ff, v222
    v_cmp_eq_u32 vcc, 32, v223
    s_nop 0
    s_cmp_eq_u64 vcc, exec
    s_cbranch_scc1 R_fq
    s_sleep 3
    s_add_u32 s53, s53, 1
    s_cmp_lt_u32 s53, s61
    s_cbranch_scc1 R_fp
    s_mov_b32 s61, 0
R_fq:
    v_lshrrev_b32 v222, 8, v222
    v_mov_b32 v223, 162844
    ds_add_u32 v223, v222
    s_mov_b64 exec, -1
    s_waitcnt lgkmcnt(0)
R_fw:
    s_barrier
    s_add_u32 s80, s4, 0x1c00000
    s_addc_u32 s81, s5, 0
    s_mov_b32 s82, 0x400000
    s_mov_b32 s83, 0x20000
    s_mov_b32 s78, 0
    buffer_load_dwordx2 v[230:231], v197, s[80:83], s78 offen sc1
    s_mov_b32 s78, 65536
    buffer_load_dwordx2 v[232:233], v197, s[80:83], s78 offen sc1
    s_mov_b32 s78, 262144
    buffer_load_dwordx2 v[234:235], v197, s[80:83], s78 offen sc1
    s_mov_b32 s78, 327680
    buffer_load_dwordx2 v[236:237], v197, s[80:83], s78 offen sc1
    v_mov_b32 v222, 162844
    ds_read_b32 v223, v222
    s_waitcnt lgkmcnt(0)
    v_readfirstlane_b32 s94, v223
    s_nop 0
    s_cmp_gt_u32 s94, 127
    s_cselect_b32 s94, 1, 0
    s_lshr_b32 s53, s28, 3
    s_lshl_b32 s53, s53, 2
    s_and_b32 s54, s28, 3
    s_add_u32 s53, s53, s54
    s_lshl_b32 s53, s53, 24
    s_lshr_b32 s54, s28, 2
    s_xor_b32 s54, s54, s94
    s_and_b32 s54, s54, 1
    s_lshl_b32 s54, s54, 13
    s_add_u32 s55, s53, s54
    s_add_u32 s55, s55, 33554432
    s_add_u32 s62, s4, s55
    s_addc_u32 s63, s5, 0
    s_sub_u32 s36, s28, 1
    s_max_i32 s36, s36, 0
    s_lshr_b32 s53, s36, 3
    s_lshl_b32 s53, s53, 2
    s_and_b32 s54, s36, 3
    s_add_u32 s53, s53, s54
    s_lshl_b32 s53, s53, 24
    s_lshr_b32 s54, s36, 2
    s_xor_b32 s54, s54, s94
    s_and_b32 s54, s54, 1
    s_lshl_b32 s54, s54, 13
    s_add_u32 s92, s53, s54
    s_add_u32 s92, s92, 33554432
    s_sub_u32 s92, s92, s55
    s_add_u32 s36, s28, 1
    s_min_u32 s36, s36, 15
    s_lshr_b32 s53, s36, 3
    s_lshl_b32 s53, s53, 2
    s_and_b32 s54, s36, 3
    s_add_u32 s53, s53, s54
    s_lshl_b32 s53, s53, 24
    s_lshr_b32 s54, s36, 2
    s_xor_b32 s54, s54, s94
    s_and_b32 s54, s54, 1
    s_lshl_b32 s54, s54, 13
    s_add_u32 s93, s53, s54
    s_add_u32 s93, s93, 33554432
    s_sub_u32 s93, s93, s55
    s_add_u32 s55, s55, 6029312
    s_mov_b32 s20, s62
    s_mov_b32 s21, s63
    s_mov_b32 s22, 0x7e000
    s_mov_b32 s23, 0x20000
    ds_read_b128 v[12:15], v40 offset:0
    ds_read_b128 v[16:19], v40 offset:16
    ds_read_b128 v[20:23], v40 offset:32
    ds_read_b128 v[24:27], v40 offset:48
    s_waitcnt lgkmcnt(0)
    v_pk_add_f32 v[12:13], v[12:13], v[14:15]
    v_pk_add_f32 v[16:17], v[16:17], v[18:19]
    v_pk_add_f32 v[20:21], v[20:21], v[22:23]
    v_pk_add_f32 v[24:25], v[24:25], v[26:27]
    v_pk_add_f32 v[12:13], v[12:13], v[16:17]
    v_pk_add_f32 v[20:21], v[20:21], v[24:25]
    v_pk_add_f32 v[12:13], v[12:13], v[20:21]
    v_mul_f32 v36, 0x3a800000, v12
    v_mul_f32 v38, 0x3a800000, v13
    v_fma_f32 v38, -v36, v36, v38
    v_max_f32 v38, 0, v38
    v_add_f32 v38, 0x3727c5ac, v38
    v_rsq_f32 v37, v38
    s_nop 0
    v_pk_add_f32 v[12:13], v[206:207], v[36:37] op_sel_hi:[1,0] neg_lo:[0,1] neg_hi:[0,1]
    v_pk_mul_f32 v[12:13], v[12:13], v[36:37] op_sel:[0,1] op_sel_hi:[1,1]
    v_pk_add_f32 v[14:15], v[208:209], v[36:37] op_sel_hi:[1,0] neg_lo:[0,1] neg_hi:[0,1]
    v_pk_mul_f32 v[14:15], v[14:15], v[36:37] op_sel:[0,1] op_sel_hi:[1,1]
    v_pk_add_f32 v[16:17], v[210:211], v[36:37] op_sel_hi:[1,0] neg_lo:[0,1] neg_hi:[0,1]
    v_pk_mul_f32 v[16:17], v[16:17], v[36:37] op_sel:[0,1] op_sel_hi:[1,1]
    v_pk_add_f32 v[18:19], v[212:213], v[36:37] op_sel_hi:[1,0] neg_lo:[0,1] neg_hi:[0,1]
    v_pk_mul_f32 v[18:19], v[18:19], v[36:37] op_sel:[0,1] op_sel_hi:[1,1]
    v_pk_add_f32 v[20:21], v[214:215], v[36:37] op_sel_hi:[1,0] neg_lo:[0,1] neg_hi:[0,1]
    v_pk_mul_f32 v[20:21], v[20:21], v[36:37] op_sel:[0,1] op_sel_hi:[1,1]
    v_pk_add_f32 v[22:23], v[216:217], v[36:37] op_sel_hi:[1,0] neg_lo:[0,1] neg_hi:[0,1]
    v_pk_mul_f32 v[22:23], v[22:23], v[36:37] op_sel:[0,1] op_sel_hi:[1,1]
    v_pk_add_f32 v[24:25], v[218:219], v[36:37] op_sel_hi:[1,0] neg_lo:[0,1] neg_hi:[0,1]
    v_pk_mul_f32 v[24:25], v[24:25], v[36:37] op_sel:[0,1] op_sel_hi:[1,1]
    v_pk_add_f32 v[26:27], v[220:221], v[36:37] op_sel_hi:[1,0] neg_lo:[0,1] neg_hi:[0,1]
    v_pk_mul_f32 v[26:27], v[26:27], v[36:37] op_sel:[0,1] op_sel_hi:[1,1]
    s_waitcnt vmcnt(0)
    v_lshlrev_b32 v222, 16, v230
    v_and_b32 v223, 0xffff0000, v230
    v_pk_fma_f32 v[206:207], v[12:13], v[222:223], v[206:207]
    v_cvt_pk_bf16_f32 v180, v206, v207
    v_lshlrev_b32 v222, 16, v231
    v_and_b32 v223, 0xffff0000, v231
    v_pk_fma_f32 v[208:209], v[14:15], v[222:223], v[208:209]
    v_cvt_pk_bf16_f32 v181, v208, v209
    v_and_b32 v180, -2, v180
    v_lshlrev_b32 v222, 16, v232
    v_and_b32 v223, 0xffff0000, v232
    v_pk_fma_f32 v[210:211], v[16:17], v[222:223], v[210:211]
    v_cvt_pk_bf16_f32 v182, v210, v211
    v_lshlrev_b32 v222, 16, v233
    v_and_b32 v223, 0xffff0000, v233
    v_pk_fma_f32 v[212:213], v[18:19], v[222:223], v[212:213]
    v_cvt_pk_bf16_f32 v183, v212, v213
    buffer_store_dwordx4 v[180:183], v196, s[20:23], 0 offen offset:0 sc1
    v_lshlrev_b32 v222, 16, v234
    v_and_b32 v223, 0xffff0000, v234
    v_pk_fma_f32 v[214:215], v[20:21], v[222:223], v[214:215]
    v_cvt_pk_bf16_f32 v184, v214, v215
    v_lshlrev_b32 v222, 16, v235
    v_and_b32 v223, 0xffff0000, v235
    v_pk_fma_f32 v[216:217], v[22:23], v[222:223], v[216:217]
    v_cvt_pk_bf16_f32 v185, v216, v217
    v_and_b32 v184, -2, v184
    v_lshlrev_b32 v222, 16, v236
    v_and_b32 v223, 0xffff0000, v236
    v_pk_fma_f32 v[218:219], v[24:25], v[222:223], v[218:219]
    v_cvt_pk_bf16_f32 v186, v218, v219
    v_lshlrev_b32 v222, 16, v237
    v_and_b32 v223, 0xffff0000, v237
    v_pk_fma_f32 v[220:221], v[26:27], v[222:223], v[220:221]
    v_cvt_pk_bf16_f32 v187, v220, v221
    buffer_store_dwordx4 v[184:187], v196, s[20:23], 0 offen offset:2048 sc1
R_s2:
    v_lshlrev_b32 v206, 16, v180
    v_and_b32 v207, 0xffff0000, v180
    v_lshlrev_b32 v208, 16, v181
    v_and_b32 v209, 0xffff0000, v181
    v_lshlrev_b32 v210, 16, v182
    v_and_b32 v211, 0xffff0000, v182
    v_lshlrev_b32 v212, 16, v183
    v_and_b32 v213, 0xffff0000, v183
    v_lshlrev_b32 v214, 16, v184
    v_and_b32 v215, 0xffff0000, v184
    v_lshlrev_b32 v216, 16, v185
    v_and_b32 v217, 0xffff0000, v185
    v_lshlrev_b32 v218, 16, v186
    v_and_b32 v219, 0xffff0000, v186
    v_lshlrev_b32 v220, 16, v187
    v_and_b32 v221, 0xffff0000, v187
    v_pk_add_f32 v[32:33], v[206:207], v[208:209]
    v_pk_mul_f32 v[34:35], v[206:207], v[206:207]
    v_pk_fma_f32 v[34:35], v[208:209], v[208:209], v[34:35]
    v_pk_add_f32 v[32:33], v[32:33], v[210:211]
    v_pk_fma_f32 v[34:35], v[210:211], v[210:211], v[34:35]
    v_pk_add_f32 v[32:33], v[32:33], v[212:213]
    v_pk_fma_f32 v[34:35], v[212:213], v[212:213], v[34:35]
    v_pk_add_f32 v[32:33], v[32:33], v[214:215]
    v_pk_fma_f32 v[34:35], v[214:215], v[214:215], v[34:35]
    v_pk_add_f32 v[32:33], v[32:33], v[216:217]
    v_pk_fma_f32 v[34:35], v[216:217], v[216:217], v[34:35]
    v_pk_add_f32 v[32:33], v[32:33], v[218:219]
    v_pk_fma_f32 v[34:35], v[218:219], v[218:219], v[34:35]
    v_pk_add_f32 v[32:33], v[32:33], v[220:221]
    v_pk_fma_f32 v[34:35], v[220:221], v[220:221], v[34:35]
    v_add_f32 v30, v32, v33
    v_add_f32 v31, v34, v35
    s_nop 0
    v_add_f32_dpp v30, v30, v30 row_ror:8 row_mask:0xf bank_mask:0xf
    v_add_f32_dpp v31, v31, v31 row_ror:8 row_mask:0xf bank_mask:0xf
    v_mov_b32 v32, v30
    v_mov_b32 v33, v31
    s_nop 0
    v_permlane16_swap_b32 v30, v32
    v_permlane16_swap_b32 v31, v33
    v_pk_add_f32 v[30:31], v[30:31], v[32:33]
    v_mov_b32 v32, v30
    v_mov_b32 v33, v31
    s_nop 0
    v_permlane32_swap_b32 v30, v32
    v_permlane32_swap_b32 v31, v33
    v_pk_add_f32 v[30:31], v[30:31], v[32:33]
    ds_write_b64 v39, v[30:31] offset:512
    s_waitcnt lgkmcnt(0)
    s_barrier
    s_cmp_lg_u32 s30, 6
    s_cbranch_scc1 R_n6
    s_cmp_lg_u32 s60, 0
    s_cbranch_scc1 R_n6
    s_lshl_b32 s53, s29, 7
    s_add_u32 s53, s53, 23117824
    v_mov_b32 v8, 1
    v_mov_b32 v9, 0
    s_mov_b64 exec, 1
    buffer_atomic_add v8, v9, s[56:59], s53 offen sc1
    s_mov_b64 exec, -1
R_n6:
    s_cmp_lg_u32 s30, 7
    s_cbranch_scc1 R_nl
    ds_read_b128 v[12:15], v40 offset:512
    ds_read_b128 v[16:19], v40 offset:528
    ds_read_b128 v[20:23], v40 offset:544
    ds_read_b128 v[24:27], v40 offset:560
    s_waitcnt lgkmcnt(0)
    v_pk_add_f32 v[12:13], v[12:13], v[14:15]
    v_pk_add_f32 v[16:17], v[16:17], v[18:19]
    v_pk_add_f32 v[20:21], v[20:21], v[22:23]
    v_pk_add_f32 v[24:25], v[24:25], v[26:27]
    v_pk_add_f32 v[12:13], v[12:13], v[16:17]
    v_pk_add_f32 v[20:21], v[20:21], v[24:25]
    v_pk_add_f32 v[12:13], v[12:13], v[20:21]
    v_mul_f32 v36, 0x3a800000, v12
    v_mul_f32 v38, 0x3a800000, v13
    v_fma_f32 v38, -v36, v36, v38
    v_max_f32 v38, 0, v38
    v_mov_b32 v42, v36
    v_mov_b32 v43, v38
    v_add_f32 v38, 0x3727c5ac, v38
    v_sqrt_f32 v38, v38
    s_nop 0
    v_mov_b32 v41, v38
    v_rcp_f32 v37, v38
    v_sub_f32 v42, v42, v36
    v_mul_f32 v42, v42, v37
    v_mul_f32 v43, v43, v37
    v_mul_f32 v43, v43, v37
    v_add_f32 v43, 0x3727c5ac, v43
    v_rsq_f32 v44, v43
    v_mov_b32 v224, v36
    v_mov_b32 v225, v37
    v_fma_f32 v226, v42, v41, v36
    v_mul_f32 v227, v37, v44
    s_add_u32 s24, s62, 0x5d0000
    s_addc_u32 s25, s63, 0
    s_mov_b32 s26, 0x800
    s_mov_b32 s27, 0x20000
    s_lshl_b32 s36, s29, 3
    v_add_u32 v6, s36, v199
    v_lshlrev_b32 v6, 4, v6
    s_mov_b64 exec, 0xff
    buffer_store_dwordx4 v[224:227], v6, s[24:27], 0 offen sc1
    s_mov_b64 exec, -1
    s_add_u32 s53, s55, 1280
    v_mov_b32 v8, 1
    v_mov_b32 v9, 162816
    v_mov_b32 v11, 0
    s_mov_b64 exec, 1
    s_waitcnt vmcnt(0)
    buffer_atomic_add v8, v11, s[56:59], s53 offen sc1
pub_17:
    s_mov_b64 exec, -1
R_nl:
    s_cmp_ge_u32 s30, 4
    s_cbranch_scc1 LOADERS
    s_mov_b32 s8, s62
    s_mov_b32 s9, s63
    s_mov_b32 s10, 0x7e000
    s_mov_b32 s11, 0x20000
    v_add_u32 v126, 0, v2
    v_add_u32 v127, 65536, v2
    s_lshl_b32 s44, s30, 17
    s_mov_b32 s34, s30
    s_mov_b32 s35, 0
    v_and_b32 v22, 15, v1
    v_lshrrev_b32 v23, 4, v1
    s_mul_i32 s37, s34, 2
    s_mul_i32 s38, s99, 4
    s_mul_i32 s36, s35, 4
    s_add_u32 s38, s38, s36
    v_add_u32 v128, 4096, v2
    v_add_u32 v129, 69632, v2
    s_add_u32 s45, s44, 16384
    s_add_u32 s46, s44, 32768
    s_add_u32 s47, s44, 49152
    v_lshrrev_b32 v6, 2, v1
    v_mul_u32_u24 v13, 128, v6
    v_and_b32 v7, 3, v1
    v_lshl_add_u32 v13, v7, 3, v13
    v_add_u32 v13, 24576, v13
    v_bfe_u32 v6, v6, 1, 2
    s_mul_i32 s36, s35, 4
    s_add_u32 s36, s36, 3
    v_xor_b32 v7, s36, v6
    v_lshl_add_u32 v16, v7, 5, v13
    s_mul_i32 s36, s35, 4
    s_add_u32 s36, s36, 2
    v_xor_b32 v7, s36, v6
    v_lshl_add_u32 v15, v7, 5, v13
    s_mul_i32 s36, s35, 4
    s_add_u32 s36, s36, 1
    v_xor_b32 v7, s36, v6
    v_lshl_add_u32 v14, v7, 5, v13
    s_mul_i32 s36, s35, 4
    s_add_u32 s36, s36, 0
    v_xor_b32 v7, s36, v6
    v_lshl_add_u32 v13, v7, 5, v13
    v_pk_mov_b32 v[24:25], 0, 0
    v_pk_mov_b32 v[26:27], 0, 0
    v_pk_mov_b32 v[28:29], 0, 0
    v_pk_mov_b32 v[30:31], 0, 0
    v_pk_mov_b32 v[32:33], 0, 0
    v_pk_mov_b32 v[34:35], 0, 0
    v_pk_mov_b32 v[36:37], 0, 0
    v_pk_mov_b32 v[38:39], 0, 0
    v_pk_mov_b32 v[40:41], 0, 0
    v_pk_mov_b32 v[42:43], 0, 0
    v_pk_mov_b32 v[44:45], 0, 0
    v_pk_mov_b32 v[46:47], 0, 0
    v_pk_mov_b32 v[48:49], 0, 0
    v_pk_mov_b32 v[50:51], 0, 0
    v_pk_mov_b32 v[52:53], 0, 0
    v_pk_mov_b32 v[54:55], 0, 0
    s_mov_b32 s43, 0
    s_mul_i32 s36, s35, 256
    s_add_u32 s36, s36, 163328
    v_lshlrev_b32 v6, 4, v23
    v_add_u32 v6, s36, v6
    s_lshl_b32 s36, s37, 8
    s_add_u32 s36, s36, 160776
    v_lshlrev_b32 v7, 4, v22
    v_add_u32 v7, s36, v7
    s_add_u32 s16, s4, 0xa000000
    s_addc_u32 s17, s5, 0
    s_mov_b32 s18, 0x800000
    s_mov_b32 s19, 0x20000
    v_mul_u32_u24 v12, 65536, v23
    v_lshl_add_u32 v12, v22, 4, v12
    s_mul_i32 s39, s38, 131072
    s_lshl_b32 s36, s37, 8
    s_add_u32 s39, s39, s36
    s_add_u32 s39, s39, 16384
    s_lshl_b32 s36, s28, 11
    s_add_u32 s39, s39, s36
    s_lshr_b32 s36, s29, 2
    s_xor_b32 s36, s36, s94
    s_and_b32 s36, s36, 1
    s_lshl_b32 s36, s36, 13
    s_add_u32 s39, s39, s36
    s_add_u32 s40, s39, 262144
    s_lshl_b32 s36, s29, 1
    s_lshr_b32 s53, s36, 3
    s_lshl_b32 s53, s53, 14
    s_and_b32 s41, s36, 7
    s_lshl_b32 s41, s41, 10
    s_add_u32 s41, s41, s53
    s_lshl_b32 s36, s37, 16
    s_add_u32 s41, s41, s36
    s_mov_b32 s53, 0
    s_mov_b32 s49, s44
    ds_read_b64_tr_b16 v[56:57], v13 offset:0
    ds_read_b64_tr_b16 v[58:59], v13 offset:2048
    ds_read_b64_tr_b16 v[60:61], v14 offset:0
    ds_read_b64_tr_b16 v[62:63], v14 offset:2048
    ds_read_b64_tr_b16 v[64:65], v15 offset:0
    ds_read_b64_tr_b16 v[66:67], v15 offset:2048
    ds_read_b64_tr_b16 v[68:69], v16 offset:0
    ds_read_b64_tr_b16 v[70:71], v16 offset:2048
    ds_read_b64_tr_b16 v[72:73], v13 offset:4096
    ds_read_b64_tr_b16 v[74:75], v13 offset:6144
    ds_read_b64_tr_b16 v[76:77], v14 offset:4096
    ds_read_b64_tr_b16 v[78:79], v14 offset:6144
    ds_read_b64_tr_b16 v[80:81], v15 offset:4096
    ds_read_b64_tr_b16 v[82:83], v15 offset:6144
    ds_read_b64_tr_b16 v[84:85], v16 offset:4096
    ds_read_b64_tr_b16 v[86:87], v16 offset:6144
dm_18p:
    buffer_load_dwordx4 v[164:167], v126, s[8:11], s44 offen offset:0 sc1
    buffer_load_dwordx4 v[168:171], v127, s[8:11], s44 offen offset:0 sc1
    buffer_load_dwordx4 v[172:175], v126, s[8:11], s44 offen offset:1024 sc1
    buffer_load_dwordx4 v[176:179], v127, s[8:11], s44 offen offset:1024 sc1
dm_18w:
    s_waitcnt vmcnt(0)
    v_or3_b32 v17, v164, v168, v172
    v_bitop3_b32 v17, v17, v176, 1 bitop3:0xa8
    v_cmp_ne_u32 vcc, 0, v17
    s_cbranch_vccz dm_18q
    s_sleep 2
    s_add_u32 s53, s53, 1
    s_cmp_lt_u32 s53, s61
    s_cbranch_scc1 dm_18p
    s_mov_b32 s61, 0
dm_18q:
    buffer_load_dwordx4 v[180:183], v126, s[8:11], s44 offen offset:2048 sc1
    buffer_load_dwordx4 v[184:187], v127, s[8:11], s44 offen offset:2048 sc1
    buffer_load_dwordx4 v[188:191], v126, s[8:11], s44 offen offset:3072 sc1
    buffer_load_dwordx4 v[192:195], v127, s[8:11], s44 offen offset:3072 sc1
    buffer_load_dwordx4 v[196:199], v128, s[8:11], s44 offen offset:0 sc1
    buffer_load_dwordx4 v[200:203], v129, s[8:11], s44 offen offset:0 sc1
    buffer_load_dwordx4 v[204:207], v128, s[8:11], s44 offen offset:1024 sc1
    buffer_load_dwordx4 v[208:211], v129, s[8:11], s44 offen offset:1024 sc1
    buffer_load_dwordx4 v[212:215], v128, s[8:11], s44 offen offset:2048 sc1
    buffer_load_dwordx4 v[216:219], v129, s[8:11], s44 offen offset:2048 sc1
    s_waitcnt lgkmcnt(0)
dm_18:
    v_mfma_f32_16x16x32_bf16 v[24:27], v[56:59], v[164:167], v[24:27]
    ds_read_b64_tr_b16 v[88:89], v13 offset:8192
    buffer_load_dwordx4 v[220:223], v128, s[8:11], s44 offen offset:3072 sc1
    v_mfma_f32_16x16x32_bf16 v[40:43], v[56:59], v[168:171], v[40:43]
    ds_read_b64_tr_b16 v[90:91], v13 offset:10240
    buffer_load_dwordx4 v[224:227], v129, s[8:11], s44 offen offset:3072 sc1
    v_mfma_f32_16x16x32_bf16 v[44:47], v[60:63], v[168:171], v[44:47]
    ds_read_b64_tr_b16 v[92:93], v14 offset:8192
    s_mov_b32 s44, s45
    v_mfma_f32_16x16x32_bf16 v[28:31], v[60:63], v[164:167], v[28:31]
    ds_read_b64_tr_b16 v[94:95], v14 offset:10240
    s_mov_b32 s45, s46
    v_mfma_f32_16x16x32_bf16 v[32:35], v[64:67], v[164:167], v[32:35]
    ds_read_b64_tr_b16 v[96:97], v15 offset:8192
    s_mov_b32 s46, s47
    v_mfma_f32_16x16x32_bf16 v[48:51], v[64:67], v[168:171], v[48:51]
    ds_read_b64_tr_b16 v[98:99], v15 offset:10240
    s_mov_b32 s47, 1048576
    v_mfma_f32_16x16x32_bf16 v[52:55], v[68:71], v[168:171], v[52:55]
    ds_read_b64_tr_b16 v[100:101], v16 offset:8192
    v_mfma_f32_16x16x32_bf16 v[36:39], v[68:71], v[164:167], v[36:39]
    ds_read_b64_tr_b16 v[102:103], v16 offset:10240
    s_waitcnt lgkmcnt(8)
    v_mfma_f32_16x16x32_bf16 v[24:27], v[72:75], v[172:175], v[24:27]
    ds_read_b64_tr_b16 v[104:105], v13 offset:12288
    buffer_load_dwordx4 v[164:167], v126, s[8:11], s44 offen offset:0 sc1
    v_mfma_f32_16x16x32_bf16 v[40:43], v[72:75], v[176:179], v[40:43]
    ds_read_b64_tr_b16 v[106:107], v13 offset:14336
    buffer_load_dwordx4 v[168:171], v127, s[8:11], s44 offen offset:0 sc1
    v_mfma_f32_16x16x32_bf16 v[44:47], v[76:79], v[176:179], v[44:47]
    ds_read_b64_tr_b16 v[108:109], v14 offset:12288
    s_waitcnt vmcnt(10)
    v_mfma_f32_16x16x32_bf16 v[28:31], v[76:79], v[172:175], v[28:31]
    ds_read_b64_tr_b16 v[110:111], v14 offset:14336
    v_or3_b32 v17, v180, v184, v188
    v_mfma_f32_16x16x32_bf16 v[32:35], v[80:83], v[172:175], v[32:35]
    ds_read_b64_tr_b16 v[112:113], v15 offset:12288
    v_bitop3_b32 v17, v17, v192, 1 bitop3:0xa8
    v_mfma_f32_16x16x32_bf16 v[48:51], v[80:83], v[176:179], v[48:51]
    ds_read_b64_tr_b16 v[114:115], v15 offset:14336
    v_cmp_ne_u32 vcc, 0, v17
    v_mfma_f32_16x16x32_bf16 v[52:55], v[84:87], v[176:179], v[52:55]
    ds_read_b64_tr_b16 v[116:117], v16 offset:12288
    ds_read_b64_tr_b16 v[118:119], v16 offset:14336
    v_mfma_f32_16x16x32_bf16 v[36:39], v[84:87], v[172:175], v[36:39]
    s_waitcnt lgkmcnt(8)
    s_cbranch_vccnz dm_18f0
dm_18g0:
    v_mfma_f32_16x16x32_bf16 v[24:27], v[88:91], v[180:183], v[24:27]
    ds_read_b64_tr_b16 v[56:57], v13 offset:16384
    buffer_load_dwordx4 v[172:175], v126, s[8:11], s44 offen offset:1024 sc1
    v_mfma_f32_16x16x32_bf16 v[40:43], v[88:91], v[184:187], v[40:43]
    ds_read_b64_tr_b16 v[58:59], v13 offset:18432
    buffer_load_dwordx4 v[176:179], v127, s[8:11], s44 offen offset:1024 sc1
    v_mfma_f32_16x16x32_bf16 v[44:47], v[92:95], v[184:187], v[44:47]
    ds_read_b64_tr_b16 v[60:61], v14 offset:16384
    v_mfma_f32_16x16x32_bf16 v[28:31], v[92:95], v[180:183], v[28:31]
    ds_read_b64_tr_b16 v[62:63], v14 offset:18432
    v_mfma_f32_16x16x32_bf16 v[32:35], v[96:99], v[180:183], v[32:35]
    ds_read_b64_tr_b16 v[64:65], v15 offset:16384
    v_mfma_f32_16x16x32_bf16 v[48:51], v[96:99], v[184:187], v[48:51]
    ds_read_b64_tr_b16 v[66:67], v15 offset:18432
    v_mfma_f32_16x16x32_bf16 v[52:55], v[100:103], v[184:187], v[52:55]
    ds_read_b64_tr_b16 v[68:69], v16 offset:16384
    v_mfma_f32_16x16x32_bf16 v[36:39], v[100:103], v[180:183], v[36:39]
    ds_read_b64_tr_b16 v[70:71], v16 offset:18432
    s_waitcnt lgkmcnt(8)
    v_mfma_f32_16x16x32_bf16 v[24:27], v[104:107], v[188:191], v[24:27]
    ds_read_b64_tr_b16 v[72:73], v13 offset:20480
    buffer_load_dwordx4 v[180:183], v126, s[8:11], s44 offen offset:2048 sc1
    v_mfma_f32_16x16x32_bf16 v[40:43], v[104:107], v[192:195], v[40:43]
    ds_read_b64_tr_b16 v[74:75], v13 offset:22528
    buffer_load_dwordx4 v[184:187], v127, s[8:11], s44 offen offset:2048 sc1
    v_mfma_f32_16x16x32_bf16 v[44:47], v[108:111], v[192:195], v[44:47]
    ds_read_b64_tr_b16 v[76:77], v14 offset:20480
    s_waitcnt vmcnt(10)
    v_mfma_f32_16x16x32_bf16 v[28:31], v[108:111], v[188:191], v[28:31]
    ds_read_b64_tr_b16 v[78:79], v14 offset:22528
    v_or3_b32 v17, v196, v200, v204
    v_mfma_f32_16x16x32_bf16 v[32:35], v[112:115], v[188:191], v[32:35]
    ds_read_b64_tr_b16 v[80:81], v15 offset:20480
    v_bitop3_b32 v17, v17, v208, 1 bitop3:0xa8
    v_mfma_f32_16x16x32_bf16 v[48:51], v[112:115], v[192:195], v[48:51]
    ds_read_b64_tr_b16 v[82:83], v15 offset:22528
    v_cmp_ne_u32 vcc, 0, v17
    v_mfma_f32_16x16x32_bf16 v[52:55], v[116:119], v[192:195], v[52:55]
    ds_read_b64_tr_b16 v[84:85], v16 offset:20480
    ds_read_b64_tr_b16 v[86:87], v16 offset:22528
    v_mfma_f32_16x16x32_bf16 v[36:39], v[116:119], v[188:191], v[36:39]
    s_waitcnt lgkmcnt(8)
    s_cbranch_vccnz dm_18f1
dm_18g1:
    v_mfma_f32_16x16x32_bf16 v[24:27], v[56:59], v[196:199], v[24:27]
    ds_read_b64_tr_b16 v[88:89], v13 offset:24576
    buffer_load_dwordx4 v[188:191], v126, s[8:11], s44 offen offset:3072 sc1
    v_mfma_f32_16x16x32_bf16 v[40:43], v[56:59], v[200:203], v[40:43]
    ds_read_b64_tr_b16 v[90:91], v13 offset:26624
    buffer_load_dwordx4 v[192:195], v127, s[8:11], s44 offen offset:3072 sc1
    v_mfma_f32_16x16x32_bf16 v[44:47], v[60:63], v[200:203], v[44:47]
    ds_read_b64_tr_b16 v[92:93], v14 offset:24576
    s_add_u32 s43, s43, 1
    v_mfma_f32_16x16x32_bf16 v[28:31], v[60:63], v[196:199], v[28:31]
    ds_read_b64_tr_b16 v[94:95], v14 offset:26624
    s_cmp_eq_u32 s43, 4
    v_mfma_f32_16x16x32_bf16 v[32:35], v[64:67], v[196:199], v[32:35]
    ds_read_b64_tr_b16 v[96:97], v15 offset:24576
    v_mfma_f32_16x16x32_bf16 v[48:51], v[64:67], v[200:203], v[48:51]
    ds_read_b64_tr_b16 v[98:99], v15 offset:26624
    v_mfma_f32_16x16x32_bf16 v[52:55], v[68:71], v[200:203], v[52:55]
    ds_read_b64_tr_b16 v[100:101], v16 offset:24576
    v_mfma_f32_16x16x32_bf16 v[36:39], v[68:71], v[196:199], v[36:39]
    ds_read_b64_tr_b16 v[102:103], v16 offset:26624
    s_waitcnt lgkmcnt(8)
    v_mfma_f32_16x16x32_bf16 v[24:27], v[72:75], v[204:207], v[24:27]
    ds_read_b64_tr_b16 v[104:105], v13 offset:28672
    buffer_load_dwordx4 v[196:199], v128, s[8:11], s44 offen offset:0 sc1
    v_mfma_f32_16x16x32_bf16 v[40:43], v[72:75], v[208:211], v[40:43]
    ds_read_b64_tr_b16 v[106:107], v13 offset:30720
    buffer_load_dwordx4 v[200:203], v129, s[8:11], s44 offen offset:0 sc1
    v_mfma_f32_16x16x32_bf16 v[44:47], v[76:79], v[208:211], v[44:47]
    ds_read_b64_tr_b16 v[108:109], v14 offset:28672
    s_waitcnt vmcnt(10)
    v_mfma_f32_16x16x32_bf16 v[28:31], v[76:79], v[204:207], v[28:31]
    ds_read_b64_tr_b16 v[110:111], v14 offset:30720
    v_add_u32 v13, 32768, v13
    v_or3_b32 v17, v212, v216, v220
    v_mfma_f32_16x16x32_bf16 v[32:35], v[80:83], v[204:207], v[32:35]
    ds_read_b64_tr_b16 v[112:113], v15 offset:28672
    v_add_u32 v14, 32768, v14
    v_bitop3_b32 v17, v17, v224, 1 bitop3:0xa8
    v_mfma_f32_16x16x32_bf16 v[48:51], v[80:83], v[208:211], v[48:51]
    ds_read_b64_tr_b16 v[114:115], v15 offset:30720
    v_add_u32 v15, 32768, v15
    v_cmp_ne_u32 vcc, 0, v17
    v_mfma_f32_16x16x32_bf16 v[52:55], v[84:87], v[208:211], v[52:55]
    ds_read_b64_tr_b16 v[116:117], v16 offset:28672
    ds_read_b64_tr_b16 v[118:119], v16 offset:30720
    v_mfma_f32_16x16x32_bf16 v[36:39], v[84:87], v[204:207], v[36:39]
    v_add_u32 v16, 32768, v16
    s_waitcnt lgkmcnt(8)
    s_cbranch_vccnz dm_18f2
dm_18g2:
    s_cbranch_scc1 dm_18x
    v_mfma_f32_16x16x32_bf16 v[24:27], v[88:91], v[212:215], v[24:27]
    ds_read_b64_tr_b16 v[56:57], v13 offset:0
    buffer_load_dwordx4 v[204:207], v128, s[8:11], s44 offen offset:1024 sc1
    v_mfma_f32_16x16x32_bf16 v[40:43], v[88:91], v[216:219], v[40:43]
    ds_read_b64_tr_b16 v[58:59], v13 offset:2048
    buffer_load_dwordx4 v[208:211], v129, s[8:11], s44 offen offset:1024 sc1
    v_mfma_f32_16x16x32_bf16 v[44:47], v[92:95], v[216:219], v[44:47]
    ds_read_b64_tr_b16 v[60:61], v14 offset:0
    s_mov_b32 s49, s44
    v_mfma_f32_16x16x32_bf16 v[28:31], v[92:95], v[212:215], v[28:31]
    ds_read_b64_tr_b16 v[62:63], v14 offset:2048
    v_mfma_f32_16x16x32_bf16 v[32:35], v[96:99], v[212:215], v[32:35]
    ds_read_b64_tr_b16 v[64:65], v15 offset:0
    v_mfma_f32_16x16x32_bf16 v[48:51], v[96:99], v[216:219], v[48:51]
    ds_read_b64_tr_b16 v[66:67], v15 offset:2048
    v_mfma_f32_16x16x32_bf16 v[52:55], v[100:103], v[216:219], v[52:55]
    ds_read_b64_tr_b16 v[68:69], v16 offset:0
    v_mfma_f32_16x16x32_bf16 v[36:39], v[100:103], v[212:215], v[36:39]
    ds_read_b64_tr_b16 v[70:71], v16 offset:2048
    s_waitcnt lgkmcnt(8)
    v_mfma_f32_16x16x32_bf16 v[24:27], v[104:107], v[220:223], v[24:27]
    ds_read_b64_tr_b16 v[72:73], v13 offset:4096
    buffer_load_dwordx4 v[212:215], v128, s[8:11], s44 offen offset:2048 sc1
    v_mfma_f32_16x16x32_bf16 v[40:43], v[104:107], v[224:227], v[40:43]
    ds_read_b64_tr_b16 v[74:75], v13 offset:6144
    buffer_load_dwordx4 v[216:219], v129, s[8:11], s44 offen offset:2048 sc1
    v_mfma_f32_16x16x32_bf16 v[44:47], v[108:111], v[224:227], v[44:47]
    ds_read_b64_tr_b16 v[76:77], v14 offset:4096
    s_waitcnt vmcnt(10)
    v_mfma_f32_16x16x32_bf16 v[28:31], v[108:111], v[220:223], v[28:31]
    ds_read_b64_tr_b16 v[78:79], v14 offset:6144
    v_or3_b32 v17, v164, v168, v172
    v_mfma_f32_16x16x32_bf16 v[32:35], v[112:115], v[220:223], v[32:35]
    ds_read_b64_tr_b16 v[80:81], v15 offset:4096
    v_bitop3_b32 v17, v17, v176, 1 bitop3:0xa8
    v_mfma_f32_16x16x32_bf16 v[48:51], v[112:115], v[224:227], v[48:51]
    ds_read_b64_tr_b16 v[82:83], v15 offset:6144
    v_cmp_ne_u32 vcc, 0, v17
    v_mfma_f32_16x16x32_bf16 v[52:55], v[116:119], v[224:227], v[52:55]
    ds_read_b64_tr_b16 v[84:85], v16 offset:4096
    ds_read_b64_tr_b16 v[86:87], v16 offset:6144
    v_mfma_f32_16x16x32_bf16 v[36:39], v[116:119], v[220:223], v[36:39]
    s_waitcnt lgkmcnt(8)
    s_cbranch_vccnz dm_18f3
dm_18g3:
    s_branch dm_18
dm_18f0:
    s_cselect_b32 s50, 1, 0
dm_18h0:
    s_sleep 2
    buffer_load_dwordx4 v[180:183], v126, s[8:11], s49 offen offset:2048 sc1
    buffer_load_dwordx4 v[184:187], v127, s[8:11], s49 offen offset:2048 sc1
    buffer_load_dwordx4 v[188:191], v126, s[8:11], s49 offen offset:3072 sc1
    buffer_load_dwordx4 v[192:195], v127, s[8:11], s49 offen offset:3072 sc1
    buffer_load_dwordx4 v[196:199], v128, s[8:11], s49 offen offset:0 sc1
    buffer_load_dwordx4 v[200:203], v129, s[8:11], s49 offen offset:0 sc1
    buffer_load_dwordx4 v[204:207], v128, s[8:11], s49 offen offset:1024 sc1
    buffer_load_dwordx4 v[208:211], v129, s[8:11], s49 offen offset:1024 sc1
    buffer_load_dwordx4 v[212:215], v128, s[8:11], s49 offen offset:2048 sc1
    buffer_load_dwordx4 v[216:219], v129, s[8:11], s49 offen offset:2048 sc1
    buffer_load_dwordx4 v[220:223], v128, s[8:11], s49 offen offset:3072 sc1
    buffer_load_dwordx4 v[224:227], v129, s[8:11], s49 offen offset:3072 sc1
    buffer_load_dwordx4 v[164:167], v126, s[8:11], s44 offen offset:0 sc1
    buffer_load_dwordx4 v[168:171], v127, s[8:11], s44 offen offset:0 sc1
    s_waitcnt vmcnt(10)
    v_or3_b32 v17, v180, v184, v188
    v_bitop3_b32 v17, v17, v192, 1 bitop3:0xa8
    v_cmp_ne_u32 vcc, 0, v17
    s_add_u32 s53, s53, 1
    s_cmp_ge_u32 s53, s61
    s_cselect_b32 s61, 0, s61
    s_cbranch_scc1 dm_18k0
    s_cbranch_vccnz dm_18h0
dm_18k0:
    s_cmp_eq_u32 s50, 1
    s_branch dm_18g0
dm_18f1:
    s_cselect_b32 s50, 1, 0
dm_18h1:
    s_sleep 2
    buffer_load_dwordx4 v[196:199], v128, s[8:11], s49 offen offset:0 sc1
    buffer_load_dwordx4 v[200:203], v129, s[8:11], s49 offen offset:0 sc1
    buffer_load_dwordx4 v[204:207], v128, s[8:11], s49 offen offset:1024 sc1
    buffer_load_dwordx4 v[208:211], v129, s[8:11], s49 offen offset:1024 sc1
    buffer_load_dwordx4 v[212:215], v128, s[8:11], s49 offen offset:2048 sc1
    buffer_load_dwordx4 v[216:219], v129, s[8:11], s49 offen offset:2048 sc1
    buffer_load_dwordx4 v[220:223], v128, s[8:11], s49 offen offset:3072 sc1
    buffer_load_dwordx4 v[224:227], v129, s[8:11], s49 offen offset:3072 sc1
    buffer_load_dwordx4 v[164:167], v126, s[8:11], s44 offen offset:0 sc1
    buffer_load_dwordx4 v[168:171], v127, s[8:11], s44 offen offset:0 sc1
    buffer_load_dwordx4 v[172:175], v126, s[8:11], s44 offen offset:1024 sc1
    buffer_load_dwordx4 v[176:179], v127, s[8:11], s44 offen offset:1024 sc1
    buffer_load_dwordx4 v[180:183], v126, s[8:11], s44 offen offset:2048 sc1
    buffer_load_dwordx4 v[184:187], v127, s[8:11], s44 offen offset:2048 sc1
    s_waitcnt vmcnt(10)
    v_or3_b32 v17, v196, v200, v204
    v_bitop3_b32 v17, v17, v208, 1 bitop3:0xa8
    v_cmp_ne_u32 vcc, 0, v17
    s_add_u32 s53, s53, 1
    s_cmp_ge_u32 s53, s61
    s_cselect_b32 s61, 0, s61
    s_cbranch_scc1 dm_18k1
    s_cbranch_vccnz dm_18h1
dm_18k1:
    s_cmp_eq_u32 s50, 1
    s_branch dm_18g1
dm_18f2:
    s_cselect_b32 s50, 1, 0
dm_18h2:
    s_sleep 2
    buffer_load_dwordx4 v[212:215], v128, s[8:11], s49 offen offset:2048 sc1
    buffer_load_dwordx4 v[216:219], v129, s[8:11], s49 offen offset:2048 sc1
    buffer_load_dwordx4 v[220:223], v128, s[8:11], s49 offen offset:3072 sc1
    buffer_load_dwordx4 v[224:227], v129, s[8:11], s49 offen offset:3072 sc1
    buffer_load_dwordx4 v[164:167], v126, s[8:11], s44 offen offset:0 sc1
    buffer_load_dwordx4 v[168:171], v127, s[8:11], s44 offen offset:0 sc1
    buffer_load_dwordx4 v[172:175], v126, s[8:11], s44 offen offset:1024 sc1
    buffer_load_dwordx4 v[176:179], v127, s[8:11], s44 offen offset:1024 sc1
    buffer_load_dwordx4 v[180:183], v126, s[8:11], s44 offen offset:2048 sc1
    buffer_load_dwordx4 v[184:187], v127, s[8:11], s44 offen offset:2048 sc1
    buffer_load_dwordx4 v[188:191], v126, s[8:11], s44 offen offset:3072 sc1
    buffer_load_dwordx4 v[192:195], v127, s[8:11], s44 offen offset:3072 sc1
    buffer_load_dwordx4 v[196:199], v128, s[8:11], s44 offen offset:0 sc1
    buffer_load_dwordx4 v[200:203], v129, s[8:11], s44 offen offset:0 sc1
    s_waitcnt vmcnt(10)
    v_or3_b32 v17, v212, v216, v220
    v_bitop3_b32 v17, v17, v224, 1 bitop3:0xa8
    v_cmp_ne_u32 vcc, 0, v17
    s_add_u32 s53, s53, 1
    s_cmp_ge_u32 s53, s61
    s_cselect_b32 s61, 0, s61
    s_cbranch_scc1 dm_18k2
    s_cbranch_vccnz dm_18h2
dm_18k2:
    s_cmp_eq_u32 s50, 1
    s_branch dm_18g2
dm_18f3:
    s_cselect_b32 s50, 1, 0
dm_18h3:
    s_sleep 2
    buffer_load_dwordx4 v[164:167], v126, s[8:11], s49 offen offset:0 sc1
    buffer_load_dwordx4 v[168:171], v127, s[8:11], s49 offen offset:0 sc1
    buffer_load_dwordx4 v[172:175], v126, s[8:11], s49 offen offset:1024 sc1
    buffer_load_dwordx4 v[176:179], v127, s[8:11], s49 offen offset:1024 sc1
    buffer_load_dwordx4 v[180:183], v126, s[8:11], s49 offen offset:2048 sc1
    buffer_load_dwordx4 v[184:187], v127, s[8:11], s49 offen offset:2048 sc1
    buffer_load_dwordx4 v[188:191], v126, s[8:11], s49 offen offset:3072 sc1
    buffer_load_dwordx4 v[192:195], v127, s[8:11], s49 offen offset:3072 sc1
    buffer_load_dwordx4 v[196:199], v128, s[8:11], s49 offen offset:0 sc1
    buffer_load_dwordx4 v[200:203], v129, s[8:11], s49 offen offset:0 sc1
    buffer_load_dwordx4 v[204:207], v128, s[8:11], s49 offen offset:1024 sc1
    buffer_load_dwordx4 v[208:211], v129, s[8:11], s49 offen offset:1024 sc1
    buffer_load_dwordx4 v[212:215], v128, s[8:11], s49 offen offset:2048 sc1
    buffer_load_dwordx4 v[216:219], v129, s[8:11], s49 offen offset:2048 sc1
    s_waitcnt vmcnt(10)
    v_or3_b32 v17, v164, v168, v172
    v_bitop3_b32 v17, v17, v176, 1 bitop3:0xa8
    v_cmp_ne_u32 vcc, 0, v17
    s_add_u32 s53, s53, 1
    s_cmp_ge_u32 s53, s61
    s_cselect_b32 s61, 0, s61
    s_cbranch_scc1 dm_18k3
    s_cbranch_vccnz dm_18h3
dm_18k3:
    s_cmp_eq_u32 s50, 1
    s_branch dm_18g3
dm_18x:
    v_mfma_f32_16x16x32_bf16 v[24:27], v[88:91], v[212:215], v[24:27]
    buffer_load_dwordx4 v[148:151], v126, s[8:11], s41 offen offset:0 sc1
    v_mfma_f32_16x16x32_bf16 v[40:43], v[88:91], v[216:219], v[40:43]
    v_mfma_f32_16x16x32_bf16 v[44:47], v[92:95], v[216:219], v[44:47]
    buffer_load_dwordx4 v[152:155], v126, s[8:11], s41 offen offset:1024 sc1
    v_mfma_f32_16x16x32_bf16 v[28:31], v[92:95], v[212:215], v[28:31]
    v_mfma_f32_16x16x32_bf16 v[32:35], v[96:99], v[212:215], v[32:35]
    buffer_load_dwordx4 v[156:159], v127, s[8:11], s41 offen offset:0 sc1
    v_mfma_f32_16x16x32_bf16 v[48:51], v[96:99], v[216:219], v[48:51]
    v_mfma_f32_16x16x32_bf16 v[52:55], v[100:103], v[216:219], v[52:55]
    buffer_load_dwordx4 v[160:163], v127, s[8:11], s41 offen offset:1024 sc1
    v_mfma_f32_16x16x32_bf16 v[36:39], v[100:103], v[212:215], v[36:39]
    s_waitcnt lgkmcnt(0)
    s_barrier
    v_mfma_f32_16x16x32_bf16 v[24:27], v[104:107], v[220:223], v[24:27]
    ds_read_b128 v[56:59], v6 offset:0
    v_mfma_f32_16x16x32_bf16 v[40:43], v[104:107], v[224:227], v[40:43]
    ds_read_b128 v[60:63], v6 offset:64
    v_mfma_f32_16x16x32_bf16 v[44:47], v[108:111], v[224:227], v[44:47]
    ds_read_b128 v[64:67], v6 offset:128
    v_mfma_f32_16x16x32_bf16 v[28:31], v[108:111], v[220:223], v[28:31]
    ds_read_b128 v[68:71], v6 offset:192
    v_mfma_f32_16x16x32_bf16 v[32:35], v[112:115], v[220:223], v[32:35]
    ds_read_b64 v[72:73], v7 offset:0
    v_mfma_f32_16x16x32_bf16 v[48:51], v[112:115], v[224:227], v[48:51]
    ds_read_b64 v[74:75], v7 offset:256
    v_mfma_f32_16x16x32_bf16 v[52:55], v[116:119], v[224:227], v[52:55]
    v_mfma_f32_16x16x32_bf16 v[36:39], v[116:119], v[220:223], v[36:39]
    s_waitcnt lgkmcnt(0)
    v_mul_f32 v134, 0xc0135761, v73
    v_mul_f32 v135, v73, v73
    v_mul_f32 v135, v135, v134
    v_mul_f32 v135, 0x3d372713, v135
    v_rcp_f32 v73, v73
    v_mul_f32 v136, 0xc0135761, v75
    v_mul_f32 v137, v75, v75
    v_mul_f32 v137, v137, v136
    v_mul_f32 v137, 0x3d372713, v137
    v_rcp_f32 v75, v75
    v_pk_fma_f32 v[24:25], v[72:73], v[56:57], v[24:25] op_sel_hi:[0,1,1] neg_lo:[1,0,0] neg_hi:[1,0,0]
    v_pk_fma_f32 v[26:27], v[72:73], v[58:59], v[26:27] op_sel_hi:[0,1,1] neg_lo:[1,0,0] neg_hi:[1,0,0]
    v_pk_mul_f32 v[122:123], v[24:25], v[24:25]
    v_pk_mul_f32 v[124:125], v[26:27], v[26:27]
    v_pk_fma_f32 v[122:123], v[122:123], v[134:135], v[134:135] op_sel:[0,1,0] op_sel_hi:[1,1,0]
    v_pk_fma_f32 v[124:125], v[124:125], v[134:135], v[134:135] op_sel:[0,1,0] op_sel_hi:[1,1,0]
    v_pk_mul_f32 v[122:123], v[122:123], v[24:25]
    v_pk_mul_f32 v[124:125], v[124:125], v[26:27]
    v_exp_f32 v122, v122
    v_exp_f32 v123, v123
    v_exp_f32 v124, v124
    v_exp_f32 v125, v125
    v_pk_fma_f32 v[122:123], v[122:123], v[72:73], v[72:73] op_sel:[0,1,1] op_sel_hi:[1,1,1]
    v_pk_fma_f32 v[124:125], v[124:125], v[72:73], v[72:73] op_sel:[0,1,1] op_sel_hi:[1,1,1]
    v_rcp_f32 v122, v122
    v_rcp_f32 v123, v123
    v_rcp_f32 v124, v124
    v_rcp_f32 v125, v125
    v_pk_mul_f32 v[24:25], v[24:25], v[122:123]
    v_pk_mul_f32 v[26:27], v[26:27], v[124:125]
    v_pk_fma_f32 v[28:29], v[72:73], v[60:61], v[28:29] op_sel_hi:[0,1,1] neg_lo:[1,0,0] neg_hi:[1,0,0]
    v_pk_fma_f32 v[30:31], v[72:73], v[62:63], v[30:31] op_sel_hi:[0,1,1] neg_lo:[1,0,0] neg_hi:[1,0,0]
    v_pk_mul_f32 v[122:123], v[28:29], v[28:29]
    v_pk_mul_f32 v[124:125], v[30:31], v[30:31]
    v_pk_fma_f32 v[122:123], v[122:123], v[134:135], v[134:135] op_sel:[0,1,0] op_sel_hi:[1,1,0]
    v_pk_fma_f32 v[124:125], v[124:125], v[134:135], v[134:135] op_sel:[0,1,0] op_sel_hi:[1,1,0]
    v_pk_mul_f32 v[122:123], v[122:123], v[28:29]
    v_pk_mul_f32 v[124:125], v[124:125], v[30:31]
    v_exp_f32 v122, v122
    v_exp_f32 v123, v123
    v_exp_f32 v124, v124
    v_exp_f32 v125, v125
    v_pk_fma_f32 v[122:123], v[122:123], v[72:73], v[72:73] op_sel:[0,1,1] op_sel_hi:[1,1,1]
    v_pk_fma_f32 v[124:125], v[124:125], v[72:73], v[72:73] op_sel:[0,1,1] op_sel_hi:[1,1,1]
    v_rcp_f32 v122, v122
    v_rcp_f32 v123, v123
    v_rcp_f32 v124, v124
    v_rcp_f32 v125, v125
    v_pk_mul_f32 v[28:29], v[28:29], v[122:123]
    v_pk_mul_f32 v[30:31], v[30:31], v[124:125]
    v_cvt_pk_bf16_f32 v24, v24, v25
    v_cvt_pk_bf16_f32 v25, v26, v27
    v_cvt_pk_bf16_f32 v26, v28, v29
    v_cvt_pk_bf16_f32 v27, v30, v31
    v_and_or_b32 v24, v24, -2, s60
    buffer_store_dwordx4 v[24:27], v12, s[16:19], s39 offen offset:0 sc1
    v_pk_fma_f32 v[40:41], v[74:75], v[56:57], v[40:41] op_sel_hi:[0,1,1] neg_lo:[1,0,0] neg_hi:[1,0,0]
    v_pk_fma_f32 v[42:43], v[74:75], v[58:59], v[42:43] op_sel_hi:[0,1,1] neg_lo:[1,0,0] neg_hi:[1,0,0]
    v_pk_mul_f32 v[122:123], v[40:41], v[40:41]
    v_pk_mul_f32 v[124:125], v[42:43], v[42:43]
    v_pk_fma_f32 v[122:123], v[122:123], v[136:137], v[136:137] op_sel:[0,1,0] op_sel_hi:[1,1,0]
    v_pk_fma_f32 v[124:125], v[124:125], v[136:137], v[136:137] op_sel:[0,1,0] op_sel_hi:[1,1,0]
    v_pk_mul_f32 v[122:123], v[122:123], v[40:41]
    v_pk_mul_f32 v[124:125], v[124:125], v[42:43]
    v_exp_f32 v122, v122
    v_exp_f32 v123, v123
    v_exp_f32 v124, v124
    v_exp_f32 v125, v125
    v_pk_fma_f32 v[122:123], v[122:123], v[74:75], v[74:75] op_sel:[0,1,1] op_sel_hi:[1,1,1]
    v_pk_fma_f32 v[124:125], v[124:125], v[74:75], v[74:75] op_sel:[0,1,1] op_sel_hi:[1,1,1]
    v_rcp_f32 v122, v122
    v_rcp_f32 v123, v123
    v_rcp_f32 v124, v124
    v_rcp_f32 v125, v125
    v_pk_mul_f32 v[40:41], v[40:41], v[122:123]
    v_pk_mul_f32 v[42:43], v[42:43], v[124:125]
    v_pk_fma_f32 v[44:45], v[74:75], v[60:61], v[44:45] op_sel_hi:[0,1,1] neg_lo:[1,0,0] neg_hi:[1,0,0]
    v_pk_fma_f32 v[46:47], v[74:75], v[62:63], v[46:47] op_sel_hi:[0,1,1] neg_lo:[1,0,0] neg_hi:[1,0,0]
    v_pk_mul_f32 v[122:123], v[44:45], v[44:45]
    v_pk_mul_f32 v[124:125], v[46:47], v[46:47]
    v_pk_fma_f32 v[122:123], v[122:123], v[136:137], v[136:137] op_sel:[0,1,0] op_sel_hi:[1,1,0]
    v_pk_fma_f32 v[124:125], v[124:125], v[136:137], v[136:137] op_sel:[0,1,0] op_sel_hi:[1,1,0]
    v_pk_mul_f32 v[122:123], v[122:123], v[44:45]
    v_pk_mul_f32 v[124:125], v[124:125], v[46:47]
    v_exp_f32 v122, v122
    v_exp_f32 v123, v123
    v_exp_f32 v124, v124
    v_exp_f32 v125, v125
    v_pk_fma_f32 v[122:123], v[122:123], v[74:75], v[74:75] op_sel:[0,1,1] op_sel_hi:[1,1,1]
    v_pk_fma_f32 v[124:125], v[124:125], v[74:75], v[74:75] op_sel:[0,1,1] op_sel_hi:[1,1,1]
    v_rcp_f32 v122, v122
    v_rcp_f32 v123, v123
    v_rcp_f32 v124, v124
    v_rcp_f32 v125, v125
    v_pk_mul_f32 v[44:45], v[44:45], v[122:123]
    v_pk_mul_f32 v[46:47], v[46:47], v[124:125]
    v_cvt_pk_bf16_f32 v40, v40, v41
    v_cvt_pk_bf16_f32 v41, v42, v43
    v_cvt_pk_bf16_f32 v42, v44, v45
    v_cvt_pk_bf16_f32 v43, v46, v47
    v_and_or_b32 v40, v40, -2, s60
    buffer_store_dwordx4 v[40:43], v12, s[16:19], s39 offen offset:256 sc1
    v_pk_fma_f32 v[32:33], v[72:73], v[64:65], v[32:33] op_sel_hi:[0,1,1] neg_lo:[1,0,0] neg_hi:[1,0,0]
    v_pk_fma_f32 v[34:35], v[72:73], v[66:67], v[34:35] op_sel_hi:[0,1,1] neg_lo:[1,0,0] neg_hi:[1,0,0]
    v_pk_mul_f32 v[122:123], v[32:33], v[32:33]
    v_pk_mul_f32 v[124:125], v[34:35], v[34:35]
    v_pk_fma_f32 v[122:123], v[122:123], v[134:135], v[134:135] op_sel:[0,1,0] op_sel_hi:[1,1,0]
    v_pk_fma_f32 v[124:125], v[124:125], v[134:135], v[134:135] op_sel:[0,1,0] op_sel_hi:[1,1,0]
    v_pk_mul_f32 v[122:123], v[122:123], v[32:33]
    v_pk_mul_f32 v[124:125], v[124:125], v[34:35]
    v_exp_f32 v122, v122
    v_exp_f32 v123, v123
    v_exp_f32 v124, v124
    v_exp_f32 v125, v125
    v_pk_fma_f32 v[122:123], v[122:123], v[72:73], v[72:73] op_sel:[0,1,1] op_sel_hi:[1,1,1]
    v_pk_fma_f32 v[124:125], v[124:125], v[72:73], v[72:73] op_sel:[0,1,1] op_sel_hi:[1,1,1]
    v_rcp_f32 v122, v122
    v_rcp_f32 v123, v123
    v_rcp_f32 v124, v124
    v_rcp_f32 v125, v125
    v_pk_mul_f32 v[32:33], v[32:33], v[122:123]
    v_pk_mul_f32 v[34:35], v[34:35], v[124:125]
    v_pk_fma_f32 v[36:37], v[72:73], v[68:69], v[36:37] op_sel_hi:[0,1,1] neg_lo:[1,0,0] neg_hi:[1,0,0]
    v_pk_fma_f32 v[38:39], v[72:73], v[70:71], v[38:39] op_sel_hi:[0,1,1] neg_lo:[1,0,0] neg_hi:[1,0,0]
    v_pk_mul_f32 v[122:123], v[36:37], v[36:37]
    v_pk_mul_f32 v[124:125], v[38:39], v[38:39]
    v_pk_fma_f32 v[122:123], v[122:123], v[134:135], v[134:135] op_sel:[0,1,0] op_sel_hi:[1,1,0]
    v_pk_fma_f32 v[124:125], v[124:125], v[134:135], v[134:135] op_sel:[0,1,0] op_sel_hi:[1,1,0]
    v_pk_mul_f32 v[122:123], v[122:123], v[36:37]
    v_pk_mul_f32 v[124:125], v[124:125], v[38:39]
    v_exp_f32 v122, v122
    v_exp_f32 v123, v123
    v_exp_f32 v124, v124
    v_exp_f32 v125, v125
    v_pk_fma_f32 v[122:123], v[122:123], v[72:73], v[72:73] op_sel:[0,1,1] op_sel_hi:[1,1,1]
    v_pk_fma_f32 v[124:125], v[124:125], v[72:73], v[72:73] op_sel:[0,1,1] op_sel_hi:[1,1,1]
    v_rcp_f32 v122, v122
    v_rcp_f32 v123, v123
    v_rcp_f32 v124, v124
    v_rcp_f32 v125, v125
    v_pk_mul_f32 v[36:37], v[36:37], v[122:123]
    v_pk_mul_f32 v[38:39], v[38:39], v[124:125]
    v_cvt_pk_bf16_f32 v32, v32, v33
    v_cvt_pk_bf16_f32 v33, v34, v35
    v_cvt_pk_bf16_f32 v34, v36, v37
    v_cvt_pk_bf16_f32 v35, v38, v39
    v_and_or_b32 v32, v32, -2, s60
    buffer_store_dwordx4 v[32:35], v12, s[16:19], s40 offen offset:0 sc1
    v_pk_fma_f32 v[48:49], v[74:75], v[64:65], v[48:49] op_sel_hi:[0,1,1] neg_lo:[1,0,0] neg_hi:[1,0,0]
    v_pk_fma_f32 v[50:51], v[74:75], v[66:67], v[50:51] op_sel_hi:[0,1,1] neg_lo:[1,0,0] neg_hi:[1,0,0]
    v_pk_mul_f32 v[122:123], v[48:49], v[48:49]
    v_pk_mul_f32 v[124:125], v[50:51], v[50:51]
    v_pk_fma_f32 v[122:123], v[122:123], v[136:137], v[136:137] op_sel:[0,1,0] op_sel_hi:[1,1,0]
    v_pk_fma_f32 v[124:125], v[124:125], v[136:137], v[136:137] op_sel:[0,1,0] op_sel_hi:[1,1,0]
    v_pk_mul_f32 v[122:123], v[122:123], v[48:49]
    v_pk_mul_f32 v[124:125], v[124:125], v[50:51]
    v_exp_f32 v122, v122
    v_exp_f32 v123, v123
    v_exp_f32 v124, v124
    v_exp_f32 v125, v125
    v_pk_fma_f32 v[122:123], v[122:123], v[74:75], v[74:75] op_sel:[0,1,1] op_sel_hi:[1,1,1]
    v_pk_fma_f32 v[124:125], v[124:125], v[74:75], v[74:75] op_sel:[0,1,1] op_sel_hi:[1,1,1]
    v_rcp_f32 v122, v122
    v_rcp_f32 v123, v123
    v_rcp_f32 v124, v124
    v_rcp_f32 v125, v125
    v_pk_mul_f32 v[48:49], v[48:49], v[122:123]
    v_pk_mul_f32 v[50:51], v[50:51], v[124:125]
    v_pk_fma_f32 v[52:53], v[74:75], v[68:69], v[52:53] op_sel_hi:[0,1,1] neg_lo:[1,0,0] neg_hi:[1,0,0]
    v_pk_fma_f32 v[54:55], v[74:75], v[70:71], v[54:55] op_sel_hi:[0,1,1] neg_lo:[1,0,0] neg_hi:[1,0,0]
    v_pk_mul_f32 v[122:123], v[52:53], v[52:53]
    v_pk_mul_f32 v[124:125], v[54:55], v[54:55]
    v_pk_fma_f32 v[122:123], v[122:123], v[136:137], v[136:137] op_sel:[0,1,0] op_sel_hi:[1,1,0]
    v_pk_fma_f32 v[124:125], v[124:125], v[136:137], v[136:137] op_sel:[0,1,0] op_sel_hi:[1,1,0]
    v_pk_mul_f32 v[122:123], v[122:123], v[52:53]
    v_pk_mul_f32 v[124:125], v[124:125], v[54:55]
    v_exp_f32 v122, v122
    v_exp_f32 v123, v123
    v_exp_f32 v124, v124
    v_exp_f32 v125, v125
    v_pk_fma_f32 v[122:123], v[122:123], v[74:75], v[74:75] op_sel:[0,1,1] op_sel_hi:[1,1,1]
    v_pk_fma_f32 v[124:125], v[124:125], v[74:75], v[74:75] op_sel:[0,1,1] op_sel_hi:[1,1,1]
    v_rcp_f32 v122, v122
    v_rcp_f32 v123, v123
    v_rcp_f32 v124, v124
    v_rcp_f32 v125, v125
    v_pk_mul_f32 v[52:53], v[52:53], v[122:123]
    v_pk_mul_f32 v[54:55], v[54:55], v[124:125]
    v_cvt_pk_bf16_f32 v48, v48, v49
    v_cvt_pk_bf16_f32 v49, v50, v51
    v_cvt_pk_bf16_f32 v50, v52, v53
    v_cvt_pk_bf16_f32 v51, v54, v55
    v_and_or_b32 v48, v48, -2, s60
    buffer_store_dwordx4 v[48:51], v12, s[16:19], s40 offen offset:256 sc1
    s_cmp_lg_u32 s60, 0
    s_cbranch_scc1 G1_np
    s_add_u32 s53, s55, 256
    s_and_b32 s54, s29, 4
    s_lshl_b32 s54, s54, 5
    s_add_u32 s53, s53, s54
    v_mov_b32 v8, 1
    v_mov_b32 v9, 162816
    v_mov_b32 v11, 0
    s_mov_b64 exec, 1
    s_waitcnt vmcnt(0)
    ds_add_rtn_u32 v10, v9, v8
    s_waitcnt lgkmcnt(0)
    v_readfirstlane_b32 s54, v10
    s_nop 0
    s_and_b32 s54, s54, 3
    s_cmp_lg_u32 s54, 3
    s_cbranch_scc1 pub_19
    buffer_atomic_add v8, v11, s[56:59], s53 offen sc1
    v_mov_b32 v9, 162872
    ds_add_u32 v9, v8
pub_19:
    s_mov_b64 exec, -1
G1_np:
    s_add_u32 s8, s4, 0xa000000
    s_addc_u32 s9, s5, 0
    s_mov_b32 s10, 0x800000
    s_mov_b32 s11, 0x20000
    v_add_u32 v126, 0, v12
    v_add_u32 v127, 262144, v12
    s_lshl_b32 s47, s28, 2
    s_add_u32 s47, s47, s30
    s_lshl_b32 s47, s47, 9
    s_lshl_b32 s53, s94, 13
    s_add_u32 s44, s47, s53
    s_add_u32 s44, s44, 16368
    s_mov_b32 s34, s30
    s_mov_b32 s35, 0
    v_and_b32 v22, 15, v1
    v_lshrrev_b32 v23, 4, v1
    s_mul_i32 s37, s34, 2
    s_mul_i32 s38, s29, 4
    s_mul_i32 s36, s35, 4
    s_add_u32 s38, s38, s36
    s_lshr_b32 s36, s38, 1
    s_lshr_b32 s53, s36, 3
    s_lshl_b32 s53, s53, 14
    s_and_b32 s39, s36, 7
    s_lshl_b32 s39, s39, 10
    s_add_u32 s39, s39, s53
    s_lshl_b32 s36, s37, 16
    s_add_u32 s39, s39, s36
    v_add_u32 v128, 524288, v12
    v_add_u32 v129, 786432, v12
    v_add_u32 v130, 1048576, v12
    v_add_u32 v131, 1310720, v12
    v_add_u32 v132, 1572864, v12
    v_add_u32 v133, 1835008, v12
    s_add_u32 s46, s44, 4194288
    s_xor_b32 s53, s94, 1
    s_lshl_b32 s53, s53, 13
    s_add_u32 s45, s47, s53
    s_add_u32 s45, s45, 2113552
    s_add_u32 s47, s45, 4194320
    v_lshrrev_b32 v6, 2, v1
    v_mul_u32_u24 v13, 128, v6
    v_and_b32 v7, 3, v1
    v_lshl_add_u32 v13, v7, 3, v13
    v_add_u32 v13, 0, v13
    v_bfe_u32 v6, v6, 1, 2
    s_mul_i32 s36, s35, 4
    s_add_u32 s36, s36, 3
    v_xor_b32 v7, s36, v6
    v_lshl_add_u32 v16, v7, 5, v13
    s_mul_i32 s36, s35, 4
    s_add_u32 s36, s36, 2
    v_xor_b32 v7, s36, v6
    v_lshl_add_u32 v15, v7, 5, v13
    s_mul_i32 s36, s35, 4
    s_add_u32 s36, s36, 1
    v_xor_b32 v7, s36, v6
    v_lshl_add_u32 v14, v7, 5, v13
    s_mul_i32 s36, s35, 4
    s_add_u32 s36, s36, 0
    v_xor_b32 v7, s36, v6
    v_lshl_add_u32 v13, v7, 5, v13
    s_lshl_b32 s36, s37, 8
    s_add_u32 s36, s36, 160768
    v_lshlrev_b32 v7, 4, v22
    v_add_u32 v7, s36, v7
    ds_read_b64 v[56:57], v7 offset:0
    ds_read_b64 v[58:59], v7 offset:256
    s_waitcnt vmcnt(4) lgkmcnt(0)
    s_cmp_eq_u32 s60, 0
    s_cbranch_scc1 G2_ne
    s_sleep 3
    buffer_load_dwordx4 v[164:167], v126, s[8:11], s44 offen offset:0 sc1
    buffer_load_dwordx4 v[168:171], v126, s[8:11], s44 offen offset:256 sc1
    buffer_load_dwordx4 v[172:175], v127, s[8:11], s44 offen offset:0 sc1
    buffer_load_dwordx4 v[176:179], v127, s[8:11], s44 offen offset:256 sc1
G2_ne:
    v_lshlrev_b32 v24, 16, v148
    v_and_b32 v25, 0xffff0000, v148
    v_pk_add_f32 v[24:25], v[24:25], v[56:57] op_sel_hi:[1,0] neg_lo:[0,1] neg_hi:[0,1]
    v_pk_mul_f32 v[24:25], v[24:25], v[56:57] op_sel:[0,1] op_sel_hi:[1,1]
    v_lshlrev_b32 v26, 16, v149
    v_and_b32 v27, 0xffff0000, v149
    v_pk_add_f32 v[26:27], v[26:27], v[56:57] op_sel_hi:[1,0] neg_lo:[0,1] neg_hi:[0,1]
    v_pk_mul_f32 v[26:27], v[26:27], v[56:57] op_sel:[0,1] op_sel_hi:[1,1]
    v_lshlrev_b32 v28, 16, v150
    v_and_b32 v29, 0xffff0000, v150
    v_pk_add_f32 v[28:29], v[28:29], v[56:57] op_sel_hi:[1,0] neg_lo:[0,1] neg_hi:[0,1]
    v_pk_mul_f32 v[28:29], v[28:29], v[56:57] op_sel:[0,1] op_sel_hi:[1,1]
    v_lshlrev_b32 v30, 16, v151
    v_and_b32 v31, 0xffff0000, v151
    v_pk_add_f32 v[30:31], v[30:31], v[56:57] op_sel_hi:[1,0] neg_lo:[0,1] neg_hi:[0,1]
    v_pk_mul_f32 v[30:31], v[30:31], v[56:57] op_sel:[0,1] op_sel_hi:[1,1]
    v_lshlrev_b32 v32, 16, v152
    v_and_b32 v33, 0xffff0000, v152
    v_pk_add_f32 v[32:33], v[32:33], v[56:57] op_sel_hi:[1,0] neg_lo:[0,1] neg_hi:[0,1]
    v_pk_mul_f32 v[32:33], v[32:33], v[56:57] op_sel:[0,1] op_sel_hi:[1,1]
    v_lshlrev_b32 v34, 16, v153
    v_and_b32 v35, 0xffff0000, v153
    v_pk_add_f32 v[34:35], v[34:35], v[56:57] op_sel_hi:[1,0] neg_lo:[0,1] neg_hi:[0,1]
    v_pk_mul_f32 v[34:35], v[34:35], v[56:57] op_sel:[0,1] op_sel_hi:[1,1]
    v_lshlrev_b32 v36, 16, v154
    v_and_b32 v37, 0xffff0000, v154
    v_pk_add_f32 v[36:37], v[36:37], v[56:57] op_sel_hi:[1,0] neg_lo:[0,1] neg_hi:[0,1]
    v_pk_mul_f32 v[36:37], v[36:37], v[56:57] op_sel:[0,1] op_sel_hi:[1,1]
    v_lshlrev_b32 v38, 16, v155
    v_and_b32 v39, 0xffff0000, v155
    v_pk_add_f32 v[38:39], v[38:39], v[56:57] op_sel_hi:[1,0] neg_lo:[0,1] neg_hi:[0,1]
    v_pk_mul_f32 v[38:39], v[38:39], v[56:57] op_sel:[0,1] op_sel_hi:[1,1]
    v_lshlrev_b32 v40, 16, v156
    v_and_b32 v41, 0xffff0000, v156
    v_pk_add_f32 v[40:41], v[40:41], v[58:59] op_sel_hi:[1,0] neg_lo:[0,1] neg_hi:[0,1]
    v_pk_mul_f32 v[40:41], v[40:41], v[58:59] op_sel:[0,1] op_sel_hi:[1,1]
    v_lshlrev_b32 v42, 16, v157
    v_and_b32 v43, 0xffff0000, v157
    v_pk_add_f32 v[42:43], v[42:43], v[58:59] op_sel_hi:[1,0] neg_lo:[0,1] neg_hi:[0,1]
    v_pk_mul_f32 v[42:43], v[42:43], v[58:59] op_sel:[0,1] op_sel_hi:[1,1]
    v_lshlrev_b32 v44, 16, v158
    v_and_b32 v45, 0xffff0000, v158
    v_pk_add_f32 v[44:45], v[44:45], v[58:59] op_sel_hi:[1,0] neg_lo:[0,1] neg_hi:[0,1]
    v_pk_mul_f32 v[44:45], v[44:45], v[58:59] op_sel:[0,1] op_sel_hi:[1,1]
    v_lshlrev_b32 v46, 16, v159
    v_and_b32 v47, 0xffff0000, v159
    v_pk_add_f32 v[46:47], v[46:47], v[58:59] op_sel_hi:[1,0] neg_lo:[0,1] neg_hi:[0,1]
    v_pk_mul_f32 v[46:47], v[46:47], v[58:59] op_sel:[0,1] op_sel_hi:[1,1]
    v_lshlrev_b32 v48, 16, v160
    v_and_b32 v49, 0xffff0000, v160
    v_pk_add_f32 v[48:49], v[48:49], v[58:59] op_sel_hi:[1,0] neg_lo:[0,1] neg_hi:[0,1]
    v_pk_mul_f32 v[48:49], v[48:49], v[58:59] op_sel:[0,1] op_sel_hi:[1,1]
    v_lshlrev_b32 v50, 16, v161
    v_and_b32 v51, 0xffff0000, v161
    v_pk_add_f32 v[50:51], v[50:51], v[58:59] op_sel_hi:[1,0] neg_lo:[0,1] neg_hi:[0,1]
    v_pk_mul_f32 v[50:51], v[50:51], v[58:59] op_sel:[0,1] op_sel_hi:[1,1]
    v_lshlrev_b32 v52, 16, v162
    v_and_b32 v53, 0xffff0000, v162
    v_pk_add_f32 v[52:53], v[52:53], v[58:59] op_sel_hi:[1,0] neg_lo:[0,1] neg_hi:[0,1]
    v_pk_mul_f32 v[52:53], v[52:53], v[58:59] op_sel:[0,1] op_sel_hi:[1,1]
    v_lshlrev_b32 v54, 16, v163
    v_and_b32 v55, 0xffff0000, v163
    v_pk_add_f32 v[54:55], v[54:55], v[58:59] op_sel_hi:[1,0] neg_lo:[0,1] neg_hi:[0,1]
    v_pk_mul_f32 v[54:55], v[54:55], v[58:59] op_sel:[0,1] op_sel_hi:[1,1]
    s_mov_b32 s43, 0
    s_add_u32 s16, s62, 0x80000
    s_addc_u32 s17, s63, 0
    s_mov_b32 s18, 0x7e000
    s_mov_b32 s19, 0x20000
    s_mov_b32 s53, 0
    s_mov_b32 s49, s44
    s_barrier
    s_cmp_eq_u32 s60, 0
    s_cbranch_scc1 dm_20z
    ds_read_b64_tr_b16 v[56:57], v13 offset:0
    ds_read_b64_tr_b16 v[58:59], v13 offset:2048
    ds_read_b64_tr_b16 v[60:61], v14 offset:0
    ds_read_b64_tr_b16 v[62:63], v14 offset:2048
    ds_read_b64_tr_b16 v[64:65], v15 offset:0
    ds_read_b64_tr_b16 v[66:67], v15 offset:2048
    ds_read_b64_tr_b16 v[68:69], v16 offset:0
    ds_read_b64_tr_b16 v[70:71], v16 offset:2048
    ds_read_b64_tr_b16 v[72:73], v13 offset:4096
    ds_read_b64_tr_b16 v[74:75], v13 offset:6144
    ds_read_b64_tr_b16 v[76:77], v14 offset:4096
    ds_read_b64_tr_b16 v[78:79], v14 offset:6144
    ds_read_b64_tr_b16 v[80:81], v15 offset:4096
    ds_read_b64_tr_b16 v[82:83], v15 offset:6144
    ds_read_b64_tr_b16 v[84:85], v16 offset:4096
    ds_read_b64_tr_b16 v[86:87], v16 offset:6144
    s_branch dm_20w
dm_20p:
    buffer_load_dwordx4 v[164:167], v126, s[8:11], s44 offen offset:0 sc1
    buffer_load_dwordx4 v[168:171], v126, s[8:11], s44 offen offset:256 sc1
    buffer_load_dwordx4 v[172:175], v127, s[8:11], s44 offen offset:0 sc1
    buffer_load_dwordx4 v[176:179], v127, s[8:11], s44 offen offset:256 sc1
dm_20w:
    s_waitcnt vmcnt(0)
    v_bitop3_b32 v17, v164, v168, v172 bitop3:0x80
    v_bitop3_b32 v17, v17, v176, s60 bitop3:0x2a
    v_cmp_ne_u32 vcc, 0, v17
    s_cbranch_vccz dm_20q
    s_sleep 2
    s_add_u32 s53, s53, 1
    s_cmp_lt_u32 s53, s61
    s_cbranch_scc1 dm_20p
    s_mov_b32 s61, 0
dm_20q:
    buffer_load_dwordx4 v[180:183], v128, s[8:11], s44 offen offset:0
    buffer_load_dwordx4 v[184:187], v128, s[8:11], s44 offen offset:256
    buffer_load_dwordx4 v[188:191], v129, s[8:11], s44 offen offset:0
    buffer_load_dwordx4 v[192:195], v129, s[8:11], s44 offen offset:256
    buffer_load_dwordx4 v[196:199], v130, s[8:11], s44 offen offset:0
    buffer_load_dwordx4 v[200:203], v130, s[8:11], s44 offen offset:256
    buffer_load_dwordx4 v[204:207], v131, s[8:11], s44 offen offset:0
    buffer_load_dwordx4 v[208:211], v131, s[8:11], s44 offen offset:256
    buffer_load_dwordx4 v[212:215], v132, s[8:11], s44 offen offset:0
    buffer_load_dwordx4 v[216:219], v132, s[8:11], s44 offen offset:256
    s_waitcnt lgkmcnt(0)
    s_branch dm_20
dm_20z:
    buffer_load_dwordx4 v[164:167], v126, s[8:11], s44 offen offset:0
    buffer_load_dwordx4 v[168:171], v126, s[8:11], s44 offen offset:256
    buffer_load_dwordx4 v[172:175], v127, s[8:11], s44 offen offset:0
    buffer_load_dwordx4 v[176:179], v127, s[8:11], s44 offen offset:256
    buffer_load_dwordx4 v[180:183], v128, s[8:11], s44 offen offset:0
    buffer_load_dwordx4 v[184:187], v128, s[8:11], s44 offen offset:256
    buffer_load_dwordx4 v[188:191], v129, s[8:11], s44 offen offset:0
    buffer_load_dwordx4 v[192:195], v129, s[8:11], s44 offen offset:256
    ds_read_b64_tr_b16 v[56:57], v13 offset:0
    ds_read_b64_tr_b16 v[58:59], v13 offset:2048
    ds_read_b64_tr_b16 v[60:61], v14 offset:0
    ds_read_b64_tr_b16 v[62:63], v14 offset:2048
    ds_read_b64_tr_b16 v[64:65], v15 offset:0
    ds_read_b64_tr_b16 v[66:67], v15 offset:2048
    ds_read_b64_tr_b16 v[68:69], v16 offset:0
    ds_read_b64_tr_b16 v[70:71], v16 offset:2048
    ds_read_b64_tr_b16 v[72:73], v13 offset:4096
    ds_read_b64_tr_b16 v[74:75], v13 offset:6144
    ds_read_b64_tr_b16 v[76:77], v14 offset:4096
    ds_read_b64_tr_b16 v[78:79], v14 offset:6144
    ds_read_b64_tr_b16 v[80:81], v15 offset:4096
    ds_read_b64_tr_b16 v[82:83], v15 offset:6144
    ds_read_b64_tr_b16 v[84:85], v16 offset:4096
    ds_read_b64_tr_b16 v[86:87], v16 offset:6144
    buffer_load_dwordx4 v[196:199], v130, s[8:11], s44 offen offset:0
    buffer_load_dwordx4 v[200:203], v130, s[8:11], s44 offen offset:256
    buffer_load_dwordx4 v[204:207], v131, s[8:11], s44 offen offset:0
    buffer_load_dwordx4 v[208:211], v131, s[8:11], s44 offen offset:256
    buffer_load_dwordx4 v[212:215], v132, s[8:11], s44 offen offset:0
    buffer_load_dwordx4 v[216:219], v132, s[8:11], s44 offen offset:256
    s_waitcnt vmcnt(10) lgkmcnt(0)
dm_20:
    v_mfma_f32_16x16x32_bf16 v[24:27], v[56:59], v[164:167], v[24:27]
    ds_read_b64_tr_b16 v[88:89], v13 offset:8192
    buffer_load_dwordx4 v[220:223], v133, s[8:11], s44 offen offset:0
    v_mfma_f32_16x16x32_bf16 v[40:43], v[56:59], v[168:171], v[40:43]
    ds_read_b64_tr_b16 v[90:91], v13 offset:10240
    buffer_load_dwordx4 v[224:227], v133, s[8:11], s44 offen offset:256
    v_mfma_f32_16x16x32_bf16 v[44:47], v[60:63], v[168:171], v[44:47]
    ds_read_b64_tr_b16 v[92:93], v14 offset:8192
    s_mov_b32 s44, s45
    v_mfma_f32_16x16x32_bf16 v[28:31], v[60:63], v[164:167], v[28:31]
    ds_read_b64_tr_b16 v[94:95], v14 offset:10240
    s_mov_b32 s45, s46
    v_mfma_f32_16x16x32_bf16 v[32:35], v[64:67], v[164:167], v[32:35]
    ds_read_b64_tr_b16 v[96:97], v15 offset:8192
    s_mov_b32 s46, s47
    v_mfma_f32_16x16x32_bf16 v[48:51], v[64:67], v[168:171], v[48:51]
    ds_read_b64_tr_b16 v[98:99], v15 offset:10240
    s_mov_b32 s47, 8388608
    v_mfma_f32_16x16x32_bf16 v[52:55], v[68:71], v[168:171], v[52:55]
    ds_read_b64_tr_b16 v[100:101], v16 offset:8192
    v_mfma_f32_16x16x32_bf16 v[36:39], v[68:71], v[164:167], v[36:39]
    ds_read_b64_tr_b16 v[102:103], v16 offset:10240
    s_waitcnt lgkmcnt(8)
    v_mfma_f32_16x16x32_bf16 v[24:27], v[72:75], v[172:175], v[24:27]
    ds_read_b64_tr_b16 v[104:105], v13 offset:12288
    buffer_load_dwordx4 v[164:167], v126, s[8:11], s44 offen offset:0
    v_mfma_f32_16x16x32_bf16 v[40:43], v[72:75], v[176:179], v[40:43]
    ds_read_b64_tr_b16 v[106:107], v13 offset:14336
    buffer_load_dwordx4 v[168:171], v126, s[8:11], s44 offen offset:256
    v_mfma_f32_16x16x32_bf16 v[44:47], v[76:79], v[176:179], v[44:47]
    ds_read_b64_tr_b16 v[108:109], v14 offset:12288
    s_waitcnt vmcnt(10)
    v_mfma_f32_16x16x32_bf16 v[28:31], v[76:79], v[172:175], v[28:31]
    ds_read_b64_tr_b16 v[110:111], v14 offset:14336
    v_bitop3_b32 v17, v180, v184, v188 bitop3:0x80
    v_mfma_f32_16x16x32_bf16 v[32:35], v[80:83], v[172:175], v[32:35]
    ds_read_b64_tr_b16 v[112:113], v15 offset:12288
    v_bitop3_b32 v17, v17, v192, s60 bitop3:0x2a
    v_mfma_f32_16x16x32_bf16 v[48:51], v[80:83], v[176:179], v[48:51]
    ds_read_b64_tr_b16 v[114:115], v15 offset:14336
    v_cmp_ne_u32 vcc, 0, v17
    v_mfma_f32_16x16x32_bf16 v[52:55], v[84:87], v[176:179], v[52:55]
    ds_read_b64_tr_b16 v[116:117], v16 offset:12288
    ds_read_b64_tr_b16 v[118:119], v16 offset:14336
    v_mfma_f32_16x16x32_bf16 v[36:39], v[84:87], v[172:175], v[36:39]
    s_waitcnt lgkmcnt(8)
    s_cbranch_vccnz dm_20f0
dm_20g0:
    v_mfma_f32_16x16x32_bf16 v[24:27], v[88:91], v[180:183], v[24:27]
    ds_read_b64_tr_b16 v[56:57], v13 offset:16384
    buffer_load_dwordx4 v[172:175], v127, s[8:11], s44 offen offset:0
    v_mfma_f32_16x16x32_bf16 v[40:43], v[88:91], v[184:187], v[40:43]
    ds_read_b64_tr_b16 v[58:59], v13 offset:18432
    buffer_load_dwordx4 v[176:179], v127, s[8:11], s44 offen offset:256
    v_mfma_f32_16x16x32_bf16 v[44:47], v[92:95], v[184:187], v[44:47]
    ds_read_b64_tr_b16 v[60:61], v14 offset:16384
    v_mfma_f32_16x16x32_bf16 v[28:31], v[92:95], v[180:183], v[28:31]
    ds_read_b64_tr_b16 v[62:63], v14 offset:18432
    v_mfma_f32_16x16x32_bf16 v[32:35], v[96:99], v[180:183], v[32:35]
    ds_read_b64_tr_b16 v[64:65], v15 offset:16384
    v_mfma_f32_16x16x32_bf16 v[48:51], v[96:99], v[184:187], v[48:51]
    ds_read_b64_tr_b16 v[66:67], v15 offset:18432
    v_mfma_f32_16x16x32_bf16 v[52:55], v[100:103], v[184:187], v[52:55]
    ds_read_b64_tr_b16 v[68:69], v16 offset:16384
    v_mfma_f32_16x16x32_bf16 v[36:39], v[100:103], v[180:183], v[36:39]
    ds_read_b64_tr_b16 v[70:71], v16 offset:18432
    s_waitcnt lgkmcnt(8)
    v_mfma_f32_16x16x32_bf16 v[24:27], v[104:107], v[188:191], v[24:27]
    ds_read_b64_tr_b16 v[72:73], v13 offset:20480
    buffer_load_dwordx4 v[180:183], v128, s[8:11], s44 offen offset:0
    v_mfma_f32_16x16x32_bf16 v[40:43], v[104:107], v[192:195], v[40:43]
    ds_read_b64_tr_b16 v[74:75], v13 offset:22528
    buffer_load_dwordx4 v[184:187], v128, s[8:11], s44 offen offset:256
    v_mfma_f32_16x16x32_bf16 v[44:47], v[108:111], v[192:195], v[44:47]
    ds_read_b64_tr_b16 v[76:77], v14 offset:20480
    s_waitcnt vmcnt(10)
    v_mfma_f32_16x16x32_bf16 v[28:31], v[108:111], v[188:191], v[28:31]
    ds_read_b64_tr_b16 v[78:79], v14 offset:22528
    v_bitop3_b32 v17, v196, v200, v204 bitop3:0x80
    v_mfma_f32_16x16x32_bf16 v[32:35], v[112:115], v[188:191], v[32:35]
    ds_read_b64_tr_b16 v[80:81], v15 offset:20480
    v_bitop3_b32 v17, v17, v208, s60 bitop3:0x2a
    v_mfma_f32_16x16x32_bf16 v[48:51], v[112:115], v[192:195], v[48:51]
    ds_read_b64_tr_b16 v[82:83], v15 offset:22528
    v_cmp_ne_u32 vcc, 0, v17
    v_mfma_f32_16x16x32_bf16 v[52:55], v[116:119], v[192:195], v[52:55]
    ds_read_b64_tr_b16 v[84:85], v16 offset:20480
    ds_read_b64_tr_b16 v[86:87], v16 offset:22528
    v_mfma_f32_16x16x32_bf16 v[36:39], v[116:119], v[188:191], v[36:39]
    s_waitcnt lgkmcnt(8)
    s_cbranch_vccnz dm_20f1
dm_20g1:
    v_mfma_f32_16x16x32_bf16 v[24:27], v[56:59], v[196:199], v[24:27]
    ds_read_b64_tr_b16 v[88:89], v13 offset:24576
    buffer_load_dwordx4 v[188:191], v129, s[8:11], s44 offen offset:0
    v_mfma_f32_16x16x32_bf16 v[40:43], v[56:59], v[200:203], v[40:43]
    ds_read_b64_tr_b16 v[90:91], v13 offset:26624
    buffer_load_dwordx4 v[192:195], v129, s[8:11], s44 offen offset:256
    v_mfma_f32_16x16x32_bf16 v[44:47], v[60:63], v[200:203], v[44:47]
    ds_read_b64_tr_b16 v[92:93], v14 offset:24576
    s_add_u32 s43, s43, 1
    v_mfma_f32_16x16x32_bf16 v[28:31], v[60:63], v[196:199], v[28:31]
    ds_read_b64_tr_b16 v[94:95], v14 offset:26624
    s_cmp_eq_u32 s43, 4
    v_mfma_f32_16x16x32_bf16 v[32:35], v[64:67], v[196:199], v[32:35]
    ds_read_b64_tr_b16 v[96:97], v15 offset:24576
    v_mfma_f32_16x16x32_bf16 v[48:51], v[64:67], v[200:203], v[48:51]
    ds_read_b64_tr_b16 v[98:99], v15 offset:26624
    v_mfma_f32_16x16x32_bf16 v[52:55], v[68:71], v[200:203], v[52:55]
    ds_read_b64_tr_b16 v[100:101], v16 offset:24576
    v_mfma_f32_16x16x32_bf16 v[36:39], v[68:71], v[196:199], v[36:39]
    ds_read_b64_tr_b16 v[102:103], v16 offset:26624
    s_waitcnt lgkmcnt(8)
    v_mfma_f32_16x16x32_bf16 v[24:27], v[72:75], v[204:207], v[24:27]
    ds_read_b64_tr_b16 v[104:105], v13 offset:28672
    buffer_load_dwordx4 v[196:199], v130, s[8:11], s44 offen offset:0
    v_mfma_f32_16x16x32_bf16 v[40:43], v[72:75], v[208:211], v[40:43]
    ds_read_b64_tr_b16 v[106:107], v13 offset:30720
    buffer_load_dwordx4 v[200:203], v130, s[8:11], s44 offen offset:256
    v_mfma_f32_16x16x32_bf16 v[44:47], v[76:79], v[208:211], v[44:47]
    ds_read_b64_tr_b16 v[108:109], v14 offset:28672
    s_waitcnt vmcnt(10)
    v_mfma_f32_16x16x32_bf16 v[28:31], v[76:79], v[204:207], v[28:31]
    ds_read_b64_tr_b16 v[110:111], v14 offset:30720
    v_add_u32 v13, 32768, v13
    v_bitop3_b32 v17, v212, v216, v220 bitop3:0x80
    v_mfma_f32_16x16x32_bf16 v[32:35], v[80:83], v[204:207], v[32:35]
    ds_read_b64_tr_b16 v[112:113], v15 offset:28672
    v_add_u32 v14, 32768, v14
    v_bitop3_b32 v17, v17, v224, s60 bitop3:0x2a
    v_mfma_f32_16x16x32_bf16 v[48:51], v[80:83], v[208:211], v[48:51]
    ds_read_b64_tr_b16 v[114:115], v15 offset:30720
    v_add_u32 v15, 32768, v15
    v_cmp_ne_u32 vcc, 0, v17
    v_mfma_f32_16x16x32_bf16 v[52:55], v[84:87], v[208:211], v[52:55]
    ds_read_b64_tr_b16 v[116:117], v16 offset:28672
    ds_read_b64_tr_b16 v[118:119], v16 offset:30720
    v_mfma_f32_16x16x32_bf16 v[36:39], v[84:87], v[204:207], v[36:39]
    v_add_u32 v16, 32768, v16
    s_waitcnt lgkmcnt(8)
    s_cbranch_vccnz dm_20f2
dm_20g2:
    s_cbranch_scc1 dm_20x
    v_mfma_f32_16x16x32_bf16 v[24:27], v[88:91], v[212:215], v[24:27]
    ds_read_b64_tr_b16 v[56:57], v13 offset:0
    buffer_load_dwordx4 v[204:207], v131, s[8:11], s44 offen offset:0
    v_mfma_f32_16x16x32_bf16 v[40:43], v[88:91], v[216:219], v[40:43]
    ds_read_b64_tr_b16 v[58:59], v13 offset:2048
    buffer_load_dwordx4 v[208:211], v131, s[8:11], s44 offen offset:256
    v_mfma_f32_16x16x32_bf16 v[44:47], v[92:95], v[216:219], v[44:47]
    ds_read_b64_tr_b16 v[60:61], v14 offset:0
    s_mov_b32 s49, s44
    v_mfma_f32_16x16x32_bf16 v[28:31], v[92:95], v[212:215], v[28:31]
    ds_read_b64_tr_b16 v[62:63], v14 offset:2048
    v_mfma_f32_16x16x32_bf16 v[32:35], v[96:99], v[212:215], v[32:35]
    ds_read_b64_tr_b16 v[64:65], v15 offset:0
    v_mfma_f32_16x16x32_bf16 v[48:51], v[96:99], v[216:219], v[48:51]
    ds_read_b64_tr_b16 v[66:67], v15 offset:2048
    v_mfma_f32_16x16x32_bf16 v[52:55], v[100:103], v[216:219], v[52:55]
    ds_read_b64_tr_b16 v[68:69], v16 offset:0
    v_mfma_f32_16x16x32_bf16 v[36:39], v[100:103], v[212:215], v[36:39]
    ds_read_b64_tr_b16 v[70:71], v16 offset:2048
    s_waitcnt lgkmcnt(8)
    v_mfma_f32_16x16x32_bf16 v[24:27], v[104:107], v[220:223], v[24:27]
    ds_read_b64_tr_b16 v[72:73], v13 offset:4096
    buffer_load_dwordx4 v[212:215], v132, s[8:11], s44 offen offset:0
    v_mfma_f32_16x16x32_bf16 v[40:43], v[104:107], v[224:227], v[40:43]
    ds_read_b64_tr_b16 v[74:75], v13 offset:6144
    buffer_load_dwordx4 v[216:219], v132, s[8:11], s44 offen offset:256
    v_mfma_f32_16x16x32_bf16 v[44:47], v[108:111], v[224:227], v[44:47]
    ds_read_b64_tr_b16 v[76:77], v14 offset:4096
    s_waitcnt vmcnt(10)
    v_mfma_f32_16x16x32_bf16 v[28:31], v[108:111], v[220:223], v[28:31]
    ds_read_b64_tr_b16 v[78:79], v14 offset:6144
    v_bitop3_b32 v17, v164, v168, v172 bitop3:0x80
    v_mfma_f32_16x16x32_bf16 v[32:35], v[112:115], v[220:223], v[32:35]
    ds_read_b64_tr_b16 v[80:81], v15 offset:4096
    v_bitop3_b32 v17, v17, v176, s60 bitop3:0x2a
    v_mfma_f32_16x16x32_bf16 v[48:51], v[112:115], v[224:227], v[48:51]
    ds_read_b64_tr_b16 v[82:83], v15 offset:6144
    v_cmp_ne_u32 vcc, 0, v17
    v_mfma_f32_16x16x32_bf16 v[52:55], v[116:119], v[224:227], v[52:55]
    ds_read_b64_tr_b16 v[84:85], v16 offset:4096
    ds_read_b64_tr_b16 v[86:87], v16 offset:6144
    v_mfma_f32_16x16x32_bf16 v[36:39], v[116:119], v[220:223], v[36:39]
    s_waitcnt lgkmcnt(8)
    s_cbranch_vccnz dm_20f3
dm_20g3:
    s_branch dm_20
dm_20f0:
    s_cselect_b32 s50, 1, 0
dm_20h0:
    s_sleep 2
    buffer_load_dwordx4 v[180:183], v128, s[8:11], s49 offen offset:0 sc1
    buffer_load_dwordx4 v[184:187], v128, s[8:11], s49 offen offset:256 sc1
    buffer_load_dwordx4 v[188:191], v129, s[8:11], s49 offen offset:0 sc1
    buffer_load_dwordx4 v[192:195], v129, s[8:11], s49 offen offset:256 sc1
    buffer_load_dwordx4 v[196:199], v130, s[8:11], s49 offen offset:0 sc1
    buffer_load_dwordx4 v[200:203], v130, s[8:11], s49 offen offset:256 sc1
    buffer_load_dwordx4 v[204:207], v131, s[8:11], s49 offen offset:0 sc1
    buffer_load_dwordx4 v[208:211], v131, s[8:11], s49 offen offset:256 sc1
    buffer_load_dwordx4 v[212:215], v132, s[8:11], s49 offen offset:0 sc1
    buffer_load_dwordx4 v[216:219], v132, s[8:11], s49 offen offset:256 sc1
    buffer_load_dwordx4 v[220:223], v133, s[8:11], s49 offen offset:0 sc1
    buffer_load_dwordx4 v[224:227], v133, s[8:11], s49 offen offset:256 sc1
    buffer_load_dwordx4 v[164:167], v126, s[8:11], s44 offen offset:0 sc1
    buffer_load_dwordx4 v[168:171], v126, s[8:11], s44 offen offset:256 sc1
    s_waitcnt vmcnt(10)
    v_bitop3_b32 v17, v180, v184, v188 bitop3:0x80
    v_bitop3_b32 v17, v17, v192, s60 bitop3:0x2a
    v_cmp_ne_u32 vcc, 0, v17
    s_add_u32 s53, s53, 1
    s_cmp_ge_u32 s53, s61
    s_cselect_b32 s61, 0, s61
    s_cbranch_scc1 dm_20k0
    s_cbranch_vccnz dm_20h0
dm_20k0:
    s_cmp_eq_u32 s50, 1
    s_branch dm_20g0
dm_20f1:
    s_cselect_b32 s50, 1, 0
dm_20h1:
    s_sleep 2
    buffer_load_dwordx4 v[196:199], v130, s[8:11], s49 offen offset:0 sc1
    buffer_load_dwordx4 v[200:203], v130, s[8:11], s49 offen offset:256 sc1
    buffer_load_dwordx4 v[204:207], v131, s[8:11], s49 offen offset:0 sc1
    buffer_load_dwordx4 v[208:211], v131, s[8:11], s49 offen offset:256 sc1
    buffer_load_dwordx4 v[212:215], v132, s[8:11], s49 offen offset:0 sc1
    buffer_load_dwordx4 v[216:219], v132, s[8:11], s49 offen offset:256 sc1
    buffer_load_dwordx4 v[220:223], v133, s[8:11], s49 offen offset:0 sc1
    buffer_load_dwordx4 v[224:227], v133, s[8:11], s49 offen offset:256 sc1
    buffer_load_dwordx4 v[164:167], v126, s[8:11], s44 offen offset:0 sc1
    buffer_load_dwordx4 v[168:171], v126, s[8:11], s44 offen offset:256 sc1
    buffer_load_dwordx4 v[172:175], v127, s[8:11], s44 offen offset:0 sc1
    buffer_load_dwordx4 v[176:179], v127, s[8:11], s44 offen offset:256 sc1
    buffer_load_dwordx4 v[180:183], v128, s[8:11], s44 offen offset:0 sc1
    buffer_load_dwordx4 v[184:187], v128, s[8:11], s44 offen offset:256 sc1
    s_waitcnt vmcnt(10)
    v_bitop3_b32 v17, v196, v200, v204 bitop3:0x80
    v_bitop3_b32 v17, v17, v208, s60 bitop3:0x2a
    v_cmp_ne_u32 vcc, 0, v17
    s_add_u32 s53, s53, 1
    s_cmp_ge_u32 s53, s61
    s_cselect_b32 s61, 0, s61
    s_cbranch_scc1 dm_20k1
    s_cbranch_vccnz dm_20h1
dm_20k1:
    s_cmp_eq_u32 s50, 1
    s_branch dm_20g1
dm_20f2:
    s_cselect_b32 s50, 1, 0
dm_20h2:
    s_sleep 2
    buffer_load_dwordx4 v[212:215], v132, s[8:11], s49 offen offset:0 sc1
    buffer_load_dwordx4 v[216:219], v132, s[8:11], s49 offen offset:256 sc1
    buffer_load_dwordx4 v[220:223], v133, s[8:11], s49 offen offset:0 sc1
    buffer_load_dwordx4 v[224:227], v133, s[8:11], s49 offen offset:256 sc1
    buffer_load_dwordx4 v[164:167], v126, s[8:11], s44 offen offset:0 sc1
    buffer_load_dwordx4 v[168:171], v126, s[8:11], s44 offen offset:256 sc1
    buffer_load_dwordx4 v[172:175], v127, s[8:11], s44 offen offset:0 sc1
    buffer_load_dwordx4 v[176:179], v127, s[8:11], s44 offen offset:256 sc1
    buffer_load_dwordx4 v[180:183], v128, s[8:11], s44 offen offset:0 sc1
    buffer_load_dwordx4 v[184:187], v128, s[8:11], s44 offen offset:256 sc1
    buffer_load_dwordx4 v[188:191], v129, s[8:11], s44 offen offset:0 sc1
    buffer_load_dwordx4 v[192:195], v129, s[8:11], s44 offen offset:256 sc1
    buffer_load_dwordx4 v[196:199], v130, s[8:11], s44 offen offset:0 sc1
    buffer_load_dwordx4 v[200:203], v130, s[8:11], s44 offen offset:256 sc1
    s_waitcnt vmcnt(10)
    v_bitop3_b32 v17, v212, v216, v220 bitop3:0x80
    v_bitop3_b32 v17, v17, v224, s60 bitop3:0x2a
    v_cmp_ne_u32 vcc, 0, v17
    s_add_u32 s53, s53, 1
    s_cmp_ge_u32 s53, s61
    s_cselect_b32 s61, 0, s61
    s_cbranch_scc1 dm_20k2
    s_cbranch_vccnz dm_20h2
dm_20k2:
    s_cmp_eq_u32 s50, 1
    s_branch dm_20g2
dm_20f3:
    s_cselect_b32 s50, 1, 0
dm_20h3:
    s_sleep 2
    buffer_load_dwordx4 v[164:167], v126, s[8:11], s49 offen offset:0 sc1
    buffer_load_dwordx4 v[168:171], v126, s[8:11], s49 offen offset:256 sc1
    buffer_load_dwordx4 v[172:175], v127, s[8:11], s49 offen offset:0 sc1
    buffer_load_dwordx4 v[176:179], v127, s[8:11], s49 offen offset:256 sc1
    buffer_load_dwordx4 v[180:183], v128, s[8:11], s49 offen offset:0 sc1
    buffer_load_dwordx4 v[184:187], v128, s[8:11], s49 offen offset:256 sc1
    buffer_load_dwordx4 v[188:191], v129, s[8:11], s49 offen offset:0 sc1
    buffer_load_dwordx4 v[192:195], v129, s[8:11], s49 offen offset:256 sc1
    buffer_load_dwordx4 v[196:199], v130, s[8:11], s49 offen offset:0 sc1
    buffer_load_dwordx4 v[200:203], v130, s[8:11], s49 offen offset:256 sc1
    buffer_load_dwordx4 v[204:207], v131, s[8:11], s49 offen offset:0 sc1
    buffer_load_dwordx4 v[208:211], v131, s[8:11], s49 offen offset:256 sc1
    buffer_load_dwordx4 v[212:215], v132, s[8:11], s49 offen offset:0 sc1
    buffer_load_dwordx4 v[216:219], v132, s[8:11], s49 offen offset:256 sc1
    s_waitcnt vmcnt(10)
    v_bitop3_b32 v17, v164, v168, v172 bitop3:0x80
    v_bitop3_b32 v17, v17, v176, s60 bitop3:0x2a
    v_cmp_ne_u32 vcc, 0, v17
    s_add_u32 s53, s53, 1
    s_cmp_ge_u32 s53, s61
    s_cselect_b32 s61, 0, s61
    s_cbranch_scc1 dm_20k3
    s_cbranch_vccnz dm_20h3
dm_20k3:
    s_cmp_eq_u32 s50, 1
    s_branch dm_20g3
dm_20x:
    v_mfma_f32_16x16x32_bf16 v[24:27], v[88:91], v[212:215], v[24:27]
    v_mfma_f32_16x16x32_bf16 v[40:43], v[88:91], v[216:219], v[40:43]
    v_mfma_f32_16x16x32_bf16 v[44:47], v[92:95], v[216:219], v[44:47]
    v_mfma_f32_16x16x32_bf16 v[28:31], v[92:95], v[212:215], v[28:31]
    v_mfma_f32_16x16x32_bf16 v[32:35], v[96:99], v[212:215], v[32:35]
    v_mfma_f32_16x16x32_bf16 v[48:51], v[96:99], v[216:219], v[48:51]
    v_mfma_f32_16x16x32_bf16 v[52:55], v[100:103], v[216:219], v[52:55]
    v_mfma_f32_16x16x32_bf16 v[36:39], v[100:103], v[212:215], v[36:39]
    s_waitcnt lgkmcnt(0)
    v_mfma_f32_16x16x32_bf16 v[24:27], v[104:107], v[220:223], v[24:27]
    s_add_u32 s44, s62, 0x5c8000
    v_mfma_f32_16x16x32_bf16 v[40:43], v[104:107], v[224:227], v[40:43]
    s_addc_u32 s45, s63, 0
    v_mfma_f32_16x16x32_bf16 v[44:47], v[108:111], v[224:227], v[44:47]
    v_mfma_f32_16x16x32_bf16 v[28:31], v[108:111], v[220:223], v[28:31]
    s_mov_b32 s46, 0x6000
    v_mfma_f32_16x16x32_bf16 v[32:35], v[112:115], v[220:223], v[32:35]
    v_mfma_f32_16x16x32_bf16 v[48:51], v[112:115], v[224:227], v[48:51]
    s_mov_b32 s47, 0x20000
    v_mfma_f32_16x16x32_bf16 v[52:55], v[116:119], v[224:227], v[52:55]
    v_mfma_f32_16x16x32_bf16 v[36:39], v[116:119], v[220:223], v[36:39]
    s_add_u32 s36, s39, 0
    v_cvt_pk_bf16_f32 v148, v24, v25
    v_cvt_pk_bf16_f32 v149, v26, v27
    v_cvt_pk_bf16_f32 v150, v28, v29
    v_cvt_pk_bf16_f32 v151, v30, v31
    v_and_b32 v148, -2, v148
    buffer_store_dwordx4 v[148:151], v2, s[16:19], s36 offen offset:0 sc1
    v_cvt_pk_bf16_f32 v152, v32, v33
    v_cvt_pk_bf16_f32 v153, v34, v35
    v_cvt_pk_bf16_f32 v154, v36, v37
    v_cvt_pk_bf16_f32 v155, v38, v39
    v_and_b32 v152, -2, v152
    buffer_store_dwordx4 v[152:155], v2, s[16:19], s36 offen offset:1024 sc1
    s_add_u32 s36, s39, 65536
    v_cvt_pk_bf16_f32 v156, v40, v41
    v_cvt_pk_bf16_f32 v157, v42, v43
    v_cvt_pk_bf16_f32 v158, v44, v45
    v_cvt_pk_bf16_f32 v159, v46, v47
    v_and_b32 v156, -2, v156
    buffer_store_dwordx4 v[156:159], v2, s[16:19], s36 offen offset:0 sc1
    v_cvt_pk_bf16_f32 v160, v48, v49
    v_cvt_pk_bf16_f32 v161, v50, v51
    v_cvt_pk_bf16_f32 v162, v52, v53
    v_cvt_pk_bf16_f32 v163, v54, v55
    v_and_b32 v160, -2, v160
    buffer_store_dwordx4 v[160:163], v2, s[16:19], s36 offen offset:1024 sc1
    s_barrier
    s_lshl_b32 s36, s37, 11
    v_add_u32 v7, s36, v2
    ds_write_b128 v7, v[148:151] offset:0
    ds_write_b128 v7, v[152:155] offset:1024
    ds_write_b128 v7, v[156:159] offset:2048
    ds_write_b128 v7, v[160:163] offset:3072
    v_lshlrev_b32 v24, 16, v148
    v_and_b32 v25, 0xffff0000, v148
    v_lshlrev_b32 v26, 16, v149
    v_and_b32 v27, 0xffff0000, v149
    v_lshlrev_b32 v28, 16, v150
    v_and_b32 v29, 0xffff0000, v150
    v_lshlrev_b32 v30, 16, v151
    v_and_b32 v31, 0xffff0000, v151
    v_lshlrev_b32 v32, 16, v152
    v_and_b32 v33, 0xffff0000, v152
    v_lshlrev_b32 v34, 16, v153
    v_and_b32 v35, 0xffff0000, v153
    v_lshlrev_b32 v36, 16, v154
    v_and_b32 v37, 0xffff0000, v154
    v_lshlrev_b32 v38, 16, v155
    v_and_b32 v39, 0xffff0000, v155
    v_lshlrev_b32 v40, 16, v156
    v_and_b32 v41, 0xffff0000, v156
    v_lshlrev_b32 v42, 16, v157
    v_and_b32 v43, 0xffff0000, v157
    v_lshlrev_b32 v44, 16, v158
    v_and_b32 v45, 0xffff0000, v158
    v_lshlrev_b32 v46, 16, v159
    v_and_b32 v47, 0xffff0000, v159
    v_lshlrev_b32 v48, 16, v160
    v_and_b32 v49, 0xffff0000, v160
    v_lshlrev_b32 v50, 16, v161
    v_and_b32 v51, 0xffff0000, v161
    v_lshlrev_b32 v52, 16, v162
    v_and_b32 v53, 0xffff0000, v162
    v_lshlrev_b32 v54, 16, v163
    v_and_b32 v55, 0xffff0000, v163
    s_add_u32 s53, s55, 512
    v_mov_b32 v8, 1
    v_mov_b32 v9, 162816
    v_mov_b32 v11, 0
    s_mov_b64 exec, 1
    s_waitcnt vmcnt(0)
    ds_add_rtn_u32 v10, v9, v8
    s_waitcnt lgkmcnt(0)
    v_readfirstlane_b32 s54, v10
    s_nop 0
    s_and_b32 s54, s54, 3
    s_cmp_lg_u32 s54, 3
    s_cbranch_scc1 pub_21
    buffer_atomic_add v8, v11, s[56:59], s53 offen sc1
    v_mov_b32 v9, 162872
    ds_add_u32 v9, v8
pub_21:
    s_mov_b64 exec, -1
    s_waitcnt lgkmcnt(0)
    s_barrier
    v_pk_add_f32 v[140:141], v[24:25], v[26:27]
    v_pk_mul_f32 v[134:135], v[24:25], v[24:25]
    v_pk_fma_f32 v[134:135], v[26:27], v[26:27], v[134:135]
    v_pk_add_f32 v[140:141], v[140:141], v[28:29]
    v_pk_fma_f32 v[134:135], v[28:29], v[28:29], v[134:135]
    v_pk_add_f32 v[140:141], v[140:141], v[30:31]
    v_pk_fma_f32 v[134:135], v[30:31], v[30:31], v[134:135]
    v_pk_add_f32 v[140:141], v[140:141], v[32:33]
    v_pk_fma_f32 v[134:135], v[32:33], v[32:33], v[134:135]
    v_pk_add_f32 v[140:141], v[140:141], v[34:35]
    v_pk_fma_f32 v[134:135], v[34:35], v[34:35], v[134:135]
    v_pk_add_f32 v[140:141], v[140:141], v[36:37]
    v_pk_fma_f32 v[134:135], v[36:37], v[36:37], v[134:135]
    v_pk_add_f32 v[140:141], v[140:141], v[38:39]
    v_pk_fma_f32 v[134:135], v[38:39], v[38:39], v[134:135]
    v_add_f32 v136, v140, v141
    v_add_f32 v137, v134, v135
    v_mov_b32 v140, v136
    v_mov_b32 v141, v137
    s_nop 0
    v_permlane16_swap_b32 v136, v140
    v_permlane16_swap_b32 v137, v141
    v_pk_add_f32 v[136:137], v[136:137], v[140:141]
    v_mov_b32 v140, v136
    v_mov_b32 v141, v137
    s_nop 0
    v_permlane32_swap_b32 v136, v140
    v_permlane32_swap_b32 v137, v141
    v_pk_add_f32 v[136:137], v[136:137], v[140:141]
    v_pk_add_f32 v[140:141], v[40:41], v[42:43]
    v_pk_mul_f32 v[134:135], v[40:41], v[40:41]
    v_pk_fma_f32 v[134:135], v[42:43], v[42:43], v[134:135]
    v_pk_add_f32 v[140:141], v[140:141], v[44:45]
    v_pk_fma_f32 v[134:135], v[44:45], v[44:45], v[134:135]
    v_pk_add_f32 v[140:141], v[140:141], v[46:47]
    v_pk_fma_f32 v[134:135], v[46:47], v[46:47], v[134:135]
    v_pk_add_f32 v[140:141], v[140:141], v[48:49]
    v_pk_fma_f32 v[134:135], v[48:49], v[48:49], v[134:135]
    v_pk_add_f32 v[140:141], v[140:141], v[50:51]
    v_pk_fma_f32 v[134:135], v[50:51], v[50:51], v[134:135]
    v_pk_add_f32 v[140:141], v[140:141], v[52:53]
    v_pk_fma_f32 v[134:135], v[52:53], v[52:53], v[134:135]
    v_pk_add_f32 v[140:141], v[140:141], v[54:55]
    v_pk_fma_f32 v[134:135], v[54:55], v[54:55], v[134:135]
    v_add_f32 v138, v140, v141
    v_add_f32 v139, v134, v135
    v_mov_b32 v140, v138
    v_mov_b32 v141, v139
    s_nop 0
    v_permlane16_swap_b32 v138, v140
    v_permlane16_swap_b32 v139, v141
    v_pk_add_f32 v[138:139], v[138:139], v[140:141]
    v_mov_b32 v140, v138
    v_mov_b32 v141, v139
    s_nop 0
    v_permlane32_swap_b32 v138, v140
    v_permlane32_swap_b32 v139, v141
    v_pk_add_f32 v[138:139], v[138:139], v[140:141]
    v_cmp_eq_u32 vcc, 0, v23
    s_nop 1
    v_cndmask_b32 v136, v138, v136, vcc
    v_cndmask_b32 v137, v139, v137, vcc
    s_lshr_b32 s53, s29, 3
    s_lshl_b32 s53, s53, 14
    s_and_b32 s40, s29, 7
    s_lshl_b32 s40, s40, 10
    s_add_u32 s40, s40, s53
    s_lshl_b32 s36, s34, 8
    s_add_u32 s40, s40, s36
    v_lshlrev_b32 v7, 3, v1
    s_bfm_b64 exec, 32, 0
    buffer_store_dwordx2 v[136:137], v7, s[44:47], s40 offen sc1
    s_mov_b64 exec, -1
    s_lshr_b32 s34, s30, 1
    s_and_b32 s35, s30, 1
    v_and_b32 v22, 15, v1
    v_lshrrev_b32 v23, 4, v1
    s_mul_i32 s37, s34, 4
    s_mul_i32 s38, s29, 14
    s_mul_i32 s36, s35, 7
    s_add_u32 s38, s38, s36
    s_mul_i32 s36, s34, 8192
    v_add_u32 v12, s36, v2
    v_lshrrev_b32 v6, 2, v1
    v_mul_u32_u24 v13, 448, v6
    v_and_b32 v7, 3, v1
    v_lshl_add_u32 v13, v7, 3, v13
    v_add_u32 v13, 73728, v13
    s_mul_i32 s36, s35, 224
    v_add_u32 v13, s36, v13
    v_bfe_u32 v6, v1, 4, 1
    v_lshlrev_b32 v6, 5, v6
    s_cmp_eq_u32 s35, 0
    s_cselect_b32 s36, 1, -1
    v_mul_lo_u32 v6, v6, s36
    v_sub_u32 v14, v13, v6
    v_add_u32 v13, v13, v6
    v_mov_b32 v17, v12
    s_mov_b32 s42, 0
    s_mov_b32 s43, 0
    s_mov_b32 s48, 57344
    v_add_u32 v18, 57344, v13
    v_add_u32 v19, 57344, v14
    ds_read_b128 v[136:139], v17 offset:0
    ds_read_b128 v[140:143], v17 offset:2048
    ds_read_b128 v[144:147], v17 offset:4096
    ds_read_b128 v[148:151], v17 offset:6144
    ds_read_b64_tr_b16 v[152:153], v18 offset:0
    ds_read_b64_tr_b16 v[154:155], v18 offset:7168
    ds_read_b64_tr_b16 v[156:157], v19 offset:32
    ds_read_b64_tr_b16 v[158:159], v19 offset:7200
    ds_read_b64_tr_b16 v[160:161], v18 offset:64
    ds_read_b64_tr_b16 v[162:163], v18 offset:7232
    ds_read_b64_tr_b16 v[164:165], v19 offset:96
    ds_read_b64_tr_b16 v[166:167], v19 offset:7264
    ds_read_b64_tr_b16 v[168:169], v18 offset:128
    ds_read_b64_tr_b16 v[170:171], v18 offset:7296
    ds_read_b64_tr_b16 v[172:173], v19 offset:160
    ds_read_b64_tr_b16 v[174:175], v19 offset:7328
    ds_read_b64_tr_b16 v[176:177], v18 offset:192
    ds_read_b64_tr_b16 v[178:179], v18 offset:7360
    s_waitcnt lgkmcnt(12)
    v_mfma_f32_16x16x32_bf16 v[24:27], v[152:155], v[136:139], 0
    ds_read_b128 v[180:183], v17 offset:1024
    s_add_u32 s42, s42, 16384
    v_mfma_f32_16x16x32_bf16 v[52:55], v[152:155], v[140:143], 0
    ds_read_b128 v[184:187], v17 offset:3072
    s_cmp_eq_u32 s42, 49152
    v_mfma_f32_16x16x32_bf16 v[80:83], v[152:155], v[144:147], 0
    ds_read_b128 v[188:191], v17 offset:5120
    s_cselect_b32 s42, 0, s42
    v_mfma_f32_16x16x32_bf16 v[108:111], v[152:155], v[148:151], 0
    ds_read_b128 v[192:195], v17 offset:7168
    s_waitcnt lgkmcnt(14)
    v_mfma_f32_16x16x32_bf16 v[112:115], v[156:159], v[148:151], 0
    ds_read_b64_tr_b16 v[196:197], v18 offset:14336
    s_add_u32 s48, s48, 28672
    v_mfma_f32_16x16x32_bf16 v[84:87], v[156:159], v[144:147], 0
    ds_read_b64_tr_b16 v[198:199], v18 offset:21504
    s_cmp_eq_u32 s48, 86016
    v_mfma_f32_16x16x32_bf16 v[56:59], v[156:159], v[140:143], 0
    ds_read_b64_tr_b16 v[200:201], v19 offset:14368
    s_cselect_b32 s48, 0, s48
    v_mfma_f32_16x16x32_bf16 v[28:31], v[156:159], v[136:139], 0
    ds_read_b64_tr_b16 v[202:203], v19 offset:21536
    s_waitcnt lgkmcnt(8)
    v_mfma_f32_16x16x32_bf16 v[32:35], v[160:163], v[136:139], 0
    ds_read_b64_tr_b16 v[204:205], v18 offset:14400
    v_add_u32 v17, s42, v12
    v_mfma_f32_16x16x32_bf16 v[60:63], v[160:163], v[140:143], 0
    ds_read_b64_tr_b16 v[206:207], v18 offset:21568
    v_mfma_f32_16x16x32_bf16 v[88:91], v[160:163], v[144:147], 0
    ds_read_b64_tr_b16 v[208:209], v19 offset:14432
    v_mfma_f32_16x16x32_bf16 v[116:119], v[160:163], v[148:151], 0
    ds_read_b64_tr_b16 v[210:211], v19 offset:21600
    v_mfma_f32_16x16x32_bf16 v[120:123], v[164:167], v[148:151], 0
    ds_read_b64_tr_b16 v[212:213], v18 offset:14464
    v_mfma_f32_16x16x32_bf16 v[92:95], v[164:167], v[144:147], 0
    ds_read_b64_tr_b16 v[214:215], v18 offset:21632
    v_mfma_f32_16x16x32_bf16 v[64:67], v[164:167], v[140:143], 0
    ds_read_b64_tr_b16 v[216:217], v19 offset:14496
    v_mfma_f32_16x16x32_bf16 v[36:39], v[164:167], v[136:139], 0
    ds_read_b64_tr_b16 v[218:219], v19 offset:21664
    v_add_u32 v19, s48, v14
    v_mfma_f32_16x16x32_bf16 v[40:43], v[168:171], v[136:139], 0
    ds_read_b64_tr_b16 v[220:221], v18 offset:14528
    v_mfma_f32_16x16x32_bf16 v[68:71], v[168:171], v[140:143], 0
    ds_read_b64_tr_b16 v[222:223], v18 offset:21696
    v_add_u32 v18, s48, v13
    v_mfma_f32_16x16x32_bf16 v[96:99], v[168:171], v[144:147], 0
    v_mfma_f32_16x16x32_bf16 v[124:127], v[168:171], v[148:151], 0
    v_mfma_f32_16x16x32_bf16 v[128:131], v[172:175], v[148:151], 0
    v_mfma_f32_16x16x32_bf16 v[100:103], v[172:175], v[144:147], 0
    v_mfma_f32_16x16x32_bf16 v[72:75], v[172:175], v[140:143], 0
    v_mfma_f32_16x16x32_bf16 v[44:47], v[172:175], v[136:139], 0
    v_mfma_f32_16x16x32_bf16 v[48:51], v[176:179], v[136:139], 0
    v_mfma_f32_16x16x32_bf16 v[76:79], v[176:179], v[140:143], 0
    v_mfma_f32_16x16x32_bf16 v[104:107], v[176:179], v[144:147], 0
    v_mfma_f32_16x16x32_bf16 v[132:135], v[176:179], v[148:151], 0
    s_waitcnt lgkmcnt(12)
    v_mfma_f32_16x16x32_bf16 v[24:27], v[196:199], v[180:183], v[24:27]
    s_add_u32 s43, s43, 1
    s_mul_i32 s36, s35, 448
    s_add_u32 s36, s36, 159744
    v_lshlrev_b32 v6, 4, v23
    v_mfma_f32_16x16x32_bf16 v[52:55], v[196:199], v[184:187], v[52:55]
    v_add_u32 v6, s36, v6
    s_lshl_b32 s36, s37, 8
    s_add_u32 s36, s36, 160768
    v_lshlrev_b32 v7, 4, v22
    v_mfma_f32_16x16x32_bf16 v[80:83], v[196:199], v[188:191], v[80:83]
    v_add_u32 v7, s36, v7
    s_add_u32 s16, s62, 0x400000
    s_addc_u32 s17, s63, 0
    s_mov_b32 s18, 0x1be000
    v_mfma_f32_16x16x32_bf16 v[108:111], v[196:199], v[192:195], v[108:111]
    s_mov_b32 s19, 0x20000
    s_mul_i32 s39, s37, 229376
    s_lshr_b32 s36, s38, 1
    s_waitcnt lgkmcnt(0)
    v_mfma_f32_16x16x32_bf16 v[112:115], v[200:203], v[192:195], v[112:115]
    s_add_u32 s36, s36, 0
    s_lshr_b32 s53, s36, 3
    s_lshl_b32 s53, s53, 14
    s_and_b32 s44, s36, 7
    v_mfma_f32_16x16x32_bf16 v[84:87], v[200:203], v[188:191], v[84:87]
    s_lshl_b32 s44, s44, 10
    s_add_u32 s44, s44, s53
    s_add_u32 s44, s44, s39
    s_lshr_b32 s36, s38, 1
    v_mfma_f32_16x16x32_bf16 v[56:59], v[200:203], v[184:187], v[56:59]
    s_add_u32 s36, s36, 1
    s_lshr_b32 s53, s36, 3
    s_lshl_b32 s53, s53, 14
    s_and_b32 s45, s36, 7
    v_mfma_f32_16x16x32_bf16 v[28:31], v[200:203], v[180:183], v[28:31]
    s_lshl_b32 s45, s45, 10
    s_add_u32 s45, s45, s53
    s_add_u32 s45, s45, s39
    s_lshr_b32 s36, s38, 1
    v_mfma_f32_16x16x32_bf16 v[32:35], v[204:207], v[180:183], v[32:35]
    s_add_u32 s36, s36, 2
    s_lshr_b32 s53, s36, 3
    s_lshl_b32 s53, s53, 14
    s_and_b32 s46, s36, 7
    v_mfma_f32_16x16x32_bf16 v[60:63], v[204:207], v[184:187], v[60:63]
    s_lshl_b32 s46, s46, 10
    s_add_u32 s46, s46, s53
    s_add_u32 s46, s46, s39
    s_lshr_b32 s36, s38, 1
    v_mfma_f32_16x16x32_bf16 v[88:91], v[204:207], v[188:191], v[88:91]
    s_add_u32 s36, s36, 3
    s_lshr_b32 s53, s36, 3
    s_lshl_b32 s53, s53, 14
    s_and_b32 s47, s36, 7
    v_mfma_f32_16x16x32_bf16 v[116:119], v[204:207], v[192:195], v[116:119]
    s_lshl_b32 s47, s47, 10
    s_add_u32 s47, s47, s53
    s_add_u32 s47, s47, s39
    v_lshrrev_b32 v226, 2, v1
    v_mfma_f32_16x16x32_bf16 v[120:123], v[208:211], v[192:195], v[120:123]
    v_mul_u32_u24 v240, 256, v226
    v_and_b32 v227, 3, v1
    v_lshl_add_u32 v240, v227, 3, v240
    v_add_u32 v240, 49152, v240
    v_mfma_f32_16x16x32_bf16 v[92:95], v[208:211], v[188:191], v[92:95]
    v_and_b32 v226, 7, v226
    s_mul_i32 s36, s35, 4
    s_add_u32 s36, s36, 3
    v_xor_b32 v227, s36, v226
    v_mfma_f32_16x16x32_bf16 v[64:67], v[208:211], v[184:187], v[64:67]
    v_lshl_add_u32 v243, v227, 5, v240
    s_mul_i32 s36, s35, 4
    s_add_u32 s36, s36, 2
    v_xor_b32 v227, s36, v226
    v_mfma_f32_16x16x32_bf16 v[36:39], v[208:211], v[180:183], v[36:39]
    v_lshl_add_u32 v242, v227, 5, v240
    s_mul_i32 s36, s35, 4
    s_add_u32 s36, s36, 1
    v_xor_b32 v227, s36, v226
    v_mfma_f32_16x16x32_bf16 v[40:43], v[212:215], v[180:183], v[40:43]
    v_lshl_add_u32 v241, v227, 5, v240
    s_mul_i32 s36, s35, 4
    s_add_u32 s36, s36, 0
    v_xor_b32 v227, s36, v226
    v_mfma_f32_16x16x32_bf16 v[68:71], v[212:215], v[184:187], v[68:71]
    v_lshl_add_u32 v240, v227, 5, v240
    s_lshl_b32 s38, s33, 3
    s_lshl_b32 s36, s35, 2
    s_add_u32 s38, s38, s36
    v_mfma_f32_16x16x32_bf16 v[96:99], v[212:215], v[188:191], v[96:99]
    s_lshr_b32 s36, s38, 1
    s_lshr_b32 s53, s36, 3
    s_lshl_b32 s53, s53, 14
    s_and_b32 s39, s36, 7
    v_mfma_f32_16x16x32_bf16 v[124:127], v[212:215], v[192:195], v[124:127]
    s_lshl_b32 s39, s39, 10
    s_add_u32 s39, s39, s53
    s_lshl_b32 s36, s37, 16
    s_add_u32 s39, s39, s36
    v_mfma_f32_16x16x32_bf16 v[128:131], v[216:219], v[192:195], v[128:131]
    s_lshl_b32 s40, s31, 17
    s_add_u32 s40, s40, s39
    s_xor_b32 s41, s31, 1
    s_lshl_b32 s41, s41, 17
    v_mfma_f32_16x16x32_bf16 v[100:103], v[216:219], v[188:191], v[100:103]
    s_add_u32 s41, s41, s39
    s_mov_b32 s84, s62
    s_mov_b32 s85, s63
    s_mov_b32 s86, 0x7e000
    v_mfma_f32_16x16x32_bf16 v[72:75], v[216:219], v[184:187], v[72:75]
    s_mov_b32 s87, 0x20000
    s_add_u32 s88, s62, 0x80000
    s_addc_u32 s89, s63, 0
    s_mov_b32 s90, 0x7e000
    v_mfma_f32_16x16x32_bf16 v[44:47], v[216:219], v[180:183], v[44:47]
    s_mov_b32 s91, 0x20000
    s_lshl_b32 s36, s37, 1
    s_add_u32 s36, s36, s35
    s_lshl_b32 s36, s36, 10
    v_mfma_f32_16x16x32_bf16 v[48:51], v[220:223], v[180:183], v[48:51]
    v_add_u32 v244, s36, v2
    v_mov_b32 v245, 1
    v_mov_b32 v246, 162880
    v_lshrrev_b32 v238, 1, v23
    v_mfma_f32_16x16x32_bf16 v[76:79], v[220:223], v[184:187], v[76:79]
    v_lshlrev_b32 v238, 8, v238
    v_lshl_add_u32 v238, v22, 4, v238
    v_and_b32 v224, 1, v23
    v_lshl_add_u32 v238, v224, 3, v238
    v_mfma_f32_16x16x32_bf16 v[104:107], v[220:223], v[188:191], v[104:107]
    v_mfma_f32_16x16x32_bf16 v[132:135], v[220:223], v[192:195], v[132:135]
    s_add_u32 s53, s55, 1408
    v_mov_b32 v8, 1
    v_mov_b32 v9, 162864
    v_mov_b32 v11, 0
    s_mov_b64 exec, 1
    s_waitcnt vmcnt(0)
    ds_add_rtn_u32 v10, v9, v8
    s_waitcnt lgkmcnt(0)
    v_readfirstlane_b32 s54, v10
    s_nop 0
    s_and_b32 s54, s54, 3
    s_cmp_lg_u32 s54, 3
    s_cbranch_scc1 pub_22
    buffer_atomic_add v8, v11, s[56:59], s53 offen sc1
pub_22:
    s_mov_b64 exec, -1
    s_barrier
    ds_read_b128 v[136:139], v17 offset:0
    ds_read_b128 v[140:143], v17 offset:2048
    ds_read_b128 v[144:147], v17 offset:4096
    ds_read_b128 v[148:151], v17 offset:6144
    ds_read_b64_tr_b16 v[152:153], v18 offset:0
    ds_read_b64_tr_b16 v[154:155], v18 offset:7168
    ds_read_b64_tr_b16 v[156:157], v19 offset:32
    ds_read_b64_tr_b16 v[158:159], v19 offset:7200
    ds_read_b64_tr_b16 v[160:161], v18 offset:64
    ds_read_b64_tr_b16 v[162:163], v18 offset:7232
    ds_read_b64_tr_b16 v[164:165], v19 offset:96
    ds_read_b64_tr_b16 v[166:167], v19 offset:7264
    ds_read_b64_tr_b16 v[168:169], v18 offset:128
    ds_read_b64_tr_b16 v[170:171], v18 offset:7296
    ds_read_b64_tr_b16 v[172:173], v19 offset:160
    ds_read_b64_tr_b16 v[174:175], v19 offset:7328
    ds_read_b64_tr_b16 v[176:177], v18 offset:192
    ds_read_b64_tr_b16 v[178:179], v18 offset:7360
    s_waitcnt lgkmcnt(12)
mm_23:
    v_mfma_f32_16x16x32_bf16 v[24:27], v[152:155], v[136:139], v[24:27]
    ds_read_b128 v[180:183], v17 offset:1024
    s_add_u32 s42, s42, 16384
    v_mfma_f32_16x16x32_bf16 v[52:55], v[152:155], v[140:143], v[52:55]
    ds_read_b128 v[184:187], v17 offset:3072
    s_cmp_eq_u32 s42, 49152
    v_mfma_f32_16x16x32_bf16 v[80:83], v[152:155], v[144:147], v[80:83]
    ds_read_b128 v[188:191], v17 offset:5120
    s_cselect_b32 s42, 0, s42
    v_mfma_f32_16x16x32_bf16 v[108:111], v[152:155], v[148:151], v[108:111]
    ds_read_b128 v[192:195], v17 offset:7168
    s_waitcnt lgkmcnt(14)
    v_mfma_f32_16x16x32_bf16 v[112:115], v[156:159], v[148:151], v[112:115]
    ds_read_b64_tr_b16 v[196:197], v18 offset:14336
    s_add_u32 s48, s48, 28672
    v_mfma_f32_16x16x32_bf16 v[84:87], v[156:159], v[144:147], v[84:87]
    ds_read_b64_tr_b16 v[198:199], v18 offset:21504
    s_cmp_eq_u32 s48, 86016
    v_mfma_f32_16x16x32_bf16 v[56:59], v[156:159], v[140:143], v[56:59]
    ds_read_b64_tr_b16 v[200:201], v19 offset:14368
    s_cselect_b32 s48, 0, s48
    v_mfma_f32_16x16x32_bf16 v[28:31], v[156:159], v[136:139], v[28:31]
    ds_read_b64_tr_b16 v[202:203], v19 offset:21536
    s_waitcnt lgkmcnt(8)
    v_mfma_f32_16x16x32_bf16 v[32:35], v[160:163], v[136:139], v[32:35]
    ds_read_b64_tr_b16 v[204:205], v18 offset:14400
    v_add_u32 v17, s42, v12
    v_mfma_f32_16x16x32_bf16 v[60:63], v[160:163], v[140:143], v[60:63]
    ds_read_b64_tr_b16 v[206:207], v18 offset:21568
    v_mfma_f32_16x16x32_bf16 v[88:91], v[160:163], v[144:147], v[88:91]
    ds_read_b64_tr_b16 v[208:209], v19 offset:14432
    v_mfma_f32_16x16x32_bf16 v[116:119], v[160:163], v[148:151], v[116:119]
    ds_read_b64_tr_b16 v[210:211], v19 offset:21600
    v_mfma_f32_16x16x32_bf16 v[120:123], v[164:167], v[148:151], v[120:123]
    ds_read_b64_tr_b16 v[212:213], v18 offset:14464
    v_mfma_f32_16x16x32_bf16 v[92:95], v[164:167], v[144:147], v[92:95]
    ds_read_b64_tr_b16 v[214:215], v18 offset:21632
    v_mfma_f32_16x16x32_bf16 v[64:67], v[164:167], v[140:143], v[64:67]
    ds_read_b64_tr_b16 v[216:217], v19 offset:14496
    v_mfma_f32_16x16x32_bf16 v[36:39], v[164:167], v[136:139], v[36:39]
    ds_read_b64_tr_b16 v[218:219], v19 offset:21664
    v_add_u32 v19, s48, v14
    v_mfma_f32_16x16x32_bf16 v[40:43], v[168:171], v[136:139], v[40:43]
    ds_read_b64_tr_b16 v[220:221], v18 offset:14528
    v_mfma_f32_16x16x32_bf16 v[68:71], v[168:171], v[140:143], v[68:71]
    ds_read_b64_tr_b16 v[222:223], v18 offset:21696
    v_add_u32 v18, s48, v13
    v_mfma_f32_16x16x32_bf16 v[96:99], v[168:171], v[144:147], v[96:99]
    v_mfma_f32_16x16x32_bf16 v[124:127], v[168:171], v[148:151], v[124:127]
    v_mfma_f32_16x16x32_bf16 v[128:131], v[172:175], v[148:151], v[128:131]
    v_mfma_f32_16x16x32_bf16 v[100:103], v[172:175], v[144:147], v[100:103]
    v_mfma_f32_16x16x32_bf16 v[72:75], v[172:175], v[140:143], v[72:75]
    v_mfma_f32_16x16x32_bf16 v[44:47], v[172:175], v[136:139], v[44:47]
    v_mfma_f32_16x16x32_bf16 v[48:51], v[176:179], v[136:139], v[48:51]
    v_mfma_f32_16x16x32_bf16 v[76:79], v[176:179], v[140:143], v[76:79]
    v_mfma_f32_16x16x32_bf16 v[104:107], v[176:179], v[144:147], v[104:107]
    v_mfma_f32_16x16x32_bf16 v[132:135], v[176:179], v[148:151], v[132:135]
    s_waitcnt lgkmcnt(12)
    v_mfma_f32_16x16x32_bf16 v[24:27], v[196:199], v[180:183], v[24:27]
    s_add_u32 s43, s43, 1
    s_cmp_lt_u32 s43, 15
    v_mfma_f32_16x16x32_bf16 v[52:55], v[196:199], v[184:187], v[52:55]
    v_mfma_f32_16x16x32_bf16 v[80:83], v[196:199], v[188:191], v[80:83]
    v_mfma_f32_16x16x32_bf16 v[108:111], v[196:199], v[192:195], v[108:111]
    s_waitcnt lgkmcnt(0)
    s_barrier
    v_mfma_f32_16x16x32_bf16 v[112:115], v[200:203], v[192:195], v[112:115]
    ds_read_b128 v[136:139], v17 offset:0
    v_mfma_f32_16x16x32_bf16 v[84:87], v[200:203], v[188:191], v[84:87]
    ds_read_b128 v[140:143], v17 offset:2048
    v_mfma_f32_16x16x32_bf16 v[56:59], v[200:203], v[184:187], v[56:59]
    ds_read_b128 v[144:147], v17 offset:4096
    v_mfma_f32_16x16x32_bf16 v[28:31], v[200:203], v[180:183], v[28:31]
    ds_read_b128 v[148:151], v17 offset:6144
    v_mfma_f32_16x16x32_bf16 v[32:35], v[204:207], v[180:183], v[32:35]
    ds_read_b64_tr_b16 v[152:153], v18 offset:0
    v_mfma_f32_16x16x32_bf16 v[60:63], v[204:207], v[184:187], v[60:63]
    ds_read_b64_tr_b16 v[154:155], v18 offset:7168
    v_mfma_f32_16x16x32_bf16 v[88:91], v[204:207], v[188:191], v[88:91]
    ds_read_b64_tr_b16 v[156:157], v19 offset:32
    v_mfma_f32_16x16x32_bf16 v[116:119], v[204:207], v[192:195], v[116:119]
    ds_read_b64_tr_b16 v[158:159], v19 offset:7200
    v_mfma_f32_16x16x32_bf16 v[120:123], v[208:211], v[192:195], v[120:123]
    ds_read_b64_tr_b16 v[160:161], v18 offset:64
    v_mfma_f32_16x16x32_bf16 v[92:95], v[208:211], v[188:191], v[92:95]
    ds_read_b64_tr_b16 v[162:163], v18 offset:7232
    v_mfma_f32_16x16x32_bf16 v[64:67], v[208:211], v[184:187], v[64:67]
    ds_read_b64_tr_b16 v[164:165], v19 offset:96
    v_mfma_f32_16x16x32_bf16 v[36:39], v[208:211], v[180:183], v[36:39]
    ds_read_b64_tr_b16 v[166:167], v19 offset:7264
    v_mfma_f32_16x16x32_bf16 v[40:43], v[212:215], v[180:183], v[40:43]
    ds_read_b64_tr_b16 v[168:169], v18 offset:128
    v_mfma_f32_16x16x32_bf16 v[68:71], v[212:215], v[184:187], v[68:71]
    ds_read_b64_tr_b16 v[170:171], v18 offset:7296
    v_mfma_f32_16x16x32_bf16 v[96:99], v[212:215], v[188:191], v[96:99]
    ds_read_b64_tr_b16 v[172:173], v19 offset:160
    v_mfma_f32_16x16x32_bf16 v[124:127], v[212:215], v[192:195], v[124:127]
    ds_read_b64_tr_b16 v[174:175], v19 offset:7328
    v_mfma_f32_16x16x32_bf16 v[128:131], v[216:219], v[192:195], v[128:131]
    ds_read_b64_tr_b16 v[176:177], v18 offset:192
    v_mfma_f32_16x16x32_bf16 v[100:103], v[216:219], v[188:191], v[100:103]
    ds_read_b64_tr_b16 v[178:179], v18 offset:7360
    v_mfma_f32_16x16x32_bf16 v[72:75], v[216:219], v[184:187], v[72:75]
    v_mfma_f32_16x16x32_bf16 v[44:47], v[216:219], v[180:183], v[44:47]
    v_mfma_f32_16x16x32_bf16 v[48:51], v[220:223], v[180:183], v[48:51]
    v_mfma_f32_16x16x32_bf16 v[76:79], v[220:223], v[184:187], v[76:79]
    v_mfma_f32_16x16x32_bf16 v[104:107], v[220:223], v[188:191], v[104:107]
    v_mfma_f32_16x16x32_bf16 v[132:135], v[220:223], v[192:195], v[132:135]
    s_waitcnt lgkmcnt(12)
    s_cbranch_scc1 mm_23
    v_mfma_f32_16x16x32_bf16 v[24:27], v[152:155], v[136:139], v[24:27]
    ds_read_b128 v[180:183], v17 offset:1024
    v_mfma_f32_16x16x32_bf16 v[52:55], v[152:155], v[140:143], v[52:55]
    ds_read_b128 v[184:187], v17 offset:3072
    v_mfma_f32_16x16x32_bf16 v[80:83], v[152:155], v[144:147], v[80:83]
    ds_read_b128 v[188:191], v17 offset:5120
    v_mfma_f32_16x16x32_bf16 v[108:111], v[152:155], v[148:151], v[108:111]
    ds_read_b128 v[192:195], v17 offset:7168
    s_waitcnt lgkmcnt(14)
    v_mfma_f32_16x16x32_bf16 v[112:115], v[156:159], v[148:151], v[112:115]
    ds_read_b64_tr_b16 v[196:197], v18 offset:14336
    v_mfma_f32_16x16x32_bf16 v[84:87], v[156:159], v[144:147], v[84:87]
    ds_read_b64_tr_b16 v[198:199], v18 offset:21504
    v_mfma_f32_16x16x32_bf16 v[56:59], v[156:159], v[140:143], v[56:59]
    ds_read_b64_tr_b16 v[200:201], v19 offset:14368
    v_mfma_f32_16x16x32_bf16 v[28:31], v[156:159], v[136:139], v[28:31]
    ds_read_b64_tr_b16 v[202:203], v19 offset:21536
    s_waitcnt lgkmcnt(8)
    v_mfma_f32_16x16x32_bf16 v[32:35], v[160:163], v[136:139], v[32:35]
    ds_read_b64_tr_b16 v[204:205], v18 offset:14400
    v_mfma_f32_16x16x32_bf16 v[60:63], v[160:163], v[140:143], v[60:63]
    ds_read_b64_tr_b16 v[206:207], v18 offset:21568
    v_mfma_f32_16x16x32_bf16 v[88:91], v[160:163], v[144:147], v[88:91]
    ds_read_b64_tr_b16 v[208:209], v19 offset:14432
    v_mfma_f32_16x16x32_bf16 v[116:119], v[160:163], v[148:151], v[116:119]
    ds_read_b64_tr_b16 v[210:211], v19 offset:21600
    v_mfma_f32_16x16x32_bf16 v[120:123], v[164:167], v[148:151], v[120:123]
    ds_read_b64_tr_b16 v[212:213], v18 offset:14464
    v_mfma_f32_16x16x32_bf16 v[92:95], v[164:167], v[144:147], v[92:95]
    ds_read_b64_tr_b16 v[214:215], v18 offset:21632
    v_mfma_f32_16x16x32_bf16 v[64:67], v[164:167], v[140:143], v[64:67]
    ds_read_b64_tr_b16 v[216:217], v19 offset:14496
    v_mfma_f32_16x16x32_bf16 v[36:39], v[164:167], v[136:139], v[36:39]
    ds_read_b64_tr_b16 v[218:219], v19 offset:21664
    v_mfma_f32_16x16x32_bf16 v[40:43], v[168:171], v[136:139], v[40:43]
    ds_read_b64_tr_b16 v[220:221], v18 offset:14528
    v_mfma_f32_16x16x32_bf16 v[68:71], v[168:171], v[140:143], v[68:71]
    ds_read_b64_tr_b16 v[222:223], v18 offset:21696
    v_mfma_f32_16x16x32_bf16 v[96:99], v[168:171], v[144:147], v[96:99]
    v_mfma_f32_16x16x32_bf16 v[124:127], v[168:171], v[148:151], v[124:127]
    v_mfma_f32_16x16x32_bf16 v[128:131], v[172:175], v[148:151], v[128:131]
    v_mfma_f32_16x16x32_bf16 v[100:103], v[172:175], v[144:147], v[100:103]
    v_mfma_f32_16x16x32_bf16 v[72:75], v[172:175], v[140:143], v[72:75]
    v_mfma_f32_16x16x32_bf16 v[44:47], v[172:175], v[136:139], v[44:47]
    v_mfma_f32_16x16x32_bf16 v[48:51], v[176:179], v[136:139], v[48:51]
    v_mfma_f32_16x16x32_bf16 v[76:79], v[176:179], v[140:143], v[76:79]
    v_mfma_f32_16x16x32_bf16 v[104:107], v[176:179], v[144:147], v[104:107]
    v_mfma_f32_16x16x32_bf16 v[132:135], v[176:179], v[148:151], v[132:135]
    s_waitcnt lgkmcnt(0)
    s_barrier
    v_mfma_f32_16x16x32_bf16 v[24:27], v[196:199], v[180:183], v[24:27]
    ds_read_b128 v[136:139], v6 offset:0
    v_mfma_f32_16x16x32_bf16 v[52:55], v[196:199], v[184:187], v[52:55]
    ds_read_b128 v[140:143], v6 offset:64
    v_mfma_f32_16x16x32_bf16 v[80:83], v[196:199], v[188:191], v[80:83]
    ds_read_b128 v[144:147], v6 offset:128
    v_mfma_f32_16x16x32_bf16 v[108:111], v[196:199], v[192:195], v[108:111]
    ds_read_b128 v[148:151], v6 offset:192
    v_mfma_f32_16x16x32_bf16 v[112:115], v[200:203], v[192:195], v[112:115]
    ds_read_b128 v[152:155], v6 offset:256
    v_mfma_f32_16x16x32_bf16 v[84:87], v[200:203], v[188:191], v[84:87]
    ds_read_b128 v[156:159], v6 offset:320
    v_mfma_f32_16x16x32_bf16 v[56:59], v[200:203], v[184:187], v[56:59]
    ds_read_b128 v[160:163], v6 offset:384
    v_mfma_f32_16x16x32_bf16 v[28:31], v[200:203], v[180:183], v[28:31]
    ds_read_b128 v[164:167], v7 offset:0
    v_mfma_f32_16x16x32_bf16 v[32:35], v[204:207], v[180:183], v[32:35]
    ds_read_b128 v[168:171], v7 offset:256
    v_mfma_f32_16x16x32_bf16 v[60:63], v[204:207], v[184:187], v[60:63]
    ds_read_b128 v[172:175], v7 offset:512
    v_mfma_f32_16x16x32_bf16 v[88:91], v[204:207], v[188:191], v[88:91]
    ds_read_b128 v[176:179], v7 offset:768
    v_mov_b32 v13, v240
    v_mfma_f32_16x16x32_bf16 v[116:119], v[204:207], v[192:195], v[116:119]
    v_add_u32 v18, 0, v240
    v_mov_b32 v14, v241
    v_mfma_f32_16x16x32_bf16 v[120:123], v[208:211], v[192:195], v[120:123]
    v_add_u32 v19, 0, v241
    v_mov_b32 v15, v242
    v_mfma_f32_16x16x32_bf16 v[92:95], v[208:211], v[188:191], v[92:95]
    v_add_u32 v20, 0, v242
    v_mov_b32 v16, v243
    v_mfma_f32_16x16x32_bf16 v[64:67], v[208:211], v[184:187], v[64:67]
    v_add_u32 v21, 0, v243
    s_mov_b32 s42, 0
    s_mov_b32 s43, 0
    v_mfma_f32_16x16x32_bf16 v[36:39], v[208:211], v[180:183], v[36:39]
    s_mov_b32 s48, 0
    v_mov_b32 v17, v12
    v_and_b32 v199, 7, v0
    v_mfma_f32_16x16x32_bf16 v[40:43], v[212:215], v[180:183], v[40:43]
    v_lshrrev_b32 v228, 6, v0
    v_lshlrev_b32 v228, 4, v228
    v_mfma_f32_16x16x32_bf16 v[68:71], v[212:215], v[184:187], v[68:71]
    v_bfe_u32 v229, v0, 3, 3
    v_add_u32 v228, v228, v229
    s_lshr_b32 s78, s29, 1
    v_mfma_f32_16x16x32_bf16 v[96:99], v[212:215], v[188:191], v[96:99]
    s_lshl_b32 s78, s78, 16
    s_and_b32 s79, s29, 1
    s_lshl_b32 s79, s79, 7
    v_mfma_f32_16x16x32_bf16 v[124:127], v[212:215], v[192:195], v[124:127]
    s_add_u32 s78, s78, s79
    s_lshr_b32 s79, s30, 1
    s_lshl_b32 s79, s79, 13
    v_mfma_f32_16x16x32_bf16 v[128:131], v[216:219], v[192:195], v[128:131]
    s_add_u32 s78, s78, s79
    v_lshlrev_b32 v196, 8, v228
    v_lshl_add_u32 v196, v199, 4, v196
    v_mfma_f32_16x16x32_bf16 v[100:103], v[216:219], v[188:191], v[100:103]
    v_add_u32 v196, s78, v196
    v_mfma_f32_16x16x32_bf16 v[72:75], v[216:219], v[184:187], v[72:75]
    v_mfma_f32_16x16x32_bf16 v[44:47], v[216:219], v[180:183], v[44:47]
    v_mfma_f32_16x16x32_bf16 v[48:51], v[220:223], v[180:183], v[48:51]
    v_mfma_f32_16x16x32_bf16 v[76:79], v[220:223], v[184:187], v[76:79]
    v_mfma_f32_16x16x32_bf16 v[104:107], v[220:223], v[188:191], v[104:107]
    v_mfma_f32_16x16x32_bf16 v[132:135], v[220:223], v[192:195], v[132:135]
    s_waitcnt lgkmcnt(0)
    s_cmp_eq_u32 s35, 1
    s_cbranch_scc1 G3_e1
    v_pk_fma_f32 v[24:25], v[164:165], v[136:137], v[24:25] op_sel_hi:[0,1,1] neg_lo:[1,0,0] neg_hi:[1,0,0]
    v_pk_fma_f32 v[26:27], v[164:165], v[138:139], v[26:27] op_sel_hi:[0,1,1] neg_lo:[1,0,0] neg_hi:[1,0,0]
    v_pk_mul_f32 v[226:227], v[24:25], v[24:25]
    v_pk_mul_f32 v[228:229], v[26:27], v[26:27]
    v_pk_fma_f32 v[226:227], v[226:227], v[166:167], v[166:167] op_sel:[0,1,0] op_sel_hi:[1,1,0]
    v_pk_fma_f32 v[228:229], v[228:229], v[166:167], v[166:167] op_sel:[0,1,0] op_sel_hi:[1,1,0]
    v_pk_mul_f32 v[226:227], v[226:227], v[24:25]
    v_pk_mul_f32 v[228:229], v[228:229], v[26:27]
    v_exp_f32 v226, v226
    v_exp_f32 v227, v227
    v_exp_f32 v228, v228
    v_exp_f32 v229, v229
    v_pk_fma_f32 v[226:227], v[226:227], v[164:165], v[164:165] op_sel:[0,1,1] op_sel_hi:[1,1,1]
    v_pk_fma_f32 v[228:229], v[228:229], v[164:165], v[164:165] op_sel:[0,1,1] op_sel_hi:[1,1,1]
    v_rcp_f32 v226, v226
    v_rcp_f32 v227, v227
    v_rcp_f32 v228, v228
    v_rcp_f32 v229, v229
    v_pk_mul_f32 v[24:25], v[24:25], v[226:227]
    v_pk_mul_f32 v[26:27], v[26:27], v[228:229]
    v_pk_fma_f32 v[28:29], v[164:165], v[140:141], v[28:29] op_sel_hi:[0,1,1] neg_lo:[1,0,0] neg_hi:[1,0,0]
    v_pk_fma_f32 v[30:31], v[164:165], v[142:143], v[30:31] op_sel_hi:[0,1,1] neg_lo:[1,0,0] neg_hi:[1,0,0]
    v_pk_mul_f32 v[226:227], v[28:29], v[28:29]
    v_pk_mul_f32 v[228:229], v[30:31], v[30:31]
    v_pk_fma_f32 v[226:227], v[226:227], v[166:167], v[166:167] op_sel:[0,1,0] op_sel_hi:[1,1,0]
    v_pk_fma_f32 v[228:229], v[228:229], v[166:167], v[166:167] op_sel:[0,1,0] op_sel_hi:[1,1,0]
    v_pk_mul_f32 v[226:227], v[226:227], v[28:29]
    v_pk_mul_f32 v[228:229], v[228:229], v[30:31]
    v_exp_f32 v226, v226
    v_exp_f32 v227, v227
    v_exp_f32 v228, v228
    v_exp_f32 v229, v229
    v_pk_fma_f32 v[226:227], v[226:227], v[164:165], v[164:165] op_sel:[0,1,1] op_sel_hi:[1,1,1]
    v_pk_fma_f32 v[228:229], v[228:229], v[164:165], v[164:165] op_sel:[0,1,1] op_sel_hi:[1,1,1]
    v_rcp_f32 v226, v226
    v_rcp_f32 v227, v227
    v_rcp_f32 v228, v228
    v_rcp_f32 v229, v229
    v_pk_mul_f32 v[28:29], v[28:29], v[226:227]
    v_pk_mul_f32 v[30:31], v[30:31], v[228:229]
    v_cvt_pk_bf16_f32 v24, v24, v25
    v_cvt_pk_bf16_f32 v25, v26, v27
    v_cvt_pk_bf16_f32 v26, v28, v29
    v_cvt_pk_bf16_f32 v27, v30, v31
    v_or_b32 v24, 1, v24
    ds_write_b128 v244, v[24:27] offset:0
    s_add_u32 s36, s44, 0
    buffer_store_dwordx4 v[24:27], v2, s[16:19], s36 offen sc1
    v_pk_fma_f32 v[52:53], v[168:169], v[136:137], v[52:53] op_sel_hi:[0,1,1] neg_lo:[1,0,0] neg_hi:[1,0,0]
    v_pk_fma_f32 v[54:55], v[168:169], v[138:139], v[54:55] op_sel_hi:[0,1,1] neg_lo:[1,0,0] neg_hi:[1,0,0]
    v_pk_mul_f32 v[226:227], v[52:53], v[52:53]
    v_pk_mul_f32 v[228:229], v[54:55], v[54:55]
    v_pk_fma_f32 v[226:227], v[226:227], v[170:171], v[170:171] op_sel:[0,1,0] op_sel_hi:[1,1,0]
    v_pk_fma_f32 v[228:229], v[228:229], v[170:171], v[170:171] op_sel:[0,1,0] op_sel_hi:[1,1,0]
    v_pk_mul_f32 v[226:227], v[226:227], v[52:53]
    v_pk_mul_f32 v[228:229], v[228:229], v[54:55]
    v_exp_f32 v226, v226
    v_exp_f32 v227, v227
    v_exp_f32 v228, v228
    v_exp_f32 v229, v229
    v_pk_fma_f32 v[226:227], v[226:227], v[168:169], v[168:169] op_sel:[0,1,1] op_sel_hi:[1,1,1]
    v_pk_fma_f32 v[228:229], v[228:229], v[168:169], v[168:169] op_sel:[0,1,1] op_sel_hi:[1,1,1]
    v_rcp_f32 v226, v226
    v_rcp_f32 v227, v227
    v_rcp_f32 v228, v228
    v_rcp_f32 v229, v229
    v_pk_mul_f32 v[52:53], v[52:53], v[226:227]
    v_pk_mul_f32 v[54:55], v[54:55], v[228:229]
    v_pk_fma_f32 v[56:57], v[168:169], v[140:141], v[56:57] op_sel_hi:[0,1,1] neg_lo:[1,0,0] neg_hi:[1,0,0]
    v_pk_fma_f32 v[58:59], v[168:169], v[142:143], v[58:59] op_sel_hi:[0,1,1] neg_lo:[1,0,0] neg_hi:[1,0,0]
    v_pk_mul_f32 v[226:227], v[56:57], v[56:57]
    v_pk_mul_f32 v[228:229], v[58:59], v[58:59]
    v_pk_fma_f32 v[226:227], v[226:227], v[170:171], v[170:171] op_sel:[0,1,0] op_sel_hi:[1,1,0]
    v_pk_fma_f32 v[228:229], v[228:229], v[170:171], v[170:171] op_sel:[0,1,0] op_sel_hi:[1,1,0]
    v_pk_mul_f32 v[226:227], v[226:227], v[56:57]
    v_pk_mul_f32 v[228:229], v[228:229], v[58:59]
    v_exp_f32 v226, v226
    v_exp_f32 v227, v227
    v_exp_f32 v228, v228
    v_exp_f32 v229, v229
    v_pk_fma_f32 v[226:227], v[226:227], v[168:169], v[168:169] op_sel:[0,1,1] op_sel_hi:[1,1,1]
    v_pk_fma_f32 v[228:229], v[228:229], v[168:169], v[168:169] op_sel:[0,1,1] op_sel_hi:[1,1,1]
    v_rcp_f32 v226, v226
    v_rcp_f32 v227, v227
    v_rcp_f32 v228, v228
    v_rcp_f32 v229, v229
    v_pk_mul_f32 v[56:57], v[56:57], v[226:227]
    v_pk_mul_f32 v[58:59], v[58:59], v[228:229]
    v_cvt_pk_bf16_f32 v52, v52, v53
    v_cvt_pk_bf16_f32 v53, v54, v55
    v_cvt_pk_bf16_f32 v54, v56, v57
    v_cvt_pk_bf16_f32 v55, v58, v59
    v_or_b32 v52, 1, v52
    ds_write_b128 v244, v[52:55] offset:2048
    s_add_u32 s36, s44, 229376
    buffer_store_dwordx4 v[52:55], v2, s[16:19], s36 offen sc1
    v_pk_fma_f32 v[80:81], v[172:173], v[136:137], v[80:81] op_sel_hi:[0,1,1] neg_lo:[1,0,0] neg_hi:[1,0,0]
    v_pk_fma_f32 v[82:83], v[172:173], v[138:139], v[82:83] op_sel_hi:[0,1,1] neg_lo:[1,0,0] neg_hi:[1,0,0]
    v_pk_mul_f32 v[226:227], v[80:81], v[80:81]
    v_pk_mul_f32 v[228:229], v[82:83], v[82:83]
    v_pk_fma_f32 v[226:227], v[226:227], v[174:175], v[174:175] op_sel:[0,1,0] op_sel_hi:[1,1,0]
    v_pk_fma_f32 v[228:229], v[228:229], v[174:175], v[174:175] op_sel:[0,1,0] op_sel_hi:[1,1,0]
    v_pk_mul_f32 v[226:227], v[226:227], v[80:81]
    v_pk_mul_f32 v[228:229], v[228:229], v[82:83]
    v_exp_f32 v226, v226
    v_exp_f32 v227, v227
    v_exp_f32 v228, v228
    v_exp_f32 v229, v229
    v_pk_fma_f32 v[226:227], v[226:227], v[172:173], v[172:173] op_sel:[0,1,1] op_sel_hi:[1,1,1]
    v_pk_fma_f32 v[228:229], v[228:229], v[172:173], v[172:173] op_sel:[0,1,1] op_sel_hi:[1,1,1]
    v_rcp_f32 v226, v226
    v_rcp_f32 v227, v227
    v_rcp_f32 v228, v228
    v_rcp_f32 v229, v229
    v_pk_mul_f32 v[80:81], v[80:81], v[226:227]
    v_pk_mul_f32 v[82:83], v[82:83], v[228:229]
    v_pk_fma_f32 v[84:85], v[172:173], v[140:141], v[84:85] op_sel_hi:[0,1,1] neg_lo:[1,0,0] neg_hi:[1,0,0]
    v_pk_fma_f32 v[86:87], v[172:173], v[142:143], v[86:87] op_sel_hi:[0,1,1] neg_lo:[1,0,0] neg_hi:[1,0,0]
    v_pk_mul_f32 v[226:227], v[84:85], v[84:85]
    v_pk_mul_f32 v[228:229], v[86:87], v[86:87]
    v_pk_fma_f32 v[226:227], v[226:227], v[174:175], v[174:175] op_sel:[0,1,0] op_sel_hi:[1,1,0]
    v_pk_fma_f32 v[228:229], v[228:229], v[174:175], v[174:175] op_sel:[0,1,0] op_sel_hi:[1,1,0]
    v_pk_mul_f32 v[226:227], v[226:227], v[84:85]
    v_pk_mul_f32 v[228:229], v[228:229], v[86:87]
    v_exp_f32 v226, v226
    v_exp_f32 v227, v227
    v_exp_f32 v228, v228
    v_exp_f32 v229, v229
    v_pk_fma_f32 v[226:227], v[226:227], v[172:173], v[172:173] op_sel:[0,1,1] op_sel_hi:[1,1,1]
    v_pk_fma_f32 v[228:229], v[228:229], v[172:173], v[172:173] op_sel:[0,1,1] op_sel_hi:[1,1,1]
    v_rcp_f32 v226, v226
    v_rcp_f32 v227, v227
    v_rcp_f32 v228, v228
    v_rcp_f32 v229, v229
    v_pk_mul_f32 v[84:85], v[84:85], v[226:227]
    v_pk_mul_f32 v[86:87], v[86:87], v[228:229]
    v_cvt_pk_bf16_f32 v80, v80, v81
    v_cvt_pk_bf16_f32 v81, v82, v83
    v_cvt_pk_bf16_f32 v82, v84, v85
    v_cvt_pk_bf16_f32 v83, v86, v87
    v_or_b32 v80, 1, v80
    ds_write_b128 v244, v[80:83] offset:4096
    s_add_u32 s36, s44, 458752
    buffer_store_dwordx4 v[80:83], v2, s[16:19], s36 offen sc1
    v_pk_fma_f32 v[108:109], v[176:177], v[136:137], v[108:109] op_sel_hi:[0,1,1] neg_lo:[1,0,0] neg_hi:[1,0,0]
    v_pk_fma_f32 v[110:111], v[176:177], v[138:139], v[110:111] op_sel_hi:[0,1,1] neg_lo:[1,0,0] neg_hi:[1,0,0]
    v_pk_mul_f32 v[226:227], v[108:109], v[108:109]
    v_pk_mul_f32 v[228:229], v[110:111], v[110:111]
    v_pk_fma_f32 v[226:227], v[226:227], v[178:179], v[178:179] op_sel:[0,1,0] op_sel_hi:[1,1,0]
    v_pk_fma_f32 v[228:229], v[228:229], v[178:179], v[178:179] op_sel:[0,1,0] op_sel_hi:[1,1,0]
    v_pk_mul_f32 v[226:227], v[226:227], v[108:109]
    v_pk_mul_f32 v[228:229], v[228:229], v[110:111]
    v_exp_f32 v226, v226
    v_exp_f32 v227, v227
    v_exp_f32 v228, v228
    v_exp_f32 v229, v229
    v_pk_fma_f32 v[226:227], v[226:227], v[176:177], v[176:177] op_sel:[0,1,1] op_sel_hi:[1,1,1]
    v_pk_fma_f32 v[228:229], v[228:229], v[176:177], v[176:177] op_sel:[0,1,1] op_sel_hi:[1,1,1]
    v_rcp_f32 v226, v226
    v_rcp_f32 v227, v227
    v_rcp_f32 v228, v228
    v_rcp_f32 v229, v229
    v_pk_mul_f32 v[108:109], v[108:109], v[226:227]
    v_pk_mul_f32 v[110:111], v[110:111], v[228:229]
    v_pk_fma_f32 v[112:113], v[176:177], v[140:141], v[112:113] op_sel_hi:[0,1,1] neg_lo:[1,0,0] neg_hi:[1,0,0]
    v_pk_fma_f32 v[114:115], v[176:177], v[142:143], v[114:115] op_sel_hi:[0,1,1] neg_lo:[1,0,0] neg_hi:[1,0,0]
    v_pk_mul_f32 v[226:227], v[112:113], v[112:113]
    v_pk_mul_f32 v[228:229], v[114:115], v[114:115]
    v_pk_fma_f32 v[226:227], v[226:227], v[178:179], v[178:179] op_sel:[0,1,0] op_sel_hi:[1,1,0]
    v_pk_fma_f32 v[228:229], v[228:229], v[178:179], v[178:179] op_sel:[0,1,0] op_sel_hi:[1,1,0]
    v_pk_mul_f32 v[226:227], v[226:227], v[112:113]
    v_pk_mul_f32 v[228:229], v[228:229], v[114:115]
    v_exp_f32 v226, v226
    v_exp_f32 v227, v227
    v_exp_f32 v228, v228
    v_exp_f32 v229, v229
    v_pk_fma_f32 v[226:227], v[226:227], v[176:177], v[176:177] op_sel:[0,1,1] op_sel_hi:[1,1,1]
    v_pk_fma_f32 v[228:229], v[228:229], v[176:177], v[176:177] op_sel:[0,1,1] op_sel_hi:[1,1,1]
    v_rcp_f32 v226, v226
    v_rcp_f32 v227, v227
    v_rcp_f32 v228, v228
    v_rcp_f32 v229, v229
    v_pk_mul_f32 v[112:113], v[112:113], v[226:227]
    v_pk_mul_f32 v[114:115], v[114:115], v[228:229]
    v_cvt_pk_bf16_f32 v108, v108, v109
    v_cvt_pk_bf16_f32 v109, v110, v111
    v_cvt_pk_bf16_f32 v110, v112, v113
    v_cvt_pk_bf16_f32 v111, v114, v115
    ds_write_b128 v244, v[108:111] offset:6144
    s_add_u32 s36, s44, 688128
    buffer_store_dwordx4 v[108:111], v2, s[16:19], s36 offen sc1
    v_pk_fma_f32 v[32:33], v[164:165], v[144:145], v[32:33] op_sel_hi:[0,1,1] neg_lo:[1,0,0] neg_hi:[1,0,0]
    v_pk_fma_f32 v[34:35], v[164:165], v[146:147], v[34:35] op_sel_hi:[0,1,1] neg_lo:[1,0,0] neg_hi:[1,0,0]
    v_pk_mul_f32 v[226:227], v[32:33], v[32:33]
    v_pk_mul_f32 v[228:229], v[34:35], v[34:35]
    v_pk_fma_f32 v[226:227], v[226:227], v[166:167], v[166:167] op_sel:[0,1,0] op_sel_hi:[1,1,0]
    v_pk_fma_f32 v[228:229], v[228:229], v[166:167], v[166:167] op_sel:[0,1,0] op_sel_hi:[1,1,0]
    v_pk_mul_f32 v[226:227], v[226:227], v[32:33]
    v_pk_mul_f32 v[228:229], v[228:229], v[34:35]
    v_exp_f32 v226, v226
    v_exp_f32 v227, v227
    v_exp_f32 v228, v228
    v_exp_f32 v229, v229
    v_pk_fma_f32 v[226:227], v[226:227], v[164:165], v[164:165] op_sel:[0,1,1] op_sel_hi:[1,1,1]
    v_pk_fma_f32 v[228:229], v[228:229], v[164:165], v[164:165] op_sel:[0,1,1] op_sel_hi:[1,1,1]
    v_rcp_f32 v226, v226
    v_rcp_f32 v227, v227
    v_rcp_f32 v228, v228
    v_rcp_f32 v229, v229
    v_pk_mul_f32 v[32:33], v[32:33], v[226:227]
    v_pk_mul_f32 v[34:35], v[34:35], v[228:229]
    v_pk_fma_f32 v[36:37], v[164:165], v[148:149], v[36:37] op_sel_hi:[0,1,1] neg_lo:[1,0,0] neg_hi:[1,0,0]
    v_pk_fma_f32 v[38:39], v[164:165], v[150:151], v[38:39] op_sel_hi:[0,1,1] neg_lo:[1,0,0] neg_hi:[1,0,0]
    v_pk_mul_f32 v[226:227], v[36:37], v[36:37]
    v_pk_mul_f32 v[228:229], v[38:39], v[38:39]
    v_pk_fma_f32 v[226:227], v[226:227], v[166:167], v[166:167] op_sel:[0,1,0] op_sel_hi:[1,1,0]
    v_pk_fma_f32 v[228:229], v[228:229], v[166:167], v[166:167] op_sel:[0,1,0] op_sel_hi:[1,1,0]
    v_pk_mul_f32 v[226:227], v[226:227], v[36:37]
    v_pk_mul_f32 v[228:229], v[228:229], v[38:39]
    v_exp_f32 v226, v226
    v_exp_f32 v227, v227
    v_exp_f32 v228, v228
    v_exp_f32 v229, v229
    v_pk_fma_f32 v[226:227], v[226:227], v[164:165], v[164:165] op_sel:[0,1,1] op_sel_hi:[1,1,1]
    v_pk_fma_f32 v[228:229], v[228:229], v[164:165], v[164:165] op_sel:[0,1,1] op_sel_hi:[1,1,1]
    v_rcp_f32 v226, v226
    v_rcp_f32 v227, v227
    v_rcp_f32 v228, v228
    v_rcp_f32 v229, v229
    v_pk_mul_f32 v[36:37], v[36:37], v[226:227]
    v_pk_mul_f32 v[38:39], v[38:39], v[228:229]
    v_cvt_pk_bf16_f32 v32, v32, v33
    v_cvt_pk_bf16_f32 v33, v34, v35
    v_cvt_pk_bf16_f32 v34, v36, v37
    v_cvt_pk_bf16_f32 v35, v38, v39
    v_or_b32 v32, 1, v32
    ds_write_b128 v244, v[32:35] offset:16384
    v_pk_fma_f32 v[60:61], v[168:169], v[144:145], v[60:61] op_sel_hi:[0,1,1] neg_lo:[1,0,0] neg_hi:[1,0,0]
    v_pk_fma_f32 v[62:63], v[168:169], v[146:147], v[62:63] op_sel_hi:[0,1,1] neg_lo:[1,0,0] neg_hi:[1,0,0]
    v_pk_mul_f32 v[226:227], v[60:61], v[60:61]
    v_pk_mul_f32 v[228:229], v[62:63], v[62:63]
    v_pk_fma_f32 v[226:227], v[226:227], v[170:171], v[170:171] op_sel:[0,1,0] op_sel_hi:[1,1,0]
    v_pk_fma_f32 v[228:229], v[228:229], v[170:171], v[170:171] op_sel:[0,1,0] op_sel_hi:[1,1,0]
    v_pk_mul_f32 v[226:227], v[226:227], v[60:61]
    v_pk_mul_f32 v[228:229], v[228:229], v[62:63]
    v_exp_f32 v226, v226
    v_exp_f32 v227, v227
    v_exp_f32 v228, v228
    v_exp_f32 v229, v229
    v_pk_fma_f32 v[226:227], v[226:227], v[168:169], v[168:169] op_sel:[0,1,1] op_sel_hi:[1,1,1]
    v_pk_fma_f32 v[228:229], v[228:229], v[168:169], v[168:169] op_sel:[0,1,1] op_sel_hi:[1,1,1]
    v_rcp_f32 v226, v226
    v_rcp_f32 v227, v227
    v_rcp_f32 v228, v228
    v_rcp_f32 v229, v229
    v_pk_mul_f32 v[60:61], v[60:61], v[226:227]
    v_pk_mul_f32 v[62:63], v[62:63], v[228:229]
    v_pk_fma_f32 v[64:65], v[168:169], v[148:149], v[64:65] op_sel_hi:[0,1,1] neg_lo:[1,0,0] neg_hi:[1,0,0]
    v_pk_fma_f32 v[66:67], v[168:169], v[150:151], v[66:67] op_sel_hi:[0,1,1] neg_lo:[1,0,0] neg_hi:[1,0,0]
    v_pk_mul_f32 v[226:227], v[64:65], v[64:65]
    v_pk_mul_f32 v[228:229], v[66:67], v[66:67]
    v_pk_fma_f32 v[226:227], v[226:227], v[170:171], v[170:171] op_sel:[0,1,0] op_sel_hi:[1,1,0]
    v_pk_fma_f32 v[228:229], v[228:229], v[170:171], v[170:171] op_sel:[0,1,0] op_sel_hi:[1,1,0]
    v_pk_mul_f32 v[226:227], v[226:227], v[64:65]
    v_pk_mul_f32 v[228:229], v[228:229], v[66:67]
    v_exp_f32 v226, v226
    v_exp_f32 v227, v227
    v_exp_f32 v228, v228
    v_exp_f32 v229, v229
    v_pk_fma_f32 v[226:227], v[226:227], v[168:169], v[168:169] op_sel:[0,1,1] op_sel_hi:[1,1,1]
    v_pk_fma_f32 v[228:229], v[228:229], v[168:169], v[168:169] op_sel:[0,1,1] op_sel_hi:[1,1,1]
    v_rcp_f32 v226, v226
    v_rcp_f32 v227, v227
    v_rcp_f32 v228, v228
    v_rcp_f32 v229, v229
    v_pk_mul_f32 v[64:65], v[64:65], v[226:227]
    v_pk_mul_f32 v[66:67], v[66:67], v[228:229]
    v_cvt_pk_bf16_f32 v60, v60, v61
    v_cvt_pk_bf16_f32 v61, v62, v63
    v_cvt_pk_bf16_f32 v62, v64, v65
    v_cvt_pk_bf16_f32 v63, v66, v67
    v_or_b32 v60, 1, v60
    ds_write_b128 v244, v[60:63] offset:18432
    s_waitcnt vmcnt(0)
    s_mov_b64 exec, 1
    ds_add_u32 v246, v245
    s_mov_b64 exec, -1
    v_pk_fma_f32 v[88:89], v[172:173], v[144:145], v[88:89] op_sel_hi:[0,1,1] neg_lo:[1,0,0] neg_hi:[1,0,0]
    v_pk_fma_f32 v[90:91], v[172:173], v[146:147], v[90:91] op_sel_hi:[0,1,1] neg_lo:[1,0,0] neg_hi:[1,0,0]
    v_pk_mul_f32 v[226:227], v[88:89], v[88:89]
    v_pk_mul_f32 v[228:229], v[90:91], v[90:91]
    v_pk_fma_f32 v[226:227], v[226:227], v[174:175], v[174:175] op_sel:[0,1,0] op_sel_hi:[1,1,0]
    v_pk_fma_f32 v[228:229], v[228:229], v[174:175], v[174:175] op_sel:[0,1,0] op_sel_hi:[1,1,0]
    v_pk_mul_f32 v[226:227], v[226:227], v[88:89]
    v_pk_mul_f32 v[228:229], v[228:229], v[90:91]
    v_exp_f32 v226, v226
    v_exp_f32 v227, v227
    v_exp_f32 v228, v228
    v_exp_f32 v229, v229
    v_pk_fma_f32 v[226:227], v[226:227], v[172:173], v[172:173] op_sel:[0,1,1] op_sel_hi:[1,1,1]
    v_pk_fma_f32 v[228:229], v[228:229], v[172:173], v[172:173] op_sel:[0,1,1] op_sel_hi:[1,1,1]
    v_rcp_f32 v226, v226
    v_rcp_f32 v227, v227
    v_rcp_f32 v228, v228
    v_rcp_f32 v229, v229
    v_pk_mul_f32 v[88:89], v[88:89], v[226:227]
    v_pk_mul_f32 v[90:91], v[90:91], v[228:229]
    v_pk_fma_f32 v[92:93], v[172:173], v[148:149], v[92:93] op_sel_hi:[0,1,1] neg_lo:[1,0,0] neg_hi:[1,0,0]
    v_pk_fma_f32 v[94:95], v[172:173], v[150:151], v[94:95] op_sel_hi:[0,1,1] neg_lo:[1,0,0] neg_hi:[1,0,0]
    v_pk_mul_f32 v[226:227], v[92:93], v[92:93]
    v_pk_mul_f32 v[228:229], v[94:95], v[94:95]
    v_pk_fma_f32 v[226:227], v[226:227], v[174:175], v[174:175] op_sel:[0,1,0] op_sel_hi:[1,1,0]
    v_pk_fma_f32 v[228:229], v[228:229], v[174:175], v[174:175] op_sel:[0,1,0] op_sel_hi:[1,1,0]
    v_pk_mul_f32 v[226:227], v[226:227], v[92:93]
    v_pk_mul_f32 v[228:229], v[228:229], v[94:95]
    v_exp_f32 v226, v226
    v_exp_f32 v227, v227
    v_exp_f32 v228, v228
    v_exp_f32 v229, v229
    v_pk_fma_f32 v[226:227], v[226:227], v[172:173], v[172:173] op_sel:[0,1,1] op_sel_hi:[1,1,1]
    v_pk_fma_f32 v[228:229], v[228:229], v[172:173], v[172:173] op_sel:[0,1,1] op_sel_hi:[1,1,1]
    v_rcp_f32 v226, v226
    v_rcp_f32 v227, v227
    v_rcp_f32 v228, v228
    v_rcp_f32 v229, v229
    v_pk_mul_f32 v[92:93], v[92:93], v[226:227]
    v_pk_mul_f32 v[94:95], v[94:95], v[228:229]
    v_cvt_pk_bf16_f32 v88, v88, v89
    v_cvt_pk_bf16_f32 v89, v90, v91
    v_cvt_pk_bf16_f32 v90, v92, v93
    v_cvt_pk_bf16_f32 v91, v94, v95
    v_or_b32 v88, 1, v88
    ds_write_b128 v244, v[88:91] offset:20480
    s_cmp_eq_u32 s60, 1
    s_cbranch_scc1 G4_p10
    buffer_load_dwordx4 v[180:183], v196, s[84:87], 0 offen offset:0 sc1
    buffer_load_dwordx4 v[188:191], v196, s[88:91], 0 offen offset:0 sc1
    buffer_load_dwordx4 v[184:187], v196, s[84:87], 0 offen offset:2048 sc1
    buffer_load_dwordx4 v[192:195], v196, s[88:91], 0 offen offset:2048 sc1
    s_branch G4_p20
G4_p10:
    s_add_u32 s36, s40, 0
    buffer_load_dwordx4 v[180:183], v2, s[84:87], s36 offen offset:0 sc1
    buffer_load_dwordx4 v[184:187], v2, s[88:91], s36 offen offset:0 sc1
    buffer_load_dwordx4 v[188:191], v2, s[84:87], s36 offen offset:1024 sc1
    buffer_load_dwordx4 v[192:195], v2, s[88:91], s36 offen offset:1024 sc1
    s_add_u32 s36, s40, 65536
    buffer_load_dwordx4 v[196:199], v2, s[84:87], s36 offen offset:0 sc1
    buffer_load_dwordx4 v[230:233], v2, s[88:91], s36 offen offset:0 sc1
    buffer_load_dwordx4 v[234:237], v2, s[84:87], s36 offen offset:1024 sc1
    buffer_load_dwordx4 v[248:251], v2, s[88:91], s36 offen offset:1024 sc1
G4_p20:
    v_pk_fma_f32 v[116:117], v[176:177], v[144:145], v[116:117] op_sel_hi:[0,1,1] neg_lo:[1,0,0] neg_hi:[1,0,0]
    v_pk_fma_f32 v[118:119], v[176:177], v[146:147], v[118:119] op_sel_hi:[0,1,1] neg_lo:[1,0,0] neg_hi:[1,0,0]
    v_pk_mul_f32 v[226:227], v[116:117], v[116:117]
    v_pk_mul_f32 v[228:229], v[118:119], v[118:119]
    v_pk_fma_f32 v[226:227], v[226:227], v[178:179], v[178:179] op_sel:[0,1,0] op_sel_hi:[1,1,0]
    v_pk_fma_f32 v[228:229], v[228:229], v[178:179], v[178:179] op_sel:[0,1,0] op_sel_hi:[1,1,0]
    v_pk_mul_f32 v[226:227], v[226:227], v[116:117]
    v_pk_mul_f32 v[228:229], v[228:229], v[118:119]
    v_exp_f32 v226, v226
    v_exp_f32 v227, v227
    v_exp_f32 v228, v228
    v_exp_f32 v229, v229
    v_pk_fma_f32 v[226:227], v[226:227], v[176:177], v[176:177] op_sel:[0,1,1] op_sel_hi:[1,1,1]
    v_pk_fma_f32 v[228:229], v[228:229], v[176:177], v[176:177] op_sel:[0,1,1] op_sel_hi:[1,1,1]
    v_rcp_f32 v226, v226
    v_rcp_f32 v227, v227
    v_rcp_f32 v228, v228
    v_rcp_f32 v229, v229
    v_pk_mul_f32 v[116:117], v[116:117], v[226:227]
    v_pk_mul_f32 v[118:119], v[118:119], v[228:229]
    v_pk_fma_f32 v[120:121], v[176:177], v[148:149], v[120:121] op_sel_hi:[0,1,1] neg_lo:[1,0,0] neg_hi:[1,0,0]
    v_pk_fma_f32 v[122:123], v[176:177], v[150:151], v[122:123] op_sel_hi:[0,1,1] neg_lo:[1,0,0] neg_hi:[1,0,0]
    v_pk_mul_f32 v[226:227], v[120:121], v[120:121]
    v_pk_mul_f32 v[228:229], v[122:123], v[122:123]
    v_pk_fma_f32 v[226:227], v[226:227], v[178:179], v[178:179] op_sel:[0,1,0] op_sel_hi:[1,1,0]
    v_pk_fma_f32 v[228:229], v[228:229], v[178:179], v[178:179] op_sel:[0,1,0] op_sel_hi:[1,1,0]
    v_pk_mul_f32 v[226:227], v[226:227], v[120:121]
    v_pk_mul_f32 v[228:229], v[228:229], v[122:123]
    v_exp_f32 v226, v226
    v_exp_f32 v227, v227
    v_exp_f32 v228, v228
    v_exp_f32 v229, v229
    v_pk_fma_f32 v[226:227], v[226:227], v[176:177], v[176:177] op_sel:[0,1,1] op_sel_hi:[1,1,1]
    v_pk_fma_f32 v[228:229], v[228:229], v[176:177], v[176:177] op_sel:[0,1,1] op_sel_hi:[1,1,1]
    v_rcp_f32 v226, v226
    v_rcp_f32 v227, v227
    v_rcp_f32 v228, v228
    v_rcp_f32 v229, v229
    v_pk_mul_f32 v[120:121], v[120:121], v[226:227]
    v_pk_mul_f32 v[122:123], v[122:123], v[228:229]
    v_cvt_pk_bf16_f32 v116, v116, v117
    v_cvt_pk_bf16_f32 v117, v118, v119
    v_cvt_pk_bf16_f32 v118, v120, v121
    v_cvt_pk_bf16_f32 v119, v122, v123
    ds_write_b128 v244, v[116:119] offset:22528
    v_pk_fma_f32 v[40:41], v[164:165], v[152:153], v[40:41] op_sel_hi:[0,1,1] neg_lo:[1,0,0] neg_hi:[1,0,0]
    v_pk_fma_f32 v[42:43], v[164:165], v[154:155], v[42:43] op_sel_hi:[0,1,1] neg_lo:[1,0,0] neg_hi:[1,0,0]
    v_pk_mul_f32 v[226:227], v[40:41], v[40:41]
    v_pk_mul_f32 v[228:229], v[42:43], v[42:43]
    v_pk_fma_f32 v[226:227], v[226:227], v[166:167], v[166:167] op_sel:[0,1,0] op_sel_hi:[1,1,0]
    v_pk_fma_f32 v[228:229], v[228:229], v[166:167], v[166:167] op_sel:[0,1,0] op_sel_hi:[1,1,0]
    v_pk_mul_f32 v[226:227], v[226:227], v[40:41]
    v_pk_mul_f32 v[228:229], v[228:229], v[42:43]
    v_exp_f32 v226, v226
    v_exp_f32 v227, v227
    v_exp_f32 v228, v228
    v_exp_f32 v229, v229
    v_pk_fma_f32 v[226:227], v[226:227], v[164:165], v[164:165] op_sel:[0,1,1] op_sel_hi:[1,1,1]
    v_pk_fma_f32 v[228:229], v[228:229], v[164:165], v[164:165] op_sel:[0,1,1] op_sel_hi:[1,1,1]
    v_rcp_f32 v226, v226
    v_rcp_f32 v227, v227
    v_rcp_f32 v228, v228
    v_rcp_f32 v229, v229
    v_pk_mul_f32 v[40:41], v[40:41], v[226:227]
    v_pk_mul_f32 v[42:43], v[42:43], v[228:229]
    v_pk_fma_f32 v[44:45], v[164:165], v[156:157], v[44:45] op_sel_hi:[0,1,1] neg_lo:[1,0,0] neg_hi:[1,0,0]
    v_pk_fma_f32 v[46:47], v[164:165], v[158:159], v[46:47] op_sel_hi:[0,1,1] neg_lo:[1,0,0] neg_hi:[1,0,0]
    v_pk_mul_f32 v[226:227], v[44:45], v[44:45]
    v_pk_mul_f32 v[228:229], v[46:47], v[46:47]
    v_pk_fma_f32 v[226:227], v[226:227], v[166:167], v[166:167] op_sel:[0,1,0] op_sel_hi:[1,1,0]
    v_pk_fma_f32 v[228:229], v[228:229], v[166:167], v[166:167] op_sel:[0,1,0] op_sel_hi:[1,1,0]
    v_pk_mul_f32 v[226:227], v[226:227], v[44:45]
    v_pk_mul_f32 v[228:229], v[228:229], v[46:47]
    v_exp_f32 v226, v226
    v_exp_f32 v227, v227
    v_exp_f32 v228, v228
    v_exp_f32 v229, v229
    v_pk_fma_f32 v[226:227], v[226:227], v[164:165], v[164:165] op_sel:[0,1,1] op_sel_hi:[1,1,1]
    v_pk_fma_f32 v[228:229], v[228:229], v[164:165], v[164:165] op_sel:[0,1,1] op_sel_hi:[1,1,1]
    v_rcp_f32 v226, v226
    v_rcp_f32 v227, v227
    v_rcp_f32 v228, v228
    v_rcp_f32 v229, v229
    v_pk_mul_f32 v[44:45], v[44:45], v[226:227]
    v_pk_mul_f32 v[46:47], v[46:47], v[228:229]
    v_cvt_pk_bf16_f32 v200, v40, v41
    v_cvt_pk_bf16_f32 v201, v42, v43
    v_cvt_pk_bf16_f32 v202, v44, v45
    v_cvt_pk_bf16_f32 v203, v46, v47
    v_or_b32 v200, 1, v200
    ds_write_b128 v244, v[200:203] offset:32768
    v_pk_fma_f32 v[68:69], v[168:169], v[152:153], v[68:69] op_sel_hi:[0,1,1] neg_lo:[1,0,0] neg_hi:[1,0,0]
    v_pk_fma_f32 v[70:71], v[168:169], v[154:155], v[70:71] op_sel_hi:[0,1,1] neg_lo:[1,0,0] neg_hi:[1,0,0]
    v_pk_mul_f32 v[226:227], v[68:69], v[68:69]
    v_pk_mul_f32 v[228:229], v[70:71], v[70:71]
    v_pk_fma_f32 v[226:227], v[226:227], v[170:171], v[170:171] op_sel:[0,1,0] op_sel_hi:[1,1,0]
    v_pk_fma_f32 v[228:229], v[228:229], v[170:171], v[170:171] op_sel:[0,1,0] op_sel_hi:[1,1,0]
    v_pk_mul_f32 v[226:227], v[226:227], v[68:69]
    v_pk_mul_f32 v[228:229], v[228:229], v[70:71]
    v_exp_f32 v226, v226
    v_exp_f32 v227, v227
    v_exp_f32 v228, v228
    v_exp_f32 v229, v229
    v_pk_fma_f32 v[226:227], v[226:227], v[168:169], v[168:169] op_sel:[0,1,1] op_sel_hi:[1,1,1]
    v_pk_fma_f32 v[228:229], v[228:229], v[168:169], v[168:169] op_sel:[0,1,1] op_sel_hi:[1,1,1]
    v_rcp_f32 v226, v226
    v_rcp_f32 v227, v227
    v_rcp_f32 v228, v228
    v_rcp_f32 v229, v229
    v_pk_mul_f32 v[68:69], v[68:69], v[226:227]
    v_pk_mul_f32 v[70:71], v[70:71], v[228:229]
    v_pk_fma_f32 v[72:73], v[168:169], v[156:157], v[72:73] op_sel_hi:[0,1,1] neg_lo:[1,0,0] neg_hi:[1,0,0]
    v_pk_fma_f32 v[74:75], v[168:169], v[158:159], v[74:75] op_sel_hi:[0,1,1] neg_lo:[1,0,0] neg_hi:[1,0,0]
    v_pk_mul_f32 v[226:227], v[72:73], v[72:73]
    v_pk_mul_f32 v[228:229], v[74:75], v[74:75]
    v_pk_fma_f32 v[226:227], v[226:227], v[170:171], v[170:171] op_sel:[0,1,0] op_sel_hi:[1,1,0]
    v_pk_fma_f32 v[228:229], v[228:229], v[170:171], v[170:171] op_sel:[0,1,0] op_sel_hi:[1,1,0]
    v_pk_mul_f32 v[226:227], v[226:227], v[72:73]
    v_pk_mul_f32 v[228:229], v[228:229], v[74:75]
    v_exp_f32 v226, v226
    v_exp_f32 v227, v227
    v_exp_f32 v228, v228
    v_exp_f32 v229, v229
    v_pk_fma_f32 v[226:227], v[226:227], v[168:169], v[168:169] op_sel:[0,1,1] op_sel_hi:[1,1,1]
    v_pk_fma_f32 v[228:229], v[228:229], v[168:169], v[168:169] op_sel:[0,1,1] op_sel_hi:[1,1,1]
    v_rcp_f32 v226, v226
    v_rcp_f32 v227, v227
    v_rcp_f32 v228, v228
    v_rcp_f32 v229, v229
    v_pk_mul_f32 v[72:73], v[72:73], v[226:227]
    v_pk_mul_f32 v[74:75], v[74:75], v[228:229]
    v_cvt_pk_bf16_f32 v204, v68, v69
    v_cvt_pk_bf16_f32 v205, v70, v71
    v_cvt_pk_bf16_f32 v206, v72, v73
    v_cvt_pk_bf16_f32 v207, v74, v75
    v_or_b32 v204, 1, v204
    ds_write_b128 v244, v[204:207] offset:34816
    v_pk_fma_f32 v[96:97], v[172:173], v[152:153], v[96:97] op_sel_hi:[0,1,1] neg_lo:[1,0,0] neg_hi:[1,0,0]
    v_pk_fma_f32 v[98:99], v[172:173], v[154:155], v[98:99] op_sel_hi:[0,1,1] neg_lo:[1,0,0] neg_hi:[1,0,0]
    v_pk_mul_f32 v[226:227], v[96:97], v[96:97]
    v_pk_mul_f32 v[228:229], v[98:99], v[98:99]
    v_pk_fma_f32 v[226:227], v[226:227], v[174:175], v[174:175] op_sel:[0,1,0] op_sel_hi:[1,1,0]
    v_pk_fma_f32 v[228:229], v[228:229], v[174:175], v[174:175] op_sel:[0,1,0] op_sel_hi:[1,1,0]
    v_pk_mul_f32 v[226:227], v[226:227], v[96:97]
    v_pk_mul_f32 v[228:229], v[228:229], v[98:99]
    v_exp_f32 v226, v226
    v_exp_f32 v227, v227
    v_exp_f32 v228, v228
    v_exp_f32 v229, v229
    v_pk_fma_f32 v[226:227], v[226:227], v[172:173], v[172:173] op_sel:[0,1,1] op_sel_hi:[1,1,1]
    v_pk_fma_f32 v[228:229], v[228:229], v[172:173], v[172:173] op_sel:[0,1,1] op_sel_hi:[1,1,1]
    v_rcp_f32 v226, v226
    v_rcp_f32 v227, v227
    v_rcp_f32 v228, v228
    v_rcp_f32 v229, v229
    v_pk_mul_f32 v[96:97], v[96:97], v[226:227]
    v_pk_mul_f32 v[98:99], v[98:99], v[228:229]
    v_pk_fma_f32 v[100:101], v[172:173], v[156:157], v[100:101] op_sel_hi:[0,1,1] neg_lo:[1,0,0] neg_hi:[1,0,0]
    v_pk_fma_f32 v[102:103], v[172:173], v[158:159], v[102:103] op_sel_hi:[0,1,1] neg_lo:[1,0,0] neg_hi:[1,0,0]
    v_pk_mul_f32 v[226:227], v[100:101], v[100:101]
    v_pk_mul_f32 v[228:229], v[102:103], v[102:103]
    v_pk_fma_f32 v[226:227], v[226:227], v[174:175], v[174:175] op_sel:[0,1,0] op_sel_hi:[1,1,0]
    v_pk_fma_f32 v[228:229], v[228:229], v[174:175], v[174:175] op_sel:[0,1,0] op_sel_hi:[1,1,0]
    v_pk_mul_f32 v[226:227], v[226:227], v[100:101]
    v_pk_mul_f32 v[228:229], v[228:229], v[102:103]
    v_exp_f32 v226, v226
    v_exp_f32 v227, v227
    v_exp_f32 v228, v228
    v_exp_f32 v229, v229
    v_pk_fma_f32 v[226:227], v[226:227], v[172:173], v[172:173] op_sel:[0,1,1] op_sel_hi:[1,1,1]
    v_pk_fma_f32 v[228:229], v[228:229], v[172:173], v[172:173] op_sel:[0,1,1] op_sel_hi:[1,1,1]
    v_rcp_f32 v226, v226
    v_rcp_f32 v227, v227
    v_rcp_f32 v228, v228
    v_rcp_f32 v229, v229
    v_pk_mul_f32 v[100:101], v[100:101], v[226:227]
    v_pk_mul_f32 v[102:103], v[102:103], v[228:229]
    v_cvt_pk_bf16_f32 v208, v96, v97
    v_cvt_pk_bf16_f32 v209, v98, v99
    v_cvt_pk_bf16_f32 v210, v100, v101
    v_cvt_pk_bf16_f32 v211, v102, v103
    v_or_b32 v208, 1, v208
    ds_write_b128 v244, v[208:211] offset:36864
    v_pk_fma_f32 v[124:125], v[176:177], v[152:153], v[124:125] op_sel_hi:[0,1,1] neg_lo:[1,0,0] neg_hi:[1,0,0]
    v_pk_fma_f32 v[126:127], v[176:177], v[154:155], v[126:127] op_sel_hi:[0,1,1] neg_lo:[1,0,0] neg_hi:[1,0,0]
    v_pk_mul_f32 v[226:227], v[124:125], v[124:125]
    v_pk_mul_f32 v[228:229], v[126:127], v[126:127]
    v_pk_fma_f32 v[226:227], v[226:227], v[178:179], v[178:179] op_sel:[0,1,0] op_sel_hi:[1,1,0]
    v_pk_fma_f32 v[228:229], v[228:229], v[178:179], v[178:179] op_sel:[0,1,0] op_sel_hi:[1,1,0]
    v_pk_mul_f32 v[226:227], v[226:227], v[124:125]
    v_pk_mul_f32 v[228:229], v[228:229], v[126:127]
    v_exp_f32 v226, v226
    v_exp_f32 v227, v227
    v_exp_f32 v228, v228
    v_exp_f32 v229, v229
    v_pk_fma_f32 v[226:227], v[226:227], v[176:177], v[176:177] op_sel:[0,1,1] op_sel_hi:[1,1,1]
    v_pk_fma_f32 v[228:229], v[228:229], v[176:177], v[176:177] op_sel:[0,1,1] op_sel_hi:[1,1,1]
    v_rcp_f32 v226, v226
    v_rcp_f32 v227, v227
    v_rcp_f32 v228, v228
    v_rcp_f32 v229, v229
    v_pk_mul_f32 v[124:125], v[124:125], v[226:227]
    v_pk_mul_f32 v[126:127], v[126:127], v[228:229]
    v_pk_fma_f32 v[128:129], v[176:177], v[156:157], v[128:129] op_sel_hi:[0,1,1] neg_lo:[1,0,0] neg_hi:[1,0,0]
    v_pk_fma_f32 v[130:131], v[176:177], v[158:159], v[130:131] op_sel_hi:[0,1,1] neg_lo:[1,0,0] neg_hi:[1,0,0]
    v_pk_mul_f32 v[226:227], v[128:129], v[128:129]
    v_pk_mul_f32 v[228:229], v[130:131], v[130:131]
    v_pk_fma_f32 v[226:227], v[226:227], v[178:179], v[178:179] op_sel:[0,1,0] op_sel_hi:[1,1,0]
    v_pk_fma_f32 v[228:229], v[228:229], v[178:179], v[178:179] op_sel:[0,1,0] op_sel_hi:[1,1,0]
    v_pk_mul_f32 v[226:227], v[226:227], v[128:129]
    v_pk_mul_f32 v[228:229], v[228:229], v[130:131]
    v_exp_f32 v226, v226
    v_exp_f32 v227, v227
    v_exp_f32 v228, v228
    v_exp_f32 v229, v229
    v_pk_fma_f32 v[226:227], v[226:227], v[176:177], v[176:177] op_sel:[0,1,1] op_sel_hi:[1,1,1]
    v_pk_fma_f32 v[228:229], v[228:229], v[176:177], v[176:177] op_sel:[0,1,1] op_sel_hi:[1,1,1]
    v_rcp_f32 v226, v226
    v_rcp_f32 v227, v227
    v_rcp_f32 v228, v228
    v_rcp_f32 v229, v229
    v_pk_mul_f32 v[128:129], v[128:129], v[226:227]
    v_pk_mul_f32 v[130:131], v[130:131], v[228:229]
    v_cvt_pk_bf16_f32 v212, v124, v125
    v_cvt_pk_bf16_f32 v213, v126, v127
    v_cvt_pk_bf16_f32 v214, v128, v129
    v_cvt_pk_bf16_f32 v215, v130, v131
    ds_write_b128 v244, v[212:215] offset:38912
    v_pk_fma_f32 v[48:49], v[164:165], v[160:161], v[48:49] op_sel_hi:[0,1,1] neg_lo:[1,0,0] neg_hi:[1,0,0]
    v_pk_fma_f32 v[50:51], v[164:165], v[162:163], v[50:51] op_sel_hi:[0,1,1] neg_lo:[1,0,0] neg_hi:[1,0,0]
    v_pk_mul_f32 v[226:227], v[48:49], v[48:49]
    v_pk_mul_f32 v[228:229], v[50:51], v[50:51]
    v_pk_fma_f32 v[226:227], v[226:227], v[166:167], v[166:167] op_sel:[0,1,0] op_sel_hi:[1,1,0]
    v_pk_fma_f32 v[228:229], v[228:229], v[166:167], v[166:167] op_sel:[0,1,0] op_sel_hi:[1,1,0]
    v_pk_mul_f32 v[226:227], v[226:227], v[48:49]
    v_pk_mul_f32 v[228:229], v[228:229], v[50:51]
    v_exp_f32 v226, v226
    v_exp_f32 v227, v227
    v_exp_f32 v228, v228
    v_exp_f32 v229, v229
    v_pk_fma_f32 v[226:227], v[226:227], v[164:165], v[164:165] op_sel:[0,1,1] op_sel_hi:[1,1,1]
    v_pk_fma_f32 v[228:229], v[228:229], v[164:165], v[164:165] op_sel:[0,1,1] op_sel_hi:[1,1,1]
    v_rcp_f32 v226, v226
    v_rcp_f32 v227, v227
    v_rcp_f32 v228, v228
    v_rcp_f32 v229, v229
    v_pk_mul_f32 v[48:49], v[48:49], v[226:227]
    v_pk_mul_f32 v[50:51], v[50:51], v[228:229]
    v_cvt_pk_bf16_f32 v216, v48, v49
    v_cvt_pk_bf16_f32 v217, v50, v51
    v_or_b32 v216, 1, v216
    s_add_u32 s36, s45, 0
    buffer_store_dwordx4 v[32:35], v2, s[16:19], s36 offen sc1
    v_pk_fma_f32 v[76:77], v[168:169], v[160:161], v[76:77] op_sel_hi:[0,1,1] neg_lo:[1,0,0] neg_hi:[1,0,0]
    v_pk_fma_f32 v[78:79], v[168:169], v[162:163], v[78:79] op_sel_hi:[0,1,1] neg_lo:[1,0,0] neg_hi:[1,0,0]
    v_pk_mul_f32 v[226:227], v[76:77], v[76:77]
    v_pk_mul_f32 v[228:229], v[78:79], v[78:79]
    v_pk_fma_f32 v[226:227], v[226:227], v[170:171], v[170:171] op_sel:[0,1,0] op_sel_hi:[1,1,0]
    v_pk_fma_f32 v[228:229], v[228:229], v[170:171], v[170:171] op_sel:[0,1,0] op_sel_hi:[1,1,0]
    v_pk_mul_f32 v[226:227], v[226:227], v[76:77]
    v_pk_mul_f32 v[228:229], v[228:229], v[78:79]
    v_exp_f32 v226, v226
    v_exp_f32 v227, v227
    v_exp_f32 v228, v228
    v_exp_f32 v229, v229
    v_pk_fma_f32 v[226:227], v[226:227], v[168:169], v[168:169] op_sel:[0,1,1] op_sel_hi:[1,1,1]
    v_pk_fma_f32 v[228:229], v[228:229], v[168:169], v[168:169] op_sel:[0,1,1] op_sel_hi:[1,1,1]
    v_rcp_f32 v226, v226
    v_rcp_f32 v227, v227
    v_rcp_f32 v228, v228
    v_rcp_f32 v229, v229
    v_pk_mul_f32 v[76:77], v[76:77], v[226:227]
    v_pk_mul_f32 v[78:79], v[78:79], v[228:229]
    v_cvt_pk_bf16_f32 v218, v76, v77
    v_cvt_pk_bf16_f32 v219, v78, v79
    v_or_b32 v218, 1, v218
    s_add_u32 s36, s45, 229376
    buffer_store_dwordx4 v[60:63], v2, s[16:19], s36 offen sc1
    v_pk_fma_f32 v[104:105], v[172:173], v[160:161], v[104:105] op_sel_hi:[0,1,1] neg_lo:[1,0,0] neg_hi:[1,0,0]
    v_pk_fma_f32 v[106:107], v[172:173], v[162:163], v[106:107] op_sel_hi:[0,1,1] neg_lo:[1,0,0] neg_hi:[1,0,0]
    v_pk_mul_f32 v[226:227], v[104:105], v[104:105]
    v_pk_mul_f32 v[228:229], v[106:107], v[106:107]
    v_pk_fma_f32 v[226:227], v[226:227], v[174:175], v[174:175] op_sel:[0,1,0] op_sel_hi:[1,1,0]
    v_pk_fma_f32 v[228:229], v[228:229], v[174:175], v[174:175] op_sel:[0,1,0] op_sel_hi:[1,1,0]
    v_pk_mul_f32 v[226:227], v[226:227], v[104:105]
    v_pk_mul_f32 v[228:229], v[228:229], v[106:107]
    v_exp_f32 v226, v226
    v_exp_f32 v227, v227
    v_exp_f32 v228, v228
    v_exp_f32 v229, v229
    v_pk_fma_f32 v[226:227], v[226:227], v[172:173], v[172:173] op_sel:[0,1,1] op_sel_hi:[1,1,1]
    v_pk_fma_f32 v[228:229], v[228:229], v[172:173], v[172:173] op_sel:[0,1,1] op_sel_hi:[1,1,1]
    v_rcp_f32 v226, v226
    v_rcp_f32 v227, v227
    v_rcp_f32 v228, v228
    v_rcp_f32 v229, v229
    v_pk_mul_f32 v[104:105], v[104:105], v[226:227]
    v_pk_mul_f32 v[106:107], v[106:107], v[228:229]
    v_cvt_pk_bf16_f32 v220, v104, v105
    v_cvt_pk_bf16_f32 v221, v106, v107
    v_or_b32 v220, 1, v220
    s_add_u32 s36, s45, 458752
    buffer_store_dwordx4 v[88:91], v2, s[16:19], s36 offen sc1
    v_pk_fma_f32 v[132:133], v[176:177], v[160:161], v[132:133] op_sel_hi:[0,1,1] neg_lo:[1,0,0] neg_hi:[1,0,0]
    v_pk_fma_f32 v[134:135], v[176:177], v[162:163], v[134:135] op_sel_hi:[0,1,1] neg_lo:[1,0,0] neg_hi:[1,0,0]
    v_pk_mul_f32 v[226:227], v[132:133], v[132:133]
    v_pk_mul_f32 v[228:229], v[134:135], v[134:135]
    v_pk_fma_f32 v[226:227], v[226:227], v[178:179], v[178:179] op_sel:[0,1,0] op_sel_hi:[1,1,0]
    v_pk_fma_f32 v[228:229], v[228:229], v[178:179], v[178:179] op_sel:[0,1,0] op_sel_hi:[1,1,0]
    v_pk_mul_f32 v[226:227], v[226:227], v[132:133]
    v_pk_mul_f32 v[228:229], v[228:229], v[134:135]
    v_exp_f32 v226, v226
    v_exp_f32 v227, v227
    v_exp_f32 v228, v228
    v_exp_f32 v229, v229
    v_pk_fma_f32 v[226:227], v[226:227], v[176:177], v[176:177] op_sel:[0,1,1] op_sel_hi:[1,1,1]
    v_pk_fma_f32 v[228:229], v[228:229], v[176:177], v[176:177] op_sel:[0,1,1] op_sel_hi:[1,1,1]
    v_rcp_f32 v226, v226
    v_rcp_f32 v227, v227
    v_rcp_f32 v228, v228
    v_rcp_f32 v229, v229
    v_pk_mul_f32 v[132:133], v[132:133], v[226:227]
    v_pk_mul_f32 v[134:135], v[134:135], v[228:229]
    v_cvt_pk_bf16_f32 v222, v132, v133
    v_cvt_pk_bf16_f32 v223, v134, v135
    s_add_u32 s36, s45, 688128
    buffer_store_dwordx4 v[116:119], v2, s[16:19], s36 offen sc1
    s_waitcnt lgkmcnt(0)
    s_mov_b32 s44, s46
    s_mov_b32 s45, s47
    s_branch G3_e2
G3_e1:
    v_pk_fma_f32 v[28:29], v[164:165], v[140:141], v[28:29] op_sel_hi:[0,1,1] neg_lo:[1,0,0] neg_hi:[1,0,0]
    v_pk_fma_f32 v[30:31], v[164:165], v[142:143], v[30:31] op_sel_hi:[0,1,1] neg_lo:[1,0,0] neg_hi:[1,0,0]
    v_pk_mul_f32 v[226:227], v[28:29], v[28:29]
    v_pk_mul_f32 v[228:229], v[30:31], v[30:31]
    v_pk_fma_f32 v[226:227], v[226:227], v[166:167], v[166:167] op_sel:[0,1,0] op_sel_hi:[1,1,0]
    v_pk_fma_f32 v[228:229], v[228:229], v[166:167], v[166:167] op_sel:[0,1,0] op_sel_hi:[1,1,0]
    v_pk_mul_f32 v[226:227], v[226:227], v[28:29]
    v_pk_mul_f32 v[228:229], v[228:229], v[30:31]
    v_exp_f32 v226, v226
    v_exp_f32 v227, v227
    v_exp_f32 v228, v228
    v_exp_f32 v229, v229
    v_pk_fma_f32 v[226:227], v[226:227], v[164:165], v[164:165] op_sel:[0,1,1] op_sel_hi:[1,1,1]
    v_pk_fma_f32 v[228:229], v[228:229], v[164:165], v[164:165] op_sel:[0,1,1] op_sel_hi:[1,1,1]
    v_rcp_f32 v226, v226
    v_rcp_f32 v227, v227
    v_rcp_f32 v228, v228
    v_rcp_f32 v229, v229
    v_pk_mul_f32 v[28:29], v[28:29], v[226:227]
    v_pk_mul_f32 v[30:31], v[30:31], v[228:229]
    v_pk_fma_f32 v[32:33], v[164:165], v[144:145], v[32:33] op_sel_hi:[0,1,1] neg_lo:[1,0,0] neg_hi:[1,0,0]
    v_pk_fma_f32 v[34:35], v[164:165], v[146:147], v[34:35] op_sel_hi:[0,1,1] neg_lo:[1,0,0] neg_hi:[1,0,0]
    v_pk_mul_f32 v[226:227], v[32:33], v[32:33]
    v_pk_mul_f32 v[228:229], v[34:35], v[34:35]
    v_pk_fma_f32 v[226:227], v[226:227], v[166:167], v[166:167] op_sel:[0,1,0] op_sel_hi:[1,1,0]
    v_pk_fma_f32 v[228:229], v[228:229], v[166:167], v[166:167] op_sel:[0,1,0] op_sel_hi:[1,1,0]
    v_pk_mul_f32 v[226:227], v[226:227], v[32:33]
    v_pk_mul_f32 v[228:229], v[228:229], v[34:35]
    v_exp_f32 v226, v226
    v_exp_f32 v227, v227
    v_exp_f32 v228, v228
    v_exp_f32 v229, v229
    v_pk_fma_f32 v[226:227], v[226:227], v[164:165], v[164:165] op_sel:[0,1,1] op_sel_hi:[1,1,1]
    v_pk_fma_f32 v[228:229], v[228:229], v[164:165], v[164:165] op_sel:[0,1,1] op_sel_hi:[1,1,1]
    v_rcp_f32 v226, v226
    v_rcp_f32 v227, v227
    v_rcp_f32 v228, v228
    v_rcp_f32 v229, v229
    v_pk_mul_f32 v[32:33], v[32:33], v[226:227]
    v_pk_mul_f32 v[34:35], v[34:35], v[228:229]
    v_cvt_pk_bf16_f32 v28, v28, v29
    v_cvt_pk_bf16_f32 v29, v30, v31
    v_cvt_pk_bf16_f32 v30, v32, v33
    v_cvt_pk_bf16_f32 v31, v34, v35
    v_or_b32 v28, 1, v28
    ds_write_b128 v244, v[28:31] offset:0
    s_add_u32 s36, s45, 0
    buffer_store_dwordx4 v[28:31], v2, s[16:19], s36 offen sc1
    v_pk_fma_f32 v[56:57], v[168:169], v[140:141], v[56:57] op_sel_hi:[0,1,1] neg_lo:[1,0,0] neg_hi:[1,0,0]
    v_pk_fma_f32 v[58:59], v[168:169], v[142:143], v[58:59] op_sel_hi:[0,1,1] neg_lo:[1,0,0] neg_hi:[1,0,0]
    v_pk_mul_f32 v[226:227], v[56:57], v[56:57]
    v_pk_mul_f32 v[228:229], v[58:59], v[58:59]
    v_pk_fma_f32 v[226:227], v[226:227], v[170:171], v[170:171] op_sel:[0,1,0] op_sel_hi:[1,1,0]
    v_pk_fma_f32 v[228:229], v[228:229], v[170:171], v[170:171] op_sel:[0,1,0] op_sel_hi:[1,1,0]
    v_pk_mul_f32 v[226:227], v[226:227], v[56:57]
    v_pk_mul_f32 v[228:229], v[228:229], v[58:59]
    v_exp_f32 v226, v226
    v_exp_f32 v227, v227
    v_exp_f32 v228, v228
    v_exp_f32 v229, v229
    v_pk_fma_f32 v[226:227], v[226:227], v[168:169], v[168:169] op_sel:[0,1,1] op_sel_hi:[1,1,1]
    v_pk_fma_f32 v[228:229], v[228:229], v[168:169], v[168:169] op_sel:[0,1,1] op_sel_hi:[1,1,1]
    v_rcp_f32 v226, v226
    v_rcp_f32 v227, v227
    v_rcp_f32 v228, v228
    v_rcp_f32 v229, v229
    v_pk_mul_f32 v[56:57], v[56:57], v[226:227]
    v_pk_mul_f32 v[58:59], v[58:59], v[228:229]
    v_pk_fma_f32 v[60:61], v[168:169], v[144:145], v[60:61] op_sel_hi:[0,1,1] neg_lo:[1,0,0] neg_hi:[1,0,0]
    v_pk_fma_f32 v[62:63], v[168:169], v[146:147], v[62:63] op_sel_hi:[0,1,1] neg_lo:[1,0,0] neg_hi:[1,0,0]
    v_pk_mul_f32 v[226:227], v[60:61], v[60:61]
    v_pk_mul_f32 v[228:229], v[62:63], v[62:63]
    v_pk_fma_f32 v[226:227], v[226:227], v[170:171], v[170:171] op_sel:[0,1,0] op_sel_hi:[1,1,0]
    v_pk_fma_f32 v[228:229], v[228:229], v[170:171], v[170:171] op_sel:[0,1,0] op_sel_hi:[1,1,0]
    v_pk_mul_f32 v[226:227], v[226:227], v[60:61]
    v_pk_mul_f32 v[228:229], v[228:229], v[62:63]
    v_exp_f32 v226, v226
    v_exp_f32 v227, v227
    v_exp_f32 v228, v228
    v_exp_f32 v229, v229
    v_pk_fma_f32 v[226:227], v[226:227], v[168:169], v[168:169] op_sel:[0,1,1] op_sel_hi:[1,1,1]
    v_pk_fma_f32 v[228:229], v[228:229], v[168:169], v[168:169] op_sel:[0,1,1] op_sel_hi:[1,1,1]
    v_rcp_f32 v226, v226
    v_rcp_f32 v227, v227
    v_rcp_f32 v228, v228
    v_rcp_f32 v229, v229
    v_pk_mul_f32 v[60:61], v[60:61], v[226:227]
    v_pk_mul_f32 v[62:63], v[62:63], v[228:229]
    v_cvt_pk_bf16_f32 v56, v56, v57
    v_cvt_pk_bf16_f32 v57, v58, v59
    v_cvt_pk_bf16_f32 v58, v60, v61
    v_cvt_pk_bf16_f32 v59, v62, v63
    v_or_b32 v56, 1, v56
    ds_write_b128 v244, v[56:59] offset:2048
    s_add_u32 s36, s45, 229376
    buffer_store_dwordx4 v[56:59], v2, s[16:19], s36 offen sc1
    v_pk_fma_f32 v[84:85], v[172:173], v[140:141], v[84:85] op_sel_hi:[0,1,1] neg_lo:[1,0,0] neg_hi:[1,0,0]
    v_pk_fma_f32 v[86:87], v[172:173], v[142:143], v[86:87] op_sel_hi:[0,1,1] neg_lo:[1,0,0] neg_hi:[1,0,0]
    v_pk_mul_f32 v[226:227], v[84:85], v[84:85]
    v_pk_mul_f32 v[228:229], v[86:87], v[86:87]
    v_pk_fma_f32 v[226:227], v[226:227], v[174:175], v[174:175] op_sel:[0,1,0] op_sel_hi:[1,1,0]
    v_pk_fma_f32 v[228:229], v[228:229], v[174:175], v[174:175] op_sel:[0,1,0] op_sel_hi:[1,1,0]
    v_pk_mul_f32 v[226:227], v[226:227], v[84:85]
    v_pk_mul_f32 v[228:229], v[228:229], v[86:87]
    v_exp_f32 v226, v226
    v_exp_f32 v227, v227
    v_exp_f32 v228, v228
    v_exp_f32 v229, v229
    v_pk_fma_f32 v[226:227], v[226:227], v[172:173], v[172:173] op_sel:[0,1,1] op_sel_hi:[1,1,1]
    v_pk_fma_f32 v[228:229], v[228:229], v[172:173], v[172:173] op_sel:[0,1,1] op_sel_hi:[1,1,1]
    v_rcp_f32 v226, v226
    v_rcp_f32 v227, v227
    v_rcp_f32 v228, v228
    v_rcp_f32 v229, v229
    v_pk_mul_f32 v[84:85], v[84:85], v[226:227]
    v_pk_mul_f32 v[86:87], v[86:87], v[228:229]
    v_pk_fma_f32 v[88:89], v[172:173], v[144:145], v[88:89] op_sel_hi:[0,1,1] neg_lo:[1,0,0] neg_hi:[1,0,0]
    v_pk_fma_f32 v[90:91], v[172:173], v[146:147], v[90:91] op_sel_hi:[0,1,1] neg_lo:[1,0,0] neg_hi:[1,0,0]
    v_pk_mul_f32 v[226:227], v[88:89], v[88:89]
    v_pk_mul_f32 v[228:229], v[90:91], v[90:91]
    v_pk_fma_f32 v[226:227], v[226:227], v[174:175], v[174:175] op_sel:[0,1,0] op_sel_hi:[1,1,0]
    v_pk_fma_f32 v[228:229], v[228:229], v[174:175], v[174:175] op_sel:[0,1,0] op_sel_hi:[1,1,0]
    v_pk_mul_f32 v[226:227], v[226:227], v[88:89]
    v_pk_mul_f32 v[228:229], v[228:229], v[90:91]
    v_exp_f32 v226, v226
    v_exp_f32 v227, v227
    v_exp_f32 v228, v228
    v_exp_f32 v229, v229
    v_pk_fma_f32 v[226:227], v[226:227], v[172:173], v[172:173] op_sel:[0,1,1] op_sel_hi:[1,1,1]
    v_pk_fma_f32 v[228:229], v[228:229], v[172:173], v[172:173] op_sel:[0,1,1] op_sel_hi:[1,1,1]
    v_rcp_f32 v226, v226
    v_rcp_f32 v227, v227
    v_rcp_f32 v228, v228
    v_rcp_f32 v229, v229
    v_pk_mul_f32 v[88:89], v[88:89], v[226:227]
    v_pk_mul_f32 v[90:91], v[90:91], v[228:229]
    v_cvt_pk_bf16_f32 v84, v84, v85
    v_cvt_pk_bf16_f32 v85, v86, v87
    v_cvt_pk_bf16_f32 v86, v88, v89
    v_cvt_pk_bf16_f32 v87, v90, v91
    v_or_b32 v84, 1, v84
    ds_write_b128 v244, v[84:87] offset:4096
    s_add_u32 s36, s45, 458752
    buffer_store_dwordx4 v[84:87], v2, s[16:19], s36 offen sc1
    v_pk_fma_f32 v[112:113], v[176:177], v[140:141], v[112:113] op_sel_hi:[0,1,1] neg_lo:[1,0,0] neg_hi:[1,0,0]
    v_pk_fma_f32 v[114:115], v[176:177], v[142:143], v[114:115] op_sel_hi:[0,1,1] neg_lo:[1,0,0] neg_hi:[1,0,0]
    v_pk_mul_f32 v[226:227], v[112:113], v[112:113]
    v_pk_mul_f32 v[228:229], v[114:115], v[114:115]
    v_pk_fma_f32 v[226:227], v[226:227], v[178:179], v[178:179] op_sel:[0,1,0] op_sel_hi:[1,1,0]
    v_pk_fma_f32 v[228:229], v[228:229], v[178:179], v[178:179] op_sel:[0,1,0] op_sel_hi:[1,1,0]
    v_pk_mul_f32 v[226:227], v[226:227], v[112:113]
    v_pk_mul_f32 v[228:229], v[228:229], v[114:115]
    v_exp_f32 v226, v226
    v_exp_f32 v227, v227
    v_exp_f32 v228, v228
    v_exp_f32 v229, v229
    v_pk_fma_f32 v[226:227], v[226:227], v[176:177], v[176:177] op_sel:[0,1,1] op_sel_hi:[1,1,1]
    v_pk_fma_f32 v[228:229], v[228:229], v[176:177], v[176:177] op_sel:[0,1,1] op_sel_hi:[1,1,1]
    v_rcp_f32 v226, v226
    v_rcp_f32 v227, v227
    v_rcp_f32 v228, v228
    v_rcp_f32 v229, v229
    v_pk_mul_f32 v[112:113], v[112:113], v[226:227]
    v_pk_mul_f32 v[114:115], v[114:115], v[228:229]
    v_pk_fma_f32 v[116:117], v[176:177], v[144:145], v[116:117] op_sel_hi:[0,1,1] neg_lo:[1,0,0] neg_hi:[1,0,0]
    v_pk_fma_f32 v[118:119], v[176:177], v[146:147], v[118:119] op_sel_hi:[0,1,1] neg_lo:[1,0,0] neg_hi:[1,0,0]
    v_pk_mul_f32 v[226:227], v[116:117], v[116:117]
    v_pk_mul_f32 v[228:229], v[118:119], v[118:119]
    v_pk_fma_f32 v[226:227], v[226:227], v[178:179], v[178:179] op_sel:[0,1,0] op_sel_hi:[1,1,0]
    v_pk_fma_f32 v[228:229], v[228:229], v[178:179], v[178:179] op_sel:[0,1,0] op_sel_hi:[1,1,0]
    v_pk_mul_f32 v[226:227], v[226:227], v[116:117]
    v_pk_mul_f32 v[228:229], v[228:229], v[118:119]
    v_exp_f32 v226, v226
    v_exp_f32 v227, v227
    v_exp_f32 v228, v228
    v_exp_f32 v229, v229
    v_pk_fma_f32 v[226:227], v[226:227], v[176:177], v[176:177] op_sel:[0,1,1] op_sel_hi:[1,1,1]
    v_pk_fma_f32 v[228:229], v[228:229], v[176:177], v[176:177] op_sel:[0,1,1] op_sel_hi:[1,1,1]
    v_rcp_f32 v226, v226
    v_rcp_f32 v227, v227
    v_rcp_f32 v228, v228
    v_rcp_f32 v229, v229
    v_pk_mul_f32 v[116:117], v[116:117], v[226:227]
    v_pk_mul_f32 v[118:119], v[118:119], v[228:229]
    v_cvt_pk_bf16_f32 v112, v112, v113
    v_cvt_pk_bf16_f32 v113, v114, v115
    v_cvt_pk_bf16_f32 v114, v116, v117
    v_cvt_pk_bf16_f32 v115, v118, v119
    ds_write_b128 v244, v[112:115] offset:6144
    s_add_u32 s36, s45, 688128
    buffer_store_dwordx4 v[112:115], v2, s[16:19], s36 offen sc1
    v_pk_fma_f32 v[36:37], v[164:165], v[148:149], v[36:37] op_sel_hi:[0,1,1] neg_lo:[1,0,0] neg_hi:[1,0,0]
    v_pk_fma_f32 v[38:39], v[164:165], v[150:151], v[38:39] op_sel_hi:[0,1,1] neg_lo:[1,0,0] neg_hi:[1,0,0]
    v_pk_mul_f32 v[226:227], v[36:37], v[36:37]
    v_pk_mul_f32 v[228:229], v[38:39], v[38:39]
    v_pk_fma_f32 v[226:227], v[226:227], v[166:167], v[166:167] op_sel:[0,1,0] op_sel_hi:[1,1,0]
    v_pk_fma_f32 v[228:229], v[228:229], v[166:167], v[166:167] op_sel:[0,1,0] op_sel_hi:[1,1,0]
    v_pk_mul_f32 v[226:227], v[226:227], v[36:37]
    v_pk_mul_f32 v[228:229], v[228:229], v[38:39]
    v_exp_f32 v226, v226
    v_exp_f32 v227, v227
    v_exp_f32 v228, v228
    v_exp_f32 v229, v229
    v_pk_fma_f32 v[226:227], v[226:227], v[164:165], v[164:165] op_sel:[0,1,1] op_sel_hi:[1,1,1]
    v_pk_fma_f32 v[228:229], v[228:229], v[164:165], v[164:165] op_sel:[0,1,1] op_sel_hi:[1,1,1]
    v_rcp_f32 v226, v226
    v_rcp_f32 v227, v227
    v_rcp_f32 v228, v228
    v_rcp_f32 v229, v229
    v_pk_mul_f32 v[36:37], v[36:37], v[226:227]
    v_pk_mul_f32 v[38:39], v[38:39], v[228:229]
    v_pk_fma_f32 v[40:41], v[164:165], v[152:153], v[40:41] op_sel_hi:[0,1,1] neg_lo:[1,0,0] neg_hi:[1,0,0]
    v_pk_fma_f32 v[42:43], v[164:165], v[154:155], v[42:43] op_sel_hi:[0,1,1] neg_lo:[1,0,0] neg_hi:[1,0,0]
    v_pk_mul_f32 v[226:227], v[40:41], v[40:41]
    v_pk_mul_f32 v[228:229], v[42:43], v[42:43]
    v_pk_fma_f32 v[226:227], v[226:227], v[166:167], v[166:167] op_sel:[0,1,0] op_sel_hi:[1,1,0]
    v_pk_fma_f32 v[228:229], v[228:229], v[166:167], v[166:167] op_sel:[0,1,0] op_sel_hi:[1,1,0]
    v_pk_mul_f32 v[226:227], v[226:227], v[40:41]
    v_pk_mul_f32 v[228:229], v[228:229], v[42:43]
    v_exp_f32 v226, v226
    v_exp_f32 v227, v227
    v_exp_f32 v228, v228
    v_exp_f32 v229, v229
    v_pk_fma_f32 v[226:227], v[226:227], v[164:165], v[164:165] op_sel:[0,1,1] op_sel_hi:[1,1,1]
    v_pk_fma_f32 v[228:229], v[228:229], v[164:165], v[164:165] op_sel:[0,1,1] op_sel_hi:[1,1,1]
    v_rcp_f32 v226, v226
    v_rcp_f32 v227, v227
    v_rcp_f32 v228, v228
    v_rcp_f32 v229, v229
    v_pk_mul_f32 v[40:41], v[40:41], v[226:227]
    v_pk_mul_f32 v[42:43], v[42:43], v[228:229]
    v_cvt_pk_bf16_f32 v36, v36, v37
    v_cvt_pk_bf16_f32 v37, v38, v39
    v_cvt_pk_bf16_f32 v38, v40, v41
    v_cvt_pk_bf16_f32 v39, v42, v43
    v_or_b32 v36, 1, v36
    ds_write_b128 v244, v[36:39] offset:16384
    v_pk_fma_f32 v[64:65], v[168:169], v[148:149], v[64:65] op_sel_hi:[0,1,1] neg_lo:[1,0,0] neg_hi:[1,0,0]
    v_pk_fma_f32 v[66:67], v[168:169], v[150:151], v[66:67] op_sel_hi:[0,1,1] neg_lo:[1,0,0] neg_hi:[1,0,0]
    v_pk_mul_f32 v[226:227], v[64:65], v[64:65]
    v_pk_mul_f32 v[228:229], v[66:67], v[66:67]
    v_pk_fma_f32 v[226:227], v[226:227], v[170:171], v[170:171] op_sel:[0,1,0] op_sel_hi:[1,1,0]
    v_pk_fma_f32 v[228:229], v[228:229], v[170:171], v[170:171] op_sel:[0,1,0] op_sel_hi:[1,1,0]
    v_pk_mul_f32 v[226:227], v[226:227], v[64:65]
    v_pk_mul_f32 v[228:229], v[228:229], v[66:67]
    v_exp_f32 v226, v226
    v_exp_f32 v227, v227
    v_exp_f32 v228, v228
    v_exp_f32 v229, v229
    v_pk_fma_f32 v[226:227], v[226:227], v[168:169], v[168:169] op_sel:[0,1,1] op_sel_hi:[1,1,1]
    v_pk_fma_f32 v[228:229], v[228:229], v[168:169], v[168:169] op_sel:[0,1,1] op_sel_hi:[1,1,1]
    v_rcp_f32 v226, v226
    v_rcp_f32 v227, v227
    v_rcp_f32 v228, v228
    v_rcp_f32 v229, v229
    v_pk_mul_f32 v[64:65], v[64:65], v[226:227]
    v_pk_mul_f32 v[66:67], v[66:67], v[228:229]
    v_pk_fma_f32 v[68:69], v[168:169], v[152:153], v[68:69] op_sel_hi:[0,1,1] neg_lo:[1,0,0] neg_hi:[1,0,0]
    v_pk_fma_f32 v[70:71], v[168:169], v[154:155], v[70:71] op_sel_hi:[0,1,1] neg_lo:[1,0,0] neg_hi:[1,0,0]
    v_pk_mul_f32 v[226:227], v[68:69], v[68:69]
    v_pk_mul_f32 v[228:229], v[70:71], v[70:71]
    v_pk_fma_f32 v[226:227], v[226:227], v[170:171], v[170:171] op_sel:[0,1,0] op_sel_hi:[1,1,0]
    v_pk_fma_f32 v[228:229], v[228:229], v[170:171], v[170:171] op_sel:[0,1,0] op_sel_hi:[1,1,0]
    v_pk_mul_f32 v[226:227], v[226:227], v[68:69]
    v_pk_mul_f32 v[228:229], v[228:229], v[70:71]
    v_exp_f32 v226, v226
    v_exp_f32 v227, v227
    v_exp_f32 v228, v228
    v_exp_f32 v229, v229
    v_pk_fma_f32 v[226:227], v[226:227], v[168:169], v[168:169] op_sel:[0,1,1] op_sel_hi:[1,1,1]
    v_pk_fma_f32 v[228:229], v[228:229], v[168:169], v[168:169] op_sel:[0,1,1] op_sel_hi:[1,1,1]
    v_rcp_f32 v226, v226
    v_rcp_f32 v227, v227
    v_rcp_f32 v228, v228
    v_rcp_f32 v229, v229
    v_pk_mul_f32 v[68:69], v[68:69], v[226:227]
    v_pk_mul_f32 v[70:71], v[70:71], v[228:229]
    v_cvt_pk_bf16_f32 v64, v64, v65
    v_cvt_pk_bf16_f32 v65, v66, v67
    v_cvt_pk_bf16_f32 v66, v68, v69
    v_cvt_pk_bf16_f32 v67, v70, v71
    v_or_b32 v64, 1, v64
    ds_write_b128 v244, v[64:67] offset:18432
    s_waitcnt vmcnt(0)
    s_mov_b64 exec, 1
    ds_add_u32 v246, v245
    s_mov_b64 exec, -1
    v_pk_fma_f32 v[92:93], v[172:173], v[148:149], v[92:93] op_sel_hi:[0,1,1] neg_lo:[1,0,0] neg_hi:[1,0,0]
    v_pk_fma_f32 v[94:95], v[172:173], v[150:151], v[94:95] op_sel_hi:[0,1,1] neg_lo:[1,0,0] neg_hi:[1,0,0]
    v_pk_mul_f32 v[226:227], v[92:93], v[92:93]
    v_pk_mul_f32 v[228:229], v[94:95], v[94:95]
    v_pk_fma_f32 v[226:227], v[226:227], v[174:175], v[174:175] op_sel:[0,1,0] op_sel_hi:[1,1,0]
    v_pk_fma_f32 v[228:229], v[228:229], v[174:175], v[174:175] op_sel:[0,1,0] op_sel_hi:[1,1,0]
    v_pk_mul_f32 v[226:227], v[226:227], v[92:93]
    v_pk_mul_f32 v[228:229], v[228:229], v[94:95]
    v_exp_f32 v226, v226
    v_exp_f32 v227, v227
    v_exp_f32 v228, v228
    v_exp_f32 v229, v229
    v_pk_fma_f32 v[226:227], v[226:227], v[172:173], v[172:173] op_sel:[0,1,1] op_sel_hi:[1,1,1]
    v_pk_fma_f32 v[228:229], v[228:229], v[172:173], v[172:173] op_sel:[0,1,1] op_sel_hi:[1,1,1]
    v_rcp_f32 v226, v226
    v_rcp_f32 v227, v227
    v_rcp_f32 v228, v228
    v_rcp_f32 v229, v229
    v_pk_mul_f32 v[92:93], v[92:93], v[226:227]
    v_pk_mul_f32 v[94:95], v[94:95], v[228:229]
    v_pk_fma_f32 v[96:97], v[172:173], v[152:153], v[96:97] op_sel_hi:[0,1,1] neg_lo:[1,0,0] neg_hi:[1,0,0]
    v_pk_fma_f32 v[98:99], v[172:173], v[154:155], v[98:99] op_sel_hi:[0,1,1] neg_lo:[1,0,0] neg_hi:[1,0,0]
    v_pk_mul_f32 v[226:227], v[96:97], v[96:97]
    v_pk_mul_f32 v[228:229], v[98:99], v[98:99]
    v_pk_fma_f32 v[226:227], v[226:227], v[174:175], v[174:175] op_sel:[0,1,0] op_sel_hi:[1,1,0]
    v_pk_fma_f32 v[228:229], v[228:229], v[174:175], v[174:175] op_sel:[0,1,0] op_sel_hi:[1,1,0]
    v_pk_mul_f32 v[226:227], v[226:227], v[96:97]
    v_pk_mul_f32 v[228:229], v[228:229], v[98:99]
    v_exp_f32 v226, v226
    v_exp_f32 v227, v227
    v_exp_f32 v228, v228
    v_exp_f32 v229, v229
    v_pk_fma_f32 v[226:227], v[226:227], v[172:173], v[172:173] op_sel:[0,1,1] op_sel_hi:[1,1,1]
    v_pk_fma_f32 v[228:229], v[228:229], v[172:173], v[172:173] op_sel:[0,1,1] op_sel_hi:[1,1,1]
    v_rcp_f32 v226, v226
    v_rcp_f32 v227, v227
    v_rcp_f32 v228, v228
    v_rcp_f32 v229, v229
    v_pk_mul_f32 v[96:97], v[96:97], v[226:227]
    v_pk_mul_f32 v[98:99], v[98:99], v[228:229]
    v_cvt_pk_bf16_f32 v92, v92, v93
    v_cvt_pk_bf16_f32 v93, v94, v95
    v_cvt_pk_bf16_f32 v94, v96, v97
    v_cvt_pk_bf16_f32 v95, v98, v99
    v_or_b32 v92, 1, v92
    ds_write_b128 v244, v[92:95] offset:20480
    s_cmp_eq_u32 s60, 1
    s_cbranch_scc1 G4_p11
    buffer_load_dwordx4 v[180:183], v196, s[84:87], 0 offen offset:0 sc1
    buffer_load_dwordx4 v[188:191], v196, s[88:91], 0 offen offset:0 sc1
    buffer_load_dwordx4 v[184:187], v196, s[84:87], 0 offen offset:2048 sc1
    buffer_load_dwordx4 v[192:195], v196, s[88:91], 0 offen offset:2048 sc1
    s_branch G4_p21
G4_p11:
    s_add_u32 s36, s40, 0
    buffer_load_dwordx4 v[180:183], v2, s[84:87], s36 offen offset:0 sc1
    buffer_load_dwordx4 v[184:187], v2, s[88:91], s36 offen offset:0 sc1
    buffer_load_dwordx4 v[188:191], v2, s[84:87], s36 offen offset:1024 sc1
    buffer_load_dwordx4 v[192:195], v2, s[88:91], s36 offen offset:1024 sc1
    s_add_u32 s36, s40, 65536
    buffer_load_dwordx4 v[196:199], v2, s[84:87], s36 offen offset:0 sc1
    buffer_load_dwordx4 v[230:233], v2, s[88:91], s36 offen offset:0 sc1
    buffer_load_dwordx4 v[234:237], v2, s[84:87], s36 offen offset:1024 sc1
    buffer_load_dwordx4 v[248:251], v2, s[88:91], s36 offen offset:1024 sc1
G4_p21:
    v_pk_fma_f32 v[120:121], v[176:177], v[148:149], v[120:121] op_sel_hi:[0,1,1] neg_lo:[1,0,0] neg_hi:[1,0,0]
    v_pk_fma_f32 v[122:123], v[176:177], v[150:151], v[122:123] op_sel_hi:[0,1,1] neg_lo:[1,0,0] neg_hi:[1,0,0]
    v_pk_mul_f32 v[226:227], v[120:121], v[120:121]
    v_pk_mul_f32 v[228:229], v[122:123], v[122:123]
    v_pk_fma_f32 v[226:227], v[226:227], v[178:179], v[178:179] op_sel:[0,1,0] op_sel_hi:[1,1,0]
    v_pk_fma_f32 v[228:229], v[228:229], v[178:179], v[178:179] op_sel:[0,1,0] op_sel_hi:[1,1,0]
    v_pk_mul_f32 v[226:227], v[226:227], v[120:121]
    v_pk_mul_f32 v[228:229], v[228:229], v[122:123]
    v_exp_f32 v226, v226
    v_exp_f32 v227, v227
    v_exp_f32 v228, v228
    v_exp_f32 v229, v229
    v_pk_fma_f32 v[226:227], v[226:227], v[176:177], v[176:177] op_sel:[0,1,1] op_sel_hi:[1,1,1]
    v_pk_fma_f32 v[228:229], v[228:229], v[176:177], v[176:177] op_sel:[0,1,1] op_sel_hi:[1,1,1]
    v_rcp_f32 v226, v226
    v_rcp_f32 v227, v227
    v_rcp_f32 v228, v228
    v_rcp_f32 v229, v229
    v_pk_mul_f32 v[120:121], v[120:121], v[226:227]
    v_pk_mul_f32 v[122:123], v[122:123], v[228:229]
    v_pk_fma_f32 v[124:125], v[176:177], v[152:153], v[124:125] op_sel_hi:[0,1,1] neg_lo:[1,0,0] neg_hi:[1,0,0]
    v_pk_fma_f32 v[126:127], v[176:177], v[154:155], v[126:127] op_sel_hi:[0,1,1] neg_lo:[1,0,0] neg_hi:[1,0,0]
    v_pk_mul_f32 v[226:227], v[124:125], v[124:125]
    v_pk_mul_f32 v[228:229], v[126:127], v[126:127]
    v_pk_fma_f32 v[226:227], v[226:227], v[178:179], v[178:179] op_sel:[0,1,0] op_sel_hi:[1,1,0]
    v_pk_fma_f32 v[228:229], v[228:229], v[178:179], v[178:179] op_sel:[0,1,0] op_sel_hi:[1,1,0]
    v_pk_mul_f32 v[226:227], v[226:227], v[124:125]
    v_pk_mul_f32 v[228:229], v[228:229], v[126:127]
    v_exp_f32 v226, v226
    v_exp_f32 v227, v227
    v_exp_f32 v228, v228
    v_exp_f32 v229, v229
    v_pk_fma_f32 v[226:227], v[226:227], v[176:177], v[176:177] op_sel:[0,1,1] op_sel_hi:[1,1,1]
    v_pk_fma_f32 v[228:229], v[228:229], v[176:177], v[176:177] op_sel:[0,1,1] op_sel_hi:[1,1,1]
    v_rcp_f32 v226, v226
    v_rcp_f32 v227, v227
    v_rcp_f32 v228, v228
    v_rcp_f32 v229, v229
    v_pk_mul_f32 v[124:125], v[124:125], v[226:227]
    v_pk_mul_f32 v[126:127], v[126:127], v[228:229]
    v_cvt_pk_bf16_f32 v120, v120, v121
    v_cvt_pk_bf16_f32 v121, v122, v123
    v_cvt_pk_bf16_f32 v122, v124, v125
    v_cvt_pk_bf16_f32 v123, v126, v127
    ds_write_b128 v244, v[120:123] offset:22528
    v_pk_fma_f32 v[44:45], v[164:165], v[156:157], v[44:45] op_sel_hi:[0,1,1] neg_lo:[1,0,0] neg_hi:[1,0,0]
    v_pk_fma_f32 v[46:47], v[164:165], v[158:159], v[46:47] op_sel_hi:[0,1,1] neg_lo:[1,0,0] neg_hi:[1,0,0]
    v_pk_mul_f32 v[226:227], v[44:45], v[44:45]
    v_pk_mul_f32 v[228:229], v[46:47], v[46:47]
    v_pk_fma_f32 v[226:227], v[226:227], v[166:167], v[166:167] op_sel:[0,1,0] op_sel_hi:[1,1,0]
    v_pk_fma_f32 v[228:229], v[228:229], v[166:167], v[166:167] op_sel:[0,1,0] op_sel_hi:[1,1,0]
    v_pk_mul_f32 v[226:227], v[226:227], v[44:45]
    v_pk_mul_f32 v[228:229], v[228:229], v[46:47]
    v_exp_f32 v226, v226
    v_exp_f32 v227, v227
    v_exp_f32 v228, v228
    v_exp_f32 v229, v229
    v_pk_fma_f32 v[226:227], v[226:227], v[164:165], v[164:165] op_sel:[0,1,1] op_sel_hi:[1,1,1]
    v_pk_fma_f32 v[228:229], v[228:229], v[164:165], v[164:165] op_sel:[0,1,1] op_sel_hi:[1,1,1]
    v_rcp_f32 v226, v226
    v_rcp_f32 v227, v227
    v_rcp_f32 v228, v228
    v_rcp_f32 v229, v229
    v_pk_mul_f32 v[44:45], v[44:45], v[226:227]
    v_pk_mul_f32 v[46:47], v[46:47], v[228:229]
    v_pk_fma_f32 v[48:49], v[164:165], v[160:161], v[48:49] op_sel_hi:[0,1,1] neg_lo:[1,0,0] neg_hi:[1,0,0]
    v_pk_fma_f32 v[50:51], v[164:165], v[162:163], v[50:51] op_sel_hi:[0,1,1] neg_lo:[1,0,0] neg_hi:[1,0,0]
    v_pk_mul_f32 v[226:227], v[48:49], v[48:49]
    v_pk_mul_f32 v[228:229], v[50:51], v[50:51]
    v_pk_fma_f32 v[226:227], v[226:227], v[166:167], v[166:167] op_sel:[0,1,0] op_sel_hi:[1,1,0]
    v_pk_fma_f32 v[228:229], v[228:229], v[166:167], v[166:167] op_sel:[0,1,0] op_sel_hi:[1,1,0]
    v_pk_mul_f32 v[226:227], v[226:227], v[48:49]
    v_pk_mul_f32 v[228:229], v[228:229], v[50:51]
    v_exp_f32 v226, v226
    v_exp_f32 v227, v227
    v_exp_f32 v228, v228
    v_exp_f32 v229, v229
    v_pk_fma_f32 v[226:227], v[226:227], v[164:165], v[164:165] op_sel:[0,1,1] op_sel_hi:[1,1,1]
    v_pk_fma_f32 v[228:229], v[228:229], v[164:165], v[164:165] op_sel:[0,1,1] op_sel_hi:[1,1,1]
    v_rcp_f32 v226, v226
    v_rcp_f32 v227, v227
    v_rcp_f32 v228, v228
    v_rcp_f32 v229, v229
    v_pk_mul_f32 v[48:49], v[48:49], v[226:227]
    v_pk_mul_f32 v[50:51], v[50:51], v[228:229]
    v_cvt_pk_bf16_f32 v200, v44, v45
    v_cvt_pk_bf16_f32 v201, v46, v47
    v_cvt_pk_bf16_f32 v202, v48, v49
    v_cvt_pk_bf16_f32 v203, v50, v51
    v_or_b32 v200, 1, v200
    ds_write_b128 v244, v[200:203] offset:32768
    v_pk_fma_f32 v[72:73], v[168:169], v[156:157], v[72:73] op_sel_hi:[0,1,1] neg_lo:[1,0,0] neg_hi:[1,0,0]
    v_pk_fma_f32 v[74:75], v[168:169], v[158:159], v[74:75] op_sel_hi:[0,1,1] neg_lo:[1,0,0] neg_hi:[1,0,0]
    v_pk_mul_f32 v[226:227], v[72:73], v[72:73]
    v_pk_mul_f32 v[228:229], v[74:75], v[74:75]
    v_pk_fma_f32 v[226:227], v[226:227], v[170:171], v[170:171] op_sel:[0,1,0] op_sel_hi:[1,1,0]
    v_pk_fma_f32 v[228:229], v[228:229], v[170:171], v[170:171] op_sel:[0,1,0] op_sel_hi:[1,1,0]
    v_pk_mul_f32 v[226:227], v[226:227], v[72:73]
    v_pk_mul_f32 v[228:229], v[228:229], v[74:75]
    v_exp_f32 v226, v226
    v_exp_f32 v227, v227
    v_exp_f32 v228, v228
    v_exp_f32 v229, v229
    v_pk_fma_f32 v[226:227], v[226:227], v[168:169], v[168:169] op_sel:[0,1,1] op_sel_hi:[1,1,1]
    v_pk_fma_f32 v[228:229], v[228:229], v[168:169], v[168:169] op_sel:[0,1,1] op_sel_hi:[1,1,1]
    v_rcp_f32 v226, v226
    v_rcp_f32 v227, v227
    v_rcp_f32 v228, v228
    v_rcp_f32 v229, v229
    v_pk_mul_f32 v[72:73], v[72:73], v[226:227]
    v_pk_mul_f32 v[74:75], v[74:75], v[228:229]
    v_pk_fma_f32 v[76:77], v[168:169], v[160:161], v[76:77] op_sel_hi:[0,1,1] neg_lo:[1,0,0] neg_hi:[1,0,0]
    v_pk_fma_f32 v[78:79], v[168:169], v[162:163], v[78:79] op_sel_hi:[0,1,1] neg_lo:[1,0,0] neg_hi:[1,0,0]
    v_pk_mul_f32 v[226:227], v[76:77], v[76:77]
    v_pk_mul_f32 v[228:229], v[78:79], v[78:79]
    v_pk_fma_f32 v[226:227], v[226:227], v[170:171], v[170:171] op_sel:[0,1,0] op_sel_hi:[1,1,0]
    v_pk_fma_f32 v[228:229], v[228:229], v[170:171], v[170:171] op_sel:[0,1,0] op_sel_hi:[1,1,0]
    v_pk_mul_f32 v[226:227], v[226:227], v[76:77]
    v_pk_mul_f32 v[228:229], v[228:229], v[78:79]
    v_exp_f32 v226, v226
    v_exp_f32 v227, v227
    v_exp_f32 v228, v228
    v_exp_f32 v229, v229
    v_pk_fma_f32 v[226:227], v[226:227], v[168:169], v[168:169] op_sel:[0,1,1] op_sel_hi:[1,1,1]
    v_pk_fma_f32 v[228:229], v[228:229], v[168:169], v[168:169] op_sel:[0,1,1] op_sel_hi:[1,1,1]
    v_rcp_f32 v226, v226
    v_rcp_f32 v227, v227
    v_rcp_f32 v228, v228
    v_rcp_f32 v229, v229
    v_pk_mul_f32 v[76:77], v[76:77], v[226:227]
    v_pk_mul_f32 v[78:79], v[78:79], v[228:229]
    v_cvt_pk_bf16_f32 v204, v72, v73
    v_cvt_pk_bf16_f32 v205, v74, v75
    v_cvt_pk_bf16_f32 v206, v76, v77
    v_cvt_pk_bf16_f32 v207, v78, v79
    v_or_b32 v204, 1, v204
    ds_write_b128 v244, v[204:207] offset:34816
    v_pk_fma_f32 v[100:101], v[172:173], v[156:157], v[100:101] op_sel_hi:[0,1,1] neg_lo:[1,0,0] neg_hi:[1,0,0]
    v_pk_fma_f32 v[102:103], v[172:173], v[158:159], v[102:103] op_sel_hi:[0,1,1] neg_lo:[1,0,0] neg_hi:[1,0,0]
    v_pk_mul_f32 v[226:227], v[100:101], v[100:101]
    v_pk_mul_f32 v[228:229], v[102:103], v[102:103]
    v_pk_fma_f32 v[226:227], v[226:227], v[174:175], v[174:175] op_sel:[0,1,0] op_sel_hi:[1,1,0]
    v_pk_fma_f32 v[228:229], v[228:229], v[174:175], v[174:175] op_sel:[0,1,0] op_sel_hi:[1,1,0]
    v_pk_mul_f32 v[226:227], v[226:227], v[100:101]
    v_pk_mul_f32 v[228:229], v[228:229], v[102:103]
    v_exp_f32 v226, v226
    v_exp_f32 v227, v227
    v_exp_f32 v228, v228
    v_exp_f32 v229, v229
    v_pk_fma_f32 v[226:227], v[226:227], v[172:173], v[172:173] op_sel:[0,1,1] op_sel_hi:[1,1,1]
    v_pk_fma_f32 v[228:229], v[228:229], v[172:173], v[172:173] op_sel:[0,1,1] op_sel_hi:[1,1,1]
    v_rcp_f32 v226, v226
    v_rcp_f32 v227, v227
    v_rcp_f32 v228, v228
    v_rcp_f32 v229, v229
    v_pk_mul_f32 v[100:101], v[100:101], v[226:227]
    v_pk_mul_f32 v[102:103], v[102:103], v[228:229]
    v_pk_fma_f32 v[104:105], v[172:173], v[160:161], v[104:105] op_sel_hi:[0,1,1] neg_lo:[1,0,0] neg_hi:[1,0,0]
    v_pk_fma_f32 v[106:107], v[172:173], v[162:163], v[106:107] op_sel_hi:[0,1,1] neg_lo:[1,0,0] neg_hi:[1,0,0]
    v_pk_mul_f32 v[226:227], v[104:105], v[104:105]
    v_pk_mul_f32 v[228:229], v[106:107], v[106:107]
    v_pk_fma_f32 v[226:227], v[226:227], v[174:175], v[174:175] op_sel:[0,1,0] op_sel_hi:[1,1,0]
    v_pk_fma_f32 v[228:229], v[228:229], v[174:175], v[174:175] op_sel:[0,1,0] op_sel_hi:[1,1,0]
    v_pk_mul_f32 v[226:227], v[226:227], v[104:105]
    v_pk_mul_f32 v[228:229], v[228:229], v[106:107]
    v_exp_f32 v226, v226
    v_exp_f32 v227, v227
    v_exp_f32 v228, v228
    v_exp_f32 v229, v229
    v_pk_fma_f32 v[226:227], v[226:227], v[172:173], v[172:173] op_sel:[0,1,1] op_sel_hi:[1,1,1]
    v_pk_fma_f32 v[228:229], v[228:229], v[172:173], v[172:173] op_sel:[0,1,1] op_sel_hi:[1,1,1]
    v_rcp_f32 v226, v226
    v_rcp_f32 v227, v227
    v_rcp_f32 v228, v228
    v_rcp_f32 v229, v229
    v_pk_mul_f32 v[104:105], v[104:105], v[226:227]
    v_pk_mul_f32 v[106:107], v[106:107], v[228:229]
    v_cvt_pk_bf16_f32 v208, v100, v101
    v_cvt_pk_bf16_f32 v209, v102, v103
    v_cvt_pk_bf16_f32 v210, v104, v105
    v_cvt_pk_bf16_f32 v211, v106, v107
    v_or_b32 v208, 1, v208
    ds_write_b128 v244, v[208:211] offset:36864
    v_pk_fma_f32 v[128:129], v[176:177], v[156:157], v[128:129] op_sel_hi:[0,1,1] neg_lo:[1,0,0] neg_hi:[1,0,0]
    v_pk_fma_f32 v[130:131], v[176:177], v[158:159], v[130:131] op_sel_hi:[0,1,1] neg_lo:[1,0,0] neg_hi:[1,0,0]
    v_pk_mul_f32 v[226:227], v[128:129], v[128:129]
    v_pk_mul_f32 v[228:229], v[130:131], v[130:131]
    v_pk_fma_f32 v[226:227], v[226:227], v[178:179], v[178:179] op_sel:[0,1,0] op_sel_hi:[1,1,0]
    v_pk_fma_f32 v[228:229], v[228:229], v[178:179], v[178:179] op_sel:[0,1,0] op_sel_hi:[1,1,0]
    v_pk_mul_f32 v[226:227], v[226:227], v[128:129]
    v_pk_mul_f32 v[228:229], v[228:229], v[130:131]
    v_exp_f32 v226, v226
    v_exp_f32 v227, v227
    v_exp_f32 v228, v228
    v_exp_f32 v229, v229
    v_pk_fma_f32 v[226:227], v[226:227], v[176:177], v[176:177] op_sel:[0,1,1] op_sel_hi:[1,1,1]
    v_pk_fma_f32 v[228:229], v[228:229], v[176:177], v[176:177] op_sel:[0,1,1] op_sel_hi:[1,1,1]
    v_rcp_f32 v226, v226
    v_rcp_f32 v227, v227
    v_rcp_f32 v228, v228
    v_rcp_f32 v229, v229
    v_pk_mul_f32 v[128:129], v[128:129], v[226:227]
    v_pk_mul_f32 v[130:131], v[130:131], v[228:229]
    v_pk_fma_f32 v[132:133], v[176:177], v[160:161], v[132:133] op_sel_hi:[0,1,1] neg_lo:[1,0,0] neg_hi:[1,0,0]
    v_pk_fma_f32 v[134:135], v[176:177], v[162:163], v[134:135] op_sel_hi:[0,1,1] neg_lo:[1,0,0] neg_hi:[1,0,0]
    v_pk_mul_f32 v[226:227], v[132:133], v[132:133]
    v_pk_mul_f32 v[228:229], v[134:135], v[134:135]
    v_pk_fma_f32 v[226:227], v[226:227], v[178:179], v[178:179] op_sel:[0,1,0] op_sel_hi:[1,1,0]
    v_pk_fma_f32 v[228:229], v[228:229], v[178:179], v[178:179] op_sel:[0,1,0] op_sel_hi:[1,1,0]
    v_pk_mul_f32 v[226:227], v[226:227], v[132:133]
    v_pk_mul_f32 v[228:229], v[228:229], v[134:135]
    v_exp_f32 v226, v226
    v_exp_f32 v227, v227
    v_exp_f32 v228, v228
    v_exp_f32 v229, v229
    v_pk_fma_f32 v[226:227], v[226:227], v[176:177], v[176:177] op_sel:[0,1,1] op_sel_hi:[1,1,1]
    v_pk_fma_f32 v[228:229], v[228:229], v[176:177], v[176:177] op_sel:[0,1,1] op_sel_hi:[1,1,1]
    v_rcp_f32 v226, v226
    v_rcp_f32 v227, v227
    v_rcp_f32 v228, v228
    v_rcp_f32 v229, v229
    v_pk_mul_f32 v[132:133], v[132:133], v[226:227]
    v_pk_mul_f32 v[134:135], v[134:135], v[228:229]
    v_cvt_pk_bf16_f32 v212, v128, v129
    v_cvt_pk_bf16_f32 v213, v130, v131
    v_cvt_pk_bf16_f32 v214, v132, v133
    v_cvt_pk_bf16_f32 v215, v134, v135
    ds_write_b128 v244, v[212:215] offset:38912
    v_pk_fma_f32 v[24:25], v[164:165], v[136:137], v[24:25] op_sel_hi:[0,1,1] neg_lo:[1,0,0] neg_hi:[1,0,0]
    v_pk_fma_f32 v[26:27], v[164:165], v[138:139], v[26:27] op_sel_hi:[0,1,1] neg_lo:[1,0,0] neg_hi:[1,0,0]
    v_pk_mul_f32 v[226:227], v[24:25], v[24:25]
    v_pk_mul_f32 v[228:229], v[26:27], v[26:27]
    v_pk_fma_f32 v[226:227], v[226:227], v[166:167], v[166:167] op_sel:[0,1,0] op_sel_hi:[1,1,0]
    v_pk_fma_f32 v[228:229], v[228:229], v[166:167], v[166:167] op_sel:[0,1,0] op_sel_hi:[1,1,0]
    v_pk_mul_f32 v[226:227], v[226:227], v[24:25]
    v_pk_mul_f32 v[228:229], v[228:229], v[26:27]
    v_exp_f32 v226, v226
    v_exp_f32 v227, v227
    v_exp_f32 v228, v228
    v_exp_f32 v229, v229
    v_pk_fma_f32 v[226:227], v[226:227], v[164:165], v[164:165] op_sel:[0,1,1] op_sel_hi:[1,1,1]
    v_pk_fma_f32 v[228:229], v[228:229], v[164:165], v[164:165] op_sel:[0,1,1] op_sel_hi:[1,1,1]
    v_rcp_f32 v226, v226
    v_rcp_f32 v227, v227
    v_rcp_f32 v228, v228
    v_rcp_f32 v229, v229
    v_pk_mul_f32 v[24:25], v[24:25], v[226:227]
    v_pk_mul_f32 v[26:27], v[26:27], v[228:229]
    v_cvt_pk_bf16_f32 v216, v24, v25
    v_cvt_pk_bf16_f32 v217, v26, v27
    v_or_b32 v216, 1, v216
    s_add_u32 s36, s46, 0
    buffer_store_dwordx4 v[36:39], v2, s[16:19], s36 offen sc1
    v_pk_fma_f32 v[52:53], v[168:169], v[136:137], v[52:53] op_sel_hi:[0,1,1] neg_lo:[1,0,0] neg_hi:[1,0,0]
    v_pk_fma_f32 v[54:55], v[168:169], v[138:139], v[54:55] op_sel_hi:[0,1,1] neg_lo:[1,0,0] neg_hi:[1,0,0]
    v_pk_mul_f32 v[226:227], v[52:53], v[52:53]
    v_pk_mul_f32 v[228:229], v[54:55], v[54:55]
    v_pk_fma_f32 v[226:227], v[226:227], v[170:171], v[170:171] op_sel:[0,1,0] op_sel_hi:[1,1,0]
    v_pk_fma_f32 v[228:229], v[228:229], v[170:171], v[170:171] op_sel:[0,1,0] op_sel_hi:[1,1,0]
    v_pk_mul_f32 v[226:227], v[226:227], v[52:53]
    v_pk_mul_f32 v[228:229], v[228:229], v[54:55]
    v_exp_f32 v226, v226
    v_exp_f32 v227, v227
    v_exp_f32 v228, v228
    v_exp_f32 v229, v229
    v_pk_fma_f32 v[226:227], v[226:227], v[168:169], v[168:169] op_sel:[0,1,1] op_sel_hi:[1,1,1]
    v_pk_fma_f32 v[228:229], v[228:229], v[168:169], v[168:169] op_sel:[0,1,1] op_sel_hi:[1,1,1]
    v_rcp_f32 v226, v226
    v_rcp_f32 v227, v227
    v_rcp_f32 v228, v228
    v_rcp_f32 v229, v229
    v_pk_mul_f32 v[52:53], v[52:53], v[226:227]
    v_pk_mul_f32 v[54:55], v[54:55], v[228:229]
    v_cvt_pk_bf16_f32 v218, v52, v53
    v_cvt_pk_bf16_f32 v219, v54, v55
    v_or_b32 v218, 1, v218
    s_add_u32 s36, s46, 229376
    buffer_store_dwordx4 v[64:67], v2, s[16:19], s36 offen sc1
    v_pk_fma_f32 v[80:81], v[172:173], v[136:137], v[80:81] op_sel_hi:[0,1,1] neg_lo:[1,0,0] neg_hi:[1,0,0]
    v_pk_fma_f32 v[82:83], v[172:173], v[138:139], v[82:83] op_sel_hi:[0,1,1] neg_lo:[1,0,0] neg_hi:[1,0,0]
    v_pk_mul_f32 v[226:227], v[80:81], v[80:81]
    v_pk_mul_f32 v[228:229], v[82:83], v[82:83]
    v_pk_fma_f32 v[226:227], v[226:227], v[174:175], v[174:175] op_sel:[0,1,0] op_sel_hi:[1,1,0]
    v_pk_fma_f32 v[228:229], v[228:229], v[174:175], v[174:175] op_sel:[0,1,0] op_sel_hi:[1,1,0]
    v_pk_mul_f32 v[226:227], v[226:227], v[80:81]
    v_pk_mul_f32 v[228:229], v[228:229], v[82:83]
    v_exp_f32 v226, v226
    v_exp_f32 v227, v227
    v_exp_f32 v228, v228
    v_exp_f32 v229, v229
    v_pk_fma_f32 v[226:227], v[226:227], v[172:173], v[172:173] op_sel:[0,1,1] op_sel_hi:[1,1,1]
    v_pk_fma_f32 v[228:229], v[228:229], v[172:173], v[172:173] op_sel:[0,1,1] op_sel_hi:[1,1,1]
    v_rcp_f32 v226, v226
    v_rcp_f32 v227, v227
    v_rcp_f32 v228, v228
    v_rcp_f32 v229, v229
    v_pk_mul_f32 v[80:81], v[80:81], v[226:227]
    v_pk_mul_f32 v[82:83], v[82:83], v[228:229]
    v_cvt_pk_bf16_f32 v220, v80, v81
    v_cvt_pk_bf16_f32 v221, v82, v83
    v_or_b32 v220, 1, v220
    s_add_u32 s36, s46, 458752
    buffer_store_dwordx4 v[92:95], v2, s[16:19], s36 offen sc1
    v_pk_fma_f32 v[108:109], v[176:177], v[136:137], v[108:109] op_sel_hi:[0,1,1] neg_lo:[1,0,0] neg_hi:[1,0,0]
    v_pk_fma_f32 v[110:111], v[176:177], v[138:139], v[110:111] op_sel_hi:[0,1,1] neg_lo:[1,0,0] neg_hi:[1,0,0]
    v_pk_mul_f32 v[226:227], v[108:109], v[108:109]
    v_pk_mul_f32 v[228:229], v[110:111], v[110:111]
    v_pk_fma_f32 v[226:227], v[226:227], v[178:179], v[178:179] op_sel:[0,1,0] op_sel_hi:[1,1,0]
    v_pk_fma_f32 v[228:229], v[228:229], v[178:179], v[178:179] op_sel:[0,1,0] op_sel_hi:[1,1,0]
    v_pk_mul_f32 v[226:227], v[226:227], v[108:109]
    v_pk_mul_f32 v[228:229], v[228:229], v[110:111]
    v_exp_f32 v226, v226
    v_exp_f32 v227, v227
    v_exp_f32 v228, v228
    v_exp_f32 v229, v229
    v_pk_fma_f32 v[226:227], v[226:227], v[176:177], v[176:177] op_sel:[0,1,1] op_sel_hi:[1,1,1]
    v_pk_fma_f32 v[228:229], v[228:229], v[176:177], v[176:177] op_sel:[0,1,1] op_sel_hi:[1,1,1]
    v_rcp_f32 v226, v226
    v_rcp_f32 v227, v227
    v_rcp_f32 v228, v228
    v_rcp_f32 v229, v229
    v_pk_mul_f32 v[108:109], v[108:109], v[226:227]
    v_pk_mul_f32 v[110:111], v[110:111], v[228:229]
    v_cvt_pk_bf16_f32 v222, v108, v109
    v_cvt_pk_bf16_f32 v223, v110, v111
    s_add_u32 s36, s46, 688128
    buffer_store_dwordx4 v[120:123], v2, s[16:19], s36 offen sc1
    s_waitcnt lgkmcnt(0)
    s_add_u32 s45, s44, 512
    s_mov_b32 s44, s47
G3_e2:
    s_waitcnt lgkmcnt(0)
    s_barrier
    ds_read_b128 v[88:91], v17 offset:0
    ds_read_b128 v[92:95], v17 offset:2048
    ds_read_b128 v[96:99], v17 offset:4096
    ds_read_b128 v[100:103], v17 offset:6144
    ds_read_b64_tr_b16 v[104:105], v18 offset:0
    ds_read_b64_tr_b16 v[106:107], v18 offset:4096
    ds_read_b64_tr_b16 v[108:109], v19 offset:0
    ds_read_b64_tr_b16 v[110:111], v19 offset:4096
    ds_read_b64_tr_b16 v[112:113], v20 offset:0
    ds_read_b64_tr_b16 v[114:115], v20 offset:4096
    ds_read_b64_tr_b16 v[116:117], v21 offset:0
    ds_read_b64_tr_b16 v[118:119], v21 offset:4096
    s_waitcnt lgkmcnt(6)
    v_mfma_f32_16x16x32_bf16 v[24:27], v[104:107], v[88:91], 0
    ds_read_b128 v[120:123], v17 offset:1024
    s_add_u32 s42, s42, 16384
    v_mfma_f32_16x16x32_bf16 v[40:43], v[104:107], v[92:95], 0
    ds_read_b128 v[124:127], v17 offset:3072
    s_cmp_eq_u32 s42, 49152
    v_mfma_f32_16x16x32_bf16 v[56:59], v[104:107], v[96:99], 0
    ds_read_b128 v[128:131], v17 offset:5120
    s_cselect_b32 s42, 0, s42
    v_mfma_f32_16x16x32_bf16 v[72:75], v[104:107], v[100:103], 0
    ds_read_b128 v[132:135], v17 offset:7168
    s_waitcnt lgkmcnt(8)
    v_mfma_f32_16x16x32_bf16 v[76:79], v[108:111], v[100:103], 0
    ds_read_b64_tr_b16 v[136:137], v18 offset:8192
    s_add_u32 s48, s48, 16384
    v_mfma_f32_16x16x32_bf16 v[60:63], v[108:111], v[96:99], 0
    ds_read_b64_tr_b16 v[138:139], v18 offset:12288
    s_cmp_eq_u32 s48, 98304
    v_mfma_f32_16x16x32_bf16 v[44:47], v[108:111], v[92:95], 0
    ds_read_b64_tr_b16 v[140:141], v19 offset:8192
    s_cselect_b32 s48, 0, s48
    v_mfma_f32_16x16x32_bf16 v[28:31], v[108:111], v[88:91], 0
    ds_read_b64_tr_b16 v[142:143], v19 offset:12288
    s_waitcnt lgkmcnt(8)
    v_mfma_f32_16x16x32_bf16 v[32:35], v[112:115], v[88:91], 0
    ds_read_b64_tr_b16 v[144:145], v20 offset:8192
    v_add_u32 v17, s42, v12
    v_mfma_f32_16x16x32_bf16 v[48:51], v[112:115], v[92:95], 0
    ds_read_b64_tr_b16 v[146:147], v20 offset:12288
    s_add_u32 s36, s44, 0
    v_mfma_f32_16x16x32_bf16 v[64:67], v[112:115], v[96:99], 0
    ds_read_b64_tr_b16 v[148:149], v21 offset:8192
    buffer_store_dwordx4 v[200:203], v2, s[16:19], s36 offen sc1
    v_mfma_f32_16x16x32_bf16 v[80:83], v[112:115], v[100:103], 0
    ds_read_b64_tr_b16 v[150:151], v21 offset:12288
    s_add_u32 s36, s45, 0
    v_mfma_f32_16x16x32_bf16 v[84:87], v[116:119], v[100:103], 0
    buffer_store_dwordx2 v[216:217], v238, s[16:19], s36 offen sc1
    v_add_u32 v18, s48, v13
    v_mfma_f32_16x16x32_bf16 v[68:71], v[116:119], v[96:99], 0
    v_add_u32 v19, s48, v14
    v_mfma_f32_16x16x32_bf16 v[52:55], v[116:119], v[92:95], 0
    v_add_u32 v20, s48, v15
    v_mfma_f32_16x16x32_bf16 v[36:39], v[116:119], v[88:91], 0
    v_add_u32 v21, s48, v16
    s_waitcnt lgkmcnt(6)
    v_mfma_f32_16x16x32_bf16 v[24:27], v[136:139], v[120:123], v[24:27]
    v_mfma_f32_16x16x32_bf16 v[40:43], v[136:139], v[124:127], v[40:43]
    v_mfma_f32_16x16x32_bf16 v[56:59], v[136:139], v[128:131], v[56:59]
    s_waitcnt lgkmcnt(0)
    s_barrier
    v_mfma_f32_16x16x32_bf16 v[72:75], v[136:139], v[132:135], v[72:75]
    ds_read_b128 v[88:91], v17 offset:0
    s_add_u32 s36, s44, 229376
    v_mfma_f32_16x16x32_bf16 v[76:79], v[140:143], v[132:135], v[76:79]
    ds_read_b128 v[92:95], v17 offset:2048
    buffer_store_dwordx4 v[204:207], v2, s[16:19], s36 offen sc1
    v_mfma_f32_16x16x32_bf16 v[60:63], v[140:143], v[128:131], v[60:63]
    ds_read_b128 v[96:99], v17 offset:4096
    s_add_u32 s36, s45, 229376
    v_mfma_f32_16x16x32_bf16 v[44:47], v[140:143], v[124:127], v[44:47]
    ds_read_b128 v[100:103], v17 offset:6144
    buffer_store_dwordx2 v[218:219], v238, s[16:19], s36 offen sc1
    v_mfma_f32_16x16x32_bf16 v[28:31], v[140:143], v[120:123], v[28:31]
    ds_read_b64_tr_b16 v[104:105], v18 offset:0
    s_add_u32 s43, s43, 1
    v_mfma_f32_16x16x32_bf16 v[32:35], v[144:147], v[120:123], v[32:35]
    ds_read_b64_tr_b16 v[106:107], v18 offset:4096
    s_cmp_lt_u32 s43, 27
    v_mfma_f32_16x16x32_bf16 v[48:51], v[144:147], v[124:127], v[48:51]
    ds_read_b64_tr_b16 v[108:109], v19 offset:0
    v_mfma_f32_16x16x32_bf16 v[64:67], v[144:147], v[128:131], v[64:67]
    ds_read_b64_tr_b16 v[110:111], v19 offset:4096
    v_mfma_f32_16x16x32_bf16 v[80:83], v[144:147], v[132:135], v[80:83]
    ds_read_b64_tr_b16 v[112:113], v20 offset:0
    v_mfma_f32_16x16x32_bf16 v[84:87], v[148:151], v[132:135], v[84:87]
    ds_read_b64_tr_b16 v[114:115], v20 offset:4096
    v_mfma_f32_16x16x32_bf16 v[68:71], v[148:151], v[128:131], v[68:71]
    ds_read_b64_tr_b16 v[116:117], v21 offset:0
    v_mfma_f32_16x16x32_bf16 v[52:55], v[148:151], v[124:127], v[52:55]
    ds_read_b64_tr_b16 v[118:119], v21 offset:4096
    v_mfma_f32_16x16x32_bf16 v[36:39], v[148:151], v[120:123], v[36:39]
    s_waitcnt lgkmcnt(6)
    v_mfma_f32_16x16x32_bf16 v[24:27], v[104:107], v[88:91], v[24:27]
    ds_read_b128 v[120:123], v17 offset:1024
    s_add_u32 s42, s42, 16384
    v_mfma_f32_16x16x32_bf16 v[40:43], v[104:107], v[92:95], v[40:43]
    ds_read_b128 v[124:127], v17 offset:3072
    s_cmp_eq_u32 s42, 49152
    v_mfma_f32_16x16x32_bf16 v[56:59], v[104:107], v[96:99], v[56:59]
    ds_read_b128 v[128:131], v17 offset:5120
    s_cselect_b32 s42, 0, s42
    v_mfma_f32_16x16x32_bf16 v[72:75], v[104:107], v[100:103], v[72:75]
    ds_read_b128 v[132:135], v17 offset:7168
    s_waitcnt lgkmcnt(8)
    v_mfma_f32_16x16x32_bf16 v[76:79], v[108:111], v[100:103], v[76:79]
    ds_read_b64_tr_b16 v[136:137], v18 offset:8192
    s_add_u32 s48, s48, 16384
    v_mfma_f32_16x16x32_bf16 v[60:63], v[108:111], v[96:99], v[60:63]
    ds_read_b64_tr_b16 v[138:139], v18 offset:12288
    s_cmp_eq_u32 s48, 98304
    v_mfma_f32_16x16x32_bf16 v[44:47], v[108:111], v[92:95], v[44:47]
    ds_read_b64_tr_b16 v[140:141], v19 offset:8192
    s_cselect_b32 s48, 0, s48
    v_mfma_f32_16x16x32_bf16 v[28:31], v[108:111], v[88:91], v[28:31]
    ds_read_b64_tr_b16 v[142:143], v19 offset:12288
    s_waitcnt lgkmcnt(8)
    v_mfma_f32_16x16x32_bf16 v[32:35], v[112:115], v[88:91], v[32:35]
    ds_read_b64_tr_b16 v[144:145], v20 offset:8192
    v_add_u32 v17, s42, v12
    v_mfma_f32_16x16x32_bf16 v[48:51], v[112:115], v[92:95], v[48:51]
    ds_read_b64_tr_b16 v[146:147], v20 offset:12288
    s_add_u32 s36, s44, 458752
    v_mfma_f32_16x16x32_bf16 v[64:67], v[112:115], v[96:99], v[64:67]
    ds_read_b64_tr_b16 v[148:149], v21 offset:8192
    buffer_store_dwordx4 v[208:211], v2, s[16:19], s36 offen sc1
    v_mfma_f32_16x16x32_bf16 v[80:83], v[112:115], v[100:103], v[80:83]
    ds_read_b64_tr_b16 v[150:151], v21 offset:12288
    s_add_u32 s36, s45, 458752
    v_mfma_f32_16x16x32_bf16 v[84:87], v[116:119], v[100:103], v[84:87]
    buffer_store_dwordx2 v[220:221], v238, s[16:19], s36 offen sc1
    v_add_u32 v18, s48, v13
    v_mfma_f32_16x16x32_bf16 v[68:71], v[116:119], v[96:99], v[68:71]
    v_add_u32 v19, s48, v14
    v_mfma_f32_16x16x32_bf16 v[52:55], v[116:119], v[92:95], v[52:55]
    v_add_u32 v20, s48, v15
    v_mfma_f32_16x16x32_bf16 v[36:39], v[116:119], v[88:91], v[36:39]
    v_add_u32 v21, s48, v16
    s_waitcnt lgkmcnt(6)
    v_mfma_f32_16x16x32_bf16 v[24:27], v[136:139], v[120:123], v[24:27]
    v_mfma_f32_16x16x32_bf16 v[40:43], v[136:139], v[124:127], v[40:43]
    s_waitcnt vmcnt(6)
    v_mfma_f32_16x16x32_bf16 v[56:59], v[136:139], v[128:131], v[56:59]
    s_waitcnt lgkmcnt(0)
    s_barrier
    v_mfma_f32_16x16x32_bf16 v[72:75], v[136:139], v[132:135], v[72:75]
    ds_read_b128 v[88:91], v17 offset:0
    s_add_u32 s36, s44, 688128
    v_mfma_f32_16x16x32_bf16 v[76:79], v[140:143], v[132:135], v[76:79]
    ds_read_b128 v[92:95], v17 offset:2048
    buffer_store_dwordx4 v[212:215], v2, s[16:19], s36 offen sc1
    v_mfma_f32_16x16x32_bf16 v[60:63], v[140:143], v[128:131], v[60:63]
    ds_read_b128 v[96:99], v17 offset:4096
    s_add_u32 s36, s45, 688128
    v_mfma_f32_16x16x32_bf16 v[44:47], v[140:143], v[124:127], v[44:47]
    ds_read_b128 v[100:103], v17 offset:6144
    buffer_store_dwordx2 v[222:223], v238, s[16:19], s36 offen sc1
    v_mfma_f32_16x16x32_bf16 v[28:31], v[140:143], v[120:123], v[28:31]
    ds_read_b64_tr_b16 v[104:105], v18 offset:0
    s_add_u32 s43, s43, 1
    v_mfma_f32_16x16x32_bf16 v[32:35], v[144:147], v[120:123], v[32:35]
    ds_read_b64_tr_b16 v[106:107], v18 offset:4096
    s_cmp_lt_u32 s43, 27
    v_mfma_f32_16x16x32_bf16 v[48:51], v[144:147], v[124:127], v[48:51]
    ds_read_b64_tr_b16 v[108:109], v19 offset:0
    v_mfma_f32_16x16x32_bf16 v[64:67], v[144:147], v[128:131], v[64:67]
    ds_read_b64_tr_b16 v[110:111], v19 offset:4096
    v_mfma_f32_16x16x32_bf16 v[80:83], v[144:147], v[132:135], v[80:83]
    ds_read_b64_tr_b16 v[112:113], v20 offset:0
    v_mfma_f32_16x16x32_bf16 v[84:87], v[148:151], v[132:135], v[84:87]
    ds_read_b64_tr_b16 v[114:115], v20 offset:4096
    v_mfma_f32_16x16x32_bf16 v[68:71], v[148:151], v[128:131], v[68:71]
    ds_read_b64_tr_b16 v[116:117], v21 offset:0
    v_mfma_f32_16x16x32_bf16 v[52:55], v[148:151], v[124:127], v[52:55]
    ds_read_b64_tr_b16 v[118:119], v21 offset:4096
    v_mfma_f32_16x16x32_bf16 v[36:39], v[148:151], v[120:123], v[36:39]
    s_waitcnt lgkmcnt(6)
mm_24:
    v_mfma_f32_16x16x32_bf16 v[24:27], v[104:107], v[88:91], v[24:27]
    ds_read_b128 v[120:123], v17 offset:1024
    s_add_u32 s42, s42, 16384
    v_mfma_f32_16x16x32_bf16 v[40:43], v[104:107], v[92:95], v[40:43]
    ds_read_b128 v[124:127], v17 offset:3072
    s_cmp_eq_u32 s42, 49152
    v_mfma_f32_16x16x32_bf16 v[56:59], v[104:107], v[96:99], v[56:59]
    ds_read_b128 v[128:131], v17 offset:5120
    s_cselect_b32 s42, 0, s42
    v_mfma_f32_16x16x32_bf16 v[72:75], v[104:107], v[100:103], v[72:75]
    ds_read_b128 v[132:135], v17 offset:7168
    s_waitcnt lgkmcnt(8)
    v_mfma_f32_16x16x32_bf16 v[76:79], v[108:111], v[100:103], v[76:79]
    ds_read_b64_tr_b16 v[136:137], v18 offset:8192
    s_add_u32 s48, s48, 16384
    v_mfma_f32_16x16x32_bf16 v[60:63], v[108:111], v[96:99], v[60:63]
    ds_read_b64_tr_b16 v[138:139], v18 offset:12288
    s_cmp_eq_u32 s48, 98304
    v_mfma_f32_16x16x32_bf16 v[44:47], v[108:111], v[92:95], v[44:47]
    ds_read_b64_tr_b16 v[140:141], v19 offset:8192
    s_cselect_b32 s48, 0, s48
    v_mfma_f32_16x16x32_bf16 v[28:31], v[108:111], v[88:91], v[28:31]
    ds_read_b64_tr_b16 v[142:143], v19 offset:12288
    s_waitcnt lgkmcnt(8)
    v_mfma_f32_16x16x32_bf16 v[32:35], v[112:115], v[88:91], v[32:35]
    ds_read_b64_tr_b16 v[144:145], v20 offset:8192
    v_add_u32 v17, s42, v12
    v_mfma_f32_16x16x32_bf16 v[48:51], v[112:115], v[92:95], v[48:51]
    ds_read_b64_tr_b16 v[146:147], v20 offset:12288
    v_add_u32 v18, s48, v13
    v_mfma_f32_16x16x32_bf16 v[64:67], v[112:115], v[96:99], v[64:67]
    ds_read_b64_tr_b16 v[148:149], v21 offset:8192
    v_add_u32 v19, s48, v14
    v_mfma_f32_16x16x32_bf16 v[80:83], v[112:115], v[100:103], v[80:83]
    ds_read_b64_tr_b16 v[150:151], v21 offset:12288
    v_add_u32 v20, s48, v15
    v_mfma_f32_16x16x32_bf16 v[84:87], v[116:119], v[100:103], v[84:87]
    v_add_u32 v21, s48, v16
    v_mfma_f32_16x16x32_bf16 v[68:71], v[116:119], v[96:99], v[68:71]
    v_mfma_f32_16x16x32_bf16 v[52:55], v[116:119], v[92:95], v[52:55]
    v_mfma_f32_16x16x32_bf16 v[36:39], v[116:119], v[88:91], v[36:39]
    s_waitcnt lgkmcnt(6)
    v_mfma_f32_16x16x32_bf16 v[24:27], v[136:139], v[120:123], v[24:27]
    s_add_u32 s43, s43, 1
    s_cmp_lt_u32 s43, 4
    v_mfma_f32_16x16x32_bf16 v[40:43], v[136:139], v[124:127], v[40:43]
    v_mfma_f32_16x16x32_bf16 v[56:59], v[136:139], v[128:131], v[56:59]
    s_waitcnt lgkmcnt(0)
    s_barrier
    v_mfma_f32_16x16x32_bf16 v[72:75], v[136:139], v[132:135], v[72:75]
    ds_read_b128 v[88:91], v17 offset:0
    v_mfma_f32_16x16x32_bf16 v[76:79], v[140:143], v[132:135], v[76:79]
    ds_read_b128 v[92:95], v17 offset:2048
    v_mfma_f32_16x16x32_bf16 v[60:63], v[140:143], v[128:131], v[60:63]
    ds_read_b128 v[96:99], v17 offset:4096
    v_mfma_f32_16x16x32_bf16 v[44:47], v[140:143], v[124:127], v[44:47]
    ds_read_b128 v[100:103], v17 offset:6144
    v_mfma_f32_16x16x32_bf16 v[28:31], v[140:143], v[120:123], v[28:31]
    ds_read_b64_tr_b16 v[104:105], v18 offset:0
    v_mfma_f32_16x16x32_bf16 v[32:35], v[144:147], v[120:123], v[32:35]
    ds_read_b64_tr_b16 v[106:107], v18 offset:4096
    v_mfma_f32_16x16x32_bf16 v[48:51], v[144:147], v[124:127], v[48:51]
    ds_read_b64_tr_b16 v[108:109], v19 offset:0
    v_mfma_f32_16x16x32_bf16 v[64:67], v[144:147], v[128:131], v[64:67]
    ds_read_b64_tr_b16 v[110:111], v19 offset:4096
    v_mfma_f32_16x16x32_bf16 v[80:83], v[144:147], v[132:135], v[80:83]
    ds_read_b64_tr_b16 v[112:113], v20 offset:0
    v_mfma_f32_16x16x32_bf16 v[84:87], v[148:151], v[132:135], v[84:87]
    ds_read_b64_tr_b16 v[114:115], v20 offset:4096
    v_mfma_f32_16x16x32_bf16 v[68:71], v[148:151], v[128:131], v[68:71]
    ds_read_b64_tr_b16 v[116:117], v21 offset:0
    v_mfma_f32_16x16x32_bf16 v[52:55], v[148:151], v[124:127], v[52:55]
    ds_read_b64_tr_b16 v[118:119], v21 offset:4096
    v_mfma_f32_16x16x32_bf16 v[36:39], v[148:151], v[120:123], v[36:39]
    s_waitcnt lgkmcnt(6)
    s_cbranch_scc1 mm_24
mm_25:
    v_mfma_f32_16x16x32_bf16 v[24:27], v[104:107], v[88:91], v[24:27]
    ds_read_b128 v[120:123], v17 offset:1024
    s_add_u32 s42, s42, 16384
    v_mfma_f32_16x16x32_bf16 v[40:43], v[104:107], v[92:95], v[40:43]
    ds_read_b128 v[124:127], v17 offset:3072
    s_cmp_eq_u32 s42, 49152
    v_mfma_f32_16x16x32_bf16 v[56:59], v[104:107], v[96:99], v[56:59]
    ds_read_b128 v[128:131], v17 offset:5120
    s_cselect_b32 s42, 0, s42
    v_mfma_f32_16x16x32_bf16 v[72:75], v[104:107], v[100:103], v[72:75]
    ds_read_b128 v[132:135], v17 offset:7168
    s_waitcnt lgkmcnt(8)
    v_mfma_f32_16x16x32_bf16 v[76:79], v[108:111], v[100:103], v[76:79]
    ds_read_b64_tr_b16 v[136:137], v18 offset:8192
    s_add_u32 s48, s48, 16384
    v_mfma_f32_16x16x32_bf16 v[60:63], v[108:111], v[96:99], v[60:63]
    ds_read_b64_tr_b16 v[138:139], v18 offset:12288
    s_cmp_eq_u32 s48, 98304
    v_mfma_f32_16x16x32_bf16 v[44:47], v[108:111], v[92:95], v[44:47]
    ds_read_b64_tr_b16 v[140:141], v19 offset:8192
    s_cselect_b32 s48, 0, s48
    v_mfma_f32_16x16x32_bf16 v[28:31], v[108:111], v[88:91], v[28:31]
    ds_read_b64_tr_b16 v[142:143], v19 offset:12288
    s_waitcnt lgkmcnt(8)
    v_mfma_f32_16x16x32_bf16 v[32:35], v[112:115], v[88:91], v[32:35]
    ds_read_b64_tr_b16 v[144:145], v20 offset:8192
    v_add_u32 v17, s42, v12
    v_mfma_f32_16x16x32_bf16 v[48:51], v[112:115], v[92:95], v[48:51]
    ds_read_b64_tr_b16 v[146:147], v20 offset:12288
    v_add_u32 v18, s48, v13
    v_mfma_f32_16x16x32_bf16 v[64:67], v[112:115], v[96:99], v[64:67]
    ds_read_b64_tr_b16 v[148:149], v21 offset:8192
    v_add_u32 v19, s48, v14
    v_mfma_f32_16x16x32_bf16 v[80:83], v[112:115], v[100:103], v[80:83]
    ds_read_b64_tr_b16 v[150:151], v21 offset:12288
    v_add_u32 v20, s48, v15
    v_mfma_f32_16x16x32_bf16 v[84:87], v[116:119], v[100:103], v[84:87]
    v_add_u32 v21, s48, v16
    v_mfma_f32_16x16x32_bf16 v[68:71], v[116:119], v[96:99], v[68:71]
    v_mfma_f32_16x16x32_bf16 v[52:55], v[116:119], v[92:95], v[52:55]
    v_mfma_f32_16x16x32_bf16 v[36:39], v[116:119], v[88:91], v[36:39]
    s_waitcnt lgkmcnt(6)
    v_mfma_f32_16x16x32_bf16 v[24:27], v[136:139], v[120:123], v[24:27]
    s_add_u32 s43, s43, 1
    s_cmp_lt_u32 s43, 27
    v_mfma_f32_16x16x32_bf16 v[40:43], v[136:139], v[124:127], v[40:43]
    s_waitcnt vmcnt(0)
    v_mfma_f32_16x16x32_bf16 v[56:59], v[136:139], v[128:131], v[56:59]
    s_waitcnt lgkmcnt(0)
    s_barrier
    v_mfma_f32_16x16x32_bf16 v[72:75], v[136:139], v[132:135], v[72:75]
    ds_read_b128 v[88:91], v17 offset:0
    v_mfma_f32_16x16x32_bf16 v[76:79], v[140:143], v[132:135], v[76:79]
    ds_read_b128 v[92:95], v17 offset:2048
    v_mfma_f32_16x16x32_bf16 v[60:63], v[140:143], v[128:131], v[60:63]
    ds_read_b128 v[96:99], v17 offset:4096
    v_mfma_f32_16x16x32_bf16 v[44:47], v[140:143], v[124:127], v[44:47]
    ds_read_b128 v[100:103], v17 offset:6144
    v_mfma_f32_16x16x32_bf16 v[28:31], v[140:143], v[120:123], v[28:31]
    ds_read_b64_tr_b16 v[104:105], v18 offset:0
    v_mfma_f32_16x16x32_bf16 v[32:35], v[144:147], v[120:123], v[32:35]
    ds_read_b64_tr_b16 v[106:107], v18 offset:4096
    v_mfma_f32_16x16x32_bf16 v[48:51], v[144:147], v[124:127], v[48:51]
    ds_read_b64_tr_b16 v[108:109], v19 offset:0
    v_mfma_f32_16x16x32_bf16 v[64:67], v[144:147], v[128:131], v[64:67]
    ds_read_b64_tr_b16 v[110:111], v19 offset:4096
    v_mfma_f32_16x16x32_bf16 v[80:83], v[144:147], v[132:135], v[80:83]
    ds_read_b64_tr_b16 v[112:113], v20 offset:0
    v_mfma_f32_16x16x32_bf16 v[84:87], v[148:151], v[132:135], v[84:87]
    ds_read_b64_tr_b16 v[114:115], v20 offset:4096
    v_mfma_f32_16x16x32_bf16 v[68:71], v[148:151], v[128:131], v[68:71]
    ds_read_b64_tr_b16 v[116:117], v21 offset:0
    v_mfma_f32_16x16x32_bf16 v[52:55], v[148:151], v[124:127], v[52:55]
    ds_read_b64_tr_b16 v[118:119], v21 offset:4096
    v_mfma_f32_16x16x32_bf16 v[36:39], v[148:151], v[120:123], v[36:39]
    s_waitcnt lgkmcnt(6)
    s_cbranch_scc1 mm_25
    s_cmp_eq_u32 s60, 1
    s_cbranch_scc1 G4_last
    v_mfma_f32_16x16x32_bf16 v[24:27], v[104:107], v[88:91], v[24:27]
    ds_read_b128 v[120:123], v17 offset:1024
    v_mfma_f32_16x16x32_bf16 v[40:43], v[104:107], v[92:95], v[40:43]
    ds_read_b128 v[124:127], v17 offset:3072
    v_mfma_f32_16x16x32_bf16 v[56:59], v[104:107], v[96:99], v[56:59]
    ds_read_b128 v[128:131], v17 offset:5120
    v_mfma_f32_16x16x32_bf16 v[72:75], v[104:107], v[100:103], v[72:75]
    ds_read_b128 v[132:135], v17 offset:7168
    s_waitcnt lgkmcnt(8)
    v_mfma_f32_16x16x32_bf16 v[76:79], v[108:111], v[100:103], v[76:79]
    ds_read_b64_tr_b16 v[136:137], v18 offset:8192
    v_mfma_f32_16x16x32_bf16 v[60:63], v[108:111], v[96:99], v[60:63]
    ds_read_b64_tr_b16 v[138:139], v18 offset:12288
    v_mfma_f32_16x16x32_bf16 v[44:47], v[108:111], v[92:95], v[44:47]
    ds_read_b64_tr_b16 v[140:141], v19 offset:8192
    v_mfma_f32_16x16x32_bf16 v[28:31], v[108:111], v[88:91], v[28:31]
    ds_read_b64_tr_b16 v[142:143], v19 offset:12288
    s_waitcnt lgkmcnt(8)
    v_mfma_f32_16x16x32_bf16 v[32:35], v[112:115], v[88:91], v[32:35]
    ds_read_b64_tr_b16 v[144:145], v20 offset:8192
    v_mfma_f32_16x16x32_bf16 v[48:51], v[112:115], v[92:95], v[48:51]
    ds_read_b64_tr_b16 v[146:147], v20 offset:12288
    v_mfma_f32_16x16x32_bf16 v[64:67], v[112:115], v[96:99], v[64:67]
    ds_read_b64_tr_b16 v[148:149], v21 offset:8192
    v_mfma_f32_16x16x32_bf16 v[80:83], v[112:115], v[100:103], v[80:83]
    ds_read_b64_tr_b16 v[150:151], v21 offset:12288
    v_mfma_f32_16x16x32_bf16 v[84:87], v[116:119], v[100:103], v[84:87]
    v_mfma_f32_16x16x32_bf16 v[68:71], v[116:119], v[96:99], v[68:71]
    v_mfma_f32_16x16x32_bf16 v[52:55], v[116:119], v[92:95], v[52:55]
    v_mfma_f32_16x16x32_bf16 v[36:39], v[116:119], v[88:91], v[36:39]
    s_waitcnt lgkmcnt(0)
    v_mfma_f32_16x16x32_bf16 v[24:27], v[136:139], v[120:123], v[24:27]
    s_mul_i32 s36, s31, 524288
    s_add_u32 s36, s36, 0
    s_add_u32 s16, s62, s36
    v_mfma_f32_16x16x32_bf16 v[40:43], v[136:139], v[124:127], v[40:43]
    s_addc_u32 s17, s63, 0
    s_mov_b32 s18, 516096
    s_mov_b32 s19, 0x20000
    v_mfma_f32_16x16x32_bf16 v[56:59], v[136:139], v[128:131], v[56:59]
    v_mfma_f32_16x16x32_bf16 v[72:75], v[136:139], v[132:135], v[72:75]
    v_mfma_f32_16x16x32_bf16 v[76:79], v[140:143], v[132:135], v[76:79]
    v_mfma_f32_16x16x32_bf16 v[60:63], v[140:143], v[128:131], v[60:63]
    v_mfma_f32_16x16x32_bf16 v[44:47], v[140:143], v[124:127], v[44:47]
    v_mfma_f32_16x16x32_bf16 v[28:31], v[140:143], v[120:123], v[28:31]
    v_mfma_f32_16x16x32_bf16 v[32:35], v[144:147], v[120:123], v[32:35]
    v_mfma_f32_16x16x32_bf16 v[48:51], v[144:147], v[124:127], v[48:51]
    v_mfma_f32_16x16x32_bf16 v[64:67], v[144:147], v[128:131], v[64:67]
    v_mfma_f32_16x16x32_bf16 v[80:83], v[144:147], v[132:135], v[80:83]
    v_mfma_f32_16x16x32_bf16 v[84:87], v[148:151], v[132:135], v[84:87]
    v_mfma_f32_16x16x32_bf16 v[68:71], v[148:151], v[128:131], v[68:71]
    v_mfma_f32_16x16x32_bf16 v[52:55], v[148:151], v[124:127], v[52:55]
    v_mfma_f32_16x16x32_bf16 v[36:39], v[148:151], v[120:123], v[36:39]
    s_add_u32 s36, s39, 0
    v_cvt_pk_bf16_f32 v24, v24, v25
    v_cvt_pk_bf16_f32 v25, v26, v27
    v_cvt_pk_bf16_f32 v26, v28, v29
    v_cvt_pk_bf16_f32 v27, v30, v31
    v_or_b32 v24, 1, v24
    buffer_store_dwordx4 v[24:27], v2, s[16:19], s36 offen offset:0 sc1
    v_cvt_pk_bf16_f32 v32, v32, v33
    v_cvt_pk_bf16_f32 v33, v34, v35
    v_cvt_pk_bf16_f32 v34, v36, v37
    v_cvt_pk_bf16_f32 v35, v38, v39
    v_or_b32 v32, 1, v32
    buffer_store_dwordx4 v[32:35], v2, s[16:19], s36 offen offset:1024 sc1
    s_add_u32 s36, s39, 65536
    v_cvt_pk_bf16_f32 v40, v40, v41
    v_cvt_pk_bf16_f32 v41, v42, v43
    v_cvt_pk_bf16_f32 v42, v44, v45
    v_cvt_pk_bf16_f32 v43, v46, v47
    v_or_b32 v40, 1, v40
    buffer_store_dwordx4 v[40:43], v2, s[16:19], s36 offen offset:0 sc1
    v_cvt_pk_bf16_f32 v48, v48, v49
    v_cvt_pk_bf16_f32 v49, v50, v51
    v_cvt_pk_bf16_f32 v50, v52, v53
    v_cvt_pk_bf16_f32 v51, v54, v55
    v_or_b32 v48, 1, v48
    buffer_store_dwordx4 v[48:51], v2, s[16:19], s36 offen offset:1024 sc1
    s_add_u32 s36, s39, 131072
    v_cvt_pk_bf16_f32 v56, v56, v57
    v_cvt_pk_bf16_f32 v57, v58, v59
    v_cvt_pk_bf16_f32 v58, v60, v61
    v_cvt_pk_bf16_f32 v59, v62, v63
    v_or_b32 v56, 1, v56
    buffer_store_dwordx4 v[56:59], v2, s[16:19], s36 offen offset:0 sc1
    v_cvt_pk_bf16_f32 v64, v64, v65
    v_cvt_pk_bf16_f32 v65, v66, v67
    v_cvt_pk_bf16_f32 v66, v68, v69
    v_cvt_pk_bf16_f32 v67, v70, v71
    v_or_b32 v64, 1, v64
    buffer_store_dwordx4 v[64:67], v2, s[16:19], s36 offen offset:1024 sc1
    s_add_u32 s36, s39, 196608
    v_cvt_pk_bf16_f32 v72, v72, v73
    v_cvt_pk_bf16_f32 v73, v74, v75
    v_cvt_pk_bf16_f32 v74, v76, v77
    v_cvt_pk_bf16_f32 v75, v78, v79
    v_or_b32 v72, 1, v72
    buffer_store_dwordx4 v[72:75], v2, s[16:19], s36 offen offset:0 sc1
    v_cvt_pk_bf16_f32 v80, v80, v81
    v_cvt_pk_bf16_f32 v81, v82, v83
    v_cvt_pk_bf16_f32 v82, v84, v85
    v_cvt_pk_bf16_f32 v83, v86, v87
    v_or_b32 v80, 1, v80
    buffer_store_dwordx4 v[80:83], v2, s[16:19], s36 offen offset:1024 sc1
    s_barrier
    s_branch NEXT
G4_last:
    v_mfma_f32_16x16x32_bf16 v[24:27], v[104:107], v[88:91], v[24:27]
    ds_read_b128 v[120:123], v17 offset:1024
    v_mfma_f32_16x16x32_bf16 v[40:43], v[104:107], v[92:95], v[40:43]
    ds_read_b128 v[124:127], v17 offset:3072
    v_mfma_f32_16x16x32_bf16 v[56:59], v[104:107], v[96:99], v[56:59]
    ds_read_b128 v[128:131], v17 offset:5120
    v_mfma_f32_16x16x32_bf16 v[72:75], v[104:107], v[100:103], v[72:75]
    ds_read_b128 v[132:135], v17 offset:7168
    s_waitcnt lgkmcnt(8)
    v_mfma_f32_16x16x32_bf16 v[76:79], v[108:111], v[100:103], v[76:79]
    ds_read_b64_tr_b16 v[136:137], v18 offset:8192
    v_mfma_f32_16x16x32_bf16 v[60:63], v[108:111], v[96:99], v[60:63]
    ds_read_b64_tr_b16 v[138:139], v18 offset:12288
    v_mfma_f32_16x16x32_bf16 v[44:47], v[108:111], v[92:95], v[44:47]
    ds_read_b64_tr_b16 v[140:141], v19 offset:8192
    v_mfma_f32_16x16x32_bf16 v[28:31], v[108:111], v[88:91], v[28:31]
    ds_read_b64_tr_b16 v[142:143], v19 offset:12288
    s_waitcnt lgkmcnt(8)
    v_mfma_f32_16x16x32_bf16 v[32:35], v[112:115], v[88:91], v[32:35]
    ds_read_b64_tr_b16 v[144:145], v20 offset:8192
    v_mfma_f32_16x16x32_bf16 v[48:51], v[112:115], v[92:95], v[48:51]
    ds_read_b64_tr_b16 v[146:147], v20 offset:12288
    s_load_dwordx2 s[6:7], s[0:1], 88
    v_mfma_f32_16x16x32_bf16 v[64:67], v[112:115], v[96:99], v[64:67]
    ds_read_b64_tr_b16 v[148:149], v21 offset:8192
    v_mfma_f32_16x16x32_bf16 v[80:83], v[112:115], v[100:103], v[80:83]
    ds_read_b64_tr_b16 v[150:151], v21 offset:12288
    v_mfma_f32_16x16x32_bf16 v[84:87], v[116:119], v[100:103], v[84:87]
    v_mfma_f32_16x16x32_bf16 v[68:71], v[116:119], v[96:99], v[68:71]
    v_mfma_f32_16x16x32_bf16 v[52:55], v[116:119], v[92:95], v[52:55]
    v_mfma_f32_16x16x32_bf16 v[36:39], v[116:119], v[88:91], v[36:39]
    s_waitcnt lgkmcnt(0)
    v_mfma_f32_16x16x32_bf16 v[24:27], v[136:139], v[120:123], v[24:27]
    s_add_u32 s16, s62, 0x80000
    s_addc_u32 s17, s63, 0
    s_mov_b32 s18, 0x7e000
    v_mfma_f32_16x16x32_bf16 v[40:43], v[136:139], v[124:127], v[40:43]
    s_mov_b32 s19, 0x20000
    s_mov_b32 s20, s6
    s_mov_b32 s21, s7
    v_mfma_f32_16x16x32_bf16 v[56:59], v[136:139], v[128:131], v[56:59]
    s_mov_b32 s22, 0x400000
    s_mov_b32 s23, 0x20000
    s_add_u32 s44, s40, 65536
    v_mfma_f32_16x16x32_bf16 v[72:75], v[136:139], v[132:135], v[72:75]
    s_lshl_b32 s46, s28, 3
    s_add_u32 s46, s46, s37
    s_lshl_b32 s47, s31, 1
    v_mfma_f32_16x16x32_bf16 v[76:79], v[140:143], v[132:135], v[76:79]
    s_add_u32 s46, s46, s47
    s_lshl_b32 s46, s46, 15
    s_lshl_b32 s47, s38, 5
    v_mfma_f32_16x16x32_bf16 v[60:63], v[140:143], v[128:131], v[60:63]
    s_add_u32 s46, s46, s47
    s_add_u32 s47, s46, 32768
    v_and_b32 v225, 1, v23
    v_mfma_f32_16x16x32_bf16 v[44:47], v[140:143], v[124:127], v[44:47]
    v_lshlrev_b32 v224, 11, v22
    v_lshl_add_u32 v224, v225, 5, v224
    v_mfma_f32_16x16x32_bf16 v[28:31], v[140:143], v[120:123], v[28:31]
    v_lshrrev_b32 v225, 1, v23
    v_lshl_add_u32 v224, v225, 4, v224
    v_mfma_f32_16x16x32_bf16 v[32:35], v[144:147], v[120:123], v[32:35]
    v_lshrrev_b32 v225, 3, v22
    v_mul_u32_u24 v225, 16320, v225
    v_mfma_f32_16x16x32_bf16 v[48:51], v[144:147], v[124:127], v[48:51]
    v_sub_u32 v224, v224, v225
    v_add_u32 v225, 16384, v224
    v_mfma_f32_16x16x32_bf16 v[64:67], v[144:147], v[128:131], v[64:67]
    v_mfma_f32_16x16x32_bf16 v[80:83], v[144:147], v[132:135], v[80:83]
    v_mfma_f32_16x16x32_bf16 v[84:87], v[148:151], v[132:135], v[84:87]
    v_mfma_f32_16x16x32_bf16 v[68:71], v[148:151], v[128:131], v[68:71]
    v_mfma_f32_16x16x32_bf16 v[52:55], v[148:151], v[124:127], v[52:55]
    v_mfma_f32_16x16x32_bf16 v[36:39], v[148:151], v[120:123], v[36:39]
    s_cmp_eq_u32 s31, 0
    s_cbranch_scc1 G4_k0
    s_add_u32 s36, s41, 0
    v_cvt_pk_bf16_f32 v24, v24, v25
    v_cvt_pk_bf16_f32 v25, v26, v27
    v_cvt_pk_bf16_f32 v26, v28, v29
    v_cvt_pk_bf16_f32 v27, v30, v31
    v_or_b32 v24, 1, v24
    buffer_store_dwordx4 v[24:27], v2, s[16:19], s36 offen offset:0 sc1
    v_cvt_pk_bf16_f32 v32, v32, v33
    v_cvt_pk_bf16_f32 v33, v34, v35
    v_cvt_pk_bf16_f32 v34, v36, v37
    v_cvt_pk_bf16_f32 v35, v38, v39
    v_or_b32 v32, 1, v32
    buffer_store_dwordx4 v[32:35], v2, s[16:19], s36 offen offset:1024 sc1
    s_add_u32 s36, s41, 65536
    v_cvt_pk_bf16_f32 v40, v40, v41
    v_cvt_pk_bf16_f32 v41, v42, v43
    v_cvt_pk_bf16_f32 v42, v44, v45
    v_cvt_pk_bf16_f32 v43, v46, v47
    v_or_b32 v40, 1, v40
    buffer_store_dwordx4 v[40:43], v2, s[16:19], s36 offen offset:0 sc1
    v_cvt_pk_bf16_f32 v48, v48, v49
    v_cvt_pk_bf16_f32 v49, v50, v51
    v_cvt_pk_bf16_f32 v50, v52, v53
    v_cvt_pk_bf16_f32 v51, v54, v55
    v_or_b32 v48, 1, v48
    buffer_store_dwordx4 v[48:51], v2, s[16:19], s36 offen offset:1024 sc1
    v_pk_mov_b32 v[24:25], v[56:57], v[56:57] op_sel:[0,1]
    v_pk_mov_b32 v[26:27], v[58:59], v[58:59] op_sel:[0,1]
    v_pk_mov_b32 v[28:29], v[60:61], v[60:61] op_sel:[0,1]
    v_pk_mov_b32 v[30:31], v[62:63], v[62:63] op_sel:[0,1]
    v_pk_mov_b32 v[32:33], v[64:65], v[64:65] op_sel:[0,1]
    v_pk_mov_b32 v[34:35], v[66:67], v[66:67] op_sel:[0,1]
    v_pk_mov_b32 v[36:37], v[68:69], v[68:69] op_sel:[0,1]
    v_pk_mov_b32 v[38:39], v[70:71], v[70:71] op_sel:[0,1]
    v_pk_mov_b32 v[40:41], v[72:73], v[72:73] op_sel:[0,1]
    v_pk_mov_b32 v[42:43], v[74:75], v[74:75] op_sel:[0,1]
    v_pk_mov_b32 v[44:45], v[76:77], v[76:77] op_sel:[0,1]
    v_pk_mov_b32 v[46:47], v[78:79], v[78:79] op_sel:[0,1]
    v_pk_mov_b32 v[48:49], v[80:81], v[80:81] op_sel:[0,1]
    v_pk_mov_b32 v[50:51], v[82:83], v[82:83] op_sel:[0,1]
    v_pk_mov_b32 v[52:53], v[84:85], v[84:85] op_sel:[0,1]
    v_pk_mov_b32 v[54:55], v[86:87], v[86:87] op_sel:[0,1]
    s_branch G4_k1
G4_k0:
    s_add_u32 s36, s41, 0
    v_cvt_pk_bf16_f32 v56, v56, v57
    v_cvt_pk_bf16_f32 v57, v58, v59
    v_cvt_pk_bf16_f32 v58, v60, v61
    v_cvt_pk_bf16_f32 v59, v62, v63
    v_or_b32 v56, 1, v56
    buffer_store_dwordx4 v[56:59], v2, s[16:19], s36 offen offset:0 sc1
    v_cvt_pk_bf16_f32 v64, v64, v65
    v_cvt_pk_bf16_f32 v65, v66, v67
    v_cvt_pk_bf16_f32 v66, v68, v69
    v_cvt_pk_bf16_f32 v67, v70, v71
    v_or_b32 v64, 1, v64
    buffer_store_dwordx4 v[64:67], v2, s[16:19], s36 offen offset:1024 sc1
    s_add_u32 s36, s41, 65536
    v_cvt_pk_bf16_f32 v72, v72, v73
    v_cvt_pk_bf16_f32 v73, v74, v75
    v_cvt_pk_bf16_f32 v74, v76, v77
    v_cvt_pk_bf16_f32 v75, v78, v79
    v_or_b32 v72, 1, v72
    buffer_store_dwordx4 v[72:75], v2, s[16:19], s36 offen offset:0 sc1
    v_cvt_pk_bf16_f32 v80, v80, v81
    v_cvt_pk_bf16_f32 v81, v82, v83
    v_cvt_pk_bf16_f32 v82, v84, v85
    v_cvt_pk_bf16_f32 v83, v86, v87
    v_or_b32 v80, 1, v80
    buffer_store_dwordx4 v[80:83], v2, s[16:19], s36 offen offset:1024 sc1
G4_k1:
    s_mov_b32 s78, 0x3f80
    s_mov_b32 s79, 0x3f800000
    v_dot2_f32_bf16 v24, v180, s78, v24
    v_dot2_f32_bf16 v25, v180, s79, v25
    v_dot2_f32_bf16 v26, v181, s78, v26
    v_dot2_f32_bf16 v27, v181, s79, v27
    v_dot2_f32_bf16 v28, v182, s78, v28
    v_dot2_f32_bf16 v29, v182, s79, v29
    v_dot2_f32_bf16 v30, v183, s78, v30
    v_dot2_f32_bf16 v31, v183, s79, v31
    v_dot2_f32_bf16 v32, v188, s78, v32
    v_dot2_f32_bf16 v33, v188, s79, v33
    v_dot2_f32_bf16 v34, v189, s78, v34
    v_dot2_f32_bf16 v35, v189, s79, v35
    v_dot2_f32_bf16 v36, v190, s78, v36
    v_dot2_f32_bf16 v37, v190, s79, v37
    v_dot2_f32_bf16 v38, v191, s78, v38
    v_dot2_f32_bf16 v39, v191, s79, v39
    v_dot2_f32_bf16 v40, v196, s78, v40
    v_dot2_f32_bf16 v41, v196, s79, v41
    v_dot2_f32_bf16 v42, v197, s78, v42
    v_dot2_f32_bf16 v43, v197, s79, v43
    v_dot2_f32_bf16 v44, v198, s78, v44
    v_dot2_f32_bf16 v45, v198, s79, v45
    v_dot2_f32_bf16 v46, v199, s78, v46
    v_dot2_f32_bf16 v47, v199, s79, v47
    v_dot2_f32_bf16 v48, v234, s78, v48
    v_dot2_f32_bf16 v49, v234, s79, v49
    v_dot2_f32_bf16 v50, v235, s78, v50
    v_dot2_f32_bf16 v51, v235, s79, v51
    v_dot2_f32_bf16 v52, v236, s78, v52
    v_dot2_f32_bf16 v53, v236, s79, v53
    v_dot2_f32_bf16 v54, v237, s78, v54
    v_dot2_f32_bf16 v55, v237, s79, v55
    v_dot2_f32_bf16 v24, v184, s78, v24
    v_dot2_f32_bf16 v25, v184, s79, v25
    v_dot2_f32_bf16 v26, v185, s78, v26
    v_dot2_f32_bf16 v27, v185, s79, v27
    v_dot2_f32_bf16 v28, v186, s78, v28
    v_dot2_f32_bf16 v29, v186, s79, v29
    v_dot2_f32_bf16 v30, v187, s78, v30
    v_dot2_f32_bf16 v31, v187, s79, v31
    v_dot2_f32_bf16 v32, v192, s78, v32
    v_dot2_f32_bf16 v33, v192, s79, v33
    v_dot2_f32_bf16 v34, v193, s78, v34
    v_dot2_f32_bf16 v35, v193, s79, v35
    v_dot2_f32_bf16 v36, v194, s78, v36
    v_dot2_f32_bf16 v37, v194, s79, v37
    v_dot2_f32_bf16 v38, v195, s78, v38
    v_dot2_f32_bf16 v39, v195, s79, v39
    v_dot2_f32_bf16 v40, v230, s78, v40
    v_dot2_f32_bf16 v41, v230, s79, v41
    v_dot2_f32_bf16 v42, v231, s78, v42
    v_dot2_f32_bf16 v43, v231, s79, v43
    v_dot2_f32_bf16 v44, v232, s78, v44
    v_dot2_f32_bf16 v45, v232, s79, v45
    v_dot2_f32_bf16 v46, v233, s78, v46
    v_dot2_f32_bf16 v47, v233, s79, v47
    v_dot2_f32_bf16 v48, v248, s78, v48
    v_dot2_f32_bf16 v49, v248, s79, v49
    v_dot2_f32_bf16 v50, v249, s78, v50
    v_dot2_f32_bf16 v51, v249, s79, v51
    v_dot2_f32_bf16 v52, v250, s78, v52
    v_dot2_f32_bf16 v53, v250, s79, v53
    v_dot2_f32_bf16 v54, v251, s78, v54
    v_dot2_f32_bf16 v55, v251, s79, v55
    s_mov_b32 s53, 0
dp_26:
    buffer_load_dwordx4 v[208:211], v2, s[16:19], s40 offen offset:0 sc1
    buffer_load_dwordx4 v[212:215], v2, s[16:19], s40 offen offset:1024 sc1
    buffer_load_dwordx4 v[216:219], v2, s[16:19], s44 offen offset:0 sc1
    buffer_load_dwordx4 v[220:223], v2, s[16:19], s44 offen offset:1024 sc1
    s_waitcnt vmcnt(0)
    v_bitop3_b32 v6, v208, v212, v216 bitop3:0x80
    v_bitop3_b32 v6, v6, v220, 1 bitop3:0x80
    v_cmp_eq_u32 vcc, 0, v6
    s_cbranch_vccz dq_27
    s_sleep 2
    s_add_u32 s53, s53, 1
    s_cmp_lt_u32 s53, s61
    s_cbranch_scc1 dp_26
    s_mov_b32 s61, 0
dq_27:
    v_dot2_f32_bf16 v24, v208, s78, v24
    v_dot2_f32_bf16 v25, v208, s79, v25
    v_dot2_f32_bf16 v26, v209, s78, v26
    v_dot2_f32_bf16 v27, v209, s79, v27
    v_dot2_f32_bf16 v28, v210, s78, v28
    v_dot2_f32_bf16 v29, v210, s79, v29
    v_dot2_f32_bf16 v30, v211, s78, v30
    v_dot2_f32_bf16 v31, v211, s79, v31
    v_cvt_pk_bf16_f32 v24, v24, v25
    v_cvt_pk_bf16_f32 v25, v26, v27
    v_cvt_pk_bf16_f32 v26, v28, v29
    v_cvt_pk_bf16_f32 v27, v30, v31
    s_nop 0
    v_permlane16_swap_b32 v24, v26
    v_permlane16_swap_b32 v25, v27
    v_dot2_f32_bf16 v32, v212, s78, v32
    v_dot2_f32_bf16 v33, v212, s79, v33
    v_dot2_f32_bf16 v34, v213, s78, v34
    v_dot2_f32_bf16 v35, v213, s79, v35
    v_dot2_f32_bf16 v36, v214, s78, v36
    v_dot2_f32_bf16 v37, v214, s79, v37
    v_dot2_f32_bf16 v38, v215, s78, v38
    v_dot2_f32_bf16 v39, v215, s79, v39
    v_cvt_pk_bf16_f32 v32, v32, v33
    v_cvt_pk_bf16_f32 v33, v34, v35
    v_cvt_pk_bf16_f32 v34, v36, v37
    v_cvt_pk_bf16_f32 v35, v38, v39
    s_nop 0
    v_permlane16_swap_b32 v32, v34
    v_permlane16_swap_b32 v33, v35
    v_mov_b32 v36, v24
    v_mov_b32 v37, v25
    v_mov_b32 v38, v26
    v_mov_b32 v39, v27
    v_mov_b32_dpp v24, v32 row_ror:8 row_mask:0xf bank_mask:0xc
    v_mov_b32_dpp v25, v33 row_ror:8 row_mask:0xf bank_mask:0xc
    v_mov_b32_dpp v26, v34 row_ror:8 row_mask:0xf bank_mask:0xc
    v_mov_b32_dpp v27, v35 row_ror:8 row_mask:0xf bank_mask:0xc
    v_mov_b32_dpp v32, v36 row_ror:8 row_mask:0xf bank_mask:0x3
    v_mov_b32_dpp v33, v37 row_ror:8 row_mask:0xf bank_mask:0x3
    v_mov_b32_dpp v34, v38 row_ror:8 row_mask:0xf bank_mask:0x3
    v_mov_b32_dpp v35, v39 row_ror:8 row_mask:0xf bank_mask:0x3
    buffer_store_dwordx4 v[24:27], v224, s[20:23], s46 offen sc1
    buffer_store_dwordx4 v[32:35], v225, s[20:23], s46 offen sc1
    v_dot2_f32_bf16 v40, v216, s78, v40
    v_dot2_f32_bf16 v41, v216, s79, v41
    v_dot2_f32_bf16 v42, v217, s78, v42
    v_dot2_f32_bf16 v43, v217, s79, v43
    v_dot2_f32_bf16 v44, v218, s78, v44
    v_dot2_f32_bf16 v45, v218, s79, v45
    v_dot2_f32_bf16 v46, v219, s78, v46
    v_dot2_f32_bf16 v47, v219, s79, v47
    v_cvt_pk_bf16_f32 v40, v40, v41
    v_cvt_pk_bf16_f32 v41, v42, v43
    v_cvt_pk_bf16_f32 v42, v44, v45
    v_cvt_pk_bf16_f32 v43, v46, v47
    s_nop 0
    v_permlane16_swap_b32 v40, v42
    v_permlane16_swap_b32 v41, v43
    v_dot2_f32_bf16 v48, v220, s78, v48
    v_dot2_f32_bf16 v49, v220, s79, v49
    v_dot2_f32_bf16 v50, v221, s78, v50
    v_dot2_f32_bf16 v51, v221, s79, v51
    v_dot2_f32_bf16 v52, v222, s78, v52
    v_dot2_f32_bf16 v53, v222, s79, v53
    v_dot2_f32_bf16 v54, v223, s78, v54
    v_dot2_f32_bf16 v55, v223, s79, v55
    v_cvt_pk_bf16_f32 v48, v48, v49
    v_cvt_pk_bf16_f32 v49, v50, v51
    v_cvt_pk_bf16_f32 v50, v52, v53
    v_cvt_pk_bf16_f32 v51, v54, v55
    s_nop 0
    v_permlane16_swap_b32 v48, v50
    v_permlane16_swap_b32 v49, v51
    v_mov_b32 v52, v40
    v_mov_b32 v53, v41
    v_mov_b32 v54, v42
    v_mov_b32 v55, v43
    v_mov_b32_dpp v40, v48 row_ror:8 row_mask:0xf bank_mask:0xc
    v_mov_b32_dpp v41, v49 row_ror:8 row_mask:0xf bank_mask:0xc
    v_mov_b32_dpp v42, v50 row_ror:8 row_mask:0xf bank_mask:0xc
    v_mov_b32_dpp v43, v51 row_ror:8 row_mask:0xf bank_mask:0xc
    v_mov_b32_dpp v48, v52 row_ror:8 row_mask:0xf bank_mask:0x3
    v_mov_b32_dpp v49, v53 row_ror:8 row_mask:0xf bank_mask:0x3
    v_mov_b32_dpp v50, v54 row_ror:8 row_mask:0xf bank_mask:0x3
    v_mov_b32_dpp v51, v55 row_ror:8 row_mask:0xf bank_mask:0x3
    buffer_store_dwordx4 v[40:43], v224, s[20:23], s47 offen sc1
    buffer_store_dwordx4 v[48:51], v225, s[20:23], s47 offen sc1
    s_branch K_fin
LOADERS:
    s_cmp_ge_u32 s30, 6
    s_cbranch_scc1 WLOAD
    s_add_u32 s54, s55, 0x500
    v_mov_b32 v222, s54
    s_lshl_b32 s53, s29, 7
    s_add_u32 s53, s53, 23117824
    v_mov_b32 v226, s53
    s_sleep 30
    s_mov_b64 exec, 1
    buffer_load_dword v227, v226, s[56:59], 0 offen sc1
    s_mov_b64 exec, -1
    s_waitcnt vmcnt(0)
    v_readfirstlane_b32 s53, v227
    s_add_u32 s54, s52, 16
    s_cmp_eq_u32 s53, s54
    s_cbranch_scc1 fok_28
    s_mov_b32 s53, 0
    s_add_u32 s54, s52, 16
    s_bfm_b64 exec, 1, 0
poll_29:
    buffer_load_dword v227, v226, s[56:59], 0 offen sc1
    s_waitcnt vmcnt(0)
    v_xor_b32 v227, s54, v227
    v_cmp_eq_u32 vcc, 0, v227
    s_nop 0
    s_cmp_eq_u64 vcc, exec
    s_cbranch_scc1 pok_30
    s_sleep 5
    s_add_u32 s53, s53, 1
    s_cmp_lt_u32 s53, s61
    s_cbranch_scc1 poll_29
    s_mov_b32 s61, 0
pok_30:
    s_mov_b64 exec, -1
fok_28:
    s_add_u32 s24, s4, 0x1400000
    s_addc_u32 s25, s5, 0
    s_mov_b32 s26, 0x20000
    s_mov_b32 s27, 0x20000
    s_cmp_eq_u32 s60, 0
    s_cselect_b32 s26, s26, 0
    s_and_b32 s36, s30, 1
    s_mul_i32 s36, s36, 128
    s_mul_i32 s37, s29, 256
    s_add_u32 s37, s36, s37
    v_lshrrev_b32 v224, 3, v1
    v_mul_u32_u24 v224, 4096, v224
    v_and_b32 v23, 112, v2
    v_add_u32 v224, v224, v23
    buffer_load_dwordx4 v[24:27], v224, s[24:27], s37 offen sc1
    s_add_u32 s37, s37, 32768
    buffer_load_dwordx4 v[28:31], v224, s[24:27], s37 offen sc1
    s_add_u32 s37, s37, 32768
    buffer_load_dwordx4 v[32:35], v224, s[24:27], s37 offen sc1
    s_add_u32 s37, s37, 32768
    buffer_load_dwordx4 v[36:39], v224, s[24:27], s37 offen sc1
    s_add_u32 s37, s37, 32768
    s_mov_b64 exec, 1
    buffer_load_dword v223, v222, s[56:59], 0 offen sc1
    s_mov_b64 exec, -1
    s_waitcnt vmcnt(0)
    v_readfirstlane_b32 s53, v223
    s_add_u32 s54, s52, 16
    s_cmp_eq_u32 s53, s54
    s_cbranch_scc1 fok_31
    s_mov_b32 s53, 0
    s_add_u32 s54, s52, 16
    s_bfm_b64 exec, 1, 0
poll_32:
    buffer_load_dword v223, v222, s[56:59], 0 offen sc1
    s_waitcnt vmcnt(0)
    v_xor_b32 v223, s54, v223
    v_cmp_eq_u32 vcc, 0, v223
    s_nop 0
    s_cmp_eq_u64 vcc, exec
    s_cbranch_scc1 pok_33
    s_sleep 5
    s_add_u32 s53, s53, 1
    s_cmp_lt_u32 s53, s61
    s_cbranch_scc1 poll_32
    s_mov_b32 s61, 0
pok_33:
    s_mov_b64 exec, -1
fok_31:
    s_add_u32 s20, s62, 0x5d0000
    s_addc_u32 s21, s63, 0
    s_mov_b32 s22, 0x800
    s_mov_b32 s23, 0x20000
    s_and_b32 s35, s30, 1
    s_lshl_b32 s35, s35, 10
    buffer_load_dwordx4 v[16:19], v2, s[20:23], s35 offen sc1
    s_cmp_lg_u32 s60, 0
    s_cbranch_scc1 pc_34
    v_add_f32 v24, v24, v28
    v_add_f32 v25, v25, v29
    v_add_f32 v26, v26, v30
    v_add_f32 v27, v27, v31
    v_add_f32 v24, v24, v32
    v_add_f32 v25, v25, v33
    v_add_f32 v26, v26, v34
    v_add_f32 v27, v27, v35
    v_add_f32 v24, v24, v36
    v_add_f32 v25, v25, v37
    v_add_f32 v26, v26, v38
    v_add_f32 v27, v27, v39
    v_add_f32_dpp v24, v24, v24 row_ror:8 row_mask:0xf bank_mask:0xf
    v_add_f32_dpp v25, v25, v25 row_ror:8 row_mask:0xf bank_mask:0xf
    v_add_f32_dpp v26, v26, v26 row_ror:8 row_mask:0xf bank_mask:0xf
    v_add_f32_dpp v27, v27, v27 row_ror:8 row_mask:0xf bank_mask:0xf
    v_mov_b32 v28, v24
    v_mov_b32 v29, v25
    v_mov_b32 v30, v26
    v_mov_b32 v31, v27
    v_permlane16_swap_b32 v24, v28
    v_permlane16_swap_b32 v25, v29
    v_permlane16_swap_b32 v26, v30
    v_permlane16_swap_b32 v27, v31
    v_add_f32 v24, v24, v28
    v_add_f32 v25, v25, v29
    v_add_f32 v26, v26, v30
    v_add_f32 v27, v27, v31
    v_mov_b32 v28, v24
    v_mov_b32 v29, v25
    v_mov_b32 v30, v26
    v_mov_b32 v31, v27
    v_permlane32_swap_b32 v24, v28
    v_permlane32_swap_b32 v25, v29
    v_permlane32_swap_b32 v26, v30
    v_permlane32_swap_b32 v27, v31
    v_add_f32 v24, v24, v28
    v_add_f32 v25, v25, v29
    v_add_f32 v26, v26, v30
    v_add_f32 v27, v27, v31
pc_34:
    s_cmp_lg_u32 s60, 0
    s_cbranch_scc1 pc_35
    s_and_b32 s36, s30, 1
    s_mul_i32 s36, s36, 128
    s_add_u32 s36, s36, 163328
    v_add_u32 v23, s36, v2
    s_bfm_b64 exec, 8, 0
    ds_write_b128 v23, v[24:27]
    s_mov_b64 exec, -1
    s_waitcnt lgkmcnt(0)
pc_35:
    s_waitcnt vmcnt(0)
    s_and_b32 s36, s30, 1
    s_lshl_b32 s36, s36, 10
    s_add_u32 s36, s36, 160768
    v_add_u32 v221, s36, v2
    ds_write_b128 v221, v[16:19]
    s_waitcnt lgkmcnt(0)
    s_cmp_eq_u32 s60, 0
    s_cbranch_scc1 AL_nw
    s_cmp_lg_u32 s30, 4
    s_cbranch_scc1 AL_nw
    s_add_u32 s54, s55, 0xffc00200
    s_add_u32 s53, s54, s92
    v_mov_b32 v9, s53
    s_add_u32 s53, s54, s93
    v_writelane_b32 v9, s53, 1
    s_mov_b32 s53, 0
    s_add_u32 s54, s52, 16
    s_bfm_b64 exec, 2, 0
poll_37:
    buffer_load_dword v8, v9, s[56:59], 0 offen sc1
    s_waitcnt vmcnt(0)
    v_xor_b32 v8, s54, v8
    v_cmp_eq_u32 vcc, 0, v8
    s_nop 0
    s_cmp_eq_u64 vcc, exec
    s_cbranch_scc1 pok_38
    s_sleep 5
    s_add_u32 s53, s53, 1
    s_cmp_lt_u32 s53, s61
    s_cbranch_scc1 poll_37
    s_mov_b32 s61, 0
pok_38:
    s_mov_b64 exec, -1
AL_nw:
    s_barrier
    s_call_b64 s[76:77], SUB_after_g1
    s_cmp_lg_u32 s30, 4
    s_cbranch_scc1 pdone_39
    s_cmp_lg_u32 s60, 0
    s_cbranch_scc1 pdone_39
    s_mul_i32 s54, s60, 2
    s_add_u32 s54, s54, 1
    v_mov_b32 v8, 162872
spin_40:
    s_sleep 8
    ds_read_b32 v9, v8
    s_waitcnt lgkmcnt(0)
    v_readfirstlane_b32 s53, v9
    s_nop 0
    s_cmp_ge_u32 s53, s54
    s_cbranch_scc0 spin_40
    s_add_u32 s54, s55, 0x100
    v_mov_b32 v9, s54
    s_add_u32 s53, s54, 128
    v_writelane_b32 v9, s53, 1
    s_add_u32 s53, s53, s93
    v_writelane_b32 v9, s53, 3
    s_add_u32 s53, s54, s92
    v_writelane_b32 v9, s53, 2
    s_mov_b32 s53, 0
    s_add_u32 s54, s52, 8
    s_bfm_b64 exec, 4, 0
poll_41:
    buffer_load_dword v8, v9, s[56:59], 0 offen sc1
    s_waitcnt vmcnt(0)
    v_xor_b32 v8, s54, v8
    v_cmp_eq_u32 vcc, 0, v8
    s_nop 0
    s_cmp_eq_u64 vcc, exec
    s_cbranch_scc1 pok_42
    s_sleep 5
    s_add_u32 s53, s53, 1
    s_cmp_lt_u32 s53, s61
    s_cbranch_scc1 poll_41
    s_mov_b32 s61, 0
pok_42:
    s_mov_b64 exec, -1
pdone_39:
    s_barrier
    s_waitcnt vmcnt(0)
    s_barrier
    s_call_b64 s[76:77], SUB_after_g2
    s_and_b32 s35, s30, 1
    s_add_u32 s12, s62, 0x80000
    s_addc_u32 s13, s63, 0
    s_mov_b32 s14, 0x7e000
    s_mov_b32 s15, 0x20000
    s_mul_i32 s38, s35, 262144
    s_lshl_b32 s41, s35, 13
    s_mov_b32 s42, 0
    s_mov_b32 s44, 0
    s_add_u32 s54, s55, 0x200
    v_mov_b32 v9, s54
    s_mov_b32 s44, 1
    s_mov_b32 s42, 16384
    s_add_u32 s54, s55, 0x580
    v_mov_b32 v222, s54
    v_lshlrev_b32 v221, 3, v1
    s_add_u32 s19, s41, s42
    v_readlane_b32 s16, v248, s44
    s_nop 0
    s_add_u32 s16, s16, s38
    s_add_u32 s44, s44, 1
    s_and_b32 s44, s44, 15
    s_add_u32 s42, s42, 16384
    s_cmp_eq_u32 s42, 49152
    s_cselect_b32 s42, 0, s42
    s_mov_b32 m0, s19
    s_mov_b32 s39, s16
    s_waitcnt vmcnt(0)
    s_barrier
    s_sleep 6
    s_mov_b32 s53, 0
    s_add_u32 s54, s52, 16
    s_bfm_b64 exec, 1, 0
poll_43:
    buffer_load_dword v8, v9, s[56:59], 0 offen sc1
    s_waitcnt vmcnt(0)
    v_xor_b32 v8, s54, v8
    v_cmp_eq_u32 vcc, 0, v8
    s_nop 0
    s_cmp_eq_u64 vcc, exec
    s_cbranch_scc1 pok_44
    s_sleep 5
    s_add_u32 s53, s53, 1
    s_cmp_lt_u32 s53, s61
    s_cbranch_scc1 poll_43
    s_mov_b32 s61, 0
pok_44:
    s_mov_b64 exec, -1
    buffer_load_dwordx4 v2, s[12:15], s39 offen sc1 lds
    buffer_load_dwordx4 v2, s[12:15], s39 offen offset:1024 sc1 lds
    s_add_u32 s19, s41, s42
    v_readlane_b32 s16, v248, s44
    s_nop 0
    s_add_u32 s16, s16, s38
    s_add_u32 s44, s44, 1
    s_and_b32 s44, s44, 15
    s_add_u32 s42, s42, 16384
    s_cmp_eq_u32 s42, 49152
    s_cselect_b32 s42, 0, s42
    s_add_u32 m0, m0, 2048
    s_add_u32 s39, s39, 65536
    buffer_load_dwordx4 v2, s[12:15], s39 offen sc1 lds
    buffer_load_dwordx4 v2, s[12:15], s39 offen offset:1024 sc1 lds
    s_add_u32 m0, m0, 2048
    s_add_u32 s39, s39, 65536
    buffer_load_dwordx4 v2, s[12:15], s39 offen sc1 lds
    buffer_load_dwordx4 v2, s[12:15], s39 offen offset:1024 sc1 lds
    s_add_u32 m0, m0, 2048
    s_add_u32 s39, s39, 65536
    buffer_load_dwordx4 v2, s[12:15], s39 offen sc1 lds
    buffer_load_dwordx4 v2, s[12:15], s39 offen offset:1024 sc1 lds
    s_mov_b32 m0, s19
    s_mov_b32 s39, s16
    buffer_load_dwordx4 v2, s[12:15], s39 offen sc1 lds
    buffer_load_dwordx4 v2, s[12:15], s39 offen offset:1024 sc1 lds
    s_add_u32 s19, s41, s42
    v_readlane_b32 s16, v248, s44
    s_nop 0
    s_add_u32 s16, s16, s38
    s_add_u32 s44, s44, 1
    s_and_b32 s44, s44, 15
    s_add_u32 s42, s42, 16384
    s_cmp_eq_u32 s42, 49152
    s_cselect_b32 s42, 0, s42
    s_add_u32 m0, m0, 2048
    s_add_u32 s39, s39, 65536
    buffer_load_dwordx4 v2, s[12:15], s39 offen sc1 lds
    buffer_load_dwordx4 v2, s[12:15], s39 offen offset:1024 sc1 lds
    s_add_u32 m0, m0, 2048
    s_add_u32 s39, s39, 65536
    buffer_load_dwordx4 v2, s[12:15], s39 offen sc1 lds
    buffer_load_dwordx4 v2, s[12:15], s39 offen offset:1024 sc1 lds
    s_add_u32 m0, m0, 2048
    s_add_u32 s39, s39, 65536
    buffer_load_dwordx4 v2, s[12:15], s39 offen sc1 lds
    buffer_load_dwordx4 v2, s[12:15], s39 offen offset:1024 sc1 lds
    s_mov_b32 m0, s19
    s_mov_b32 s39, s16
    s_waitcnt vmcnt(8)
    s_barrier
    buffer_load_dwordx4 v2, s[12:15], s39 offen sc1 lds
    buffer_load_dwordx4 v2, s[12:15], s39 offen offset:1024 sc1 lds
    s_add_u32 s19, s41, s42
    v_readlane_b32 s16, v248, s44
    s_nop 0
    s_add_u32 s16, s16, s38
    s_add_u32 s44, s44, 1
    s_and_b32 s44, s44, 15
    s_add_u32 s42, s42, 16384
    s_cmp_eq_u32 s42, 49152
    s_cselect_b32 s42, 0, s42
    s_add_u32 m0, m0, 2048
    s_add_u32 s39, s39, 65536
    buffer_load_dwordx4 v2, s[12:15], s39 offen sc1 lds
    buffer_load_dwordx4 v2, s[12:15], s39 offen offset:1024 sc1 lds
    s_add_u32 m0, m0, 2048
    s_add_u32 s39, s39, 65536
    buffer_load_dwordx4 v2, s[12:15], s39 offen sc1 lds
    buffer_load_dwordx4 v2, s[12:15], s39 offen offset:1024 sc1 lds
    s_add_u32 m0, m0, 2048
    s_add_u32 s39, s39, 65536
    buffer_load_dwordx4 v2, s[12:15], s39 offen sc1 lds
    buffer_load_dwordx4 v2, s[12:15], s39 offen offset:1024 sc1 lds
    s_mov_b32 m0, s19
    s_mov_b32 s39, s16
    s_add_u32 s24, s4, 0x1420000
    s_addc_u32 s25, s5, 0
    s_mov_b32 s26, 0x70000
    s_mov_b32 s27, 0x20000
    s_cmp_eq_u32 s60, 0
    s_cselect_b32 s26, s26, 0
    s_and_b32 s36, s30, 1
    s_mul_i32 s36, s36, 448
    s_mul_i32 s37, s29, 896
    s_add_u32 s37, s36, s37
    v_lshrrev_b32 v224, 5, v1
    v_mul_u32_u24 v224, 14336, v224
    v_and_b32 v179, 496, v2
    v_add_u32 v224, v224, v179
    buffer_load_dwordx4 v[180:183], v224, s[24:27], s37 offen sc1
    s_add_u32 s37, s37, 28672
    buffer_load_dwordx4 v[184:187], v224, s[24:27], s37 offen sc1
    s_add_u32 s37, s37, 28672
    buffer_load_dwordx4 v[188:191], v224, s[24:27], s37 offen sc1
    s_add_u32 s37, s37, 28672
    buffer_load_dwordx4 v[192:195], v224, s[24:27], s37 offen sc1
    s_add_u32 s37, s37, 28672
    s_waitcnt vmcnt(12)
    s_barrier
    buffer_load_dwordx4 v2, s[12:15], s39 offen sc1 lds
    buffer_load_dwordx4 v2, s[12:15], s39 offen offset:1024 sc1 lds
    s_add_u32 s19, s41, s42
    v_readlane_b32 s16, v248, s44
    s_nop 0
    s_add_u32 s16, s16, s38
    s_add_u32 s44, s44, 1
    s_and_b32 s44, s44, 15
    s_add_u32 s42, s42, 16384
    s_cmp_eq_u32 s42, 49152
    s_cselect_b32 s42, 0, s42
    s_add_u32 m0, m0, 2048
    s_add_u32 s39, s39, 65536
    buffer_load_dwordx4 v2, s[12:15], s39 offen sc1 lds
    buffer_load_dwordx4 v2, s[12:15], s39 offen offset:1024 sc1 lds
    s_add_u32 m0, m0, 2048
    s_add_u32 s39, s39, 65536
    buffer_load_dwordx4 v2, s[12:15], s39 offen sc1 lds
    buffer_load_dwordx4 v2, s[12:15], s39 offen offset:1024 sc1 lds
    s_add_u32 m0, m0, 2048
    s_add_u32 s39, s39, 65536
    buffer_load_dwordx4 v2, s[12:15], s39 offen sc1 lds
    buffer_load_dwordx4 v2, s[12:15], s39 offen offset:1024 sc1 lds
    s_mov_b32 m0, s19
    s_mov_b32 s39, s16
    buffer_load_dwordx4 v[196:199], v224, s[24:27], s37 offen sc1
    s_add_u32 s37, s37, 28672
    buffer_load_dwordx4 v[200:203], v224, s[24:27], s37 offen sc1
    s_add_u32 s37, s37, 28672
    buffer_load_dwordx4 v[204:207], v224, s[24:27], s37 offen sc1
    s_add_u32 s37, s37, 28672
    buffer_load_dwordx4 v[208:211], v224, s[24:27], s37 offen sc1
    s_add_u32 s37, s37, 28672
    buffer_load_dwordx4 v[212:215], v224, s[24:27], s37 offen sc1
    s_add_u32 s37, s37, 28672
    s_waitcnt vmcnt(17)
    s_barrier
    buffer_load_dwordx4 v2, s[12:15], s39 offen sc1 lds
    buffer_load_dwordx4 v2, s[12:15], s39 offen offset:1024 sc1 lds
    s_add_u32 s19, s41, s42
    v_readlane_b32 s16, v248, s44
    s_nop 0
    s_add_u32 s16, s16, s38
    s_add_u32 s44, s44, 1
    s_and_b32 s44, s44, 15
    s_add_u32 s42, s42, 16384
    s_cmp_eq_u32 s42, 49152
    s_cselect_b32 s42, 0, s42
    s_add_u32 m0, m0, 2048
    s_add_u32 s39, s39, 65536
    buffer_load_dwordx4 v2, s[12:15], s39 offen sc1 lds
    buffer_load_dwordx4 v2, s[12:15], s39 offen offset:1024 sc1 lds
    s_add_u32 m0, m0, 2048
    s_add_u32 s39, s39, 65536
    buffer_load_dwordx4 v2, s[12:15], s39 offen sc1 lds
    buffer_load_dwordx4 v2, s[12:15], s39 offen offset:1024 sc1 lds
    s_add_u32 m0, m0, 2048
    s_add_u32 s39, s39, 65536
    buffer_load_dwordx4 v2, s[12:15], s39 offen sc1 lds
    buffer_load_dwordx4 v2, s[12:15], s39 offen offset:1024 sc1 lds
    s_mov_b32 m0, s19
    s_mov_b32 s39, s16
    s_waitcnt vmcnt(13)
    s_barrier
    buffer_load_dwordx4 v2, s[12:15], s39 offen sc1 lds
    buffer_load_dwordx4 v2, s[12:15], s39 offen offset:1024 sc1 lds
    s_add_u32 s19, s41, s42
    v_readlane_b32 s16, v248, s44
    s_nop 0
    s_add_u32 s16, s16, s38
    s_add_u32 s44, s44, 1
    s_and_b32 s44, s44, 15
    s_add_u32 s42, s42, 16384
    s_cmp_eq_u32 s42, 49152
    s_cselect_b32 s42, 0, s42
    s_add_u32 m0, m0, 2048
    s_add_u32 s39, s39, 65536
    buffer_load_dwordx4 v2, s[12:15], s39 offen sc1 lds
    buffer_load_dwordx4 v2, s[12:15], s39 offen offset:1024 sc1 lds
    s_add_u32 m0, m0, 2048
    s_add_u32 s39, s39, 65536
    buffer_load_dwordx4 v2, s[12:15], s39 offen sc1 lds
    buffer_load_dwordx4 v2, s[12:15], s39 offen offset:1024 sc1 lds
    s_add_u32 m0, m0, 2048
    s_add_u32 s39, s39, 65536
    buffer_load_dwordx4 v2, s[12:15], s39 offen sc1 lds
    buffer_load_dwordx4 v2, s[12:15], s39 offen offset:1024 sc1 lds
    s_mov_b32 m0, s19
    s_mov_b32 s39, s16
    s_waitcnt vmcnt(16)
    s_cmp_lg_u32 s60, 0
    s_cbranch_scc1 pc_45
    v_add_f32 v180, v180, v184
    v_add_f32 v181, v181, v185
    v_add_f32 v182, v182, v186
    v_add_f32 v183, v183, v187
    v_add_f32 v180, v180, v188
    v_add_f32 v181, v181, v189
    v_add_f32 v182, v182, v190
    v_add_f32 v183, v183, v191
    v_add_f32 v180, v180, v192
    v_add_f32 v181, v181, v193
    v_add_f32 v182, v182, v194
    v_add_f32 v183, v183, v195
    v_add_f32 v180, v180, v196
    v_add_f32 v181, v181, v197
    v_add_f32 v182, v182, v198
    v_add_f32 v183, v183, v199
pc_45:
    s_mov_b64 exec, 1
    buffer_load_dword v223, v222, s[56:59], 0 offen sc1
    s_mov_b64 exec, -1
    s_waitcnt vmcnt(9)
    s_barrier
    buffer_load_dwordx4 v2, s[12:15], s39 offen sc1 lds
    buffer_load_dwordx4 v2, s[12:15], s39 offen offset:1024 sc1 lds
    s_add_u32 s19, s41, s42
    v_readlane_b32 s16, v248, s44
    s_nop 0
    s_add_u32 s16, s16, s38
    s_add_u32 s44, s44, 1
    s_and_b32 s44, s44, 15
    s_add_u32 s42, s42, 16384
    s_cmp_eq_u32 s42, 49152
    s_cselect_b32 s42, 0, s42
    s_add_u32 m0, m0, 2048
    s_add_u32 s39, s39, 65536
    buffer_load_dwordx4 v2, s[12:15], s39 offen sc1 lds
    buffer_load_dwordx4 v2, s[12:15], s39 offen offset:1024 sc1 lds
    s_add_u32 m0, m0, 2048
    s_add_u32 s39, s39, 65536
    buffer_load_dwordx4 v2, s[12:15], s39 offen sc1 lds
    buffer_load_dwordx4 v2, s[12:15], s39 offen offset:1024 sc1 lds
    s_add_u32 m0, m0, 2048
    s_add_u32 s39, s39, 65536
    buffer_load_dwordx4 v2, s[12:15], s39 offen sc1 lds
    buffer_load_dwordx4 v2, s[12:15], s39 offen offset:1024 sc1 lds
    s_mov_b32 m0, s19
    s_mov_b32 s39, s16
    s_cmp_lg_u32 s60, 0
    s_cbranch_scc1 pc_46
    v_add_f32 v180, v180, v200
    v_add_f32 v181, v181, v201
    v_add_f32 v182, v182, v202
    v_add_f32 v183, v183, v203
    v_add_f32 v180, v180, v204
    v_add_f32 v181, v181, v205
    v_add_f32 v182, v182, v206
    v_add_f32 v183, v183, v207
    v_add_f32 v180, v180, v208
    v_add_f32 v181, v181, v209
    v_add_f32 v182, v182, v210
    v_add_f32 v183, v183, v211
    v_add_f32 v180, v180, v212
    v_add_f32 v181, v181, v213
    v_add_f32 v182, v182, v214
    v_add_f32 v183, v183, v215
pc_46:
    buffer_load_dwordx4 v[184:187], v224, s[24:27], s37 offen sc1
    s_add_u32 s37, s37, 28672
    buffer_load_dwordx4 v[188:191], v224, s[24:27], s37 offen sc1
    s_add_u32 s37, s37, 28672
    buffer_load_dwordx4 v[192:195], v224, s[24:27], s37 offen sc1
    s_add_u32 s37, s37, 28672
    buffer_load_dwordx4 v[196:199], v224, s[24:27], s37 offen sc1
    s_add_u32 s37, s37, 28672
    buffer_load_dwordx4 v[200:203], v224, s[24:27], s37 offen sc1
    s_add_u32 s37, s37, 28672
    buffer_load_dwordx4 v[204:207], v224, s[24:27], s37 offen sc1
    s_add_u32 s37, s37, 28672
    buffer_load_dwordx4 v[208:211], v224, s[24:27], s37 offen sc1
    s_add_u32 s37, s37, 28672
    s_waitcnt vmcnt(16)
    s_barrier
    buffer_load_dwordx4 v2, s[12:15], s39 offen sc1 lds
    buffer_load_dwordx4 v2, s[12:15], s39 offen offset:1024 sc1 lds
    s_add_u32 s19, s41, s42
    v_readlane_b32 s16, v248, s44
    s_nop 0
    s_add_u32 s16, s16, s38
    s_add_u32 s44, s44, 1
    s_and_b32 s44, s44, 15
    s_add_u32 s42, s42, 16384
    s_cmp_eq_u32 s42, 49152
    s_cselect_b32 s42, 0, s42
    s_add_u32 m0, m0, 2048
    s_add_u32 s39, s39, 65536
    buffer_load_dwordx4 v2, s[12:15], s39 offen sc1 lds
    buffer_load_dwordx4 v2, s[12:15], s39 offen offset:1024 sc1 lds
    s_add_u32 m0, m0, 2048
    s_add_u32 s39, s39, 65536
    buffer_load_dwordx4 v2, s[12:15], s39 offen sc1 lds
    buffer_load_dwordx4 v2, s[12:15], s39 offen offset:1024 sc1 lds
    s_add_u32 m0, m0, 2048
    s_add_u32 s39, s39, 65536
    buffer_load_dwordx4 v2, s[12:15], s39 offen sc1 lds
    buffer_load_dwordx4 v2, s[12:15], s39 offen offset:1024 sc1 lds
    s_mov_b32 m0, s19
    s_mov_b32 s39, s16
    s_waitcnt vmcnt(23)
    v_readfirstlane_b32 s53, v223
    s_add_u32 s54, s52, 16
    s_cmp_eq_u32 s53, s54
    s_cbranch_scc1 fok_47
    s_mov_b32 s53, 0
    s_add_u32 s54, s52, 16
    s_bfm_b64 exec, 1, 0
poll_48:
    buffer_load_dword v223, v222, s[56:59], 0 offen sc1
    s_waitcnt vmcnt(0)
    v_xor_b32 v223, s54, v223
    v_cmp_eq_u32 vcc, 0, v223
    s_nop 0
    s_cmp_eq_u64 vcc, exec
    s_cbranch_scc1 pok_49
    s_sleep 5
    s_add_u32 s53, s53, 1
    s_cmp_lt_u32 s53, s61
    s_cbranch_scc1 poll_48
    s_mov_b32 s61, 0
pok_49:
    s_mov_b64 exec, -1
fok_47:
    s_add_u32 s20, s62, 0x5c8000
    s_addc_u32 s21, s63, 0
    s_mov_b32 s22, 0x6000
    s_mov_b32 s23, 0x20000
    s_and_b32 s35, s30, 1
    s_lshl_b32 s35, s35, 9
    s_add_u32 s36, s35, 0
    buffer_load_dwordx2 v[16:17], v221, s[20:23], s36 offen offset:0 sc1
    buffer_load_dwordx2 v[18:19], v221, s[20:23], s36 offen offset:1024 sc1
    buffer_load_dwordx2 v[20:21], v221, s[20:23], s36 offen offset:2048 sc1
    buffer_load_dwordx2 v[22:23], v221, s[20:23], s36 offen offset:3072 sc1
    s_add_u32 s36, s36, 4096
    buffer_load_dwordx2 v[24:25], v221, s[20:23], s36 offen offset:0 sc1
    buffer_load_dwordx2 v[26:27], v221, s[20:23], s36 offen offset:1024 sc1
    buffer_load_dwordx2 v[28:29], v221, s[20:23], s36 offen offset:2048 sc1
    buffer_load_dwordx2 v[30:31], v221, s[20:23], s36 offen offset:3072 sc1
    s_waitcnt vmcnt(23)
    s_barrier
    buffer_load_dwordx4 v2, s[12:15], s39 offen sc1 lds
    buffer_load_dwordx4 v2, s[12:15], s39 offen offset:1024 sc1 lds
    s_add_u32 s19, s41, s42
    v_readlane_b32 s16, v248, s44
    s_nop 0
    s_add_u32 s16, s16, s38
    s_add_u32 s44, s44, 1
    s_and_b32 s44, s44, 15
    s_add_u32 s42, s42, 16384
    s_cmp_eq_u32 s42, 49152
    s_cselect_b32 s42, 0, s42
    s_add_u32 m0, m0, 2048
    s_add_u32 s39, s39, 65536
    buffer_load_dwordx4 v2, s[12:15], s39 offen sc1 lds
    buffer_load_dwordx4 v2, s[12:15], s39 offen offset:1024 sc1 lds
    s_add_u32 m0, m0, 2048
    s_add_u32 s39, s39, 65536
    buffer_load_dwordx4 v2, s[12:15], s39 offen sc1 lds
    buffer_load_dwordx4 v2, s[12:15], s39 offen offset:1024 sc1 lds
    s_add_u32 m0, m0, 2048
    s_add_u32 s39, s39, 65536
    buffer_load_dwordx4 v2, s[12:15], s39 offen sc1 lds
    buffer_load_dwordx4 v2, s[12:15], s39 offen offset:1024 sc1 lds
    s_mov_b32 m0, s19
    s_mov_b32 s39, s16
    s_add_u32 s36, s35, 16384
    buffer_load_dwordx2 v[32:33], v221, s[20:23], s36 offen offset:0 sc1
    buffer_load_dwordx2 v[34:35], v221, s[20:23], s36 offen offset:1024 sc1
    buffer_load_dwordx2 v[36:37], v221, s[20:23], s36 offen offset:2048 sc1
    buffer_load_dwordx2 v[38:39], v221, s[20:23], s36 offen offset:3072 sc1
    s_add_u32 s36, s36, 4096
    buffer_load_dwordx2 v[40:41], v221, s[20:23], s36 offen offset:0 sc1
    buffer_load_dwordx2 v[42:43], v221, s[20:23], s36 offen offset:1024 sc1
    buffer_load_dwordx2 v[44:45], v221, s[20:23], s36 offen offset:2048 sc1
    buffer_load_dwordx2 v[46:47], v221, s[20:23], s36 offen offset:3072 sc1
    s_waitcnt vmcnt(24)
    s_barrier
    buffer_load_dwordx4 v2, s[12:15], s39 offen sc1 lds
    buffer_load_dwordx4 v2, s[12:15], s39 offen offset:1024 sc1 lds
    s_add_u32 s19, s41, s42
    v_readlane_b32 s16, v248, s44
    s_nop 0
    s_add_u32 s16, s16, s38
    s_add_u32 s44, s44, 1
    s_and_b32 s44, s44, 15
    s_add_u32 s42, s42, 16384
    s_cmp_eq_u32 s42, 49152
    s_cselect_b32 s42, 0, s42
    s_add_u32 m0, m0, 2048
    s_add_u32 s39, s39, 65536
    buffer_load_dwordx4 v2, s[12:15], s39 offen sc1 lds
    buffer_load_dwordx4 v2, s[12:15], s39 offen offset:1024 sc1 lds
    s_add_u32 m0, m0, 2048
    s_add_u32 s39, s39, 65536
    buffer_load_dwordx4 v2, s[12:15], s39 offen sc1 lds
    buffer_load_dwordx4 v2, s[12:15], s39 offen offset:1024 sc1 lds
    s_add_u32 m0, m0, 2048
    s_add_u32 s39, s39, 65536
    buffer_load_dwordx4 v2, s[12:15], s39 offen sc1 lds
    buffer_load_dwordx4 v2, s[12:15], s39 offen offset:1024 sc1 lds
    s_mov_b32 m0, s19
    s_mov_b32 s39, s16
    s_waitcnt vmcnt(40)
    s_cmp_lg_u32 s60, 0
    s_cbranch_scc1 pc_50
    v_add_f32 v180, v180, v184
    v_add_f32 v181, v181, v185
    v_add_f32 v182, v182, v186
    v_add_f32 v183, v183, v187
    v_add_f32 v180, v180, v188
    v_add_f32 v181, v181, v189
    v_add_f32 v182, v182, v190
    v_add_f32 v183, v183, v191
    v_add_f32 v180, v180, v192
    v_add_f32 v181, v181, v193
    v_add_f32 v182, v182, v194
    v_add_f32 v183, v183, v195
    v_add_f32 v180, v180, v196
    v_add_f32 v181, v181, v197
    v_add_f32 v182, v182, v198
    v_add_f32 v183, v183, v199
pc_50:
    s_waitcnt vmcnt(16)
    s_barrier
    buffer_load_dwordx4 v2, s[12:15], s39 offen sc1 lds
    buffer_load_dwordx4 v2, s[12:15], s39 offen offset:1024 sc1 lds
    s_add_u32 s19, s41, s42
    v_readlane_b32 s16, v248, s44
    s_nop 0
    s_add_u32 s16, s16, s38
    s_add_u32 s44, s44, 1
    s_and_b32 s44, s44, 15
    s_add_u32 s42, s42, 16384
    s_cmp_eq_u32 s42, 49152
    s_cselect_b32 s42, 0, s42
    s_add_u32 m0, m0, 2048
    s_add_u32 s39, s39, 65536
    buffer_load_dwordx4 v2, s[12:15], s39 offen sc1 lds
    buffer_load_dwordx4 v2, s[12:15], s39 offen offset:1024 sc1 lds
    s_add_u32 m0, m0, 2048
    s_add_u32 s39, s39, 65536
    buffer_load_dwordx4 v2, s[12:15], s39 offen sc1 lds
    buffer_load_dwordx4 v2, s[12:15], s39 offen offset:1024 sc1 lds
    s_add_u32 m0, m0, 2048
    s_add_u32 s39, s39, 65536
    buffer_load_dwordx4 v2, s[12:15], s39 offen sc1 lds
    buffer_load_dwordx4 v2, s[12:15], s39 offen offset:1024 sc1 lds
    s_mov_b32 m0, s19
    s_mov_b32 s39, s16
    s_cmp_lg_u32 s60, 0
    s_cbranch_scc1 pc_51
    v_add_f32 v180, v180, v200
    v_add_f32 v181, v181, v201
    v_add_f32 v182, v182, v202
    v_add_f32 v183, v183, v203
    v_add_f32 v180, v180, v204
    v_add_f32 v181, v181, v205
    v_add_f32 v182, v182, v206
    v_add_f32 v183, v183, v207
    v_add_f32 v180, v180, v208
    v_add_f32 v181, v181, v209
    v_add_f32 v182, v182, v210
    v_add_f32 v183, v183, v211
pc_51:
    s_waitcnt vmcnt(8)
    s_barrier
    buffer_load_dwordx4 v2, s[12:15], s39 offen sc1 lds
    buffer_load_dwordx4 v2, s[12:15], s39 offen offset:1024 sc1 lds
    s_add_u32 s19, s41, s42
    v_readlane_b32 s16, v248, s44
    s_nop 0
    s_add_u32 s16, s16, s38
    s_add_u32 s44, s44, 1
    s_and_b32 s44, s44, 15
    s_add_u32 s42, s42, 16384
    s_cmp_eq_u32 s42, 49152
    s_cselect_b32 s42, 0, s42
    s_add_u32 m0, m0, 2048
    s_add_u32 s39, s39, 65536
    buffer_load_dwordx4 v2, s[12:15], s39 offen sc1 lds
    buffer_load_dwordx4 v2, s[12:15], s39 offen offset:1024 sc1 lds
    s_add_u32 m0, m0, 2048
    s_add_u32 s39, s39, 65536
    buffer_load_dwordx4 v2, s[12:15], s39 offen sc1 lds
    buffer_load_dwordx4 v2, s[12:15], s39 offen offset:1024 sc1 lds
    s_add_u32 m0, m0, 2048
    s_add_u32 s39, s39, 65536
    buffer_load_dwordx4 v2, s[12:15], s39 offen sc1 lds
    buffer_load_dwordx4 v2, s[12:15], s39 offen offset:1024 sc1 lds
    s_mov_b32 m0, s19
    s_mov_b32 s39, s16
    s_cmp_lg_u32 s60, 0
    s_cbranch_scc1 pc_52
    v_mov_b32 v184, v180
    v_mov_b32 v185, v181
    v_mov_b32 v186, v182
    v_mov_b32 v187, v183
    v_permlane32_swap_b32 v180, v184
    v_permlane32_swap_b32 v181, v185
    v_permlane32_swap_b32 v182, v186
    v_permlane32_swap_b32 v183, v187
    v_add_f32 v180, v180, v184
    v_add_f32 v181, v181, v185
    v_add_f32 v182, v182, v186
    v_add_f32 v183, v183, v187
    s_and_b32 s36, s30, 1
    s_mul_i32 s36, s36, 448
    s_add_u32 s36, s36, 159744
    v_add_u32 v179, s36, v2
    s_bfm_b64 exec, 28, 0
    ds_write_b128 v179, v[180:183]
    s_mov_b64 exec, -1
    s_waitcnt lgkmcnt(0)
pc_52:
    s_waitcnt vmcnt(8)
    s_barrier
    buffer_load_dwordx4 v2, s[12:15], s39 offen sc1 lds
    buffer_load_dwordx4 v2, s[12:15], s39 offen offset:1024 sc1 lds
    s_add_u32 s19, s41, s42
    v_readlane_b32 s16, v248, s44
    s_nop 0
    s_add_u32 s16, s16, s38
    s_add_u32 s44, s44, 1
    s_and_b32 s44, s44, 15
    s_add_u32 s42, s42, 16384
    s_cmp_eq_u32 s42, 49152
    s_cselect_b32 s42, 0, s42
    s_add_u32 m0, m0, 2048
    s_add_u32 s39, s39, 65536
    buffer_load_dwordx4 v2, s[12:15], s39 offen sc1 lds
    buffer_load_dwordx4 v2, s[12:15], s39 offen offset:1024 sc1 lds
    s_add_u32 m0, m0, 2048
    s_add_u32 s39, s39, 65536
    buffer_load_dwordx4 v2, s[12:15], s39 offen sc1 lds
    buffer_load_dwordx4 v2, s[12:15], s39 offen offset:1024 sc1 lds
    s_add_u32 m0, m0, 2048
    s_add_u32 s39, s39, 65536
    buffer_load_dwordx4 v2, s[12:15], s39 offen sc1 lds
    buffer_load_dwordx4 v2, s[12:15], s39 offen offset:1024 sc1 lds
    s_mov_b32 m0, s19
    s_mov_b32 s39, s16
    s_waitcnt vmcnt(32)
    v_add_f32 v16, v16, v32
    v_add_f32 v17, v17, v33
    v_add_f32 v18, v18, v34
    v_add_f32 v19, v19, v35
    v_add_f32 v20, v20, v36
    v_add_f32 v21, v21, v37
    v_add_f32 v22, v22, v38
    v_add_f32 v23, v23, v39
    v_add_f32 v24, v24, v40
    v_add_f32 v25, v25, v41
    v_add_f32 v26, v26, v42
    v_add_f32 v27, v27, v43
    v_add_f32 v28, v28, v44
    v_add_f32 v29, v29, v45
    v_add_f32 v30, v30, v46
    v_add_f32 v31, v31, v47
    s_waitcnt vmcnt(8)
    s_barrier
    buffer_load_dwordx4 v2, s[12:15], s39 offen sc1 lds
    buffer_load_dwordx4 v2, s[12:15], s39 offen offset:1024 sc1 lds
    s_add_u32 s19, s41, s42
    v_readlane_b32 s16, v248, s44
    s_nop 0
    s_add_u32 s16, s16, s38
    s_add_u32 s44, s44, 1
    s_and_b32 s44, s44, 15
    s_add_u32 s42, s42, 16384
    s_cmp_eq_u32 s42, 49152
    s_cselect_b32 s42, 0, s42
    s_add_u32 m0, m0, 2048
    s_add_u32 s39, s39, 65536
    buffer_load_dwordx4 v2, s[12:15], s39 offen sc1 lds
    buffer_load_dwordx4 v2, s[12:15], s39 offen offset:1024 sc1 lds
    s_add_u32 m0, m0, 2048
    s_add_u32 s39, s39, 65536
    buffer_load_dwordx4 v2, s[12:15], s39 offen sc1 lds
    buffer_load_dwordx4 v2, s[12:15], s39 offen offset:1024 sc1 lds
    s_add_u32 m0, m0, 2048
    s_add_u32 s39, s39, 65536
    buffer_load_dwordx4 v2, s[12:15], s39 offen sc1 lds
    buffer_load_dwordx4 v2, s[12:15], s39 offen offset:1024 sc1 lds
    s_mov_b32 m0, s19
    s_mov_b32 s39, s16
    v_add_f32 v16, v16, v24
    v_add_f32 v17, v17, v25
    v_add_f32 v18, v18, v26
    v_add_f32 v19, v19, v27
    v_add_f32 v20, v20, v28
    v_add_f32 v21, v21, v29
    v_add_f32 v22, v22, v30
    v_add_f32 v23, v23, v31
    v_add_f32 v16, v16, v20
    v_add_f32 v17, v17, v21
    v_add_f32 v18, v18, v22
    v_add_f32 v19, v19, v23
    v_add_f32 v16, v16, v18
    v_add_f32 v17, v17, v19
    v_mul_f32 v20, 0x3a800000, v16
    v_mul_f32 v217, 0x3a800000, v17
    s_waitcnt vmcnt(8)
    s_barrier
    buffer_load_dwordx4 v2, s[12:15], s39 offen sc1 lds
    buffer_load_dwordx4 v2, s[12:15], s39 offen offset:1024 sc1 lds
    s_add_u32 m0, m0, 2048
    s_add_u32 s39, s39, 65536
    buffer_load_dwordx4 v2, s[12:15], s39 offen sc1 lds
    buffer_load_dwordx4 v2, s[12:15], s39 offen offset:1024 sc1 lds
    s_add_u32 m0, m0, 2048
    s_add_u32 s39, s39, 65536
    buffer_load_dwordx4 v2, s[12:15], s39 offen sc1 lds
    buffer_load_dwordx4 v2, s[12:15], s39 offen offset:1024 sc1 lds
    s_add_u32 m0, m0, 2048
    s_add_u32 s39, s39, 65536
    buffer_load_dwordx4 v2, s[12:15], s39 offen sc1 lds
    buffer_load_dwordx4 v2, s[12:15], s39 offen offset:1024 sc1 lds
    v_fma_f32 v217, -v20, v20, v217
    v_max_f32 v217, 0, v217
    v_add_f32 v217, 0x3727c5ac, v217
    v_sqrt_f32 v217, v217
    s_nop 0
    v_mov_b32 v21, v217
    v_rcp_f32 v219, v217
    s_nop 0
    v_mul_f32 v22, 0xc0135761, v219
    v_mul_f32 v23, v219, v219
    v_mul_f32 v23, v23, v22
    v_mul_f32 v23, 0x3d372713, v23
    s_lshl_b32 s35, s35, 1
    s_add_u32 s35, s35, 160768
    v_add_u32 v220, s35, v2
    ds_write_b128 v220, v[20:23]
    s_waitcnt lgkmcnt(0)
    s_waitcnt vmcnt(8)
    s_barrier
    s_call_b64 s[76:77], SUB_r_pre0
    s_waitcnt vmcnt(4)
    s_barrier
    s_cmp_lg_u32 s60, 0
    s_cbranch_scc1 tw4_56
    s_load_dwordx2 s[48:49], s[0:1], 80
    s_lshl_b32 s45, s2, 1
    s_and_b32 s50, s30, 1
    s_add_u32 s45, s45, s50
    s_mul_i32 s45, s45, 14336
    s_mov_b32 s50, 7340032
    s_mov_b32 s51, 0x20000
    s_waitcnt lgkmcnt(0)
    buffer_load_dwordx4 v[20:23], v2, s[48:51], s45 offen offset:0
    buffer_load_dwordx4 v[20:23], v2, s[48:51], s45 offen offset:1024
    buffer_load_dwordx4 v[20:23], v2, s[48:51], s45 offen offset:2048
    buffer_load_dwordx4 v[20:23], v2, s[48:51], s45 offen offset:3072
    s_add_u32 s45, s45, 4096
    buffer_load_dwordx4 v[20:23], v2, s[48:51], s45 offen offset:0
    buffer_load_dwordx4 v[20:23], v2, s[48:51], s45 offen offset:1024
    buffer_load_dwordx4 v[20:23], v2, s[48:51], s45 offen offset:2048
    buffer_load_dwordx4 v[20:23], v2, s[48:51], s45 offen offset:3072
    s_add_u32 s45, s45, 4096
    buffer_load_dwordx4 v[20:23], v2, s[48:51], s45 offen offset:0
    buffer_load_dwordx4 v[20:23], v2, s[48:51], s45 offen offset:1024
    buffer_load_dwordx4 v[20:23], v2, s[48:51], s45 offen offset:2048
    buffer_load_dwordx4 v[20:23], v2, s[48:51], s45 offen offset:3072
    s_add_u32 s45, s45, 4096
    buffer_load_dwordx4 v[20:23], v2, s[48:51], s45 offen offset:0
    buffer_load_dwordx4 v[20:23], v2, s[48:51], s45 offen offset:1024
tw4_56:
    s_barrier
    s_and_b32 s35, s30, 1
    s_add_u32 s12, s62, 0x400000
    s_addc_u32 s13, s63, 0
    s_mov_b32 s14, 0x1be000
    s_mov_b32 s15, 0x20000
    s_mul_i32 s38, s35, 917504
    s_mul_i32 s36, s31, 114688
    s_add_u32 s38, s38, s36
    s_lshl_b32 s41, s35, 13
    s_mov_b32 s42, 0
    s_mov_b32 s44, 0
    s_add_u32 s54, s55, 0x700
    s_lshl_b32 s53, s31, 7
    s_add_u32 s54, s54, s53
    v_mov_b32 v9, s54
    s_add_u32 s54, s55, 0x600
    s_lshl_b32 s53, s31, 7
    s_add_u32 s54, s54, s53
    v_mov_b32 v10, s54
    s_add_u32 s54, s55, 0x300
    s_lshl_b32 s53, s31, 7
    s_add_u32 s54, s54, s53
    v_mov_b32 v12, s54
    v_mov_b32 v13, 1
    s_and_b32 s51, s30, 1
    s_lshl_b32 s51, s51, 30
    s_lshl_b32 s54, s60, 2
    s_add_u32 s54, s54, 4
    v_mov_b32 v14, 162880
spin_57:
    s_sleep 2
    ds_read_b32 v15, v14
    s_waitcnt lgkmcnt(0)
    v_readfirstlane_b32 s53, v15
    s_nop 0
    s_cmp_ge_u32 s53, s54
    s_cbranch_scc0 spin_57
    s_mov_b64 exec, 1
    buffer_atomic_add v13, v9, s[56:59], s51 offen sc1
    s_mov_b64 exec, -1
    v_xor_b32 v15, 128, v12
    s_mov_b32 s44, 3
    s_call_b64 s[76:77], PREP_a_issue_4
    s_mov_b32 m0, s19
    s_mov_b32 s39, s16
    s_mov_b32 s40, s17
    s_waitcnt vmcnt(16)
    s_barrier
    s_mov_b64 exec, 1
    buffer_load_dword v8, v9, s[56:59], 0 offen sc1
    s_mov_b64 exec, -1
    s_waitcnt vmcnt(9)
    s_barrier
    s_waitcnt vmcnt(0)
    v_readfirstlane_b32 s53, v8
    s_add_u32 s54, s52, 8
    s_cmp_eq_u32 s53, s54
    s_cbranch_scc1 fok_58
    s_mov_b32 s53, 0
    s_add_u32 s54, s52, 8
    s_bfm_b64 exec, 1, 0
poll_59:
    buffer_load_dword v8, v9, s[56:59], 0 offen sc1
    s_waitcnt vmcnt(0)
    v_xor_b32 v8, s54, v8
    v_cmp_eq_u32 vcc, 0, v8
    s_nop 0
    s_cmp_eq_u64 vcc, exec
    s_cbranch_scc1 pok_60
    s_sleep 5
    s_add_u32 s53, s53, 1
    s_cmp_lt_u32 s53, s61
    s_cbranch_scc1 poll_59
    s_mov_b32 s61, 0
pok_60:
    s_mov_b64 exec, -1
fok_58:
    buffer_load_dwordx4 v2, s[12:15], s39 offen sc1 lds
    s_add_u32 m0, m0, 1024
    s_nop 0
    buffer_load_dwordx4 v2, s[12:15], s40 offen sc1 lds
    s_call_b64 s[76:77], PREP_a_issue_4
    s_add_u32 m0, m0, 1024
    s_add_u32 s39, s39, 229376
    buffer_load_dwordx4 v2, s[12:15], s39 offen sc1 lds
    s_add_u32 m0, m0, 1024
    s_add_u32 s40, s40, 229376
    buffer_load_dwordx4 v2, s[12:15], s40 offen sc1 lds
    s_add_u32 m0, m0, 1024
    s_add_u32 s39, s39, 229376
    buffer_load_dwordx4 v2, s[12:15], s39 offen sc1 lds
    s_add_u32 m0, m0, 1024
    s_add_u32 s40, s40, 229376
    buffer_load_dwordx4 v2, s[12:15], s40 offen sc1 lds
    s_add_u32 m0, m0, 1024
    s_add_u32 s39, s39, 229376
    buffer_load_dwordx4 v2, s[12:15], s39 offen sc1 lds
    s_add_u32 m0, m0, 1024
    s_add_u32 s40, s40, 229376
    buffer_load_dwordx4 v2, s[12:15], s40 offen sc1 lds
    s_mov_b32 m0, s19
    s_mov_b32 s39, s16
    s_mov_b32 s40, s17
    s_waitcnt vmcnt(9)
    s_barrier
    s_mov_b64 exec, 1
    buffer_atomic_add v13, v10, s[56:59], s51 offen sc1
    s_mov_b64 exec, -1
    buffer_load_dwordx4 v2, s[12:15], s39 offen sc1 lds
    s_add_u32 m0, m0, 1024
    s_nop 0
    buffer_load_dwordx4 v2, s[12:15], s40 offen sc1 lds
    s_call_b64 s[76:77], PREP_a_issue_4
    s_add_u32 m0, m0, 1024
    s_add_u32 s39, s39, 229376
    buffer_load_dwordx4 v2, s[12:15], s39 offen sc1 lds
    s_add_u32 m0, m0, 1024
    s_add_u32 s40, s40, 229376
    buffer_load_dwordx4 v2, s[12:15], s40 offen sc1 lds
    s_add_u32 m0, m0, 1024
    s_add_u32 s39, s39, 229376
    buffer_load_dwordx4 v2, s[12:15], s39 offen sc1 lds
    s_add_u32 m0, m0, 1024
    s_add_u32 s40, s40, 229376
    buffer_load_dwordx4 v2, s[12:15], s40 offen sc1 lds
    s_add_u32 m0, m0, 1024
    s_add_u32 s39, s39, 229376
    buffer_load_dwordx4 v2, s[12:15], s39 offen sc1 lds
    s_add_u32 m0, m0, 1024
    s_add_u32 s40, s40, 229376
    buffer_load_dwordx4 v2, s[12:15], s40 offen sc1 lds
    s_mov_b32 m0, s19
    s_mov_b32 s39, s16
    s_mov_b32 s40, s17
    s_waitcnt vmcnt(9)
    s_barrier
    buffer_load_dwordx4 v2, s[12:15], s39 offen sc1 lds
    s_add_u32 m0, m0, 1024
    s_nop 0
    buffer_load_dwordx4 v2, s[12:15], s40 offen sc1 lds
    s_call_b64 s[76:77], PREP_a_issue_4
    s_add_u32 m0, m0, 1024
    s_add_u32 s39, s39, 229376
    buffer_load_dwordx4 v2, s[12:15], s39 offen sc1 lds
    s_add_u32 m0, m0, 1024
    s_add_u32 s40, s40, 229376
    buffer_load_dwordx4 v2, s[12:15], s40 offen sc1 lds
    s_add_u32 m0, m0, 1024
    s_add_u32 s39, s39, 229376
    buffer_load_dwordx4 v2, s[12:15], s39 offen sc1 lds
    s_add_u32 m0, m0, 1024
    s_add_u32 s40, s40, 229376
    buffer_load_dwordx4 v2, s[12:15], s40 offen sc1 lds
    s_add_u32 m0, m0, 1024
    s_add_u32 s39, s39, 229376
    buffer_load_dwordx4 v2, s[12:15], s39 offen sc1 lds
    s_add_u32 m0, m0, 1024
    s_add_u32 s40, s40, 229376
    buffer_load_dwordx4 v2, s[12:15], s40 offen sc1 lds
    s_mov_b32 m0, s19
    s_mov_b32 s39, s16
    s_mov_b32 s40, s17
    s_waitcnt vmcnt(8)
    s_barrier
    buffer_load_dwordx4 v2, s[12:15], s39 offen sc1 lds
    s_add_u32 m0, m0, 1024
    s_nop 0
    buffer_load_dwordx4 v2, s[12:15], s40 offen sc1 lds
    s_mov_b64 exec, 1
    buffer_load_dword v11, v10, s[56:59], 0 offen sc1
    s_mov_b64 exec, -1
    s_call_b64 s[76:77], PREP_a_issue_4
    s_add_u32 m0, m0, 1024
    s_add_u32 s39, s39, 229376
    buffer_load_dwordx4 v2, s[12:15], s39 offen sc1 lds
    s_add_u32 m0, m0, 1024
    s_add_u32 s40, s40, 229376
    buffer_load_dwordx4 v2, s[12:15], s40 offen sc1 lds
    s_add_u32 m0, m0, 1024
    s_add_u32 s39, s39, 229376
    buffer_load_dwordx4 v2, s[12:15], s39 offen sc1 lds
    s_add_u32 m0, m0, 1024
    s_add_u32 s40, s40, 229376
    buffer_load_dwordx4 v2, s[12:15], s40 offen sc1 lds
    s_add_u32 m0, m0, 1024
    s_add_u32 s39, s39, 229376
    buffer_load_dwordx4 v2, s[12:15], s39 offen sc1 lds
    s_add_u32 m0, m0, 1024
    s_add_u32 s40, s40, 229376
    buffer_load_dwordx4 v2, s[12:15], s40 offen sc1 lds
    s_mov_b32 m0, s19
    s_mov_b32 s39, s16
    s_mov_b32 s40, s17
    s_waitcnt vmcnt(9)
    s_barrier
    s_mov_b64 exec, 1
    buffer_atomic_add v13, v12, s[56:59], s51 offen sc1
    s_mov_b64 exec, -1
    buffer_load_dwordx4 v2, s[12:15], s39 offen sc1 lds
    s_add_u32 m0, m0, 1024
    s_nop 0
    buffer_load_dwordx4 v2, s[12:15], s40 offen sc1 lds
    s_call_b64 s[76:77], PREP_a_issue_4
    s_add_u32 m0, m0, 1024
    s_add_u32 s39, s39, 229376
    buffer_load_dwordx4 v2, s[12:15], s39 offen sc1 lds
    s_add_u32 m0, m0, 1024
    s_add_u32 s40, s40, 229376
    buffer_load_dwordx4 v2, s[12:15], s40 offen sc1 lds
    s_add_u32 m0, m0, 1024
    s_add_u32 s39, s39, 229376
    buffer_load_dwordx4 v2, s[12:15], s39 offen sc1 lds
    s_add_u32 m0, m0, 1024
    s_add_u32 s40, s40, 229376
    buffer_load_dwordx4 v2, s[12:15], s40 offen sc1 lds
    s_add_u32 m0, m0, 1024
    s_add_u32 s39, s39, 229376
    buffer_load_dwordx4 v2, s[12:15], s39 offen sc1 lds
    s_add_u32 m0, m0, 1024
    s_add_u32 s40, s40, 229376
    buffer_load_dwordx4 v2, s[12:15], s40 offen sc1 lds
    s_mov_b32 m0, s19
    s_mov_b32 s39, s16
    s_mov_b32 s40, s17
    s_waitcnt vmcnt(9)
    s_barrier
    buffer_load_dwordx4 v2, s[12:15], s39 offen sc1 lds
    s_add_u32 m0, m0, 1024
    s_nop 0
    buffer_load_dwordx4 v2, s[12:15], s40 offen sc1 lds
    s_waitcnt vmcnt(17)
    v_readfirstlane_b32 s53, v11
    s_add_u32 s54, s52, 8
    s_cmp_eq_u32 s53, s54
    s_cbranch_scc1 fok_61
    s_mov_b32 s53, 0
    s_add_u32 s54, s52, 8
    s_bfm_b64 exec, 1, 0
poll_62:
    buffer_load_dword v11, v10, s[56:59], 0 offen sc1
    s_waitcnt vmcnt(0)
    v_xor_b32 v11, s54, v11
    v_cmp_eq_u32 vcc, 0, v11
    s_nop 0
    s_cmp_eq_u64 vcc, exec
    s_cbranch_scc1 pok_63
    s_sleep 5
    s_add_u32 s53, s53, 1
    s_cmp_lt_u32 s53, s61
    s_cbranch_scc1 poll_62
    s_mov_b32 s61, 0
pok_63:
    s_mov_b64 exec, -1
fok_61:
    s_call_b64 s[76:77], PREP_a_issue_4
    s_add_u32 m0, m0, 1024
    s_add_u32 s39, s39, 229376
    buffer_load_dwordx4 v2, s[12:15], s39 offen sc1 lds
    s_add_u32 m0, m0, 1024
    s_add_u32 s40, s40, 229376
    buffer_load_dwordx4 v2, s[12:15], s40 offen sc1 lds
    s_add_u32 m0, m0, 1024
    s_add_u32 s39, s39, 229376
    buffer_load_dwordx4 v2, s[12:15], s39 offen sc1 lds
    s_add_u32 m0, m0, 1024
    s_add_u32 s40, s40, 229376
    buffer_load_dwordx4 v2, s[12:15], s40 offen sc1 lds
    s_add_u32 m0, m0, 1024
    s_add_u32 s39, s39, 229376
    buffer_load_dwordx4 v2, s[12:15], s39 offen sc1 lds
    s_add_u32 m0, m0, 1024
    s_add_u32 s40, s40, 229376
    buffer_load_dwordx4 v2, s[12:15], s40 offen sc1 lds
    s_mov_b32 m0, s19
    s_mov_b32 s39, s16
    s_mov_b32 s40, s17
    s_waitcnt vmcnt(8)
    s_barrier
    buffer_load_dwordx4 v2, s[12:15], s39 offen sc1 lds
    s_add_u32 m0, m0, 1024
    s_nop 0
    buffer_load_dwordx4 v2, s[12:15], s40 offen sc1 lds
    s_mov_b32 s43, 1
ld_64:
    s_add_u32 s19, s41, s42
    v_readlane_b32 s16, v249, s44
    v_readlane_b32 s17, v250, s44
    s_add_u32 s16, s16, s38
    s_add_u32 s17, s17, s38
    s_add_u32 s44, s44, 1
    s_add_u32 s42, s42, 16384
    s_cmp_eq_u32 s42, 49152
    s_cselect_b32 s42, 0, s42
    s_add_u32 m0, m0, 1024
    s_add_u32 s39, s39, 229376
    buffer_load_dwordx4 v2, s[12:15], s39 offen sc1 lds
    s_add_u32 m0, m0, 1024
    s_add_u32 s40, s40, 229376
    buffer_load_dwordx4 v2, s[12:15], s40 offen sc1 lds
    s_add_u32 m0, m0, 1024
    s_add_u32 s39, s39, 229376
    buffer_load_dwordx4 v2, s[12:15], s39 offen sc1 lds
    s_add_u32 m0, m0, 1024
    s_add_u32 s40, s40, 229376
    buffer_load_dwordx4 v2, s[12:15], s40 offen sc1 lds
    s_add_u32 m0, m0, 1024
    s_add_u32 s39, s39, 229376
    buffer_load_dwordx4 v2, s[12:15], s39 offen sc1 lds
    s_add_u32 m0, m0, 1024
    s_add_u32 s40, s40, 229376
    buffer_load_dwordx4 v2, s[12:15], s40 offen sc1 lds
    s_mov_b32 m0, s19
    s_mov_b32 s39, s16
    s_mov_b32 s40, s17
    s_waitcnt vmcnt(8)
    s_barrier
    buffer_load_dwordx4 v2, s[12:15], s39 offen sc1 lds
    s_add_u32 m0, m0, 1024
    s_nop 0
    buffer_load_dwordx4 v2, s[12:15], s40 offen sc1 lds
    s_add_u32 s43, s43, 1
    s_cmp_lt_u32 s43, 4
    s_cbranch_scc1 ld_64
    s_call_b64 s[76:77], PREP_a_issue_4
    s_add_u32 m0, m0, 1024
    s_add_u32 s39, s39, 229376
    buffer_load_dwordx4 v2, s[12:15], s39 offen sc1 lds
    s_add_u32 m0, m0, 1024
    s_add_u32 s40, s40, 229376
    buffer_load_dwordx4 v2, s[12:15], s40 offen sc1 lds
    s_add_u32 m0, m0, 1024
    s_add_u32 s39, s39, 229376
    buffer_load_dwordx4 v2, s[12:15], s39 offen sc1 lds
    s_add_u32 m0, m0, 1024
    s_add_u32 s40, s40, 229376
    buffer_load_dwordx4 v2, s[12:15], s40 offen sc1 lds
    s_add_u32 m0, m0, 1024
    s_add_u32 s39, s39, 229376
    buffer_load_dwordx4 v2, s[12:15], s39 offen sc1 lds
    s_add_u32 m0, m0, 1024
    s_add_u32 s40, s40, 229376
    buffer_load_dwordx4 v2, s[12:15], s40 offen sc1 lds
    s_mov_b32 m0, s19
    s_mov_b32 s39, s16
    s_mov_b32 s40, s17
    s_waitcnt vmcnt(8)
    s_barrier
    buffer_load_dwordx4 v2, s[12:15], s39 offen sc1 lds
    s_add_u32 m0, m0, 1024
    s_nop 0
    buffer_load_dwordx4 v2, s[12:15], s40 offen sc1 lds
    s_mov_b64 exec, 1
    buffer_load_dword v11, v12, s[56:59], 0 offen sc1
    s_mov_b64 exec, -1
    s_call_b64 s[76:77], PREP_a_issue_4
    s_add_u32 m0, m0, 1024
    s_add_u32 s39, s39, 229376
    buffer_load_dwordx4 v2, s[12:15], s39 offen sc1 lds
    s_add_u32 m0, m0, 1024
    s_add_u32 s40, s40, 229376
    buffer_load_dwordx4 v2, s[12:15], s40 offen sc1 lds
    s_add_u32 m0, m0, 1024
    s_add_u32 s39, s39, 229376
    buffer_load_dwordx4 v2, s[12:15], s39 offen sc1 lds
    s_add_u32 m0, m0, 1024
    s_add_u32 s40, s40, 229376
    buffer_load_dwordx4 v2, s[12:15], s40 offen sc1 lds
    s_add_u32 m0, m0, 1024
    s_add_u32 s39, s39, 229376
    buffer_load_dwordx4 v2, s[12:15], s39 offen sc1 lds
    s_add_u32 m0, m0, 1024
    s_add_u32 s40, s40, 229376
    buffer_load_dwordx4 v2, s[12:15], s40 offen sc1 lds
    s_mov_b32 m0, s19
    s_mov_b32 s39, s16
    s_mov_b32 s40, s17
    s_waitcnt vmcnt(9)
    s_barrier
    buffer_load_dwordx4 v2, s[12:15], s39 offen sc1 lds
    s_add_u32 m0, m0, 1024
    s_nop 0
    buffer_load_dwordx4 v2, s[12:15], s40 offen sc1 lds
    s_call_b64 s[76:77], PREP_a_issue_4
    s_add_u32 m0, m0, 1024
    s_add_u32 s39, s39, 229376
    buffer_load_dwordx4 v2, s[12:15], s39 offen sc1 lds
    s_add_u32 m0, m0, 1024
    s_add_u32 s40, s40, 229376
    buffer_load_dwordx4 v2, s[12:15], s40 offen sc1 lds
    s_add_u32 m0, m0, 1024
    s_add_u32 s39, s39, 229376
    buffer_load_dwordx4 v2, s[12:15], s39 offen sc1 lds
    s_add_u32 m0, m0, 1024
    s_add_u32 s40, s40, 229376
    buffer_load_dwordx4 v2, s[12:15], s40 offen sc1 lds
    s_add_u32 m0, m0, 1024
    s_add_u32 s39, s39, 229376
    buffer_load_dwordx4 v2, s[12:15], s39 offen sc1 lds
    s_add_u32 m0, m0, 1024
    s_add_u32 s40, s40, 229376
    buffer_load_dwordx4 v2, s[12:15], s40 offen sc1 lds
    s_mov_b32 m0, s19
    s_mov_b32 s39, s16
    s_mov_b32 s40, s17
    s_waitcnt vmcnt(8)
    s_barrier
    buffer_load_dwordx4 v2, s[12:15], s39 offen sc1 lds
    s_add_u32 m0, m0, 1024
    s_nop 0
    buffer_load_dwordx4 v2, s[12:15], s40 offen sc1 lds
    s_waitcnt vmcnt(16)
    v_readfirstlane_b32 s53, v11
    s_add_u32 s54, s52, 8
    s_cmp_eq_u32 s53, s54
    s_cbranch_scc1 fok_65
    s_mov_b32 s53, 0
    s_add_u32 s54, s52, 8
    s_bfm_b64 exec, 1, 0
poll_66:
    buffer_load_dword v11, v12, s[56:59], 0 offen sc1
    s_waitcnt vmcnt(0)
    v_xor_b32 v11, s54, v11
    v_cmp_eq_u32 vcc, 0, v11
    s_nop 0
    s_cmp_eq_u64 vcc, exec
    s_cbranch_scc1 pok_67
    s_sleep 5
    s_add_u32 s53, s53, 1
    s_cmp_lt_u32 s53, s61
    s_cbranch_scc1 poll_66
    s_mov_b32 s61, 0
pok_67:
    s_mov_b64 exec, -1
fok_65:
    s_call_b64 s[76:77], PREP_a_issue_4
    s_add_u32 m0, m0, 1024
    s_add_u32 s39, s39, 229376
    buffer_load_dwordx4 v2, s[12:15], s39 offen sc1 lds
    s_add_u32 m0, m0, 1024
    s_add_u32 s40, s40, 229376
    buffer_load_dwordx4 v2, s[12:15], s40 offen sc1 lds
    s_add_u32 m0, m0, 1024
    s_add_u32 s39, s39, 229376
    buffer_load_dwordx4 v2, s[12:15], s39 offen sc1 lds
    s_add_u32 m0, m0, 1024
    s_add_u32 s40, s40, 229376
    buffer_load_dwordx4 v2, s[12:15], s40 offen sc1 lds
    s_add_u32 m0, m0, 1024
    s_add_u32 s39, s39, 229376
    buffer_load_dwordx4 v2, s[12:15], s39 offen sc1 lds
    s_add_u32 m0, m0, 1024
    s_add_u32 s40, s40, 229376
    buffer_load_dwordx4 v2, s[12:15], s40 offen sc1 lds
    s_mov_b32 m0, s19
    s_mov_b32 s39, s16
    s_mov_b32 s40, s17
    s_waitcnt vmcnt(8)
    s_barrier
    buffer_load_dwordx4 v2, s[12:15], s39 offen sc1 lds
    s_add_u32 m0, m0, 1024
    s_nop 0
    buffer_load_dwordx4 v2, s[12:15], s40 offen sc1 lds
    s_mov_b32 s43, 1
ld_68:
    s_add_u32 s19, s41, s42
    v_readlane_b32 s16, v249, s44
    v_readlane_b32 s17, v250, s44
    s_add_u32 s16, s16, s38
    s_add_u32 s17, s17, s38
    s_add_u32 s44, s44, 1
    s_add_u32 s42, s42, 16384
    s_cmp_eq_u32 s42, 49152
    s_cselect_b32 s42, 0, s42
    s_add_u32 m0, m0, 1024
    s_add_u32 s39, s39, 229376
    buffer_load_dwordx4 v2, s[12:15], s39 offen sc1 lds
    s_add_u32 m0, m0, 1024
    s_add_u32 s40, s40, 229376
    buffer_load_dwordx4 v2, s[12:15], s40 offen sc1 lds
    s_add_u32 m0, m0, 1024
    s_add_u32 s39, s39, 229376
    buffer_load_dwordx4 v2, s[12:15], s39 offen sc1 lds
    s_add_u32 m0, m0, 1024
    s_add_u32 s40, s40, 229376
    buffer_load_dwordx4 v2, s[12:15], s40 offen sc1 lds
    s_add_u32 m0, m0, 1024
    s_add_u32 s39, s39, 229376
    buffer_load_dwordx4 v2, s[12:15], s39 offen sc1 lds
    s_add_u32 m0, m0, 1024
    s_add_u32 s40, s40, 229376
    buffer_load_dwordx4 v2, s[12:15], s40 offen sc1 lds
    s_mov_b32 m0, s19
    s_mov_b32 s39, s16
    s_mov_b32 s40, s17
    s_waitcnt vmcnt(8)
    s_barrier
    buffer_load_dwordx4 v2, s[12:15], s39 offen sc1 lds
    s_add_u32 m0, m0, 1024
    s_nop 0
    buffer_load_dwordx4 v2, s[12:15], s40 offen sc1 lds
    s_add_u32 s43, s43, 1
    s_cmp_lt_u32 s43, 5
    s_cbranch_scc1 ld_68
    s_call_b64 s[76:77], PREP_a_issue_4
    s_add_u32 m0, m0, 1024
    s_add_u32 s39, s39, 229376
    buffer_load_dwordx4 v2, s[12:15], s39 offen sc1 lds
    s_add_u32 m0, m0, 1024
    s_add_u32 s40, s40, 229376
    buffer_load_dwordx4 v2, s[12:15], s40 offen sc1 lds
    s_add_u32 m0, m0, 1024
    s_add_u32 s39, s39, 229376
    buffer_load_dwordx4 v2, s[12:15], s39 offen sc1 lds
    s_add_u32 m0, m0, 1024
    s_add_u32 s40, s40, 229376
    buffer_load_dwordx4 v2, s[12:15], s40 offen sc1 lds
    s_add_u32 m0, m0, 1024
    s_add_u32 s39, s39, 229376
    buffer_load_dwordx4 v2, s[12:15], s39 offen sc1 lds
    s_add_u32 m0, m0, 1024
    s_add_u32 s40, s40, 229376
    buffer_load_dwordx4 v2, s[12:15], s40 offen sc1 lds
    s_mov_b32 m0, s19
    s_mov_b32 s39, s16
    s_mov_b32 s40, s17
    s_waitcnt vmcnt(8)
    s_barrier
    buffer_load_dwordx4 v2, s[12:15], s39 offen sc1 lds
    s_add_u32 m0, m0, 1024
    s_nop 0
    buffer_load_dwordx4 v2, s[12:15], s40 offen sc1 lds
    s_mov_b64 exec, 1
    buffer_load_dword v11, v15, s[56:59], 0 offen sc1
    s_mov_b64 exec, -1
    s_call_b64 s[76:77], PREP_a_issue_4
    s_add_u32 m0, m0, 1024
    s_add_u32 s39, s39, 229376
    buffer_load_dwordx4 v2, s[12:15], s39 offen sc1 lds
    s_add_u32 m0, m0, 1024
    s_add_u32 s40, s40, 229376
    buffer_load_dwordx4 v2, s[12:15], s40 offen sc1 lds
    s_add_u32 m0, m0, 1024
    s_add_u32 s39, s39, 229376
    buffer_load_dwordx4 v2, s[12:15], s39 offen sc1 lds
    s_add_u32 m0, m0, 1024
    s_add_u32 s40, s40, 229376
    buffer_load_dwordx4 v2, s[12:15], s40 offen sc1 lds
    s_add_u32 m0, m0, 1024
    s_add_u32 s39, s39, 229376
    buffer_load_dwordx4 v2, s[12:15], s39 offen sc1 lds
    s_add_u32 m0, m0, 1024
    s_add_u32 s40, s40, 229376
    buffer_load_dwordx4 v2, s[12:15], s40 offen sc1 lds
    s_mov_b32 m0, s19
    s_mov_b32 s39, s16
    s_mov_b32 s40, s17
    s_waitcnt vmcnt(9)
    s_barrier
    buffer_load_dwordx4 v2, s[12:15], s39 offen sc1 lds
    s_add_u32 m0, m0, 1024
    s_nop 0
    buffer_load_dwordx4 v2, s[12:15], s40 offen sc1 lds
    s_call_b64 s[76:77], PREP_a_issue_4
    s_add_u32 m0, m0, 1024
    s_add_u32 s39, s39, 229376
    buffer_load_dwordx4 v2, s[12:15], s39 offen sc1 lds
    s_add_u32 m0, m0, 1024
    s_add_u32 s40, s40, 229376
    buffer_load_dwordx4 v2, s[12:15], s40 offen sc1 lds
    s_add_u32 m0, m0, 1024
    s_add_u32 s39, s39, 229376
    buffer_load_dwordx4 v2, s[12:15], s39 offen sc1 lds
    s_add_u32 m0, m0, 1024
    s_add_u32 s40, s40, 229376
    buffer_load_dwordx4 v2, s[12:15], s40 offen sc1 lds
    s_add_u32 m0, m0, 1024
    s_add_u32 s39, s39, 229376
    buffer_load_dwordx4 v2, s[12:15], s39 offen sc1 lds
    s_add_u32 m0, m0, 1024
    s_add_u32 s40, s40, 229376
    buffer_load_dwordx4 v2, s[12:15], s40 offen sc1 lds
    s_mov_b32 m0, s19
    s_mov_b32 s39, s16
    s_mov_b32 s40, s17
    s_waitcnt vmcnt(8)
    s_barrier
    buffer_load_dwordx4 v2, s[12:15], s39 offen sc1 lds
    s_add_u32 m0, m0, 1024
    s_nop 0
    buffer_load_dwordx4 v2, s[12:15], s40 offen sc1 lds
    s_waitcnt vmcnt(16)
    v_readfirstlane_b32 s53, v11
    s_add_u32 s54, s52, 8
    s_cmp_eq_u32 s53, s54
    s_cbranch_scc1 fok_69
    s_mov_b32 s53, 0
    s_add_u32 s54, s52, 8
    s_bfm_b64 exec, 1, 0
poll_70:
    buffer_load_dword v11, v15, s[56:59], 0 offen sc1
    s_waitcnt vmcnt(0)
    v_xor_b32 v11, s54, v11
    v_cmp_eq_u32 vcc, 0, v11
    s_nop 0
    s_cmp_eq_u64 vcc, exec
    s_cbranch_scc1 pok_71
    s_sleep 5
    s_add_u32 s53, s53, 1
    s_cmp_lt_u32 s53, s61
    s_cbranch_scc1 poll_70
    s_mov_b32 s61, 0
pok_71:
    s_mov_b64 exec, -1
fok_69:
    s_call_b64 s[76:77], PREP_a_issue_4
    s_add_u32 m0, m0, 1024
    s_add_u32 s39, s39, 229376
    buffer_load_dwordx4 v2, s[12:15], s39 offen sc1 lds
    s_add_u32 m0, m0, 1024
    s_add_u32 s40, s40, 229376
    buffer_load_dwordx4 v2, s[12:15], s40 offen sc1 lds
    s_add_u32 m0, m0, 1024
    s_add_u32 s39, s39, 229376
    buffer_load_dwordx4 v2, s[12:15], s39 offen sc1 lds
    s_add_u32 m0, m0, 1024
    s_add_u32 s40, s40, 229376
    buffer_load_dwordx4 v2, s[12:15], s40 offen sc1 lds
    s_add_u32 m0, m0, 1024
    s_add_u32 s39, s39, 229376
    buffer_load_dwordx4 v2, s[12:15], s39 offen sc1 lds
    s_add_u32 m0, m0, 1024
    s_add_u32 s40, s40, 229376
    buffer_load_dwordx4 v2, s[12:15], s40 offen sc1 lds
    s_mov_b32 m0, s19
    s_mov_b32 s39, s16
    s_mov_b32 s40, s17
    s_waitcnt vmcnt(8)
    s_barrier
    buffer_load_dwordx4 v2, s[12:15], s39 offen sc1 lds
    s_add_u32 m0, m0, 1024
    s_nop 0
    buffer_load_dwordx4 v2, s[12:15], s40 offen sc1 lds
    s_mov_b32 s43, 1
ld_72:
    s_add_u32 s19, s41, s42
    v_readlane_b32 s16, v249, s44
    v_readlane_b32 s17, v250, s44
    s_add_u32 s16, s16, s38
    s_add_u32 s17, s17, s38
    s_add_u32 s44, s44, 1
    s_add_u32 s42, s42, 16384
    s_cmp_eq_u32 s42, 49152
    s_cselect_b32 s42, 0, s42
    s_add_u32 m0, m0, 1024
    s_add_u32 s39, s39, 229376
    buffer_load_dwordx4 v2, s[12:15], s39 offen sc1 lds
    s_add_u32 m0, m0, 1024
    s_add_u32 s40, s40, 229376
    buffer_load_dwordx4 v2, s[12:15], s40 offen sc1 lds
    s_add_u32 m0, m0, 1024
    s_add_u32 s39, s39, 229376
    buffer_load_dwordx4 v2, s[12:15], s39 offen sc1 lds
    s_add_u32 m0, m0, 1024
    s_add_u32 s40, s40, 229376
    buffer_load_dwordx4 v2, s[12:15], s40 offen sc1 lds
    s_add_u32 m0, m0, 1024
    s_add_u32 s39, s39, 229376
    buffer_load_dwordx4 v2, s[12:15], s39 offen sc1 lds
    s_add_u32 m0, m0, 1024
    s_add_u32 s40, s40, 229376
    buffer_load_dwordx4 v2, s[12:15], s40 offen sc1 lds
    s_mov_b32 m0, s19
    s_mov_b32 s39, s16
    s_mov_b32 s40, s17
    s_waitcnt vmcnt(8)
    s_barrier
    buffer_load_dwordx4 v2, s[12:15], s39 offen sc1 lds
    s_add_u32 m0, m0, 1024
    s_nop 0
    buffer_load_dwordx4 v2, s[12:15], s40 offen sc1 lds
    s_add_u32 s43, s43, 1
    s_cmp_lt_u32 s43, 3
    s_cbranch_scc1 ld_72
    s_call_b64 s[76:77], PREP_a_issue_4
    s_add_u32 m0, m0, 1024
    s_add_u32 s39, s39, 229376
    buffer_load_dwordx4 v2, s[12:15], s39 offen sc1 lds
    s_add_u32 m0, m0, 1024
    s_add_u32 s40, s40, 229376
    buffer_load_dwordx4 v2, s[12:15], s40 offen sc1 lds
    s_add_u32 m0, m0, 1024
    s_add_u32 s39, s39, 229376
    buffer_load_dwordx4 v2, s[12:15], s39 offen sc1 lds
    s_add_u32 m0, m0, 1024
    s_add_u32 s40, s40, 229376
    buffer_load_dwordx4 v2, s[12:15], s40 offen sc1 lds
    s_add_u32 m0, m0, 1024
    s_add_u32 s39, s39, 229376
    buffer_load_dwordx4 v2, s[12:15], s39 offen sc1 lds
    s_add_u32 m0, m0, 1024
    s_add_u32 s40, s40, 229376
    buffer_load_dwordx4 v2, s[12:15], s40 offen sc1 lds
    s_mov_b32 m0, s19
    s_mov_b32 s39, s16
    s_mov_b32 s40, s17
    s_waitcnt vmcnt(8)
    s_barrier
    buffer_load_dwordx4 v2, s[12:15], s39 offen sc1 lds
    s_add_u32 m0, m0, 1024
    s_nop 0
    buffer_load_dwordx4 v2, s[12:15], s40 offen sc1 lds
    s_add_u32 m0, m0, 1024
    s_add_u32 s39, s39, 229376
    buffer_load_dwordx4 v2, s[12:15], s39 offen sc1 lds
    s_add_u32 m0, m0, 1024
    s_add_u32 s40, s40, 229376
    buffer_load_dwordx4 v2, s[12:15], s40 offen sc1 lds
    s_add_u32 m0, m0, 1024
    s_add_u32 s39, s39, 229376
    buffer_load_dwordx4 v2, s[12:15], s39 offen sc1 lds
    s_add_u32 m0, m0, 1024
    s_add_u32 s40, s40, 229376
    buffer_load_dwordx4 v2, s[12:15], s40 offen sc1 lds
    s_add_u32 m0, m0, 1024
    s_add_u32 s39, s39, 229376
    buffer_load_dwordx4 v2, s[12:15], s39 offen sc1 lds
    s_add_u32 m0, m0, 1024
    s_add_u32 s40, s40, 229376
    buffer_load_dwordx4 v2, s[12:15], s40 offen sc1 lds
    s_waitcnt vmcnt(8)
    s_barrier
    s_waitcnt vmcnt(0)
    s_barrier
    s_cmp_eq_u32 s60, 1
    s_cbranch_scc1 K_fin
    s_barrier
    s_branch NEXT
WLOAD:
    s_cmp_eq_u32 s60, 1
    s_cbranch_scc1 WL_1
    s_mov_b64 s[12:13], s[68:69]
    s_mov_b32 s14, 2097152
    s_mov_b32 s15, 0x20000
    s_and_b32 s35, s30, 1
    s_mul_i32 s38, s99, 128
    s_mul_i32 s41, s35, 65536
    s_add_u32 s38, s38, s41
    s_mul_i32 s41, s35, 4096
    s_add_u32 s41, s41, 24576
    s_mov_b32 s42, 0
    s_mov_b32 s44, s67
    s_branch WL_2
WL_1:
    s_mov_b64 s[12:13], s[68:69]
    s_mov_b32 s14, 2097152
    s_mov_b32 s15, 0x20000
    s_and_b32 s35, s30, 1
    s_mul_i32 s38, s99, 128
    s_mul_i32 s41, s35, 65536
    s_add_u32 s38, s38, s41
    s_mul_i32 s41, s35, 4096
    s_add_u32 s41, s41, 24576
    s_mov_b32 s42, 0
    s_mov_b32 s44, s67
WL_2:
    s_waitcnt vmcnt(0)
    s_barrier
    s_call_b64 s[76:77], SUB_after_g1
    s_barrier
    s_waitcnt vmcnt(0)
    s_barrier
    s_call_b64 s[76:77], SUB_after_g2
    s_mov_b64 s[12:13], s[72:73]
    s_mov_b32 s14, 7340032
    s_mov_b32 s15, 0x20000
    s_and_b32 s35, s30, 1
    s_mul_i32 s38, s29, 448
    s_mul_i32 s41, s35, 229376
    s_add_u32 s38, s38, s41
    s_mul_i32 s41, s35, 14336
    s_add_u32 s41, s41, 73728
    s_mov_b32 s42, 0
    s_mov_b32 s44, 0
    s_mov_b32 s42, 28672
    s_mov_b32 s44, 2
    s_add_u32 s19, s41, s42
    v_readlane_b32 s16, v248, s44
    s_nop 0
    s_add_u32 s16, s16, s38
    s_add_u32 s44, s44, 1
    s_and_b32 s44, s44, 15
    s_add_u32 s42, s42, 28672
    s_cmp_eq_u32 s42, 86016
    s_cselect_b32 s42, 0, s42
    s_mov_b32 m0, s19
    s_mov_b32 s39, s16
    s_waitcnt vmcnt(14)
    s_barrier
    buffer_load_dwordx4 v241, s[12:15], s39 offen lds
    s_add_u32 m0, m0, 1024
    s_nop 0
    buffer_load_dwordx4 v242, s[12:15], s39 offen lds
    s_add_u32 m0, m0, 1024
    s_nop 0
    buffer_load_dwordx4 v243, s[12:15], s39 offen lds
    s_mov_b32 s43, 1
ld_73:
    s_add_u32 s19, s41, s42
    v_readlane_b32 s16, v248, s44
    s_nop 0
    s_add_u32 s16, s16, s38
    s_add_u32 s44, s44, 1
    s_and_b32 s44, s44, 15
    s_add_u32 s42, s42, 28672
    s_cmp_eq_u32 s42, 86016
    s_cselect_b32 s42, 0, s42
    s_add_u32 m0, m0, 1024
    s_nop 0
    buffer_load_dwordx4 v244, s[12:15], s39 offen lds
    s_add_u32 m0, m0, 1024
    s_nop 0
    buffer_load_dwordx4 v245, s[12:15], s39 offen lds
    s_add_u32 m0, m0, 1024
    s_nop 0
    buffer_load_dwordx4 v246, s[12:15], s39 offen lds
    s_add_u32 m0, m0, 1024
    s_nop 0
    buffer_load_dwordx4 v247, s[12:15], s39 offen lds
    s_add_u32 m0, m0, 1024
    s_add_u32 s39, s39, 114688
    buffer_load_dwordx4 v241, s[12:15], s39 offen lds
    s_add_u32 m0, m0, 1024
    s_nop 0
    buffer_load_dwordx4 v242, s[12:15], s39 offen lds
    s_add_u32 m0, m0, 1024
    s_nop 0
    buffer_load_dwordx4 v243, s[12:15], s39 offen lds
    s_add_u32 m0, m0, 1024
    s_nop 0
    buffer_load_dwordx4 v244, s[12:15], s39 offen lds
    s_add_u32 m0, m0, 1024
    s_nop 0
    buffer_load_dwordx4 v245, s[12:15], s39 offen lds
    s_add_u32 m0, m0, 1024
    s_nop 0
    buffer_load_dwordx4 v246, s[12:15], s39 offen lds
    s_add_u32 m0, m0, 1024
    s_nop 0
    buffer_load_dwordx4 v247, s[12:15], s39 offen lds
    s_mov_b32 m0, s19
    s_mov_b32 s39, s16
    s_waitcnt vmcnt(14)
    s_barrier
    buffer_load_dwordx4 v241, s[12:15], s39 offen lds
    s_add_u32 m0, m0, 1024
    s_nop 0
    buffer_load_dwordx4 v242, s[12:15], s39 offen lds
    s_add_u32 m0, m0, 1024
    s_nop 0
    buffer_load_dwordx4 v243, s[12:15], s39 offen lds
    s_add_u32 s43, s43, 1
    s_cmp_lt_u32 s43, 13
    s_cbranch_scc1 ld_73
    s_add_u32 s19, s41, s42
    v_readlane_b32 s16, v248, s44
    s_nop 0
    s_add_u32 s16, s16, s38
    s_add_u32 s44, s44, 1
    s_and_b32 s44, s44, 15
    s_add_u32 s42, s42, 28672
    s_cmp_eq_u32 s42, 86016
    s_cselect_b32 s42, 0, s42
    s_add_u32 m0, m0, 1024
    s_nop 0
    buffer_load_dwordx4 v244, s[12:15], s39 offen lds
    s_add_u32 m0, m0, 1024
    s_nop 0
    buffer_load_dwordx4 v245, s[12:15], s39 offen lds
    s_add_u32 m0, m0, 1024
    s_nop 0
    buffer_load_dwordx4 v246, s[12:15], s39 offen lds
    s_add_u32 m0, m0, 1024
    s_nop 0
    buffer_load_dwordx4 v247, s[12:15], s39 offen lds
    s_add_u32 m0, m0, 1024
    s_add_u32 s39, s39, 114688
    buffer_load_dwordx4 v241, s[12:15], s39 offen lds
    s_add_u32 m0, m0, 1024
    s_nop 0
    buffer_load_dwordx4 v242, s[12:15], s39 offen lds
    s_add_u32 m0, m0, 1024
    s_nop 0
    buffer_load_dwordx4 v243, s[12:15], s39 offen lds
    s_add_u32 m0, m0, 1024
    s_nop 0
    buffer_load_dwordx4 v244, s[12:15], s39 offen lds
    s_add_u32 m0, m0, 1024
    s_nop 0
    buffer_load_dwordx4 v245, s[12:15], s39 offen lds
    s_add_u32 m0, m0, 1024
    s_nop 0
    buffer_load_dwordx4 v246, s[12:15], s39 offen lds
    s_add_u32 m0, m0, 1024
    s_nop 0
    buffer_load_dwordx4 v247, s[12:15], s39 offen lds
    s_mov_b32 m0, s19
    s_mov_b32 s39, s16
    s_waitcnt vmcnt(14)
    s_barrier
    buffer_load_dwordx4 v241, s[12:15], s39 offen lds
    s_add_u32 m0, m0, 1024
    s_nop 0
    buffer_load_dwordx4 v242, s[12:15], s39 offen lds
    s_add_u32 m0, m0, 1024
    s_nop 0
    buffer_load_dwordx4 v243, s[12:15], s39 offen lds
    s_add_u32 m0, m0, 1024
    s_nop 0
    buffer_load_dwordx4 v244, s[12:15], s39 offen lds
    s_add_u32 m0, m0, 1024
    s_nop 0
    buffer_load_dwordx4 v245, s[12:15], s39 offen lds
    s_add_u32 m0, m0, 1024
    s_nop 0
    buffer_load_dwordx4 v246, s[12:15], s39 offen lds
    s_add_u32 m0, m0, 1024
    s_nop 0
    buffer_load_dwordx4 v247, s[12:15], s39 offen lds
    s_add_u32 m0, m0, 1024
    s_add_u32 s39, s39, 114688
    buffer_load_dwordx4 v241, s[12:15], s39 offen lds
    s_add_u32 m0, m0, 1024
    s_nop 0
    buffer_load_dwordx4 v242, s[12:15], s39 offen lds
    s_add_u32 m0, m0, 1024
    s_nop 0
    buffer_load_dwordx4 v243, s[12:15], s39 offen lds
    s_add_u32 m0, m0, 1024
    s_nop 0
    buffer_load_dwordx4 v244, s[12:15], s39 offen lds
    s_add_u32 m0, m0, 1024
    s_nop 0
    buffer_load_dwordx4 v245, s[12:15], s39 offen lds
    s_add_u32 m0, m0, 1024
    s_nop 0
    buffer_load_dwordx4 v246, s[12:15], s39 offen lds
    s_add_u32 m0, m0, 1024
    s_nop 0
    buffer_load_dwordx4 v247, s[12:15], s39 offen lds
    s_waitcnt vmcnt(14)
    s_barrier
    s_call_b64 s[76:77], SUB_r_pre0
    s_waitcnt vmcnt(4)
    s_barrier
    s_barrier
    s_mov_b64 s[12:13], s[74:75]
    s_mov_b32 s14, 7340032
    s_mov_b32 s15, 0x20000
    s_and_b32 s35, s30, 1
    s_mul_i32 s38, s33, 256
    s_mul_i32 s41, s31, 3670016
    s_add_u32 s38, s38, s41
    s_mul_i32 s41, s35, 8192
    s_add_u32 s41, s41, 49152
    s_mov_b32 s42, 0
    s_mov_b32 s44, 0
    s_mov_b32 s49, s44
    s_and_b32 s43, s28, 3
    s_mul_i32 s43, s43, 6
    s_lshr_b32 s43, s43, 2
    s_mov_b32 s50, 0
wpre_74:
    s_mul_i32 s42, s43, 16384
    s_add_u32 s44, s49, s43
    s_mov_b32 s45, 8192
    s_add_u32 s19, s41, s42
    v_readlane_b32 s16, v249, s44
    s_nop 0
    s_bitcmp1_b32 s16, 0
    s_cselect_b32 s17, 16384, s45
    s_cselect_b32 s18, -40960, s45
    s_andn2_b32 s16, s16, 1
    s_add_u32 s16, s16, s38
    s_add_u32 s44, s44, 1
    s_add_u32 s42, s42, 16384
    s_cmp_eq_u32 s42, 98304
    s_cselect_b32 s42, 0, s42
    s_mov_b32 m0, s19
    s_mov_b32 s39, s16
    s_mov_b32 s32, s17
    s_mov_b32 s3, s18
    buffer_load_dwordx4 v239, s[12:15], s39 offen lds
    s_add_u32 m0, m0, 1024
    s_add_u32 s39, s39, s32
    buffer_load_dwordx4 v240, s[12:15], s39 offen lds
    s_add_u32 m0, m0, 1024
    s_add_u32 s39, s39, s32
    buffer_load_dwordx4 v239, s[12:15], s39 offen lds
    s_add_u32 m0, m0, 1024
    s_add_u32 s39, s39, s32
    buffer_load_dwordx4 v240, s[12:15], s39 offen lds
    s_waitcnt vmcnt(6)
    s_add_u32 m0, m0, 1024
    s_add_u32 s39, s39, s3
    buffer_load_dwordx4 v239, s[12:15], s39 offen lds
    s_add_u32 m0, m0, 1024
    s_add_u32 s39, s39, s32
    buffer_load_dwordx4 v240, s[12:15], s39 offen lds
    s_add_u32 m0, m0, 1024
    s_add_u32 s39, s39, s32
    buffer_load_dwordx4 v239, s[12:15], s39 offen lds
    s_add_u32 m0, m0, 1024
    s_add_u32 s39, s39, s32
    buffer_load_dwordx4 v240, s[12:15], s39 offen lds
    s_waitcnt vmcnt(6)
    s_add_u32 s43, s43, 1
    s_cmp_eq_u32 s43, 6
    s_cselect_b32 s43, 0, s43
    s_add_u32 s50, s50, 1
    s_cmp_lt_u32 s50, 6
    s_cbranch_scc1 wpre_74
    s_mov_b32 s42, 0
    s_add_u32 s44, s49, 6
    s_cmp_eq_u32 s60, 1
    s_cbranch_scc1 WL_t1
    s_call_b64 s[76:77], PREP_w_issue_4
    s_mov_b32 m0, s19
    s_mov_b32 s39, s16
    s_mov_b32 s32, s17
    s_mov_b32 s3, s18
    s_waitcnt vmcnt(0)
    s_barrier
    s_waitcnt vmcnt(0)
    s_barrier
    buffer_load_dwordx4 v239, s[12:15], s39 offen lds
    s_add_u32 m0, m0, 1024
    s_add_u32 s39, s39, s32
    buffer_load_dwordx4 v240, s[12:15], s39 offen lds
    s_call_b64 s[76:77], PREP_w_issue_4
    s_add_u32 m0, m0, 1024
    s_add_u32 s39, s39, s32
    buffer_load_dwordx4 v239, s[12:15], s39 offen lds
    s_add_u32 m0, m0, 1024
    s_add_u32 s39, s39, s32
    buffer_load_dwordx4 v240, s[12:15], s39 offen lds
    s_add_u32 m0, m0, 1024
    s_add_u32 s39, s39, s3
    buffer_load_dwordx4 v239, s[12:15], s39 offen lds
    s_add_u32 m0, m0, 1024
    s_add_u32 s39, s39, s32
    buffer_load_dwordx4 v240, s[12:15], s39 offen lds
    s_add_u32 m0, m0, 1024
    s_add_u32 s39, s39, s32
    buffer_load_dwordx4 v239, s[12:15], s39 offen lds
    s_add_u32 m0, m0, 1024
    s_add_u32 s39, s39, s32
    buffer_load_dwordx4 v240, s[12:15], s39 offen lds
    s_mov_b32 m0, s19
    s_mov_b32 s39, s16
    s_mov_b32 s32, s17
    s_mov_b32 s3, s18
    s_waitcnt vmcnt(8)
    s_barrier
    buffer_load_dwordx4 v239, s[12:15], s39 offen lds
    s_add_u32 m0, m0, 1024
    s_add_u32 s39, s39, s32
    buffer_load_dwordx4 v240, s[12:15], s39 offen lds
    s_call_b64 s[76:77], PREP_w_issue_4
    s_add_u32 m0, m0, 1024
    s_add_u32 s39, s39, s32
    buffer_load_dwordx4 v239, s[12:15], s39 offen lds
    s_add_u32 m0, m0, 1024
    s_add_u32 s39, s39, s32
    buffer_load_dwordx4 v240, s[12:15], s39 offen lds
    s_add_u32 m0, m0, 1024
    s_add_u32 s39, s39, s3
    buffer_load_dwordx4 v239, s[12:15], s39 offen lds
    s_add_u32 m0, m0, 1024
    s_add_u32 s39, s39, s32
    buffer_load_dwordx4 v240, s[12:15], s39 offen lds
    s_add_u32 m0, m0, 1024
    s_add_u32 s39, s39, s32
    buffer_load_dwordx4 v239, s[12:15], s39 offen lds
    s_add_u32 m0, m0, 1024
    s_add_u32 s39, s39, s32
    buffer_load_dwordx4 v240, s[12:15], s39 offen lds
    s_mov_b32 m0, s19
    s_mov_b32 s39, s16
    s_mov_b32 s32, s17
    s_mov_b32 s3, s18
    s_waitcnt vmcnt(16)
    s_barrier
    buffer_load_dwordx4 v239, s[12:15], s39 offen lds
    s_add_u32 m0, m0, 1024
    s_add_u32 s39, s39, s32
    buffer_load_dwordx4 v240, s[12:15], s39 offen lds
    s_call_b64 s[76:77], PREP_w_issue_4
    s_add_u32 m0, m0, 1024
    s_add_u32 s39, s39, s32
    buffer_load_dwordx4 v239, s[12:15], s39 offen lds
    s_add_u32 m0, m0, 1024
    s_add_u32 s39, s39, s32
    buffer_load_dwordx4 v240, s[12:15], s39 offen lds
    s_add_u32 m0, m0, 1024
    s_add_u32 s39, s39, s3
    buffer_load_dwordx4 v239, s[12:15], s39 offen lds
    s_add_u32 m0, m0, 1024
    s_add_u32 s39, s39, s32
    buffer_load_dwordx4 v240, s[12:15], s39 offen lds
    s_add_u32 m0, m0, 1024
    s_add_u32 s39, s39, s32
    buffer_load_dwordx4 v239, s[12:15], s39 offen lds
    s_add_u32 m0, m0, 1024
    s_add_u32 s39, s39, s32
    buffer_load_dwordx4 v240, s[12:15], s39 offen lds
    s_mov_b32 m0, s19
    s_mov_b32 s39, s16
    s_mov_b32 s32, s17
    s_mov_b32 s3, s18
    s_waitcnt vmcnt(24)
    s_barrier
    buffer_load_dwordx4 v239, s[12:15], s39 offen lds
    s_add_u32 m0, m0, 1024
    s_add_u32 s39, s39, s32
    buffer_load_dwordx4 v240, s[12:15], s39 offen lds
    s_mov_b32 s43, 1
ld_75:
    s_mov_b32 s45, 8192
    s_add_u32 s19, s41, s42
    v_readlane_b32 s16, v249, s44
    s_nop 0
    s_bitcmp1_b32 s16, 0
    s_cselect_b32 s17, 16384, s45
    s_cselect_b32 s18, -40960, s45
    s_andn2_b32 s16, s16, 1
    s_add_u32 s16, s16, s38
    s_add_u32 s44, s44, 1
    s_add_u32 s42, s42, 16384
    s_cmp_eq_u32 s42, 98304
    s_cselect_b32 s42, 0, s42
    s_add_u32 m0, m0, 1024
    s_add_u32 s39, s39, s32
    buffer_load_dwordx4 v239, s[12:15], s39 offen lds
    s_add_u32 m0, m0, 1024
    s_add_u32 s39, s39, s32
    buffer_load_dwordx4 v240, s[12:15], s39 offen lds
    s_add_u32 m0, m0, 1024
    s_add_u32 s39, s39, s3
    buffer_load_dwordx4 v239, s[12:15], s39 offen lds
    s_add_u32 m0, m0, 1024
    s_add_u32 s39, s39, s32
    buffer_load_dwordx4 v240, s[12:15], s39 offen lds
    s_add_u32 m0, m0, 1024
    s_add_u32 s39, s39, s32
    buffer_load_dwordx4 v239, s[12:15], s39 offen lds
    s_add_u32 m0, m0, 1024
    s_add_u32 s39, s39, s32
    buffer_load_dwordx4 v240, s[12:15], s39 offen lds
    s_mov_b32 m0, s19
    s_mov_b32 s39, s16
    s_mov_b32 s32, s17
    s_mov_b32 s3, s18
    s_waitcnt vmcnt(32)
    s_barrier
    buffer_load_dwordx4 v239, s[12:15], s39 offen lds
    s_add_u32 m0, m0, 1024
    s_add_u32 s39, s39, s32
    buffer_load_dwordx4 v240, s[12:15], s39 offen lds
    s_add_u32 s43, s43, 1
    s_cmp_lt_u32 s43, 18
    s_cbranch_scc1 ld_75
    s_call_b64 s[76:77], PREP_w_issue_4
    s_add_u32 m0, m0, 1024
    s_add_u32 s39, s39, s32
    buffer_load_dwordx4 v239, s[12:15], s39 offen lds
    s_add_u32 m0, m0, 1024
    s_add_u32 s39, s39, s32
    buffer_load_dwordx4 v240, s[12:15], s39 offen lds
    s_add_u32 m0, m0, 1024
    s_add_u32 s39, s39, s3
    buffer_load_dwordx4 v239, s[12:15], s39 offen lds
    s_add_u32 m0, m0, 1024
    s_add_u32 s39, s39, s32
    buffer_load_dwordx4 v240, s[12:15], s39 offen lds
    s_add_u32 m0, m0, 1024
    s_add_u32 s39, s39, s32
    buffer_load_dwordx4 v239, s[12:15], s39 offen lds
    s_add_u32 m0, m0, 1024
    s_add_u32 s39, s39, s32
    buffer_load_dwordx4 v240, s[12:15], s39 offen lds
    s_mov_b32 m0, s19
    s_mov_b32 s39, s16
    s_mov_b32 s32, s17
    s_mov_b32 s3, s18
    s_waitcnt vmcnt(32)
    s_barrier
    buffer_load_dwordx4 v239, s[12:15], s39 offen lds
    s_add_u32 m0, m0, 1024
    s_add_u32 s39, s39, s32
    buffer_load_dwordx4 v240, s[12:15], s39 offen lds
    s_add_u32 m0, m0, 1024
    s_add_u32 s39, s39, s32
    buffer_load_dwordx4 v239, s[12:15], s39 offen lds
    s_add_u32 m0, m0, 1024
    s_add_u32 s39, s39, s32
    buffer_load_dwordx4 v240, s[12:15], s39 offen lds
    s_add_u32 m0, m0, 1024
    s_add_u32 s39, s39, s3
    buffer_load_dwordx4 v239, s[12:15], s39 offen lds
    s_add_u32 m0, m0, 1024
    s_add_u32 s39, s39, s32
    buffer_load_dwordx4 v240, s[12:15], s39 offen lds
    s_add_u32 m0, m0, 1024
    s_add_u32 s39, s39, s32
    buffer_load_dwordx4 v239, s[12:15], s39 offen lds
    s_add_u32 m0, m0, 1024
    s_add_u32 s39, s39, s32
    buffer_load_dwordx4 v240, s[12:15], s39 offen lds
    s_waitcnt vmcnt(32)
    s_barrier
    s_mov_b64 s[12:13], s[68:69]
    s_mov_b32 s14, 2097152
    s_mov_b32 s15, 0x20000
    s_and_b32 s35, s30, 1
    s_mul_i32 s38, s99, 128
    s_mul_i32 s41, s35, 65536
    s_add_u32 s38, s38, s41
    s_mul_i32 s41, s35, 4096
    s_add_u32 s41, s41, 24576
    s_mov_b32 s42, 0
    s_mov_b32 s44, s67
    s_mov_b32 s42, 90112
    s_mov_b32 s44, s67
    s_add_u32 s44, s44, 11
    s_and_b32 s44, s44, 15
    s_call_b64 s[76:77], SUB_w_issue_1
    s_mov_b32 s42, 98304
    s_mov_b32 s44, s67
    s_add_u32 s44, s44, 12
    s_and_b32 s44, s44, 15
    s_call_b64 s[76:77], SUB_w_issue_1
    s_mov_b32 s42, 122880
    s_mov_b32 s44, s67
    s_add_u32 s44, s44, 15
    s_and_b32 s44, s44, 15
    s_call_b64 s[76:77], SUB_w_issue_1
    s_add_u32 s39, s38, 1179648
    buffer_load_dwordx4 v[16:19], v238, s[12:15], s39 offen
    s_add_u32 s39, s39, 16384
    buffer_load_dwordx4 v[20:23], v238, s[12:15], s39 offen
    s_add_u32 s39, s39, 16384
    buffer_load_dwordx4 v[24:27], v238, s[12:15], s39 offen
    s_add_u32 s39, s39, 16384
    buffer_load_dwordx4 v[28:31], v238, s[12:15], s39 offen
    s_add_u32 s39, s39, 16384
    s_waitcnt vmcnt(40)
    s_barrier
    s_mov_b32 s42, 106496
    s_mov_b32 s44, s67
    s_add_u32 s44, s44, 13
    s_and_b32 s44, s44, 15
    s_call_b64 s[76:77], SUB_w_issue_1
    s_mov_b32 s42, 114688
    s_mov_b32 s44, s67
    s_add_u32 s44, s44, 14
    s_and_b32 s44, s44, 15
    s_call_b64 s[76:77], SUB_w_issue_1
    s_add_u32 s39, s38, 1310720
    buffer_load_dwordx4 v[32:35], v238, s[12:15], s39 offen
    s_add_u32 s39, s39, 16384
    buffer_load_dwordx4 v[36:39], v238, s[12:15], s39 offen
    s_add_u32 s39, s39, 16384
    buffer_load_dwordx4 v[40:43], v238, s[12:15], s39 offen
    s_add_u32 s39, s39, 16384
    buffer_load_dwordx4 v[44:47], v238, s[12:15], s39 offen
    s_add_u32 s39, s39, 16384
    s_waitcnt vmcnt(44)
    s_barrier
    s_mov_b32 s42, 24576
    s_mov_b32 s44, s67
    s_add_u32 s44, s44, 3
    s_and_b32 s44, s44, 15
    s_call_b64 s[76:77], SUB_w_issue_1
    s_mov_b32 s42, 32768
    s_mov_b32 s44, s67
    s_add_u32 s44, s44, 4
    s_and_b32 s44, s44, 15
    s_call_b64 s[76:77], SUB_w_issue_1
    s_waitcnt vmcnt(44)
    s_barrier
    s_mov_b32 s42, 40960
    s_mov_b32 s44, s67
    s_add_u32 s44, s44, 5
    s_and_b32 s44, s44, 15
    s_call_b64 s[76:77], SUB_w_issue_1
    s_mov_b32 s42, 49152
    s_mov_b32 s44, s67
    s_add_u32 s44, s44, 6
    s_and_b32 s44, s44, 15
    s_call_b64 s[76:77], SUB_w_issue_1
    s_mov_b32 s42, 0
    s_mov_b32 s44, s67
    s_add_u32 s44, s44, 0
    s_and_b32 s44, s44, 15
    s_call_b64 s[76:77], SUB_w_issue_1
    s_waitcnt vmcnt(48)
    s_barrier
    s_mov_b32 s42, 57344
    s_mov_b32 s44, s67
    s_add_u32 s44, s44, 7
    s_and_b32 s44, s44, 15
    s_call_b64 s[76:77], SUB_w_issue_1
    s_mov_b32 s42, 65536
    s_mov_b32 s44, s67
    s_add_u32 s44, s44, 8
    s_and_b32 s44, s44, 15
    s_call_b64 s[76:77], SUB_w_issue_1
    s_mov_b32 s42, 8192
    s_mov_b32 s44, s67
    s_add_u32 s44, s44, 1
    s_and_b32 s44, s44, 15
    s_call_b64 s[76:77], SUB_w_issue_1
    s_mov_b32 s42, 16384
    s_mov_b32 s44, s67
    s_add_u32 s44, s44, 2
    s_and_b32 s44, s44, 15
    s_call_b64 s[76:77], SUB_w_issue_1
    s_barrier
    s_add_u32 s36, s41, 73728
    v_add_u32 v6, s36, v2
    s_waitcnt vmcnt(0)
    ds_write_b128 v6, v[16:19] offset:0
    ds_write_b128 v6, v[20:23] offset:1024
    ds_write_b128 v6, v[24:27] offset:2048
    ds_write_b128 v6, v[28:31] offset:3072
    ds_write_b128 v6, v[32:35] offset:8192
    ds_write_b128 v6, v[36:39] offset:9216
    ds_write_b128 v6, v[40:43] offset:10240
    ds_write_b128 v6, v[44:47] offset:11264
    s_waitcnt lgkmcnt(0)
    s_branch NEXT
WL_t1:
    s_call_b64 s[76:77], PREP_w_issue_4
    s_mov_b32 m0, s19
    s_mov_b32 s39, s16
    s_mov_b32 s32, s17
    s_mov_b32 s3, s18
    s_waitcnt vmcnt(0)
    s_barrier
    s_waitcnt vmcnt(0)
    s_barrier
    s_waitcnt vmcnt(0)
    s_barrier
    s_waitcnt vmcnt(0)
    s_barrier
    s_waitcnt vmcnt(0)
    s_barrier
    buffer_load_dwordx4 v239, s[12:15], s39 offen lds
    s_add_u32 m0, m0, 1024
    s_add_u32 s39, s39, s32
    buffer_load_dwordx4 v240, s[12:15], s39 offen lds
    s_mov_b32 s43, 1
ld_76:
    s_mov_b32 s45, 8192
    s_add_u32 s19, s41, s42
    v_readlane_b32 s16, v249, s44
    s_nop 0
    s_bitcmp1_b32 s16, 0
    s_cselect_b32 s17, 16384, s45
    s_cselect_b32 s18, -40960, s45
    s_andn2_b32 s16, s16, 1
    s_add_u32 s16, s16, s38
    s_add_u32 s44, s44, 1
    s_add_u32 s42, s42, 16384
    s_cmp_eq_u32 s42, 98304
    s_cselect_b32 s42, 0, s42
    s_add_u32 m0, m0, 1024
    s_add_u32 s39, s39, s32
    buffer_load_dwordx4 v239, s[12:15], s39 offen lds
    s_add_u32 m0, m0, 1024
    s_add_u32 s39, s39, s32
    buffer_load_dwordx4 v240, s[12:15], s39 offen lds
    s_add_u32 m0, m0, 1024
    s_add_u32 s39, s39, s3
    buffer_load_dwordx4 v239, s[12:15], s39 offen lds
    s_add_u32 m0, m0, 1024
    s_add_u32 s39, s39, s32
    buffer_load_dwordx4 v240, s[12:15], s39 offen lds
    s_add_u32 m0, m0, 1024
    s_add_u32 s39, s39, s32
    buffer_load_dwordx4 v239, s[12:15], s39 offen lds
    s_add_u32 m0, m0, 1024
    s_add_u32 s39, s39, s32
    buffer_load_dwordx4 v240, s[12:15], s39 offen lds
    s_mov_b32 m0, s19
    s_mov_b32 s39, s16
    s_mov_b32 s32, s17
    s_mov_b32 s3, s18
    s_waitcnt vmcnt(8)
    s_barrier
    buffer_load_dwordx4 v239, s[12:15], s39 offen lds
    s_add_u32 m0, m0, 1024
    s_add_u32 s39, s39, s32
    buffer_load_dwordx4 v240, s[12:15], s39 offen lds
    s_add_u32 s43, s43, 1
    s_cmp_lt_u32 s43, 21
    s_cbranch_scc1 ld_76
    s_call_b64 s[76:77], PREP_w_issue_4
    s_add_u32 m0, m0, 1024
    s_add_u32 s39, s39, s32
    buffer_load_dwordx4 v239, s[12:15], s39 offen lds
    s_add_u32 m0, m0, 1024
    s_add_u32 s39, s39, s32
    buffer_load_dwordx4 v240, s[12:15], s39 offen lds
    s_add_u32 m0, m0, 1024
    s_add_u32 s39, s39, s3
    buffer_load_dwordx4 v239, s[12:15], s39 offen lds
    s_add_u32 m0, m0, 1024
    s_add_u32 s39, s39, s32
    buffer_load_dwordx4 v240, s[12:15], s39 offen lds
    s_add_u32 m0, m0, 1024
    s_add_u32 s39, s39, s32
    buffer_load_dwordx4 v239, s[12:15], s39 offen lds
    s_add_u32 m0, m0, 1024
    s_add_u32 s39, s39, s32
    buffer_load_dwordx4 v240, s[12:15], s39 offen lds
    s_mov_b32 m0, s19
    s_mov_b32 s39, s16
    s_mov_b32 s32, s17
    s_mov_b32 s3, s18
    s_waitcnt vmcnt(8)
    s_barrier
    buffer_load_dwordx4 v239, s[12:15], s39 offen lds
    s_add_u32 m0, m0, 1024
    s_add_u32 s39, s39, s32
    buffer_load_dwordx4 v240, s[12:15], s39 offen lds
    s_add_u32 m0, m0, 1024
    s_add_u32 s39, s39, s32
    buffer_load_dwordx4 v239, s[12:15], s39 offen lds
    s_add_u32 m0, m0, 1024
    s_add_u32 s39, s39, s32
    buffer_load_dwordx4 v240, s[12:15], s39 offen lds
    s_add_u32 m0, m0, 1024
    s_add_u32 s39, s39, s3
    buffer_load_dwordx4 v239, s[12:15], s39 offen lds
    s_add_u32 m0, m0, 1024
    s_add_u32 s39, s39, s32
    buffer_load_dwordx4 v240, s[12:15], s39 offen lds
    s_add_u32 m0, m0, 1024
    s_add_u32 s39, s39, s32
    buffer_load_dwordx4 v239, s[12:15], s39 offen lds
    s_add_u32 m0, m0, 1024
    s_add_u32 s39, s39, s32
    buffer_load_dwordx4 v240, s[12:15], s39 offen lds
    s_waitcnt vmcnt(8)
    s_barrier
    s_waitcnt vmcnt(0)
    s_barrier
    s_branch K_fin
NEXT:
    s_setprio 0
    s_add_u32 s60, s60, 1
    s_add_u32 s55, s55, 4194304
    s_add_u32 s62, s62, 4194304
    s_addc_u32 s63, s63, 0
    s_branch LAYER
K_fin:
    s_endpgm
SUB_w1_regs:
    s_mov_b64 s[12:13], s[68:69]
    s_mov_b32 s14, 2097152
    s_mov_b32 s15, 0x20000
    s_and_b32 s35, s30, 3
    s_mul_i32 s35, s35, 294912
    s_lshl_b32 s39, s99, 7
    s_add_u32 s39, s39, s35
    buffer_load_dwordx4 v[176:179], v238, s[12:15], s39 offen
    s_add_u32 s39, s39, 16384
    buffer_load_dwordx4 v[188:191], v238, s[12:15], s39 offen
    s_add_u32 s39, s39, 16384
    buffer_load_dwordx4 v[192:195], v238, s[12:15], s39 offen
    s_add_u32 s39, s39, 16384
    buffer_load_dwordx4 v[200:203], v238, s[12:15], s39 offen
    s_add_u32 s39, s39, 16384
    s_waitcnt vmcnt(8)
    buffer_load_dwordx4 v[204:207], v238, s[12:15], s39 offen
    s_add_u32 s39, s39, 16384
    buffer_load_dwordx4 v[208:211], v238, s[12:15], s39 offen
    s_add_u32 s39, s39, 16384
    buffer_load_dwordx4 v[212:215], v238, s[12:15], s39 offen
    s_add_u32 s39, s39, 16384
    buffer_load_dwordx4 v[216:219], v238, s[12:15], s39 offen
    s_add_u32 s39, s39, 16384
    s_waitcnt vmcnt(8)
    buffer_load_dwordx4 v[220:223], v238, s[12:15], s39 offen
    s_add_u32 s39, s39, 16384
    buffer_load_dwordx4 v[224:227], v238, s[12:15], s39 offen
    s_add_u32 s39, s39, 16384
    buffer_load_dwordx4 v[16:19], v238, s[12:15], s39 offen
    s_add_u32 s39, s39, 16384
    buffer_load_dwordx4 v[20:23], v238, s[12:15], s39 offen
    s_add_u32 s39, s39, 16384
    s_waitcnt vmcnt(8)
    buffer_load_dwordx4 v[24:27], v238, s[12:15], s39 offen
    s_add_u32 s39, s39, 16384
    buffer_load_dwordx4 v[28:31], v238, s[12:15], s39 offen
    s_add_u32 s39, s39, 16384
    buffer_load_dwordx4 v[32:35], v238, s[12:15], s39 offen
    s_add_u32 s39, s39, 16384
    buffer_load_dwordx4 v[36:39], v238, s[12:15], s39 offen
    s_add_u32 s39, s39, 16384
    s_waitcnt vmcnt(8)
    buffer_load_dwordx4 v[40:43], v238, s[12:15], s39 offen
    s_add_u32 s39, s39, 16384
    buffer_load_dwordx4 v[44:47], v238, s[12:15], s39 offen
    s_add_u32 s39, s39, 16384
    s_setpc_b64 s[76:77]
SUB_park:
    s_mov_b64 s[12:13], s[70:71]
    s_mov_b32 s14, 2097152
    s_mov_b32 s15, 0x20000
    s_and_b32 s35, s30, 3
    s_lshl_b32 s35, s35, 19
    s_lshl_b32 s39, s29, 7
    s_add_u32 s39, s39, s35
    buffer_load_dwordx4 v[48:51], v238, s[12:15], s39 offen
    s_add_u32 s39, s39, 16384
    buffer_load_dwordx4 v[52:55], v238, s[12:15], s39 offen
    s_add_u32 s39, s39, 16384
    buffer_load_dwordx4 v[56:59], v238, s[12:15], s39 offen
    s_add_u32 s39, s39, 16384
    buffer_load_dwordx4 v[60:63], v238, s[12:15], s39 offen
    s_add_u32 s39, s39, 16384
    s_waitcnt vmcnt(8)
    buffer_load_dwordx4 v[64:67], v238, s[12:15], s39 offen
    s_add_u32 s39, s39, 16384
    buffer_load_dwordx4 v[68:71], v238, s[12:15], s39 offen
    s_add_u32 s39, s39, 16384
    buffer_load_dwordx4 v[72:75], v238, s[12:15], s39 offen
    s_add_u32 s39, s39, 16384
    buffer_load_dwordx4 v[76:79], v238, s[12:15], s39 offen
    s_add_u32 s39, s39, 16384
    s_waitcnt vmcnt(8)
    buffer_load_dwordx4 v[80:83], v238, s[12:15], s39 offen
    s_add_u32 s39, s39, 16384
    buffer_load_dwordx4 v[84:87], v238, s[12:15], s39 offen
    s_add_u32 s39, s39, 16384
    buffer_load_dwordx4 v[88:91], v238, s[12:15], s39 offen
    s_add_u32 s39, s39, 16384
    buffer_load_dwordx4 v[92:95], v238, s[12:15], s39 offen
    s_add_u32 s39, s39, 16384
    s_waitcnt vmcnt(8)
    buffer_load_dwordx4 v[96:99], v238, s[12:15], s39 offen
    s_add_u32 s39, s39, 16384
    buffer_load_dwordx4 v[100:103], v238, s[12:15], s39 offen
    s_add_u32 s39, s39, 16384
    buffer_load_dwordx4 v[104:107], v238, s[12:15], s39 offen
    s_add_u32 s39, s39, 16384
    buffer_load_dwordx4 v[108:111], v238, s[12:15], s39 offen
    s_add_u32 s39, s39, 16384
    s_waitcnt vmcnt(8)
    buffer_load_dwordx4 v[112:115], v238, s[12:15], s39 offen
    s_add_u32 s39, s39, 16384
    buffer_load_dwordx4 v[116:119], v238, s[12:15], s39 offen
    s_add_u32 s39, s39, 16384
    buffer_load_dwordx4 v[120:123], v238, s[12:15], s39 offen
    s_add_u32 s39, s39, 16384
    buffer_load_dwordx4 v[124:127], v238, s[12:15], s39 offen
    s_add_u32 s39, s39, 16384
    s_waitcnt vmcnt(8)
    buffer_load_dwordx4 v[128:131], v238, s[12:15], s39 offen
    s_add_u32 s39, s39, 16384
    buffer_load_dwordx4 v[132:135], v238, s[12:15], s39 offen
    s_add_u32 s39, s39, 16384
    buffer_load_dwordx4 v[136:139], v238, s[12:15], s39 offen
    s_add_u32 s39, s39, 16384
    buffer_load_dwordx4 v[140:143], v238, s[12:15], s39 offen
    s_add_u32 s39, s39, 16384
    s_waitcnt vmcnt(8)
    buffer_load_dwordx4 v[144:147], v238, s[12:15], s39 offen
    s_add_u32 s39, s39, 16384
    buffer_load_dwordx4 v[148:151], v238, s[12:15], s39 offen
    s_add_u32 s39, s39, 16384
    buffer_load_dwordx4 v[152:155], v238, s[12:15], s39 offen
    s_add_u32 s39, s39, 16384
    buffer_load_dwordx4 v[156:159], v238, s[12:15], s39 offen
    s_add_u32 s39, s39, 16384
    s_waitcnt vmcnt(8)
    buffer_load_dwordx4 v[160:163], v238, s[12:15], s39 offen
    s_add_u32 s39, s39, 16384
    buffer_load_dwordx4 v[164:167], v238, s[12:15], s39 offen
    s_add_u32 s39, s39, 16384
    buffer_load_dwordx4 v[168:171], v238, s[12:15], s39 offen
    s_add_u32 s39, s39, 16384
    buffer_load_dwordx4 v[172:175], v238, s[12:15], s39 offen
    s_add_u32 s39, s39, 16384
    s_waitcnt vmcnt(8)
    s_setpc_b64 s[76:77]
SUB_w1_put:
    s_and_b32 s35, s30, 3
    s_mul_i32 s35, s35, 18432
    v_add_u32 v8, s35, v2
    v_mov_b32 v6, 162836
spin_77:
    s_sleep 2
    ds_read_b32 v7, v6
    s_waitcnt lgkmcnt(0)
    v_readfirstlane_b32 s53, v7
    s_nop 0
    s_cmp_ge_u32 s53, 8
    s_cbranch_scc0 spin_77
    s_waitcnt vmcnt(0)
    ds_write_b128 v8, v[176:179] offset:24576
    ds_write_b128 v8, v[188:191] offset:25600
    ds_write_b128 v8, v[192:195] offset:26624
    ds_write_b128 v8, v[200:203] offset:27648
    ds_write_b128 v8, v[204:207] offset:28672
    ds_write_b128 v8, v[208:211] offset:29696
    ds_write_b128 v8, v[212:215] offset:30720
    ds_write_b128 v8, v[216:219] offset:31744
    ds_write_b128 v8, v[220:223] offset:32768
    ds_write_b128 v8, v[224:227] offset:33792
    ds_write_b128 v8, v[16:19] offset:34816
    ds_write_b128 v8, v[20:23] offset:35840
    ds_write_b128 v8, v[24:27] offset:36864
    ds_write_b128 v8, v[28:31] offset:37888
    ds_write_b128 v8, v[32:35] offset:38912
    ds_write_b128 v8, v[36:39] offset:39936
    ds_write_b128 v8, v[40:43] offset:40960
    ds_write_b128 v8, v[44:47] offset:41984
    s_waitcnt lgkmcnt(0)
    s_setpc_b64 s[76:77]
SUB_after_g1:
    s_mov_b64 s[12:13], s[72:73]
    s_mov_b32 s14, 7340032
    s_mov_b32 s15, 0x20000
    v_readlane_b32 s36, v251, 0
    v_readlane_b32 s37, v251, 1
    s_and_b32 s35, s30, 3
    s_mul_i32 s38, s35, 114688
    s_mul_i32 s39, s29, 448
    s_add_u32 s38, s38, s39
    s_and_b32 s36, s36, 15
    s_mul_i32 s36, s36, 458752
    s_add_u32 s36, s36, s38
    s_and_b32 s37, s37, 15
    s_mul_i32 s37, s37, 458752
    s_add_u32 s37, s37, s38
    s_mul_i32 s39, s35, 7168
    s_add_u32 m0, s39, 131072
    s_nop 0
    buffer_load_dwordx4 v241, s[12:15], s36 offen lds
    s_add_u32 m0, m0, 1024
    s_nop 0
    buffer_load_dwordx4 v242, s[12:15], s36 offen lds
    s_add_u32 m0, m0, 1024
    s_nop 0
    buffer_load_dwordx4 v243, s[12:15], s36 offen lds
    s_add_u32 m0, m0, 1024
    s_nop 0
    buffer_load_dwordx4 v244, s[12:15], s36 offen lds
    s_add_u32 m0, m0, 1024
    s_nop 0
    buffer_load_dwordx4 v245, s[12:15], s36 offen lds
    s_add_u32 m0, m0, 1024
    s_nop 0
    buffer_load_dwordx4 v246, s[12:15], s36 offen lds
    s_add_u32 m0, m0, 1024
    s_nop 0
    buffer_load_dwordx4 v247, s[12:15], s36 offen lds
    buffer_load_dwordx4 v[176:179], v241, s[12:15], s37 offen
    buffer_load_dwordx4 v[180:183], v242, s[12:15], s37 offen
    buffer_load_dwordx4 v[184:187], v243, s[12:15], s37 offen
    buffer_load_dwordx4 v[188:191], v244, s[12:15], s37 offen
    buffer_load_dwordx4 v[192:195], v245, s[12:15], s37 offen
    buffer_load_dwordx4 v[196:199], v246, s[12:15], s37 offen
    buffer_load_dwordx4 v[200:203], v247, s[12:15], s37 offen
    s_lshr_b32 s36, s67, 2
    s_sub_u32 s36, s35, s36
    s_and_b32 s36, s36, 3
    s_lshl_b32 s36, s36, 15
    v_add_u32 v6, s36, v2
    s_waitcnt vmcnt(14)
    ds_write_b128 v6, v[48:51] offset:0
    ds_write_b128 v6, v[52:55] offset:1024
    ds_write_b128 v6, v[56:59] offset:2048
    ds_write_b128 v6, v[60:63] offset:3072
    ds_write_b128 v6, v[64:67] offset:4096
    ds_write_b128 v6, v[68:71] offset:5120
    ds_write_b128 v6, v[72:75] offset:6144
    ds_write_b128 v6, v[76:79] offset:7168
    ds_write_b128 v6, v[80:83] offset:8192
    ds_write_b128 v6, v[84:87] offset:9216
    ds_write_b128 v6, v[88:91] offset:10240
    ds_write_b128 v6, v[92:95] offset:11264
    ds_write_b128 v6, v[96:99] offset:12288
    ds_write_b128 v6, v[100:103] offset:13312
    ds_write_b128 v6, v[104:107] offset:14336
    ds_write_b128 v6, v[108:111] offset:15360
    ds_write_b128 v6, v[112:115] offset:16384
    ds_write_b128 v6, v[116:119] offset:17408
    ds_write_b128 v6, v[120:123] offset:18432
    ds_write_b128 v6, v[124:127] offset:19456
    ds_write_b128 v6, v[128:131] offset:20480
    ds_write_b128 v6, v[132:135] offset:21504
    ds_write_b128 v6, v[136:139] offset:22528
    ds_write_b128 v6, v[140:143] offset:23552
    ds_write_b128 v6, v[144:147] offset:24576
    ds_write_b128 v6, v[148:151] offset:25600
    ds_write_b128 v6, v[152:155] offset:26624
    ds_write_b128 v6, v[156:159] offset:27648
    ds_write_b128 v6, v[160:163] offset:28672
    ds_write_b128 v6, v[164:167] offset:29696
    ds_write_b128 v6, v[168:171] offset:30720
    ds_write_b128 v6, v[172:175] offset:31744
    s_waitcnt lgkmcnt(0)
    s_setpc_b64 s[76:77]
SUB_after_g2:
    s_and_b32 s35, s30, 3
    s_mul_i32 s39, s35, 7168
    s_add_u32 s39, s39, 73728
    v_add_u32 v6, s39, v2
    ds_write_b128 v6, v[176:179] offset:0
    ds_write_b128 v6, v[180:183] offset:1024
    ds_write_b128 v6, v[184:187] offset:2048
    ds_write_b128 v6, v[188:191] offset:3072
    ds_write_b128 v6, v[192:195] offset:4096
    ds_write_b128 v6, v[196:199] offset:5120
    ds_write_b128 v6, v[200:203] offset:6144
    s_waitcnt lgkmcnt(0)
    s_setpc_b64 s[76:77]
SUB_r_pre0:
    s_waitcnt lgkmcnt(0)
    v_and_b32 v199, 7, v0
    v_lshrrev_b32 v228, 6, v0
    v_lshlrev_b32 v228, 4, v228
    v_bfe_u32 v229, v0, 3, 3
    v_add_u32 v228, v228, v229
    s_lshr_b32 s78, s29, 1
    s_lshl_b32 s78, s78, 16
    s_and_b32 s79, s29, 1
    s_lshl_b32 s79, s79, 7
    s_add_u32 s78, s78, s79
    s_lshr_b32 s79, s30, 1
    s_lshl_b32 s79, s79, 13
    s_add_u32 s78, s78, s79
    v_lshlrev_b32 v196, 8, v228
    v_lshl_add_u32 v196, v199, 4, v196
    v_add_u32 v196, s78, v196
    s_mov_b32 s84, s62
    s_mov_b32 s85, s63
    s_mov_b32 s86, 0x7e000
    s_mov_b32 s87, 0x20000
    s_add_u32 s88, s62, 0x80000
    s_addc_u32 s89, s63, 0
    s_mov_b32 s90, 0x7e000
    s_mov_b32 s91, 0x20000
    s_cmp_eq_u32 s60, 0
    s_cselect_b32 s86, s86, 0
    s_cselect_b32 s90, s90, 0
    buffer_load_dwordx4 v[180:183], v196, s[84:87], 0 offen offset:0 sc1
    buffer_load_dwordx4 v[188:191], v196, s[88:91], 0 offen offset:0 sc1
    buffer_load_dwordx4 v[184:187], v196, s[84:87], 0 offen offset:2048 sc1
    buffer_load_dwordx4 v[192:195], v196, s[88:91], 0 offen offset:2048 sc1
    s_setpc_b64 s[76:77]
SUB_w_issue_1:
    s_add_u32 s19, s41, s42
    s_mul_i32 s16, s44, 131072
    s_add_u32 s16, s16, s38
    s_add_u32 s44, s44, 1
    s_and_b32 s44, s44, 15
    s_add_u32 s42, s42, 8192
    s_cmp_eq_u32 s42, 131072
    s_cselect_b32 s42, 0, s42
    s_mov_b32 m0, s19
    s_mov_b32 s39, s16
    buffer_load_dwordx4 v238, s[12:15], s39 offen lds
    s_add_u32 m0, m0, 1024
    s_add_u32 s39, s39, 16384
    buffer_load_dwordx4 v238, s[12:15], s39 offen lds
    s_add_u32 m0, m0, 1024
    s_add_u32 s39, s39, 16384
    buffer_load_dwordx4 v238, s[12:15], s39 offen lds
    s_add_u32 m0, m0, 1024
    s_add_u32 s39, s39, 16384
    buffer_load_dwordx4 v238, s[12:15], s39 offen lds
    s_setpc_b64 s[76:77]
PREP_a_issue_4:
    s_add_u32 s19, s41, s42
    v_readlane_b32 s16, v249, s44
    v_readlane_b32 s17, v250, s44
    s_add_u32 s16, s16, s38
    s_add_u32 s17, s17, s38
    s_add_u32 s44, s44, 1
    s_add_u32 s42, s42, 16384
    s_cmp_eq_u32 s42, 49152
    s_cselect_b32 s42, 0, s42
    s_setpc_b64 s[76:77]
PREP_w_issue_4:
    s_mov_b32 s45, 8192
    s_add_u32 s19, s41, s42
    v_readlane_b32 s16, v249, s44
    s_nop 0
    s_bitcmp1_b32 s16, 0
    s_cselect_b32 s17, 16384, s45
    s_cselect_b32 s18, -40960, s45
    s_andn2_b32 s16, s16, 1
    s_add_u32 s16, s16, s38
    s_add_u32 s44, s44, 1
    s_add_u32 s42, s42, 16384
    s_cmp_eq_u32 s42, 98304
    s_cselect_b32 s42, 0, s42
    s_setpc_b64 s[76:77]
K_end:
    s_endpgm
.p2align 6
K_tab:
.short 4096,5137,6178,11379,18660,25941,40502,33223,47784,55065,19706,12427,26988,34269,48830,41551,56096,9264,20736,10448,23824,25008,38384,35296,39568,49856,54128,52944,0,0,0,0
.short 4096,5137,6178,18659,11380,25941,33222,47783,40504,55065,12426,26987,19708,34269,41550,56111,48816,9264,10448,23824,20736,25008,35296,39568,38384,49856,52944,54128,0,0,0,0
.short 4096,5137,6178,11379,25940,18661,33222,40503,55064,47785,12426,19707,34268,26989,41550,48831,9264,56096,10448,20736,25008,23824,35296,38384,49856,39568,52944,54128,0,0,0,0
.short 4096,5137,6178,11379,18660,33221,25942,40503,47784,12425,55066,19707,26988,41549,34270,48831,56096,10448,9264,20736,23824,35296,25008,38384,39568,52944,49856,54128,0,0,0,0
.short 11377,12418,13459,18660,4101,25942,33223,47784,40505,55066,5147,26988,19709,34270,41551,56096,48816,6176,10288,23824,20736,25008,35296,39568,38384,49856,52944,54128,0,0,0,0
.short 11377,12418,13459,4100,25941,18662,33223,40504,55065,47786,5147,19708,34269,26990,41551,48816,6176,56096,10288,20736,25008,23824,35296,38384,49856,39568,52944,54128,0,0,0,0
.short 11377,12418,13459,4100,18661,33222,25943,40504,47785,5146,55067,19708,26989,41550,34271,48816,56096,10288,6176,20736,23824,35296,25008,38384,39568,52944,49856,54128,0,0,0,0
.short 11377,12418,13459,4100,18661,25942,40503,33224,47785,55066,19707,5148,26989,34270,48831,41536,56096,6176,20736,10288,23824,25008,38384,35296,39568,49856,54128,52944,0,0,0,0
.short 18658,19699,20740,4101,25942,11383,33224,40505,55066,47787,5148,12429,34270,26991,41536,48817,6176,56096,9264,10448,25008,23824,35296,38384,49856,39568,52944,54128,0,0,0,0
.short 18658,19699,20740,4101,11382,33223,25944,40505,47786,5147,55068,12429,26990,41551,34256,48817,56096,9264,6176,10448,23824,35296,25008,38384,39568,52944,49856,54128,0,0,0,0
.short 18658,19699,20740,4101,11382,25943,40504,33225,47786,55067,12428,5149,26990,34271,48816,41537,56096,6176,10448,9264,23824,25008,38384,35296,39568,49856,54128,52944,0,0,0,0
.short 18658,19699,20740,11381,4102,25943,33224,47785,40506,55067,5148,26989,12430,34271,41536,56097,48816,6176,9264,23824,10448,25008,35296,39568,38384,49856,52944,54128,0,0,0,0
.short 25939,26980,28021,4102,11383,33224,18665,40506,47787,5148,55069,12430,19711,41536,34257,48818,56096,9264,6176,10448,20736,35296,24848,38384,39568,52944,49856,54128,0,0,0,0
.short 25939,26980,28021,4102,11383,18664,40505,33226,47787,55068,12429,5150,19711,34256,48817,41538,56096,6176,10448,9264,20736,24848,38384,35296,39568,49856,54128,52944,0,0,0,0
.short 25939,26980,28021,11382,4103,18664,33225,47786,40507,55068,5149,19710,12431,34256,41537,56098,48816,6176,9264,20736,10448,24848,35296,39568,38384,49856,52944,54128,0,0,0,0
.short 25939,26980,28021,4102,18663,11384,33225,40506,55067,47788,5149,12430,34271,19696,41537,48818,6176,56096,9264,10448,24848,20736,35296,38384,49856,39568,52944,54128,0,0,0,0
.short 33220,34261,35302,4103,11384,18665,40506,25947,47788,55069,12430,5151,19696,26977,48818,41539,56096,6176,10448,9264,20736,23824,38384,25008,39568,49856,54128,52944,0,0,0,0
.short 33220,34261,35302,11383,4104,18665,25946,47787,40508,55069,5150,19711,12416,26977,41538,56099,48816,6176,9264,20736,10448,23824,25008,39568,38384,49856,52944,54128,0,0,0,0
.short 33220,34261,35302,4103,18664,11385,25946,40507,55068,47789,5150,12431,26976,19697,41538,48819,6176,56096,9264,10448,23824,20736,25008,38384,49856,39568,52944,54128,0,0,0,0
.short 33220,34261,35302,4103,11384,25945,18666,40507,47788,5149,55070,12431,19696,41537,26978,48819,56096,9264,6176,10448,20736,25008,23824,38384,39568,52944,49856,54128,0,0,0,0
.short 40501,41542,42583,11384,4105,18666,25947,47788,33229,55070,5151,19696,12417,26978,34259,56100,48816,6176,9264,20736,10448,23824,25008,39408,35296,49856,52944,54128,0,0,0,0
.short 40501,41542,42583,4104,18665,11386,25947,33228,55069,47790,5151,12416,26977,19698,34259,48820,6176,56096,9264,10448,23824,20736,25008,35296,49856,39408,52944,54128,0,0,0,0
.short 40501,41542,42583,4104,11385,25946,18667,33228,47789,5150,55071,12416,19697,34258,26979,48820,56096,9264,6176,10448,20736,25008,23824,35296,39408,52944,49856,54128,0,0,0,0
.short 40501,41542,42583,4104,11385,18666,33227,25948,47789,55070,12431,5136,19697,26978,48819,34260,56096,6176,10448,9264,20736,23824,35296,25008,39408,49856,54128,52944,0,0,0,0
.short 47782,48823,49864,4105,18666,11387,25948,33229,55070,40511,5136,12417,26978,19699,34260,41541,6176,56096,9264,10448,23824,20736,25008,35296,39568,38384,52944,54128,0,0,0,0
.short 47782,48823,49864,4105,11386,25947,18668,33229,40510,5151,55056,12417,19698,34259,26980,41541,56096,9264,6176,10448,20736,25008,23824,35296,38384,52944,39568,54128,0,0,0,0
.short 47782,48823,49864,4105,11386,18667,33228,25949,40510,55071,12416,5137,19698,26979,41540,34261,56096,6176,10448,9264,20736,23824,35296,25008,38384,39568,54128,52944,0,0,0,0
.short 47782,48823,49864,11385,4106,18667,25948,40509,33230,55071,5136,19697,12418,26979,34260,56101,41536,6176,9264,20736,10448,23824,25008,38384,35296,39568,52944,54128,0,0,0,0
.short 55063,56104,57145,4106,11387,25948,18669,33230,40511,5136,47777,12418,19699,34260,26981,41542,48816,9264,6176,10448,20736,25008,23824,35296,38384,49856,39568,53968,0,0,0,0
.short 55063,56104,57145,4106,11387,18668,33229,25950,40511,47776,12417,5138,19699,26980,41541,34262,48816,6176,10448,9264,20736,23824,35296,25008,38384,39568,53968,49856,0,0,0,0
.short 55063,56104,57145,11386,4107,18668,25949,40510,33231,47776,5137,19698,12419,26980,34261,48822,41536,6176,9264,20736,10448,23824,25008,38384,35296,39568,49856,53968,0,0,0,0
.short 55063,56104,57145,4106,18667,11388,25949,33230,47791,40496,5137,12418,26979,19700,34261,41542,6176,48816,9264,10448,23824,20736,25008,35296,39568,38384,49856,53968,0,0,0,0
.short 4104,5145,6186,11387,18668,25949,40510,33231,47776,55057,19698,12419,26980,34261,48822,41543,56096,9264,20736,10448,23824,25008,38384,35296,39568,49856,54128,52944,0,0,0,0
.short 4104,5145,6186,18667,11388,25949,33230,47791,40496,55057,12418,26979,19700,34261,41542,56103,48816,9264,10448,23824,20736,25008,35296,39568,38384,49856,52944,54128,0,0,0,0
.short 4104,5145,6186,11387,25948,18669,33230,40511,55056,47777,12418,19699,34260,26981,41542,48823,9264,56096,10448,20736,25008,23824,35296,38384,49856,39568,52944,54128,0,0,0,0
.short 4104,5145,6186,11387,18668,33229,25950,40511,47776,12417,55058,19699,26980,41541,34262,48823,56096,10448,9264,20736,23824,35296,25008,38384,39568,52944,49856,54128,0,0,0,0
.short 11385,12426,13467,18668,4109,25950,33231,47776,40497,55058,5139,26980,19701,34262,41543,56104,48816,6176,10288,23824,20736,25008,35296,39568,38384,49856,52944,54128,0,0,0,0
.short 11385,12426,13467,4108,25949,18670,33231,40496,55057,47778,5139,19700,34261,26982,41543,48824,6176,56096,10288,20736,25008,23824,35296,38384,49856,39568,52944,54128,0,0,0,0
.short 11385,12426,13467,4108,18669,33230,25951,40496,47777,5138,55059,19700,26981,41542,34263,48824,56096,10288,6176,20736,23824,35296,25008,38384,39568,52944,49856,54128,0,0,0,0
.short 11385,12426,13467,4108,18669,25950,40511,33216,47777,55058,19699,5140,26981,34262,48823,41544,56096,6176,20736,10288,23824,25008,38384,35296,39568,49856,54128,52944,0,0,0,0
.short 18666,19707,20748,4109,25950,11391,33216,40497,55058,47779,5140,12421,34262,26983,41544,48825,6176,56096,9264,10448,25008,23824,35296,38384,49856,39568,52944,54128,0,0,0,0
.short 18666,19707,20748,4109,11390,33231,25936,40497,47778,5139,55060,12421,26982,41543,34264,48825,56096,9264,6176,10448,23824,35296,25008,38384,39568,52944,49856,54128,0,0,0,0
.short 18666,19707,20748,4109,11390,25951,40496,33217,47778,55059,12420,5141,26982,34263,48824,41545,56096,6176,10448,9264,23824,25008,38384,35296,39568,49856,54128,52944,0,0,0,0
.short 18666,19707,20748,11389,4110,25951,33216,47777,40498,55059,5140,26981,12422,34263,41544,56105,48816,6176,9264,23824,10448,25008,35296,39568,38384,49856,52944,54128,0,0,0,0
.short 25947,26988,28029,4110,11391,33216,18657,40498,47779,5140,55061,12422,19703,41544,34265,48826,56096,9264,6176,10448,20736,35296,24848,38384,39568,52944,49856,54128,0,0,0,0
.short 25947,26988,28029,4110,11391,18656,40497,33218,47779,55060,12421,5142,19703,34264,48825,41546,56096,6176,10448,9264,20736,24848,38384,35296,39568,49856,54128,52944,0,0,0,0
.short 25947,26988,28029,11390,4111,18656,33217,47778,40499,55060,5141,19702,12423,34264,41545,56106,48816,6176,9264,20736,10448,24848,35296,39568,38384,49856,52944,54128,0,0,0,0
.short 25947,26988,28029,4110,18671,11376,33217,40498,55059,47780,5141,12422,34263,19704,41545,48826,6176,56096,9264,10448,24848,20736,35296,38384,49856,39568,52944,54128,0,0,0,0
.short 33228,34269,35310,4111,11376,18657,40498,25939,47780,55061,12422,5143,19704,26985,48826,41547,56096,6176,10448,9264,20736,23824,38384,25008,39568,49856,54128,52944,0,0,0,0
.short 33228,34269,35310,11391,4096,18657,25938,47779,40500,55061,5142,19703,12424,26985,41546,56107,48816,6176,9264,20736,10448,23824,25008,39568,38384,49856,52944,54128,0,0,0,0
.short 33228,34269,35310,4111,18656,11377,25938,40499,55060,47781,5142,12423,26984,19705,41546,48827,6176,56096,9264,10448,23824,20736,25008,38384,49856,39568,52944,54128,0,0,0,0
.short 33228,34269,35310,4111,11376,25937,18658,40499,47780,5141,55062,12423,19704,41545,26986,48827,56096,9264,6176,10448,20736,25008,23824,38384,39568,52944,49856,54128,0,0,0,0
.short 40509,41550,42591,11376,4097,18658,25939,47780,33221,55062,5143,19704,12425,26986,34267,56108,48816,6176,9264,20736,10448,23824,25008,39408,35296,49856,52944,54128,0,0,0,0
.short 40509,41550,42591,4096,18657,11378,25939,33220,55061,47782,5143,12424,26985,19706,34267,48828,6176,56096,9264,10448,23824,20736,25008,35296,49856,39408,52944,54128,0,0,0,0
.short 40509,41550,42591,4096,11377,25938,18659,33220,47781,5142,55063,12424,19705,34266,26987,48828,56096,9264,6176,10448,20736,25008,23824,35296,39408,52944,49856,54128,0,0,0,0
.short 40509,41550,42591,4096,11377,18658,33219,25940,47781,55062,12423,5144,19705,26986,48827,34268,56096,6176,10448,9264,20736,23824,35296,25008,39408,49856,54128,52944,0,0,0,0
.short 47790,48831,49856,4097,18658,11379,25940,33221,55062,40503,5144,12425,26986,19707,34268,41549,6176,56096,9264,10448,23824,20736,25008,35296,39568,38384,52944,54128,0,0,0,0
.short 47790,48831,49856,4097,11378,25939,18660,33221,40502,5143,55064,12425,19706,34267,26988,41549,56096,9264,6176,10448,20736,25008,23824,35296,38384,52944,39568,54128,0,0,0,0
.short 47790,48831,49856,4097,11378,18659,33220,25941,40502,55063,12424,5145,19706,26987,41548,34269,56096,6176,10448,9264,20736,23824,35296,25008,38384,39568,54128,52944,0,0,0,0
.short 47790,48831,49856,11377,4098,18659,25940,40501,33222,55063,5144,19705,12426,26987,34268,56109,41536,6176,9264,20736,10448,23824,25008,38384,35296,39568,52944,54128,0,0,0,0
.short 55071,56096,57137,4098,11379,25940,18661,33222,40503,5144,47785,12426,19707,34268,26989,41550,48816,9264,6176,10448,20736,25008,23824,35296,38384,49856,39568,53968,0,0,0,0
.short 55071,56096,57137,4098,11379,18660,33221,25942,40503,47784,12425,5146,19707,26988,41549,34270,48816,6176,10448,9264,20736,23824,35296,25008,38384,39568,53968,49856,0,0,0,0
.short 55071,56096,57137,11378,4099,18660,25941,40502,33223,47784,5145,19706,12427,26988,34269,48830,41536,6176,9264,20736,10448,23824,25008,38384,35296,39568,49856,53968,0,0,0,0
.short 55071,56096,57137,4098,18659,11380,25941,33222,47783,40504,5145,12426,26987,19708,34269,41550,6176,48816,9264,10448,23824,20736,25008,35296,39568,38384,49856,53968,0,0,0,0
.section .rodata,"a"
.p2align 6
.amdhsa_kernel interleave_layers__ssm_conv_h3__mixer_s_mlp__prompt_kernel
  .amdhsa_next_free_vgpr 256
  .amdhsa_next_free_sgpr 102
  .amdhsa_accum_offset 256
  .amdhsa_group_segment_fixed_size 0
  .amdhsa_kernarg_size 112
  .amdhsa_user_sgpr_count 2
  .amdhsa_user_sgpr_kernarg_segment_ptr 1
  .amdhsa_system_sgpr_workgroup_id_x 1
  .amdhsa_float_denorm_mode_32 3
.end_amdhsa_kernel
```

```asm
; @launch grid=(256,1,1) block=(512,1,1) lds=163840
.amdgcn_target "amdgcn-amd-amdhsa--gfx950"
.text
.globl interleave_layers__ssm_conv_h3__mixer_s_mlp__prompt_kernel
.p2align 8
.type interleave_layers__ssm_conv_h3__mixer_s_mlp__prompt_kernel,@function
interleave_layers__ssm_conv_h3__mixer_s_mlp__prompt_kernel:
    s_cmp_ge_u32 s2, 256
    s_cbranch_scc1 K_end
    s_load_dwordx8 s[8:15], s[0:1], 8
    s_load_dwordx2 s[6:7], s[0:1], 0
    s_load_dwordx8 s[68:75], s[0:1], 56
    s_load_dwordx2 s[4:5], s[0:1], 104
    s_load_dwordx2 s[84:85], s[0:1], 96
    s_memrealtime s[46:47]
    s_load_dwordx2 s[96:97], s[0:1], 40
    v_lshrrev_b32 v1, 6, v0
    s_nop 0
    v_readfirstlane_b32 s30, v1
    s_getpc_b64 s[48:49]
K_pc:
    s_lshr_b32 s36, s2, 3
    s_lshl_b32 s36, s36, 11
    v_lshlrev_b32 v4, 2, v0
    v_add_u32 v4, s36, v4
    v_cmp_gt_u32 vcc, K_end-K_pc-8, v4
    s_nop 0
    s_and_saveexec_b64 s[36:37], vcc
    s_cbranch_execz K_3
    v_mov_b32 v5, s49
    v_add_co_u32 v4, vcc, s48, v4
    s_nop 1
    v_addc_co_u32 v5, vcc, 0, v5, vcc
    global_load_dword v250, v[4:5], off
K_3:
    s_mov_b64 exec, -1
    v_and_b32 v6, 31, v0
    v_lshrrev_b32 v7, 5, v0
    s_and_b32 s34, s2, 7
    s_lshr_b32 s35, s2, 3
    s_lshl_b32 s36, s35, 17
    s_lshl_b32 s37, s34, 8
    s_add_u32 s36, s36, s37
    v_lshlrev_b32 v8, 13, v7
    v_lshl_add_u32 v8, v6, 3, v8
    v_add_u32 v12, s36, v8
    v_add_u32 v14, 4096, v12
    s_mov_b32 s18, 4194304
    s_mov_b32 s19, 0x20000
    s_mov_b32 s22, s18
    s_mov_b32 s23, s19
    s_waitcnt lgkmcnt(0)
    s_mov_b32 s86, 256
    s_mov_b32 s87, 0x20000
    v_mov_b32 v78, 0
    s_lshl_b32 s45, s2, 3
    s_add_u32 s45, s45, s30
    s_cmp_lg_u32 s45, 4
    s_cbranch_scc1 KV_t0
    s_lshl_b32 s44, s46, 6
    s_or_b32 s44, s44, 1
    v_mov_b32 v76, s44
    s_mov_b64 exec, 1
    buffer_store_dword v76, v78, s[84:87], 0 offen sc1
    s_mov_b64 exec, -1
KV_t0:
    s_mov_b64 s[16:17], s[8:9]
    s_mov_b64 s[20:21], s[10:11]
    buffer_load_dwordx2 v[28:29], v12, s[16:19], 0 offen offset:0 nt
    buffer_load_dwordx2 v[30:31], v12, s[16:19], 0 offen offset:2048 nt
    buffer_load_dwordx2 v[32:33], v14, s[16:19], 0 offen offset:0 nt
    buffer_load_dwordx2 v[34:35], v14, s[16:19], 0 offen offset:2048 nt
    buffer_load_dwordx2 v[36:37], v12, s[20:23], 0 offen offset:0 nt
    buffer_load_dwordx2 v[38:39], v12, s[20:23], 0 offen offset:2048 nt
    buffer_load_dwordx2 v[40:41], v14, s[20:23], 0 offen offset:0 nt
    buffer_load_dwordx2 v[42:43], v14, s[20:23], 0 offen offset:2048 nt
    v_subrev_u32 v9, 6144, v12
    v_subrev_u32 v10, 4096, v12
    v_subrev_u32 v11, 2048, v12
    s_lshl_b32 s37, s34, 10
    v_lshlrev_b32 v16, 5, v6
    v_add_u32 v16, s37, v16
    s_mov_b32 s24, s12
    s_mov_b32 s25, s13
    s_mov_b32 s26, 0x2000
    s_mov_b32 s27, 0x20000
    v_and_b32 v8, 1, v7
    v_lshl_add_u32 v16, v8, 4, v16
    buffer_load_dwordx4 v[44:47], v16, s[24:27], 0 offen
    s_cmp_lg_u32 s30, 4
    s_cbranch_scc1 KV_t2
    buffer_load_dword v76, v78, s[84:87], 0 offen sc1
KV_t2:
    s_bfm_b64 exec, 32, 0
    buffer_load_dwordx2 v[22:23], v9, s[16:19], 0 offen nt
    buffer_load_dwordx2 v[24:25], v10, s[16:19], 0 offen nt
    buffer_load_dwordx2 v[26:27], v11, s[16:19], 0 offen nt
    s_mov_b64 exec, -1
    v_and_b32 v1, 63, v0
    v_lshlrev_b32 v2, 4, v1
    v_lshlrev_b32 v3, 2, v1
    s_and_b32 s32, s2, 7
    s_lshr_b32 s33, s2, 3
    s_and_b32 s28, s32, 2
    s_lshr_b32 s34, s32, 2
    s_or_b32 s28, s28, s34
    s_lshl_b32 s28, s28, 2
    s_and_b32 s34, s33, 3
    s_add_u32 s28, s28, s34
    s_and_b32 s31, s32, 1
    s_lshr_b32 s33, s33, 2
    s_lshl_b32 s29, s31, 3
    s_add_u32 s29, s29, s33
    s_lshl_b32 s67, s33, 1
    s_and_b32 s67, s67, 0
    s_xor_b32 s99, s29, 1
    s_mov_b32 s60, 0
    s_mov_b32 s61, 40000
    s_mov_b32 s52, 0
    s_mov_b32 s55, 0
    s_mov_b32 s92, 0
    s_mov_b32 s93, 0
    s_mov_b32 s94, 0
    s_mov_b32 s56, s4
    s_mov_b32 s57, s5
    s_mov_b32 s58, 0xa000000
    s_mov_b32 s59, 0x20000
    v_and_b32 v199, 7, v0
    v_lshrrev_b32 v228, 6, v0
    v_lshlrev_b32 v228, 4, v228
    v_bfe_u32 v229, v0, 3, 3
    v_add_u32 v228, v228, v229
    s_lshr_b32 s78, s29, 1
    s_lshl_b32 s78, s78, 16
    s_and_b32 s79, s29, 1
    s_lshl_b32 s79, s79, 7
    s_add_u32 s78, s78, s79
    s_lshr_b32 s79, s30, 1
    s_lshl_b32 s79, s79, 13
    s_add_u32 s78, s78, s79
    v_lshlrev_b32 v196, 8, v228
    v_lshl_add_u32 v196, v199, 4, v196
    v_add_u32 v196, s78, v196
    s_lshl_b32 s78, s28, 7
    s_lshl_b32 s79, s29, 3
    s_add_u32 s78, s78, s79
    v_add_u32 v197, s78, v199
    v_lshlrev_b32 v198, 11, v197
    v_lshrrev_b32 v229, 2, v228
    v_lshlrev_b32 v229, 3, v229
    v_and_b32 v228, 3, v228
    v_add_u32 v228, v228, v229
    v_lshl_add_u32 v198, v228, 3, v198
    v_and_b32 v197, 127, v197
    v_lshlrev_b32 v197, 3, v197
    v_lshl_add_u32 v197, v228, 11, v197
    s_lshr_b32 s78, s28, 3
    s_lshl_b32 s78, s78, 2
    s_and_b32 s79, s28, 3
    s_add_u32 s78, s78, s79
    s_lshl_b32 s78, s78, 24
    s_and_b32 s79, s28, 4
    s_lshl_b32 s79, s79, 8
    s_add_u32 s78, s78, s79
    v_add_u32 v197, s78, v197
    s_add_u32 s62, s4, 33554432
    s_addc_u32 s63, s5, 0
    s_and_b32 s41, s30, 3
    s_and_b32 s38, s2, 7
    s_lshl_b32 s38, s38, 5
    s_lshr_b32 s39, s2, 3
    s_add_u32 s38, s38, s39
    s_lshl_b32 s39, s38, 2
    s_add_u32 s39, s39, s41
    s_mul_i32 s40, s41, 24576
    s_lshr_b32 s36, s39, 1
    s_lshl_b32 s36, s36, 2
    s_load_dword s98, s[96:97], s36
    s_lshl_b32 s36, s39, 12
    s_add_u32 s12, s14, s36
    s_addc_u32 s13, s15, 0
    s_mov_b32 s14, 4096
    s_mov_b32 s15, 0x20000
    s_lshr_b32 s45, s30, 2
    s_lshl_b32 s45, s45, 11
    s_add_u32 s36, s45, 0xffffffc0
    v_add_u32 v70, s36, v2
    v_add_u32 v71, 16, v70
    s_add_u32 s36, s45, 0x3c0
    v_add_u32 v72, s36, v2
    v_add_u32 v73, 16, v72
    s_mov_b32 s36, 4032
    v_add_u32 v74, s36, v2
    v_add_u32 v75, 16, v74
    s_and_b32 s34, s2, 7
    s_lshr_b32 s35, s2, 3
    v_mov_b32 v80, 0
    v_mov_b32 v81, 0
    v_mov_b32 v82, 0
    v_mov_b32 v83, 0
    v_add_u32 v86, s40, v2
    ds_write_b128 v86, v[80:83] offset:22784
    s_bfm_b64 exec, 26, 0
    ds_write_b128 v86, v[80:83] offset:23808
    s_mov_b64 exec, -1
    v_lshlrev_b32 v8, 2, v7
    v_sub_u32 v8, 60, v8
    v_lshrrev_b32 v85, 3, v8
    v_bfe_u32 v84, v6, 1, 3
    v_xor_b32 v85, v85, v84
    v_lshlrev_b32 v85, 4, v85
    v_and_b32 v8, 7, v8
    v_lshl_add_u32 v85, v8, 1, v85
    v_lshl_add_u32 v84, v6, 9, v85
    v_add_u32 v84, 98304, v84
    s_waitcnt vmcnt(0)
    s_cmp_lg_u32 s30, 4
    s_cbranch_scc1 KV_t1
KV_t1:
    buffer_load_dwordx4 v[52:55], v70, s[12:15], 0 offen nt
    buffer_load_dwordx2 v[56:57], v71, s[12:15], 0 offen nt
    buffer_load_dwordx4 v[58:61], v72, s[12:15], 0 offen nt
    buffer_load_dwordx2 v[62:63], v73, s[12:15], 0 offen nt
    buffer_load_dwordx4 v[64:67], v74, s[12:15], 0 offen nt
    buffer_load_dwordx2 v[68:69], v75, s[12:15], 0 offen nt
    v_mov_b32 v48, v44
    v_mov_b32 v49, v45
    v_mov_b32 v50, v46
    v_mov_b32 v51, v47
    v_mov_b32 v126, v30
    v_mov_b32 v127, v31
    v_mov_b32 v128, v32
    v_mov_b32 v129, v33
    v_mov_b32 v130, v34
    v_mov_b32 v131, v35
    v_permlane32_swap_b32 v44, v48
    v_permlane32_swap_b32 v45, v49
    v_permlane32_swap_b32 v46, v50
    v_permlane32_swap_b32 v47, v51
    v_permlane32_swap_b32 v22, v126
    v_permlane32_swap_b32 v23, v127
    v_permlane32_swap_b32 v24, v128
    v_permlane32_swap_b32 v25, v129
    v_permlane32_swap_b32 v26, v130
    v_permlane32_swap_b32 v27, v131
    v_lshlrev_b32 v88, 16, v44
    v_and_b32 v90, 0xffff0000, v44
    v_lshlrev_b32 v92, 16, v45
    v_and_b32 v94, 0xffff0000, v45
    v_lshlrev_b32 v89, 16, v46
    v_and_b32 v91, 0xffff0000, v46
    v_lshlrev_b32 v93, 16, v47
    v_and_b32 v95, 0xffff0000, v47
    v_lshlrev_b32 v96, 16, v22
    v_and_b32 v97, 0xffff0000, v22
    v_lshlrev_b32 v98, 16, v24
    v_and_b32 v99, 0xffff0000, v24
    v_lshlrev_b32 v100, 16, v26
    v_and_b32 v101, 0xffff0000, v26
    v_lshlrev_b32 v102, 16, v28
    v_and_b32 v103, 0xffff0000, v28
    v_lshlrev_b32 v104, 16, v30
    v_and_b32 v105, 0xffff0000, v30
    v_lshlrev_b32 v106, 16, v32
    v_and_b32 v107, 0xffff0000, v32
    v_lshlrev_b32 v108, 16, v34
    v_and_b32 v109, 0xffff0000, v34
    v_lshlrev_b32 v110, 16, v36
    v_and_b32 v111, 0xffff0000, v36
    v_lshlrev_b32 v112, 16, v38
    v_and_b32 v113, 0xffff0000, v38
    v_lshlrev_b32 v114, 16, v40
    v_and_b32 v115, 0xffff0000, v40
    v_lshlrev_b32 v116, 16, v42
    v_and_b32 v117, 0xffff0000, v42
    v_pk_mul_f32 v[118:119], v[96:97], v[94:95]
    v_pk_mul_f32 v[120:121], v[98:99], v[94:95]
    v_pk_mul_f32 v[122:123], v[100:101], v[94:95]
    v_pk_mul_f32 v[124:125], v[102:103], v[94:95]
    v_pk_fma_f32 v[118:119], v[98:99], v[92:93], v[118:119]
    v_pk_fma_f32 v[120:121], v[100:101], v[92:93], v[120:121]
    v_pk_fma_f32 v[122:123], v[102:103], v[92:93], v[122:123]
    v_pk_fma_f32 v[124:125], v[104:105], v[92:93], v[124:125]
    v_pk_fma_f32 v[118:119], v[100:101], v[90:91], v[118:119]
    v_pk_fma_f32 v[120:121], v[102:103], v[90:91], v[120:121]
    v_pk_fma_f32 v[122:123], v[104:105], v[90:91], v[122:123]
    v_pk_fma_f32 v[124:125], v[106:107], v[90:91], v[124:125]
    v_pk_fma_f32 v[118:119], v[102:103], v[88:89], v[118:119]
    v_pk_fma_f32 v[120:121], v[104:105], v[88:89], v[120:121]
    v_pk_fma_f32 v[122:123], v[106:107], v[88:89], v[122:123]
    v_pk_fma_f32 v[124:125], v[108:109], v[88:89], v[124:125]
    v_pk_mul_f32 v[118:119], v[118:119], v[110:111]
    v_pk_mul_f32 v[120:121], v[120:121], v[112:113]
    v_pk_mul_f32 v[122:123], v[122:123], v[114:115]
    v_pk_mul_f32 v[124:125], v[124:125], v[116:117]
    v_cvt_pk_bf16_f32 v136, v124, v122
    v_cvt_pk_bf16_f32 v137, v120, v118
    ds_write_b64 v84, v[136:137] offset:0
    v_cvt_pk_bf16_f32 v138, v125, v123
    v_cvt_pk_bf16_f32 v139, v121, v119
    ds_write_b64 v84, v[138:139] offset:128
    v_lshlrev_b32 v88, 16, v48
    v_and_b32 v90, 0xffff0000, v48
    v_lshlrev_b32 v92, 16, v49
    v_and_b32 v94, 0xffff0000, v49
    v_lshlrev_b32 v89, 16, v50
    v_and_b32 v91, 0xffff0000, v50
    v_lshlrev_b32 v93, 16, v51
    v_and_b32 v95, 0xffff0000, v51
    v_lshlrev_b32 v96, 16, v23
    v_and_b32 v97, 0xffff0000, v23
    v_lshlrev_b32 v98, 16, v25
    v_and_b32 v99, 0xffff0000, v25
    v_lshlrev_b32 v100, 16, v27
    v_and_b32 v101, 0xffff0000, v27
    v_lshlrev_b32 v102, 16, v29
    v_and_b32 v103, 0xffff0000, v29
    v_lshlrev_b32 v104, 16, v31
    v_and_b32 v105, 0xffff0000, v31
    v_lshlrev_b32 v106, 16, v33
    v_and_b32 v107, 0xffff0000, v33
    v_lshlrev_b32 v108, 16, v35
    v_and_b32 v109, 0xffff0000, v35
    v_lshlrev_b32 v110, 16, v37
    v_and_b32 v111, 0xffff0000, v37
    v_lshlrev_b32 v112, 16, v39
    v_and_b32 v113, 0xffff0000, v39
    v_lshlrev_b32 v114, 16, v41
    v_and_b32 v115, 0xffff0000, v41
    v_lshlrev_b32 v116, 16, v43
    v_and_b32 v117, 0xffff0000, v43
    v_pk_mul_f32 v[118:119], v[96:97], v[94:95]
    v_pk_mul_f32 v[120:121], v[98:99], v[94:95]
    v_pk_mul_f32 v[122:123], v[100:101], v[94:95]
    v_pk_mul_f32 v[124:125], v[102:103], v[94:95]
    v_pk_fma_f32 v[118:119], v[98:99], v[92:93], v[118:119]
    v_pk_fma_f32 v[120:121], v[100:101], v[92:93], v[120:121]
    v_pk_fma_f32 v[122:123], v[102:103], v[92:93], v[122:123]
    v_pk_fma_f32 v[124:125], v[104:105], v[92:93], v[124:125]
    v_pk_fma_f32 v[118:119], v[100:101], v[90:91], v[118:119]
    v_pk_fma_f32 v[120:121], v[102:103], v[90:91], v[120:121]
    v_pk_fma_f32 v[122:123], v[104:105], v[90:91], v[122:123]
    v_pk_fma_f32 v[124:125], v[106:107], v[90:91], v[124:125]
    v_pk_fma_f32 v[118:119], v[102:103], v[88:89], v[118:119]
    v_pk_fma_f32 v[120:121], v[104:105], v[88:89], v[120:121]
    v_pk_fma_f32 v[122:123], v[106:107], v[88:89], v[122:123]
    v_pk_fma_f32 v[124:125], v[108:109], v[88:89], v[124:125]
    v_pk_mul_f32 v[118:119], v[118:119], v[110:111]
    v_pk_mul_f32 v[120:121], v[120:121], v[112:113]
    v_pk_mul_f32 v[122:123], v[122:123], v[114:115]
    v_pk_mul_f32 v[124:125], v[124:125], v[116:117]
    v_cvt_pk_bf16_f32 v140, v124, v122
    v_cvt_pk_bf16_f32 v141, v120, v118
    ds_write_b64 v84, v[140:141] offset:256
    v_cvt_pk_bf16_f32 v142, v125, v123
    v_cvt_pk_bf16_f32 v143, v121, v119
    ds_write_b64 v84, v[142:143] offset:384
    s_cmp_lg_u32 s30, 4
    s_cbranch_scc1 HB_2
    v_add_u32 v18, 162816, v3
    ds_write_b32 v18, v78
    s_mov_b32 s53, 0
    s_waitcnt vmcnt(6)
HB_p:
    v_readfirstlane_b32 s52, v76
    s_nop 0
    s_cmp_eq_u32 s52, 0
    s_cbranch_scc1 HB_r
    s_cmp_ge_u32 s53, 400
    s_cbranch_scc1 HB_q
    s_add_u32 s54, s46, 8192
    s_lshl_b32 s54, s54, 6
    s_sub_u32 s54, s54, s52
    s_cmp_lt_u32 s54, 786432
    s_cbranch_scc1 HB_q
HB_r:
    buffer_load_dword v76, v78, s[84:87], 0 offen sc1
    s_waitcnt vmcnt(0)
    s_add_u32 s53, s53, 1
    s_cmp_lt_u32 s53, s61
    s_cbranch_scc1 HB_p
    s_mov_b32 s52, 1
    s_mov_b32 s61, 0
HB_q:
    v_mov_b32 v18, 162828
    v_mov_b32 v19, s52
    s_waitcnt lgkmcnt(0)
    ds_write_b32 v18, v19
HB_2:
    s_add_u32 s16, s4, 0x2000000
    s_addc_u32 s17, s5, 0
    s_mov_b32 s18, 0x8000000
    s_mov_b32 s19, 0x20000
    v_lshrrev_b32 v8, 3, v0
    v_and_b32 v85, 7, v0
    v_lshlrev_b32 v149, 12, v8
    v_lshl_add_u32 v149, v85, 4, v149
    s_lshl_b32 s36, s34, 24
    s_sub_u32 s37, 31, s35
    s_lshl_b32 s37, s37, 7
    s_add_u32 s36, s36, s37
    s_add_u32 s37, s36, 262144
    v_lshrrev_b32 v148, 3, v8
    v_xor_b32 v148, v148, v85
    v_lshlrev_b32 v148, 4, v148
    v_lshl_add_u32 v148, v8, 7, v148
    v_add_u32 v148, 98304, v148
    v_mov_b32 v18, 162828
    s_waitcnt lgkmcnt(0)
    s_barrier
    ds_read_b128 v[152:155], v148 offset:0
    ds_read_b128 v[156:159], v148 offset:8192
    ds_read_b32 v19, v18
    s_waitcnt lgkmcnt(2)
    v_or_b32 v152, 1, v152
    buffer_store_dwordx4 v[152:155], v149, s[16:19], s36 offen sc1
    s_waitcnt lgkmcnt(1)
    v_or_b32 v156, 1, v156
    buffer_store_dwordx4 v[156:159], v149, s[16:19], s37 offen sc1
    s_waitcnt lgkmcnt(0)
    v_readfirstlane_b32 s52, v19
    s_cmp_lg_u32 s30, 0
    s_cbranch_scc1 KV_ni
    s_cmp_ge_u32 s35, 16
    s_cbranch_scc1 KV_ni
    v_mov_b32 v8, s52
    s_lshl_b32 s37, s34, 7
    s_lshl_b32 s53, s35, 10
    s_add_u32 s37, s37, s53
    s_add_u32 s37, s37, 23101440
    s_mov_b64 exec, 1
    buffer_store_dword v8, v78, s[56:59], s37 offen sc1
    s_mov_b64 exec, -1
KV_ni:
    s_cmp_ge_u32 s2, 255
    s_cbranch_scc1 KV_n3
    s_cmp_lg_u32 s30, 5
    s_cbranch_scc1 KV_n3
    s_and_b32 s42, s2, 31
    s_lshl_b32 s42, s42, 8
    s_lshr_b32 s43, s2, 5
    s_lshl_b32 s43, s43, 14
    s_add_u32 s42, s42, s43
    s_add_u32 s42, s42, 39714816
    v_and_b32 v8, 1, v1
    v_lshlrev_b32 v8, 13, v8
    v_lshrrev_b32 v85, 1, v1
    v_lshl_add_u32 v8, v85, 7, v8
    s_mov_b64 exec, 0xf
    buffer_store_dword v8, v8, s[56:59], s42 offen sc1
    s_mov_b64 exec, -1
KV_n3:
    s_lshl_b32 s36, s34, 5
    s_add_u32 s36, s36, s35
    s_lshl_b32 s36, s36, 7
    s_add_u32 s36, s36, 23068672
    v_mov_b32 v18, 1
    v_mov_b32 v19, 162820
    v_mov_b32 v21, 0
    s_mov_b64 exec, 1
    s_waitcnt vmcnt(0)
    ds_add_rtn_u32 v20, v19, v18
    v_mov_b32 v19, s52
    s_waitcnt lgkmcnt(0)
    v_readfirstlane_b32 s54, v20
    s_nop 0
    s_and_b32 s54, s54, 7
    s_cmp_lg_u32 s54, 7
    s_cbranch_scc1 pub_1
    buffer_store_dword v19, v21, s[56:59], s36 offen sc1
pub_1:
    s_mov_b64 exec, -1
    s_mov_b32 s8, s6
    s_mov_b32 s9, s7
    s_mov_b32 s10, 0x400000
    s_mov_b32 s11, 0x20000
    buffer_load_dwordx2 v[180:181], v198, s[8:11], 0 offen offset:0 nt
    buffer_load_dwordx2 v[182:183], v198, s[8:11], 0 offen offset:32 nt
    buffer_load_dwordx2 v[184:185], v198, s[8:11], 0 offen offset:128 nt
    buffer_load_dwordx2 v[186:187], v198, s[8:11], 0 offen offset:160 nt
    v_add_u32 v160, s45, v86
    v_alignbit_b32 v88, v53, v52, 16
    v_mov_b32 v92, v53
    v_alignbit_b32 v96, v54, v53, 16
    v_alignbit_b32 v89, v54, v53, 16
    v_mov_b32 v93, v54
    v_alignbit_b32 v97, v55, v54, 16
    v_alignbit_b32 v90, v55, v54, 16
    v_mov_b32 v94, v55
    v_alignbit_b32 v98, v56, v55, 16
    v_alignbit_b32 v91, v56, v55, 16
    v_mov_b32 v95, v56
    v_alignbit_b32 v99, v57, v56, 16
    ds_write_b128 v160, v[88:91] offset:0
    ds_write_b128 v160, v[92:95] offset:4160
    ds_write_b128 v160, v[96:99] offset:8320
    ds_write_b128 v160, v[54:57] offset:12480
    v_alignbit_b32 v100, v59, v58, 16
    v_mov_b32 v104, v59
    v_alignbit_b32 v108, v60, v59, 16
    v_alignbit_b32 v101, v60, v59, 16
    v_mov_b32 v105, v60
    v_alignbit_b32 v109, v61, v60, 16
    v_alignbit_b32 v102, v61, v60, 16
    v_mov_b32 v106, v61
    v_alignbit_b32 v110, v62, v61, 16
    v_alignbit_b32 v103, v62, v61, 16
    v_mov_b32 v107, v62
    v_alignbit_b32 v111, v63, v62, 16
    ds_write_b128 v160, v[100:103] offset:1024
    ds_write_b128 v160, v[104:107] offset:5184
    ds_write_b128 v160, v[108:111] offset:9344
    ds_write_b128 v160, v[60:63] offset:13504
    v_alignbit_b32 v112, v65, v64, 16
    v_mov_b32 v116, v65
    v_alignbit_b32 v120, v66, v65, 16
    v_alignbit_b32 v113, v66, v65, 16
    v_mov_b32 v117, v66
    v_alignbit_b32 v121, v67, v66, 16
    v_alignbit_b32 v114, v67, v66, 16
    v_mov_b32 v118, v67
    v_alignbit_b32 v122, v68, v67, 16
    v_alignbit_b32 v115, v68, v67, 16
    v_mov_b32 v119, v68
    v_alignbit_b32 v123, v69, v68, 16
    s_mov_b64 exec, 0xf
    ds_write_b128 v86, v[112:115] offset:4096
    ds_write_b128 v86, v[116:119] offset:8256
    ds_write_b128 v86, v[120:123] offset:12416
    ds_write_b128 v86, v[66:69] offset:16576
    s_mov_b64 exec, -1
    s_waitcnt lgkmcnt(0)
    s_barrier
    v_mov_b32 v238, 0
    v_mov_b32 v239, 0
    v_mov_b32 v240, 0
    v_mov_b32 v241, 0
    v_mov_b32 v242, 0
    v_mov_b32 v243, 0
    v_mov_b32 v244, 0
    v_mov_b32 v245, 0
    v_mov_b32 v246, 0
    v_mov_b32 v247, 0
    s_cmp_ge_u32 s30, 4
    s_cbranch_scc1 FR_b
    s_and_b32 s38, s2, 7
    s_lshl_b32 s38, s38, 5
    s_lshr_b32 s39, s2, 3
    s_add_u32 s38, s38, s39
    s_lshl_b32 s39, s38, 2
    s_add_u32 s39, s39, s30
    s_mul_i32 s40, s30, 24576
    s_and_b32 s36, s39, 127
    s_lshl_b32 s36, s36, 12
    s_lshr_b32 s37, s39, 7
    s_lshl_b32 s37, s37, 24
    s_add_u32 s36, s36, s37
    s_add_u32 s36, s36, 33554432
    s_add_u32 s16, s4, s36
    s_addc_u32 s17, s5, 0
    s_mov_b32 s18, 4096
    s_mov_b32 s19, 0x20000
    v_lshrrev_b32 v6, 2, v1
    v_mul_u32_u24 v12, 96, v6
    v_and_b32 v6, 3, v1
    v_lshl_add_u32 v12, v6, 4, v12
    v_add_u32 v12, s40, v12
    v_and_b32 v35, 15, v1
    v_lshrrev_b32 v36, 4, v1
    v_and_b32 v6, 3, v35
    v_mul_u32_u24 v32, 4160, v6
    v_lshl_add_u32 v32, v36, 4, v32
    v_lshrrev_b32 v6, 2, v35
    v_lshl_add_u32 v32, v6, 3, v32
    v_add_u32 v32, s40, v32
    v_sub_u32 v6, 15, v35
    v_mul_u32_u24 v34, 96, v6
    v_add_u32 v34, s40, v34
    v_lshl_add_u32 v33, v36, 4, v34
    ds_read_b64 v[72:73], v32 offset:0
    ds_read_b64 v[74:75], v32 offset:8
    ds_read_b64 v[76:77], v32 offset:32
    ds_read_b64 v[78:79], v32 offset:40
    ds_read_b64 v[80:81], v32 offset:1024
    ds_read_b64 v[82:83], v32 offset:1032
    ds_read_b64 v[84:85], v32 offset:1056
    ds_read_b64 v[86:87], v32 offset:1064
    ds_read_b64 v[88:89], v32 offset:2048
    ds_read_b64 v[90:91], v32 offset:2056
    ds_read_b64 v[92:93], v32 offset:2080
    ds_read_b64 v[94:95], v32 offset:2088
    ds_read_b64 v[96:97], v32 offset:3072
    ds_read_b64 v[98:99], v32 offset:3080
    ds_read_b64 v[100:101], v32 offset:3104
    ds_read_b64 v[102:103], v32 offset:3112
    s_bitcmp1_b32 s39, 0
    s_cselect_b32 s36, 0, 16
    s_lshl_b32 s41, s98, s36
    s_and_b32 s41, s41, 0xffff0000
    s_lshr_b32 s36, s41, 16
    v_lshl_add_u32 v6, v36, 3, v35
    v_sub_u32 v6, 31, v6
    v_mov_b32 v10, s36
    v_mov_b32 v11, s41
    v_and_b32 v8, 1, v6
    v_cmp_eq_u32 vcc, 1, v8
    s_nop 1
    v_cndmask_b32 v10, v10, v11, vcc
    v_ashrrev_i32 v6, 1, v6
    v_cmp_eq_u32 vcc, 0, v6
    s_nop 1
    v_cndmask_b32 v152, 0, v10, vcc
    v_cmp_eq_u32 vcc, 1, v6
    s_nop 1
    v_cndmask_b32 v153, 0, v10, vcc
    v_cmp_eq_u32 vcc, 2, v6
    s_nop 1
    v_cndmask_b32 v154, 0, v10, vcc
    v_cmp_eq_u32 vcc, 3, v6
    s_nop 1
    v_cndmask_b32 v155, 0, v10, vcc
    v_cmp_eq_u32 vcc, 8, v6
    s_nop 1
    v_cndmask_b32 v156, 0, v10, vcc
    v_cmp_eq_u32 vcc, 9, v6
    s_nop 1
    v_cndmask_b32 v157, 0, v10, vcc
    v_cmp_eq_u32 vcc, 10, v6
    s_nop 1
    v_cndmask_b32 v158, 0, v10, vcc
    v_cmp_eq_u32 vcc, 11, v6
    s_nop 1
    v_cndmask_b32 v159, 0, v10, vcc
    s_add_u32 s12, s4, 0x2100000
    s_addc_u32 s13, s5, 0
    s_mov_b32 s14, 0x7f00000
    s_mov_b32 s15, 0x20000
    v_bfe_u32 v6, v1, 2, 2
    v_mul_u32_u24 v168, 24640, v6
    v_lshrrev_b32 v6, 1, v36
    v_mul_u32_u24 v6, 72, v6
    v_add_u32 v168, v168, v6
    v_and_b32 v6, 1, v36
    v_lshl_add_u32 v168, v6, 5, v168
    v_and_b32 v6, 3, v1
    v_lshl_add_u32 v168, v6, 3, v168
    s_mul_i32 s36, s30, 1152
    v_add_u32 v168, s36, v168
    v_lshlrev_b32 v169, 3, v1
    s_lshl_b32 s44, s38, 11
    s_and_b32 s37, s30, 1
    s_lshl_b32 s37, s37, 10
    s_add_u32 s44, s44, s37
    s_lshr_b32 s37, s30, 1
    s_lshl_b32 s37, s37, 26
    s_add_u32 s44, s44, s37
    v_not_b32 v34, v1
    v_and_b32 v34, 1, v34
    s_mul_i32 s36, s30, 24640
    v_mul_u32_u24 v170, 72, v35
    v_lshl_add_u32 v170, v36, 3, v170
    v_add_u32 v170, s36, v170
    s_cmp_lg_u32 s30, 0
    s_cbranch_scc1 CV_w
    s_and_b32 s36, s2, 7
    s_lshl_b32 s36, s36, 12
    s_add_u32 s36, s36, 23068672
    v_lshlrev_b32 v9, 7, v1
    v_add_u32 v9, s36, v9
    s_mov_b32 s53, 0
    s_add_u32 s54, s52, 0
    s_bfm_b64 exec, 32, 0
poll_2:
    buffer_load_dword v8, v9, s[56:59], 0 offen sc1
    s_waitcnt vmcnt(0)
    v_xor_b32 v8, s54, v8
    v_cmp_eq_u32 vcc, 0, v8
    s_nop 0
    s_cmp_eq_u64 vcc, exec
    s_cbranch_scc1 pok_3
    s_sleep 5
    s_add_u32 s53, s53, 1
    s_cmp_lt_u32 s53, s61
    s_cbranch_scc1 poll_2
    s_mov_b32 s61, 0
pok_3:
    s_mov_b64 exec, -1
    v_mov_b32 v8, 162832
    v_mov_b32 v9, 1
    s_waitcnt lgkmcnt(0)
    ds_write_b32 v8, v9
CV_w:
    v_mov_b32 v8, 162832
spin_4:
    ds_read_b32 v9, v8
    s_waitcnt lgkmcnt(0)
    v_readfirstlane_b32 s53, v9
    s_nop 0
    s_cmp_ge_u32 s53, 1
    s_cbranch_scc0 spin_4
    buffer_load_dwordx4 v[16:19], v2, s[16:19], 0 offen offset:0 sc1
    buffer_load_dwordx4 v[20:23], v2, s[16:19], 0 offen offset:1024 sc1
    buffer_load_dwordx4 v[24:27], v2, s[16:19], 0 offen offset:2048 sc1
    buffer_load_dwordx4 v[28:31], v2, s[16:19], 0 offen offset:3072 sc1
    s_waitcnt vmcnt(3)
    ds_write_b128 v12, v[16:19] offset:16640
    s_waitcnt vmcnt(2)
    ds_write_b128 v12, v[20:23] offset:18176
    s_waitcnt vmcnt(1)
    ds_write_b128 v12, v[24:27] offset:19712
    s_waitcnt vmcnt(0)
    ds_write_b128 v12, v[28:31] offset:21248
    v_mov_b32 v8, 162836
    v_mov_b32 v9, 1
    s_mov_b64 exec, 1
    ds_add_u32 v8, v9
    s_mov_b64 exec, -1
    s_waitcnt lgkmcnt(0)
    ds_read_b128 v[136:139], v33 offset:21248
    ds_read_b128 v[140:143], v33 offset:19712
    ds_read_b128 v[144:147], v33 offset:18176
    ds_read_b128 v[148:151], v33 offset:16640
    s_waitcnt lgkmcnt(3)
    v_mfma_f32_16x16x32_bf16 v[40:43], v[152:155], v[136:139], 0
    v_mfma_f32_16x16x32_bf16 v[44:47], v[156:159], v[136:139], 0
    s_waitcnt lgkmcnt(2)
    v_mfma_f32_16x16x32_bf16 v[48:51], v[152:155], v[140:143], 0
    v_mfma_f32_16x16x32_bf16 v[52:55], v[156:159], v[140:143], 0
    s_waitcnt lgkmcnt(1)
    v_mfma_f32_16x16x32_bf16 v[56:59], v[152:155], v[144:147], 0
    v_mfma_f32_16x16x32_bf16 v[60:63], v[156:159], v[144:147], 0
    s_waitcnt lgkmcnt(0)
    v_mfma_f32_16x16x32_bf16 v[64:67], v[152:155], v[148:151], 0
    v_mfma_f32_16x16x32_bf16 v[68:71], v[156:159], v[148:151], 0
    s_mov_b32 s43, 0
CV_r:
    s_waitcnt lgkmcnt(0)
    v_mfma_f32_16x16x32_bf16 v[40:43], v[72:75], v[136:139], v[40:43]
    v_mfma_f32_16x16x32_bf16 v[48:51], v[72:75], v[140:143], v[48:51]
    v_mfma_f32_16x16x32_bf16 v[56:59], v[72:75], v[144:147], v[56:59]
    v_mfma_f32_16x16x32_bf16 v[64:67], v[72:75], v[148:151], v[64:67]
    v_mfma_f32_16x16x32_bf16 v[44:47], v[76:79], v[136:139], v[44:47]
    v_mfma_f32_16x16x32_bf16 v[52:55], v[76:79], v[140:143], v[52:55]
    v_mfma_f32_16x16x32_bf16 v[60:63], v[76:79], v[144:147], v[60:63]
    v_mfma_f32_16x16x32_bf16 v[68:71], v[76:79], v[148:151], v[68:71]
    v_mfma_f32_16x16x32_bf16 v[48:51], v[80:83], v[136:139], v[48:51]
    v_mfma_f32_16x16x32_bf16 v[56:59], v[80:83], v[140:143], v[56:59]
    v_mfma_f32_16x16x32_bf16 v[64:67], v[80:83], v[144:147], v[64:67]
    v_mfma_f32_16x16x32_bf16 v[52:55], v[84:87], v[136:139], v[52:55]
    v_mfma_f32_16x16x32_bf16 v[60:63], v[84:87], v[140:143], v[60:63]
    v_mfma_f32_16x16x32_bf16 v[68:71], v[84:87], v[144:147], v[68:71]
    v_mfma_f32_16x16x32_bf16 v[56:59], v[88:91], v[136:139], v[56:59]
    v_mfma_f32_16x16x32_bf16 v[64:67], v[88:91], v[140:143], v[64:67]
    v_mfma_f32_16x16x32_bf16 v[60:63], v[92:95], v[136:139], v[60:63]
    v_mfma_f32_16x16x32_bf16 v[68:71], v[92:95], v[140:143], v[68:71]
    v_mfma_f32_16x16x32_bf16 v[64:67], v[96:99], v[136:139], v[64:67]
    v_mfma_f32_16x16x32_bf16 v[68:71], v[100:103], v[136:139], v[68:71]
    ds_read_b128 v[152:155], v33 offset:21344
    ds_read_b128 v[156:159], v33 offset:19808
    ds_read_b128 v[160:163], v33 offset:18272
    ds_read_b128 v[164:167], v33 offset:16736
    ds_read_b64 v[104:105], v32 offset:64
    ds_read_b64 v[106:107], v32 offset:72
    ds_read_b64 v[108:109], v32 offset:96
    ds_read_b64 v[110:111], v32 offset:104
    ds_read_b64 v[112:113], v32 offset:1088
    ds_read_b64 v[114:115], v32 offset:1096
    ds_read_b64 v[116:117], v32 offset:1120
    ds_read_b64 v[118:119], v32 offset:1128
    ds_read_b64 v[120:121], v32 offset:2112
    ds_read_b64 v[122:123], v32 offset:2120
    ds_read_b64 v[124:125], v32 offset:2144
    ds_read_b64 v[126:127], v32 offset:2152
    ds_read_b64 v[128:129], v32 offset:3136
    ds_read_b64 v[130:131], v32 offset:3144
    ds_read_b64 v[132:133], v32 offset:3168
    ds_read_b64 v[134:135], v32 offset:3176
    s_waitcnt lgkmcnt(0)
    v_mfma_f32_16x16x32_bf16 v[40:43], v[104:107], v[152:155], v[40:43]
    v_mfma_f32_16x16x32_bf16 v[48:51], v[104:107], v[156:159], v[48:51]
    v_mfma_f32_16x16x32_bf16 v[56:59], v[104:107], v[160:163], v[56:59]
    v_mfma_f32_16x16x32_bf16 v[64:67], v[104:107], v[164:167], v[64:67]
    v_mfma_f32_16x16x32_bf16 v[44:47], v[108:111], v[152:155], v[44:47]
    v_mfma_f32_16x16x32_bf16 v[52:55], v[108:111], v[156:159], v[52:55]
    v_mfma_f32_16x16x32_bf16 v[60:63], v[108:111], v[160:163], v[60:63]
    v_mfma_f32_16x16x32_bf16 v[68:71], v[108:111], v[164:167], v[68:71]
    v_mfma_f32_16x16x32_bf16 v[48:51], v[112:115], v[152:155], v[48:51]
    v_mfma_f32_16x16x32_bf16 v[56:59], v[112:115], v[156:159], v[56:59]
    v_mfma_f32_16x16x32_bf16 v[64:67], v[112:115], v[160:163], v[64:67]
    v_mfma_f32_16x16x32_bf16 v[52:55], v[116:119], v[152:155], v[52:55]
    v_mfma_f32_16x16x32_bf16 v[60:63], v[116:119], v[156:159], v[60:63]
    v_mfma_f32_16x16x32_bf16 v[68:71], v[116:119], v[160:163], v[68:71]
    v_mfma_f32_16x16x32_bf16 v[56:59], v[120:123], v[152:155], v[56:59]
    v_mfma_f32_16x16x32_bf16 v[64:67], v[120:123], v[156:159], v[64:67]
    v_mfma_f32_16x16x32_bf16 v[60:63], v[124:127], v[152:155], v[60:63]
    v_mfma_f32_16x16x32_bf16 v[68:71], v[124:127], v[156:159], v[68:71]
    v_mfma_f32_16x16x32_bf16 v[64:67], v[128:131], v[152:155], v[64:67]
    v_mfma_f32_16x16x32_bf16 v[68:71], v[132:135], v[152:155], v[68:71]
    ds_read_b128 v[136:139], v33 offset:21440
    ds_read_b128 v[140:143], v33 offset:19904
    ds_read_b128 v[144:147], v33 offset:18368
    ds_read_b128 v[148:151], v33 offset:16832
    ds_read_b64 v[72:73], v32 offset:128
    ds_read_b64 v[74:75], v32 offset:136
    ds_read_b64 v[76:77], v32 offset:160
    ds_read_b64 v[78:79], v32 offset:168
    ds_read_b64 v[80:81], v32 offset:1152
    ds_read_b64 v[82:83], v32 offset:1160
    ds_read_b64 v[84:85], v32 offset:1184
    ds_read_b64 v[86:87], v32 offset:1192
    ds_read_b64 v[88:89], v32 offset:2176
    ds_read_b64 v[90:91], v32 offset:2184
    ds_read_b64 v[92:93], v32 offset:2208
    ds_read_b64 v[94:95], v32 offset:2216
    ds_read_b64 v[96:97], v32 offset:3200
    ds_read_b64 v[98:99], v32 offset:3208
    ds_read_b64 v[100:101], v32 offset:3232
    ds_read_b64 v[102:103], v32 offset:3240
    v_add_u32 v32, 128, v32
    v_add_u32 v33, 192, v33
    s_add_u32 s43, s43, 1
    s_cmp_lt_u32 s43, 4
    s_cbranch_scc1 CV_r
CV_l:
    s_waitcnt lgkmcnt(10)
    v_mfma_f32_16x16x32_bf16 v[40:43], v[72:75], v[136:139], v[40:43]
    ds_read_b128 v[152:155], v33 offset:21344
    v_mfma_f32_16x16x32_bf16 v[48:51], v[72:75], v[140:143], v[48:51]
    ds_read_b128 v[156:159], v33 offset:19808
    v_mfma_f32_16x16x32_bf16 v[56:59], v[72:75], v[144:147], v[56:59]
    ds_read_b128 v[160:163], v33 offset:18272
    v_mfma_f32_16x16x32_bf16 v[64:67], v[72:75], v[148:151], v[64:67]
    ds_read_b128 v[164:167], v33 offset:16736
    v_mfma_f32_16x16x32_bf16 v[44:47], v[76:79], v[136:139], v[44:47]
    ds_read_b64 v[104:105], v32 offset:64
    v_mfma_f32_16x16x32_bf16 v[52:55], v[76:79], v[140:143], v[52:55]
    ds_read_b64 v[106:107], v32 offset:72
    v_mfma_f32_16x16x32_bf16 v[60:63], v[76:79], v[144:147], v[60:63]
    ds_read_b64 v[108:109], v32 offset:96
    v_mfma_f32_16x16x32_bf16 v[68:71], v[76:79], v[148:151], v[68:71]
    ds_read_b64 v[110:111], v32 offset:104
    v_mfma_f32_16x16x32_bf16 v[48:51], v[80:83], v[136:139], v[48:51]
    ds_read_b64 v[112:113], v32 offset:1088
    v_mfma_f32_16x16x32_bf16 v[56:59], v[80:83], v[140:143], v[56:59]
    ds_read_b64 v[114:115], v32 offset:1096
    s_waitcnt lgkmcnt(10)
    v_mfma_f32_16x16x32_bf16 v[64:67], v[80:83], v[144:147], v[64:67]
    ds_read_b64 v[116:117], v32 offset:1120
    v_mfma_f32_16x16x32_bf16 v[52:55], v[84:87], v[136:139], v[52:55]
    ds_read_b64 v[118:119], v32 offset:1128
    v_mfma_f32_16x16x32_bf16 v[60:63], v[84:87], v[140:143], v[60:63]
    ds_read_b64 v[120:121], v32 offset:2112
    v_mfma_f32_16x16x32_bf16 v[68:71], v[84:87], v[144:147], v[68:71]
    ds_read_b64 v[122:123], v32 offset:2120
    v_mfma_f32_16x16x32_bf16 v[56:59], v[88:91], v[136:139], v[56:59]
    ds_read_b64 v[124:125], v32 offset:2144
    v_mfma_f32_16x16x32_bf16 v[64:67], v[88:91], v[140:143], v[64:67]
    ds_read_b64 v[126:127], v32 offset:2152
    v_mfma_f32_16x16x32_bf16 v[60:63], v[92:95], v[136:139], v[60:63]
    ds_read_b64 v[128:129], v32 offset:3136
    v_mfma_f32_16x16x32_bf16 v[68:71], v[92:95], v[140:143], v[68:71]
    ds_read_b64 v[130:131], v32 offset:3144
    v_mfma_f32_16x16x32_bf16 v[64:67], v[96:99], v[136:139], v[64:67]
    ds_read_b64 v[132:133], v32 offset:3168
    v_mfma_f32_16x16x32_bf16 v[68:71], v[100:103], v[136:139], v[68:71]
    ds_read_b64 v[134:135], v32 offset:3176
    s_waitcnt lgkmcnt(10)
    v_mfma_f32_16x16x32_bf16 v[40:43], v[104:107], v[152:155], v[40:43]
    ds_read_b128 v[136:139], v33 offset:21440
    v_mfma_f32_16x16x32_bf16 v[48:51], v[104:107], v[156:159], v[48:51]
    ds_read_b128 v[140:143], v33 offset:19904
    v_mfma_f32_16x16x32_bf16 v[56:59], v[104:107], v[160:163], v[56:59]
    ds_read_b128 v[144:147], v33 offset:18368
    v_mfma_f32_16x16x32_bf16 v[64:67], v[104:107], v[164:167], v[64:67]
    ds_read_b128 v[148:151], v33 offset:16832
    v_mfma_f32_16x16x32_bf16 v[44:47], v[108:111], v[152:155], v[44:47]
    ds_read_b64 v[72:73], v32 offset:128
    v_mfma_f32_16x16x32_bf16 v[52:55], v[108:111], v[156:159], v[52:55]
    ds_read_b64 v[74:75], v32 offset:136
    v_add_u32 v33, 192, v33
    v_mfma_f32_16x16x32_bf16 v[60:63], v[108:111], v[160:163], v[60:63]
    ds_read_b64 v[76:77], v32 offset:160
    s_add_u32 s43, s43, 1
    v_mfma_f32_16x16x32_bf16 v[68:71], v[108:111], v[164:167], v[68:71]
    ds_read_b64 v[78:79], v32 offset:168
    s_cmp_lt_u32 s43, 8
    v_mfma_f32_16x16x32_bf16 v[48:51], v[112:115], v[152:155], v[48:51]
    ds_read_b64 v[80:81], v32 offset:1152
    v_mfma_f32_16x16x32_bf16 v[56:59], v[112:115], v[156:159], v[56:59]
    ds_read_b64 v[82:83], v32 offset:1160
    s_waitcnt lgkmcnt(10)
    v_mfma_f32_16x16x32_bf16 v[64:67], v[112:115], v[160:163], v[64:67]
    ds_read_b64 v[84:85], v32 offset:1184
    v_mfma_f32_16x16x32_bf16 v[52:55], v[116:119], v[152:155], v[52:55]
    ds_read_b64 v[86:87], v32 offset:1192
    v_mfma_f32_16x16x32_bf16 v[60:63], v[116:119], v[156:159], v[60:63]
    ds_read_b64 v[88:89], v32 offset:2176
    v_mfma_f32_16x16x32_bf16 v[68:71], v[116:119], v[160:163], v[68:71]
    ds_read_b64 v[90:91], v32 offset:2184
    v_mfma_f32_16x16x32_bf16 v[56:59], v[120:123], v[152:155], v[56:59]
    ds_read_b64 v[92:93], v32 offset:2208
    v_mfma_f32_16x16x32_bf16 v[64:67], v[120:123], v[156:159], v[64:67]
    ds_read_b64 v[94:95], v32 offset:2216
    v_mfma_f32_16x16x32_bf16 v[60:63], v[124:127], v[152:155], v[60:63]
    ds_read_b64 v[96:97], v32 offset:3200
    v_mfma_f32_16x16x32_bf16 v[68:71], v[124:127], v[156:159], v[68:71]
    ds_read_b64 v[98:99], v32 offset:3208
    v_mfma_f32_16x16x32_bf16 v[64:67], v[128:131], v[152:155], v[64:67]
    ds_read_b64 v[100:101], v32 offset:3232
    v_mfma_f32_16x16x32_bf16 v[68:71], v[132:135], v[152:155], v[68:71]
    ds_read_b64 v[102:103], v32 offset:3240
    v_add_u32 v32, 128, v32
    s_cbranch_scc1 CV_l
    s_waitcnt lgkmcnt(0)
    v_cvt_pk_bf16_f32 v16, v40, v41
    v_cvt_pk_bf16_f32 v17, v42, v43
    ds_write_b64 v170, v[16:17] offset:0
    v_cvt_pk_bf16_f32 v18, v44, v45
    v_cvt_pk_bf16_f32 v19, v46, v47
    ds_write_b64 v170, v[18:19] offset:32
    v_cvt_pk_bf16_f32 v20, v48, v49
    v_cvt_pk_bf16_f32 v21, v50, v51
    ds_write_b64 v170, v[20:21] offset:1152
    v_cvt_pk_bf16_f32 v22, v52, v53
    v_cvt_pk_bf16_f32 v23, v54, v55
    ds_write_b64 v170, v[22:23] offset:1184
    v_cvt_pk_bf16_f32 v24, v56, v57
    v_cvt_pk_bf16_f32 v25, v58, v59
    ds_write_b64 v170, v[24:25] offset:2304
    v_cvt_pk_bf16_f32 v26, v60, v61
    v_cvt_pk_bf16_f32 v27, v62, v63
    ds_write_b64 v170, v[26:27] offset:2336
    v_cvt_pk_bf16_f32 v28, v64, v65
    v_cvt_pk_bf16_f32 v29, v66, v67
    ds_write_b64 v170, v[28:29] offset:3456
    v_cvt_pk_bf16_f32 v30, v68, v69
    v_cvt_pk_bf16_f32 v31, v70, v71
    ds_write_b64 v170, v[30:31] offset:3488
    v_mov_b32 v8, 162824
    v_mov_b32 v9, 1
    s_waitcnt lgkmcnt(0)
    s_mov_b64 exec, 1
    ds_add_u32 v8, v9
    s_mov_b64 exec, -1
    v_mov_b32 v8, 162824
spin_5:
    ds_read_b32 v9, v8
    s_waitcnt lgkmcnt(0)
    v_readfirstlane_b32 s53, v9
    s_nop 0
    s_cmp_ge_u32 s53, 4
    s_cbranch_scc0 spin_5
    ds_read_b64_tr_b16 v[104:105], v168 offset:0
    ds_read_b64_tr_b16 v[106:107], v168 offset:144
    ds_read_b64_tr_b16 v[108:109], v168 offset:288
    ds_read_b64_tr_b16 v[110:111], v168 offset:432
    ds_read_b64_tr_b16 v[112:113], v168 offset:576
    ds_read_b64_tr_b16 v[114:115], v168 offset:720
    ds_read_b64_tr_b16 v[116:117], v168 offset:864
    ds_read_b64_tr_b16 v[118:119], v168 offset:1008
    s_waitcnt lgkmcnt(7)
    v_or_b32 v104, v34, v104
    buffer_store_dwordx2 v[104:105], v169, s[12:15], s44 offen offset:0 sc1
    s_waitcnt lgkmcnt(6)
    v_or_b32 v106, v34, v106
    buffer_store_dwordx2 v[106:107], v169, s[12:15], s44 offen offset:512 sc1
    s_add_u32 s44, s44, 16777216
    s_waitcnt lgkmcnt(5)
    v_or_b32 v108, v34, v108
    buffer_store_dwordx2 v[108:109], v169, s[12:15], s44 offen offset:0 sc1
    s_waitcnt lgkmcnt(4)
    v_or_b32 v110, v34, v110
    buffer_store_dwordx2 v[110:111], v169, s[12:15], s44 offen offset:512 sc1
    s_add_u32 s44, s44, 16777216
    s_waitcnt lgkmcnt(3)
    v_or_b32 v112, v34, v112
    buffer_store_dwordx2 v[112:113], v169, s[12:15], s44 offen offset:0 sc1
    s_waitcnt lgkmcnt(2)
    v_or_b32 v114, v34, v114
    buffer_store_dwordx2 v[114:115], v169, s[12:15], s44 offen offset:512 sc1
    s_add_u32 s44, s44, 16777216
    s_waitcnt lgkmcnt(1)
    v_or_b32 v116, v34, v116
    buffer_store_dwordx2 v[116:117], v169, s[12:15], s44 offen offset:0 sc1
    s_waitcnt lgkmcnt(0)
    v_or_b32 v118, v34, v118
    buffer_store_dwordx2 v[118:119], v169, s[12:15], s44 offen offset:512 sc1
    s_add_u32 s44, s44, 16777216
    v_mov_b32 v8, 162836
    v_mov_b32 v9, 1
    s_mov_b64 exec, 1
    ds_add_u32 v8, v9
    s_mov_b64 exec, -1
    s_and_b32 s36, s2, 7
    s_lshl_b32 s36, s36, 7
    s_add_u32 s36, s36, 23101440
    v_mov_b32 v6, 1
    v_mov_b32 v7, 162820
    v_lshlrev_b32 v9, 10, v1
    s_mov_b64 exec, 1
    s_waitcnt vmcnt(0)
    s_waitcnt lgkmcnt(0)
    ds_add_rtn_u32 v8, v7, v6
    ds_read_b32 v10, v7 offset:28
    s_waitcnt lgkmcnt(0)
    v_readfirstlane_b32 s54, v8
    v_readfirstlane_b32 s53, v10
    s_cmp_lg_u32 s54, 15
    s_cbranch_scc1 fa_6
    s_mov_b64 exec, 0xffff
    s_or_b32 s53, s53, 1
    v_mov_b32 v6, s53
    buffer_atomic_add v6, v9, s[56:59], s36 offen sc1
fa_6:
    s_mov_b64 exec, -1
    s_branch FR_end
FR_b:
    s_getpc_b64 s[34:35]
K_tpc:
    s_lshl_b32 s36, s29, 2
    s_and_b32 s37, s28, 3
    s_add_u32 s36, s36, s37
    s_lshl_b32 s36, s36, 6
    s_add_u32 s36, s36, K_tab-K_tpc
    s_add_u32 s34, s34, s36
    s_addc_u32 s35, s35, 0
    v_and_b32 v248, 31, v1
    v_lshlrev_b32 v248, 1, v248
    global_load_ushort v251, v248, s[34:35]
    v_lshrrev_b32 v253, 3, v1
    v_lshlrev_b32 v238, 11, v253
    v_and_b32 v253, 6, v253
    v_and_b32 v254, 7, v1
    v_xor_b32 v253, v253, v254
    v_lshl_add_u32 v238, v253, 4, v238
    v_lshrrev_b32 v253, 4, v1
    v_lshlrev_b32 v239, 11, v253
    v_add_u32 v253, 0, v253
    v_lshlrev_b32 v253, 1, v253
    v_and_b32 v254, 15, v1
    v_xor_b32 v253, v253, v254
    v_lshl_add_u32 v239, v253, 4, v239
    v_lshrrev_b32 v253, 4, v1
    v_lshlrev_b32 v240, 11, v253
    v_add_u32 v253, 4, v253
    v_lshlrev_b32 v253, 1, v253
    v_and_b32 v254, 15, v1
    v_xor_b32 v253, v253, v254
    v_lshl_add_u32 v240, v253, 4, v240
    v_add_u32 v254, 0, v1
    v_mul_u32_u24 v253, 2341, v254
    v_lshrrev_b32 v253, 16, v253
    v_mul_u32_u24 v241, 28, v253
    v_sub_u32 v254, v254, v241
    v_mul_u32_u24 v241, 7168, v253
    v_lshrrev_b32 v253, 1, v253
    v_and_b32 v253, 2, v253
    v_xor_b32 v254, v254, v253
    v_lshl_add_u32 v241, v254, 4, v241
    v_add_u32 v254, 64, v1
    v_mul_u32_u24 v253, 2341, v254
    v_lshrrev_b32 v253, 16, v253
    v_mul_u32_u24 v242, 28, v253
    v_sub_u32 v254, v254, v242
    v_mul_u32_u24 v242, 7168, v253
    v_lshrrev_b32 v253, 1, v253
    v_and_b32 v253, 2, v253
    v_xor_b32 v254, v254, v253
    v_lshl_add_u32 v242, v254, 4, v242
    v_add_u32 v254, 128, v1
    v_mul_u32_u24 v253, 2341, v254
    v_lshrrev_b32 v253, 16, v253
    v_mul_u32_u24 v243, 28, v253
    v_sub_u32 v254, v254, v243
    v_mul_u32_u24 v243, 7168, v253
    v_lshrrev_b32 v253, 1, v253
    v_and_b32 v253, 2, v253
    v_xor_b32 v254, v254, v253
    v_lshl_add_u32 v243, v254, 4, v243
    v_add_u32 v254, 192, v1
    v_mul_u32_u24 v253, 2341, v254
    v_lshrrev_b32 v253, 16, v253
    v_mul_u32_u24 v244, 28, v253
    v_sub_u32 v254, v254, v244
    v_mul_u32_u24 v244, 7168, v253
    v_lshrrev_b32 v253, 1, v253
    v_and_b32 v253, 2, v253
    v_xor_b32 v254, v254, v253
    v_lshl_add_u32 v244, v254, 4, v244
    v_add_u32 v254, 256, v1
    v_mul_u32_u24 v253, 2341, v254
    v_lshrrev_b32 v253, 16, v253
    v_mul_u32_u24 v245, 28, v253
    v_sub_u32 v254, v254, v245
    v_mul_u32_u24 v245, 7168, v253
    v_lshrrev_b32 v253, 1, v253
    v_and_b32 v253, 2, v253
    v_xor_b32 v254, v254, v253
    v_lshl_add_u32 v245, v254, 4, v245
    v_add_u32 v254, 320, v1
    v_mul_u32_u24 v253, 2341, v254
    v_lshrrev_b32 v253, 16, v253
    v_mul_u32_u24 v246, 28, v253
    v_sub_u32 v254, v254, v246
    v_mul_u32_u24 v246, 7168, v253
    v_lshrrev_b32 v253, 1, v253
    v_and_b32 v253, 2, v253
    v_xor_b32 v254, v254, v253
    v_lshl_add_u32 v246, v254, 4, v246
    v_add_u32 v254, 384, v1
    v_mul_u32_u24 v253, 2341, v254
    v_lshrrev_b32 v253, 16, v253
    v_mul_u32_u24 v247, 28, v253
    v_sub_u32 v254, v254, v247
    v_mul_u32_u24 v247, 7168, v253
    v_lshrrev_b32 v253, 1, v253
    v_and_b32 v253, 2, v253
    v_xor_b32 v254, v254, v253
    v_lshl_add_u32 v247, v254, 4, v247
    s_cmp_ge_u32 s30, 6
    s_cbranch_scc1 FB_cs
    s_cmp_ge_u32 s2, 255
    s_cbranch_scc1 FB_np
    s_cmp_lg_u32 s30, 5
    s_cbranch_scc1 FB_np
    s_and_b32 s42, s2, 31
    s_lshl_b32 s42, s42, 8
    s_lshr_b32 s43, s2, 5
    s_lshl_b32 s43, s43, 14
    s_add_u32 s42, s42, s43
    s_add_u32 s42, s42, 39714816
    v_mov_b32 v14, 0
    s_mov_b64 exec, 1
    s_mov_b32 s46, -1
    s_mov_b32 s47, -1
    s_mov_b32 s43, 0
FB_ml:
    s_add_u32 s45, s42, 0
    s_memtime s[34:35]
    s_waitcnt lgkmcnt(0)
    buffer_load_dword v13, v14, s[56:59], s45 offen sc1
    s_waitcnt vmcnt(0)
    s_memtime s[36:37]
    s_waitcnt lgkmcnt(0)
    s_sub_u32 s36, s36, s34
    s_min_u32 s46, s46, s36
    s_add_u32 s45, s42, 8192
    s_memtime s[34:35]
    s_waitcnt lgkmcnt(0)
    buffer_load_dword v13, v14, s[56:59], s45 offen sc1
    s_waitcnt vmcnt(0)
    s_memtime s[36:37]
    s_waitcnt lgkmcnt(0)
    s_sub_u32 s36, s36, s34
    s_min_u32 s47, s47, s36
    s_add_u32 s42, s42, 128
    s_add_u32 s43, s43, 1
    s_cmp_lt_u32 s43, 2
    s_cbranch_scc1 FB_ml
    s_cmp_lt_u32 s47, s46
    s_cselect_b32 s45, 1, 0
    s_lshr_b32 s46, s28, 2
    s_xor_b32 s45, s45, s46
    s_and_b32 s45, s45, 1
    s_lshl_b32 s45, s45, 8
    s_mov_b64 exec, -1
    v_mov_b32 v6, 162848
    v_mov_b32 v7, s45
    s_waitcnt lgkmcnt(0)
    ds_write_b32 v6, v7
FB_np:
    s_cmp_lg_u32 s30, 4
    s_cbranch_scc1 FB_ni
    v_mov_b32 v12, s52
    s_lshr_b32 s53, s28, 3
    s_lshl_b32 s53, s53, 2
    s_and_b32 s54, s28, 3
    s_add_u32 s53, s53, s54
    s_lshl_b32 s53, s53, 24
    s_lshr_b32 s54, s28, 2
    s_xor_b32 s54, s54, s94
    s_and_b32 s54, s54, 1
    s_lshl_b32 s54, s54, 13
    s_add_u32 s37, s53, s54
    s_add_u32 s37, s37, 33554432
    s_andn2_b32 s37, s37, 0x2000
    s_lshl_b32 s53, s29, 7
    s_add_u32 s37, s37, s53
    s_add_u32 s37, s37, 6029312
    v_and_b32 v13, 1, v1
    v_lshlrev_b32 v13, 13, v13
    v_lshrrev_b32 v14, 1, v1
    v_lshl_add_u32 v13, v14, 22, v13
    s_mov_b64 exec, 0xf
    buffer_store_dword v12, v13, s[56:59], s37 offen sc1
    s_cmp_lg_u32 s28, 0
    s_cbranch_scc1 FB_n2
    s_add_u32 s37, s53, 23117824
    s_mov_b64 exec, 1
    buffer_store_dword v12, v13, s[56:59], s37 offen sc1
FB_n2:
    s_mov_b64 exec, -1
FB_ni:
    v_mov_b32 v6, 162836
spin_7:
    s_sleep 2
    ds_read_b32 v7, v6
    s_waitcnt lgkmcnt(0)
    v_readfirstlane_b32 s53, v7
    s_nop 0
    s_cmp_ge_u32 s53, 4
    s_cbranch_scc0 spin_7
    s_load_dwordx2 s[48:49], s[0:1], 64
    s_lshl_b32 s45, s2, 1
    s_and_b32 s50, s30, 1
    s_add_u32 s45, s45, s50
    s_mul_i32 s45, s45, 4096
    s_mov_b32 s50, 2097152
    s_mov_b32 s51, 0x20000
    s_waitcnt lgkmcnt(0)
    buffer_load_dwordx4 v[20:23], v2, s[48:51], s45 offen offset:0
    buffer_load_dwordx4 v[20:23], v2, s[48:51], s45 offen offset:1024
    buffer_load_dwordx4 v[20:23], v2, s[48:51], s45 offen offset:2048
    buffer_load_dwordx4 v[20:23], v2, s[48:51], s45 offen offset:3072
    s_and_b32 s36, s2, 7
    s_lshl_b32 s36, s36, 7
    s_add_u32 s36, s36, 23101440
    v_mov_b32 v6, 1
    v_mov_b32 v7, 162820
    v_lshlrev_b32 v9, 10, v1
    s_mov_b64 exec, 1
    s_waitcnt vmcnt(0)
    s_waitcnt lgkmcnt(0)
    ds_add_rtn_u32 v8, v7, v6
    ds_read_b32 v10, v7 offset:28
    s_waitcnt lgkmcnt(0)
    v_readfirstlane_b32 s54, v8
    v_readfirstlane_b32 s53, v10
    s_cmp_lg_u32 s54, 15
    s_cbranch_scc1 fa_8
    s_mov_b64 exec, 0xffff
    s_or_b32 s53, s53, 1
    v_mov_b32 v6, s53
    buffer_atomic_add v6, v9, s[56:59], s36 offen sc1
fa_8:
    s_mov_b64 exec, -1
    v_bfe_u32 v252, v251, 2, 2
    v_lshlrev_b32 v248, 14, v252
    v_and_b32 v252, 3, v251
    v_lshl_add_u32 v248, v252, 11, v248
    v_bfe_u32 v252, v251, 7, 3
    v_lshlrev_b32 v249, 14, v252
    v_bfe_u32 v252, v251, 4, 3
    v_lshl_add_u32 v249, v252, 10, v249
    v_bfe_u32 v252, v251, 13, 3
    v_lshlrev_b32 v250, 14, v252
    v_bfe_u32 v252, v251, 10, 3
    v_lshl_add_u32 v250, v252, 10, v250
    v_mov_b32 v6, 162840
spin_9:
    s_sleep 4
    ds_read_b32 v7, v6
    s_waitcnt lgkmcnt(0)
    v_readfirstlane_b32 s53, v7
    s_nop 0
    s_cmp_ge_u32 s53, 2
    s_cbranch_scc0 spin_9
    s_call_b64 s[76:77], SUB_w1_regs
    s_call_b64 s[76:77], SUB_park
    v_mov_b32 v6, 162840
spin_10:
    s_sleep 3
    ds_read_b32 v7, v6
    s_waitcnt lgkmcnt(0)
    v_readfirstlane_b32 s53, v7
    s_nop 0
    s_cmp_ge_u32 s53, 4
    s_cbranch_scc0 spin_10
    s_mov_b64 s[12:13], s[68:69]
    s_mov_b32 s14, 2097152
    s_mov_b32 s15, 0x20000
    s_and_b32 s35, s30, 1
    s_mul_i32 s38, s99, 128
    s_mul_i32 s41, s35, 65536
    s_add_u32 s38, s38, s41
    s_mul_i32 s41, s35, 4096
    s_add_u32 s41, s41, 24576
    s_mov_b32 s42, 0
    s_mov_b32 s44, s67
    s_mov_b32 s42, 73728
    s_mov_b32 s44, s67
    s_add_u32 s44, s44, 9
    s_and_b32 s44, s44, 15
    s_call_b64 s[76:77], SUB_w_issue_1
    s_waitcnt vmcnt(8)
    s_mov_b32 s42, 81920
    s_mov_b32 s44, s67
    s_add_u32 s44, s44, 10
    s_and_b32 s44, s44, 15
    s_call_b64 s[76:77], SUB_w_issue_1
    s_waitcnt vmcnt(8)
    s_mov_b32 s42, 90112
    s_mov_b32 s44, s67
    s_add_u32 s44, s44, 11
    s_and_b32 s44, s44, 15
    s_call_b64 s[76:77], SUB_w_issue_1
    s_waitcnt vmcnt(8)
    s_call_b64 s[76:77], SUB_w1_put
    s_branch FR_end
FB_cs:
    v_and_b32 v164, 15, v1
    v_mov_b32 v165, 0x3f803f80
    v_cmp_eq_u32 vcc, 0, v164
    s_nop 1
    v_cndmask_b32 v16, 0, v165, vcc
    v_cndmask_b32 v17, 0, v165, vcc
    v_cndmask_b32 v18, 0, v165, vcc
    v_cndmask_b32 v19, 0, v165, vcc
    v_cmp_eq_u32 vcc, 1, v164
    s_nop 1
    v_cndmask_b32 v20, 0, v165, vcc
    v_cndmask_b32 v21, 0, v165, vcc
    v_cndmask_b32 v22, 0, v165, vcc
    v_cndmask_b32 v23, 0, v165, vcc
    v_cmp_eq_u32 vcc, 2, v164
    s_nop 1
    v_cndmask_b32 v24, 0, v165, vcc
    v_cndmask_b32 v25, 0, v165, vcc
    v_cndmask_b32 v26, 0, v165, vcc
    v_cndmask_b32 v27, 0, v165, vcc
    v_cmp_eq_u32 vcc, 3, v164
    s_nop 1
    v_cndmask_b32 v28, 0, v165, vcc
    v_cndmask_b32 v29, 0, v165, vcc
    v_cndmask_b32 v30, 0, v165, vcc
    v_cndmask_b32 v31, 0, v165, vcc
    v_cmp_eq_u32 vcc, 4, v164
    s_nop 1
    v_cndmask_b32 v32, 0, v165, vcc
    v_cndmask_b32 v33, 0, v165, vcc
    v_cndmask_b32 v34, 0, v165, vcc
    v_cndmask_b32 v35, 0, v165, vcc
    v_cmp_eq_u32 vcc, 5, v164
    s_nop 1
    v_cndmask_b32 v36, 0, v165, vcc
    v_cndmask_b32 v37, 0, v165, vcc
    v_cndmask_b32 v38, 0, v165, vcc
    v_cndmask_b32 v39, 0, v165, vcc
    v_cmp_eq_u32 vcc, 6, v164
    s_nop 1
    v_cndmask_b32 v40, 0, v165, vcc
    v_cndmask_b32 v41, 0, v165, vcc
    v_cndmask_b32 v42, 0, v165, vcc
    v_cndmask_b32 v43, 0, v165, vcc
    v_cmp_eq_u32 vcc, 7, v164
    s_nop 1
    v_cndmask_b32 v44, 0, v165, vcc
    v_cndmask_b32 v45, 0, v165, vcc
    v_cndmask_b32 v46, 0, v165, vcc
    v_cndmask_b32 v47, 0, v165, vcc
    v_cmp_eq_u32 vcc, 8, v164
    s_nop 1
    v_cndmask_b32 v48, 0, v165, vcc
    v_cndmask_b32 v49, 0, v165, vcc
    v_cndmask_b32 v50, 0, v165, vcc
    v_cndmask_b32 v51, 0, v165, vcc
    v_cmp_eq_u32 vcc, 9, v164
    s_nop 1
    v_cndmask_b32 v52, 0, v165, vcc
    v_cndmask_b32 v53, 0, v165, vcc
    v_cndmask_b32 v54, 0, v165, vcc
    v_cndmask_b32 v55, 0, v165, vcc
    v_cmp_eq_u32 vcc, 10, v164
    s_nop 1
    v_cndmask_b32 v56, 0, v165, vcc
    v_cndmask_b32 v57, 0, v165, vcc
    v_cndmask_b32 v58, 0, v165, vcc
    v_cndmask_b32 v59, 0, v165, vcc
    v_cmp_eq_u32 vcc, 11, v164
    s_nop 1
    v_cndmask_b32 v60, 0, v165, vcc
    v_cndmask_b32 v61, 0, v165, vcc
    v_cndmask_b32 v62, 0, v165, vcc
    v_cndmask_b32 v63, 0, v165, vcc
    v_cmp_eq_u32 vcc, 12, v164
    s_nop 1
    v_cndmask_b32 v64, 0, v165, vcc
    v_cndmask_b32 v65, 0, v165, vcc
    v_cndmask_b32 v66, 0, v165, vcc
    v_cndmask_b32 v67, 0, v165, vcc
    v_cmp_eq_u32 vcc, 13, v164
    s_nop 1
    v_cndmask_b32 v68, 0, v165, vcc
    v_cndmask_b32 v69, 0, v165, vcc
    v_cndmask_b32 v70, 0, v165, vcc
    v_cndmask_b32 v71, 0, v165, vcc
    s_mov_b32 s35, 0
    v_lshrrev_b32 v253, 2, v1
    v_mul_u32_u24 v144, 128, v253
    v_and_b32 v254, 3, v1
    v_lshl_add_u32 v144, v254, 3, v144
    v_add_u32 v144, 24576, v144
    v_bfe_u32 v253, v253, 1, 2
    s_mul_i32 s36, s35, 4
    s_add_u32 s36, s36, 3
    v_xor_b32 v254, s36, v253
    v_lshl_add_u32 v147, v254, 5, v144
    s_mul_i32 s36, s35, 4
    s_add_u32 s36, s36, 2
    v_xor_b32 v254, s36, v253
    v_lshl_add_u32 v146, v254, 5, v144
    s_mul_i32 s36, s35, 4
    s_add_u32 s36, s36, 1
    v_xor_b32 v254, s36, v253
    v_lshl_add_u32 v145, v254, 5, v144
    s_mul_i32 s36, s35, 4
    s_add_u32 s36, s36, 0
    v_xor_b32 v254, s36, v253
    v_lshl_add_u32 v144, v254, 5, v144
    s_and_b32 s35, s30, 1
    s_mul_i32 s35, s35, 4096
    s_add_u32 s35, s35, 73728
    v_add_u32 v144, s35, v144
    v_add_u32 v145, s35, v145
    v_add_u32 v146, s35, v146
    v_add_u32 v147, s35, v147
    s_mov_b32 s35, 0
    v_lshrrev_b32 v253, 2, v1
    v_mul_u32_u24 v148, 448, v253
    v_and_b32 v254, 3, v1
    v_lshl_add_u32 v148, v254, 3, v148
    v_add_u32 v148, 73728, v148
    s_mul_i32 s36, s35, 224
    v_add_u32 v148, s36, v148
    v_bfe_u32 v253, v1, 4, 1
    v_lshlrev_b32 v253, 5, v253
    s_cmp_eq_u32 s35, 0
    s_cselect_b32 s36, 1, -1
    v_mul_lo_u32 v253, v253, s36
    v_sub_u32 v149, v148, v253
    v_add_u32 v148, v148, v253
    s_and_b32 s35, s30, 1
    s_mul_i32 s35, s35, 14336
    s_add_u32 s35, s35, 32768
    v_add_u32 v148, s35, v148
    v_add_u32 v149, s35, v149
    s_mov_b32 s35, 1
    v_lshrrev_b32 v253, 2, v1
    v_mul_u32_u24 v150, 448, v253
    v_and_b32 v254, 3, v1
    v_lshl_add_u32 v150, v254, 3, v150
    v_add_u32 v150, 73728, v150
    s_mul_i32 s36, s35, 224
    v_add_u32 v150, s36, v150
    v_bfe_u32 v253, v1, 4, 1
    v_lshlrev_b32 v253, 5, v253
    s_cmp_eq_u32 s35, 0
    s_cselect_b32 s36, 1, -1
    v_mul_lo_u32 v253, v253, s36
    v_sub_u32 v151, v150, v253
    v_add_u32 v150, v150, v253
    s_and_b32 s35, s30, 1
    s_mul_i32 s35, s35, 14336
    s_add_u32 s35, s35, 32768
    v_add_u32 v150, s35, v150
    v_add_u32 v151, s35, v151
    v_mov_b32 v156, 0
    v_mov_b32 v157, 0
    v_mov_b32 v158, 0
    v_mov_b32 v159, 0
    v_mov_b32 v160, 0
    v_mov_b32 v161, 0
    v_mov_b32 v162, 0
    v_mov_b32 v163, 0
    v_lshrrev_b32 v166, 4, v1
    v_lshlrev_b32 v166, 4, v166
    v_lshl_add_u32 v166, v164, 6, v166
    v_mov_b32 v165, 0x7f000000
    v_cmp_gt_u32 vcc, 4, v164
    s_nop 1
    v_cndmask_b32 v167, v165, v166, vcc
    v_cmp_gt_u32 vcc, 14, v164
    s_nop 1
    v_cndmask_b32 v168, v165, v166, vcc
    v_mov_b32 v6, 162836
spin_11:
    s_sleep 2
    ds_read_b32 v7, v6
    s_waitcnt lgkmcnt(0)
    v_readfirstlane_b32 s53, v7
    s_nop 0
    s_cmp_ge_u32 s53, 4
    s_cbranch_scc0 spin_11
    s_mov_b64 s[12:13], s[68:69]
    s_mov_b32 s14, 2097152
    s_mov_b32 s15, 0x20000
    s_and_b32 s35, s30, 1
    s_mul_i32 s38, s99, 128
    s_mul_i32 s41, s35, 65536
    s_add_u32 s38, s38, s41
    s_mul_i32 s41, s35, 4096
    s_add_u32 s41, s41, 24576
    s_mov_b32 s42, 0
    s_mov_b32 s44, s67
    s_mov_b32 s42, 73728
    s_mov_b32 s44, s28
    s_add_u32 s19, s41, s42
    s_mul_i32 s16, s44, 131072
    s_add_u32 s16, s16, s38
    s_add_u32 s44, s44, 1
    s_and_b32 s44, s44, 15
    s_add_u32 s42, s42, 8192
    s_cmp_eq_u32 s42, 131072
    s_cselect_b32 s42, 0, s42
    s_mov_b32 m0, s19
    s_mov_b32 s39, s16
    buffer_load_dwordx4 v238, s[12:15], s39 offen lds
    s_add_u32 m0, m0, 1024
    s_add_u32 s39, s39, 16384
    buffer_load_dwordx4 v238, s[12:15], s39 offen lds
    s_add_u32 m0, m0, 1024
    s_add_u32 s39, s39, 16384
    buffer_load_dwordx4 v238, s[12:15], s39 offen lds
    s_add_u32 m0, m0, 1024
    s_add_u32 s39, s39, 16384
    buffer_load_dwordx4 v238, s[12:15], s39 offen lds
    s_mov_b64 s[12:13], s[72:73]
    s_mov_b32 s14, 7340032
    s_mov_b32 s15, 0x20000
    s_and_b32 s35, s30, 1
    s_mul_i32 s38, s29, 448
    s_mul_i32 s41, s35, 229376
    s_add_u32 s38, s38, s41
    s_mul_i32 s41, s35, 14336
    s_add_u32 s41, s41, 73728
    s_mov_b32 s42, 0
    s_mov_b32 s44, 0
    s_mov_b32 s42, 32768
    s_mov_b32 s44, s28
    s_add_u32 s19, s41, s42
    s_mul_i32 s16, s44, 458752
    s_add_u32 s16, s16, s38
    s_add_u32 s44, s44, 1
    s_and_b32 s44, s44, 15
    s_add_u32 s42, s42, 28672
    s_cmp_eq_u32 s42, 86016
    s_cselect_b32 s42, 0, s42
    s_mov_b32 m0, s19
    s_mov_b32 s39, s16
    buffer_load_dwordx4 v241, s[12:15], s39 offen lds
    s_add_u32 m0, m0, 1024
    s_nop 0
    buffer_load_dwordx4 v242, s[12:15], s39 offen lds
    s_add_u32 m0, m0, 1024
    s_nop 0
    buffer_load_dwordx4 v243, s[12:15], s39 offen lds
    s_add_u32 m0, m0, 1024
    s_nop 0
    buffer_load_dwordx4 v244, s[12:15], s39 offen lds
    s_add_u32 m0, m0, 1024
    s_nop 0
    buffer_load_dwordx4 v245, s[12:15], s39 offen lds
    s_add_u32 m0, m0, 1024
    s_nop 0
    buffer_load_dwordx4 v246, s[12:15], s39 offen lds
    s_add_u32 m0, m0, 1024
    s_nop 0
    buffer_load_dwordx4 v247, s[12:15], s39 offen lds
    s_add_u32 m0, m0, 1024
    s_add_u32 s39, s39, 114688
    buffer_load_dwordx4 v241, s[12:15], s39 offen lds
    s_add_u32 m0, m0, 1024
    s_nop 0
    buffer_load_dwordx4 v242, s[12:15], s39 offen lds
    s_add_u32 m0, m0, 1024
    s_nop 0
    buffer_load_dwordx4 v243, s[12:15], s39 offen lds
    s_add_u32 m0, m0, 1024
    s_nop 0
    buffer_load_dwordx4 v244, s[12:15], s39 offen lds
    s_add_u32 m0, m0, 1024
    s_nop 0
    buffer_load_dwordx4 v245, s[12:15], s39 offen lds
    s_add_u32 m0, m0, 1024
    s_nop 0
    buffer_load_dwordx4 v246, s[12:15], s39 offen lds
    s_add_u32 m0, m0, 1024
    s_nop 0
    buffer_load_dwordx4 v247, s[12:15], s39 offen lds
    s_waitcnt vmcnt(14)
    s_setprio 1
    ds_read_b64_tr_b16 v[128:129], v144 offset:0
    ds_read_b64_tr_b16 v[130:131], v144 offset:2048
    ds_read_b64_tr_b16 v[132:133], v145 offset:0
    ds_read_b64_tr_b16 v[134:135], v145 offset:2048
    ds_read_b64_tr_b16 v[136:137], v146 offset:0
    ds_read_b64_tr_b16 v[138:139], v146 offset:2048
    ds_read_b64_tr_b16 v[140:141], v147 offset:0
    ds_read_b64_tr_b16 v[142:143], v147 offset:2048
    s_add_u32 s20, s4, 0x1400000
    s_addc_u32 s21, s5, 0
    s_mov_b32 s22, 0x20000
    s_mov_b32 s23, 0x20000
    s_lshl_b32 s35, s28, 1
    s_and_b32 s36, s30, 1
    s_add_u32 s35, s35, s36
    s_mul_i32 s35, s35, 4096
    s_mul_i32 s36, s29, 256
    s_add_u32 s35, s35, s36
    s_waitcnt lgkmcnt(0)
    v_mfma_f32_16x16x32_bf16 v[160:163], v[128:131], v[16:19], v[160:163]
    v_mfma_f32_16x16x32_bf16 v[160:163], v[132:135], v[20:23], v[160:163]
    v_mfma_f32_16x16x32_bf16 v[160:163], v[136:139], v[24:27], v[160:163]
    v_mfma_f32_16x16x32_bf16 v[160:163], v[140:143], v[28:31], v[160:163]
    s_nop 7
    buffer_store_dwordx4 v[160:163], v167, s[20:23], s35 offen sc1
    s_waitcnt vmcnt(1)
    v_mov_b32 v6, 162840
    v_mov_b32 v7, 1
    s_mov_b64 exec, 1
    ds_add_u32 v6, v7
    s_mov_b64 exec, -1
    ds_read_b64_tr_b16 v[72:73], v148 offset:0
    ds_read_b64_tr_b16 v[74:75], v148 offset:7168
    ds_read_b64_tr_b16 v[76:77], v149 offset:32
    ds_read_b64_tr_b16 v[78:79], v149 offset:7200
    ds_read_b64_tr_b16 v[80:81], v148 offset:64
    ds_read_b64_tr_b16 v[82:83], v148 offset:7232
    ds_read_b64_tr_b16 v[84:85], v149 offset:96
    ds_read_b64_tr_b16 v[86:87], v149 offset:7264
    ds_read_b64_tr_b16 v[88:89], v148 offset:128
    ds_read_b64_tr_b16 v[90:91], v148 offset:7296
    ds_read_b64_tr_b16 v[92:93], v149 offset:160
    ds_read_b64_tr_b16 v[94:95], v149 offset:7328
    ds_read_b64_tr_b16 v[96:97], v148 offset:192
    ds_read_b64_tr_b16 v[98:99], v148 offset:7360
    ds_read_b64_tr_b16 v[100:101], v150 offset:0
    ds_read_b64_tr_b16 v[102:103], v150 offset:7168
    ds_read_b64_tr_b16 v[104:105], v151 offset:32
    ds_read_b64_tr_b16 v[106:107], v151 offset:7200
    ds_read_b64_tr_b16 v[108:109], v150 offset:64
    ds_read_b64_tr_b16 v[110:111], v150 offset:7232
    ds_read_b64_tr_b16 v[112:113], v151 offset:96
    ds_read_b64_tr_b16 v[114:115], v151 offset:7264
    ds_read_b64_tr_b16 v[116:117], v150 offset:128
    ds_read_b64_tr_b16 v[118:119], v150 offset:7296
    ds_read_b64_tr_b16 v[120:121], v151 offset:160
    ds_read_b64_tr_b16 v[122:123], v151 offset:7328
    ds_read_b64_tr_b16 v[124:125], v150 offset:192
    ds_read_b64_tr_b16 v[126:127], v150 offset:7360
    s_add_u32 s20, s4, 0x1420000
    s_addc_u32 s21, s5, 0
    s_mov_b32 s22, 0x70000
    s_mov_b32 s23, 0x20000
    s_lshl_b32 s35, s28, 1
    s_and_b32 s36, s30, 1
    s_add_u32 s35, s35, s36
    s_mul_i32 s35, s35, 14336
    s_mul_i32 s36, s29, 896
    s_add_u32 s35, s35, s36
    s_waitcnt lgkmcnt(0)
    v_mfma_f32_16x16x32_bf16 v[156:159], v[72:75], v[16:19], v[156:159]
    v_mfma_f32_16x16x32_bf16 v[156:159], v[76:79], v[20:23], v[156:159]
    v_mfma_f32_16x16x32_bf16 v[156:159], v[80:83], v[24:27], v[156:159]
    v_mfma_f32_16x16x32_bf16 v[156:159], v[84:87], v[28:31], v[156:159]
    v_mfma_f32_16x16x32_bf16 v[156:159], v[88:91], v[32:35], v[156:159]
    v_mfma_f32_16x16x32_bf16 v[156:159], v[92:95], v[36:39], v[156:159]
    v_mfma_f32_16x16x32_bf16 v[156:159], v[96:99], v[40:43], v[156:159]
    v_mfma_f32_16x16x32_bf16 v[156:159], v[100:103], v[44:47], v[156:159]
    v_mfma_f32_16x16x32_bf16 v[156:159], v[104:107], v[48:51], v[156:159]
    v_mfma_f32_16x16x32_bf16 v[156:159], v[108:111], v[52:55], v[156:159]
    v_mfma_f32_16x16x32_bf16 v[156:159], v[112:115], v[56:59], v[156:159]
    v_mfma_f32_16x16x32_bf16 v[156:159], v[116:119], v[60:63], v[156:159]
    v_mfma_f32_16x16x32_bf16 v[156:159], v[120:123], v[64:67], v[156:159]
    v_mfma_f32_16x16x32_bf16 v[156:159], v[124:127], v[68:71], v[156:159]
    s_nop 7
    buffer_store_dwordx4 v[156:159], v168, s[20:23], s35 offen sc1
    s_and_b32 s36, s2, 7
    s_lshl_b32 s36, s36, 7
    s_add_u32 s36, s36, 23101440
    v_mov_b32 v6, 1
    v_mov_b32 v7, 162820
    v_lshlrev_b32 v9, 10, v1
    s_mov_b64 exec, 1
    s_waitcnt lgkmcnt(0)
    ds_add_rtn_u32 v8, v7, v6
    ds_read_b32 v10, v7 offset:28
    s_waitcnt lgkmcnt(0)
    v_readfirstlane_b32 s54, v8
    v_readfirstlane_b32 s53, v10
    s_cmp_lg_u32 s54, 15
    s_cbranch_scc1 fa_12
    s_mov_b64 exec, 0xffff
    s_or_b32 s53, s53, 1
    v_mov_b32 v6, s53
    buffer_atomic_add v6, v9, s[56:59], s36 offen sc1
fa_12:
    s_mov_b64 exec, -1
    v_and_b32 v252, 15, v251
    v_mul_u32_u24 v248, 458752, v252
    s_and_b32 s36, s30, 1
    s_mul_i32 s36, s36, 6
    s_add_u32 s36, s36, 4
    v_bfe_u32 v252, v251, s36, 6
    v_mul_u32_u24 v250, 37, v252
    v_lshrrev_b32 v250, 8, v250
    v_mul_u32_u24 v250, 7, v250
    v_sub_u32 v250, v252, v250
    v_cmp_eq_u32 vcc, 3, v250
    s_nop 1
    v_cndmask_b32 v250, 0, 1, vcc
    v_lshl_add_u32 v249, v252, 16, v250
    v_mov_b32 v6, 162840
    v_mov_b32 v7, 1
    s_mov_b64 exec, 1
    ds_add_u32 v6, v7
    s_mov_b64 exec, -1
    s_setprio 0
    s_call_b64 s[76:77], SUB_w1_regs
    s_call_b64 s[76:77], SUB_park
    v_mov_b32 v6, 162840
spin_13:
    s_sleep 3
    ds_read_b32 v7, v6
    s_waitcnt lgkmcnt(0)
    v_readfirstlane_b32 s53, v7
    s_nop 0
    s_cmp_ge_u32 s53, 4
    s_cbranch_scc0 spin_13
    s_mov_b64 s[12:13], s[68:69]
    s_mov_b32 s14, 2097152
    s_mov_b32 s15, 0x20000
    s_and_b32 s35, s30, 1
    s_mul_i32 s38, s99, 128
    s_mul_i32 s41, s35, 65536
    s_add_u32 s38, s38, s41
    s_mul_i32 s41, s35, 4096
    s_add_u32 s41, s41, 24576
    s_mov_b32 s42, 0
    s_mov_b32 s44, s67
    s_mov_b32 s42, 98304
    s_mov_b32 s44, s67
    s_add_u32 s44, s44, 12
    s_and_b32 s44, s44, 15
    s_call_b64 s[76:77], SUB_w_issue_1
    s_waitcnt vmcnt(8)
    s_mov_b32 s42, 106496
    s_mov_b32 s44, s67
    s_add_u32 s44, s44, 13
    s_and_b32 s44, s44, 15
    s_call_b64 s[76:77], SUB_w_issue_1
    s_waitcnt vmcnt(8)
    s_mov_b32 s42, 114688
    s_mov_b32 s44, s67
    s_add_u32 s44, s44, 14
    s_and_b32 s44, s44, 15
    s_call_b64 s[76:77], SUB_w_issue_1
    s_waitcnt vmcnt(8)
    s_mov_b32 s42, 122880
    s_mov_b32 s44, s67
    s_add_u32 s44, s44, 15
    s_and_b32 s44, s44, 15
    s_call_b64 s[76:77], SUB_w_issue_1
    s_waitcnt vmcnt(8)
    s_call_b64 s[76:77], SUB_w1_put
FR_end:
LAYER:
    v_lshlrev_b32 v40, 6, v199
    v_add_u32 v40, 161792, v40
    s_lshl_b32 s35, s30, 3
    v_add_u32 v39, s35, v40
    s_cmp_eq_u32 s60, 0
    s_cbranch_scc1 R_l0
    s_sub_u32 s8, s62, 0x400000
    s_subb_u32 s9, s63, 0
    s_mov_b32 s10, 0x7e000
    s_mov_b32 s11, 0x20000
    s_sub_u32 s12, s62, 0x380000
    s_subb_u32 s13, s63, 0
    s_mov_b32 s14, 0x7e000
    s_mov_b32 s15, 0x20000
    s_mov_b32 s20, s62
    s_mov_b32 s21, s63
    s_mov_b32 s22, 0x7e000
    s_mov_b32 s23, 0x20000
    s_mov_b32 s78, 0x3f80
    s_mov_b32 s79, 0x3f800000
    v_lshlrev_b32 v222, 16, v230
    v_and_b32 v223, 0xffff0000, v230
    v_lshlrev_b32 v206, 16, v180
    v_and_b32 v207, 0xffff0000, v180
    v_lshlrev_b32 v12, 16, v188
    v_and_b32 v13, 0xffff0000, v188
    v_pk_add_f32 v[206:207], v[206:207], v[12:13]
    v_lshlrev_b32 v224, 16, v231
    v_and_b32 v225, 0xffff0000, v231
    v_lshlrev_b32 v208, 16, v181
    v_and_b32 v209, 0xffff0000, v181
    v_lshlrev_b32 v14, 16, v189
    v_and_b32 v15, 0xffff0000, v189
    v_pk_add_f32 v[208:209], v[208:209], v[14:15]
    v_lshlrev_b32 v226, 16, v232
    v_and_b32 v227, 0xffff0000, v232
    v_lshlrev_b32 v210, 16, v182
    v_and_b32 v211, 0xffff0000, v182
    v_lshlrev_b32 v16, 16, v190
    v_and_b32 v17, 0xffff0000, v190
    v_pk_add_f32 v[210:211], v[210:211], v[16:17]
    v_lshlrev_b32 v228, 16, v233
    v_and_b32 v229, 0xffff0000, v233
    v_lshlrev_b32 v212, 16, v183
    v_and_b32 v213, 0xffff0000, v183
    v_lshlrev_b32 v18, 16, v191
    v_and_b32 v19, 0xffff0000, v191
    v_pk_add_f32 v[212:213], v[212:213], v[18:19]
    v_lshlrev_b32 v230, 16, v234
    v_and_b32 v231, 0xffff0000, v234
    v_lshlrev_b32 v214, 16, v184
    v_and_b32 v215, 0xffff0000, v184
    v_lshlrev_b32 v20, 16, v192
    v_and_b32 v21, 0xffff0000, v192
    v_pk_add_f32 v[214:215], v[214:215], v[20:21]
    v_lshlrev_b32 v232, 16, v235
    v_and_b32 v233, 0xffff0000, v235
    v_lshlrev_b32 v216, 16, v185
    v_and_b32 v217, 0xffff0000, v185
    v_lshlrev_b32 v22, 16, v193
    v_and_b32 v23, 0xffff0000, v193
    v_pk_add_f32 v[216:217], v[216:217], v[22:23]
    v_lshlrev_b32 v234, 16, v236
    v_and_b32 v235, 0xffff0000, v236
    v_lshlrev_b32 v218, 16, v186
    v_and_b32 v219, 0xffff0000, v186
    v_lshlrev_b32 v24, 16, v194
    v_and_b32 v25, 0xffff0000, v194
    v_pk_add_f32 v[218:219], v[218:219], v[24:25]
    v_lshlrev_b32 v236, 16, v237
    v_and_b32 v237, 0xffff0000, v237
    v_lshlrev_b32 v220, 16, v187
    v_and_b32 v221, 0xffff0000, v187
    v_lshlrev_b32 v26, 16, v195
    v_and_b32 v27, 0xffff0000, v195
    v_pk_add_f32 v[220:221], v[220:221], v[26:27]
    s_mov_b32 s53, 0
    s_sleep 10
    s_cmp_ge_u32 s30, 6
    s_cbranch_scc1 dp_14
    s_sleep 14
dp_14:
    buffer_load_dwordx4 v[180:183], v196, s[8:11], 0 offen offset:0 sc1
    buffer_load_dwordx4 v[188:191], v196, s[12:15], 0 offen offset:0 sc1
    buffer_load_dwordx4 v[184:187], v196, s[8:11], 0 offen offset:2048 sc1
    buffer_load_dwordx4 v[192:195], v196, s[12:15], 0 offen offset:2048 sc1
    s_waitcnt vmcnt(0)
    v_bitop3_b32 v6, v180, v184, v188 bitop3:0x80
    v_bitop3_b32 v6, v6, v192, 1 bitop3:0x80
    v_cmp_eq_u32 vcc, 0, v6
    s_cbranch_vccz dq_15
    s_sleep 4
    s_add_u32 s53, s53, 1
    s_cmp_lt_u32 s53, s61
    s_cbranch_scc1 dp_14
    s_mov_b32 s61, 0
dq_15:
    v_dot2_f32_bf16 v206, v180, s78, v206
    v_dot2_f32_bf16 v207, v180, s79, v207
    v_dot2_f32_bf16 v208, v181, s78, v208
    v_dot2_f32_bf16 v209, v181, s79, v209
    v_dot2_f32_bf16 v210, v182, s78, v210
    v_dot2_f32_bf16 v211, v182, s79, v211
    v_dot2_f32_bf16 v212, v183, s78, v212
    v_dot2_f32_bf16 v213, v183, s79, v213
    v_dot2_f32_bf16 v214, v184, s78, v214
    v_dot2_f32_bf16 v215, v184, s79, v215
    v_dot2_f32_bf16 v216, v185, s78, v216
    v_dot2_f32_bf16 v217, v185, s79, v217
    v_dot2_f32_bf16 v218, v186, s78, v218
    v_dot2_f32_bf16 v219, v186, s79, v219
    v_dot2_f32_bf16 v220, v187, s78, v220
    v_dot2_f32_bf16 v221, v187, s79, v221
    v_dot2_f32_bf16 v206, v188, s78, v206
    v_dot2_f32_bf16 v207, v188, s79, v207
    v_dot2_f32_bf16 v208, v189, s78, v208
    v_dot2_f32_bf16 v209, v189, s79, v209
    v_dot2_f32_bf16 v210, v190, s78, v210
    v_dot2_f32_bf16 v211, v190, s79, v211
    v_dot2_f32_bf16 v212, v191, s78, v212
    v_dot2_f32_bf16 v213, v191, s79, v213
    v_dot2_f32_bf16 v214, v192, s78, v214
    v_dot2_f32_bf16 v215, v192, s79, v215
    v_dot2_f32_bf16 v216, v193, s78, v216
    v_dot2_f32_bf16 v217, v193, s79, v217
    v_dot2_f32_bf16 v218, v194, s78, v218
    v_dot2_f32_bf16 v219, v194, s79, v219
    v_dot2_f32_bf16 v220, v195, s78, v220
    v_dot2_f32_bf16 v221, v195, s79, v221
    s_nop 2
    v_pk_add_f32 v[32:33], v[206:207], v[208:209]
    v_pk_mul_f32 v[34:35], v[206:207], v[206:207]
    v_pk_fma_f32 v[34:35], v[208:209], v[208:209], v[34:35]
    v_pk_add_f32 v[32:33], v[32:33], v[210:211]
    v_pk_fma_f32 v[34:35], v[210:211], v[210:211], v[34:35]
    v_pk_add_f32 v[32:33], v[32:33], v[212:213]
    v_pk_fma_f32 v[34:35], v[212:213], v[212:213], v[34:35]
    v_pk_add_f32 v[32:33], v[32:33], v[214:215]
    v_pk_fma_f32 v[34:35], v[214:215], v[214:215], v[34:35]
    v_pk_add_f32 v[32:33], v[32:33], v[216:217]
    v_pk_fma_f32 v[34:35], v[216:217], v[216:217], v[34:35]
    v_pk_add_f32 v[32:33], v[32:33], v[218:219]
    v_pk_fma_f32 v[34:35], v[218:219], v[218:219], v[34:35]
    v_pk_add_f32 v[32:33], v[32:33], v[220:221]
    v_pk_fma_f32 v[34:35], v[220:221], v[220:221], v[34:35]
    v_add_f32 v30, v32, v33
    v_add_f32 v31, v34, v35
    s_nop 0
    v_add_f32_dpp v30, v30, v30 row_ror:8 row_mask:0xf bank_mask:0xf
    v_add_f32_dpp v31, v31, v31 row_ror:8 row_mask:0xf bank_mask:0xf
    v_mov_b32 v32, v30
    v_mov_b32 v33, v31
    s_nop 0
    v_permlane16_swap_b32 v30, v32
    v_permlane16_swap_b32 v31, v33
    v_pk_add_f32 v[30:31], v[30:31], v[32:33]
    v_mov_b32 v32, v30
    v_mov_b32 v33, v31
    s_nop 0
    v_permlane32_swap_b32 v30, v32
    v_permlane32_swap_b32 v31, v33
    v_pk_add_f32 v[30:31], v[30:31], v[32:33]
    ds_write_b64 v39, v[30:31] offset:0
    s_waitcnt lgkmcnt(0)
    s_barrier
    ds_read_b128 v[12:15], v40 offset:0
    ds_read_b128 v[16:19], v40 offset:16
    ds_read_b128 v[20:23], v40 offset:32
    ds_read_b128 v[24:27], v40 offset:48
    s_waitcnt lgkmcnt(0)
    v_pk_add_f32 v[12:13], v[12:13], v[14:15]
    v_pk_add_f32 v[16:17], v[16:17], v[18:19]
    v_pk_add_f32 v[20:21], v[20:21], v[22:23]
    v_pk_add_f32 v[24:25], v[24:25], v[26:27]
    v_pk_add_f32 v[12:13], v[12:13], v[16:17]
    v_pk_add_f32 v[20:21], v[20:21], v[24:25]
    v_pk_add_f32 v[12:13], v[12:13], v[20:21]
    v_mul_f32 v36, 0x3a800000, v12
    v_mul_f32 v38, 0x3a800000, v13
    v_fma_f32 v38, -v36, v36, v38
    v_max_f32 v38, 0, v38
    v_add_f32 v38, 0x3727c5ac, v38
    v_rsq_f32 v37, v38
    s_nop 0
    v_mul_f32 v36, v36, v37
    v_pk_fma_f32 v[12:13], v[206:207], v[36:37], v[36:37] op_sel:[0,1,0] op_sel_hi:[1,1,0] neg_lo:[0,0,1] neg_hi:[0,0,1]
    v_pk_fma_f32 v[14:15], v[208:209], v[36:37], v[36:37] op_sel:[0,1,0] op_sel_hi:[1,1,0] neg_lo:[0,0,1] neg_hi:[0,0,1]
    v_pk_fma_f32 v[16:17], v[210:211], v[36:37], v[36:37] op_sel:[0,1,0] op_sel_hi:[1,1,0] neg_lo:[0,0,1] neg_hi:[0,0,1]
    v_pk_fma_f32 v[18:19], v[212:213], v[36:37], v[36:37] op_sel:[0,1,0] op_sel_hi:[1,1,0] neg_lo:[0,0,1] neg_hi:[0,0,1]
    v_pk_fma_f32 v[20:21], v[214:215], v[36:37], v[36:37] op_sel:[0,1,0] op_sel_hi:[1,1,0] neg_lo:[0,0,1] neg_hi:[0,0,1]
    v_pk_fma_f32 v[22:23], v[216:217], v[36:37], v[36:37] op_sel:[0,1,0] op_sel_hi:[1,1,0] neg_lo:[0,0,1] neg_hi:[0,0,1]
    v_pk_fma_f32 v[24:25], v[218:219], v[36:37], v[36:37] op_sel:[0,1,0] op_sel_hi:[1,1,0] neg_lo:[0,0,1] neg_hi:[0,0,1]
    v_pk_fma_f32 v[26:27], v[220:221], v[36:37], v[36:37] op_sel:[0,1,0] op_sel_hi:[1,1,0] neg_lo:[0,0,1] neg_hi:[0,0,1]
    v_pk_fma_f32 v[206:207], v[12:13], v[222:223], v[206:207]
    v_cvt_pk_bf16_f32 v180, v206, v207
    v_pk_fma_f32 v[208:209], v[14:15], v[224:225], v[208:209]
    v_cvt_pk_bf16_f32 v181, v208, v209
    v_and_b32 v180, -2, v180
    v_pk_fma_f32 v[210:211], v[16:17], v[226:227], v[210:211]
    v_cvt_pk_bf16_f32 v182, v210, v211
    v_pk_fma_f32 v[212:213], v[18:19], v[228:229], v[212:213]
    v_cvt_pk_bf16_f32 v183, v212, v213
    buffer_store_dwordx4 v[180:183], v196, s[20:23], 0 offen offset:0 sc1
    v_pk_fma_f32 v[214:215], v[20:21], v[230:231], v[214:215]
    v_cvt_pk_bf16_f32 v184, v214, v215
    v_pk_fma_f32 v[216:217], v[22:23], v[232:233], v[216:217]
    v_cvt_pk_bf16_f32 v185, v216, v217
    v_and_b32 v184, -2, v184
    v_pk_fma_f32 v[218:219], v[24:25], v[234:235], v[218:219]
    v_cvt_pk_bf16_f32 v186, v218, v219
    v_pk_fma_f32 v[220:221], v[26:27], v[236:237], v[220:221]
    v_cvt_pk_bf16_f32 v187, v220, v221
    buffer_store_dwordx4 v[184:187], v196, s[20:23], 0 offen offset:2048 sc1
    s_branch R_s2
R_l0:
    v_lshlrev_b32 v206, 16, v180
    v_and_b32 v207, 0xffff0000, v180
    v_lshlrev_b32 v208, 16, v181
    v_and_b32 v209, 0xffff0000, v181
    v_lshlrev_b32 v210, 16, v182
    v_and_b32 v211, 0xffff0000, v182
    v_lshlrev_b32 v212, 16, v183
    v_and_b32 v213, 0xffff0000, v183
    v_lshlrev_b32 v214, 16, v184
    v_and_b32 v215, 0xffff0000, v184
    v_lshlrev_b32 v216, 16, v185
    v_and_b32 v217, 0xffff0000, v185
    v_lshlrev_b32 v218, 16, v186
    v_and_b32 v219, 0xffff0000, v186
    v_lshlrev_b32 v220, 16, v187
    v_and_b32 v221, 0xffff0000, v187
    v_pk_add_f32 v[32:33], v[206:207], v[208:209]
    v_pk_mul_f32 v[34:35], v[206:207], v[206:207]
    v_pk_fma_f32 v[34:35], v[208:209], v[208:209], v[34:35]
    v_pk_add_f32 v[32:33], v[32:33], v[210:211]
    v_pk_fma_f32 v[34:35], v[210:211], v[210:211], v[34:35]
    v_pk_add_f32 v[32:33], v[32:33], v[212:213]
    v_pk_fma_f32 v[34:35], v[212:213], v[212:213], v[34:35]
    v_pk_add_f32 v[32:33], v[32:33], v[214:215]
    v_pk_fma_f32 v[34:35], v[214:215], v[214:215], v[34:35]
    v_pk_add_f32 v[32:33], v[32:33], v[216:217]
    v_pk_fma_f32 v[34:35], v[216:217], v[216:217], v[34:35]
    v_pk_add_f32 v[32:33], v[32:33], v[218:219]
    v_pk_fma_f32 v[34:35], v[218:219], v[218:219], v[34:35]
    v_pk_add_f32 v[32:33], v[32:33], v[220:221]
    v_pk_fma_f32 v[34:35], v[220:221], v[220:221], v[34:35]
    v_add_f32 v30, v32, v33
    v_add_f32 v31, v34, v35
    s_nop 0
    v_add_f32_dpp v30, v30, v30 row_ror:8 row_mask:0xf bank_mask:0xf
    v_add_f32_dpp v31, v31, v31 row_ror:8 row_mask:0xf bank_mask:0xf
    v_mov_b32 v32, v30
    v_mov_b32 v33, v31
    s_nop 0
    v_permlane16_swap_b32 v30, v32
    v_permlane16_swap_b32 v31, v33
    v_pk_add_f32 v[30:31], v[30:31], v[32:33]
    v_mov_b32 v32, v30
    v_mov_b32 v33, v31
    s_nop 0
    v_permlane32_swap_b32 v30, v32
    v_permlane32_swap_b32 v31, v33
    v_pk_add_f32 v[30:31], v[30:31], v[32:33]
    ds_write_b64 v39, v[30:31] offset:0
    s_waitcnt lgkmcnt(0)
    s_cmp_lg_u32 s30, 4
    s_cbranch_scc1 R_fw
    v_mov_b32 v222, 162820
spin_16:
    s_sleep 4
    ds_read_b32 v223, v222
    s_waitcnt lgkmcnt(0)
    v_readfirstlane_b32 s53, v223
    s_nop 0
    s_cmp_ge_u32 s53, 16
    s_cbranch_scc0 spin_16
    s_lshl_b32 s36, s28, 10
    s_add_u32 s36, s36, 23101440
    v_lshlrev_b32 v226, 7, v1
    v_add_u32 v226, s36, v226
    s_mov_b32 s53, 0
    s_mov_b64 exec, 0xff
R_fp:
    buffer_load_dword v222, v226, s[56:59], 0 offen sc1
    s_waitcnt vmcnt(0)
    v_subrev_u32 v222, s52, v222
    v_and_b32 v223, 0xffffc0ff, v222
    v_cmp_eq_u32 vcc, 32, v223
    s_nop 0
    s_cmp_eq_u64 vcc, exec
    s_cbranch_scc1 R_fq
    s_sleep 3
    s_add_u32 s53, s53, 1
    s_cmp_lt_u32 s53, s61
    s_cbranch_scc1 R_fp
    s_mov_b32 s61, 0
R_fq:
    v_lshrrev_b32 v222, 8, v222
    v_mov_b32 v223, 162844
    ds_add_u32 v223, v222
    s_mov_b64 exec, -1
    s_waitcnt lgkmcnt(0)
R_fw:
    s_barrier
    s_add_u32 s80, s4, 0x2100000
    s_addc_u32 s81, s5, 0
    s_mov_b32 s82, 0x7f00000
    s_mov_b32 s83, 0x20000
    s_mov_b32 s78, 0
    buffer_load_dwordx2 v[230:231], v197, s[80:83], s78 offen sc1
    s_mov_b32 s78, 8192
    buffer_load_dwordx2 v[232:233], v197, s[80:83], s78 offen sc1
    s_mov_b32 s78, 32768
    buffer_load_dwordx2 v[234:235], v197, s[80:83], s78 offen sc1
    s_mov_b32 s78, 40960
    buffer_load_dwordx2 v[236:237], v197, s[80:83], s78 offen sc1
    v_mov_b32 v222, 162844
    ds_read_b32 v223, v222
    s_waitcnt lgkmcnt(0)
    v_readfirstlane_b32 s94, v223
    s_nop 0
    s_cmp_gt_u32 s94, 127
    s_cselect_b32 s94, 1, 0
    s_lshr_b32 s53, s28, 3
    s_lshl_b32 s53, s53, 2
    s_and_b32 s54, s28, 3
    s_add_u32 s53, s53, s54
    s_lshl_b32 s53, s53, 24
    s_lshr_b32 s54, s28, 2
    s_xor_b32 s54, s54, s94
    s_and_b32 s54, s54, 1
    s_lshl_b32 s54, s54, 13
    s_add_u32 s55, s53, s54
    s_add_u32 s55, s55, 33554432
    s_add_u32 s62, s4, s55
    s_addc_u32 s63, s5, 0
    s_sub_u32 s36, s28, 1
    s_max_i32 s36, s36, 0
    s_lshr_b32 s53, s36, 3
    s_lshl_b32 s53, s53, 2
    s_and_b32 s54, s36, 3
    s_add_u32 s53, s53, s54
    s_lshl_b32 s53, s53, 24
    s_lshr_b32 s54, s36, 2
    s_xor_b32 s54, s54, s94
    s_and_b32 s54, s54, 1
    s_lshl_b32 s54, s54, 13
    s_add_u32 s92, s53, s54
    s_add_u32 s92, s92, 33554432
    s_sub_u32 s92, s92, s55
    s_add_u32 s36, s28, 1
    s_min_u32 s36, s36, 15
    s_lshr_b32 s53, s36, 3
    s_lshl_b32 s53, s53, 2
    s_and_b32 s54, s36, 3
    s_add_u32 s53, s53, s54
    s_lshl_b32 s53, s53, 24
    s_lshr_b32 s54, s36, 2
    s_xor_b32 s54, s54, s94
    s_and_b32 s54, s54, 1
    s_lshl_b32 s54, s54, 13
    s_add_u32 s93, s53, s54
    s_add_u32 s93, s93, 33554432
    s_sub_u32 s93, s93, s55
    s_add_u32 s55, s55, 6029312
    s_mov_b32 s20, s62
    s_mov_b32 s21, s63
    s_mov_b32 s22, 0x7e000
    s_mov_b32 s23, 0x20000
    ds_read_b128 v[12:15], v40 offset:0
    ds_read_b128 v[16:19], v40 offset:16
    ds_read_b128 v[20:23], v40 offset:32
    ds_read_b128 v[24:27], v40 offset:48
    s_waitcnt lgkmcnt(0)
    v_pk_add_f32 v[12:13], v[12:13], v[14:15]
    v_pk_add_f32 v[16:17], v[16:17], v[18:19]
    v_pk_add_f32 v[20:21], v[20:21], v[22:23]
    v_pk_add_f32 v[24:25], v[24:25], v[26:27]
    v_pk_add_f32 v[12:13], v[12:13], v[16:17]
    v_pk_add_f32 v[20:21], v[20:21], v[24:25]
    v_pk_add_f32 v[12:13], v[12:13], v[20:21]
    v_mul_f32 v36, 0x3a800000, v12
    v_mul_f32 v38, 0x3a800000, v13
    v_fma_f32 v38, -v36, v36, v38
    v_max_f32 v38, 0, v38
    v_add_f32 v38, 0x3727c5ac, v38
    v_rsq_f32 v37, v38
    s_nop 0
    v_pk_add_f32 v[12:13], v[206:207], v[36:37] op_sel_hi:[1,0] neg_lo:[0,1] neg_hi:[0,1]
    v_pk_mul_f32 v[12:13], v[12:13], v[36:37] op_sel:[0,1] op_sel_hi:[1,1]
    v_pk_add_f32 v[14:15], v[208:209], v[36:37] op_sel_hi:[1,0] neg_lo:[0,1] neg_hi:[0,1]
    v_pk_mul_f32 v[14:15], v[14:15], v[36:37] op_sel:[0,1] op_sel_hi:[1,1]
    v_pk_add_f32 v[16:17], v[210:211], v[36:37] op_sel_hi:[1,0] neg_lo:[0,1] neg_hi:[0,1]
    v_pk_mul_f32 v[16:17], v[16:17], v[36:37] op_sel:[0,1] op_sel_hi:[1,1]
    v_pk_add_f32 v[18:19], v[212:213], v[36:37] op_sel_hi:[1,0] neg_lo:[0,1] neg_hi:[0,1]
    v_pk_mul_f32 v[18:19], v[18:19], v[36:37] op_sel:[0,1] op_sel_hi:[1,1]
    v_pk_add_f32 v[20:21], v[214:215], v[36:37] op_sel_hi:[1,0] neg_lo:[0,1] neg_hi:[0,1]
    v_pk_mul_f32 v[20:21], v[20:21], v[36:37] op_sel:[0,1] op_sel_hi:[1,1]
    v_pk_add_f32 v[22:23], v[216:217], v[36:37] op_sel_hi:[1,0] neg_lo:[0,1] neg_hi:[0,1]
    v_pk_mul_f32 v[22:23], v[22:23], v[36:37] op_sel:[0,1] op_sel_hi:[1,1]
    v_pk_add_f32 v[24:25], v[218:219], v[36:37] op_sel_hi:[1,0] neg_lo:[0,1] neg_hi:[0,1]
    v_pk_mul_f32 v[24:25], v[24:25], v[36:37] op_sel:[0,1] op_sel_hi:[1,1]
    v_pk_add_f32 v[26:27], v[220:221], v[36:37] op_sel_hi:[1,0] neg_lo:[0,1] neg_hi:[0,1]
    v_pk_mul_f32 v[26:27], v[26:27], v[36:37] op_sel:[0,1] op_sel_hi:[1,1]
    s_waitcnt vmcnt(0)
    v_lshlrev_b32 v222, 16, v230
    v_and_b32 v223, 0xffff0000, v230
    v_pk_fma_f32 v[206:207], v[12:13], v[222:223], v[206:207]
    v_cvt_pk_bf16_f32 v180, v206, v207
    v_lshlrev_b32 v222, 16, v231
    v_and_b32 v223, 0xffff0000, v231
    v_pk_fma_f32 v[208:209], v[14:15], v[222:223], v[208:209]
    v_cvt_pk_bf16_f32 v181, v208, v209
    v_and_b32 v180, -2, v180
    v_lshlrev_b32 v222, 16, v232
    v_and_b32 v223, 0xffff0000, v232
    v_pk_fma_f32 v[210:211], v[16:17], v[222:223], v[210:211]
    v_cvt_pk_bf16_f32 v182, v210, v211
    v_lshlrev_b32 v222, 16, v233
    v_and_b32 v223, 0xffff0000, v233
    v_pk_fma_f32 v[212:213], v[18:19], v[222:223], v[212:213]
    v_cvt_pk_bf16_f32 v183, v212, v213
    buffer_store_dwordx4 v[180:183], v196, s[20:23], 0 offen offset:0 sc1
    v_lshlrev_b32 v222, 16, v234
    v_and_b32 v223, 0xffff0000, v234
    v_pk_fma_f32 v[214:215], v[20:21], v[222:223], v[214:215]
    v_cvt_pk_bf16_f32 v184, v214, v215
    v_lshlrev_b32 v222, 16, v235
    v_and_b32 v223, 0xffff0000, v235
    v_pk_fma_f32 v[216:217], v[22:23], v[222:223], v[216:217]
    v_cvt_pk_bf16_f32 v185, v216, v217
    v_and_b32 v184, -2, v184
    v_lshlrev_b32 v222, 16, v236
    v_and_b32 v223, 0xffff0000, v236
    v_pk_fma_f32 v[218:219], v[24:25], v[222:223], v[218:219]
    v_cvt_pk_bf16_f32 v186, v218, v219
    v_lshlrev_b32 v222, 16, v237
    v_and_b32 v223, 0xffff0000, v237
    v_pk_fma_f32 v[220:221], v[26:27], v[222:223], v[220:221]
    v_cvt_pk_bf16_f32 v187, v220, v221
    buffer_store_dwordx4 v[184:187], v196, s[20:23], 0 offen offset:2048 sc1
R_s2:
    v_lshlrev_b32 v206, 16, v180
    v_and_b32 v207, 0xffff0000, v180
    v_lshlrev_b32 v208, 16, v181
    v_and_b32 v209, 0xffff0000, v181
    v_lshlrev_b32 v210, 16, v182
    v_and_b32 v211, 0xffff0000, v182
    v_lshlrev_b32 v212, 16, v183
    v_and_b32 v213, 0xffff0000, v183
    v_lshlrev_b32 v214, 16, v184
    v_and_b32 v215, 0xffff0000, v184
    v_lshlrev_b32 v216, 16, v185
    v_and_b32 v217, 0xffff0000, v185
    v_lshlrev_b32 v218, 16, v186
    v_and_b32 v219, 0xffff0000, v186
    v_lshlrev_b32 v220, 16, v187
    v_and_b32 v221, 0xffff0000, v187
    v_pk_add_f32 v[32:33], v[206:207], v[208:209]
    v_pk_mul_f32 v[34:35], v[206:207], v[206:207]
    v_pk_fma_f32 v[34:35], v[208:209], v[208:209], v[34:35]
    v_pk_add_f32 v[32:33], v[32:33], v[210:211]
    v_pk_fma_f32 v[34:35], v[210:211], v[210:211], v[34:35]
    v_pk_add_f32 v[32:33], v[32:33], v[212:213]
    v_pk_fma_f32 v[34:35], v[212:213], v[212:213], v[34:35]
    v_pk_add_f32 v[32:33], v[32:33], v[214:215]
    v_pk_fma_f32 v[34:35], v[214:215], v[214:215], v[34:35]
    v_pk_add_f32 v[32:33], v[32:33], v[216:217]
    v_pk_fma_f32 v[34:35], v[216:217], v[216:217], v[34:35]
    v_pk_add_f32 v[32:33], v[32:33], v[218:219]
    v_pk_fma_f32 v[34:35], v[218:219], v[218:219], v[34:35]
    v_pk_add_f32 v[32:33], v[32:33], v[220:221]
    v_pk_fma_f32 v[34:35], v[220:221], v[220:221], v[34:35]
    v_add_f32 v30, v32, v33
    v_add_f32 v31, v34, v35
    s_nop 0
    v_add_f32_dpp v30, v30, v30 row_ror:8 row_mask:0xf bank_mask:0xf
    v_add_f32_dpp v31, v31, v31 row_ror:8 row_mask:0xf bank_mask:0xf
    v_mov_b32 v32, v30
    v_mov_b32 v33, v31
    s_nop 0
    v_permlane16_swap_b32 v30, v32
    v_permlane16_swap_b32 v31, v33
    v_pk_add_f32 v[30:31], v[30:31], v[32:33]
    v_mov_b32 v32, v30
    v_mov_b32 v33, v31
    s_nop 0
    v_permlane32_swap_b32 v30, v32
    v_permlane32_swap_b32 v31, v33
    v_pk_add_f32 v[30:31], v[30:31], v[32:33]
    ds_write_b64 v39, v[30:31] offset:512
    s_waitcnt lgkmcnt(0)
    s_barrier
    s_cmp_lg_u32 s30, 6
    s_cbranch_scc1 R_n6
    s_cmp_lg_u32 s60, 0
    s_cbranch_scc1 R_n6
    s_lshl_b32 s53, s29, 7
    s_add_u32 s53, s53, 23117824
    v_mov_b32 v8, 1
    v_mov_b32 v9, 0
    s_mov_b64 exec, 1
    buffer_atomic_add v8, v9, s[56:59], s53 offen sc1
    s_mov_b64 exec, -1
R_n6:
    s_cmp_lg_u32 s30, 7
    s_cbranch_scc1 R_nl
    ds_read_b128 v[12:15], v40 offset:512
    ds_read_b128 v[16:19], v40 offset:528
    ds_read_b128 v[20:23], v40 offset:544
    ds_read_b128 v[24:27], v40 offset:560
    s_waitcnt lgkmcnt(0)
    v_pk_add_f32 v[12:13], v[12:13], v[14:15]
    v_pk_add_f32 v[16:17], v[16:17], v[18:19]
    v_pk_add_f32 v[20:21], v[20:21], v[22:23]
    v_pk_add_f32 v[24:25], v[24:25], v[26:27]
    v_pk_add_f32 v[12:13], v[12:13], v[16:17]
    v_pk_add_f32 v[20:21], v[20:21], v[24:25]
    v_pk_add_f32 v[12:13], v[12:13], v[20:21]
    v_mul_f32 v36, 0x3a800000, v12
    v_mul_f32 v38, 0x3a800000, v13
    v_fma_f32 v38, -v36, v36, v38
    v_max_f32 v38, 0, v38
    v_mov_b32 v42, v36
    v_mov_b32 v43, v38
    v_add_f32 v38, 0x3727c5ac, v38
    v_sqrt_f32 v38, v38
    s_nop 0
    v_mov_b32 v41, v38
    v_rcp_f32 v37, v38
    v_sub_f32 v42, v42, v36
    v_mul_f32 v42, v42, v37
    v_mul_f32 v43, v43, v37
    v_mul_f32 v43, v43, v37
    v_add_f32 v43, 0x3727c5ac, v43
    v_rsq_f32 v44, v43
    v_mov_b32 v224, v36
    v_mov_b32 v225, v37
    v_fma_f32 v226, v42, v41, v36
    v_mul_f32 v227, v37, v44
    s_add_u32 s24, s62, 0x5d0000
    s_addc_u32 s25, s63, 0
    s_mov_b32 s26, 0x800
    s_mov_b32 s27, 0x20000
    s_lshl_b32 s36, s29, 3
    v_add_u32 v6, s36, v199
    v_lshlrev_b32 v6, 4, v6
    s_mov_b64 exec, 0xff
    buffer_store_dwordx4 v[224:227], v6, s[24:27], 0 offen sc1
    s_mov_b64 exec, -1
    s_add_u32 s53, s55, 1280
    v_mov_b32 v8, 1
    v_mov_b32 v9, 162816
    v_mov_b32 v11, 0
    s_mov_b64 exec, 1
    s_waitcnt vmcnt(0)
    buffer_atomic_add v8, v11, s[56:59], s53 offen sc1
pub_17:
    s_mov_b64 exec, -1
R_nl:
    s_cmp_ge_u32 s30, 4
    s_cbranch_scc1 LOADERS
    s_mov_b32 s8, s62
    s_mov_b32 s9, s63
    s_mov_b32 s10, 0x7e000
    s_mov_b32 s11, 0x20000
    v_add_u32 v126, 0, v2
    v_add_u32 v127, 65536, v2
    s_lshl_b32 s44, s30, 17
    s_mov_b32 s34, s30
    s_mov_b32 s35, 0
    v_and_b32 v22, 15, v1
    v_lshrrev_b32 v23, 4, v1
    s_mul_i32 s37, s34, 2
    s_mul_i32 s38, s99, 4
    s_mul_i32 s36, s35, 4
    s_add_u32 s38, s38, s36
    v_add_u32 v128, 4096, v2
    v_add_u32 v129, 69632, v2
    s_add_u32 s45, s44, 16384
    s_add_u32 s46, s44, 32768
    s_add_u32 s47, s44, 49152
    v_lshrrev_b32 v6, 2, v1
    v_mul_u32_u24 v13, 128, v6
    v_and_b32 v7, 3, v1
    v_lshl_add_u32 v13, v7, 3, v13
    v_add_u32 v13, 24576, v13
    v_bfe_u32 v6, v6, 1, 2
    s_mul_i32 s36, s35, 4
    s_add_u32 s36, s36, 3
    v_xor_b32 v7, s36, v6
    v_lshl_add_u32 v16, v7, 5, v13
    s_mul_i32 s36, s35, 4
    s_add_u32 s36, s36, 2
    v_xor_b32 v7, s36, v6
    v_lshl_add_u32 v15, v7, 5, v13
    s_mul_i32 s36, s35, 4
    s_add_u32 s36, s36, 1
    v_xor_b32 v7, s36, v6
    v_lshl_add_u32 v14, v7, 5, v13
    s_mul_i32 s36, s35, 4
    s_add_u32 s36, s36, 0
    v_xor_b32 v7, s36, v6
    v_lshl_add_u32 v13, v7, 5, v13
    v_pk_mov_b32 v[24:25], 0, 0
    v_pk_mov_b32 v[26:27], 0, 0
    v_pk_mov_b32 v[28:29], 0, 0
    v_pk_mov_b32 v[30:31], 0, 0
    v_pk_mov_b32 v[32:33], 0, 0
    v_pk_mov_b32 v[34:35], 0, 0
    v_pk_mov_b32 v[36:37], 0, 0
    v_pk_mov_b32 v[38:39], 0, 0
    v_pk_mov_b32 v[40:41], 0, 0
    v_pk_mov_b32 v[42:43], 0, 0
    v_pk_mov_b32 v[44:45], 0, 0
    v_pk_mov_b32 v[46:47], 0, 0
    v_pk_mov_b32 v[48:49], 0, 0
    v_pk_mov_b32 v[50:51], 0, 0
    v_pk_mov_b32 v[52:53], 0, 0
    v_pk_mov_b32 v[54:55], 0, 0
    s_mov_b32 s43, 0
    s_mul_i32 s36, s35, 256
    s_add_u32 s36, s36, 163328
    v_lshlrev_b32 v6, 4, v23
    v_add_u32 v6, s36, v6
    s_lshl_b32 s36, s37, 8
    s_add_u32 s36, s36, 160776
    v_lshlrev_b32 v7, 4, v22
    v_add_u32 v7, s36, v7
    s_add_u32 s16, s62, 0x100000
    s_addc_u32 s17, s63, 0
    s_mov_b32 s18, 0x7e000
    s_mov_b32 s19, 0x20000
    v_lshlrev_b32 v12, 11, v23
    v_lshl_add_u32 v12, v22, 4, v12
    s_lshl_b32 s39, s38, 13
    s_lshl_b32 s36, s37, 8
    s_add_u32 s39, s39, s36
    s_add_u32 s40, s39, 16384
    s_lshl_b32 s36, s29, 1
    s_lshr_b32 s53, s36, 3
    s_lshl_b32 s53, s53, 14
    s_and_b32 s41, s36, 7
    s_lshl_b32 s41, s41, 10
    s_add_u32 s41, s41, s53
    s_lshl_b32 s36, s37, 16
    s_add_u32 s41, s41, s36
    s_mov_b32 s53, 0
    s_mov_b32 s49, s44
    ds_read_b64_tr_b16 v[56:57], v13 offset:0
    ds_read_b64_tr_b16 v[58:59], v13 offset:2048
    ds_read_b64_tr_b16 v[60:61], v14 offset:0
    ds_read_b64_tr_b16 v[62:63], v14 offset:2048
    ds_read_b64_tr_b16 v[64:65], v15 offset:0
    ds_read_b64_tr_b16 v[66:67], v15 offset:2048
    ds_read_b64_tr_b16 v[68:69], v16 offset:0
    ds_read_b64_tr_b16 v[70:71], v16 offset:2048
    ds_read_b64_tr_b16 v[72:73], v13 offset:4096
    ds_read_b64_tr_b16 v[74:75], v13 offset:6144
    ds_read_b64_tr_b16 v[76:77], v14 offset:4096
    ds_read_b64_tr_b16 v[78:79], v14 offset:6144
    ds_read_b64_tr_b16 v[80:81], v15 offset:4096
    ds_read_b64_tr_b16 v[82:83], v15 offset:6144
    ds_read_b64_tr_b16 v[84:85], v16 offset:4096
    ds_read_b64_tr_b16 v[86:87], v16 offset:6144
dm_18p:
    buffer_load_dwordx4 v[164:167], v126, s[8:11], s44 offen offset:0 sc1
    buffer_load_dwordx4 v[168:171], v127, s[8:11], s44 offen offset:0 sc1
    buffer_load_dwordx4 v[172:175], v126, s[8:11], s44 offen offset:1024 sc1
    buffer_load_dwordx4 v[176:179], v127, s[8:11], s44 offen offset:1024 sc1
dm_18w:
    s_waitcnt vmcnt(0)
    v_or3_b32 v17, v164, v168, v172
    v_bitop3_b32 v17, v17, v176, 1 bitop3:0xa8
    v_cmp_ne_u32 vcc, 0, v17
    s_cbranch_vccz dm_18q
    s_sleep 2
    s_add_u32 s53, s53, 1
    s_cmp_lt_u32 s53, s61
    s_cbranch_scc1 dm_18p
    s_mov_b32 s61, 0
dm_18q:
    buffer_load_dwordx4 v[180:183], v126, s[8:11], s44 offen offset:2048 sc1
    buffer_load_dwordx4 v[184:187], v127, s[8:11], s44 offen offset:2048 sc1
    buffer_load_dwordx4 v[188:191], v126, s[8:11], s44 offen offset:3072 sc1
    buffer_load_dwordx4 v[192:195], v127, s[8:11], s44 offen offset:3072 sc1
    buffer_load_dwordx4 v[196:199], v128, s[8:11], s44 offen offset:0 sc1
    buffer_load_dwordx4 v[200:203], v129, s[8:11], s44 offen offset:0 sc1
    buffer_load_dwordx4 v[204:207], v128, s[8:11], s44 offen offset:1024 sc1
    buffer_load_dwordx4 v[208:211], v129, s[8:11], s44 offen offset:1024 sc1
    buffer_load_dwordx4 v[212:215], v128, s[8:11], s44 offen offset:2048 sc1
    buffer_load_dwordx4 v[216:219], v129, s[8:11], s44 offen offset:2048 sc1
    s_waitcnt lgkmcnt(0)
dm_18:
    v_mfma_f32_16x16x32_bf16 v[24:27], v[56:59], v[164:167], v[24:27]
    ds_read_b64_tr_b16 v[88:89], v13 offset:8192
    buffer_load_dwordx4 v[220:223], v128, s[8:11], s44 offen offset:3072 sc1
    v_mfma_f32_16x16x32_bf16 v[40:43], v[56:59], v[168:171], v[40:43]
    ds_read_b64_tr_b16 v[90:91], v13 offset:10240
    buffer_load_dwordx4 v[224:227], v129, s[8:11], s44 offen offset:3072 sc1
    v_mfma_f32_16x16x32_bf16 v[44:47], v[60:63], v[168:171], v[44:47]
    ds_read_b64_tr_b16 v[92:93], v14 offset:8192
    s_mov_b32 s44, s45
    v_mfma_f32_16x16x32_bf16 v[28:31], v[60:63], v[164:167], v[28:31]
    ds_read_b64_tr_b16 v[94:95], v14 offset:10240
    s_mov_b32 s45, s46
    v_mfma_f32_16x16x32_bf16 v[32:35], v[64:67], v[164:167], v[32:35]
    ds_read_b64_tr_b16 v[96:97], v15 offset:8192
    s_mov_b32 s46, s47
    v_mfma_f32_16x16x32_bf16 v[48:51], v[64:67], v[168:171], v[48:51]
    ds_read_b64_tr_b16 v[98:99], v15 offset:10240
    s_mov_b32 s47, 1048576
    v_mfma_f32_16x16x32_bf16 v[52:55], v[68:71], v[168:171], v[52:55]
    ds_read_b64_tr_b16 v[100:101], v16 offset:8192
    v_mfma_f32_16x16x32_bf16 v[36:39], v[68:71], v[164:167], v[36:39]
    ds_read_b64_tr_b16 v[102:103], v16 offset:10240
    s_waitcnt lgkmcnt(8)
    v_mfma_f32_16x16x32_bf16 v[24:27], v[72:75], v[172:175], v[24:27]
    ds_read_b64_tr_b16 v[104:105], v13 offset:12288
    buffer_load_dwordx4 v[164:167], v126, s[8:11], s44 offen offset:0 sc1
    v_mfma_f32_16x16x32_bf16 v[40:43], v[72:75], v[176:179], v[40:43]
    ds_read_b64_tr_b16 v[106:107], v13 offset:14336
    buffer_load_dwordx4 v[168:171], v127, s[8:11], s44 offen offset:0 sc1
    v_mfma_f32_16x16x32_bf16 v[44:47], v[76:79], v[176:179], v[44:47]
    ds_read_b64_tr_b16 v[108:109], v14 offset:12288
    s_waitcnt vmcnt(10)
    v_mfma_f32_16x16x32_bf16 v[28:31], v[76:79], v[172:175], v[28:31]
    ds_read_b64_tr_b16 v[110:111], v14 offset:14336
    v_or3_b32 v17, v180, v184, v188
    v_mfma_f32_16x16x32_bf16 v[32:35], v[80:83], v[172:175], v[32:35]
    ds_read_b64_tr_b16 v[112:113], v15 offset:12288
    v_bitop3_b32 v17, v17, v192, 1 bitop3:0xa8
    v_mfma_f32_16x16x32_bf16 v[48:51], v[80:83], v[176:179], v[48:51]
    ds_read_b64_tr_b16 v[114:115], v15 offset:14336
    v_cmp_ne_u32 vcc, 0, v17
    v_mfma_f32_16x16x32_bf16 v[52:55], v[84:87], v[176:179], v[52:55]
    ds_read_b64_tr_b16 v[116:117], v16 offset:12288
    ds_read_b64_tr_b16 v[118:119], v16 offset:14336
    v_mfma_f32_16x16x32_bf16 v[36:39], v[84:87], v[172:175], v[36:39]
    s_waitcnt lgkmcnt(8)
    s_cbranch_vccnz dm_18f0
dm_18g0:
    v_mfma_f32_16x16x32_bf16 v[24:27], v[88:91], v[180:183], v[24:27]
    ds_read_b64_tr_b16 v[56:57], v13 offset:16384
    buffer_load_dwordx4 v[172:175], v126, s[8:11], s44 offen offset:1024 sc1
    v_mfma_f32_16x16x32_bf16 v[40:43], v[88:91], v[184:187], v[40:43]
    ds_read_b64_tr_b16 v[58:59], v13 offset:18432
    buffer_load_dwordx4 v[176:179], v127, s[8:11], s44 offen offset:1024 sc1
    v_mfma_f32_16x16x32_bf16 v[44:47], v[92:95], v[184:187], v[44:47]
    ds_read_b64_tr_b16 v[60:61], v14 offset:16384
    v_mfma_f32_16x16x32_bf16 v[28:31], v[92:95], v[180:183], v[28:31]
    ds_read_b64_tr_b16 v[62:63], v14 offset:18432
    v_mfma_f32_16x16x32_bf16 v[32:35], v[96:99], v[180:183], v[32:35]
    ds_read_b64_tr_b16 v[64:65], v15 offset:16384
    v_mfma_f32_16x16x32_bf16 v[48:51], v[96:99], v[184:187], v[48:51]
    ds_read_b64_tr_b16 v[66:67], v15 offset:18432
    v_mfma_f32_16x16x32_bf16 v[52:55], v[100:103], v[184:187], v[52:55]
    ds_read_b64_tr_b16 v[68:69], v16 offset:16384
    v_mfma_f32_16x16x32_bf16 v[36:39], v[100:103], v[180:183], v[36:39]
    ds_read_b64_tr_b16 v[70:71], v16 offset:18432
    s_waitcnt lgkmcnt(8)
    v_mfma_f32_16x16x32_bf16 v[24:27], v[104:107], v[188:191], v[24:27]
    ds_read_b64_tr_b16 v[72:73], v13 offset:20480
    buffer_load_dwordx4 v[180:183], v126, s[8:11], s44 offen offset:2048 sc1
    v_mfma_f32_16x16x32_bf16 v[40:43], v[104:107], v[192:195], v[40:43]
    ds_read_b64_tr_b16 v[74:75], v13 offset:22528
    buffer_load_dwordx4 v[184:187], v127, s[8:11], s44 offen offset:2048 sc1
    v_mfma_f32_16x16x32_bf16 v[44:47], v[108:111], v[192:195], v[44:47]
    ds_read_b64_tr_b16 v[76:77], v14 offset:20480
    s_waitcnt vmcnt(10)
    v_mfma_f32_16x16x32_bf16 v[28:31], v[108:111], v[188:191], v[28:31]
    ds_read_b64_tr_b16 v[78:79], v14 offset:22528
    v_or3_b32 v17, v196, v200, v204
    v_mfma_f32_16x16x32_bf16 v[32:35], v[112:115], v[188:191], v[32:35]
    ds_read_b64_tr_b16 v[80:81], v15 offset:20480
    v_bitop3_b32 v17, v17, v208, 1 bitop3:0xa8
    v_mfma_f32_16x16x32_bf16 v[48:51], v[112:115], v[192:195], v[48:51]
    ds_read_b64_tr_b16 v[82:83], v15 offset:22528
    v_cmp_ne_u32 vcc, 0, v17
    v_mfma_f32_16x16x32_bf16 v[52:55], v[116:119], v[192:195], v[52:55]
    ds_read_b64_tr_b16 v[84:85], v16 offset:20480
    ds_read_b64_tr_b16 v[86:87], v16 offset:22528
    v_mfma_f32_16x16x32_bf16 v[36:39], v[116:119], v[188:191], v[36:39]
    s_waitcnt lgkmcnt(8)
    s_cbranch_vccnz dm_18f1
dm_18g1:
    v_mfma_f32_16x16x32_bf16 v[24:27], v[56:59], v[196:199], v[24:27]
    ds_read_b64_tr_b16 v[88:89], v13 offset:24576
    buffer_load_dwordx4 v[188:191], v126, s[8:11], s44 offen offset:3072 sc1
    v_mfma_f32_16x16x32_bf16 v[40:43], v[56:59], v[200:203], v[40:43]
    ds_read_b64_tr_b16 v[90:91], v13 offset:26624
    buffer_load_dwordx4 v[192:195], v127, s[8:11], s44 offen offset:3072 sc1
    v_mfma_f32_16x16x32_bf16 v[44:47], v[60:63], v[200:203], v[44:47]
    ds_read_b64_tr_b16 v[92:93], v14 offset:24576
    v_mfma_f32_16x16x32_bf16 v[28:31], v[60:63], v[196:199], v[28:31]
    ds_read_b64_tr_b16 v[94:95], v14 offset:26624
    v_mfma_f32_16x16x32_bf16 v[32:35], v[64:67], v[196:199], v[32:35]
    ds_read_b64_tr_b16 v[96:97], v15 offset:24576
    s_add_u32 s43, s43, 1
    v_mfma_f32_16x16x32_bf16 v[48:51], v[64:67], v[200:203], v[48:51]
    ds_read_b64_tr_b16 v[98:99], v15 offset:26624
    v_mfma_f32_16x16x32_bf16 v[52:55], v[68:71], v[200:203], v[52:55]
    ds_read_b64_tr_b16 v[100:101], v16 offset:24576
    v_mfma_f32_16x16x32_bf16 v[36:39], v[68:71], v[196:199], v[36:39]
    ds_read_b64_tr_b16 v[102:103], v16 offset:26624
    s_waitcnt lgkmcnt(8)
    v_mfma_f32_16x16x32_bf16 v[24:27], v[72:75], v[204:207], v[24:27]
    ds_read_b64_tr_b16 v[104:105], v13 offset:28672
    buffer_load_dwordx4 v[196:199], v128, s[8:11], s44 offen offset:0 sc1
    v_mfma_f32_16x16x32_bf16 v[40:43], v[72:75], v[208:211], v[40:43]
    ds_read_b64_tr_b16 v[106:107], v13 offset:30720
    buffer_load_dwordx4 v[200:203], v129, s[8:11], s44 offen offset:0 sc1
    v_mfma_f32_16x16x32_bf16 v[44:47], v[76:79], v[208:211], v[44:47]
    ds_read_b64_tr_b16 v[108:109], v14 offset:28672
    s_waitcnt vmcnt(10)
    v_mfma_f32_16x16x32_bf16 v[28:31], v[76:79], v[204:207], v[28:31]
    ds_read_b64_tr_b16 v[110:111], v14 offset:30720
    v_add_u32 v13, 32768, v13
    v_or3_b32 v17, v212, v216, v220
    v_mfma_f32_16x16x32_bf16 v[32:35], v[80:83], v[204:207], v[32:35]
    ds_read_b64_tr_b16 v[112:113], v15 offset:28672
    v_add_u32 v14, 32768, v14
    v_bitop3_b32 v17, v17, v224, 1 bitop3:0xa8
    v_mfma_f32_16x16x32_bf16 v[48:51], v[80:83], v[208:211], v[48:51]
    ds_read_b64_tr_b16 v[114:115], v15 offset:30720
    v_add_u32 v15, 32768, v15
    v_cmp_ne_u32 vcc, 0, v17
    v_mfma_f32_16x16x32_bf16 v[52:55], v[84:87], v[208:211], v[52:55]
    ds_read_b64_tr_b16 v[116:117], v16 offset:28672
    ds_read_b64_tr_b16 v[118:119], v16 offset:30720
    s_cmp_eq_u32 s43, 4
    v_mfma_f32_16x16x32_bf16 v[36:39], v[84:87], v[204:207], v[36:39]
    v_add_u32 v16, 32768, v16
    s_waitcnt lgkmcnt(8)
    s_cbranch_vccnz dm_18f2
dm_18g2:
    s_cbranch_scc1 dm_18x
    v_mfma_f32_16x16x32_bf16 v[24:27], v[88:91], v[212:215], v[24:27]
    ds_read_b64_tr_b16 v[56:57], v13 offset:0
    buffer_load_dwordx4 v[204:207], v128, s[8:11], s44 offen offset:1024 sc1
    v_mfma_f32_16x16x32_bf16 v[40:43], v[88:91], v[216:219], v[40:43]
    ds_read_b64_tr_b16 v[58:59], v13 offset:2048
    buffer_load_dwordx4 v[208:211], v129, s[8:11], s44 offen offset:1024 sc1
    v_mfma_f32_16x16x32_bf16 v[44:47], v[92:95], v[216:219], v[44:47]
    ds_read_b64_tr_b16 v[60:61], v14 offset:0
    s_mov_b32 s49, s44
    v_mfma_f32_16x16x32_bf16 v[28:31], v[92:95], v[212:215], v[28:31]
    ds_read_b64_tr_b16 v[62:63], v14 offset:2048
    v_mfma_f32_16x16x32_bf16 v[32:35], v[96:99], v[212:215], v[32:35]
    ds_read_b64_tr_b16 v[64:65], v15 offset:0
    v_mfma_f32_16x16x32_bf16 v[48:51], v[96:99], v[216:219], v[48:51]
    ds_read_b64_tr_b16 v[66:67], v15 offset:2048
    v_mfma_f32_16x16x32_bf16 v[52:55], v[100:103], v[216:219], v[52:55]
    ds_read_b64_tr_b16 v[68:69], v16 offset:0
    v_mfma_f32_16x16x32_bf16 v[36:39], v[100:103], v[212:215], v[36:39]
    ds_read_b64_tr_b16 v[70:71], v16 offset:2048
    s_waitcnt lgkmcnt(8)
    v_mfma_f32_16x16x32_bf16 v[24:27], v[104:107], v[220:223], v[24:27]
    ds_read_b64_tr_b16 v[72:73], v13 offset:4096
    buffer_load_dwordx4 v[212:215], v128, s[8:11], s44 offen offset:2048 sc1
    v_mfma_f32_16x16x32_bf16 v[40:43], v[104:107], v[224:227], v[40:43]
    ds_read_b64_tr_b16 v[74:75], v13 offset:6144
    buffer_load_dwordx4 v[216:219], v129, s[8:11], s44 offen offset:2048 sc1
    v_mfma_f32_16x16x32_bf16 v[44:47], v[108:111], v[224:227], v[44:47]
    ds_read_b64_tr_b16 v[76:77], v14 offset:4096
    s_waitcnt vmcnt(10)
    v_mfma_f32_16x16x32_bf16 v[28:31], v[108:111], v[220:223], v[28:31]
    ds_read_b64_tr_b16 v[78:79], v14 offset:6144
    v_or3_b32 v17, v164, v168, v172
    v_mfma_f32_16x16x32_bf16 v[32:35], v[112:115], v[220:223], v[32:35]
    ds_read_b64_tr_b16 v[80:81], v15 offset:4096
    v_bitop3_b32 v17, v17, v176, 1 bitop3:0xa8
    v_mfma_f32_16x16x32_bf16 v[48:51], v[112:115], v[224:227], v[48:51]
    ds_read_b64_tr_b16 v[82:83], v15 offset:6144
    v_cmp_ne_u32 vcc, 0, v17
    v_mfma_f32_16x16x32_bf16 v[52:55], v[116:119], v[224:227], v[52:55]
    ds_read_b64_tr_b16 v[84:85], v16 offset:4096
    ds_read_b64_tr_b16 v[86:87], v16 offset:6144
    v_mfma_f32_16x16x32_bf16 v[36:39], v[116:119], v[220:223], v[36:39]
    s_waitcnt lgkmcnt(8)
    s_cbranch_vccnz dm_18f3
dm_18g3:
    s_branch dm_18
dm_18f0:
    s_cselect_b32 s50, 1, 0
dm_18h0:
    s_sleep 2
    buffer_load_dwordx4 v[180:183], v126, s[8:11], s49 offen offset:2048 sc1
    buffer_load_dwordx4 v[184:187], v127, s[8:11], s49 offen offset:2048 sc1
    buffer_load_dwordx4 v[188:191], v126, s[8:11], s49 offen offset:3072 sc1
    buffer_load_dwordx4 v[192:195], v127, s[8:11], s49 offen offset:3072 sc1
    buffer_load_dwordx4 v[196:199], v128, s[8:11], s49 offen offset:0 sc1
    buffer_load_dwordx4 v[200:203], v129, s[8:11], s49 offen offset:0 sc1
    buffer_load_dwordx4 v[204:207], v128, s[8:11], s49 offen offset:1024 sc1
    buffer_load_dwordx4 v[208:211], v129, s[8:11], s49 offen offset:1024 sc1
    buffer_load_dwordx4 v[212:215], v128, s[8:11], s49 offen offset:2048 sc1
    buffer_load_dwordx4 v[216:219], v129, s[8:11], s49 offen offset:2048 sc1
    buffer_load_dwordx4 v[220:223], v128, s[8:11], s49 offen offset:3072 sc1
    buffer_load_dwordx4 v[224:227], v129, s[8:11], s49 offen offset:3072 sc1
    buffer_load_dwordx4 v[164:167], v126, s[8:11], s44 offen offset:0 sc1
    buffer_load_dwordx4 v[168:171], v127, s[8:11], s44 offen offset:0 sc1
    s_waitcnt vmcnt(10)
    v_or3_b32 v17, v180, v184, v188
    v_bitop3_b32 v17, v17, v192, 1 bitop3:0xa8
    v_cmp_ne_u32 vcc, 0, v17
    s_add_u32 s53, s53, 1
    s_cmp_ge_u32 s53, s61
    s_cselect_b32 s61, 0, s61
    s_cbranch_scc1 dm_18k0
    s_cbranch_vccnz dm_18h0
dm_18k0:
    s_cmp_eq_u32 s50, 1
    s_branch dm_18g0
dm_18f1:
    s_cselect_b32 s50, 1, 0
dm_18h1:
    s_sleep 2
    buffer_load_dwordx4 v[196:199], v128, s[8:11], s49 offen offset:0 sc1
    buffer_load_dwordx4 v[200:203], v129, s[8:11], s49 offen offset:0 sc1
    buffer_load_dwordx4 v[204:207], v128, s[8:11], s49 offen offset:1024 sc1
    buffer_load_dwordx4 v[208:211], v129, s[8:11], s49 offen offset:1024 sc1
    buffer_load_dwordx4 v[212:215], v128, s[8:11], s49 offen offset:2048 sc1
    buffer_load_dwordx4 v[216:219], v129, s[8:11], s49 offen offset:2048 sc1
    buffer_load_dwordx4 v[220:223], v128, s[8:11], s49 offen offset:3072 sc1
    buffer_load_dwordx4 v[224:227], v129, s[8:11], s49 offen offset:3072 sc1
    buffer_load_dwordx4 v[164:167], v126, s[8:11], s44 offen offset:0 sc1
    buffer_load_dwordx4 v[168:171], v127, s[8:11], s44 offen offset:0 sc1
    buffer_load_dwordx4 v[172:175], v126, s[8:11], s44 offen offset:1024 sc1
    buffer_load_dwordx4 v[176:179], v127, s[8:11], s44 offen offset:1024 sc1
    buffer_load_dwordx4 v[180:183], v126, s[8:11], s44 offen offset:2048 sc1
    buffer_load_dwordx4 v[184:187], v127, s[8:11], s44 offen offset:2048 sc1
    s_waitcnt vmcnt(10)
    v_or3_b32 v17, v196, v200, v204
    v_bitop3_b32 v17, v17, v208, 1 bitop3:0xa8
    v_cmp_ne_u32 vcc, 0, v17
    s_add_u32 s53, s53, 1
    s_cmp_ge_u32 s53, s61
    s_cselect_b32 s61, 0, s61
    s_cbranch_scc1 dm_18k1
    s_cbranch_vccnz dm_18h1
dm_18k1:
    s_cmp_eq_u32 s50, 1
    s_branch dm_18g1
dm_18f2:
    s_cselect_b32 s50, 1, 0
dm_18h2:
    s_sleep 2
    buffer_load_dwordx4 v[212:215], v128, s[8:11], s49 offen offset:2048 sc1
    buffer_load_dwordx4 v[216:219], v129, s[8:11], s49 offen offset:2048 sc1
    buffer_load_dwordx4 v[220:223], v128, s[8:11], s49 offen offset:3072 sc1
    buffer_load_dwordx4 v[224:227], v129, s[8:11], s49 offen offset:3072 sc1
    buffer_load_dwordx4 v[164:167], v126, s[8:11], s44 offen offset:0 sc1
    buffer_load_dwordx4 v[168:171], v127, s[8:11], s44 offen offset:0 sc1
    buffer_load_dwordx4 v[172:175], v126, s[8:11], s44 offen offset:1024 sc1
    buffer_load_dwordx4 v[176:179], v127, s[8:11], s44 offen offset:1024 sc1
    buffer_load_dwordx4 v[180:183], v126, s[8:11], s44 offen offset:2048 sc1
    buffer_load_dwordx4 v[184:187], v127, s[8:11], s44 offen offset:2048 sc1
    buffer_load_dwordx4 v[188:191], v126, s[8:11], s44 offen offset:3072 sc1
    buffer_load_dwordx4 v[192:195], v127, s[8:11], s44 offen offset:3072 sc1
    buffer_load_dwordx4 v[196:199], v128, s[8:11], s44 offen offset:0 sc1
    buffer_load_dwordx4 v[200:203], v129, s[8:11], s44 offen offset:0 sc1
    s_waitcnt vmcnt(10)
    v_or3_b32 v17, v212, v216, v220
    v_bitop3_b32 v17, v17, v224, 1 bitop3:0xa8
    v_cmp_ne_u32 vcc, 0, v17
    s_add_u32 s53, s53, 1
    s_cmp_ge_u32 s53, s61
    s_cselect_b32 s61, 0, s61
    s_cbranch_scc1 dm_18k2
    s_cbranch_vccnz dm_18h2
dm_18k2:
    s_cmp_eq_u32 s50, 1
    s_branch dm_18g2
dm_18f3:
    s_cselect_b32 s50, 1, 0
dm_18h3:
    s_sleep 2
    buffer_load_dwordx4 v[164:167], v126, s[8:11], s49 offen offset:0 sc1
    buffer_load_dwordx4 v[168:171], v127, s[8:11], s49 offen offset:0 sc1
    buffer_load_dwordx4 v[172:175], v126, s[8:11], s49 offen offset:1024 sc1
    buffer_load_dwordx4 v[176:179], v127, s[8:11], s49 offen offset:1024 sc1
    buffer_load_dwordx4 v[180:183], v126, s[8:11], s49 offen offset:2048 sc1
    buffer_load_dwordx4 v[184:187], v127, s[8:11], s49 offen offset:2048 sc1
    buffer_load_dwordx4 v[188:191], v126, s[8:11], s49 offen offset:3072 sc1
    buffer_load_dwordx4 v[192:195], v127, s[8:11], s49 offen offset:3072 sc1
    buffer_load_dwordx4 v[196:199], v128, s[8:11], s49 offen offset:0 sc1
    buffer_load_dwordx4 v[200:203], v129, s[8:11], s49 offen offset:0 sc1
    buffer_load_dwordx4 v[204:207], v128, s[8:11], s49 offen offset:1024 sc1
    buffer_load_dwordx4 v[208:211], v129, s[8:11], s49 offen offset:1024 sc1
    buffer_load_dwordx4 v[212:215], v128, s[8:11], s49 offen offset:2048 sc1
    buffer_load_dwordx4 v[216:219], v129, s[8:11], s49 offen offset:2048 sc1
    s_waitcnt vmcnt(10)
    v_or3_b32 v17, v164, v168, v172
    v_bitop3_b32 v17, v17, v176, 1 bitop3:0xa8
    v_cmp_ne_u32 vcc, 0, v17
    s_add_u32 s53, s53, 1
    s_cmp_ge_u32 s53, s61
    s_cselect_b32 s61, 0, s61
    s_cbranch_scc1 dm_18k3
    s_cbranch_vccnz dm_18h3
dm_18k3:
    s_cmp_eq_u32 s50, 1
    s_branch dm_18g3
dm_18x:
    v_mfma_f32_16x16x32_bf16 v[24:27], v[88:91], v[212:215], v[24:27]
    buffer_load_dwordx4 v[148:151], v126, s[8:11], s41 offen offset:0 sc1
    v_mfma_f32_16x16x32_bf16 v[40:43], v[88:91], v[216:219], v[40:43]
    v_mfma_f32_16x16x32_bf16 v[44:47], v[92:95], v[216:219], v[44:47]
    buffer_load_dwordx4 v[152:155], v126, s[8:11], s41 offen offset:1024 sc1
    v_mfma_f32_16x16x32_bf16 v[28:31], v[92:95], v[212:215], v[28:31]
    v_mfma_f32_16x16x32_bf16 v[32:35], v[96:99], v[212:215], v[32:35]
    buffer_load_dwordx4 v[156:159], v127, s[8:11], s41 offen offset:0 sc1
    v_mfma_f32_16x16x32_bf16 v[48:51], v[96:99], v[216:219], v[48:51]
    v_mfma_f32_16x16x32_bf16 v[52:55], v[100:103], v[216:219], v[52:55]
    buffer_load_dwordx4 v[160:163], v127, s[8:11], s41 offen offset:1024 sc1
    v_mfma_f32_16x16x32_bf16 v[36:39], v[100:103], v[212:215], v[36:39]
    s_waitcnt lgkmcnt(0)
    s_barrier
    v_mfma_f32_16x16x32_bf16 v[24:27], v[104:107], v[220:223], v[24:27]
    ds_read_b128 v[56:59], v6 offset:0
    v_mfma_f32_16x16x32_bf16 v[40:43], v[104:107], v[224:227], v[40:43]
    ds_read_b128 v[60:63], v6 offset:64
    v_mfma_f32_16x16x32_bf16 v[44:47], v[108:111], v[224:227], v[44:47]
    ds_read_b128 v[64:67], v6 offset:128
    v_mfma_f32_16x16x32_bf16 v[28:31], v[108:111], v[220:223], v[28:31]
    ds_read_b128 v[68:71], v6 offset:192
    v_mfma_f32_16x16x32_bf16 v[32:35], v[112:115], v[220:223], v[32:35]
    ds_read_b64 v[72:73], v7 offset:0
    v_mfma_f32_16x16x32_bf16 v[48:51], v[112:115], v[224:227], v[48:51]
    ds_read_b64 v[74:75], v7 offset:256
    v_mfma_f32_16x16x32_bf16 v[52:55], v[116:119], v[224:227], v[52:55]
    v_mfma_f32_16x16x32_bf16 v[36:39], v[116:119], v[220:223], v[36:39]
    s_waitcnt lgkmcnt(0)
    v_mul_f32 v134, 0xc0135761, v73
    v_mul_f32 v135, v73, v73
    v_mul_f32 v135, v135, v134
    v_mul_f32 v135, 0x3d372713, v135
    v_rcp_f32 v73, v73
    v_mul_f32 v136, 0xc0135761, v75
    v_mul_f32 v137, v75, v75
    v_mul_f32 v137, v137, v136
    v_mul_f32 v137, 0x3d372713, v137
    v_rcp_f32 v75, v75
    v_pk_fma_f32 v[24:25], v[72:73], v[56:57], v[24:25] op_sel_hi:[0,1,1] neg_lo:[1,0,0] neg_hi:[1,0,0]
    v_pk_fma_f32 v[26:27], v[72:73], v[58:59], v[26:27] op_sel_hi:[0,1,1] neg_lo:[1,0,0] neg_hi:[1,0,0]
    v_pk_mul_f32 v[122:123], v[24:25], v[24:25]
    v_pk_mul_f32 v[124:125], v[26:27], v[26:27]
    v_pk_fma_f32 v[122:123], v[122:123], v[134:135], v[134:135] op_sel:[0,1,0] op_sel_hi:[1,1,0]
    v_pk_fma_f32 v[124:125], v[124:125], v[134:135], v[134:135] op_sel:[0,1,0] op_sel_hi:[1,1,0]
    v_pk_mul_f32 v[122:123], v[122:123], v[24:25]
    v_pk_mul_f32 v[124:125], v[124:125], v[26:27]
    v_exp_f32 v122, v122
    v_exp_f32 v123, v123
    v_exp_f32 v124, v124
    v_exp_f32 v125, v125
    v_pk_fma_f32 v[122:123], v[122:123], v[72:73], v[72:73] op_sel:[0,1,1] op_sel_hi:[1,1,1]
    v_pk_fma_f32 v[124:125], v[124:125], v[72:73], v[72:73] op_sel:[0,1,1] op_sel_hi:[1,1,1]
    v_rcp_f32 v122, v122
    v_rcp_f32 v123, v123
    v_rcp_f32 v124, v124
    v_rcp_f32 v125, v125
    v_pk_mul_f32 v[24:25], v[24:25], v[122:123]
    v_pk_mul_f32 v[26:27], v[26:27], v[124:125]
    v_pk_fma_f32 v[28:29], v[72:73], v[60:61], v[28:29] op_sel_hi:[0,1,1] neg_lo:[1,0,0] neg_hi:[1,0,0]
    v_pk_fma_f32 v[30:31], v[72:73], v[62:63], v[30:31] op_sel_hi:[0,1,1] neg_lo:[1,0,0] neg_hi:[1,0,0]
    v_pk_mul_f32 v[122:123], v[28:29], v[28:29]
    v_pk_mul_f32 v[124:125], v[30:31], v[30:31]
    v_pk_fma_f32 v[122:123], v[122:123], v[134:135], v[134:135] op_sel:[0,1,0] op_sel_hi:[1,1,0]
    v_pk_fma_f32 v[124:125], v[124:125], v[134:135], v[134:135] op_sel:[0,1,0] op_sel_hi:[1,1,0]
    v_pk_mul_f32 v[122:123], v[122:123], v[28:29]
    v_pk_mul_f32 v[124:125], v[124:125], v[30:31]
    v_exp_f32 v122, v122
    v_exp_f32 v123, v123
    v_exp_f32 v124, v124
    v_exp_f32 v125, v125
    v_pk_fma_f32 v[122:123], v[122:123], v[72:73], v[72:73] op_sel:[0,1,1] op_sel_hi:[1,1,1]
    v_pk_fma_f32 v[124:125], v[124:125], v[72:73], v[72:73] op_sel:[0,1,1] op_sel_hi:[1,1,1]
    v_rcp_f32 v122, v122
    v_rcp_f32 v123, v123
    v_rcp_f32 v124, v124
    v_rcp_f32 v125, v125
    v_pk_mul_f32 v[28:29], v[28:29], v[122:123]
    v_pk_mul_f32 v[30:31], v[30:31], v[124:125]
    v_cvt_pk_bf16_f32 v24, v24, v25
    v_cvt_pk_bf16_f32 v25, v26, v27
    v_cvt_pk_bf16_f32 v26, v28, v29
    v_cvt_pk_bf16_f32 v27, v30, v31
    v_and_b32 v24, -2, v24
    buffer_store_dwordx4 v[24:27], v12, s[16:19], s39 offen offset:0 sc1
    v_pk_fma_f32 v[40:41], v[74:75], v[56:57], v[40:41] op_sel_hi:[0,1,1] neg_lo:[1,0,0] neg_hi:[1,0,0]
    v_pk_fma_f32 v[42:43], v[74:75], v[58:59], v[42:43] op_sel_hi:[0,1,1] neg_lo:[1,0,0] neg_hi:[1,0,0]
    v_pk_mul_f32 v[122:123], v[40:41], v[40:41]
    v_pk_mul_f32 v[124:125], v[42:43], v[42:43]
    v_pk_fma_f32 v[122:123], v[122:123], v[136:137], v[136:137] op_sel:[0,1,0] op_sel_hi:[1,1,0]
    v_pk_fma_f32 v[124:125], v[124:125], v[136:137], v[136:137] op_sel:[0,1,0] op_sel_hi:[1,1,0]
    v_pk_mul_f32 v[122:123], v[122:123], v[40:41]
    v_pk_mul_f32 v[124:125], v[124:125], v[42:43]
    v_exp_f32 v122, v122
    v_exp_f32 v123, v123
    v_exp_f32 v124, v124
    v_exp_f32 v125, v125
    v_pk_fma_f32 v[122:123], v[122:123], v[74:75], v[74:75] op_sel:[0,1,1] op_sel_hi:[1,1,1]
    v_pk_fma_f32 v[124:125], v[124:125], v[74:75], v[74:75] op_sel:[0,1,1] op_sel_hi:[1,1,1]
    v_rcp_f32 v122, v122
    v_rcp_f32 v123, v123
    v_rcp_f32 v124, v124
    v_rcp_f32 v125, v125
    v_pk_mul_f32 v[40:41], v[40:41], v[122:123]
    v_pk_mul_f32 v[42:43], v[42:43], v[124:125]
    v_pk_fma_f32 v[44:45], v[74:75], v[60:61], v[44:45] op_sel_hi:[0,1,1] neg_lo:[1,0,0] neg_hi:[1,0,0]
    v_pk_fma_f32 v[46:47], v[74:75], v[62:63], v[46:47] op_sel_hi:[0,1,1] neg_lo:[1,0,0] neg_hi:[1,0,0]
    v_pk_mul_f32 v[122:123], v[44:45], v[44:45]
    v_pk_mul_f32 v[124:125], v[46:47], v[46:47]
    v_pk_fma_f32 v[122:123], v[122:123], v[136:137], v[136:137] op_sel:[0,1,0] op_sel_hi:[1,1,0]
    v_pk_fma_f32 v[124:125], v[124:125], v[136:137], v[136:137] op_sel:[0,1,0] op_sel_hi:[1,1,0]
    v_pk_mul_f32 v[122:123], v[122:123], v[44:45]
    v_pk_mul_f32 v[124:125], v[124:125], v[46:47]
    v_exp_f32 v122, v122
    v_exp_f32 v123, v123
    v_exp_f32 v124, v124
    v_exp_f32 v125, v125
    v_pk_fma_f32 v[122:123], v[122:123], v[74:75], v[74:75] op_sel:[0,1,1] op_sel_hi:[1,1,1]
    v_pk_fma_f32 v[124:125], v[124:125], v[74:75], v[74:75] op_sel:[0,1,1] op_sel_hi:[1,1,1]
    v_rcp_f32 v122, v122
    v_rcp_f32 v123, v123
    v_rcp_f32 v124, v124
    v_rcp_f32 v125, v125
    v_pk_mul_f32 v[44:45], v[44:45], v[122:123]
    v_pk_mul_f32 v[46:47], v[46:47], v[124:125]
    v_cvt_pk_bf16_f32 v40, v40, v41
    v_cvt_pk_bf16_f32 v41, v42, v43
    v_cvt_pk_bf16_f32 v42, v44, v45
    v_cvt_pk_bf16_f32 v43, v46, v47
    v_and_b32 v40, -2, v40
    buffer_store_dwordx4 v[40:43], v12, s[16:19], s39 offen offset:256 sc1
    v_pk_fma_f32 v[32:33], v[72:73], v[64:65], v[32:33] op_sel_hi:[0,1,1] neg_lo:[1,0,0] neg_hi:[1,0,0]
    v_pk_fma_f32 v[34:35], v[72:73], v[66:67], v[34:35] op_sel_hi:[0,1,1] neg_lo:[1,0,0] neg_hi:[1,0,0]
    v_pk_mul_f32 v[122:123], v[32:33], v[32:33]
    v_pk_mul_f32 v[124:125], v[34:35], v[34:35]
    v_pk_fma_f32 v[122:123], v[122:123], v[134:135], v[134:135] op_sel:[0,1,0] op_sel_hi:[1,1,0]
    v_pk_fma_f32 v[124:125], v[124:125], v[134:135], v[134:135] op_sel:[0,1,0] op_sel_hi:[1,1,0]
    v_pk_mul_f32 v[122:123], v[122:123], v[32:33]
    v_pk_mul_f32 v[124:125], v[124:125], v[34:35]
    v_exp_f32 v122, v122
    v_exp_f32 v123, v123
    v_exp_f32 v124, v124
    v_exp_f32 v125, v125
    v_pk_fma_f32 v[122:123], v[122:123], v[72:73], v[72:73] op_sel:[0,1,1] op_sel_hi:[1,1,1]
    v_pk_fma_f32 v[124:125], v[124:125], v[72:73], v[72:73] op_sel:[0,1,1] op_sel_hi:[1,1,1]
    v_rcp_f32 v122, v122
    v_rcp_f32 v123, v123
    v_rcp_f32 v124, v124
    v_rcp_f32 v125, v125
    v_pk_mul_f32 v[32:33], v[32:33], v[122:123]
    v_pk_mul_f32 v[34:35], v[34:35], v[124:125]
    v_pk_fma_f32 v[36:37], v[72:73], v[68:69], v[36:37] op_sel_hi:[0,1,1] neg_lo:[1,0,0] neg_hi:[1,0,0]
    v_pk_fma_f32 v[38:39], v[72:73], v[70:71], v[38:39] op_sel_hi:[0,1,1] neg_lo:[1,0,0] neg_hi:[1,0,0]
    v_pk_mul_f32 v[122:123], v[36:37], v[36:37]
    v_pk_mul_f32 v[124:125], v[38:39], v[38:39]
    v_pk_fma_f32 v[122:123], v[122:123], v[134:135], v[134:135] op_sel:[0,1,0] op_sel_hi:[1,1,0]
    v_pk_fma_f32 v[124:125], v[124:125], v[134:135], v[134:135] op_sel:[0,1,0] op_sel_hi:[1,1,0]
    v_pk_mul_f32 v[122:123], v[122:123], v[36:37]
    v_pk_mul_f32 v[124:125], v[124:125], v[38:39]
    v_exp_f32 v122, v122
    v_exp_f32 v123, v123
    v_exp_f32 v124, v124
    v_exp_f32 v125, v125
    v_pk_fma_f32 v[122:123], v[122:123], v[72:73], v[72:73] op_sel:[0,1,1] op_sel_hi:[1,1,1]
    v_pk_fma_f32 v[124:125], v[124:125], v[72:73], v[72:73] op_sel:[0,1,1] op_sel_hi:[1,1,1]
    v_rcp_f32 v122, v122
    v_rcp_f32 v123, v123
    v_rcp_f32 v124, v124
    v_rcp_f32 v125, v125
    v_pk_mul_f32 v[36:37], v[36:37], v[122:123]
    v_pk_mul_f32 v[38:39], v[38:39], v[124:125]
    v_cvt_pk_bf16_f32 v32, v32, v33
    v_cvt_pk_bf16_f32 v33, v34, v35
    v_cvt_pk_bf16_f32 v34, v36, v37
    v_cvt_pk_bf16_f32 v35, v38, v39
    v_and_b32 v32, -2, v32
    buffer_store_dwordx4 v[32:35], v12, s[16:19], s40 offen offset:0 sc1
    v_pk_fma_f32 v[48:49], v[74:75], v[64:65], v[48:49] op_sel_hi:[0,1,1] neg_lo:[1,0,0] neg_hi:[1,0,0]
    v_pk_fma_f32 v[50:51], v[74:75], v[66:67], v[50:51] op_sel_hi:[0,1,1] neg_lo:[1,0,0] neg_hi:[1,0,0]
    v_pk_mul_f32 v[122:123], v[48:49], v[48:49]
    v_pk_mul_f32 v[124:125], v[50:51], v[50:51]
    v_pk_fma_f32 v[122:123], v[122:123], v[136:137], v[136:137] op_sel:[0,1,0] op_sel_hi:[1,1,0]
    v_pk_fma_f32 v[124:125], v[124:125], v[136:137], v[136:137] op_sel:[0,1,0] op_sel_hi:[1,1,0]
    v_pk_mul_f32 v[122:123], v[122:123], v[48:49]
    v_pk_mul_f32 v[124:125], v[124:125], v[50:51]
    v_exp_f32 v122, v122
    v_exp_f32 v123, v123
    v_exp_f32 v124, v124
    v_exp_f32 v125, v125
    v_pk_fma_f32 v[122:123], v[122:123], v[74:75], v[74:75] op_sel:[0,1,1] op_sel_hi:[1,1,1]
    v_pk_fma_f32 v[124:125], v[124:125], v[74:75], v[74:75] op_sel:[0,1,1] op_sel_hi:[1,1,1]
    v_rcp_f32 v122, v122
    v_rcp_f32 v123, v123
    v_rcp_f32 v124, v124
    v_rcp_f32 v125, v125
    v_pk_mul_f32 v[48:49], v[48:49], v[122:123]
    v_pk_mul_f32 v[50:51], v[50:51], v[124:125]
    v_pk_fma_f32 v[52:53], v[74:75], v[68:69], v[52:53] op_sel_hi:[0,1,1] neg_lo:[1,0,0] neg_hi:[1,0,0]
    v_pk_fma_f32 v[54:55], v[74:75], v[70:71], v[54:55] op_sel_hi:[0,1,1] neg_lo:[1,0,0] neg_hi:[1,0,0]
    v_pk_mul_f32 v[122:123], v[52:53], v[52:53]
    v_pk_mul_f32 v[124:125], v[54:55], v[54:55]
    v_pk_fma_f32 v[122:123], v[122:123], v[136:137], v[136:137] op_sel:[0,1,0] op_sel_hi:[1,1,0]
    v_pk_fma_f32 v[124:125], v[124:125], v[136:137], v[136:137] op_sel:[0,1,0] op_sel_hi:[1,1,0]
    v_pk_mul_f32 v[122:123], v[122:123], v[52:53]
    v_pk_mul_f32 v[124:125], v[124:125], v[54:55]
    v_exp_f32 v122, v122
    v_exp_f32 v123, v123
    v_exp_f32 v124, v124
    v_exp_f32 v125, v125
    v_pk_fma_f32 v[122:123], v[122:123], v[74:75], v[74:75] op_sel:[0,1,1] op_sel_hi:[1,1,1]
    v_pk_fma_f32 v[124:125], v[124:125], v[74:75], v[74:75] op_sel:[0,1,1] op_sel_hi:[1,1,1]
    v_rcp_f32 v122, v122
    v_rcp_f32 v123, v123
    v_rcp_f32 v124, v124
    v_rcp_f32 v125, v125
    v_pk_mul_f32 v[52:53], v[52:53], v[122:123]
    v_pk_mul_f32 v[54:55], v[54:55], v[124:125]
    v_cvt_pk_bf16_f32 v48, v48, v49
    v_cvt_pk_bf16_f32 v49, v50, v51
    v_cvt_pk_bf16_f32 v50, v52, v53
    v_cvt_pk_bf16_f32 v51, v54, v55
    v_and_b32 v48, -2, v48
    buffer_store_dwordx4 v[48:51], v12, s[16:19], s40 offen offset:256 sc1
    s_add_u32 s8, s4, 0x2100000
    s_addc_u32 s9, s5, 0
    s_mov_b32 s10, 0x8400000
    s_mov_b32 s11, 0x20000
    s_sub_u32 s47, s55, 39583744
    s_lshl_b32 s46, s30, 9
    s_add_u32 s47, s47, s46
    s_add_u32 s45, s92, 2048
    s_cmp_eq_u32 s28, 0
    s_cselect_b32 s45, 1073741824, s45
    s_cmp_eq_u32 s30, 0
    s_cselect_b32 s45, s45, 0
    s_add_u32 s53, s47, 0xfffffff0
    v_add_u32 v126, s53, v12
    v_add_u32 v127, 256, v126
    v_add_u32 v134, s45, v126
    v_cmp_gt_u32 vcc, 1, v22
    s_nop 1
    v_cndmask_b32 v126, v126, v134, vcc
    s_mov_b32 s34, s30
    s_mov_b32 s35, 0
    v_and_b32 v22, 15, v1
    v_lshrrev_b32 v23, 4, v1
    s_mul_i32 s37, s34, 2
    s_mul_i32 s38, s29, 4
    s_mul_i32 s36, s35, 4
    s_add_u32 s38, s38, s36
    s_lshr_b32 s36, s38, 1
    s_lshr_b32 s53, s36, 3
    s_lshl_b32 s53, s53, 14
    s_and_b32 s39, s36, 7
    s_lshl_b32 s39, s39, 10
    s_add_u32 s39, s39, s53
    s_lshl_b32 s36, s37, 16
    s_add_u32 s39, s39, s36
    s_sub_u32 s46, s93, 2048
    s_cmp_eq_u32 s28, 15
    s_cselect_b32 s46, 1073741824, s46
    s_cmp_eq_u32 s30, 3
    s_cselect_b32 s46, s46, 0
    s_add_u32 s53, s47, 0x10
    v_add_u32 v128, s53, v12
    v_add_u32 v129, 256, v128
    v_add_u32 v134, s46, v129
    v_cmp_le_u32 vcc, 15, v22
    s_nop 1
    v_cndmask_b32 v129, v129, v134, vcc
    s_add_u32 s53, s47, 0xffffffe0
    v_add_u32 v130, s53, v12
    v_add_u32 v131, 256, v130
    v_add_u32 v134, s45, v130
    v_cmp_gt_u32 vcc, 2, v22
    s_nop 1
    v_cndmask_b32 v130, v130, v134, vcc
    s_add_u32 s53, s47, 0x20
    v_add_u32 v132, s53, v12
    v_add_u32 v133, 256, v132
    v_add_u32 v134, s46, v133
    v_cmp_le_u32 vcc, 14, v22
    s_nop 1
    v_cndmask_b32 v133, v133, v134, vcc
    v_mov_b32 v134, v126
    v_mov_b32 v135, v127
    v_lshrrev_b32 v6, 2, v1
    v_mul_u32_u24 v13, 128, v6
    v_and_b32 v7, 3, v1
    v_lshl_add_u32 v13, v7, 3, v13
    v_add_u32 v13, 0, v13
    v_bfe_u32 v6, v6, 1, 2
    s_mul_i32 s36, s35, 4
    s_add_u32 s36, s36, 3
    v_xor_b32 v7, s36, v6
    v_lshl_add_u32 v16, v7, 5, v13
    s_mul_i32 s36, s35, 4
    s_add_u32 s36, s36, 2
    v_xor_b32 v7, s36, v6
    v_lshl_add_u32 v15, v7, 5, v13
    s_mul_i32 s36, s35, 4
    s_add_u32 s36, s36, 1
    v_xor_b32 v7, s36, v6
    v_lshl_add_u32 v14, v7, 5, v13
    s_mul_i32 s36, s35, 4
    s_add_u32 s36, s36, 0
    v_xor_b32 v7, s36, v6
    v_lshl_add_u32 v13, v7, 5, v13
    s_lshl_b32 s36, s37, 8
    s_add_u32 s36, s36, 160768
    v_lshlrev_b32 v7, 4, v22
    v_add_u32 v7, s36, v7
    ds_read_b64 v[56:57], v7 offset:0
    ds_read_b64 v[58:59], v7 offset:256
    s_waitcnt vmcnt(4) lgkmcnt(0)
    s_sleep 3
    s_cmp_lg_u32 s60, 0
    s_cbranch_scc1 G2_nd
    s_sleep 20
G2_nd:
    s_mov_b32 s44, 0
    buffer_load_dwordx4 v[164:167], v126, s[8:11], s44 offen sc1
    buffer_load_dwordx4 v[168:171], v127, s[8:11], s44 offen sc1
    s_add_u32 s44, s44, 16384
    buffer_load_dwordx4 v[172:175], v126, s[8:11], s44 offen sc1
    buffer_load_dwordx4 v[176:179], v127, s[8:11], s44 offen sc1
    s_add_u32 s44, s44, 16384
    v_lshlrev_b32 v24, 16, v148
    v_and_b32 v25, 0xffff0000, v148
    v_pk_add_f32 v[24:25], v[24:25], v[56:57] op_sel_hi:[1,0] neg_lo:[0,1] neg_hi:[0,1]
    v_pk_mul_f32 v[24:25], v[24:25], v[56:57] op_sel:[0,1] op_sel_hi:[1,1]
    v_lshlrev_b32 v26, 16, v149
    v_and_b32 v27, 0xffff0000, v149
    v_pk_add_f32 v[26:27], v[26:27], v[56:57] op_sel_hi:[1,0] neg_lo:[0,1] neg_hi:[0,1]
    v_pk_mul_f32 v[26:27], v[26:27], v[56:57] op_sel:[0,1] op_sel_hi:[1,1]
    v_lshlrev_b32 v28, 16, v150
    v_and_b32 v29, 0xffff0000, v150
    v_pk_add_f32 v[28:29], v[28:29], v[56:57] op_sel_hi:[1,0] neg_lo:[0,1] neg_hi:[0,1]
    v_pk_mul_f32 v[28:29], v[28:29], v[56:57] op_sel:[0,1] op_sel_hi:[1,1]
    v_lshlrev_b32 v30, 16, v151
    v_and_b32 v31, 0xffff0000, v151
    v_pk_add_f32 v[30:31], v[30:31], v[56:57] op_sel_hi:[1,0] neg_lo:[0,1] neg_hi:[0,1]
    v_pk_mul_f32 v[30:31], v[30:31], v[56:57] op_sel:[0,1] op_sel_hi:[1,1]
    v_lshlrev_b32 v32, 16, v152
    v_and_b32 v33, 0xffff0000, v152
    v_pk_add_f32 v[32:33], v[32:33], v[56:57] op_sel_hi:[1,0] neg_lo:[0,1] neg_hi:[0,1]
    v_pk_mul_f32 v[32:33], v[32:33], v[56:57] op_sel:[0,1] op_sel_hi:[1,1]
    v_lshlrev_b32 v34, 16, v153
    v_and_b32 v35, 0xffff0000, v153
    v_pk_add_f32 v[34:35], v[34:35], v[56:57] op_sel_hi:[1,0] neg_lo:[0,1] neg_hi:[0,1]
    v_pk_mul_f32 v[34:35], v[34:35], v[56:57] op_sel:[0,1] op_sel_hi:[1,1]
    v_lshlrev_b32 v36, 16, v154
    v_and_b32 v37, 0xffff0000, v154
    v_pk_add_f32 v[36:37], v[36:37], v[56:57] op_sel_hi:[1,0] neg_lo:[0,1] neg_hi:[0,1]
    v_pk_mul_f32 v[36:37], v[36:37], v[56:57] op_sel:[0,1] op_sel_hi:[1,1]
    v_lshlrev_b32 v38, 16, v155
    v_and_b32 v39, 0xffff0000, v155
    v_pk_add_f32 v[38:39], v[38:39], v[56:57] op_sel_hi:[1,0] neg_lo:[0,1] neg_hi:[0,1]
    v_pk_mul_f32 v[38:39], v[38:39], v[56:57] op_sel:[0,1] op_sel_hi:[1,1]
    v_lshlrev_b32 v40, 16, v156
    v_and_b32 v41, 0xffff0000, v156
    v_pk_add_f32 v[40:41], v[40:41], v[58:59] op_sel_hi:[1,0] neg_lo:[0,1] neg_hi:[0,1]
    v_pk_mul_f32 v[40:41], v[40:41], v[58:59] op_sel:[0,1] op_sel_hi:[1,1]
    v_lshlrev_b32 v42, 16, v157
    v_and_b32 v43, 0xffff0000, v157
    v_pk_add_f32 v[42:43], v[42:43], v[58:59] op_sel_hi:[1,0] neg_lo:[0,1] neg_hi:[0,1]
    v_pk_mul_f32 v[42:43], v[42:43], v[58:59] op_sel:[0,1] op_sel_hi:[1,1]
    v_lshlrev_b32 v44, 16, v158
    v_and_b32 v45, 0xffff0000, v158
    v_pk_add_f32 v[44:45], v[44:45], v[58:59] op_sel_hi:[1,0] neg_lo:[0,1] neg_hi:[0,1]
    v_pk_mul_f32 v[44:45], v[44:45], v[58:59] op_sel:[0,1] op_sel_hi:[1,1]
    v_lshlrev_b32 v46, 16, v159
    v_and_b32 v47, 0xffff0000, v159
    v_pk_add_f32 v[46:47], v[46:47], v[58:59] op_sel_hi:[1,0] neg_lo:[0,1] neg_hi:[0,1]
    v_pk_mul_f32 v[46:47], v[46:47], v[58:59] op_sel:[0,1] op_sel_hi:[1,1]
    v_lshlrev_b32 v48, 16, v160
    v_and_b32 v49, 0xffff0000, v160
    v_pk_add_f32 v[48:49], v[48:49], v[58:59] op_sel_hi:[1,0] neg_lo:[0,1] neg_hi:[0,1]
    v_pk_mul_f32 v[48:49], v[48:49], v[58:59] op_sel:[0,1] op_sel_hi:[1,1]
    v_lshlrev_b32 v50, 16, v161
    v_and_b32 v51, 0xffff0000, v161
    v_pk_add_f32 v[50:51], v[50:51], v[58:59] op_sel_hi:[1,0] neg_lo:[0,1] neg_hi:[0,1]
    v_pk_mul_f32 v[50:51], v[50:51], v[58:59] op_sel:[0,1] op_sel_hi:[1,1]
    v_lshlrev_b32 v52, 16, v162
    v_and_b32 v53, 0xffff0000, v162
    v_pk_add_f32 v[52:53], v[52:53], v[58:59] op_sel_hi:[1,0] neg_lo:[0,1] neg_hi:[0,1]
    v_pk_mul_f32 v[52:53], v[52:53], v[58:59] op_sel:[0,1] op_sel_hi:[1,1]
    v_lshlrev_b32 v54, 16, v163
    v_and_b32 v55, 0xffff0000, v163
    v_pk_add_f32 v[54:55], v[54:55], v[58:59] op_sel_hi:[1,0] neg_lo:[0,1] neg_hi:[0,1]
    v_pk_mul_f32 v[54:55], v[54:55], v[58:59] op_sel:[0,1] op_sel_hi:[1,1]
    s_mov_b32 s43, 0
    s_add_u32 s16, s62, 0x80000
    s_addc_u32 s17, s63, 0
    s_mov_b32 s18, 0x7e000
    s_mov_b32 s19, 0x20000
    s_mov_b32 s53, 0
    s_mov_b32 s49, s44
    s_barrier
    ds_read_b64_tr_b16 v[56:57], v13 offset:0
    ds_read_b64_tr_b16 v[58:59], v13 offset:2048
    ds_read_b64_tr_b16 v[60:61], v14 offset:0
    ds_read_b64_tr_b16 v[62:63], v14 offset:2048
    ds_read_b64_tr_b16 v[64:65], v15 offset:0
    ds_read_b64_tr_b16 v[66:67], v15 offset:2048
    ds_read_b64_tr_b16 v[68:69], v16 offset:0
    ds_read_b64_tr_b16 v[70:71], v16 offset:2048
    ds_read_b64_tr_b16 v[72:73], v13 offset:4096
    ds_read_b64_tr_b16 v[74:75], v13 offset:6144
    ds_read_b64_tr_b16 v[76:77], v14 offset:4096
    ds_read_b64_tr_b16 v[78:79], v14 offset:6144
    ds_read_b64_tr_b16 v[80:81], v15 offset:4096
    ds_read_b64_tr_b16 v[82:83], v15 offset:6144
    ds_read_b64_tr_b16 v[84:85], v16 offset:4096
    ds_read_b64_tr_b16 v[86:87], v16 offset:6144
    s_branch dm_19w
dm_19p:
    s_mov_b32 s44, 0
    buffer_load_dwordx4 v[164:167], v126, s[8:11], s44 offen sc1
    buffer_load_dwordx4 v[168:171], v127, s[8:11], s44 offen sc1
    s_add_u32 s44, s44, 16384
    buffer_load_dwordx4 v[172:175], v126, s[8:11], s44 offen sc1
    buffer_load_dwordx4 v[176:179], v127, s[8:11], s44 offen sc1
    s_add_u32 s44, s44, 16384
dm_19w:
    s_waitcnt vmcnt(0)
    v_or3_b32 v17, v164, v168, v172
    v_bitop3_b32 v17, v17, v176, 1 bitop3:0xa8
    v_cmp_ne_u32 vcc, 0, v17
    s_cbranch_vccz dm_19q
    s_sleep 2
    s_add_u32 s53, s53, 1
    s_cmp_lt_u32 s53, s61
    s_cbranch_scc1 dm_19p
    s_mov_b32 s61, 0
dm_19q:
    buffer_load_dwordx4 v[180:183], v126, s[8:11], s44 offen
    buffer_load_dwordx4 v[184:187], v127, s[8:11], s44 offen
    s_add_u32 s44, s44, 16384
    buffer_load_dwordx4 v[188:191], v126, s[8:11], s44 offen
    buffer_load_dwordx4 v[192:195], v127, s[8:11], s44 offen
    s_add_u32 s44, s44, 16384
    buffer_load_dwordx4 v[196:199], v126, s[8:11], s44 offen
    buffer_load_dwordx4 v[200:203], v127, s[8:11], s44 offen
    s_add_u32 s44, s44, 16384
    buffer_load_dwordx4 v[204:207], v126, s[8:11], s44 offen
    buffer_load_dwordx4 v[208:211], v127, s[8:11], s44 offen
    s_add_u32 s44, s44, 16384
    buffer_load_dwordx4 v[212:215], v126, s[8:11], s44 offen
    buffer_load_dwordx4 v[216:219], v127, s[8:11], s44 offen
    s_add_u32 s44, s44, 16384
    s_waitcnt lgkmcnt(0)
dm_19:
    v_mfma_f32_16x16x32_bf16 v[24:27], v[56:59], v[164:167], v[24:27]
    ds_read_b64_tr_b16 v[88:89], v13 offset:8192
    buffer_load_dwordx4 v[220:223], v126, s[8:11], s44 offen
    v_mfma_f32_16x16x32_bf16 v[40:43], v[56:59], v[168:171], v[40:43]
    ds_read_b64_tr_b16 v[90:91], v13 offset:10240
    buffer_load_dwordx4 v[224:227], v127, s[8:11], s44 offen
    v_mfma_f32_16x16x32_bf16 v[44:47], v[60:63], v[168:171], v[44:47]
    ds_read_b64_tr_b16 v[92:93], v14 offset:8192
    s_add_u32 s44, s44, 16384
    v_mfma_f32_16x16x32_bf16 v[28:31], v[60:63], v[164:167], v[28:31]
    ds_read_b64_tr_b16 v[94:95], v14 offset:10240
    v_mov_b32 v126, v128
    v_mfma_f32_16x16x32_bf16 v[32:35], v[64:67], v[164:167], v[32:35]
    ds_read_b64_tr_b16 v[96:97], v15 offset:8192
    v_mov_b32 v127, v129
    v_mfma_f32_16x16x32_bf16 v[48:51], v[64:67], v[168:171], v[48:51]
    ds_read_b64_tr_b16 v[98:99], v15 offset:10240
    v_mov_b32 v128, v130
    v_mfma_f32_16x16x32_bf16 v[52:55], v[68:71], v[168:171], v[52:55]
    ds_read_b64_tr_b16 v[100:101], v16 offset:8192
    v_mov_b32 v129, v131
    v_mfma_f32_16x16x32_bf16 v[36:39], v[68:71], v[164:167], v[36:39]
    ds_read_b64_tr_b16 v[102:103], v16 offset:10240
    s_waitcnt lgkmcnt(8)
    v_mfma_f32_16x16x32_bf16 v[24:27], v[72:75], v[172:175], v[24:27]
    ds_read_b64_tr_b16 v[104:105], v13 offset:12288
    buffer_load_dwordx4 v[164:167], v126, s[8:11], s44 offen
    v_mfma_f32_16x16x32_bf16 v[40:43], v[72:75], v[176:179], v[40:43]
    ds_read_b64_tr_b16 v[106:107], v13 offset:14336
    buffer_load_dwordx4 v[168:171], v127, s[8:11], s44 offen
    v_mfma_f32_16x16x32_bf16 v[44:47], v[76:79], v[176:179], v[44:47]
    ds_read_b64_tr_b16 v[108:109], v14 offset:12288
    s_add_u32 s44, s44, 16384
    s_waitcnt vmcnt(10)
    v_mfma_f32_16x16x32_bf16 v[28:31], v[76:79], v[172:175], v[28:31]
    ds_read_b64_tr_b16 v[110:111], v14 offset:14336
    v_or3_b32 v17, v180, v184, v188
    v_mfma_f32_16x16x32_bf16 v[32:35], v[80:83], v[172:175], v[32:35]
    ds_read_b64_tr_b16 v[112:113], v15 offset:12288
    v_bitop3_b32 v17, v17, v192, 1 bitop3:0xa8
    v_mfma_f32_16x16x32_bf16 v[48:51], v[80:83], v[176:179], v[48:51]
    ds_read_b64_tr_b16 v[114:115], v15 offset:14336
    v_cmp_ne_u32 vcc, 0, v17
    v_mfma_f32_16x16x32_bf16 v[52:55], v[84:87], v[176:179], v[52:55]
    ds_read_b64_tr_b16 v[116:117], v16 offset:12288
    ds_read_b64_tr_b16 v[118:119], v16 offset:14336
    v_mfma_f32_16x16x32_bf16 v[36:39], v[84:87], v[172:175], v[36:39]
    s_waitcnt lgkmcnt(8)
    s_cbranch_vccnz dm_19f0
dm_19g0:
    v_mfma_f32_16x16x32_bf16 v[24:27], v[88:91], v[180:183], v[24:27]
    ds_read_b64_tr_b16 v[56:57], v13 offset:16384
    buffer_load_dwordx4 v[172:175], v126, s[8:11], s44 offen
    v_mfma_f32_16x16x32_bf16 v[40:43], v[88:91], v[184:187], v[40:43]
    ds_read_b64_tr_b16 v[58:59], v13 offset:18432
    buffer_load_dwordx4 v[176:179], v127, s[8:11], s44 offen
    v_mfma_f32_16x16x32_bf16 v[44:47], v[92:95], v[184:187], v[44:47]
    ds_read_b64_tr_b16 v[60:61], v14 offset:16384
    s_add_u32 s44, s44, 16384
    v_mfma_f32_16x16x32_bf16 v[28:31], v[92:95], v[180:183], v[28:31]
    ds_read_b64_tr_b16 v[62:63], v14 offset:18432
    v_mov_b32 v130, v132
    v_mfma_f32_16x16x32_bf16 v[32:35], v[96:99], v[180:183], v[32:35]
    ds_read_b64_tr_b16 v[64:65], v15 offset:16384
    v_mov_b32 v131, v133
    v_mfma_f32_16x16x32_bf16 v[48:51], v[96:99], v[184:187], v[48:51]
    ds_read_b64_tr_b16 v[66:67], v15 offset:18432
    v_mov_b32 v132, 1073741824
    v_mfma_f32_16x16x32_bf16 v[52:55], v[100:103], v[184:187], v[52:55]
    ds_read_b64_tr_b16 v[68:69], v16 offset:16384
    v_mov_b32 v133, 1073741824
    v_mfma_f32_16x16x32_bf16 v[36:39], v[100:103], v[180:183], v[36:39]
    ds_read_b64_tr_b16 v[70:71], v16 offset:18432
    s_waitcnt lgkmcnt(8)
    v_mfma_f32_16x16x32_bf16 v[24:27], v[104:107], v[188:191], v[24:27]
    ds_read_b64_tr_b16 v[72:73], v13 offset:20480
    buffer_load_dwordx4 v[180:183], v126, s[8:11], s44 offen
    v_mfma_f32_16x16x32_bf16 v[40:43], v[104:107], v[192:195], v[40:43]
    ds_read_b64_tr_b16 v[74:75], v13 offset:22528
    buffer_load_dwordx4 v[184:187], v127, s[8:11], s44 offen
    v_mfma_f32_16x16x32_bf16 v[44:47], v[108:111], v[192:195], v[44:47]
    ds_read_b64_tr_b16 v[76:77], v14 offset:20480
    s_add_u32 s44, s44, 16384
    s_waitcnt vmcnt(10)
    v_mfma_f32_16x16x32_bf16 v[28:31], v[108:111], v[188:191], v[28:31]
    ds_read_b64_tr_b16 v[78:79], v14 offset:22528
    v_or3_b32 v17, v196, v200, v204
    v_mfma_f32_16x16x32_bf16 v[32:35], v[112:115], v[188:191], v[32:35]
    ds_read_b64_tr_b16 v[80:81], v15 offset:20480
    v_bitop3_b32 v17, v17, v208, 1 bitop3:0xa8
    v_mfma_f32_16x16x32_bf16 v[48:51], v[112:115], v[192:195], v[48:51]
    ds_read_b64_tr_b16 v[82:83], v15 offset:22528
    v_cmp_ne_u32 vcc, 0, v17
    v_mfma_f32_16x16x32_bf16 v[52:55], v[116:119], v[192:195], v[52:55]
    ds_read_b64_tr_b16 v[84:85], v16 offset:20480
    ds_read_b64_tr_b16 v[86:87], v16 offset:22528
    v_mfma_f32_16x16x32_bf16 v[36:39], v[116:119], v[188:191], v[36:39]
    s_waitcnt lgkmcnt(8)
    s_cbranch_vccnz dm_19f1
dm_19g1:
    v_mfma_f32_16x16x32_bf16 v[24:27], v[56:59], v[196:199], v[24:27]
    ds_read_b64_tr_b16 v[88:89], v13 offset:24576
    buffer_load_dwordx4 v[188:191], v126, s[8:11], s44 offen
    v_mfma_f32_16x16x32_bf16 v[40:43], v[56:59], v[200:203], v[40:43]
    ds_read_b64_tr_b16 v[90:91], v13 offset:26624
    buffer_load_dwordx4 v[192:195], v127, s[8:11], s44 offen
    v_mfma_f32_16x16x32_bf16 v[44:47], v[60:63], v[200:203], v[44:47]
    ds_read_b64_tr_b16 v[92:93], v14 offset:24576
    s_add_u32 s44, s44, 16384
    v_mfma_f32_16x16x32_bf16 v[28:31], v[60:63], v[196:199], v[28:31]
    ds_read_b64_tr_b16 v[94:95], v14 offset:26624
    v_mfma_f32_16x16x32_bf16 v[32:35], v[64:67], v[196:199], v[32:35]
    ds_read_b64_tr_b16 v[96:97], v15 offset:24576
    s_add_u32 s43, s43, 1
    v_mfma_f32_16x16x32_bf16 v[48:51], v[64:67], v[200:203], v[48:51]
    ds_read_b64_tr_b16 v[98:99], v15 offset:26624
    v_mfma_f32_16x16x32_bf16 v[52:55], v[68:71], v[200:203], v[52:55]
    ds_read_b64_tr_b16 v[100:101], v16 offset:24576
    v_mfma_f32_16x16x32_bf16 v[36:39], v[68:71], v[196:199], v[36:39]
    ds_read_b64_tr_b16 v[102:103], v16 offset:26624
    s_waitcnt lgkmcnt(8)
    v_mfma_f32_16x16x32_bf16 v[24:27], v[72:75], v[204:207], v[24:27]
    ds_read_b64_tr_b16 v[104:105], v13 offset:28672
    buffer_load_dwordx4 v[196:199], v126, s[8:11], s44 offen
    v_mfma_f32_16x16x32_bf16 v[40:43], v[72:75], v[208:211], v[40:43]
    ds_read_b64_tr_b16 v[106:107], v13 offset:30720
    buffer_load_dwordx4 v[200:203], v127, s[8:11], s44 offen
    v_mfma_f32_16x16x32_bf16 v[44:47], v[76:79], v[208:211], v[44:47]
    ds_read_b64_tr_b16 v[108:109], v14 offset:28672
    s_add_u32 s44, s44, 16384
    s_waitcnt vmcnt(10)
    v_mfma_f32_16x16x32_bf16 v[28:31], v[76:79], v[204:207], v[28:31]
    ds_read_b64_tr_b16 v[110:111], v14 offset:30720
    v_add_u32 v13, 32768, v13
    v_or3_b32 v17, v212, v216, v220
    v_mfma_f32_16x16x32_bf16 v[32:35], v[80:83], v[204:207], v[32:35]
    ds_read_b64_tr_b16 v[112:113], v15 offset:28672
    v_add_u32 v14, 32768, v14
    v_bitop3_b32 v17, v17, v224, 1 bitop3:0xa8
    v_mfma_f32_16x16x32_bf16 v[48:51], v[80:83], v[208:211], v[48:51]
    ds_read_b64_tr_b16 v[114:115], v15 offset:30720
    v_add_u32 v15, 32768, v15
    v_cmp_ne_u32 vcc, 0, v17
    v_mfma_f32_16x16x32_bf16 v[52:55], v[84:87], v[208:211], v[52:55]
    ds_read_b64_tr_b16 v[116:117], v16 offset:28672
    ds_read_b64_tr_b16 v[118:119], v16 offset:30720
    s_cmp_eq_u32 s43, 4
    v_mfma_f32_16x16x32_bf16 v[36:39], v[84:87], v[204:207], v[36:39]
    v_add_u32 v16, 32768, v16
    s_waitcnt lgkmcnt(8)
    s_cbranch_vccnz dm_19f2
dm_19g2:
    s_cbranch_scc1 dm_19x
    v_mfma_f32_16x16x32_bf16 v[24:27], v[88:91], v[212:215], v[24:27]
    ds_read_b64_tr_b16 v[56:57], v13 offset:0
    buffer_load_dwordx4 v[204:207], v126, s[8:11], s44 offen
    v_mfma_f32_16x16x32_bf16 v[40:43], v[88:91], v[216:219], v[40:43]
    ds_read_b64_tr_b16 v[58:59], v13 offset:2048
    buffer_load_dwordx4 v[208:211], v127, s[8:11], s44 offen
    v_mfma_f32_16x16x32_bf16 v[44:47], v[92:95], v[216:219], v[44:47]
    ds_read_b64_tr_b16 v[60:61], v14 offset:0
    s_add_u32 s44, s44, 16384
    v_mfma_f32_16x16x32_bf16 v[28:31], v[92:95], v[212:215], v[28:31]
    ds_read_b64_tr_b16 v[62:63], v14 offset:2048
    v_mov_b32 v134, v126
    v_mfma_f32_16x16x32_bf16 v[32:35], v[96:99], v[212:215], v[32:35]
    ds_read_b64_tr_b16 v[64:65], v15 offset:0
    v_mov_b32 v135, v127
    v_mfma_f32_16x16x32_bf16 v[48:51], v[96:99], v[216:219], v[48:51]
    ds_read_b64_tr_b16 v[66:67], v15 offset:2048
    v_mfma_f32_16x16x32_bf16 v[52:55], v[100:103], v[216:219], v[52:55]
    ds_read_b64_tr_b16 v[68:69], v16 offset:0
    v_mfma_f32_16x16x32_bf16 v[36:39], v[100:103], v[212:215], v[36:39]
    ds_read_b64_tr_b16 v[70:71], v16 offset:2048
    s_waitcnt lgkmcnt(8)
    v_mfma_f32_16x16x32_bf16 v[24:27], v[104:107], v[220:223], v[24:27]
    ds_read_b64_tr_b16 v[72:73], v13 offset:4096
    buffer_load_dwordx4 v[212:215], v126, s[8:11], s44 offen
    v_mfma_f32_16x16x32_bf16 v[40:43], v[104:107], v[224:227], v[40:43]
    ds_read_b64_tr_b16 v[74:75], v13 offset:6144
    buffer_load_dwordx4 v[216:219], v127, s[8:11], s44 offen
    v_mfma_f32_16x16x32_bf16 v[44:47], v[108:111], v[224:227], v[44:47]
    ds_read_b64_tr_b16 v[76:77], v14 offset:4096
    s_add_u32 s44, s44, 16384
    s_waitcnt vmcnt(10)
    v_mfma_f32_16x16x32_bf16 v[28:31], v[108:111], v[220:223], v[28:31]
    ds_read_b64_tr_b16 v[78:79], v14 offset:6144
    v_or3_b32 v17, v164, v168, v172
    v_mfma_f32_16x16x32_bf16 v[32:35], v[112:115], v[220:223], v[32:35]
    ds_read_b64_tr_b16 v[80:81], v15 offset:4096
    v_bitop3_b32 v17, v17, v176, 1 bitop3:0xa8
    v_mfma_f32_16x16x32_bf16 v[48:51], v[112:115], v[224:227], v[48:51]
    ds_read_b64_tr_b16 v[82:83], v15 offset:6144
    v_cmp_ne_u32 vcc, 0, v17
    v_mfma_f32_16x16x32_bf16 v[52:55], v[116:119], v[224:227], v[52:55]
    ds_read_b64_tr_b16 v[84:85], v16 offset:4096
    ds_read_b64_tr_b16 v[86:87], v16 offset:6144
    v_mfma_f32_16x16x32_bf16 v[36:39], v[116:119], v[220:223], v[36:39]
    s_waitcnt lgkmcnt(8)
    s_cbranch_vccnz dm_19f3
dm_19g3:
    s_branch dm_19
dm_19f0:
    s_cselect_b32 s50, 1, 0
dm_19h0:
    s_sleep 2
    s_sub_u32 s44, s44, 114688
    buffer_load_dwordx4 v[180:183], v134, s[8:11], s44 offen sc1
    buffer_load_dwordx4 v[184:187], v135, s[8:11], s44 offen sc1
    s_add_u32 s44, s44, 16384
    buffer_load_dwordx4 v[188:191], v134, s[8:11], s44 offen sc1
    buffer_load_dwordx4 v[192:195], v135, s[8:11], s44 offen sc1
    s_add_u32 s44, s44, 16384
    buffer_load_dwordx4 v[196:199], v134, s[8:11], s44 offen sc1
    buffer_load_dwordx4 v[200:203], v135, s[8:11], s44 offen sc1
    s_add_u32 s44, s44, 16384
    buffer_load_dwordx4 v[204:207], v134, s[8:11], s44 offen sc1
    buffer_load_dwordx4 v[208:211], v135, s[8:11], s44 offen sc1
    s_add_u32 s44, s44, 16384
    buffer_load_dwordx4 v[212:215], v134, s[8:11], s44 offen sc1
    buffer_load_dwordx4 v[216:219], v135, s[8:11], s44 offen sc1
    s_add_u32 s44, s44, 16384
    buffer_load_dwordx4 v[220:223], v134, s[8:11], s44 offen sc1
    buffer_load_dwordx4 v[224:227], v135, s[8:11], s44 offen sc1
    s_add_u32 s44, s44, 16384
    buffer_load_dwordx4 v[164:167], v126, s[8:11], s44 offen sc1
    buffer_load_dwordx4 v[168:171], v127, s[8:11], s44 offen sc1
    s_add_u32 s44, s44, 16384
    s_waitcnt vmcnt(10)
    v_or3_b32 v17, v180, v184, v188
    v_bitop3_b32 v17, v17, v192, 1 bitop3:0xa8
    v_cmp_ne_u32 vcc, 0, v17
    s_add_u32 s53, s53, 1
    s_cmp_ge_u32 s53, s61
    s_cselect_b32 s61, 0, s61
    s_cbranch_scc1 dm_19k0
    s_cbranch_vccnz dm_19h0
dm_19k0:
    s_cmp_eq_u32 s50, 1
    s_branch dm_19g0
dm_19f1:
    s_cselect_b32 s50, 1, 0
dm_19h1:
    s_sleep 2
    s_sub_u32 s44, s44, 114688
    buffer_load_dwordx4 v[196:199], v134, s[8:11], s44 offen sc1
    buffer_load_dwordx4 v[200:203], v135, s[8:11], s44 offen sc1
    s_add_u32 s44, s44, 16384
    buffer_load_dwordx4 v[204:207], v134, s[8:11], s44 offen sc1
    buffer_load_dwordx4 v[208:211], v135, s[8:11], s44 offen sc1
    s_add_u32 s44, s44, 16384
    buffer_load_dwordx4 v[212:215], v134, s[8:11], s44 offen sc1
    buffer_load_dwordx4 v[216:219], v135, s[8:11], s44 offen sc1
    s_add_u32 s44, s44, 16384
    buffer_load_dwordx4 v[220:223], v134, s[8:11], s44 offen sc1
    buffer_load_dwordx4 v[224:227], v135, s[8:11], s44 offen sc1
    s_add_u32 s44, s44, 16384
    buffer_load_dwordx4 v[164:167], v126, s[8:11], s44 offen sc1
    buffer_load_dwordx4 v[168:171], v127, s[8:11], s44 offen sc1
    s_add_u32 s44, s44, 16384
    buffer_load_dwordx4 v[172:175], v126, s[8:11], s44 offen sc1
    buffer_load_dwordx4 v[176:179], v127, s[8:11], s44 offen sc1
    s_add_u32 s44, s44, 16384
    buffer_load_dwordx4 v[180:183], v126, s[8:11], s44 offen sc1
    buffer_load_dwordx4 v[184:187], v127, s[8:11], s44 offen sc1
    s_add_u32 s44, s44, 16384
    s_waitcnt vmcnt(10)
    v_or3_b32 v17, v196, v200, v204
    v_bitop3_b32 v17, v17, v208, 1 bitop3:0xa8
    v_cmp_ne_u32 vcc, 0, v17
    s_add_u32 s53, s53, 1
    s_cmp_ge_u32 s53, s61
    s_cselect_b32 s61, 0, s61
    s_cbranch_scc1 dm_19k1
    s_cbranch_vccnz dm_19h1
dm_19k1:
    s_cmp_eq_u32 s50, 1
    s_branch dm_19g1
dm_19f2:
    s_cselect_b32 s50, 1, 0
dm_19h2:
    s_sleep 2
    s_sub_u32 s44, s44, 114688
    buffer_load_dwordx4 v[212:215], v134, s[8:11], s44 offen sc1
    buffer_load_dwordx4 v[216:219], v135, s[8:11], s44 offen sc1
    s_add_u32 s44, s44, 16384
    buffer_load_dwordx4 v[220:223], v134, s[8:11], s44 offen sc1
    buffer_load_dwordx4 v[224:227], v135, s[8:11], s44 offen sc1
    s_add_u32 s44, s44, 16384
    buffer_load_dwordx4 v[164:167], v126, s[8:11], s44 offen sc1
    buffer_load_dwordx4 v[168:171], v127, s[8:11], s44 offen sc1
    s_add_u32 s44, s44, 16384
    buffer_load_dwordx4 v[172:175], v126, s[8:11], s44 offen sc1
    buffer_load_dwordx4 v[176:179], v127, s[8:11], s44 offen sc1
    s_add_u32 s44, s44, 16384
    buffer_load_dwordx4 v[180:183], v126, s[8:11], s44 offen sc1
    buffer_load_dwordx4 v[184:187], v127, s[8:11], s44 offen sc1
    s_add_u32 s44, s44, 16384
    buffer_load_dwordx4 v[188:191], v126, s[8:11], s44 offen sc1
    buffer_load_dwordx4 v[192:195], v127, s[8:11], s44 offen sc1
    s_add_u32 s44, s44, 16384
    buffer_load_dwordx4 v[196:199], v126, s[8:11], s44 offen sc1
    buffer_load_dwordx4 v[200:203], v127, s[8:11], s44 offen sc1
    s_add_u32 s44, s44, 16384
    s_waitcnt vmcnt(10)
    v_or3_b32 v17, v212, v216, v220
    v_bitop3_b32 v17, v17, v224, 1 bitop3:0xa8
    v_cmp_ne_u32 vcc, 0, v17
    s_add_u32 s53, s53, 1
    s_cmp_ge_u32 s53, s61
    s_cselect_b32 s61, 0, s61
    s_cbranch_scc1 dm_19k2
    s_cbranch_vccnz dm_19h2
dm_19k2:
    s_cmp_eq_u32 s50, 1
    s_branch dm_19g2
dm_19f3:
    s_cselect_b32 s50, 1, 0
dm_19h3:
    s_sleep 2
    s_sub_u32 s44, s44, 114688
    buffer_load_dwordx4 v[164:167], v134, s[8:11], s44 offen sc1
    buffer_load_dwordx4 v[168:171], v135, s[8:11], s44 offen sc1
    s_add_u32 s44, s44, 16384
    buffer_load_dwordx4 v[172:175], v134, s[8:11], s44 offen sc1
    buffer_load_dwordx4 v[176:179], v135, s[8:11], s44 offen sc1
    s_add_u32 s44, s44, 16384
    buffer_load_dwordx4 v[180:183], v134, s[8:11], s44 offen sc1
    buffer_load_dwordx4 v[184:187], v135, s[8:11], s44 offen sc1
    s_add_u32 s44, s44, 16384
    buffer_load_dwordx4 v[188:191], v134, s[8:11], s44 offen sc1
    buffer_load_dwordx4 v[192:195], v135, s[8:11], s44 offen sc1
    s_add_u32 s44, s44, 16384
    buffer_load_dwordx4 v[196:199], v134, s[8:11], s44 offen sc1
    buffer_load_dwordx4 v[200:203], v135, s[8:11], s44 offen sc1
    s_add_u32 s44, s44, 16384
    buffer_load_dwordx4 v[204:207], v134, s[8:11], s44 offen sc1
    buffer_load_dwordx4 v[208:211], v135, s[8:11], s44 offen sc1
    s_add_u32 s44, s44, 16384
    buffer_load_dwordx4 v[212:215], v134, s[8:11], s44 offen sc1
    buffer_load_dwordx4 v[216:219], v135, s[8:11], s44 offen sc1
    s_add_u32 s44, s44, 16384
    s_waitcnt vmcnt(10)
    v_or3_b32 v17, v164, v168, v172
    v_bitop3_b32 v17, v17, v176, 1 bitop3:0xa8
    v_cmp_ne_u32 vcc, 0, v17
    s_add_u32 s53, s53, 1
    s_cmp_ge_u32 s53, s61
    s_cselect_b32 s61, 0, s61
    s_cbranch_scc1 dm_19k3
    s_cbranch_vccnz dm_19h3
dm_19k3:
    s_cmp_eq_u32 s50, 1
    s_branch dm_19g3
dm_19x:
    v_mfma_f32_16x16x32_bf16 v[24:27], v[88:91], v[212:215], v[24:27]
    v_mfma_f32_16x16x32_bf16 v[40:43], v[88:91], v[216:219], v[40:43]
    v_mfma_f32_16x16x32_bf16 v[44:47], v[92:95], v[216:219], v[44:47]
    v_mfma_f32_16x16x32_bf16 v[28:31], v[92:95], v[212:215], v[28:31]
    v_mfma_f32_16x16x32_bf16 v[32:35], v[96:99], v[212:215], v[32:35]
    v_mfma_f32_16x16x32_bf16 v[48:51], v[96:99], v[216:219], v[48:51]
    v_mfma_f32_16x16x32_bf16 v[52:55], v[100:103], v[216:219], v[52:55]
    v_mfma_f32_16x16x32_bf16 v[36:39], v[100:103], v[212:215], v[36:39]
    s_waitcnt lgkmcnt(0)
    v_mfma_f32_16x16x32_bf16 v[24:27], v[104:107], v[220:223], v[24:27]
    s_add_u32 s44, s62, 0x5c8000
    v_mfma_f32_16x16x32_bf16 v[40:43], v[104:107], v[224:227], v[40:43]
    s_addc_u32 s45, s63, 0
    v_mfma_f32_16x16x32_bf16 v[44:47], v[108:111], v[224:227], v[44:47]
    v_mfma_f32_16x16x32_bf16 v[28:31], v[108:111], v[220:223], v[28:31]
    s_mov_b32 s46, 0x6000
    v_mfma_f32_16x16x32_bf16 v[32:35], v[112:115], v[220:223], v[32:35]
    v_mfma_f32_16x16x32_bf16 v[48:51], v[112:115], v[224:227], v[48:51]
    s_mov_b32 s47, 0x20000
    v_mfma_f32_16x16x32_bf16 v[52:55], v[116:119], v[224:227], v[52:55]
    v_mfma_f32_16x16x32_bf16 v[36:39], v[116:119], v[220:223], v[36:39]
    s_add_u32 s36, s39, 0
    v_cvt_pk_bf16_f32 v148, v24, v25
    v_cvt_pk_bf16_f32 v149, v26, v27
    v_cvt_pk_bf16_f32 v150, v28, v29
    v_cvt_pk_bf16_f32 v151, v30, v31
    v_and_b32 v148, -2, v148
    buffer_store_dwordx4 v[148:151], v2, s[16:19], s36 offen offset:0 sc1
    v_cvt_pk_bf16_f32 v152, v32, v33
    v_cvt_pk_bf16_f32 v153, v34, v35
    v_cvt_pk_bf16_f32 v154, v36, v37
    v_cvt_pk_bf16_f32 v155, v38, v39
    v_and_b32 v152, -2, v152
    buffer_store_dwordx4 v[152:155], v2, s[16:19], s36 offen offset:1024 sc1
    s_add_u32 s36, s39, 65536
    v_cvt_pk_bf16_f32 v156, v40, v41
    v_cvt_pk_bf16_f32 v157, v42, v43
    v_cvt_pk_bf16_f32 v158, v44, v45
    v_cvt_pk_bf16_f32 v159, v46, v47
    v_and_b32 v156, -2, v156
    buffer_store_dwordx4 v[156:159], v2, s[16:19], s36 offen offset:0 sc1
    v_cvt_pk_bf16_f32 v160, v48, v49
    v_cvt_pk_bf16_f32 v161, v50, v51
    v_cvt_pk_bf16_f32 v162, v52, v53
    v_cvt_pk_bf16_f32 v163, v54, v55
    v_and_b32 v160, -2, v160
    buffer_store_dwordx4 v[160:163], v2, s[16:19], s36 offen offset:1024 sc1
    s_barrier
    s_lshl_b32 s36, s37, 11
    v_add_u32 v7, s36, v2
    ds_write_b128 v7, v[148:151] offset:0
    ds_write_b128 v7, v[152:155] offset:1024
    ds_write_b128 v7, v[156:159] offset:2048
    ds_write_b128 v7, v[160:163] offset:3072
    v_lshlrev_b32 v24, 16, v148
    v_and_b32 v25, 0xffff0000, v148
    v_lshlrev_b32 v26, 16, v149
    v_and_b32 v27, 0xffff0000, v149
    v_lshlrev_b32 v28, 16, v150
    v_and_b32 v29, 0xffff0000, v150
    v_lshlrev_b32 v30, 16, v151
    v_and_b32 v31, 0xffff0000, v151
    v_lshlrev_b32 v32, 16, v152
    v_and_b32 v33, 0xffff0000, v152
    v_lshlrev_b32 v34, 16, v153
    v_and_b32 v35, 0xffff0000, v153
    v_lshlrev_b32 v36, 16, v154
    v_and_b32 v37, 0xffff0000, v154
    v_lshlrev_b32 v38, 16, v155
    v_and_b32 v39, 0xffff0000, v155
    v_lshlrev_b32 v40, 16, v156
    v_and_b32 v41, 0xffff0000, v156
    v_lshlrev_b32 v42, 16, v157
    v_and_b32 v43, 0xffff0000, v157
    v_lshlrev_b32 v44, 16, v158
    v_and_b32 v45, 0xffff0000, v158
    v_lshlrev_b32 v46, 16, v159
    v_and_b32 v47, 0xffff0000, v159
    v_lshlrev_b32 v48, 16, v160
    v_and_b32 v49, 0xffff0000, v160
    v_lshlrev_b32 v50, 16, v161
    v_and_b32 v51, 0xffff0000, v161
    v_lshlrev_b32 v52, 16, v162
    v_and_b32 v53, 0xffff0000, v162
    v_lshlrev_b32 v54, 16, v163
    v_and_b32 v55, 0xffff0000, v163
    s_add_u32 s53, s55, 512
    v_mov_b32 v8, 1
    v_mov_b32 v9, 162816
    v_mov_b32 v11, 0
    s_mov_b64 exec, 1
    s_waitcnt vmcnt(0)
    ds_add_rtn_u32 v10, v9, v8
    s_waitcnt lgkmcnt(0)
    v_readfirstlane_b32 s54, v10
    s_nop 0
    s_and_b32 s54, s54, 3
    s_cmp_lg_u32 s54, 3
    s_cbranch_scc1 pub_20
    buffer_atomic_add v8, v11, s[56:59], s53 offen sc1
    v_mov_b32 v9, 162872
    ds_add_u32 v9, v8
pub_20:
    s_mov_b64 exec, -1
    s_waitcnt lgkmcnt(0)
    s_barrier
    v_pk_add_f32 v[142:143], v[24:25], v[26:27]
    v_pk_mul_f32 v[136:137], v[24:25], v[24:25]
    v_pk_fma_f32 v[136:137], v[26:27], v[26:27], v[136:137]
    v_pk_add_f32 v[142:143], v[142:143], v[28:29]
    v_pk_fma_f32 v[136:137], v[28:29], v[28:29], v[136:137]
    v_pk_add_f32 v[142:143], v[142:143], v[30:31]
    v_pk_fma_f32 v[136:137], v[30:31], v[30:31], v[136:137]
    v_pk_add_f32 v[142:143], v[142:143], v[32:33]
    v_pk_fma_f32 v[136:137], v[32:33], v[32:33], v[136:137]
    v_pk_add_f32 v[142:143], v[142:143], v[34:35]
    v_pk_fma_f32 v[136:137], v[34:35], v[34:35], v[136:137]
    v_pk_add_f32 v[142:143], v[142:143], v[36:37]
    v_pk_fma_f32 v[136:137], v[36:37], v[36:37], v[136:137]
    v_pk_add_f32 v[142:143], v[142:143], v[38:39]
    v_pk_fma_f32 v[136:137], v[38:39], v[38:39], v[136:137]
    v_add_f32 v138, v142, v143
    v_add_f32 v139, v136, v137
    v_mov_b32 v142, v138
    v_mov_b32 v143, v139
    s_nop 0
    v_permlane16_swap_b32 v138, v142
    v_permlane16_swap_b32 v139, v143
    v_pk_add_f32 v[138:139], v[138:139], v[142:143]
    v_mov_b32 v142, v138
    v_mov_b32 v143, v139
    s_nop 0
    v_permlane32_swap_b32 v138, v142
    v_permlane32_swap_b32 v139, v143
    v_pk_add_f32 v[138:139], v[138:139], v[142:143]
    v_pk_add_f32 v[142:143], v[40:41], v[42:43]
    v_pk_mul_f32 v[136:137], v[40:41], v[40:41]
    v_pk_fma_f32 v[136:137], v[42:43], v[42:43], v[136:137]
    v_pk_add_f32 v[142:143], v[142:143], v[44:45]
    v_pk_fma_f32 v[136:137], v[44:45], v[44:45], v[136:137]
    v_pk_add_f32 v[142:143], v[142:143], v[46:47]
    v_pk_fma_f32 v[136:137], v[46:47], v[46:47], v[136:137]
    v_pk_add_f32 v[142:143], v[142:143], v[48:49]
    v_pk_fma_f32 v[136:137], v[48:49], v[48:49], v[136:137]
    v_pk_add_f32 v[142:143], v[142:143], v[50:51]
    v_pk_fma_f32 v[136:137], v[50:51], v[50:51], v[136:137]
    v_pk_add_f32 v[142:143], v[142:143], v[52:53]
    v_pk_fma_f32 v[136:137], v[52:53], v[52:53], v[136:137]
    v_pk_add_f32 v[142:143], v[142:143], v[54:55]
    v_pk_fma_f32 v[136:137], v[54:55], v[54:55], v[136:137]
    v_add_f32 v140, v142, v143
    v_add_f32 v141, v136, v137
    v_mov_b32 v142, v140
    v_mov_b32 v143, v141
    s_nop 0
    v_permlane16_swap_b32 v140, v142
    v_permlane16_swap_b32 v141, v143
    v_pk_add_f32 v[140:141], v[140:141], v[142:143]
    v_mov_b32 v142, v140
    v_mov_b32 v143, v141
    s_nop 0
    v_permlane32_swap_b32 v140, v142
    v_permlane32_swap_b32 v141, v143
    v_pk_add_f32 v[140:141], v[140:141], v[142:143]
    v_cmp_eq_u32 vcc, 0, v23
    s_nop 1
    v_cndmask_b32 v138, v140, v138, vcc
    v_cndmask_b32 v139, v141, v139, vcc
    s_lshr_b32 s53, s29, 3
    s_lshl_b32 s53, s53, 14
    s_and_b32 s40, s29, 7
    s_lshl_b32 s40, s40, 10
    s_add_u32 s40, s40, s53
    s_lshl_b32 s36, s34, 8
    s_add_u32 s40, s40, s36
    v_lshlrev_b32 v7, 3, v1
    s_bfm_b64 exec, 32, 0
    buffer_store_dwordx2 v[138:139], v7, s[44:47], s40 offen sc1
    s_mov_b64 exec, -1
    s_lshr_b32 s34, s30, 1
    s_and_b32 s35, s30, 1
    v_and_b32 v22, 15, v1
    v_lshrrev_b32 v23, 4, v1
    s_mul_i32 s37, s34, 4
    s_mul_i32 s38, s29, 14
    s_mul_i32 s36, s35, 7
    s_add_u32 s38, s38, s36
    s_mul_i32 s36, s34, 8192
    v_add_u32 v12, s36, v2
    v_lshrrev_b32 v6, 2, v1
    v_mul_u32_u24 v13, 448, v6
    v_and_b32 v7, 3, v1
    v_lshl_add_u32 v13, v7, 3, v13
    v_add_u32 v13, 73728, v13
    s_mul_i32 s36, s35, 224
    v_add_u32 v13, s36, v13
    v_bfe_u32 v6, v1, 4, 1
    v_lshlrev_b32 v6, 5, v6
    s_cmp_eq_u32 s35, 0
    s_cselect_b32 s36, 1, -1
    v_mul_lo_u32 v6, v6, s36
    v_sub_u32 v14, v13, v6
    v_add_u32 v13, v13, v6
    v_mov_b32 v17, v12
    s_mov_b32 s42, 0
    s_mov_b32 s43, 0
    s_mov_b32 s48, 57344
    v_add_u32 v18, 57344, v13
    v_add_u32 v19, 57344, v14
    ds_read_b128 v[136:139], v17 offset:0
    ds_read_b128 v[140:143], v17 offset:2048
    ds_read_b128 v[144:147], v17 offset:4096
    ds_read_b128 v[148:151], v17 offset:6144
    ds_read_b64_tr_b16 v[152:153], v18 offset:0
    ds_read_b64_tr_b16 v[154:155], v18 offset:7168
    ds_read_b64_tr_b16 v[156:157], v19 offset:32
    ds_read_b64_tr_b16 v[158:159], v19 offset:7200
    ds_read_b64_tr_b16 v[160:161], v18 offset:64
    ds_read_b64_tr_b16 v[162:163], v18 offset:7232
    ds_read_b64_tr_b16 v[164:165], v19 offset:96
    ds_read_b64_tr_b16 v[166:167], v19 offset:7264
    ds_read_b64_tr_b16 v[168:169], v18 offset:128
    ds_read_b64_tr_b16 v[170:171], v18 offset:7296
    ds_read_b64_tr_b16 v[172:173], v19 offset:160
    ds_read_b64_tr_b16 v[174:175], v19 offset:7328
    ds_read_b64_tr_b16 v[176:177], v18 offset:192
    ds_read_b64_tr_b16 v[178:179], v18 offset:7360
    s_waitcnt lgkmcnt(12)
    v_mfma_f32_16x16x32_bf16 v[24:27], v[152:155], v[136:139], 0
    ds_read_b128 v[180:183], v17 offset:1024
    s_add_u32 s42, s42, 16384
    v_mfma_f32_16x16x32_bf16 v[52:55], v[152:155], v[140:143], 0
    ds_read_b128 v[184:187], v17 offset:3072
    s_cmp_eq_u32 s42, 49152
    v_mfma_f32_16x16x32_bf16 v[80:83], v[152:155], v[144:147], 0
    ds_read_b128 v[188:191], v17 offset:5120
    s_cselect_b32 s42, 0, s42
    v_mfma_f32_16x16x32_bf16 v[108:111], v[152:155], v[148:151], 0
    ds_read_b128 v[192:195], v17 offset:7168
    s_waitcnt lgkmcnt(14)
    v_mfma_f32_16x16x32_bf16 v[112:115], v[156:159], v[148:151], 0
    ds_read_b64_tr_b16 v[196:197], v18 offset:14336
    s_add_u32 s48, s48, 28672
    v_mfma_f32_16x16x32_bf16 v[84:87], v[156:159], v[144:147], 0
    ds_read_b64_tr_b16 v[198:199], v18 offset:21504
    s_cmp_eq_u32 s48, 86016
    v_mfma_f32_16x16x32_bf16 v[56:59], v[156:159], v[140:143], 0
    ds_read_b64_tr_b16 v[200:201], v19 offset:14368
    s_cselect_b32 s48, 0, s48
    v_mfma_f32_16x16x32_bf16 v[28:31], v[156:159], v[136:139], 0
    ds_read_b64_tr_b16 v[202:203], v19 offset:21536
    s_waitcnt lgkmcnt(8)
    v_mfma_f32_16x16x32_bf16 v[32:35], v[160:163], v[136:139], 0
    ds_read_b64_tr_b16 v[204:205], v18 offset:14400
    v_add_u32 v17, s42, v12
    v_mfma_f32_16x16x32_bf16 v[60:63], v[160:163], v[140:143], 0
    ds_read_b64_tr_b16 v[206:207], v18 offset:21568
    v_mfma_f32_16x16x32_bf16 v[88:91], v[160:163], v[144:147], 0
    ds_read_b64_tr_b16 v[208:209], v19 offset:14432
    v_mfma_f32_16x16x32_bf16 v[116:119], v[160:163], v[148:151], 0
    ds_read_b64_tr_b16 v[210:211], v19 offset:21600
    v_mfma_f32_16x16x32_bf16 v[120:123], v[164:167], v[148:151], 0
    ds_read_b64_tr_b16 v[212:213], v18 offset:14464
    v_mfma_f32_16x16x32_bf16 v[92:95], v[164:167], v[144:147], 0
    ds_read_b64_tr_b16 v[214:215], v18 offset:21632
    v_mfma_f32_16x16x32_bf16 v[64:67], v[164:167], v[140:143], 0
    ds_read_b64_tr_b16 v[216:217], v19 offset:14496
    v_mfma_f32_16x16x32_bf16 v[36:39], v[164:167], v[136:139], 0
    ds_read_b64_tr_b16 v[218:219], v19 offset:21664
    v_add_u32 v19, s48, v14
    v_mfma_f32_16x16x32_bf16 v[40:43], v[168:171], v[136:139], 0
    ds_read_b64_tr_b16 v[220:221], v18 offset:14528
    v_mfma_f32_16x16x32_bf16 v[68:71], v[168:171], v[140:143], 0
    ds_read_b64_tr_b16 v[222:223], v18 offset:21696
    v_add_u32 v18, s48, v13
    v_mfma_f32_16x16x32_bf16 v[96:99], v[168:171], v[144:147], 0
    v_mfma_f32_16x16x32_bf16 v[124:127], v[168:171], v[148:151], 0
    v_mfma_f32_16x16x32_bf16 v[128:131], v[172:175], v[148:151], 0
    v_mfma_f32_16x16x32_bf16 v[100:103], v[172:175], v[144:147], 0
    v_mfma_f32_16x16x32_bf16 v[72:75], v[172:175], v[140:143], 0
    v_mfma_f32_16x16x32_bf16 v[44:47], v[172:175], v[136:139], 0
    v_mfma_f32_16x16x32_bf16 v[48:51], v[176:179], v[136:139], 0
    v_mfma_f32_16x16x32_bf16 v[76:79], v[176:179], v[140:143], 0
    v_mfma_f32_16x16x32_bf16 v[104:107], v[176:179], v[144:147], 0
    v_mfma_f32_16x16x32_bf16 v[132:135], v[176:179], v[148:151], 0
    s_waitcnt lgkmcnt(12)
    v_mfma_f32_16x16x32_bf16 v[24:27], v[196:199], v[180:183], v[24:27]
    s_add_u32 s43, s43, 1
    s_mul_i32 s36, s35, 448
    s_add_u32 s36, s36, 159744
    v_lshlrev_b32 v6, 4, v23
    v_mfma_f32_16x16x32_bf16 v[52:55], v[196:199], v[184:187], v[52:55]
    v_add_u32 v6, s36, v6
    s_lshl_b32 s36, s37, 8
    s_add_u32 s36, s36, 160768
    v_lshlrev_b32 v7, 4, v22
    v_mfma_f32_16x16x32_bf16 v[80:83], v[196:199], v[188:191], v[80:83]
    v_add_u32 v7, s36, v7
    s_add_u32 s16, s62, 0x400000
    s_addc_u32 s17, s63, 0
    s_mov_b32 s18, 0x1be000
    v_mfma_f32_16x16x32_bf16 v[108:111], v[196:199], v[192:195], v[108:111]
    s_mov_b32 s19, 0x20000
    s_mul_i32 s39, s37, 229376
    s_lshr_b32 s36, s38, 1
    s_waitcnt lgkmcnt(0)
    v_mfma_f32_16x16x32_bf16 v[112:115], v[200:203], v[192:195], v[112:115]
    s_add_u32 s36, s36, 0
    s_lshr_b32 s53, s36, 3
    s_lshl_b32 s53, s53, 14
    s_and_b32 s44, s36, 7
    v_mfma_f32_16x16x32_bf16 v[84:87], v[200:203], v[188:191], v[84:87]
    s_lshl_b32 s44, s44, 10
    s_add_u32 s44, s44, s53
    s_add_u32 s44, s44, s39
    s_lshr_b32 s36, s38, 1
    v_mfma_f32_16x16x32_bf16 v[56:59], v[200:203], v[184:187], v[56:59]
    s_add_u32 s36, s36, 1
    s_lshr_b32 s53, s36, 3
    s_lshl_b32 s53, s53, 14
    s_and_b32 s45, s36, 7
    v_mfma_f32_16x16x32_bf16 v[28:31], v[200:203], v[180:183], v[28:31]
    s_lshl_b32 s45, s45, 10
    s_add_u32 s45, s45, s53
    s_add_u32 s45, s45, s39
    s_lshr_b32 s36, s38, 1
    v_mfma_f32_16x16x32_bf16 v[32:35], v[204:207], v[180:183], v[32:35]
    s_add_u32 s36, s36, 2
    s_lshr_b32 s53, s36, 3
    s_lshl_b32 s53, s53, 14
    s_and_b32 s46, s36, 7
    v_mfma_f32_16x16x32_bf16 v[60:63], v[204:207], v[184:187], v[60:63]
    s_lshl_b32 s46, s46, 10
    s_add_u32 s46, s46, s53
    s_add_u32 s46, s46, s39
    s_lshr_b32 s36, s38, 1
    v_mfma_f32_16x16x32_bf16 v[88:91], v[204:207], v[188:191], v[88:91]
    s_add_u32 s36, s36, 3
    s_lshr_b32 s53, s36, 3
    s_lshl_b32 s53, s53, 14
    s_and_b32 s47, s36, 7
    v_mfma_f32_16x16x32_bf16 v[116:119], v[204:207], v[192:195], v[116:119]
    s_lshl_b32 s47, s47, 10
    s_add_u32 s47, s47, s53
    s_add_u32 s47, s47, s39
    v_lshrrev_b32 v226, 2, v1
    v_mfma_f32_16x16x32_bf16 v[120:123], v[208:211], v[192:195], v[120:123]
    v_mul_u32_u24 v240, 256, v226
    v_and_b32 v227, 3, v1
    v_lshl_add_u32 v240, v227, 3, v240
    v_add_u32 v240, 49152, v240
    v_mfma_f32_16x16x32_bf16 v[92:95], v[208:211], v[188:191], v[92:95]
    v_and_b32 v226, 7, v226
    s_mul_i32 s36, s35, 4
    s_add_u32 s36, s36, 3
    v_xor_b32 v227, s36, v226
    v_mfma_f32_16x16x32_bf16 v[64:67], v[208:211], v[184:187], v[64:67]
    v_lshl_add_u32 v243, v227, 5, v240
    s_mul_i32 s36, s35, 4
    s_add_u32 s36, s36, 2
    v_xor_b32 v227, s36, v226
    v_mfma_f32_16x16x32_bf16 v[36:39], v[208:211], v[180:183], v[36:39]
    v_lshl_add_u32 v242, v227, 5, v240
    s_mul_i32 s36, s35, 4
    s_add_u32 s36, s36, 1
    v_xor_b32 v227, s36, v226
    v_mfma_f32_16x16x32_bf16 v[40:43], v[212:215], v[180:183], v[40:43]
    v_lshl_add_u32 v241, v227, 5, v240
    s_mul_i32 s36, s35, 4
    s_add_u32 s36, s36, 0
    v_xor_b32 v227, s36, v226
    v_mfma_f32_16x16x32_bf16 v[68:71], v[212:215], v[184:187], v[68:71]
    v_lshl_add_u32 v240, v227, 5, v240
    s_lshl_b32 s38, s33, 3
    s_lshl_b32 s36, s35, 2
    s_add_u32 s38, s38, s36
    v_mfma_f32_16x16x32_bf16 v[96:99], v[212:215], v[188:191], v[96:99]
    s_lshr_b32 s36, s38, 1
    s_lshr_b32 s53, s36, 3
    s_lshl_b32 s53, s53, 14
    s_and_b32 s39, s36, 7
    v_mfma_f32_16x16x32_bf16 v[124:127], v[212:215], v[192:195], v[124:127]
    s_lshl_b32 s39, s39, 10
    s_add_u32 s39, s39, s53
    s_lshl_b32 s36, s37, 16
    s_add_u32 s39, s39, s36
    v_mfma_f32_16x16x32_bf16 v[128:131], v[216:219], v[192:195], v[128:131]
    s_lshl_b32 s40, s31, 17
    s_add_u32 s40, s40, s39
    s_xor_b32 s41, s31, 1
    s_lshl_b32 s41, s41, 17
    v_mfma_f32_16x16x32_bf16 v[100:103], v[216:219], v[188:191], v[100:103]
    s_add_u32 s41, s41, s39
    s_mov_b32 s84, s62
    s_mov_b32 s85, s63
    s_mov_b32 s86, 0x7e000
    v_mfma_f32_16x16x32_bf16 v[72:75], v[216:219], v[184:187], v[72:75]
    s_mov_b32 s87, 0x20000
    s_add_u32 s88, s62, 0x80000
    s_addc_u32 s89, s63, 0
    s_mov_b32 s90, 0x7e000
    v_mfma_f32_16x16x32_bf16 v[44:47], v[216:219], v[180:183], v[44:47]
    s_mov_b32 s91, 0x20000
    s_lshl_b32 s36, s37, 1
    s_add_u32 s36, s36, s35
    s_lshl_b32 s36, s36, 10
    v_mfma_f32_16x16x32_bf16 v[48:51], v[220:223], v[180:183], v[48:51]
    v_add_u32 v244, s36, v2
    v_mov_b32 v245, 1
    v_mov_b32 v246, 162880
    v_lshrrev_b32 v238, 1, v23
    v_mfma_f32_16x16x32_bf16 v[76:79], v[220:223], v[184:187], v[76:79]
    v_lshlrev_b32 v238, 8, v238
    v_lshl_add_u32 v238, v22, 4, v238
    v_and_b32 v224, 1, v23
    v_lshl_add_u32 v238, v224, 3, v238
    v_mfma_f32_16x16x32_bf16 v[104:107], v[220:223], v[188:191], v[104:107]
    v_mfma_f32_16x16x32_bf16 v[132:135], v[220:223], v[192:195], v[132:135]
    s_add_u32 s53, s55, 1408
    v_mov_b32 v8, 1
    v_mov_b32 v9, 162864
    v_mov_b32 v11, 0
    s_mov_b64 exec, 1
    s_waitcnt vmcnt(0)
    ds_add_rtn_u32 v10, v9, v8
    s_waitcnt lgkmcnt(0)
    v_readfirstlane_b32 s54, v10
    s_nop 0
    s_and_b32 s54, s54, 3
    s_cmp_lg_u32 s54, 3
    s_cbranch_scc1 pub_21
    buffer_atomic_add v8, v11, s[56:59], s53 offen sc1
pub_21:
    s_mov_b64 exec, -1
    s_barrier
    ds_read_b128 v[136:139], v17 offset:0
    ds_read_b128 v[140:143], v17 offset:2048
    ds_read_b128 v[144:147], v17 offset:4096
    ds_read_b128 v[148:151], v17 offset:6144
    ds_read_b64_tr_b16 v[152:153], v18 offset:0
    ds_read_b64_tr_b16 v[154:155], v18 offset:7168
    ds_read_b64_tr_b16 v[156:157], v19 offset:32
    ds_read_b64_tr_b16 v[158:159], v19 offset:7200
    ds_read_b64_tr_b16 v[160:161], v18 offset:64
    ds_read_b64_tr_b16 v[162:163], v18 offset:7232
    ds_read_b64_tr_b16 v[164:165], v19 offset:96
    ds_read_b64_tr_b16 v[166:167], v19 offset:7264
    ds_read_b64_tr_b16 v[168:169], v18 offset:128
    ds_read_b64_tr_b16 v[170:171], v18 offset:7296
    ds_read_b64_tr_b16 v[172:173], v19 offset:160
    ds_read_b64_tr_b16 v[174:175], v19 offset:7328
    ds_read_b64_tr_b16 v[176:177], v18 offset:192
    ds_read_b64_tr_b16 v[178:179], v18 offset:7360
    s_waitcnt lgkmcnt(12)
mm_22:
    v_mfma_f32_16x16x32_bf16 v[24:27], v[152:155], v[136:139], v[24:27]
    ds_read_b128 v[180:183], v17 offset:1024
    s_add_u32 s42, s42, 16384
    v_mfma_f32_16x16x32_bf16 v[52:55], v[152:155], v[140:143], v[52:55]
    ds_read_b128 v[184:187], v17 offset:3072
    s_cmp_eq_u32 s42, 49152
    v_mfma_f32_16x16x32_bf16 v[80:83], v[152:155], v[144:147], v[80:83]
    ds_read_b128 v[188:191], v17 offset:5120
    s_cselect_b32 s42, 0, s42
    v_mfma_f32_16x16x32_bf16 v[108:111], v[152:155], v[148:151], v[108:111]
    ds_read_b128 v[192:195], v17 offset:7168
    s_waitcnt lgkmcnt(14)
    v_mfma_f32_16x16x32_bf16 v[112:115], v[156:159], v[148:151], v[112:115]
    ds_read_b64_tr_b16 v[196:197], v18 offset:14336
    s_add_u32 s48, s48, 28672
    v_mfma_f32_16x16x32_bf16 v[84:87], v[156:159], v[144:147], v[84:87]
    ds_read_b64_tr_b16 v[198:199], v18 offset:21504
    s_cmp_eq_u32 s48, 86016
    v_mfma_f32_16x16x32_bf16 v[56:59], v[156:159], v[140:143], v[56:59]
    ds_read_b64_tr_b16 v[200:201], v19 offset:14368
    s_cselect_b32 s48, 0, s48
    v_mfma_f32_16x16x32_bf16 v[28:31], v[156:159], v[136:139], v[28:31]
    ds_read_b64_tr_b16 v[202:203], v19 offset:21536
    s_waitcnt lgkmcnt(8)
    v_mfma_f32_16x16x32_bf16 v[32:35], v[160:163], v[136:139], v[32:35]
    ds_read_b64_tr_b16 v[204:205], v18 offset:14400
    v_add_u32 v17, s42, v12
    v_mfma_f32_16x16x32_bf16 v[60:63], v[160:163], v[140:143], v[60:63]
    ds_read_b64_tr_b16 v[206:207], v18 offset:21568
    v_mfma_f32_16x16x32_bf16 v[88:91], v[160:163], v[144:147], v[88:91]
    ds_read_b64_tr_b16 v[208:209], v19 offset:14432
    v_mfma_f32_16x16x32_bf16 v[116:119], v[160:163], v[148:151], v[116:119]
    ds_read_b64_tr_b16 v[210:211], v19 offset:21600
    v_mfma_f32_16x16x32_bf16 v[120:123], v[164:167], v[148:151], v[120:123]
    ds_read_b64_tr_b16 v[212:213], v18 offset:14464
    v_mfma_f32_16x16x32_bf16 v[92:95], v[164:167], v[144:147], v[92:95]
    ds_read_b64_tr_b16 v[214:215], v18 offset:21632
    v_mfma_f32_16x16x32_bf16 v[64:67], v[164:167], v[140:143], v[64:67]
    ds_read_b64_tr_b16 v[216:217], v19 offset:14496
    v_mfma_f32_16x16x32_bf16 v[36:39], v[164:167], v[136:139], v[36:39]
    ds_read_b64_tr_b16 v[218:219], v19 offset:21664
    v_add_u32 v19, s48, v14
    v_mfma_f32_16x16x32_bf16 v[40:43], v[168:171], v[136:139], v[40:43]
    ds_read_b64_tr_b16 v[220:221], v18 offset:14528
    v_mfma_f32_16x16x32_bf16 v[68:71], v[168:171], v[140:143], v[68:71]
    ds_read_b64_tr_b16 v[222:223], v18 offset:21696
    v_add_u32 v18, s48, v13
    v_mfma_f32_16x16x32_bf16 v[96:99], v[168:171], v[144:147], v[96:99]
    v_mfma_f32_16x16x32_bf16 v[124:127], v[168:171], v[148:151], v[124:127]
    v_mfma_f32_16x16x32_bf16 v[128:131], v[172:175], v[148:151], v[128:131]
    v_mfma_f32_16x16x32_bf16 v[100:103], v[172:175], v[144:147], v[100:103]
    v_mfma_f32_16x16x32_bf16 v[72:75], v[172:175], v[140:143], v[72:75]
    v_mfma_f32_16x16x32_bf16 v[44:47], v[172:175], v[136:139], v[44:47]
    v_mfma_f32_16x16x32_bf16 v[48:51], v[176:179], v[136:139], v[48:51]
    v_mfma_f32_16x16x32_bf16 v[76:79], v[176:179], v[140:143], v[76:79]
    v_mfma_f32_16x16x32_bf16 v[104:107], v[176:179], v[144:147], v[104:107]
    v_mfma_f32_16x16x32_bf16 v[132:135], v[176:179], v[148:151], v[132:135]
    s_waitcnt lgkmcnt(12)
    v_mfma_f32_16x16x32_bf16 v[24:27], v[196:199], v[180:183], v[24:27]
    s_add_u32 s43, s43, 1
    s_cmp_lt_u32 s43, 15
    v_mfma_f32_16x16x32_bf16 v[52:55], v[196:199], v[184:187], v[52:55]
    v_mfma_f32_16x16x32_bf16 v[80:83], v[196:199], v[188:191], v[80:83]
    v_mfma_f32_16x16x32_bf16 v[108:111], v[196:199], v[192:195], v[108:111]
    s_waitcnt lgkmcnt(0)
    s_barrier
    v_mfma_f32_16x16x32_bf16 v[112:115], v[200:203], v[192:195], v[112:115]
    ds_read_b128 v[136:139], v17 offset:0
    v_mfma_f32_16x16x32_bf16 v[84:87], v[200:203], v[188:191], v[84:87]
    ds_read_b128 v[140:143], v17 offset:2048
    v_mfma_f32_16x16x32_bf16 v[56:59], v[200:203], v[184:187], v[56:59]
    ds_read_b128 v[144:147], v17 offset:4096
    v_mfma_f32_16x16x32_bf16 v[28:31], v[200:203], v[180:183], v[28:31]
    ds_read_b128 v[148:151], v17 offset:6144
    v_mfma_f32_16x16x32_bf16 v[32:35], v[204:207], v[180:183], v[32:35]
    ds_read_b64_tr_b16 v[152:153], v18 offset:0
    v_mfma_f32_16x16x32_bf16 v[60:63], v[204:207], v[184:187], v[60:63]
    ds_read_b64_tr_b16 v[154:155], v18 offset:7168
    v_mfma_f32_16x16x32_bf16 v[88:91], v[204:207], v[188:191], v[88:91]
    ds_read_b64_tr_b16 v[156:157], v19 offset:32
    v_mfma_f32_16x16x32_bf16 v[116:119], v[204:207], v[192:195], v[116:119]
    ds_read_b64_tr_b16 v[158:159], v19 offset:7200
    v_mfma_f32_16x16x32_bf16 v[120:123], v[208:211], v[192:195], v[120:123]
    ds_read_b64_tr_b16 v[160:161], v18 offset:64
    v_mfma_f32_16x16x32_bf16 v[92:95], v[208:211], v[188:191], v[92:95]
    ds_read_b64_tr_b16 v[162:163], v18 offset:7232
    v_mfma_f32_16x16x32_bf16 v[64:67], v[208:211], v[184:187], v[64:67]
    ds_read_b64_tr_b16 v[164:165], v19 offset:96
    v_mfma_f32_16x16x32_bf16 v[36:39], v[208:211], v[180:183], v[36:39]
    ds_read_b64_tr_b16 v[166:167], v19 offset:7264
    v_mfma_f32_16x16x32_bf16 v[40:43], v[212:215], v[180:183], v[40:43]
    ds_read_b64_tr_b16 v[168:169], v18 offset:128
    v_mfma_f32_16x16x32_bf16 v[68:71], v[212:215], v[184:187], v[68:71]
    ds_read_b64_tr_b16 v[170:171], v18 offset:7296
    v_mfma_f32_16x16x32_bf16 v[96:99], v[212:215], v[188:191], v[96:99]
    ds_read_b64_tr_b16 v[172:173], v19 offset:160
    v_mfma_f32_16x16x32_bf16 v[124:127], v[212:215], v[192:195], v[124:127]
    ds_read_b64_tr_b16 v[174:175], v19 offset:7328
    v_mfma_f32_16x16x32_bf16 v[128:131], v[216:219], v[192:195], v[128:131]
    ds_read_b64_tr_b16 v[176:177], v18 offset:192
    v_mfma_f32_16x16x32_bf16 v[100:103], v[216:219], v[188:191], v[100:103]
    ds_read_b64_tr_b16 v[178:179], v18 offset:7360
    v_mfma_f32_16x16x32_bf16 v[72:75], v[216:219], v[184:187], v[72:75]
    v_mfma_f32_16x16x32_bf16 v[44:47], v[216:219], v[180:183], v[44:47]
    v_mfma_f32_16x16x32_bf16 v[48:51], v[220:223], v[180:183], v[48:51]
    v_mfma_f32_16x16x32_bf16 v[76:79], v[220:223], v[184:187], v[76:79]
    v_mfma_f32_16x16x32_bf16 v[104:107], v[220:223], v[188:191], v[104:107]
    v_mfma_f32_16x16x32_bf16 v[132:135], v[220:223], v[192:195], v[132:135]
    s_waitcnt lgkmcnt(12)
    s_cbranch_scc1 mm_22
    v_mfma_f32_16x16x32_bf16 v[24:27], v[152:155], v[136:139], v[24:27]
    ds_read_b128 v[180:183], v17 offset:1024
    v_mfma_f32_16x16x32_bf16 v[52:55], v[152:155], v[140:143], v[52:55]
    ds_read_b128 v[184:187], v17 offset:3072
    v_mfma_f32_16x16x32_bf16 v[80:83], v[152:155], v[144:147], v[80:83]
    ds_read_b128 v[188:191], v17 offset:5120
    v_mfma_f32_16x16x32_bf16 v[108:111], v[152:155], v[148:151], v[108:111]
    ds_read_b128 v[192:195], v17 offset:7168
    s_waitcnt lgkmcnt(14)
    v_mfma_f32_16x16x32_bf16 v[112:115], v[156:159], v[148:151], v[112:115]
    ds_read_b64_tr_b16 v[196:197], v18 offset:14336
    v_mfma_f32_16x16x32_bf16 v[84:87], v[156:159], v[144:147], v[84:87]
    ds_read_b64_tr_b16 v[198:199], v18 offset:21504
    v_mfma_f32_16x16x32_bf16 v[56:59], v[156:159], v[140:143], v[56:59]
    ds_read_b64_tr_b16 v[200:201], v19 offset:14368
    v_mfma_f32_16x16x32_bf16 v[28:31], v[156:159], v[136:139], v[28:31]
    ds_read_b64_tr_b16 v[202:203], v19 offset:21536
    s_waitcnt lgkmcnt(8)
    v_mfma_f32_16x16x32_bf16 v[32:35], v[160:163], v[136:139], v[32:35]
    ds_read_b64_tr_b16 v[204:205], v18 offset:14400
    v_mfma_f32_16x16x32_bf16 v[60:63], v[160:163], v[140:143], v[60:63]
    ds_read_b64_tr_b16 v[206:207], v18 offset:21568
    v_mfma_f32_16x16x32_bf16 v[88:91], v[160:163], v[144:147], v[88:91]
    ds_read_b64_tr_b16 v[208:209], v19 offset:14432
    v_mfma_f32_16x16x32_bf16 v[116:119], v[160:163], v[148:151], v[116:119]
    ds_read_b64_tr_b16 v[210:211], v19 offset:21600
    v_mfma_f32_16x16x32_bf16 v[120:123], v[164:167], v[148:151], v[120:123]
    ds_read_b64_tr_b16 v[212:213], v18 offset:14464
    v_mfma_f32_16x16x32_bf16 v[92:95], v[164:167], v[144:147], v[92:95]
    ds_read_b64_tr_b16 v[214:215], v18 offset:21632
    v_mfma_f32_16x16x32_bf16 v[64:67], v[164:167], v[140:143], v[64:67]
    ds_read_b64_tr_b16 v[216:217], v19 offset:14496
    v_mfma_f32_16x16x32_bf16 v[36:39], v[164:167], v[136:139], v[36:39]
    ds_read_b64_tr_b16 v[218:219], v19 offset:21664
    v_mfma_f32_16x16x32_bf16 v[40:43], v[168:171], v[136:139], v[40:43]
    ds_read_b64_tr_b16 v[220:221], v18 offset:14528
    v_mfma_f32_16x16x32_bf16 v[68:71], v[168:171], v[140:143], v[68:71]
    ds_read_b64_tr_b16 v[222:223], v18 offset:21696
    v_mfma_f32_16x16x32_bf16 v[96:99], v[168:171], v[144:147], v[96:99]
    v_mfma_f32_16x16x32_bf16 v[124:127], v[168:171], v[148:151], v[124:127]
    v_mfma_f32_16x16x32_bf16 v[128:131], v[172:175], v[148:151], v[128:131]
    v_mfma_f32_16x16x32_bf16 v[100:103], v[172:175], v[144:147], v[100:103]
    v_mfma_f32_16x16x32_bf16 v[72:75], v[172:175], v[140:143], v[72:75]
    v_mfma_f32_16x16x32_bf16 v[44:47], v[172:175], v[136:139], v[44:47]
    v_mfma_f32_16x16x32_bf16 v[48:51], v[176:179], v[136:139], v[48:51]
    v_mfma_f32_16x16x32_bf16 v[76:79], v[176:179], v[140:143], v[76:79]
    v_mfma_f32_16x16x32_bf16 v[104:107], v[176:179], v[144:147], v[104:107]
    v_mfma_f32_16x16x32_bf16 v[132:135], v[176:179], v[148:151], v[132:135]
    s_waitcnt lgkmcnt(0)
    s_barrier
    v_mfma_f32_16x16x32_bf16 v[24:27], v[196:199], v[180:183], v[24:27]
    ds_read_b128 v[136:139], v6 offset:0
    v_mfma_f32_16x16x32_bf16 v[52:55], v[196:199], v[184:187], v[52:55]
    ds_read_b128 v[140:143], v6 offset:64
    v_mfma_f32_16x16x32_bf16 v[80:83], v[196:199], v[188:191], v[80:83]
    ds_read_b128 v[144:147], v6 offset:128
    v_mfma_f32_16x16x32_bf16 v[108:111], v[196:199], v[192:195], v[108:111]
    ds_read_b128 v[148:151], v6 offset:192
    v_mfma_f32_16x16x32_bf16 v[112:115], v[200:203], v[192:195], v[112:115]
    ds_read_b128 v[152:155], v6 offset:256
    v_mfma_f32_16x16x32_bf16 v[84:87], v[200:203], v[188:191], v[84:87]
    ds_read_b128 v[156:159], v6 offset:320
    v_mfma_f32_16x16x32_bf16 v[56:59], v[200:203], v[184:187], v[56:59]
    ds_read_b128 v[160:163], v6 offset:384
    v_mfma_f32_16x16x32_bf16 v[28:31], v[200:203], v[180:183], v[28:31]
    ds_read_b128 v[164:167], v7 offset:0
    v_mfma_f32_16x16x32_bf16 v[32:35], v[204:207], v[180:183], v[32:35]
    ds_read_b128 v[168:171], v7 offset:256
    v_mfma_f32_16x16x32_bf16 v[60:63], v[204:207], v[184:187], v[60:63]
    ds_read_b128 v[172:175], v7 offset:512
    v_mfma_f32_16x16x32_bf16 v[88:91], v[204:207], v[188:191], v[88:91]
    ds_read_b128 v[176:179], v7 offset:768
    v_mov_b32 v13, v240
    v_mfma_f32_16x16x32_bf16 v[116:119], v[204:207], v[192:195], v[116:119]
    v_add_u32 v18, 0, v240
    v_mov_b32 v14, v241
    v_mfma_f32_16x16x32_bf16 v[120:123], v[208:211], v[192:195], v[120:123]
    v_add_u32 v19, 0, v241
    v_mov_b32 v15, v242
    v_mfma_f32_16x16x32_bf16 v[92:95], v[208:211], v[188:191], v[92:95]
    v_add_u32 v20, 0, v242
    v_mov_b32 v16, v243
    v_mfma_f32_16x16x32_bf16 v[64:67], v[208:211], v[184:187], v[64:67]
    v_add_u32 v21, 0, v243
    s_mov_b32 s42, 0
    s_mov_b32 s43, 0
    v_mfma_f32_16x16x32_bf16 v[36:39], v[208:211], v[180:183], v[36:39]
    s_mov_b32 s48, 0
    v_mov_b32 v17, v12
    v_and_b32 v199, 7, v0
    v_mfma_f32_16x16x32_bf16 v[40:43], v[212:215], v[180:183], v[40:43]
    v_lshrrev_b32 v228, 6, v0
    v_lshlrev_b32 v228, 4, v228
    v_mfma_f32_16x16x32_bf16 v[68:71], v[212:215], v[184:187], v[68:71]
    v_bfe_u32 v229, v0, 3, 3
    v_add_u32 v228, v228, v229
    s_lshr_b32 s78, s29, 1
    v_mfma_f32_16x16x32_bf16 v[96:99], v[212:215], v[188:191], v[96:99]
    s_lshl_b32 s78, s78, 16
    s_and_b32 s79, s29, 1
    s_lshl_b32 s79, s79, 7
    v_mfma_f32_16x16x32_bf16 v[124:127], v[212:215], v[192:195], v[124:127]
    s_add_u32 s78, s78, s79
    s_lshr_b32 s79, s30, 1
    s_lshl_b32 s79, s79, 13
    v_mfma_f32_16x16x32_bf16 v[128:131], v[216:219], v[192:195], v[128:131]
    s_add_u32 s78, s78, s79
    v_lshlrev_b32 v196, 8, v228
    v_lshl_add_u32 v196, v199, 4, v196
    v_mfma_f32_16x16x32_bf16 v[100:103], v[216:219], v[188:191], v[100:103]
    v_add_u32 v196, s78, v196
    v_mfma_f32_16x16x32_bf16 v[72:75], v[216:219], v[184:187], v[72:75]
    v_mfma_f32_16x16x32_bf16 v[44:47], v[216:219], v[180:183], v[44:47]
    v_mfma_f32_16x16x32_bf16 v[48:51], v[220:223], v[180:183], v[48:51]
    v_mfma_f32_16x16x32_bf16 v[76:79], v[220:223], v[184:187], v[76:79]
    v_mfma_f32_16x16x32_bf16 v[104:107], v[220:223], v[188:191], v[104:107]
    v_mfma_f32_16x16x32_bf16 v[132:135], v[220:223], v[192:195], v[132:135]
    s_waitcnt lgkmcnt(0)
    s_cmp_eq_u32 s35, 1
    s_cbranch_scc1 G3_e1
    v_pk_fma_f32 v[24:25], v[164:165], v[136:137], v[24:25] op_sel_hi:[0,1,1] neg_lo:[1,0,0] neg_hi:[1,0,0]
    v_pk_fma_f32 v[26:27], v[164:165], v[138:139], v[26:27] op_sel_hi:[0,1,1] neg_lo:[1,0,0] neg_hi:[1,0,0]
    v_pk_mul_f32 v[226:227], v[24:25], v[24:25]
    v_pk_mul_f32 v[228:229], v[26:27], v[26:27]
    v_pk_fma_f32 v[226:227], v[226:227], v[166:167], v[166:167] op_sel:[0,1,0] op_sel_hi:[1,1,0]
    v_pk_fma_f32 v[228:229], v[228:229], v[166:167], v[166:167] op_sel:[0,1,0] op_sel_hi:[1,1,0]
    v_pk_mul_f32 v[226:227], v[226:227], v[24:25]
    v_pk_mul_f32 v[228:229], v[228:229], v[26:27]
    v_exp_f32 v226, v226
    v_exp_f32 v227, v227
    v_exp_f32 v228, v228
    v_exp_f32 v229, v229
    v_pk_fma_f32 v[226:227], v[226:227], v[164:165], v[164:165] op_sel:[0,1,1] op_sel_hi:[1,1,1]
    v_pk_fma_f32 v[228:229], v[228:229], v[164:165], v[164:165] op_sel:[0,1,1] op_sel_hi:[1,1,1]
    v_rcp_f32 v226, v226
    v_rcp_f32 v227, v227
    v_rcp_f32 v228, v228
    v_rcp_f32 v229, v229
    v_pk_mul_f32 v[24:25], v[24:25], v[226:227]
    v_pk_mul_f32 v[26:27], v[26:27], v[228:229]
    v_pk_fma_f32 v[28:29], v[164:165], v[140:141], v[28:29] op_sel_hi:[0,1,1] neg_lo:[1,0,0] neg_hi:[1,0,0]
    v_pk_fma_f32 v[30:31], v[164:165], v[142:143], v[30:31] op_sel_hi:[0,1,1] neg_lo:[1,0,0] neg_hi:[1,0,0]
    v_pk_mul_f32 v[226:227], v[28:29], v[28:29]
    v_pk_mul_f32 v[228:229], v[30:31], v[30:31]
    v_pk_fma_f32 v[226:227], v[226:227], v[166:167], v[166:167] op_sel:[0,1,0] op_sel_hi:[1,1,0]
    v_pk_fma_f32 v[228:229], v[228:229], v[166:167], v[166:167] op_sel:[0,1,0] op_sel_hi:[1,1,0]
    v_pk_mul_f32 v[226:227], v[226:227], v[28:29]
    v_pk_mul_f32 v[228:229], v[228:229], v[30:31]
    v_exp_f32 v226, v226
    v_exp_f32 v227, v227
    v_exp_f32 v228, v228
    v_exp_f32 v229, v229
    v_pk_fma_f32 v[226:227], v[226:227], v[164:165], v[164:165] op_sel:[0,1,1] op_sel_hi:[1,1,1]
    v_pk_fma_f32 v[228:229], v[228:229], v[164:165], v[164:165] op_sel:[0,1,1] op_sel_hi:[1,1,1]
    v_rcp_f32 v226, v226
    v_rcp_f32 v227, v227
    v_rcp_f32 v228, v228
    v_rcp_f32 v229, v229
    v_pk_mul_f32 v[28:29], v[28:29], v[226:227]
    v_pk_mul_f32 v[30:31], v[30:31], v[228:229]
    v_cvt_pk_bf16_f32 v24, v24, v25
    v_cvt_pk_bf16_f32 v25, v26, v27
    v_cvt_pk_bf16_f32 v26, v28, v29
    v_cvt_pk_bf16_f32 v27, v30, v31
    v_or_b32 v24, 1, v24
    ds_write_b128 v244, v[24:27] offset:0
    s_add_u32 s36, s44, 0
    buffer_store_dwordx4 v[24:27], v2, s[16:19], s36 offen sc1
    v_pk_fma_f32 v[52:53], v[168:169], v[136:137], v[52:53] op_sel_hi:[0,1,1] neg_lo:[1,0,0] neg_hi:[1,0,0]
    v_pk_fma_f32 v[54:55], v[168:169], v[138:139], v[54:55] op_sel_hi:[0,1,1] neg_lo:[1,0,0] neg_hi:[1,0,0]
    v_pk_mul_f32 v[226:227], v[52:53], v[52:53]
    v_pk_mul_f32 v[228:229], v[54:55], v[54:55]
    v_pk_fma_f32 v[226:227], v[226:227], v[170:171], v[170:171] op_sel:[0,1,0] op_sel_hi:[1,1,0]
    v_pk_fma_f32 v[228:229], v[228:229], v[170:171], v[170:171] op_sel:[0,1,0] op_sel_hi:[1,1,0]
    v_pk_mul_f32 v[226:227], v[226:227], v[52:53]
    v_pk_mul_f32 v[228:229], v[228:229], v[54:55]
    v_exp_f32 v226, v226
    v_exp_f32 v227, v227
    v_exp_f32 v228, v228
    v_exp_f32 v229, v229
    v_pk_fma_f32 v[226:227], v[226:227], v[168:169], v[168:169] op_sel:[0,1,1] op_sel_hi:[1,1,1]
    v_pk_fma_f32 v[228:229], v[228:229], v[168:169], v[168:169] op_sel:[0,1,1] op_sel_hi:[1,1,1]
    v_rcp_f32 v226, v226
    v_rcp_f32 v227, v227
    v_rcp_f32 v228, v228
    v_rcp_f32 v229, v229
    v_pk_mul_f32 v[52:53], v[52:53], v[226:227]
    v_pk_mul_f32 v[54:55], v[54:55], v[228:229]
    v_pk_fma_f32 v[56:57], v[168:169], v[140:141], v[56:57] op_sel_hi:[0,1,1] neg_lo:[1,0,0] neg_hi:[1,0,0]
    v_pk_fma_f32 v[58:59], v[168:169], v[142:143], v[58:59] op_sel_hi:[0,1,1] neg_lo:[1,0,0] neg_hi:[1,0,0]
    v_pk_mul_f32 v[226:227], v[56:57], v[56:57]
    v_pk_mul_f32 v[228:229], v[58:59], v[58:59]
    v_pk_fma_f32 v[226:227], v[226:227], v[170:171], v[170:171] op_sel:[0,1,0] op_sel_hi:[1,1,0]
    v_pk_fma_f32 v[228:229], v[228:229], v[170:171], v[170:171] op_sel:[0,1,0] op_sel_hi:[1,1,0]
    v_pk_mul_f32 v[226:227], v[226:227], v[56:57]
    v_pk_mul_f32 v[228:229], v[228:229], v[58:59]
    v_exp_f32 v226, v226
    v_exp_f32 v227, v227
    v_exp_f32 v228, v228
    v_exp_f32 v229, v229
    v_pk_fma_f32 v[226:227], v[226:227], v[168:169], v[168:169] op_sel:[0,1,1] op_sel_hi:[1,1,1]
    v_pk_fma_f32 v[228:229], v[228:229], v[168:169], v[168:169] op_sel:[0,1,1] op_sel_hi:[1,1,1]
    v_rcp_f32 v226, v226
    v_rcp_f32 v227, v227
    v_rcp_f32 v228, v228
    v_rcp_f32 v229, v229
    v_pk_mul_f32 v[56:57], v[56:57], v[226:227]
    v_pk_mul_f32 v[58:59], v[58:59], v[228:229]
    v_cvt_pk_bf16_f32 v52, v52, v53
    v_cvt_pk_bf16_f32 v53, v54, v55
    v_cvt_pk_bf16_f32 v54, v56, v57
    v_cvt_pk_bf16_f32 v55, v58, v59
    v_or_b32 v52, 1, v52
    ds_write_b128 v244, v[52:55] offset:2048
    s_add_u32 s36, s44, 229376
    buffer_store_dwordx4 v[52:55], v2, s[16:19], s36 offen sc1
    v_pk_fma_f32 v[80:81], v[172:173], v[136:137], v[80:81] op_sel_hi:[0,1,1] neg_lo:[1,0,0] neg_hi:[1,0,0]
    v_pk_fma_f32 v[82:83], v[172:173], v[138:139], v[82:83] op_sel_hi:[0,1,1] neg_lo:[1,0,0] neg_hi:[1,0,0]
    v_pk_mul_f32 v[226:227], v[80:81], v[80:81]
    v_pk_mul_f32 v[228:229], v[82:83], v[82:83]
    v_pk_fma_f32 v[226:227], v[226:227], v[174:175], v[174:175] op_sel:[0,1,0] op_sel_hi:[1,1,0]
    v_pk_fma_f32 v[228:229], v[228:229], v[174:175], v[174:175] op_sel:[0,1,0] op_sel_hi:[1,1,0]
    v_pk_mul_f32 v[226:227], v[226:227], v[80:81]
    v_pk_mul_f32 v[228:229], v[228:229], v[82:83]
    v_exp_f32 v226, v226
    v_exp_f32 v227, v227
    v_exp_f32 v228, v228
    v_exp_f32 v229, v229
    v_pk_fma_f32 v[226:227], v[226:227], v[172:173], v[172:173] op_sel:[0,1,1] op_sel_hi:[1,1,1]
    v_pk_fma_f32 v[228:229], v[228:229], v[172:173], v[172:173] op_sel:[0,1,1] op_sel_hi:[1,1,1]
    v_rcp_f32 v226, v226
    v_rcp_f32 v227, v227
    v_rcp_f32 v228, v228
    v_rcp_f32 v229, v229
    v_pk_mul_f32 v[80:81], v[80:81], v[226:227]
    v_pk_mul_f32 v[82:83], v[82:83], v[228:229]
    v_pk_fma_f32 v[84:85], v[172:173], v[140:141], v[84:85] op_sel_hi:[0,1,1] neg_lo:[1,0,0] neg_hi:[1,0,0]
    v_pk_fma_f32 v[86:87], v[172:173], v[142:143], v[86:87] op_sel_hi:[0,1,1] neg_lo:[1,0,0] neg_hi:[1,0,0]
    v_pk_mul_f32 v[226:227], v[84:85], v[84:85]
    v_pk_mul_f32 v[228:229], v[86:87], v[86:87]
    v_pk_fma_f32 v[226:227], v[226:227], v[174:175], v[174:175] op_sel:[0,1,0] op_sel_hi:[1,1,0]
    v_pk_fma_f32 v[228:229], v[228:229], v[174:175], v[174:175] op_sel:[0,1,0] op_sel_hi:[1,1,0]
    v_pk_mul_f32 v[226:227], v[226:227], v[84:85]
    v_pk_mul_f32 v[228:229], v[228:229], v[86:87]
    v_exp_f32 v226, v226
    v_exp_f32 v227, v227
    v_exp_f32 v228, v228
    v_exp_f32 v229, v229
    v_pk_fma_f32 v[226:227], v[226:227], v[172:173], v[172:173] op_sel:[0,1,1] op_sel_hi:[1,1,1]
    v_pk_fma_f32 v[228:229], v[228:229], v[172:173], v[172:173] op_sel:[0,1,1] op_sel_hi:[1,1,1]
    v_rcp_f32 v226, v226
    v_rcp_f32 v227, v227
    v_rcp_f32 v228, v228
    v_rcp_f32 v229, v229
    v_pk_mul_f32 v[84:85], v[84:85], v[226:227]
    v_pk_mul_f32 v[86:87], v[86:87], v[228:229]
    v_cvt_pk_bf16_f32 v80, v80, v81
    v_cvt_pk_bf16_f32 v81, v82, v83
    v_cvt_pk_bf16_f32 v82, v84, v85
    v_cvt_pk_bf16_f32 v83, v86, v87
    v_or_b32 v80, 1, v80
    ds_write_b128 v244, v[80:83] offset:4096
    s_add_u32 s36, s44, 458752
    buffer_store_dwordx4 v[80:83], v2, s[16:19], s36 offen sc1
    v_pk_fma_f32 v[108:109], v[176:177], v[136:137], v[108:109] op_sel_hi:[0,1,1] neg_lo:[1,0,0] neg_hi:[1,0,0]
    v_pk_fma_f32 v[110:111], v[176:177], v[138:139], v[110:111] op_sel_hi:[0,1,1] neg_lo:[1,0,0] neg_hi:[1,0,0]
    v_pk_mul_f32 v[226:227], v[108:109], v[108:109]
    v_pk_mul_f32 v[228:229], v[110:111], v[110:111]
    v_pk_fma_f32 v[226:227], v[226:227], v[178:179], v[178:179] op_sel:[0,1,0] op_sel_hi:[1,1,0]
    v_pk_fma_f32 v[228:229], v[228:229], v[178:179], v[178:179] op_sel:[0,1,0] op_sel_hi:[1,1,0]
    v_pk_mul_f32 v[226:227], v[226:227], v[108:109]
    v_pk_mul_f32 v[228:229], v[228:229], v[110:111]
    v_exp_f32 v226, v226
    v_exp_f32 v227, v227
    v_exp_f32 v228, v228
    v_exp_f32 v229, v229
    v_pk_fma_f32 v[226:227], v[226:227], v[176:177], v[176:177] op_sel:[0,1,1] op_sel_hi:[1,1,1]
    v_pk_fma_f32 v[228:229], v[228:229], v[176:177], v[176:177] op_sel:[0,1,1] op_sel_hi:[1,1,1]
    v_rcp_f32 v226, v226
    v_rcp_f32 v227, v227
    v_rcp_f32 v228, v228
    v_rcp_f32 v229, v229
    v_pk_mul_f32 v[108:109], v[108:109], v[226:227]
    v_pk_mul_f32 v[110:111], v[110:111], v[228:229]
    v_pk_fma_f32 v[112:113], v[176:177], v[140:141], v[112:113] op_sel_hi:[0,1,1] neg_lo:[1,0,0] neg_hi:[1,0,0]
    v_pk_fma_f32 v[114:115], v[176:177], v[142:143], v[114:115] op_sel_hi:[0,1,1] neg_lo:[1,0,0] neg_hi:[1,0,0]
    v_pk_mul_f32 v[226:227], v[112:113], v[112:113]
    v_pk_mul_f32 v[228:229], v[114:115], v[114:115]
    v_pk_fma_f32 v[226:227], v[226:227], v[178:179], v[178:179] op_sel:[0,1,0] op_sel_hi:[1,1,0]
    v_pk_fma_f32 v[228:229], v[228:229], v[178:179], v[178:179] op_sel:[0,1,0] op_sel_hi:[1,1,0]
    v_pk_mul_f32 v[226:227], v[226:227], v[112:113]
    v_pk_mul_f32 v[228:229], v[228:229], v[114:115]
    v_exp_f32 v226, v226
    v_exp_f32 v227, v227
    v_exp_f32 v228, v228
    v_exp_f32 v229, v229
    v_pk_fma_f32 v[226:227], v[226:227], v[176:177], v[176:177] op_sel:[0,1,1] op_sel_hi:[1,1,1]
    v_pk_fma_f32 v[228:229], v[228:229], v[176:177], v[176:177] op_sel:[0,1,1] op_sel_hi:[1,1,1]
    v_rcp_f32 v226, v226
    v_rcp_f32 v227, v227
    v_rcp_f32 v228, v228
    v_rcp_f32 v229, v229
    v_pk_mul_f32 v[112:113], v[112:113], v[226:227]
    v_pk_mul_f32 v[114:115], v[114:115], v[228:229]
    v_cvt_pk_bf16_f32 v108, v108, v109
    v_cvt_pk_bf16_f32 v109, v110, v111
    v_cvt_pk_bf16_f32 v110, v112, v113
    v_cvt_pk_bf16_f32 v111, v114, v115
    ds_write_b128 v244, v[108:111] offset:6144
    s_add_u32 s36, s44, 688128
    buffer_store_dwordx4 v[108:111], v2, s[16:19], s36 offen sc1
    v_pk_fma_f32 v[32:33], v[164:165], v[144:145], v[32:33] op_sel_hi:[0,1,1] neg_lo:[1,0,0] neg_hi:[1,0,0]
    v_pk_fma_f32 v[34:35], v[164:165], v[146:147], v[34:35] op_sel_hi:[0,1,1] neg_lo:[1,0,0] neg_hi:[1,0,0]
    v_pk_mul_f32 v[226:227], v[32:33], v[32:33]
    v_pk_mul_f32 v[228:229], v[34:35], v[34:35]
    v_pk_fma_f32 v[226:227], v[226:227], v[166:167], v[166:167] op_sel:[0,1,0] op_sel_hi:[1,1,0]
    v_pk_fma_f32 v[228:229], v[228:229], v[166:167], v[166:167] op_sel:[0,1,0] op_sel_hi:[1,1,0]
    v_pk_mul_f32 v[226:227], v[226:227], v[32:33]
    v_pk_mul_f32 v[228:229], v[228:229], v[34:35]
    v_exp_f32 v226, v226
    v_exp_f32 v227, v227
    v_exp_f32 v228, v228
    v_exp_f32 v229, v229
    v_pk_fma_f32 v[226:227], v[226:227], v[164:165], v[164:165] op_sel:[0,1,1] op_sel_hi:[1,1,1]
    v_pk_fma_f32 v[228:229], v[228:229], v[164:165], v[164:165] op_sel:[0,1,1] op_sel_hi:[1,1,1]
    v_rcp_f32 v226, v226
    v_rcp_f32 v227, v227
    v_rcp_f32 v228, v228
    v_rcp_f32 v229, v229
    v_pk_mul_f32 v[32:33], v[32:33], v[226:227]
    v_pk_mul_f32 v[34:35], v[34:35], v[228:229]
    v_pk_fma_f32 v[36:37], v[164:165], v[148:149], v[36:37] op_sel_hi:[0,1,1] neg_lo:[1,0,0] neg_hi:[1,0,0]
    v_pk_fma_f32 v[38:39], v[164:165], v[150:151], v[38:39] op_sel_hi:[0,1,1] neg_lo:[1,0,0] neg_hi:[1,0,0]
    v_pk_mul_f32 v[226:227], v[36:37], v[36:37]
    v_pk_mul_f32 v[228:229], v[38:39], v[38:39]
    v_pk_fma_f32 v[226:227], v[226:227], v[166:167], v[166:167] op_sel:[0,1,0] op_sel_hi:[1,1,0]
    v_pk_fma_f32 v[228:229], v[228:229], v[166:167], v[166:167] op_sel:[0,1,0] op_sel_hi:[1,1,0]
    v_pk_mul_f32 v[226:227], v[226:227], v[36:37]
    v_pk_mul_f32 v[228:229], v[228:229], v[38:39]
    v_exp_f32 v226, v226
    v_exp_f32 v227, v227
    v_exp_f32 v228, v228
    v_exp_f32 v229, v229
    v_pk_fma_f32 v[226:227], v[226:227], v[164:165], v[164:165] op_sel:[0,1,1] op_sel_hi:[1,1,1]
    v_pk_fma_f32 v[228:229], v[228:229], v[164:165], v[164:165] op_sel:[0,1,1] op_sel_hi:[1,1,1]
    v_rcp_f32 v226, v226
    v_rcp_f32 v227, v227
    v_rcp_f32 v228, v228
    v_rcp_f32 v229, v229
    v_pk_mul_f32 v[36:37], v[36:37], v[226:227]
    v_pk_mul_f32 v[38:39], v[38:39], v[228:229]
    v_cvt_pk_bf16_f32 v32, v32, v33
    v_cvt_pk_bf16_f32 v33, v34, v35
    v_cvt_pk_bf16_f32 v34, v36, v37
    v_cvt_pk_bf16_f32 v35, v38, v39
    v_or_b32 v32, 1, v32
    ds_write_b128 v244, v[32:35] offset:16384
    v_pk_fma_f32 v[60:61], v[168:169], v[144:145], v[60:61] op_sel_hi:[0,1,1] neg_lo:[1,0,0] neg_hi:[1,0,0]
    v_pk_fma_f32 v[62:63], v[168:169], v[146:147], v[62:63] op_sel_hi:[0,1,1] neg_lo:[1,0,0] neg_hi:[1,0,0]
    v_pk_mul_f32 v[226:227], v[60:61], v[60:61]
    v_pk_mul_f32 v[228:229], v[62:63], v[62:63]
    v_pk_fma_f32 v[226:227], v[226:227], v[170:171], v[170:171] op_sel:[0,1,0] op_sel_hi:[1,1,0]
    v_pk_fma_f32 v[228:229], v[228:229], v[170:171], v[170:171] op_sel:[0,1,0] op_sel_hi:[1,1,0]
    v_pk_mul_f32 v[226:227], v[226:227], v[60:61]
    v_pk_mul_f32 v[228:229], v[228:229], v[62:63]
    v_exp_f32 v226, v226
    v_exp_f32 v227, v227
    v_exp_f32 v228, v228
    v_exp_f32 v229, v229
    v_pk_fma_f32 v[226:227], v[226:227], v[168:169], v[168:169] op_sel:[0,1,1] op_sel_hi:[1,1,1]
    v_pk_fma_f32 v[228:229], v[228:229], v[168:169], v[168:169] op_sel:[0,1,1] op_sel_hi:[1,1,1]
    v_rcp_f32 v226, v226
    v_rcp_f32 v227, v227
    v_rcp_f32 v228, v228
    v_rcp_f32 v229, v229
    v_pk_mul_f32 v[60:61], v[60:61], v[226:227]
    v_pk_mul_f32 v[62:63], v[62:63], v[228:229]
    v_pk_fma_f32 v[64:65], v[168:169], v[148:149], v[64:65] op_sel_hi:[0,1,1] neg_lo:[1,0,0] neg_hi:[1,0,0]
    v_pk_fma_f32 v[66:67], v[168:169], v[150:151], v[66:67] op_sel_hi:[0,1,1] neg_lo:[1,0,0] neg_hi:[1,0,0]
    v_pk_mul_f32 v[226:227], v[64:65], v[64:65]
    v_pk_mul_f32 v[228:229], v[66:67], v[66:67]
    v_pk_fma_f32 v[226:227], v[226:227], v[170:171], v[170:171] op_sel:[0,1,0] op_sel_hi:[1,1,0]
    v_pk_fma_f32 v[228:229], v[228:229], v[170:171], v[170:171] op_sel:[0,1,0] op_sel_hi:[1,1,0]
    v_pk_mul_f32 v[226:227], v[226:227], v[64:65]
    v_pk_mul_f32 v[228:229], v[228:229], v[66:67]
    v_exp_f32 v226, v226
    v_exp_f32 v227, v227
    v_exp_f32 v228, v228
    v_exp_f32 v229, v229
    v_pk_fma_f32 v[226:227], v[226:227], v[168:169], v[168:169] op_sel:[0,1,1] op_sel_hi:[1,1,1]
    v_pk_fma_f32 v[228:229], v[228:229], v[168:169], v[168:169] op_sel:[0,1,1] op_sel_hi:[1,1,1]
    v_rcp_f32 v226, v226
    v_rcp_f32 v227, v227
    v_rcp_f32 v228, v228
    v_rcp_f32 v229, v229
    v_pk_mul_f32 v[64:65], v[64:65], v[226:227]
    v_pk_mul_f32 v[66:67], v[66:67], v[228:229]
    v_cvt_pk_bf16_f32 v60, v60, v61
    v_cvt_pk_bf16_f32 v61, v62, v63
    v_cvt_pk_bf16_f32 v62, v64, v65
    v_cvt_pk_bf16_f32 v63, v66, v67
    v_or_b32 v60, 1, v60
    ds_write_b128 v244, v[60:63] offset:18432
    s_waitcnt vmcnt(0)
    s_mov_b64 exec, 1
    ds_add_u32 v246, v245
    s_mov_b64 exec, -1
    v_pk_fma_f32 v[88:89], v[172:173], v[144:145], v[88:89] op_sel_hi:[0,1,1] neg_lo:[1,0,0] neg_hi:[1,0,0]
    v_pk_fma_f32 v[90:91], v[172:173], v[146:147], v[90:91] op_sel_hi:[0,1,1] neg_lo:[1,0,0] neg_hi:[1,0,0]
    v_pk_mul_f32 v[226:227], v[88:89], v[88:89]
    v_pk_mul_f32 v[228:229], v[90:91], v[90:91]
    v_pk_fma_f32 v[226:227], v[226:227], v[174:175], v[174:175] op_sel:[0,1,0] op_sel_hi:[1,1,0]
    v_pk_fma_f32 v[228:229], v[228:229], v[174:175], v[174:175] op_sel:[0,1,0] op_sel_hi:[1,1,0]
    v_pk_mul_f32 v[226:227], v[226:227], v[88:89]
    v_pk_mul_f32 v[228:229], v[228:229], v[90:91]
    v_exp_f32 v226, v226
    v_exp_f32 v227, v227
    v_exp_f32 v228, v228
    v_exp_f32 v229, v229
    v_pk_fma_f32 v[226:227], v[226:227], v[172:173], v[172:173] op_sel:[0,1,1] op_sel_hi:[1,1,1]
    v_pk_fma_f32 v[228:229], v[228:229], v[172:173], v[172:173] op_sel:[0,1,1] op_sel_hi:[1,1,1]
    v_rcp_f32 v226, v226
    v_rcp_f32 v227, v227
    v_rcp_f32 v228, v228
    v_rcp_f32 v229, v229
    v_pk_mul_f32 v[88:89], v[88:89], v[226:227]
    v_pk_mul_f32 v[90:91], v[90:91], v[228:229]
    v_pk_fma_f32 v[92:93], v[172:173], v[148:149], v[92:93] op_sel_hi:[0,1,1] neg_lo:[1,0,0] neg_hi:[1,0,0]
    v_pk_fma_f32 v[94:95], v[172:173], v[150:151], v[94:95] op_sel_hi:[0,1,1] neg_lo:[1,0,0] neg_hi:[1,0,0]
    v_pk_mul_f32 v[226:227], v[92:93], v[92:93]
    v_pk_mul_f32 v[228:229], v[94:95], v[94:95]
    v_pk_fma_f32 v[226:227], v[226:227], v[174:175], v[174:175] op_sel:[0,1,0] op_sel_hi:[1,1,0]
    v_pk_fma_f32 v[228:229], v[228:229], v[174:175], v[174:175] op_sel:[0,1,0] op_sel_hi:[1,1,0]
    v_pk_mul_f32 v[226:227], v[226:227], v[92:93]
    v_pk_mul_f32 v[228:229], v[228:229], v[94:95]
    v_exp_f32 v226, v226
    v_exp_f32 v227, v227
    v_exp_f32 v228, v228
    v_exp_f32 v229, v229
    v_pk_fma_f32 v[226:227], v[226:227], v[172:173], v[172:173] op_sel:[0,1,1] op_sel_hi:[1,1,1]
    v_pk_fma_f32 v[228:229], v[228:229], v[172:173], v[172:173] op_sel:[0,1,1] op_sel_hi:[1,1,1]
    v_rcp_f32 v226, v226
    v_rcp_f32 v227, v227
    v_rcp_f32 v228, v228
    v_rcp_f32 v229, v229
    v_pk_mul_f32 v[92:93], v[92:93], v[226:227]
    v_pk_mul_f32 v[94:95], v[94:95], v[228:229]
    v_cvt_pk_bf16_f32 v88, v88, v89
    v_cvt_pk_bf16_f32 v89, v90, v91
    v_cvt_pk_bf16_f32 v90, v92, v93
    v_cvt_pk_bf16_f32 v91, v94, v95
    v_or_b32 v88, 1, v88
    ds_write_b128 v244, v[88:91] offset:20480
    s_cmp_eq_u32 s60, 1
    s_cbranch_scc1 G4_p10
    buffer_load_dwordx4 v[180:183], v196, s[84:87], 0 offen offset:0 sc1
    buffer_load_dwordx4 v[188:191], v196, s[88:91], 0 offen offset:0 sc1
    buffer_load_dwordx4 v[184:187], v196, s[84:87], 0 offen offset:2048 sc1
    buffer_load_dwordx4 v[192:195], v196, s[88:91], 0 offen offset:2048 sc1
    s_branch G4_p20
G4_p10:
    s_add_u32 s36, s40, 0
    buffer_load_dwordx4 v[180:183], v2, s[84:87], s36 offen offset:0 sc1
    buffer_load_dwordx4 v[184:187], v2, s[88:91], s36 offen offset:0 sc1
    buffer_load_dwordx4 v[188:191], v2, s[84:87], s36 offen offset:1024 sc1
    buffer_load_dwordx4 v[192:195], v2, s[88:91], s36 offen offset:1024 sc1
    s_add_u32 s36, s40, 65536
    buffer_load_dwordx4 v[196:199], v2, s[84:87], s36 offen offset:0 sc1
    buffer_load_dwordx4 v[230:233], v2, s[88:91], s36 offen offset:0 sc1
    buffer_load_dwordx4 v[234:237], v2, s[84:87], s36 offen offset:1024 sc1
    buffer_load_dwordx4 v[248:251], v2, s[88:91], s36 offen offset:1024 sc1
G4_p20:
    v_pk_fma_f32 v[116:117], v[176:177], v[144:145], v[116:117] op_sel_hi:[0,1,1] neg_lo:[1,0,0] neg_hi:[1,0,0]
    v_pk_fma_f32 v[118:119], v[176:177], v[146:147], v[118:119] op_sel_hi:[0,1,1] neg_lo:[1,0,0] neg_hi:[1,0,0]
    v_pk_mul_f32 v[226:227], v[116:117], v[116:117]
    v_pk_mul_f32 v[228:229], v[118:119], v[118:119]
    v_pk_fma_f32 v[226:227], v[226:227], v[178:179], v[178:179] op_sel:[0,1,0] op_sel_hi:[1,1,0]
    v_pk_fma_f32 v[228:229], v[228:229], v[178:179], v[178:179] op_sel:[0,1,0] op_sel_hi:[1,1,0]
    v_pk_mul_f32 v[226:227], v[226:227], v[116:117]
    v_pk_mul_f32 v[228:229], v[228:229], v[118:119]
    v_exp_f32 v226, v226
    v_exp_f32 v227, v227
    v_exp_f32 v228, v228
    v_exp_f32 v229, v229
    v_pk_fma_f32 v[226:227], v[226:227], v[176:177], v[176:177] op_sel:[0,1,1] op_sel_hi:[1,1,1]
    v_pk_fma_f32 v[228:229], v[228:229], v[176:177], v[176:177] op_sel:[0,1,1] op_sel_hi:[1,1,1]
    v_rcp_f32 v226, v226
    v_rcp_f32 v227, v227
    v_rcp_f32 v228, v228
    v_rcp_f32 v229, v229
    v_pk_mul_f32 v[116:117], v[116:117], v[226:227]
    v_pk_mul_f32 v[118:119], v[118:119], v[228:229]
    v_pk_fma_f32 v[120:121], v[176:177], v[148:149], v[120:121] op_sel_hi:[0,1,1] neg_lo:[1,0,0] neg_hi:[1,0,0]
    v_pk_fma_f32 v[122:123], v[176:177], v[150:151], v[122:123] op_sel_hi:[0,1,1] neg_lo:[1,0,0] neg_hi:[1,0,0]
    v_pk_mul_f32 v[226:227], v[120:121], v[120:121]
    v_pk_mul_f32 v[228:229], v[122:123], v[122:123]
    v_pk_fma_f32 v[226:227], v[226:227], v[178:179], v[178:179] op_sel:[0,1,0] op_sel_hi:[1,1,0]
    v_pk_fma_f32 v[228:229], v[228:229], v[178:179], v[178:179] op_sel:[0,1,0] op_sel_hi:[1,1,0]
    v_pk_mul_f32 v[226:227], v[226:227], v[120:121]
    v_pk_mul_f32 v[228:229], v[228:229], v[122:123]
    v_exp_f32 v226, v226
    v_exp_f32 v227, v227
    v_exp_f32 v228, v228
    v_exp_f32 v229, v229
    v_pk_fma_f32 v[226:227], v[226:227], v[176:177], v[176:177] op_sel:[0,1,1] op_sel_hi:[1,1,1]
    v_pk_fma_f32 v[228:229], v[228:229], v[176:177], v[176:177] op_sel:[0,1,1] op_sel_hi:[1,1,1]
    v_rcp_f32 v226, v226
    v_rcp_f32 v227, v227
    v_rcp_f32 v228, v228
    v_rcp_f32 v229, v229
    v_pk_mul_f32 v[120:121], v[120:121], v[226:227]
    v_pk_mul_f32 v[122:123], v[122:123], v[228:229]
    v_cvt_pk_bf16_f32 v116, v116, v117
    v_cvt_pk_bf16_f32 v117, v118, v119
    v_cvt_pk_bf16_f32 v118, v120, v121
    v_cvt_pk_bf16_f32 v119, v122, v123
    ds_write_b128 v244, v[116:119] offset:22528
    v_pk_fma_f32 v[40:41], v[164:165], v[152:153], v[40:41] op_sel_hi:[0,1,1] neg_lo:[1,0,0] neg_hi:[1,0,0]
    v_pk_fma_f32 v[42:43], v[164:165], v[154:155], v[42:43] op_sel_hi:[0,1,1] neg_lo:[1,0,0] neg_hi:[1,0,0]
    v_pk_mul_f32 v[226:227], v[40:41], v[40:41]
    v_pk_mul_f32 v[228:229], v[42:43], v[42:43]
    v_pk_fma_f32 v[226:227], v[226:227], v[166:167], v[166:167] op_sel:[0,1,0] op_sel_hi:[1,1,0]
    v_pk_fma_f32 v[228:229], v[228:229], v[166:167], v[166:167] op_sel:[0,1,0] op_sel_hi:[1,1,0]
    v_pk_mul_f32 v[226:227], v[226:227], v[40:41]
    v_pk_mul_f32 v[228:229], v[228:229], v[42:43]
    v_exp_f32 v226, v226
    v_exp_f32 v227, v227
    v_exp_f32 v228, v228
    v_exp_f32 v229, v229
    v_pk_fma_f32 v[226:227], v[226:227], v[164:165], v[164:165] op_sel:[0,1,1] op_sel_hi:[1,1,1]
    v_pk_fma_f32 v[228:229], v[228:229], v[164:165], v[164:165] op_sel:[0,1,1] op_sel_hi:[1,1,1]
    v_rcp_f32 v226, v226
    v_rcp_f32 v227, v227
    v_rcp_f32 v228, v228
    v_rcp_f32 v229, v229
    v_pk_mul_f32 v[40:41], v[40:41], v[226:227]
    v_pk_mul_f32 v[42:43], v[42:43], v[228:229]
    v_pk_fma_f32 v[44:45], v[164:165], v[156:157], v[44:45] op_sel_hi:[0,1,1] neg_lo:[1,0,0] neg_hi:[1,0,0]
    v_pk_fma_f32 v[46:47], v[164:165], v[158:159], v[46:47] op_sel_hi:[0,1,1] neg_lo:[1,0,0] neg_hi:[1,0,0]
    v_pk_mul_f32 v[226:227], v[44:45], v[44:45]
    v_pk_mul_f32 v[228:229], v[46:47], v[46:47]
    v_pk_fma_f32 v[226:227], v[226:227], v[166:167], v[166:167] op_sel:[0,1,0] op_sel_hi:[1,1,0]
    v_pk_fma_f32 v[228:229], v[228:229], v[166:167], v[166:167] op_sel:[0,1,0] op_sel_hi:[1,1,0]
    v_pk_mul_f32 v[226:227], v[226:227], v[44:45]
    v_pk_mul_f32 v[228:229], v[228:229], v[46:47]
    v_exp_f32 v226, v226
    v_exp_f32 v227, v227
    v_exp_f32 v228, v228
    v_exp_f32 v229, v229
    v_pk_fma_f32 v[226:227], v[226:227], v[164:165], v[164:165] op_sel:[0,1,1] op_sel_hi:[1,1,1]
    v_pk_fma_f32 v[228:229], v[228:229], v[164:165], v[164:165] op_sel:[0,1,1] op_sel_hi:[1,1,1]
    v_rcp_f32 v226, v226
    v_rcp_f32 v227, v227
    v_rcp_f32 v228, v228
    v_rcp_f32 v229, v229
    v_pk_mul_f32 v[44:45], v[44:45], v[226:227]
    v_pk_mul_f32 v[46:47], v[46:47], v[228:229]
    v_cvt_pk_bf16_f32 v200, v40, v41
    v_cvt_pk_bf16_f32 v201, v42, v43
    v_cvt_pk_bf16_f32 v202, v44, v45
    v_cvt_pk_bf16_f32 v203, v46, v47
    v_or_b32 v200, 1, v200
    ds_write_b128 v244, v[200:203] offset:32768
    v_pk_fma_f32 v[68:69], v[168:169], v[152:153], v[68:69] op_sel_hi:[0,1,1] neg_lo:[1,0,0] neg_hi:[1,0,0]
    v_pk_fma_f32 v[70:71], v[168:169], v[154:155], v[70:71] op_sel_hi:[0,1,1] neg_lo:[1,0,0] neg_hi:[1,0,0]
    v_pk_mul_f32 v[226:227], v[68:69], v[68:69]
    v_pk_mul_f32 v[228:229], v[70:71], v[70:71]
    v_pk_fma_f32 v[226:227], v[226:227], v[170:171], v[170:171] op_sel:[0,1,0] op_sel_hi:[1,1,0]
    v_pk_fma_f32 v[228:229], v[228:229], v[170:171], v[170:171] op_sel:[0,1,0] op_sel_hi:[1,1,0]
    v_pk_mul_f32 v[226:227], v[226:227], v[68:69]
    v_pk_mul_f32 v[228:229], v[228:229], v[70:71]
    v_exp_f32 v226, v226
    v_exp_f32 v227, v227
    v_exp_f32 v228, v228
    v_exp_f32 v229, v229
    v_pk_fma_f32 v[226:227], v[226:227], v[168:169], v[168:169] op_sel:[0,1,1] op_sel_hi:[1,1,1]
    v_pk_fma_f32 v[228:229], v[228:229], v[168:169], v[168:169] op_sel:[0,1,1] op_sel_hi:[1,1,1]
    v_rcp_f32 v226, v226
    v_rcp_f32 v227, v227
    v_rcp_f32 v228, v228
    v_rcp_f32 v229, v229
    v_pk_mul_f32 v[68:69], v[68:69], v[226:227]
    v_pk_mul_f32 v[70:71], v[70:71], v[228:229]
    v_pk_fma_f32 v[72:73], v[168:169], v[156:157], v[72:73] op_sel_hi:[0,1,1] neg_lo:[1,0,0] neg_hi:[1,0,0]
    v_pk_fma_f32 v[74:75], v[168:169], v[158:159], v[74:75] op_sel_hi:[0,1,1] neg_lo:[1,0,0] neg_hi:[1,0,0]
    v_pk_mul_f32 v[226:227], v[72:73], v[72:73]
    v_pk_mul_f32 v[228:229], v[74:75], v[74:75]
    v_pk_fma_f32 v[226:227], v[226:227], v[170:171], v[170:171] op_sel:[0,1,0] op_sel_hi:[1,1,0]
    v_pk_fma_f32 v[228:229], v[228:229], v[170:171], v[170:171] op_sel:[0,1,0] op_sel_hi:[1,1,0]
    v_pk_mul_f32 v[226:227], v[226:227], v[72:73]
    v_pk_mul_f32 v[228:229], v[228:229], v[74:75]
    v_exp_f32 v226, v226
    v_exp_f32 v227, v227
    v_exp_f32 v228, v228
    v_exp_f32 v229, v229
    v_pk_fma_f32 v[226:227], v[226:227], v[168:169], v[168:169] op_sel:[0,1,1] op_sel_hi:[1,1,1]
    v_pk_fma_f32 v[228:229], v[228:229], v[168:169], v[168:169] op_sel:[0,1,1] op_sel_hi:[1,1,1]
    v_rcp_f32 v226, v226
    v_rcp_f32 v227, v227
    v_rcp_f32 v228, v228
    v_rcp_f32 v229, v229
    v_pk_mul_f32 v[72:73], v[72:73], v[226:227]
    v_pk_mul_f32 v[74:75], v[74:75], v[228:229]
    v_cvt_pk_bf16_f32 v204, v68, v69
    v_cvt_pk_bf16_f32 v205, v70, v71
    v_cvt_pk_bf16_f32 v206, v72, v73
    v_cvt_pk_bf16_f32 v207, v74, v75
    v_or_b32 v204, 1, v204
    ds_write_b128 v244, v[204:207] offset:34816
    v_pk_fma_f32 v[96:97], v[172:173], v[152:153], v[96:97] op_sel_hi:[0,1,1] neg_lo:[1,0,0] neg_hi:[1,0,0]
    v_pk_fma_f32 v[98:99], v[172:173], v[154:155], v[98:99] op_sel_hi:[0,1,1] neg_lo:[1,0,0] neg_hi:[1,0,0]
    v_pk_mul_f32 v[226:227], v[96:97], v[96:97]
    v_pk_mul_f32 v[228:229], v[98:99], v[98:99]
    v_pk_fma_f32 v[226:227], v[226:227], v[174:175], v[174:175] op_sel:[0,1,0] op_sel_hi:[1,1,0]
    v_pk_fma_f32 v[228:229], v[228:229], v[174:175], v[174:175] op_sel:[0,1,0] op_sel_hi:[1,1,0]
    v_pk_mul_f32 v[226:227], v[226:227], v[96:97]
    v_pk_mul_f32 v[228:229], v[228:229], v[98:99]
    v_exp_f32 v226, v226
    v_exp_f32 v227, v227
    v_exp_f32 v228, v228
    v_exp_f32 v229, v229
    v_pk_fma_f32 v[226:227], v[226:227], v[172:173], v[172:173] op_sel:[0,1,1] op_sel_hi:[1,1,1]
    v_pk_fma_f32 v[228:229], v[228:229], v[172:173], v[172:173] op_sel:[0,1,1] op_sel_hi:[1,1,1]
    v_rcp_f32 v226, v226
    v_rcp_f32 v227, v227
    v_rcp_f32 v228, v228
    v_rcp_f32 v229, v229
    v_pk_mul_f32 v[96:97], v[96:97], v[226:227]
    v_pk_mul_f32 v[98:99], v[98:99], v[228:229]
    v_pk_fma_f32 v[100:101], v[172:173], v[156:157], v[100:101] op_sel_hi:[0,1,1] neg_lo:[1,0,0] neg_hi:[1,0,0]
    v_pk_fma_f32 v[102:103], v[172:173], v[158:159], v[102:103] op_sel_hi:[0,1,1] neg_lo:[1,0,0] neg_hi:[1,0,0]
    v_pk_mul_f32 v[226:227], v[100:101], v[100:101]
    v_pk_mul_f32 v[228:229], v[102:103], v[102:103]
    v_pk_fma_f32 v[226:227], v[226:227], v[174:175], v[174:175] op_sel:[0,1,0] op_sel_hi:[1,1,0]
    v_pk_fma_f32 v[228:229], v[228:229], v[174:175], v[174:175] op_sel:[0,1,0] op_sel_hi:[1,1,0]
    v_pk_mul_f32 v[226:227], v[226:227], v[100:101]
    v_pk_mul_f32 v[228:229], v[228:229], v[102:103]
    v_exp_f32 v226, v226
    v_exp_f32 v227, v227
    v_exp_f32 v228, v228
    v_exp_f32 v229, v229
    v_pk_fma_f32 v[226:227], v[226:227], v[172:173], v[172:173] op_sel:[0,1,1] op_sel_hi:[1,1,1]
    v_pk_fma_f32 v[228:229], v[228:229], v[172:173], v[172:173] op_sel:[0,1,1] op_sel_hi:[1,1,1]
    v_rcp_f32 v226, v226
    v_rcp_f32 v227, v227
    v_rcp_f32 v228, v228
    v_rcp_f32 v229, v229
    v_pk_mul_f32 v[100:101], v[100:101], v[226:227]
    v_pk_mul_f32 v[102:103], v[102:103], v[228:229]
    v_cvt_pk_bf16_f32 v208, v96, v97
    v_cvt_pk_bf16_f32 v209, v98, v99
    v_cvt_pk_bf16_f32 v210, v100, v101
    v_cvt_pk_bf16_f32 v211, v102, v103
    v_or_b32 v208, 1, v208
    ds_write_b128 v244, v[208:211] offset:36864
    v_pk_fma_f32 v[124:125], v[176:177], v[152:153], v[124:125] op_sel_hi:[0,1,1] neg_lo:[1,0,0] neg_hi:[1,0,0]
    v_pk_fma_f32 v[126:127], v[176:177], v[154:155], v[126:127] op_sel_hi:[0,1,1] neg_lo:[1,0,0] neg_hi:[1,0,0]
    v_pk_mul_f32 v[226:227], v[124:125], v[124:125]
    v_pk_mul_f32 v[228:229], v[126:127], v[126:127]
    v_pk_fma_f32 v[226:227], v[226:227], v[178:179], v[178:179] op_sel:[0,1,0] op_sel_hi:[1,1,0]
    v_pk_fma_f32 v[228:229], v[228:229], v[178:179], v[178:179] op_sel:[0,1,0] op_sel_hi:[1,1,0]
    v_pk_mul_f32 v[226:227], v[226:227], v[124:125]
    v_pk_mul_f32 v[228:229], v[228:229], v[126:127]
    v_exp_f32 v226, v226
    v_exp_f32 v227, v227
    v_exp_f32 v228, v228
    v_exp_f32 v229, v229
    v_pk_fma_f32 v[226:227], v[226:227], v[176:177], v[176:177] op_sel:[0,1,1] op_sel_hi:[1,1,1]
    v_pk_fma_f32 v[228:229], v[228:229], v[176:177], v[176:177] op_sel:[0,1,1] op_sel_hi:[1,1,1]
    v_rcp_f32 v226, v226
    v_rcp_f32 v227, v227
    v_rcp_f32 v228, v228
    v_rcp_f32 v229, v229
    v_pk_mul_f32 v[124:125], v[124:125], v[226:227]
    v_pk_mul_f32 v[126:127], v[126:127], v[228:229]
    v_pk_fma_f32 v[128:129], v[176:177], v[156:157], v[128:129] op_sel_hi:[0,1,1] neg_lo:[1,0,0] neg_hi:[1,0,0]
    v_pk_fma_f32 v[130:131], v[176:177], v[158:159], v[130:131] op_sel_hi:[0,1,1] neg_lo:[1,0,0] neg_hi:[1,0,0]
    v_pk_mul_f32 v[226:227], v[128:129], v[128:129]
    v_pk_mul_f32 v[228:229], v[130:131], v[130:131]
    v_pk_fma_f32 v[226:227], v[226:227], v[178:179], v[178:179] op_sel:[0,1,0] op_sel_hi:[1,1,0]
    v_pk_fma_f32 v[228:229], v[228:229], v[178:179], v[178:179] op_sel:[0,1,0] op_sel_hi:[1,1,0]
    v_pk_mul_f32 v[226:227], v[226:227], v[128:129]
    v_pk_mul_f32 v[228:229], v[228:229], v[130:131]
    v_exp_f32 v226, v226
    v_exp_f32 v227, v227
    v_exp_f32 v228, v228
    v_exp_f32 v229, v229
    v_pk_fma_f32 v[226:227], v[226:227], v[176:177], v[176:177] op_sel:[0,1,1] op_sel_hi:[1,1,1]
    v_pk_fma_f32 v[228:229], v[228:229], v[176:177], v[176:177] op_sel:[0,1,1] op_sel_hi:[1,1,1]
    v_rcp_f32 v226, v226
    v_rcp_f32 v227, v227
    v_rcp_f32 v228, v228
    v_rcp_f32 v229, v229
    v_pk_mul_f32 v[128:129], v[128:129], v[226:227]
    v_pk_mul_f32 v[130:131], v[130:131], v[228:229]
    v_cvt_pk_bf16_f32 v212, v124, v125
    v_cvt_pk_bf16_f32 v213, v126, v127
    v_cvt_pk_bf16_f32 v214, v128, v129
    v_cvt_pk_bf16_f32 v215, v130, v131
    ds_write_b128 v244, v[212:215] offset:38912
    v_pk_fma_f32 v[48:49], v[164:165], v[160:161], v[48:49] op_sel_hi:[0,1,1] neg_lo:[1,0,0] neg_hi:[1,0,0]
    v_pk_fma_f32 v[50:51], v[164:165], v[162:163], v[50:51] op_sel_hi:[0,1,1] neg_lo:[1,0,0] neg_hi:[1,0,0]
    v_pk_mul_f32 v[226:227], v[48:49], v[48:49]
    v_pk_mul_f32 v[228:229], v[50:51], v[50:51]
    v_pk_fma_f32 v[226:227], v[226:227], v[166:167], v[166:167] op_sel:[0,1,0] op_sel_hi:[1,1,0]
    v_pk_fma_f32 v[228:229], v[228:229], v[166:167], v[166:167] op_sel:[0,1,0] op_sel_hi:[1,1,0]
    v_pk_mul_f32 v[226:227], v[226:227], v[48:49]
    v_pk_mul_f32 v[228:229], v[228:229], v[50:51]
    v_exp_f32 v226, v226
    v_exp_f32 v227, v227
    v_exp_f32 v228, v228
    v_exp_f32 v229, v229
    v_pk_fma_f32 v[226:227], v[226:227], v[164:165], v[164:165] op_sel:[0,1,1] op_sel_hi:[1,1,1]
    v_pk_fma_f32 v[228:229], v[228:229], v[164:165], v[164:165] op_sel:[0,1,1] op_sel_hi:[1,1,1]
    v_rcp_f32 v226, v226
    v_rcp_f32 v227, v227
    v_rcp_f32 v228, v228
    v_rcp_f32 v229, v229
    v_pk_mul_f32 v[48:49], v[48:49], v[226:227]
    v_pk_mul_f32 v[50:51], v[50:51], v[228:229]
    v_cvt_pk_bf16_f32 v216, v48, v49
    v_cvt_pk_bf16_f32 v217, v50, v51
    v_or_b32 v216, 1, v216
    s_add_u32 s36, s45, 0
    buffer_store_dwordx4 v[32:35], v2, s[16:19], s36 offen sc1
    v_pk_fma_f32 v[76:77], v[168:169], v[160:161], v[76:77] op_sel_hi:[0,1,1] neg_lo:[1,0,0] neg_hi:[1,0,0]
    v_pk_fma_f32 v[78:79], v[168:169], v[162:163], v[78:79] op_sel_hi:[0,1,1] neg_lo:[1,0,0] neg_hi:[1,0,0]
    v_pk_mul_f32 v[226:227], v[76:77], v[76:77]
    v_pk_mul_f32 v[228:229], v[78:79], v[78:79]
    v_pk_fma_f32 v[226:227], v[226:227], v[170:171], v[170:171] op_sel:[0,1,0] op_sel_hi:[1,1,0]
    v_pk_fma_f32 v[228:229], v[228:229], v[170:171], v[170:171] op_sel:[0,1,0] op_sel_hi:[1,1,0]
    v_pk_mul_f32 v[226:227], v[226:227], v[76:77]
    v_pk_mul_f32 v[228:229], v[228:229], v[78:79]
    v_exp_f32 v226, v226
    v_exp_f32 v227, v227
    v_exp_f32 v228, v228
    v_exp_f32 v229, v229
    v_pk_fma_f32 v[226:227], v[226:227], v[168:169], v[168:169] op_sel:[0,1,1] op_sel_hi:[1,1,1]
    v_pk_fma_f32 v[228:229], v[228:229], v[168:169], v[168:169] op_sel:[0,1,1] op_sel_hi:[1,1,1]
    v_rcp_f32 v226, v226
    v_rcp_f32 v227, v227
    v_rcp_f32 v228, v228
    v_rcp_f32 v229, v229
    v_pk_mul_f32 v[76:77], v[76:77], v[226:227]
    v_pk_mul_f32 v[78:79], v[78:79], v[228:229]
    v_cvt_pk_bf16_f32 v218, v76, v77
    v_cvt_pk_bf16_f32 v219, v78, v79
    v_or_b32 v218, 1, v218
    s_add_u32 s36, s45, 229376
    buffer_store_dwordx4 v[60:63], v2, s[16:19], s36 offen sc1
    v_pk_fma_f32 v[104:105], v[172:173], v[160:161], v[104:105] op_sel_hi:[0,1,1] neg_lo:[1,0,0] neg_hi:[1,0,0]
    v_pk_fma_f32 v[106:107], v[172:173], v[162:163], v[106:107] op_sel_hi:[0,1,1] neg_lo:[1,0,0] neg_hi:[1,0,0]
    v_pk_mul_f32 v[226:227], v[104:105], v[104:105]
    v_pk_mul_f32 v[228:229], v[106:107], v[106:107]
    v_pk_fma_f32 v[226:227], v[226:227], v[174:175], v[174:175] op_sel:[0,1,0] op_sel_hi:[1,1,0]
    v_pk_fma_f32 v[228:229], v[228:229], v[174:175], v[174:175] op_sel:[0,1,0] op_sel_hi:[1,1,0]
    v_pk_mul_f32 v[226:227], v[226:227], v[104:105]
    v_pk_mul_f32 v[228:229], v[228:229], v[106:107]
    v_exp_f32 v226, v226
    v_exp_f32 v227, v227
    v_exp_f32 v228, v228
    v_exp_f32 v229, v229
    v_pk_fma_f32 v[226:227], v[226:227], v[172:173], v[172:173] op_sel:[0,1,1] op_sel_hi:[1,1,1]
    v_pk_fma_f32 v[228:229], v[228:229], v[172:173], v[172:173] op_sel:[0,1,1] op_sel_hi:[1,1,1]
    v_rcp_f32 v226, v226
    v_rcp_f32 v227, v227
    v_rcp_f32 v228, v228
    v_rcp_f32 v229, v229
    v_pk_mul_f32 v[104:105], v[104:105], v[226:227]
    v_pk_mul_f32 v[106:107], v[106:107], v[228:229]
    v_cvt_pk_bf16_f32 v220, v104, v105
    v_cvt_pk_bf16_f32 v221, v106, v107
    v_or_b32 v220, 1, v220
    s_add_u32 s36, s45, 458752
    buffer_store_dwordx4 v[88:91], v2, s[16:19], s36 offen sc1
    v_pk_fma_f32 v[132:133], v[176:177], v[160:161], v[132:133] op_sel_hi:[0,1,1] neg_lo:[1,0,0] neg_hi:[1,0,0]
    v_pk_fma_f32 v[134:135], v[176:177], v[162:163], v[134:135] op_sel_hi:[0,1,1] neg_lo:[1,0,0] neg_hi:[1,0,0]
    v_pk_mul_f32 v[226:227], v[132:133], v[132:133]
    v_pk_mul_f32 v[228:229], v[134:135], v[134:135]
    v_pk_fma_f32 v[226:227], v[226:227], v[178:179], v[178:179] op_sel:[0,1,0] op_sel_hi:[1,1,0]
    v_pk_fma_f32 v[228:229], v[228:229], v[178:179], v[178:179] op_sel:[0,1,0] op_sel_hi:[1,1,0]
    v_pk_mul_f32 v[226:227], v[226:227], v[132:133]
    v_pk_mul_f32 v[228:229], v[228:229], v[134:135]
    v_exp_f32 v226, v226
    v_exp_f32 v227, v227
    v_exp_f32 v228, v228
    v_exp_f32 v229, v229
    v_pk_fma_f32 v[226:227], v[226:227], v[176:177], v[176:177] op_sel:[0,1,1] op_sel_hi:[1,1,1]
    v_pk_fma_f32 v[228:229], v[228:229], v[176:177], v[176:177] op_sel:[0,1,1] op_sel_hi:[1,1,1]
    v_rcp_f32 v226, v226
    v_rcp_f32 v227, v227
    v_rcp_f32 v228, v228
    v_rcp_f32 v229, v229
    v_pk_mul_f32 v[132:133], v[132:133], v[226:227]
    v_pk_mul_f32 v[134:135], v[134:135], v[228:229]
    v_cvt_pk_bf16_f32 v222, v132, v133
    v_cvt_pk_bf16_f32 v223, v134, v135
    s_add_u32 s36, s45, 688128
    buffer_store_dwordx4 v[116:119], v2, s[16:19], s36 offen sc1
    s_waitcnt lgkmcnt(0)
    s_mov_b32 s44, s46
    s_mov_b32 s45, s47
    s_branch G3_e2
G3_e1:
    v_pk_fma_f32 v[28:29], v[164:165], v[140:141], v[28:29] op_sel_hi:[0,1,1] neg_lo:[1,0,0] neg_hi:[1,0,0]
    v_pk_fma_f32 v[30:31], v[164:165], v[142:143], v[30:31] op_sel_hi:[0,1,1] neg_lo:[1,0,0] neg_hi:[1,0,0]
    v_pk_mul_f32 v[226:227], v[28:29], v[28:29]
    v_pk_mul_f32 v[228:229], v[30:31], v[30:31]
    v_pk_fma_f32 v[226:227], v[226:227], v[166:167], v[166:167] op_sel:[0,1,0] op_sel_hi:[1,1,0]
    v_pk_fma_f32 v[228:229], v[228:229], v[166:167], v[166:167] op_sel:[0,1,0] op_sel_hi:[1,1,0]
    v_pk_mul_f32 v[226:227], v[226:227], v[28:29]
    v_pk_mul_f32 v[228:229], v[228:229], v[30:31]
    v_exp_f32 v226, v226
    v_exp_f32 v227, v227
    v_exp_f32 v228, v228
    v_exp_f32 v229, v229
    v_pk_fma_f32 v[226:227], v[226:227], v[164:165], v[164:165] op_sel:[0,1,1] op_sel_hi:[1,1,1]
    v_pk_fma_f32 v[228:229], v[228:229], v[164:165], v[164:165] op_sel:[0,1,1] op_sel_hi:[1,1,1]
    v_rcp_f32 v226, v226
    v_rcp_f32 v227, v227
    v_rcp_f32 v228, v228
    v_rcp_f32 v229, v229
    v_pk_mul_f32 v[28:29], v[28:29], v[226:227]
    v_pk_mul_f32 v[30:31], v[30:31], v[228:229]
    v_pk_fma_f32 v[32:33], v[164:165], v[144:145], v[32:33] op_sel_hi:[0,1,1] neg_lo:[1,0,0] neg_hi:[1,0,0]
    v_pk_fma_f32 v[34:35], v[164:165], v[146:147], v[34:35] op_sel_hi:[0,1,1] neg_lo:[1,0,0] neg_hi:[1,0,0]
    v_pk_mul_f32 v[226:227], v[32:33], v[32:33]
    v_pk_mul_f32 v[228:229], v[34:35], v[34:35]
    v_pk_fma_f32 v[226:227], v[226:227], v[166:167], v[166:167] op_sel:[0,1,0] op_sel_hi:[1,1,0]
    v_pk_fma_f32 v[228:229], v[228:229], v[166:167], v[166:167] op_sel:[0,1,0] op_sel_hi:[1,1,0]
    v_pk_mul_f32 v[226:227], v[226:227], v[32:33]
    v_pk_mul_f32 v[228:229], v[228:229], v[34:35]
    v_exp_f32 v226, v226
    v_exp_f32 v227, v227
    v_exp_f32 v228, v228
    v_exp_f32 v229, v229
    v_pk_fma_f32 v[226:227], v[226:227], v[164:165], v[164:165] op_sel:[0,1,1] op_sel_hi:[1,1,1]
    v_pk_fma_f32 v[228:229], v[228:229], v[164:165], v[164:165] op_sel:[0,1,1] op_sel_hi:[1,1,1]
    v_rcp_f32 v226, v226
    v_rcp_f32 v227, v227
    v_rcp_f32 v228, v228
    v_rcp_f32 v229, v229
    v_pk_mul_f32 v[32:33], v[32:33], v[226:227]
    v_pk_mul_f32 v[34:35], v[34:35], v[228:229]
    v_cvt_pk_bf16_f32 v28, v28, v29
    v_cvt_pk_bf16_f32 v29, v30, v31
    v_cvt_pk_bf16_f32 v30, v32, v33
    v_cvt_pk_bf16_f32 v31, v34, v35
    v_or_b32 v28, 1, v28
    ds_write_b128 v244, v[28:31] offset:0
    s_add_u32 s36, s45, 0
    buffer_store_dwordx4 v[28:31], v2, s[16:19], s36 offen sc1
    v_pk_fma_f32 v[56:57], v[168:169], v[140:141], v[56:57] op_sel_hi:[0,1,1] neg_lo:[1,0,0] neg_hi:[1,0,0]
    v_pk_fma_f32 v[58:59], v[168:169], v[142:143], v[58:59] op_sel_hi:[0,1,1] neg_lo:[1,0,0] neg_hi:[1,0,0]
    v_pk_mul_f32 v[226:227], v[56:57], v[56:57]
    v_pk_mul_f32 v[228:229], v[58:59], v[58:59]
    v_pk_fma_f32 v[226:227], v[226:227], v[170:171], v[170:171] op_sel:[0,1,0] op_sel_hi:[1,1,0]
    v_pk_fma_f32 v[228:229], v[228:229], v[170:171], v[170:171] op_sel:[0,1,0] op_sel_hi:[1,1,0]
    v_pk_mul_f32 v[226:227], v[226:227], v[56:57]
    v_pk_mul_f32 v[228:229], v[228:229], v[58:59]
    v_exp_f32 v226, v226
    v_exp_f32 v227, v227
    v_exp_f32 v228, v228
    v_exp_f32 v229, v229
    v_pk_fma_f32 v[226:227], v[226:227], v[168:169], v[168:169] op_sel:[0,1,1] op_sel_hi:[1,1,1]
    v_pk_fma_f32 v[228:229], v[228:229], v[168:169], v[168:169] op_sel:[0,1,1] op_sel_hi:[1,1,1]
    v_rcp_f32 v226, v226
    v_rcp_f32 v227, v227
    v_rcp_f32 v228, v228
    v_rcp_f32 v229, v229
    v_pk_mul_f32 v[56:57], v[56:57], v[226:227]
    v_pk_mul_f32 v[58:59], v[58:59], v[228:229]
    v_pk_fma_f32 v[60:61], v[168:169], v[144:145], v[60:61] op_sel_hi:[0,1,1] neg_lo:[1,0,0] neg_hi:[1,0,0]
    v_pk_fma_f32 v[62:63], v[168:169], v[146:147], v[62:63] op_sel_hi:[0,1,1] neg_lo:[1,0,0] neg_hi:[1,0,0]
    v_pk_mul_f32 v[226:227], v[60:61], v[60:61]
    v_pk_mul_f32 v[228:229], v[62:63], v[62:63]
    v_pk_fma_f32 v[226:227], v[226:227], v[170:171], v[170:171] op_sel:[0,1,0] op_sel_hi:[1,1,0]
    v_pk_fma_f32 v[228:229], v[228:229], v[170:171], v[170:171] op_sel:[0,1,0] op_sel_hi:[1,1,0]
    v_pk_mul_f32 v[226:227], v[226:227], v[60:61]
    v_pk_mul_f32 v[228:229], v[228:229], v[62:63]
    v_exp_f32 v226, v226
    v_exp_f32 v227, v227
    v_exp_f32 v228, v228
    v_exp_f32 v229, v229
    v_pk_fma_f32 v[226:227], v[226:227], v[168:169], v[168:169] op_sel:[0,1,1] op_sel_hi:[1,1,1]
    v_pk_fma_f32 v[228:229], v[228:229], v[168:169], v[168:169] op_sel:[0,1,1] op_sel_hi:[1,1,1]
    v_rcp_f32 v226, v226
    v_rcp_f32 v227, v227
    v_rcp_f32 v228, v228
    v_rcp_f32 v229, v229
    v_pk_mul_f32 v[60:61], v[60:61], v[226:227]
    v_pk_mul_f32 v[62:63], v[62:63], v[228:229]
    v_cvt_pk_bf16_f32 v56, v56, v57
    v_cvt_pk_bf16_f32 v57, v58, v59
    v_cvt_pk_bf16_f32 v58, v60, v61
    v_cvt_pk_bf16_f32 v59, v62, v63
    v_or_b32 v56, 1, v56
    ds_write_b128 v244, v[56:59] offset:2048
    s_add_u32 s36, s45, 229376
    buffer_store_dwordx4 v[56:59], v2, s[16:19], s36 offen sc1
    v_pk_fma_f32 v[84:85], v[172:173], v[140:141], v[84:85] op_sel_hi:[0,1,1] neg_lo:[1,0,0] neg_hi:[1,0,0]
    v_pk_fma_f32 v[86:87], v[172:173], v[142:143], v[86:87] op_sel_hi:[0,1,1] neg_lo:[1,0,0] neg_hi:[1,0,0]
    v_pk_mul_f32 v[226:227], v[84:85], v[84:85]
    v_pk_mul_f32 v[228:229], v[86:87], v[86:87]
    v_pk_fma_f32 v[226:227], v[226:227], v[174:175], v[174:175] op_sel:[0,1,0] op_sel_hi:[1,1,0]
    v_pk_fma_f32 v[228:229], v[228:229], v[174:175], v[174:175] op_sel:[0,1,0] op_sel_hi:[1,1,0]
    v_pk_mul_f32 v[226:227], v[226:227], v[84:85]
    v_pk_mul_f32 v[228:229], v[228:229], v[86:87]
    v_exp_f32 v226, v226
    v_exp_f32 v227, v227
    v_exp_f32 v228, v228
    v_exp_f32 v229, v229
    v_pk_fma_f32 v[226:227], v[226:227], v[172:173], v[172:173] op_sel:[0,1,1] op_sel_hi:[1,1,1]
    v_pk_fma_f32 v[228:229], v[228:229], v[172:173], v[172:173] op_sel:[0,1,1] op_sel_hi:[1,1,1]
    v_rcp_f32 v226, v226
    v_rcp_f32 v227, v227
    v_rcp_f32 v228, v228
    v_rcp_f32 v229, v229
    v_pk_mul_f32 v[84:85], v[84:85], v[226:227]
    v_pk_mul_f32 v[86:87], v[86:87], v[228:229]
    v_pk_fma_f32 v[88:89], v[172:173], v[144:145], v[88:89] op_sel_hi:[0,1,1] neg_lo:[1,0,0] neg_hi:[1,0,0]
    v_pk_fma_f32 v[90:91], v[172:173], v[146:147], v[90:91] op_sel_hi:[0,1,1] neg_lo:[1,0,0] neg_hi:[1,0,0]
    v_pk_mul_f32 v[226:227], v[88:89], v[88:89]
    v_pk_mul_f32 v[228:229], v[90:91], v[90:91]
    v_pk_fma_f32 v[226:227], v[226:227], v[174:175], v[174:175] op_sel:[0,1,0] op_sel_hi:[1,1,0]
    v_pk_fma_f32 v[228:229], v[228:229], v[174:175], v[174:175] op_sel:[0,1,0] op_sel_hi:[1,1,0]
    v_pk_mul_f32 v[226:227], v[226:227], v[88:89]
    v_pk_mul_f32 v[228:229], v[228:229], v[90:91]
    v_exp_f32 v226, v226
    v_exp_f32 v227, v227
    v_exp_f32 v228, v228
    v_exp_f32 v229, v229
    v_pk_fma_f32 v[226:227], v[226:227], v[172:173], v[172:173] op_sel:[0,1,1] op_sel_hi:[1,1,1]
    v_pk_fma_f32 v[228:229], v[228:229], v[172:173], v[172:173] op_sel:[0,1,1] op_sel_hi:[1,1,1]
    v_rcp_f32 v226, v226
    v_rcp_f32 v227, v227
    v_rcp_f32 v228, v228
    v_rcp_f32 v229, v229
    v_pk_mul_f32 v[88:89], v[88:89], v[226:227]
    v_pk_mul_f32 v[90:91], v[90:91], v[228:229]
    v_cvt_pk_bf16_f32 v84, v84, v85
    v_cvt_pk_bf16_f32 v85, v86, v87
    v_cvt_pk_bf16_f32 v86, v88, v89
    v_cvt_pk_bf16_f32 v87, v90, v91
    v_or_b32 v84, 1, v84
    ds_write_b128 v244, v[84:87] offset:4096
    s_add_u32 s36, s45, 458752
    buffer_store_dwordx4 v[84:87], v2, s[16:19], s36 offen sc1
    v_pk_fma_f32 v[112:113], v[176:177], v[140:141], v[112:113] op_sel_hi:[0,1,1] neg_lo:[1,0,0] neg_hi:[1,0,0]
    v_pk_fma_f32 v[114:115], v[176:177], v[142:143], v[114:115] op_sel_hi:[0,1,1] neg_lo:[1,0,0] neg_hi:[1,0,0]
    v_pk_mul_f32 v[226:227], v[112:113], v[112:113]
    v_pk_mul_f32 v[228:229], v[114:115], v[114:115]
    v_pk_fma_f32 v[226:227], v[226:227], v[178:179], v[178:179] op_sel:[0,1,0] op_sel_hi:[1,1,0]
    v_pk_fma_f32 v[228:229], v[228:229], v[178:179], v[178:179] op_sel:[0,1,0] op_sel_hi:[1,1,0]
    v_pk_mul_f32 v[226:227], v[226:227], v[112:113]
    v_pk_mul_f32 v[228:229], v[228:229], v[114:115]
    v_exp_f32 v226, v226
    v_exp_f32 v227, v227
    v_exp_f32 v228, v228
    v_exp_f32 v229, v229
    v_pk_fma_f32 v[226:227], v[226:227], v[176:177], v[176:177] op_sel:[0,1,1] op_sel_hi:[1,1,1]
    v_pk_fma_f32 v[228:229], v[228:229], v[176:177], v[176:177] op_sel:[0,1,1] op_sel_hi:[1,1,1]
    v_rcp_f32 v226, v226
    v_rcp_f32 v227, v227
    v_rcp_f32 v228, v228
    v_rcp_f32 v229, v229
    v_pk_mul_f32 v[112:113], v[112:113], v[226:227]
    v_pk_mul_f32 v[114:115], v[114:115], v[228:229]
    v_pk_fma_f32 v[116:117], v[176:177], v[144:145], v[116:117] op_sel_hi:[0,1,1] neg_lo:[1,0,0] neg_hi:[1,0,0]
    v_pk_fma_f32 v[118:119], v[176:177], v[146:147], v[118:119] op_sel_hi:[0,1,1] neg_lo:[1,0,0] neg_hi:[1,0,0]
    v_pk_mul_f32 v[226:227], v[116:117], v[116:117]
    v_pk_mul_f32 v[228:229], v[118:119], v[118:119]
    v_pk_fma_f32 v[226:227], v[226:227], v[178:179], v[178:179] op_sel:[0,1,0] op_sel_hi:[1,1,0]
    v_pk_fma_f32 v[228:229], v[228:229], v[178:179], v[178:179] op_sel:[0,1,0] op_sel_hi:[1,1,0]
    v_pk_mul_f32 v[226:227], v[226:227], v[116:117]
    v_pk_mul_f32 v[228:229], v[228:229], v[118:119]
    v_exp_f32 v226, v226
    v_exp_f32 v227, v227
    v_exp_f32 v228, v228
    v_exp_f32 v229, v229
    v_pk_fma_f32 v[226:227], v[226:227], v[176:177], v[176:177] op_sel:[0,1,1] op_sel_hi:[1,1,1]
    v_pk_fma_f32 v[228:229], v[228:229], v[176:177], v[176:177] op_sel:[0,1,1] op_sel_hi:[1,1,1]
    v_rcp_f32 v226, v226
    v_rcp_f32 v227, v227
    v_rcp_f32 v228, v228
    v_rcp_f32 v229, v229
    v_pk_mul_f32 v[116:117], v[116:117], v[226:227]
    v_pk_mul_f32 v[118:119], v[118:119], v[228:229]
    v_cvt_pk_bf16_f32 v112, v112, v113
    v_cvt_pk_bf16_f32 v113, v114, v115
    v_cvt_pk_bf16_f32 v114, v116, v117
    v_cvt_pk_bf16_f32 v115, v118, v119
    ds_write_b128 v244, v[112:115] offset:6144
    s_add_u32 s36, s45, 688128
    buffer_store_dwordx4 v[112:115], v2, s[16:19], s36 offen sc1
    v_pk_fma_f32 v[36:37], v[164:165], v[148:149], v[36:37] op_sel_hi:[0,1,1] neg_lo:[1,0,0] neg_hi:[1,0,0]
    v_pk_fma_f32 v[38:39], v[164:165], v[150:151], v[38:39] op_sel_hi:[0,1,1] neg_lo:[1,0,0] neg_hi:[1,0,0]
    v_pk_mul_f32 v[226:227], v[36:37], v[36:37]
    v_pk_mul_f32 v[228:229], v[38:39], v[38:39]
    v_pk_fma_f32 v[226:227], v[226:227], v[166:167], v[166:167] op_sel:[0,1,0] op_sel_hi:[1,1,0]
    v_pk_fma_f32 v[228:229], v[228:229], v[166:167], v[166:167] op_sel:[0,1,0] op_sel_hi:[1,1,0]
    v_pk_mul_f32 v[226:227], v[226:227], v[36:37]
    v_pk_mul_f32 v[228:229], v[228:229], v[38:39]
    v_exp_f32 v226, v226
    v_exp_f32 v227, v227
    v_exp_f32 v228, v228
    v_exp_f32 v229, v229
    v_pk_fma_f32 v[226:227], v[226:227], v[164:165], v[164:165] op_sel:[0,1,1] op_sel_hi:[1,1,1]
    v_pk_fma_f32 v[228:229], v[228:229], v[164:165], v[164:165] op_sel:[0,1,1] op_sel_hi:[1,1,1]
    v_rcp_f32 v226, v226
    v_rcp_f32 v227, v227
    v_rcp_f32 v228, v228
    v_rcp_f32 v229, v229
    v_pk_mul_f32 v[36:37], v[36:37], v[226:227]
    v_pk_mul_f32 v[38:39], v[38:39], v[228:229]
    v_pk_fma_f32 v[40:41], v[164:165], v[152:153], v[40:41] op_sel_hi:[0,1,1] neg_lo:[1,0,0] neg_hi:[1,0,0]
    v_pk_fma_f32 v[42:43], v[164:165], v[154:155], v[42:43] op_sel_hi:[0,1,1] neg_lo:[1,0,0] neg_hi:[1,0,0]
    v_pk_mul_f32 v[226:227], v[40:41], v[40:41]
    v_pk_mul_f32 v[228:229], v[42:43], v[42:43]
    v_pk_fma_f32 v[226:227], v[226:227], v[166:167], v[166:167] op_sel:[0,1,0] op_sel_hi:[1,1,0]
    v_pk_fma_f32 v[228:229], v[228:229], v[166:167], v[166:167] op_sel:[0,1,0] op_sel_hi:[1,1,0]
    v_pk_mul_f32 v[226:227], v[226:227], v[40:41]
    v_pk_mul_f32 v[228:229], v[228:229], v[42:43]
    v_exp_f32 v226, v226
    v_exp_f32 v227, v227
    v_exp_f32 v228, v228
    v_exp_f32 v229, v229
    v_pk_fma_f32 v[226:227], v[226:227], v[164:165], v[164:165] op_sel:[0,1,1] op_sel_hi:[1,1,1]
    v_pk_fma_f32 v[228:229], v[228:229], v[164:165], v[164:165] op_sel:[0,1,1] op_sel_hi:[1,1,1]
    v_rcp_f32 v226, v226
    v_rcp_f32 v227, v227
    v_rcp_f32 v228, v228
    v_rcp_f32 v229, v229
    v_pk_mul_f32 v[40:41], v[40:41], v[226:227]
    v_pk_mul_f32 v[42:43], v[42:43], v[228:229]
    v_cvt_pk_bf16_f32 v36, v36, v37
    v_cvt_pk_bf16_f32 v37, v38, v39
    v_cvt_pk_bf16_f32 v38, v40, v41
    v_cvt_pk_bf16_f32 v39, v42, v43
    v_or_b32 v36, 1, v36
    ds_write_b128 v244, v[36:39] offset:16384
    v_pk_fma_f32 v[64:65], v[168:169], v[148:149], v[64:65] op_sel_hi:[0,1,1] neg_lo:[1,0,0] neg_hi:[1,0,0]
    v_pk_fma_f32 v[66:67], v[168:169], v[150:151], v[66:67] op_sel_hi:[0,1,1] neg_lo:[1,0,0] neg_hi:[1,0,0]
    v_pk_mul_f32 v[226:227], v[64:65], v[64:65]
    v_pk_mul_f32 v[228:229], v[66:67], v[66:67]
    v_pk_fma_f32 v[226:227], v[226:227], v[170:171], v[170:171] op_sel:[0,1,0] op_sel_hi:[1,1,0]
    v_pk_fma_f32 v[228:229], v[228:229], v[170:171], v[170:171] op_sel:[0,1,0] op_sel_hi:[1,1,0]
    v_pk_mul_f32 v[226:227], v[226:227], v[64:65]
    v_pk_mul_f32 v[228:229], v[228:229], v[66:67]
    v_exp_f32 v226, v226
    v_exp_f32 v227, v227
    v_exp_f32 v228, v228
    v_exp_f32 v229, v229
    v_pk_fma_f32 v[226:227], v[226:227], v[168:169], v[168:169] op_sel:[0,1,1] op_sel_hi:[1,1,1]
    v_pk_fma_f32 v[228:229], v[228:229], v[168:169], v[168:169] op_sel:[0,1,1] op_sel_hi:[1,1,1]
    v_rcp_f32 v226, v226
    v_rcp_f32 v227, v227
    v_rcp_f32 v228, v228
    v_rcp_f32 v229, v229
    v_pk_mul_f32 v[64:65], v[64:65], v[226:227]
    v_pk_mul_f32 v[66:67], v[66:67], v[228:229]
    v_pk_fma_f32 v[68:69], v[168:169], v[152:153], v[68:69] op_sel_hi:[0,1,1] neg_lo:[1,0,0] neg_hi:[1,0,0]
    v_pk_fma_f32 v[70:71], v[168:169], v[154:155], v[70:71] op_sel_hi:[0,1,1] neg_lo:[1,0,0] neg_hi:[1,0,0]
    v_pk_mul_f32 v[226:227], v[68:69], v[68:69]
    v_pk_mul_f32 v[228:229], v[70:71], v[70:71]
    v_pk_fma_f32 v[226:227], v[226:227], v[170:171], v[170:171] op_sel:[0,1,0] op_sel_hi:[1,1,0]
    v_pk_fma_f32 v[228:229], v[228:229], v[170:171], v[170:171] op_sel:[0,1,0] op_sel_hi:[1,1,0]
    v_pk_mul_f32 v[226:227], v[226:227], v[68:69]
    v_pk_mul_f32 v[228:229], v[228:229], v[70:71]
    v_exp_f32 v226, v226
    v_exp_f32 v227, v227
    v_exp_f32 v228, v228
    v_exp_f32 v229, v229
    v_pk_fma_f32 v[226:227], v[226:227], v[168:169], v[168:169] op_sel:[0,1,1] op_sel_hi:[1,1,1]
    v_pk_fma_f32 v[228:229], v[228:229], v[168:169], v[168:169] op_sel:[0,1,1] op_sel_hi:[1,1,1]
    v_rcp_f32 v226, v226
    v_rcp_f32 v227, v227
    v_rcp_f32 v228, v228
    v_rcp_f32 v229, v229
    v_pk_mul_f32 v[68:69], v[68:69], v[226:227]
    v_pk_mul_f32 v[70:71], v[70:71], v[228:229]
    v_cvt_pk_bf16_f32 v64, v64, v65
    v_cvt_pk_bf16_f32 v65, v66, v67
    v_cvt_pk_bf16_f32 v66, v68, v69
    v_cvt_pk_bf16_f32 v67, v70, v71
    v_or_b32 v64, 1, v64
    ds_write_b128 v244, v[64:67] offset:18432
    s_waitcnt vmcnt(0)
    s_mov_b64 exec, 1
    ds_add_u32 v246, v245
    s_mov_b64 exec, -1
    v_pk_fma_f32 v[92:93], v[172:173], v[148:149], v[92:93] op_sel_hi:[0,1,1] neg_lo:[1,0,0] neg_hi:[1,0,0]
    v_pk_fma_f32 v[94:95], v[172:173], v[150:151], v[94:95] op_sel_hi:[0,1,1] neg_lo:[1,0,0] neg_hi:[1,0,0]
    v_pk_mul_f32 v[226:227], v[92:93], v[92:93]
    v_pk_mul_f32 v[228:229], v[94:95], v[94:95]
    v_pk_fma_f32 v[226:227], v[226:227], v[174:175], v[174:175] op_sel:[0,1,0] op_sel_hi:[1,1,0]
    v_pk_fma_f32 v[228:229], v[228:229], v[174:175], v[174:175] op_sel:[0,1,0] op_sel_hi:[1,1,0]
    v_pk_mul_f32 v[226:227], v[226:227], v[92:93]
    v_pk_mul_f32 v[228:229], v[228:229], v[94:95]
    v_exp_f32 v226, v226
    v_exp_f32 v227, v227
    v_exp_f32 v228, v228
    v_exp_f32 v229, v229
    v_pk_fma_f32 v[226:227], v[226:227], v[172:173], v[172:173] op_sel:[0,1,1] op_sel_hi:[1,1,1]
    v_pk_fma_f32 v[228:229], v[228:229], v[172:173], v[172:173] op_sel:[0,1,1] op_sel_hi:[1,1,1]
    v_rcp_f32 v226, v226
    v_rcp_f32 v227, v227
    v_rcp_f32 v228, v228
    v_rcp_f32 v229, v229
    v_pk_mul_f32 v[92:93], v[92:93], v[226:227]
    v_pk_mul_f32 v[94:95], v[94:95], v[228:229]
    v_pk_fma_f32 v[96:97], v[172:173], v[152:153], v[96:97] op_sel_hi:[0,1,1] neg_lo:[1,0,0] neg_hi:[1,0,0]
    v_pk_fma_f32 v[98:99], v[172:173], v[154:155], v[98:99] op_sel_hi:[0,1,1] neg_lo:[1,0,0] neg_hi:[1,0,0]
    v_pk_mul_f32 v[226:227], v[96:97], v[96:97]
    v_pk_mul_f32 v[228:229], v[98:99], v[98:99]
    v_pk_fma_f32 v[226:227], v[226:227], v[174:175], v[174:175] op_sel:[0,1,0] op_sel_hi:[1,1,0]
    v_pk_fma_f32 v[228:229], v[228:229], v[174:175], v[174:175] op_sel:[0,1,0] op_sel_hi:[1,1,0]
    v_pk_mul_f32 v[226:227], v[226:227], v[96:97]
    v_pk_mul_f32 v[228:229], v[228:229], v[98:99]
    v_exp_f32 v226, v226
    v_exp_f32 v227, v227
    v_exp_f32 v228, v228
    v_exp_f32 v229, v229
    v_pk_fma_f32 v[226:227], v[226:227], v[172:173], v[172:173] op_sel:[0,1,1] op_sel_hi:[1,1,1]
    v_pk_fma_f32 v[228:229], v[228:229], v[172:173], v[172:173] op_sel:[0,1,1] op_sel_hi:[1,1,1]
    v_rcp_f32 v226, v226
    v_rcp_f32 v227, v227
    v_rcp_f32 v228, v228
    v_rcp_f32 v229, v229
    v_pk_mul_f32 v[96:97], v[96:97], v[226:227]
    v_pk_mul_f32 v[98:99], v[98:99], v[228:229]
    v_cvt_pk_bf16_f32 v92, v92, v93
    v_cvt_pk_bf16_f32 v93, v94, v95
    v_cvt_pk_bf16_f32 v94, v96, v97
    v_cvt_pk_bf16_f32 v95, v98, v99
    v_or_b32 v92, 1, v92
    ds_write_b128 v244, v[92:95] offset:20480
    s_cmp_eq_u32 s60, 1
    s_cbranch_scc1 G4_p11
    buffer_load_dwordx4 v[180:183], v196, s[84:87], 0 offen offset:0 sc1
    buffer_load_dwordx4 v[188:191], v196, s[88:91], 0 offen offset:0 sc1
    buffer_load_dwordx4 v[184:187], v196, s[84:87], 0 offen offset:2048 sc1
    buffer_load_dwordx4 v[192:195], v196, s[88:91], 0 offen offset:2048 sc1
    s_branch G4_p21
G4_p11:
    s_add_u32 s36, s40, 0
    buffer_load_dwordx4 v[180:183], v2, s[84:87], s36 offen offset:0 sc1
    buffer_load_dwordx4 v[184:187], v2, s[88:91], s36 offen offset:0 sc1
    buffer_load_dwordx4 v[188:191], v2, s[84:87], s36 offen offset:1024 sc1
    buffer_load_dwordx4 v[192:195], v2, s[88:91], s36 offen offset:1024 sc1
    s_add_u32 s36, s40, 65536
    buffer_load_dwordx4 v[196:199], v2, s[84:87], s36 offen offset:0 sc1
    buffer_load_dwordx4 v[230:233], v2, s[88:91], s36 offen offset:0 sc1
    buffer_load_dwordx4 v[234:237], v2, s[84:87], s36 offen offset:1024 sc1
    buffer_load_dwordx4 v[248:251], v2, s[88:91], s36 offen offset:1024 sc1
G4_p21:
    v_pk_fma_f32 v[120:121], v[176:177], v[148:149], v[120:121] op_sel_hi:[0,1,1] neg_lo:[1,0,0] neg_hi:[1,0,0]
    v_pk_fma_f32 v[122:123], v[176:177], v[150:151], v[122:123] op_sel_hi:[0,1,1] neg_lo:[1,0,0] neg_hi:[1,0,0]
    v_pk_mul_f32 v[226:227], v[120:121], v[120:121]
    v_pk_mul_f32 v[228:229], v[122:123], v[122:123]
    v_pk_fma_f32 v[226:227], v[226:227], v[178:179], v[178:179] op_sel:[0,1,0] op_sel_hi:[1,1,0]
    v_pk_fma_f32 v[228:229], v[228:229], v[178:179], v[178:179] op_sel:[0,1,0] op_sel_hi:[1,1,0]
    v_pk_mul_f32 v[226:227], v[226:227], v[120:121]
    v_pk_mul_f32 v[228:229], v[228:229], v[122:123]
    v_exp_f32 v226, v226
    v_exp_f32 v227, v227
    v_exp_f32 v228, v228
    v_exp_f32 v229, v229
    v_pk_fma_f32 v[226:227], v[226:227], v[176:177], v[176:177] op_sel:[0,1,1] op_sel_hi:[1,1,1]
    v_pk_fma_f32 v[228:229], v[228:229], v[176:177], v[176:177] op_sel:[0,1,1] op_sel_hi:[1,1,1]
    v_rcp_f32 v226, v226
    v_rcp_f32 v227, v227
    v_rcp_f32 v228, v228
    v_rcp_f32 v229, v229
    v_pk_mul_f32 v[120:121], v[120:121], v[226:227]
    v_pk_mul_f32 v[122:123], v[122:123], v[228:229]
    v_pk_fma_f32 v[124:125], v[176:177], v[152:153], v[124:125] op_sel_hi:[0,1,1] neg_lo:[1,0,0] neg_hi:[1,0,0]
    v_pk_fma_f32 v[126:127], v[176:177], v[154:155], v[126:127] op_sel_hi:[0,1,1] neg_lo:[1,0,0] neg_hi:[1,0,0]
    v_pk_mul_f32 v[226:227], v[124:125], v[124:125]
    v_pk_mul_f32 v[228:229], v[126:127], v[126:127]
    v_pk_fma_f32 v[226:227], v[226:227], v[178:179], v[178:179] op_sel:[0,1,0] op_sel_hi:[1,1,0]
    v_pk_fma_f32 v[228:229], v[228:229], v[178:179], v[178:179] op_sel:[0,1,0] op_sel_hi:[1,1,0]
    v_pk_mul_f32 v[226:227], v[226:227], v[124:125]
    v_pk_mul_f32 v[228:229], v[228:229], v[126:127]
    v_exp_f32 v226, v226
    v_exp_f32 v227, v227
    v_exp_f32 v228, v228
    v_exp_f32 v229, v229
    v_pk_fma_f32 v[226:227], v[226:227], v[176:177], v[176:177] op_sel:[0,1,1] op_sel_hi:[1,1,1]
    v_pk_fma_f32 v[228:229], v[228:229], v[176:177], v[176:177] op_sel:[0,1,1] op_sel_hi:[1,1,1]
    v_rcp_f32 v226, v226
    v_rcp_f32 v227, v227
    v_rcp_f32 v228, v228
    v_rcp_f32 v229, v229
    v_pk_mul_f32 v[124:125], v[124:125], v[226:227]
    v_pk_mul_f32 v[126:127], v[126:127], v[228:229]
    v_cvt_pk_bf16_f32 v120, v120, v121
    v_cvt_pk_bf16_f32 v121, v122, v123
    v_cvt_pk_bf16_f32 v122, v124, v125
    v_cvt_pk_bf16_f32 v123, v126, v127
    ds_write_b128 v244, v[120:123] offset:22528
    v_pk_fma_f32 v[44:45], v[164:165], v[156:157], v[44:45] op_sel_hi:[0,1,1] neg_lo:[1,0,0] neg_hi:[1,0,0]
    v_pk_fma_f32 v[46:47], v[164:165], v[158:159], v[46:47] op_sel_hi:[0,1,1] neg_lo:[1,0,0] neg_hi:[1,0,0]
    v_pk_mul_f32 v[226:227], v[44:45], v[44:45]
    v_pk_mul_f32 v[228:229], v[46:47], v[46:47]
    v_pk_fma_f32 v[226:227], v[226:227], v[166:167], v[166:167] op_sel:[0,1,0] op_sel_hi:[1,1,0]
    v_pk_fma_f32 v[228:229], v[228:229], v[166:167], v[166:167] op_sel:[0,1,0] op_sel_hi:[1,1,0]
    v_pk_mul_f32 v[226:227], v[226:227], v[44:45]
    v_pk_mul_f32 v[228:229], v[228:229], v[46:47]
    v_exp_f32 v226, v226
    v_exp_f32 v227, v227
    v_exp_f32 v228, v228
    v_exp_f32 v229, v229
    v_pk_fma_f32 v[226:227], v[226:227], v[164:165], v[164:165] op_sel:[0,1,1] op_sel_hi:[1,1,1]
    v_pk_fma_f32 v[228:229], v[228:229], v[164:165], v[164:165] op_sel:[0,1,1] op_sel_hi:[1,1,1]
    v_rcp_f32 v226, v226
    v_rcp_f32 v227, v227
    v_rcp_f32 v228, v228
    v_rcp_f32 v229, v229
    v_pk_mul_f32 v[44:45], v[44:45], v[226:227]
    v_pk_mul_f32 v[46:47], v[46:47], v[228:229]
    v_pk_fma_f32 v[48:49], v[164:165], v[160:161], v[48:49] op_sel_hi:[0,1,1] neg_lo:[1,0,0] neg_hi:[1,0,0]
    v_pk_fma_f32 v[50:51], v[164:165], v[162:163], v[50:51] op_sel_hi:[0,1,1] neg_lo:[1,0,0] neg_hi:[1,0,0]
    v_pk_mul_f32 v[226:227], v[48:49], v[48:49]
    v_pk_mul_f32 v[228:229], v[50:51], v[50:51]
    v_pk_fma_f32 v[226:227], v[226:227], v[166:167], v[166:167] op_sel:[0,1,0] op_sel_hi:[1,1,0]
    v_pk_fma_f32 v[228:229], v[228:229], v[166:167], v[166:167] op_sel:[0,1,0] op_sel_hi:[1,1,0]
    v_pk_mul_f32 v[226:227], v[226:227], v[48:49]
    v_pk_mul_f32 v[228:229], v[228:229], v[50:51]
    v_exp_f32 v226, v226
    v_exp_f32 v227, v227
    v_exp_f32 v228, v228
    v_exp_f32 v229, v229
    v_pk_fma_f32 v[226:227], v[226:227], v[164:165], v[164:165] op_sel:[0,1,1] op_sel_hi:[1,1,1]
    v_pk_fma_f32 v[228:229], v[228:229], v[164:165], v[164:165] op_sel:[0,1,1] op_sel_hi:[1,1,1]
    v_rcp_f32 v226, v226
    v_rcp_f32 v227, v227
    v_rcp_f32 v228, v228
    v_rcp_f32 v229, v229
    v_pk_mul_f32 v[48:49], v[48:49], v[226:227]
    v_pk_mul_f32 v[50:51], v[50:51], v[228:229]
    v_cvt_pk_bf16_f32 v200, v44, v45
    v_cvt_pk_bf16_f32 v201, v46, v47
    v_cvt_pk_bf16_f32 v202, v48, v49
    v_cvt_pk_bf16_f32 v203, v50, v51
    v_or_b32 v200, 1, v200
    ds_write_b128 v244, v[200:203] offset:32768
    v_pk_fma_f32 v[72:73], v[168:169], v[156:157], v[72:73] op_sel_hi:[0,1,1] neg_lo:[1,0,0] neg_hi:[1,0,0]
    v_pk_fma_f32 v[74:75], v[168:169], v[158:159], v[74:75] op_sel_hi:[0,1,1] neg_lo:[1,0,0] neg_hi:[1,0,0]
    v_pk_mul_f32 v[226:227], v[72:73], v[72:73]
    v_pk_mul_f32 v[228:229], v[74:75], v[74:75]
    v_pk_fma_f32 v[226:227], v[226:227], v[170:171], v[170:171] op_sel:[0,1,0] op_sel_hi:[1,1,0]
    v_pk_fma_f32 v[228:229], v[228:229], v[170:171], v[170:171] op_sel:[0,1,0] op_sel_hi:[1,1,0]
    v_pk_mul_f32 v[226:227], v[226:227], v[72:73]
    v_pk_mul_f32 v[228:229], v[228:229], v[74:75]
    v_exp_f32 v226, v226
    v_exp_f32 v227, v227
    v_exp_f32 v228, v228
    v_exp_f32 v229, v229
    v_pk_fma_f32 v[226:227], v[226:227], v[168:169], v[168:169] op_sel:[0,1,1] op_sel_hi:[1,1,1]
    v_pk_fma_f32 v[228:229], v[228:229], v[168:169], v[168:169] op_sel:[0,1,1] op_sel_hi:[1,1,1]
    v_rcp_f32 v226, v226
    v_rcp_f32 v227, v227
    v_rcp_f32 v228, v228
    v_rcp_f32 v229, v229
    v_pk_mul_f32 v[72:73], v[72:73], v[226:227]
    v_pk_mul_f32 v[74:75], v[74:75], v[228:229]
    v_pk_fma_f32 v[76:77], v[168:169], v[160:161], v[76:77] op_sel_hi:[0,1,1] neg_lo:[1,0,0] neg_hi:[1,0,0]
    v_pk_fma_f32 v[78:79], v[168:169], v[162:163], v[78:79] op_sel_hi:[0,1,1] neg_lo:[1,0,0] neg_hi:[1,0,0]
    v_pk_mul_f32 v[226:227], v[76:77], v[76:77]
    v_pk_mul_f32 v[228:229], v[78:79], v[78:79]
    v_pk_fma_f32 v[226:227], v[226:227], v[170:171], v[170:171] op_sel:[0,1,0] op_sel_hi:[1,1,0]
    v_pk_fma_f32 v[228:229], v[228:229], v[170:171], v[170:171] op_sel:[0,1,0] op_sel_hi:[1,1,0]
    v_pk_mul_f32 v[226:227], v[226:227], v[76:77]
    v_pk_mul_f32 v[228:229], v[228:229], v[78:79]
    v_exp_f32 v226, v226
    v_exp_f32 v227, v227
    v_exp_f32 v228, v228
    v_exp_f32 v229, v229
    v_pk_fma_f32 v[226:227], v[226:227], v[168:169], v[168:169] op_sel:[0,1,1] op_sel_hi:[1,1,1]
    v_pk_fma_f32 v[228:229], v[228:229], v[168:169], v[168:169] op_sel:[0,1,1] op_sel_hi:[1,1,1]
    v_rcp_f32 v226, v226
    v_rcp_f32 v227, v227
    v_rcp_f32 v228, v228
    v_rcp_f32 v229, v229
    v_pk_mul_f32 v[76:77], v[76:77], v[226:227]
    v_pk_mul_f32 v[78:79], v[78:79], v[228:229]
    v_cvt_pk_bf16_f32 v204, v72, v73
    v_cvt_pk_bf16_f32 v205, v74, v75
    v_cvt_pk_bf16_f32 v206, v76, v77
    v_cvt_pk_bf16_f32 v207, v78, v79
    v_or_b32 v204, 1, v204
    ds_write_b128 v244, v[204:207] offset:34816
    v_pk_fma_f32 v[100:101], v[172:173], v[156:157], v[100:101] op_sel_hi:[0,1,1] neg_lo:[1,0,0] neg_hi:[1,0,0]
    v_pk_fma_f32 v[102:103], v[172:173], v[158:159], v[102:103] op_sel_hi:[0,1,1] neg_lo:[1,0,0] neg_hi:[1,0,0]
    v_pk_mul_f32 v[226:227], v[100:101], v[100:101]
    v_pk_mul_f32 v[228:229], v[102:103], v[102:103]
    v_pk_fma_f32 v[226:227], v[226:227], v[174:175], v[174:175] op_sel:[0,1,0] op_sel_hi:[1,1,0]
    v_pk_fma_f32 v[228:229], v[228:229], v[174:175], v[174:175] op_sel:[0,1,0] op_sel_hi:[1,1,0]
    v_pk_mul_f32 v[226:227], v[226:227], v[100:101]
    v_pk_mul_f32 v[228:229], v[228:229], v[102:103]
    v_exp_f32 v226, v226
    v_exp_f32 v227, v227
    v_exp_f32 v228, v228
    v_exp_f32 v229, v229
    v_pk_fma_f32 v[226:227], v[226:227], v[172:173], v[172:173] op_sel:[0,1,1] op_sel_hi:[1,1,1]
    v_pk_fma_f32 v[228:229], v[228:229], v[172:173], v[172:173] op_sel:[0,1,1] op_sel_hi:[1,1,1]
    v_rcp_f32 v226, v226
    v_rcp_f32 v227, v227
    v_rcp_f32 v228, v228
    v_rcp_f32 v229, v229
    v_pk_mul_f32 v[100:101], v[100:101], v[226:227]
    v_pk_mul_f32 v[102:103], v[102:103], v[228:229]
    v_pk_fma_f32 v[104:105], v[172:173], v[160:161], v[104:105] op_sel_hi:[0,1,1] neg_lo:[1,0,0] neg_hi:[1,0,0]
    v_pk_fma_f32 v[106:107], v[172:173], v[162:163], v[106:107] op_sel_hi:[0,1,1] neg_lo:[1,0,0] neg_hi:[1,0,0]
    v_pk_mul_f32 v[226:227], v[104:105], v[104:105]
    v_pk_mul_f32 v[228:229], v[106:107], v[106:107]
    v_pk_fma_f32 v[226:227], v[226:227], v[174:175], v[174:175] op_sel:[0,1,0] op_sel_hi:[1,1,0]
    v_pk_fma_f32 v[228:229], v[228:229], v[174:175], v[174:175] op_sel:[0,1,0] op_sel_hi:[1,1,0]
    v_pk_mul_f32 v[226:227], v[226:227], v[104:105]
    v_pk_mul_f32 v[228:229], v[228:229], v[106:107]
    v_exp_f32 v226, v226
    v_exp_f32 v227, v227
    v_exp_f32 v228, v228
    v_exp_f32 v229, v229
    v_pk_fma_f32 v[226:227], v[226:227], v[172:173], v[172:173] op_sel:[0,1,1] op_sel_hi:[1,1,1]
    v_pk_fma_f32 v[228:229], v[228:229], v[172:173], v[172:173] op_sel:[0,1,1] op_sel_hi:[1,1,1]
    v_rcp_f32 v226, v226
    v_rcp_f32 v227, v227
    v_rcp_f32 v228, v228
    v_rcp_f32 v229, v229
    v_pk_mul_f32 v[104:105], v[104:105], v[226:227]
    v_pk_mul_f32 v[106:107], v[106:107], v[228:229]
    v_cvt_pk_bf16_f32 v208, v100, v101
    v_cvt_pk_bf16_f32 v209, v102, v103
    v_cvt_pk_bf16_f32 v210, v104, v105
    v_cvt_pk_bf16_f32 v211, v106, v107
    v_or_b32 v208, 1, v208
    ds_write_b128 v244, v[208:211] offset:36864
    v_pk_fma_f32 v[128:129], v[176:177], v[156:157], v[128:129] op_sel_hi:[0,1,1] neg_lo:[1,0,0] neg_hi:[1,0,0]
    v_pk_fma_f32 v[130:131], v[176:177], v[158:159], v[130:131] op_sel_hi:[0,1,1] neg_lo:[1,0,0] neg_hi:[1,0,0]
    v_pk_mul_f32 v[226:227], v[128:129], v[128:129]
    v_pk_mul_f32 v[228:229], v[130:131], v[130:131]
    v_pk_fma_f32 v[226:227], v[226:227], v[178:179], v[178:179] op_sel:[0,1,0] op_sel_hi:[1,1,0]
    v_pk_fma_f32 v[228:229], v[228:229], v[178:179], v[178:179] op_sel:[0,1,0] op_sel_hi:[1,1,0]
    v_pk_mul_f32 v[226:227], v[226:227], v[128:129]
    v_pk_mul_f32 v[228:229], v[228:229], v[130:131]
    v_exp_f32 v226, v226
    v_exp_f32 v227, v227
    v_exp_f32 v228, v228
    v_exp_f32 v229, v229
    v_pk_fma_f32 v[226:227], v[226:227], v[176:177], v[176:177] op_sel:[0,1,1] op_sel_hi:[1,1,1]
    v_pk_fma_f32 v[228:229], v[228:229], v[176:177], v[176:177] op_sel:[0,1,1] op_sel_hi:[1,1,1]
    v_rcp_f32 v226, v226
    v_rcp_f32 v227, v227
    v_rcp_f32 v228, v228
    v_rcp_f32 v229, v229
    v_pk_mul_f32 v[128:129], v[128:129], v[226:227]
    v_pk_mul_f32 v[130:131], v[130:131], v[228:229]
    v_pk_fma_f32 v[132:133], v[176:177], v[160:161], v[132:133] op_sel_hi:[0,1,1] neg_lo:[1,0,0] neg_hi:[1,0,0]
    v_pk_fma_f32 v[134:135], v[176:177], v[162:163], v[134:135] op_sel_hi:[0,1,1] neg_lo:[1,0,0] neg_hi:[1,0,0]
    v_pk_mul_f32 v[226:227], v[132:133], v[132:133]
    v_pk_mul_f32 v[228:229], v[134:135], v[134:135]
    v_pk_fma_f32 v[226:227], v[226:227], v[178:179], v[178:179] op_sel:[0,1,0] op_sel_hi:[1,1,0]
    v_pk_fma_f32 v[228:229], v[228:229], v[178:179], v[178:179] op_sel:[0,1,0] op_sel_hi:[1,1,0]
    v_pk_mul_f32 v[226:227], v[226:227], v[132:133]
    v_pk_mul_f32 v[228:229], v[228:229], v[134:135]
    v_exp_f32 v226, v226
    v_exp_f32 v227, v227
    v_exp_f32 v228, v228
    v_exp_f32 v229, v229
    v_pk_fma_f32 v[226:227], v[226:227], v[176:177], v[176:177] op_sel:[0,1,1] op_sel_hi:[1,1,1]
    v_pk_fma_f32 v[228:229], v[228:229], v[176:177], v[176:177] op_sel:[0,1,1] op_sel_hi:[1,1,1]
    v_rcp_f32 v226, v226
    v_rcp_f32 v227, v227
    v_rcp_f32 v228, v228
    v_rcp_f32 v229, v229
    v_pk_mul_f32 v[132:133], v[132:133], v[226:227]
    v_pk_mul_f32 v[134:135], v[134:135], v[228:229]
    v_cvt_pk_bf16_f32 v212, v128, v129
    v_cvt_pk_bf16_f32 v213, v130, v131
    v_cvt_pk_bf16_f32 v214, v132, v133
    v_cvt_pk_bf16_f32 v215, v134, v135
    ds_write_b128 v244, v[212:215] offset:38912
    v_pk_fma_f32 v[24:25], v[164:165], v[136:137], v[24:25] op_sel_hi:[0,1,1] neg_lo:[1,0,0] neg_hi:[1,0,0]
    v_pk_fma_f32 v[26:27], v[164:165], v[138:139], v[26:27] op_sel_hi:[0,1,1] neg_lo:[1,0,0] neg_hi:[1,0,0]
    v_pk_mul_f32 v[226:227], v[24:25], v[24:25]
    v_pk_mul_f32 v[228:229], v[26:27], v[26:27]
    v_pk_fma_f32 v[226:227], v[226:227], v[166:167], v[166:167] op_sel:[0,1,0] op_sel_hi:[1,1,0]
    v_pk_fma_f32 v[228:229], v[228:229], v[166:167], v[166:167] op_sel:[0,1,0] op_sel_hi:[1,1,0]
    v_pk_mul_f32 v[226:227], v[226:227], v[24:25]
    v_pk_mul_f32 v[228:229], v[228:229], v[26:27]
    v_exp_f32 v226, v226
    v_exp_f32 v227, v227
    v_exp_f32 v228, v228
    v_exp_f32 v229, v229
    v_pk_fma_f32 v[226:227], v[226:227], v[164:165], v[164:165] op_sel:[0,1,1] op_sel_hi:[1,1,1]
    v_pk_fma_f32 v[228:229], v[228:229], v[164:165], v[164:165] op_sel:[0,1,1] op_sel_hi:[1,1,1]
    v_rcp_f32 v226, v226
    v_rcp_f32 v227, v227
    v_rcp_f32 v228, v228
    v_rcp_f32 v229, v229
    v_pk_mul_f32 v[24:25], v[24:25], v[226:227]
    v_pk_mul_f32 v[26:27], v[26:27], v[228:229]
    v_cvt_pk_bf16_f32 v216, v24, v25
    v_cvt_pk_bf16_f32 v217, v26, v27
    v_or_b32 v216, 1, v216
    s_add_u32 s36, s46, 0
    buffer_store_dwordx4 v[36:39], v2, s[16:19], s36 offen sc1
    v_pk_fma_f32 v[52:53], v[168:169], v[136:137], v[52:53] op_sel_hi:[0,1,1] neg_lo:[1,0,0] neg_hi:[1,0,0]
    v_pk_fma_f32 v[54:55], v[168:169], v[138:139], v[54:55] op_sel_hi:[0,1,1] neg_lo:[1,0,0] neg_hi:[1,0,0]
    v_pk_mul_f32 v[226:227], v[52:53], v[52:53]
    v_pk_mul_f32 v[228:229], v[54:55], v[54:55]
    v_pk_fma_f32 v[226:227], v[226:227], v[170:171], v[170:171] op_sel:[0,1,0] op_sel_hi:[1,1,0]
    v_pk_fma_f32 v[228:229], v[228:229], v[170:171], v[170:171] op_sel:[0,1,0] op_sel_hi:[1,1,0]
    v_pk_mul_f32 v[226:227], v[226:227], v[52:53]
    v_pk_mul_f32 v[228:229], v[228:229], v[54:55]
    v_exp_f32 v226, v226
    v_exp_f32 v227, v227
    v_exp_f32 v228, v228
    v_exp_f32 v229, v229
    v_pk_fma_f32 v[226:227], v[226:227], v[168:169], v[168:169] op_sel:[0,1,1] op_sel_hi:[1,1,1]
    v_pk_fma_f32 v[228:229], v[228:229], v[168:169], v[168:169] op_sel:[0,1,1] op_sel_hi:[1,1,1]
    v_rcp_f32 v226, v226
    v_rcp_f32 v227, v227
    v_rcp_f32 v228, v228
    v_rcp_f32 v229, v229
    v_pk_mul_f32 v[52:53], v[52:53], v[226:227]
    v_pk_mul_f32 v[54:55], v[54:55], v[228:229]
    v_cvt_pk_bf16_f32 v218, v52, v53
    v_cvt_pk_bf16_f32 v219, v54, v55
    v_or_b32 v218, 1, v218
    s_add_u32 s36, s46, 229376
    buffer_store_dwordx4 v[64:67], v2, s[16:19], s36 offen sc1
    v_pk_fma_f32 v[80:81], v[172:173], v[136:137], v[80:81] op_sel_hi:[0,1,1] neg_lo:[1,0,0] neg_hi:[1,0,0]
    v_pk_fma_f32 v[82:83], v[172:173], v[138:139], v[82:83] op_sel_hi:[0,1,1] neg_lo:[1,0,0] neg_hi:[1,0,0]
    v_pk_mul_f32 v[226:227], v[80:81], v[80:81]
    v_pk_mul_f32 v[228:229], v[82:83], v[82:83]
    v_pk_fma_f32 v[226:227], v[226:227], v[174:175], v[174:175] op_sel:[0,1,0] op_sel_hi:[1,1,0]
    v_pk_fma_f32 v[228:229], v[228:229], v[174:175], v[174:175] op_sel:[0,1,0] op_sel_hi:[1,1,0]
    v_pk_mul_f32 v[226:227], v[226:227], v[80:81]
    v_pk_mul_f32 v[228:229], v[228:229], v[82:83]
    v_exp_f32 v226, v226
    v_exp_f32 v227, v227
    v_exp_f32 v228, v228
    v_exp_f32 v229, v229
    v_pk_fma_f32 v[226:227], v[226:227], v[172:173], v[172:173] op_sel:[0,1,1] op_sel_hi:[1,1,1]
    v_pk_fma_f32 v[228:229], v[228:229], v[172:173], v[172:173] op_sel:[0,1,1] op_sel_hi:[1,1,1]
    v_rcp_f32 v226, v226
    v_rcp_f32 v227, v227
    v_rcp_f32 v228, v228
    v_rcp_f32 v229, v229
    v_pk_mul_f32 v[80:81], v[80:81], v[226:227]
    v_pk_mul_f32 v[82:83], v[82:83], v[228:229]
    v_cvt_pk_bf16_f32 v220, v80, v81
    v_cvt_pk_bf16_f32 v221, v82, v83
    v_or_b32 v220, 1, v220
    s_add_u32 s36, s46, 458752
    buffer_store_dwordx4 v[92:95], v2, s[16:19], s36 offen sc1
    v_pk_fma_f32 v[108:109], v[176:177], v[136:137], v[108:109] op_sel_hi:[0,1,1] neg_lo:[1,0,0] neg_hi:[1,0,0]
    v_pk_fma_f32 v[110:111], v[176:177], v[138:139], v[110:111] op_sel_hi:[0,1,1] neg_lo:[1,0,0] neg_hi:[1,0,0]
    v_pk_mul_f32 v[226:227], v[108:109], v[108:109]
    v_pk_mul_f32 v[228:229], v[110:111], v[110:111]
    v_pk_fma_f32 v[226:227], v[226:227], v[178:179], v[178:179] op_sel:[0,1,0] op_sel_hi:[1,1,0]
    v_pk_fma_f32 v[228:229], v[228:229], v[178:179], v[178:179] op_sel:[0,1,0] op_sel_hi:[1,1,0]
    v_pk_mul_f32 v[226:227], v[226:227], v[108:109]
    v_pk_mul_f32 v[228:229], v[228:229], v[110:111]
    v_exp_f32 v226, v226
    v_exp_f32 v227, v227
    v_exp_f32 v228, v228
    v_exp_f32 v229, v229
    v_pk_fma_f32 v[226:227], v[226:227], v[176:177], v[176:177] op_sel:[0,1,1] op_sel_hi:[1,1,1]
    v_pk_fma_f32 v[228:229], v[228:229], v[176:177], v[176:177] op_sel:[0,1,1] op_sel_hi:[1,1,1]
    v_rcp_f32 v226, v226
    v_rcp_f32 v227, v227
    v_rcp_f32 v228, v228
    v_rcp_f32 v229, v229
    v_pk_mul_f32 v[108:109], v[108:109], v[226:227]
    v_pk_mul_f32 v[110:111], v[110:111], v[228:229]
    v_cvt_pk_bf16_f32 v222, v108, v109
    v_cvt_pk_bf16_f32 v223, v110, v111
    s_add_u32 s36, s46, 688128
    buffer_store_dwordx4 v[120:123], v2, s[16:19], s36 offen sc1
    s_waitcnt lgkmcnt(0)
    s_add_u32 s45, s44, 512
    s_mov_b32 s44, s47
G3_e2:
    s_waitcnt lgkmcnt(0)
    s_barrier
    ds_read_b128 v[88:91], v17 offset:0
    ds_read_b128 v[92:95], v17 offset:2048
    ds_read_b128 v[96:99], v17 offset:4096
    ds_read_b128 v[100:103], v17 offset:6144
    ds_read_b64_tr_b16 v[104:105], v18 offset:0
    ds_read_b64_tr_b16 v[106:107], v18 offset:4096
    ds_read_b64_tr_b16 v[108:109], v19 offset:0
    ds_read_b64_tr_b16 v[110:111], v19 offset:4096
    ds_read_b64_tr_b16 v[112:113], v20 offset:0
    ds_read_b64_tr_b16 v[114:115], v20 offset:4096
    ds_read_b64_tr_b16 v[116:117], v21 offset:0
    ds_read_b64_tr_b16 v[118:119], v21 offset:4096
    s_waitcnt lgkmcnt(6)
    v_mfma_f32_16x16x32_bf16 v[24:27], v[104:107], v[88:91], 0
    ds_read_b128 v[120:123], v17 offset:1024
    s_add_u32 s42, s42, 16384
    v_mfma_f32_16x16x32_bf16 v[40:43], v[104:107], v[92:95], 0
    ds_read_b128 v[124:127], v17 offset:3072
    s_cmp_eq_u32 s42, 49152
    v_mfma_f32_16x16x32_bf16 v[56:59], v[104:107], v[96:99], 0
    ds_read_b128 v[128:131], v17 offset:5120
    s_cselect_b32 s42, 0, s42
    v_mfma_f32_16x16x32_bf16 v[72:75], v[104:107], v[100:103], 0
    ds_read_b128 v[132:135], v17 offset:7168
    s_waitcnt lgkmcnt(8)
    v_mfma_f32_16x16x32_bf16 v[76:79], v[108:111], v[100:103], 0
    ds_read_b64_tr_b16 v[136:137], v18 offset:8192
    s_add_u32 s48, s48, 16384
    v_mfma_f32_16x16x32_bf16 v[60:63], v[108:111], v[96:99], 0
    ds_read_b64_tr_b16 v[138:139], v18 offset:12288
    s_cmp_eq_u32 s48, 98304
    v_mfma_f32_16x16x32_bf16 v[44:47], v[108:111], v[92:95], 0
    ds_read_b64_tr_b16 v[140:141], v19 offset:8192
    s_cselect_b32 s48, 0, s48
    v_mfma_f32_16x16x32_bf16 v[28:31], v[108:111], v[88:91], 0
    ds_read_b64_tr_b16 v[142:143], v19 offset:12288
    s_waitcnt lgkmcnt(8)
    v_mfma_f32_16x16x32_bf16 v[32:35], v[112:115], v[88:91], 0
    ds_read_b64_tr_b16 v[144:145], v20 offset:8192
    v_add_u32 v17, s42, v12
    v_mfma_f32_16x16x32_bf16 v[48:51], v[112:115], v[92:95], 0
    ds_read_b64_tr_b16 v[146:147], v20 offset:12288
    s_add_u32 s36, s44, 0
    v_mfma_f32_16x16x32_bf16 v[64:67], v[112:115], v[96:99], 0
    ds_read_b64_tr_b16 v[148:149], v21 offset:8192
    buffer_store_dwordx4 v[200:203], v2, s[16:19], s36 offen sc1
    v_mfma_f32_16x16x32_bf16 v[80:83], v[112:115], v[100:103], 0
    ds_read_b64_tr_b16 v[150:151], v21 offset:12288
    s_add_u32 s36, s45, 0
    v_mfma_f32_16x16x32_bf16 v[84:87], v[116:119], v[100:103], 0
    buffer_store_dwordx2 v[216:217], v238, s[16:19], s36 offen sc1
    v_add_u32 v18, s48, v13
    v_mfma_f32_16x16x32_bf16 v[68:71], v[116:119], v[96:99], 0
    v_add_u32 v19, s48, v14
    v_mfma_f32_16x16x32_bf16 v[52:55], v[116:119], v[92:95], 0
    v_add_u32 v20, s48, v15
    v_mfma_f32_16x16x32_bf16 v[36:39], v[116:119], v[88:91], 0
    v_add_u32 v21, s48, v16
    s_waitcnt lgkmcnt(6)
    v_mfma_f32_16x16x32_bf16 v[24:27], v[136:139], v[120:123], v[24:27]
    v_mfma_f32_16x16x32_bf16 v[40:43], v[136:139], v[124:127], v[40:43]
    v_mfma_f32_16x16x32_bf16 v[56:59], v[136:139], v[128:131], v[56:59]
    s_waitcnt lgkmcnt(0)
    s_barrier
    v_mfma_f32_16x16x32_bf16 v[72:75], v[136:139], v[132:135], v[72:75]
    ds_read_b128 v[88:91], v17 offset:0
    s_add_u32 s36, s44, 229376
    v_mfma_f32_16x16x32_bf16 v[76:79], v[140:143], v[132:135], v[76:79]
    ds_read_b128 v[92:95], v17 offset:2048
    buffer_store_dwordx4 v[204:207], v2, s[16:19], s36 offen sc1
    v_mfma_f32_16x16x32_bf16 v[60:63], v[140:143], v[128:131], v[60:63]
    ds_read_b128 v[96:99], v17 offset:4096
    s_add_u32 s36, s45, 229376
    v_mfma_f32_16x16x32_bf16 v[44:47], v[140:143], v[124:127], v[44:47]
    ds_read_b128 v[100:103], v17 offset:6144
    buffer_store_dwordx2 v[218:219], v238, s[16:19], s36 offen sc1
    v_mfma_f32_16x16x32_bf16 v[28:31], v[140:143], v[120:123], v[28:31]
    ds_read_b64_tr_b16 v[104:105], v18 offset:0
    s_add_u32 s43, s43, 1
    v_mfma_f32_16x16x32_bf16 v[32:35], v[144:147], v[120:123], v[32:35]
    ds_read_b64_tr_b16 v[106:107], v18 offset:4096
    s_cmp_lt_u32 s43, 27
    v_mfma_f32_16x16x32_bf16 v[48:51], v[144:147], v[124:127], v[48:51]
    ds_read_b64_tr_b16 v[108:109], v19 offset:0
    v_mfma_f32_16x16x32_bf16 v[64:67], v[144:147], v[128:131], v[64:67]
    ds_read_b64_tr_b16 v[110:111], v19 offset:4096
    v_mfma_f32_16x16x32_bf16 v[80:83], v[144:147], v[132:135], v[80:83]
    ds_read_b64_tr_b16 v[112:113], v20 offset:0
    v_mfma_f32_16x16x32_bf16 v[84:87], v[148:151], v[132:135], v[84:87]
    ds_read_b64_tr_b16 v[114:115], v20 offset:4096
    v_mfma_f32_16x16x32_bf16 v[68:71], v[148:151], v[128:131], v[68:71]
    ds_read_b64_tr_b16 v[116:117], v21 offset:0
    v_mfma_f32_16x16x32_bf16 v[52:55], v[148:151], v[124:127], v[52:55]
    ds_read_b64_tr_b16 v[118:119], v21 offset:4096
    v_mfma_f32_16x16x32_bf16 v[36:39], v[148:151], v[120:123], v[36:39]
    s_waitcnt lgkmcnt(6)
    v_mfma_f32_16x16x32_bf16 v[24:27], v[104:107], v[88:91], v[24:27]
    ds_read_b128 v[120:123], v17 offset:1024
    s_add_u32 s42, s42, 16384
    v_mfma_f32_16x16x32_bf16 v[40:43], v[104:107], v[92:95], v[40:43]
    ds_read_b128 v[124:127], v17 offset:3072
    s_cmp_eq_u32 s42, 49152
    v_mfma_f32_16x16x32_bf16 v[56:59], v[104:107], v[96:99], v[56:59]
    ds_read_b128 v[128:131], v17 offset:5120
    s_cselect_b32 s42, 0, s42
    v_mfma_f32_16x16x32_bf16 v[72:75], v[104:107], v[100:103], v[72:75]
    ds_read_b128 v[132:135], v17 offset:7168
    s_waitcnt lgkmcnt(8)
    v_mfma_f32_16x16x32_bf16 v[76:79], v[108:111], v[100:103], v[76:79]
    ds_read_b64_tr_b16 v[136:137], v18 offset:8192
    s_add_u32 s48, s48, 16384
    v_mfma_f32_16x16x32_bf16 v[60:63], v[108:111], v[96:99], v[60:63]
    ds_read_b64_tr_b16 v[138:139], v18 offset:12288
    s_cmp_eq_u32 s48, 98304
    v_mfma_f32_16x16x32_bf16 v[44:47], v[108:111], v[92:95], v[44:47]
    ds_read_b64_tr_b16 v[140:141], v19 offset:8192
    s_cselect_b32 s48, 0, s48
    v_mfma_f32_16x16x32_bf16 v[28:31], v[108:111], v[88:91], v[28:31]
    ds_read_b64_tr_b16 v[142:143], v19 offset:12288
    s_waitcnt lgkmcnt(8)
    v_mfma_f32_16x16x32_bf16 v[32:35], v[112:115], v[88:91], v[32:35]
    ds_read_b64_tr_b16 v[144:145], v20 offset:8192
    v_add_u32 v17, s42, v12
    v_mfma_f32_16x16x32_bf16 v[48:51], v[112:115], v[92:95], v[48:51]
    ds_read_b64_tr_b16 v[146:147], v20 offset:12288
    s_add_u32 s36, s44, 458752
    v_mfma_f32_16x16x32_bf16 v[64:67], v[112:115], v[96:99], v[64:67]
    ds_read_b64_tr_b16 v[148:149], v21 offset:8192
    buffer_store_dwordx4 v[208:211], v2, s[16:19], s36 offen sc1
    v_mfma_f32_16x16x32_bf16 v[80:83], v[112:115], v[100:103], v[80:83]
    ds_read_b64_tr_b16 v[150:151], v21 offset:12288
    s_add_u32 s36, s45, 458752
    v_mfma_f32_16x16x32_bf16 v[84:87], v[116:119], v[100:103], v[84:87]
    buffer_store_dwordx2 v[220:221], v238, s[16:19], s36 offen sc1
    v_add_u32 v18, s48, v13
    v_mfma_f32_16x16x32_bf16 v[68:71], v[116:119], v[96:99], v[68:71]
    v_add_u32 v19, s48, v14
    v_mfma_f32_16x16x32_bf16 v[52:55], v[116:119], v[92:95], v[52:55]
    v_add_u32 v20, s48, v15
    v_mfma_f32_16x16x32_bf16 v[36:39], v[116:119], v[88:91], v[36:39]
    v_add_u32 v21, s48, v16
    s_waitcnt lgkmcnt(6)
    v_mfma_f32_16x16x32_bf16 v[24:27], v[136:139], v[120:123], v[24:27]
    v_mfma_f32_16x16x32_bf16 v[40:43], v[136:139], v[124:127], v[40:43]
    s_waitcnt vmcnt(6)
    v_mfma_f32_16x16x32_bf16 v[56:59], v[136:139], v[128:131], v[56:59]
    s_waitcnt lgkmcnt(0)
    s_barrier
    v_mfma_f32_16x16x32_bf16 v[72:75], v[136:139], v[132:135], v[72:75]
    ds_read_b128 v[88:91], v17 offset:0
    s_add_u32 s36, s44, 688128
    v_mfma_f32_16x16x32_bf16 v[76:79], v[140:143], v[132:135], v[76:79]
    ds_read_b128 v[92:95], v17 offset:2048
    buffer_store_dwordx4 v[212:215], v2, s[16:19], s36 offen sc1
    v_mfma_f32_16x16x32_bf16 v[60:63], v[140:143], v[128:131], v[60:63]
    ds_read_b128 v[96:99], v17 offset:4096
    s_add_u32 s36, s45, 688128
    v_mfma_f32_16x16x32_bf16 v[44:47], v[140:143], v[124:127], v[44:47]
    ds_read_b128 v[100:103], v17 offset:6144
    buffer_store_dwordx2 v[222:223], v238, s[16:19], s36 offen sc1
    v_mfma_f32_16x16x32_bf16 v[28:31], v[140:143], v[120:123], v[28:31]
    ds_read_b64_tr_b16 v[104:105], v18 offset:0
    s_add_u32 s43, s43, 1
    v_mfma_f32_16x16x32_bf16 v[32:35], v[144:147], v[120:123], v[32:35]
    ds_read_b64_tr_b16 v[106:107], v18 offset:4096
    s_cmp_lt_u32 s43, 27
    v_mfma_f32_16x16x32_bf16 v[48:51], v[144:147], v[124:127], v[48:51]
    ds_read_b64_tr_b16 v[108:109], v19 offset:0
    v_mfma_f32_16x16x32_bf16 v[64:67], v[144:147], v[128:131], v[64:67]
    ds_read_b64_tr_b16 v[110:111], v19 offset:4096
    v_mfma_f32_16x16x32_bf16 v[80:83], v[144:147], v[132:135], v[80:83]
    ds_read_b64_tr_b16 v[112:113], v20 offset:0
    v_mfma_f32_16x16x32_bf16 v[84:87], v[148:151], v[132:135], v[84:87]
    ds_read_b64_tr_b16 v[114:115], v20 offset:4096
    v_mfma_f32_16x16x32_bf16 v[68:71], v[148:151], v[128:131], v[68:71]
    ds_read_b64_tr_b16 v[116:117], v21 offset:0
    v_mfma_f32_16x16x32_bf16 v[52:55], v[148:151], v[124:127], v[52:55]
    ds_read_b64_tr_b16 v[118:119], v21 offset:4096
    v_mfma_f32_16x16x32_bf16 v[36:39], v[148:151], v[120:123], v[36:39]
    s_waitcnt lgkmcnt(6)
mm_23:
    v_mfma_f32_16x16x32_bf16 v[24:27], v[104:107], v[88:91], v[24:27]
    ds_read_b128 v[120:123], v17 offset:1024
    s_add_u32 s42, s42, 16384
    v_mfma_f32_16x16x32_bf16 v[40:43], v[104:107], v[92:95], v[40:43]
    ds_read_b128 v[124:127], v17 offset:3072
    s_cmp_eq_u32 s42, 49152
    v_mfma_f32_16x16x32_bf16 v[56:59], v[104:107], v[96:99], v[56:59]
    ds_read_b128 v[128:131], v17 offset:5120
    s_cselect_b32 s42, 0, s42
    v_mfma_f32_16x16x32_bf16 v[72:75], v[104:107], v[100:103], v[72:75]
    ds_read_b128 v[132:135], v17 offset:7168
    s_waitcnt lgkmcnt(8)
    v_mfma_f32_16x16x32_bf16 v[76:79], v[108:111], v[100:103], v[76:79]
    ds_read_b64_tr_b16 v[136:137], v18 offset:8192
    s_add_u32 s48, s48, 16384
    v_mfma_f32_16x16x32_bf16 v[60:63], v[108:111], v[96:99], v[60:63]
    ds_read_b64_tr_b16 v[138:139], v18 offset:12288
    s_cmp_eq_u32 s48, 98304
    v_mfma_f32_16x16x32_bf16 v[44:47], v[108:111], v[92:95], v[44:47]
    ds_read_b64_tr_b16 v[140:141], v19 offset:8192
    s_cselect_b32 s48, 0, s48
    v_mfma_f32_16x16x32_bf16 v[28:31], v[108:111], v[88:91], v[28:31]
    ds_read_b64_tr_b16 v[142:143], v19 offset:12288
    s_waitcnt lgkmcnt(8)
    v_mfma_f32_16x16x32_bf16 v[32:35], v[112:115], v[88:91], v[32:35]
    ds_read_b64_tr_b16 v[144:145], v20 offset:8192
    v_add_u32 v17, s42, v12
    v_mfma_f32_16x16x32_bf16 v[48:51], v[112:115], v[92:95], v[48:51]
    ds_read_b64_tr_b16 v[146:147], v20 offset:12288
    v_add_u32 v18, s48, v13
    v_mfma_f32_16x16x32_bf16 v[64:67], v[112:115], v[96:99], v[64:67]
    ds_read_b64_tr_b16 v[148:149], v21 offset:8192
    v_add_u32 v19, s48, v14
    v_mfma_f32_16x16x32_bf16 v[80:83], v[112:115], v[100:103], v[80:83]
    ds_read_b64_tr_b16 v[150:151], v21 offset:12288
    v_add_u32 v20, s48, v15
    v_mfma_f32_16x16x32_bf16 v[84:87], v[116:119], v[100:103], v[84:87]
    v_add_u32 v21, s48, v16
    v_mfma_f32_16x16x32_bf16 v[68:71], v[116:119], v[96:99], v[68:71]
    v_mfma_f32_16x16x32_bf16 v[52:55], v[116:119], v[92:95], v[52:55]
    v_mfma_f32_16x16x32_bf16 v[36:39], v[116:119], v[88:91], v[36:39]
    s_waitcnt lgkmcnt(6)
    v_mfma_f32_16x16x32_bf16 v[24:27], v[136:139], v[120:123], v[24:27]
    s_add_u32 s43, s43, 1
    s_cmp_lt_u32 s43, 4
    v_mfma_f32_16x16x32_bf16 v[40:43], v[136:139], v[124:127], v[40:43]
    v_mfma_f32_16x16x32_bf16 v[56:59], v[136:139], v[128:131], v[56:59]
    s_waitcnt lgkmcnt(0)
    s_barrier
    v_mfma_f32_16x16x32_bf16 v[72:75], v[136:139], v[132:135], v[72:75]
    ds_read_b128 v[88:91], v17 offset:0
    v_mfma_f32_16x16x32_bf16 v[76:79], v[140:143], v[132:135], v[76:79]
    ds_read_b128 v[92:95], v17 offset:2048
    v_mfma_f32_16x16x32_bf16 v[60:63], v[140:143], v[128:131], v[60:63]
    ds_read_b128 v[96:99], v17 offset:4096
    v_mfma_f32_16x16x32_bf16 v[44:47], v[140:143], v[124:127], v[44:47]
    ds_read_b128 v[100:103], v17 offset:6144
    v_mfma_f32_16x16x32_bf16 v[28:31], v[140:143], v[120:123], v[28:31]
    ds_read_b64_tr_b16 v[104:105], v18 offset:0
    v_mfma_f32_16x16x32_bf16 v[32:35], v[144:147], v[120:123], v[32:35]
    ds_read_b64_tr_b16 v[106:107], v18 offset:4096
    v_mfma_f32_16x16x32_bf16 v[48:51], v[144:147], v[124:127], v[48:51]
    ds_read_b64_tr_b16 v[108:109], v19 offset:0
    v_mfma_f32_16x16x32_bf16 v[64:67], v[144:147], v[128:131], v[64:67]
    ds_read_b64_tr_b16 v[110:111], v19 offset:4096
    v_mfma_f32_16x16x32_bf16 v[80:83], v[144:147], v[132:135], v[80:83]
    ds_read_b64_tr_b16 v[112:113], v20 offset:0
    v_mfma_f32_16x16x32_bf16 v[84:87], v[148:151], v[132:135], v[84:87]
    ds_read_b64_tr_b16 v[114:115], v20 offset:4096
    v_mfma_f32_16x16x32_bf16 v[68:71], v[148:151], v[128:131], v[68:71]
    ds_read_b64_tr_b16 v[116:117], v21 offset:0
    v_mfma_f32_16x16x32_bf16 v[52:55], v[148:151], v[124:127], v[52:55]
    ds_read_b64_tr_b16 v[118:119], v21 offset:4096
    v_mfma_f32_16x16x32_bf16 v[36:39], v[148:151], v[120:123], v[36:39]
    s_waitcnt lgkmcnt(6)
    s_cbranch_scc1 mm_23
mm_24:
    v_mfma_f32_16x16x32_bf16 v[24:27], v[104:107], v[88:91], v[24:27]
    ds_read_b128 v[120:123], v17 offset:1024
    s_add_u32 s42, s42, 16384
    v_mfma_f32_16x16x32_bf16 v[40:43], v[104:107], v[92:95], v[40:43]
    ds_read_b128 v[124:127], v17 offset:3072
    s_cmp_eq_u32 s42, 49152
    v_mfma_f32_16x16x32_bf16 v[56:59], v[104:107], v[96:99], v[56:59]
    ds_read_b128 v[128:131], v17 offset:5120
    s_cselect_b32 s42, 0, s42
    v_mfma_f32_16x16x32_bf16 v[72:75], v[104:107], v[100:103], v[72:75]
    ds_read_b128 v[132:135], v17 offset:7168
    s_waitcnt lgkmcnt(8)
    v_mfma_f32_16x16x32_bf16 v[76:79], v[108:111], v[100:103], v[76:79]
    ds_read_b64_tr_b16 v[136:137], v18 offset:8192
    s_add_u32 s48, s48, 16384
    v_mfma_f32_16x16x32_bf16 v[60:63], v[108:111], v[96:99], v[60:63]
    ds_read_b64_tr_b16 v[138:139], v18 offset:12288
    s_cmp_eq_u32 s48, 98304
    v_mfma_f32_16x16x32_bf16 v[44:47], v[108:111], v[92:95], v[44:47]
    ds_read_b64_tr_b16 v[140:141], v19 offset:8192
    s_cselect_b32 s48, 0, s48
    v_mfma_f32_16x16x32_bf16 v[28:31], v[108:111], v[88:91], v[28:31]
    ds_read_b64_tr_b16 v[142:143], v19 offset:12288
    s_waitcnt lgkmcnt(8)
    v_mfma_f32_16x16x32_bf16 v[32:35], v[112:115], v[88:91], v[32:35]
    ds_read_b64_tr_b16 v[144:145], v20 offset:8192
    v_add_u32 v17, s42, v12
    v_mfma_f32_16x16x32_bf16 v[48:51], v[112:115], v[92:95], v[48:51]
    ds_read_b64_tr_b16 v[146:147], v20 offset:12288
    v_add_u32 v18, s48, v13
    v_mfma_f32_16x16x32_bf16 v[64:67], v[112:115], v[96:99], v[64:67]
    ds_read_b64_tr_b16 v[148:149], v21 offset:8192
    v_add_u32 v19, s48, v14
    v_mfma_f32_16x16x32_bf16 v[80:83], v[112:115], v[100:103], v[80:83]
    ds_read_b64_tr_b16 v[150:151], v21 offset:12288
    v_add_u32 v20, s48, v15
    v_mfma_f32_16x16x32_bf16 v[84:87], v[116:119], v[100:103], v[84:87]
    v_add_u32 v21, s48, v16
    v_mfma_f32_16x16x32_bf16 v[68:71], v[116:119], v[96:99], v[68:71]
    v_mfma_f32_16x16x32_bf16 v[52:55], v[116:119], v[92:95], v[52:55]
    v_mfma_f32_16x16x32_bf16 v[36:39], v[116:119], v[88:91], v[36:39]
    s_waitcnt lgkmcnt(6)
    v_mfma_f32_16x16x32_bf16 v[24:27], v[136:139], v[120:123], v[24:27]
    s_add_u32 s43, s43, 1
    s_cmp_lt_u32 s43, 27
    v_mfma_f32_16x16x32_bf16 v[40:43], v[136:139], v[124:127], v[40:43]
    s_waitcnt vmcnt(0)
    v_mfma_f32_16x16x32_bf16 v[56:59], v[136:139], v[128:131], v[56:59]
    s_waitcnt lgkmcnt(0)
    s_barrier
    v_mfma_f32_16x16x32_bf16 v[72:75], v[136:139], v[132:135], v[72:75]
    ds_read_b128 v[88:91], v17 offset:0
    v_mfma_f32_16x16x32_bf16 v[76:79], v[140:143], v[132:135], v[76:79]
    ds_read_b128 v[92:95], v17 offset:2048
    v_mfma_f32_16x16x32_bf16 v[60:63], v[140:143], v[128:131], v[60:63]
    ds_read_b128 v[96:99], v17 offset:4096
    v_mfma_f32_16x16x32_bf16 v[44:47], v[140:143], v[124:127], v[44:47]
    ds_read_b128 v[100:103], v17 offset:6144
    v_mfma_f32_16x16x32_bf16 v[28:31], v[140:143], v[120:123], v[28:31]
    ds_read_b64_tr_b16 v[104:105], v18 offset:0
    v_mfma_f32_16x16x32_bf16 v[32:35], v[144:147], v[120:123], v[32:35]
    ds_read_b64_tr_b16 v[106:107], v18 offset:4096
    v_mfma_f32_16x16x32_bf16 v[48:51], v[144:147], v[124:127], v[48:51]
    ds_read_b64_tr_b16 v[108:109], v19 offset:0
    v_mfma_f32_16x16x32_bf16 v[64:67], v[144:147], v[128:131], v[64:67]
    ds_read_b64_tr_b16 v[110:111], v19 offset:4096
    v_mfma_f32_16x16x32_bf16 v[80:83], v[144:147], v[132:135], v[80:83]
    ds_read_b64_tr_b16 v[112:113], v20 offset:0
    v_mfma_f32_16x16x32_bf16 v[84:87], v[148:151], v[132:135], v[84:87]
    ds_read_b64_tr_b16 v[114:115], v20 offset:4096
    v_mfma_f32_16x16x32_bf16 v[68:71], v[148:151], v[128:131], v[68:71]
    ds_read_b64_tr_b16 v[116:117], v21 offset:0
    v_mfma_f32_16x16x32_bf16 v[52:55], v[148:151], v[124:127], v[52:55]
    ds_read_b64_tr_b16 v[118:119], v21 offset:4096
    v_mfma_f32_16x16x32_bf16 v[36:39], v[148:151], v[120:123], v[36:39]
    s_waitcnt lgkmcnt(6)
    s_cbranch_scc1 mm_24
    s_cmp_eq_u32 s60, 1
    s_cbranch_scc1 G4_last
    v_mfma_f32_16x16x32_bf16 v[24:27], v[104:107], v[88:91], v[24:27]
    ds_read_b128 v[120:123], v17 offset:1024
    v_mfma_f32_16x16x32_bf16 v[40:43], v[104:107], v[92:95], v[40:43]
    ds_read_b128 v[124:127], v17 offset:3072
    v_mfma_f32_16x16x32_bf16 v[56:59], v[104:107], v[96:99], v[56:59]
    ds_read_b128 v[128:131], v17 offset:5120
    v_mfma_f32_16x16x32_bf16 v[72:75], v[104:107], v[100:103], v[72:75]
    ds_read_b128 v[132:135], v17 offset:7168
    s_waitcnt lgkmcnt(8)
    v_mfma_f32_16x16x32_bf16 v[76:79], v[108:111], v[100:103], v[76:79]
    ds_read_b64_tr_b16 v[136:137], v18 offset:8192
    v_mfma_f32_16x16x32_bf16 v[60:63], v[108:111], v[96:99], v[60:63]
    ds_read_b64_tr_b16 v[138:139], v18 offset:12288
    v_mfma_f32_16x16x32_bf16 v[44:47], v[108:111], v[92:95], v[44:47]
    ds_read_b64_tr_b16 v[140:141], v19 offset:8192
    v_mfma_f32_16x16x32_bf16 v[28:31], v[108:111], v[88:91], v[28:31]
    ds_read_b64_tr_b16 v[142:143], v19 offset:12288
    s_waitcnt lgkmcnt(8)
    v_mfma_f32_16x16x32_bf16 v[32:35], v[112:115], v[88:91], v[32:35]
    ds_read_b64_tr_b16 v[144:145], v20 offset:8192
    v_mfma_f32_16x16x32_bf16 v[48:51], v[112:115], v[92:95], v[48:51]
    ds_read_b64_tr_b16 v[146:147], v20 offset:12288
    v_mfma_f32_16x16x32_bf16 v[64:67], v[112:115], v[96:99], v[64:67]
    ds_read_b64_tr_b16 v[148:149], v21 offset:8192
    v_mfma_f32_16x16x32_bf16 v[80:83], v[112:115], v[100:103], v[80:83]
    ds_read_b64_tr_b16 v[150:151], v21 offset:12288
    v_mfma_f32_16x16x32_bf16 v[84:87], v[116:119], v[100:103], v[84:87]
    v_mfma_f32_16x16x32_bf16 v[68:71], v[116:119], v[96:99], v[68:71]
    v_mfma_f32_16x16x32_bf16 v[52:55], v[116:119], v[92:95], v[52:55]
    v_mfma_f32_16x16x32_bf16 v[36:39], v[116:119], v[88:91], v[36:39]
    s_waitcnt lgkmcnt(0)
    v_mfma_f32_16x16x32_bf16 v[24:27], v[136:139], v[120:123], v[24:27]
    s_mul_i32 s36, s31, 524288
    s_add_u32 s36, s36, 0
    s_add_u32 s16, s62, s36
    v_mfma_f32_16x16x32_bf16 v[40:43], v[136:139], v[124:127], v[40:43]
    s_addc_u32 s17, s63, 0
    s_mov_b32 s18, 516096
    s_mov_b32 s19, 0x20000
    v_mfma_f32_16x16x32_bf16 v[56:59], v[136:139], v[128:131], v[56:59]
    v_mfma_f32_16x16x32_bf16 v[72:75], v[136:139], v[132:135], v[72:75]
    v_mfma_f32_16x16x32_bf16 v[76:79], v[140:143], v[132:135], v[76:79]
    v_mfma_f32_16x16x32_bf16 v[60:63], v[140:143], v[128:131], v[60:63]
    v_mfma_f32_16x16x32_bf16 v[44:47], v[140:143], v[124:127], v[44:47]
    v_mfma_f32_16x16x32_bf16 v[28:31], v[140:143], v[120:123], v[28:31]
    v_mfma_f32_16x16x32_bf16 v[32:35], v[144:147], v[120:123], v[32:35]
    v_mfma_f32_16x16x32_bf16 v[48:51], v[144:147], v[124:127], v[48:51]
    v_mfma_f32_16x16x32_bf16 v[64:67], v[144:147], v[128:131], v[64:67]
    v_mfma_f32_16x16x32_bf16 v[80:83], v[144:147], v[132:135], v[80:83]
    v_mfma_f32_16x16x32_bf16 v[84:87], v[148:151], v[132:135], v[84:87]
    v_mfma_f32_16x16x32_bf16 v[68:71], v[148:151], v[128:131], v[68:71]
    v_mfma_f32_16x16x32_bf16 v[52:55], v[148:151], v[124:127], v[52:55]
    v_mfma_f32_16x16x32_bf16 v[36:39], v[148:151], v[120:123], v[36:39]
    s_add_u32 s36, s39, 0
    v_cvt_pk_bf16_f32 v24, v24, v25
    v_cvt_pk_bf16_f32 v25, v26, v27
    v_cvt_pk_bf16_f32 v26, v28, v29
    v_cvt_pk_bf16_f32 v27, v30, v31
    v_or_b32 v24, 1, v24
    buffer_store_dwordx4 v[24:27], v2, s[16:19], s36 offen offset:0 sc1
    v_cvt_pk_bf16_f32 v32, v32, v33
    v_cvt_pk_bf16_f32 v33, v34, v35
    v_cvt_pk_bf16_f32 v34, v36, v37
    v_cvt_pk_bf16_f32 v35, v38, v39
    v_or_b32 v32, 1, v32
    buffer_store_dwordx4 v[32:35], v2, s[16:19], s36 offen offset:1024 sc1
    s_add_u32 s36, s39, 65536
    v_cvt_pk_bf16_f32 v40, v40, v41
    v_cvt_pk_bf16_f32 v41, v42, v43
    v_cvt_pk_bf16_f32 v42, v44, v45
    v_cvt_pk_bf16_f32 v43, v46, v47
    v_or_b32 v40, 1, v40
    buffer_store_dwordx4 v[40:43], v2, s[16:19], s36 offen offset:0 sc1
    v_cvt_pk_bf16_f32 v48, v48, v49
    v_cvt_pk_bf16_f32 v49, v50, v51
    v_cvt_pk_bf16_f32 v50, v52, v53
    v_cvt_pk_bf16_f32 v51, v54, v55
    v_or_b32 v48, 1, v48
    buffer_store_dwordx4 v[48:51], v2, s[16:19], s36 offen offset:1024 sc1
    s_add_u32 s36, s39, 131072
    v_cvt_pk_bf16_f32 v56, v56, v57
    v_cvt_pk_bf16_f32 v57, v58, v59
    v_cvt_pk_bf16_f32 v58, v60, v61
    v_cvt_pk_bf16_f32 v59, v62, v63
    v_or_b32 v56, 1, v56
    buffer_store_dwordx4 v[56:59], v2, s[16:19], s36 offen offset:0 sc1
    v_cvt_pk_bf16_f32 v64, v64, v65
    v_cvt_pk_bf16_f32 v65, v66, v67
    v_cvt_pk_bf16_f32 v66, v68, v69
    v_cvt_pk_bf16_f32 v67, v70, v71
    v_or_b32 v64, 1, v64
    buffer_store_dwordx4 v[64:67], v2, s[16:19], s36 offen offset:1024 sc1
    s_add_u32 s36, s39, 196608
    v_cvt_pk_bf16_f32 v72, v72, v73
    v_cvt_pk_bf16_f32 v73, v74, v75
    v_cvt_pk_bf16_f32 v74, v76, v77
    v_cvt_pk_bf16_f32 v75, v78, v79
    v_or_b32 v72, 1, v72
    buffer_store_dwordx4 v[72:75], v2, s[16:19], s36 offen offset:0 sc1
    v_cvt_pk_bf16_f32 v80, v80, v81
    v_cvt_pk_bf16_f32 v81, v82, v83
    v_cvt_pk_bf16_f32 v82, v84, v85
    v_cvt_pk_bf16_f32 v83, v86, v87
    v_or_b32 v80, 1, v80
    buffer_store_dwordx4 v[80:83], v2, s[16:19], s36 offen offset:1024 sc1
    s_barrier
    s_branch NEXT
G4_last:
    v_mfma_f32_16x16x32_bf16 v[24:27], v[104:107], v[88:91], v[24:27]
    ds_read_b128 v[120:123], v17 offset:1024
    v_mfma_f32_16x16x32_bf16 v[40:43], v[104:107], v[92:95], v[40:43]
    ds_read_b128 v[124:127], v17 offset:3072
    v_mfma_f32_16x16x32_bf16 v[56:59], v[104:107], v[96:99], v[56:59]
    ds_read_b128 v[128:131], v17 offset:5120
    v_mfma_f32_16x16x32_bf16 v[72:75], v[104:107], v[100:103], v[72:75]
    ds_read_b128 v[132:135], v17 offset:7168
    s_waitcnt lgkmcnt(8)
    v_mfma_f32_16x16x32_bf16 v[76:79], v[108:111], v[100:103], v[76:79]
    ds_read_b64_tr_b16 v[136:137], v18 offset:8192
    v_mfma_f32_16x16x32_bf16 v[60:63], v[108:111], v[96:99], v[60:63]
    ds_read_b64_tr_b16 v[138:139], v18 offset:12288
    v_mfma_f32_16x16x32_bf16 v[44:47], v[108:111], v[92:95], v[44:47]
    ds_read_b64_tr_b16 v[140:141], v19 offset:8192
    v_mfma_f32_16x16x32_bf16 v[28:31], v[108:111], v[88:91], v[28:31]
    ds_read_b64_tr_b16 v[142:143], v19 offset:12288
    s_waitcnt lgkmcnt(8)
    v_mfma_f32_16x16x32_bf16 v[32:35], v[112:115], v[88:91], v[32:35]
    ds_read_b64_tr_b16 v[144:145], v20 offset:8192
    v_mfma_f32_16x16x32_bf16 v[48:51], v[112:115], v[92:95], v[48:51]
    ds_read_b64_tr_b16 v[146:147], v20 offset:12288
    s_load_dwordx2 s[6:7], s[0:1], 88
    v_mfma_f32_16x16x32_bf16 v[64:67], v[112:115], v[96:99], v[64:67]
    ds_read_b64_tr_b16 v[148:149], v21 offset:8192
    v_mfma_f32_16x16x32_bf16 v[80:83], v[112:115], v[100:103], v[80:83]
    ds_read_b64_tr_b16 v[150:151], v21 offset:12288
    v_mfma_f32_16x16x32_bf16 v[84:87], v[116:119], v[100:103], v[84:87]
    v_mfma_f32_16x16x32_bf16 v[68:71], v[116:119], v[96:99], v[68:71]
    v_mfma_f32_16x16x32_bf16 v[52:55], v[116:119], v[92:95], v[52:55]
    v_mfma_f32_16x16x32_bf16 v[36:39], v[116:119], v[88:91], v[36:39]
    s_waitcnt lgkmcnt(0)
    v_mfma_f32_16x16x32_bf16 v[24:27], v[136:139], v[120:123], v[24:27]
    s_add_u32 s16, s62, 0x80000
    s_addc_u32 s17, s63, 0
    s_mov_b32 s18, 0x7e000
    v_mfma_f32_16x16x32_bf16 v[40:43], v[136:139], v[124:127], v[40:43]
    s_mov_b32 s19, 0x20000
    s_mov_b32 s20, s6
    s_mov_b32 s21, s7
    v_mfma_f32_16x16x32_bf16 v[56:59], v[136:139], v[128:131], v[56:59]
    s_mov_b32 s22, 0x400000
    s_mov_b32 s23, 0x20000
    s_add_u32 s44, s40, 65536
    v_mfma_f32_16x16x32_bf16 v[72:75], v[136:139], v[132:135], v[72:75]
    s_lshl_b32 s46, s28, 3
    s_add_u32 s46, s46, s37
    s_lshl_b32 s47, s31, 1
    v_mfma_f32_16x16x32_bf16 v[76:79], v[140:143], v[132:135], v[76:79]
    s_add_u32 s46, s46, s47
    s_lshl_b32 s46, s46, 15
    s_lshl_b32 s47, s38, 5
    v_mfma_f32_16x16x32_bf16 v[60:63], v[140:143], v[128:131], v[60:63]
    s_add_u32 s46, s46, s47
    s_add_u32 s47, s46, 32768
    v_and_b32 v225, 1, v23
    v_mfma_f32_16x16x32_bf16 v[44:47], v[140:143], v[124:127], v[44:47]
    v_lshlrev_b32 v224, 11, v22
    v_lshl_add_u32 v224, v225, 5, v224
    v_mfma_f32_16x16x32_bf16 v[28:31], v[140:143], v[120:123], v[28:31]
    v_lshrrev_b32 v225, 1, v23
    v_lshl_add_u32 v224, v225, 4, v224
    v_mfma_f32_16x16x32_bf16 v[32:35], v[144:147], v[120:123], v[32:35]
    v_lshrrev_b32 v225, 3, v22
    v_mul_u32_u24 v225, 16320, v225
    v_mfma_f32_16x16x32_bf16 v[48:51], v[144:147], v[124:127], v[48:51]
    v_sub_u32 v224, v224, v225
    v_add_u32 v225, 16384, v224
    v_mfma_f32_16x16x32_bf16 v[64:67], v[144:147], v[128:131], v[64:67]
    v_mfma_f32_16x16x32_bf16 v[80:83], v[144:147], v[132:135], v[80:83]
    v_mfma_f32_16x16x32_bf16 v[84:87], v[148:151], v[132:135], v[84:87]
    v_mfma_f32_16x16x32_bf16 v[68:71], v[148:151], v[128:131], v[68:71]
    v_mfma_f32_16x16x32_bf16 v[52:55], v[148:151], v[124:127], v[52:55]
    v_mfma_f32_16x16x32_bf16 v[36:39], v[148:151], v[120:123], v[36:39]
    s_cmp_eq_u32 s31, 0
    s_cbranch_scc1 G4_k0
    s_add_u32 s36, s41, 0
    v_cvt_pk_bf16_f32 v24, v24, v25
    v_cvt_pk_bf16_f32 v25, v26, v27
    v_cvt_pk_bf16_f32 v26, v28, v29
    v_cvt_pk_bf16_f32 v27, v30, v31
    v_or_b32 v24, 1, v24
    buffer_store_dwordx4 v[24:27], v2, s[16:19], s36 offen offset:0 sc1
    v_cvt_pk_bf16_f32 v32, v32, v33
    v_cvt_pk_bf16_f32 v33, v34, v35
    v_cvt_pk_bf16_f32 v34, v36, v37
    v_cvt_pk_bf16_f32 v35, v38, v39
    v_or_b32 v32, 1, v32
    buffer_store_dwordx4 v[32:35], v2, s[16:19], s36 offen offset:1024 sc1
    s_add_u32 s36, s41, 65536
    v_cvt_pk_bf16_f32 v40, v40, v41
    v_cvt_pk_bf16_f32 v41, v42, v43
    v_cvt_pk_bf16_f32 v42, v44, v45
    v_cvt_pk_bf16_f32 v43, v46, v47
    v_or_b32 v40, 1, v40
    buffer_store_dwordx4 v[40:43], v2, s[16:19], s36 offen offset:0 sc1
    v_cvt_pk_bf16_f32 v48, v48, v49
    v_cvt_pk_bf16_f32 v49, v50, v51
    v_cvt_pk_bf16_f32 v50, v52, v53
    v_cvt_pk_bf16_f32 v51, v54, v55
    v_or_b32 v48, 1, v48
    buffer_store_dwordx4 v[48:51], v2, s[16:19], s36 offen offset:1024 sc1
    v_pk_mov_b32 v[24:25], v[56:57], v[56:57] op_sel:[0,1]
    v_pk_mov_b32 v[26:27], v[58:59], v[58:59] op_sel:[0,1]
    v_pk_mov_b32 v[28:29], v[60:61], v[60:61] op_sel:[0,1]
    v_pk_mov_b32 v[30:31], v[62:63], v[62:63] op_sel:[0,1]
    v_pk_mov_b32 v[32:33], v[64:65], v[64:65] op_sel:[0,1]
    v_pk_mov_b32 v[34:35], v[66:67], v[66:67] op_sel:[0,1]
    v_pk_mov_b32 v[36:37], v[68:69], v[68:69] op_sel:[0,1]
    v_pk_mov_b32 v[38:39], v[70:71], v[70:71] op_sel:[0,1]
    v_pk_mov_b32 v[40:41], v[72:73], v[72:73] op_sel:[0,1]
    v_pk_mov_b32 v[42:43], v[74:75], v[74:75] op_sel:[0,1]
    v_pk_mov_b32 v[44:45], v[76:77], v[76:77] op_sel:[0,1]
    v_pk_mov_b32 v[46:47], v[78:79], v[78:79] op_sel:[0,1]
    v_pk_mov_b32 v[48:49], v[80:81], v[80:81] op_sel:[0,1]
    v_pk_mov_b32 v[50:51], v[82:83], v[82:83] op_sel:[0,1]
    v_pk_mov_b32 v[52:53], v[84:85], v[84:85] op_sel:[0,1]
    v_pk_mov_b32 v[54:55], v[86:87], v[86:87] op_sel:[0,1]
    s_branch G4_k1
G4_k0:
    s_add_u32 s36, s41, 0
    v_cvt_pk_bf16_f32 v56, v56, v57
    v_cvt_pk_bf16_f32 v57, v58, v59
    v_cvt_pk_bf16_f32 v58, v60, v61
    v_cvt_pk_bf16_f32 v59, v62, v63
    v_or_b32 v56, 1, v56
    buffer_store_dwordx4 v[56:59], v2, s[16:19], s36 offen offset:0 sc1
    v_cvt_pk_bf16_f32 v64, v64, v65
    v_cvt_pk_bf16_f32 v65, v66, v67
    v_cvt_pk_bf16_f32 v66, v68, v69
    v_cvt_pk_bf16_f32 v67, v70, v71
    v_or_b32 v64, 1, v64
    buffer_store_dwordx4 v[64:67], v2, s[16:19], s36 offen offset:1024 sc1
    s_add_u32 s36, s41, 65536
    v_cvt_pk_bf16_f32 v72, v72, v73
    v_cvt_pk_bf16_f32 v73, v74, v75
    v_cvt_pk_bf16_f32 v74, v76, v77
    v_cvt_pk_bf16_f32 v75, v78, v79
    v_or_b32 v72, 1, v72
    buffer_store_dwordx4 v[72:75], v2, s[16:19], s36 offen offset:0 sc1
    v_cvt_pk_bf16_f32 v80, v80, v81
    v_cvt_pk_bf16_f32 v81, v82, v83
    v_cvt_pk_bf16_f32 v82, v84, v85
    v_cvt_pk_bf16_f32 v83, v86, v87
    v_or_b32 v80, 1, v80
    buffer_store_dwordx4 v[80:83], v2, s[16:19], s36 offen offset:1024 sc1
G4_k1:
    s_mov_b32 s78, 0x3f80
    s_mov_b32 s79, 0x3f800000
    v_dot2_f32_bf16 v24, v180, s78, v24
    v_dot2_f32_bf16 v25, v180, s79, v25
    v_dot2_f32_bf16 v26, v181, s78, v26
    v_dot2_f32_bf16 v27, v181, s79, v27
    v_dot2_f32_bf16 v28, v182, s78, v28
    v_dot2_f32_bf16 v29, v182, s79, v29
    v_dot2_f32_bf16 v30, v183, s78, v30
    v_dot2_f32_bf16 v31, v183, s79, v31
    v_dot2_f32_bf16 v32, v188, s78, v32
    v_dot2_f32_bf16 v33, v188, s79, v33
    v_dot2_f32_bf16 v34, v189, s78, v34
    v_dot2_f32_bf16 v35, v189, s79, v35
    v_dot2_f32_bf16 v36, v190, s78, v36
    v_dot2_f32_bf16 v37, v190, s79, v37
    v_dot2_f32_bf16 v38, v191, s78, v38
    v_dot2_f32_bf16 v39, v191, s79, v39
    v_dot2_f32_bf16 v40, v196, s78, v40
    v_dot2_f32_bf16 v41, v196, s79, v41
    v_dot2_f32_bf16 v42, v197, s78, v42
    v_dot2_f32_bf16 v43, v197, s79, v43
    v_dot2_f32_bf16 v44, v198, s78, v44
    v_dot2_f32_bf16 v45, v198, s79, v45
    v_dot2_f32_bf16 v46, v199, s78, v46
    v_dot2_f32_bf16 v47, v199, s79, v47
    v_dot2_f32_bf16 v48, v234, s78, v48
    v_dot2_f32_bf16 v49, v234, s79, v49
    v_dot2_f32_bf16 v50, v235, s78, v50
    v_dot2_f32_bf16 v51, v235, s79, v51
    v_dot2_f32_bf16 v52, v236, s78, v52
    v_dot2_f32_bf16 v53, v236, s79, v53
    v_dot2_f32_bf16 v54, v237, s78, v54
    v_dot2_f32_bf16 v55, v237, s79, v55
    v_dot2_f32_bf16 v24, v184, s78, v24
    v_dot2_f32_bf16 v25, v184, s79, v25
    v_dot2_f32_bf16 v26, v185, s78, v26
    v_dot2_f32_bf16 v27, v185, s79, v27
    v_dot2_f32_bf16 v28, v186, s78, v28
    v_dot2_f32_bf16 v29, v186, s79, v29
    v_dot2_f32_bf16 v30, v187, s78, v30
    v_dot2_f32_bf16 v31, v187, s79, v31
    v_dot2_f32_bf16 v32, v192, s78, v32
    v_dot2_f32_bf16 v33, v192, s79, v33
    v_dot2_f32_bf16 v34, v193, s78, v34
    v_dot2_f32_bf16 v35, v193, s79, v35
    v_dot2_f32_bf16 v36, v194, s78, v36
    v_dot2_f32_bf16 v37, v194, s79, v37
    v_dot2_f32_bf16 v38, v195, s78, v38
    v_dot2_f32_bf16 v39, v195, s79, v39
    v_dot2_f32_bf16 v40, v230, s78, v40
    v_dot2_f32_bf16 v41, v230, s79, v41
    v_dot2_f32_bf16 v42, v231, s78, v42
    v_dot2_f32_bf16 v43, v231, s79, v43
    v_dot2_f32_bf16 v44, v232, s78, v44
    v_dot2_f32_bf16 v45, v232, s79, v45
    v_dot2_f32_bf16 v46, v233, s78, v46
    v_dot2_f32_bf16 v47, v233, s79, v47
    v_dot2_f32_bf16 v48, v248, s78, v48
    v_dot2_f32_bf16 v49, v248, s79, v49
    v_dot2_f32_bf16 v50, v249, s78, v50
    v_dot2_f32_bf16 v51, v249, s79, v51
    v_dot2_f32_bf16 v52, v250, s78, v52
    v_dot2_f32_bf16 v53, v250, s79, v53
    v_dot2_f32_bf16 v54, v251, s78, v54
    v_dot2_f32_bf16 v55, v251, s79, v55
    s_mov_b32 s53, 0
dp_25:
    buffer_load_dwordx4 v[208:211], v2, s[16:19], s40 offen offset:0 sc1
    buffer_load_dwordx4 v[212:215], v2, s[16:19], s40 offen offset:1024 sc1
    buffer_load_dwordx4 v[216:219], v2, s[16:19], s44 offen offset:0 sc1
    buffer_load_dwordx4 v[220:223], v2, s[16:19], s44 offen offset:1024 sc1
    s_waitcnt vmcnt(0)
    v_bitop3_b32 v6, v208, v212, v216 bitop3:0x80
    v_bitop3_b32 v6, v6, v220, 1 bitop3:0x80
    v_cmp_eq_u32 vcc, 0, v6
    s_cbranch_vccz dq_26
    s_sleep 2
    s_add_u32 s53, s53, 1
    s_cmp_lt_u32 s53, s61
    s_cbranch_scc1 dp_25
    s_mov_b32 s61, 0
dq_26:
    v_dot2_f32_bf16 v24, v208, s78, v24
    v_dot2_f32_bf16 v25, v208, s79, v25
    v_dot2_f32_bf16 v26, v209, s78, v26
    v_dot2_f32_bf16 v27, v209, s79, v27
    v_dot2_f32_bf16 v28, v210, s78, v28
    v_dot2_f32_bf16 v29, v210, s79, v29
    v_dot2_f32_bf16 v30, v211, s78, v30
    v_dot2_f32_bf16 v31, v211, s79, v31
    v_cvt_pk_bf16_f32 v24, v24, v25
    v_cvt_pk_bf16_f32 v25, v26, v27
    v_cvt_pk_bf16_f32 v26, v28, v29
    v_cvt_pk_bf16_f32 v27, v30, v31
    s_nop 0
    v_permlane16_swap_b32 v24, v26
    v_permlane16_swap_b32 v25, v27
    v_dot2_f32_bf16 v32, v212, s78, v32
    v_dot2_f32_bf16 v33, v212, s79, v33
    v_dot2_f32_bf16 v34, v213, s78, v34
    v_dot2_f32_bf16 v35, v213, s79, v35
    v_dot2_f32_bf16 v36, v214, s78, v36
    v_dot2_f32_bf16 v37, v214, s79, v37
    v_dot2_f32_bf16 v38, v215, s78, v38
    v_dot2_f32_bf16 v39, v215, s79, v39
    v_cvt_pk_bf16_f32 v32, v32, v33
    v_cvt_pk_bf16_f32 v33, v34, v35
    v_cvt_pk_bf16_f32 v34, v36, v37
    v_cvt_pk_bf16_f32 v35, v38, v39
    s_nop 0
    v_permlane16_swap_b32 v32, v34
    v_permlane16_swap_b32 v33, v35
    v_mov_b32 v36, v24
    v_mov_b32 v37, v25
    v_mov_b32 v38, v26
    v_mov_b32 v39, v27
    v_mov_b32_dpp v24, v32 row_ror:8 row_mask:0xf bank_mask:0xc
    v_mov_b32_dpp v25, v33 row_ror:8 row_mask:0xf bank_mask:0xc
    v_mov_b32_dpp v26, v34 row_ror:8 row_mask:0xf bank_mask:0xc
    v_mov_b32_dpp v27, v35 row_ror:8 row_mask:0xf bank_mask:0xc
    v_mov_b32_dpp v32, v36 row_ror:8 row_mask:0xf bank_mask:0x3
    v_mov_b32_dpp v33, v37 row_ror:8 row_mask:0xf bank_mask:0x3
    v_mov_b32_dpp v34, v38 row_ror:8 row_mask:0xf bank_mask:0x3
    v_mov_b32_dpp v35, v39 row_ror:8 row_mask:0xf bank_mask:0x3
    buffer_store_dwordx4 v[24:27], v224, s[20:23], s46 offen sc1
    buffer_store_dwordx4 v[32:35], v225, s[20:23], s46 offen sc1
    v_dot2_f32_bf16 v40, v216, s78, v40
    v_dot2_f32_bf16 v41, v216, s79, v41
    v_dot2_f32_bf16 v42, v217, s78, v42
    v_dot2_f32_bf16 v43, v217, s79, v43
    v_dot2_f32_bf16 v44, v218, s78, v44
    v_dot2_f32_bf16 v45, v218, s79, v45
    v_dot2_f32_bf16 v46, v219, s78, v46
    v_dot2_f32_bf16 v47, v219, s79, v47
    v_cvt_pk_bf16_f32 v40, v40, v41
    v_cvt_pk_bf16_f32 v41, v42, v43
    v_cvt_pk_bf16_f32 v42, v44, v45
    v_cvt_pk_bf16_f32 v43, v46, v47
    s_nop 0
    v_permlane16_swap_b32 v40, v42
    v_permlane16_swap_b32 v41, v43
    v_dot2_f32_bf16 v48, v220, s78, v48
    v_dot2_f32_bf16 v49, v220, s79, v49
    v_dot2_f32_bf16 v50, v221, s78, v50
    v_dot2_f32_bf16 v51, v221, s79, v51
    v_dot2_f32_bf16 v52, v222, s78, v52
    v_dot2_f32_bf16 v53, v222, s79, v53
    v_dot2_f32_bf16 v54, v223, s78, v54
    v_dot2_f32_bf16 v55, v223, s79, v55
    v_cvt_pk_bf16_f32 v48, v48, v49
    v_cvt_pk_bf16_f32 v49, v50, v51
    v_cvt_pk_bf16_f32 v50, v52, v53
    v_cvt_pk_bf16_f32 v51, v54, v55
    s_nop 0
    v_permlane16_swap_b32 v48, v50
    v_permlane16_swap_b32 v49, v51
    v_mov_b32 v52, v40
    v_mov_b32 v53, v41
    v_mov_b32 v54, v42
    v_mov_b32 v55, v43
    v_mov_b32_dpp v40, v48 row_ror:8 row_mask:0xf bank_mask:0xc
    v_mov_b32_dpp v41, v49 row_ror:8 row_mask:0xf bank_mask:0xc
    v_mov_b32_dpp v42, v50 row_ror:8 row_mask:0xf bank_mask:0xc
    v_mov_b32_dpp v43, v51 row_ror:8 row_mask:0xf bank_mask:0xc
    v_mov_b32_dpp v48, v52 row_ror:8 row_mask:0xf bank_mask:0x3
    v_mov_b32_dpp v49, v53 row_ror:8 row_mask:0xf bank_mask:0x3
    v_mov_b32_dpp v50, v54 row_ror:8 row_mask:0xf bank_mask:0x3
    v_mov_b32_dpp v51, v55 row_ror:8 row_mask:0xf bank_mask:0x3
    buffer_store_dwordx4 v[40:43], v224, s[20:23], s47 offen sc1
    buffer_store_dwordx4 v[48:51], v225, s[20:23], s47 offen sc1
    s_branch K_fin
LOADERS:
    s_cmp_ge_u32 s30, 6
    s_cbranch_scc1 WLOAD
    s_add_u32 s54, s55, 0x500
    v_mov_b32 v222, s54
    s_lshl_b32 s53, s29, 7
    s_add_u32 s53, s53, 23117824
    v_mov_b32 v226, s53
    s_sleep 30
    s_mov_b64 exec, 1
    buffer_load_dword v227, v226, s[56:59], 0 offen sc1
    s_mov_b64 exec, -1
    s_waitcnt vmcnt(0)
    v_readfirstlane_b32 s53, v227
    s_add_u32 s54, s52, 16
    s_cmp_eq_u32 s53, s54
    s_cbranch_scc1 fok_27
    s_mov_b32 s53, 0
    s_add_u32 s54, s52, 16
    s_bfm_b64 exec, 1, 0
poll_28:
    buffer_load_dword v227, v226, s[56:59], 0 offen sc1
    s_waitcnt vmcnt(0)
    v_xor_b32 v227, s54, v227
    v_cmp_eq_u32 vcc, 0, v227
    s_nop 0
    s_cmp_eq_u64 vcc, exec
    s_cbranch_scc1 pok_29
    s_sleep 5
    s_add_u32 s53, s53, 1
    s_cmp_lt_u32 s53, s61
    s_cbranch_scc1 poll_28
    s_mov_b32 s61, 0
pok_29:
    s_mov_b64 exec, -1
fok_27:
    s_add_u32 s24, s4, 0x1400000
    s_addc_u32 s25, s5, 0
    s_mov_b32 s26, 0x20000
    s_mov_b32 s27, 0x20000
    s_cmp_eq_u32 s60, 0
    s_cselect_b32 s26, s26, 0
    s_and_b32 s36, s30, 1
    s_mul_i32 s36, s36, 128
    s_mul_i32 s37, s29, 256
    s_add_u32 s37, s36, s37
    v_lshrrev_b32 v224, 3, v1
    v_mul_u32_u24 v224, 4096, v224
    v_and_b32 v23, 112, v2
    v_add_u32 v224, v224, v23
    buffer_load_dwordx4 v[24:27], v224, s[24:27], s37 offen sc1
    s_add_u32 s37, s37, 32768
    buffer_load_dwordx4 v[28:31], v224, s[24:27], s37 offen sc1
    s_add_u32 s37, s37, 32768
    buffer_load_dwordx4 v[32:35], v224, s[24:27], s37 offen sc1
    s_add_u32 s37, s37, 32768
    buffer_load_dwordx4 v[36:39], v224, s[24:27], s37 offen sc1
    s_add_u32 s37, s37, 32768
    s_mov_b64 exec, 1
    buffer_load_dword v223, v222, s[56:59], 0 offen sc1
    s_mov_b64 exec, -1
    s_waitcnt vmcnt(0)
    v_readfirstlane_b32 s53, v223
    s_add_u32 s54, s52, 16
    s_cmp_eq_u32 s53, s54
    s_cbranch_scc1 fok_30
    s_mov_b32 s53, 0
    s_add_u32 s54, s52, 16
    s_bfm_b64 exec, 1, 0
poll_31:
    buffer_load_dword v223, v222, s[56:59], 0 offen sc1
    s_waitcnt vmcnt(0)
    v_xor_b32 v223, s54, v223
    v_cmp_eq_u32 vcc, 0, v223
    s_nop 0
    s_cmp_eq_u64 vcc, exec
    s_cbranch_scc1 pok_32
    s_sleep 5
    s_add_u32 s53, s53, 1
    s_cmp_lt_u32 s53, s61
    s_cbranch_scc1 poll_31
    s_mov_b32 s61, 0
pok_32:
    s_mov_b64 exec, -1
fok_30:
    s_add_u32 s20, s62, 0x5d0000
    s_addc_u32 s21, s63, 0
    s_mov_b32 s22, 0x800
    s_mov_b32 s23, 0x20000
    s_and_b32 s35, s30, 1
    s_lshl_b32 s35, s35, 10
    buffer_load_dwordx4 v[16:19], v2, s[20:23], s35 offen sc1
    s_cmp_lg_u32 s60, 0
    s_cbranch_scc1 pc_33
    v_add_f32 v24, v24, v28
    v_add_f32 v25, v25, v29
    v_add_f32 v26, v26, v30
    v_add_f32 v27, v27, v31
    v_add_f32 v24, v24, v32
    v_add_f32 v25, v25, v33
    v_add_f32 v26, v26, v34
    v_add_f32 v27, v27, v35
    v_add_f32 v24, v24, v36
    v_add_f32 v25, v25, v37
    v_add_f32 v26, v26, v38
    v_add_f32 v27, v27, v39
    v_add_f32_dpp v24, v24, v24 row_ror:8 row_mask:0xf bank_mask:0xf
    v_add_f32_dpp v25, v25, v25 row_ror:8 row_mask:0xf bank_mask:0xf
    v_add_f32_dpp v26, v26, v26 row_ror:8 row_mask:0xf bank_mask:0xf
    v_add_f32_dpp v27, v27, v27 row_ror:8 row_mask:0xf bank_mask:0xf
    v_mov_b32 v28, v24
    v_mov_b32 v29, v25
    v_mov_b32 v30, v26
    v_mov_b32 v31, v27
    v_permlane16_swap_b32 v24, v28
    v_permlane16_swap_b32 v25, v29
    v_permlane16_swap_b32 v26, v30
    v_permlane16_swap_b32 v27, v31
    v_add_f32 v24, v24, v28
    v_add_f32 v25, v25, v29
    v_add_f32 v26, v26, v30
    v_add_f32 v27, v27, v31
    v_mov_b32 v28, v24
    v_mov_b32 v29, v25
    v_mov_b32 v30, v26
    v_mov_b32 v31, v27
    v_permlane32_swap_b32 v24, v28
    v_permlane32_swap_b32 v25, v29
    v_permlane32_swap_b32 v26, v30
    v_permlane32_swap_b32 v27, v31
    v_add_f32 v24, v24, v28
    v_add_f32 v25, v25, v29
    v_add_f32 v26, v26, v30
    v_add_f32 v27, v27, v31
pc_33:
    s_cmp_lg_u32 s60, 0
    s_cbranch_scc1 pc_34
    s_and_b32 s36, s30, 1
    s_mul_i32 s36, s36, 128
    s_add_u32 s36, s36, 163328
    v_add_u32 v23, s36, v2
    s_bfm_b64 exec, 8, 0
    ds_write_b128 v23, v[24:27]
    s_mov_b64 exec, -1
    s_waitcnt lgkmcnt(0)
pc_34:
    s_waitcnt vmcnt(0)
    s_and_b32 s36, s30, 1
    s_lshl_b32 s36, s36, 10
    s_add_u32 s36, s36, 160768
    v_add_u32 v221, s36, v2
    ds_write_b128 v221, v[16:19]
    s_waitcnt lgkmcnt(0)
    s_cmp_lg_u32 s30, 4
    s_cbranch_scc1 AL_nw
    s_cmp_eq_u32 s60, 0
    s_cbranch_scc1 AL_l0
    s_add_u32 s54, s55, 0xffc00300
    s_add_u32 s53, s54, s92
    v_mov_b32 v9, s53
    s_add_u32 s53, s53, 128
    v_writelane_b32 v9, s53, 1
    s_add_u32 s53, s54, s93
    v_writelane_b32 v9, s53, 2
    s_add_u32 s53, s53, 128
    v_writelane_b32 v9, s53, 3
    s_mov_b32 s53, 0
    s_add_u32 s54, s52, 8
    s_bfm_b64 exec, 4, 0
poll_36:
    buffer_load_dword v8, v9, s[56:59], 0 offen sc1
    s_waitcnt vmcnt(0)
    v_xor_b32 v8, s54, v8
    v_cmp_eq_u32 vcc, 0, v8
    s_nop 0
    s_cmp_eq_u64 vcc, exec
    s_cbranch_scc1 pok_37
    s_sleep 5
    s_add_u32 s53, s53, 1
    s_cmp_lt_u32 s53, s61
    s_cbranch_scc1 poll_36
    s_mov_b32 s61, 0
pok_37:
    s_mov_b64 exec, -1
    s_branch AL_nw
AL_l0:
    s_add_u32 s54, s55, 1280
    s_xor_b32 s54, s54, 0x2000
    v_mov_b32 v9, s54
    s_mov_b32 s53, 0
    s_add_u32 s54, s52, 16
    s_bfm_b64 exec, 1, 0
poll_38:
    buffer_load_dword v8, v9, s[56:59], 0 offen sc1
    s_waitcnt vmcnt(0)
    v_xor_b32 v8, s54, v8
    v_cmp_eq_u32 vcc, 0, v8
    s_nop 0
    s_cmp_eq_u64 vcc, exec
    s_cbranch_scc1 pok_39
    s_sleep 5
    s_add_u32 s53, s53, 1
    s_cmp_lt_u32 s53, s61
    s_cbranch_scc1 poll_38
    s_mov_b32 s61, 0
pok_39:
    s_mov_b64 exec, -1
AL_nw:
    s_barrier
    s_call_b64 s[76:77], SUB_after_g1
    s_barrier
    s_waitcnt vmcnt(0)
    s_barrier
    s_call_b64 s[76:77], SUB_after_g2
    s_and_b32 s35, s30, 1
    s_add_u32 s12, s62, 0x80000
    s_addc_u32 s13, s63, 0
    s_mov_b32 s14, 0x7e000
    s_mov_b32 s15, 0x20000
    s_mul_i32 s38, s35, 262144
    s_lshl_b32 s41, s35, 13
    s_mov_b32 s42, 0
    s_mov_b32 s44, 0
    s_add_u32 s54, s55, 0x200
    v_mov_b32 v9, s54
    s_mov_b32 s44, 1
    s_mov_b32 s42, 16384
    s_add_u32 s54, s55, 0x580
    v_mov_b32 v222, s54
    v_lshlrev_b32 v221, 3, v1
    s_add_u32 s19, s41, s42
    v_readlane_b32 s16, v248, s44
    s_nop 0
    s_add_u32 s16, s16, s38
    s_add_u32 s44, s44, 1
    s_and_b32 s44, s44, 15
    s_add_u32 s42, s42, 16384
    s_cmp_eq_u32 s42, 49152
    s_cselect_b32 s42, 0, s42
    s_mov_b32 m0, s19
    s_mov_b32 s39, s16
    s_waitcnt vmcnt(0)
    s_barrier
    s_sleep 6
    s_mov_b32 s53, 0
    s_add_u32 s54, s52, 16
    s_bfm_b64 exec, 1, 0
poll_40:
    buffer_load_dword v8, v9, s[56:59], 0 offen sc1
    s_waitcnt vmcnt(0)
    v_xor_b32 v8, s54, v8
    v_cmp_eq_u32 vcc, 0, v8
    s_nop 0
    s_cmp_eq_u64 vcc, exec
    s_cbranch_scc1 pok_41
    s_sleep 5
    s_add_u32 s53, s53, 1
    s_cmp_lt_u32 s53, s61
    s_cbranch_scc1 poll_40
    s_mov_b32 s61, 0
pok_41:
    s_mov_b64 exec, -1
    buffer_load_dwordx4 v2, s[12:15], s39 offen sc1 lds
    buffer_load_dwordx4 v2, s[12:15], s39 offen offset:1024 sc1 lds
    s_add_u32 s19, s41, s42
    v_readlane_b32 s16, v248, s44
    s_nop 0
    s_add_u32 s16, s16, s38
    s_add_u32 s44, s44, 1
    s_and_b32 s44, s44, 15
    s_add_u32 s42, s42, 16384
    s_cmp_eq_u32 s42, 49152
    s_cselect_b32 s42, 0, s42
    s_add_u32 m0, m0, 2048
    s_add_u32 s39, s39, 65536
    buffer_load_dwordx4 v2, s[12:15], s39 offen sc1 lds
    buffer_load_dwordx4 v2, s[12:15], s39 offen offset:1024 sc1 lds
    s_add_u32 m0, m0, 2048
    s_add_u32 s39, s39, 65536
    buffer_load_dwordx4 v2, s[12:15], s39 offen sc1 lds
    buffer_load_dwordx4 v2, s[12:15], s39 offen offset:1024 sc1 lds
    s_add_u32 m0, m0, 2048
    s_add_u32 s39, s39, 65536
    buffer_load_dwordx4 v2, s[12:15], s39 offen sc1 lds
    buffer_load_dwordx4 v2, s[12:15], s39 offen offset:1024 sc1 lds
    s_mov_b32 m0, s19
    s_mov_b32 s39, s16
    buffer_load_dwordx4 v2, s[12:15], s39 offen sc1 lds
    buffer_load_dwordx4 v2, s[12:15], s39 offen offset:1024 sc1 lds
    s_add_u32 s19, s41, s42
    v_readlane_b32 s16, v248, s44
    s_nop 0
    s_add_u32 s16, s16, s38
    s_add_u32 s44, s44, 1
    s_and_b32 s44, s44, 15
    s_add_u32 s42, s42, 16384
    s_cmp_eq_u32 s42, 49152
    s_cselect_b32 s42, 0, s42
    s_add_u32 m0, m0, 2048
    s_add_u32 s39, s39, 65536
    buffer_load_dwordx4 v2, s[12:15], s39 offen sc1 lds
    buffer_load_dwordx4 v2, s[12:15], s39 offen offset:1024 sc1 lds
    s_add_u32 m0, m0, 2048
    s_add_u32 s39, s39, 65536
    buffer_load_dwordx4 v2, s[12:15], s39 offen sc1 lds
    buffer_load_dwordx4 v2, s[12:15], s39 offen offset:1024 sc1 lds
    s_add_u32 m0, m0, 2048
    s_add_u32 s39, s39, 65536
    buffer_load_dwordx4 v2, s[12:15], s39 offen sc1 lds
    buffer_load_dwordx4 v2, s[12:15], s39 offen offset:1024 sc1 lds
    s_mov_b32 m0, s19
    s_mov_b32 s39, s16
    s_waitcnt vmcnt(8)
    s_barrier
    buffer_load_dwordx4 v2, s[12:15], s39 offen sc1 lds
    buffer_load_dwordx4 v2, s[12:15], s39 offen offset:1024 sc1 lds
    s_add_u32 s19, s41, s42
    v_readlane_b32 s16, v248, s44
    s_nop 0
    s_add_u32 s16, s16, s38
    s_add_u32 s44, s44, 1
    s_and_b32 s44, s44, 15
    s_add_u32 s42, s42, 16384
    s_cmp_eq_u32 s42, 49152
    s_cselect_b32 s42, 0, s42
    s_add_u32 m0, m0, 2048
    s_add_u32 s39, s39, 65536
    buffer_load_dwordx4 v2, s[12:15], s39 offen sc1 lds
    buffer_load_dwordx4 v2, s[12:15], s39 offen offset:1024 sc1 lds
    s_add_u32 m0, m0, 2048
    s_add_u32 s39, s39, 65536
    buffer_load_dwordx4 v2, s[12:15], s39 offen sc1 lds
    buffer_load_dwordx4 v2, s[12:15], s39 offen offset:1024 sc1 lds
    s_add_u32 m0, m0, 2048
    s_add_u32 s39, s39, 65536
    buffer_load_dwordx4 v2, s[12:15], s39 offen sc1 lds
    buffer_load_dwordx4 v2, s[12:15], s39 offen offset:1024 sc1 lds
    s_mov_b32 m0, s19
    s_mov_b32 s39, s16
    s_add_u32 s24, s4, 0x1420000
    s_addc_u32 s25, s5, 0
    s_mov_b32 s26, 0x70000
    s_mov_b32 s27, 0x20000
    s_cmp_eq_u32 s60, 0
    s_cselect_b32 s26, s26, 0
    s_and_b32 s36, s30, 1
    s_mul_i32 s36, s36, 448
    s_mul_i32 s37, s29, 896
    s_add_u32 s37, s36, s37
    v_lshrrev_b32 v224, 5, v1
    v_mul_u32_u24 v224, 14336, v224
    v_and_b32 v179, 496, v2
    v_add_u32 v224, v224, v179
    buffer_load_dwordx4 v[180:183], v224, s[24:27], s37 offen sc1
    s_add_u32 s37, s37, 28672
    buffer_load_dwordx4 v[184:187], v224, s[24:27], s37 offen sc1
    s_add_u32 s37, s37, 28672
    buffer_load_dwordx4 v[188:191], v224, s[24:27], s37 offen sc1
    s_add_u32 s37, s37, 28672
    buffer_load_dwordx4 v[192:195], v224, s[24:27], s37 offen sc1
    s_add_u32 s37, s37, 28672
    s_waitcnt vmcnt(12)
    s_barrier
    buffer_load_dwordx4 v2, s[12:15], s39 offen sc1 lds
    buffer_load_dwordx4 v2, s[12:15], s39 offen offset:1024 sc1 lds
    s_add_u32 s19, s41, s42
    v_readlane_b32 s16, v248, s44
    s_nop 0
    s_add_u32 s16, s16, s38
    s_add_u32 s44, s44, 1
    s_and_b32 s44, s44, 15
    s_add_u32 s42, s42, 16384
    s_cmp_eq_u32 s42, 49152
    s_cselect_b32 s42, 0, s42
    s_add_u32 m0, m0, 2048
    s_add_u32 s39, s39, 65536
    buffer_load_dwordx4 v2, s[12:15], s39 offen sc1 lds
    buffer_load_dwordx4 v2, s[12:15], s39 offen offset:1024 sc1 lds
    s_add_u32 m0, m0, 2048
    s_add_u32 s39, s39, 65536
    buffer_load_dwordx4 v2, s[12:15], s39 offen sc1 lds
    buffer_load_dwordx4 v2, s[12:15], s39 offen offset:1024 sc1 lds
    s_add_u32 m0, m0, 2048
    s_add_u32 s39, s39, 65536
    buffer_load_dwordx4 v2, s[12:15], s39 offen sc1 lds
    buffer_load_dwordx4 v2, s[12:15], s39 offen offset:1024 sc1 lds
    s_mov_b32 m0, s19
    s_mov_b32 s39, s16
    buffer_load_dwordx4 v[196:199], v224, s[24:27], s37 offen sc1
    s_add_u32 s37, s37, 28672
    buffer_load_dwordx4 v[200:203], v224, s[24:27], s37 offen sc1
    s_add_u32 s37, s37, 28672
    buffer_load_dwordx4 v[204:207], v224, s[24:27], s37 offen sc1
    s_add_u32 s37, s37, 28672
    buffer_load_dwordx4 v[208:211], v224, s[24:27], s37 offen sc1
    s_add_u32 s37, s37, 28672
    buffer_load_dwordx4 v[212:215], v224, s[24:27], s37 offen sc1
    s_add_u32 s37, s37, 28672
    s_waitcnt vmcnt(17)
    s_barrier
    buffer_load_dwordx4 v2, s[12:15], s39 offen sc1 lds
    buffer_load_dwordx4 v2, s[12:15], s39 offen offset:1024 sc1 lds
    s_add_u32 s19, s41, s42
    v_readlane_b32 s16, v248, s44
    s_nop 0
    s_add_u32 s16, s16, s38
    s_add_u32 s44, s44, 1
    s_and_b32 s44, s44, 15
    s_add_u32 s42, s42, 16384
    s_cmp_eq_u32 s42, 49152
    s_cselect_b32 s42, 0, s42
    s_add_u32 m0, m0, 2048
    s_add_u32 s39, s39, 65536
    buffer_load_dwordx4 v2, s[12:15], s39 offen sc1 lds
    buffer_load_dwordx4 v2, s[12:15], s39 offen offset:1024 sc1 lds
    s_add_u32 m0, m0, 2048
    s_add_u32 s39, s39, 65536
    buffer_load_dwordx4 v2, s[12:15], s39 offen sc1 lds
    buffer_load_dwordx4 v2, s[12:15], s39 offen offset:1024 sc1 lds
    s_add_u32 m0, m0, 2048
    s_add_u32 s39, s39, 65536
    buffer_load_dwordx4 v2, s[12:15], s39 offen sc1 lds
    buffer_load_dwordx4 v2, s[12:15], s39 offen offset:1024 sc1 lds
    s_mov_b32 m0, s19
    s_mov_b32 s39, s16
    s_waitcnt vmcnt(13)
    s_barrier
    buffer_load_dwordx4 v2, s[12:15], s39 offen sc1 lds
    buffer_load_dwordx4 v2, s[12:15], s39 offen offset:1024 sc1 lds
    s_add_u32 s19, s41, s42
    v_readlane_b32 s16, v248, s44
    s_nop 0
    s_add_u32 s16, s16, s38
    s_add_u32 s44, s44, 1
    s_and_b32 s44, s44, 15
    s_add_u32 s42, s42, 16384
    s_cmp_eq_u32 s42, 49152
    s_cselect_b32 s42, 0, s42
    s_add_u32 m0, m0, 2048
    s_add_u32 s39, s39, 65536
    buffer_load_dwordx4 v2, s[12:15], s39 offen sc1 lds
    buffer_load_dwordx4 v2, s[12:15], s39 offen offset:1024 sc1 lds
    s_add_u32 m0, m0, 2048
    s_add_u32 s39, s39, 65536
    buffer_load_dwordx4 v2, s[12:15], s39 offen sc1 lds
    buffer_load_dwordx4 v2, s[12:15], s39 offen offset:1024 sc1 lds
    s_add_u32 m0, m0, 2048
    s_add_u32 s39, s39, 65536
    buffer_load_dwordx4 v2, s[12:15], s39 offen sc1 lds
    buffer_load_dwordx4 v2, s[12:15], s39 offen offset:1024 sc1 lds
    s_mov_b32 m0, s19
    s_mov_b32 s39, s16
    s_waitcnt vmcnt(16)
    s_cmp_lg_u32 s60, 0
    s_cbranch_scc1 pc_42
    v_add_f32 v180, v180, v184
    v_add_f32 v181, v181, v185
    v_add_f32 v182, v182, v186
    v_add_f32 v183, v183, v187
    v_add_f32 v180, v180, v188
    v_add_f32 v181, v181, v189
    v_add_f32 v182, v182, v190
    v_add_f32 v183, v183, v191
    v_add_f32 v180, v180, v192
    v_add_f32 v181, v181, v193
    v_add_f32 v182, v182, v194
    v_add_f32 v183, v183, v195
    v_add_f32 v180, v180, v196
    v_add_f32 v181, v181, v197
    v_add_f32 v182, v182, v198
    v_add_f32 v183, v183, v199
pc_42:
    s_mov_b64 exec, 1
    buffer_load_dword v223, v222, s[56:59], 0 offen sc1
    s_mov_b64 exec, -1
    s_waitcnt vmcnt(9)
    s_barrier
    buffer_load_dwordx4 v2, s[12:15], s39 offen sc1 lds
    buffer_load_dwordx4 v2, s[12:15], s39 offen offset:1024 sc1 lds
    s_add_u32 s19, s41, s42
    v_readlane_b32 s16, v248, s44
    s_nop 0
    s_add_u32 s16, s16, s38
    s_add_u32 s44, s44, 1
    s_and_b32 s44, s44, 15
    s_add_u32 s42, s42, 16384
    s_cmp_eq_u32 s42, 49152
    s_cselect_b32 s42, 0, s42
    s_add_u32 m0, m0, 2048
    s_add_u32 s39, s39, 65536
    buffer_load_dwordx4 v2, s[12:15], s39 offen sc1 lds
    buffer_load_dwordx4 v2, s[12:15], s39 offen offset:1024 sc1 lds
    s_add_u32 m0, m0, 2048
    s_add_u32 s39, s39, 65536
    buffer_load_dwordx4 v2, s[12:15], s39 offen sc1 lds
    buffer_load_dwordx4 v2, s[12:15], s39 offen offset:1024 sc1 lds
    s_add_u32 m0, m0, 2048
    s_add_u32 s39, s39, 65536
    buffer_load_dwordx4 v2, s[12:15], s39 offen sc1 lds
    buffer_load_dwordx4 v2, s[12:15], s39 offen offset:1024 sc1 lds
    s_mov_b32 m0, s19
    s_mov_b32 s39, s16
    s_cmp_lg_u32 s60, 0
    s_cbranch_scc1 pc_43
    v_add_f32 v180, v180, v200
    v_add_f32 v181, v181, v201
    v_add_f32 v182, v182, v202
    v_add_f32 v183, v183, v203
    v_add_f32 v180, v180, v204
    v_add_f32 v181, v181, v205
    v_add_f32 v182, v182, v206
    v_add_f32 v183, v183, v207
    v_add_f32 v180, v180, v208
    v_add_f32 v181, v181, v209
    v_add_f32 v182, v182, v210
    v_add_f32 v183, v183, v211
    v_add_f32 v180, v180, v212
    v_add_f32 v181, v181, v213
    v_add_f32 v182, v182, v214
    v_add_f32 v183, v183, v215
pc_43:
    buffer_load_dwordx4 v[184:187], v224, s[24:27], s37 offen sc1
    s_add_u32 s37, s37, 28672
    buffer_load_dwordx4 v[188:191], v224, s[24:27], s37 offen sc1
    s_add_u32 s37, s37, 28672
    buffer_load_dwordx4 v[192:195], v224, s[24:27], s37 offen sc1
    s_add_u32 s37, s37, 28672
    buffer_load_dwordx4 v[196:199], v224, s[24:27], s37 offen sc1
    s_add_u32 s37, s37, 28672
    buffer_load_dwordx4 v[200:203], v224, s[24:27], s37 offen sc1
    s_add_u32 s37, s37, 28672
    buffer_load_dwordx4 v[204:207], v224, s[24:27], s37 offen sc1
    s_add_u32 s37, s37, 28672
    buffer_load_dwordx4 v[208:211], v224, s[24:27], s37 offen sc1
    s_add_u32 s37, s37, 28672
    s_waitcnt vmcnt(16)
    s_barrier
    buffer_load_dwordx4 v2, s[12:15], s39 offen sc1 lds
    buffer_load_dwordx4 v2, s[12:15], s39 offen offset:1024 sc1 lds
    s_add_u32 s19, s41, s42
    v_readlane_b32 s16, v248, s44
    s_nop 0
    s_add_u32 s16, s16, s38
    s_add_u32 s44, s44, 1
    s_and_b32 s44, s44, 15
    s_add_u32 s42, s42, 16384
    s_cmp_eq_u32 s42, 49152
    s_cselect_b32 s42, 0, s42
    s_add_u32 m0, m0, 2048
    s_add_u32 s39, s39, 65536
    buffer_load_dwordx4 v2, s[12:15], s39 offen sc1 lds
    buffer_load_dwordx4 v2, s[12:15], s39 offen offset:1024 sc1 lds
    s_add_u32 m0, m0, 2048
    s_add_u32 s39, s39, 65536
    buffer_load_dwordx4 v2, s[12:15], s39 offen sc1 lds
    buffer_load_dwordx4 v2, s[12:15], s39 offen offset:1024 sc1 lds
    s_add_u32 m0, m0, 2048
    s_add_u32 s39, s39, 65536
    buffer_load_dwordx4 v2, s[12:15], s39 offen sc1 lds
    buffer_load_dwordx4 v2, s[12:15], s39 offen offset:1024 sc1 lds
    s_mov_b32 m0, s19
    s_mov_b32 s39, s16
    s_waitcnt vmcnt(23)
    v_readfirstlane_b32 s53, v223
    s_add_u32 s54, s52, 16
    s_cmp_eq_u32 s53, s54
    s_cbranch_scc1 fok_44
    s_mov_b32 s53, 0
    s_add_u32 s54, s52, 16
    s_bfm_b64 exec, 1, 0
poll_45:
    buffer_load_dword v223, v222, s[56:59], 0 offen sc1
    s_waitcnt vmcnt(0)
    v_xor_b32 v223, s54, v223
    v_cmp_eq_u32 vcc, 0, v223
    s_nop 0
    s_cmp_eq_u64 vcc, exec
    s_cbranch_scc1 pok_46
    s_sleep 5
    s_add_u32 s53, s53, 1
    s_cmp_lt_u32 s53, s61
    s_cbranch_scc1 poll_45
    s_mov_b32 s61, 0
pok_46:
    s_mov_b64 exec, -1
fok_44:
    s_add_u32 s20, s62, 0x5c8000
    s_addc_u32 s21, s63, 0
    s_mov_b32 s22, 0x6000
    s_mov_b32 s23, 0x20000
    s_and_b32 s35, s30, 1
    s_lshl_b32 s35, s35, 9
    s_add_u32 s36, s35, 0
    buffer_load_dwordx2 v[16:17], v221, s[20:23], s36 offen offset:0 sc1
    buffer_load_dwordx2 v[18:19], v221, s[20:23], s36 offen offset:1024 sc1
    buffer_load_dwordx2 v[20:21], v221, s[20:23], s36 offen offset:2048 sc1
    buffer_load_dwordx2 v[22:23], v221, s[20:23], s36 offen offset:3072 sc1
    s_add_u32 s36, s36, 4096
    buffer_load_dwordx2 v[24:25], v221, s[20:23], s36 offen offset:0 sc1
    buffer_load_dwordx2 v[26:27], v221, s[20:23], s36 offen offset:1024 sc1
    buffer_load_dwordx2 v[28:29], v221, s[20:23], s36 offen offset:2048 sc1
    buffer_load_dwordx2 v[30:31], v221, s[20:23], s36 offen offset:3072 sc1
    s_waitcnt vmcnt(23)
    s_barrier
    buffer_load_dwordx4 v2, s[12:15], s39 offen sc1 lds
    buffer_load_dwordx4 v2, s[12:15], s39 offen offset:1024 sc1 lds
    s_add_u32 s19, s41, s42
    v_readlane_b32 s16, v248, s44
    s_nop 0
    s_add_u32 s16, s16, s38
    s_add_u32 s44, s44, 1
    s_and_b32 s44, s44, 15
    s_add_u32 s42, s42, 16384
    s_cmp_eq_u32 s42, 49152
    s_cselect_b32 s42, 0, s42
    s_add_u32 m0, m0, 2048
    s_add_u32 s39, s39, 65536
    buffer_load_dwordx4 v2, s[12:15], s39 offen sc1 lds
    buffer_load_dwordx4 v2, s[12:15], s39 offen offset:1024 sc1 lds
    s_add_u32 m0, m0, 2048
    s_add_u32 s39, s39, 65536
    buffer_load_dwordx4 v2, s[12:15], s39 offen sc1 lds
    buffer_load_dwordx4 v2, s[12:15], s39 offen offset:1024 sc1 lds
    s_add_u32 m0, m0, 2048
    s_add_u32 s39, s39, 65536
    buffer_load_dwordx4 v2, s[12:15], s39 offen sc1 lds
    buffer_load_dwordx4 v2, s[12:15], s39 offen offset:1024 sc1 lds
    s_mov_b32 m0, s19
    s_mov_b32 s39, s16
    s_add_u32 s36, s35, 16384
    buffer_load_dwordx2 v[32:33], v221, s[20:23], s36 offen offset:0 sc1
    buffer_load_dwordx2 v[34:35], v221, s[20:23], s36 offen offset:1024 sc1
    buffer_load_dwordx2 v[36:37], v221, s[20:23], s36 offen offset:2048 sc1
    buffer_load_dwordx2 v[38:39], v221, s[20:23], s36 offen offset:3072 sc1
    s_add_u32 s36, s36, 4096
    buffer_load_dwordx2 v[40:41], v221, s[20:23], s36 offen offset:0 sc1
    buffer_load_dwordx2 v[42:43], v221, s[20:23], s36 offen offset:1024 sc1
    buffer_load_dwordx2 v[44:45], v221, s[20:23], s36 offen offset:2048 sc1
    buffer_load_dwordx2 v[46:47], v221, s[20:23], s36 offen offset:3072 sc1
    s_waitcnt vmcnt(24)
    s_barrier
    buffer_load_dwordx4 v2, s[12:15], s39 offen sc1 lds
    buffer_load_dwordx4 v2, s[12:15], s39 offen offset:1024 sc1 lds
    s_add_u32 s19, s41, s42
    v_readlane_b32 s16, v248, s44
    s_nop 0
    s_add_u32 s16, s16, s38
    s_add_u32 s44, s44, 1
    s_and_b32 s44, s44, 15
    s_add_u32 s42, s42, 16384
    s_cmp_eq_u32 s42, 49152
    s_cselect_b32 s42, 0, s42
    s_add_u32 m0, m0, 2048
    s_add_u32 s39, s39, 65536
    buffer_load_dwordx4 v2, s[12:15], s39 offen sc1 lds
    buffer_load_dwordx4 v2, s[12:15], s39 offen offset:1024 sc1 lds
    s_add_u32 m0, m0, 2048
    s_add_u32 s39, s39, 65536
    buffer_load_dwordx4 v2, s[12:15], s39 offen sc1 lds
    buffer_load_dwordx4 v2, s[12:15], s39 offen offset:1024 sc1 lds
    s_add_u32 m0, m0, 2048
    s_add_u32 s39, s39, 65536
    buffer_load_dwordx4 v2, s[12:15], s39 offen sc1 lds
    buffer_load_dwordx4 v2, s[12:15], s39 offen offset:1024 sc1 lds
    s_mov_b32 m0, s19
    s_mov_b32 s39, s16
    s_waitcnt vmcnt(40)
    s_cmp_lg_u32 s60, 0
    s_cbranch_scc1 pc_47
    v_add_f32 v180, v180, v184
    v_add_f32 v181, v181, v185
    v_add_f32 v182, v182, v186
    v_add_f32 v183, v183, v187
    v_add_f32 v180, v180, v188
    v_add_f32 v181, v181, v189
    v_add_f32 v182, v182, v190
    v_add_f32 v183, v183, v191
    v_add_f32 v180, v180, v192
    v_add_f32 v181, v181, v193
    v_add_f32 v182, v182, v194
    v_add_f32 v183, v183, v195
    v_add_f32 v180, v180, v196
    v_add_f32 v181, v181, v197
    v_add_f32 v182, v182, v198
    v_add_f32 v183, v183, v199
pc_47:
    s_waitcnt vmcnt(16)
    s_barrier
    buffer_load_dwordx4 v2, s[12:15], s39 offen sc1 lds
    buffer_load_dwordx4 v2, s[12:15], s39 offen offset:1024 sc1 lds
    s_add_u32 s19, s41, s42
    v_readlane_b32 s16, v248, s44
    s_nop 0
    s_add_u32 s16, s16, s38
    s_add_u32 s44, s44, 1
    s_and_b32 s44, s44, 15
    s_add_u32 s42, s42, 16384
    s_cmp_eq_u32 s42, 49152
    s_cselect_b32 s42, 0, s42
    s_add_u32 m0, m0, 2048
    s_add_u32 s39, s39, 65536
    buffer_load_dwordx4 v2, s[12:15], s39 offen sc1 lds
    buffer_load_dwordx4 v2, s[12:15], s39 offen offset:1024 sc1 lds
    s_add_u32 m0, m0, 2048
    s_add_u32 s39, s39, 65536
    buffer_load_dwordx4 v2, s[12:15], s39 offen sc1 lds
    buffer_load_dwordx4 v2, s[12:15], s39 offen offset:1024 sc1 lds
    s_add_u32 m0, m0, 2048
    s_add_u32 s39, s39, 65536
    buffer_load_dwordx4 v2, s[12:15], s39 offen sc1 lds
    buffer_load_dwordx4 v2, s[12:15], s39 offen offset:1024 sc1 lds
    s_mov_b32 m0, s19
    s_mov_b32 s39, s16
    s_cmp_lg_u32 s60, 0
    s_cbranch_scc1 pc_48
    v_add_f32 v180, v180, v200
    v_add_f32 v181, v181, v201
    v_add_f32 v182, v182, v202
    v_add_f32 v183, v183, v203
    v_add_f32 v180, v180, v204
    v_add_f32 v181, v181, v205
    v_add_f32 v182, v182, v206
    v_add_f32 v183, v183, v207
    v_add_f32 v180, v180, v208
    v_add_f32 v181, v181, v209
    v_add_f32 v182, v182, v210
    v_add_f32 v183, v183, v211
pc_48:
    s_waitcnt vmcnt(8)
    s_barrier
    buffer_load_dwordx4 v2, s[12:15], s39 offen sc1 lds
    buffer_load_dwordx4 v2, s[12:15], s39 offen offset:1024 sc1 lds
    s_add_u32 s19, s41, s42
    v_readlane_b32 s16, v248, s44
    s_nop 0
    s_add_u32 s16, s16, s38
    s_add_u32 s44, s44, 1
    s_and_b32 s44, s44, 15
    s_add_u32 s42, s42, 16384
    s_cmp_eq_u32 s42, 49152
    s_cselect_b32 s42, 0, s42
    s_add_u32 m0, m0, 2048
    s_add_u32 s39, s39, 65536
    buffer_load_dwordx4 v2, s[12:15], s39 offen sc1 lds
    buffer_load_dwordx4 v2, s[12:15], s39 offen offset:1024 sc1 lds
    s_add_u32 m0, m0, 2048
    s_add_u32 s39, s39, 65536
    buffer_load_dwordx4 v2, s[12:15], s39 offen sc1 lds
    buffer_load_dwordx4 v2, s[12:15], s39 offen offset:1024 sc1 lds
    s_add_u32 m0, m0, 2048
    s_add_u32 s39, s39, 65536
    buffer_load_dwordx4 v2, s[12:15], s39 offen sc1 lds
    buffer_load_dwordx4 v2, s[12:15], s39 offen offset:1024 sc1 lds
    s_mov_b32 m0, s19
    s_mov_b32 s39, s16
    s_cmp_lg_u32 s60, 0
    s_cbranch_scc1 pc_49
    v_mov_b32 v184, v180
    v_mov_b32 v185, v181
    v_mov_b32 v186, v182
    v_mov_b32 v187, v183
    v_permlane32_swap_b32 v180, v184
    v_permlane32_swap_b32 v181, v185
    v_permlane32_swap_b32 v182, v186
    v_permlane32_swap_b32 v183, v187
    v_add_f32 v180, v180, v184
    v_add_f32 v181, v181, v185
    v_add_f32 v182, v182, v186
    v_add_f32 v183, v183, v187
    s_and_b32 s36, s30, 1
    s_mul_i32 s36, s36, 448
    s_add_u32 s36, s36, 159744
    v_add_u32 v179, s36, v2
    s_bfm_b64 exec, 28, 0
    ds_write_b128 v179, v[180:183]
    s_mov_b64 exec, -1
    s_waitcnt lgkmcnt(0)
pc_49:
    s_waitcnt vmcnt(8)
    s_barrier
    buffer_load_dwordx4 v2, s[12:15], s39 offen sc1 lds
    buffer_load_dwordx4 v2, s[12:15], s39 offen offset:1024 sc1 lds
    s_add_u32 s19, s41, s42
    v_readlane_b32 s16, v248, s44
    s_nop 0
    s_add_u32 s16, s16, s38
    s_add_u32 s44, s44, 1
    s_and_b32 s44, s44, 15
    s_add_u32 s42, s42, 16384
    s_cmp_eq_u32 s42, 49152
    s_cselect_b32 s42, 0, s42
    s_add_u32 m0, m0, 2048
    s_add_u32 s39, s39, 65536
    buffer_load_dwordx4 v2, s[12:15], s39 offen sc1 lds
    buffer_load_dwordx4 v2, s[12:15], s39 offen offset:1024 sc1 lds
    s_add_u32 m0, m0, 2048
    s_add_u32 s39, s39, 65536
    buffer_load_dwordx4 v2, s[12:15], s39 offen sc1 lds
    buffer_load_dwordx4 v2, s[12:15], s39 offen offset:1024 sc1 lds
    s_add_u32 m0, m0, 2048
    s_add_u32 s39, s39, 65536
    buffer_load_dwordx4 v2, s[12:15], s39 offen sc1 lds
    buffer_load_dwordx4 v2, s[12:15], s39 offen offset:1024 sc1 lds
    s_mov_b32 m0, s19
    s_mov_b32 s39, s16
    s_waitcnt vmcnt(32)
    v_add_f32 v16, v16, v32
    v_add_f32 v17, v17, v33
    v_add_f32 v18, v18, v34
    v_add_f32 v19, v19, v35
    v_add_f32 v20, v20, v36
    v_add_f32 v21, v21, v37
    v_add_f32 v22, v22, v38
    v_add_f32 v23, v23, v39
    v_add_f32 v24, v24, v40
    v_add_f32 v25, v25, v41
    v_add_f32 v26, v26, v42
    v_add_f32 v27, v27, v43
    v_add_f32 v28, v28, v44
    v_add_f32 v29, v29, v45
    v_add_f32 v30, v30, v46
    v_add_f32 v31, v31, v47
    s_waitcnt vmcnt(8)
    s_barrier
    buffer_load_dwordx4 v2, s[12:15], s39 offen sc1 lds
    buffer_load_dwordx4 v2, s[12:15], s39 offen offset:1024 sc1 lds
    s_add_u32 s19, s41, s42
    v_readlane_b32 s16, v248, s44
    s_nop 0
    s_add_u32 s16, s16, s38
    s_add_u32 s44, s44, 1
    s_and_b32 s44, s44, 15
    s_add_u32 s42, s42, 16384
    s_cmp_eq_u32 s42, 49152
    s_cselect_b32 s42, 0, s42
    s_add_u32 m0, m0, 2048
    s_add_u32 s39, s39, 65536
    buffer_load_dwordx4 v2, s[12:15], s39 offen sc1 lds
    buffer_load_dwordx4 v2, s[12:15], s39 offen offset:1024 sc1 lds
    s_add_u32 m0, m0, 2048
    s_add_u32 s39, s39, 65536
    buffer_load_dwordx4 v2, s[12:15], s39 offen sc1 lds
    buffer_load_dwordx4 v2, s[12:15], s39 offen offset:1024 sc1 lds
    s_add_u32 m0, m0, 2048
    s_add_u32 s39, s39, 65536
    buffer_load_dwordx4 v2, s[12:15], s39 offen sc1 lds
    buffer_load_dwordx4 v2, s[12:15], s39 offen offset:1024 sc1 lds
    s_mov_b32 m0, s19
    s_mov_b32 s39, s16
    v_add_f32 v16, v16, v24
    v_add_f32 v17, v17, v25
    v_add_f32 v18, v18, v26
    v_add_f32 v19, v19, v27
    v_add_f32 v20, v20, v28
    v_add_f32 v21, v21, v29
    v_add_f32 v22, v22, v30
    v_add_f32 v23, v23, v31
    v_add_f32 v16, v16, v20
    v_add_f32 v17, v17, v21
    v_add_f32 v18, v18, v22
    v_add_f32 v19, v19, v23
    v_add_f32 v16, v16, v18
    v_add_f32 v17, v17, v19
    v_mul_f32 v20, 0x3a800000, v16
    v_mul_f32 v217, 0x3a800000, v17
    s_waitcnt vmcnt(8)
    s_barrier
    buffer_load_dwordx4 v2, s[12:15], s39 offen sc1 lds
    buffer_load_dwordx4 v2, s[12:15], s39 offen offset:1024 sc1 lds
    s_add_u32 m0, m0, 2048
    s_add_u32 s39, s39, 65536
    buffer_load_dwordx4 v2, s[12:15], s39 offen sc1 lds
    buffer_load_dwordx4 v2, s[12:15], s39 offen offset:1024 sc1 lds
    s_add_u32 m0, m0, 2048
    s_add_u32 s39, s39, 65536
    buffer_load_dwordx4 v2, s[12:15], s39 offen sc1 lds
    buffer_load_dwordx4 v2, s[12:15], s39 offen offset:1024 sc1 lds
    s_add_u32 m0, m0, 2048
    s_add_u32 s39, s39, 65536
    buffer_load_dwordx4 v2, s[12:15], s39 offen sc1 lds
    buffer_load_dwordx4 v2, s[12:15], s39 offen offset:1024 sc1 lds
    v_fma_f32 v217, -v20, v20, v217
    v_max_f32 v217, 0, v217
    v_add_f32 v217, 0x3727c5ac, v217
    v_sqrt_f32 v217, v217
    s_nop 0
    v_mov_b32 v21, v217
    v_rcp_f32 v219, v217
    s_nop 0
    v_mul_f32 v22, 0xc0135761, v219
    v_mul_f32 v23, v219, v219
    v_mul_f32 v23, v23, v22
    v_mul_f32 v23, 0x3d372713, v23
    s_lshl_b32 s35, s35, 1
    s_add_u32 s35, s35, 160768
    v_add_u32 v220, s35, v2
    ds_write_b128 v220, v[20:23]
    s_waitcnt lgkmcnt(0)
    s_waitcnt vmcnt(8)
    s_barrier
    s_call_b64 s[76:77], SUB_r_pre0
    s_waitcnt vmcnt(4)
    s_barrier
    s_cmp_lg_u32 s60, 0
    s_cbranch_scc1 tw4_53
    s_load_dwordx2 s[48:49], s[0:1], 80
    s_lshl_b32 s45, s2, 1
    s_and_b32 s50, s30, 1
    s_add_u32 s45, s45, s50
    s_mul_i32 s45, s45, 14336
    s_mov_b32 s50, 7340032
    s_mov_b32 s51, 0x20000
    s_waitcnt lgkmcnt(0)
    buffer_load_dwordx4 v[20:23], v2, s[48:51], s45 offen offset:0
    buffer_load_dwordx4 v[20:23], v2, s[48:51], s45 offen offset:1024
    buffer_load_dwordx4 v[20:23], v2, s[48:51], s45 offen offset:2048
    buffer_load_dwordx4 v[20:23], v2, s[48:51], s45 offen offset:3072
    s_add_u32 s45, s45, 4096
    buffer_load_dwordx4 v[20:23], v2, s[48:51], s45 offen offset:0
    buffer_load_dwordx4 v[20:23], v2, s[48:51], s45 offen offset:1024
    buffer_load_dwordx4 v[20:23], v2, s[48:51], s45 offen offset:2048
    buffer_load_dwordx4 v[20:23], v2, s[48:51], s45 offen offset:3072
    s_add_u32 s45, s45, 4096
    buffer_load_dwordx4 v[20:23], v2, s[48:51], s45 offen offset:0
    buffer_load_dwordx4 v[20:23], v2, s[48:51], s45 offen offset:1024
    buffer_load_dwordx4 v[20:23], v2, s[48:51], s45 offen offset:2048
    buffer_load_dwordx4 v[20:23], v2, s[48:51], s45 offen offset:3072
    s_add_u32 s45, s45, 4096
    buffer_load_dwordx4 v[20:23], v2, s[48:51], s45 offen offset:0
    buffer_load_dwordx4 v[20:23], v2, s[48:51], s45 offen offset:1024
tw4_53:
    s_barrier
    s_and_b32 s35, s30, 1
    s_add_u32 s12, s62, 0x400000
    s_addc_u32 s13, s63, 0
    s_mov_b32 s14, 0x1be000
    s_mov_b32 s15, 0x20000
    s_mul_i32 s38, s35, 917504
    s_mul_i32 s36, s31, 114688
    s_add_u32 s38, s38, s36
    s_lshl_b32 s41, s35, 13
    s_mov_b32 s42, 0
    s_mov_b32 s44, 0
    s_add_u32 s54, s55, 0x700
    s_lshl_b32 s53, s31, 7
    s_add_u32 s54, s54, s53
    v_mov_b32 v9, s54
    s_add_u32 s54, s55, 0x600
    s_lshl_b32 s53, s31, 7
    s_add_u32 s54, s54, s53
    v_mov_b32 v10, s54
    s_add_u32 s54, s55, 0x300
    s_lshl_b32 s53, s31, 7
    s_add_u32 s54, s54, s53
    v_mov_b32 v12, s54
    v_mov_b32 v13, 1
    s_and_b32 s51, s30, 1
    s_lshl_b32 s51, s51, 30
    s_lshl_b32 s54, s60, 2
    s_add_u32 s54, s54, 4
    v_mov_b32 v14, 162880
spin_54:
    s_sleep 2
    ds_read_b32 v15, v14
    s_waitcnt lgkmcnt(0)
    v_readfirstlane_b32 s53, v15
    s_nop 0
    s_cmp_ge_u32 s53, s54
    s_cbranch_scc0 spin_54
    s_mov_b64 exec, 1
    buffer_atomic_add v13, v9, s[56:59], s51 offen sc1
    s_mov_b64 exec, -1
    v_xor_b32 v15, 128, v12
    s_mov_b32 s44, 3
    s_call_b64 s[76:77], PREP_a_issue_4
    s_mov_b32 m0, s19
    s_mov_b32 s39, s16
    s_mov_b32 s40, s17
    s_waitcnt vmcnt(16)
    s_barrier
    s_mov_b64 exec, 1
    buffer_load_dword v8, v9, s[56:59], 0 offen sc1
    s_mov_b64 exec, -1
    s_waitcnt vmcnt(9)
    s_barrier
    s_waitcnt vmcnt(0)
    v_readfirstlane_b32 s53, v8
    s_add_u32 s54, s52, 8
    s_cmp_eq_u32 s53, s54
    s_cbranch_scc1 fok_55
    s_mov_b32 s53, 0
    s_add_u32 s54, s52, 8
    s_bfm_b64 exec, 1, 0
poll_56:
    buffer_load_dword v8, v9, s[56:59], 0 offen sc1
    s_waitcnt vmcnt(0)
    v_xor_b32 v8, s54, v8
    v_cmp_eq_u32 vcc, 0, v8
    s_nop 0
    s_cmp_eq_u64 vcc, exec
    s_cbranch_scc1 pok_57
    s_sleep 5
    s_add_u32 s53, s53, 1
    s_cmp_lt_u32 s53, s61
    s_cbranch_scc1 poll_56
    s_mov_b32 s61, 0
pok_57:
    s_mov_b64 exec, -1
fok_55:
    buffer_load_dwordx4 v2, s[12:15], s39 offen sc1 lds
    s_add_u32 m0, m0, 1024
    s_nop 0
    buffer_load_dwordx4 v2, s[12:15], s40 offen sc1 lds
    s_call_b64 s[76:77], PREP_a_issue_4
    s_add_u32 m0, m0, 1024
    s_add_u32 s39, s39, 229376
    buffer_load_dwordx4 v2, s[12:15], s39 offen sc1 lds
    s_add_u32 m0, m0, 1024
    s_add_u32 s40, s40, 229376
    buffer_load_dwordx4 v2, s[12:15], s40 offen sc1 lds
    s_add_u32 m0, m0, 1024
    s_add_u32 s39, s39, 229376
    buffer_load_dwordx4 v2, s[12:15], s39 offen sc1 lds
    s_add_u32 m0, m0, 1024
    s_add_u32 s40, s40, 229376
    buffer_load_dwordx4 v2, s[12:15], s40 offen sc1 lds
    s_add_u32 m0, m0, 1024
    s_add_u32 s39, s39, 229376
    buffer_load_dwordx4 v2, s[12:15], s39 offen sc1 lds
    s_add_u32 m0, m0, 1024
    s_add_u32 s40, s40, 229376
    buffer_load_dwordx4 v2, s[12:15], s40 offen sc1 lds
    s_mov_b32 m0, s19
    s_mov_b32 s39, s16
    s_mov_b32 s40, s17
    s_waitcnt vmcnt(9)
    s_barrier
    s_mov_b64 exec, 1
    buffer_atomic_add v13, v10, s[56:59], s51 offen sc1
    s_mov_b64 exec, -1
    buffer_load_dwordx4 v2, s[12:15], s39 offen sc1 lds
    s_add_u32 m0, m0, 1024
    s_nop 0
    buffer_load_dwordx4 v2, s[12:15], s40 offen sc1 lds
    s_call_b64 s[76:77], PREP_a_issue_4
    s_add_u32 m0, m0, 1024
    s_add_u32 s39, s39, 229376
    buffer_load_dwordx4 v2, s[12:15], s39 offen sc1 lds
    s_add_u32 m0, m0, 1024
    s_add_u32 s40, s40, 229376
    buffer_load_dwordx4 v2, s[12:15], s40 offen sc1 lds
    s_add_u32 m0, m0, 1024
    s_add_u32 s39, s39, 229376
    buffer_load_dwordx4 v2, s[12:15], s39 offen sc1 lds
    s_add_u32 m0, m0, 1024
    s_add_u32 s40, s40, 229376
    buffer_load_dwordx4 v2, s[12:15], s40 offen sc1 lds
    s_add_u32 m0, m0, 1024
    s_add_u32 s39, s39, 229376
    buffer_load_dwordx4 v2, s[12:15], s39 offen sc1 lds
    s_add_u32 m0, m0, 1024
    s_add_u32 s40, s40, 229376
    buffer_load_dwordx4 v2, s[12:15], s40 offen sc1 lds
    s_mov_b32 m0, s19
    s_mov_b32 s39, s16
    s_mov_b32 s40, s17
    s_waitcnt vmcnt(9)
    s_barrier
    buffer_load_dwordx4 v2, s[12:15], s39 offen sc1 lds
    s_add_u32 m0, m0, 1024
    s_nop 0
    buffer_load_dwordx4 v2, s[12:15], s40 offen sc1 lds
    s_call_b64 s[76:77], PREP_a_issue_4
    s_add_u32 m0, m0, 1024
    s_add_u32 s39, s39, 229376
    buffer_load_dwordx4 v2, s[12:15], s39 offen sc1 lds
    s_add_u32 m0, m0, 1024
    s_add_u32 s40, s40, 229376
    buffer_load_dwordx4 v2, s[12:15], s40 offen sc1 lds
    s_add_u32 m0, m0, 1024
    s_add_u32 s39, s39, 229376
    buffer_load_dwordx4 v2, s[12:15], s39 offen sc1 lds
    s_add_u32 m0, m0, 1024
    s_add_u32 s40, s40, 229376
    buffer_load_dwordx4 v2, s[12:15], s40 offen sc1 lds
    s_add_u32 m0, m0, 1024
    s_add_u32 s39, s39, 229376
    buffer_load_dwordx4 v2, s[12:15], s39 offen sc1 lds
    s_add_u32 m0, m0, 1024
    s_add_u32 s40, s40, 229376
    buffer_load_dwordx4 v2, s[12:15], s40 offen sc1 lds
    s_mov_b32 m0, s19
    s_mov_b32 s39, s16
    s_mov_b32 s40, s17
    s_waitcnt vmcnt(8)
    s_barrier
    buffer_load_dwordx4 v2, s[12:15], s39 offen sc1 lds
    s_add_u32 m0, m0, 1024
    s_nop 0
    buffer_load_dwordx4 v2, s[12:15], s40 offen sc1 lds
    s_mov_b64 exec, 1
    buffer_load_dword v11, v10, s[56:59], 0 offen sc1
    s_mov_b64 exec, -1
    s_call_b64 s[76:77], PREP_a_issue_4
    s_add_u32 m0, m0, 1024
    s_add_u32 s39, s39, 229376
    buffer_load_dwordx4 v2, s[12:15], s39 offen sc1 lds
    s_add_u32 m0, m0, 1024
    s_add_u32 s40, s40, 229376
    buffer_load_dwordx4 v2, s[12:15], s40 offen sc1 lds
    s_add_u32 m0, m0, 1024
    s_add_u32 s39, s39, 229376
    buffer_load_dwordx4 v2, s[12:15], s39 offen sc1 lds
    s_add_u32 m0, m0, 1024
    s_add_u32 s40, s40, 229376
    buffer_load_dwordx4 v2, s[12:15], s40 offen sc1 lds
    s_add_u32 m0, m0, 1024
    s_add_u32 s39, s39, 229376
    buffer_load_dwordx4 v2, s[12:15], s39 offen sc1 lds
    s_add_u32 m0, m0, 1024
    s_add_u32 s40, s40, 229376
    buffer_load_dwordx4 v2, s[12:15], s40 offen sc1 lds
    s_mov_b32 m0, s19
    s_mov_b32 s39, s16
    s_mov_b32 s40, s17
    s_waitcnt vmcnt(9)
    s_barrier
    s_mov_b64 exec, 1
    buffer_atomic_add v13, v12, s[56:59], s51 offen sc1
    s_mov_b64 exec, -1
    buffer_load_dwordx4 v2, s[12:15], s39 offen sc1 lds
    s_add_u32 m0, m0, 1024
    s_nop 0
    buffer_load_dwordx4 v2, s[12:15], s40 offen sc1 lds
    s_call_b64 s[76:77], PREP_a_issue_4
    s_add_u32 m0, m0, 1024
    s_add_u32 s39, s39, 229376
    buffer_load_dwordx4 v2, s[12:15], s39 offen sc1 lds
    s_add_u32 m0, m0, 1024
    s_add_u32 s40, s40, 229376
    buffer_load_dwordx4 v2, s[12:15], s40 offen sc1 lds
    s_add_u32 m0, m0, 1024
    s_add_u32 s39, s39, 229376
    buffer_load_dwordx4 v2, s[12:15], s39 offen sc1 lds
    s_add_u32 m0, m0, 1024
    s_add_u32 s40, s40, 229376
    buffer_load_dwordx4 v2, s[12:15], s40 offen sc1 lds
    s_add_u32 m0, m0, 1024
    s_add_u32 s39, s39, 229376
    buffer_load_dwordx4 v2, s[12:15], s39 offen sc1 lds
    s_add_u32 m0, m0, 1024
    s_add_u32 s40, s40, 229376
    buffer_load_dwordx4 v2, s[12:15], s40 offen sc1 lds
    s_mov_b32 m0, s19
    s_mov_b32 s39, s16
    s_mov_b32 s40, s17
    s_waitcnt vmcnt(9)
    s_barrier
    buffer_load_dwordx4 v2, s[12:15], s39 offen sc1 lds
    s_add_u32 m0, m0, 1024
    s_nop 0
    buffer_load_dwordx4 v2, s[12:15], s40 offen sc1 lds
    s_waitcnt vmcnt(17)
    v_readfirstlane_b32 s53, v11
    s_add_u32 s54, s52, 8
    s_cmp_eq_u32 s53, s54
    s_cbranch_scc1 fok_58
    s_mov_b32 s53, 0
    s_add_u32 s54, s52, 8
    s_bfm_b64 exec, 1, 0
poll_59:
    buffer_load_dword v11, v10, s[56:59], 0 offen sc1
    s_waitcnt vmcnt(0)
    v_xor_b32 v11, s54, v11
    v_cmp_eq_u32 vcc, 0, v11
    s_nop 0
    s_cmp_eq_u64 vcc, exec
    s_cbranch_scc1 pok_60
    s_sleep 5
    s_add_u32 s53, s53, 1
    s_cmp_lt_u32 s53, s61
    s_cbranch_scc1 poll_59
    s_mov_b32 s61, 0
pok_60:
    s_mov_b64 exec, -1
fok_58:
    s_call_b64 s[76:77], PREP_a_issue_4
    s_add_u32 m0, m0, 1024
    s_add_u32 s39, s39, 229376
    buffer_load_dwordx4 v2, s[12:15], s39 offen sc1 lds
    s_add_u32 m0, m0, 1024
    s_add_u32 s40, s40, 229376
    buffer_load_dwordx4 v2, s[12:15], s40 offen sc1 lds
    s_add_u32 m0, m0, 1024
    s_add_u32 s39, s39, 229376
    buffer_load_dwordx4 v2, s[12:15], s39 offen sc1 lds
    s_add_u32 m0, m0, 1024
    s_add_u32 s40, s40, 229376
    buffer_load_dwordx4 v2, s[12:15], s40 offen sc1 lds
    s_add_u32 m0, m0, 1024
    s_add_u32 s39, s39, 229376
    buffer_load_dwordx4 v2, s[12:15], s39 offen sc1 lds
    s_add_u32 m0, m0, 1024
    s_add_u32 s40, s40, 229376
    buffer_load_dwordx4 v2, s[12:15], s40 offen sc1 lds
    s_mov_b32 m0, s19
    s_mov_b32 s39, s16
    s_mov_b32 s40, s17
    s_waitcnt vmcnt(8)
    s_barrier
    buffer_load_dwordx4 v2, s[12:15], s39 offen sc1 lds
    s_add_u32 m0, m0, 1024
    s_nop 0
    buffer_load_dwordx4 v2, s[12:15], s40 offen sc1 lds
    s_mov_b32 s43, 1
ld_61:
    s_add_u32 s19, s41, s42
    v_readlane_b32 s16, v249, s44
    v_readlane_b32 s17, v250, s44
    s_add_u32 s16, s16, s38
    s_add_u32 s17, s17, s38
    s_add_u32 s44, s44, 1
    s_add_u32 s42, s42, 16384
    s_cmp_eq_u32 s42, 49152
    s_cselect_b32 s42, 0, s42
    s_add_u32 m0, m0, 1024
    s_add_u32 s39, s39, 229376
    buffer_load_dwordx4 v2, s[12:15], s39 offen sc1 lds
    s_add_u32 m0, m0, 1024
    s_add_u32 s40, s40, 229376
    buffer_load_dwordx4 v2, s[12:15], s40 offen sc1 lds
    s_add_u32 m0, m0, 1024
    s_add_u32 s39, s39, 229376
    buffer_load_dwordx4 v2, s[12:15], s39 offen sc1 lds
    s_add_u32 m0, m0, 1024
    s_add_u32 s40, s40, 229376
    buffer_load_dwordx4 v2, s[12:15], s40 offen sc1 lds
    s_add_u32 m0, m0, 1024
    s_add_u32 s39, s39, 229376
    buffer_load_dwordx4 v2, s[12:15], s39 offen sc1 lds
    s_add_u32 m0, m0, 1024
    s_add_u32 s40, s40, 229376
    buffer_load_dwordx4 v2, s[12:15], s40 offen sc1 lds
    s_mov_b32 m0, s19
    s_mov_b32 s39, s16
    s_mov_b32 s40, s17
    s_waitcnt vmcnt(8)
    s_barrier
    buffer_load_dwordx4 v2, s[12:15], s39 offen sc1 lds
    s_add_u32 m0, m0, 1024
    s_nop 0
    buffer_load_dwordx4 v2, s[12:15], s40 offen sc1 lds
    s_add_u32 s43, s43, 1
    s_cmp_lt_u32 s43, 4
    s_cbranch_scc1 ld_61
    s_call_b64 s[76:77], PREP_a_issue_4
    s_add_u32 m0, m0, 1024
    s_add_u32 s39, s39, 229376
    buffer_load_dwordx4 v2, s[12:15], s39 offen sc1 lds
    s_add_u32 m0, m0, 1024
    s_add_u32 s40, s40, 229376
    buffer_load_dwordx4 v2, s[12:15], s40 offen sc1 lds
    s_add_u32 m0, m0, 1024
    s_add_u32 s39, s39, 229376
    buffer_load_dwordx4 v2, s[12:15], s39 offen sc1 lds
    s_add_u32 m0, m0, 1024
    s_add_u32 s40, s40, 229376
    buffer_load_dwordx4 v2, s[12:15], s40 offen sc1 lds
    s_add_u32 m0, m0, 1024
    s_add_u32 s39, s39, 229376
    buffer_load_dwordx4 v2, s[12:15], s39 offen sc1 lds
    s_add_u32 m0, m0, 1024
    s_add_u32 s40, s40, 229376
    buffer_load_dwordx4 v2, s[12:15], s40 offen sc1 lds
    s_mov_b32 m0, s19
    s_mov_b32 s39, s16
    s_mov_b32 s40, s17
    s_waitcnt vmcnt(8)
    s_barrier
    buffer_load_dwordx4 v2, s[12:15], s39 offen sc1 lds
    s_add_u32 m0, m0, 1024
    s_nop 0
    buffer_load_dwordx4 v2, s[12:15], s40 offen sc1 lds
    s_mov_b64 exec, 1
    buffer_load_dword v11, v12, s[56:59], 0 offen sc1
    s_mov_b64 exec, -1
    s_call_b64 s[76:77], PREP_a_issue_4
    s_add_u32 m0, m0, 1024
    s_add_u32 s39, s39, 229376
    buffer_load_dwordx4 v2, s[12:15], s39 offen sc1 lds
    s_add_u32 m0, m0, 1024
    s_add_u32 s40, s40, 229376
    buffer_load_dwordx4 v2, s[12:15], s40 offen sc1 lds
    s_add_u32 m0, m0, 1024
    s_add_u32 s39, s39, 229376
    buffer_load_dwordx4 v2, s[12:15], s39 offen sc1 lds
    s_add_u32 m0, m0, 1024
    s_add_u32 s40, s40, 229376
    buffer_load_dwordx4 v2, s[12:15], s40 offen sc1 lds
    s_add_u32 m0, m0, 1024
    s_add_u32 s39, s39, 229376
    buffer_load_dwordx4 v2, s[12:15], s39 offen sc1 lds
    s_add_u32 m0, m0, 1024
    s_add_u32 s40, s40, 229376
    buffer_load_dwordx4 v2, s[12:15], s40 offen sc1 lds
    s_mov_b32 m0, s19
    s_mov_b32 s39, s16
    s_mov_b32 s40, s17
    s_waitcnt vmcnt(9)
    s_barrier
    buffer_load_dwordx4 v2, s[12:15], s39 offen sc1 lds
    s_add_u32 m0, m0, 1024
    s_nop 0
    buffer_load_dwordx4 v2, s[12:15], s40 offen sc1 lds
    s_call_b64 s[76:77], PREP_a_issue_4
    s_add_u32 m0, m0, 1024
    s_add_u32 s39, s39, 229376
    buffer_load_dwordx4 v2, s[12:15], s39 offen sc1 lds
    s_add_u32 m0, m0, 1024
    s_add_u32 s40, s40, 229376
    buffer_load_dwordx4 v2, s[12:15], s40 offen sc1 lds
    s_add_u32 m0, m0, 1024
    s_add_u32 s39, s39, 229376
    buffer_load_dwordx4 v2, s[12:15], s39 offen sc1 lds
    s_add_u32 m0, m0, 1024
    s_add_u32 s40, s40, 229376
    buffer_load_dwordx4 v2, s[12:15], s40 offen sc1 lds
    s_add_u32 m0, m0, 1024
    s_add_u32 s39, s39, 229376
    buffer_load_dwordx4 v2, s[12:15], s39 offen sc1 lds
    s_add_u32 m0, m0, 1024
    s_add_u32 s40, s40, 229376
    buffer_load_dwordx4 v2, s[12:15], s40 offen sc1 lds
    s_mov_b32 m0, s19
    s_mov_b32 s39, s16
    s_mov_b32 s40, s17
    s_waitcnt vmcnt(8)
    s_barrier
    buffer_load_dwordx4 v2, s[12:15], s39 offen sc1 lds
    s_add_u32 m0, m0, 1024
    s_nop 0
    buffer_load_dwordx4 v2, s[12:15], s40 offen sc1 lds
    s_waitcnt vmcnt(16)
    v_readfirstlane_b32 s53, v11
    s_add_u32 s54, s52, 8
    s_cmp_eq_u32 s53, s54
    s_cbranch_scc1 fok_62
    s_mov_b32 s53, 0
    s_add_u32 s54, s52, 8
    s_bfm_b64 exec, 1, 0
poll_63:
    buffer_load_dword v11, v12, s[56:59], 0 offen sc1
    s_waitcnt vmcnt(0)
    v_xor_b32 v11, s54, v11
    v_cmp_eq_u32 vcc, 0, v11
    s_nop 0
    s_cmp_eq_u64 vcc, exec
    s_cbranch_scc1 pok_64
    s_sleep 5
    s_add_u32 s53, s53, 1
    s_cmp_lt_u32 s53, s61
    s_cbranch_scc1 poll_63
    s_mov_b32 s61, 0
pok_64:
    s_mov_b64 exec, -1
fok_62:
    s_call_b64 s[76:77], PREP_a_issue_4
    s_add_u32 m0, m0, 1024
    s_add_u32 s39, s39, 229376
    buffer_load_dwordx4 v2, s[12:15], s39 offen sc1 lds
    s_add_u32 m0, m0, 1024
    s_add_u32 s40, s40, 229376
    buffer_load_dwordx4 v2, s[12:15], s40 offen sc1 lds
    s_add_u32 m0, m0, 1024
    s_add_u32 s39, s39, 229376
    buffer_load_dwordx4 v2, s[12:15], s39 offen sc1 lds
    s_add_u32 m0, m0, 1024
    s_add_u32 s40, s40, 229376
    buffer_load_dwordx4 v2, s[12:15], s40 offen sc1 lds
    s_add_u32 m0, m0, 1024
    s_add_u32 s39, s39, 229376
    buffer_load_dwordx4 v2, s[12:15], s39 offen sc1 lds
    s_add_u32 m0, m0, 1024
    s_add_u32 s40, s40, 229376
    buffer_load_dwordx4 v2, s[12:15], s40 offen sc1 lds
    s_mov_b32 m0, s19
    s_mov_b32 s39, s16
    s_mov_b32 s40, s17
    s_waitcnt vmcnt(8)
    s_barrier
    buffer_load_dwordx4 v2, s[12:15], s39 offen sc1 lds
    s_add_u32 m0, m0, 1024
    s_nop 0
    buffer_load_dwordx4 v2, s[12:15], s40 offen sc1 lds
    s_mov_b32 s43, 1
ld_65:
    s_add_u32 s19, s41, s42
    v_readlane_b32 s16, v249, s44
    v_readlane_b32 s17, v250, s44
    s_add_u32 s16, s16, s38
    s_add_u32 s17, s17, s38
    s_add_u32 s44, s44, 1
    s_add_u32 s42, s42, 16384
    s_cmp_eq_u32 s42, 49152
    s_cselect_b32 s42, 0, s42
    s_add_u32 m0, m0, 1024
    s_add_u32 s39, s39, 229376
    buffer_load_dwordx4 v2, s[12:15], s39 offen sc1 lds
    s_add_u32 m0, m0, 1024
    s_add_u32 s40, s40, 229376
    buffer_load_dwordx4 v2, s[12:15], s40 offen sc1 lds
    s_add_u32 m0, m0, 1024
    s_add_u32 s39, s39, 229376
    buffer_load_dwordx4 v2, s[12:15], s39 offen sc1 lds
    s_add_u32 m0, m0, 1024
    s_add_u32 s40, s40, 229376
    buffer_load_dwordx4 v2, s[12:15], s40 offen sc1 lds
    s_add_u32 m0, m0, 1024
    s_add_u32 s39, s39, 229376
    buffer_load_dwordx4 v2, s[12:15], s39 offen sc1 lds
    s_add_u32 m0, m0, 1024
    s_add_u32 s40, s40, 229376
    buffer_load_dwordx4 v2, s[12:15], s40 offen sc1 lds
    s_mov_b32 m0, s19
    s_mov_b32 s39, s16
    s_mov_b32 s40, s17
    s_waitcnt vmcnt(8)
    s_barrier
    buffer_load_dwordx4 v2, s[12:15], s39 offen sc1 lds
    s_add_u32 m0, m0, 1024
    s_nop 0
    buffer_load_dwordx4 v2, s[12:15], s40 offen sc1 lds
    s_add_u32 s43, s43, 1
    s_cmp_lt_u32 s43, 5
    s_cbranch_scc1 ld_65
    s_call_b64 s[76:77], PREP_a_issue_4
    s_add_u32 m0, m0, 1024
    s_add_u32 s39, s39, 229376
    buffer_load_dwordx4 v2, s[12:15], s39 offen sc1 lds
    s_add_u32 m0, m0, 1024
    s_add_u32 s40, s40, 229376
    buffer_load_dwordx4 v2, s[12:15], s40 offen sc1 lds
    s_add_u32 m0, m0, 1024
    s_add_u32 s39, s39, 229376
    buffer_load_dwordx4 v2, s[12:15], s39 offen sc1 lds
    s_add_u32 m0, m0, 1024
    s_add_u32 s40, s40, 229376
    buffer_load_dwordx4 v2, s[12:15], s40 offen sc1 lds
    s_add_u32 m0, m0, 1024
    s_add_u32 s39, s39, 229376
    buffer_load_dwordx4 v2, s[12:15], s39 offen sc1 lds
    s_add_u32 m0, m0, 1024
    s_add_u32 s40, s40, 229376
    buffer_load_dwordx4 v2, s[12:15], s40 offen sc1 lds
    s_mov_b32 m0, s19
    s_mov_b32 s39, s16
    s_mov_b32 s40, s17
    s_waitcnt vmcnt(8)
    s_barrier
    buffer_load_dwordx4 v2, s[12:15], s39 offen sc1 lds
    s_add_u32 m0, m0, 1024
    s_nop 0
    buffer_load_dwordx4 v2, s[12:15], s40 offen sc1 lds
    s_mov_b64 exec, 1
    buffer_load_dword v11, v15, s[56:59], 0 offen sc1
    s_mov_b64 exec, -1
    s_call_b64 s[76:77], PREP_a_issue_4
    s_add_u32 m0, m0, 1024
    s_add_u32 s39, s39, 229376
    buffer_load_dwordx4 v2, s[12:15], s39 offen sc1 lds
    s_add_u32 m0, m0, 1024
    s_add_u32 s40, s40, 229376
    buffer_load_dwordx4 v2, s[12:15], s40 offen sc1 lds
    s_add_u32 m0, m0, 1024
    s_add_u32 s39, s39, 229376
    buffer_load_dwordx4 v2, s[12:15], s39 offen sc1 lds
    s_add_u32 m0, m0, 1024
    s_add_u32 s40, s40, 229376
    buffer_load_dwordx4 v2, s[12:15], s40 offen sc1 lds
    s_add_u32 m0, m0, 1024
    s_add_u32 s39, s39, 229376
    buffer_load_dwordx4 v2, s[12:15], s39 offen sc1 lds
    s_add_u32 m0, m0, 1024
    s_add_u32 s40, s40, 229376
    buffer_load_dwordx4 v2, s[12:15], s40 offen sc1 lds
    s_mov_b32 m0, s19
    s_mov_b32 s39, s16
    s_mov_b32 s40, s17
    s_waitcnt vmcnt(9)
    s_barrier
    buffer_load_dwordx4 v2, s[12:15], s39 offen sc1 lds
    s_add_u32 m0, m0, 1024
    s_nop 0
    buffer_load_dwordx4 v2, s[12:15], s40 offen sc1 lds
    s_call_b64 s[76:77], PREP_a_issue_4
    s_add_u32 m0, m0, 1024
    s_add_u32 s39, s39, 229376
    buffer_load_dwordx4 v2, s[12:15], s39 offen sc1 lds
    s_add_u32 m0, m0, 1024
    s_add_u32 s40, s40, 229376
    buffer_load_dwordx4 v2, s[12:15], s40 offen sc1 lds
    s_add_u32 m0, m0, 1024
    s_add_u32 s39, s39, 229376
    buffer_load_dwordx4 v2, s[12:15], s39 offen sc1 lds
    s_add_u32 m0, m0, 1024
    s_add_u32 s40, s40, 229376
    buffer_load_dwordx4 v2, s[12:15], s40 offen sc1 lds
    s_add_u32 m0, m0, 1024
    s_add_u32 s39, s39, 229376
    buffer_load_dwordx4 v2, s[12:15], s39 offen sc1 lds
    s_add_u32 m0, m0, 1024
    s_add_u32 s40, s40, 229376
    buffer_load_dwordx4 v2, s[12:15], s40 offen sc1 lds
    s_mov_b32 m0, s19
    s_mov_b32 s39, s16
    s_mov_b32 s40, s17
    s_waitcnt vmcnt(8)
    s_barrier
    buffer_load_dwordx4 v2, s[12:15], s39 offen sc1 lds
    s_add_u32 m0, m0, 1024
    s_nop 0
    buffer_load_dwordx4 v2, s[12:15], s40 offen sc1 lds
    s_waitcnt vmcnt(16)
    v_readfirstlane_b32 s53, v11
    s_add_u32 s54, s52, 8
    s_cmp_eq_u32 s53, s54
    s_cbranch_scc1 fok_66
    s_mov_b32 s53, 0
    s_add_u32 s54, s52, 8
    s_bfm_b64 exec, 1, 0
poll_67:
    buffer_load_dword v11, v15, s[56:59], 0 offen sc1
    s_waitcnt vmcnt(0)
    v_xor_b32 v11, s54, v11
    v_cmp_eq_u32 vcc, 0, v11
    s_nop 0
    s_cmp_eq_u64 vcc, exec
    s_cbranch_scc1 pok_68
    s_sleep 5
    s_add_u32 s53, s53, 1
    s_cmp_lt_u32 s53, s61
    s_cbranch_scc1 poll_67
    s_mov_b32 s61, 0
pok_68:
    s_mov_b64 exec, -1
fok_66:
    s_call_b64 s[76:77], PREP_a_issue_4
    s_add_u32 m0, m0, 1024
    s_add_u32 s39, s39, 229376
    buffer_load_dwordx4 v2, s[12:15], s39 offen sc1 lds
    s_add_u32 m0, m0, 1024
    s_add_u32 s40, s40, 229376
    buffer_load_dwordx4 v2, s[12:15], s40 offen sc1 lds
    s_add_u32 m0, m0, 1024
    s_add_u32 s39, s39, 229376
    buffer_load_dwordx4 v2, s[12:15], s39 offen sc1 lds
    s_add_u32 m0, m0, 1024
    s_add_u32 s40, s40, 229376
    buffer_load_dwordx4 v2, s[12:15], s40 offen sc1 lds
    s_add_u32 m0, m0, 1024
    s_add_u32 s39, s39, 229376
    buffer_load_dwordx4 v2, s[12:15], s39 offen sc1 lds
    s_add_u32 m0, m0, 1024
    s_add_u32 s40, s40, 229376
    buffer_load_dwordx4 v2, s[12:15], s40 offen sc1 lds
    s_mov_b32 m0, s19
    s_mov_b32 s39, s16
    s_mov_b32 s40, s17
    s_waitcnt vmcnt(8)
    s_barrier
    buffer_load_dwordx4 v2, s[12:15], s39 offen sc1 lds
    s_add_u32 m0, m0, 1024
    s_nop 0
    buffer_load_dwordx4 v2, s[12:15], s40 offen sc1 lds
    s_mov_b32 s43, 1
ld_69:
    s_add_u32 s19, s41, s42
    v_readlane_b32 s16, v249, s44
    v_readlane_b32 s17, v250, s44
    s_add_u32 s16, s16, s38
    s_add_u32 s17, s17, s38
    s_add_u32 s44, s44, 1
    s_add_u32 s42, s42, 16384
    s_cmp_eq_u32 s42, 49152
    s_cselect_b32 s42, 0, s42
    s_add_u32 m0, m0, 1024
    s_add_u32 s39, s39, 229376
    buffer_load_dwordx4 v2, s[12:15], s39 offen sc1 lds
    s_add_u32 m0, m0, 1024
    s_add_u32 s40, s40, 229376
    buffer_load_dwordx4 v2, s[12:15], s40 offen sc1 lds
    s_add_u32 m0, m0, 1024
    s_add_u32 s39, s39, 229376
    buffer_load_dwordx4 v2, s[12:15], s39 offen sc1 lds
    s_add_u32 m0, m0, 1024
    s_add_u32 s40, s40, 229376
    buffer_load_dwordx4 v2, s[12:15], s40 offen sc1 lds
    s_add_u32 m0, m0, 1024
    s_add_u32 s39, s39, 229376
    buffer_load_dwordx4 v2, s[12:15], s39 offen sc1 lds
    s_add_u32 m0, m0, 1024
    s_add_u32 s40, s40, 229376
    buffer_load_dwordx4 v2, s[12:15], s40 offen sc1 lds
    s_mov_b32 m0, s19
    s_mov_b32 s39, s16
    s_mov_b32 s40, s17
    s_waitcnt vmcnt(8)
    s_barrier
    buffer_load_dwordx4 v2, s[12:15], s39 offen sc1 lds
    s_add_u32 m0, m0, 1024
    s_nop 0
    buffer_load_dwordx4 v2, s[12:15], s40 offen sc1 lds
    s_add_u32 s43, s43, 1
    s_cmp_lt_u32 s43, 3
    s_cbranch_scc1 ld_69
    s_call_b64 s[76:77], PREP_a_issue_4
    s_add_u32 m0, m0, 1024
    s_add_u32 s39, s39, 229376
    buffer_load_dwordx4 v2, s[12:15], s39 offen sc1 lds
    s_add_u32 m0, m0, 1024
    s_add_u32 s40, s40, 229376
    buffer_load_dwordx4 v2, s[12:15], s40 offen sc1 lds
    s_add_u32 m0, m0, 1024
    s_add_u32 s39, s39, 229376
    buffer_load_dwordx4 v2, s[12:15], s39 offen sc1 lds
    s_add_u32 m0, m0, 1024
    s_add_u32 s40, s40, 229376
    buffer_load_dwordx4 v2, s[12:15], s40 offen sc1 lds
    s_add_u32 m0, m0, 1024
    s_add_u32 s39, s39, 229376
    buffer_load_dwordx4 v2, s[12:15], s39 offen sc1 lds
    s_add_u32 m0, m0, 1024
    s_add_u32 s40, s40, 229376
    buffer_load_dwordx4 v2, s[12:15], s40 offen sc1 lds
    s_mov_b32 m0, s19
    s_mov_b32 s39, s16
    s_mov_b32 s40, s17
    s_waitcnt vmcnt(8)
    s_barrier
    buffer_load_dwordx4 v2, s[12:15], s39 offen sc1 lds
    s_add_u32 m0, m0, 1024
    s_nop 0
    buffer_load_dwordx4 v2, s[12:15], s40 offen sc1 lds
    s_add_u32 m0, m0, 1024
    s_add_u32 s39, s39, 229376
    buffer_load_dwordx4 v2, s[12:15], s39 offen sc1 lds
    s_add_u32 m0, m0, 1024
    s_add_u32 s40, s40, 229376
    buffer_load_dwordx4 v2, s[12:15], s40 offen sc1 lds
    s_add_u32 m0, m0, 1024
    s_add_u32 s39, s39, 229376
    buffer_load_dwordx4 v2, s[12:15], s39 offen sc1 lds
    s_add_u32 m0, m0, 1024
    s_add_u32 s40, s40, 229376
    buffer_load_dwordx4 v2, s[12:15], s40 offen sc1 lds
    s_add_u32 m0, m0, 1024
    s_add_u32 s39, s39, 229376
    buffer_load_dwordx4 v2, s[12:15], s39 offen sc1 lds
    s_add_u32 m0, m0, 1024
    s_add_u32 s40, s40, 229376
    buffer_load_dwordx4 v2, s[12:15], s40 offen sc1 lds
    s_waitcnt vmcnt(8)
    s_barrier
    s_waitcnt vmcnt(0)
    s_barrier
    s_cmp_eq_u32 s60, 1
    s_cbranch_scc1 K_fin
    s_barrier
    s_branch NEXT
WLOAD:
    s_cmp_eq_u32 s60, 1
    s_cbranch_scc1 WL_1
    s_mov_b64 s[12:13], s[68:69]
    s_mov_b32 s14, 2097152
    s_mov_b32 s15, 0x20000
    s_and_b32 s35, s30, 1
    s_mul_i32 s38, s99, 128
    s_mul_i32 s41, s35, 65536
    s_add_u32 s38, s38, s41
    s_mul_i32 s41, s35, 4096
    s_add_u32 s41, s41, 24576
    s_mov_b32 s42, 0
    s_mov_b32 s44, s67
    s_branch WL_2
WL_1:
    s_mov_b64 s[12:13], s[68:69]
    s_mov_b32 s14, 2097152
    s_mov_b32 s15, 0x20000
    s_and_b32 s35, s30, 1
    s_mul_i32 s38, s99, 128
    s_mul_i32 s41, s35, 65536
    s_add_u32 s38, s38, s41
    s_mul_i32 s41, s35, 4096
    s_add_u32 s41, s41, 24576
    s_mov_b32 s42, 0
    s_mov_b32 s44, s67
WL_2:
    s_waitcnt vmcnt(0)
    s_barrier
    s_call_b64 s[76:77], SUB_after_g1
    s_barrier
    s_waitcnt vmcnt(0)
    s_barrier
    s_call_b64 s[76:77], SUB_after_g2
    s_mov_b64 s[12:13], s[72:73]
    s_mov_b32 s14, 7340032
    s_mov_b32 s15, 0x20000
    s_and_b32 s35, s30, 1
    s_mul_i32 s38, s29, 448
    s_mul_i32 s41, s35, 229376
    s_add_u32 s38, s38, s41
    s_mul_i32 s41, s35, 14336
    s_add_u32 s41, s41, 73728
    s_mov_b32 s42, 0
    s_mov_b32 s44, 0
    s_mov_b32 s42, 28672
    s_mov_b32 s44, 2
    s_add_u32 s19, s41, s42
    v_readlane_b32 s16, v248, s44
    s_nop 0
    s_add_u32 s16, s16, s38
    s_add_u32 s44, s44, 1
    s_and_b32 s44, s44, 15
    s_add_u32 s42, s42, 28672
    s_cmp_eq_u32 s42, 86016
    s_cselect_b32 s42, 0, s42
    s_mov_b32 m0, s19
    s_mov_b32 s39, s16
    s_waitcnt vmcnt(14)
    s_barrier
    buffer_load_dwordx4 v241, s[12:15], s39 offen lds
    s_add_u32 m0, m0, 1024
    s_nop 0
    buffer_load_dwordx4 v242, s[12:15], s39 offen lds
    s_add_u32 m0, m0, 1024
    s_nop 0
    buffer_load_dwordx4 v243, s[12:15], s39 offen lds
    s_mov_b32 s43, 1
ld_70:
    s_add_u32 s19, s41, s42
    v_readlane_b32 s16, v248, s44
    s_nop 0
    s_add_u32 s16, s16, s38
    s_add_u32 s44, s44, 1
    s_and_b32 s44, s44, 15
    s_add_u32 s42, s42, 28672
    s_cmp_eq_u32 s42, 86016
    s_cselect_b32 s42, 0, s42
    s_add_u32 m0, m0, 1024
    s_nop 0
    buffer_load_dwordx4 v244, s[12:15], s39 offen lds
    s_add_u32 m0, m0, 1024
    s_nop 0
    buffer_load_dwordx4 v245, s[12:15], s39 offen lds
    s_add_u32 m0, m0, 1024
    s_nop 0
    buffer_load_dwordx4 v246, s[12:15], s39 offen lds
    s_add_u32 m0, m0, 1024
    s_nop 0
    buffer_load_dwordx4 v247, s[12:15], s39 offen lds
    s_add_u32 m0, m0, 1024
    s_add_u32 s39, s39, 114688
    buffer_load_dwordx4 v241, s[12:15], s39 offen lds
    s_add_u32 m0, m0, 1024
    s_nop 0
    buffer_load_dwordx4 v242, s[12:15], s39 offen lds
    s_add_u32 m0, m0, 1024
    s_nop 0
    buffer_load_dwordx4 v243, s[12:15], s39 offen lds
    s_add_u32 m0, m0, 1024
    s_nop 0
    buffer_load_dwordx4 v244, s[12:15], s39 offen lds
    s_add_u32 m0, m0, 1024
    s_nop 0
    buffer_load_dwordx4 v245, s[12:15], s39 offen lds
    s_add_u32 m0, m0, 1024
    s_nop 0
    buffer_load_dwordx4 v246, s[12:15], s39 offen lds
    s_add_u32 m0, m0, 1024
    s_nop 0
    buffer_load_dwordx4 v247, s[12:15], s39 offen lds
    s_mov_b32 m0, s19
    s_mov_b32 s39, s16
    s_waitcnt vmcnt(14)
    s_barrier
    buffer_load_dwordx4 v241, s[12:15], s39 offen lds
    s_add_u32 m0, m0, 1024
    s_nop 0
    buffer_load_dwordx4 v242, s[12:15], s39 offen lds
    s_add_u32 m0, m0, 1024
    s_nop 0
    buffer_load_dwordx4 v243, s[12:15], s39 offen lds
    s_add_u32 s43, s43, 1
    s_cmp_lt_u32 s43, 13
    s_cbranch_scc1 ld_70
    s_add_u32 s19, s41, s42
    v_readlane_b32 s16, v248, s44
    s_nop 0
    s_add_u32 s16, s16, s38
    s_add_u32 s44, s44, 1
    s_and_b32 s44, s44, 15
    s_add_u32 s42, s42, 28672
    s_cmp_eq_u32 s42, 86016
    s_cselect_b32 s42, 0, s42
    s_add_u32 m0, m0, 1024
    s_nop 0
    buffer_load_dwordx4 v244, s[12:15], s39 offen lds
    s_add_u32 m0, m0, 1024
    s_nop 0
    buffer_load_dwordx4 v245, s[12:15], s39 offen lds
    s_add_u32 m0, m0, 1024
    s_nop 0
    buffer_load_dwordx4 v246, s[12:15], s39 offen lds
    s_add_u32 m0, m0, 1024
    s_nop 0
    buffer_load_dwordx4 v247, s[12:15], s39 offen lds
    s_add_u32 m0, m0, 1024
    s_add_u32 s39, s39, 114688
    buffer_load_dwordx4 v241, s[12:15], s39 offen lds
    s_add_u32 m0, m0, 1024
    s_nop 0
    buffer_load_dwordx4 v242, s[12:15], s39 offen lds
    s_add_u32 m0, m0, 1024
    s_nop 0
    buffer_load_dwordx4 v243, s[12:15], s39 offen lds
    s_add_u32 m0, m0, 1024
    s_nop 0
    buffer_load_dwordx4 v244, s[12:15], s39 offen lds
    s_add_u32 m0, m0, 1024
    s_nop 0
    buffer_load_dwordx4 v245, s[12:15], s39 offen lds
    s_add_u32 m0, m0, 1024
    s_nop 0
    buffer_load_dwordx4 v246, s[12:15], s39 offen lds
    s_add_u32 m0, m0, 1024
    s_nop 0
    buffer_load_dwordx4 v247, s[12:15], s39 offen lds
    s_mov_b32 m0, s19
    s_mov_b32 s39, s16
    s_waitcnt vmcnt(14)
    s_barrier
    buffer_load_dwordx4 v241, s[12:15], s39 offen lds
    s_add_u32 m0, m0, 1024
    s_nop 0
    buffer_load_dwordx4 v242, s[12:15], s39 offen lds
    s_add_u32 m0, m0, 1024
    s_nop 0
    buffer_load_dwordx4 v243, s[12:15], s39 offen lds
    s_add_u32 m0, m0, 1024
    s_nop 0
    buffer_load_dwordx4 v244, s[12:15], s39 offen lds
    s_add_u32 m0, m0, 1024
    s_nop 0
    buffer_load_dwordx4 v245, s[12:15], s39 offen lds
    s_add_u32 m0, m0, 1024
    s_nop 0
    buffer_load_dwordx4 v246, s[12:15], s39 offen lds
    s_add_u32 m0, m0, 1024
    s_nop 0
    buffer_load_dwordx4 v247, s[12:15], s39 offen lds
    s_add_u32 m0, m0, 1024
    s_add_u32 s39, s39, 114688
    buffer_load_dwordx4 v241, s[12:15], s39 offen lds
    s_add_u32 m0, m0, 1024
    s_nop 0
    buffer_load_dwordx4 v242, s[12:15], s39 offen lds
    s_add_u32 m0, m0, 1024
    s_nop 0
    buffer_load_dwordx4 v243, s[12:15], s39 offen lds
    s_add_u32 m0, m0, 1024
    s_nop 0
    buffer_load_dwordx4 v244, s[12:15], s39 offen lds
    s_add_u32 m0, m0, 1024
    s_nop 0
    buffer_load_dwordx4 v245, s[12:15], s39 offen lds
    s_add_u32 m0, m0, 1024
    s_nop 0
    buffer_load_dwordx4 v246, s[12:15], s39 offen lds
    s_add_u32 m0, m0, 1024
    s_nop 0
    buffer_load_dwordx4 v247, s[12:15], s39 offen lds
    s_waitcnt vmcnt(14)
    s_barrier
    s_call_b64 s[76:77], SUB_r_pre0
    s_waitcnt vmcnt(4)
    s_barrier
    s_barrier
    s_mov_b64 s[12:13], s[74:75]
    s_mov_b32 s14, 7340032
    s_mov_b32 s15, 0x20000
    s_and_b32 s35, s30, 1
    s_mul_i32 s38, s33, 256
    s_mul_i32 s41, s31, 3670016
    s_add_u32 s38, s38, s41
    s_mul_i32 s41, s35, 8192
    s_add_u32 s41, s41, 49152
    s_mov_b32 s42, 0
    s_mov_b32 s44, 0
    s_mov_b32 s49, s44
    s_and_b32 s43, s28, 3
    s_mul_i32 s43, s43, 6
    s_lshr_b32 s43, s43, 2
    s_mov_b32 s50, 0
wpre_71:
    s_mul_i32 s42, s43, 16384
    s_add_u32 s44, s49, s43
    s_mov_b32 s45, 8192
    s_add_u32 s19, s41, s42
    v_readlane_b32 s16, v249, s44
    s_nop 0
    s_bitcmp1_b32 s16, 0
    s_cselect_b32 s17, 16384, s45
    s_cselect_b32 s18, -40960, s45
    s_andn2_b32 s16, s16, 1
    s_add_u32 s16, s16, s38
    s_add_u32 s44, s44, 1
    s_add_u32 s42, s42, 16384
    s_cmp_eq_u32 s42, 98304
    s_cselect_b32 s42, 0, s42
    s_mov_b32 m0, s19
    s_mov_b32 s39, s16
    s_mov_b32 s32, s17
    s_mov_b32 s3, s18
    buffer_load_dwordx4 v239, s[12:15], s39 offen lds
    s_add_u32 m0, m0, 1024
    s_add_u32 s39, s39, s32
    buffer_load_dwordx4 v240, s[12:15], s39 offen lds
    s_add_u32 m0, m0, 1024
    s_add_u32 s39, s39, s32
    buffer_load_dwordx4 v239, s[12:15], s39 offen lds
    s_add_u32 m0, m0, 1024
    s_add_u32 s39, s39, s32
    buffer_load_dwordx4 v240, s[12:15], s39 offen lds
    s_waitcnt vmcnt(6)
    s_add_u32 m0, m0, 1024
    s_add_u32 s39, s39, s3
    buffer_load_dwordx4 v239, s[12:15], s39 offen lds
    s_add_u32 m0, m0, 1024
    s_add_u32 s39, s39, s32
    buffer_load_dwordx4 v240, s[12:15], s39 offen lds
    s_add_u32 m0, m0, 1024
    s_add_u32 s39, s39, s32
    buffer_load_dwordx4 v239, s[12:15], s39 offen lds
    s_add_u32 m0, m0, 1024
    s_add_u32 s39, s39, s32
    buffer_load_dwordx4 v240, s[12:15], s39 offen lds
    s_waitcnt vmcnt(6)
    s_add_u32 s43, s43, 1
    s_cmp_eq_u32 s43, 6
    s_cselect_b32 s43, 0, s43
    s_add_u32 s50, s50, 1
    s_cmp_lt_u32 s50, 6
    s_cbranch_scc1 wpre_71
    s_mov_b32 s42, 0
    s_add_u32 s44, s49, 6
    s_cmp_eq_u32 s60, 1
    s_cbranch_scc1 WL_t1
    s_call_b64 s[76:77], PREP_w_issue_4
    s_mov_b32 m0, s19
    s_mov_b32 s39, s16
    s_mov_b32 s32, s17
    s_mov_b32 s3, s18
    s_waitcnt vmcnt(0)
    s_barrier
    s_waitcnt vmcnt(0)
    s_barrier
    buffer_load_dwordx4 v239, s[12:15], s39 offen lds
    s_add_u32 m0, m0, 1024
    s_add_u32 s39, s39, s32
    buffer_load_dwordx4 v240, s[12:15], s39 offen lds
    s_call_b64 s[76:77], PREP_w_issue_4
    s_add_u32 m0, m0, 1024
    s_add_u32 s39, s39, s32
    buffer_load_dwordx4 v239, s[12:15], s39 offen lds
    s_add_u32 m0, m0, 1024
    s_add_u32 s39, s39, s32
    buffer_load_dwordx4 v240, s[12:15], s39 offen lds
    s_add_u32 m0, m0, 1024
    s_add_u32 s39, s39, s3
    buffer_load_dwordx4 v239, s[12:15], s39 offen lds
    s_add_u32 m0, m0, 1024
    s_add_u32 s39, s39, s32
    buffer_load_dwordx4 v240, s[12:15], s39 offen lds
    s_add_u32 m0, m0, 1024
    s_add_u32 s39, s39, s32
    buffer_load_dwordx4 v239, s[12:15], s39 offen lds
    s_add_u32 m0, m0, 1024
    s_add_u32 s39, s39, s32
    buffer_load_dwordx4 v240, s[12:15], s39 offen lds
    s_mov_b32 m0, s19
    s_mov_b32 s39, s16
    s_mov_b32 s32, s17
    s_mov_b32 s3, s18
    s_waitcnt vmcnt(8)
    s_barrier
    buffer_load_dwordx4 v239, s[12:15], s39 offen lds
    s_add_u32 m0, m0, 1024
    s_add_u32 s39, s39, s32
    buffer_load_dwordx4 v240, s[12:15], s39 offen lds
    s_call_b64 s[76:77], PREP_w_issue_4
    s_add_u32 m0, m0, 1024
    s_add_u32 s39, s39, s32
    buffer_load_dwordx4 v239, s[12:15], s39 offen lds
    s_add_u32 m0, m0, 1024
    s_add_u32 s39, s39, s32
    buffer_load_dwordx4 v240, s[12:15], s39 offen lds
    s_add_u32 m0, m0, 1024
    s_add_u32 s39, s39, s3
    buffer_load_dwordx4 v239, s[12:15], s39 offen lds
    s_add_u32 m0, m0, 1024
    s_add_u32 s39, s39, s32
    buffer_load_dwordx4 v240, s[12:15], s39 offen lds
    s_add_u32 m0, m0, 1024
    s_add_u32 s39, s39, s32
    buffer_load_dwordx4 v239, s[12:15], s39 offen lds
    s_add_u32 m0, m0, 1024
    s_add_u32 s39, s39, s32
    buffer_load_dwordx4 v240, s[12:15], s39 offen lds
    s_mov_b32 m0, s19
    s_mov_b32 s39, s16
    s_mov_b32 s32, s17
    s_mov_b32 s3, s18
    s_waitcnt vmcnt(16)
    s_barrier
    buffer_load_dwordx4 v239, s[12:15], s39 offen lds
    s_add_u32 m0, m0, 1024
    s_add_u32 s39, s39, s32
    buffer_load_dwordx4 v240, s[12:15], s39 offen lds
    s_call_b64 s[76:77], PREP_w_issue_4
    s_add_u32 m0, m0, 1024
    s_add_u32 s39, s39, s32
    buffer_load_dwordx4 v239, s[12:15], s39 offen lds
    s_add_u32 m0, m0, 1024
    s_add_u32 s39, s39, s32
    buffer_load_dwordx4 v240, s[12:15], s39 offen lds
    s_add_u32 m0, m0, 1024
    s_add_u32 s39, s39, s3
    buffer_load_dwordx4 v239, s[12:15], s39 offen lds
    s_add_u32 m0, m0, 1024
    s_add_u32 s39, s39, s32
    buffer_load_dwordx4 v240, s[12:15], s39 offen lds
    s_add_u32 m0, m0, 1024
    s_add_u32 s39, s39, s32
    buffer_load_dwordx4 v239, s[12:15], s39 offen lds
    s_add_u32 m0, m0, 1024
    s_add_u32 s39, s39, s32
    buffer_load_dwordx4 v240, s[12:15], s39 offen lds
    s_mov_b32 m0, s19
    s_mov_b32 s39, s16
    s_mov_b32 s32, s17
    s_mov_b32 s3, s18
    s_waitcnt vmcnt(24)
    s_barrier
    buffer_load_dwordx4 v239, s[12:15], s39 offen lds
    s_add_u32 m0, m0, 1024
    s_add_u32 s39, s39, s32
    buffer_load_dwordx4 v240, s[12:15], s39 offen lds
    s_mov_b32 s43, 1
ld_72:
    s_mov_b32 s45, 8192
    s_add_u32 s19, s41, s42
    v_readlane_b32 s16, v249, s44
    s_nop 0
    s_bitcmp1_b32 s16, 0
    s_cselect_b32 s17, 16384, s45
    s_cselect_b32 s18, -40960, s45
    s_andn2_b32 s16, s16, 1
    s_add_u32 s16, s16, s38
    s_add_u32 s44, s44, 1
    s_add_u32 s42, s42, 16384
    s_cmp_eq_u32 s42, 98304
    s_cselect_b32 s42, 0, s42
    s_add_u32 m0, m0, 1024
    s_add_u32 s39, s39, s32
    buffer_load_dwordx4 v239, s[12:15], s39 offen lds
    s_add_u32 m0, m0, 1024
    s_add_u32 s39, s39, s32
    buffer_load_dwordx4 v240, s[12:15], s39 offen lds
    s_add_u32 m0, m0, 1024
    s_add_u32 s39, s39, s3
    buffer_load_dwordx4 v239, s[12:15], s39 offen lds
    s_add_u32 m0, m0, 1024
    s_add_u32 s39, s39, s32
    buffer_load_dwordx4 v240, s[12:15], s39 offen lds
    s_add_u32 m0, m0, 1024
    s_add_u32 s39, s39, s32
    buffer_load_dwordx4 v239, s[12:15], s39 offen lds
    s_add_u32 m0, m0, 1024
    s_add_u32 s39, s39, s32
    buffer_load_dwordx4 v240, s[12:15], s39 offen lds
    s_mov_b32 m0, s19
    s_mov_b32 s39, s16
    s_mov_b32 s32, s17
    s_mov_b32 s3, s18
    s_waitcnt vmcnt(32)
    s_barrier
    buffer_load_dwordx4 v239, s[12:15], s39 offen lds
    s_add_u32 m0, m0, 1024
    s_add_u32 s39, s39, s32
    buffer_load_dwordx4 v240, s[12:15], s39 offen lds
    s_add_u32 s43, s43, 1
    s_cmp_lt_u32 s43, 18
    s_cbranch_scc1 ld_72
    s_call_b64 s[76:77], PREP_w_issue_4
    s_add_u32 m0, m0, 1024
    s_add_u32 s39, s39, s32
    buffer_load_dwordx4 v239, s[12:15], s39 offen lds
    s_add_u32 m0, m0, 1024
    s_add_u32 s39, s39, s32
    buffer_load_dwordx4 v240, s[12:15], s39 offen lds
    s_add_u32 m0, m0, 1024
    s_add_u32 s39, s39, s3
    buffer_load_dwordx4 v239, s[12:15], s39 offen lds
    s_add_u32 m0, m0, 1024
    s_add_u32 s39, s39, s32
    buffer_load_dwordx4 v240, s[12:15], s39 offen lds
    s_add_u32 m0, m0, 1024
    s_add_u32 s39, s39, s32
    buffer_load_dwordx4 v239, s[12:15], s39 offen lds
    s_add_u32 m0, m0, 1024
    s_add_u32 s39, s39, s32
    buffer_load_dwordx4 v240, s[12:15], s39 offen lds
    s_mov_b32 m0, s19
    s_mov_b32 s39, s16
    s_mov_b32 s32, s17
    s_mov_b32 s3, s18
    s_waitcnt vmcnt(32)
    s_barrier
    buffer_load_dwordx4 v239, s[12:15], s39 offen lds
    s_add_u32 m0, m0, 1024
    s_add_u32 s39, s39, s32
    buffer_load_dwordx4 v240, s[12:15], s39 offen lds
    s_add_u32 m0, m0, 1024
    s_add_u32 s39, s39, s32
    buffer_load_dwordx4 v239, s[12:15], s39 offen lds
    s_add_u32 m0, m0, 1024
    s_add_u32 s39, s39, s32
    buffer_load_dwordx4 v240, s[12:15], s39 offen lds
    s_add_u32 m0, m0, 1024
    s_add_u32 s39, s39, s3
    buffer_load_dwordx4 v239, s[12:15], s39 offen lds
    s_add_u32 m0, m0, 1024
    s_add_u32 s39, s39, s32
    buffer_load_dwordx4 v240, s[12:15], s39 offen lds
    s_add_u32 m0, m0, 1024
    s_add_u32 s39, s39, s32
    buffer_load_dwordx4 v239, s[12:15], s39 offen lds
    s_add_u32 m0, m0, 1024
    s_add_u32 s39, s39, s32
    buffer_load_dwordx4 v240, s[12:15], s39 offen lds
    s_waitcnt vmcnt(32)
    s_barrier
    s_mov_b64 s[12:13], s[68:69]
    s_mov_b32 s14, 2097152
    s_mov_b32 s15, 0x20000
    s_and_b32 s35, s30, 1
    s_mul_i32 s38, s99, 128
    s_mul_i32 s41, s35, 65536
    s_add_u32 s38, s38, s41
    s_mul_i32 s41, s35, 4096
    s_add_u32 s41, s41, 24576
    s_mov_b32 s42, 0
    s_mov_b32 s44, s67
    s_mov_b32 s42, 90112
    s_mov_b32 s44, s67
    s_add_u32 s44, s44, 11
    s_and_b32 s44, s44, 15
    s_call_b64 s[76:77], SUB_w_issue_1
    s_mov_b32 s42, 98304
    s_mov_b32 s44, s67
    s_add_u32 s44, s44, 12
    s_and_b32 s44, s44, 15
    s_call_b64 s[76:77], SUB_w_issue_1
    s_mov_b32 s42, 122880
    s_mov_b32 s44, s67
    s_add_u32 s44, s44, 15
    s_and_b32 s44, s44, 15
    s_call_b64 s[76:77], SUB_w_issue_1
    s_add_u32 s39, s38, 1179648
    buffer_load_dwordx4 v[16:19], v238, s[12:15], s39 offen
    s_add_u32 s39, s39, 16384
    buffer_load_dwordx4 v[20:23], v238, s[12:15], s39 offen
    s_add_u32 s39, s39, 16384
    buffer_load_dwordx4 v[24:27], v238, s[12:15], s39 offen
    s_add_u32 s39, s39, 16384
    buffer_load_dwordx4 v[28:31], v238, s[12:15], s39 offen
    s_add_u32 s39, s39, 16384
    s_waitcnt vmcnt(40)
    s_barrier
    s_mov_b32 s42, 106496
    s_mov_b32 s44, s67
    s_add_u32 s44, s44, 13
    s_and_b32 s44, s44, 15
    s_call_b64 s[76:77], SUB_w_issue_1
    s_mov_b32 s42, 114688
    s_mov_b32 s44, s67
    s_add_u32 s44, s44, 14
    s_and_b32 s44, s44, 15
    s_call_b64 s[76:77], SUB_w_issue_1
    s_add_u32 s39, s38, 1310720
    buffer_load_dwordx4 v[32:35], v238, s[12:15], s39 offen
    s_add_u32 s39, s39, 16384
    buffer_load_dwordx4 v[36:39], v238, s[12:15], s39 offen
    s_add_u32 s39, s39, 16384
    buffer_load_dwordx4 v[40:43], v238, s[12:15], s39 offen
    s_add_u32 s39, s39, 16384
    buffer_load_dwordx4 v[44:47], v238, s[12:15], s39 offen
    s_add_u32 s39, s39, 16384
    s_waitcnt vmcnt(44)
    s_barrier
    s_mov_b32 s42, 24576
    s_mov_b32 s44, s67
    s_add_u32 s44, s44, 3
    s_and_b32 s44, s44, 15
    s_call_b64 s[76:77], SUB_w_issue_1
    s_mov_b32 s42, 32768
    s_mov_b32 s44, s67
    s_add_u32 s44, s44, 4
    s_and_b32 s44, s44, 15
    s_call_b64 s[76:77], SUB_w_issue_1
    s_waitcnt vmcnt(44)
    s_barrier
    s_mov_b32 s42, 40960
    s_mov_b32 s44, s67
    s_add_u32 s44, s44, 5
    s_and_b32 s44, s44, 15
    s_call_b64 s[76:77], SUB_w_issue_1
    s_mov_b32 s42, 49152
    s_mov_b32 s44, s67
    s_add_u32 s44, s44, 6
    s_and_b32 s44, s44, 15
    s_call_b64 s[76:77], SUB_w_issue_1
    s_mov_b32 s42, 0
    s_mov_b32 s44, s67
    s_add_u32 s44, s44, 0
    s_and_b32 s44, s44, 15
    s_call_b64 s[76:77], SUB_w_issue_1
    s_waitcnt vmcnt(48)
    s_barrier
    s_mov_b32 s42, 57344
    s_mov_b32 s44, s67
    s_add_u32 s44, s44, 7
    s_and_b32 s44, s44, 15
    s_call_b64 s[76:77], SUB_w_issue_1
    s_mov_b32 s42, 65536
    s_mov_b32 s44, s67
    s_add_u32 s44, s44, 8
    s_and_b32 s44, s44, 15
    s_call_b64 s[76:77], SUB_w_issue_1
    s_mov_b32 s42, 8192
    s_mov_b32 s44, s67
    s_add_u32 s44, s44, 1
    s_and_b32 s44, s44, 15
    s_call_b64 s[76:77], SUB_w_issue_1
    s_mov_b32 s42, 16384
    s_mov_b32 s44, s67
    s_add_u32 s44, s44, 2
    s_and_b32 s44, s44, 15
    s_call_b64 s[76:77], SUB_w_issue_1
    s_barrier
    s_add_u32 s36, s41, 73728
    v_add_u32 v6, s36, v2
    s_waitcnt vmcnt(0)
    ds_write_b128 v6, v[16:19] offset:0
    ds_write_b128 v6, v[20:23] offset:1024
    ds_write_b128 v6, v[24:27] offset:2048
    ds_write_b128 v6, v[28:31] offset:3072
    ds_write_b128 v6, v[32:35] offset:8192
    ds_write_b128 v6, v[36:39] offset:9216
    ds_write_b128 v6, v[40:43] offset:10240
    ds_write_b128 v6, v[44:47] offset:11264
    s_waitcnt lgkmcnt(0)
    s_branch NEXT
WL_t1:
    s_call_b64 s[76:77], PREP_w_issue_4
    s_mov_b32 m0, s19
    s_mov_b32 s39, s16
    s_mov_b32 s32, s17
    s_mov_b32 s3, s18
    s_waitcnt vmcnt(0)
    s_barrier
    s_waitcnt vmcnt(0)
    s_barrier
    s_waitcnt vmcnt(0)
    s_barrier
    s_waitcnt vmcnt(0)
    s_barrier
    s_waitcnt vmcnt(0)
    s_barrier
    buffer_load_dwordx4 v239, s[12:15], s39 offen lds
    s_add_u32 m0, m0, 1024
    s_add_u32 s39, s39, s32
    buffer_load_dwordx4 v240, s[12:15], s39 offen lds
    s_mov_b32 s43, 1
ld_73:
    s_mov_b32 s45, 8192
    s_add_u32 s19, s41, s42
    v_readlane_b32 s16, v249, s44
    s_nop 0
    s_bitcmp1_b32 s16, 0
    s_cselect_b32 s17, 16384, s45
    s_cselect_b32 s18, -40960, s45
    s_andn2_b32 s16, s16, 1
    s_add_u32 s16, s16, s38
    s_add_u32 s44, s44, 1
    s_add_u32 s42, s42, 16384
    s_cmp_eq_u32 s42, 98304
    s_cselect_b32 s42, 0, s42
    s_add_u32 m0, m0, 1024
    s_add_u32 s39, s39, s32
    buffer_load_dwordx4 v239, s[12:15], s39 offen lds
    s_add_u32 m0, m0, 1024
    s_add_u32 s39, s39, s32
    buffer_load_dwordx4 v240, s[12:15], s39 offen lds
    s_add_u32 m0, m0, 1024
    s_add_u32 s39, s39, s3
    buffer_load_dwordx4 v239, s[12:15], s39 offen lds
    s_add_u32 m0, m0, 1024
    s_add_u32 s39, s39, s32
    buffer_load_dwordx4 v240, s[12:15], s39 offen lds
    s_add_u32 m0, m0, 1024
    s_add_u32 s39, s39, s32
    buffer_load_dwordx4 v239, s[12:15], s39 offen lds
    s_add_u32 m0, m0, 1024
    s_add_u32 s39, s39, s32
    buffer_load_dwordx4 v240, s[12:15], s39 offen lds
    s_mov_b32 m0, s19
    s_mov_b32 s39, s16
    s_mov_b32 s32, s17
    s_mov_b32 s3, s18
    s_waitcnt vmcnt(8)
    s_barrier
    buffer_load_dwordx4 v239, s[12:15], s39 offen lds
    s_add_u32 m0, m0, 1024
    s_add_u32 s39, s39, s32
    buffer_load_dwordx4 v240, s[12:15], s39 offen lds
    s_add_u32 s43, s43, 1
    s_cmp_lt_u32 s43, 21
    s_cbranch_scc1 ld_73
    s_call_b64 s[76:77], PREP_w_issue_4
    s_add_u32 m0, m0, 1024
    s_add_u32 s39, s39, s32
    buffer_load_dwordx4 v239, s[12:15], s39 offen lds
    s_add_u32 m0, m0, 1024
    s_add_u32 s39, s39, s32
    buffer_load_dwordx4 v240, s[12:15], s39 offen lds
    s_add_u32 m0, m0, 1024
    s_add_u32 s39, s39, s3
    buffer_load_dwordx4 v239, s[12:15], s39 offen lds
    s_add_u32 m0, m0, 1024
    s_add_u32 s39, s39, s32
    buffer_load_dwordx4 v240, s[12:15], s39 offen lds
    s_add_u32 m0, m0, 1024
    s_add_u32 s39, s39, s32
    buffer_load_dwordx4 v239, s[12:15], s39 offen lds
    s_add_u32 m0, m0, 1024
    s_add_u32 s39, s39, s32
    buffer_load_dwordx4 v240, s[12:15], s39 offen lds
    s_mov_b32 m0, s19
    s_mov_b32 s39, s16
    s_mov_b32 s32, s17
    s_mov_b32 s3, s18
    s_waitcnt vmcnt(8)
    s_barrier
    buffer_load_dwordx4 v239, s[12:15], s39 offen lds
    s_add_u32 m0, m0, 1024
    s_add_u32 s39, s39, s32
    buffer_load_dwordx4 v240, s[12:15], s39 offen lds
    s_add_u32 m0, m0, 1024
    s_add_u32 s39, s39, s32
    buffer_load_dwordx4 v239, s[12:15], s39 offen lds
    s_add_u32 m0, m0, 1024
    s_add_u32 s39, s39, s32
    buffer_load_dwordx4 v240, s[12:15], s39 offen lds
    s_add_u32 m0, m0, 1024
    s_add_u32 s39, s39, s3
    buffer_load_dwordx4 v239, s[12:15], s39 offen lds
    s_add_u32 m0, m0, 1024
    s_add_u32 s39, s39, s32
    buffer_load_dwordx4 v240, s[12:15], s39 offen lds
    s_add_u32 m0, m0, 1024
    s_add_u32 s39, s39, s32
    buffer_load_dwordx4 v239, s[12:15], s39 offen lds
    s_add_u32 m0, m0, 1024
    s_add_u32 s39, s39, s32
    buffer_load_dwordx4 v240, s[12:15], s39 offen lds
    s_waitcnt vmcnt(8)
    s_barrier
    s_waitcnt vmcnt(0)
    s_barrier
    s_branch K_fin
NEXT:
    s_setprio 0
    s_add_u32 s60, s60, 1
    s_add_u32 s55, s55, 4194304
    s_add_u32 s62, s62, 4194304
    s_addc_u32 s63, s63, 0
    s_branch LAYER
K_fin:
    s_endpgm
SUB_w1_regs:
    s_mov_b64 s[12:13], s[68:69]
    s_mov_b32 s14, 2097152
    s_mov_b32 s15, 0x20000
    s_and_b32 s35, s30, 3
    s_mul_i32 s35, s35, 294912
    s_lshl_b32 s39, s99, 7
    s_add_u32 s39, s39, s35
    buffer_load_dwordx4 v[176:179], v238, s[12:15], s39 offen
    s_add_u32 s39, s39, 16384
    buffer_load_dwordx4 v[188:191], v238, s[12:15], s39 offen
    s_add_u32 s39, s39, 16384
    buffer_load_dwordx4 v[192:195], v238, s[12:15], s39 offen
    s_add_u32 s39, s39, 16384
    buffer_load_dwordx4 v[200:203], v238, s[12:15], s39 offen
    s_add_u32 s39, s39, 16384
    s_waitcnt vmcnt(8)
    buffer_load_dwordx4 v[204:207], v238, s[12:15], s39 offen
    s_add_u32 s39, s39, 16384
    buffer_load_dwordx4 v[208:211], v238, s[12:15], s39 offen
    s_add_u32 s39, s39, 16384
    buffer_load_dwordx4 v[212:215], v238, s[12:15], s39 offen
    s_add_u32 s39, s39, 16384
    buffer_load_dwordx4 v[216:219], v238, s[12:15], s39 offen
    s_add_u32 s39, s39, 16384
    s_waitcnt vmcnt(8)
    buffer_load_dwordx4 v[220:223], v238, s[12:15], s39 offen
    s_add_u32 s39, s39, 16384
    buffer_load_dwordx4 v[224:227], v238, s[12:15], s39 offen
    s_add_u32 s39, s39, 16384
    buffer_load_dwordx4 v[16:19], v238, s[12:15], s39 offen
    s_add_u32 s39, s39, 16384
    buffer_load_dwordx4 v[20:23], v238, s[12:15], s39 offen
    s_add_u32 s39, s39, 16384
    s_waitcnt vmcnt(8)
    buffer_load_dwordx4 v[24:27], v238, s[12:15], s39 offen
    s_add_u32 s39, s39, 16384
    buffer_load_dwordx4 v[28:31], v238, s[12:15], s39 offen
    s_add_u32 s39, s39, 16384
    buffer_load_dwordx4 v[32:35], v238, s[12:15], s39 offen
    s_add_u32 s39, s39, 16384
    buffer_load_dwordx4 v[36:39], v238, s[12:15], s39 offen
    s_add_u32 s39, s39, 16384
    s_waitcnt vmcnt(8)
    buffer_load_dwordx4 v[40:43], v238, s[12:15], s39 offen
    s_add_u32 s39, s39, 16384
    buffer_load_dwordx4 v[44:47], v238, s[12:15], s39 offen
    s_add_u32 s39, s39, 16384
    s_setpc_b64 s[76:77]
SUB_park:
    s_mov_b64 s[12:13], s[70:71]
    s_mov_b32 s14, 2097152
    s_mov_b32 s15, 0x20000
    s_and_b32 s35, s30, 3
    s_lshl_b32 s35, s35, 19
    s_lshl_b32 s39, s29, 7
    s_add_u32 s39, s39, s35
    buffer_load_dwordx4 v[48:51], v238, s[12:15], s39 offen
    s_add_u32 s39, s39, 16384
    buffer_load_dwordx4 v[52:55], v238, s[12:15], s39 offen
    s_add_u32 s39, s39, 16384
    buffer_load_dwordx4 v[56:59], v238, s[12:15], s39 offen
    s_add_u32 s39, s39, 16384
    buffer_load_dwordx4 v[60:63], v238, s[12:15], s39 offen
    s_add_u32 s39, s39, 16384
    s_waitcnt vmcnt(8)
    buffer_load_dwordx4 v[64:67], v238, s[12:15], s39 offen
    s_add_u32 s39, s39, 16384
    buffer_load_dwordx4 v[68:71], v238, s[12:15], s39 offen
    s_add_u32 s39, s39, 16384
    buffer_load_dwordx4 v[72:75], v238, s[12:15], s39 offen
    s_add_u32 s39, s39, 16384
    buffer_load_dwordx4 v[76:79], v238, s[12:15], s39 offen
    s_add_u32 s39, s39, 16384
    s_waitcnt vmcnt(8)
    buffer_load_dwordx4 v[80:83], v238, s[12:15], s39 offen
    s_add_u32 s39, s39, 16384
    buffer_load_dwordx4 v[84:87], v238, s[12:15], s39 offen
    s_add_u32 s39, s39, 16384
    buffer_load_dwordx4 v[88:91], v238, s[12:15], s39 offen
    s_add_u32 s39, s39, 16384
    buffer_load_dwordx4 v[92:95], v238, s[12:15], s39 offen
    s_add_u32 s39, s39, 16384
    s_waitcnt vmcnt(8)
    buffer_load_dwordx4 v[96:99], v238, s[12:15], s39 offen
    s_add_u32 s39, s39, 16384
    buffer_load_dwordx4 v[100:103], v238, s[12:15], s39 offen
    s_add_u32 s39, s39, 16384
    buffer_load_dwordx4 v[104:107], v238, s[12:15], s39 offen
    s_add_u32 s39, s39, 16384
    buffer_load_dwordx4 v[108:111], v238, s[12:15], s39 offen
    s_add_u32 s39, s39, 16384
    s_waitcnt vmcnt(8)
    buffer_load_dwordx4 v[112:115], v238, s[12:15], s39 offen
    s_add_u32 s39, s39, 16384
    buffer_load_dwordx4 v[116:119], v238, s[12:15], s39 offen
    s_add_u32 s39, s39, 16384
    buffer_load_dwordx4 v[120:123], v238, s[12:15], s39 offen
    s_add_u32 s39, s39, 16384
    buffer_load_dwordx4 v[124:127], v238, s[12:15], s39 offen
    s_add_u32 s39, s39, 16384
    s_waitcnt vmcnt(8)
    buffer_load_dwordx4 v[128:131], v238, s[12:15], s39 offen
    s_add_u32 s39, s39, 16384
    buffer_load_dwordx4 v[132:135], v238, s[12:15], s39 offen
    s_add_u32 s39, s39, 16384
    buffer_load_dwordx4 v[136:139], v238, s[12:15], s39 offen
    s_add_u32 s39, s39, 16384
    buffer_load_dwordx4 v[140:143], v238, s[12:15], s39 offen
    s_add_u32 s39, s39, 16384
    s_waitcnt vmcnt(8)
    buffer_load_dwordx4 v[144:147], v238, s[12:15], s39 offen
    s_add_u32 s39, s39, 16384
    buffer_load_dwordx4 v[148:151], v238, s[12:15], s39 offen
    s_add_u32 s39, s39, 16384
    buffer_load_dwordx4 v[152:155], v238, s[12:15], s39 offen
    s_add_u32 s39, s39, 16384
    buffer_load_dwordx4 v[156:159], v238, s[12:15], s39 offen
    s_add_u32 s39, s39, 16384
    s_waitcnt vmcnt(8)
    buffer_load_dwordx4 v[160:163], v238, s[12:15], s39 offen
    s_add_u32 s39, s39, 16384
    buffer_load_dwordx4 v[164:167], v238, s[12:15], s39 offen
    s_add_u32 s39, s39, 16384
    buffer_load_dwordx4 v[168:171], v238, s[12:15], s39 offen
    s_add_u32 s39, s39, 16384
    buffer_load_dwordx4 v[172:175], v238, s[12:15], s39 offen
    s_add_u32 s39, s39, 16384
    s_waitcnt vmcnt(8)
    s_setpc_b64 s[76:77]
SUB_w1_put:
    s_and_b32 s35, s30, 3
    s_mul_i32 s35, s35, 18432
    v_add_u32 v8, s35, v2
    v_mov_b32 v6, 162836
spin_74:
    s_sleep 2
    ds_read_b32 v7, v6
    s_waitcnt lgkmcnt(0)
    v_readfirstlane_b32 s53, v7
    s_nop 0
    s_cmp_ge_u32 s53, 8
    s_cbranch_scc0 spin_74
    s_waitcnt vmcnt(0)
    ds_write_b128 v8, v[176:179] offset:24576
    ds_write_b128 v8, v[188:191] offset:25600
    ds_write_b128 v8, v[192:195] offset:26624
    ds_write_b128 v8, v[200:203] offset:27648
    ds_write_b128 v8, v[204:207] offset:28672
    ds_write_b128 v8, v[208:211] offset:29696
    ds_write_b128 v8, v[212:215] offset:30720
    ds_write_b128 v8, v[216:219] offset:31744
    ds_write_b128 v8, v[220:223] offset:32768
    ds_write_b128 v8, v[224:227] offset:33792
    ds_write_b128 v8, v[16:19] offset:34816
    ds_write_b128 v8, v[20:23] offset:35840
    ds_write_b128 v8, v[24:27] offset:36864
    ds_write_b128 v8, v[28:31] offset:37888
    ds_write_b128 v8, v[32:35] offset:38912
    ds_write_b128 v8, v[36:39] offset:39936
    ds_write_b128 v8, v[40:43] offset:40960
    ds_write_b128 v8, v[44:47] offset:41984
    s_waitcnt lgkmcnt(0)
    s_setpc_b64 s[76:77]
SUB_after_g1:
    s_mov_b64 s[12:13], s[72:73]
    s_mov_b32 s14, 7340032
    s_mov_b32 s15, 0x20000
    v_readlane_b32 s36, v251, 0
    v_readlane_b32 s37, v251, 1
    s_and_b32 s35, s30, 3
    s_mul_i32 s38, s35, 114688
    s_mul_i32 s39, s29, 448
    s_add_u32 s38, s38, s39
    s_and_b32 s36, s36, 15
    s_mul_i32 s36, s36, 458752
    s_add_u32 s36, s36, s38
    s_and_b32 s37, s37, 15
    s_mul_i32 s37, s37, 458752
    s_add_u32 s37, s37, s38
    s_mul_i32 s39, s35, 7168
    s_add_u32 m0, s39, 131072
    s_nop 0
    buffer_load_dwordx4 v241, s[12:15], s36 offen lds
    s_add_u32 m0, m0, 1024
    s_nop 0
    buffer_load_dwordx4 v242, s[12:15], s36 offen lds
    s_add_u32 m0, m0, 1024
    s_nop 0
    buffer_load_dwordx4 v243, s[12:15], s36 offen lds
    s_add_u32 m0, m0, 1024
    s_nop 0
    buffer_load_dwordx4 v244, s[12:15], s36 offen lds
    s_add_u32 m0, m0, 1024
    s_nop 0
    buffer_load_dwordx4 v245, s[12:15], s36 offen lds
    s_add_u32 m0, m0, 1024
    s_nop 0
    buffer_load_dwordx4 v246, s[12:15], s36 offen lds
    s_add_u32 m0, m0, 1024
    s_nop 0
    buffer_load_dwordx4 v247, s[12:15], s36 offen lds
    buffer_load_dwordx4 v[176:179], v241, s[12:15], s37 offen
    buffer_load_dwordx4 v[180:183], v242, s[12:15], s37 offen
    buffer_load_dwordx4 v[184:187], v243, s[12:15], s37 offen
    buffer_load_dwordx4 v[188:191], v244, s[12:15], s37 offen
    buffer_load_dwordx4 v[192:195], v245, s[12:15], s37 offen
    buffer_load_dwordx4 v[196:199], v246, s[12:15], s37 offen
    buffer_load_dwordx4 v[200:203], v247, s[12:15], s37 offen
    s_lshr_b32 s36, s67, 2
    s_sub_u32 s36, s35, s36
    s_and_b32 s36, s36, 3
    s_lshl_b32 s36, s36, 15
    v_add_u32 v6, s36, v2
    s_waitcnt vmcnt(14)
    ds_write_b128 v6, v[48:51] offset:0
    ds_write_b128 v6, v[52:55] offset:1024
    ds_write_b128 v6, v[56:59] offset:2048
    ds_write_b128 v6, v[60:63] offset:3072
    ds_write_b128 v6, v[64:67] offset:4096
    ds_write_b128 v6, v[68:71] offset:5120
    ds_write_b128 v6, v[72:75] offset:6144
    ds_write_b128 v6, v[76:79] offset:7168
    ds_write_b128 v6, v[80:83] offset:8192
    ds_write_b128 v6, v[84:87] offset:9216
    ds_write_b128 v6, v[88:91] offset:10240
    ds_write_b128 v6, v[92:95] offset:11264
    ds_write_b128 v6, v[96:99] offset:12288
    ds_write_b128 v6, v[100:103] offset:13312
    ds_write_b128 v6, v[104:107] offset:14336
    ds_write_b128 v6, v[108:111] offset:15360
    ds_write_b128 v6, v[112:115] offset:16384
    ds_write_b128 v6, v[116:119] offset:17408
    ds_write_b128 v6, v[120:123] offset:18432
    ds_write_b128 v6, v[124:127] offset:19456
    ds_write_b128 v6, v[128:131] offset:20480
    ds_write_b128 v6, v[132:135] offset:21504
    ds_write_b128 v6, v[136:139] offset:22528
    ds_write_b128 v6, v[140:143] offset:23552
    ds_write_b128 v6, v[144:147] offset:24576
    ds_write_b128 v6, v[148:151] offset:25600
    ds_write_b128 v6, v[152:155] offset:26624
    ds_write_b128 v6, v[156:159] offset:27648
    ds_write_b128 v6, v[160:163] offset:28672
    ds_write_b128 v6, v[164:167] offset:29696
    ds_write_b128 v6, v[168:171] offset:30720
    ds_write_b128 v6, v[172:175] offset:31744
    s_waitcnt lgkmcnt(0)
    s_setpc_b64 s[76:77]
SUB_after_g2:
    s_and_b32 s35, s30, 3
    s_mul_i32 s39, s35, 7168
    s_add_u32 s39, s39, 73728
    v_add_u32 v6, s39, v2
    ds_write_b128 v6, v[176:179] offset:0
    ds_write_b128 v6, v[180:183] offset:1024
    ds_write_b128 v6, v[184:187] offset:2048
    ds_write_b128 v6, v[188:191] offset:3072
    ds_write_b128 v6, v[192:195] offset:4096
    ds_write_b128 v6, v[196:199] offset:5120
    ds_write_b128 v6, v[200:203] offset:6144
    s_waitcnt lgkmcnt(0)
    s_setpc_b64 s[76:77]
SUB_r_pre0:
    s_waitcnt lgkmcnt(0)
    v_and_b32 v199, 7, v0
    v_lshrrev_b32 v228, 6, v0
    v_lshlrev_b32 v228, 4, v228
    v_bfe_u32 v229, v0, 3, 3
    v_add_u32 v228, v228, v229
    s_lshr_b32 s78, s29, 1
    s_lshl_b32 s78, s78, 16
    s_and_b32 s79, s29, 1
    s_lshl_b32 s79, s79, 7
    s_add_u32 s78, s78, s79
    s_lshr_b32 s79, s30, 1
    s_lshl_b32 s79, s79, 13
    s_add_u32 s78, s78, s79
    v_lshlrev_b32 v196, 8, v228
    v_lshl_add_u32 v196, v199, 4, v196
    v_add_u32 v196, s78, v196
    s_mov_b32 s84, s62
    s_mov_b32 s85, s63
    s_mov_b32 s86, 0x7e000
    s_mov_b32 s87, 0x20000
    s_add_u32 s88, s62, 0x80000
    s_addc_u32 s89, s63, 0
    s_mov_b32 s90, 0x7e000
    s_mov_b32 s91, 0x20000
    s_cmp_eq_u32 s60, 0
    s_cselect_b32 s86, s86, 0
    s_cselect_b32 s90, s90, 0
    buffer_load_dwordx4 v[180:183], v196, s[84:87], 0 offen offset:0 sc1
    buffer_load_dwordx4 v[188:191], v196, s[88:91], 0 offen offset:0 sc1
    buffer_load_dwordx4 v[184:187], v196, s[84:87], 0 offen offset:2048 sc1
    buffer_load_dwordx4 v[192:195], v196, s[88:91], 0 offen offset:2048 sc1
    s_setpc_b64 s[76:77]
SUB_w_issue_1:
    s_add_u32 s19, s41, s42
    s_mul_i32 s16, s44, 131072
    s_add_u32 s16, s16, s38
    s_add_u32 s44, s44, 1
    s_and_b32 s44, s44, 15
    s_add_u32 s42, s42, 8192
    s_cmp_eq_u32 s42, 131072
    s_cselect_b32 s42, 0, s42
    s_mov_b32 m0, s19
    s_mov_b32 s39, s16
    buffer_load_dwordx4 v238, s[12:15], s39 offen lds
    s_add_u32 m0, m0, 1024
    s_add_u32 s39, s39, 16384
    buffer_load_dwordx4 v238, s[12:15], s39 offen lds
    s_add_u32 m0, m0, 1024
    s_add_u32 s39, s39, 16384
    buffer_load_dwordx4 v238, s[12:15], s39 offen lds
    s_add_u32 m0, m0, 1024
    s_add_u32 s39, s39, 16384
    buffer_load_dwordx4 v238, s[12:15], s39 offen lds
    s_setpc_b64 s[76:77]
PREP_a_issue_4:
    s_add_u32 s19, s41, s42
    v_readlane_b32 s16, v249, s44
    v_readlane_b32 s17, v250, s44
    s_add_u32 s16, s16, s38
    s_add_u32 s17, s17, s38
    s_add_u32 s44, s44, 1
    s_add_u32 s42, s42, 16384
    s_cmp_eq_u32 s42, 49152
    s_cselect_b32 s42, 0, s42
    s_setpc_b64 s[76:77]
PREP_w_issue_4:
    s_mov_b32 s45, 8192
    s_add_u32 s19, s41, s42
    v_readlane_b32 s16, v249, s44
    s_nop 0
    s_bitcmp1_b32 s16, 0
    s_cselect_b32 s17, 16384, s45
    s_cselect_b32 s18, -40960, s45
    s_andn2_b32 s16, s16, 1
    s_add_u32 s16, s16, s38
    s_add_u32 s44, s44, 1
    s_add_u32 s42, s42, 16384
    s_cmp_eq_u32 s42, 98304
    s_cselect_b32 s42, 0, s42
    s_setpc_b64 s[76:77]
K_end:
    s_endpgm
.p2align 6
K_tab:
.short 4096,5137,6178,11379,18660,25941,40502,33223,47784,55065,19706,12427,26988,34269,48830,41551,56096,9264,20736,10448,23824,25008,38384,35296,39568,49856,54128,52944,0,0,0,0
.short 4096,5137,6178,18659,11380,25941,33222,47783,40504,55065,12426,26987,19708,34269,41550,56111,48816,9264,10448,23824,20736,25008,35296,39568,38384,49856,52944,54128,0,0,0,0
.short 4096,5137,6178,11379,25940,18661,33222,40503,55064,47785,12426,19707,34268,26989,41550,48831,9264,56096,10448,20736,25008,23824,35296,38384,49856,39568,52944,54128,0,0,0,0
.short 4096,5137,6178,11379,18660,33221,25942,40503,47784,12425,55066,19707,26988,41549,34270,48831,56096,10448,9264,20736,23824,35296,25008,38384,39568,52944,49856,54128,0,0,0,0
.short 11377,12418,13459,18660,4101,25942,33223,47784,40505,55066,5147,26988,19709,34270,41551,56096,48816,6176,10288,23824,20736,25008,35296,39568,38384,49856,52944,54128,0,0,0,0
.short 11377,12418,13459,4100,25941,18662,33223,40504,55065,47786,5147,19708,34269,26990,41551,48816,6176,56096,10288,20736,25008,23824,35296,38384,49856,39568,52944,54128,0,0,0,0
.short 11377,12418,13459,4100,18661,33222,25943,40504,47785,5146,55067,19708,26989,41550,34271,48816,56096,10288,6176,20736,23824,35296,25008,38384,39568,52944,49856,54128,0,0,0,0
.short 11377,12418,13459,4100,18661,25942,40503,33224,47785,55066,19707,5148,26989,34270,48831,41536,56096,6176,20736,10288,23824,25008,38384,35296,39568,49856,54128,52944,0,0,0,0
.short 18658,19699,20740,4101,25942,11383,33224,40505,55066,47787,5148,12429,34270,26991,41536,48817,6176,56096,9264,10448,25008,23824,35296,38384,49856,39568,52944,54128,0,0,0,0
.short 18658,19699,20740,4101,11382,33223,25944,40505,47786,5147,55068,12429,26990,41551,34256,48817,56096,9264,6176,10448,23824,35296,25008,38384,39568,52944,49856,54128,0,0,0,0
.short 18658,19699,20740,4101,11382,25943,40504,33225,47786,55067,12428,5149,26990,34271,48816,41537,56096,6176,10448,9264,23824,25008,38384,35296,39568,49856,54128,52944,0,0,0,0
.short 18658,19699,20740,11381,4102,25943,33224,47785,40506,55067,5148,26989,12430,34271,41536,56097,48816,6176,9264,23824,10448,25008,35296,39568,38384,49856,52944,54128,0,0,0,0
.short 25939,26980,28021,4102,11383,33224,18665,40506,47787,5148,55069,12430,19711,41536,34257,48818,56096,9264,6176,10448,20736,35296,24848,38384,39568,52944,49856,54128,0,0,0,0
.short 25939,26980,28021,4102,11383,18664,40505,33226,47787,55068,12429,5150,19711,34256,48817,41538,56096,6176,10448,9264,20736,24848,38384,35296,39568,49856,54128,52944,0,0,0,0
.short 25939,26980,28021,11382,4103,18664,33225,47786,40507,55068,5149,19710,12431,34256,41537,56098,48816,6176,9264,20736,10448,24848,35296,39568,38384,49856,52944,54128,0,0,0,0
.short 25939,26980,28021,4102,18663,11384,33225,40506,55067,47788,5149,12430,34271,19696,41537,48818,6176,56096,9264,10448,24848,20736,35296,38384,49856,39568,52944,54128,0,0,0,0
.short 33220,34261,35302,4103,11384,18665,40506,25947,47788,55069,12430,5151,19696,26977,48818,41539,56096,6176,10448,9264,20736,23824,38384,25008,39568,49856,54128,52944,0,0,0,0
.short 33220,34261,35302,11383,4104,18665,25946,47787,40508,55069,5150,19711,12416,26977,41538,56099,48816,6176,9264,20736,10448,23824,25008,39568,38384,49856,52944,54128,0,0,0,0
.short 33220,34261,35302,4103,18664,11385,25946,40507,55068,47789,5150,12431,26976,19697,41538,48819,6176,56096,9264,10448,23824,20736,25008,38384,49856,39568,52944,54128,0,0,0,0
.short 33220,34261,35302,4103,11384,25945,18666,40507,47788,5149,55070,12431,19696,41537,26978,48819,56096,9264,6176,10448,20736,25008,23824,38384,39568,52944,49856,54128,0,0,0,0
.short 40501,41542,42583,11384,4105,18666,25947,47788,33229,55070,5151,19696,12417,26978,34259,56100,48816,6176,9264,20736,10448,23824,25008,39408,35296,49856,52944,54128,0,0,0,0
.short 40501,41542,42583,4104,18665,11386,25947,33228,55069,47790,5151,12416,26977,19698,34259,48820,6176,56096,9264,10448,23824,20736,25008,35296,49856,39408,52944,54128,0,0,0,0
.short 40501,41542,42583,4104,11385,25946,18667,33228,47789,5150,55071,12416,19697,34258,26979,48820,56096,9264,6176,10448,20736,25008,23824,35296,39408,52944,49856,54128,0,0,0,0
.short 40501,41542,42583,4104,11385,18666,33227,25948,47789,55070,12431,5136,19697,26978,48819,34260,56096,6176,10448,9264,20736,23824,35296,25008,39408,49856,54128,52944,0,0,0,0
.short 47782,48823,49864,4105,18666,11387,25948,33229,55070,40511,5136,12417,26978,19699,34260,41541,6176,56096,9264,10448,23824,20736,25008,35296,39568,38384,52944,54128,0,0,0,0
.short 47782,48823,49864,4105,11386,25947,18668,33229,40510,5151,55056,12417,19698,34259,26980,41541,56096,9264,6176,10448,20736,25008,23824,35296,38384,52944,39568,54128,0,0,0,0
.short 47782,48823,49864,4105,11386,18667,33228,25949,40510,55071,12416,5137,19698,26979,41540,34261,56096,6176,10448,9264,20736,23824,35296,25008,38384,39568,54128,52944,0,0,0,0
.short 47782,48823,49864,11385,4106,18667,25948,40509,33230,55071,5136,19697,12418,26979,34260,56101,41536,6176,9264,20736,10448,23824,25008,38384,35296,39568,52944,54128,0,0,0,0
.short 55063,56104,57145,4106,11387,25948,18669,33230,40511,5136,47777,12418,19699,34260,26981,41542,48816,9264,6176,10448,20736,25008,23824,35296,38384,49856,39568,53968,0,0,0,0
.short 55063,56104,57145,4106,11387,18668,33229,25950,40511,47776,12417,5138,19699,26980,41541,34262,48816,6176,10448,9264,20736,23824,35296,25008,38384,39568,53968,49856,0,0,0,0
.short 55063,56104,57145,11386,4107,18668,25949,40510,33231,47776,5137,19698,12419,26980,34261,48822,41536,6176,9264,20736,10448,23824,25008,38384,35296,39568,49856,53968,0,0,0,0
.short 55063,56104,57145,4106,18667,11388,25949,33230,47791,40496,5137,12418,26979,19700,34261,41542,6176,48816,9264,10448,23824,20736,25008,35296,39568,38384,49856,53968,0,0,0,0
.short 4104,5145,6186,11387,18668,25949,40510,33231,47776,55057,19698,12419,26980,34261,48822,41543,56096,9264,20736,10448,23824,25008,38384,35296,39568,49856,54128,52944,0,0,0,0
.short 4104,5145,6186,18667,11388,25949,33230,47791,40496,55057,12418,26979,19700,34261,41542,56103,48816,9264,10448,23824,20736,25008,35296,39568,38384,49856,52944,54128,0,0,0,0
.short 4104,5145,6186,11387,25948,18669,33230,40511,55056,47777,12418,19699,34260,26981,41542,48823,9264,56096,10448,20736,25008,23824,35296,38384,49856,39568,52944,54128,0,0,0,0
.short 4104,5145,6186,11387,18668,33229,25950,40511,47776,12417,55058,19699,26980,41541,34262,48823,56096,10448,9264,20736,23824,35296,25008,38384,39568,52944,49856,54128,0,0,0,0
.short 11385,12426,13467,18668,4109,25950,33231,47776,40497,55058,5139,26980,19701,34262,41543,56104,48816,6176,10288,23824,20736,25008,35296,39568,38384,49856,52944,54128,0,0,0,0
.short 11385,12426,13467,4108,25949,18670,33231,40496,55057,47778,5139,19700,34261,26982,41543,48824,6176,56096,10288,20736,25008,23824,35296,38384,49856,39568,52944,54128,0,0,0,0
.short 11385,12426,13467,4108,18669,33230,25951,40496,47777,5138,55059,19700,26981,41542,34263,48824,56096,10288,6176,20736,23824,35296,25008,38384,39568,52944,49856,54128,0,0,0,0
.short 11385,12426,13467,4108,18669,25950,40511,33216,47777,55058,19699,5140,26981,34262,48823,41544,56096,6176,20736,10288,23824,25008,38384,35296,39568,49856,54128,52944,0,0,0,0
.short 18666,19707,20748,4109,25950,11391,33216,40497,55058,47779,5140,12421,34262,26983,41544,48825,6176,56096,9264,10448,25008,23824,35296,38384,49856,39568,52944,54128,0,0,0,0
.short 18666,19707,20748,4109,11390,33231,25936,40497,47778,5139,55060,12421,26982,41543,34264,48825,56096,9264,6176,10448,23824,35296,25008,38384,39568,52944,49856,54128,0,0,0,0
.short 18666,19707,20748,4109,11390,25951,40496,33217,47778,55059,12420,5141,26982,34263,48824,41545,56096,6176,10448,9264,23824,25008,38384,35296,39568,49856,54128,52944,0,0,0,0
.short 18666,19707,20748,11389,4110,25951,33216,47777,40498,55059,5140,26981,12422,34263,41544,56105,48816,6176,9264,23824,10448,25008,35296,39568,38384,49856,52944,54128,0,0,0,0
.short 25947,26988,28029,4110,11391,33216,18657,40498,47779,5140,55061,12422,19703,41544,34265,48826,56096,9264,6176,10448,20736,35296,24848,38384,39568,52944,49856,54128,0,0,0,0
.short 25947,26988,28029,4110,11391,18656,40497,33218,47779,55060,12421,5142,19703,34264,48825,41546,56096,6176,10448,9264,20736,24848,38384,35296,39568,49856,54128,52944,0,0,0,0
.short 25947,26988,28029,11390,4111,18656,33217,47778,40499,55060,5141,19702,12423,34264,41545,56106,48816,6176,9264,20736,10448,24848,35296,39568,38384,49856,52944,54128,0,0,0,0
.short 25947,26988,28029,4110,18671,11376,33217,40498,55059,47780,5141,12422,34263,19704,41545,48826,6176,56096,9264,10448,24848,20736,35296,38384,49856,39568,52944,54128,0,0,0,0
.short 33228,34269,35310,4111,11376,18657,40498,25939,47780,55061,12422,5143,19704,26985,48826,41547,56096,6176,10448,9264,20736,23824,38384,25008,39568,49856,54128,52944,0,0,0,0
.short 33228,34269,35310,11391,4096,18657,25938,47779,40500,55061,5142,19703,12424,26985,41546,56107,48816,6176,9264,20736,10448,23824,25008,39568,38384,49856,52944,54128,0,0,0,0
.short 33228,34269,35310,4111,18656,11377,25938,40499,55060,47781,5142,12423,26984,19705,41546,48827,6176,56096,9264,10448,23824,20736,25008,38384,49856,39568,52944,54128,0,0,0,0
.short 33228,34269,35310,4111,11376,25937,18658,40499,47780,5141,55062,12423,19704,41545,26986,48827,56096,9264,6176,10448,20736,25008,23824,38384,39568,52944,49856,54128,0,0,0,0
.short 40509,41550,42591,11376,4097,18658,25939,47780,33221,55062,5143,19704,12425,26986,34267,56108,48816,6176,9264,20736,10448,23824,25008,39408,35296,49856,52944,54128,0,0,0,0
.short 40509,41550,42591,4096,18657,11378,25939,33220,55061,47782,5143,12424,26985,19706,34267,48828,6176,56096,9264,10448,23824,20736,25008,35296,49856,39408,52944,54128,0,0,0,0
.short 40509,41550,42591,4096,11377,25938,18659,33220,47781,5142,55063,12424,19705,34266,26987,48828,56096,9264,6176,10448,20736,25008,23824,35296,39408,52944,49856,54128,0,0,0,0
.short 40509,41550,42591,4096,11377,18658,33219,25940,47781,55062,12423,5144,19705,26986,48827,34268,56096,6176,10448,9264,20736,23824,35296,25008,39408,49856,54128,52944,0,0,0,0
.short 47790,48831,49856,4097,18658,11379,25940,33221,55062,40503,5144,12425,26986,19707,34268,41549,6176,56096,9264,10448,23824,20736,25008,35296,39568,38384,52944,54128,0,0,0,0
.short 47790,48831,49856,4097,11378,25939,18660,33221,40502,5143,55064,12425,19706,34267,26988,41549,56096,9264,6176,10448,20736,25008,23824,35296,38384,52944,39568,54128,0,0,0,0
.short 47790,48831,49856,4097,11378,18659,33220,25941,40502,55063,12424,5145,19706,26987,41548,34269,56096,6176,10448,9264,20736,23824,35296,25008,38384,39568,54128,52944,0,0,0,0
.short 47790,48831,49856,11377,4098,18659,25940,40501,33222,55063,5144,19705,12426,26987,34268,56109,41536,6176,9264,20736,10448,23824,25008,38384,35296,39568,52944,54128,0,0,0,0
.short 55071,56096,57137,4098,11379,25940,18661,33222,40503,5144,47785,12426,19707,34268,26989,41550,48816,9264,6176,10448,20736,25008,23824,35296,38384,49856,39568,53968,0,0,0,0
.short 55071,56096,57137,4098,11379,18660,33221,25942,40503,47784,12425,5146,19707,26988,41549,34270,48816,6176,10448,9264,20736,23824,35296,25008,38384,39568,53968,49856,0,0,0,0
.short 55071,56096,57137,11378,4099,18660,25941,40502,33223,47784,5145,19706,12427,26988,34269,48830,41536,6176,9264,20736,10448,23824,25008,38384,35296,39568,49856,53968,0,0,0,0
.short 55071,56096,57137,4098,18659,11380,25941,33222,47783,40504,5145,12426,26987,19708,34269,41550,6176,48816,9264,10448,23824,20736,25008,35296,39568,38384,49856,53968,0,0,0,0
.section .rodata,"a"
.p2align 6
.amdhsa_kernel interleave_layers__ssm_conv_h3__mixer_s_mlp__prompt_kernel
  .amdhsa_next_free_vgpr 256
  .amdhsa_next_free_sgpr 102
  .amdhsa_accum_offset 256
  .amdhsa_group_segment_fixed_size 0
  .amdhsa_kernarg_size 112
  .amdhsa_user_sgpr_count 2
  .amdhsa_user_sgpr_kernarg_segment_ptr 1
  .amdhsa_system_sgpr_workgroup_id_x 1
  .amdhsa_float_denorm_mode_32 3
.end_amdhsa_kernel
```

```asm
; @launch grid=(256,1,1) block=(512,1,1) lds=163840
.amdgcn_target "amdgcn-amd-amdhsa--gfx950"
.text
.globl interleave_layers__ssm_conv_h3__mixer_s_mlp__prompt_kernel
.p2align 8
.type interleave_layers__ssm_conv_h3__mixer_s_mlp__prompt_kernel,@function
interleave_layers__ssm_conv_h3__mixer_s_mlp__prompt_kernel:
    s_cmp_ge_u32 s2, 256
    s_cbranch_scc1 K_end
    s_load_dwordx8 s[8:15], s[0:1], 8
    s_load_dwordx2 s[6:7], s[0:1], 0
    s_load_dwordx8 s[68:75], s[0:1], 56
    s_load_dwordx2 s[4:5], s[0:1], 104
    s_load_dwordx2 s[84:85], s[0:1], 96
    s_memrealtime s[46:47]
    s_load_dwordx2 s[96:97], s[0:1], 40
    v_lshrrev_b32 v1, 6, v0
    s_nop 0
    v_readfirstlane_b32 s30, v1
    s_getpc_b64 s[48:49]
K_pc:
    s_lshr_b32 s36, s2, 3
    s_lshl_b32 s36, s36, 11
    v_lshlrev_b32 v4, 2, v0
    v_add_u32 v4, s36, v4
    v_cmp_gt_u32 vcc, K_end-K_pc-8, v4
    s_nop 0
    s_and_saveexec_b64 s[36:37], vcc
    s_cbranch_execz K_3
    v_mov_b32 v5, s49
    v_add_co_u32 v4, vcc, s48, v4
    s_nop 1
    v_addc_co_u32 v5, vcc, 0, v5, vcc
    global_load_dword v250, v[4:5], off
K_3:
    s_mov_b64 exec, -1
    v_and_b32 v6, 31, v0
    v_lshrrev_b32 v7, 5, v0
    s_and_b32 s34, s2, 7
    s_lshr_b32 s35, s2, 3
    s_lshl_b32 s36, s35, 17
    s_lshl_b32 s37, s34, 8
    s_add_u32 s36, s36, s37
    v_lshlrev_b32 v8, 13, v7
    v_lshl_add_u32 v8, v6, 3, v8
    v_add_u32 v12, s36, v8
    v_add_u32 v14, 4096, v12
    s_mov_b32 s18, 4194304
    s_mov_b32 s19, 0x20000
    s_mov_b32 s22, s18
    s_mov_b32 s23, s19
    s_waitcnt lgkmcnt(0)
    s_mov_b32 s86, 256
    s_mov_b32 s87, 0x20000
    v_mov_b32 v78, 0
    s_lshl_b32 s45, s2, 3
    s_add_u32 s45, s45, s30
    s_cmp_lg_u32 s45, 4
    s_cbranch_scc1 KV_t0
    s_getreg_b32 s45, hwreg(HW_REG_XCC_ID, 0, 3)
    s_lshl_b32 s45, s45, 1
    s_lshl_b32 s44, s46, 6
    s_or_b32 s44, s44, s45
    s_or_b32 s44, s44, 1
    v_mov_b32 v76, s44
    v_mov_b32 v77, 0
    s_mov_b64 exec, 1
    buffer_store_dwordx2 v[76:77], v78, s[84:87], 0 offen sc1
    s_mov_b64 exec, -1
KV_t0:
    s_mov_b64 s[16:17], s[8:9]
    s_mov_b64 s[20:21], s[10:11]
    buffer_load_dwordx2 v[28:29], v12, s[16:19], 0 offen offset:0 nt
    buffer_load_dwordx2 v[30:31], v12, s[16:19], 0 offen offset:2048 nt
    buffer_load_dwordx2 v[32:33], v14, s[16:19], 0 offen offset:0 nt
    buffer_load_dwordx2 v[34:35], v14, s[16:19], 0 offen offset:2048 nt
    buffer_load_dwordx2 v[36:37], v12, s[20:23], 0 offen offset:0 nt
    buffer_load_dwordx2 v[38:39], v12, s[20:23], 0 offen offset:2048 nt
    buffer_load_dwordx2 v[40:41], v14, s[20:23], 0 offen offset:0 nt
    buffer_load_dwordx2 v[42:43], v14, s[20:23], 0 offen offset:2048 nt
    v_subrev_u32 v9, 6144, v12
    v_subrev_u32 v10, 4096, v12
    v_subrev_u32 v11, 2048, v12
    s_lshl_b32 s37, s34, 10
    v_lshlrev_b32 v16, 5, v6
    v_add_u32 v16, s37, v16
    s_mov_b32 s24, s12
    s_mov_b32 s25, s13
    s_mov_b32 s26, 0x2000
    s_mov_b32 s27, 0x20000
    v_and_b32 v8, 1, v7
    v_lshl_add_u32 v16, v8, 4, v16
    buffer_load_dwordx4 v[44:47], v16, s[24:27], 0 offen
    s_cmp_lg_u32 s30, 4
    s_cbranch_scc1 KV_t2
    buffer_load_dword v76, v78, s[84:87], 0 offen sc1
KV_t2:
    s_bfm_b64 exec, 32, 0
    buffer_load_dwordx2 v[22:23], v9, s[16:19], 0 offen nt
    buffer_load_dwordx2 v[24:25], v10, s[16:19], 0 offen nt
    buffer_load_dwordx2 v[26:27], v11, s[16:19], 0 offen nt
    s_mov_b64 exec, -1
    v_and_b32 v1, 63, v0
    v_lshlrev_b32 v2, 4, v1
    v_lshlrev_b32 v3, 2, v1
    s_mov_b32 s67, 0
    s_mov_b32 s60, 0
    s_mov_b32 s61, 40000
    s_mov_b32 s52, 0
    s_mov_b32 s55, 0
    s_mov_b32 s92, 0
    s_mov_b32 s93, 0
    s_mov_b32 s94, 0
    s_mov_b32 s56, s4
    s_mov_b32 s57, s5
    s_mov_b32 s58, 0xa000000
    s_mov_b32 s59, 0x20000
    s_add_u32 s62, s4, 33554432
    s_addc_u32 s63, s5, 0
    s_and_b32 s41, s30, 3
    s_and_b32 s38, s2, 7
    s_lshl_b32 s38, s38, 5
    s_lshr_b32 s39, s2, 3
    s_add_u32 s38, s38, s39
    s_lshl_b32 s39, s38, 2
    s_add_u32 s39, s39, s41
    s_mul_i32 s40, s41, 24576
    s_lshr_b32 s36, s39, 1
    s_lshl_b32 s36, s36, 2
    s_load_dword s98, s[96:97], s36
    s_lshl_b32 s36, s39, 12
    s_add_u32 s12, s14, s36
    s_addc_u32 s13, s15, 0
    s_mov_b32 s14, 4096
    s_mov_b32 s15, 0x20000
    s_lshr_b32 s45, s30, 2
    s_lshl_b32 s45, s45, 11
    s_add_u32 s36, s45, 0xffffffc0
    v_add_u32 v70, s36, v2
    v_add_u32 v71, 16, v70
    s_add_u32 s36, s45, 0x3c0
    v_add_u32 v72, s36, v2
    v_add_u32 v73, 16, v72
    s_mov_b32 s36, 4032
    v_add_u32 v74, s36, v2
    v_add_u32 v75, 16, v74
    s_and_b32 s34, s2, 7
    s_lshr_b32 s35, s2, 3
    v_mov_b32 v80, 0
    v_mov_b32 v81, 0
    v_mov_b32 v82, 0
    v_mov_b32 v83, 0
    v_add_u32 v86, s40, v2
    ds_write_b128 v86, v[80:83] offset:22784
    s_bfm_b64 exec, 26, 0
    ds_write_b128 v86, v[80:83] offset:23808
    s_mov_b64 exec, -1
    v_lshlrev_b32 v8, 2, v7
    v_sub_u32 v8, 60, v8
    v_lshrrev_b32 v85, 3, v8
    v_bfe_u32 v84, v6, 1, 3
    v_xor_b32 v85, v85, v84
    v_lshlrev_b32 v85, 4, v85
    v_and_b32 v8, 7, v8
    v_lshl_add_u32 v85, v8, 1, v85
    v_lshl_add_u32 v84, v6, 9, v85
    v_add_u32 v84, 98304, v84
    s_waitcnt vmcnt(0)
    s_cmp_lg_u32 s30, 4
    s_cbranch_scc1 KV_t1
KV_t1:
    buffer_load_dwordx4 v[52:55], v70, s[12:15], 0 offen nt
    buffer_load_dwordx2 v[56:57], v71, s[12:15], 0 offen nt
    buffer_load_dwordx4 v[58:61], v72, s[12:15], 0 offen nt
    buffer_load_dwordx2 v[62:63], v73, s[12:15], 0 offen nt
    buffer_load_dwordx4 v[64:67], v74, s[12:15], 0 offen nt
    buffer_load_dwordx2 v[68:69], v75, s[12:15], 0 offen nt
    v_mov_b32 v48, v44
    v_mov_b32 v49, v45
    v_mov_b32 v50, v46
    v_mov_b32 v51, v47
    v_mov_b32 v126, v30
    v_mov_b32 v127, v31
    v_mov_b32 v128, v32
    v_mov_b32 v129, v33
    v_mov_b32 v130, v34
    v_mov_b32 v131, v35
    v_permlane32_swap_b32 v44, v48
    v_permlane32_swap_b32 v45, v49
    v_permlane32_swap_b32 v46, v50
    v_permlane32_swap_b32 v47, v51
    v_permlane32_swap_b32 v22, v126
    v_permlane32_swap_b32 v23, v127
    v_permlane32_swap_b32 v24, v128
    v_permlane32_swap_b32 v25, v129
    v_permlane32_swap_b32 v26, v130
    v_permlane32_swap_b32 v27, v131
    v_lshlrev_b32 v88, 16, v44
    v_and_b32 v90, 0xffff0000, v44
    v_lshlrev_b32 v92, 16, v45
    v_and_b32 v94, 0xffff0000, v45
    v_lshlrev_b32 v89, 16, v46
    v_and_b32 v91, 0xffff0000, v46
    v_lshlrev_b32 v93, 16, v47
    v_and_b32 v95, 0xffff0000, v47
    v_lshlrev_b32 v96, 16, v22
    v_and_b32 v97, 0xffff0000, v22
    v_lshlrev_b32 v98, 16, v24
    v_and_b32 v99, 0xffff0000, v24
    v_lshlrev_b32 v100, 16, v26
    v_and_b32 v101, 0xffff0000, v26
    v_lshlrev_b32 v102, 16, v28
    v_and_b32 v103, 0xffff0000, v28
    v_lshlrev_b32 v104, 16, v30
    v_and_b32 v105, 0xffff0000, v30
    v_lshlrev_b32 v106, 16, v32
    v_and_b32 v107, 0xffff0000, v32
    v_lshlrev_b32 v108, 16, v34
    v_and_b32 v109, 0xffff0000, v34
    v_lshlrev_b32 v110, 16, v36
    v_and_b32 v111, 0xffff0000, v36
    v_lshlrev_b32 v112, 16, v38
    v_and_b32 v113, 0xffff0000, v38
    v_lshlrev_b32 v114, 16, v40
    v_and_b32 v115, 0xffff0000, v40
    v_lshlrev_b32 v116, 16, v42
    v_and_b32 v117, 0xffff0000, v42
    v_pk_mul_f32 v[118:119], v[96:97], v[94:95]
    v_pk_mul_f32 v[120:121], v[98:99], v[94:95]
    v_pk_mul_f32 v[122:123], v[100:101], v[94:95]
    v_pk_mul_f32 v[124:125], v[102:103], v[94:95]
    v_pk_fma_f32 v[118:119], v[98:99], v[92:93], v[118:119]
    v_pk_fma_f32 v[120:121], v[100:101], v[92:93], v[120:121]
    v_pk_fma_f32 v[122:123], v[102:103], v[92:93], v[122:123]
    v_pk_fma_f32 v[124:125], v[104:105], v[92:93], v[124:125]
    v_pk_fma_f32 v[118:119], v[100:101], v[90:91], v[118:119]
    v_pk_fma_f32 v[120:121], v[102:103], v[90:91], v[120:121]
    v_pk_fma_f32 v[122:123], v[104:105], v[90:91], v[122:123]
    v_pk_fma_f32 v[124:125], v[106:107], v[90:91], v[124:125]
    v_pk_fma_f32 v[118:119], v[102:103], v[88:89], v[118:119]
    v_pk_fma_f32 v[120:121], v[104:105], v[88:89], v[120:121]
    v_pk_fma_f32 v[122:123], v[106:107], v[88:89], v[122:123]
    v_pk_fma_f32 v[124:125], v[108:109], v[88:89], v[124:125]
    v_pk_mul_f32 v[118:119], v[118:119], v[110:111]
    v_pk_mul_f32 v[120:121], v[120:121], v[112:113]
    v_pk_mul_f32 v[122:123], v[122:123], v[114:115]
    v_pk_mul_f32 v[124:125], v[124:125], v[116:117]
    v_cvt_pk_bf16_f32 v136, v124, v122
    v_cvt_pk_bf16_f32 v137, v120, v118
    ds_write_b64 v84, v[136:137] offset:0
    v_cvt_pk_bf16_f32 v138, v125, v123
    v_cvt_pk_bf16_f32 v139, v121, v119
    ds_write_b64 v84, v[138:139] offset:128
    v_lshlrev_b32 v88, 16, v48
    v_and_b32 v90, 0xffff0000, v48
    v_lshlrev_b32 v92, 16, v49
    v_and_b32 v94, 0xffff0000, v49
    v_lshlrev_b32 v89, 16, v50
    v_and_b32 v91, 0xffff0000, v50
    v_lshlrev_b32 v93, 16, v51
    v_and_b32 v95, 0xffff0000, v51
    v_lshlrev_b32 v96, 16, v23
    v_and_b32 v97, 0xffff0000, v23
    v_lshlrev_b32 v98, 16, v25
    v_and_b32 v99, 0xffff0000, v25
    v_lshlrev_b32 v100, 16, v27
    v_and_b32 v101, 0xffff0000, v27
    v_lshlrev_b32 v102, 16, v29
    v_and_b32 v103, 0xffff0000, v29
    v_lshlrev_b32 v104, 16, v31
    v_and_b32 v105, 0xffff0000, v31
    v_lshlrev_b32 v106, 16, v33
    v_and_b32 v107, 0xffff0000, v33
    v_lshlrev_b32 v108, 16, v35
    v_and_b32 v109, 0xffff0000, v35
    v_lshlrev_b32 v110, 16, v37
    v_and_b32 v111, 0xffff0000, v37
    v_lshlrev_b32 v112, 16, v39
    v_and_b32 v113, 0xffff0000, v39
    v_lshlrev_b32 v114, 16, v41
    v_and_b32 v115, 0xffff0000, v41
    v_lshlrev_b32 v116, 16, v43
    v_and_b32 v117, 0xffff0000, v43
    v_pk_mul_f32 v[118:119], v[96:97], v[94:95]
    v_pk_mul_f32 v[120:121], v[98:99], v[94:95]
    v_pk_mul_f32 v[122:123], v[100:101], v[94:95]
    v_pk_mul_f32 v[124:125], v[102:103], v[94:95]
    v_pk_fma_f32 v[118:119], v[98:99], v[92:93], v[118:119]
    v_pk_fma_f32 v[120:121], v[100:101], v[92:93], v[120:121]
    v_pk_fma_f32 v[122:123], v[102:103], v[92:93], v[122:123]
    v_pk_fma_f32 v[124:125], v[104:105], v[92:93], v[124:125]
    v_pk_fma_f32 v[118:119], v[100:101], v[90:91], v[118:119]
    v_pk_fma_f32 v[120:121], v[102:103], v[90:91], v[120:121]
    v_pk_fma_f32 v[122:123], v[104:105], v[90:91], v[122:123]
    v_pk_fma_f32 v[124:125], v[106:107], v[90:91], v[124:125]
    v_pk_fma_f32 v[118:119], v[102:103], v[88:89], v[118:119]
    v_pk_fma_f32 v[120:121], v[104:105], v[88:89], v[120:121]
    v_pk_fma_f32 v[122:123], v[106:107], v[88:89], v[122:123]
    v_pk_fma_f32 v[124:125], v[108:109], v[88:89], v[124:125]
    v_pk_mul_f32 v[118:119], v[118:119], v[110:111]
    v_pk_mul_f32 v[120:121], v[120:121], v[112:113]
    v_pk_mul_f32 v[122:123], v[122:123], v[114:115]
    v_pk_mul_f32 v[124:125], v[124:125], v[116:117]
    v_cvt_pk_bf16_f32 v140, v124, v122
    v_cvt_pk_bf16_f32 v141, v120, v118
    ds_write_b64 v84, v[140:141] offset:256
    v_cvt_pk_bf16_f32 v142, v125, v123
    v_cvt_pk_bf16_f32 v143, v121, v119
    ds_write_b64 v84, v[142:143] offset:384
    s_cmp_lg_u32 s30, 4
    s_cbranch_scc1 HB_2
    v_add_u32 v18, 162816, v3
    ds_write_b32 v18, v78
    s_mov_b32 s53, 0
    s_waitcnt vmcnt(6)
HB_p:
    v_readfirstlane_b32 s52, v76
    s_nop 0
    s_cmp_eq_u32 s52, 0
    s_cbranch_scc1 HB_r
    s_cmp_ge_u32 s53, 400
    s_cbranch_scc1 HB_q
    s_add_u32 s54, s46, 8192
    s_lshl_b32 s54, s54, 6
    s_sub_u32 s54, s54, s52
    s_cmp_lt_u32 s54, 786432
    s_cbranch_scc1 HB_q
HB_r:
    buffer_load_dword v76, v78, s[84:87], 0 offen sc1
    s_waitcnt vmcnt(0)
    s_add_u32 s53, s53, 1
    s_cmp_lt_u32 s53, s61
    s_cbranch_scc1 HB_p
    s_mov_b32 s52, 1
    s_mov_b32 s61, 0
HB_q:
    v_mov_b32 v18, 162828
    v_mov_b32 v19, s52
    s_waitcnt lgkmcnt(0)
    ds_write_b32 v18, v19
HB_2:
    s_add_u32 s16, s4, 0x2000000
    s_addc_u32 s17, s5, 0
    s_mov_b32 s18, 0x8000000
    s_mov_b32 s19, 0x20000
    v_lshrrev_b32 v8, 3, v0
    v_and_b32 v85, 7, v0
    v_lshlrev_b32 v149, 12, v8
    v_lshl_add_u32 v149, v85, 4, v149
    s_lshl_b32 s36, s34, 24
    s_sub_u32 s37, 31, s35
    s_lshl_b32 s37, s37, 7
    s_add_u32 s36, s36, s37
    s_add_u32 s37, s36, 262144
    v_lshrrev_b32 v148, 3, v8
    v_xor_b32 v148, v148, v85
    v_lshlrev_b32 v148, 4, v148
    v_lshl_add_u32 v148, v8, 7, v148
    v_add_u32 v148, 98304, v148
    v_mov_b32 v18, 162828
    s_waitcnt lgkmcnt(0)
    s_barrier
    ds_read_b128 v[152:155], v148 offset:0
    ds_read_b128 v[156:159], v148 offset:8192
    ds_read_b32 v19, v18
    s_waitcnt lgkmcnt(2)
    v_or_b32 v152, 1, v152
    buffer_store_dwordx4 v[152:155], v149, s[16:19], s36 offen sc1
    s_waitcnt lgkmcnt(1)
    v_or_b32 v156, 1, v156
    buffer_store_dwordx4 v[156:159], v149, s[16:19], s37 offen sc1
    s_waitcnt lgkmcnt(0)
    v_readfirstlane_b32 s52, v19
    s_cmp_lg_u32 s30, 0
    s_cbranch_scc1 KV_ni
    s_cmp_ge_u32 s35, 16
    s_cbranch_scc1 KV_ni
    v_mov_b32 v8, s52
    s_lshl_b32 s37, s34, 7
    s_lshl_b32 s53, s35, 10
    s_add_u32 s37, s37, s53
    s_add_u32 s37, s37, 23101440
    s_mov_b64 exec, 1
    buffer_store_dword v8, v78, s[56:59], s37 offen sc1
    s_mov_b64 exec, -1
KV_ni:
    s_cmp_ge_u32 s2, 32
    s_cbranch_scc1 KV_n3
    s_cmp_lg_u32 s30, 5
    s_cbranch_scc1 KV_n3
    s_and_b32 s42, s2, 7
    s_lshl_b32 s42, s42, 10
    s_lshr_b32 s43, s2, 3
    s_lshl_b32 s43, s43, 14
    s_add_u32 s42, s42, s43
    s_add_u32 s42, s42, 39714816
    v_lshrrev_b32 v8, 5, v1
    v_mul_u32_u24 v8, 7680, v8
    v_add_u32 v8, v8, v2
    buffer_store_dwordx4 v[80:83], v8, s[56:59], s42 offen sc1
KV_n3:
    s_bfe_u32 s32, s52, 0x30001
    s_add_u32 s32, s32, s2
    s_and_b32 s32, s32, 7
    s_lshr_b32 s33, s2, 3
    s_and_b32 s28, s32, 2
    s_lshr_b32 s53, s32, 2
    s_or_b32 s28, s28, s53
    s_lshl_b32 s28, s28, 2
    s_and_b32 s53, s33, 3
    s_add_u32 s28, s28, s53
    s_and_b32 s31, s32, 1
    s_lshr_b32 s33, s33, 2
    s_lshl_b32 s29, s31, 3
    s_add_u32 s29, s29, s33
    s_xor_b32 s99, s29, 1
    v_and_b32 v199, 7, v0
    v_lshrrev_b32 v228, 6, v0
    v_lshlrev_b32 v228, 4, v228
    v_bfe_u32 v229, v0, 3, 3
    v_add_u32 v228, v228, v229
    s_lshr_b32 s78, s29, 1
    s_lshl_b32 s78, s78, 16
    s_and_b32 s79, s29, 1
    s_lshl_b32 s79, s79, 7
    s_add_u32 s78, s78, s79
    s_lshr_b32 s79, s30, 1
    s_lshl_b32 s79, s79, 13
    s_add_u32 s78, s78, s79
    v_lshlrev_b32 v196, 8, v228
    v_lshl_add_u32 v196, v199, 4, v196
    v_add_u32 v196, s78, v196
    s_lshl_b32 s78, s28, 7
    s_lshl_b32 s79, s29, 3
    s_add_u32 s78, s78, s79
    v_add_u32 v197, s78, v199
    v_lshlrev_b32 v198, 11, v197
    v_lshrrev_b32 v229, 2, v228
    v_lshlrev_b32 v229, 3, v229
    v_and_b32 v228, 3, v228
    v_add_u32 v228, v228, v229
    v_lshl_add_u32 v198, v228, 3, v198
    v_and_b32 v197, 63, v197
    v_lshlrev_b32 v197, 3, v197
    v_and_b32 v229, 15, v228
    v_lshl_add_u32 v197, v229, 9, v197
    v_lshrrev_b32 v229, 4, v228
    v_lshl_add_u32 v197, v229, 14, v197
    s_lshr_b32 s78, s28, 3
    s_lshl_b32 s78, s78, 2
    s_and_b32 s79, s28, 3
    s_add_u32 s78, s78, s79
    s_lshl_b32 s78, s78, 24
    s_and_b32 s79, s28, 4
    s_lshl_b32 s79, s79, 11
    s_add_u32 s78, s78, s79
    s_lshl_b32 s79, s31, 18
    s_add_u32 s78, s78, s79
    v_add_u32 v197, s78, v197
    s_lshl_b32 s36, s34, 5
    s_add_u32 s36, s36, s35
    s_lshl_b32 s36, s36, 7
    s_add_u32 s36, s36, 23068672
    v_mov_b32 v18, 1
    v_mov_b32 v19, 162820
    v_mov_b32 v21, 0
    s_mov_b64 exec, 1
    s_waitcnt vmcnt(0)
    ds_add_rtn_u32 v20, v19, v18
    v_mov_b32 v19, s52
    s_waitcnt lgkmcnt(0)
    v_readfirstlane_b32 s54, v20
    s_nop 0
    s_and_b32 s54, s54, 7
    s_cmp_lg_u32 s54, 7
    s_cbranch_scc1 pub_1
    buffer_store_dword v19, v21, s[56:59], s36 offen sc1
pub_1:
    s_mov_b64 exec, -1
    s_mov_b32 s8, s6
    s_mov_b32 s9, s7
    s_mov_b32 s10, 0x400000
    s_mov_b32 s11, 0x20000
    buffer_load_dwordx2 v[180:181], v198, s[8:11], 0 offen offset:0 nt
    buffer_load_dwordx2 v[182:183], v198, s[8:11], 0 offen offset:32 nt
    buffer_load_dwordx2 v[184:185], v198, s[8:11], 0 offen offset:128 nt
    buffer_load_dwordx2 v[186:187], v198, s[8:11], 0 offen offset:160 nt
    v_add_u32 v160, s45, v86
    v_alignbit_b32 v88, v53, v52, 16
    v_mov_b32 v92, v53
    v_alignbit_b32 v96, v54, v53, 16
    v_alignbit_b32 v89, v54, v53, 16
    v_mov_b32 v93, v54
    v_alignbit_b32 v97, v55, v54, 16
    v_alignbit_b32 v90, v55, v54, 16
    v_mov_b32 v94, v55
    v_alignbit_b32 v98, v56, v55, 16
    v_alignbit_b32 v91, v56, v55, 16
    v_mov_b32 v95, v56
    v_alignbit_b32 v99, v57, v56, 16
    ds_write_b128 v160, v[88:91] offset:0
    ds_write_b128 v160, v[92:95] offset:4160
    ds_write_b128 v160, v[96:99] offset:8320
    ds_write_b128 v160, v[54:57] offset:12480
    v_alignbit_b32 v100, v59, v58, 16
    v_mov_b32 v104, v59
    v_alignbit_b32 v108, v60, v59, 16
    v_alignbit_b32 v101, v60, v59, 16
    v_mov_b32 v105, v60
    v_alignbit_b32 v109, v61, v60, 16
    v_alignbit_b32 v102, v61, v60, 16
    v_mov_b32 v106, v61
    v_alignbit_b32 v110, v62, v61, 16
    v_alignbit_b32 v103, v62, v61, 16
    v_mov_b32 v107, v62
    v_alignbit_b32 v111, v63, v62, 16
    ds_write_b128 v160, v[100:103] offset:1024
    ds_write_b128 v160, v[104:107] offset:5184
    ds_write_b128 v160, v[108:111] offset:9344
    ds_write_b128 v160, v[60:63] offset:13504
    v_alignbit_b32 v112, v65, v64, 16
    v_mov_b32 v116, v65
    v_alignbit_b32 v120, v66, v65, 16
    v_alignbit_b32 v113, v66, v65, 16
    v_mov_b32 v117, v66
    v_alignbit_b32 v121, v67, v66, 16
    v_alignbit_b32 v114, v67, v66, 16
    v_mov_b32 v118, v67
    v_alignbit_b32 v122, v68, v67, 16
    v_alignbit_b32 v115, v68, v67, 16
    v_mov_b32 v119, v68
    v_alignbit_b32 v123, v69, v68, 16
    s_mov_b64 exec, 0xf
    ds_write_b128 v86, v[112:115] offset:4096
    ds_write_b128 v86, v[116:119] offset:8256
    ds_write_b128 v86, v[120:123] offset:12416
    ds_write_b128 v86, v[66:69] offset:16576
    s_mov_b64 exec, -1
    s_waitcnt lgkmcnt(0)
    s_barrier
    v_mov_b32 v238, 0
    v_mov_b32 v239, 0
    v_mov_b32 v240, 0
    v_mov_b32 v241, 0
    v_mov_b32 v242, 0
    v_mov_b32 v243, 0
    v_mov_b32 v244, 0
    v_mov_b32 v245, 0
    v_mov_b32 v246, 0
    v_mov_b32 v247, 0
    s_cmp_ge_u32 s30, 4
    s_cbranch_scc1 FR_b
    s_and_b32 s38, s2, 7
    s_lshl_b32 s38, s38, 5
    s_lshr_b32 s39, s2, 3
    s_add_u32 s38, s38, s39
    s_lshl_b32 s39, s38, 2
    s_add_u32 s39, s39, s30
    s_mul_i32 s40, s30, 24576
    s_and_b32 s36, s39, 127
    s_lshl_b32 s36, s36, 12
    s_lshr_b32 s37, s39, 7
    s_lshl_b32 s37, s37, 24
    s_add_u32 s36, s36, s37
    s_add_u32 s36, s36, 33554432
    s_add_u32 s16, s4, s36
    s_addc_u32 s17, s5, 0
    s_mov_b32 s18, 4096
    s_mov_b32 s19, 0x20000
    v_lshrrev_b32 v6, 2, v1
    v_mul_u32_u24 v12, 96, v6
    v_and_b32 v6, 3, v1
    v_lshl_add_u32 v12, v6, 4, v12
    v_add_u32 v12, s40, v12
    v_and_b32 v35, 15, v1
    v_lshrrev_b32 v36, 4, v1
    v_and_b32 v6, 3, v35
    v_mul_u32_u24 v32, 4160, v6
    v_lshl_add_u32 v32, v36, 4, v32
    v_lshrrev_b32 v6, 2, v35
    v_lshl_add_u32 v32, v6, 3, v32
    v_add_u32 v32, s40, v32
    v_sub_u32 v6, 15, v35
    v_mul_u32_u24 v34, 96, v6
    v_add_u32 v34, s40, v34
    v_lshl_add_u32 v33, v36, 4, v34
    ds_read_b64 v[72:73], v32 offset:0
    ds_read_b64 v[74:75], v32 offset:8
    ds_read_b64 v[76:77], v32 offset:32
    ds_read_b64 v[78:79], v32 offset:40
    ds_read_b64 v[80:81], v32 offset:1024
    ds_read_b64 v[82:83], v32 offset:1032
    ds_read_b64 v[84:85], v32 offset:1056
    ds_read_b64 v[86:87], v32 offset:1064
    ds_read_b64 v[88:89], v32 offset:2048
    ds_read_b64 v[90:91], v32 offset:2056
    ds_read_b64 v[92:93], v32 offset:2080
    ds_read_b64 v[94:95], v32 offset:2088
    ds_read_b64 v[96:97], v32 offset:3072
    ds_read_b64 v[98:99], v32 offset:3080
    ds_read_b64 v[100:101], v32 offset:3104
    ds_read_b64 v[102:103], v32 offset:3112
    s_bitcmp1_b32 s39, 0
    s_cselect_b32 s36, 0, 16
    s_lshl_b32 s41, s98, s36
    s_and_b32 s41, s41, 0xffff0000
    s_lshr_b32 s36, s41, 16
    v_lshl_add_u32 v6, v36, 3, v35
    v_sub_u32 v6, 31, v6
    v_mov_b32 v10, s36
    v_mov_b32 v11, s41
    v_and_b32 v8, 1, v6
    v_cmp_eq_u32 vcc, 1, v8
    s_nop 1
    v_cndmask_b32 v10, v10, v11, vcc
    v_ashrrev_i32 v6, 1, v6
    v_cmp_eq_u32 vcc, 0, v6
    s_nop 1
    v_cndmask_b32 v152, 0, v10, vcc
    v_cmp_eq_u32 vcc, 1, v6
    s_nop 1
    v_cndmask_b32 v153, 0, v10, vcc
    v_cmp_eq_u32 vcc, 2, v6
    s_nop 1
    v_cndmask_b32 v154, 0, v10, vcc
    v_cmp_eq_u32 vcc, 3, v6
    s_nop 1
    v_cndmask_b32 v155, 0, v10, vcc
    v_cmp_eq_u32 vcc, 8, v6
    s_nop 1
    v_cndmask_b32 v156, 0, v10, vcc
    v_cmp_eq_u32 vcc, 9, v6
    s_nop 1
    v_cndmask_b32 v157, 0, v10, vcc
    v_cmp_eq_u32 vcc, 10, v6
    s_nop 1
    v_cndmask_b32 v158, 0, v10, vcc
    v_cmp_eq_u32 vcc, 11, v6
    s_nop 1
    v_cndmask_b32 v159, 0, v10, vcc
    s_add_u32 s12, s4, 0x2100000
    s_addc_u32 s13, s5, 0
    s_mov_b32 s14, 0x7f00000
    s_mov_b32 s15, 0x20000
    v_bfe_u32 v6, v1, 2, 2
    v_mul_u32_u24 v168, 24640, v6
    v_lshrrev_b32 v6, 1, v36
    v_mul_u32_u24 v6, 72, v6
    v_add_u32 v168, v168, v6
    v_and_b32 v6, 1, v36
    v_lshl_add_u32 v168, v6, 5, v168
    v_and_b32 v6, 3, v1
    v_lshl_add_u32 v168, v6, 3, v168
    s_mul_i32 s36, s30, 1152
    v_add_u32 v168, s36, v168
    v_lshlrev_b32 v169, 3, v1
    s_lshr_b32 s44, s38, 4
    s_lshl_b32 s44, s44, 14
    s_and_b32 s37, s38, 15
    s_lshl_b32 s37, s37, 9
    s_add_u32 s44, s44, s37
    s_and_b32 s37, s30, 1
    s_lshl_b32 s37, s37, 13
    s_add_u32 s44, s44, s37
    s_lshr_b32 s37, s30, 1
    s_lshl_b32 s37, s37, 26
    s_add_u32 s44, s44, s37
    v_not_b32 v34, v1
    v_and_b32 v34, 1, v34
    s_mul_i32 s36, s30, 24640
    v_mul_u32_u24 v170, 72, v35
    v_lshl_add_u32 v170, v36, 3, v170
    v_add_u32 v170, s36, v170
    v_mov_b32 v35, 0
    s_and_b32 s45, s2, 31
    s_lshl_b32 s45, s45, 7
    s_add_u32 s45, s45, 23117824
    s_cmp_lg_u32 s30, 0
    s_cbranch_scc1 CV_w
    s_and_b32 s36, s2, 7
    s_lshl_b32 s36, s36, 12
    s_add_u32 s36, s36, 23068672
    v_lshlrev_b32 v9, 7, v1
    v_add_u32 v9, s36, v9
    s_mov_b32 s53, 0
    s_add_u32 s54, s52, 0
    s_bfm_b64 exec, 32, 0
poll_2:
    buffer_load_dword v8, v9, s[56:59], 0 offen sc1
    s_waitcnt vmcnt(0)
    v_xor_b32 v8, s54, v8
    v_cmp_eq_u32 vcc, 0, v8
    s_nop 0
    s_cmp_eq_u64 vcc, exec
    s_cbranch_scc1 pok_3
    s_sleep 5
    s_add_u32 s53, s53, 1
    s_cmp_lt_u32 s53, s61
    s_cbranch_scc1 poll_2
    s_mov_b32 s61, 0
pok_3:
    s_mov_b64 exec, -1
    v_mov_b32 v8, 162832
    v_mov_b32 v9, 1
    s_waitcnt lgkmcnt(0)
    ds_write_b32 v8, v9
CV_w:
    v_mov_b32 v8, 162832
spin_4:
    ds_read_b32 v9, v8
    s_waitcnt lgkmcnt(0)
    v_readfirstlane_b32 s53, v9
    s_nop 0
    s_cmp_ge_u32 s53, 1
    s_cbranch_scc0 spin_4
    buffer_load_dwordx4 v[16:19], v2, s[16:19], 0 offen offset:0 sc1 nt
    buffer_load_dwordx4 v[20:23], v2, s[16:19], 0 offen offset:1024 sc1 nt
    buffer_load_dwordx4 v[24:27], v2, s[16:19], 0 offen offset:2048 sc1 nt
    buffer_load_dwordx4 v[28:31], v2, s[16:19], 0 offen offset:3072 sc1 nt
    s_waitcnt vmcnt(3)
    ds_write_b128 v12, v[16:19] offset:16640
    s_waitcnt vmcnt(2)
    ds_write_b128 v12, v[20:23] offset:18176
    s_waitcnt vmcnt(1)
    ds_write_b128 v12, v[24:27] offset:19712
    s_waitcnt vmcnt(0)
    ds_write_b128 v12, v[28:31] offset:21248
    v_mov_b32 v8, 162836
    v_mov_b32 v9, 1
    s_mov_b64 exec, 1
    ds_add_u32 v8, v9
    s_mov_b64 exec, -1
    s_waitcnt lgkmcnt(0)
    ds_read_b128 v[136:139], v33 offset:21248
    ds_read_b128 v[140:143], v33 offset:19712
    ds_read_b128 v[144:147], v33 offset:18176
    ds_read_b128 v[148:151], v33 offset:16640
    s_waitcnt lgkmcnt(3)
    v_mfma_f32_16x16x32_bf16 v[40:43], v[152:155], v[136:139], 0
    v_mfma_f32_16x16x32_bf16 v[44:47], v[156:159], v[136:139], 0
    s_waitcnt lgkmcnt(2)
    v_mfma_f32_16x16x32_bf16 v[48:51], v[152:155], v[140:143], 0
    v_mfma_f32_16x16x32_bf16 v[52:55], v[156:159], v[140:143], 0
    s_waitcnt lgkmcnt(1)
    v_mfma_f32_16x16x32_bf16 v[56:59], v[152:155], v[144:147], 0
    v_mfma_f32_16x16x32_bf16 v[60:63], v[156:159], v[144:147], 0
    s_waitcnt lgkmcnt(0)
    v_mfma_f32_16x16x32_bf16 v[64:67], v[152:155], v[148:151], 0
    v_mfma_f32_16x16x32_bf16 v[68:71], v[156:159], v[148:151], 0
    s_mov_b32 s43, 0
CV_r:
    s_waitcnt lgkmcnt(0)
    v_mfma_f32_16x16x32_bf16 v[40:43], v[72:75], v[136:139], v[40:43]
    v_mfma_f32_16x16x32_bf16 v[48:51], v[72:75], v[140:143], v[48:51]
    v_mfma_f32_16x16x32_bf16 v[56:59], v[72:75], v[144:147], v[56:59]
    v_mfma_f32_16x16x32_bf16 v[64:67], v[72:75], v[148:151], v[64:67]
    v_mfma_f32_16x16x32_bf16 v[44:47], v[76:79], v[136:139], v[44:47]
    v_mfma_f32_16x16x32_bf16 v[52:55], v[76:79], v[140:143], v[52:55]
    v_mfma_f32_16x16x32_bf16 v[60:63], v[76:79], v[144:147], v[60:63]
    v_mfma_f32_16x16x32_bf16 v[68:71], v[76:79], v[148:151], v[68:71]
    v_mfma_f32_16x16x32_bf16 v[48:51], v[80:83], v[136:139], v[48:51]
    v_mfma_f32_16x16x32_bf16 v[56:59], v[80:83], v[140:143], v[56:59]
    v_mfma_f32_16x16x32_bf16 v[64:67], v[80:83], v[144:147], v[64:67]
    v_mfma_f32_16x16x32_bf16 v[52:55], v[84:87], v[136:139], v[52:55]
    v_mfma_f32_16x16x32_bf16 v[60:63], v[84:87], v[140:143], v[60:63]
    v_mfma_f32_16x16x32_bf16 v[68:71], v[84:87], v[144:147], v[68:71]
    v_mfma_f32_16x16x32_bf16 v[56:59], v[88:91], v[136:139], v[56:59]
    v_mfma_f32_16x16x32_bf16 v[64:67], v[88:91], v[140:143], v[64:67]
    v_mfma_f32_16x16x32_bf16 v[60:63], v[92:95], v[136:139], v[60:63]
    v_mfma_f32_16x16x32_bf16 v[68:71], v[92:95], v[140:143], v[68:71]
    v_mfma_f32_16x16x32_bf16 v[64:67], v[96:99], v[136:139], v[64:67]
    v_mfma_f32_16x16x32_bf16 v[68:71], v[100:103], v[136:139], v[68:71]
    ds_read_b128 v[152:155], v33 offset:21344
    ds_read_b128 v[156:159], v33 offset:19808
    ds_read_b128 v[160:163], v33 offset:18272
    ds_read_b128 v[164:167], v33 offset:16736
    ds_read_b64 v[104:105], v32 offset:64
    ds_read_b64 v[106:107], v32 offset:72
    ds_read_b64 v[108:109], v32 offset:96
    ds_read_b64 v[110:111], v32 offset:104
    ds_read_b64 v[112:113], v32 offset:1088
    ds_read_b64 v[114:115], v32 offset:1096
    ds_read_b64 v[116:117], v32 offset:1120
    ds_read_b64 v[118:119], v32 offset:1128
    ds_read_b64 v[120:121], v32 offset:2112
    ds_read_b64 v[122:123], v32 offset:2120
    ds_read_b64 v[124:125], v32 offset:2144
    ds_read_b64 v[126:127], v32 offset:2152
    ds_read_b64 v[128:129], v32 offset:3136
    ds_read_b64 v[130:131], v32 offset:3144
    ds_read_b64 v[132:133], v32 offset:3168
    ds_read_b64 v[134:135], v32 offset:3176
    s_waitcnt lgkmcnt(0)
    v_mfma_f32_16x16x32_bf16 v[40:43], v[104:107], v[152:155], v[40:43]
    v_mfma_f32_16x16x32_bf16 v[48:51], v[104:107], v[156:159], v[48:51]
    v_mfma_f32_16x16x32_bf16 v[56:59], v[104:107], v[160:163], v[56:59]
    v_mfma_f32_16x16x32_bf16 v[64:67], v[104:107], v[164:167], v[64:67]
    v_mfma_f32_16x16x32_bf16 v[44:47], v[108:111], v[152:155], v[44:47]
    v_mfma_f32_16x16x32_bf16 v[52:55], v[108:111], v[156:159], v[52:55]
    v_mfma_f32_16x16x32_bf16 v[60:63], v[108:111], v[160:163], v[60:63]
    v_mfma_f32_16x16x32_bf16 v[68:71], v[108:111], v[164:167], v[68:71]
    v_mfma_f32_16x16x32_bf16 v[48:51], v[112:115], v[152:155], v[48:51]
    v_mfma_f32_16x16x32_bf16 v[56:59], v[112:115], v[156:159], v[56:59]
    v_mfma_f32_16x16x32_bf16 v[64:67], v[112:115], v[160:163], v[64:67]
    v_mfma_f32_16x16x32_bf16 v[52:55], v[116:119], v[152:155], v[52:55]
    v_mfma_f32_16x16x32_bf16 v[60:63], v[116:119], v[156:159], v[60:63]
    v_mfma_f32_16x16x32_bf16 v[68:71], v[116:119], v[160:163], v[68:71]
    v_mfma_f32_16x16x32_bf16 v[56:59], v[120:123], v[152:155], v[56:59]
    v_mfma_f32_16x16x32_bf16 v[64:67], v[120:123], v[156:159], v[64:67]
    v_mfma_f32_16x16x32_bf16 v[60:63], v[124:127], v[152:155], v[60:63]
    v_mfma_f32_16x16x32_bf16 v[68:71], v[124:127], v[156:159], v[68:71]
    v_mfma_f32_16x16x32_bf16 v[64:67], v[128:131], v[152:155], v[64:67]
    v_mfma_f32_16x16x32_bf16 v[68:71], v[132:135], v[152:155], v[68:71]
    ds_read_b128 v[136:139], v33 offset:21440
    ds_read_b128 v[140:143], v33 offset:19904
    ds_read_b128 v[144:147], v33 offset:18368
    ds_read_b128 v[148:151], v33 offset:16832
    ds_read_b64 v[72:73], v32 offset:128
    ds_read_b64 v[74:75], v32 offset:136
    ds_read_b64 v[76:77], v32 offset:160
    ds_read_b64 v[78:79], v32 offset:168
    ds_read_b64 v[80:81], v32 offset:1152
    ds_read_b64 v[82:83], v32 offset:1160
    ds_read_b64 v[84:85], v32 offset:1184
    ds_read_b64 v[86:87], v32 offset:1192
    ds_read_b64 v[88:89], v32 offset:2176
    ds_read_b64 v[90:91], v32 offset:2184
    ds_read_b64 v[92:93], v32 offset:2208
    ds_read_b64 v[94:95], v32 offset:2216
    ds_read_b64 v[96:97], v32 offset:3200
    ds_read_b64 v[98:99], v32 offset:3208
    ds_read_b64 v[100:101], v32 offset:3232
    ds_read_b64 v[102:103], v32 offset:3240
    v_add_u32 v32, 128, v32
    v_add_u32 v33, 192, v33
    s_add_u32 s43, s43, 1
    s_cmp_lt_u32 s43, 4
    s_cbranch_scc1 CV_r
CV_l:
    s_waitcnt lgkmcnt(10)
    v_mfma_f32_16x16x32_bf16 v[40:43], v[72:75], v[136:139], v[40:43]
    ds_read_b128 v[152:155], v33 offset:21344
    v_mfma_f32_16x16x32_bf16 v[48:51], v[72:75], v[140:143], v[48:51]
    ds_read_b128 v[156:159], v33 offset:19808
    s_cmp_eq_u32 s43, 5
    v_mfma_f32_16x16x32_bf16 v[56:59], v[72:75], v[144:147], v[56:59]
    ds_read_b128 v[160:163], v33 offset:18272
    s_cselect_b64 exec, 1, 0
    buffer_load_dword v12, v35, s[56:59], s45 offen sc1
    s_mov_b64 exec, -1
    v_mfma_f32_16x16x32_bf16 v[64:67], v[72:75], v[148:151], v[64:67]
    ds_read_b128 v[164:167], v33 offset:16736
    v_mfma_f32_16x16x32_bf16 v[44:47], v[76:79], v[136:139], v[44:47]
    ds_read_b64 v[104:105], v32 offset:64
    v_mfma_f32_16x16x32_bf16 v[52:55], v[76:79], v[140:143], v[52:55]
    ds_read_b64 v[106:107], v32 offset:72
    v_mfma_f32_16x16x32_bf16 v[60:63], v[76:79], v[144:147], v[60:63]
    ds_read_b64 v[108:109], v32 offset:96
    v_mfma_f32_16x16x32_bf16 v[68:71], v[76:79], v[148:151], v[68:71]
    ds_read_b64 v[110:111], v32 offset:104
    v_mfma_f32_16x16x32_bf16 v[48:51], v[80:83], v[136:139], v[48:51]
    ds_read_b64 v[112:113], v32 offset:1088
    v_mfma_f32_16x16x32_bf16 v[56:59], v[80:83], v[140:143], v[56:59]
    ds_read_b64 v[114:115], v32 offset:1096
    s_waitcnt lgkmcnt(10)
    v_mfma_f32_16x16x32_bf16 v[64:67], v[80:83], v[144:147], v[64:67]
    ds_read_b64 v[116:117], v32 offset:1120
    v_mfma_f32_16x16x32_bf16 v[52:55], v[84:87], v[136:139], v[52:55]
    ds_read_b64 v[118:119], v32 offset:1128
    v_mfma_f32_16x16x32_bf16 v[60:63], v[84:87], v[140:143], v[60:63]
    ds_read_b64 v[120:121], v32 offset:2112
    v_mfma_f32_16x16x32_bf16 v[68:71], v[84:87], v[144:147], v[68:71]
    ds_read_b64 v[122:123], v32 offset:2120
    v_mfma_f32_16x16x32_bf16 v[56:59], v[88:91], v[136:139], v[56:59]
    ds_read_b64 v[124:125], v32 offset:2144
    v_mfma_f32_16x16x32_bf16 v[64:67], v[88:91], v[140:143], v[64:67]
    ds_read_b64 v[126:127], v32 offset:2152
    v_mfma_f32_16x16x32_bf16 v[60:63], v[92:95], v[136:139], v[60:63]
    ds_read_b64 v[128:129], v32 offset:3136
    v_mfma_f32_16x16x32_bf16 v[68:71], v[92:95], v[140:143], v[68:71]
    ds_read_b64 v[130:131], v32 offset:3144
    v_mfma_f32_16x16x32_bf16 v[64:67], v[96:99], v[136:139], v[64:67]
    ds_read_b64 v[132:133], v32 offset:3168
    v_mfma_f32_16x16x32_bf16 v[68:71], v[100:103], v[136:139], v[68:71]
    ds_read_b64 v[134:135], v32 offset:3176
    s_waitcnt lgkmcnt(10)
    v_mfma_f32_16x16x32_bf16 v[40:43], v[104:107], v[152:155], v[40:43]
    ds_read_b128 v[136:139], v33 offset:21440
    v_mfma_f32_16x16x32_bf16 v[48:51], v[104:107], v[156:159], v[48:51]
    ds_read_b128 v[140:143], v33 offset:19904
    v_mfma_f32_16x16x32_bf16 v[56:59], v[104:107], v[160:163], v[56:59]
    ds_read_b128 v[144:147], v33 offset:18368
    v_mfma_f32_16x16x32_bf16 v[64:67], v[104:107], v[164:167], v[64:67]
    ds_read_b128 v[148:151], v33 offset:16832
    v_mfma_f32_16x16x32_bf16 v[44:47], v[108:111], v[152:155], v[44:47]
    ds_read_b64 v[72:73], v32 offset:128
    v_mfma_f32_16x16x32_bf16 v[52:55], v[108:111], v[156:159], v[52:55]
    ds_read_b64 v[74:75], v32 offset:136
    v_add_u32 v33, 192, v33
    v_mfma_f32_16x16x32_bf16 v[60:63], v[108:111], v[160:163], v[60:63]
    ds_read_b64 v[76:77], v32 offset:160
    s_add_u32 s43, s43, 1
    v_mfma_f32_16x16x32_bf16 v[68:71], v[108:111], v[164:167], v[68:71]
    ds_read_b64 v[78:79], v32 offset:168
    s_cmp_lt_u32 s43, 8
    v_mfma_f32_16x16x32_bf16 v[48:51], v[112:115], v[152:155], v[48:51]
    ds_read_b64 v[80:81], v32 offset:1152
    v_mfma_f32_16x16x32_bf16 v[56:59], v[112:115], v[156:159], v[56:59]
    ds_read_b64 v[82:83], v32 offset:1160
    s_waitcnt lgkmcnt(10)
    v_mfma_f32_16x16x32_bf16 v[64:67], v[112:115], v[160:163], v[64:67]
    ds_read_b64 v[84:85], v32 offset:1184
    v_mfma_f32_16x16x32_bf16 v[52:55], v[116:119], v[152:155], v[52:55]
    ds_read_b64 v[86:87], v32 offset:1192
    v_mfma_f32_16x16x32_bf16 v[60:63], v[116:119], v[156:159], v[60:63]
    ds_read_b64 v[88:89], v32 offset:2176
    v_mfma_f32_16x16x32_bf16 v[68:71], v[116:119], v[160:163], v[68:71]
    ds_read_b64 v[90:91], v32 offset:2184
    v_mfma_f32_16x16x32_bf16 v[56:59], v[120:123], v[152:155], v[56:59]
    ds_read_b64 v[92:93], v32 offset:2208
    v_mfma_f32_16x16x32_bf16 v[64:67], v[120:123], v[156:159], v[64:67]
    ds_read_b64 v[94:95], v32 offset:2216
    v_mfma_f32_16x16x32_bf16 v[60:63], v[124:127], v[152:155], v[60:63]
    ds_read_b64 v[96:97], v32 offset:3200
    v_mfma_f32_16x16x32_bf16 v[68:71], v[124:127], v[156:159], v[68:71]
    ds_read_b64 v[98:99], v32 offset:3208
    v_mfma_f32_16x16x32_bf16 v[64:67], v[128:131], v[152:155], v[64:67]
    ds_read_b64 v[100:101], v32 offset:3232
    v_mfma_f32_16x16x32_bf16 v[68:71], v[132:135], v[152:155], v[68:71]
    ds_read_b64 v[102:103], v32 offset:3240
    v_add_u32 v32, 128, v32
    s_cbranch_scc1 CV_l
    s_waitcnt lgkmcnt(0)
    v_cvt_pk_bf16_f32 v16, v40, v41
    v_cvt_pk_bf16_f32 v17, v42, v43
    ds_write_b64 v170, v[16:17] offset:0
    v_cvt_pk_bf16_f32 v18, v44, v45
    v_cvt_pk_bf16_f32 v19, v46, v47
    ds_write_b64 v170, v[18:19] offset:32
    v_cvt_pk_bf16_f32 v20, v48, v49
    v_cvt_pk_bf16_f32 v21, v50, v51
    ds_write_b64 v170, v[20:21] offset:1152
    v_cvt_pk_bf16_f32 v22, v52, v53
    v_cvt_pk_bf16_f32 v23, v54, v55
    ds_write_b64 v170, v[22:23] offset:1184
    v_cvt_pk_bf16_f32 v24, v56, v57
    v_cvt_pk_bf16_f32 v25, v58, v59
    ds_write_b64 v170, v[24:25] offset:2304
    v_cvt_pk_bf16_f32 v26, v60, v61
    v_cvt_pk_bf16_f32 v27, v62, v63
    ds_write_b64 v170, v[26:27] offset:2336
    v_cvt_pk_bf16_f32 v28, v64, v65
    v_cvt_pk_bf16_f32 v29, v66, v67
    ds_write_b64 v170, v[28:29] offset:3456
    v_cvt_pk_bf16_f32 v30, v68, v69
    v_cvt_pk_bf16_f32 v31, v70, v71
    ds_write_b64 v170, v[30:31] offset:3488
    s_mov_b32 s53, 0
    s_waitcnt vmcnt(0)
CV_v:
    v_readfirstlane_b32 s94, v12
    s_nop 0
    s_sub_u32 s94, s94, s52
    s_and_b32 s37, s94, 0xfffffe01
    s_cbranch_scc0 CV_k
    buffer_load_dword v12, v35, s[56:59], s45 offen sc1
    s_waitcnt vmcnt(0)
    s_add_u32 s53, s53, 1
    s_cmp_lt_u32 s53, s61
    s_cbranch_scc1 CV_v
    s_mov_b32 s61, 0
    s_mov_b32 s94, 0
CV_k:
    s_lshr_b32 s94, s94, 1
    s_add_u32 s37, s94, 65536
    v_mov_b32 v8, 162844
    v_mov_b32 v9, s37
    ds_write_b32 v8, v9
    s_cmp_gt_u32 s94, 10
    s_cselect_b32 s37, 0x2000, 0
    s_xor_b32 s44, s44, s37
    v_mov_b32 v8, 162824
    v_mov_b32 v9, 1
    s_waitcnt lgkmcnt(0)
    s_mov_b64 exec, 1
    ds_add_u32 v8, v9
    s_mov_b64 exec, -1
    v_mov_b32 v8, 162824
spin_5:
    ds_read_b32 v9, v8
    s_waitcnt lgkmcnt(0)
    v_readfirstlane_b32 s53, v9
    s_nop 0
    s_cmp_ge_u32 s53, 4
    s_cbranch_scc0 spin_5
    ds_read_b64_tr_b16 v[104:105], v168 offset:0
    ds_read_b64_tr_b16 v[106:107], v168 offset:144
    ds_read_b64_tr_b16 v[108:109], v168 offset:288
    ds_read_b64_tr_b16 v[110:111], v168 offset:432
    ds_read_b64_tr_b16 v[112:113], v168 offset:576
    ds_read_b64_tr_b16 v[114:115], v168 offset:720
    ds_read_b64_tr_b16 v[116:117], v168 offset:864
    ds_read_b64_tr_b16 v[118:119], v168 offset:1008
    s_waitcnt lgkmcnt(7)
    v_or_b32 v104, v34, v104
    buffer_store_dwordx2 v[104:105], v169, s[12:15], s44 offen sc1
    s_add_u32 s44, s44, 262144
    s_waitcnt lgkmcnt(6)
    v_or_b32 v106, v34, v106
    buffer_store_dwordx2 v[106:107], v169, s[12:15], s44 offen sc1
    s_add_u32 s44, s44, 16515072
    s_waitcnt lgkmcnt(5)
    v_or_b32 v108, v34, v108
    buffer_store_dwordx2 v[108:109], v169, s[12:15], s44 offen sc1
    s_add_u32 s44, s44, 262144
    s_waitcnt lgkmcnt(4)
    v_or_b32 v110, v34, v110
    buffer_store_dwordx2 v[110:111], v169, s[12:15], s44 offen sc1
    s_add_u32 s44, s44, 16515072
    s_waitcnt lgkmcnt(3)
    v_or_b32 v112, v34, v112
    buffer_store_dwordx2 v[112:113], v169, s[12:15], s44 offen sc1
    s_add_u32 s44, s44, 262144
    s_waitcnt lgkmcnt(2)
    v_or_b32 v114, v34, v114
    buffer_store_dwordx2 v[114:115], v169, s[12:15], s44 offen sc1
    s_add_u32 s44, s44, 16515072
    s_waitcnt lgkmcnt(1)
    v_or_b32 v116, v34, v116
    buffer_store_dwordx2 v[116:117], v169, s[12:15], s44 offen sc1
    s_add_u32 s44, s44, 262144
    s_waitcnt lgkmcnt(0)
    v_or_b32 v118, v34, v118
    buffer_store_dwordx2 v[118:119], v169, s[12:15], s44 offen sc1
    s_add_u32 s44, s44, 16515072
    v_mov_b32 v8, 162836
    v_mov_b32 v9, 1
    s_mov_b64 exec, 1
    ds_add_u32 v8, v9
    s_mov_b64 exec, -1
    s_and_b32 s36, s2, 7
    s_lshl_b32 s36, s36, 7
    s_add_u32 s36, s36, 23101440
    v_mov_b32 v6, 1
    v_mov_b32 v7, 162820
    v_lshlrev_b32 v9, 10, v1
    s_mov_b64 exec, 1
    s_waitcnt vmcnt(0)
    s_waitcnt lgkmcnt(0)
    ds_add_rtn_u32 v8, v7, v6
    s_waitcnt lgkmcnt(0)
    v_readfirstlane_b32 s54, v8
    s_nop 0
    s_cmp_lg_u32 s54, 15
    s_cbranch_scc1 fa_6
    s_mov_b64 exec, 0xffff
    buffer_atomic_add v6, v9, s[56:59], s36 offen sc1
fa_6:
    s_mov_b64 exec, -1
    s_branch FR_end
FR_b:
    s_cmp_ge_u32 s2, 32
    s_cbranch_scc1 FB_np
    s_cmp_lg_u32 s30, 5
    s_cbranch_scc1 FB_np
    s_and_b32 s42, s2, 7
    s_lshl_b32 s42, s42, 10
    s_lshr_b32 s43, s2, 3
    s_lshl_b32 s43, s43, 14
    s_add_u32 s42, s42, s43
    s_add_u32 s42, s42, 39714816
    v_mov_b32 v14, 0
    s_mov_b64 exec, 1
    s_mov_b32 s46, -1
    s_mov_b32 s47, -1
    s_add_u32 s48, s4, s42
    s_addc_u32 s49, s5, 0
    s_load_dword s101, s[48:49], 384
    s_waitcnt lgkmcnt(0)
    s_memtime s[34:35]
    s_waitcnt lgkmcnt(0)
    s_load_dword s101, s[48:49], 0
    s_waitcnt lgkmcnt(0)
    s_memtime s[36:37]
    s_waitcnt lgkmcnt(0)
    s_sub_u32 s43, s36, s34
    s_min_u32 s46, s46, s43
    s_load_dword s101, s[48:49], 8192
    s_waitcnt lgkmcnt(0)
    s_memtime s[34:35]
    s_waitcnt lgkmcnt(0)
    s_sub_u32 s43, s34, s36
    s_min_u32 s47, s47, s43
    s_load_dword s101, s[48:49], 128
    s_waitcnt lgkmcnt(0)
    s_memtime s[36:37]
    s_waitcnt lgkmcnt(0)
    s_sub_u32 s43, s36, s34
    s_min_u32 s46, s46, s43
    s_load_dword s101, s[48:49], 8320
    s_waitcnt lgkmcnt(0)
    s_memtime s[34:35]
    s_waitcnt lgkmcnt(0)
    s_sub_u32 s43, s34, s36
    s_min_u32 s47, s47, s43
    s_cmp_lt_u32 s47, s46
    s_cselect_b32 s45, 1, 0
    s_lshr_b32 s46, s28, 2
    s_xor_b32 s45, s45, s46
    s_and_b32 s45, s45, 1
    s_lshl_b32 s45, s45, 8
    s_or_b32 s43, s45, 1
    v_mov_b32 v12, s43
    buffer_atomic_add v12, v14, s[84:87], 0 offen offset:4 sc0 sc1
    s_waitcnt vmcnt(0)
    v_readfirstlane_b32 s36, v12
    s_nop 0
    s_add_u32 s36, s36, s43
    s_and_b32 s37, s36, 255
    s_cmp_lg_u32 s37, 21
    s_cbranch_scc1 FB_np
    s_lshr_b32 s36, s36, 8
    s_lshl_b32 s36, s36, 1
    s_add_u32 s36, s36, s52
    s_bfm_b64 exec, 32, 0
    v_mov_b32 v12, s36
    v_lshlrev_b32 v13, 7, v1
    s_mov_b32 s36, 23117824
    buffer_store_dword v12, v13, s[56:59], s36 offen sc1
FB_np:
    s_mov_b64 exec, -1
    s_getpc_b64 s[34:35]
K_tpc:
    s_lshl_b32 s36, s29, 2
    s_and_b32 s37, s28, 3
    s_add_u32 s36, s36, s37
    s_lshl_b32 s36, s36, 6
    s_add_u32 s36, s36, K_tab-K_tpc
    s_add_u32 s34, s34, s36
    s_addc_u32 s35, s35, 0
    v_and_b32 v248, 31, v1
    v_lshlrev_b32 v248, 1, v248
    global_load_ushort v251, v248, s[34:35]
    v_lshrrev_b32 v253, 3, v1
    v_lshlrev_b32 v238, 11, v253
    v_and_b32 v253, 6, v253
    v_and_b32 v254, 7, v1
    v_xor_b32 v253, v253, v254
    v_lshl_add_u32 v238, v253, 4, v238
    v_lshrrev_b32 v253, 4, v1
    v_lshlrev_b32 v239, 11, v253
    v_add_u32 v253, 0, v253
    v_lshlrev_b32 v253, 1, v253
    v_and_b32 v254, 15, v1
    v_xor_b32 v253, v253, v254
    v_lshl_add_u32 v239, v253, 4, v239
    v_lshrrev_b32 v253, 4, v1
    v_lshlrev_b32 v240, 11, v253
    v_add_u32 v253, 4, v253
    v_lshlrev_b32 v253, 1, v253
    v_and_b32 v254, 15, v1
    v_xor_b32 v253, v253, v254
    v_lshl_add_u32 v240, v253, 4, v240
    v_add_u32 v254, 0, v1
    v_mul_u32_u24 v253, 2341, v254
    v_lshrrev_b32 v253, 16, v253
    v_mul_u32_u24 v241, 28, v253
    v_sub_u32 v254, v254, v241
    v_mul_u32_u24 v241, 7168, v253
    v_lshrrev_b32 v253, 1, v253
    v_and_b32 v253, 2, v253
    v_xor_b32 v254, v254, v253
    v_lshl_add_u32 v241, v254, 4, v241
    v_add_u32 v254, 64, v1
    v_mul_u32_u24 v253, 2341, v254
    v_lshrrev_b32 v253, 16, v253
    v_mul_u32_u24 v242, 28, v253
    v_sub_u32 v254, v254, v242
    v_mul_u32_u24 v242, 7168, v253
    v_lshrrev_b32 v253, 1, v253
    v_and_b32 v253, 2, v253
    v_xor_b32 v254, v254, v253
    v_lshl_add_u32 v242, v254, 4, v242
    v_add_u32 v254, 128, v1
    v_mul_u32_u24 v253, 2341, v254
    v_lshrrev_b32 v253, 16, v253
    v_mul_u32_u24 v243, 28, v253
    v_sub_u32 v254, v254, v243
    v_mul_u32_u24 v243, 7168, v253
    v_lshrrev_b32 v253, 1, v253
    v_and_b32 v253, 2, v253
    v_xor_b32 v254, v254, v253
    v_lshl_add_u32 v243, v254, 4, v243
    v_add_u32 v254, 192, v1
    v_mul_u32_u24 v253, 2341, v254
    v_lshrrev_b32 v253, 16, v253
    v_mul_u32_u24 v244, 28, v253
    v_sub_u32 v254, v254, v244
    v_mul_u32_u24 v244, 7168, v253
    v_lshrrev_b32 v253, 1, v253
    v_and_b32 v253, 2, v253
    v_xor_b32 v254, v254, v253
    v_lshl_add_u32 v244, v254, 4, v244
    v_add_u32 v254, 256, v1
    v_mul_u32_u24 v253, 2341, v254
    v_lshrrev_b32 v253, 16, v253
    v_mul_u32_u24 v245, 28, v253
    v_sub_u32 v254, v254, v245
    v_mul_u32_u24 v245, 7168, v253
    v_lshrrev_b32 v253, 1, v253
    v_and_b32 v253, 2, v253
    v_xor_b32 v254, v254, v253
    v_lshl_add_u32 v245, v254, 4, v245
    v_add_u32 v254, 320, v1
    v_mul_u32_u24 v253, 2341, v254
    v_lshrrev_b32 v253, 16, v253
    v_mul_u32_u24 v246, 28, v253
    v_sub_u32 v254, v254, v246
    v_mul_u32_u24 v246, 7168, v253
    v_lshrrev_b32 v253, 1, v253
    v_and_b32 v253, 2, v253
    v_xor_b32 v254, v254, v253
    v_lshl_add_u32 v246, v254, 4, v246
    v_add_u32 v254, 384, v1
    v_mul_u32_u24 v253, 2341, v254
    v_lshrrev_b32 v253, 16, v253
    v_mul_u32_u24 v247, 28, v253
    v_sub_u32 v254, v254, v247
    v_mul_u32_u24 v247, 7168, v253
    v_lshrrev_b32 v253, 1, v253
    v_and_b32 v253, 2, v253
    v_xor_b32 v254, v254, v253
    v_lshl_add_u32 v247, v254, 4, v247
    s_cmp_ge_u32 s30, 6
    s_cbranch_scc1 FB_cs
    s_cmp_lg_u32 s30, 4
    s_cbranch_scc1 FB_ni
    v_mov_b32 v12, s52
    s_lshr_b32 s53, s28, 3
    s_lshl_b32 s53, s53, 2
    s_and_b32 s54, s28, 3
    s_add_u32 s53, s53, s54
    s_lshl_b32 s53, s53, 24
    s_lshr_b32 s54, s28, 2
    s_xor_b32 s54, s54, s94
    s_and_b32 s54, s54, 1
    s_lshl_b32 s54, s54, 13
    s_add_u32 s37, s53, s54
    s_add_u32 s37, s37, 33554432
    s_andn2_b32 s37, s37, 0x2000
    s_lshl_b32 s53, s29, 7
    s_add_u32 s37, s37, s53
    s_add_u32 s37, s37, 6029312
    v_and_b32 v13, 1, v1
    v_lshlrev_b32 v13, 13, v13
    v_lshrrev_b32 v14, 1, v1
    v_lshl_add_u32 v13, v14, 22, v13
    s_mov_b64 exec, 0xf
    buffer_store_dword v12, v13, s[56:59], s37 offen sc1
    s_cmp_lg_u32 s28, 0
    s_cbranch_scc1 FB_n2
    s_add_u32 s37, s53, 23121920
    s_mov_b64 exec, 1
    buffer_store_dword v12, v13, s[56:59], s37 offen sc1
FB_n2:
    s_mov_b64 exec, -1
FB_ni:
    v_mov_b32 v6, 162836
spin_7:
    s_sleep 2
    ds_read_b32 v7, v6
    s_waitcnt lgkmcnt(0)
    v_readfirstlane_b32 s53, v7
    s_nop 0
    s_cmp_ge_u32 s53, 4
    s_cbranch_scc0 spin_7
    s_load_dwordx2 s[48:49], s[0:1], 64
    s_lshl_b32 s45, s2, 1
    s_and_b32 s50, s30, 1
    s_add_u32 s45, s45, s50
    s_mul_i32 s45, s45, 4096
    s_mov_b32 s50, 2097152
    s_mov_b32 s51, 0x20000
    s_waitcnt lgkmcnt(0)
    buffer_load_dwordx4 v[20:23], v2, s[48:51], s45 offen offset:0
    buffer_load_dwordx4 v[20:23], v2, s[48:51], s45 offen offset:1024
    buffer_load_dwordx4 v[20:23], v2, s[48:51], s45 offen offset:2048
    buffer_load_dwordx4 v[20:23], v2, s[48:51], s45 offen offset:3072
    s_and_b32 s36, s2, 7
    s_lshl_b32 s36, s36, 7
    s_add_u32 s36, s36, 23101440
    v_mov_b32 v6, 1
    v_mov_b32 v7, 162820
    v_lshlrev_b32 v9, 10, v1
    s_mov_b64 exec, 1
    s_waitcnt vmcnt(0)
    s_waitcnt lgkmcnt(0)
    ds_add_rtn_u32 v8, v7, v6
    s_waitcnt lgkmcnt(0)
    v_readfirstlane_b32 s54, v8
    s_nop 0
    s_cmp_lg_u32 s54, 15
    s_cbranch_scc1 fa_8
    s_mov_b64 exec, 0xffff
    buffer_atomic_add v6, v9, s[56:59], s36 offen sc1
fa_8:
    s_mov_b64 exec, -1
    v_bfe_u32 v252, v251, 2, 2
    v_lshlrev_b32 v248, 14, v252
    v_and_b32 v252, 3, v251
    v_lshl_add_u32 v248, v252, 11, v248
    v_bfe_u32 v252, v251, 7, 3
    v_lshlrev_b32 v249, 14, v252
    v_bfe_u32 v252, v251, 4, 3
    v_lshl_add_u32 v249, v252, 10, v249
    v_bfe_u32 v252, v251, 13, 3
    v_lshlrev_b32 v250, 14, v252
    v_bfe_u32 v252, v251, 10, 3
    v_lshl_add_u32 v250, v252, 10, v250
    v_mov_b32 v6, 162840
spin_9:
    s_sleep 4
    ds_read_b32 v7, v6
    s_waitcnt lgkmcnt(0)
    v_readfirstlane_b32 s53, v7
    s_nop 0
    s_cmp_ge_u32 s53, 2
    s_cbranch_scc0 spin_9
    s_call_b64 s[76:77], SUB_w1_regs
    s_call_b64 s[76:77], SUB_park
    v_mov_b32 v6, 162840
spin_10:
    s_sleep 3
    ds_read_b32 v7, v6
    s_waitcnt lgkmcnt(0)
    v_readfirstlane_b32 s53, v7
    s_nop 0
    s_cmp_ge_u32 s53, 4
    s_cbranch_scc0 spin_10
    s_mov_b64 s[12:13], s[68:69]
    s_mov_b32 s14, 2097152
    s_mov_b32 s15, 0x20000
    s_and_b32 s35, s30, 1
    s_mul_i32 s38, s99, 128
    s_mul_i32 s41, s35, 65536
    s_add_u32 s38, s38, s41
    s_mul_i32 s41, s35, 4096
    s_add_u32 s41, s41, 24576
    s_mov_b32 s42, 0
    s_mov_b32 s44, s67
    s_mov_b32 s42, 73728
    s_mov_b32 s44, s67
    s_add_u32 s44, s44, 9
    s_and_b32 s44, s44, 15
    s_call_b64 s[76:77], SUB_w_issue_1
    s_waitcnt vmcnt(8)
    s_mov_b32 s42, 81920
    s_mov_b32 s44, s67
    s_add_u32 s44, s44, 10
    s_and_b32 s44, s44, 15
    s_call_b64 s[76:77], SUB_w_issue_1
    s_waitcnt vmcnt(8)
    s_mov_b32 s42, 90112
    s_mov_b32 s44, s67
    s_add_u32 s44, s44, 11
    s_and_b32 s44, s44, 15
    s_call_b64 s[76:77], SUB_w_issue_1
    s_waitcnt vmcnt(8)
    s_call_b64 s[76:77], SUB_w1_put
    s_branch FR_end
FB_cs:
    v_and_b32 v164, 15, v1
    v_mov_b32 v165, 0x3f803f80
    v_cmp_eq_u32 vcc, 0, v164
    s_nop 1
    v_cndmask_b32 v16, 0, v165, vcc
    v_cndmask_b32 v17, 0, v165, vcc
    v_cndmask_b32 v18, 0, v165, vcc
    v_cndmask_b32 v19, 0, v165, vcc
    v_cmp_eq_u32 vcc, 1, v164
    s_nop 1
    v_cndmask_b32 v20, 0, v165, vcc
    v_cndmask_b32 v21, 0, v165, vcc
    v_cndmask_b32 v22, 0, v165, vcc
    v_cndmask_b32 v23, 0, v165, vcc
    v_cmp_eq_u32 vcc, 2, v164
    s_nop 1
    v_cndmask_b32 v24, 0, v165, vcc
    v_cndmask_b32 v25, 0, v165, vcc
    v_cndmask_b32 v26, 0, v165, vcc
    v_cndmask_b32 v27, 0, v165, vcc
    v_cmp_eq_u32 vcc, 3, v164
    s_nop 1
    v_cndmask_b32 v28, 0, v165, vcc
    v_cndmask_b32 v29, 0, v165, vcc
    v_cndmask_b32 v30, 0, v165, vcc
    v_cndmask_b32 v31, 0, v165, vcc
    v_cmp_eq_u32 vcc, 4, v164
    s_nop 1
    v_cndmask_b32 v32, 0, v165, vcc
    v_cndmask_b32 v33, 0, v165, vcc
    v_cndmask_b32 v34, 0, v165, vcc
    v_cndmask_b32 v35, 0, v165, vcc
    v_cmp_eq_u32 vcc, 5, v164
    s_nop 1
    v_cndmask_b32 v36, 0, v165, vcc
    v_cndmask_b32 v37, 0, v165, vcc
    v_cndmask_b32 v38, 0, v165, vcc
    v_cndmask_b32 v39, 0, v165, vcc
    v_cmp_eq_u32 vcc, 6, v164
    s_nop 1
    v_cndmask_b32 v40, 0, v165, vcc
    v_cndmask_b32 v41, 0, v165, vcc
    v_cndmask_b32 v42, 0, v165, vcc
    v_cndmask_b32 v43, 0, v165, vcc
    v_cmp_eq_u32 vcc, 7, v164
    s_nop 1
    v_cndmask_b32 v44, 0, v165, vcc
    v_cndmask_b32 v45, 0, v165, vcc
    v_cndmask_b32 v46, 0, v165, vcc
    v_cndmask_b32 v47, 0, v165, vcc
    v_cmp_eq_u32 vcc, 8, v164
    s_nop 1
    v_cndmask_b32 v48, 0, v165, vcc
    v_cndmask_b32 v49, 0, v165, vcc
    v_cndmask_b32 v50, 0, v165, vcc
    v_cndmask_b32 v51, 0, v165, vcc
    v_cmp_eq_u32 vcc, 9, v164
    s_nop 1
    v_cndmask_b32 v52, 0, v165, vcc
    v_cndmask_b32 v53, 0, v165, vcc
    v_cndmask_b32 v54, 0, v165, vcc
    v_cndmask_b32 v55, 0, v165, vcc
    v_cmp_eq_u32 vcc, 10, v164
    s_nop 1
    v_cndmask_b32 v56, 0, v165, vcc
    v_cndmask_b32 v57, 0, v165, vcc
    v_cndmask_b32 v58, 0, v165, vcc
    v_cndmask_b32 v59, 0, v165, vcc
    v_cmp_eq_u32 vcc, 11, v164
    s_nop 1
    v_cndmask_b32 v60, 0, v165, vcc
    v_cndmask_b32 v61, 0, v165, vcc
    v_cndmask_b32 v62, 0, v165, vcc
    v_cndmask_b32 v63, 0, v165, vcc
    v_cmp_eq_u32 vcc, 12, v164
    s_nop 1
    v_cndmask_b32 v64, 0, v165, vcc
    v_cndmask_b32 v65, 0, v165, vcc
    v_cndmask_b32 v66, 0, v165, vcc
    v_cndmask_b32 v67, 0, v165, vcc
    v_cmp_eq_u32 vcc, 13, v164
    s_nop 1
    v_cndmask_b32 v68, 0, v165, vcc
    v_cndmask_b32 v69, 0, v165, vcc
    v_cndmask_b32 v70, 0, v165, vcc
    v_cndmask_b32 v71, 0, v165, vcc
    s_mov_b32 s35, 0
    v_lshrrev_b32 v253, 2, v1
    v_mul_u32_u24 v144, 128, v253
    v_and_b32 v254, 3, v1
    v_lshl_add_u32 v144, v254, 3, v144
    v_add_u32 v144, 24576, v144
    v_bfe_u32 v253, v253, 1, 2
    s_mul_i32 s36, s35, 4
    s_add_u32 s36, s36, 3
    v_xor_b32 v254, s36, v253
    v_lshl_add_u32 v147, v254, 5, v144
    s_mul_i32 s36, s35, 4
    s_add_u32 s36, s36, 2
    v_xor_b32 v254, s36, v253
    v_lshl_add_u32 v146, v254, 5, v144
    s_mul_i32 s36, s35, 4
    s_add_u32 s36, s36, 1
    v_xor_b32 v254, s36, v253
    v_lshl_add_u32 v145, v254, 5, v144
    s_mul_i32 s36, s35, 4
    s_add_u32 s36, s36, 0
    v_xor_b32 v254, s36, v253
    v_lshl_add_u32 v144, v254, 5, v144
    s_and_b32 s35, s30, 1
    s_mul_i32 s35, s35, 4096
    s_add_u32 s35, s35, 73728
    v_add_u32 v144, s35, v144
    v_add_u32 v145, s35, v145
    v_add_u32 v146, s35, v146
    v_add_u32 v147, s35, v147
    s_mov_b32 s35, 0
    v_lshrrev_b32 v253, 2, v1
    v_mul_u32_u24 v148, 448, v253
    v_and_b32 v254, 3, v1
    v_lshl_add_u32 v148, v254, 3, v148
    v_add_u32 v148, 73728, v148
    s_mul_i32 s36, s35, 224
    v_add_u32 v148, s36, v148
    v_bfe_u32 v253, v1, 4, 1
    v_lshlrev_b32 v253, 5, v253
    s_cmp_eq_u32 s35, 0
    s_cselect_b32 s36, 1, -1
    v_mul_lo_u32 v253, v253, s36
    v_sub_u32 v149, v148, v253
    v_add_u32 v148, v148, v253
    s_and_b32 s35, s30, 1
    s_mul_i32 s35, s35, 14336
    s_add_u32 s35, s35, 32768
    v_add_u32 v148, s35, v148
    v_add_u32 v149, s35, v149
    s_mov_b32 s35, 1
    v_lshrrev_b32 v253, 2, v1
    v_mul_u32_u24 v150, 448, v253
    v_and_b32 v254, 3, v1
    v_lshl_add_u32 v150, v254, 3, v150
    v_add_u32 v150, 73728, v150
    s_mul_i32 s36, s35, 224
    v_add_u32 v150, s36, v150
    v_bfe_u32 v253, v1, 4, 1
    v_lshlrev_b32 v253, 5, v253
    s_cmp_eq_u32 s35, 0
    s_cselect_b32 s36, 1, -1
    v_mul_lo_u32 v253, v253, s36
    v_sub_u32 v151, v150, v253
    v_add_u32 v150, v150, v253
    s_and_b32 s35, s30, 1
    s_mul_i32 s35, s35, 14336
    s_add_u32 s35, s35, 32768
    v_add_u32 v150, s35, v150
    v_add_u32 v151, s35, v151
    v_mov_b32 v156, 0
    v_mov_b32 v157, 0
    v_mov_b32 v158, 0
    v_mov_b32 v159, 0
    v_mov_b32 v160, 0
    v_mov_b32 v161, 0
    v_mov_b32 v162, 0
    v_mov_b32 v163, 0
    v_lshrrev_b32 v166, 4, v1
    v_lshlrev_b32 v166, 4, v166
    v_lshl_add_u32 v166, v164, 6, v166
    v_mov_b32 v165, 0x7f000000
    v_cmp_gt_u32 vcc, 4, v164
    s_nop 1
    v_cndmask_b32 v167, v165, v166, vcc
    v_cmp_gt_u32 vcc, 14, v164
    s_nop 1
    v_cndmask_b32 v168, v165, v166, vcc
    v_mov_b32 v6, 162836
spin_11:
    s_sleep 2
    ds_read_b32 v7, v6
    s_waitcnt lgkmcnt(0)
    v_readfirstlane_b32 s53, v7
    s_nop 0
    s_cmp_ge_u32 s53, 4
    s_cbranch_scc0 spin_11
    s_mov_b64 s[12:13], s[68:69]
    s_mov_b32 s14, 2097152
    s_mov_b32 s15, 0x20000
    s_and_b32 s35, s30, 1
    s_mul_i32 s38, s99, 128
    s_mul_i32 s41, s35, 65536
    s_add_u32 s38, s38, s41
    s_mul_i32 s41, s35, 4096
    s_add_u32 s41, s41, 24576
    s_mov_b32 s42, 0
    s_mov_b32 s44, s67
    s_mov_b32 s42, 73728
    s_mov_b32 s44, s28
    s_add_u32 s19, s41, s42
    s_mul_i32 s16, s44, 131072
    s_add_u32 s16, s16, s38
    s_add_u32 s44, s44, 1
    s_and_b32 s44, s44, 15
    s_add_u32 s42, s42, 8192
    s_cmp_eq_u32 s42, 131072
    s_cselect_b32 s42, 0, s42
    s_mov_b32 m0, s19
    s_mov_b32 s39, s16
    buffer_load_dwordx4 v238, s[12:15], s39 offen lds
    s_add_u32 m0, m0, 1024
    s_add_u32 s39, s39, 16384
    buffer_load_dwordx4 v238, s[12:15], s39 offen lds
    s_add_u32 m0, m0, 1024
    s_add_u32 s39, s39, 16384
    buffer_load_dwordx4 v238, s[12:15], s39 offen lds
    s_add_u32 m0, m0, 1024
    s_add_u32 s39, s39, 16384
    buffer_load_dwordx4 v238, s[12:15], s39 offen lds
    s_mov_b64 s[12:13], s[72:73]
    s_mov_b32 s14, 7340032
    s_mov_b32 s15, 0x20000
    s_and_b32 s35, s30, 1
    s_mul_i32 s38, s29, 448
    s_mul_i32 s41, s35, 229376
    s_add_u32 s38, s38, s41
    s_mul_i32 s41, s35, 14336
    s_add_u32 s41, s41, 73728
    s_mov_b32 s42, 0
    s_mov_b32 s44, 0
    s_mov_b32 s42, 32768
    s_mov_b32 s44, s28
    s_add_u32 s19, s41, s42
    s_mul_i32 s16, s44, 458752
    s_add_u32 s16, s16, s38
    s_add_u32 s44, s44, 1
    s_and_b32 s44, s44, 15
    s_add_u32 s42, s42, 28672
    s_cmp_eq_u32 s42, 86016
    s_cselect_b32 s42, 0, s42
    s_mov_b32 m0, s19
    s_mov_b32 s39, s16
    buffer_load_dwordx4 v241, s[12:15], s39 offen lds
    s_add_u32 m0, m0, 1024
    s_nop 0
    buffer_load_dwordx4 v242, s[12:15], s39 offen lds
    s_add_u32 m0, m0, 1024
    s_nop 0
    buffer_load_dwordx4 v243, s[12:15], s39 offen lds
    s_add_u32 m0, m0, 1024
    s_nop 0
    buffer_load_dwordx4 v244, s[12:15], s39 offen lds
    s_add_u32 m0, m0, 1024
    s_nop 0
    buffer_load_dwordx4 v245, s[12:15], s39 offen lds
    s_add_u32 m0, m0, 1024
    s_nop 0
    buffer_load_dwordx4 v246, s[12:15], s39 offen lds
    s_add_u32 m0, m0, 1024
    s_nop 0
    buffer_load_dwordx4 v247, s[12:15], s39 offen lds
    s_add_u32 m0, m0, 1024
    s_add_u32 s39, s39, 114688
    buffer_load_dwordx4 v241, s[12:15], s39 offen lds
    s_add_u32 m0, m0, 1024
    s_nop 0
    buffer_load_dwordx4 v242, s[12:15], s39 offen lds
    s_add_u32 m0, m0, 1024
    s_nop 0
    buffer_load_dwordx4 v243, s[12:15], s39 offen lds
    s_add_u32 m0, m0, 1024
    s_nop 0
    buffer_load_dwordx4 v244, s[12:15], s39 offen lds
    s_add_u32 m0, m0, 1024
    s_nop 0
    buffer_load_dwordx4 v245, s[12:15], s39 offen lds
    s_add_u32 m0, m0, 1024
    s_nop 0
    buffer_load_dwordx4 v246, s[12:15], s39 offen lds
    s_add_u32 m0, m0, 1024
    s_nop 0
    buffer_load_dwordx4 v247, s[12:15], s39 offen lds
    s_waitcnt vmcnt(14)
    s_setprio 1
    ds_read_b64_tr_b16 v[128:129], v144 offset:0
    ds_read_b64_tr_b16 v[130:131], v144 offset:2048
    ds_read_b64_tr_b16 v[132:133], v145 offset:0
    ds_read_b64_tr_b16 v[134:135], v145 offset:2048
    ds_read_b64_tr_b16 v[136:137], v146 offset:0
    ds_read_b64_tr_b16 v[138:139], v146 offset:2048
    ds_read_b64_tr_b16 v[140:141], v147 offset:0
    ds_read_b64_tr_b16 v[142:143], v147 offset:2048
    s_add_u32 s20, s4, 0x1400000
    s_addc_u32 s21, s5, 0
    s_mov_b32 s22, 0x20000
    s_mov_b32 s23, 0x20000
    s_lshl_b32 s35, s28, 1
    s_and_b32 s36, s30, 1
    s_add_u32 s35, s35, s36
    s_mul_i32 s35, s35, 4096
    s_mul_i32 s36, s29, 256
    s_add_u32 s35, s35, s36
    s_waitcnt lgkmcnt(0)
    v_mfma_f32_16x16x32_bf16 v[160:163], v[128:131], v[16:19], v[160:163]
    v_mfma_f32_16x16x32_bf16 v[160:163], v[132:135], v[20:23], v[160:163]
    v_mfma_f32_16x16x32_bf16 v[160:163], v[136:139], v[24:27], v[160:163]
    v_mfma_f32_16x16x32_bf16 v[160:163], v[140:143], v[28:31], v[160:163]
    s_nop 7
    buffer_store_dwordx4 v[160:163], v167, s[20:23], s35 offen sc1
    s_waitcnt vmcnt(1)
    v_mov_b32 v6, 162840
    v_mov_b32 v7, 1
    s_mov_b64 exec, 1
    ds_add_u32 v6, v7
    s_mov_b64 exec, -1
    ds_read_b64_tr_b16 v[72:73], v148 offset:0
    ds_read_b64_tr_b16 v[74:75], v148 offset:7168
    ds_read_b64_tr_b16 v[76:77], v149 offset:32
    ds_read_b64_tr_b16 v[78:79], v149 offset:7200
    ds_read_b64_tr_b16 v[80:81], v148 offset:64
    ds_read_b64_tr_b16 v[82:83], v148 offset:7232
    ds_read_b64_tr_b16 v[84:85], v149 offset:96
    ds_read_b64_tr_b16 v[86:87], v149 offset:7264
    ds_read_b64_tr_b16 v[88:89], v148 offset:128
    ds_read_b64_tr_b16 v[90:91], v148 offset:7296
    ds_read_b64_tr_b16 v[92:93], v149 offset:160
    ds_read_b64_tr_b16 v[94:95], v149 offset:7328
    ds_read_b64_tr_b16 v[96:97], v148 offset:192
    ds_read_b64_tr_b16 v[98:99], v148 offset:7360
    ds_read_b64_tr_b16 v[100:101], v150 offset:0
    ds_read_b64_tr_b16 v[102:103], v150 offset:7168
    ds_read_b64_tr_b16 v[104:105], v151 offset:32
    ds_read_b64_tr_b16 v[106:107], v151 offset:7200
    ds_read_b64_tr_b16 v[108:109], v150 offset:64
    ds_read_b64_tr_b16 v[110:111], v150 offset:7232
    ds_read_b64_tr_b16 v[112:113], v151 offset:96
    ds_read_b64_tr_b16 v[114:115], v151 offset:7264
    ds_read_b64_tr_b16 v[116:117], v150 offset:128
    ds_read_b64_tr_b16 v[118:119], v150 offset:7296
    ds_read_b64_tr_b16 v[120:121], v151 offset:160
    ds_read_b64_tr_b16 v[122:123], v151 offset:7328
    ds_read_b64_tr_b16 v[124:125], v150 offset:192
    ds_read_b64_tr_b16 v[126:127], v150 offset:7360
    s_add_u32 s20, s4, 0x1420000
    s_addc_u32 s21, s5, 0
    s_mov_b32 s22, 0x70000
    s_mov_b32 s23, 0x20000
    s_lshl_b32 s35, s28, 1
    s_and_b32 s36, s30, 1
    s_add_u32 s35, s35, s36
    s_mul_i32 s35, s35, 14336
    s_mul_i32 s36, s29, 896
    s_add_u32 s35, s35, s36
    s_waitcnt lgkmcnt(0)
    v_mfma_f32_16x16x32_bf16 v[156:159], v[72:75], v[16:19], v[156:159]
    v_mfma_f32_16x16x32_bf16 v[156:159], v[76:79], v[20:23], v[156:159]
    v_mfma_f32_16x16x32_bf16 v[156:159], v[80:83], v[24:27], v[156:159]
    v_mfma_f32_16x16x32_bf16 v[156:159], v[84:87], v[28:31], v[156:159]
    v_mfma_f32_16x16x32_bf16 v[156:159], v[88:91], v[32:35], v[156:159]
    v_mfma_f32_16x16x32_bf16 v[156:159], v[92:95], v[36:39], v[156:159]
    v_mfma_f32_16x16x32_bf16 v[156:159], v[96:99], v[40:43], v[156:159]
    v_mfma_f32_16x16x32_bf16 v[156:159], v[100:103], v[44:47], v[156:159]
    v_mfma_f32_16x16x32_bf16 v[156:159], v[104:107], v[48:51], v[156:159]
    v_mfma_f32_16x16x32_bf16 v[156:159], v[108:111], v[52:55], v[156:159]
    v_mfma_f32_16x16x32_bf16 v[156:159], v[112:115], v[56:59], v[156:159]
    v_mfma_f32_16x16x32_bf16 v[156:159], v[116:119], v[60:63], v[156:159]
    v_mfma_f32_16x16x32_bf16 v[156:159], v[120:123], v[64:67], v[156:159]
    v_mfma_f32_16x16x32_bf16 v[156:159], v[124:127], v[68:71], v[156:159]
    s_nop 7
    buffer_store_dwordx4 v[156:159], v168, s[20:23], s35 offen sc1
    s_and_b32 s36, s2, 7
    s_lshl_b32 s36, s36, 7
    s_add_u32 s36, s36, 23101440
    v_mov_b32 v6, 1
    v_mov_b32 v7, 162820
    v_lshlrev_b32 v9, 10, v1
    s_mov_b64 exec, 1
    s_waitcnt lgkmcnt(0)
    ds_add_rtn_u32 v8, v7, v6
    s_waitcnt lgkmcnt(0)
    v_readfirstlane_b32 s54, v8
    s_nop 0
    s_cmp_lg_u32 s54, 15
    s_cbranch_scc1 fa_12
    s_mov_b64 exec, 0xffff
    buffer_atomic_add v6, v9, s[56:59], s36 offen sc1
fa_12:
    s_mov_b64 exec, -1
    v_and_b32 v252, 15, v251
    v_mul_u32_u24 v248, 458752, v252
    s_and_b32 s36, s30, 1
    s_mul_i32 s36, s36, 6
    s_add_u32 s36, s36, 4
    v_bfe_u32 v252, v251, s36, 6
    v_mul_u32_u24 v250, 37, v252
    v_lshrrev_b32 v250, 8, v250
    v_mul_u32_u24 v250, 7, v250
    v_sub_u32 v250, v252, v250
    v_cmp_eq_u32 vcc, 3, v250
    s_nop 1
    v_cndmask_b32 v250, 0, 1, vcc
    v_lshl_add_u32 v249, v252, 16, v250
    v_mov_b32 v6, 162840
    v_mov_b32 v7, 1
    s_mov_b64 exec, 1
    ds_add_u32 v6, v7
    s_mov_b64 exec, -1
    s_setprio 0
    s_call_b64 s[76:77], SUB_w1_regs
    s_call_b64 s[76:77], SUB_park
    v_mov_b32 v6, 162840
spin_13:
    s_sleep 3
    ds_read_b32 v7, v6
    s_waitcnt lgkmcnt(0)
    v_readfirstlane_b32 s53, v7
    s_nop 0
    s_cmp_ge_u32 s53, 4
    s_cbranch_scc0 spin_13
    s_mov_b64 s[12:13], s[68:69]
    s_mov_b32 s14, 2097152
    s_mov_b32 s15, 0x20000
    s_and_b32 s35, s30, 1
    s_mul_i32 s38, s99, 128
    s_mul_i32 s41, s35, 65536
    s_add_u32 s38, s38, s41
    s_mul_i32 s41, s35, 4096
    s_add_u32 s41, s41, 24576
    s_mov_b32 s42, 0
    s_mov_b32 s44, s67
    s_mov_b32 s42, 98304
    s_mov_b32 s44, s67
    s_add_u32 s44, s44, 12
    s_and_b32 s44, s44, 15
    s_call_b64 s[76:77], SUB_w_issue_1
    s_waitcnt vmcnt(8)
    s_mov_b32 s42, 106496
    s_mov_b32 s44, s67
    s_add_u32 s44, s44, 13
    s_and_b32 s44, s44, 15
    s_call_b64 s[76:77], SUB_w_issue_1
    s_waitcnt vmcnt(8)
    s_mov_b32 s42, 114688
    s_mov_b32 s44, s67
    s_add_u32 s44, s44, 14
    s_and_b32 s44, s44, 15
    s_call_b64 s[76:77], SUB_w_issue_1
    s_waitcnt vmcnt(8)
    s_mov_b32 s42, 122880
    s_mov_b32 s44, s67
    s_add_u32 s44, s44, 15
    s_and_b32 s44, s44, 15
    s_call_b64 s[76:77], SUB_w_issue_1
    s_waitcnt vmcnt(8)
    s_call_b64 s[76:77], SUB_w1_put
FR_end:
LAYER:
    v_lshlrev_b32 v40, 6, v199
    v_add_u32 v40, 161792, v40
    s_lshl_b32 s35, s30, 3
    v_add_u32 v39, s35, v40
    s_cmp_eq_u32 s60, 0
    s_cbranch_scc1 R_l0
    s_sub_u32 s8, s62, 0x400000
    s_subb_u32 s9, s63, 0
    s_mov_b32 s10, 0x7e000
    s_mov_b32 s11, 0x20000
    s_sub_u32 s12, s62, 0x380000
    s_subb_u32 s13, s63, 0
    s_mov_b32 s14, 0x7e000
    s_mov_b32 s15, 0x20000
    s_mov_b32 s20, s62
    s_mov_b32 s21, s63
    s_mov_b32 s22, 0x7e000
    s_mov_b32 s23, 0x20000
    s_mov_b32 s78, 0x3f80
    s_mov_b32 s79, 0x3f800000
    v_lshlrev_b32 v222, 16, v230
    v_and_b32 v223, 0xffff0000, v230
    v_lshlrev_b32 v206, 16, v180
    v_and_b32 v207, 0xffff0000, v180
    v_lshlrev_b32 v12, 16, v188
    v_and_b32 v13, 0xffff0000, v188
    v_pk_add_f32 v[206:207], v[206:207], v[12:13]
    v_lshlrev_b32 v224, 16, v231
    v_and_b32 v225, 0xffff0000, v231
    v_lshlrev_b32 v208, 16, v181
    v_and_b32 v209, 0xffff0000, v181
    v_lshlrev_b32 v14, 16, v189
    v_and_b32 v15, 0xffff0000, v189
    v_pk_add_f32 v[208:209], v[208:209], v[14:15]
    v_lshlrev_b32 v226, 16, v232
    v_and_b32 v227, 0xffff0000, v232
    v_lshlrev_b32 v210, 16, v182
    v_and_b32 v211, 0xffff0000, v182
    v_lshlrev_b32 v16, 16, v190
    v_and_b32 v17, 0xffff0000, v190
    v_pk_add_f32 v[210:211], v[210:211], v[16:17]
    v_lshlrev_b32 v228, 16, v233
    v_and_b32 v229, 0xffff0000, v233
    v_lshlrev_b32 v212, 16, v183
    v_and_b32 v213, 0xffff0000, v183
    v_lshlrev_b32 v18, 16, v191
    v_and_b32 v19, 0xffff0000, v191
    v_pk_add_f32 v[212:213], v[212:213], v[18:19]
    v_lshlrev_b32 v230, 16, v234
    v_and_b32 v231, 0xffff0000, v234
    v_lshlrev_b32 v214, 16, v184
    v_and_b32 v215, 0xffff0000, v184
    v_lshlrev_b32 v20, 16, v192
    v_and_b32 v21, 0xffff0000, v192
    v_pk_add_f32 v[214:215], v[214:215], v[20:21]
    v_lshlrev_b32 v232, 16, v235
    v_and_b32 v233, 0xffff0000, v235
    v_lshlrev_b32 v216, 16, v185
    v_and_b32 v217, 0xffff0000, v185
    v_lshlrev_b32 v22, 16, v193
    v_and_b32 v23, 0xffff0000, v193
    v_pk_add_f32 v[216:217], v[216:217], v[22:23]
    v_lshlrev_b32 v234, 16, v236
    v_and_b32 v235, 0xffff0000, v236
    v_lshlrev_b32 v218, 16, v186
    v_and_b32 v219, 0xffff0000, v186
    v_lshlrev_b32 v24, 16, v194
    v_and_b32 v25, 0xffff0000, v194
    v_pk_add_f32 v[218:219], v[218:219], v[24:25]
    v_lshlrev_b32 v236, 16, v237
    v_and_b32 v237, 0xffff0000, v237
    v_lshlrev_b32 v220, 16, v187
    v_and_b32 v221, 0xffff0000, v187
    v_lshlrev_b32 v26, 16, v195
    v_and_b32 v27, 0xffff0000, v195
    v_pk_add_f32 v[220:221], v[220:221], v[26:27]
    s_mov_b32 s53, 0
    s_sleep 10
    s_cmp_ge_u32 s30, 6
    s_cbranch_scc1 dp_14
    s_sleep 14
dp_14:
    buffer_load_dwordx4 v[180:183], v196, s[8:11], 0 offen offset:0 sc1
    buffer_load_dwordx4 v[188:191], v196, s[12:15], 0 offen offset:0 sc1
    buffer_load_dwordx4 v[184:187], v196, s[8:11], 0 offen offset:2048 sc1
    buffer_load_dwordx4 v[192:195], v196, s[12:15], 0 offen offset:2048 sc1
    s_waitcnt vmcnt(0)
    v_bitop3_b32 v6, v180, v184, v188 bitop3:0x80
    v_bitop3_b32 v6, v6, v192, 1 bitop3:0x80
    v_cmp_eq_u32 vcc, 0, v6
    s_cbranch_vccz dq_15
    s_sleep 4
    s_add_u32 s53, s53, 1
    s_cmp_lt_u32 s53, s61
    s_cbranch_scc1 dp_14
    s_mov_b32 s61, 0
dq_15:
    v_dot2_f32_bf16 v206, v180, s78, v206
    v_dot2_f32_bf16 v207, v180, s79, v207
    v_dot2_f32_bf16 v208, v181, s78, v208
    v_dot2_f32_bf16 v209, v181, s79, v209
    v_dot2_f32_bf16 v210, v182, s78, v210
    v_dot2_f32_bf16 v211, v182, s79, v211
    v_dot2_f32_bf16 v212, v183, s78, v212
    v_dot2_f32_bf16 v213, v183, s79, v213
    v_dot2_f32_bf16 v214, v184, s78, v214
    v_dot2_f32_bf16 v215, v184, s79, v215
    v_dot2_f32_bf16 v216, v185, s78, v216
    v_dot2_f32_bf16 v217, v185, s79, v217
    v_dot2_f32_bf16 v218, v186, s78, v218
    v_dot2_f32_bf16 v219, v186, s79, v219
    v_dot2_f32_bf16 v220, v187, s78, v220
    v_dot2_f32_bf16 v221, v187, s79, v221
    v_dot2_f32_bf16 v206, v188, s78, v206
    v_dot2_f32_bf16 v207, v188, s79, v207
    v_dot2_f32_bf16 v208, v189, s78, v208
    v_dot2_f32_bf16 v209, v189, s79, v209
    v_dot2_f32_bf16 v210, v190, s78, v210
    v_dot2_f32_bf16 v211, v190, s79, v211
    v_dot2_f32_bf16 v212, v191, s78, v212
    v_dot2_f32_bf16 v213, v191, s79, v213
    v_dot2_f32_bf16 v214, v192, s78, v214
    v_dot2_f32_bf16 v215, v192, s79, v215
    v_dot2_f32_bf16 v216, v193, s78, v216
    v_dot2_f32_bf16 v217, v193, s79, v217
    v_dot2_f32_bf16 v218, v194, s78, v218
    v_dot2_f32_bf16 v219, v194, s79, v219
    v_dot2_f32_bf16 v220, v195, s78, v220
    v_dot2_f32_bf16 v221, v195, s79, v221
    s_nop 2
    v_pk_add_f32 v[32:33], v[206:207], v[208:209]
    v_pk_mul_f32 v[34:35], v[206:207], v[206:207]
    v_pk_fma_f32 v[34:35], v[208:209], v[208:209], v[34:35]
    v_pk_add_f32 v[32:33], v[32:33], v[210:211]
    v_pk_fma_f32 v[34:35], v[210:211], v[210:211], v[34:35]
    v_pk_add_f32 v[32:33], v[32:33], v[212:213]
    v_pk_fma_f32 v[34:35], v[212:213], v[212:213], v[34:35]
    v_pk_add_f32 v[32:33], v[32:33], v[214:215]
    v_pk_fma_f32 v[34:35], v[214:215], v[214:215], v[34:35]
    v_pk_add_f32 v[32:33], v[32:33], v[216:217]
    v_pk_fma_f32 v[34:35], v[216:217], v[216:217], v[34:35]
    v_pk_add_f32 v[32:33], v[32:33], v[218:219]
    v_pk_fma_f32 v[34:35], v[218:219], v[218:219], v[34:35]
    v_pk_add_f32 v[32:33], v[32:33], v[220:221]
    v_pk_fma_f32 v[34:35], v[220:221], v[220:221], v[34:35]
    v_add_f32 v30, v32, v33
    v_add_f32 v31, v34, v35
    s_nop 0
    v_add_f32_dpp v30, v30, v30 row_ror:8 row_mask:0xf bank_mask:0xf
    v_add_f32_dpp v31, v31, v31 row_ror:8 row_mask:0xf bank_mask:0xf
    v_mov_b32 v32, v30
    v_mov_b32 v33, v31
    s_nop 0
    v_permlane16_swap_b32 v30, v32
    v_permlane16_swap_b32 v31, v33
    v_pk_add_f32 v[30:31], v[30:31], v[32:33]
    v_mov_b32 v32, v30
    v_mov_b32 v33, v31
    s_nop 0
    v_permlane32_swap_b32 v30, v32
    v_permlane32_swap_b32 v31, v33
    v_pk_add_f32 v[30:31], v[30:31], v[32:33]
    ds_write_b64 v39, v[30:31] offset:0
    s_waitcnt lgkmcnt(0)
    s_barrier
    ds_read_b128 v[12:15], v40 offset:0
    ds_read_b128 v[16:19], v40 offset:16
    ds_read_b128 v[20:23], v40 offset:32
    ds_read_b128 v[24:27], v40 offset:48
    s_waitcnt lgkmcnt(0)
    v_pk_add_f32 v[12:13], v[12:13], v[14:15]
    v_pk_add_f32 v[16:17], v[16:17], v[18:19]
    v_pk_add_f32 v[20:21], v[20:21], v[22:23]
    v_pk_add_f32 v[24:25], v[24:25], v[26:27]
    v_pk_add_f32 v[12:13], v[12:13], v[16:17]
    v_pk_add_f32 v[20:21], v[20:21], v[24:25]
    v_pk_add_f32 v[12:13], v[12:13], v[20:21]
    v_mul_f32 v36, 0x3a800000, v12
    v_mul_f32 v38, 0x3a800000, v13
    v_fma_f32 v38, -v36, v36, v38
    v_max_f32 v38, 0, v38
    v_add_f32 v38, 0x3727c5ac, v38
    v_rsq_f32 v37, v38
    s_nop 0
    v_mul_f32 v36, v36, v37
    v_pk_fma_f32 v[12:13], v[206:207], v[36:37], v[36:37] op_sel:[0,1,0] op_sel_hi:[1,1,0] neg_lo:[0,0,1] neg_hi:[0,0,1]
    v_pk_fma_f32 v[14:15], v[208:209], v[36:37], v[36:37] op_sel:[0,1,0] op_sel_hi:[1,1,0] neg_lo:[0,0,1] neg_hi:[0,0,1]
    v_pk_fma_f32 v[16:17], v[210:211], v[36:37], v[36:37] op_sel:[0,1,0] op_sel_hi:[1,1,0] neg_lo:[0,0,1] neg_hi:[0,0,1]
    v_pk_fma_f32 v[18:19], v[212:213], v[36:37], v[36:37] op_sel:[0,1,0] op_sel_hi:[1,1,0] neg_lo:[0,0,1] neg_hi:[0,0,1]
    v_pk_fma_f32 v[20:21], v[214:215], v[36:37], v[36:37] op_sel:[0,1,0] op_sel_hi:[1,1,0] neg_lo:[0,0,1] neg_hi:[0,0,1]
    v_pk_fma_f32 v[22:23], v[216:217], v[36:37], v[36:37] op_sel:[0,1,0] op_sel_hi:[1,1,0] neg_lo:[0,0,1] neg_hi:[0,0,1]
    v_pk_fma_f32 v[24:25], v[218:219], v[36:37], v[36:37] op_sel:[0,1,0] op_sel_hi:[1,1,0] neg_lo:[0,0,1] neg_hi:[0,0,1]
    v_pk_fma_f32 v[26:27], v[220:221], v[36:37], v[36:37] op_sel:[0,1,0] op_sel_hi:[1,1,0] neg_lo:[0,0,1] neg_hi:[0,0,1]
    v_pk_fma_f32 v[206:207], v[12:13], v[222:223], v[206:207]
    v_cvt_pk_bf16_f32 v180, v206, v207
    v_pk_fma_f32 v[208:209], v[14:15], v[224:225], v[208:209]
    v_cvt_pk_bf16_f32 v181, v208, v209
    v_and_b32 v180, -2, v180
    v_pk_fma_f32 v[210:211], v[16:17], v[226:227], v[210:211]
    v_cvt_pk_bf16_f32 v182, v210, v211
    v_pk_fma_f32 v[212:213], v[18:19], v[228:229], v[212:213]
    v_cvt_pk_bf16_f32 v183, v212, v213
    buffer_store_dwordx4 v[180:183], v196, s[20:23], 0 offen offset:0 sc1
    v_pk_fma_f32 v[214:215], v[20:21], v[230:231], v[214:215]
    v_cvt_pk_bf16_f32 v184, v214, v215
    v_pk_fma_f32 v[216:217], v[22:23], v[232:233], v[216:217]
    v_cvt_pk_bf16_f32 v185, v216, v217
    v_and_b32 v184, -2, v184
    v_pk_fma_f32 v[218:219], v[24:25], v[234:235], v[218:219]
    v_cvt_pk_bf16_f32 v186, v218, v219
    v_pk_fma_f32 v[220:221], v[26:27], v[236:237], v[220:221]
    v_cvt_pk_bf16_f32 v187, v220, v221
    buffer_store_dwordx4 v[184:187], v196, s[20:23], 0 offen offset:2048 sc1
    s_branch R_s2
R_l0:
    v_lshlrev_b32 v206, 16, v180
    v_and_b32 v207, 0xffff0000, v180
    v_lshlrev_b32 v208, 16, v181
    v_and_b32 v209, 0xffff0000, v181
    v_lshlrev_b32 v210, 16, v182
    v_and_b32 v211, 0xffff0000, v182
    v_lshlrev_b32 v212, 16, v183
    v_and_b32 v213, 0xffff0000, v183
    v_lshlrev_b32 v214, 16, v184
    v_and_b32 v215, 0xffff0000, v184
    v_lshlrev_b32 v216, 16, v185
    v_and_b32 v217, 0xffff0000, v185
    v_lshlrev_b32 v218, 16, v186
    v_and_b32 v219, 0xffff0000, v186
    v_lshlrev_b32 v220, 16, v187
    v_and_b32 v221, 0xffff0000, v187
    v_pk_add_f32 v[32:33], v[206:207], v[208:209]
    v_pk_mul_f32 v[34:35], v[206:207], v[206:207]
    v_pk_fma_f32 v[34:35], v[208:209], v[208:209], v[34:35]
    v_pk_add_f32 v[32:33], v[32:33], v[210:211]
    v_pk_fma_f32 v[34:35], v[210:211], v[210:211], v[34:35]
    v_pk_add_f32 v[32:33], v[32:33], v[212:213]
    v_pk_fma_f32 v[34:35], v[212:213], v[212:213], v[34:35]
    v_pk_add_f32 v[32:33], v[32:33], v[214:215]
    v_pk_fma_f32 v[34:35], v[214:215], v[214:215], v[34:35]
    v_pk_add_f32 v[32:33], v[32:33], v[216:217]
    v_pk_fma_f32 v[34:35], v[216:217], v[216:217], v[34:35]
    v_pk_add_f32 v[32:33], v[32:33], v[218:219]
    v_pk_fma_f32 v[34:35], v[218:219], v[218:219], v[34:35]
    v_pk_add_f32 v[32:33], v[32:33], v[220:221]
    v_pk_fma_f32 v[34:35], v[220:221], v[220:221], v[34:35]
    v_add_f32 v30, v32, v33
    v_add_f32 v31, v34, v35
    s_nop 0
    v_add_f32_dpp v30, v30, v30 row_ror:8 row_mask:0xf bank_mask:0xf
    v_add_f32_dpp v31, v31, v31 row_ror:8 row_mask:0xf bank_mask:0xf
    v_mov_b32 v32, v30
    v_mov_b32 v33, v31
    s_nop 0
    v_permlane16_swap_b32 v30, v32
    v_permlane16_swap_b32 v31, v33
    v_pk_add_f32 v[30:31], v[30:31], v[32:33]
    v_mov_b32 v32, v30
    v_mov_b32 v33, v31
    s_nop 0
    v_permlane32_swap_b32 v30, v32
    v_permlane32_swap_b32 v31, v33
    v_pk_add_f32 v[30:31], v[30:31], v[32:33]
    ds_write_b64 v39, v[30:31] offset:0
    s_waitcnt lgkmcnt(0)
    s_lshl_b32 s36, s28, 10
    s_add_u32 s36, s36, 23101440
    s_lshl_b32 s53, s30, 7
    s_add_u32 s36, s36, s53
    v_mov_b32 v226, s36
    v_mov_b32 v222, 162844
spin_16:
    ds_read_b32 v223, v222
    s_waitcnt lgkmcnt(0)
    v_readfirstlane_b32 s94, v223
    s_nop 0
    s_cmp_ge_u32 s94, 65536
    s_cbranch_scc0 spin_16
    s_cmp_gt_u32 s94, 65546
    s_cselect_b32 s94, 1, 0
    s_lshl_b32 s53, s94, 13
    v_xor_b32 v197, s53, v197
    s_waitcnt vmcnt(0)
    s_barrier
    s_mov_b32 s53, 0
    s_add_u32 s54, s52, 32
    s_bfm_b64 exec, 1, 0
poll_17:
    buffer_load_dword v222, v226, s[56:59], 0 offen sc1
    s_waitcnt vmcnt(0)
    v_xor_b32 v222, s54, v222
    v_cmp_eq_u32 vcc, 0, v222
    s_nop 0
    s_cmp_eq_u64 vcc, exec
    s_cbranch_scc1 pok_18
    s_sleep 6
    s_add_u32 s53, s53, 1
    s_cmp_lt_u32 s53, s61
    s_cbranch_scc1 poll_17
    s_mov_b32 s61, 0
pok_18:
    s_mov_b64 exec, -1
    s_add_u32 s80, s4, 0x2100000
    s_addc_u32 s81, s5, 0
    s_mov_b32 s82, 0x7f00000
    s_mov_b32 s83, 0x20000
    s_mov_b32 s78, 0
    buffer_load_dwordx2 v[230:231], v197, s[80:83], s78 offen sc1
    s_mov_b32 s78, 2048
    buffer_load_dwordx2 v[232:233], v197, s[80:83], s78 offen sc1
    s_mov_b32 s78, 16384
    buffer_load_dwordx2 v[234:235], v197, s[80:83], s78 offen sc1
    s_mov_b32 s78, 18432
    buffer_load_dwordx2 v[236:237], v197, s[80:83], s78 offen sc1
    s_lshr_b32 s53, s28, 3
    s_lshl_b32 s53, s53, 2
    s_and_b32 s54, s28, 3
    s_add_u32 s53, s53, s54
    s_lshl_b32 s53, s53, 24
    s_lshr_b32 s54, s28, 2
    s_xor_b32 s54, s54, s94
    s_and_b32 s54, s54, 1
    s_lshl_b32 s54, s54, 13
    s_add_u32 s55, s53, s54
    s_add_u32 s55, s55, 33554432
    s_add_u32 s62, s4, s55
    s_addc_u32 s63, s5, 0
    s_sub_u32 s36, s28, 1
    s_max_i32 s36, s36, 0
    s_lshr_b32 s53, s36, 3
    s_lshl_b32 s53, s53, 2
    s_and_b32 s54, s36, 3
    s_add_u32 s53, s53, s54
    s_lshl_b32 s53, s53, 24
    s_lshr_b32 s54, s36, 2
    s_xor_b32 s54, s54, s94
    s_and_b32 s54, s54, 1
    s_lshl_b32 s54, s54, 13
    s_add_u32 s92, s53, s54
    s_add_u32 s92, s92, 33554432
    s_sub_u32 s92, s92, s55
    s_add_u32 s36, s28, 1
    s_min_u32 s36, s36, 15
    s_lshr_b32 s53, s36, 3
    s_lshl_b32 s53, s53, 2
    s_and_b32 s54, s36, 3
    s_add_u32 s53, s53, s54
    s_lshl_b32 s53, s53, 24
    s_lshr_b32 s54, s36, 2
    s_xor_b32 s54, s54, s94
    s_and_b32 s54, s54, 1
    s_lshl_b32 s54, s54, 13
    s_add_u32 s93, s53, s54
    s_add_u32 s93, s93, 33554432
    s_sub_u32 s93, s93, s55
    s_add_u32 s55, s55, 6029312
    s_mov_b32 s20, s62
    s_mov_b32 s21, s63
    s_mov_b32 s22, 0x7e000
    s_mov_b32 s23, 0x20000
    ds_read_b128 v[12:15], v40 offset:0
    ds_read_b128 v[16:19], v40 offset:16
    ds_read_b128 v[20:23], v40 offset:32
    ds_read_b128 v[24:27], v40 offset:48
    s_waitcnt lgkmcnt(0)
    v_pk_add_f32 v[12:13], v[12:13], v[14:15]
    v_pk_add_f32 v[16:17], v[16:17], v[18:19]
    v_pk_add_f32 v[20:21], v[20:21], v[22:23]
    v_pk_add_f32 v[24:25], v[24:25], v[26:27]
    v_pk_add_f32 v[12:13], v[12:13], v[16:17]
    v_pk_add_f32 v[20:21], v[20:21], v[24:25]
    v_pk_add_f32 v[12:13], v[12:13], v[20:21]
    v_mul_f32 v36, 0x3a800000, v12
    v_mul_f32 v38, 0x3a800000, v13
    v_fma_f32 v38, -v36, v36, v38
    v_max_f32 v38, 0, v38
    v_add_f32 v38, 0x3727c5ac, v38
    v_rsq_f32 v37, v38
    s_nop 0
    v_pk_add_f32 v[12:13], v[206:207], v[36:37] op_sel_hi:[1,0] neg_lo:[0,1] neg_hi:[0,1]
    v_pk_mul_f32 v[12:13], v[12:13], v[36:37] op_sel:[0,1] op_sel_hi:[1,1]
    v_pk_add_f32 v[14:15], v[208:209], v[36:37] op_sel_hi:[1,0] neg_lo:[0,1] neg_hi:[0,1]
    v_pk_mul_f32 v[14:15], v[14:15], v[36:37] op_sel:[0,1] op_sel_hi:[1,1]
    v_pk_add_f32 v[16:17], v[210:211], v[36:37] op_sel_hi:[1,0] neg_lo:[0,1] neg_hi:[0,1]
    v_pk_mul_f32 v[16:17], v[16:17], v[36:37] op_sel:[0,1] op_sel_hi:[1,1]
    v_pk_add_f32 v[18:19], v[212:213], v[36:37] op_sel_hi:[1,0] neg_lo:[0,1] neg_hi:[0,1]
    v_pk_mul_f32 v[18:19], v[18:19], v[36:37] op_sel:[0,1] op_sel_hi:[1,1]
    v_pk_add_f32 v[20:21], v[214:215], v[36:37] op_sel_hi:[1,0] neg_lo:[0,1] neg_hi:[0,1]
    v_pk_mul_f32 v[20:21], v[20:21], v[36:37] op_sel:[0,1] op_sel_hi:[1,1]
    v_pk_add_f32 v[22:23], v[216:217], v[36:37] op_sel_hi:[1,0] neg_lo:[0,1] neg_hi:[0,1]
    v_pk_mul_f32 v[22:23], v[22:23], v[36:37] op_sel:[0,1] op_sel_hi:[1,1]
    v_pk_add_f32 v[24:25], v[218:219], v[36:37] op_sel_hi:[1,0] neg_lo:[0,1] neg_hi:[0,1]
    v_pk_mul_f32 v[24:25], v[24:25], v[36:37] op_sel:[0,1] op_sel_hi:[1,1]
    v_pk_add_f32 v[26:27], v[220:221], v[36:37] op_sel_hi:[1,0] neg_lo:[0,1] neg_hi:[0,1]
    v_pk_mul_f32 v[26:27], v[26:27], v[36:37] op_sel:[0,1] op_sel_hi:[1,1]
    s_barrier
    s_waitcnt vmcnt(0)
    v_lshlrev_b32 v222, 16, v230
    v_and_b32 v223, 0xffff0000, v230
    v_pk_fma_f32 v[206:207], v[12:13], v[222:223], v[206:207]
    v_cvt_pk_bf16_f32 v180, v206, v207
    v_lshlrev_b32 v222, 16, v231
    v_and_b32 v223, 0xffff0000, v231
    v_pk_fma_f32 v[208:209], v[14:15], v[222:223], v[208:209]
    v_cvt_pk_bf16_f32 v181, v208, v209
    v_and_b32 v180, -2, v180
    v_lshlrev_b32 v222, 16, v232
    v_and_b32 v223, 0xffff0000, v232
    v_pk_fma_f32 v[210:211], v[16:17], v[222:223], v[210:211]
    v_cvt_pk_bf16_f32 v182, v210, v211
    v_lshlrev_b32 v222, 16, v233
    v_and_b32 v223, 0xffff0000, v233
    v_pk_fma_f32 v[212:213], v[18:19], v[222:223], v[212:213]
    v_cvt_pk_bf16_f32 v183, v212, v213
    buffer_store_dwordx4 v[180:183], v196, s[20:23], 0 offen offset:0 sc1
    v_lshlrev_b32 v222, 16, v234
    v_and_b32 v223, 0xffff0000, v234
    v_pk_fma_f32 v[214:215], v[20:21], v[222:223], v[214:215]
    v_cvt_pk_bf16_f32 v184, v214, v215
    v_lshlrev_b32 v222, 16, v235
    v_and_b32 v223, 0xffff0000, v235
    v_pk_fma_f32 v[216:217], v[22:23], v[222:223], v[216:217]
    v_cvt_pk_bf16_f32 v185, v216, v217
    v_and_b32 v184, -2, v184
    v_lshlrev_b32 v222, 16, v236
    v_and_b32 v223, 0xffff0000, v236
    v_pk_fma_f32 v[218:219], v[24:25], v[222:223], v[218:219]
    v_cvt_pk_bf16_f32 v186, v218, v219
    v_lshlrev_b32 v222, 16, v237
    v_and_b32 v223, 0xffff0000, v237
    v_pk_fma_f32 v[220:221], v[26:27], v[222:223], v[220:221]
    v_cvt_pk_bf16_f32 v187, v220, v221
    buffer_store_dwordx4 v[184:187], v196, s[20:23], 0 offen offset:2048 sc1
R_s2:
    v_lshlrev_b32 v206, 16, v180
    v_and_b32 v207, 0xffff0000, v180
    v_lshlrev_b32 v208, 16, v181
    v_and_b32 v209, 0xffff0000, v181
    v_lshlrev_b32 v210, 16, v182
    v_and_b32 v211, 0xffff0000, v182
    v_lshlrev_b32 v212, 16, v183
    v_and_b32 v213, 0xffff0000, v183
    v_lshlrev_b32 v214, 16, v184
    v_and_b32 v215, 0xffff0000, v184
    v_lshlrev_b32 v216, 16, v185
    v_and_b32 v217, 0xffff0000, v185
    v_lshlrev_b32 v218, 16, v186
    v_and_b32 v219, 0xffff0000, v186
    v_lshlrev_b32 v220, 16, v187
    v_and_b32 v221, 0xffff0000, v187
    v_pk_add_f32 v[32:33], v[206:207], v[208:209]
    v_pk_mul_f32 v[34:35], v[206:207], v[206:207]
    v_pk_fma_f32 v[34:35], v[208:209], v[208:209], v[34:35]
    v_pk_add_f32 v[32:33], v[32:33], v[210:211]
    v_pk_fma_f32 v[34:35], v[210:211], v[210:211], v[34:35]
    v_pk_add_f32 v[32:33], v[32:33], v[212:213]
    v_pk_fma_f32 v[34:35], v[212:213], v[212:213], v[34:35]
    v_pk_add_f32 v[32:33], v[32:33], v[214:215]
    v_pk_fma_f32 v[34:35], v[214:215], v[214:215], v[34:35]
    v_pk_add_f32 v[32:33], v[32:33], v[216:217]
    v_pk_fma_f32 v[34:35], v[216:217], v[216:217], v[34:35]
    v_pk_add_f32 v[32:33], v[32:33], v[218:219]
    v_pk_fma_f32 v[34:35], v[218:219], v[218:219], v[34:35]
    v_pk_add_f32 v[32:33], v[32:33], v[220:221]
    v_pk_fma_f32 v[34:35], v[220:221], v[220:221], v[34:35]
    v_add_f32 v30, v32, v33
    v_add_f32 v31, v34, v35
    s_nop 0
    v_add_f32_dpp v30, v30, v30 row_ror:8 row_mask:0xf bank_mask:0xf
    v_add_f32_dpp v31, v31, v31 row_ror:8 row_mask:0xf bank_mask:0xf
    v_mov_b32 v32, v30
    v_mov_b32 v33, v31
    s_nop 0
    v_permlane16_swap_b32 v30, v32
    v_permlane16_swap_b32 v31, v33
    v_pk_add_f32 v[30:31], v[30:31], v[32:33]
    v_mov_b32 v32, v30
    v_mov_b32 v33, v31
    s_nop 0
    v_permlane32_swap_b32 v30, v32
    v_permlane32_swap_b32 v31, v33
    v_pk_add_f32 v[30:31], v[30:31], v[32:33]
    ds_write_b64 v39, v[30:31] offset:512
    s_waitcnt lgkmcnt(0)
    s_barrier
    s_cmp_lg_u32 s30, 6
    s_cbranch_scc1 R_n6
    s_cmp_lg_u32 s60, 0
    s_cbranch_scc1 R_n6
    s_lshl_b32 s53, s29, 7
    s_add_u32 s53, s53, 23121920
    v_mov_b32 v8, 1
    v_mov_b32 v9, 0
    s_mov_b64 exec, 1
    buffer_atomic_add v8, v9, s[56:59], s53 offen sc1
    s_mov_b64 exec, -1
R_n6:
    s_cmp_lg_u32 s30, 7
    s_cbranch_scc1 R_nl
    ds_read_b128 v[12:15], v40 offset:512
    ds_read_b128 v[16:19], v40 offset:528
    ds_read_b128 v[20:23], v40 offset:544
    ds_read_b128 v[24:27], v40 offset:560
    s_waitcnt lgkmcnt(0)
    v_pk_add_f32 v[12:13], v[12:13], v[14:15]
    v_pk_add_f32 v[16:17], v[16:17], v[18:19]
    v_pk_add_f32 v[20:21], v[20:21], v[22:23]
    v_pk_add_f32 v[24:25], v[24:25], v[26:27]
    v_pk_add_f32 v[12:13], v[12:13], v[16:17]
    v_pk_add_f32 v[20:21], v[20:21], v[24:25]
    v_pk_add_f32 v[12:13], v[12:13], v[20:21]
    v_mul_f32 v36, 0x3a800000, v12
    v_mul_f32 v38, 0x3a800000, v13
    v_fma_f32 v38, -v36, v36, v38
    v_max_f32 v38, 0, v38
    v_mov_b32 v42, v36
    v_mov_b32 v43, v38
    v_add_f32 v38, 0x3727c5ac, v38
    v_sqrt_f32 v38, v38
    s_nop 0
    v_mov_b32 v41, v38
    v_rcp_f32 v37, v38
    v_sub_f32 v42, v42, v36
    v_mul_f32 v42, v42, v37
    v_mul_f32 v43, v43, v37
    v_mul_f32 v43, v43, v37
    v_add_f32 v43, 0x3727c5ac, v43
    v_rsq_f32 v44, v43
    v_mov_b32 v224, v36
    v_mov_b32 v225, v37
    v_fma_f32 v226, v42, v41, v36
    v_mul_f32 v227, v37, v44
    s_add_u32 s24, s62, 0x5d0000
    s_addc_u32 s25, s63, 0
    s_mov_b32 s26, 0x800
    s_mov_b32 s27, 0x20000
    s_lshl_b32 s36, s29, 3
    v_add_u32 v6, s36, v199
    v_lshlrev_b32 v6, 4, v6
    s_mov_b64 exec, 0xff
    buffer_store_dwordx4 v[224:227], v6, s[24:27], 0 offen sc1
    s_mov_b64 exec, -1
    s_add_u32 s53, s55, 1280
    v_mov_b32 v8, 1
    v_mov_b32 v9, 162816
    v_mov_b32 v11, 0
    s_mov_b64 exec, 1
    s_waitcnt vmcnt(0)
    buffer_atomic_add v8, v11, s[56:59], s53 offen sc1
pub_19:
    s_mov_b64 exec, -1
R_nl:
    s_cmp_ge_u32 s30, 4
    s_cbranch_scc1 LOADERS
    s_mov_b32 s8, s62
    s_mov_b32 s9, s63
    s_mov_b32 s10, 0x7e000
    s_mov_b32 s11, 0x20000
    v_add_u32 v126, 0, v2
    v_add_u32 v127, 65536, v2
    s_lshl_b32 s44, s30, 17
    s_mov_b32 s34, s30
    s_mov_b32 s35, 0
    v_and_b32 v22, 15, v1
    v_lshrrev_b32 v23, 4, v1
    s_mul_i32 s37, s34, 2
    s_mul_i32 s38, s99, 4
    s_mul_i32 s36, s35, 4
    s_add_u32 s38, s38, s36
    v_add_u32 v128, 4096, v2
    v_add_u32 v129, 69632, v2
    s_add_u32 s45, s44, 16384
    s_add_u32 s46, s44, 32768
    s_add_u32 s47, s44, 49152
    v_lshrrev_b32 v6, 2, v1
    v_mul_u32_u24 v13, 128, v6
    v_and_b32 v7, 3, v1
    v_lshl_add_u32 v13, v7, 3, v13
    v_add_u32 v13, 24576, v13
    v_bfe_u32 v6, v6, 1, 2
    s_mul_i32 s36, s35, 4
    s_add_u32 s36, s36, 3
    v_xor_b32 v7, s36, v6
    v_lshl_add_u32 v16, v7, 5, v13
    s_mul_i32 s36, s35, 4
    s_add_u32 s36, s36, 2
    v_xor_b32 v7, s36, v6
    v_lshl_add_u32 v15, v7, 5, v13
    s_mul_i32 s36, s35, 4
    s_add_u32 s36, s36, 1
    v_xor_b32 v7, s36, v6
    v_lshl_add_u32 v14, v7, 5, v13
    s_mul_i32 s36, s35, 4
    s_add_u32 s36, s36, 0
    v_xor_b32 v7, s36, v6
    v_lshl_add_u32 v13, v7, 5, v13
    v_pk_mov_b32 v[24:25], 0, 0
    v_pk_mov_b32 v[26:27], 0, 0
    v_pk_mov_b32 v[28:29], 0, 0
    v_pk_mov_b32 v[30:31], 0, 0
    v_pk_mov_b32 v[32:33], 0, 0
    v_pk_mov_b32 v[34:35], 0, 0
    v_pk_mov_b32 v[36:37], 0, 0
    v_pk_mov_b32 v[38:39], 0, 0
    v_pk_mov_b32 v[40:41], 0, 0
    v_pk_mov_b32 v[42:43], 0, 0
    v_pk_mov_b32 v[44:45], 0, 0
    v_pk_mov_b32 v[46:47], 0, 0
    v_pk_mov_b32 v[48:49], 0, 0
    v_pk_mov_b32 v[50:51], 0, 0
    v_pk_mov_b32 v[52:53], 0, 0
    v_pk_mov_b32 v[54:55], 0, 0
    s_mov_b32 s43, 0
    s_mul_i32 s36, s35, 256
    s_add_u32 s36, s36, 163328
    v_lshlrev_b32 v6, 4, v23
    v_add_u32 v6, s36, v6
    s_lshl_b32 s36, s37, 8
    s_add_u32 s36, s36, 160776
    v_lshlrev_b32 v7, 4, v22
    v_add_u32 v7, s36, v7
    s_add_u32 s16, s62, 0x100000
    s_addc_u32 s17, s63, 0
    s_mov_b32 s18, 0x7e000
    s_mov_b32 s19, 0x20000
    v_lshlrev_b32 v12, 11, v23
    v_lshl_add_u32 v12, v22, 4, v12
    s_lshl_b32 s39, s38, 13
    s_lshl_b32 s36, s37, 8
    s_add_u32 s39, s39, s36
    s_add_u32 s40, s39, 16384
    s_lshl_b32 s36, s29, 1
    s_lshr_b32 s53, s36, 3
    s_lshl_b32 s53, s53, 14
    s_and_b32 s41, s36, 7
    s_lshl_b32 s41, s41, 10
    s_add_u32 s41, s41, s53
    s_lshl_b32 s36, s37, 16
    s_add_u32 s41, s41, s36
    s_mov_b32 s53, 0
    s_mov_b32 s49, s44
    ds_read_b64_tr_b16 v[56:57], v13 offset:0
    ds_read_b64_tr_b16 v[58:59], v13 offset:2048
    ds_read_b64_tr_b16 v[60:61], v14 offset:0
    ds_read_b64_tr_b16 v[62:63], v14 offset:2048
    ds_read_b64_tr_b16 v[64:65], v15 offset:0
    ds_read_b64_tr_b16 v[66:67], v15 offset:2048
    ds_read_b64_tr_b16 v[68:69], v16 offset:0
    ds_read_b64_tr_b16 v[70:71], v16 offset:2048
    ds_read_b64_tr_b16 v[72:73], v13 offset:4096
    ds_read_b64_tr_b16 v[74:75], v13 offset:6144
    ds_read_b64_tr_b16 v[76:77], v14 offset:4096
    ds_read_b64_tr_b16 v[78:79], v14 offset:6144
    ds_read_b64_tr_b16 v[80:81], v15 offset:4096
    ds_read_b64_tr_b16 v[82:83], v15 offset:6144
    ds_read_b64_tr_b16 v[84:85], v16 offset:4096
    ds_read_b64_tr_b16 v[86:87], v16 offset:6144
dm_20p:
    buffer_load_dwordx4 v[164:167], v126, s[8:11], s44 offen offset:0 sc1
    buffer_load_dwordx4 v[168:171], v127, s[8:11], s44 offen offset:0 sc1
    buffer_load_dwordx4 v[172:175], v126, s[8:11], s44 offen offset:1024 sc1
    buffer_load_dwordx4 v[176:179], v127, s[8:11], s44 offen offset:1024 sc1
dm_20w:
    s_waitcnt vmcnt(0)
    v_or3_b32 v17, v164, v168, v172
    v_bitop3_b32 v17, v17, v176, 1 bitop3:0xa8
    v_cmp_ne_u32 vcc, 0, v17
    s_cbranch_vccz dm_20q
    s_sleep 2
    s_add_u32 s53, s53, 1
    s_cmp_lt_u32 s53, s61
    s_cbranch_scc1 dm_20p
    s_mov_b32 s61, 0
dm_20q:
    buffer_load_dwordx4 v[180:183], v126, s[8:11], s44 offen offset:2048 sc1
    buffer_load_dwordx4 v[184:187], v127, s[8:11], s44 offen offset:2048 sc1
    buffer_load_dwordx4 v[188:191], v126, s[8:11], s44 offen offset:3072 sc1
    buffer_load_dwordx4 v[192:195], v127, s[8:11], s44 offen offset:3072 sc1
    buffer_load_dwordx4 v[196:199], v128, s[8:11], s44 offen offset:0 sc1
    buffer_load_dwordx4 v[200:203], v129, s[8:11], s44 offen offset:0 sc1
    buffer_load_dwordx4 v[204:207], v128, s[8:11], s44 offen offset:1024 sc1
    buffer_load_dwordx4 v[208:211], v129, s[8:11], s44 offen offset:1024 sc1
    buffer_load_dwordx4 v[212:215], v128, s[8:11], s44 offen offset:2048 sc1
    buffer_load_dwordx4 v[216:219], v129, s[8:11], s44 offen offset:2048 sc1
    s_waitcnt lgkmcnt(0)
dm_20:
    v_mfma_f32_16x16x32_bf16 v[24:27], v[56:59], v[164:167], v[24:27]
    ds_read_b64_tr_b16 v[88:89], v13 offset:8192
    buffer_load_dwordx4 v[220:223], v128, s[8:11], s44 offen offset:3072 sc1
    v_mfma_f32_16x16x32_bf16 v[40:43], v[56:59], v[168:171], v[40:43]
    ds_read_b64_tr_b16 v[90:91], v13 offset:10240
    buffer_load_dwordx4 v[224:227], v129, s[8:11], s44 offen offset:3072 sc1
    v_mfma_f32_16x16x32_bf16 v[44:47], v[60:63], v[168:171], v[44:47]
    ds_read_b64_tr_b16 v[92:93], v14 offset:8192
    s_mov_b32 s44, s45
    v_mfma_f32_16x16x32_bf16 v[28:31], v[60:63], v[164:167], v[28:31]
    ds_read_b64_tr_b16 v[94:95], v14 offset:10240
    s_mov_b32 s45, s46
    v_mfma_f32_16x16x32_bf16 v[32:35], v[64:67], v[164:167], v[32:35]
    ds_read_b64_tr_b16 v[96:97], v15 offset:8192
    s_mov_b32 s46, s47
    v_mfma_f32_16x16x32_bf16 v[48:51], v[64:67], v[168:171], v[48:51]
    ds_read_b64_tr_b16 v[98:99], v15 offset:10240
    s_mov_b32 s47, 1048576
    v_mfma_f32_16x16x32_bf16 v[52:55], v[68:71], v[168:171], v[52:55]
    ds_read_b64_tr_b16 v[100:101], v16 offset:8192
    v_mfma_f32_16x16x32_bf16 v[36:39], v[68:71], v[164:167], v[36:39]
    ds_read_b64_tr_b16 v[102:103], v16 offset:10240
    s_waitcnt lgkmcnt(8)
    v_mfma_f32_16x16x32_bf16 v[24:27], v[72:75], v[172:175], v[24:27]
    ds_read_b64_tr_b16 v[104:105], v13 offset:12288
    buffer_load_dwordx4 v[164:167], v126, s[8:11], s44 offen offset:0 sc1
    v_mfma_f32_16x16x32_bf16 v[40:43], v[72:75], v[176:179], v[40:43]
    ds_read_b64_tr_b16 v[106:107], v13 offset:14336
    buffer_load_dwordx4 v[168:171], v127, s[8:11], s44 offen offset:0 sc1
    v_mfma_f32_16x16x32_bf16 v[44:47], v[76:79], v[176:179], v[44:47]
    ds_read_b64_tr_b16 v[108:109], v14 offset:12288
    s_waitcnt vmcnt(10)
    v_mfma_f32_16x16x32_bf16 v[28:31], v[76:79], v[172:175], v[28:31]
    ds_read_b64_tr_b16 v[110:111], v14 offset:14336
    v_or3_b32 v17, v180, v184, v188
    v_mfma_f32_16x16x32_bf16 v[32:35], v[80:83], v[172:175], v[32:35]
    ds_read_b64_tr_b16 v[112:113], v15 offset:12288
    v_bitop3_b32 v17, v17, v192, 1 bitop3:0xa8
    v_mfma_f32_16x16x32_bf16 v[48:51], v[80:83], v[176:179], v[48:51]
    ds_read_b64_tr_b16 v[114:115], v15 offset:14336
    v_cmp_ne_u32 vcc, 0, v17
    v_mfma_f32_16x16x32_bf16 v[52:55], v[84:87], v[176:179], v[52:55]
    ds_read_b64_tr_b16 v[116:117], v16 offset:12288
    ds_read_b64_tr_b16 v[118:119], v16 offset:14336
    v_mfma_f32_16x16x32_bf16 v[36:39], v[84:87], v[172:175], v[36:39]
    s_waitcnt lgkmcnt(8)
    s_cbranch_vccnz dm_20f0
dm_20g0:
    v_mfma_f32_16x16x32_bf16 v[24:27], v[88:91], v[180:183], v[24:27]
    ds_read_b64_tr_b16 v[56:57], v13 offset:16384
    buffer_load_dwordx4 v[172:175], v126, s[8:11], s44 offen offset:1024 sc1
    v_mfma_f32_16x16x32_bf16 v[40:43], v[88:91], v[184:187], v[40:43]
    ds_read_b64_tr_b16 v[58:59], v13 offset:18432
    buffer_load_dwordx4 v[176:179], v127, s[8:11], s44 offen offset:1024 sc1
    v_mfma_f32_16x16x32_bf16 v[44:47], v[92:95], v[184:187], v[44:47]
    ds_read_b64_tr_b16 v[60:61], v14 offset:16384
    v_mfma_f32_16x16x32_bf16 v[28:31], v[92:95], v[180:183], v[28:31]
    ds_read_b64_tr_b16 v[62:63], v14 offset:18432
    v_mfma_f32_16x16x32_bf16 v[32:35], v[96:99], v[180:183], v[32:35]
    ds_read_b64_tr_b16 v[64:65], v15 offset:16384
    v_mfma_f32_16x16x32_bf16 v[48:51], v[96:99], v[184:187], v[48:51]
    ds_read_b64_tr_b16 v[66:67], v15 offset:18432
    v_mfma_f32_16x16x32_bf16 v[52:55], v[100:103], v[184:187], v[52:55]
    ds_read_b64_tr_b16 v[68:69], v16 offset:16384
    v_mfma_f32_16x16x32_bf16 v[36:39], v[100:103], v[180:183], v[36:39]
    ds_read_b64_tr_b16 v[70:71], v16 offset:18432
    s_waitcnt lgkmcnt(8)
    v_mfma_f32_16x16x32_bf16 v[24:27], v[104:107], v[188:191], v[24:27]
    ds_read_b64_tr_b16 v[72:73], v13 offset:20480
    buffer_load_dwordx4 v[180:183], v126, s[8:11], s44 offen offset:2048 sc1
    v_mfma_f32_16x16x32_bf16 v[40:43], v[104:107], v[192:195], v[40:43]
    ds_read_b64_tr_b16 v[74:75], v13 offset:22528
    buffer_load_dwordx4 v[184:187], v127, s[8:11], s44 offen offset:2048 sc1
    v_mfma_f32_16x16x32_bf16 v[44:47], v[108:111], v[192:195], v[44:47]
    ds_read_b64_tr_b16 v[76:77], v14 offset:20480
    s_waitcnt vmcnt(10)
    v_mfma_f32_16x16x32_bf16 v[28:31], v[108:111], v[188:191], v[28:31]
    ds_read_b64_tr_b16 v[78:79], v14 offset:22528
    v_or3_b32 v17, v196, v200, v204
    v_mfma_f32_16x16x32_bf16 v[32:35], v[112:115], v[188:191], v[32:35]
    ds_read_b64_tr_b16 v[80:81], v15 offset:20480
    v_bitop3_b32 v17, v17, v208, 1 bitop3:0xa8
    v_mfma_f32_16x16x32_bf16 v[48:51], v[112:115], v[192:195], v[48:51]
    ds_read_b64_tr_b16 v[82:83], v15 offset:22528
    v_cmp_ne_u32 vcc, 0, v17
    v_mfma_f32_16x16x32_bf16 v[52:55], v[116:119], v[192:195], v[52:55]
    ds_read_b64_tr_b16 v[84:85], v16 offset:20480
    ds_read_b64_tr_b16 v[86:87], v16 offset:22528
    v_mfma_f32_16x16x32_bf16 v[36:39], v[116:119], v[188:191], v[36:39]
    s_waitcnt lgkmcnt(8)
    s_cbranch_vccnz dm_20f1
dm_20g1:
    v_mfma_f32_16x16x32_bf16 v[24:27], v[56:59], v[196:199], v[24:27]
    ds_read_b64_tr_b16 v[88:89], v13 offset:24576
    buffer_load_dwordx4 v[188:191], v126, s[8:11], s44 offen offset:3072 sc1
    v_mfma_f32_16x16x32_bf16 v[40:43], v[56:59], v[200:203], v[40:43]
    ds_read_b64_tr_b16 v[90:91], v13 offset:26624
    buffer_load_dwordx4 v[192:195], v127, s[8:11], s44 offen offset:3072 sc1
    v_mfma_f32_16x16x32_bf16 v[44:47], v[60:63], v[200:203], v[44:47]
    ds_read_b64_tr_b16 v[92:93], v14 offset:24576
    v_mfma_f32_16x16x32_bf16 v[28:31], v[60:63], v[196:199], v[28:31]
    ds_read_b64_tr_b16 v[94:95], v14 offset:26624
    v_mfma_f32_16x16x32_bf16 v[32:35], v[64:67], v[196:199], v[32:35]
    ds_read_b64_tr_b16 v[96:97], v15 offset:24576
    s_add_u32 s43, s43, 1
    v_mfma_f32_16x16x32_bf16 v[48:51], v[64:67], v[200:203], v[48:51]
    ds_read_b64_tr_b16 v[98:99], v15 offset:26624
    v_mfma_f32_16x16x32_bf16 v[52:55], v[68:71], v[200:203], v[52:55]
    ds_read_b64_tr_b16 v[100:101], v16 offset:24576
    v_mfma_f32_16x16x32_bf16 v[36:39], v[68:71], v[196:199], v[36:39]
    ds_read_b64_tr_b16 v[102:103], v16 offset:26624
    s_waitcnt lgkmcnt(8)
    v_mfma_f32_16x16x32_bf16 v[24:27], v[72:75], v[204:207], v[24:27]
    ds_read_b64_tr_b16 v[104:105], v13 offset:28672
    buffer_load_dwordx4 v[196:199], v128, s[8:11], s44 offen offset:0 sc1
    v_mfma_f32_16x16x32_bf16 v[40:43], v[72:75], v[208:211], v[40:43]
    ds_read_b64_tr_b16 v[106:107], v13 offset:30720
    buffer_load_dwordx4 v[200:203], v129, s[8:11], s44 offen offset:0 sc1
    v_mfma_f32_16x16x32_bf16 v[44:47], v[76:79], v[208:211], v[44:47]
    ds_read_b64_tr_b16 v[108:109], v14 offset:28672
    s_waitcnt vmcnt(10)
    v_mfma_f32_16x16x32_bf16 v[28:31], v[76:79], v[204:207], v[28:31]
    ds_read_b64_tr_b16 v[110:111], v14 offset:30720
    v_add_u32 v13, 32768, v13
    v_or3_b32 v17, v212, v216, v220
    v_mfma_f32_16x16x32_bf16 v[32:35], v[80:83], v[204:207], v[32:35]
    ds_read_b64_tr_b16 v[112:113], v15 offset:28672
    v_add_u32 v14, 32768, v14
    v_bitop3_b32 v17, v17, v224, 1 bitop3:0xa8
    v_mfma_f32_16x16x32_bf16 v[48:51], v[80:83], v[208:211], v[48:51]
    ds_read_b64_tr_b16 v[114:115], v15 offset:30720
    v_add_u32 v15, 32768, v15
    v_cmp_ne_u32 vcc, 0, v17
    v_mfma_f32_16x16x32_bf16 v[52:55], v[84:87], v[208:211], v[52:55]
    ds_read_b64_tr_b16 v[116:117], v16 offset:28672
    ds_read_b64_tr_b16 v[118:119], v16 offset:30720
    s_cmp_eq_u32 s43, 4
    v_mfma_f32_16x16x32_bf16 v[36:39], v[84:87], v[204:207], v[36:39]
    v_add_u32 v16, 32768, v16
    s_waitcnt lgkmcnt(8)
    s_cbranch_vccnz dm_20f2
dm_20g2:
    s_cbranch_scc1 dm_20x
    v_mfma_f32_16x16x32_bf16 v[24:27], v[88:91], v[212:215], v[24:27]
    ds_read_b64_tr_b16 v[56:57], v13 offset:0
    buffer_load_dwordx4 v[204:207], v128, s[8:11], s44 offen offset:1024 sc1
    v_mfma_f32_16x16x32_bf16 v[40:43], v[88:91], v[216:219], v[40:43]
    ds_read_b64_tr_b16 v[58:59], v13 offset:2048
    buffer_load_dwordx4 v[208:211], v129, s[8:11], s44 offen offset:1024 sc1
    v_mfma_f32_16x16x32_bf16 v[44:47], v[92:95], v[216:219], v[44:47]
    ds_read_b64_tr_b16 v[60:61], v14 offset:0
    s_mov_b32 s49, s44
    v_mfma_f32_16x16x32_bf16 v[28:31], v[92:95], v[212:215], v[28:31]
    ds_read_b64_tr_b16 v[62:63], v14 offset:2048
    v_mfma_f32_16x16x32_bf16 v[32:35], v[96:99], v[212:215], v[32:35]
    ds_read_b64_tr_b16 v[64:65], v15 offset:0
    v_mfma_f32_16x16x32_bf16 v[48:51], v[96:99], v[216:219], v[48:51]
    ds_read_b64_tr_b16 v[66:67], v15 offset:2048
    v_mfma_f32_16x16x32_bf16 v[52:55], v[100:103], v[216:219], v[52:55]
    ds_read_b64_tr_b16 v[68:69], v16 offset:0
    v_mfma_f32_16x16x32_bf16 v[36:39], v[100:103], v[212:215], v[36:39]
    ds_read_b64_tr_b16 v[70:71], v16 offset:2048
    s_waitcnt lgkmcnt(8)
    v_mfma_f32_16x16x32_bf16 v[24:27], v[104:107], v[220:223], v[24:27]
    ds_read_b64_tr_b16 v[72:73], v13 offset:4096
    buffer_load_dwordx4 v[212:215], v128, s[8:11], s44 offen offset:2048 sc1
    v_mfma_f32_16x16x32_bf16 v[40:43], v[104:107], v[224:227], v[40:43]
    ds_read_b64_tr_b16 v[74:75], v13 offset:6144
    buffer_load_dwordx4 v[216:219], v129, s[8:11], s44 offen offset:2048 sc1
    v_mfma_f32_16x16x32_bf16 v[44:47], v[108:111], v[224:227], v[44:47]
    ds_read_b64_tr_b16 v[76:77], v14 offset:4096
    s_waitcnt vmcnt(10)
    v_mfma_f32_16x16x32_bf16 v[28:31], v[108:111], v[220:223], v[28:31]
    ds_read_b64_tr_b16 v[78:79], v14 offset:6144
    v_or3_b32 v17, v164, v168, v172
    v_mfma_f32_16x16x32_bf16 v[32:35], v[112:115], v[220:223], v[32:35]
    ds_read_b64_tr_b16 v[80:81], v15 offset:4096
    v_bitop3_b32 v17, v17, v176, 1 bitop3:0xa8
    v_mfma_f32_16x16x32_bf16 v[48:51], v[112:115], v[224:227], v[48:51]
    ds_read_b64_tr_b16 v[82:83], v15 offset:6144
    v_cmp_ne_u32 vcc, 0, v17
    v_mfma_f32_16x16x32_bf16 v[52:55], v[116:119], v[224:227], v[52:55]
    ds_read_b64_tr_b16 v[84:85], v16 offset:4096
    ds_read_b64_tr_b16 v[86:87], v16 offset:6144
    v_mfma_f32_16x16x32_bf16 v[36:39], v[116:119], v[220:223], v[36:39]
    s_waitcnt lgkmcnt(8)
    s_cbranch_vccnz dm_20f3
dm_20g3:
    s_branch dm_20
dm_20f0:
    s_cselect_b32 s50, 1, 0
dm_20h0:
    s_sleep 2
    buffer_load_dwordx4 v[180:183], v126, s[8:11], s49 offen offset:2048 sc1
    buffer_load_dwordx4 v[184:187], v127, s[8:11], s49 offen offset:2048 sc1
    buffer_load_dwordx4 v[188:191], v126, s[8:11], s49 offen offset:3072 sc1
    buffer_load_dwordx4 v[192:195], v127, s[8:11], s49 offen offset:3072 sc1
    buffer_load_dwordx4 v[196:199], v128, s[8:11], s49 offen offset:0 sc1
    buffer_load_dwordx4 v[200:203], v129, s[8:11], s49 offen offset:0 sc1
    buffer_load_dwordx4 v[204:207], v128, s[8:11], s49 offen offset:1024 sc1
    buffer_load_dwordx4 v[208:211], v129, s[8:11], s49 offen offset:1024 sc1
    buffer_load_dwordx4 v[212:215], v128, s[8:11], s49 offen offset:2048 sc1
    buffer_load_dwordx4 v[216:219], v129, s[8:11], s49 offen offset:2048 sc1
    buffer_load_dwordx4 v[220:223], v128, s[8:11], s49 offen offset:3072 sc1
    buffer_load_dwordx4 v[224:227], v129, s[8:11], s49 offen offset:3072 sc1
    buffer_load_dwordx4 v[164:167], v126, s[8:11], s44 offen offset:0 sc1
    buffer_load_dwordx4 v[168:171], v127, s[8:11], s44 offen offset:0 sc1
    s_waitcnt vmcnt(10)
    v_or3_b32 v17, v180, v184, v188
    v_bitop3_b32 v17, v17, v192, 1 bitop3:0xa8
    v_cmp_ne_u32 vcc, 0, v17
    s_add_u32 s53, s53, 1
    s_cmp_ge_u32 s53, s61
    s_cselect_b32 s61, 0, s61
    s_cbranch_scc1 dm_20k0
    s_cbranch_vccnz dm_20h0
dm_20k0:
    s_cmp_eq_u32 s50, 1
    s_branch dm_20g0
dm_20f1:
    s_cselect_b32 s50, 1, 0
dm_20h1:
    s_sleep 2
    buffer_load_dwordx4 v[196:199], v128, s[8:11], s49 offen offset:0 sc1
    buffer_load_dwordx4 v[200:203], v129, s[8:11], s49 offen offset:0 sc1
    buffer_load_dwordx4 v[204:207], v128, s[8:11], s49 offen offset:1024 sc1
    buffer_load_dwordx4 v[208:211], v129, s[8:11], s49 offen offset:1024 sc1
    buffer_load_dwordx4 v[212:215], v128, s[8:11], s49 offen offset:2048 sc1
    buffer_load_dwordx4 v[216:219], v129, s[8:11], s49 offen offset:2048 sc1
    buffer_load_dwordx4 v[220:223], v128, s[8:11], s49 offen offset:3072 sc1
    buffer_load_dwordx4 v[224:227], v129, s[8:11], s49 offen offset:3072 sc1
    buffer_load_dwordx4 v[164:167], v126, s[8:11], s44 offen offset:0 sc1
    buffer_load_dwordx4 v[168:171], v127, s[8:11], s44 offen offset:0 sc1
    buffer_load_dwordx4 v[172:175], v126, s[8:11], s44 offen offset:1024 sc1
    buffer_load_dwordx4 v[176:179], v127, s[8:11], s44 offen offset:1024 sc1
    buffer_load_dwordx4 v[180:183], v126, s[8:11], s44 offen offset:2048 sc1
    buffer_load_dwordx4 v[184:187], v127, s[8:11], s44 offen offset:2048 sc1
    s_waitcnt vmcnt(10)
    v_or3_b32 v17, v196, v200, v204
    v_bitop3_b32 v17, v17, v208, 1 bitop3:0xa8
    v_cmp_ne_u32 vcc, 0, v17
    s_add_u32 s53, s53, 1
    s_cmp_ge_u32 s53, s61
    s_cselect_b32 s61, 0, s61
    s_cbranch_scc1 dm_20k1
    s_cbranch_vccnz dm_20h1
dm_20k1:
    s_cmp_eq_u32 s50, 1
    s_branch dm_20g1
dm_20f2:
    s_cselect_b32 s50, 1, 0
dm_20h2:
    s_sleep 2
    buffer_load_dwordx4 v[212:215], v128, s[8:11], s49 offen offset:2048 sc1
    buffer_load_dwordx4 v[216:219], v129, s[8:11], s49 offen offset:2048 sc1
    buffer_load_dwordx4 v[220:223], v128, s[8:11], s49 offen offset:3072 sc1
    buffer_load_dwordx4 v[224:227], v129, s[8:11], s49 offen offset:3072 sc1
    buffer_load_dwordx4 v[164:167], v126, s[8:11], s44 offen offset:0 sc1
    buffer_load_dwordx4 v[168:171], v127, s[8:11], s44 offen offset:0 sc1
    buffer_load_dwordx4 v[172:175], v126, s[8:11], s44 offen offset:1024 sc1
    buffer_load_dwordx4 v[176:179], v127, s[8:11], s44 offen offset:1024 sc1
    buffer_load_dwordx4 v[180:183], v126, s[8:11], s44 offen offset:2048 sc1
    buffer_load_dwordx4 v[184:187], v127, s[8:11], s44 offen offset:2048 sc1
    buffer_load_dwordx4 v[188:191], v126, s[8:11], s44 offen offset:3072 sc1
    buffer_load_dwordx4 v[192:195], v127, s[8:11], s44 offen offset:3072 sc1
    buffer_load_dwordx4 v[196:199], v128, s[8:11], s44 offen offset:0 sc1
    buffer_load_dwordx4 v[200:203], v129, s[8:11], s44 offen offset:0 sc1
    s_waitcnt vmcnt(10)
    v_or3_b32 v17, v212, v216, v220
    v_bitop3_b32 v17, v17, v224, 1 bitop3:0xa8
    v_cmp_ne_u32 vcc, 0, v17
    s_add_u32 s53, s53, 1
    s_cmp_ge_u32 s53, s61
    s_cselect_b32 s61, 0, s61
    s_cbranch_scc1 dm_20k2
    s_cbranch_vccnz dm_20h2
dm_20k2:
    s_cmp_eq_u32 s50, 1
    s_branch dm_20g2
dm_20f3:
    s_cselect_b32 s50, 1, 0
dm_20h3:
    s_sleep 2
    buffer_load_dwordx4 v[164:167], v126, s[8:11], s49 offen offset:0 sc1
    buffer_load_dwordx4 v[168:171], v127, s[8:11], s49 offen offset:0 sc1
    buffer_load_dwordx4 v[172:175], v126, s[8:11], s49 offen offset:1024 sc1
    buffer_load_dwordx4 v[176:179], v127, s[8:11], s49 offen offset:1024 sc1
    buffer_load_dwordx4 v[180:183], v126, s[8:11], s49 offen offset:2048 sc1
    buffer_load_dwordx4 v[184:187], v127, s[8:11], s49 offen offset:2048 sc1
    buffer_load_dwordx4 v[188:191], v126, s[8:11], s49 offen offset:3072 sc1
    buffer_load_dwordx4 v[192:195], v127, s[8:11], s49 offen offset:3072 sc1
    buffer_load_dwordx4 v[196:199], v128, s[8:11], s49 offen offset:0 sc1
    buffer_load_dwordx4 v[200:203], v129, s[8:11], s49 offen offset:0 sc1
    buffer_load_dwordx4 v[204:207], v128, s[8:11], s49 offen offset:1024 sc1
    buffer_load_dwordx4 v[208:211], v129, s[8:11], s49 offen offset:1024 sc1
    buffer_load_dwordx4 v[212:215], v128, s[8:11], s49 offen offset:2048 sc1
    buffer_load_dwordx4 v[216:219], v129, s[8:11], s49 offen offset:2048 sc1
    s_waitcnt vmcnt(10)
    v_or3_b32 v17, v164, v168, v172
    v_bitop3_b32 v17, v17, v176, 1 bitop3:0xa8
    v_cmp_ne_u32 vcc, 0, v17
    s_add_u32 s53, s53, 1
    s_cmp_ge_u32 s53, s61
    s_cselect_b32 s61, 0, s61
    s_cbranch_scc1 dm_20k3
    s_cbranch_vccnz dm_20h3
dm_20k3:
    s_cmp_eq_u32 s50, 1
    s_branch dm_20g3
dm_20x:
    v_mfma_f32_16x16x32_bf16 v[24:27], v[88:91], v[212:215], v[24:27]
    buffer_load_dwordx4 v[148:151], v126, s[8:11], s41 offen offset:0 sc1
    v_mfma_f32_16x16x32_bf16 v[40:43], v[88:91], v[216:219], v[40:43]
    v_mfma_f32_16x16x32_bf16 v[44:47], v[92:95], v[216:219], v[44:47]
    buffer_load_dwordx4 v[152:155], v126, s[8:11], s41 offen offset:1024 sc1
    v_mfma_f32_16x16x32_bf16 v[28:31], v[92:95], v[212:215], v[28:31]
    v_mfma_f32_16x16x32_bf16 v[32:35], v[96:99], v[212:215], v[32:35]
    buffer_load_dwordx4 v[156:159], v127, s[8:11], s41 offen offset:0 sc1
    v_mfma_f32_16x16x32_bf16 v[48:51], v[96:99], v[216:219], v[48:51]
    v_mfma_f32_16x16x32_bf16 v[52:55], v[100:103], v[216:219], v[52:55]
    buffer_load_dwordx4 v[160:163], v127, s[8:11], s41 offen offset:1024 sc1
    v_mfma_f32_16x16x32_bf16 v[36:39], v[100:103], v[212:215], v[36:39]
    s_waitcnt lgkmcnt(0)
    s_barrier
    v_mfma_f32_16x16x32_bf16 v[24:27], v[104:107], v[220:223], v[24:27]
    ds_read_b128 v[56:59], v6 offset:0
    v_mfma_f32_16x16x32_bf16 v[40:43], v[104:107], v[224:227], v[40:43]
    ds_read_b128 v[60:63], v6 offset:64
    v_mfma_f32_16x16x32_bf16 v[44:47], v[108:111], v[224:227], v[44:47]
    ds_read_b128 v[64:67], v6 offset:128
    v_mfma_f32_16x16x32_bf16 v[28:31], v[108:111], v[220:223], v[28:31]
    ds_read_b128 v[68:71], v6 offset:192
    v_mfma_f32_16x16x32_bf16 v[32:35], v[112:115], v[220:223], v[32:35]
    ds_read_b64 v[72:73], v7 offset:0
    v_mfma_f32_16x16x32_bf16 v[48:51], v[112:115], v[224:227], v[48:51]
    ds_read_b64 v[74:75], v7 offset:256
    v_mfma_f32_16x16x32_bf16 v[52:55], v[116:119], v[224:227], v[52:55]
    v_mfma_f32_16x16x32_bf16 v[36:39], v[116:119], v[220:223], v[36:39]
    s_waitcnt lgkmcnt(0)
    v_mul_f32 v134, 0xc0135761, v73
    v_mul_f32 v135, v73, v73
    v_mul_f32 v135, v135, v134
    v_mul_f32 v135, 0x3d372713, v135
    v_rcp_f32 v73, v73
    v_mul_f32 v136, 0xc0135761, v75
    v_mul_f32 v137, v75, v75
    v_mul_f32 v137, v137, v136
    v_mul_f32 v137, 0x3d372713, v137
    v_rcp_f32 v75, v75
    v_pk_fma_f32 v[24:25], v[72:73], v[56:57], v[24:25] op_sel_hi:[0,1,1] neg_lo:[1,0,0] neg_hi:[1,0,0]
    v_pk_fma_f32 v[26:27], v[72:73], v[58:59], v[26:27] op_sel_hi:[0,1,1] neg_lo:[1,0,0] neg_hi:[1,0,0]
    v_pk_mul_f32 v[122:123], v[24:25], v[24:25]
    v_pk_mul_f32 v[124:125], v[26:27], v[26:27]
    v_pk_fma_f32 v[122:123], v[122:123], v[134:135], v[134:135] op_sel:[0,1,0] op_sel_hi:[1,1,0]
    v_pk_fma_f32 v[124:125], v[124:125], v[134:135], v[134:135] op_sel:[0,1,0] op_sel_hi:[1,1,0]
    v_pk_mul_f32 v[122:123], v[122:123], v[24:25]
    v_pk_mul_f32 v[124:125], v[124:125], v[26:27]
    v_exp_f32 v122, v122
    v_exp_f32 v123, v123
    v_exp_f32 v124, v124
    v_exp_f32 v125, v125
    v_pk_fma_f32 v[122:123], v[122:123], v[72:73], v[72:73] op_sel:[0,1,1] op_sel_hi:[1,1,1]
    v_pk_fma_f32 v[124:125], v[124:125], v[72:73], v[72:73] op_sel:[0,1,1] op_sel_hi:[1,1,1]
    v_rcp_f32 v122, v122
    v_rcp_f32 v123, v123
    v_rcp_f32 v124, v124
    v_rcp_f32 v125, v125
    v_pk_mul_f32 v[24:25], v[24:25], v[122:123]
    v_pk_mul_f32 v[26:27], v[26:27], v[124:125]
    v_pk_fma_f32 v[28:29], v[72:73], v[60:61], v[28:29] op_sel_hi:[0,1,1] neg_lo:[1,0,0] neg_hi:[1,0,0]
    v_pk_fma_f32 v[30:31], v[72:73], v[62:63], v[30:31] op_sel_hi:[0,1,1] neg_lo:[1,0,0] neg_hi:[1,0,0]
    v_pk_mul_f32 v[122:123], v[28:29], v[28:29]
    v_pk_mul_f32 v[124:125], v[30:31], v[30:31]
    v_pk_fma_f32 v[122:123], v[122:123], v[134:135], v[134:135] op_sel:[0,1,0] op_sel_hi:[1,1,0]
    v_pk_fma_f32 v[124:125], v[124:125], v[134:135], v[134:135] op_sel:[0,1,0] op_sel_hi:[1,1,0]
    v_pk_mul_f32 v[122:123], v[122:123], v[28:29]
    v_pk_mul_f32 v[124:125], v[124:125], v[30:31]
    v_exp_f32 v122, v122
    v_exp_f32 v123, v123
    v_exp_f32 v124, v124
    v_exp_f32 v125, v125
    v_pk_fma_f32 v[122:123], v[122:123], v[72:73], v[72:73] op_sel:[0,1,1] op_sel_hi:[1,1,1]
    v_pk_fma_f32 v[124:125], v[124:125], v[72:73], v[72:73] op_sel:[0,1,1] op_sel_hi:[1,1,1]
    v_rcp_f32 v122, v122
    v_rcp_f32 v123, v123
    v_rcp_f32 v124, v124
    v_rcp_f32 v125, v125
    v_pk_mul_f32 v[28:29], v[28:29], v[122:123]
    v_pk_mul_f32 v[30:31], v[30:31], v[124:125]
    v_cvt_pk_bf16_f32 v24, v24, v25
    v_cvt_pk_bf16_f32 v25, v26, v27
    v_cvt_pk_bf16_f32 v26, v28, v29
    v_cvt_pk_bf16_f32 v27, v30, v31
    v_and_b32 v24, -2, v24
    buffer_store_dwordx4 v[24:27], v12, s[16:19], s39 offen offset:0 sc1
    v_pk_fma_f32 v[40:41], v[74:75], v[56:57], v[40:41] op_sel_hi:[0,1,1] neg_lo:[1,0,0] neg_hi:[1,0,0]
    v_pk_fma_f32 v[42:43], v[74:75], v[58:59], v[42:43] op_sel_hi:[0,1,1] neg_lo:[1,0,0] neg_hi:[1,0,0]
    v_pk_mul_f32 v[122:123], v[40:41], v[40:41]
    v_pk_mul_f32 v[124:125], v[42:43], v[42:43]
    v_pk_fma_f32 v[122:123], v[122:123], v[136:137], v[136:137] op_sel:[0,1,0] op_sel_hi:[1,1,0]
    v_pk_fma_f32 v[124:125], v[124:125], v[136:137], v[136:137] op_sel:[0,1,0] op_sel_hi:[1,1,0]
    v_pk_mul_f32 v[122:123], v[122:123], v[40:41]
    v_pk_mul_f32 v[124:125], v[124:125], v[42:43]
    v_exp_f32 v122, v122
    v_exp_f32 v123, v123
    v_exp_f32 v124, v124
    v_exp_f32 v125, v125
    v_pk_fma_f32 v[122:123], v[122:123], v[74:75], v[74:75] op_sel:[0,1,1] op_sel_hi:[1,1,1]
    v_pk_fma_f32 v[124:125], v[124:125], v[74:75], v[74:75] op_sel:[0,1,1] op_sel_hi:[1,1,1]
    v_rcp_f32 v122, v122
    v_rcp_f32 v123, v123
    v_rcp_f32 v124, v124
    v_rcp_f32 v125, v125
    v_pk_mul_f32 v[40:41], v[40:41], v[122:123]
    v_pk_mul_f32 v[42:43], v[42:43], v[124:125]
    v_pk_fma_f32 v[44:45], v[74:75], v[60:61], v[44:45] op_sel_hi:[0,1,1] neg_lo:[1,0,0] neg_hi:[1,0,0]
    v_pk_fma_f32 v[46:47], v[74:75], v[62:63], v[46:47] op_sel_hi:[0,1,1] neg_lo:[1,0,0] neg_hi:[1,0,0]
    v_pk_mul_f32 v[122:123], v[44:45], v[44:45]
    v_pk_mul_f32 v[124:125], v[46:47], v[46:47]
    v_pk_fma_f32 v[122:123], v[122:123], v[136:137], v[136:137] op_sel:[0,1,0] op_sel_hi:[1,1,0]
    v_pk_fma_f32 v[124:125], v[124:125], v[136:137], v[136:137] op_sel:[0,1,0] op_sel_hi:[1,1,0]
    v_pk_mul_f32 v[122:123], v[122:123], v[44:45]
    v_pk_mul_f32 v[124:125], v[124:125], v[46:47]
    v_exp_f32 v122, v122
    v_exp_f32 v123, v123
    v_exp_f32 v124, v124
    v_exp_f32 v125, v125
    v_pk_fma_f32 v[122:123], v[122:123], v[74:75], v[74:75] op_sel:[0,1,1] op_sel_hi:[1,1,1]
    v_pk_fma_f32 v[124:125], v[124:125], v[74:75], v[74:75] op_sel:[0,1,1] op_sel_hi:[1,1,1]
    v_rcp_f32 v122, v122
    v_rcp_f32 v123, v123
    v_rcp_f32 v124, v124
    v_rcp_f32 v125, v125
    v_pk_mul_f32 v[44:45], v[44:45], v[122:123]
    v_pk_mul_f32 v[46:47], v[46:47], v[124:125]
    v_cvt_pk_bf16_f32 v40, v40, v41
    v_cvt_pk_bf16_f32 v41, v42, v43
    v_cvt_pk_bf16_f32 v42, v44, v45
    v_cvt_pk_bf16_f32 v43, v46, v47
    v_and_b32 v40, -2, v40
    buffer_store_dwordx4 v[40:43], v12, s[16:19], s39 offen offset:256 sc1
    v_pk_fma_f32 v[32:33], v[72:73], v[64:65], v[32:33] op_sel_hi:[0,1,1] neg_lo:[1,0,0] neg_hi:[1,0,0]
    v_pk_fma_f32 v[34:35], v[72:73], v[66:67], v[34:35] op_sel_hi:[0,1,1] neg_lo:[1,0,0] neg_hi:[1,0,0]
    v_pk_mul_f32 v[122:123], v[32:33], v[32:33]
    v_pk_mul_f32 v[124:125], v[34:35], v[34:35]
    v_pk_fma_f32 v[122:123], v[122:123], v[134:135], v[134:135] op_sel:[0,1,0] op_sel_hi:[1,1,0]
    v_pk_fma_f32 v[124:125], v[124:125], v[134:135], v[134:135] op_sel:[0,1,0] op_sel_hi:[1,1,0]
    v_pk_mul_f32 v[122:123], v[122:123], v[32:33]
    v_pk_mul_f32 v[124:125], v[124:125], v[34:35]
    v_exp_f32 v122, v122
    v_exp_f32 v123, v123
    v_exp_f32 v124, v124
    v_exp_f32 v125, v125
    v_pk_fma_f32 v[122:123], v[122:123], v[72:73], v[72:73] op_sel:[0,1,1] op_sel_hi:[1,1,1]
    v_pk_fma_f32 v[124:125], v[124:125], v[72:73], v[72:73] op_sel:[0,1,1] op_sel_hi:[1,1,1]
    v_rcp_f32 v122, v122
    v_rcp_f32 v123, v123
    v_rcp_f32 v124, v124
    v_rcp_f32 v125, v125
    v_pk_mul_f32 v[32:33], v[32:33], v[122:123]
    v_pk_mul_f32 v[34:35], v[34:35], v[124:125]
    v_pk_fma_f32 v[36:37], v[72:73], v[68:69], v[36:37] op_sel_hi:[0,1,1] neg_lo:[1,0,0] neg_hi:[1,0,0]
    v_pk_fma_f32 v[38:39], v[72:73], v[70:71], v[38:39] op_sel_hi:[0,1,1] neg_lo:[1,0,0] neg_hi:[1,0,0]
    v_pk_mul_f32 v[122:123], v[36:37], v[36:37]
    v_pk_mul_f32 v[124:125], v[38:39], v[38:39]
    v_pk_fma_f32 v[122:123], v[122:123], v[134:135], v[134:135] op_sel:[0,1,0] op_sel_hi:[1,1,0]
    v_pk_fma_f32 v[124:125], v[124:125], v[134:135], v[134:135] op_sel:[0,1,0] op_sel_hi:[1,1,0]
    v_pk_mul_f32 v[122:123], v[122:123], v[36:37]
    v_pk_mul_f32 v[124:125], v[124:125], v[38:39]
    v_exp_f32 v122, v122
    v_exp_f32 v123, v123
    v_exp_f32 v124, v124
    v_exp_f32 v125, v125
    v_pk_fma_f32 v[122:123], v[122:123], v[72:73], v[72:73] op_sel:[0,1,1] op_sel_hi:[1,1,1]
    v_pk_fma_f32 v[124:125], v[124:125], v[72:73], v[72:73] op_sel:[0,1,1] op_sel_hi:[1,1,1]
    v_rcp_f32 v122, v122
    v_rcp_f32 v123, v123
    v_rcp_f32 v124, v124
    v_rcp_f32 v125, v125
    v_pk_mul_f32 v[36:37], v[36:37], v[122:123]
    v_pk_mul_f32 v[38:39], v[38:39], v[124:125]
    v_cvt_pk_bf16_f32 v32, v32, v33
    v_cvt_pk_bf16_f32 v33, v34, v35
    v_cvt_pk_bf16_f32 v34, v36, v37
    v_cvt_pk_bf16_f32 v35, v38, v39
    v_and_b32 v32, -2, v32
    buffer_store_dwordx4 v[32:35], v12, s[16:19], s40 offen offset:0 sc1
    v_pk_fma_f32 v[48:49], v[74:75], v[64:65], v[48:49] op_sel_hi:[0,1,1] neg_lo:[1,0,0] neg_hi:[1,0,0]
    v_pk_fma_f32 v[50:51], v[74:75], v[66:67], v[50:51] op_sel_hi:[0,1,1] neg_lo:[1,0,0] neg_hi:[1,0,0]
    v_pk_mul_f32 v[122:123], v[48:49], v[48:49]
    v_pk_mul_f32 v[124:125], v[50:51], v[50:51]
    v_pk_fma_f32 v[122:123], v[122:123], v[136:137], v[136:137] op_sel:[0,1,0] op_sel_hi:[1,1,0]
    v_pk_fma_f32 v[124:125], v[124:125], v[136:137], v[136:137] op_sel:[0,1,0] op_sel_hi:[1,1,0]
    v_pk_mul_f32 v[122:123], v[122:123], v[48:49]
    v_pk_mul_f32 v[124:125], v[124:125], v[50:51]
    v_exp_f32 v122, v122
    v_exp_f32 v123, v123
    v_exp_f32 v124, v124
    v_exp_f32 v125, v125
    v_pk_fma_f32 v[122:123], v[122:123], v[74:75], v[74:75] op_sel:[0,1,1] op_sel_hi:[1,1,1]
    v_pk_fma_f32 v[124:125], v[124:125], v[74:75], v[74:75] op_sel:[0,1,1] op_sel_hi:[1,1,1]
    v_rcp_f32 v122, v122
    v_rcp_f32 v123, v123
    v_rcp_f32 v124, v124
    v_rcp_f32 v125, v125
    v_pk_mul_f32 v[48:49], v[48:49], v[122:123]
    v_pk_mul_f32 v[50:51], v[50:51], v[124:125]
    v_pk_fma_f32 v[52:53], v[74:75], v[68:69], v[52:53] op_sel_hi:[0,1,1] neg_lo:[1,0,0] neg_hi:[1,0,0]
    v_pk_fma_f32 v[54:55], v[74:75], v[70:71], v[54:55] op_sel_hi:[0,1,1] neg_lo:[1,0,0] neg_hi:[1,0,0]
    v_pk_mul_f32 v[122:123], v[52:53], v[52:53]
    v_pk_mul_f32 v[124:125], v[54:55], v[54:55]
    v_pk_fma_f32 v[122:123], v[122:123], v[136:137], v[136:137] op_sel:[0,1,0] op_sel_hi:[1,1,0]
    v_pk_fma_f32 v[124:125], v[124:125], v[136:137], v[136:137] op_sel:[0,1,0] op_sel_hi:[1,1,0]
    v_pk_mul_f32 v[122:123], v[122:123], v[52:53]
    v_pk_mul_f32 v[124:125], v[124:125], v[54:55]
    v_exp_f32 v122, v122
    v_exp_f32 v123, v123
    v_exp_f32 v124, v124
    v_exp_f32 v125, v125
    v_pk_fma_f32 v[122:123], v[122:123], v[74:75], v[74:75] op_sel:[0,1,1] op_sel_hi:[1,1,1]
    v_pk_fma_f32 v[124:125], v[124:125], v[74:75], v[74:75] op_sel:[0,1,1] op_sel_hi:[1,1,1]
    v_rcp_f32 v122, v122
    v_rcp_f32 v123, v123
    v_rcp_f32 v124, v124
    v_rcp_f32 v125, v125
    v_pk_mul_f32 v[52:53], v[52:53], v[122:123]
    v_pk_mul_f32 v[54:55], v[54:55], v[124:125]
    v_cvt_pk_bf16_f32 v48, v48, v49
    v_cvt_pk_bf16_f32 v49, v50, v51
    v_cvt_pk_bf16_f32 v50, v52, v53
    v_cvt_pk_bf16_f32 v51, v54, v55
    v_and_b32 v48, -2, v48
    buffer_store_dwordx4 v[48:51], v12, s[16:19], s40 offen offset:256 sc1
    s_add_u32 s8, s4, 0x2100000
    s_addc_u32 s9, s5, 0
    s_mov_b32 s10, 0x8400000
    s_mov_b32 s11, 0x20000
    s_sub_u32 s47, s55, 39583744
    s_lshl_b32 s46, s30, 9
    s_add_u32 s47, s47, s46
    s_add_u32 s45, s92, 2048
    s_cmp_eq_u32 s28, 0
    s_cselect_b32 s45, 1073741824, s45
    s_cmp_eq_u32 s30, 0
    s_cselect_b32 s45, s45, 0
    s_add_u32 s53, s47, 0xfffffff0
    v_add_u32 v126, s53, v12
    v_add_u32 v127, 256, v126
    v_add_u32 v134, s45, v126
    v_cmp_gt_u32 vcc, 1, v22
    s_nop 1
    v_cndmask_b32 v126, v126, v134, vcc
    s_mov_b32 s34, s30
    s_mov_b32 s35, 0
    v_and_b32 v22, 15, v1
    v_lshrrev_b32 v23, 4, v1
    s_mul_i32 s37, s34, 2
    s_mul_i32 s38, s29, 4
    s_mul_i32 s36, s35, 4
    s_add_u32 s38, s38, s36
    s_lshr_b32 s36, s38, 1
    s_lshr_b32 s53, s36, 3
    s_lshl_b32 s53, s53, 14
    s_and_b32 s39, s36, 7
    s_lshl_b32 s39, s39, 10
    s_add_u32 s39, s39, s53
    s_lshl_b32 s36, s37, 16
    s_add_u32 s39, s39, s36
    s_sub_u32 s46, s93, 2048
    s_cmp_eq_u32 s28, 15
    s_cselect_b32 s46, 1073741824, s46
    s_cmp_eq_u32 s30, 3
    s_cselect_b32 s46, s46, 0
    s_add_u32 s53, s47, 0x10
    v_add_u32 v128, s53, v12
    v_add_u32 v129, 256, v128
    v_add_u32 v134, s46, v129
    v_cmp_le_u32 vcc, 15, v22
    s_nop 1
    v_cndmask_b32 v129, v129, v134, vcc
    s_add_u32 s53, s47, 0xffffffe0
    v_add_u32 v130, s53, v12
    v_add_u32 v131, 256, v130
    v_add_u32 v134, s45, v130
    v_cmp_gt_u32 vcc, 2, v22
    s_nop 1
    v_cndmask_b32 v130, v130, v134, vcc
    s_add_u32 s53, s47, 0x20
    v_add_u32 v132, s53, v12
    v_add_u32 v133, 256, v132
    v_add_u32 v134, s46, v133
    v_cmp_le_u32 vcc, 14, v22
    s_nop 1
    v_cndmask_b32 v133, v133, v134, vcc
    v_mov_b32 v134, v126
    v_mov_b32 v135, v127
    v_lshrrev_b32 v6, 2, v1
    v_mul_u32_u24 v13, 128, v6
    v_and_b32 v7, 3, v1
    v_lshl_add_u32 v13, v7, 3, v13
    v_add_u32 v13, 0, v13
    v_bfe_u32 v6, v6, 1, 2
    s_mul_i32 s36, s35, 4
    s_add_u32 s36, s36, 3
    v_xor_b32 v7, s36, v6
    v_lshl_add_u32 v16, v7, 5, v13
    s_mul_i32 s36, s35, 4
    s_add_u32 s36, s36, 2
    v_xor_b32 v7, s36, v6
    v_lshl_add_u32 v15, v7, 5, v13
    s_mul_i32 s36, s35, 4
    s_add_u32 s36, s36, 1
    v_xor_b32 v7, s36, v6
    v_lshl_add_u32 v14, v7, 5, v13
    s_mul_i32 s36, s35, 4
    s_add_u32 s36, s36, 0
    v_xor_b32 v7, s36, v6
    v_lshl_add_u32 v13, v7, 5, v13
    s_lshl_b32 s36, s37, 8
    s_add_u32 s36, s36, 160768
    v_lshlrev_b32 v7, 4, v22
    v_add_u32 v7, s36, v7
    ds_read_b64 v[56:57], v7 offset:0
    ds_read_b64 v[58:59], v7 offset:256
    s_waitcnt vmcnt(4) lgkmcnt(0)
    s_sleep 3
    s_cmp_lg_u32 s60, 0
    s_cbranch_scc1 G2_nd
    s_sleep 2
G2_nd:
    s_mov_b32 s44, 0
    buffer_load_dwordx4 v[164:167], v126, s[8:11], s44 offen sc1
    buffer_load_dwordx4 v[168:171], v127, s[8:11], s44 offen sc1
    s_add_u32 s44, s44, 16384
    buffer_load_dwordx4 v[172:175], v126, s[8:11], s44 offen sc1
    buffer_load_dwordx4 v[176:179], v127, s[8:11], s44 offen sc1
    s_add_u32 s44, s44, 16384
    v_lshlrev_b32 v24, 16, v148
    v_and_b32 v25, 0xffff0000, v148
    v_pk_add_f32 v[24:25], v[24:25], v[56:57] op_sel_hi:[1,0] neg_lo:[0,1] neg_hi:[0,1]
    v_pk_mul_f32 v[24:25], v[24:25], v[56:57] op_sel:[0,1] op_sel_hi:[1,1]
    v_lshlrev_b32 v26, 16, v149
    v_and_b32 v27, 0xffff0000, v149
    v_pk_add_f32 v[26:27], v[26:27], v[56:57] op_sel_hi:[1,0] neg_lo:[0,1] neg_hi:[0,1]
    v_pk_mul_f32 v[26:27], v[26:27], v[56:57] op_sel:[0,1] op_sel_hi:[1,1]
    v_lshlrev_b32 v28, 16, v150
    v_and_b32 v29, 0xffff0000, v150
    v_pk_add_f32 v[28:29], v[28:29], v[56:57] op_sel_hi:[1,0] neg_lo:[0,1] neg_hi:[0,1]
    v_pk_mul_f32 v[28:29], v[28:29], v[56:57] op_sel:[0,1] op_sel_hi:[1,1]
    v_lshlrev_b32 v30, 16, v151
    v_and_b32 v31, 0xffff0000, v151
    v_pk_add_f32 v[30:31], v[30:31], v[56:57] op_sel_hi:[1,0] neg_lo:[0,1] neg_hi:[0,1]
    v_pk_mul_f32 v[30:31], v[30:31], v[56:57] op_sel:[0,1] op_sel_hi:[1,1]
    v_lshlrev_b32 v32, 16, v152
    v_and_b32 v33, 0xffff0000, v152
    v_pk_add_f32 v[32:33], v[32:33], v[56:57] op_sel_hi:[1,0] neg_lo:[0,1] neg_hi:[0,1]
    v_pk_mul_f32 v[32:33], v[32:33], v[56:57] op_sel:[0,1] op_sel_hi:[1,1]
    v_lshlrev_b32 v34, 16, v153
    v_and_b32 v35, 0xffff0000, v153
    v_pk_add_f32 v[34:35], v[34:35], v[56:57] op_sel_hi:[1,0] neg_lo:[0,1] neg_hi:[0,1]
    v_pk_mul_f32 v[34:35], v[34:35], v[56:57] op_sel:[0,1] op_sel_hi:[1,1]
    v_lshlrev_b32 v36, 16, v154
    v_and_b32 v37, 0xffff0000, v154
    v_pk_add_f32 v[36:37], v[36:37], v[56:57] op_sel_hi:[1,0] neg_lo:[0,1] neg_hi:[0,1]
    v_pk_mul_f32 v[36:37], v[36:37], v[56:57] op_sel:[0,1] op_sel_hi:[1,1]
    v_lshlrev_b32 v38, 16, v155
    v_and_b32 v39, 0xffff0000, v155
    v_pk_add_f32 v[38:39], v[38:39], v[56:57] op_sel_hi:[1,0] neg_lo:[0,1] neg_hi:[0,1]
    v_pk_mul_f32 v[38:39], v[38:39], v[56:57] op_sel:[0,1] op_sel_hi:[1,1]
    v_lshlrev_b32 v40, 16, v156
    v_and_b32 v41, 0xffff0000, v156
    v_pk_add_f32 v[40:41], v[40:41], v[58:59] op_sel_hi:[1,0] neg_lo:[0,1] neg_hi:[0,1]
    v_pk_mul_f32 v[40:41], v[40:41], v[58:59] op_sel:[0,1] op_sel_hi:[1,1]
    v_lshlrev_b32 v42, 16, v157
    v_and_b32 v43, 0xffff0000, v157
    v_pk_add_f32 v[42:43], v[42:43], v[58:59] op_sel_hi:[1,0] neg_lo:[0,1] neg_hi:[0,1]
    v_pk_mul_f32 v[42:43], v[42:43], v[58:59] op_sel:[0,1] op_sel_hi:[1,1]
    v_lshlrev_b32 v44, 16, v158
    v_and_b32 v45, 0xffff0000, v158
    v_pk_add_f32 v[44:45], v[44:45], v[58:59] op_sel_hi:[1,0] neg_lo:[0,1] neg_hi:[0,1]
    v_pk_mul_f32 v[44:45], v[44:45], v[58:59] op_sel:[0,1] op_sel_hi:[1,1]
    v_lshlrev_b32 v46, 16, v159
    v_and_b32 v47, 0xffff0000, v159
    v_pk_add_f32 v[46:47], v[46:47], v[58:59] op_sel_hi:[1,0] neg_lo:[0,1] neg_hi:[0,1]
    v_pk_mul_f32 v[46:47], v[46:47], v[58:59] op_sel:[0,1] op_sel_hi:[1,1]
    v_lshlrev_b32 v48, 16, v160
    v_and_b32 v49, 0xffff0000, v160
    v_pk_add_f32 v[48:49], v[48:49], v[58:59] op_sel_hi:[1,0] neg_lo:[0,1] neg_hi:[0,1]
    v_pk_mul_f32 v[48:49], v[48:49], v[58:59] op_sel:[0,1] op_sel_hi:[1,1]
    v_lshlrev_b32 v50, 16, v161
    v_and_b32 v51, 0xffff0000, v161
    v_pk_add_f32 v[50:51], v[50:51], v[58:59] op_sel_hi:[1,0] neg_lo:[0,1] neg_hi:[0,1]
    v_pk_mul_f32 v[50:51], v[50:51], v[58:59] op_sel:[0,1] op_sel_hi:[1,1]
    v_lshlrev_b32 v52, 16, v162
    v_and_b32 v53, 0xffff0000, v162
    v_pk_add_f32 v[52:53], v[52:53], v[58:59] op_sel_hi:[1,0] neg_lo:[0,1] neg_hi:[0,1]
    v_pk_mul_f32 v[52:53], v[52:53], v[58:59] op_sel:[0,1] op_sel_hi:[1,1]
    v_lshlrev_b32 v54, 16, v163
    v_and_b32 v55, 0xffff0000, v163
    v_pk_add_f32 v[54:55], v[54:55], v[58:59] op_sel_hi:[1,0] neg_lo:[0,1] neg_hi:[0,1]
    v_pk_mul_f32 v[54:55], v[54:55], v[58:59] op_sel:[0,1] op_sel_hi:[1,1]
    s_mov_b32 s43, 0
    s_add_u32 s16, s62, 0x80000
    s_addc_u32 s17, s63, 0
    s_mov_b32 s18, 0x7e000
    s_mov_b32 s19, 0x20000
    s_mov_b32 s53, 0
    s_mov_b32 s49, s44
    s_barrier
    ds_read_b64_tr_b16 v[56:57], v13 offset:0
    ds_read_b64_tr_b16 v[58:59], v13 offset:2048
    ds_read_b64_tr_b16 v[60:61], v14 offset:0
    ds_read_b64_tr_b16 v[62:63], v14 offset:2048
    ds_read_b64_tr_b16 v[64:65], v15 offset:0
    ds_read_b64_tr_b16 v[66:67], v15 offset:2048
    ds_read_b64_tr_b16 v[68:69], v16 offset:0
    ds_read_b64_tr_b16 v[70:71], v16 offset:2048
    ds_read_b64_tr_b16 v[72:73], v13 offset:4096
    ds_read_b64_tr_b16 v[74:75], v13 offset:6144
    ds_read_b64_tr_b16 v[76:77], v14 offset:4096
    ds_read_b64_tr_b16 v[78:79], v14 offset:6144
    ds_read_b64_tr_b16 v[80:81], v15 offset:4096
    ds_read_b64_tr_b16 v[82:83], v15 offset:6144
    ds_read_b64_tr_b16 v[84:85], v16 offset:4096
    ds_read_b64_tr_b16 v[86:87], v16 offset:6144
    s_branch dm_21w
dm_21p:
    s_mov_b32 s44, 0
    buffer_load_dwordx4 v[164:167], v126, s[8:11], s44 offen sc1
    buffer_load_dwordx4 v[168:171], v127, s[8:11], s44 offen sc1
    s_add_u32 s44, s44, 16384
    buffer_load_dwordx4 v[172:175], v126, s[8:11], s44 offen sc1
    buffer_load_dwordx4 v[176:179], v127, s[8:11], s44 offen sc1
    s_add_u32 s44, s44, 16384
dm_21w:
    s_waitcnt vmcnt(0)
    v_or3_b32 v17, v164, v168, v172
    v_bitop3_b32 v17, v17, v176, 1 bitop3:0xa8
    v_cmp_ne_u32 vcc, 0, v17
    s_cbranch_vccz dm_21q
    s_sleep 2
    s_add_u32 s53, s53, 1
    s_cmp_lt_u32 s53, s61
    s_cbranch_scc1 dm_21p
    s_mov_b32 s61, 0
dm_21q:
    buffer_load_dwordx4 v[180:183], v126, s[8:11], s44 offen
    buffer_load_dwordx4 v[184:187], v127, s[8:11], s44 offen
    s_add_u32 s44, s44, 16384
    buffer_load_dwordx4 v[188:191], v126, s[8:11], s44 offen
    buffer_load_dwordx4 v[192:195], v127, s[8:11], s44 offen
    s_add_u32 s44, s44, 16384
    buffer_load_dwordx4 v[196:199], v126, s[8:11], s44 offen
    buffer_load_dwordx4 v[200:203], v127, s[8:11], s44 offen
    s_add_u32 s44, s44, 16384
    buffer_load_dwordx4 v[204:207], v126, s[8:11], s44 offen
    buffer_load_dwordx4 v[208:211], v127, s[8:11], s44 offen
    s_add_u32 s44, s44, 16384
    buffer_load_dwordx4 v[212:215], v126, s[8:11], s44 offen
    buffer_load_dwordx4 v[216:219], v127, s[8:11], s44 offen
    s_add_u32 s44, s44, 16384
    s_waitcnt lgkmcnt(0)
dm_21:
    v_mfma_f32_16x16x32_bf16 v[24:27], v[56:59], v[164:167], v[24:27]
    ds_read_b64_tr_b16 v[88:89], v13 offset:8192
    buffer_load_dwordx4 v[220:223], v126, s[8:11], s44 offen
    v_mfma_f32_16x16x32_bf16 v[40:43], v[56:59], v[168:171], v[40:43]
    ds_read_b64_tr_b16 v[90:91], v13 offset:10240
    buffer_load_dwordx4 v[224:227], v127, s[8:11], s44 offen
    v_mfma_f32_16x16x32_bf16 v[44:47], v[60:63], v[168:171], v[44:47]
    ds_read_b64_tr_b16 v[92:93], v14 offset:8192
    s_add_u32 s44, s44, 16384
    v_mfma_f32_16x16x32_bf16 v[28:31], v[60:63], v[164:167], v[28:31]
    ds_read_b64_tr_b16 v[94:95], v14 offset:10240
    v_mov_b32 v126, v128
    v_mfma_f32_16x16x32_bf16 v[32:35], v[64:67], v[164:167], v[32:35]
    ds_read_b64_tr_b16 v[96:97], v15 offset:8192
    v_mov_b32 v127, v129
    v_mfma_f32_16x16x32_bf16 v[48:51], v[64:67], v[168:171], v[48:51]
    ds_read_b64_tr_b16 v[98:99], v15 offset:10240
    v_mov_b32 v128, v130
    v_mfma_f32_16x16x32_bf16 v[52:55], v[68:71], v[168:171], v[52:55]
    ds_read_b64_tr_b16 v[100:101], v16 offset:8192
    v_mov_b32 v129, v131
    v_mfma_f32_16x16x32_bf16 v[36:39], v[68:71], v[164:167], v[36:39]
    ds_read_b64_tr_b16 v[102:103], v16 offset:10240
    s_waitcnt lgkmcnt(8)
    v_mfma_f32_16x16x32_bf16 v[24:27], v[72:75], v[172:175], v[24:27]
    ds_read_b64_tr_b16 v[104:105], v13 offset:12288
    buffer_load_dwordx4 v[164:167], v126, s[8:11], s44 offen
    v_mfma_f32_16x16x32_bf16 v[40:43], v[72:75], v[176:179], v[40:43]
    ds_read_b64_tr_b16 v[106:107], v13 offset:14336
    buffer_load_dwordx4 v[168:171], v127, s[8:11], s44 offen
    v_mfma_f32_16x16x32_bf16 v[44:47], v[76:79], v[176:179], v[44:47]
    ds_read_b64_tr_b16 v[108:109], v14 offset:12288
    s_add_u32 s44, s44, 16384
    s_waitcnt vmcnt(10)
    v_mfma_f32_16x16x32_bf16 v[28:31], v[76:79], v[172:175], v[28:31]
    ds_read_b64_tr_b16 v[110:111], v14 offset:14336
    v_or3_b32 v17, v180, v184, v188
    v_mfma_f32_16x16x32_bf16 v[32:35], v[80:83], v[172:175], v[32:35]
    ds_read_b64_tr_b16 v[112:113], v15 offset:12288
    v_bitop3_b32 v17, v17, v192, 1 bitop3:0xa8
    v_mfma_f32_16x16x32_bf16 v[48:51], v[80:83], v[176:179], v[48:51]
    ds_read_b64_tr_b16 v[114:115], v15 offset:14336
    v_cmp_ne_u32 vcc, 0, v17
    v_mfma_f32_16x16x32_bf16 v[52:55], v[84:87], v[176:179], v[52:55]
    ds_read_b64_tr_b16 v[116:117], v16 offset:12288
    ds_read_b64_tr_b16 v[118:119], v16 offset:14336
    v_mfma_f32_16x16x32_bf16 v[36:39], v[84:87], v[172:175], v[36:39]
    s_waitcnt lgkmcnt(8)
    s_cbranch_vccnz dm_21f0
dm_21g0:
    v_mfma_f32_16x16x32_bf16 v[24:27], v[88:91], v[180:183], v[24:27]
    ds_read_b64_tr_b16 v[56:57], v13 offset:16384
    buffer_load_dwordx4 v[172:175], v126, s[8:11], s44 offen
    v_mfma_f32_16x16x32_bf16 v[40:43], v[88:91], v[184:187], v[40:43]
    ds_read_b64_tr_b16 v[58:59], v13 offset:18432
    buffer_load_dwordx4 v[176:179], v127, s[8:11], s44 offen
    v_mfma_f32_16x16x32_bf16 v[44:47], v[92:95], v[184:187], v[44:47]
    ds_read_b64_tr_b16 v[60:61], v14 offset:16384
    s_add_u32 s44, s44, 16384
    v_mfma_f32_16x16x32_bf16 v[28:31], v[92:95], v[180:183], v[28:31]
    ds_read_b64_tr_b16 v[62:63], v14 offset:18432
    v_mov_b32 v130, v132
    v_mfma_f32_16x16x32_bf16 v[32:35], v[96:99], v[180:183], v[32:35]
    ds_read_b64_tr_b16 v[64:65], v15 offset:16384
    v_mov_b32 v131, v133
    v_mfma_f32_16x16x32_bf16 v[48:51], v[96:99], v[184:187], v[48:51]
    ds_read_b64_tr_b16 v[66:67], v15 offset:18432
    v_mov_b32 v132, 1073741824
    v_mfma_f32_16x16x32_bf16 v[52:55], v[100:103], v[184:187], v[52:55]
    ds_read_b64_tr_b16 v[68:69], v16 offset:16384
    v_mov_b32 v133, 1073741824
    v_mfma_f32_16x16x32_bf16 v[36:39], v[100:103], v[180:183], v[36:39]
    ds_read_b64_tr_b16 v[70:71], v16 offset:18432
    s_waitcnt lgkmcnt(8)
    v_mfma_f32_16x16x32_bf16 v[24:27], v[104:107], v[188:191], v[24:27]
    ds_read_b64_tr_b16 v[72:73], v13 offset:20480
    buffer_load_dwordx4 v[180:183], v126, s[8:11], s44 offen
    v_mfma_f32_16x16x32_bf16 v[40:43], v[104:107], v[192:195], v[40:43]
    ds_read_b64_tr_b16 v[74:75], v13 offset:22528
    buffer_load_dwordx4 v[184:187], v127, s[8:11], s44 offen
    v_mfma_f32_16x16x32_bf16 v[44:47], v[108:111], v[192:195], v[44:47]
    ds_read_b64_tr_b16 v[76:77], v14 offset:20480
    s_add_u32 s44, s44, 16384
    s_waitcnt vmcnt(10)
    v_mfma_f32_16x16x32_bf16 v[28:31], v[108:111], v[188:191], v[28:31]
    ds_read_b64_tr_b16 v[78:79], v14 offset:22528
    v_or3_b32 v17, v196, v200, v204
    v_mfma_f32_16x16x32_bf16 v[32:35], v[112:115], v[188:191], v[32:35]
    ds_read_b64_tr_b16 v[80:81], v15 offset:20480
    v_bitop3_b32 v17, v17, v208, 1 bitop3:0xa8
    v_mfma_f32_16x16x32_bf16 v[48:51], v[112:115], v[192:195], v[48:51]
    ds_read_b64_tr_b16 v[82:83], v15 offset:22528
    v_cmp_ne_u32 vcc, 0, v17
    v_mfma_f32_16x16x32_bf16 v[52:55], v[116:119], v[192:195], v[52:55]
    ds_read_b64_tr_b16 v[84:85], v16 offset:20480
    ds_read_b64_tr_b16 v[86:87], v16 offset:22528
    v_mfma_f32_16x16x32_bf16 v[36:39], v[116:119], v[188:191], v[36:39]
    s_waitcnt lgkmcnt(8)
    s_cbranch_vccnz dm_21f1
dm_21g1:
    v_mfma_f32_16x16x32_bf16 v[24:27], v[56:59], v[196:199], v[24:27]
    ds_read_b64_tr_b16 v[88:89], v13 offset:24576
    buffer_load_dwordx4 v[188:191], v126, s[8:11], s44 offen
    v_mfma_f32_16x16x32_bf16 v[40:43], v[56:59], v[200:203], v[40:43]
    ds_read_b64_tr_b16 v[90:91], v13 offset:26624
    buffer_load_dwordx4 v[192:195], v127, s[8:11], s44 offen
    v_mfma_f32_16x16x32_bf16 v[44:47], v[60:63], v[200:203], v[44:47]
    ds_read_b64_tr_b16 v[92:93], v14 offset:24576
    s_add_u32 s44, s44, 16384
    v_mfma_f32_16x16x32_bf16 v[28:31], v[60:63], v[196:199], v[28:31]
    ds_read_b64_tr_b16 v[94:95], v14 offset:26624
    v_mfma_f32_16x16x32_bf16 v[32:35], v[64:67], v[196:199], v[32:35]
    ds_read_b64_tr_b16 v[96:97], v15 offset:24576
    s_add_u32 s43, s43, 1
    v_mfma_f32_16x16x32_bf16 v[48:51], v[64:67], v[200:203], v[48:51]
    ds_read_b64_tr_b16 v[98:99], v15 offset:26624
    v_mfma_f32_16x16x32_bf16 v[52:55], v[68:71], v[200:203], v[52:55]
    ds_read_b64_tr_b16 v[100:101], v16 offset:24576
    v_mfma_f32_16x16x32_bf16 v[36:39], v[68:71], v[196:199], v[36:39]
    ds_read_b64_tr_b16 v[102:103], v16 offset:26624
    s_waitcnt lgkmcnt(8)
    v_mfma_f32_16x16x32_bf16 v[24:27], v[72:75], v[204:207], v[24:27]
    ds_read_b64_tr_b16 v[104:105], v13 offset:28672
    buffer_load_dwordx4 v[196:199], v126, s[8:11], s44 offen
    v_mfma_f32_16x16x32_bf16 v[40:43], v[72:75], v[208:211], v[40:43]
    ds_read_b64_tr_b16 v[106:107], v13 offset:30720
    buffer_load_dwordx4 v[200:203], v127, s[8:11], s44 offen
    v_mfma_f32_16x16x32_bf16 v[44:47], v[76:79], v[208:211], v[44:47]
    ds_read_b64_tr_b16 v[108:109], v14 offset:28672
    s_add_u32 s44, s44, 16384
    s_waitcnt vmcnt(10)
    v_mfma_f32_16x16x32_bf16 v[28:31], v[76:79], v[204:207], v[28:31]
    ds_read_b64_tr_b16 v[110:111], v14 offset:30720
    v_add_u32 v13, 32768, v13
    v_or3_b32 v17, v212, v216, v220
    v_mfma_f32_16x16x32_bf16 v[32:35], v[80:83], v[204:207], v[32:35]
    ds_read_b64_tr_b16 v[112:113], v15 offset:28672
    v_add_u32 v14, 32768, v14
    v_bitop3_b32 v17, v17, v224, 1 bitop3:0xa8
    v_mfma_f32_16x16x32_bf16 v[48:51], v[80:83], v[208:211], v[48:51]
    ds_read_b64_tr_b16 v[114:115], v15 offset:30720
    v_add_u32 v15, 32768, v15
    v_cmp_ne_u32 vcc, 0, v17
    v_mfma_f32_16x16x32_bf16 v[52:55], v[84:87], v[208:211], v[52:55]
    ds_read_b64_tr_b16 v[116:117], v16 offset:28672
    ds_read_b64_tr_b16 v[118:119], v16 offset:30720
    s_cmp_eq_u32 s43, 4
    v_mfma_f32_16x16x32_bf16 v[36:39], v[84:87], v[204:207], v[36:39]
    v_add_u32 v16, 32768, v16
    s_waitcnt lgkmcnt(8)
    s_cbranch_vccnz dm_21f2
dm_21g2:
    s_cbranch_scc1 dm_21x
    v_mfma_f32_16x16x32_bf16 v[24:27], v[88:91], v[212:215], v[24:27]
    ds_read_b64_tr_b16 v[56:57], v13 offset:0
    buffer_load_dwordx4 v[204:207], v126, s[8:11], s44 offen
    v_mfma_f32_16x16x32_bf16 v[40:43], v[88:91], v[216:219], v[40:43]
    ds_read_b64_tr_b16 v[58:59], v13 offset:2048
    buffer_load_dwordx4 v[208:211], v127, s[8:11], s44 offen
    v_mfma_f32_16x16x32_bf16 v[44:47], v[92:95], v[216:219], v[44:47]
    ds_read_b64_tr_b16 v[60:61], v14 offset:0
    s_add_u32 s44, s44, 16384
    v_mfma_f32_16x16x32_bf16 v[28:31], v[92:95], v[212:215], v[28:31]
    ds_read_b64_tr_b16 v[62:63], v14 offset:2048
    v_mov_b32 v134, v126
    v_mfma_f32_16x16x32_bf16 v[32:35], v[96:99], v[212:215], v[32:35]
    ds_read_b64_tr_b16 v[64:65], v15 offset:0
    v_mov_b32 v135, v127
    v_mfma_f32_16x16x32_bf16 v[48:51], v[96:99], v[216:219], v[48:51]
    ds_read_b64_tr_b16 v[66:67], v15 offset:2048
    v_mfma_f32_16x16x32_bf16 v[52:55], v[100:103], v[216:219], v[52:55]
    ds_read_b64_tr_b16 v[68:69], v16 offset:0
    v_mfma_f32_16x16x32_bf16 v[36:39], v[100:103], v[212:215], v[36:39]
    ds_read_b64_tr_b16 v[70:71], v16 offset:2048
    s_waitcnt lgkmcnt(8)
    v_mfma_f32_16x16x32_bf16 v[24:27], v[104:107], v[220:223], v[24:27]
    ds_read_b64_tr_b16 v[72:73], v13 offset:4096
    buffer_load_dwordx4 v[212:215], v126, s[8:11], s44 offen
    v_mfma_f32_16x16x32_bf16 v[40:43], v[104:107], v[224:227], v[40:43]
    ds_read_b64_tr_b16 v[74:75], v13 offset:6144
    buffer_load_dwordx4 v[216:219], v127, s[8:11], s44 offen
    v_mfma_f32_16x16x32_bf16 v[44:47], v[108:111], v[224:227], v[44:47]
    ds_read_b64_tr_b16 v[76:77], v14 offset:4096
    s_add_u32 s44, s44, 16384
    s_waitcnt vmcnt(10)
    v_mfma_f32_16x16x32_bf16 v[28:31], v[108:111], v[220:223], v[28:31]
    ds_read_b64_tr_b16 v[78:79], v14 offset:6144
    v_or3_b32 v17, v164, v168, v172
    v_mfma_f32_16x16x32_bf16 v[32:35], v[112:115], v[220:223], v[32:35]
    ds_read_b64_tr_b16 v[80:81], v15 offset:4096
    v_bitop3_b32 v17, v17, v176, 1 bitop3:0xa8
    v_mfma_f32_16x16x32_bf16 v[48:51], v[112:115], v[224:227], v[48:51]
    ds_read_b64_tr_b16 v[82:83], v15 offset:6144
    v_cmp_ne_u32 vcc, 0, v17
    v_mfma_f32_16x16x32_bf16 v[52:55], v[116:119], v[224:227], v[52:55]
    ds_read_b64_tr_b16 v[84:85], v16 offset:4096
    ds_read_b64_tr_b16 v[86:87], v16 offset:6144
    v_mfma_f32_16x16x32_bf16 v[36:39], v[116:119], v[220:223], v[36:39]
    s_waitcnt lgkmcnt(8)
    s_cbranch_vccnz dm_21f3
dm_21g3:
    s_branch dm_21
dm_21f0:
    s_cselect_b32 s50, 1, 0
dm_21h0:
    s_sleep 2
    s_sub_u32 s44, s44, 114688
    buffer_load_dwordx4 v[180:183], v134, s[8:11], s44 offen sc1
    buffer_load_dwordx4 v[184:187], v135, s[8:11], s44 offen sc1
    s_add_u32 s44, s44, 16384
    buffer_load_dwordx4 v[188:191], v134, s[8:11], s44 offen sc1
    buffer_load_dwordx4 v[192:195], v135, s[8:11], s44 offen sc1
    s_add_u32 s44, s44, 16384
    buffer_load_dwordx4 v[196:199], v134, s[8:11], s44 offen sc1
    buffer_load_dwordx4 v[200:203], v135, s[8:11], s44 offen sc1
    s_add_u32 s44, s44, 16384
    buffer_load_dwordx4 v[204:207], v134, s[8:11], s44 offen sc1
    buffer_load_dwordx4 v[208:211], v135, s[8:11], s44 offen sc1
    s_add_u32 s44, s44, 16384
    buffer_load_dwordx4 v[212:215], v134, s[8:11], s44 offen sc1
    buffer_load_dwordx4 v[216:219], v135, s[8:11], s44 offen sc1
    s_add_u32 s44, s44, 16384
    buffer_load_dwordx4 v[220:223], v134, s[8:11], s44 offen sc1
    buffer_load_dwordx4 v[224:227], v135, s[8:11], s44 offen sc1
    s_add_u32 s44, s44, 16384
    buffer_load_dwordx4 v[164:167], v126, s[8:11], s44 offen sc1
    buffer_load_dwordx4 v[168:171], v127, s[8:11], s44 offen sc1
    s_add_u32 s44, s44, 16384
    s_waitcnt vmcnt(10)
    v_or3_b32 v17, v180, v184, v188
    v_bitop3_b32 v17, v17, v192, 1 bitop3:0xa8
    v_cmp_ne_u32 vcc, 0, v17
    s_add_u32 s53, s53, 1
    s_cmp_ge_u32 s53, s61
    s_cselect_b32 s61, 0, s61
    s_cbranch_scc1 dm_21k0
    s_cbranch_vccnz dm_21h0
dm_21k0:
    s_cmp_eq_u32 s50, 1
    s_branch dm_21g0
dm_21f1:
    s_cselect_b32 s50, 1, 0
dm_21h1:
    s_sleep 2
    s_sub_u32 s44, s44, 114688
    buffer_load_dwordx4 v[196:199], v134, s[8:11], s44 offen sc1
    buffer_load_dwordx4 v[200:203], v135, s[8:11], s44 offen sc1
    s_add_u32 s44, s44, 16384
    buffer_load_dwordx4 v[204:207], v134, s[8:11], s44 offen sc1
    buffer_load_dwordx4 v[208:211], v135, s[8:11], s44 offen sc1
    s_add_u32 s44, s44, 16384
    buffer_load_dwordx4 v[212:215], v134, s[8:11], s44 offen sc1
    buffer_load_dwordx4 v[216:219], v135, s[8:11], s44 offen sc1
    s_add_u32 s44, s44, 16384
    buffer_load_dwordx4 v[220:223], v134, s[8:11], s44 offen sc1
    buffer_load_dwordx4 v[224:227], v135, s[8:11], s44 offen sc1
    s_add_u32 s44, s44, 16384
    buffer_load_dwordx4 v[164:167], v126, s[8:11], s44 offen sc1
    buffer_load_dwordx4 v[168:171], v127, s[8:11], s44 offen sc1
    s_add_u32 s44, s44, 16384
    buffer_load_dwordx4 v[172:175], v126, s[8:11], s44 offen sc1
    buffer_load_dwordx4 v[176:179], v127, s[8:11], s44 offen sc1
    s_add_u32 s44, s44, 16384
    buffer_load_dwordx4 v[180:183], v126, s[8:11], s44 offen sc1
    buffer_load_dwordx4 v[184:187], v127, s[8:11], s44 offen sc1
    s_add_u32 s44, s44, 16384
    s_waitcnt vmcnt(10)
    v_or3_b32 v17, v196, v200, v204
    v_bitop3_b32 v17, v17, v208, 1 bitop3:0xa8
    v_cmp_ne_u32 vcc, 0, v17
    s_add_u32 s53, s53, 1
    s_cmp_ge_u32 s53, s61
    s_cselect_b32 s61, 0, s61
    s_cbranch_scc1 dm_21k1
    s_cbranch_vccnz dm_21h1
dm_21k1:
    s_cmp_eq_u32 s50, 1
    s_branch dm_21g1
dm_21f2:
    s_cselect_b32 s50, 1, 0
dm_21h2:
    s_sleep 2
    s_sub_u32 s44, s44, 114688
    buffer_load_dwordx4 v[212:215], v134, s[8:11], s44 offen sc1
    buffer_load_dwordx4 v[216:219], v135, s[8:11], s44 offen sc1
    s_add_u32 s44, s44, 16384
    buffer_load_dwordx4 v[220:223], v134, s[8:11], s44 offen sc1
    buffer_load_dwordx4 v[224:227], v135, s[8:11], s44 offen sc1
    s_add_u32 s44, s44, 16384
    buffer_load_dwordx4 v[164:167], v126, s[8:11], s44 offen sc1
    buffer_load_dwordx4 v[168:171], v127, s[8:11], s44 offen sc1
    s_add_u32 s44, s44, 16384
    buffer_load_dwordx4 v[172:175], v126, s[8:11], s44 offen sc1
    buffer_load_dwordx4 v[176:179], v127, s[8:11], s44 offen sc1
    s_add_u32 s44, s44, 16384
    buffer_load_dwordx4 v[180:183], v126, s[8:11], s44 offen sc1
    buffer_load_dwordx4 v[184:187], v127, s[8:11], s44 offen sc1
    s_add_u32 s44, s44, 16384
    buffer_load_dwordx4 v[188:191], v126, s[8:11], s44 offen sc1
    buffer_load_dwordx4 v[192:195], v127, s[8:11], s44 offen sc1
    s_add_u32 s44, s44, 16384
    buffer_load_dwordx4 v[196:199], v126, s[8:11], s44 offen sc1
    buffer_load_dwordx4 v[200:203], v127, s[8:11], s44 offen sc1
    s_add_u32 s44, s44, 16384
    s_waitcnt vmcnt(10)
    v_or3_b32 v17, v212, v216, v220
    v_bitop3_b32 v17, v17, v224, 1 bitop3:0xa8
    v_cmp_ne_u32 vcc, 0, v17
    s_add_u32 s53, s53, 1
    s_cmp_ge_u32 s53, s61
    s_cselect_b32 s61, 0, s61
    s_cbranch_scc1 dm_21k2
    s_cbranch_vccnz dm_21h2
dm_21k2:
    s_cmp_eq_u32 s50, 1
    s_branch dm_21g2
dm_21f3:
    s_cselect_b32 s50, 1, 0
dm_21h3:
    s_sleep 2
    s_sub_u32 s44, s44, 114688
    buffer_load_dwordx4 v[164:167], v134, s[8:11], s44 offen sc1
    buffer_load_dwordx4 v[168:171], v135, s[8:11], s44 offen sc1
    s_add_u32 s44, s44, 16384
    buffer_load_dwordx4 v[172:175], v134, s[8:11], s44 offen sc1
    buffer_load_dwordx4 v[176:179], v135, s[8:11], s44 offen sc1
    s_add_u32 s44, s44, 16384
    buffer_load_dwordx4 v[180:183], v134, s[8:11], s44 offen sc1
    buffer_load_dwordx4 v[184:187], v135, s[8:11], s44 offen sc1
    s_add_u32 s44, s44, 16384
    buffer_load_dwordx4 v[188:191], v134, s[8:11], s44 offen sc1
    buffer_load_dwordx4 v[192:195], v135, s[8:11], s44 offen sc1
    s_add_u32 s44, s44, 16384
    buffer_load_dwordx4 v[196:199], v134, s[8:11], s44 offen sc1
    buffer_load_dwordx4 v[200:203], v135, s[8:11], s44 offen sc1
    s_add_u32 s44, s44, 16384
    buffer_load_dwordx4 v[204:207], v134, s[8:11], s44 offen sc1
    buffer_load_dwordx4 v[208:211], v135, s[8:11], s44 offen sc1
    s_add_u32 s44, s44, 16384
    buffer_load_dwordx4 v[212:215], v134, s[8:11], s44 offen sc1
    buffer_load_dwordx4 v[216:219], v135, s[8:11], s44 offen sc1
    s_add_u32 s44, s44, 16384
    s_waitcnt vmcnt(10)
    v_or3_b32 v17, v164, v168, v172
    v_bitop3_b32 v17, v17, v176, 1 bitop3:0xa8
    v_cmp_ne_u32 vcc, 0, v17
    s_add_u32 s53, s53, 1
    s_cmp_ge_u32 s53, s61
    s_cselect_b32 s61, 0, s61
    s_cbranch_scc1 dm_21k3
    s_cbranch_vccnz dm_21h3
dm_21k3:
    s_cmp_eq_u32 s50, 1
    s_branch dm_21g3
dm_21x:
    v_mfma_f32_16x16x32_bf16 v[24:27], v[88:91], v[212:215], v[24:27]
    v_mfma_f32_16x16x32_bf16 v[40:43], v[88:91], v[216:219], v[40:43]
    v_mfma_f32_16x16x32_bf16 v[44:47], v[92:95], v[216:219], v[44:47]
    v_mfma_f32_16x16x32_bf16 v[28:31], v[92:95], v[212:215], v[28:31]
    v_mfma_f32_16x16x32_bf16 v[32:35], v[96:99], v[212:215], v[32:35]
    v_mfma_f32_16x16x32_bf16 v[48:51], v[96:99], v[216:219], v[48:51]
    v_mfma_f32_16x16x32_bf16 v[52:55], v[100:103], v[216:219], v[52:55]
    v_mfma_f32_16x16x32_bf16 v[36:39], v[100:103], v[212:215], v[36:39]
    s_waitcnt lgkmcnt(0)
    v_mfma_f32_16x16x32_bf16 v[24:27], v[104:107], v[220:223], v[24:27]
    s_add_u32 s44, s62, 0x5c8000
    v_mfma_f32_16x16x32_bf16 v[40:43], v[104:107], v[224:227], v[40:43]
    s_addc_u32 s45, s63, 0
    v_mfma_f32_16x16x32_bf16 v[44:47], v[108:111], v[224:227], v[44:47]
    v_mfma_f32_16x16x32_bf16 v[28:31], v[108:111], v[220:223], v[28:31]
    s_mov_b32 s46, 0x6000
    v_mfma_f32_16x16x32_bf16 v[32:35], v[112:115], v[220:223], v[32:35]
    v_mfma_f32_16x16x32_bf16 v[48:51], v[112:115], v[224:227], v[48:51]
    s_mov_b32 s47, 0x20000
    v_mfma_f32_16x16x32_bf16 v[52:55], v[116:119], v[224:227], v[52:55]
    v_mfma_f32_16x16x32_bf16 v[36:39], v[116:119], v[220:223], v[36:39]
    s_add_u32 s36, s39, 0
    v_cvt_pk_bf16_f32 v148, v24, v25
    v_cvt_pk_bf16_f32 v149, v26, v27
    v_cvt_pk_bf16_f32 v150, v28, v29
    v_cvt_pk_bf16_f32 v151, v30, v31
    v_and_b32 v148, -2, v148
    buffer_store_dwordx4 v[148:151], v2, s[16:19], s36 offen offset:0 sc1
    v_cvt_pk_bf16_f32 v152, v32, v33
    v_cvt_pk_bf16_f32 v153, v34, v35
    v_cvt_pk_bf16_f32 v154, v36, v37
    v_cvt_pk_bf16_f32 v155, v38, v39
    v_and_b32 v152, -2, v152
    buffer_store_dwordx4 v[152:155], v2, s[16:19], s36 offen offset:1024 sc1
    s_add_u32 s36, s39, 65536
    v_cvt_pk_bf16_f32 v156, v40, v41
    v_cvt_pk_bf16_f32 v157, v42, v43
    v_cvt_pk_bf16_f32 v158, v44, v45
    v_cvt_pk_bf16_f32 v159, v46, v47
    v_and_b32 v156, -2, v156
    buffer_store_dwordx4 v[156:159], v2, s[16:19], s36 offen offset:0 sc1
    v_cvt_pk_bf16_f32 v160, v48, v49
    v_cvt_pk_bf16_f32 v161, v50, v51
    v_cvt_pk_bf16_f32 v162, v52, v53
    v_cvt_pk_bf16_f32 v163, v54, v55
    v_and_b32 v160, -2, v160
    buffer_store_dwordx4 v[160:163], v2, s[16:19], s36 offen offset:1024 sc1
    s_barrier
    s_lshl_b32 s36, s37, 11
    v_add_u32 v7, s36, v2
    ds_write_b128 v7, v[148:151] offset:0
    ds_write_b128 v7, v[152:155] offset:1024
    ds_write_b128 v7, v[156:159] offset:2048
    ds_write_b128 v7, v[160:163] offset:3072
    v_lshlrev_b32 v24, 16, v148
    v_and_b32 v25, 0xffff0000, v148
    v_lshlrev_b32 v26, 16, v149
    v_and_b32 v27, 0xffff0000, v149
    v_lshlrev_b32 v28, 16, v150
    v_and_b32 v29, 0xffff0000, v150
    v_lshlrev_b32 v30, 16, v151
    v_and_b32 v31, 0xffff0000, v151
    v_lshlrev_b32 v32, 16, v152
    v_and_b32 v33, 0xffff0000, v152
    v_lshlrev_b32 v34, 16, v153
    v_and_b32 v35, 0xffff0000, v153
    v_lshlrev_b32 v36, 16, v154
    v_and_b32 v37, 0xffff0000, v154
    v_lshlrev_b32 v38, 16, v155
    v_and_b32 v39, 0xffff0000, v155
    v_lshlrev_b32 v40, 16, v156
    v_and_b32 v41, 0xffff0000, v156
    v_lshlrev_b32 v42, 16, v157
    v_and_b32 v43, 0xffff0000, v157
    v_lshlrev_b32 v44, 16, v158
    v_and_b32 v45, 0xffff0000, v158
    v_lshlrev_b32 v46, 16, v159
    v_and_b32 v47, 0xffff0000, v159
    v_lshlrev_b32 v48, 16, v160
    v_and_b32 v49, 0xffff0000, v160
    v_lshlrev_b32 v50, 16, v161
    v_and_b32 v51, 0xffff0000, v161
    v_lshlrev_b32 v52, 16, v162
    v_and_b32 v53, 0xffff0000, v162
    v_lshlrev_b32 v54, 16, v163
    v_and_b32 v55, 0xffff0000, v163
    s_add_u32 s53, s55, 512
    v_mov_b32 v8, 1
    v_mov_b32 v9, 162816
    v_mov_b32 v11, 0
    s_mov_b64 exec, 1
    s_waitcnt vmcnt(0)
    ds_add_rtn_u32 v10, v9, v8
    s_waitcnt lgkmcnt(0)
    v_readfirstlane_b32 s54, v10
    s_nop 0
    s_and_b32 s54, s54, 3
    s_cmp_lg_u32 s54, 3
    s_cbranch_scc1 pub_22
    buffer_atomic_add v8, v11, s[56:59], s53 offen sc1
    v_mov_b32 v9, 162872
    ds_add_u32 v9, v8
pub_22:
    s_mov_b64 exec, -1
    s_waitcnt lgkmcnt(0)
    s_barrier
    v_pk_add_f32 v[142:143], v[24:25], v[26:27]
    v_pk_mul_f32 v[136:137], v[24:25], v[24:25]
    v_pk_fma_f32 v[136:137], v[26:27], v[26:27], v[136:137]
    v_pk_add_f32 v[142:143], v[142:143], v[28:29]
    v_pk_fma_f32 v[136:137], v[28:29], v[28:29], v[136:137]
    v_pk_add_f32 v[142:143], v[142:143], v[30:31]
    v_pk_fma_f32 v[136:137], v[30:31], v[30:31], v[136:137]
    v_pk_add_f32 v[142:143], v[142:143], v[32:33]
    v_pk_fma_f32 v[136:137], v[32:33], v[32:33], v[136:137]
    v_pk_add_f32 v[142:143], v[142:143], v[34:35]
    v_pk_fma_f32 v[136:137], v[34:35], v[34:35], v[136:137]
    v_pk_add_f32 v[142:143], v[142:143], v[36:37]
    v_pk_fma_f32 v[136:137], v[36:37], v[36:37], v[136:137]
    v_pk_add_f32 v[142:143], v[142:143], v[38:39]
    v_pk_fma_f32 v[136:137], v[38:39], v[38:39], v[136:137]
    v_add_f32 v138, v142, v143
    v_add_f32 v139, v136, v137
    v_mov_b32 v142, v138
    v_mov_b32 v143, v139
    s_nop 0
    v_permlane16_swap_b32 v138, v142
    v_permlane16_swap_b32 v139, v143
    v_pk_add_f32 v[138:139], v[138:139], v[142:143]
    v_mov_b32 v142, v138
    v_mov_b32 v143, v139
    s_nop 0
    v_permlane32_swap_b32 v138, v142
    v_permlane32_swap_b32 v139, v143
    v_pk_add_f32 v[138:139], v[138:139], v[142:143]
    v_pk_add_f32 v[142:143], v[40:41], v[42:43]
    v_pk_mul_f32 v[136:137], v[40:41], v[40:41]
    v_pk_fma_f32 v[136:137], v[42:43], v[42:43], v[136:137]
    v_pk_add_f32 v[142:143], v[142:143], v[44:45]
    v_pk_fma_f32 v[136:137], v[44:45], v[44:45], v[136:137]
    v_pk_add_f32 v[142:143], v[142:143], v[46:47]
    v_pk_fma_f32 v[136:137], v[46:47], v[46:47], v[136:137]
    v_pk_add_f32 v[142:143], v[142:143], v[48:49]
    v_pk_fma_f32 v[136:137], v[48:49], v[48:49], v[136:137]
    v_pk_add_f32 v[142:143], v[142:143], v[50:51]
    v_pk_fma_f32 v[136:137], v[50:51], v[50:51], v[136:137]
    v_pk_add_f32 v[142:143], v[142:143], v[52:53]
    v_pk_fma_f32 v[136:137], v[52:53], v[52:53], v[136:137]
    v_pk_add_f32 v[142:143], v[142:143], v[54:55]
    v_pk_fma_f32 v[136:137], v[54:55], v[54:55], v[136:137]
    v_add_f32 v140, v142, v143
    v_add_f32 v141, v136, v137
    v_mov_b32 v142, v140
    v_mov_b32 v143, v141
    s_nop 0
    v_permlane16_swap_b32 v140, v142
    v_permlane16_swap_b32 v141, v143
    v_pk_add_f32 v[140:141], v[140:141], v[142:143]
    v_mov_b32 v142, v140
    v_mov_b32 v143, v141
    s_nop 0
    v_permlane32_swap_b32 v140, v142
    v_permlane32_swap_b32 v141, v143
    v_pk_add_f32 v[140:141], v[140:141], v[142:143]
    v_cmp_eq_u32 vcc, 0, v23
    s_nop 1
    v_cndmask_b32 v138, v140, v138, vcc
    v_cndmask_b32 v139, v141, v139, vcc
    s_lshr_b32 s53, s29, 3
    s_lshl_b32 s53, s53, 14
    s_and_b32 s40, s29, 7
    s_lshl_b32 s40, s40, 10
    s_add_u32 s40, s40, s53
    s_lshl_b32 s36, s34, 8
    s_add_u32 s40, s40, s36
    v_lshlrev_b32 v7, 3, v1
    s_bfm_b64 exec, 32, 0
    buffer_store_dwordx2 v[138:139], v7, s[44:47], s40 offen sc1
    s_mov_b64 exec, -1
    s_lshr_b32 s34, s30, 1
    s_and_b32 s35, s30, 1
    v_and_b32 v22, 15, v1
    v_lshrrev_b32 v23, 4, v1
    s_mul_i32 s37, s34, 4
    s_mul_i32 s38, s29, 14
    s_mul_i32 s36, s35, 7
    s_add_u32 s38, s38, s36
    s_mul_i32 s36, s34, 8192
    v_add_u32 v12, s36, v2
    v_lshrrev_b32 v6, 2, v1
    v_mul_u32_u24 v13, 448, v6
    v_and_b32 v7, 3, v1
    v_lshl_add_u32 v13, v7, 3, v13
    v_add_u32 v13, 73728, v13
    s_mul_i32 s36, s35, 224
    v_add_u32 v13, s36, v13
    v_bfe_u32 v6, v1, 4, 1
    v_lshlrev_b32 v6, 5, v6
    s_cmp_eq_u32 s35, 0
    s_cselect_b32 s36, 1, -1
    v_mul_lo_u32 v6, v6, s36
    v_sub_u32 v14, v13, v6
    v_add_u32 v13, v13, v6
    v_mov_b32 v17, v12
    s_mov_b32 s42, 0
    s_mov_b32 s43, 0
    s_mov_b32 s48, 57344
    v_add_u32 v18, 57344, v13
    v_add_u32 v19, 57344, v14
    ds_read_b128 v[136:139], v17 offset:0
    ds_read_b128 v[140:143], v17 offset:2048
    ds_read_b128 v[144:147], v17 offset:4096
    ds_read_b128 v[148:151], v17 offset:6144
    ds_read_b64_tr_b16 v[152:153], v18 offset:0
    ds_read_b64_tr_b16 v[154:155], v18 offset:7168
    ds_read_b64_tr_b16 v[156:157], v19 offset:32
    ds_read_b64_tr_b16 v[158:159], v19 offset:7200
    ds_read_b64_tr_b16 v[160:161], v18 offset:64
    ds_read_b64_tr_b16 v[162:163], v18 offset:7232
    ds_read_b64_tr_b16 v[164:165], v19 offset:96
    ds_read_b64_tr_b16 v[166:167], v19 offset:7264
    ds_read_b64_tr_b16 v[168:169], v18 offset:128
    ds_read_b64_tr_b16 v[170:171], v18 offset:7296
    ds_read_b64_tr_b16 v[172:173], v19 offset:160
    ds_read_b64_tr_b16 v[174:175], v19 offset:7328
    ds_read_b64_tr_b16 v[176:177], v18 offset:192
    ds_read_b64_tr_b16 v[178:179], v18 offset:7360
    s_waitcnt lgkmcnt(12)
    v_mfma_f32_16x16x32_bf16 v[24:27], v[152:155], v[136:139], 0
    ds_read_b128 v[180:183], v17 offset:1024
    s_add_u32 s42, s42, 16384
    v_mfma_f32_16x16x32_bf16 v[52:55], v[152:155], v[140:143], 0
    ds_read_b128 v[184:187], v17 offset:3072
    s_cmp_eq_u32 s42, 49152
    v_mfma_f32_16x16x32_bf16 v[80:83], v[152:155], v[144:147], 0
    ds_read_b128 v[188:191], v17 offset:5120
    s_cselect_b32 s42, 0, s42
    v_mfma_f32_16x16x32_bf16 v[108:111], v[152:155], v[148:151], 0
    ds_read_b128 v[192:195], v17 offset:7168
    s_waitcnt lgkmcnt(14)
    v_mfma_f32_16x16x32_bf16 v[112:115], v[156:159], v[148:151], 0
    ds_read_b64_tr_b16 v[196:197], v18 offset:14336
    s_add_u32 s48, s48, 28672
    v_mfma_f32_16x16x32_bf16 v[84:87], v[156:159], v[144:147], 0
    ds_read_b64_tr_b16 v[198:199], v18 offset:21504
    s_cmp_eq_u32 s48, 86016
    v_mfma_f32_16x16x32_bf16 v[56:59], v[156:159], v[140:143], 0
    ds_read_b64_tr_b16 v[200:201], v19 offset:14368
    s_cselect_b32 s48, 0, s48
    v_mfma_f32_16x16x32_bf16 v[28:31], v[156:159], v[136:139], 0
    ds_read_b64_tr_b16 v[202:203], v19 offset:21536
    s_waitcnt lgkmcnt(8)
    v_mfma_f32_16x16x32_bf16 v[32:35], v[160:163], v[136:139], 0
    ds_read_b64_tr_b16 v[204:205], v18 offset:14400
    v_add_u32 v17, s42, v12
    v_mfma_f32_16x16x32_bf16 v[60:63], v[160:163], v[140:143], 0
    ds_read_b64_tr_b16 v[206:207], v18 offset:21568
    v_mfma_f32_16x16x32_bf16 v[88:91], v[160:163], v[144:147], 0
    ds_read_b64_tr_b16 v[208:209], v19 offset:14432
    v_mfma_f32_16x16x32_bf16 v[116:119], v[160:163], v[148:151], 0
    ds_read_b64_tr_b16 v[210:211], v19 offset:21600
    v_mfma_f32_16x16x32_bf16 v[120:123], v[164:167], v[148:151], 0
    ds_read_b64_tr_b16 v[212:213], v18 offset:14464
    v_mfma_f32_16x16x32_bf16 v[92:95], v[164:167], v[144:147], 0
    ds_read_b64_tr_b16 v[214:215], v18 offset:21632
    v_mfma_f32_16x16x32_bf16 v[64:67], v[164:167], v[140:143], 0
    ds_read_b64_tr_b16 v[216:217], v19 offset:14496
    v_mfma_f32_16x16x32_bf16 v[36:39], v[164:167], v[136:139], 0
    ds_read_b64_tr_b16 v[218:219], v19 offset:21664
    v_add_u32 v19, s48, v14
    v_mfma_f32_16x16x32_bf16 v[40:43], v[168:171], v[136:139], 0
    ds_read_b64_tr_b16 v[220:221], v18 offset:14528
    v_mfma_f32_16x16x32_bf16 v[68:71], v[168:171], v[140:143], 0
    ds_read_b64_tr_b16 v[222:223], v18 offset:21696
    v_add_u32 v18, s48, v13
    v_mfma_f32_16x16x32_bf16 v[96:99], v[168:171], v[144:147], 0
    v_mfma_f32_16x16x32_bf16 v[124:127], v[168:171], v[148:151], 0
    v_mfma_f32_16x16x32_bf16 v[128:131], v[172:175], v[148:151], 0
    v_mfma_f32_16x16x32_bf16 v[100:103], v[172:175], v[144:147], 0
    v_mfma_f32_16x16x32_bf16 v[72:75], v[172:175], v[140:143], 0
    v_mfma_f32_16x16x32_bf16 v[44:47], v[172:175], v[136:139], 0
    v_mfma_f32_16x16x32_bf16 v[48:51], v[176:179], v[136:139], 0
    v_mfma_f32_16x16x32_bf16 v[76:79], v[176:179], v[140:143], 0
    v_mfma_f32_16x16x32_bf16 v[104:107], v[176:179], v[144:147], 0
    v_mfma_f32_16x16x32_bf16 v[132:135], v[176:179], v[148:151], 0
    s_waitcnt lgkmcnt(12)
    v_mfma_f32_16x16x32_bf16 v[24:27], v[196:199], v[180:183], v[24:27]
    s_add_u32 s43, s43, 1
    s_mul_i32 s36, s35, 448
    s_add_u32 s36, s36, 159744
    v_lshlrev_b32 v6, 4, v23
    v_mfma_f32_16x16x32_bf16 v[52:55], v[196:199], v[184:187], v[52:55]
    v_add_u32 v6, s36, v6
    s_lshl_b32 s36, s37, 8
    s_add_u32 s36, s36, 160768
    v_lshlrev_b32 v7, 4, v22
    v_mfma_f32_16x16x32_bf16 v[80:83], v[196:199], v[188:191], v[80:83]
    v_add_u32 v7, s36, v7
    s_add_u32 s16, s62, 0x400000
    s_addc_u32 s17, s63, 0
    s_mov_b32 s18, 0x1be000
    v_mfma_f32_16x16x32_bf16 v[108:111], v[196:199], v[192:195], v[108:111]
    s_mov_b32 s19, 0x20000
    s_mul_i32 s39, s37, 229376
    s_lshr_b32 s36, s38, 1
    s_waitcnt lgkmcnt(0)
    v_mfma_f32_16x16x32_bf16 v[112:115], v[200:203], v[192:195], v[112:115]
    s_add_u32 s36, s36, 0
    s_lshr_b32 s53, s36, 3
    s_lshl_b32 s53, s53, 14
    s_and_b32 s44, s36, 7
    v_mfma_f32_16x16x32_bf16 v[84:87], v[200:203], v[188:191], v[84:87]
    s_lshl_b32 s44, s44, 10
    s_add_u32 s44, s44, s53
    s_add_u32 s44, s44, s39
    s_lshr_b32 s36, s38, 1
    v_mfma_f32_16x16x32_bf16 v[56:59], v[200:203], v[184:187], v[56:59]
    s_add_u32 s36, s36, 1
    s_lshr_b32 s53, s36, 3
    s_lshl_b32 s53, s53, 14
    s_and_b32 s45, s36, 7
    v_mfma_f32_16x16x32_bf16 v[28:31], v[200:203], v[180:183], v[28:31]
    s_lshl_b32 s45, s45, 10
    s_add_u32 s45, s45, s53
    s_add_u32 s45, s45, s39
    s_lshr_b32 s36, s38, 1
    v_mfma_f32_16x16x32_bf16 v[32:35], v[204:207], v[180:183], v[32:35]
    s_add_u32 s36, s36, 2
    s_lshr_b32 s53, s36, 3
    s_lshl_b32 s53, s53, 14
    s_and_b32 s46, s36, 7
    v_mfma_f32_16x16x32_bf16 v[60:63], v[204:207], v[184:187], v[60:63]
    s_lshl_b32 s46, s46, 10
    s_add_u32 s46, s46, s53
    s_add_u32 s46, s46, s39
    s_lshr_b32 s36, s38, 1
    v_mfma_f32_16x16x32_bf16 v[88:91], v[204:207], v[188:191], v[88:91]
    s_add_u32 s36, s36, 3
    s_lshr_b32 s53, s36, 3
    s_lshl_b32 s53, s53, 14
    s_and_b32 s47, s36, 7
    v_mfma_f32_16x16x32_bf16 v[116:119], v[204:207], v[192:195], v[116:119]
    s_lshl_b32 s47, s47, 10
    s_add_u32 s47, s47, s53
    s_add_u32 s47, s47, s39
    v_lshrrev_b32 v226, 2, v1
    v_mfma_f32_16x16x32_bf16 v[120:123], v[208:211], v[192:195], v[120:123]
    v_mul_u32_u24 v240, 256, v226
    v_and_b32 v227, 3, v1
    v_lshl_add_u32 v240, v227, 3, v240
    v_add_u32 v240, 49152, v240
    v_mfma_f32_16x16x32_bf16 v[92:95], v[208:211], v[188:191], v[92:95]
    v_and_b32 v226, 7, v226
    s_mul_i32 s36, s35, 4
    s_add_u32 s36, s36, 3
    v_xor_b32 v227, s36, v226
    v_mfma_f32_16x16x32_bf16 v[64:67], v[208:211], v[184:187], v[64:67]
    v_lshl_add_u32 v243, v227, 5, v240
    s_mul_i32 s36, s35, 4
    s_add_u32 s36, s36, 2
    v_xor_b32 v227, s36, v226
    v_mfma_f32_16x16x32_bf16 v[36:39], v[208:211], v[180:183], v[36:39]
    v_lshl_add_u32 v242, v227, 5, v240
    s_mul_i32 s36, s35, 4
    s_add_u32 s36, s36, 1
    v_xor_b32 v227, s36, v226
    v_mfma_f32_16x16x32_bf16 v[40:43], v[212:215], v[180:183], v[40:43]
    v_lshl_add_u32 v241, v227, 5, v240
    s_mul_i32 s36, s35, 4
    s_add_u32 s36, s36, 0
    v_xor_b32 v227, s36, v226
    v_mfma_f32_16x16x32_bf16 v[68:71], v[212:215], v[184:187], v[68:71]
    v_lshl_add_u32 v240, v227, 5, v240
    s_lshl_b32 s38, s33, 3
    s_lshl_b32 s36, s35, 2
    s_add_u32 s38, s38, s36
    v_mfma_f32_16x16x32_bf16 v[96:99], v[212:215], v[188:191], v[96:99]
    s_lshr_b32 s36, s38, 1
    s_lshr_b32 s53, s36, 3
    s_lshl_b32 s53, s53, 14
    s_and_b32 s39, s36, 7
    v_mfma_f32_16x16x32_bf16 v[124:127], v[212:215], v[192:195], v[124:127]
    s_lshl_b32 s39, s39, 10
    s_add_u32 s39, s39, s53
    s_lshl_b32 s36, s37, 16
    s_add_u32 s39, s39, s36
    v_mfma_f32_16x16x32_bf16 v[128:131], v[216:219], v[192:195], v[128:131]
    s_lshl_b32 s40, s31, 17
    s_add_u32 s40, s40, s39
    s_xor_b32 s41, s31, 1
    s_lshl_b32 s41, s41, 17
    v_mfma_f32_16x16x32_bf16 v[100:103], v[216:219], v[188:191], v[100:103]
    s_add_u32 s41, s41, s39
    s_mov_b32 s84, s62
    s_mov_b32 s85, s63
    s_mov_b32 s86, 0x7e000
    v_mfma_f32_16x16x32_bf16 v[72:75], v[216:219], v[184:187], v[72:75]
    s_mov_b32 s87, 0x20000
    s_add_u32 s88, s62, 0x80000
    s_addc_u32 s89, s63, 0
    s_mov_b32 s90, 0x7e000
    v_mfma_f32_16x16x32_bf16 v[44:47], v[216:219], v[180:183], v[44:47]
    s_mov_b32 s91, 0x20000
    s_lshl_b32 s36, s37, 1
    s_add_u32 s36, s36, s35
    s_lshl_b32 s36, s36, 10
    v_mfma_f32_16x16x32_bf16 v[48:51], v[220:223], v[180:183], v[48:51]
    v_add_u32 v244, s36, v2
    v_mov_b32 v245, 1
    v_mov_b32 v246, 162880
    v_lshrrev_b32 v238, 1, v23
    v_mfma_f32_16x16x32_bf16 v[76:79], v[220:223], v[184:187], v[76:79]
    v_lshlrev_b32 v238, 8, v238
    v_lshl_add_u32 v238, v22, 4, v238
    v_and_b32 v224, 1, v23
    v_lshl_add_u32 v238, v224, 3, v238
    v_mfma_f32_16x16x32_bf16 v[104:107], v[220:223], v[188:191], v[104:107]
    v_mfma_f32_16x16x32_bf16 v[132:135], v[220:223], v[192:195], v[132:135]
    s_add_u32 s53, s55, 1408
    v_mov_b32 v8, 1
    v_mov_b32 v9, 162864
    v_mov_b32 v11, 0
    s_mov_b64 exec, 1
    s_waitcnt vmcnt(0)
    ds_add_rtn_u32 v10, v9, v8
    s_waitcnt lgkmcnt(0)
    v_readfirstlane_b32 s54, v10
    s_nop 0
    s_and_b32 s54, s54, 3
    s_cmp_lg_u32 s54, 3
    s_cbranch_scc1 pub_23
    buffer_atomic_add v8, v11, s[56:59], s53 offen sc1
pub_23:
    s_mov_b64 exec, -1
    s_barrier
    ds_read_b128 v[136:139], v17 offset:0
    ds_read_b128 v[140:143], v17 offset:2048
    ds_read_b128 v[144:147], v17 offset:4096
    ds_read_b128 v[148:151], v17 offset:6144
    ds_read_b64_tr_b16 v[152:153], v18 offset:0
    ds_read_b64_tr_b16 v[154:155], v18 offset:7168
    ds_read_b64_tr_b16 v[156:157], v19 offset:32
    ds_read_b64_tr_b16 v[158:159], v19 offset:7200
    ds_read_b64_tr_b16 v[160:161], v18 offset:64
    ds_read_b64_tr_b16 v[162:163], v18 offset:7232
    ds_read_b64_tr_b16 v[164:165], v19 offset:96
    ds_read_b64_tr_b16 v[166:167], v19 offset:7264
    ds_read_b64_tr_b16 v[168:169], v18 offset:128
    ds_read_b64_tr_b16 v[170:171], v18 offset:7296
    ds_read_b64_tr_b16 v[172:173], v19 offset:160
    ds_read_b64_tr_b16 v[174:175], v19 offset:7328
    ds_read_b64_tr_b16 v[176:177], v18 offset:192
    ds_read_b64_tr_b16 v[178:179], v18 offset:7360
    s_waitcnt lgkmcnt(12)
mm_24:
    v_mfma_f32_16x16x32_bf16 v[24:27], v[152:155], v[136:139], v[24:27]
    ds_read_b128 v[180:183], v17 offset:1024
    s_add_u32 s42, s42, 16384
    v_mfma_f32_16x16x32_bf16 v[52:55], v[152:155], v[140:143], v[52:55]
    ds_read_b128 v[184:187], v17 offset:3072
    s_cmp_eq_u32 s42, 49152
    v_mfma_f32_16x16x32_bf16 v[80:83], v[152:155], v[144:147], v[80:83]
    ds_read_b128 v[188:191], v17 offset:5120
    s_cselect_b32 s42, 0, s42
    v_mfma_f32_16x16x32_bf16 v[108:111], v[152:155], v[148:151], v[108:111]
    ds_read_b128 v[192:195], v17 offset:7168
    s_waitcnt lgkmcnt(14)
    v_mfma_f32_16x16x32_bf16 v[112:115], v[156:159], v[148:151], v[112:115]
    ds_read_b64_tr_b16 v[196:197], v18 offset:14336
    s_add_u32 s48, s48, 28672
    v_mfma_f32_16x16x32_bf16 v[84:87], v[156:159], v[144:147], v[84:87]
    ds_read_b64_tr_b16 v[198:199], v18 offset:21504
    s_cmp_eq_u32 s48, 86016
    v_mfma_f32_16x16x32_bf16 v[56:59], v[156:159], v[140:143], v[56:59]
    ds_read_b64_tr_b16 v[200:201], v19 offset:14368
    s_cselect_b32 s48, 0, s48
    v_mfma_f32_16x16x32_bf16 v[28:31], v[156:159], v[136:139], v[28:31]
    ds_read_b64_tr_b16 v[202:203], v19 offset:21536
    s_waitcnt lgkmcnt(8)
    v_mfma_f32_16x16x32_bf16 v[32:35], v[160:163], v[136:139], v[32:35]
    ds_read_b64_tr_b16 v[204:205], v18 offset:14400
    v_add_u32 v17, s42, v12
    v_mfma_f32_16x16x32_bf16 v[60:63], v[160:163], v[140:143], v[60:63]
    ds_read_b64_tr_b16 v[206:207], v18 offset:21568
    v_mfma_f32_16x16x32_bf16 v[88:91], v[160:163], v[144:147], v[88:91]
    ds_read_b64_tr_b16 v[208:209], v19 offset:14432
    v_mfma_f32_16x16x32_bf16 v[116:119], v[160:163], v[148:151], v[116:119]
    ds_read_b64_tr_b16 v[210:211], v19 offset:21600
    v_mfma_f32_16x16x32_bf16 v[120:123], v[164:167], v[148:151], v[120:123]
    ds_read_b64_tr_b16 v[212:213], v18 offset:14464
    v_mfma_f32_16x16x32_bf16 v[92:95], v[164:167], v[144:147], v[92:95]
    ds_read_b64_tr_b16 v[214:215], v18 offset:21632
    v_mfma_f32_16x16x32_bf16 v[64:67], v[164:167], v[140:143], v[64:67]
    ds_read_b64_tr_b16 v[216:217], v19 offset:14496
    v_mfma_f32_16x16x32_bf16 v[36:39], v[164:167], v[136:139], v[36:39]
    ds_read_b64_tr_b16 v[218:219], v19 offset:21664
    v_add_u32 v19, s48, v14
    v_mfma_f32_16x16x32_bf16 v[40:43], v[168:171], v[136:139], v[40:43]
    ds_read_b64_tr_b16 v[220:221], v18 offset:14528
    v_mfma_f32_16x16x32_bf16 v[68:71], v[168:171], v[140:143], v[68:71]
    ds_read_b64_tr_b16 v[222:223], v18 offset:21696
    v_add_u32 v18, s48, v13
    v_mfma_f32_16x16x32_bf16 v[96:99], v[168:171], v[144:147], v[96:99]
    v_mfma_f32_16x16x32_bf16 v[124:127], v[168:171], v[148:151], v[124:127]
    v_mfma_f32_16x16x32_bf16 v[128:131], v[172:175], v[148:151], v[128:131]
    v_mfma_f32_16x16x32_bf16 v[100:103], v[172:175], v[144:147], v[100:103]
    v_mfma_f32_16x16x32_bf16 v[72:75], v[172:175], v[140:143], v[72:75]
    v_mfma_f32_16x16x32_bf16 v[44:47], v[172:175], v[136:139], v[44:47]
    v_mfma_f32_16x16x32_bf16 v[48:51], v[176:179], v[136:139], v[48:51]
    v_mfma_f32_16x16x32_bf16 v[76:79], v[176:179], v[140:143], v[76:79]
    v_mfma_f32_16x16x32_bf16 v[104:107], v[176:179], v[144:147], v[104:107]
    v_mfma_f32_16x16x32_bf16 v[132:135], v[176:179], v[148:151], v[132:135]
    s_waitcnt lgkmcnt(12)
    v_mfma_f32_16x16x32_bf16 v[24:27], v[196:199], v[180:183], v[24:27]
    s_add_u32 s43, s43, 1
    s_cmp_lt_u32 s43, 15
    v_mfma_f32_16x16x32_bf16 v[52:55], v[196:199], v[184:187], v[52:55]
    v_mfma_f32_16x16x32_bf16 v[80:83], v[196:199], v[188:191], v[80:83]
    v_mfma_f32_16x16x32_bf16 v[108:111], v[196:199], v[192:195], v[108:111]
    s_waitcnt lgkmcnt(0)
    s_barrier
    v_mfma_f32_16x16x32_bf16 v[112:115], v[200:203], v[192:195], v[112:115]
    ds_read_b128 v[136:139], v17 offset:0
    v_mfma_f32_16x16x32_bf16 v[84:87], v[200:203], v[188:191], v[84:87]
    ds_read_b128 v[140:143], v17 offset:2048
    v_mfma_f32_16x16x32_bf16 v[56:59], v[200:203], v[184:187], v[56:59]
    ds_read_b128 v[144:147], v17 offset:4096
    v_mfma_f32_16x16x32_bf16 v[28:31], v[200:203], v[180:183], v[28:31]
    ds_read_b128 v[148:151], v17 offset:6144
    v_mfma_f32_16x16x32_bf16 v[32:35], v[204:207], v[180:183], v[32:35]
    ds_read_b64_tr_b16 v[152:153], v18 offset:0
    v_mfma_f32_16x16x32_bf16 v[60:63], v[204:207], v[184:187], v[60:63]
    ds_read_b64_tr_b16 v[154:155], v18 offset:7168
    v_mfma_f32_16x16x32_bf16 v[88:91], v[204:207], v[188:191], v[88:91]
    ds_read_b64_tr_b16 v[156:157], v19 offset:32
    v_mfma_f32_16x16x32_bf16 v[116:119], v[204:207], v[192:195], v[116:119]
    ds_read_b64_tr_b16 v[158:159], v19 offset:7200
    v_mfma_f32_16x16x32_bf16 v[120:123], v[208:211], v[192:195], v[120:123]
    ds_read_b64_tr_b16 v[160:161], v18 offset:64
    v_mfma_f32_16x16x32_bf16 v[92:95], v[208:211], v[188:191], v[92:95]
    ds_read_b64_tr_b16 v[162:163], v18 offset:7232
    v_mfma_f32_16x16x32_bf16 v[64:67], v[208:211], v[184:187], v[64:67]
    ds_read_b64_tr_b16 v[164:165], v19 offset:96
    v_mfma_f32_16x16x32_bf16 v[36:39], v[208:211], v[180:183], v[36:39]
    ds_read_b64_tr_b16 v[166:167], v19 offset:7264
    v_mfma_f32_16x16x32_bf16 v[40:43], v[212:215], v[180:183], v[40:43]
    ds_read_b64_tr_b16 v[168:169], v18 offset:128
    v_mfma_f32_16x16x32_bf16 v[68:71], v[212:215], v[184:187], v[68:71]
    ds_read_b64_tr_b16 v[170:171], v18 offset:7296
    v_mfma_f32_16x16x32_bf16 v[96:99], v[212:215], v[188:191], v[96:99]
    ds_read_b64_tr_b16 v[172:173], v19 offset:160
    v_mfma_f32_16x16x32_bf16 v[124:127], v[212:215], v[192:195], v[124:127]
    ds_read_b64_tr_b16 v[174:175], v19 offset:7328
    v_mfma_f32_16x16x32_bf16 v[128:131], v[216:219], v[192:195], v[128:131]
    ds_read_b64_tr_b16 v[176:177], v18 offset:192
    v_mfma_f32_16x16x32_bf16 v[100:103], v[216:219], v[188:191], v[100:103]
    ds_read_b64_tr_b16 v[178:179], v18 offset:7360
    v_mfma_f32_16x16x32_bf16 v[72:75], v[216:219], v[184:187], v[72:75]
    v_mfma_f32_16x16x32_bf16 v[44:47], v[216:219], v[180:183], v[44:47]
    v_mfma_f32_16x16x32_bf16 v[48:51], v[220:223], v[180:183], v[48:51]
    v_mfma_f32_16x16x32_bf16 v[76:79], v[220:223], v[184:187], v[76:79]
    v_mfma_f32_16x16x32_bf16 v[104:107], v[220:223], v[188:191], v[104:107]
    v_mfma_f32_16x16x32_bf16 v[132:135], v[220:223], v[192:195], v[132:135]
    s_waitcnt lgkmcnt(12)
    s_cbranch_scc1 mm_24
    v_mfma_f32_16x16x32_bf16 v[24:27], v[152:155], v[136:139], v[24:27]
    ds_read_b128 v[180:183], v17 offset:1024
    v_mfma_f32_16x16x32_bf16 v[52:55], v[152:155], v[140:143], v[52:55]
    ds_read_b128 v[184:187], v17 offset:3072
    v_mfma_f32_16x16x32_bf16 v[80:83], v[152:155], v[144:147], v[80:83]
    ds_read_b128 v[188:191], v17 offset:5120
    v_mfma_f32_16x16x32_bf16 v[108:111], v[152:155], v[148:151], v[108:111]
    ds_read_b128 v[192:195], v17 offset:7168
    s_waitcnt lgkmcnt(14)
    v_mfma_f32_16x16x32_bf16 v[112:115], v[156:159], v[148:151], v[112:115]
    ds_read_b64_tr_b16 v[196:197], v18 offset:14336
    v_mfma_f32_16x16x32_bf16 v[84:87], v[156:159], v[144:147], v[84:87]
    ds_read_b64_tr_b16 v[198:199], v18 offset:21504
    v_mfma_f32_16x16x32_bf16 v[56:59], v[156:159], v[140:143], v[56:59]
    ds_read_b64_tr_b16 v[200:201], v19 offset:14368
    v_mfma_f32_16x16x32_bf16 v[28:31], v[156:159], v[136:139], v[28:31]
    ds_read_b64_tr_b16 v[202:203], v19 offset:21536
    s_waitcnt lgkmcnt(8)
    v_mfma_f32_16x16x32_bf16 v[32:35], v[160:163], v[136:139], v[32:35]
    ds_read_b64_tr_b16 v[204:205], v18 offset:14400
    v_mfma_f32_16x16x32_bf16 v[60:63], v[160:163], v[140:143], v[60:63]
    ds_read_b64_tr_b16 v[206:207], v18 offset:21568
    v_mfma_f32_16x16x32_bf16 v[88:91], v[160:163], v[144:147], v[88:91]
    ds_read_b64_tr_b16 v[208:209], v19 offset:14432
    v_mfma_f32_16x16x32_bf16 v[116:119], v[160:163], v[148:151], v[116:119]
    ds_read_b64_tr_b16 v[210:211], v19 offset:21600
    v_mfma_f32_16x16x32_bf16 v[120:123], v[164:167], v[148:151], v[120:123]
    ds_read_b64_tr_b16 v[212:213], v18 offset:14464
    v_mfma_f32_16x16x32_bf16 v[92:95], v[164:167], v[144:147], v[92:95]
    ds_read_b64_tr_b16 v[214:215], v18 offset:21632
    v_mfma_f32_16x16x32_bf16 v[64:67], v[164:167], v[140:143], v[64:67]
    ds_read_b64_tr_b16 v[216:217], v19 offset:14496
    v_mfma_f32_16x16x32_bf16 v[36:39], v[164:167], v[136:139], v[36:39]
    ds_read_b64_tr_b16 v[218:219], v19 offset:21664
    v_mfma_f32_16x16x32_bf16 v[40:43], v[168:171], v[136:139], v[40:43]
    ds_read_b64_tr_b16 v[220:221], v18 offset:14528
    v_mfma_f32_16x16x32_bf16 v[68:71], v[168:171], v[140:143], v[68:71]
    ds_read_b64_tr_b16 v[222:223], v18 offset:21696
    v_mfma_f32_16x16x32_bf16 v[96:99], v[168:171], v[144:147], v[96:99]
    v_mfma_f32_16x16x32_bf16 v[124:127], v[168:171], v[148:151], v[124:127]
    v_mfma_f32_16x16x32_bf16 v[128:131], v[172:175], v[148:151], v[128:131]
    v_mfma_f32_16x16x32_bf16 v[100:103], v[172:175], v[144:147], v[100:103]
    v_mfma_f32_16x16x32_bf16 v[72:75], v[172:175], v[140:143], v[72:75]
    v_mfma_f32_16x16x32_bf16 v[44:47], v[172:175], v[136:139], v[44:47]
    v_mfma_f32_16x16x32_bf16 v[48:51], v[176:179], v[136:139], v[48:51]
    v_mfma_f32_16x16x32_bf16 v[76:79], v[176:179], v[140:143], v[76:79]
    v_mfma_f32_16x16x32_bf16 v[104:107], v[176:179], v[144:147], v[104:107]
    v_mfma_f32_16x16x32_bf16 v[132:135], v[176:179], v[148:151], v[132:135]
    s_waitcnt lgkmcnt(0)
    s_barrier
    v_mfma_f32_16x16x32_bf16 v[24:27], v[196:199], v[180:183], v[24:27]
    ds_read_b128 v[136:139], v6 offset:0
    v_mfma_f32_16x16x32_bf16 v[52:55], v[196:199], v[184:187], v[52:55]
    ds_read_b128 v[140:143], v6 offset:64
    v_mfma_f32_16x16x32_bf16 v[80:83], v[196:199], v[188:191], v[80:83]
    ds_read_b128 v[144:147], v6 offset:128
    v_mfma_f32_16x16x32_bf16 v[108:111], v[196:199], v[192:195], v[108:111]
    ds_read_b128 v[148:151], v6 offset:192
    v_mfma_f32_16x16x32_bf16 v[112:115], v[200:203], v[192:195], v[112:115]
    ds_read_b128 v[152:155], v6 offset:256
    v_mfma_f32_16x16x32_bf16 v[84:87], v[200:203], v[188:191], v[84:87]
    ds_read_b128 v[156:159], v6 offset:320
    v_mfma_f32_16x16x32_bf16 v[56:59], v[200:203], v[184:187], v[56:59]
    ds_read_b128 v[160:163], v6 offset:384
    v_mfma_f32_16x16x32_bf16 v[28:31], v[200:203], v[180:183], v[28:31]
    ds_read_b128 v[164:167], v7 offset:0
    v_mfma_f32_16x16x32_bf16 v[32:35], v[204:207], v[180:183], v[32:35]
    ds_read_b128 v[168:171], v7 offset:256
    v_mfma_f32_16x16x32_bf16 v[60:63], v[204:207], v[184:187], v[60:63]
    ds_read_b128 v[172:175], v7 offset:512
    v_mfma_f32_16x16x32_bf16 v[88:91], v[204:207], v[188:191], v[88:91]
    ds_read_b128 v[176:179], v7 offset:768
    v_mov_b32 v13, v240
    v_mfma_f32_16x16x32_bf16 v[116:119], v[204:207], v[192:195], v[116:119]
    v_add_u32 v18, 0, v240
    v_mov_b32 v14, v241
    v_mfma_f32_16x16x32_bf16 v[120:123], v[208:211], v[192:195], v[120:123]
    v_add_u32 v19, 0, v241
    v_mov_b32 v15, v242
    v_mfma_f32_16x16x32_bf16 v[92:95], v[208:211], v[188:191], v[92:95]
    v_add_u32 v20, 0, v242
    v_mov_b32 v16, v243
    v_mfma_f32_16x16x32_bf16 v[64:67], v[208:211], v[184:187], v[64:67]
    v_add_u32 v21, 0, v243
    s_mov_b32 s42, 0
    s_mov_b32 s43, 0
    v_mfma_f32_16x16x32_bf16 v[36:39], v[208:211], v[180:183], v[36:39]
    s_mov_b32 s48, 0
    v_mov_b32 v17, v12
    v_and_b32 v199, 7, v0
    v_mfma_f32_16x16x32_bf16 v[40:43], v[212:215], v[180:183], v[40:43]
    v_lshrrev_b32 v228, 6, v0
    v_lshlrev_b32 v228, 4, v228
    v_mfma_f32_16x16x32_bf16 v[68:71], v[212:215], v[184:187], v[68:71]
    v_bfe_u32 v229, v0, 3, 3
    v_add_u32 v228, v228, v229
    s_lshr_b32 s78, s29, 1
    v_mfma_f32_16x16x32_bf16 v[96:99], v[212:215], v[188:191], v[96:99]
    s_lshl_b32 s78, s78, 16
    s_and_b32 s79, s29, 1
    s_lshl_b32 s79, s79, 7
    v_mfma_f32_16x16x32_bf16 v[124:127], v[212:215], v[192:195], v[124:127]
    s_add_u32 s78, s78, s79
    s_lshr_b32 s79, s30, 1
    s_lshl_b32 s79, s79, 13
    v_mfma_f32_16x16x32_bf16 v[128:131], v[216:219], v[192:195], v[128:131]
    s_add_u32 s78, s78, s79
    v_lshlrev_b32 v196, 8, v228
    v_lshl_add_u32 v196, v199, 4, v196
    v_mfma_f32_16x16x32_bf16 v[100:103], v[216:219], v[188:191], v[100:103]
    v_add_u32 v196, s78, v196
    v_mfma_f32_16x16x32_bf16 v[72:75], v[216:219], v[184:187], v[72:75]
    v_mfma_f32_16x16x32_bf16 v[44:47], v[216:219], v[180:183], v[44:47]
    v_mfma_f32_16x16x32_bf16 v[48:51], v[220:223], v[180:183], v[48:51]
    v_mfma_f32_16x16x32_bf16 v[76:79], v[220:223], v[184:187], v[76:79]
    v_mfma_f32_16x16x32_bf16 v[104:107], v[220:223], v[188:191], v[104:107]
    v_mfma_f32_16x16x32_bf16 v[132:135], v[220:223], v[192:195], v[132:135]
    s_waitcnt lgkmcnt(0)
    s_cmp_eq_u32 s35, 1
    s_cbranch_scc1 G3_e1
    v_pk_fma_f32 v[24:25], v[164:165], v[136:137], v[24:25] op_sel_hi:[0,1,1] neg_lo:[1,0,0] neg_hi:[1,0,0]
    v_pk_fma_f32 v[26:27], v[164:165], v[138:139], v[26:27] op_sel_hi:[0,1,1] neg_lo:[1,0,0] neg_hi:[1,0,0]
    v_pk_mul_f32 v[226:227], v[24:25], v[24:25]
    v_pk_mul_f32 v[228:229], v[26:27], v[26:27]
    v_pk_fma_f32 v[226:227], v[226:227], v[166:167], v[166:167] op_sel:[0,1,0] op_sel_hi:[1,1,0]
    v_pk_fma_f32 v[228:229], v[228:229], v[166:167], v[166:167] op_sel:[0,1,0] op_sel_hi:[1,1,0]
    v_pk_mul_f32 v[226:227], v[226:227], v[24:25]
    v_pk_mul_f32 v[228:229], v[228:229], v[26:27]
    v_exp_f32 v226, v226
    v_exp_f32 v227, v227
    v_exp_f32 v228, v228
    v_exp_f32 v229, v229
    v_pk_fma_f32 v[226:227], v[226:227], v[164:165], v[164:165] op_sel:[0,1,1] op_sel_hi:[1,1,1]
    v_pk_fma_f32 v[228:229], v[228:229], v[164:165], v[164:165] op_sel:[0,1,1] op_sel_hi:[1,1,1]
    v_rcp_f32 v226, v226
    v_rcp_f32 v227, v227
    v_rcp_f32 v228, v228
    v_rcp_f32 v229, v229
    v_pk_mul_f32 v[24:25], v[24:25], v[226:227]
    v_pk_mul_f32 v[26:27], v[26:27], v[228:229]
    v_pk_fma_f32 v[28:29], v[164:165], v[140:141], v[28:29] op_sel_hi:[0,1,1] neg_lo:[1,0,0] neg_hi:[1,0,0]
    v_pk_fma_f32 v[30:31], v[164:165], v[142:143], v[30:31] op_sel_hi:[0,1,1] neg_lo:[1,0,0] neg_hi:[1,0,0]
    v_pk_mul_f32 v[226:227], v[28:29], v[28:29]
    v_pk_mul_f32 v[228:229], v[30:31], v[30:31]
    v_pk_fma_f32 v[226:227], v[226:227], v[166:167], v[166:167] op_sel:[0,1,0] op_sel_hi:[1,1,0]
    v_pk_fma_f32 v[228:229], v[228:229], v[166:167], v[166:167] op_sel:[0,1,0] op_sel_hi:[1,1,0]
    v_pk_mul_f32 v[226:227], v[226:227], v[28:29]
    v_pk_mul_f32 v[228:229], v[228:229], v[30:31]
    v_exp_f32 v226, v226
    v_exp_f32 v227, v227
    v_exp_f32 v228, v228
    v_exp_f32 v229, v229
    v_pk_fma_f32 v[226:227], v[226:227], v[164:165], v[164:165] op_sel:[0,1,1] op_sel_hi:[1,1,1]
    v_pk_fma_f32 v[228:229], v[228:229], v[164:165], v[164:165] op_sel:[0,1,1] op_sel_hi:[1,1,1]
    v_rcp_f32 v226, v226
    v_rcp_f32 v227, v227
    v_rcp_f32 v228, v228
    v_rcp_f32 v229, v229
    v_pk_mul_f32 v[28:29], v[28:29], v[226:227]
    v_pk_mul_f32 v[30:31], v[30:31], v[228:229]
    v_cvt_pk_bf16_f32 v24, v24, v25
    v_cvt_pk_bf16_f32 v25, v26, v27
    v_cvt_pk_bf16_f32 v26, v28, v29
    v_cvt_pk_bf16_f32 v27, v30, v31
    v_or_b32 v24, 1, v24
    ds_write_b128 v244, v[24:27] offset:0
    s_add_u32 s36, s44, 0
    buffer_store_dwordx4 v[24:27], v2, s[16:19], s36 offen sc1
    v_pk_fma_f32 v[52:53], v[168:169], v[136:137], v[52:53] op_sel_hi:[0,1,1] neg_lo:[1,0,0] neg_hi:[1,0,0]
    v_pk_fma_f32 v[54:55], v[168:169], v[138:139], v[54:55] op_sel_hi:[0,1,1] neg_lo:[1,0,0] neg_hi:[1,0,0]
    v_pk_mul_f32 v[226:227], v[52:53], v[52:53]
    v_pk_mul_f32 v[228:229], v[54:55], v[54:55]
    v_pk_fma_f32 v[226:227], v[226:227], v[170:171], v[170:171] op_sel:[0,1,0] op_sel_hi:[1,1,0]
    v_pk_fma_f32 v[228:229], v[228:229], v[170:171], v[170:171] op_sel:[0,1,0] op_sel_hi:[1,1,0]
    v_pk_mul_f32 v[226:227], v[226:227], v[52:53]
    v_pk_mul_f32 v[228:229], v[228:229], v[54:55]
    v_exp_f32 v226, v226
    v_exp_f32 v227, v227
    v_exp_f32 v228, v228
    v_exp_f32 v229, v229
    v_pk_fma_f32 v[226:227], v[226:227], v[168:169], v[168:169] op_sel:[0,1,1] op_sel_hi:[1,1,1]
    v_pk_fma_f32 v[228:229], v[228:229], v[168:169], v[168:169] op_sel:[0,1,1] op_sel_hi:[1,1,1]
    v_rcp_f32 v226, v226
    v_rcp_f32 v227, v227
    v_rcp_f32 v228, v228
    v_rcp_f32 v229, v229
    v_pk_mul_f32 v[52:53], v[52:53], v[226:227]
    v_pk_mul_f32 v[54:55], v[54:55], v[228:229]
    v_pk_fma_f32 v[56:57], v[168:169], v[140:141], v[56:57] op_sel_hi:[0,1,1] neg_lo:[1,0,0] neg_hi:[1,0,0]
    v_pk_fma_f32 v[58:59], v[168:169], v[142:143], v[58:59] op_sel_hi:[0,1,1] neg_lo:[1,0,0] neg_hi:[1,0,0]
    v_pk_mul_f32 v[226:227], v[56:57], v[56:57]
    v_pk_mul_f32 v[228:229], v[58:59], v[58:59]
    v_pk_fma_f32 v[226:227], v[226:227], v[170:171], v[170:171] op_sel:[0,1,0] op_sel_hi:[1,1,0]
    v_pk_fma_f32 v[228:229], v[228:229], v[170:171], v[170:171] op_sel:[0,1,0] op_sel_hi:[1,1,0]
    v_pk_mul_f32 v[226:227], v[226:227], v[56:57]
    v_pk_mul_f32 v[228:229], v[228:229], v[58:59]
    v_exp_f32 v226, v226
    v_exp_f32 v227, v227
    v_exp_f32 v228, v228
    v_exp_f32 v229, v229
    v_pk_fma_f32 v[226:227], v[226:227], v[168:169], v[168:169] op_sel:[0,1,1] op_sel_hi:[1,1,1]
    v_pk_fma_f32 v[228:229], v[228:229], v[168:169], v[168:169] op_sel:[0,1,1] op_sel_hi:[1,1,1]
    v_rcp_f32 v226, v226
    v_rcp_f32 v227, v227
    v_rcp_f32 v228, v228
    v_rcp_f32 v229, v229
    v_pk_mul_f32 v[56:57], v[56:57], v[226:227]
    v_pk_mul_f32 v[58:59], v[58:59], v[228:229]
    v_cvt_pk_bf16_f32 v52, v52, v53
    v_cvt_pk_bf16_f32 v53, v54, v55
    v_cvt_pk_bf16_f32 v54, v56, v57
    v_cvt_pk_bf16_f32 v55, v58, v59
    v_or_b32 v52, 1, v52
    ds_write_b128 v244, v[52:55] offset:2048
    s_add_u32 s36, s44, 229376
    buffer_store_dwordx4 v[52:55], v2, s[16:19], s36 offen sc1
    v_pk_fma_f32 v[80:81], v[172:173], v[136:137], v[80:81] op_sel_hi:[0,1,1] neg_lo:[1,0,0] neg_hi:[1,0,0]
    v_pk_fma_f32 v[82:83], v[172:173], v[138:139], v[82:83] op_sel_hi:[0,1,1] neg_lo:[1,0,0] neg_hi:[1,0,0]
    v_pk_mul_f32 v[226:227], v[80:81], v[80:81]
    v_pk_mul_f32 v[228:229], v[82:83], v[82:83]
    v_pk_fma_f32 v[226:227], v[226:227], v[174:175], v[174:175] op_sel:[0,1,0] op_sel_hi:[1,1,0]
    v_pk_fma_f32 v[228:229], v[228:229], v[174:175], v[174:175] op_sel:[0,1,0] op_sel_hi:[1,1,0]
    v_pk_mul_f32 v[226:227], v[226:227], v[80:81]
    v_pk_mul_f32 v[228:229], v[228:229], v[82:83]
    v_exp_f32 v226, v226
    v_exp_f32 v227, v227
    v_exp_f32 v228, v228
    v_exp_f32 v229, v229
    v_pk_fma_f32 v[226:227], v[226:227], v[172:173], v[172:173] op_sel:[0,1,1] op_sel_hi:[1,1,1]
    v_pk_fma_f32 v[228:229], v[228:229], v[172:173], v[172:173] op_sel:[0,1,1] op_sel_hi:[1,1,1]
    v_rcp_f32 v226, v226
    v_rcp_f32 v227, v227
    v_rcp_f32 v228, v228
    v_rcp_f32 v229, v229
    v_pk_mul_f32 v[80:81], v[80:81], v[226:227]
    v_pk_mul_f32 v[82:83], v[82:83], v[228:229]
    v_pk_fma_f32 v[84:85], v[172:173], v[140:141], v[84:85] op_sel_hi:[0,1,1] neg_lo:[1,0,0] neg_hi:[1,0,0]
    v_pk_fma_f32 v[86:87], v[172:173], v[142:143], v[86:87] op_sel_hi:[0,1,1] neg_lo:[1,0,0] neg_hi:[1,0,0]
    v_pk_mul_f32 v[226:227], v[84:85], v[84:85]
    v_pk_mul_f32 v[228:229], v[86:87], v[86:87]
    v_pk_fma_f32 v[226:227], v[226:227], v[174:175], v[174:175] op_sel:[0,1,0] op_sel_hi:[1,1,0]
    v_pk_fma_f32 v[228:229], v[228:229], v[174:175], v[174:175] op_sel:[0,1,0] op_sel_hi:[1,1,0]
    v_pk_mul_f32 v[226:227], v[226:227], v[84:85]
    v_pk_mul_f32 v[228:229], v[228:229], v[86:87]
    v_exp_f32 v226, v226
    v_exp_f32 v227, v227
    v_exp_f32 v228, v228
    v_exp_f32 v229, v229
    v_pk_fma_f32 v[226:227], v[226:227], v[172:173], v[172:173] op_sel:[0,1,1] op_sel_hi:[1,1,1]
    v_pk_fma_f32 v[228:229], v[228:229], v[172:173], v[172:173] op_sel:[0,1,1] op_sel_hi:[1,1,1]
    v_rcp_f32 v226, v226
    v_rcp_f32 v227, v227
    v_rcp_f32 v228, v228
    v_rcp_f32 v229, v229
    v_pk_mul_f32 v[84:85], v[84:85], v[226:227]
    v_pk_mul_f32 v[86:87], v[86:87], v[228:229]
    v_cvt_pk_bf16_f32 v80, v80, v81
    v_cvt_pk_bf16_f32 v81, v82, v83
    v_cvt_pk_bf16_f32 v82, v84, v85
    v_cvt_pk_bf16_f32 v83, v86, v87
    v_or_b32 v80, 1, v80
    ds_write_b128 v244, v[80:83] offset:4096
    s_add_u32 s36, s44, 458752
    buffer_store_dwordx4 v[80:83], v2, s[16:19], s36 offen sc1
    v_pk_fma_f32 v[108:109], v[176:177], v[136:137], v[108:109] op_sel_hi:[0,1,1] neg_lo:[1,0,0] neg_hi:[1,0,0]
    v_pk_fma_f32 v[110:111], v[176:177], v[138:139], v[110:111] op_sel_hi:[0,1,1] neg_lo:[1,0,0] neg_hi:[1,0,0]
    v_pk_mul_f32 v[226:227], v[108:109], v[108:109]
    v_pk_mul_f32 v[228:229], v[110:111], v[110:111]
    v_pk_fma_f32 v[226:227], v[226:227], v[178:179], v[178:179] op_sel:[0,1,0] op_sel_hi:[1,1,0]
    v_pk_fma_f32 v[228:229], v[228:229], v[178:179], v[178:179] op_sel:[0,1,0] op_sel_hi:[1,1,0]
    v_pk_mul_f32 v[226:227], v[226:227], v[108:109]
    v_pk_mul_f32 v[228:229], v[228:229], v[110:111]
    v_exp_f32 v226, v226
    v_exp_f32 v227, v227
    v_exp_f32 v228, v228
    v_exp_f32 v229, v229
    v_pk_fma_f32 v[226:227], v[226:227], v[176:177], v[176:177] op_sel:[0,1,1] op_sel_hi:[1,1,1]
    v_pk_fma_f32 v[228:229], v[228:229], v[176:177], v[176:177] op_sel:[0,1,1] op_sel_hi:[1,1,1]
    v_rcp_f32 v226, v226
    v_rcp_f32 v227, v227
    v_rcp_f32 v228, v228
    v_rcp_f32 v229, v229
    v_pk_mul_f32 v[108:109], v[108:109], v[226:227]
    v_pk_mul_f32 v[110:111], v[110:111], v[228:229]
    v_pk_fma_f32 v[112:113], v[176:177], v[140:141], v[112:113] op_sel_hi:[0,1,1] neg_lo:[1,0,0] neg_hi:[1,0,0]
    v_pk_fma_f32 v[114:115], v[176:177], v[142:143], v[114:115] op_sel_hi:[0,1,1] neg_lo:[1,0,0] neg_hi:[1,0,0]
    v_pk_mul_f32 v[226:227], v[112:113], v[112:113]
    v_pk_mul_f32 v[228:229], v[114:115], v[114:115]
    v_pk_fma_f32 v[226:227], v[226:227], v[178:179], v[178:179] op_sel:[0,1,0] op_sel_hi:[1,1,0]
    v_pk_fma_f32 v[228:229], v[228:229], v[178:179], v[178:179] op_sel:[0,1,0] op_sel_hi:[1,1,0]
    v_pk_mul_f32 v[226:227], v[226:227], v[112:113]
    v_pk_mul_f32 v[228:229], v[228:229], v[114:115]
    v_exp_f32 v226, v226
    v_exp_f32 v227, v227
    v_exp_f32 v228, v228
    v_exp_f32 v229, v229
    v_pk_fma_f32 v[226:227], v[226:227], v[176:177], v[176:177] op_sel:[0,1,1] op_sel_hi:[1,1,1]
    v_pk_fma_f32 v[228:229], v[228:229], v[176:177], v[176:177] op_sel:[0,1,1] op_sel_hi:[1,1,1]
    v_rcp_f32 v226, v226
    v_rcp_f32 v227, v227
    v_rcp_f32 v228, v228
    v_rcp_f32 v229, v229
    v_pk_mul_f32 v[112:113], v[112:113], v[226:227]
    v_pk_mul_f32 v[114:115], v[114:115], v[228:229]
    v_cvt_pk_bf16_f32 v108, v108, v109
    v_cvt_pk_bf16_f32 v109, v110, v111
    v_cvt_pk_bf16_f32 v110, v112, v113
    v_cvt_pk_bf16_f32 v111, v114, v115
    ds_write_b128 v244, v[108:111] offset:6144
    s_add_u32 s36, s44, 688128
    buffer_store_dwordx4 v[108:111], v2, s[16:19], s36 offen sc1
    v_pk_fma_f32 v[32:33], v[164:165], v[144:145], v[32:33] op_sel_hi:[0,1,1] neg_lo:[1,0,0] neg_hi:[1,0,0]
    v_pk_fma_f32 v[34:35], v[164:165], v[146:147], v[34:35] op_sel_hi:[0,1,1] neg_lo:[1,0,0] neg_hi:[1,0,0]
    v_pk_mul_f32 v[226:227], v[32:33], v[32:33]
    v_pk_mul_f32 v[228:229], v[34:35], v[34:35]
    v_pk_fma_f32 v[226:227], v[226:227], v[166:167], v[166:167] op_sel:[0,1,0] op_sel_hi:[1,1,0]
    v_pk_fma_f32 v[228:229], v[228:229], v[166:167], v[166:167] op_sel:[0,1,0] op_sel_hi:[1,1,0]
    v_pk_mul_f32 v[226:227], v[226:227], v[32:33]
    v_pk_mul_f32 v[228:229], v[228:229], v[34:35]
    v_exp_f32 v226, v226
    v_exp_f32 v227, v227
    v_exp_f32 v228, v228
    v_exp_f32 v229, v229
    v_pk_fma_f32 v[226:227], v[226:227], v[164:165], v[164:165] op_sel:[0,1,1] op_sel_hi:[1,1,1]
    v_pk_fma_f32 v[228:229], v[228:229], v[164:165], v[164:165] op_sel:[0,1,1] op_sel_hi:[1,1,1]
    v_rcp_f32 v226, v226
    v_rcp_f32 v227, v227
    v_rcp_f32 v228, v228
    v_rcp_f32 v229, v229
    v_pk_mul_f32 v[32:33], v[32:33], v[226:227]
    v_pk_mul_f32 v[34:35], v[34:35], v[228:229]
    v_pk_fma_f32 v[36:37], v[164:165], v[148:149], v[36:37] op_sel_hi:[0,1,1] neg_lo:[1,0,0] neg_hi:[1,0,0]
    v_pk_fma_f32 v[38:39], v[164:165], v[150:151], v[38:39] op_sel_hi:[0,1,1] neg_lo:[1,0,0] neg_hi:[1,0,0]
    v_pk_mul_f32 v[226:227], v[36:37], v[36:37]
    v_pk_mul_f32 v[228:229], v[38:39], v[38:39]
    v_pk_fma_f32 v[226:227], v[226:227], v[166:167], v[166:167] op_sel:[0,1,0] op_sel_hi:[1,1,0]
    v_pk_fma_f32 v[228:229], v[228:229], v[166:167], v[166:167] op_sel:[0,1,0] op_sel_hi:[1,1,0]
    v_pk_mul_f32 v[226:227], v[226:227], v[36:37]
    v_pk_mul_f32 v[228:229], v[228:229], v[38:39]
    v_exp_f32 v226, v226
    v_exp_f32 v227, v227
    v_exp_f32 v228, v228
    v_exp_f32 v229, v229
    v_pk_fma_f32 v[226:227], v[226:227], v[164:165], v[164:165] op_sel:[0,1,1] op_sel_hi:[1,1,1]
    v_pk_fma_f32 v[228:229], v[228:229], v[164:165], v[164:165] op_sel:[0,1,1] op_sel_hi:[1,1,1]
    v_rcp_f32 v226, v226
    v_rcp_f32 v227, v227
    v_rcp_f32 v228, v228
    v_rcp_f32 v229, v229
    v_pk_mul_f32 v[36:37], v[36:37], v[226:227]
    v_pk_mul_f32 v[38:39], v[38:39], v[228:229]
    v_cvt_pk_bf16_f32 v32, v32, v33
    v_cvt_pk_bf16_f32 v33, v34, v35
    v_cvt_pk_bf16_f32 v34, v36, v37
    v_cvt_pk_bf16_f32 v35, v38, v39
    v_or_b32 v32, 1, v32
    ds_write_b128 v244, v[32:35] offset:16384
    v_pk_fma_f32 v[60:61], v[168:169], v[144:145], v[60:61] op_sel_hi:[0,1,1] neg_lo:[1,0,0] neg_hi:[1,0,0]
    v_pk_fma_f32 v[62:63], v[168:169], v[146:147], v[62:63] op_sel_hi:[0,1,1] neg_lo:[1,0,0] neg_hi:[1,0,0]
    v_pk_mul_f32 v[226:227], v[60:61], v[60:61]
    v_pk_mul_f32 v[228:229], v[62:63], v[62:63]
    v_pk_fma_f32 v[226:227], v[226:227], v[170:171], v[170:171] op_sel:[0,1,0] op_sel_hi:[1,1,0]
    v_pk_fma_f32 v[228:229], v[228:229], v[170:171], v[170:171] op_sel:[0,1,0] op_sel_hi:[1,1,0]
    v_pk_mul_f32 v[226:227], v[226:227], v[60:61]
    v_pk_mul_f32 v[228:229], v[228:229], v[62:63]
    v_exp_f32 v226, v226
    v_exp_f32 v227, v227
    v_exp_f32 v228, v228
    v_exp_f32 v229, v229
    v_pk_fma_f32 v[226:227], v[226:227], v[168:169], v[168:169] op_sel:[0,1,1] op_sel_hi:[1,1,1]
    v_pk_fma_f32 v[228:229], v[228:229], v[168:169], v[168:169] op_sel:[0,1,1] op_sel_hi:[1,1,1]
    v_rcp_f32 v226, v226
    v_rcp_f32 v227, v227
    v_rcp_f32 v228, v228
    v_rcp_f32 v229, v229
    v_pk_mul_f32 v[60:61], v[60:61], v[226:227]
    v_pk_mul_f32 v[62:63], v[62:63], v[228:229]
    v_pk_fma_f32 v[64:65], v[168:169], v[148:149], v[64:65] op_sel_hi:[0,1,1] neg_lo:[1,0,0] neg_hi:[1,0,0]
    v_pk_fma_f32 v[66:67], v[168:169], v[150:151], v[66:67] op_sel_hi:[0,1,1] neg_lo:[1,0,0] neg_hi:[1,0,0]
    v_pk_mul_f32 v[226:227], v[64:65], v[64:65]
    v_pk_mul_f32 v[228:229], v[66:67], v[66:67]
    v_pk_fma_f32 v[226:227], v[226:227], v[170:171], v[170:171] op_sel:[0,1,0] op_sel_hi:[1,1,0]
    v_pk_fma_f32 v[228:229], v[228:229], v[170:171], v[170:171] op_sel:[0,1,0] op_sel_hi:[1,1,0]
    v_pk_mul_f32 v[226:227], v[226:227], v[64:65]
    v_pk_mul_f32 v[228:229], v[228:229], v[66:67]
    v_exp_f32 v226, v226
    v_exp_f32 v227, v227
    v_exp_f32 v228, v228
    v_exp_f32 v229, v229
    v_pk_fma_f32 v[226:227], v[226:227], v[168:169], v[168:169] op_sel:[0,1,1] op_sel_hi:[1,1,1]
    v_pk_fma_f32 v[228:229], v[228:229], v[168:169], v[168:169] op_sel:[0,1,1] op_sel_hi:[1,1,1]
    v_rcp_f32 v226, v226
    v_rcp_f32 v227, v227
    v_rcp_f32 v228, v228
    v_rcp_f32 v229, v229
    v_pk_mul_f32 v[64:65], v[64:65], v[226:227]
    v_pk_mul_f32 v[66:67], v[66:67], v[228:229]
    v_cvt_pk_bf16_f32 v60, v60, v61
    v_cvt_pk_bf16_f32 v61, v62, v63
    v_cvt_pk_bf16_f32 v62, v64, v65
    v_cvt_pk_bf16_f32 v63, v66, v67
    v_or_b32 v60, 1, v60
    ds_write_b128 v244, v[60:63] offset:18432
    s_waitcnt vmcnt(0)
    s_mov_b64 exec, 1
    ds_add_u32 v246, v245
    s_mov_b64 exec, -1
    v_pk_fma_f32 v[88:89], v[172:173], v[144:145], v[88:89] op_sel_hi:[0,1,1] neg_lo:[1,0,0] neg_hi:[1,0,0]
    v_pk_fma_f32 v[90:91], v[172:173], v[146:147], v[90:91] op_sel_hi:[0,1,1] neg_lo:[1,0,0] neg_hi:[1,0,0]
    v_pk_mul_f32 v[226:227], v[88:89], v[88:89]
    v_pk_mul_f32 v[228:229], v[90:91], v[90:91]
    v_pk_fma_f32 v[226:227], v[226:227], v[174:175], v[174:175] op_sel:[0,1,0] op_sel_hi:[1,1,0]
    v_pk_fma_f32 v[228:229], v[228:229], v[174:175], v[174:175] op_sel:[0,1,0] op_sel_hi:[1,1,0]
    v_pk_mul_f32 v[226:227], v[226:227], v[88:89]
    v_pk_mul_f32 v[228:229], v[228:229], v[90:91]
    v_exp_f32 v226, v226
    v_exp_f32 v227, v227
    v_exp_f32 v228, v228
    v_exp_f32 v229, v229
    v_pk_fma_f32 v[226:227], v[226:227], v[172:173], v[172:173] op_sel:[0,1,1] op_sel_hi:[1,1,1]
    v_pk_fma_f32 v[228:229], v[228:229], v[172:173], v[172:173] op_sel:[0,1,1] op_sel_hi:[1,1,1]
    v_rcp_f32 v226, v226
    v_rcp_f32 v227, v227
    v_rcp_f32 v228, v228
    v_rcp_f32 v229, v229
    v_pk_mul_f32 v[88:89], v[88:89], v[226:227]
    v_pk_mul_f32 v[90:91], v[90:91], v[228:229]
    v_pk_fma_f32 v[92:93], v[172:173], v[148:149], v[92:93] op_sel_hi:[0,1,1] neg_lo:[1,0,0] neg_hi:[1,0,0]
    v_pk_fma_f32 v[94:95], v[172:173], v[150:151], v[94:95] op_sel_hi:[0,1,1] neg_lo:[1,0,0] neg_hi:[1,0,0]
    v_pk_mul_f32 v[226:227], v[92:93], v[92:93]
    v_pk_mul_f32 v[228:229], v[94:95], v[94:95]
    v_pk_fma_f32 v[226:227], v[226:227], v[174:175], v[174:175] op_sel:[0,1,0] op_sel_hi:[1,1,0]
    v_pk_fma_f32 v[228:229], v[228:229], v[174:175], v[174:175] op_sel:[0,1,0] op_sel_hi:[1,1,0]
    v_pk_mul_f32 v[226:227], v[226:227], v[92:93]
    v_pk_mul_f32 v[228:229], v[228:229], v[94:95]
    v_exp_f32 v226, v226
    v_exp_f32 v227, v227
    v_exp_f32 v228, v228
    v_exp_f32 v229, v229
    v_pk_fma_f32 v[226:227], v[226:227], v[172:173], v[172:173] op_sel:[0,1,1] op_sel_hi:[1,1,1]
    v_pk_fma_f32 v[228:229], v[228:229], v[172:173], v[172:173] op_sel:[0,1,1] op_sel_hi:[1,1,1]
    v_rcp_f32 v226, v226
    v_rcp_f32 v227, v227
    v_rcp_f32 v228, v228
    v_rcp_f32 v229, v229
    v_pk_mul_f32 v[92:93], v[92:93], v[226:227]
    v_pk_mul_f32 v[94:95], v[94:95], v[228:229]
    v_cvt_pk_bf16_f32 v88, v88, v89
    v_cvt_pk_bf16_f32 v89, v90, v91
    v_cvt_pk_bf16_f32 v90, v92, v93
    v_cvt_pk_bf16_f32 v91, v94, v95
    v_or_b32 v88, 1, v88
    ds_write_b128 v244, v[88:91] offset:20480
    s_cmp_eq_u32 s60, 1
    s_cbranch_scc1 G4_p10
    buffer_load_dwordx4 v[180:183], v196, s[84:87], 0 offen offset:0 sc1
    buffer_load_dwordx4 v[188:191], v196, s[88:91], 0 offen offset:0 sc1
    buffer_load_dwordx4 v[184:187], v196, s[84:87], 0 offen offset:2048 sc1
    buffer_load_dwordx4 v[192:195], v196, s[88:91], 0 offen offset:2048 sc1
    s_branch G4_p20
G4_p10:
    s_add_u32 s36, s40, 0
    buffer_load_dwordx4 v[180:183], v2, s[84:87], s36 offen offset:0 sc1
    buffer_load_dwordx4 v[184:187], v2, s[88:91], s36 offen offset:0 sc1
    buffer_load_dwordx4 v[188:191], v2, s[84:87], s36 offen offset:1024 sc1
    buffer_load_dwordx4 v[192:195], v2, s[88:91], s36 offen offset:1024 sc1
    s_add_u32 s36, s40, 65536
    buffer_load_dwordx4 v[196:199], v2, s[84:87], s36 offen offset:0 sc1
    buffer_load_dwordx4 v[230:233], v2, s[88:91], s36 offen offset:0 sc1
    buffer_load_dwordx4 v[234:237], v2, s[84:87], s36 offen offset:1024 sc1
    buffer_load_dwordx4 v[248:251], v2, s[88:91], s36 offen offset:1024 sc1
G4_p20:
    v_pk_fma_f32 v[116:117], v[176:177], v[144:145], v[116:117] op_sel_hi:[0,1,1] neg_lo:[1,0,0] neg_hi:[1,0,0]
    v_pk_fma_f32 v[118:119], v[176:177], v[146:147], v[118:119] op_sel_hi:[0,1,1] neg_lo:[1,0,0] neg_hi:[1,0,0]
    v_pk_mul_f32 v[226:227], v[116:117], v[116:117]
    v_pk_mul_f32 v[228:229], v[118:119], v[118:119]
    v_pk_fma_f32 v[226:227], v[226:227], v[178:179], v[178:179] op_sel:[0,1,0] op_sel_hi:[1,1,0]
    v_pk_fma_f32 v[228:229], v[228:229], v[178:179], v[178:179] op_sel:[0,1,0] op_sel_hi:[1,1,0]
    v_pk_mul_f32 v[226:227], v[226:227], v[116:117]
    v_pk_mul_f32 v[228:229], v[228:229], v[118:119]
    v_exp_f32 v226, v226
    v_exp_f32 v227, v227
    v_exp_f32 v228, v228
    v_exp_f32 v229, v229
    v_pk_fma_f32 v[226:227], v[226:227], v[176:177], v[176:177] op_sel:[0,1,1] op_sel_hi:[1,1,1]
    v_pk_fma_f32 v[228:229], v[228:229], v[176:177], v[176:177] op_sel:[0,1,1] op_sel_hi:[1,1,1]
    v_rcp_f32 v226, v226
    v_rcp_f32 v227, v227
    v_rcp_f32 v228, v228
    v_rcp_f32 v229, v229
    v_pk_mul_f32 v[116:117], v[116:117], v[226:227]
    v_pk_mul_f32 v[118:119], v[118:119], v[228:229]
    v_pk_fma_f32 v[120:121], v[176:177], v[148:149], v[120:121] op_sel_hi:[0,1,1] neg_lo:[1,0,0] neg_hi:[1,0,0]
    v_pk_fma_f32 v[122:123], v[176:177], v[150:151], v[122:123] op_sel_hi:[0,1,1] neg_lo:[1,0,0] neg_hi:[1,0,0]
    v_pk_mul_f32 v[226:227], v[120:121], v[120:121]
    v_pk_mul_f32 v[228:229], v[122:123], v[122:123]
    v_pk_fma_f32 v[226:227], v[226:227], v[178:179], v[178:179] op_sel:[0,1,0] op_sel_hi:[1,1,0]
    v_pk_fma_f32 v[228:229], v[228:229], v[178:179], v[178:179] op_sel:[0,1,0] op_sel_hi:[1,1,0]
    v_pk_mul_f32 v[226:227], v[226:227], v[120:121]
    v_pk_mul_f32 v[228:229], v[228:229], v[122:123]
    v_exp_f32 v226, v226
    v_exp_f32 v227, v227
    v_exp_f32 v228, v228
    v_exp_f32 v229, v229
    v_pk_fma_f32 v[226:227], v[226:227], v[176:177], v[176:177] op_sel:[0,1,1] op_sel_hi:[1,1,1]
    v_pk_fma_f32 v[228:229], v[228:229], v[176:177], v[176:177] op_sel:[0,1,1] op_sel_hi:[1,1,1]
    v_rcp_f32 v226, v226
    v_rcp_f32 v227, v227
    v_rcp_f32 v228, v228
    v_rcp_f32 v229, v229
    v_pk_mul_f32 v[120:121], v[120:121], v[226:227]
    v_pk_mul_f32 v[122:123], v[122:123], v[228:229]
    v_cvt_pk_bf16_f32 v116, v116, v117
    v_cvt_pk_bf16_f32 v117, v118, v119
    v_cvt_pk_bf16_f32 v118, v120, v121
    v_cvt_pk_bf16_f32 v119, v122, v123
    ds_write_b128 v244, v[116:119] offset:22528
    v_pk_fma_f32 v[40:41], v[164:165], v[152:153], v[40:41] op_sel_hi:[0,1,1] neg_lo:[1,0,0] neg_hi:[1,0,0]
    v_pk_fma_f32 v[42:43], v[164:165], v[154:155], v[42:43] op_sel_hi:[0,1,1] neg_lo:[1,0,0] neg_hi:[1,0,0]
    v_pk_mul_f32 v[226:227], v[40:41], v[40:41]
    v_pk_mul_f32 v[228:229], v[42:43], v[42:43]
    v_pk_fma_f32 v[226:227], v[226:227], v[166:167], v[166:167] op_sel:[0,1,0] op_sel_hi:[1,1,0]
    v_pk_fma_f32 v[228:229], v[228:229], v[166:167], v[166:167] op_sel:[0,1,0] op_sel_hi:[1,1,0]
    v_pk_mul_f32 v[226:227], v[226:227], v[40:41]
    v_pk_mul_f32 v[228:229], v[228:229], v[42:43]
    v_exp_f32 v226, v226
    v_exp_f32 v227, v227
    v_exp_f32 v228, v228
    v_exp_f32 v229, v229
    v_pk_fma_f32 v[226:227], v[226:227], v[164:165], v[164:165] op_sel:[0,1,1] op_sel_hi:[1,1,1]
    v_pk_fma_f32 v[228:229], v[228:229], v[164:165], v[164:165] op_sel:[0,1,1] op_sel_hi:[1,1,1]
    v_rcp_f32 v226, v226
    v_rcp_f32 v227, v227
    v_rcp_f32 v228, v228
    v_rcp_f32 v229, v229
    v_pk_mul_f32 v[40:41], v[40:41], v[226:227]
    v_pk_mul_f32 v[42:43], v[42:43], v[228:229]
    v_pk_fma_f32 v[44:45], v[164:165], v[156:157], v[44:45] op_sel_hi:[0,1,1] neg_lo:[1,0,0] neg_hi:[1,0,0]
    v_pk_fma_f32 v[46:47], v[164:165], v[158:159], v[46:47] op_sel_hi:[0,1,1] neg_lo:[1,0,0] neg_hi:[1,0,0]
    v_pk_mul_f32 v[226:227], v[44:45], v[44:45]
    v_pk_mul_f32 v[228:229], v[46:47], v[46:47]
    v_pk_fma_f32 v[226:227], v[226:227], v[166:167], v[166:167] op_sel:[0,1,0] op_sel_hi:[1,1,0]
    v_pk_fma_f32 v[228:229], v[228:229], v[166:167], v[166:167] op_sel:[0,1,0] op_sel_hi:[1,1,0]
    v_pk_mul_f32 v[226:227], v[226:227], v[44:45]
    v_pk_mul_f32 v[228:229], v[228:229], v[46:47]
    v_exp_f32 v226, v226
    v_exp_f32 v227, v227
    v_exp_f32 v228, v228
    v_exp_f32 v229, v229
    v_pk_fma_f32 v[226:227], v[226:227], v[164:165], v[164:165] op_sel:[0,1,1] op_sel_hi:[1,1,1]
    v_pk_fma_f32 v[228:229], v[228:229], v[164:165], v[164:165] op_sel:[0,1,1] op_sel_hi:[1,1,1]
    v_rcp_f32 v226, v226
    v_rcp_f32 v227, v227
    v_rcp_f32 v228, v228
    v_rcp_f32 v229, v229
    v_pk_mul_f32 v[44:45], v[44:45], v[226:227]
    v_pk_mul_f32 v[46:47], v[46:47], v[228:229]
    v_cvt_pk_bf16_f32 v200, v40, v41
    v_cvt_pk_bf16_f32 v201, v42, v43
    v_cvt_pk_bf16_f32 v202, v44, v45
    v_cvt_pk_bf16_f32 v203, v46, v47
    v_or_b32 v200, 1, v200
    ds_write_b128 v244, v[200:203] offset:32768
    v_pk_fma_f32 v[68:69], v[168:169], v[152:153], v[68:69] op_sel_hi:[0,1,1] neg_lo:[1,0,0] neg_hi:[1,0,0]
    v_pk_fma_f32 v[70:71], v[168:169], v[154:155], v[70:71] op_sel_hi:[0,1,1] neg_lo:[1,0,0] neg_hi:[1,0,0]
    v_pk_mul_f32 v[226:227], v[68:69], v[68:69]
    v_pk_mul_f32 v[228:229], v[70:71], v[70:71]
    v_pk_fma_f32 v[226:227], v[226:227], v[170:171], v[170:171] op_sel:[0,1,0] op_sel_hi:[1,1,0]
    v_pk_fma_f32 v[228:229], v[228:229], v[170:171], v[170:171] op_sel:[0,1,0] op_sel_hi:[1,1,0]
    v_pk_mul_f32 v[226:227], v[226:227], v[68:69]
    v_pk_mul_f32 v[228:229], v[228:229], v[70:71]
    v_exp_f32 v226, v226
    v_exp_f32 v227, v227
    v_exp_f32 v228, v228
    v_exp_f32 v229, v229
    v_pk_fma_f32 v[226:227], v[226:227], v[168:169], v[168:169] op_sel:[0,1,1] op_sel_hi:[1,1,1]
    v_pk_fma_f32 v[228:229], v[228:229], v[168:169], v[168:169] op_sel:[0,1,1] op_sel_hi:[1,1,1]
    v_rcp_f32 v226, v226
    v_rcp_f32 v227, v227
    v_rcp_f32 v228, v228
    v_rcp_f32 v229, v229
    v_pk_mul_f32 v[68:69], v[68:69], v[226:227]
    v_pk_mul_f32 v[70:71], v[70:71], v[228:229]
    v_pk_fma_f32 v[72:73], v[168:169], v[156:157], v[72:73] op_sel_hi:[0,1,1] neg_lo:[1,0,0] neg_hi:[1,0,0]
    v_pk_fma_f32 v[74:75], v[168:169], v[158:159], v[74:75] op_sel_hi:[0,1,1] neg_lo:[1,0,0] neg_hi:[1,0,0]
    v_pk_mul_f32 v[226:227], v[72:73], v[72:73]
    v_pk_mul_f32 v[228:229], v[74:75], v[74:75]
    v_pk_fma_f32 v[226:227], v[226:227], v[170:171], v[170:171] op_sel:[0,1,0] op_sel_hi:[1,1,0]
    v_pk_fma_f32 v[228:229], v[228:229], v[170:171], v[170:171] op_sel:[0,1,0] op_sel_hi:[1,1,0]
    v_pk_mul_f32 v[226:227], v[226:227], v[72:73]
    v_pk_mul_f32 v[228:229], v[228:229], v[74:75]
    v_exp_f32 v226, v226
    v_exp_f32 v227, v227
    v_exp_f32 v228, v228
    v_exp_f32 v229, v229
    v_pk_fma_f32 v[226:227], v[226:227], v[168:169], v[168:169] op_sel:[0,1,1] op_sel_hi:[1,1,1]
    v_pk_fma_f32 v[228:229], v[228:229], v[168:169], v[168:169] op_sel:[0,1,1] op_sel_hi:[1,1,1]
    v_rcp_f32 v226, v226
    v_rcp_f32 v227, v227
    v_rcp_f32 v228, v228
    v_rcp_f32 v229, v229
    v_pk_mul_f32 v[72:73], v[72:73], v[226:227]
    v_pk_mul_f32 v[74:75], v[74:75], v[228:229]
    v_cvt_pk_bf16_f32 v204, v68, v69
    v_cvt_pk_bf16_f32 v205, v70, v71
    v_cvt_pk_bf16_f32 v206, v72, v73
    v_cvt_pk_bf16_f32 v207, v74, v75
    v_or_b32 v204, 1, v204
    ds_write_b128 v244, v[204:207] offset:34816
    v_pk_fma_f32 v[96:97], v[172:173], v[152:153], v[96:97] op_sel_hi:[0,1,1] neg_lo:[1,0,0] neg_hi:[1,0,0]
    v_pk_fma_f32 v[98:99], v[172:173], v[154:155], v[98:99] op_sel_hi:[0,1,1] neg_lo:[1,0,0] neg_hi:[1,0,0]
    v_pk_mul_f32 v[226:227], v[96:97], v[96:97]
    v_pk_mul_f32 v[228:229], v[98:99], v[98:99]
    v_pk_fma_f32 v[226:227], v[226:227], v[174:175], v[174:175] op_sel:[0,1,0] op_sel_hi:[1,1,0]
    v_pk_fma_f32 v[228:229], v[228:229], v[174:175], v[174:175] op_sel:[0,1,0] op_sel_hi:[1,1,0]
    v_pk_mul_f32 v[226:227], v[226:227], v[96:97]
    v_pk_mul_f32 v[228:229], v[228:229], v[98:99]
    v_exp_f32 v226, v226
    v_exp_f32 v227, v227
    v_exp_f32 v228, v228
    v_exp_f32 v229, v229
    v_pk_fma_f32 v[226:227], v[226:227], v[172:173], v[172:173] op_sel:[0,1,1] op_sel_hi:[1,1,1]
    v_pk_fma_f32 v[228:229], v[228:229], v[172:173], v[172:173] op_sel:[0,1,1] op_sel_hi:[1,1,1]
    v_rcp_f32 v226, v226
    v_rcp_f32 v227, v227
    v_rcp_f32 v228, v228
    v_rcp_f32 v229, v229
    v_pk_mul_f32 v[96:97], v[96:97], v[226:227]
    v_pk_mul_f32 v[98:99], v[98:99], v[228:229]
    v_pk_fma_f32 v[100:101], v[172:173], v[156:157], v[100:101] op_sel_hi:[0,1,1] neg_lo:[1,0,0] neg_hi:[1,0,0]
    v_pk_fma_f32 v[102:103], v[172:173], v[158:159], v[102:103] op_sel_hi:[0,1,1] neg_lo:[1,0,0] neg_hi:[1,0,0]
    v_pk_mul_f32 v[226:227], v[100:101], v[100:101]
    v_pk_mul_f32 v[228:229], v[102:103], v[102:103]
    v_pk_fma_f32 v[226:227], v[226:227], v[174:175], v[174:175] op_sel:[0,1,0] op_sel_hi:[1,1,0]
    v_pk_fma_f32 v[228:229], v[228:229], v[174:175], v[174:175] op_sel:[0,1,0] op_sel_hi:[1,1,0]
    v_pk_mul_f32 v[226:227], v[226:227], v[100:101]
    v_pk_mul_f32 v[228:229], v[228:229], v[102:103]
    v_exp_f32 v226, v226
    v_exp_f32 v227, v227
    v_exp_f32 v228, v228
    v_exp_f32 v229, v229
    v_pk_fma_f32 v[226:227], v[226:227], v[172:173], v[172:173] op_sel:[0,1,1] op_sel_hi:[1,1,1]
    v_pk_fma_f32 v[228:229], v[228:229], v[172:173], v[172:173] op_sel:[0,1,1] op_sel_hi:[1,1,1]
    v_rcp_f32 v226, v226
    v_rcp_f32 v227, v227
    v_rcp_f32 v228, v228
    v_rcp_f32 v229, v229
    v_pk_mul_f32 v[100:101], v[100:101], v[226:227]
    v_pk_mul_f32 v[102:103], v[102:103], v[228:229]
    v_cvt_pk_bf16_f32 v208, v96, v97
    v_cvt_pk_bf16_f32 v209, v98, v99
    v_cvt_pk_bf16_f32 v210, v100, v101
    v_cvt_pk_bf16_f32 v211, v102, v103
    v_or_b32 v208, 1, v208
    ds_write_b128 v244, v[208:211] offset:36864
    v_pk_fma_f32 v[124:125], v[176:177], v[152:153], v[124:125] op_sel_hi:[0,1,1] neg_lo:[1,0,0] neg_hi:[1,0,0]
    v_pk_fma_f32 v[126:127], v[176:177], v[154:155], v[126:127] op_sel_hi:[0,1,1] neg_lo:[1,0,0] neg_hi:[1,0,0]
    v_pk_mul_f32 v[226:227], v[124:125], v[124:125]
    v_pk_mul_f32 v[228:229], v[126:127], v[126:127]
    v_pk_fma_f32 v[226:227], v[226:227], v[178:179], v[178:179] op_sel:[0,1,0] op_sel_hi:[1,1,0]
    v_pk_fma_f32 v[228:229], v[228:229], v[178:179], v[178:179] op_sel:[0,1,0] op_sel_hi:[1,1,0]
    v_pk_mul_f32 v[226:227], v[226:227], v[124:125]
    v_pk_mul_f32 v[228:229], v[228:229], v[126:127]
    v_exp_f32 v226, v226
    v_exp_f32 v227, v227
    v_exp_f32 v228, v228
    v_exp_f32 v229, v229
    v_pk_fma_f32 v[226:227], v[226:227], v[176:177], v[176:177] op_sel:[0,1,1] op_sel_hi:[1,1,1]
    v_pk_fma_f32 v[228:229], v[228:229], v[176:177], v[176:177] op_sel:[0,1,1] op_sel_hi:[1,1,1]
    v_rcp_f32 v226, v226
    v_rcp_f32 v227, v227
    v_rcp_f32 v228, v228
    v_rcp_f32 v229, v229
    v_pk_mul_f32 v[124:125], v[124:125], v[226:227]
    v_pk_mul_f32 v[126:127], v[126:127], v[228:229]
    v_pk_fma_f32 v[128:129], v[176:177], v[156:157], v[128:129] op_sel_hi:[0,1,1] neg_lo:[1,0,0] neg_hi:[1,0,0]
    v_pk_fma_f32 v[130:131], v[176:177], v[158:159], v[130:131] op_sel_hi:[0,1,1] neg_lo:[1,0,0] neg_hi:[1,0,0]
    v_pk_mul_f32 v[226:227], v[128:129], v[128:129]
    v_pk_mul_f32 v[228:229], v[130:131], v[130:131]
    v_pk_fma_f32 v[226:227], v[226:227], v[178:179], v[178:179] op_sel:[0,1,0] op_sel_hi:[1,1,0]
    v_pk_fma_f32 v[228:229], v[228:229], v[178:179], v[178:179] op_sel:[0,1,0] op_sel_hi:[1,1,0]
    v_pk_mul_f32 v[226:227], v[226:227], v[128:129]
    v_pk_mul_f32 v[228:229], v[228:229], v[130:131]
    v_exp_f32 v226, v226
    v_exp_f32 v227, v227
    v_exp_f32 v228, v228
    v_exp_f32 v229, v229
    v_pk_fma_f32 v[226:227], v[226:227], v[176:177], v[176:177] op_sel:[0,1,1] op_sel_hi:[1,1,1]
    v_pk_fma_f32 v[228:229], v[228:229], v[176:177], v[176:177] op_sel:[0,1,1] op_sel_hi:[1,1,1]
    v_rcp_f32 v226, v226
    v_rcp_f32 v227, v227
    v_rcp_f32 v228, v228
    v_rcp_f32 v229, v229
    v_pk_mul_f32 v[128:129], v[128:129], v[226:227]
    v_pk_mul_f32 v[130:131], v[130:131], v[228:229]
    v_cvt_pk_bf16_f32 v212, v124, v125
    v_cvt_pk_bf16_f32 v213, v126, v127
    v_cvt_pk_bf16_f32 v214, v128, v129
    v_cvt_pk_bf16_f32 v215, v130, v131
    ds_write_b128 v244, v[212:215] offset:38912
    v_pk_fma_f32 v[48:49], v[164:165], v[160:161], v[48:49] op_sel_hi:[0,1,1] neg_lo:[1,0,0] neg_hi:[1,0,0]
    v_pk_fma_f32 v[50:51], v[164:165], v[162:163], v[50:51] op_sel_hi:[0,1,1] neg_lo:[1,0,0] neg_hi:[1,0,0]
    v_pk_mul_f32 v[226:227], v[48:49], v[48:49]
    v_pk_mul_f32 v[228:229], v[50:51], v[50:51]
    v_pk_fma_f32 v[226:227], v[226:227], v[166:167], v[166:167] op_sel:[0,1,0] op_sel_hi:[1,1,0]
    v_pk_fma_f32 v[228:229], v[228:229], v[166:167], v[166:167] op_sel:[0,1,0] op_sel_hi:[1,1,0]
    v_pk_mul_f32 v[226:227], v[226:227], v[48:49]
    v_pk_mul_f32 v[228:229], v[228:229], v[50:51]
    v_exp_f32 v226, v226
    v_exp_f32 v227, v227
    v_exp_f32 v228, v228
    v_exp_f32 v229, v229
    v_pk_fma_f32 v[226:227], v[226:227], v[164:165], v[164:165] op_sel:[0,1,1] op_sel_hi:[1,1,1]
    v_pk_fma_f32 v[228:229], v[228:229], v[164:165], v[164:165] op_sel:[0,1,1] op_sel_hi:[1,1,1]
    v_rcp_f32 v226, v226
    v_rcp_f32 v227, v227
    v_rcp_f32 v228, v228
    v_rcp_f32 v229, v229
    v_pk_mul_f32 v[48:49], v[48:49], v[226:227]
    v_pk_mul_f32 v[50:51], v[50:51], v[228:229]
    v_cvt_pk_bf16_f32 v216, v48, v49
    v_cvt_pk_bf16_f32 v217, v50, v51
    v_or_b32 v216, 1, v216
    s_add_u32 s36, s45, 0
    buffer_store_dwordx4 v[32:35], v2, s[16:19], s36 offen sc1
    v_pk_fma_f32 v[76:77], v[168:169], v[160:161], v[76:77] op_sel_hi:[0,1,1] neg_lo:[1,0,0] neg_hi:[1,0,0]
    v_pk_fma_f32 v[78:79], v[168:169], v[162:163], v[78:79] op_sel_hi:[0,1,1] neg_lo:[1,0,0] neg_hi:[1,0,0]
    v_pk_mul_f32 v[226:227], v[76:77], v[76:77]
    v_pk_mul_f32 v[228:229], v[78:79], v[78:79]
    v_pk_fma_f32 v[226:227], v[226:227], v[170:171], v[170:171] op_sel:[0,1,0] op_sel_hi:[1,1,0]
    v_pk_fma_f32 v[228:229], v[228:229], v[170:171], v[170:171] op_sel:[0,1,0] op_sel_hi:[1,1,0]
    v_pk_mul_f32 v[226:227], v[226:227], v[76:77]
    v_pk_mul_f32 v[228:229], v[228:229], v[78:79]
    v_exp_f32 v226, v226
    v_exp_f32 v227, v227
    v_exp_f32 v228, v228
    v_exp_f32 v229, v229
    v_pk_fma_f32 v[226:227], v[226:227], v[168:169], v[168:169] op_sel:[0,1,1] op_sel_hi:[1,1,1]
    v_pk_fma_f32 v[228:229], v[228:229], v[168:169], v[168:169] op_sel:[0,1,1] op_sel_hi:[1,1,1]
    v_rcp_f32 v226, v226
    v_rcp_f32 v227, v227
    v_rcp_f32 v228, v228
    v_rcp_f32 v229, v229
    v_pk_mul_f32 v[76:77], v[76:77], v[226:227]
    v_pk_mul_f32 v[78:79], v[78:79], v[228:229]
    v_cvt_pk_bf16_f32 v218, v76, v77
    v_cvt_pk_bf16_f32 v219, v78, v79
    v_or_b32 v218, 1, v218
    s_add_u32 s36, s45, 229376
    buffer_store_dwordx4 v[60:63], v2, s[16:19], s36 offen sc1
    v_pk_fma_f32 v[104:105], v[172:173], v[160:161], v[104:105] op_sel_hi:[0,1,1] neg_lo:[1,0,0] neg_hi:[1,0,0]
    v_pk_fma_f32 v[106:107], v[172:173], v[162:163], v[106:107] op_sel_hi:[0,1,1] neg_lo:[1,0,0] neg_hi:[1,0,0]
    v_pk_mul_f32 v[226:227], v[104:105], v[104:105]
    v_pk_mul_f32 v[228:229], v[106:107], v[106:107]
    v_pk_fma_f32 v[226:227], v[226:227], v[174:175], v[174:175] op_sel:[0,1,0] op_sel_hi:[1,1,0]
    v_pk_fma_f32 v[228:229], v[228:229], v[174:175], v[174:175] op_sel:[0,1,0] op_sel_hi:[1,1,0]
    v_pk_mul_f32 v[226:227], v[226:227], v[104:105]
    v_pk_mul_f32 v[228:229], v[228:229], v[106:107]
    v_exp_f32 v226, v226
    v_exp_f32 v227, v227
    v_exp_f32 v228, v228
    v_exp_f32 v229, v229
    v_pk_fma_f32 v[226:227], v[226:227], v[172:173], v[172:173] op_sel:[0,1,1] op_sel_hi:[1,1,1]
    v_pk_fma_f32 v[228:229], v[228:229], v[172:173], v[172:173] op_sel:[0,1,1] op_sel_hi:[1,1,1]
    v_rcp_f32 v226, v226
    v_rcp_f32 v227, v227
    v_rcp_f32 v228, v228
    v_rcp_f32 v229, v229
    v_pk_mul_f32 v[104:105], v[104:105], v[226:227]
    v_pk_mul_f32 v[106:107], v[106:107], v[228:229]
    v_cvt_pk_bf16_f32 v220, v104, v105
    v_cvt_pk_bf16_f32 v221, v106, v107
    v_or_b32 v220, 1, v220
    s_add_u32 s36, s45, 458752
    buffer_store_dwordx4 v[88:91], v2, s[16:19], s36 offen sc1
    v_pk_fma_f32 v[132:133], v[176:177], v[160:161], v[132:133] op_sel_hi:[0,1,1] neg_lo:[1,0,0] neg_hi:[1,0,0]
    v_pk_fma_f32 v[134:135], v[176:177], v[162:163], v[134:135] op_sel_hi:[0,1,1] neg_lo:[1,0,0] neg_hi:[1,0,0]
    v_pk_mul_f32 v[226:227], v[132:133], v[132:133]
    v_pk_mul_f32 v[228:229], v[134:135], v[134:135]
    v_pk_fma_f32 v[226:227], v[226:227], v[178:179], v[178:179] op_sel:[0,1,0] op_sel_hi:[1,1,0]
    v_pk_fma_f32 v[228:229], v[228:229], v[178:179], v[178:179] op_sel:[0,1,0] op_sel_hi:[1,1,0]
    v_pk_mul_f32 v[226:227], v[226:227], v[132:133]
    v_pk_mul_f32 v[228:229], v[228:229], v[134:135]
    v_exp_f32 v226, v226
    v_exp_f32 v227, v227
    v_exp_f32 v228, v228
    v_exp_f32 v229, v229
    v_pk_fma_f32 v[226:227], v[226:227], v[176:177], v[176:177] op_sel:[0,1,1] op_sel_hi:[1,1,1]
    v_pk_fma_f32 v[228:229], v[228:229], v[176:177], v[176:177] op_sel:[0,1,1] op_sel_hi:[1,1,1]
    v_rcp_f32 v226, v226
    v_rcp_f32 v227, v227
    v_rcp_f32 v228, v228
    v_rcp_f32 v229, v229
    v_pk_mul_f32 v[132:133], v[132:133], v[226:227]
    v_pk_mul_f32 v[134:135], v[134:135], v[228:229]
    v_cvt_pk_bf16_f32 v222, v132, v133
    v_cvt_pk_bf16_f32 v223, v134, v135
    s_add_u32 s36, s45, 688128
    buffer_store_dwordx4 v[116:119], v2, s[16:19], s36 offen sc1
    s_waitcnt lgkmcnt(0)
    s_mov_b32 s44, s46
    s_mov_b32 s45, s47
    s_branch G3_e2
G3_e1:
    v_pk_fma_f32 v[28:29], v[164:165], v[140:141], v[28:29] op_sel_hi:[0,1,1] neg_lo:[1,0,0] neg_hi:[1,0,0]
    v_pk_fma_f32 v[30:31], v[164:165], v[142:143], v[30:31] op_sel_hi:[0,1,1] neg_lo:[1,0,0] neg_hi:[1,0,0]
    v_pk_mul_f32 v[226:227], v[28:29], v[28:29]
    v_pk_mul_f32 v[228:229], v[30:31], v[30:31]
    v_pk_fma_f32 v[226:227], v[226:227], v[166:167], v[166:167] op_sel:[0,1,0] op_sel_hi:[1,1,0]
    v_pk_fma_f32 v[228:229], v[228:229], v[166:167], v[166:167] op_sel:[0,1,0] op_sel_hi:[1,1,0]
    v_pk_mul_f32 v[226:227], v[226:227], v[28:29]
    v_pk_mul_f32 v[228:229], v[228:229], v[30:31]
    v_exp_f32 v226, v226
    v_exp_f32 v227, v227
    v_exp_f32 v228, v228
    v_exp_f32 v229, v229
    v_pk_fma_f32 v[226:227], v[226:227], v[164:165], v[164:165] op_sel:[0,1,1] op_sel_hi:[1,1,1]
    v_pk_fma_f32 v[228:229], v[228:229], v[164:165], v[164:165] op_sel:[0,1,1] op_sel_hi:[1,1,1]
    v_rcp_f32 v226, v226
    v_rcp_f32 v227, v227
    v_rcp_f32 v228, v228
    v_rcp_f32 v229, v229
    v_pk_mul_f32 v[28:29], v[28:29], v[226:227]
    v_pk_mul_f32 v[30:31], v[30:31], v[228:229]
    v_pk_fma_f32 v[32:33], v[164:165], v[144:145], v[32:33] op_sel_hi:[0,1,1] neg_lo:[1,0,0] neg_hi:[1,0,0]
    v_pk_fma_f32 v[34:35], v[164:165], v[146:147], v[34:35] op_sel_hi:[0,1,1] neg_lo:[1,0,0] neg_hi:[1,0,0]
    v_pk_mul_f32 v[226:227], v[32:33], v[32:33]
    v_pk_mul_f32 v[228:229], v[34:35], v[34:35]
    v_pk_fma_f32 v[226:227], v[226:227], v[166:167], v[166:167] op_sel:[0,1,0] op_sel_hi:[1,1,0]
    v_pk_fma_f32 v[228:229], v[228:229], v[166:167], v[166:167] op_sel:[0,1,0] op_sel_hi:[1,1,0]
    v_pk_mul_f32 v[226:227], v[226:227], v[32:33]
    v_pk_mul_f32 v[228:229], v[228:229], v[34:35]
    v_exp_f32 v226, v226
    v_exp_f32 v227, v227
    v_exp_f32 v228, v228
    v_exp_f32 v229, v229
    v_pk_fma_f32 v[226:227], v[226:227], v[164:165], v[164:165] op_sel:[0,1,1] op_sel_hi:[1,1,1]
    v_pk_fma_f32 v[228:229], v[228:229], v[164:165], v[164:165] op_sel:[0,1,1] op_sel_hi:[1,1,1]
    v_rcp_f32 v226, v226
    v_rcp_f32 v227, v227
    v_rcp_f32 v228, v228
    v_rcp_f32 v229, v229
    v_pk_mul_f32 v[32:33], v[32:33], v[226:227]
    v_pk_mul_f32 v[34:35], v[34:35], v[228:229]
    v_cvt_pk_bf16_f32 v28, v28, v29
    v_cvt_pk_bf16_f32 v29, v30, v31
    v_cvt_pk_bf16_f32 v30, v32, v33
    v_cvt_pk_bf16_f32 v31, v34, v35
    v_or_b32 v28, 1, v28
    ds_write_b128 v244, v[28:31] offset:0
    s_add_u32 s36, s45, 0
    buffer_store_dwordx4 v[28:31], v2, s[16:19], s36 offen sc1
    v_pk_fma_f32 v[56:57], v[168:169], v[140:141], v[56:57] op_sel_hi:[0,1,1] neg_lo:[1,0,0] neg_hi:[1,0,0]
    v_pk_fma_f32 v[58:59], v[168:169], v[142:143], v[58:59] op_sel_hi:[0,1,1] neg_lo:[1,0,0] neg_hi:[1,0,0]
    v_pk_mul_f32 v[226:227], v[56:57], v[56:57]
    v_pk_mul_f32 v[228:229], v[58:59], v[58:59]
    v_pk_fma_f32 v[226:227], v[226:227], v[170:171], v[170:171] op_sel:[0,1,0] op_sel_hi:[1,1,0]
    v_pk_fma_f32 v[228:229], v[228:229], v[170:171], v[170:171] op_sel:[0,1,0] op_sel_hi:[1,1,0]
    v_pk_mul_f32 v[226:227], v[226:227], v[56:57]
    v_pk_mul_f32 v[228:229], v[228:229], v[58:59]
    v_exp_f32 v226, v226
    v_exp_f32 v227, v227
    v_exp_f32 v228, v228
    v_exp_f32 v229, v229
    v_pk_fma_f32 v[226:227], v[226:227], v[168:169], v[168:169] op_sel:[0,1,1] op_sel_hi:[1,1,1]
    v_pk_fma_f32 v[228:229], v[228:229], v[168:169], v[168:169] op_sel:[0,1,1] op_sel_hi:[1,1,1]
    v_rcp_f32 v226, v226
    v_rcp_f32 v227, v227
    v_rcp_f32 v228, v228
    v_rcp_f32 v229, v229
    v_pk_mul_f32 v[56:57], v[56:57], v[226:227]
    v_pk_mul_f32 v[58:59], v[58:59], v[228:229]
    v_pk_fma_f32 v[60:61], v[168:169], v[144:145], v[60:61] op_sel_hi:[0,1,1] neg_lo:[1,0,0] neg_hi:[1,0,0]
    v_pk_fma_f32 v[62:63], v[168:169], v[146:147], v[62:63] op_sel_hi:[0,1,1] neg_lo:[1,0,0] neg_hi:[1,0,0]
    v_pk_mul_f32 v[226:227], v[60:61], v[60:61]
    v_pk_mul_f32 v[228:229], v[62:63], v[62:63]
    v_pk_fma_f32 v[226:227], v[226:227], v[170:171], v[170:171] op_sel:[0,1,0] op_sel_hi:[1,1,0]
    v_pk_fma_f32 v[228:229], v[228:229], v[170:171], v[170:171] op_sel:[0,1,0] op_sel_hi:[1,1,0]
    v_pk_mul_f32 v[226:227], v[226:227], v[60:61]
    v_pk_mul_f32 v[228:229], v[228:229], v[62:63]
    v_exp_f32 v226, v226
    v_exp_f32 v227, v227
    v_exp_f32 v228, v228
    v_exp_f32 v229, v229
    v_pk_fma_f32 v[226:227], v[226:227], v[168:169], v[168:169] op_sel:[0,1,1] op_sel_hi:[1,1,1]
    v_pk_fma_f32 v[228:229], v[228:229], v[168:169], v[168:169] op_sel:[0,1,1] op_sel_hi:[1,1,1]
    v_rcp_f32 v226, v226
    v_rcp_f32 v227, v227
    v_rcp_f32 v228, v228
    v_rcp_f32 v229, v229
    v_pk_mul_f32 v[60:61], v[60:61], v[226:227]
    v_pk_mul_f32 v[62:63], v[62:63], v[228:229]
    v_cvt_pk_bf16_f32 v56, v56, v57
    v_cvt_pk_bf16_f32 v57, v58, v59
    v_cvt_pk_bf16_f32 v58, v60, v61
    v_cvt_pk_bf16_f32 v59, v62, v63
    v_or_b32 v56, 1, v56
    ds_write_b128 v244, v[56:59] offset:2048
    s_add_u32 s36, s45, 229376
    buffer_store_dwordx4 v[56:59], v2, s[16:19], s36 offen sc1
    v_pk_fma_f32 v[84:85], v[172:173], v[140:141], v[84:85] op_sel_hi:[0,1,1] neg_lo:[1,0,0] neg_hi:[1,0,0]
    v_pk_fma_f32 v[86:87], v[172:173], v[142:143], v[86:87] op_sel_hi:[0,1,1] neg_lo:[1,0,0] neg_hi:[1,0,0]
    v_pk_mul_f32 v[226:227], v[84:85], v[84:85]
    v_pk_mul_f32 v[228:229], v[86:87], v[86:87]
    v_pk_fma_f32 v[226:227], v[226:227], v[174:175], v[174:175] op_sel:[0,1,0] op_sel_hi:[1,1,0]
    v_pk_fma_f32 v[228:229], v[228:229], v[174:175], v[174:175] op_sel:[0,1,0] op_sel_hi:[1,1,0]
    v_pk_mul_f32 v[226:227], v[226:227], v[84:85]
    v_pk_mul_f32 v[228:229], v[228:229], v[86:87]
    v_exp_f32 v226, v226
    v_exp_f32 v227, v227
    v_exp_f32 v228, v228
    v_exp_f32 v229, v229
    v_pk_fma_f32 v[226:227], v[226:227], v[172:173], v[172:173] op_sel:[0,1,1] op_sel_hi:[1,1,1]
    v_pk_fma_f32 v[228:229], v[228:229], v[172:173], v[172:173] op_sel:[0,1,1] op_sel_hi:[1,1,1]
    v_rcp_f32 v226, v226
    v_rcp_f32 v227, v227
    v_rcp_f32 v228, v228
    v_rcp_f32 v229, v229
    v_pk_mul_f32 v[84:85], v[84:85], v[226:227]
    v_pk_mul_f32 v[86:87], v[86:87], v[228:229]
    v_pk_fma_f32 v[88:89], v[172:173], v[144:145], v[88:89] op_sel_hi:[0,1,1] neg_lo:[1,0,0] neg_hi:[1,0,0]
    v_pk_fma_f32 v[90:91], v[172:173], v[146:147], v[90:91] op_sel_hi:[0,1,1] neg_lo:[1,0,0] neg_hi:[1,0,0]
    v_pk_mul_f32 v[226:227], v[88:89], v[88:89]
    v_pk_mul_f32 v[228:229], v[90:91], v[90:91]
    v_pk_fma_f32 v[226:227], v[226:227], v[174:175], v[174:175] op_sel:[0,1,0] op_sel_hi:[1,1,0]
    v_pk_fma_f32 v[228:229], v[228:229], v[174:175], v[174:175] op_sel:[0,1,0] op_sel_hi:[1,1,0]
    v_pk_mul_f32 v[226:227], v[226:227], v[88:89]
    v_pk_mul_f32 v[228:229], v[228:229], v[90:91]
    v_exp_f32 v226, v226
    v_exp_f32 v227, v227
    v_exp_f32 v228, v228
    v_exp_f32 v229, v229
    v_pk_fma_f32 v[226:227], v[226:227], v[172:173], v[172:173] op_sel:[0,1,1] op_sel_hi:[1,1,1]
    v_pk_fma_f32 v[228:229], v[228:229], v[172:173], v[172:173] op_sel:[0,1,1] op_sel_hi:[1,1,1]
    v_rcp_f32 v226, v226
    v_rcp_f32 v227, v227
    v_rcp_f32 v228, v228
    v_rcp_f32 v229, v229
    v_pk_mul_f32 v[88:89], v[88:89], v[226:227]
    v_pk_mul_f32 v[90:91], v[90:91], v[228:229]
    v_cvt_pk_bf16_f32 v84, v84, v85
    v_cvt_pk_bf16_f32 v85, v86, v87
    v_cvt_pk_bf16_f32 v86, v88, v89
    v_cvt_pk_bf16_f32 v87, v90, v91
    v_or_b32 v84, 1, v84
    ds_write_b128 v244, v[84:87] offset:4096
    s_add_u32 s36, s45, 458752
    buffer_store_dwordx4 v[84:87], v2, s[16:19], s36 offen sc1
    v_pk_fma_f32 v[112:113], v[176:177], v[140:141], v[112:113] op_sel_hi:[0,1,1] neg_lo:[1,0,0] neg_hi:[1,0,0]
    v_pk_fma_f32 v[114:115], v[176:177], v[142:143], v[114:115] op_sel_hi:[0,1,1] neg_lo:[1,0,0] neg_hi:[1,0,0]
    v_pk_mul_f32 v[226:227], v[112:113], v[112:113]
    v_pk_mul_f32 v[228:229], v[114:115], v[114:115]
    v_pk_fma_f32 v[226:227], v[226:227], v[178:179], v[178:179] op_sel:[0,1,0] op_sel_hi:[1,1,0]
    v_pk_fma_f32 v[228:229], v[228:229], v[178:179], v[178:179] op_sel:[0,1,0] op_sel_hi:[1,1,0]
    v_pk_mul_f32 v[226:227], v[226:227], v[112:113]
    v_pk_mul_f32 v[228:229], v[228:229], v[114:115]
    v_exp_f32 v226, v226
    v_exp_f32 v227, v227
    v_exp_f32 v228, v228
    v_exp_f32 v229, v229
    v_pk_fma_f32 v[226:227], v[226:227], v[176:177], v[176:177] op_sel:[0,1,1] op_sel_hi:[1,1,1]
    v_pk_fma_f32 v[228:229], v[228:229], v[176:177], v[176:177] op_sel:[0,1,1] op_sel_hi:[1,1,1]
    v_rcp_f32 v226, v226
    v_rcp_f32 v227, v227
    v_rcp_f32 v228, v228
    v_rcp_f32 v229, v229
    v_pk_mul_f32 v[112:113], v[112:113], v[226:227]
    v_pk_mul_f32 v[114:115], v[114:115], v[228:229]
    v_pk_fma_f32 v[116:117], v[176:177], v[144:145], v[116:117] op_sel_hi:[0,1,1] neg_lo:[1,0,0] neg_hi:[1,0,0]
    v_pk_fma_f32 v[118:119], v[176:177], v[146:147], v[118:119] op_sel_hi:[0,1,1] neg_lo:[1,0,0] neg_hi:[1,0,0]
    v_pk_mul_f32 v[226:227], v[116:117], v[116:117]
    v_pk_mul_f32 v[228:229], v[118:119], v[118:119]
    v_pk_fma_f32 v[226:227], v[226:227], v[178:179], v[178:179] op_sel:[0,1,0] op_sel_hi:[1,1,0]
    v_pk_fma_f32 v[228:229], v[228:229], v[178:179], v[178:179] op_sel:[0,1,0] op_sel_hi:[1,1,0]
    v_pk_mul_f32 v[226:227], v[226:227], v[116:117]
    v_pk_mul_f32 v[228:229], v[228:229], v[118:119]
    v_exp_f32 v226, v226
    v_exp_f32 v227, v227
    v_exp_f32 v228, v228
    v_exp_f32 v229, v229
    v_pk_fma_f32 v[226:227], v[226:227], v[176:177], v[176:177] op_sel:[0,1,1] op_sel_hi:[1,1,1]
    v_pk_fma_f32 v[228:229], v[228:229], v[176:177], v[176:177] op_sel:[0,1,1] op_sel_hi:[1,1,1]
    v_rcp_f32 v226, v226
    v_rcp_f32 v227, v227
    v_rcp_f32 v228, v228
    v_rcp_f32 v229, v229
    v_pk_mul_f32 v[116:117], v[116:117], v[226:227]
    v_pk_mul_f32 v[118:119], v[118:119], v[228:229]
    v_cvt_pk_bf16_f32 v112, v112, v113
    v_cvt_pk_bf16_f32 v113, v114, v115
    v_cvt_pk_bf16_f32 v114, v116, v117
    v_cvt_pk_bf16_f32 v115, v118, v119
    ds_write_b128 v244, v[112:115] offset:6144
    s_add_u32 s36, s45, 688128
    buffer_store_dwordx4 v[112:115], v2, s[16:19], s36 offen sc1
    v_pk_fma_f32 v[36:37], v[164:165], v[148:149], v[36:37] op_sel_hi:[0,1,1] neg_lo:[1,0,0] neg_hi:[1,0,0]
    v_pk_fma_f32 v[38:39], v[164:165], v[150:151], v[38:39] op_sel_hi:[0,1,1] neg_lo:[1,0,0] neg_hi:[1,0,0]
    v_pk_mul_f32 v[226:227], v[36:37], v[36:37]
    v_pk_mul_f32 v[228:229], v[38:39], v[38:39]
    v_pk_fma_f32 v[226:227], v[226:227], v[166:167], v[166:167] op_sel:[0,1,0] op_sel_hi:[1,1,0]
    v_pk_fma_f32 v[228:229], v[228:229], v[166:167], v[166:167] op_sel:[0,1,0] op_sel_hi:[1,1,0]
    v_pk_mul_f32 v[226:227], v[226:227], v[36:37]
    v_pk_mul_f32 v[228:229], v[228:229], v[38:39]
    v_exp_f32 v226, v226
    v_exp_f32 v227, v227
    v_exp_f32 v228, v228
    v_exp_f32 v229, v229
    v_pk_fma_f32 v[226:227], v[226:227], v[164:165], v[164:165] op_sel:[0,1,1] op_sel_hi:[1,1,1]
    v_pk_fma_f32 v[228:229], v[228:229], v[164:165], v[164:165] op_sel:[0,1,1] op_sel_hi:[1,1,1]
    v_rcp_f32 v226, v226
    v_rcp_f32 v227, v227
    v_rcp_f32 v228, v228
    v_rcp_f32 v229, v229
    v_pk_mul_f32 v[36:37], v[36:37], v[226:227]
    v_pk_mul_f32 v[38:39], v[38:39], v[228:229]
    v_pk_fma_f32 v[40:41], v[164:165], v[152:153], v[40:41] op_sel_hi:[0,1,1] neg_lo:[1,0,0] neg_hi:[1,0,0]
    v_pk_fma_f32 v[42:43], v[164:165], v[154:155], v[42:43] op_sel_hi:[0,1,1] neg_lo:[1,0,0] neg_hi:[1,0,0]
    v_pk_mul_f32 v[226:227], v[40:41], v[40:41]
    v_pk_mul_f32 v[228:229], v[42:43], v[42:43]
    v_pk_fma_f32 v[226:227], v[226:227], v[166:167], v[166:167] op_sel:[0,1,0] op_sel_hi:[1,1,0]
    v_pk_fma_f32 v[228:229], v[228:229], v[166:167], v[166:167] op_sel:[0,1,0] op_sel_hi:[1,1,0]
    v_pk_mul_f32 v[226:227], v[226:227], v[40:41]
    v_pk_mul_f32 v[228:229], v[228:229], v[42:43]
    v_exp_f32 v226, v226
    v_exp_f32 v227, v227
    v_exp_f32 v228, v228
    v_exp_f32 v229, v229
    v_pk_fma_f32 v[226:227], v[226:227], v[164:165], v[164:165] op_sel:[0,1,1] op_sel_hi:[1,1,1]
    v_pk_fma_f32 v[228:229], v[228:229], v[164:165], v[164:165] op_sel:[0,1,1] op_sel_hi:[1,1,1]
    v_rcp_f32 v226, v226
    v_rcp_f32 v227, v227
    v_rcp_f32 v228, v228
    v_rcp_f32 v229, v229
    v_pk_mul_f32 v[40:41], v[40:41], v[226:227]
    v_pk_mul_f32 v[42:43], v[42:43], v[228:229]
    v_cvt_pk_bf16_f32 v36, v36, v37
    v_cvt_pk_bf16_f32 v37, v38, v39
    v_cvt_pk_bf16_f32 v38, v40, v41
    v_cvt_pk_bf16_f32 v39, v42, v43
    v_or_b32 v36, 1, v36
    ds_write_b128 v244, v[36:39] offset:16384
    v_pk_fma_f32 v[64:65], v[168:169], v[148:149], v[64:65] op_sel_hi:[0,1,1] neg_lo:[1,0,0] neg_hi:[1,0,0]
    v_pk_fma_f32 v[66:67], v[168:169], v[150:151], v[66:67] op_sel_hi:[0,1,1] neg_lo:[1,0,0] neg_hi:[1,0,0]
    v_pk_mul_f32 v[226:227], v[64:65], v[64:65]
    v_pk_mul_f32 v[228:229], v[66:67], v[66:67]
    v_pk_fma_f32 v[226:227], v[226:227], v[170:171], v[170:171] op_sel:[0,1,0] op_sel_hi:[1,1,0]
    v_pk_fma_f32 v[228:229], v[228:229], v[170:171], v[170:171] op_sel:[0,1,0] op_sel_hi:[1,1,0]
    v_pk_mul_f32 v[226:227], v[226:227], v[64:65]
    v_pk_mul_f32 v[228:229], v[228:229], v[66:67]
    v_exp_f32 v226, v226
    v_exp_f32 v227, v227
    v_exp_f32 v228, v228
    v_exp_f32 v229, v229
    v_pk_fma_f32 v[226:227], v[226:227], v[168:169], v[168:169] op_sel:[0,1,1] op_sel_hi:[1,1,1]
    v_pk_fma_f32 v[228:229], v[228:229], v[168:169], v[168:169] op_sel:[0,1,1] op_sel_hi:[1,1,1]
    v_rcp_f32 v226, v226
    v_rcp_f32 v227, v227
    v_rcp_f32 v228, v228
    v_rcp_f32 v229, v229
    v_pk_mul_f32 v[64:65], v[64:65], v[226:227]
    v_pk_mul_f32 v[66:67], v[66:67], v[228:229]
    v_pk_fma_f32 v[68:69], v[168:169], v[152:153], v[68:69] op_sel_hi:[0,1,1] neg_lo:[1,0,0] neg_hi:[1,0,0]
    v_pk_fma_f32 v[70:71], v[168:169], v[154:155], v[70:71] op_sel_hi:[0,1,1] neg_lo:[1,0,0] neg_hi:[1,0,0]
    v_pk_mul_f32 v[226:227], v[68:69], v[68:69]
    v_pk_mul_f32 v[228:229], v[70:71], v[70:71]
    v_pk_fma_f32 v[226:227], v[226:227], v[170:171], v[170:171] op_sel:[0,1,0] op_sel_hi:[1,1,0]
    v_pk_fma_f32 v[228:229], v[228:229], v[170:171], v[170:171] op_sel:[0,1,0] op_sel_hi:[1,1,0]
    v_pk_mul_f32 v[226:227], v[226:227], v[68:69]
    v_pk_mul_f32 v[228:229], v[228:229], v[70:71]
    v_exp_f32 v226, v226
    v_exp_f32 v227, v227
    v_exp_f32 v228, v228
    v_exp_f32 v229, v229
    v_pk_fma_f32 v[226:227], v[226:227], v[168:169], v[168:169] op_sel:[0,1,1] op_sel_hi:[1,1,1]
    v_pk_fma_f32 v[228:229], v[228:229], v[168:169], v[168:169] op_sel:[0,1,1] op_sel_hi:[1,1,1]
    v_rcp_f32 v226, v226
    v_rcp_f32 v227, v227
    v_rcp_f32 v228, v228
    v_rcp_f32 v229, v229
    v_pk_mul_f32 v[68:69], v[68:69], v[226:227]
    v_pk_mul_f32 v[70:71], v[70:71], v[228:229]
    v_cvt_pk_bf16_f32 v64, v64, v65
    v_cvt_pk_bf16_f32 v65, v66, v67
    v_cvt_pk_bf16_f32 v66, v68, v69
    v_cvt_pk_bf16_f32 v67, v70, v71
    v_or_b32 v64, 1, v64
    ds_write_b128 v244, v[64:67] offset:18432
    s_waitcnt vmcnt(0)
    s_mov_b64 exec, 1
    ds_add_u32 v246, v245
    s_mov_b64 exec, -1
    v_pk_fma_f32 v[92:93], v[172:173], v[148:149], v[92:93] op_sel_hi:[0,1,1] neg_lo:[1,0,0] neg_hi:[1,0,0]
    v_pk_fma_f32 v[94:95], v[172:173], v[150:151], v[94:95] op_sel_hi:[0,1,1] neg_lo:[1,0,0] neg_hi:[1,0,0]
    v_pk_mul_f32 v[226:227], v[92:93], v[92:93]
    v_pk_mul_f32 v[228:229], v[94:95], v[94:95]
    v_pk_fma_f32 v[226:227], v[226:227], v[174:175], v[174:175] op_sel:[0,1,0] op_sel_hi:[1,1,0]
    v_pk_fma_f32 v[228:229], v[228:229], v[174:175], v[174:175] op_sel:[0,1,0] op_sel_hi:[1,1,0]
    v_pk_mul_f32 v[226:227], v[226:227], v[92:93]
    v_pk_mul_f32 v[228:229], v[228:229], v[94:95]
    v_exp_f32 v226, v226
    v_exp_f32 v227, v227
    v_exp_f32 v228, v228
    v_exp_f32 v229, v229
    v_pk_fma_f32 v[226:227], v[226:227], v[172:173], v[172:173] op_sel:[0,1,1] op_sel_hi:[1,1,1]
    v_pk_fma_f32 v[228:229], v[228:229], v[172:173], v[172:173] op_sel:[0,1,1] op_sel_hi:[1,1,1]
    v_rcp_f32 v226, v226
    v_rcp_f32 v227, v227
    v_rcp_f32 v228, v228
    v_rcp_f32 v229, v229
    v_pk_mul_f32 v[92:93], v[92:93], v[226:227]
    v_pk_mul_f32 v[94:95], v[94:95], v[228:229]
    v_pk_fma_f32 v[96:97], v[172:173], v[152:153], v[96:97] op_sel_hi:[0,1,1] neg_lo:[1,0,0] neg_hi:[1,0,0]
    v_pk_fma_f32 v[98:99], v[172:173], v[154:155], v[98:99] op_sel_hi:[0,1,1] neg_lo:[1,0,0] neg_hi:[1,0,0]
    v_pk_mul_f32 v[226:227], v[96:97], v[96:97]
    v_pk_mul_f32 v[228:229], v[98:99], v[98:99]
    v_pk_fma_f32 v[226:227], v[226:227], v[174:175], v[174:175] op_sel:[0,1,0] op_sel_hi:[1,1,0]
    v_pk_fma_f32 v[228:229], v[228:229], v[174:175], v[174:175] op_sel:[0,1,0] op_sel_hi:[1,1,0]
    v_pk_mul_f32 v[226:227], v[226:227], v[96:97]
    v_pk_mul_f32 v[228:229], v[228:229], v[98:99]
    v_exp_f32 v226, v226
    v_exp_f32 v227, v227
    v_exp_f32 v228, v228
    v_exp_f32 v229, v229
    v_pk_fma_f32 v[226:227], v[226:227], v[172:173], v[172:173] op_sel:[0,1,1] op_sel_hi:[1,1,1]
    v_pk_fma_f32 v[228:229], v[228:229], v[172:173], v[172:173] op_sel:[0,1,1] op_sel_hi:[1,1,1]
    v_rcp_f32 v226, v226
    v_rcp_f32 v227, v227
    v_rcp_f32 v228, v228
    v_rcp_f32 v229, v229
    v_pk_mul_f32 v[96:97], v[96:97], v[226:227]
    v_pk_mul_f32 v[98:99], v[98:99], v[228:229]
    v_cvt_pk_bf16_f32 v92, v92, v93
    v_cvt_pk_bf16_f32 v93, v94, v95
    v_cvt_pk_bf16_f32 v94, v96, v97
    v_cvt_pk_bf16_f32 v95, v98, v99
    v_or_b32 v92, 1, v92
    ds_write_b128 v244, v[92:95] offset:20480
    s_cmp_eq_u32 s60, 1
    s_cbranch_scc1 G4_p11
    buffer_load_dwordx4 v[180:183], v196, s[84:87], 0 offen offset:0 sc1
    buffer_load_dwordx4 v[188:191], v196, s[88:91], 0 offen offset:0 sc1
    buffer_load_dwordx4 v[184:187], v196, s[84:87], 0 offen offset:2048 sc1
    buffer_load_dwordx4 v[192:195], v196, s[88:91], 0 offen offset:2048 sc1
    s_branch G4_p21
G4_p11:
    s_add_u32 s36, s40, 0
    buffer_load_dwordx4 v[180:183], v2, s[84:87], s36 offen offset:0 sc1
    buffer_load_dwordx4 v[184:187], v2, s[88:91], s36 offen offset:0 sc1
    buffer_load_dwordx4 v[188:191], v2, s[84:87], s36 offen offset:1024 sc1
    buffer_load_dwordx4 v[192:195], v2, s[88:91], s36 offen offset:1024 sc1
    s_add_u32 s36, s40, 65536
    buffer_load_dwordx4 v[196:199], v2, s[84:87], s36 offen offset:0 sc1
    buffer_load_dwordx4 v[230:233], v2, s[88:91], s36 offen offset:0 sc1
    buffer_load_dwordx4 v[234:237], v2, s[84:87], s36 offen offset:1024 sc1
    buffer_load_dwordx4 v[248:251], v2, s[88:91], s36 offen offset:1024 sc1
G4_p21:
    v_pk_fma_f32 v[120:121], v[176:177], v[148:149], v[120:121] op_sel_hi:[0,1,1] neg_lo:[1,0,0] neg_hi:[1,0,0]
    v_pk_fma_f32 v[122:123], v[176:177], v[150:151], v[122:123] op_sel_hi:[0,1,1] neg_lo:[1,0,0] neg_hi:[1,0,0]
    v_pk_mul_f32 v[226:227], v[120:121], v[120:121]
    v_pk_mul_f32 v[228:229], v[122:123], v[122:123]
    v_pk_fma_f32 v[226:227], v[226:227], v[178:179], v[178:179] op_sel:[0,1,0] op_sel_hi:[1,1,0]
    v_pk_fma_f32 v[228:229], v[228:229], v[178:179], v[178:179] op_sel:[0,1,0] op_sel_hi:[1,1,0]
    v_pk_mul_f32 v[226:227], v[226:227], v[120:121]
    v_pk_mul_f32 v[228:229], v[228:229], v[122:123]
    v_exp_f32 v226, v226
    v_exp_f32 v227, v227
    v_exp_f32 v228, v228
    v_exp_f32 v229, v229
    v_pk_fma_f32 v[226:227], v[226:227], v[176:177], v[176:177] op_sel:[0,1,1] op_sel_hi:[1,1,1]
    v_pk_fma_f32 v[228:229], v[228:229], v[176:177], v[176:177] op_sel:[0,1,1] op_sel_hi:[1,1,1]
    v_rcp_f32 v226, v226
    v_rcp_f32 v227, v227
    v_rcp_f32 v228, v228
    v_rcp_f32 v229, v229
    v_pk_mul_f32 v[120:121], v[120:121], v[226:227]
    v_pk_mul_f32 v[122:123], v[122:123], v[228:229]
    v_pk_fma_f32 v[124:125], v[176:177], v[152:153], v[124:125] op_sel_hi:[0,1,1] neg_lo:[1,0,0] neg_hi:[1,0,0]
    v_pk_fma_f32 v[126:127], v[176:177], v[154:155], v[126:127] op_sel_hi:[0,1,1] neg_lo:[1,0,0] neg_hi:[1,0,0]
    v_pk_mul_f32 v[226:227], v[124:125], v[124:125]
    v_pk_mul_f32 v[228:229], v[126:127], v[126:127]
    v_pk_fma_f32 v[226:227], v[226:227], v[178:179], v[178:179] op_sel:[0,1,0] op_sel_hi:[1,1,0]
    v_pk_fma_f32 v[228:229], v[228:229], v[178:179], v[178:179] op_sel:[0,1,0] op_sel_hi:[1,1,0]
    v_pk_mul_f32 v[226:227], v[226:227], v[124:125]
    v_pk_mul_f32 v[228:229], v[228:229], v[126:127]
    v_exp_f32 v226, v226
    v_exp_f32 v227, v227
    v_exp_f32 v228, v228
    v_exp_f32 v229, v229
    v_pk_fma_f32 v[226:227], v[226:227], v[176:177], v[176:177] op_sel:[0,1,1] op_sel_hi:[1,1,1]
    v_pk_fma_f32 v[228:229], v[228:229], v[176:177], v[176:177] op_sel:[0,1,1] op_sel_hi:[1,1,1]
    v_rcp_f32 v226, v226
    v_rcp_f32 v227, v227
    v_rcp_f32 v228, v228
    v_rcp_f32 v229, v229
    v_pk_mul_f32 v[124:125], v[124:125], v[226:227]
    v_pk_mul_f32 v[126:127], v[126:127], v[228:229]
    v_cvt_pk_bf16_f32 v120, v120, v121
    v_cvt_pk_bf16_f32 v121, v122, v123
    v_cvt_pk_bf16_f32 v122, v124, v125
    v_cvt_pk_bf16_f32 v123, v126, v127
    ds_write_b128 v244, v[120:123] offset:22528
    v_pk_fma_f32 v[44:45], v[164:165], v[156:157], v[44:45] op_sel_hi:[0,1,1] neg_lo:[1,0,0] neg_hi:[1,0,0]
    v_pk_fma_f32 v[46:47], v[164:165], v[158:159], v[46:47] op_sel_hi:[0,1,1] neg_lo:[1,0,0] neg_hi:[1,0,0]
    v_pk_mul_f32 v[226:227], v[44:45], v[44:45]
    v_pk_mul_f32 v[228:229], v[46:47], v[46:47]
    v_pk_fma_f32 v[226:227], v[226:227], v[166:167], v[166:167] op_sel:[0,1,0] op_sel_hi:[1,1,0]
    v_pk_fma_f32 v[228:229], v[228:229], v[166:167], v[166:167] op_sel:[0,1,0] op_sel_hi:[1,1,0]
    v_pk_mul_f32 v[226:227], v[226:227], v[44:45]
    v_pk_mul_f32 v[228:229], v[228:229], v[46:47]
    v_exp_f32 v226, v226
    v_exp_f32 v227, v227
    v_exp_f32 v228, v228
    v_exp_f32 v229, v229
    v_pk_fma_f32 v[226:227], v[226:227], v[164:165], v[164:165] op_sel:[0,1,1] op_sel_hi:[1,1,1]
    v_pk_fma_f32 v[228:229], v[228:229], v[164:165], v[164:165] op_sel:[0,1,1] op_sel_hi:[1,1,1]
    v_rcp_f32 v226, v226
    v_rcp_f32 v227, v227
    v_rcp_f32 v228, v228
    v_rcp_f32 v229, v229
    v_pk_mul_f32 v[44:45], v[44:45], v[226:227]
    v_pk_mul_f32 v[46:47], v[46:47], v[228:229]
    v_pk_fma_f32 v[48:49], v[164:165], v[160:161], v[48:49] op_sel_hi:[0,1,1] neg_lo:[1,0,0] neg_hi:[1,0,0]
    v_pk_fma_f32 v[50:51], v[164:165], v[162:163], v[50:51] op_sel_hi:[0,1,1] neg_lo:[1,0,0] neg_hi:[1,0,0]
    v_pk_mul_f32 v[226:227], v[48:49], v[48:49]
    v_pk_mul_f32 v[228:229], v[50:51], v[50:51]
    v_pk_fma_f32 v[226:227], v[226:227], v[166:167], v[166:167] op_sel:[0,1,0] op_sel_hi:[1,1,0]
    v_pk_fma_f32 v[228:229], v[228:229], v[166:167], v[166:167] op_sel:[0,1,0] op_sel_hi:[1,1,0]
    v_pk_mul_f32 v[226:227], v[226:227], v[48:49]
    v_pk_mul_f32 v[228:229], v[228:229], v[50:51]
    v_exp_f32 v226, v226
    v_exp_f32 v227, v227
    v_exp_f32 v228, v228
    v_exp_f32 v229, v229
    v_pk_fma_f32 v[226:227], v[226:227], v[164:165], v[164:165] op_sel:[0,1,1] op_sel_hi:[1,1,1]
    v_pk_fma_f32 v[228:229], v[228:229], v[164:165], v[164:165] op_sel:[0,1,1] op_sel_hi:[1,1,1]
    v_rcp_f32 v226, v226
    v_rcp_f32 v227, v227
    v_rcp_f32 v228, v228
    v_rcp_f32 v229, v229
    v_pk_mul_f32 v[48:49], v[48:49], v[226:227]
    v_pk_mul_f32 v[50:51], v[50:51], v[228:229]
    v_cvt_pk_bf16_f32 v200, v44, v45
    v_cvt_pk_bf16_f32 v201, v46, v47
    v_cvt_pk_bf16_f32 v202, v48, v49
    v_cvt_pk_bf16_f32 v203, v50, v51
    v_or_b32 v200, 1, v200
    ds_write_b128 v244, v[200:203] offset:32768
    v_pk_fma_f32 v[72:73], v[168:169], v[156:157], v[72:73] op_sel_hi:[0,1,1] neg_lo:[1,0,0] neg_hi:[1,0,0]
    v_pk_fma_f32 v[74:75], v[168:169], v[158:159], v[74:75] op_sel_hi:[0,1,1] neg_lo:[1,0,0] neg_hi:[1,0,0]
    v_pk_mul_f32 v[226:227], v[72:73], v[72:73]
    v_pk_mul_f32 v[228:229], v[74:75], v[74:75]
    v_pk_fma_f32 v[226:227], v[226:227], v[170:171], v[170:171] op_sel:[0,1,0] op_sel_hi:[1,1,0]
    v_pk_fma_f32 v[228:229], v[228:229], v[170:171], v[170:171] op_sel:[0,1,0] op_sel_hi:[1,1,0]
    v_pk_mul_f32 v[226:227], v[226:227], v[72:73]
    v_pk_mul_f32 v[228:229], v[228:229], v[74:75]
    v_exp_f32 v226, v226
    v_exp_f32 v227, v227
    v_exp_f32 v228, v228
    v_exp_f32 v229, v229
    v_pk_fma_f32 v[226:227], v[226:227], v[168:169], v[168:169] op_sel:[0,1,1] op_sel_hi:[1,1,1]
    v_pk_fma_f32 v[228:229], v[228:229], v[168:169], v[168:169] op_sel:[0,1,1] op_sel_hi:[1,1,1]
    v_rcp_f32 v226, v226
    v_rcp_f32 v227, v227
    v_rcp_f32 v228, v228
    v_rcp_f32 v229, v229
    v_pk_mul_f32 v[72:73], v[72:73], v[226:227]
    v_pk_mul_f32 v[74:75], v[74:75], v[228:229]
    v_pk_fma_f32 v[76:77], v[168:169], v[160:161], v[76:77] op_sel_hi:[0,1,1] neg_lo:[1,0,0] neg_hi:[1,0,0]
    v_pk_fma_f32 v[78:79], v[168:169], v[162:163], v[78:79] op_sel_hi:[0,1,1] neg_lo:[1,0,0] neg_hi:[1,0,0]
    v_pk_mul_f32 v[226:227], v[76:77], v[76:77]
    v_pk_mul_f32 v[228:229], v[78:79], v[78:79]
    v_pk_fma_f32 v[226:227], v[226:227], v[170:171], v[170:171] op_sel:[0,1,0] op_sel_hi:[1,1,0]
    v_pk_fma_f32 v[228:229], v[228:229], v[170:171], v[170:171] op_sel:[0,1,0] op_sel_hi:[1,1,0]
    v_pk_mul_f32 v[226:227], v[226:227], v[76:77]
    v_pk_mul_f32 v[228:229], v[228:229], v[78:79]
    v_exp_f32 v226, v226
    v_exp_f32 v227, v227
    v_exp_f32 v228, v228
    v_exp_f32 v229, v229
    v_pk_fma_f32 v[226:227], v[226:227], v[168:169], v[168:169] op_sel:[0,1,1] op_sel_hi:[1,1,1]
    v_pk_fma_f32 v[228:229], v[228:229], v[168:169], v[168:169] op_sel:[0,1,1] op_sel_hi:[1,1,1]
    v_rcp_f32 v226, v226
    v_rcp_f32 v227, v227
    v_rcp_f32 v228, v228
    v_rcp_f32 v229, v229
    v_pk_mul_f32 v[76:77], v[76:77], v[226:227]
    v_pk_mul_f32 v[78:79], v[78:79], v[228:229]
    v_cvt_pk_bf16_f32 v204, v72, v73
    v_cvt_pk_bf16_f32 v205, v74, v75
    v_cvt_pk_bf16_f32 v206, v76, v77
    v_cvt_pk_bf16_f32 v207, v78, v79
    v_or_b32 v204, 1, v204
    ds_write_b128 v244, v[204:207] offset:34816
    v_pk_fma_f32 v[100:101], v[172:173], v[156:157], v[100:101] op_sel_hi:[0,1,1] neg_lo:[1,0,0] neg_hi:[1,0,0]
    v_pk_fma_f32 v[102:103], v[172:173], v[158:159], v[102:103] op_sel_hi:[0,1,1] neg_lo:[1,0,0] neg_hi:[1,0,0]
    v_pk_mul_f32 v[226:227], v[100:101], v[100:101]
    v_pk_mul_f32 v[228:229], v[102:103], v[102:103]
    v_pk_fma_f32 v[226:227], v[226:227], v[174:175], v[174:175] op_sel:[0,1,0] op_sel_hi:[1,1,0]
    v_pk_fma_f32 v[228:229], v[228:229], v[174:175], v[174:175] op_sel:[0,1,0] op_sel_hi:[1,1,0]
    v_pk_mul_f32 v[226:227], v[226:227], v[100:101]
    v_pk_mul_f32 v[228:229], v[228:229], v[102:103]
    v_exp_f32 v226, v226
    v_exp_f32 v227, v227
    v_exp_f32 v228, v228
    v_exp_f32 v229, v229
    v_pk_fma_f32 v[226:227], v[226:227], v[172:173], v[172:173] op_sel:[0,1,1] op_sel_hi:[1,1,1]
    v_pk_fma_f32 v[228:229], v[228:229], v[172:173], v[172:173] op_sel:[0,1,1] op_sel_hi:[1,1,1]
    v_rcp_f32 v226, v226
    v_rcp_f32 v227, v227
    v_rcp_f32 v228, v228
    v_rcp_f32 v229, v229
    v_pk_mul_f32 v[100:101], v[100:101], v[226:227]
    v_pk_mul_f32 v[102:103], v[102:103], v[228:229]
    v_pk_fma_f32 v[104:105], v[172:173], v[160:161], v[104:105] op_sel_hi:[0,1,1] neg_lo:[1,0,0] neg_hi:[1,0,0]
    v_pk_fma_f32 v[106:107], v[172:173], v[162:163], v[106:107] op_sel_hi:[0,1,1] neg_lo:[1,0,0] neg_hi:[1,0,0]
    v_pk_mul_f32 v[226:227], v[104:105], v[104:105]
    v_pk_mul_f32 v[228:229], v[106:107], v[106:107]
    v_pk_fma_f32 v[226:227], v[226:227], v[174:175], v[174:175] op_sel:[0,1,0] op_sel_hi:[1,1,0]
    v_pk_fma_f32 v[228:229], v[228:229], v[174:175], v[174:175] op_sel:[0,1,0] op_sel_hi:[1,1,0]
    v_pk_mul_f32 v[226:227], v[226:227], v[104:105]
    v_pk_mul_f32 v[228:229], v[228:229], v[106:107]
    v_exp_f32 v226, v226
    v_exp_f32 v227, v227
    v_exp_f32 v228, v228
    v_exp_f32 v229, v229
    v_pk_fma_f32 v[226:227], v[226:227], v[172:173], v[172:173] op_sel:[0,1,1] op_sel_hi:[1,1,1]
    v_pk_fma_f32 v[228:229], v[228:229], v[172:173], v[172:173] op_sel:[0,1,1] op_sel_hi:[1,1,1]
    v_rcp_f32 v226, v226
    v_rcp_f32 v227, v227
    v_rcp_f32 v228, v228
    v_rcp_f32 v229, v229
    v_pk_mul_f32 v[104:105], v[104:105], v[226:227]
    v_pk_mul_f32 v[106:107], v[106:107], v[228:229]
    v_cvt_pk_bf16_f32 v208, v100, v101
    v_cvt_pk_bf16_f32 v209, v102, v103
    v_cvt_pk_bf16_f32 v210, v104, v105
    v_cvt_pk_bf16_f32 v211, v106, v107
    v_or_b32 v208, 1, v208
    ds_write_b128 v244, v[208:211] offset:36864
    v_pk_fma_f32 v[128:129], v[176:177], v[156:157], v[128:129] op_sel_hi:[0,1,1] neg_lo:[1,0,0] neg_hi:[1,0,0]
    v_pk_fma_f32 v[130:131], v[176:177], v[158:159], v[130:131] op_sel_hi:[0,1,1] neg_lo:[1,0,0] neg_hi:[1,0,0]
    v_pk_mul_f32 v[226:227], v[128:129], v[128:129]
    v_pk_mul_f32 v[228:229], v[130:131], v[130:131]
    v_pk_fma_f32 v[226:227], v[226:227], v[178:179], v[178:179] op_sel:[0,1,0] op_sel_hi:[1,1,0]
    v_pk_fma_f32 v[228:229], v[228:229], v[178:179], v[178:179] op_sel:[0,1,0] op_sel_hi:[1,1,0]
    v_pk_mul_f32 v[226:227], v[226:227], v[128:129]
    v_pk_mul_f32 v[228:229], v[228:229], v[130:131]
    v_exp_f32 v226, v226
    v_exp_f32 v227, v227
    v_exp_f32 v228, v228
    v_exp_f32 v229, v229
    v_pk_fma_f32 v[226:227], v[226:227], v[176:177], v[176:177] op_sel:[0,1,1] op_sel_hi:[1,1,1]
    v_pk_fma_f32 v[228:229], v[228:229], v[176:177], v[176:177] op_sel:[0,1,1] op_sel_hi:[1,1,1]
    v_rcp_f32 v226, v226
    v_rcp_f32 v227, v227
    v_rcp_f32 v228, v228
    v_rcp_f32 v229, v229
    v_pk_mul_f32 v[128:129], v[128:129], v[226:227]
    v_pk_mul_f32 v[130:131], v[130:131], v[228:229]
    v_pk_fma_f32 v[132:133], v[176:177], v[160:161], v[132:133] op_sel_hi:[0,1,1] neg_lo:[1,0,0] neg_hi:[1,0,0]
    v_pk_fma_f32 v[134:135], v[176:177], v[162:163], v[134:135] op_sel_hi:[0,1,1] neg_lo:[1,0,0] neg_hi:[1,0,0]
    v_pk_mul_f32 v[226:227], v[132:133], v[132:133]
    v_pk_mul_f32 v[228:229], v[134:135], v[134:135]
    v_pk_fma_f32 v[226:227], v[226:227], v[178:179], v[178:179] op_sel:[0,1,0] op_sel_hi:[1,1,0]
    v_pk_fma_f32 v[228:229], v[228:229], v[178:179], v[178:179] op_sel:[0,1,0] op_sel_hi:[1,1,0]
    v_pk_mul_f32 v[226:227], v[226:227], v[132:133]
    v_pk_mul_f32 v[228:229], v[228:229], v[134:135]
    v_exp_f32 v226, v226
    v_exp_f32 v227, v227
    v_exp_f32 v228, v228
    v_exp_f32 v229, v229
    v_pk_fma_f32 v[226:227], v[226:227], v[176:177], v[176:177] op_sel:[0,1,1] op_sel_hi:[1,1,1]
    v_pk_fma_f32 v[228:229], v[228:229], v[176:177], v[176:177] op_sel:[0,1,1] op_sel_hi:[1,1,1]
    v_rcp_f32 v226, v226
    v_rcp_f32 v227, v227
    v_rcp_f32 v228, v228
    v_rcp_f32 v229, v229
    v_pk_mul_f32 v[132:133], v[132:133], v[226:227]
    v_pk_mul_f32 v[134:135], v[134:135], v[228:229]
    v_cvt_pk_bf16_f32 v212, v128, v129
    v_cvt_pk_bf16_f32 v213, v130, v131
    v_cvt_pk_bf16_f32 v214, v132, v133
    v_cvt_pk_bf16_f32 v215, v134, v135
    ds_write_b128 v244, v[212:215] offset:38912
    v_pk_fma_f32 v[24:25], v[164:165], v[136:137], v[24:25] op_sel_hi:[0,1,1] neg_lo:[1,0,0] neg_hi:[1,0,0]
    v_pk_fma_f32 v[26:27], v[164:165], v[138:139], v[26:27] op_sel_hi:[0,1,1] neg_lo:[1,0,0] neg_hi:[1,0,0]
    v_pk_mul_f32 v[226:227], v[24:25], v[24:25]
    v_pk_mul_f32 v[228:229], v[26:27], v[26:27]
    v_pk_fma_f32 v[226:227], v[226:227], v[166:167], v[166:167] op_sel:[0,1,0] op_sel_hi:[1,1,0]
    v_pk_fma_f32 v[228:229], v[228:229], v[166:167], v[166:167] op_sel:[0,1,0] op_sel_hi:[1,1,0]
    v_pk_mul_f32 v[226:227], v[226:227], v[24:25]
    v_pk_mul_f32 v[228:229], v[228:229], v[26:27]
    v_exp_f32 v226, v226
    v_exp_f32 v227, v227
    v_exp_f32 v228, v228
    v_exp_f32 v229, v229
    v_pk_fma_f32 v[226:227], v[226:227], v[164:165], v[164:165] op_sel:[0,1,1] op_sel_hi:[1,1,1]
    v_pk_fma_f32 v[228:229], v[228:229], v[164:165], v[164:165] op_sel:[0,1,1] op_sel_hi:[1,1,1]
    v_rcp_f32 v226, v226
    v_rcp_f32 v227, v227
    v_rcp_f32 v228, v228
    v_rcp_f32 v229, v229
    v_pk_mul_f32 v[24:25], v[24:25], v[226:227]
    v_pk_mul_f32 v[26:27], v[26:27], v[228:229]
    v_cvt_pk_bf16_f32 v216, v24, v25
    v_cvt_pk_bf16_f32 v217, v26, v27
    v_or_b32 v216, 1, v216
    s_add_u32 s36, s46, 0
    buffer_store_dwordx4 v[36:39], v2, s[16:19], s36 offen sc1
    v_pk_fma_f32 v[52:53], v[168:169], v[136:137], v[52:53] op_sel_hi:[0,1,1] neg_lo:[1,0,0] neg_hi:[1,0,0]
    v_pk_fma_f32 v[54:55], v[168:169], v[138:139], v[54:55] op_sel_hi:[0,1,1] neg_lo:[1,0,0] neg_hi:[1,0,0]
    v_pk_mul_f32 v[226:227], v[52:53], v[52:53]
    v_pk_mul_f32 v[228:229], v[54:55], v[54:55]
    v_pk_fma_f32 v[226:227], v[226:227], v[170:171], v[170:171] op_sel:[0,1,0] op_sel_hi:[1,1,0]
    v_pk_fma_f32 v[228:229], v[228:229], v[170:171], v[170:171] op_sel:[0,1,0] op_sel_hi:[1,1,0]
    v_pk_mul_f32 v[226:227], v[226:227], v[52:53]
    v_pk_mul_f32 v[228:229], v[228:229], v[54:55]
    v_exp_f32 v226, v226
    v_exp_f32 v227, v227
    v_exp_f32 v228, v228
    v_exp_f32 v229, v229
    v_pk_fma_f32 v[226:227], v[226:227], v[168:169], v[168:169] op_sel:[0,1,1] op_sel_hi:[1,1,1]
    v_pk_fma_f32 v[228:229], v[228:229], v[168:169], v[168:169] op_sel:[0,1,1] op_sel_hi:[1,1,1]
    v_rcp_f32 v226, v226
    v_rcp_f32 v227, v227
    v_rcp_f32 v228, v228
    v_rcp_f32 v229, v229
    v_pk_mul_f32 v[52:53], v[52:53], v[226:227]
    v_pk_mul_f32 v[54:55], v[54:55], v[228:229]
    v_cvt_pk_bf16_f32 v218, v52, v53
    v_cvt_pk_bf16_f32 v219, v54, v55
    v_or_b32 v218, 1, v218
    s_add_u32 s36, s46, 229376
    buffer_store_dwordx4 v[64:67], v2, s[16:19], s36 offen sc1
    v_pk_fma_f32 v[80:81], v[172:173], v[136:137], v[80:81] op_sel_hi:[0,1,1] neg_lo:[1,0,0] neg_hi:[1,0,0]
    v_pk_fma_f32 v[82:83], v[172:173], v[138:139], v[82:83] op_sel_hi:[0,1,1] neg_lo:[1,0,0] neg_hi:[1,0,0]
    v_pk_mul_f32 v[226:227], v[80:81], v[80:81]
    v_pk_mul_f32 v[228:229], v[82:83], v[82:83]
    v_pk_fma_f32 v[226:227], v[226:227], v[174:175], v[174:175] op_sel:[0,1,0] op_sel_hi:[1,1,0]
    v_pk_fma_f32 v[228:229], v[228:229], v[174:175], v[174:175] op_sel:[0,1,0] op_sel_hi:[1,1,0]
    v_pk_mul_f32 v[226:227], v[226:227], v[80:81]
    v_pk_mul_f32 v[228:229], v[228:229], v[82:83]
    v_exp_f32 v226, v226
    v_exp_f32 v227, v227
    v_exp_f32 v228, v228
    v_exp_f32 v229, v229
    v_pk_fma_f32 v[226:227], v[226:227], v[172:173], v[172:173] op_sel:[0,1,1] op_sel_hi:[1,1,1]
    v_pk_fma_f32 v[228:229], v[228:229], v[172:173], v[172:173] op_sel:[0,1,1] op_sel_hi:[1,1,1]
    v_rcp_f32 v226, v226
    v_rcp_f32 v227, v227
    v_rcp_f32 v228, v228
    v_rcp_f32 v229, v229
    v_pk_mul_f32 v[80:81], v[80:81], v[226:227]
    v_pk_mul_f32 v[82:83], v[82:83], v[228:229]
    v_cvt_pk_bf16_f32 v220, v80, v81
    v_cvt_pk_bf16_f32 v221, v82, v83
    v_or_b32 v220, 1, v220
    s_add_u32 s36, s46, 458752
    buffer_store_dwordx4 v[92:95], v2, s[16:19], s36 offen sc1
    v_pk_fma_f32 v[108:109], v[176:177], v[136:137], v[108:109] op_sel_hi:[0,1,1] neg_lo:[1,0,0] neg_hi:[1,0,0]
    v_pk_fma_f32 v[110:111], v[176:177], v[138:139], v[110:111] op_sel_hi:[0,1,1] neg_lo:[1,0,0] neg_hi:[1,0,0]
    v_pk_mul_f32 v[226:227], v[108:109], v[108:109]
    v_pk_mul_f32 v[228:229], v[110:111], v[110:111]
    v_pk_fma_f32 v[226:227], v[226:227], v[178:179], v[178:179] op_sel:[0,1,0] op_sel_hi:[1,1,0]
    v_pk_fma_f32 v[228:229], v[228:229], v[178:179], v[178:179] op_sel:[0,1,0] op_sel_hi:[1,1,0]
    v_pk_mul_f32 v[226:227], v[226:227], v[108:109]
    v_pk_mul_f32 v[228:229], v[228:229], v[110:111]
    v_exp_f32 v226, v226
    v_exp_f32 v227, v227
    v_exp_f32 v228, v228
    v_exp_f32 v229, v229
    v_pk_fma_f32 v[226:227], v[226:227], v[176:177], v[176:177] op_sel:[0,1,1] op_sel_hi:[1,1,1]
    v_pk_fma_f32 v[228:229], v[228:229], v[176:177], v[176:177] op_sel:[0,1,1] op_sel_hi:[1,1,1]
    v_rcp_f32 v226, v226
    v_rcp_f32 v227, v227
    v_rcp_f32 v228, v228
    v_rcp_f32 v229, v229
    v_pk_mul_f32 v[108:109], v[108:109], v[226:227]
    v_pk_mul_f32 v[110:111], v[110:111], v[228:229]
    v_cvt_pk_bf16_f32 v222, v108, v109
    v_cvt_pk_bf16_f32 v223, v110, v111
    s_add_u32 s36, s46, 688128
    buffer_store_dwordx4 v[120:123], v2, s[16:19], s36 offen sc1
    s_waitcnt lgkmcnt(0)
    s_add_u32 s45, s44, 512
    s_mov_b32 s44, s47
G3_e2:
    s_waitcnt lgkmcnt(0)
    s_barrier
    ds_read_b128 v[88:91], v17 offset:0
    ds_read_b128 v[92:95], v17 offset:2048
    ds_read_b128 v[96:99], v17 offset:4096
    ds_read_b128 v[100:103], v17 offset:6144
    ds_read_b64_tr_b16 v[104:105], v18 offset:0
    ds_read_b64_tr_b16 v[106:107], v18 offset:4096
    ds_read_b64_tr_b16 v[108:109], v19 offset:0
    ds_read_b64_tr_b16 v[110:111], v19 offset:4096
    ds_read_b64_tr_b16 v[112:113], v20 offset:0
    ds_read_b64_tr_b16 v[114:115], v20 offset:4096
    ds_read_b64_tr_b16 v[116:117], v21 offset:0
    ds_read_b64_tr_b16 v[118:119], v21 offset:4096
    s_waitcnt lgkmcnt(6)
    v_mfma_f32_16x16x32_bf16 v[24:27], v[104:107], v[88:91], 0
    ds_read_b128 v[120:123], v17 offset:1024
    s_add_u32 s42, s42, 16384
    v_mfma_f32_16x16x32_bf16 v[40:43], v[104:107], v[92:95], 0
    ds_read_b128 v[124:127], v17 offset:3072
    s_cmp_eq_u32 s42, 49152
    v_mfma_f32_16x16x32_bf16 v[56:59], v[104:107], v[96:99], 0
    ds_read_b128 v[128:131], v17 offset:5120
    s_cselect_b32 s42, 0, s42
    v_mfma_f32_16x16x32_bf16 v[72:75], v[104:107], v[100:103], 0
    ds_read_b128 v[132:135], v17 offset:7168
    s_waitcnt lgkmcnt(8)
    v_mfma_f32_16x16x32_bf16 v[76:79], v[108:111], v[100:103], 0
    ds_read_b64_tr_b16 v[136:137], v18 offset:8192
    s_add_u32 s48, s48, 16384
    v_mfma_f32_16x16x32_bf16 v[60:63], v[108:111], v[96:99], 0
    ds_read_b64_tr_b16 v[138:139], v18 offset:12288
    s_cmp_eq_u32 s48, 98304
    v_mfma_f32_16x16x32_bf16 v[44:47], v[108:111], v[92:95], 0
    ds_read_b64_tr_b16 v[140:141], v19 offset:8192
    s_cselect_b32 s48, 0, s48
    v_mfma_f32_16x16x32_bf16 v[28:31], v[108:111], v[88:91], 0
    ds_read_b64_tr_b16 v[142:143], v19 offset:12288
    s_waitcnt lgkmcnt(8)
    v_mfma_f32_16x16x32_bf16 v[32:35], v[112:115], v[88:91], 0
    ds_read_b64_tr_b16 v[144:145], v20 offset:8192
    v_add_u32 v17, s42, v12
    v_mfma_f32_16x16x32_bf16 v[48:51], v[112:115], v[92:95], 0
    ds_read_b64_tr_b16 v[146:147], v20 offset:12288
    s_add_u32 s36, s44, 0
    v_mfma_f32_16x16x32_bf16 v[64:67], v[112:115], v[96:99], 0
    ds_read_b64_tr_b16 v[148:149], v21 offset:8192
    buffer_store_dwordx4 v[200:203], v2, s[16:19], s36 offen sc1
    v_mfma_f32_16x16x32_bf16 v[80:83], v[112:115], v[100:103], 0
    ds_read_b64_tr_b16 v[150:151], v21 offset:12288
    s_add_u32 s36, s45, 0
    v_mfma_f32_16x16x32_bf16 v[84:87], v[116:119], v[100:103], 0
    buffer_store_dwordx2 v[216:217], v238, s[16:19], s36 offen sc1
    v_add_u32 v18, s48, v13
    v_mfma_f32_16x16x32_bf16 v[68:71], v[116:119], v[96:99], 0
    v_add_u32 v19, s48, v14
    v_mfma_f32_16x16x32_bf16 v[52:55], v[116:119], v[92:95], 0
    v_add_u32 v20, s48, v15
    v_mfma_f32_16x16x32_bf16 v[36:39], v[116:119], v[88:91], 0
    v_add_u32 v21, s48, v16
    s_waitcnt lgkmcnt(6)
    v_mfma_f32_16x16x32_bf16 v[24:27], v[136:139], v[120:123], v[24:27]
    v_mfma_f32_16x16x32_bf16 v[40:43], v[136:139], v[124:127], v[40:43]
    v_mfma_f32_16x16x32_bf16 v[56:59], v[136:139], v[128:131], v[56:59]
    s_waitcnt lgkmcnt(0)
    s_barrier
    v_mfma_f32_16x16x32_bf16 v[72:75], v[136:139], v[132:135], v[72:75]
    ds_read_b128 v[88:91], v17 offset:0
    s_add_u32 s36, s44, 229376
    v_mfma_f32_16x16x32_bf16 v[76:79], v[140:143], v[132:135], v[76:79]
    ds_read_b128 v[92:95], v17 offset:2048
    buffer_store_dwordx4 v[204:207], v2, s[16:19], s36 offen sc1
    v_mfma_f32_16x16x32_bf16 v[60:63], v[140:143], v[128:131], v[60:63]
    ds_read_b128 v[96:99], v17 offset:4096
    s_add_u32 s36, s45, 229376
    v_mfma_f32_16x16x32_bf16 v[44:47], v[140:143], v[124:127], v[44:47]
    ds_read_b128 v[100:103], v17 offset:6144
    buffer_store_dwordx2 v[218:219], v238, s[16:19], s36 offen sc1
    v_mfma_f32_16x16x32_bf16 v[28:31], v[140:143], v[120:123], v[28:31]
    ds_read_b64_tr_b16 v[104:105], v18 offset:0
    s_add_u32 s43, s43, 1
    v_mfma_f32_16x16x32_bf16 v[32:35], v[144:147], v[120:123], v[32:35]
    ds_read_b64_tr_b16 v[106:107], v18 offset:4096
    s_cmp_lt_u32 s43, 27
    v_mfma_f32_16x16x32_bf16 v[48:51], v[144:147], v[124:127], v[48:51]
    ds_read_b64_tr_b16 v[108:109], v19 offset:0
    v_mfma_f32_16x16x32_bf16 v[64:67], v[144:147], v[128:131], v[64:67]
    ds_read_b64_tr_b16 v[110:111], v19 offset:4096
    v_mfma_f32_16x16x32_bf16 v[80:83], v[144:147], v[132:135], v[80:83]
    ds_read_b64_tr_b16 v[112:113], v20 offset:0
    v_mfma_f32_16x16x32_bf16 v[84:87], v[148:151], v[132:135], v[84:87]
    ds_read_b64_tr_b16 v[114:115], v20 offset:4096
    v_mfma_f32_16x16x32_bf16 v[68:71], v[148:151], v[128:131], v[68:71]
    ds_read_b64_tr_b16 v[116:117], v21 offset:0
    v_mfma_f32_16x16x32_bf16 v[52:55], v[148:151], v[124:127], v[52:55]
    ds_read_b64_tr_b16 v[118:119], v21 offset:4096
    v_mfma_f32_16x16x32_bf16 v[36:39], v[148:151], v[120:123], v[36:39]
    s_waitcnt lgkmcnt(6)
    v_mfma_f32_16x16x32_bf16 v[24:27], v[104:107], v[88:91], v[24:27]
    ds_read_b128 v[120:123], v17 offset:1024
    s_add_u32 s42, s42, 16384
    v_mfma_f32_16x16x32_bf16 v[40:43], v[104:107], v[92:95], v[40:43]
    ds_read_b128 v[124:127], v17 offset:3072
    s_cmp_eq_u32 s42, 49152
    v_mfma_f32_16x16x32_bf16 v[56:59], v[104:107], v[96:99], v[56:59]
    ds_read_b128 v[128:131], v17 offset:5120
    s_cselect_b32 s42, 0, s42
    v_mfma_f32_16x16x32_bf16 v[72:75], v[104:107], v[100:103], v[72:75]
    ds_read_b128 v[132:135], v17 offset:7168
    s_waitcnt lgkmcnt(8)
    v_mfma_f32_16x16x32_bf16 v[76:79], v[108:111], v[100:103], v[76:79]
    ds_read_b64_tr_b16 v[136:137], v18 offset:8192
    s_add_u32 s48, s48, 16384
    v_mfma_f32_16x16x32_bf16 v[60:63], v[108:111], v[96:99], v[60:63]
    ds_read_b64_tr_b16 v[138:139], v18 offset:12288
    s_cmp_eq_u32 s48, 98304
    v_mfma_f32_16x16x32_bf16 v[44:47], v[108:111], v[92:95], v[44:47]
    ds_read_b64_tr_b16 v[140:141], v19 offset:8192
    s_cselect_b32 s48, 0, s48
    v_mfma_f32_16x16x32_bf16 v[28:31], v[108:111], v[88:91], v[28:31]
    ds_read_b64_tr_b16 v[142:143], v19 offset:12288
    s_waitcnt lgkmcnt(8)
    v_mfma_f32_16x16x32_bf16 v[32:35], v[112:115], v[88:91], v[32:35]
    ds_read_b64_tr_b16 v[144:145], v20 offset:8192
    v_add_u32 v17, s42, v12
    v_mfma_f32_16x16x32_bf16 v[48:51], v[112:115], v[92:95], v[48:51]
    ds_read_b64_tr_b16 v[146:147], v20 offset:12288
    s_add_u32 s36, s44, 458752
    v_mfma_f32_16x16x32_bf16 v[64:67], v[112:115], v[96:99], v[64:67]
    ds_read_b64_tr_b16 v[148:149], v21 offset:8192
    buffer_store_dwordx4 v[208:211], v2, s[16:19], s36 offen sc1
    v_mfma_f32_16x16x32_bf16 v[80:83], v[112:115], v[100:103], v[80:83]
    ds_read_b64_tr_b16 v[150:151], v21 offset:12288
    s_add_u32 s36, s45, 458752
    v_mfma_f32_16x16x32_bf16 v[84:87], v[116:119], v[100:103], v[84:87]
    buffer_store_dwordx2 v[220:221], v238, s[16:19], s36 offen sc1
    v_add_u32 v18, s48, v13
    v_mfma_f32_16x16x32_bf16 v[68:71], v[116:119], v[96:99], v[68:71]
    v_add_u32 v19, s48, v14
    v_mfma_f32_16x16x32_bf16 v[52:55], v[116:119], v[92:95], v[52:55]
    v_add_u32 v20, s48, v15
    v_mfma_f32_16x16x32_bf16 v[36:39], v[116:119], v[88:91], v[36:39]
    v_add_u32 v21, s48, v16
    s_waitcnt lgkmcnt(6)
    v_mfma_f32_16x16x32_bf16 v[24:27], v[136:139], v[120:123], v[24:27]
    v_mfma_f32_16x16x32_bf16 v[40:43], v[136:139], v[124:127], v[40:43]
    s_waitcnt vmcnt(6)
    v_mfma_f32_16x16x32_bf16 v[56:59], v[136:139], v[128:131], v[56:59]
    s_waitcnt lgkmcnt(0)
    s_barrier
    v_mfma_f32_16x16x32_bf16 v[72:75], v[136:139], v[132:135], v[72:75]
    ds_read_b128 v[88:91], v17 offset:0
    s_add_u32 s36, s44, 688128
    v_mfma_f32_16x16x32_bf16 v[76:79], v[140:143], v[132:135], v[76:79]
    ds_read_b128 v[92:95], v17 offset:2048
    buffer_store_dwordx4 v[212:215], v2, s[16:19], s36 offen sc1
    v_mfma_f32_16x16x32_bf16 v[60:63], v[140:143], v[128:131], v[60:63]
    ds_read_b128 v[96:99], v17 offset:4096
    s_add_u32 s36, s45, 688128
    v_mfma_f32_16x16x32_bf16 v[44:47], v[140:143], v[124:127], v[44:47]
    ds_read_b128 v[100:103], v17 offset:6144
    buffer_store_dwordx2 v[222:223], v238, s[16:19], s36 offen sc1
    v_mfma_f32_16x16x32_bf16 v[28:31], v[140:143], v[120:123], v[28:31]
    ds_read_b64_tr_b16 v[104:105], v18 offset:0
    s_add_u32 s43, s43, 1
    v_mfma_f32_16x16x32_bf16 v[32:35], v[144:147], v[120:123], v[32:35]
    ds_read_b64_tr_b16 v[106:107], v18 offset:4096
    s_cmp_lt_u32 s43, 27
    v_mfma_f32_16x16x32_bf16 v[48:51], v[144:147], v[124:127], v[48:51]
    ds_read_b64_tr_b16 v[108:109], v19 offset:0
    v_mfma_f32_16x16x32_bf16 v[64:67], v[144:147], v[128:131], v[64:67]
    ds_read_b64_tr_b16 v[110:111], v19 offset:4096
    v_mfma_f32_16x16x32_bf16 v[80:83], v[144:147], v[132:135], v[80:83]
    ds_read_b64_tr_b16 v[112:113], v20 offset:0
    v_mfma_f32_16x16x32_bf16 v[84:87], v[148:151], v[132:135], v[84:87]
    ds_read_b64_tr_b16 v[114:115], v20 offset:4096
    v_mfma_f32_16x16x32_bf16 v[68:71], v[148:151], v[128:131], v[68:71]
    ds_read_b64_tr_b16 v[116:117], v21 offset:0
    v_mfma_f32_16x16x32_bf16 v[52:55], v[148:151], v[124:127], v[52:55]
    ds_read_b64_tr_b16 v[118:119], v21 offset:4096
    v_mfma_f32_16x16x32_bf16 v[36:39], v[148:151], v[120:123], v[36:39]
    s_waitcnt lgkmcnt(6)
mm_25:
    v_mfma_f32_16x16x32_bf16 v[24:27], v[104:107], v[88:91], v[24:27]
    ds_read_b128 v[120:123], v17 offset:1024
    s_add_u32 s42, s42, 16384
    v_mfma_f32_16x16x32_bf16 v[40:43], v[104:107], v[92:95], v[40:43]
    ds_read_b128 v[124:127], v17 offset:3072
    s_cmp_eq_u32 s42, 49152
    v_mfma_f32_16x16x32_bf16 v[56:59], v[104:107], v[96:99], v[56:59]
    ds_read_b128 v[128:131], v17 offset:5120
    s_cselect_b32 s42, 0, s42
    v_mfma_f32_16x16x32_bf16 v[72:75], v[104:107], v[100:103], v[72:75]
    ds_read_b128 v[132:135], v17 offset:7168
    s_waitcnt lgkmcnt(8)
    v_mfma_f32_16x16x32_bf16 v[76:79], v[108:111], v[100:103], v[76:79]
    ds_read_b64_tr_b16 v[136:137], v18 offset:8192
    s_add_u32 s48, s48, 16384
    v_mfma_f32_16x16x32_bf16 v[60:63], v[108:111], v[96:99], v[60:63]
    ds_read_b64_tr_b16 v[138:139], v18 offset:12288
    s_cmp_eq_u32 s48, 98304
    v_mfma_f32_16x16x32_bf16 v[44:47], v[108:111], v[92:95], v[44:47]
    ds_read_b64_tr_b16 v[140:141], v19 offset:8192
    s_cselect_b32 s48, 0, s48
    v_mfma_f32_16x16x32_bf16 v[28:31], v[108:111], v[88:91], v[28:31]
    ds_read_b64_tr_b16 v[142:143], v19 offset:12288
    s_waitcnt lgkmcnt(8)
    v_mfma_f32_16x16x32_bf16 v[32:35], v[112:115], v[88:91], v[32:35]
    ds_read_b64_tr_b16 v[144:145], v20 offset:8192
    v_add_u32 v17, s42, v12
    v_mfma_f32_16x16x32_bf16 v[48:51], v[112:115], v[92:95], v[48:51]
    ds_read_b64_tr_b16 v[146:147], v20 offset:12288
    v_add_u32 v18, s48, v13
    v_mfma_f32_16x16x32_bf16 v[64:67], v[112:115], v[96:99], v[64:67]
    ds_read_b64_tr_b16 v[148:149], v21 offset:8192
    v_add_u32 v19, s48, v14
    v_mfma_f32_16x16x32_bf16 v[80:83], v[112:115], v[100:103], v[80:83]
    ds_read_b64_tr_b16 v[150:151], v21 offset:12288
    v_add_u32 v20, s48, v15
    v_mfma_f32_16x16x32_bf16 v[84:87], v[116:119], v[100:103], v[84:87]
    v_add_u32 v21, s48, v16
    v_mfma_f32_16x16x32_bf16 v[68:71], v[116:119], v[96:99], v[68:71]
    v_mfma_f32_16x16x32_bf16 v[52:55], v[116:119], v[92:95], v[52:55]
    v_mfma_f32_16x16x32_bf16 v[36:39], v[116:119], v[88:91], v[36:39]
    s_waitcnt lgkmcnt(6)
    v_mfma_f32_16x16x32_bf16 v[24:27], v[136:139], v[120:123], v[24:27]
    s_add_u32 s43, s43, 1
    s_cmp_lt_u32 s43, 4
    v_mfma_f32_16x16x32_bf16 v[40:43], v[136:139], v[124:127], v[40:43]
    v_mfma_f32_16x16x32_bf16 v[56:59], v[136:139], v[128:131], v[56:59]
    s_waitcnt lgkmcnt(0)
    s_barrier
    v_mfma_f32_16x16x32_bf16 v[72:75], v[136:139], v[132:135], v[72:75]
    ds_read_b128 v[88:91], v17 offset:0
    v_mfma_f32_16x16x32_bf16 v[76:79], v[140:143], v[132:135], v[76:79]
    ds_read_b128 v[92:95], v17 offset:2048
    v_mfma_f32_16x16x32_bf16 v[60:63], v[140:143], v[128:131], v[60:63]
    ds_read_b128 v[96:99], v17 offset:4096
    v_mfma_f32_16x16x32_bf16 v[44:47], v[140:143], v[124:127], v[44:47]
    ds_read_b128 v[100:103], v17 offset:6144
    v_mfma_f32_16x16x32_bf16 v[28:31], v[140:143], v[120:123], v[28:31]
    ds_read_b64_tr_b16 v[104:105], v18 offset:0
    v_mfma_f32_16x16x32_bf16 v[32:35], v[144:147], v[120:123], v[32:35]
    ds_read_b64_tr_b16 v[106:107], v18 offset:4096
    v_mfma_f32_16x16x32_bf16 v[48:51], v[144:147], v[124:127], v[48:51]
    ds_read_b64_tr_b16 v[108:109], v19 offset:0
    v_mfma_f32_16x16x32_bf16 v[64:67], v[144:147], v[128:131], v[64:67]
    ds_read_b64_tr_b16 v[110:111], v19 offset:4096
    v_mfma_f32_16x16x32_bf16 v[80:83], v[144:147], v[132:135], v[80:83]
    ds_read_b64_tr_b16 v[112:113], v20 offset:0
    v_mfma_f32_16x16x32_bf16 v[84:87], v[148:151], v[132:135], v[84:87]
    ds_read_b64_tr_b16 v[114:115], v20 offset:4096
    v_mfma_f32_16x16x32_bf16 v[68:71], v[148:151], v[128:131], v[68:71]
    ds_read_b64_tr_b16 v[116:117], v21 offset:0
    v_mfma_f32_16x16x32_bf16 v[52:55], v[148:151], v[124:127], v[52:55]
    ds_read_b64_tr_b16 v[118:119], v21 offset:4096
    v_mfma_f32_16x16x32_bf16 v[36:39], v[148:151], v[120:123], v[36:39]
    s_waitcnt lgkmcnt(6)
    s_cbranch_scc1 mm_25
mm_26:
    v_mfma_f32_16x16x32_bf16 v[24:27], v[104:107], v[88:91], v[24:27]
    ds_read_b128 v[120:123], v17 offset:1024
    s_add_u32 s42, s42, 16384
    v_mfma_f32_16x16x32_bf16 v[40:43], v[104:107], v[92:95], v[40:43]
    ds_read_b128 v[124:127], v17 offset:3072
    s_cmp_eq_u32 s42, 49152
    v_mfma_f32_16x16x32_bf16 v[56:59], v[104:107], v[96:99], v[56:59]
    ds_read_b128 v[128:131], v17 offset:5120
    s_cselect_b32 s42, 0, s42
    v_mfma_f32_16x16x32_bf16 v[72:75], v[104:107], v[100:103], v[72:75]
    ds_read_b128 v[132:135], v17 offset:7168
    s_waitcnt lgkmcnt(8)
    v_mfma_f32_16x16x32_bf16 v[76:79], v[108:111], v[100:103], v[76:79]
    ds_read_b64_tr_b16 v[136:137], v18 offset:8192
    s_add_u32 s48, s48, 16384
    v_mfma_f32_16x16x32_bf16 v[60:63], v[108:111], v[96:99], v[60:63]
    ds_read_b64_tr_b16 v[138:139], v18 offset:12288
    s_cmp_eq_u32 s48, 98304
    v_mfma_f32_16x16x32_bf16 v[44:47], v[108:111], v[92:95], v[44:47]
    ds_read_b64_tr_b16 v[140:141], v19 offset:8192
    s_cselect_b32 s48, 0, s48
    v_mfma_f32_16x16x32_bf16 v[28:31], v[108:111], v[88:91], v[28:31]
    ds_read_b64_tr_b16 v[142:143], v19 offset:12288
    s_waitcnt lgkmcnt(8)
    v_mfma_f32_16x16x32_bf16 v[32:35], v[112:115], v[88:91], v[32:35]
    ds_read_b64_tr_b16 v[144:145], v20 offset:8192
    v_add_u32 v17, s42, v12
    v_mfma_f32_16x16x32_bf16 v[48:51], v[112:115], v[92:95], v[48:51]
    ds_read_b64_tr_b16 v[146:147], v20 offset:12288
    v_add_u32 v18, s48, v13
    v_mfma_f32_16x16x32_bf16 v[64:67], v[112:115], v[96:99], v[64:67]
    ds_read_b64_tr_b16 v[148:149], v21 offset:8192
    v_add_u32 v19, s48, v14
    v_mfma_f32_16x16x32_bf16 v[80:83], v[112:115], v[100:103], v[80:83]
    ds_read_b64_tr_b16 v[150:151], v21 offset:12288
    v_add_u32 v20, s48, v15
    v_mfma_f32_16x16x32_bf16 v[84:87], v[116:119], v[100:103], v[84:87]
    v_add_u32 v21, s48, v16
    v_mfma_f32_16x16x32_bf16 v[68:71], v[116:119], v[96:99], v[68:71]
    v_mfma_f32_16x16x32_bf16 v[52:55], v[116:119], v[92:95], v[52:55]
    v_mfma_f32_16x16x32_bf16 v[36:39], v[116:119], v[88:91], v[36:39]
    s_waitcnt lgkmcnt(6)
    v_mfma_f32_16x16x32_bf16 v[24:27], v[136:139], v[120:123], v[24:27]
    s_add_u32 s43, s43, 1
    s_cmp_lt_u32 s43, 27
    v_mfma_f32_16x16x32_bf16 v[40:43], v[136:139], v[124:127], v[40:43]
    s_waitcnt vmcnt(0)
    v_mfma_f32_16x16x32_bf16 v[56:59], v[136:139], v[128:131], v[56:59]
    s_waitcnt lgkmcnt(0)
    s_barrier
    v_mfma_f32_16x16x32_bf16 v[72:75], v[136:139], v[132:135], v[72:75]
    ds_read_b128 v[88:91], v17 offset:0
    v_mfma_f32_16x16x32_bf16 v[76:79], v[140:143], v[132:135], v[76:79]
    ds_read_b128 v[92:95], v17 offset:2048
    v_mfma_f32_16x16x32_bf16 v[60:63], v[140:143], v[128:131], v[60:63]
    ds_read_b128 v[96:99], v17 offset:4096
    v_mfma_f32_16x16x32_bf16 v[44:47], v[140:143], v[124:127], v[44:47]
    ds_read_b128 v[100:103], v17 offset:6144
    v_mfma_f32_16x16x32_bf16 v[28:31], v[140:143], v[120:123], v[28:31]
    ds_read_b64_tr_b16 v[104:105], v18 offset:0
    v_mfma_f32_16x16x32_bf16 v[32:35], v[144:147], v[120:123], v[32:35]
    ds_read_b64_tr_b16 v[106:107], v18 offset:4096
    v_mfma_f32_16x16x32_bf16 v[48:51], v[144:147], v[124:127], v[48:51]
    ds_read_b64_tr_b16 v[108:109], v19 offset:0
    v_mfma_f32_16x16x32_bf16 v[64:67], v[144:147], v[128:131], v[64:67]
    ds_read_b64_tr_b16 v[110:111], v19 offset:4096
    v_mfma_f32_16x16x32_bf16 v[80:83], v[144:147], v[132:135], v[80:83]
    ds_read_b64_tr_b16 v[112:113], v20 offset:0
    v_mfma_f32_16x16x32_bf16 v[84:87], v[148:151], v[132:135], v[84:87]
    ds_read_b64_tr_b16 v[114:115], v20 offset:4096
    v_mfma_f32_16x16x32_bf16 v[68:71], v[148:151], v[128:131], v[68:71]
    ds_read_b64_tr_b16 v[116:117], v21 offset:0
    v_mfma_f32_16x16x32_bf16 v[52:55], v[148:151], v[124:127], v[52:55]
    ds_read_b64_tr_b16 v[118:119], v21 offset:4096
    v_mfma_f32_16x16x32_bf16 v[36:39], v[148:151], v[120:123], v[36:39]
    s_waitcnt lgkmcnt(6)
    s_cbranch_scc1 mm_26
    s_cmp_eq_u32 s60, 1
    s_cbranch_scc1 G4_last
    v_mfma_f32_16x16x32_bf16 v[24:27], v[104:107], v[88:91], v[24:27]
    ds_read_b128 v[120:123], v17 offset:1024
    v_mfma_f32_16x16x32_bf16 v[40:43], v[104:107], v[92:95], v[40:43]
    ds_read_b128 v[124:127], v17 offset:3072
    v_mfma_f32_16x16x32_bf16 v[56:59], v[104:107], v[96:99], v[56:59]
    ds_read_b128 v[128:131], v17 offset:5120
    v_mfma_f32_16x16x32_bf16 v[72:75], v[104:107], v[100:103], v[72:75]
    ds_read_b128 v[132:135], v17 offset:7168
    s_waitcnt lgkmcnt(8)
    v_mfma_f32_16x16x32_bf16 v[76:79], v[108:111], v[100:103], v[76:79]
    ds_read_b64_tr_b16 v[136:137], v18 offset:8192
    v_mfma_f32_16x16x32_bf16 v[60:63], v[108:111], v[96:99], v[60:63]
    ds_read_b64_tr_b16 v[138:139], v18 offset:12288
    v_mfma_f32_16x16x32_bf16 v[44:47], v[108:111], v[92:95], v[44:47]
    ds_read_b64_tr_b16 v[140:141], v19 offset:8192
    v_mfma_f32_16x16x32_bf16 v[28:31], v[108:111], v[88:91], v[28:31]
    ds_read_b64_tr_b16 v[142:143], v19 offset:12288
    s_waitcnt lgkmcnt(8)
    v_mfma_f32_16x16x32_bf16 v[32:35], v[112:115], v[88:91], v[32:35]
    ds_read_b64_tr_b16 v[144:145], v20 offset:8192
    v_mfma_f32_16x16x32_bf16 v[48:51], v[112:115], v[92:95], v[48:51]
    ds_read_b64_tr_b16 v[146:147], v20 offset:12288
    v_mfma_f32_16x16x32_bf16 v[64:67], v[112:115], v[96:99], v[64:67]
    ds_read_b64_tr_b16 v[148:149], v21 offset:8192
    v_mfma_f32_16x16x32_bf16 v[80:83], v[112:115], v[100:103], v[80:83]
    ds_read_b64_tr_b16 v[150:151], v21 offset:12288
    v_mfma_f32_16x16x32_bf16 v[84:87], v[116:119], v[100:103], v[84:87]
    v_mfma_f32_16x16x32_bf16 v[68:71], v[116:119], v[96:99], v[68:71]
    v_mfma_f32_16x16x32_bf16 v[52:55], v[116:119], v[92:95], v[52:55]
    v_mfma_f32_16x16x32_bf16 v[36:39], v[116:119], v[88:91], v[36:39]
    s_waitcnt lgkmcnt(0)
    v_mfma_f32_16x16x32_bf16 v[24:27], v[136:139], v[120:123], v[24:27]
    s_mul_i32 s36, s31, 524288
    s_add_u32 s36, s36, 0
    s_add_u32 s16, s62, s36
    v_mfma_f32_16x16x32_bf16 v[40:43], v[136:139], v[124:127], v[40:43]
    s_addc_u32 s17, s63, 0
    s_mov_b32 s18, 516096
    s_mov_b32 s19, 0x20000
    v_mfma_f32_16x16x32_bf16 v[56:59], v[136:139], v[128:131], v[56:59]
    v_mfma_f32_16x16x32_bf16 v[72:75], v[136:139], v[132:135], v[72:75]
    v_mfma_f32_16x16x32_bf16 v[76:79], v[140:143], v[132:135], v[76:79]
    v_mfma_f32_16x16x32_bf16 v[60:63], v[140:143], v[128:131], v[60:63]
    v_mfma_f32_16x16x32_bf16 v[44:47], v[140:143], v[124:127], v[44:47]
    v_mfma_f32_16x16x32_bf16 v[28:31], v[140:143], v[120:123], v[28:31]
    v_mfma_f32_16x16x32_bf16 v[32:35], v[144:147], v[120:123], v[32:35]
    v_mfma_f32_16x16x32_bf16 v[48:51], v[144:147], v[124:127], v[48:51]
    v_mfma_f32_16x16x32_bf16 v[64:67], v[144:147], v[128:131], v[64:67]
    v_mfma_f32_16x16x32_bf16 v[80:83], v[144:147], v[132:135], v[80:83]
    v_mfma_f32_16x16x32_bf16 v[84:87], v[148:151], v[132:135], v[84:87]
    v_mfma_f32_16x16x32_bf16 v[68:71], v[148:151], v[128:131], v[68:71]
    v_mfma_f32_16x16x32_bf16 v[52:55], v[148:151], v[124:127], v[52:55]
    v_mfma_f32_16x16x32_bf16 v[36:39], v[148:151], v[120:123], v[36:39]
    s_add_u32 s36, s39, 0
    v_cvt_pk_bf16_f32 v24, v24, v25
    v_cvt_pk_bf16_f32 v25, v26, v27
    v_cvt_pk_bf16_f32 v26, v28, v29
    v_cvt_pk_bf16_f32 v27, v30, v31
    v_or_b32 v24, 1, v24
    buffer_store_dwordx4 v[24:27], v2, s[16:19], s36 offen offset:0 sc1
    v_cvt_pk_bf16_f32 v32, v32, v33
    v_cvt_pk_bf16_f32 v33, v34, v35
    v_cvt_pk_bf16_f32 v34, v36, v37
    v_cvt_pk_bf16_f32 v35, v38, v39
    v_or_b32 v32, 1, v32
    buffer_store_dwordx4 v[32:35], v2, s[16:19], s36 offen offset:1024 sc1
    s_add_u32 s36, s39, 65536
    v_cvt_pk_bf16_f32 v40, v40, v41
    v_cvt_pk_bf16_f32 v41, v42, v43
    v_cvt_pk_bf16_f32 v42, v44, v45
    v_cvt_pk_bf16_f32 v43, v46, v47
    v_or_b32 v40, 1, v40
    buffer_store_dwordx4 v[40:43], v2, s[16:19], s36 offen offset:0 sc1
    v_cvt_pk_bf16_f32 v48, v48, v49
    v_cvt_pk_bf16_f32 v49, v50, v51
    v_cvt_pk_bf16_f32 v50, v52, v53
    v_cvt_pk_bf16_f32 v51, v54, v55
    v_or_b32 v48, 1, v48
    buffer_store_dwordx4 v[48:51], v2, s[16:19], s36 offen offset:1024 sc1
    s_add_u32 s36, s39, 131072
    v_cvt_pk_bf16_f32 v56, v56, v57
    v_cvt_pk_bf16_f32 v57, v58, v59
    v_cvt_pk_bf16_f32 v58, v60, v61
    v_cvt_pk_bf16_f32 v59, v62, v63
    v_or_b32 v56, 1, v56
    buffer_store_dwordx4 v[56:59], v2, s[16:19], s36 offen offset:0 sc1
    v_cvt_pk_bf16_f32 v64, v64, v65
    v_cvt_pk_bf16_f32 v65, v66, v67
    v_cvt_pk_bf16_f32 v66, v68, v69
    v_cvt_pk_bf16_f32 v67, v70, v71
    v_or_b32 v64, 1, v64
    buffer_store_dwordx4 v[64:67], v2, s[16:19], s36 offen offset:1024 sc1
    s_add_u32 s36, s39, 196608
    v_cvt_pk_bf16_f32 v72, v72, v73
    v_cvt_pk_bf16_f32 v73, v74, v75
    v_cvt_pk_bf16_f32 v74, v76, v77
    v_cvt_pk_bf16_f32 v75, v78, v79
    v_or_b32 v72, 1, v72
    buffer_store_dwordx4 v[72:75], v2, s[16:19], s36 offen offset:0 sc1
    v_cvt_pk_bf16_f32 v80, v80, v81
    v_cvt_pk_bf16_f32 v81, v82, v83
    v_cvt_pk_bf16_f32 v82, v84, v85
    v_cvt_pk_bf16_f32 v83, v86, v87
    v_or_b32 v80, 1, v80
    buffer_store_dwordx4 v[80:83], v2, s[16:19], s36 offen offset:1024 sc1
    s_barrier
    s_branch NEXT
G4_last:
    v_mfma_f32_16x16x32_bf16 v[24:27], v[104:107], v[88:91], v[24:27]
    ds_read_b128 v[120:123], v17 offset:1024
    v_mfma_f32_16x16x32_bf16 v[40:43], v[104:107], v[92:95], v[40:43]
    ds_read_b128 v[124:127], v17 offset:3072
    v_mfma_f32_16x16x32_bf16 v[56:59], v[104:107], v[96:99], v[56:59]
    ds_read_b128 v[128:131], v17 offset:5120
    v_mfma_f32_16x16x32_bf16 v[72:75], v[104:107], v[100:103], v[72:75]
    ds_read_b128 v[132:135], v17 offset:7168
    s_waitcnt lgkmcnt(8)
    v_mfma_f32_16x16x32_bf16 v[76:79], v[108:111], v[100:103], v[76:79]
    ds_read_b64_tr_b16 v[136:137], v18 offset:8192
    v_mfma_f32_16x16x32_bf16 v[60:63], v[108:111], v[96:99], v[60:63]
    ds_read_b64_tr_b16 v[138:139], v18 offset:12288
    v_mfma_f32_16x16x32_bf16 v[44:47], v[108:111], v[92:95], v[44:47]
    ds_read_b64_tr_b16 v[140:141], v19 offset:8192
    v_mfma_f32_16x16x32_bf16 v[28:31], v[108:111], v[88:91], v[28:31]
    ds_read_b64_tr_b16 v[142:143], v19 offset:12288
    s_waitcnt lgkmcnt(8)
    v_mfma_f32_16x16x32_bf16 v[32:35], v[112:115], v[88:91], v[32:35]
    ds_read_b64_tr_b16 v[144:145], v20 offset:8192
    v_mfma_f32_16x16x32_bf16 v[48:51], v[112:115], v[92:95], v[48:51]
    ds_read_b64_tr_b16 v[146:147], v20 offset:12288
    s_load_dwordx2 s[6:7], s[0:1], 88
    v_mfma_f32_16x16x32_bf16 v[64:67], v[112:115], v[96:99], v[64:67]
    ds_read_b64_tr_b16 v[148:149], v21 offset:8192
    v_mfma_f32_16x16x32_bf16 v[80:83], v[112:115], v[100:103], v[80:83]
    ds_read_b64_tr_b16 v[150:151], v21 offset:12288
    v_mfma_f32_16x16x32_bf16 v[84:87], v[116:119], v[100:103], v[84:87]
    v_mfma_f32_16x16x32_bf16 v[68:71], v[116:119], v[96:99], v[68:71]
    v_mfma_f32_16x16x32_bf16 v[52:55], v[116:119], v[92:95], v[52:55]
    v_mfma_f32_16x16x32_bf16 v[36:39], v[116:119], v[88:91], v[36:39]
    s_waitcnt lgkmcnt(0)
    v_mfma_f32_16x16x32_bf16 v[24:27], v[136:139], v[120:123], v[24:27]
    s_add_u32 s16, s62, 0x80000
    s_addc_u32 s17, s63, 0
    s_mov_b32 s18, 0x7e000
    v_mfma_f32_16x16x32_bf16 v[40:43], v[136:139], v[124:127], v[40:43]
    s_mov_b32 s19, 0x20000
    s_mov_b32 s20, s6
    s_mov_b32 s21, s7
    v_mfma_f32_16x16x32_bf16 v[56:59], v[136:139], v[128:131], v[56:59]
    s_mov_b32 s22, 0x400000
    s_mov_b32 s23, 0x20000
    s_add_u32 s44, s40, 65536
    v_mfma_f32_16x16x32_bf16 v[72:75], v[136:139], v[132:135], v[72:75]
    s_lshl_b32 s46, s28, 3
    s_add_u32 s46, s46, s37
    s_lshl_b32 s47, s31, 1
    v_mfma_f32_16x16x32_bf16 v[76:79], v[140:143], v[132:135], v[76:79]
    s_add_u32 s46, s46, s47
    s_lshl_b32 s46, s46, 15
    s_lshl_b32 s47, s38, 5
    v_mfma_f32_16x16x32_bf16 v[60:63], v[140:143], v[128:131], v[60:63]
    s_add_u32 s46, s46, s47
    s_add_u32 s47, s46, 32768
    v_and_b32 v225, 1, v23
    v_mfma_f32_16x16x32_bf16 v[44:47], v[140:143], v[124:127], v[44:47]
    v_lshlrev_b32 v224, 11, v22
    v_lshl_add_u32 v224, v225, 5, v224
    v_mfma_f32_16x16x32_bf16 v[28:31], v[140:143], v[120:123], v[28:31]
    v_lshrrev_b32 v225, 1, v23
    v_lshl_add_u32 v224, v225, 4, v224
    v_mfma_f32_16x16x32_bf16 v[32:35], v[144:147], v[120:123], v[32:35]
    v_lshrrev_b32 v225, 3, v22
    v_mul_u32_u24 v225, 16320, v225
    v_mfma_f32_16x16x32_bf16 v[48:51], v[144:147], v[124:127], v[48:51]
    v_sub_u32 v224, v224, v225
    v_add_u32 v225, 16384, v224
    v_mfma_f32_16x16x32_bf16 v[64:67], v[144:147], v[128:131], v[64:67]
    v_mfma_f32_16x16x32_bf16 v[80:83], v[144:147], v[132:135], v[80:83]
    v_mfma_f32_16x16x32_bf16 v[84:87], v[148:151], v[132:135], v[84:87]
    v_mfma_f32_16x16x32_bf16 v[68:71], v[148:151], v[128:131], v[68:71]
    v_mfma_f32_16x16x32_bf16 v[52:55], v[148:151], v[124:127], v[52:55]
    v_mfma_f32_16x16x32_bf16 v[36:39], v[148:151], v[120:123], v[36:39]
    s_cmp_eq_u32 s31, 0
    s_cbranch_scc1 G4_k0
    s_add_u32 s36, s41, 0
    v_cvt_pk_bf16_f32 v24, v24, v25
    v_cvt_pk_bf16_f32 v25, v26, v27
    v_cvt_pk_bf16_f32 v26, v28, v29
    v_cvt_pk_bf16_f32 v27, v30, v31
    v_or_b32 v24, 1, v24
    buffer_store_dwordx4 v[24:27], v2, s[16:19], s36 offen offset:0 sc1
    v_cvt_pk_bf16_f32 v32, v32, v33
    v_cvt_pk_bf16_f32 v33, v34, v35
    v_cvt_pk_bf16_f32 v34, v36, v37
    v_cvt_pk_bf16_f32 v35, v38, v39
    v_or_b32 v32, 1, v32
    buffer_store_dwordx4 v[32:35], v2, s[16:19], s36 offen offset:1024 sc1
    s_add_u32 s36, s41, 65536
    v_cvt_pk_bf16_f32 v40, v40, v41
    v_cvt_pk_bf16_f32 v41, v42, v43
    v_cvt_pk_bf16_f32 v42, v44, v45
    v_cvt_pk_bf16_f32 v43, v46, v47
    v_or_b32 v40, 1, v40
    buffer_store_dwordx4 v[40:43], v2, s[16:19], s36 offen offset:0 sc1
    v_cvt_pk_bf16_f32 v48, v48, v49
    v_cvt_pk_bf16_f32 v49, v50, v51
    v_cvt_pk_bf16_f32 v50, v52, v53
    v_cvt_pk_bf16_f32 v51, v54, v55
    v_or_b32 v48, 1, v48
    buffer_store_dwordx4 v[48:51], v2, s[16:19], s36 offen offset:1024 sc1
    v_pk_mov_b32 v[24:25], v[56:57], v[56:57] op_sel:[0,1]
    v_pk_mov_b32 v[26:27], v[58:59], v[58:59] op_sel:[0,1]
    v_pk_mov_b32 v[28:29], v[60:61], v[60:61] op_sel:[0,1]
    v_pk_mov_b32 v[30:31], v[62:63], v[62:63] op_sel:[0,1]
    v_pk_mov_b32 v[32:33], v[64:65], v[64:65] op_sel:[0,1]
    v_pk_mov_b32 v[34:35], v[66:67], v[66:67] op_sel:[0,1]
    v_pk_mov_b32 v[36:37], v[68:69], v[68:69] op_sel:[0,1]
    v_pk_mov_b32 v[38:39], v[70:71], v[70:71] op_sel:[0,1]
    v_pk_mov_b32 v[40:41], v[72:73], v[72:73] op_sel:[0,1]
    v_pk_mov_b32 v[42:43], v[74:75], v[74:75] op_sel:[0,1]
    v_pk_mov_b32 v[44:45], v[76:77], v[76:77] op_sel:[0,1]
    v_pk_mov_b32 v[46:47], v[78:79], v[78:79] op_sel:[0,1]
    v_pk_mov_b32 v[48:49], v[80:81], v[80:81] op_sel:[0,1]
    v_pk_mov_b32 v[50:51], v[82:83], v[82:83] op_sel:[0,1]
    v_pk_mov_b32 v[52:53], v[84:85], v[84:85] op_sel:[0,1]
    v_pk_mov_b32 v[54:55], v[86:87], v[86:87] op_sel:[0,1]
    s_branch G4_k1
G4_k0:
    s_add_u32 s36, s41, 0
    v_cvt_pk_bf16_f32 v56, v56, v57
    v_cvt_pk_bf16_f32 v57, v58, v59
    v_cvt_pk_bf16_f32 v58, v60, v61
    v_cvt_pk_bf16_f32 v59, v62, v63
    v_or_b32 v56, 1, v56
    buffer_store_dwordx4 v[56:59], v2, s[16:19], s36 offen offset:0 sc1
    v_cvt_pk_bf16_f32 v64, v64, v65
    v_cvt_pk_bf16_f32 v65, v66, v67
    v_cvt_pk_bf16_f32 v66, v68, v69
    v_cvt_pk_bf16_f32 v67, v70, v71
    v_or_b32 v64, 1, v64
    buffer_store_dwordx4 v[64:67], v2, s[16:19], s36 offen offset:1024 sc1
    s_add_u32 s36, s41, 65536
    v_cvt_pk_bf16_f32 v72, v72, v73
    v_cvt_pk_bf16_f32 v73, v74, v75
    v_cvt_pk_bf16_f32 v74, v76, v77
    v_cvt_pk_bf16_f32 v75, v78, v79
    v_or_b32 v72, 1, v72
    buffer_store_dwordx4 v[72:75], v2, s[16:19], s36 offen offset:0 sc1
    v_cvt_pk_bf16_f32 v80, v80, v81
    v_cvt_pk_bf16_f32 v81, v82, v83
    v_cvt_pk_bf16_f32 v82, v84, v85
    v_cvt_pk_bf16_f32 v83, v86, v87
    v_or_b32 v80, 1, v80
    buffer_store_dwordx4 v[80:83], v2, s[16:19], s36 offen offset:1024 sc1
G4_k1:
    s_mov_b32 s78, 0x3f80
    s_mov_b32 s79, 0x3f800000
    v_dot2_f32_bf16 v24, v180, s78, v24
    v_dot2_f32_bf16 v25, v180, s79, v25
    v_dot2_f32_bf16 v26, v181, s78, v26
    v_dot2_f32_bf16 v27, v181, s79, v27
    v_dot2_f32_bf16 v28, v182, s78, v28
    v_dot2_f32_bf16 v29, v182, s79, v29
    v_dot2_f32_bf16 v30, v183, s78, v30
    v_dot2_f32_bf16 v31, v183, s79, v31
    v_dot2_f32_bf16 v32, v188, s78, v32
    v_dot2_f32_bf16 v33, v188, s79, v33
    v_dot2_f32_bf16 v34, v189, s78, v34
    v_dot2_f32_bf16 v35, v189, s79, v35
    v_dot2_f32_bf16 v36, v190, s78, v36
    v_dot2_f32_bf16 v37, v190, s79, v37
    v_dot2_f32_bf16 v38, v191, s78, v38
    v_dot2_f32_bf16 v39, v191, s79, v39
    v_dot2_f32_bf16 v40, v196, s78, v40
    v_dot2_f32_bf16 v41, v196, s79, v41
    v_dot2_f32_bf16 v42, v197, s78, v42
    v_dot2_f32_bf16 v43, v197, s79, v43
    v_dot2_f32_bf16 v44, v198, s78, v44
    v_dot2_f32_bf16 v45, v198, s79, v45
    v_dot2_f32_bf16 v46, v199, s78, v46
    v_dot2_f32_bf16 v47, v199, s79, v47
    v_dot2_f32_bf16 v48, v234, s78, v48
    v_dot2_f32_bf16 v49, v234, s79, v49
    v_dot2_f32_bf16 v50, v235, s78, v50
    v_dot2_f32_bf16 v51, v235, s79, v51
    v_dot2_f32_bf16 v52, v236, s78, v52
    v_dot2_f32_bf16 v53, v236, s79, v53
    v_dot2_f32_bf16 v54, v237, s78, v54
    v_dot2_f32_bf16 v55, v237, s79, v55
    v_dot2_f32_bf16 v24, v184, s78, v24
    v_dot2_f32_bf16 v25, v184, s79, v25
    v_dot2_f32_bf16 v26, v185, s78, v26
    v_dot2_f32_bf16 v27, v185, s79, v27
    v_dot2_f32_bf16 v28, v186, s78, v28
    v_dot2_f32_bf16 v29, v186, s79, v29
    v_dot2_f32_bf16 v30, v187, s78, v30
    v_dot2_f32_bf16 v31, v187, s79, v31
    v_dot2_f32_bf16 v32, v192, s78, v32
    v_dot2_f32_bf16 v33, v192, s79, v33
    v_dot2_f32_bf16 v34, v193, s78, v34
    v_dot2_f32_bf16 v35, v193, s79, v35
    v_dot2_f32_bf16 v36, v194, s78, v36
    v_dot2_f32_bf16 v37, v194, s79, v37
    v_dot2_f32_bf16 v38, v195, s78, v38
    v_dot2_f32_bf16 v39, v195, s79, v39
    v_dot2_f32_bf16 v40, v230, s78, v40
    v_dot2_f32_bf16 v41, v230, s79, v41
    v_dot2_f32_bf16 v42, v231, s78, v42
    v_dot2_f32_bf16 v43, v231, s79, v43
    v_dot2_f32_bf16 v44, v232, s78, v44
    v_dot2_f32_bf16 v45, v232, s79, v45
    v_dot2_f32_bf16 v46, v233, s78, v46
    v_dot2_f32_bf16 v47, v233, s79, v47
    v_dot2_f32_bf16 v48, v248, s78, v48
    v_dot2_f32_bf16 v49, v248, s79, v49
    v_dot2_f32_bf16 v50, v249, s78, v50
    v_dot2_f32_bf16 v51, v249, s79, v51
    v_dot2_f32_bf16 v52, v250, s78, v52
    v_dot2_f32_bf16 v53, v250, s79, v53
    v_dot2_f32_bf16 v54, v251, s78, v54
    v_dot2_f32_bf16 v55, v251, s79, v55
    s_mov_b32 s53, 0
dp_27:
    buffer_load_dwordx4 v[208:211], v2, s[16:19], s40 offen offset:0 sc1
    buffer_load_dwordx4 v[212:215], v2, s[16:19], s40 offen offset:1024 sc1
    buffer_load_dwordx4 v[216:219], v2, s[16:19], s44 offen offset:0 sc1
    buffer_load_dwordx4 v[220:223], v2, s[16:19], s44 offen offset:1024 sc1
    s_waitcnt vmcnt(0)
    v_bitop3_b32 v6, v208, v212, v216 bitop3:0x80
    v_bitop3_b32 v6, v6, v220, 1 bitop3:0x80
    v_cmp_eq_u32 vcc, 0, v6
    s_cbranch_vccz dq_28
    s_sleep 2
    s_add_u32 s53, s53, 1
    s_cmp_lt_u32 s53, s61
    s_cbranch_scc1 dp_27
    s_mov_b32 s61, 0
dq_28:
    v_dot2_f32_bf16 v24, v208, s78, v24
    v_dot2_f32_bf16 v25, v208, s79, v25
    v_dot2_f32_bf16 v26, v209, s78, v26
    v_dot2_f32_bf16 v27, v209, s79, v27
    v_dot2_f32_bf16 v28, v210, s78, v28
    v_dot2_f32_bf16 v29, v210, s79, v29
    v_dot2_f32_bf16 v30, v211, s78, v30
    v_dot2_f32_bf16 v31, v211, s79, v31
    v_cvt_pk_bf16_f32 v24, v24, v25
    v_cvt_pk_bf16_f32 v25, v26, v27
    v_cvt_pk_bf16_f32 v26, v28, v29
    v_cvt_pk_bf16_f32 v27, v30, v31
    s_nop 0
    v_permlane16_swap_b32 v24, v26
    v_permlane16_swap_b32 v25, v27
    v_dot2_f32_bf16 v32, v212, s78, v32
    v_dot2_f32_bf16 v33, v212, s79, v33
    v_dot2_f32_bf16 v34, v213, s78, v34
    v_dot2_f32_bf16 v35, v213, s79, v35
    v_dot2_f32_bf16 v36, v214, s78, v36
    v_dot2_f32_bf16 v37, v214, s79, v37
    v_dot2_f32_bf16 v38, v215, s78, v38
    v_dot2_f32_bf16 v39, v215, s79, v39
    v_cvt_pk_bf16_f32 v32, v32, v33
    v_cvt_pk_bf16_f32 v33, v34, v35
    v_cvt_pk_bf16_f32 v34, v36, v37
    v_cvt_pk_bf16_f32 v35, v38, v39
    s_nop 0
    v_permlane16_swap_b32 v32, v34
    v_permlane16_swap_b32 v33, v35
    v_mov_b32 v36, v24
    v_mov_b32 v37, v25
    v_mov_b32 v38, v26
    v_mov_b32 v39, v27
    v_mov_b32_dpp v24, v32 row_ror:8 row_mask:0xf bank_mask:0xc
    v_mov_b32_dpp v25, v33 row_ror:8 row_mask:0xf bank_mask:0xc
    v_mov_b32_dpp v26, v34 row_ror:8 row_mask:0xf bank_mask:0xc
    v_mov_b32_dpp v27, v35 row_ror:8 row_mask:0xf bank_mask:0xc
    v_mov_b32_dpp v32, v36 row_ror:8 row_mask:0xf bank_mask:0x3
    v_mov_b32_dpp v33, v37 row_ror:8 row_mask:0xf bank_mask:0x3
    v_mov_b32_dpp v34, v38 row_ror:8 row_mask:0xf bank_mask:0x3
    v_mov_b32_dpp v35, v39 row_ror:8 row_mask:0xf bank_mask:0x3
    buffer_store_dwordx4 v[24:27], v224, s[20:23], s46 offen sc1
    buffer_store_dwordx4 v[32:35], v225, s[20:23], s46 offen sc1
    v_dot2_f32_bf16 v40, v216, s78, v40
    v_dot2_f32_bf16 v41, v216, s79, v41
    v_dot2_f32_bf16 v42, v217, s78, v42
    v_dot2_f32_bf16 v43, v217, s79, v43
    v_dot2_f32_bf16 v44, v218, s78, v44
    v_dot2_f32_bf16 v45, v218, s79, v45
    v_dot2_f32_bf16 v46, v219, s78, v46
    v_dot2_f32_bf16 v47, v219, s79, v47
    v_cvt_pk_bf16_f32 v40, v40, v41
    v_cvt_pk_bf16_f32 v41, v42, v43
    v_cvt_pk_bf16_f32 v42, v44, v45
    v_cvt_pk_bf16_f32 v43, v46, v47
    s_nop 0
    v_permlane16_swap_b32 v40, v42
    v_permlane16_swap_b32 v41, v43
    v_dot2_f32_bf16 v48, v220, s78, v48
    v_dot2_f32_bf16 v49, v220, s79, v49
    v_dot2_f32_bf16 v50, v221, s78, v50
    v_dot2_f32_bf16 v51, v221, s79, v51
    v_dot2_f32_bf16 v52, v222, s78, v52
    v_dot2_f32_bf16 v53, v222, s79, v53
    v_dot2_f32_bf16 v54, v223, s78, v54
    v_dot2_f32_bf16 v55, v223, s79, v55
    v_cvt_pk_bf16_f32 v48, v48, v49
    v_cvt_pk_bf16_f32 v49, v50, v51
    v_cvt_pk_bf16_f32 v50, v52, v53
    v_cvt_pk_bf16_f32 v51, v54, v55
    s_nop 0
    v_permlane16_swap_b32 v48, v50
    v_permlane16_swap_b32 v49, v51
    v_mov_b32 v52, v40
    v_mov_b32 v53, v41
    v_mov_b32 v54, v42
    v_mov_b32 v55, v43
    v_mov_b32_dpp v40, v48 row_ror:8 row_mask:0xf bank_mask:0xc
    v_mov_b32_dpp v41, v49 row_ror:8 row_mask:0xf bank_mask:0xc
    v_mov_b32_dpp v42, v50 row_ror:8 row_mask:0xf bank_mask:0xc
    v_mov_b32_dpp v43, v51 row_ror:8 row_mask:0xf bank_mask:0xc
    v_mov_b32_dpp v48, v52 row_ror:8 row_mask:0xf bank_mask:0x3
    v_mov_b32_dpp v49, v53 row_ror:8 row_mask:0xf bank_mask:0x3
    v_mov_b32_dpp v50, v54 row_ror:8 row_mask:0xf bank_mask:0x3
    v_mov_b32_dpp v51, v55 row_ror:8 row_mask:0xf bank_mask:0x3
    buffer_store_dwordx4 v[40:43], v224, s[20:23], s47 offen sc1
    buffer_store_dwordx4 v[48:51], v225, s[20:23], s47 offen sc1
    s_branch K_fin
LOADERS:
    s_cmp_ge_u32 s30, 6
    s_cbranch_scc1 WLOAD
    s_add_u32 s54, s55, 0x500
    v_mov_b32 v222, s54
    s_lshl_b32 s53, s29, 7
    s_add_u32 s53, s53, 23121920
    v_mov_b32 v226, s53
    s_sleep 30
    s_mov_b64 exec, 1
    buffer_load_dword v227, v226, s[56:59], 0 offen sc1
    s_mov_b64 exec, -1
    s_waitcnt vmcnt(0)
    v_readfirstlane_b32 s53, v227
    s_add_u32 s54, s52, 16
    s_cmp_eq_u32 s53, s54
    s_cbranch_scc1 fok_29
    s_mov_b32 s53, 0
    s_add_u32 s54, s52, 16
    s_bfm_b64 exec, 1, 0
poll_30:
    buffer_load_dword v227, v226, s[56:59], 0 offen sc1
    s_waitcnt vmcnt(0)
    v_xor_b32 v227, s54, v227
    v_cmp_eq_u32 vcc, 0, v227
    s_nop 0
    s_cmp_eq_u64 vcc, exec
    s_cbranch_scc1 pok_31
    s_sleep 5
    s_add_u32 s53, s53, 1
    s_cmp_lt_u32 s53, s61
    s_cbranch_scc1 poll_30
    s_mov_b32 s61, 0
pok_31:
    s_mov_b64 exec, -1
fok_29:
    s_add_u32 s24, s4, 0x1400000
    s_addc_u32 s25, s5, 0
    s_mov_b32 s26, 0x20000
    s_mov_b32 s27, 0x20000
    s_cmp_eq_u32 s60, 0
    s_cselect_b32 s26, s26, 0
    s_and_b32 s36, s30, 1
    s_mul_i32 s36, s36, 128
    s_mul_i32 s37, s29, 256
    s_add_u32 s37, s36, s37
    v_lshrrev_b32 v224, 3, v1
    v_mul_u32_u24 v224, 4096, v224
    v_and_b32 v23, 112, v2
    v_add_u32 v224, v224, v23
    s_cmp_eq_u32 s60, 0
    s_cselect_b64 exec, -1, 0
    buffer_load_dwordx4 v[24:27], v224, s[24:27], s37 offen sc1
    s_add_u32 s37, s37, 32768
    buffer_load_dwordx4 v[28:31], v224, s[24:27], s37 offen sc1
    s_add_u32 s37, s37, 32768
    buffer_load_dwordx4 v[32:35], v224, s[24:27], s37 offen sc1
    s_add_u32 s37, s37, 32768
    buffer_load_dwordx4 v[36:39], v224, s[24:27], s37 offen sc1
    s_add_u32 s37, s37, 32768
    s_mov_b64 exec, -1
    s_mov_b64 exec, 1
    buffer_load_dword v223, v222, s[56:59], 0 offen sc1
    s_mov_b64 exec, -1
    s_waitcnt vmcnt(0)
    v_readfirstlane_b32 s53, v223
    s_add_u32 s54, s52, 16
    s_cmp_eq_u32 s53, s54
    s_cbranch_scc1 fok_32
    s_mov_b32 s53, 0
    s_add_u32 s54, s52, 16
    s_bfm_b64 exec, 1, 0
poll_33:
    buffer_load_dword v223, v222, s[56:59], 0 offen sc1
    s_waitcnt vmcnt(0)
    v_xor_b32 v223, s54, v223
    v_cmp_eq_u32 vcc, 0, v223
    s_nop 0
    s_cmp_eq_u64 vcc, exec
    s_cbranch_scc1 pok_34
    s_sleep 5
    s_add_u32 s53, s53, 1
    s_cmp_lt_u32 s53, s61
    s_cbranch_scc1 poll_33
    s_mov_b32 s61, 0
pok_34:
    s_mov_b64 exec, -1
fok_32:
    s_add_u32 s20, s62, 0x5d0000
    s_addc_u32 s21, s63, 0
    s_mov_b32 s22, 0x800
    s_mov_b32 s23, 0x20000
    s_and_b32 s35, s30, 1
    s_lshl_b32 s35, s35, 10
    buffer_load_dwordx4 v[16:19], v2, s[20:23], s35 offen sc1
    s_cmp_lg_u32 s60, 0
    s_cbranch_scc1 pc_35
    v_add_f32 v24, v24, v28
    v_add_f32 v25, v25, v29
    v_add_f32 v26, v26, v30
    v_add_f32 v27, v27, v31
    v_add_f32 v24, v24, v32
    v_add_f32 v25, v25, v33
    v_add_f32 v26, v26, v34
    v_add_f32 v27, v27, v35
    v_add_f32 v24, v24, v36
    v_add_f32 v25, v25, v37
    v_add_f32 v26, v26, v38
    v_add_f32 v27, v27, v39
    v_add_f32_dpp v24, v24, v24 row_ror:8 row_mask:0xf bank_mask:0xf
    v_add_f32_dpp v25, v25, v25 row_ror:8 row_mask:0xf bank_mask:0xf
    v_add_f32_dpp v26, v26, v26 row_ror:8 row_mask:0xf bank_mask:0xf
    v_add_f32_dpp v27, v27, v27 row_ror:8 row_mask:0xf bank_mask:0xf
    v_mov_b32 v28, v24
    v_mov_b32 v29, v25
    v_mov_b32 v30, v26
    v_mov_b32 v31, v27
    v_permlane16_swap_b32 v24, v28
    v_permlane16_swap_b32 v25, v29
    v_permlane16_swap_b32 v26, v30
    v_permlane16_swap_b32 v27, v31
    v_add_f32 v24, v24, v28
    v_add_f32 v25, v25, v29
    v_add_f32 v26, v26, v30
    v_add_f32 v27, v27, v31
    v_mov_b32 v28, v24
    v_mov_b32 v29, v25
    v_mov_b32 v30, v26
    v_mov_b32 v31, v27
    v_permlane32_swap_b32 v24, v28
    v_permlane32_swap_b32 v25, v29
    v_permlane32_swap_b32 v26, v30
    v_permlane32_swap_b32 v27, v31
    v_add_f32 v24, v24, v28
    v_add_f32 v25, v25, v29
    v_add_f32 v26, v26, v30
    v_add_f32 v27, v27, v31
pc_35:
    s_cmp_lg_u32 s60, 0
    s_cbranch_scc1 pc_36
    s_and_b32 s36, s30, 1
    s_mul_i32 s36, s36, 128
    s_add_u32 s36, s36, 163328
    v_add_u32 v23, s36, v2
    s_bfm_b64 exec, 8, 0
    ds_write_b128 v23, v[24:27]
    s_mov_b64 exec, -1
    s_waitcnt lgkmcnt(0)
pc_36:
    s_waitcnt vmcnt(0)
    s_and_b32 s36, s30, 1
    s_lshl_b32 s36, s36, 10
    s_add_u32 s36, s36, 160768
    v_add_u32 v221, s36, v2
    ds_write_b128 v221, v[16:19]
    s_waitcnt lgkmcnt(0)
    s_cmp_lg_u32 s30, 4
    s_cbranch_scc1 AL_nw
    s_cmp_eq_u32 s60, 0
    s_cbranch_scc1 AL_nw
    s_add_u32 s54, s55, 0xffc00300
    s_add_u32 s53, s54, s92
    v_mov_b32 v9, s53
    s_add_u32 s53, s53, 128
    v_writelane_b32 v9, s53, 1
    s_add_u32 s53, s54, s93
    v_writelane_b32 v9, s53, 2
    s_add_u32 s53, s53, 128
    v_writelane_b32 v9, s53, 3
    s_mov_b32 s53, 0
    s_add_u32 s54, s52, 8
    s_bfm_b64 exec, 4, 0
poll_38:
    buffer_load_dword v8, v9, s[56:59], 0 offen sc1
    s_waitcnt vmcnt(0)
    v_xor_b32 v8, s54, v8
    v_cmp_eq_u32 vcc, 0, v8
    s_nop 0
    s_cmp_eq_u64 vcc, exec
    s_cbranch_scc1 pok_39
    s_sleep 5
    s_add_u32 s53, s53, 1
    s_cmp_lt_u32 s53, s61
    s_cbranch_scc1 poll_38
    s_mov_b32 s61, 0
pok_39:
    s_mov_b64 exec, -1
AL_nw:
    s_barrier
    s_call_b64 s[76:77], SUB_after_g1
    s_barrier
    s_waitcnt vmcnt(0)
    s_barrier
    s_call_b64 s[76:77], SUB_after_g2
    s_and_b32 s35, s30, 1
    s_add_u32 s12, s62, 0x80000
    s_addc_u32 s13, s63, 0
    s_mov_b32 s14, 0x7e000
    s_mov_b32 s15, 0x20000
    s_mul_i32 s38, s35, 262144
    s_lshl_b32 s41, s35, 13
    s_mov_b32 s42, 0
    s_mov_b32 s44, 0
    s_add_u32 s54, s55, 0x200
    v_mov_b32 v9, s54
    s_mov_b32 s44, 1
    s_mov_b32 s42, 16384
    s_add_u32 s54, s55, 0x580
    v_mov_b32 v222, s54
    v_lshlrev_b32 v221, 3, v1
    s_add_u32 s19, s41, s42
    v_readlane_b32 s16, v248, s44
    s_nop 0
    s_add_u32 s16, s16, s38
    s_add_u32 s44, s44, 1
    s_and_b32 s44, s44, 15
    s_add_u32 s42, s42, 16384
    s_cmp_eq_u32 s42, 49152
    s_cselect_b32 s42, 0, s42
    s_mov_b32 m0, s19
    s_mov_b32 s39, s16
    s_waitcnt vmcnt(63)
    s_barrier
    s_sleep 6
    s_mov_b32 s53, 0
    s_add_u32 s54, s52, 16
    s_bfm_b64 exec, 1, 0
poll_40:
    buffer_load_dword v8, v9, s[56:59], 0 offen sc1
    s_waitcnt vmcnt(0)
    v_xor_b32 v8, s54, v8
    v_cmp_eq_u32 vcc, 0, v8
    s_nop 0
    s_cmp_eq_u64 vcc, exec
    s_cbranch_scc1 pok_41
    s_sleep 5
    s_add_u32 s53, s53, 1
    s_cmp_lt_u32 s53, s61
    s_cbranch_scc1 poll_40
    s_mov_b32 s61, 0
pok_41:
    s_mov_b64 exec, -1
    buffer_load_dwordx4 v2, s[12:15], s39 offen sc1 lds
    buffer_load_dwordx4 v2, s[12:15], s39 offen offset:1024 sc1 lds
    s_add_u32 s19, s41, s42
    v_readlane_b32 s16, v248, s44
    s_nop 0
    s_add_u32 s16, s16, s38
    s_add_u32 s44, s44, 1
    s_and_b32 s44, s44, 15
    s_add_u32 s42, s42, 16384
    s_cmp_eq_u32 s42, 49152
    s_cselect_b32 s42, 0, s42
    s_add_u32 m0, m0, 2048
    s_add_u32 s39, s39, 65536
    buffer_load_dwordx4 v2, s[12:15], s39 offen sc1 lds
    buffer_load_dwordx4 v2, s[12:15], s39 offen offset:1024 sc1 lds
    s_add_u32 m0, m0, 2048
    s_add_u32 s39, s39, 65536
    buffer_load_dwordx4 v2, s[12:15], s39 offen sc1 lds
    buffer_load_dwordx4 v2, s[12:15], s39 offen offset:1024 sc1 lds
    s_add_u32 m0, m0, 2048
    s_add_u32 s39, s39, 65536
    buffer_load_dwordx4 v2, s[12:15], s39 offen sc1 lds
    buffer_load_dwordx4 v2, s[12:15], s39 offen offset:1024 sc1 lds
    s_mov_b32 m0, s19
    s_mov_b32 s39, s16
    buffer_load_dwordx4 v2, s[12:15], s39 offen sc1 lds
    buffer_load_dwordx4 v2, s[12:15], s39 offen offset:1024 sc1 lds
    s_add_u32 s19, s41, s42
    v_readlane_b32 s16, v248, s44
    s_nop 0
    s_add_u32 s16, s16, s38
    s_add_u32 s44, s44, 1
    s_and_b32 s44, s44, 15
    s_add_u32 s42, s42, 16384
    s_cmp_eq_u32 s42, 49152
    s_cselect_b32 s42, 0, s42
    s_add_u32 m0, m0, 2048
    s_add_u32 s39, s39, 65536
    buffer_load_dwordx4 v2, s[12:15], s39 offen sc1 lds
    buffer_load_dwordx4 v2, s[12:15], s39 offen offset:1024 sc1 lds
    s_add_u32 m0, m0, 2048
    s_add_u32 s39, s39, 65536
    buffer_load_dwordx4 v2, s[12:15], s39 offen sc1 lds
    buffer_load_dwordx4 v2, s[12:15], s39 offen offset:1024 sc1 lds
    s_add_u32 m0, m0, 2048
    s_add_u32 s39, s39, 65536
    buffer_load_dwordx4 v2, s[12:15], s39 offen sc1 lds
    buffer_load_dwordx4 v2, s[12:15], s39 offen offset:1024 sc1 lds
    s_mov_b32 m0, s19
    s_mov_b32 s39, s16
    s_waitcnt vmcnt(8)
    s_barrier
    buffer_load_dwordx4 v2, s[12:15], s39 offen sc1 lds
    buffer_load_dwordx4 v2, s[12:15], s39 offen offset:1024 sc1 lds
    s_add_u32 s19, s41, s42
    v_readlane_b32 s16, v248, s44
    s_nop 0
    s_add_u32 s16, s16, s38
    s_add_u32 s44, s44, 1
    s_and_b32 s44, s44, 15
    s_add_u32 s42, s42, 16384
    s_cmp_eq_u32 s42, 49152
    s_cselect_b32 s42, 0, s42
    s_add_u32 m0, m0, 2048
    s_add_u32 s39, s39, 65536
    buffer_load_dwordx4 v2, s[12:15], s39 offen sc1 lds
    buffer_load_dwordx4 v2, s[12:15], s39 offen offset:1024 sc1 lds
    s_add_u32 m0, m0, 2048
    s_add_u32 s39, s39, 65536
    buffer_load_dwordx4 v2, s[12:15], s39 offen sc1 lds
    buffer_load_dwordx4 v2, s[12:15], s39 offen offset:1024 sc1 lds
    s_add_u32 m0, m0, 2048
    s_add_u32 s39, s39, 65536
    buffer_load_dwordx4 v2, s[12:15], s39 offen sc1 lds
    buffer_load_dwordx4 v2, s[12:15], s39 offen offset:1024 sc1 lds
    s_mov_b32 m0, s19
    s_mov_b32 s39, s16
    s_add_u32 s24, s4, 0x1420000
    s_addc_u32 s25, s5, 0
    s_mov_b32 s26, 0x70000
    s_mov_b32 s27, 0x20000
    s_cmp_eq_u32 s60, 0
    s_cselect_b32 s26, s26, 0
    s_and_b32 s36, s30, 1
    s_mul_i32 s36, s36, 448
    s_mul_i32 s37, s29, 896
    s_add_u32 s37, s36, s37
    v_lshrrev_b32 v224, 5, v1
    v_mul_u32_u24 v224, 14336, v224
    v_and_b32 v179, 496, v2
    v_add_u32 v224, v224, v179
    s_cmp_eq_u32 s60, 0
    s_cselect_b64 exec, -1, 0
    buffer_load_dwordx4 v[180:183], v224, s[24:27], s37 offen sc1
    s_add_u32 s37, s37, 28672
    buffer_load_dwordx4 v[184:187], v224, s[24:27], s37 offen sc1
    s_add_u32 s37, s37, 28672
    buffer_load_dwordx4 v[188:191], v224, s[24:27], s37 offen sc1
    s_add_u32 s37, s37, 28672
    s_mov_b64 exec, -1
    s_waitcnt vmcnt(11)
    s_barrier
    buffer_load_dwordx4 v2, s[12:15], s39 offen sc1 lds
    buffer_load_dwordx4 v2, s[12:15], s39 offen offset:1024 sc1 lds
    s_add_u32 s19, s41, s42
    v_readlane_b32 s16, v248, s44
    s_nop 0
    s_add_u32 s16, s16, s38
    s_add_u32 s44, s44, 1
    s_and_b32 s44, s44, 15
    s_add_u32 s42, s42, 16384
    s_cmp_eq_u32 s42, 49152
    s_cselect_b32 s42, 0, s42
    s_add_u32 m0, m0, 2048
    s_add_u32 s39, s39, 65536
    buffer_load_dwordx4 v2, s[12:15], s39 offen sc1 lds
    buffer_load_dwordx4 v2, s[12:15], s39 offen offset:1024 sc1 lds
    s_add_u32 m0, m0, 2048
    s_add_u32 s39, s39, 65536
    buffer_load_dwordx4 v2, s[12:15], s39 offen sc1 lds
    buffer_load_dwordx4 v2, s[12:15], s39 offen offset:1024 sc1 lds
    s_add_u32 m0, m0, 2048
    s_add_u32 s39, s39, 65536
    buffer_load_dwordx4 v2, s[12:15], s39 offen sc1 lds
    buffer_load_dwordx4 v2, s[12:15], s39 offen offset:1024 sc1 lds
    s_mov_b32 m0, s19
    s_mov_b32 s39, s16
    s_cmp_eq_u32 s60, 0
    s_cselect_b64 exec, -1, 0
    buffer_load_dwordx4 v[192:195], v224, s[24:27], s37 offen sc1
    s_add_u32 s37, s37, 28672
    buffer_load_dwordx4 v[196:199], v224, s[24:27], s37 offen sc1
    s_add_u32 s37, s37, 28672
    buffer_load_dwordx4 v[200:203], v224, s[24:27], s37 offen sc1
    s_add_u32 s37, s37, 28672
    s_mov_b64 exec, -1
    s_waitcnt vmcnt(14)
    s_barrier
    buffer_load_dwordx4 v2, s[12:15], s39 offen sc1 lds
    buffer_load_dwordx4 v2, s[12:15], s39 offen offset:1024 sc1 lds
    s_add_u32 s19, s41, s42
    v_readlane_b32 s16, v248, s44
    s_nop 0
    s_add_u32 s16, s16, s38
    s_add_u32 s44, s44, 1
    s_and_b32 s44, s44, 15
    s_add_u32 s42, s42, 16384
    s_cmp_eq_u32 s42, 49152
    s_cselect_b32 s42, 0, s42
    s_add_u32 m0, m0, 2048
    s_add_u32 s39, s39, 65536
    buffer_load_dwordx4 v2, s[12:15], s39 offen sc1 lds
    buffer_load_dwordx4 v2, s[12:15], s39 offen offset:1024 sc1 lds
    s_add_u32 m0, m0, 2048
    s_add_u32 s39, s39, 65536
    buffer_load_dwordx4 v2, s[12:15], s39 offen sc1 lds
    buffer_load_dwordx4 v2, s[12:15], s39 offen offset:1024 sc1 lds
    s_add_u32 m0, m0, 2048
    s_add_u32 s39, s39, 65536
    buffer_load_dwordx4 v2, s[12:15], s39 offen sc1 lds
    buffer_load_dwordx4 v2, s[12:15], s39 offen offset:1024 sc1 lds
    s_mov_b32 m0, s19
    s_mov_b32 s39, s16
    s_cmp_eq_u32 s60, 0
    s_cselect_b64 exec, -1, 0
    buffer_load_dwordx4 v[204:207], v224, s[24:27], s37 offen sc1
    s_add_u32 s37, s37, 28672
    buffer_load_dwordx4 v[208:211], v224, s[24:27], s37 offen sc1
    s_add_u32 s37, s37, 28672
    buffer_load_dwordx4 v[212:215], v224, s[24:27], s37 offen sc1
    s_add_u32 s37, s37, 28672
    s_mov_b64 exec, -1
    s_mov_b64 exec, 1
    buffer_load_dword v223, v222, s[56:59], 0 offen sc1
    s_mov_b64 exec, -1
    s_waitcnt vmcnt(15)
    s_barrier
    buffer_load_dwordx4 v2, s[12:15], s39 offen sc1 lds
    buffer_load_dwordx4 v2, s[12:15], s39 offen offset:1024 sc1 lds
    s_add_u32 s19, s41, s42
    v_readlane_b32 s16, v248, s44
    s_nop 0
    s_add_u32 s16, s16, s38
    s_add_u32 s44, s44, 1
    s_and_b32 s44, s44, 15
    s_add_u32 s42, s42, 16384
    s_cmp_eq_u32 s42, 49152
    s_cselect_b32 s42, 0, s42
    s_add_u32 m0, m0, 2048
    s_add_u32 s39, s39, 65536
    buffer_load_dwordx4 v2, s[12:15], s39 offen sc1 lds
    buffer_load_dwordx4 v2, s[12:15], s39 offen offset:1024 sc1 lds
    s_add_u32 m0, m0, 2048
    s_add_u32 s39, s39, 65536
    buffer_load_dwordx4 v2, s[12:15], s39 offen sc1 lds
    buffer_load_dwordx4 v2, s[12:15], s39 offen offset:1024 sc1 lds
    s_add_u32 m0, m0, 2048
    s_add_u32 s39, s39, 65536
    buffer_load_dwordx4 v2, s[12:15], s39 offen sc1 lds
    buffer_load_dwordx4 v2, s[12:15], s39 offen offset:1024 sc1 lds
    s_mov_b32 m0, s19
    s_mov_b32 s39, s16
    s_waitcnt vmcnt(12)
    s_barrier
    buffer_load_dwordx4 v2, s[12:15], s39 offen sc1 lds
    buffer_load_dwordx4 v2, s[12:15], s39 offen offset:1024 sc1 lds
    s_add_u32 s19, s41, s42
    v_readlane_b32 s16, v248, s44
    s_nop 0
    s_add_u32 s16, s16, s38
    s_add_u32 s44, s44, 1
    s_and_b32 s44, s44, 15
    s_add_u32 s42, s42, 16384
    s_cmp_eq_u32 s42, 49152
    s_cselect_b32 s42, 0, s42
    s_add_u32 m0, m0, 2048
    s_add_u32 s39, s39, 65536
    buffer_load_dwordx4 v2, s[12:15], s39 offen sc1 lds
    buffer_load_dwordx4 v2, s[12:15], s39 offen offset:1024 sc1 lds
    s_add_u32 m0, m0, 2048
    s_add_u32 s39, s39, 65536
    buffer_load_dwordx4 v2, s[12:15], s39 offen sc1 lds
    buffer_load_dwordx4 v2, s[12:15], s39 offen offset:1024 sc1 lds
    s_add_u32 m0, m0, 2048
    s_add_u32 s39, s39, 65536
    buffer_load_dwordx4 v2, s[12:15], s39 offen sc1 lds
    buffer_load_dwordx4 v2, s[12:15], s39 offen offset:1024 sc1 lds
    s_mov_b32 m0, s19
    s_mov_b32 s39, s16
    s_waitcnt vmcnt(16)
    v_readfirstlane_b32 s53, v223
    s_add_u32 s54, s52, 16
    s_cmp_eq_u32 s53, s54
    s_cbranch_scc1 fok_42
    s_mov_b32 s53, 0
    s_add_u32 s54, s52, 16
    s_bfm_b64 exec, 1, 0
poll_43:
    buffer_load_dword v223, v222, s[56:59], 0 offen sc1
    s_waitcnt vmcnt(0)
    v_xor_b32 v223, s54, v223
    v_cmp_eq_u32 vcc, 0, v223
    s_nop 0
    s_cmp_eq_u64 vcc, exec
    s_cbranch_scc1 pok_44
    s_sleep 5
    s_add_u32 s53, s53, 1
    s_cmp_lt_u32 s53, s61
    s_cbranch_scc1 poll_43
    s_mov_b32 s61, 0
pok_44:
    s_mov_b64 exec, -1
fok_42:
    s_add_u32 s20, s62, 0x5c8000
    s_addc_u32 s21, s63, 0
    s_mov_b32 s22, 0x6000
    s_mov_b32 s23, 0x20000
    s_and_b32 s35, s30, 1
    s_lshl_b32 s35, s35, 9
    s_add_u32 s36, s35, 0
    buffer_load_dwordx2 v[16:17], v221, s[20:23], s36 offen offset:0 sc1
    buffer_load_dwordx2 v[18:19], v221, s[20:23], s36 offen offset:1024 sc1
    buffer_load_dwordx2 v[20:21], v221, s[20:23], s36 offen offset:2048 sc1
    buffer_load_dwordx2 v[22:23], v221, s[20:23], s36 offen offset:3072 sc1
    s_cmp_lg_u32 s60, 0
    s_cbranch_scc1 pc_45
    v_add_f32 v180, v180, v184
    v_add_f32 v181, v181, v185
    v_add_f32 v182, v182, v186
    v_add_f32 v183, v183, v187
    v_add_f32 v180, v180, v188
    v_add_f32 v181, v181, v189
    v_add_f32 v182, v182, v190
    v_add_f32 v183, v183, v191
    v_add_f32 v180, v180, v192
    v_add_f32 v181, v181, v193
    v_add_f32 v182, v182, v194
    v_add_f32 v183, v183, v195
    v_add_f32 v180, v180, v196
    v_add_f32 v181, v181, v197
    v_add_f32 v182, v182, v198
    v_add_f32 v183, v183, v199
pc_45:
    s_waitcnt vmcnt(12)
    s_barrier
    buffer_load_dwordx4 v2, s[12:15], s39 offen sc1 lds
    buffer_load_dwordx4 v2, s[12:15], s39 offen offset:1024 sc1 lds
    s_add_u32 s19, s41, s42
    v_readlane_b32 s16, v248, s44
    s_nop 0
    s_add_u32 s16, s16, s38
    s_add_u32 s44, s44, 1
    s_and_b32 s44, s44, 15
    s_add_u32 s42, s42, 16384
    s_cmp_eq_u32 s42, 49152
    s_cselect_b32 s42, 0, s42
    s_add_u32 m0, m0, 2048
    s_add_u32 s39, s39, 65536
    buffer_load_dwordx4 v2, s[12:15], s39 offen sc1 lds
    buffer_load_dwordx4 v2, s[12:15], s39 offen offset:1024 sc1 lds
    s_add_u32 m0, m0, 2048
    s_add_u32 s39, s39, 65536
    buffer_load_dwordx4 v2, s[12:15], s39 offen sc1 lds
    buffer_load_dwordx4 v2, s[12:15], s39 offen offset:1024 sc1 lds
    s_add_u32 m0, m0, 2048
    s_add_u32 s39, s39, 65536
    buffer_load_dwordx4 v2, s[12:15], s39 offen sc1 lds
    buffer_load_dwordx4 v2, s[12:15], s39 offen offset:1024 sc1 lds
    s_mov_b32 m0, s19
    s_mov_b32 s39, s16
    s_add_u32 s36, s35, 4096
    buffer_load_dwordx2 v[24:25], v221, s[20:23], s36 offen offset:0 sc1
    buffer_load_dwordx2 v[26:27], v221, s[20:23], s36 offen offset:1024 sc1
    buffer_load_dwordx2 v[28:29], v221, s[20:23], s36 offen offset:2048 sc1
    buffer_load_dwordx2 v[30:31], v221, s[20:23], s36 offen offset:3072 sc1
    s_cmp_lg_u32 s60, 0
    s_cbranch_scc1 pc_46
    v_add_f32 v180, v180, v200
    v_add_f32 v181, v181, v201
    v_add_f32 v182, v182, v202
    v_add_f32 v183, v183, v203
    v_add_f32 v180, v180, v204
    v_add_f32 v181, v181, v205
    v_add_f32 v182, v182, v206
    v_add_f32 v183, v183, v207
    v_add_f32 v180, v180, v208
    v_add_f32 v181, v181, v209
    v_add_f32 v182, v182, v210
    v_add_f32 v183, v183, v211
    v_add_f32 v180, v180, v212
    v_add_f32 v181, v181, v213
    v_add_f32 v182, v182, v214
    v_add_f32 v183, v183, v215
pc_46:
    s_cmp_eq_u32 s60, 0
    s_cselect_b64 exec, -1, 0
    buffer_load_dwordx4 v[184:187], v224, s[24:27], s37 offen sc1
    s_add_u32 s37, s37, 28672
    buffer_load_dwordx4 v[188:191], v224, s[24:27], s37 offen sc1
    s_add_u32 s37, s37, 28672
    buffer_load_dwordx4 v[192:195], v224, s[24:27], s37 offen sc1
    s_add_u32 s37, s37, 28672
    s_mov_b64 exec, -1
    s_waitcnt vmcnt(19)
    s_barrier
    buffer_load_dwordx4 v2, s[12:15], s39 offen sc1 lds
    buffer_load_dwordx4 v2, s[12:15], s39 offen offset:1024 sc1 lds
    s_add_u32 s19, s41, s42
    v_readlane_b32 s16, v248, s44
    s_nop 0
    s_add_u32 s16, s16, s38
    s_add_u32 s44, s44, 1
    s_and_b32 s44, s44, 15
    s_add_u32 s42, s42, 16384
    s_cmp_eq_u32 s42, 49152
    s_cselect_b32 s42, 0, s42
    s_add_u32 m0, m0, 2048
    s_add_u32 s39, s39, 65536
    buffer_load_dwordx4 v2, s[12:15], s39 offen sc1 lds
    buffer_load_dwordx4 v2, s[12:15], s39 offen offset:1024 sc1 lds
    s_add_u32 m0, m0, 2048
    s_add_u32 s39, s39, 65536
    buffer_load_dwordx4 v2, s[12:15], s39 offen sc1 lds
    buffer_load_dwordx4 v2, s[12:15], s39 offen offset:1024 sc1 lds
    s_add_u32 m0, m0, 2048
    s_add_u32 s39, s39, 65536
    buffer_load_dwordx4 v2, s[12:15], s39 offen sc1 lds
    buffer_load_dwordx4 v2, s[12:15], s39 offen offset:1024 sc1 lds
    s_mov_b32 m0, s19
    s_mov_b32 s39, s16
    s_add_u32 s36, s35, 16384
    buffer_load_dwordx2 v[32:33], v221, s[20:23], s36 offen offset:0 sc1
    buffer_load_dwordx2 v[34:35], v221, s[20:23], s36 offen offset:1024 sc1
    buffer_load_dwordx2 v[36:37], v221, s[20:23], s36 offen offset:2048 sc1
    buffer_load_dwordx2 v[38:39], v221, s[20:23], s36 offen offset:3072 sc1
    s_cmp_eq_u32 s60, 0
    s_cselect_b64 exec, -1, 0
    buffer_load_dwordx4 v[196:199], v224, s[24:27], s37 offen sc1
    s_add_u32 s37, s37, 28672
    buffer_load_dwordx4 v[200:203], v224, s[24:27], s37 offen sc1
    s_add_u32 s37, s37, 28672
    s_mov_b64 exec, -1
    s_waitcnt vmcnt(21)
    s_barrier
    buffer_load_dwordx4 v2, s[12:15], s39 offen sc1 lds
    buffer_load_dwordx4 v2, s[12:15], s39 offen offset:1024 sc1 lds
    s_add_u32 s19, s41, s42
    v_readlane_b32 s16, v248, s44
    s_nop 0
    s_add_u32 s16, s16, s38
    s_add_u32 s44, s44, 1
    s_and_b32 s44, s44, 15
    s_add_u32 s42, s42, 16384
    s_cmp_eq_u32 s42, 49152
    s_cselect_b32 s42, 0, s42
    s_add_u32 m0, m0, 2048
    s_add_u32 s39, s39, 65536
    buffer_load_dwordx4 v2, s[12:15], s39 offen sc1 lds
    buffer_load_dwordx4 v2, s[12:15], s39 offen offset:1024 sc1 lds
    s_add_u32 m0, m0, 2048
    s_add_u32 s39, s39, 65536
    buffer_load_dwordx4 v2, s[12:15], s39 offen sc1 lds
    buffer_load_dwordx4 v2, s[12:15], s39 offen offset:1024 sc1 lds
    s_add_u32 m0, m0, 2048
    s_add_u32 s39, s39, 65536
    buffer_load_dwordx4 v2, s[12:15], s39 offen sc1 lds
    buffer_load_dwordx4 v2, s[12:15], s39 offen offset:1024 sc1 lds
    s_mov_b32 m0, s19
    s_mov_b32 s39, s16
    s_add_u32 s36, s35, 20480
    buffer_load_dwordx2 v[40:41], v221, s[20:23], s36 offen offset:0 sc1
    buffer_load_dwordx2 v[42:43], v221, s[20:23], s36 offen offset:1024 sc1
    buffer_load_dwordx2 v[44:45], v221, s[20:23], s36 offen offset:2048 sc1
    buffer_load_dwordx2 v[46:47], v221, s[20:23], s36 offen offset:3072 sc1
    s_cmp_eq_u32 s60, 0
    s_cselect_b64 exec, -1, 0
    buffer_load_dwordx4 v[204:207], v224, s[24:27], s37 offen sc1
    s_add_u32 s37, s37, 28672
    buffer_load_dwordx4 v[208:211], v224, s[24:27], s37 offen sc1
    s_add_u32 s37, s37, 28672
    s_mov_b64 exec, -1
    s_waitcnt vmcnt(20)
    s_barrier
    buffer_load_dwordx4 v2, s[12:15], s39 offen sc1 lds
    buffer_load_dwordx4 v2, s[12:15], s39 offen offset:1024 sc1 lds
    s_add_u32 s19, s41, s42
    v_readlane_b32 s16, v248, s44
    s_nop 0
    s_add_u32 s16, s16, s38
    s_add_u32 s44, s44, 1
    s_and_b32 s44, s44, 15
    s_add_u32 s42, s42, 16384
    s_cmp_eq_u32 s42, 49152
    s_cselect_b32 s42, 0, s42
    s_add_u32 m0, m0, 2048
    s_add_u32 s39, s39, 65536
    buffer_load_dwordx4 v2, s[12:15], s39 offen sc1 lds
    buffer_load_dwordx4 v2, s[12:15], s39 offen offset:1024 sc1 lds
    s_add_u32 m0, m0, 2048
    s_add_u32 s39, s39, 65536
    buffer_load_dwordx4 v2, s[12:15], s39 offen sc1 lds
    buffer_load_dwordx4 v2, s[12:15], s39 offen offset:1024 sc1 lds
    s_add_u32 m0, m0, 2048
    s_add_u32 s39, s39, 65536
    buffer_load_dwordx4 v2, s[12:15], s39 offen sc1 lds
    buffer_load_dwordx4 v2, s[12:15], s39 offen offset:1024 sc1 lds
    s_mov_b32 m0, s19
    s_mov_b32 s39, s16
    s_waitcnt vmcnt(14)
    s_barrier
    buffer_load_dwordx4 v2, s[12:15], s39 offen sc1 lds
    buffer_load_dwordx4 v2, s[12:15], s39 offen offset:1024 sc1 lds
    s_add_u32 s19, s41, s42
    v_readlane_b32 s16, v248, s44
    s_nop 0
    s_add_u32 s16, s16, s38
    s_add_u32 s44, s44, 1
    s_and_b32 s44, s44, 15
    s_add_u32 s42, s42, 16384
    s_cmp_eq_u32 s42, 49152
    s_cselect_b32 s42, 0, s42
    s_add_u32 m0, m0, 2048
    s_add_u32 s39, s39, 65536
    buffer_load_dwordx4 v2, s[12:15], s39 offen sc1 lds
    buffer_load_dwordx4 v2, s[12:15], s39 offen offset:1024 sc1 lds
    s_add_u32 m0, m0, 2048
    s_add_u32 s39, s39, 65536
    buffer_load_dwordx4 v2, s[12:15], s39 offen sc1 lds
    buffer_load_dwordx4 v2, s[12:15], s39 offen offset:1024 sc1 lds
    s_add_u32 m0, m0, 2048
    s_add_u32 s39, s39, 65536
    buffer_load_dwordx4 v2, s[12:15], s39 offen sc1 lds
    buffer_load_dwordx4 v2, s[12:15], s39 offen offset:1024 sc1 lds
    s_mov_b32 m0, s19
    s_mov_b32 s39, s16
    s_waitcnt vmcnt(16)
    v_add_f32 v16, v16, v32
    v_add_f32 v17, v17, v33
    v_add_f32 v18, v18, v34
    v_add_f32 v19, v19, v35
    v_add_f32 v20, v20, v36
    v_add_f32 v21, v21, v37
    v_add_f32 v22, v22, v38
    v_add_f32 v23, v23, v39
    v_add_f32 v24, v24, v40
    v_add_f32 v25, v25, v41
    v_add_f32 v26, v26, v42
    v_add_f32 v27, v27, v43
    v_add_f32 v28, v28, v44
    v_add_f32 v29, v29, v45
    v_add_f32 v30, v30, v46
    v_add_f32 v31, v31, v47
    s_waitcnt vmcnt(8)
    s_barrier
    buffer_load_dwordx4 v2, s[12:15], s39 offen sc1 lds
    buffer_load_dwordx4 v2, s[12:15], s39 offen offset:1024 sc1 lds
    s_add_u32 s19, s41, s42
    v_readlane_b32 s16, v248, s44
    s_nop 0
    s_add_u32 s16, s16, s38
    s_add_u32 s44, s44, 1
    s_and_b32 s44, s44, 15
    s_add_u32 s42, s42, 16384
    s_cmp_eq_u32 s42, 49152
    s_cselect_b32 s42, 0, s42
    s_add_u32 m0, m0, 2048
    s_add_u32 s39, s39, 65536
    buffer_load_dwordx4 v2, s[12:15], s39 offen sc1 lds
    buffer_load_dwordx4 v2, s[12:15], s39 offen offset:1024 sc1 lds
    s_add_u32 m0, m0, 2048
    s_add_u32 s39, s39, 65536
    buffer_load_dwordx4 v2, s[12:15], s39 offen sc1 lds
    buffer_load_dwordx4 v2, s[12:15], s39 offen offset:1024 sc1 lds
    s_add_u32 m0, m0, 2048
    s_add_u32 s39, s39, 65536
    buffer_load_dwordx4 v2, s[12:15], s39 offen sc1 lds
    buffer_load_dwordx4 v2, s[12:15], s39 offen offset:1024 sc1 lds
    s_mov_b32 m0, s19
    s_mov_b32 s39, s16
    v_add_f32 v16, v16, v24
    v_add_f32 v17, v17, v25
    v_add_f32 v18, v18, v26
    v_add_f32 v19, v19, v27
    v_add_f32 v20, v20, v28
    v_add_f32 v21, v21, v29
    v_add_f32 v22, v22, v30
    v_add_f32 v23, v23, v31
    v_add_f32 v16, v16, v20
    v_add_f32 v17, v17, v21
    v_add_f32 v18, v18, v22
    v_add_f32 v19, v19, v23
    v_add_f32 v16, v16, v18
    v_add_f32 v17, v17, v19
    v_mul_f32 v20, 0x3a800000, v16
    v_mul_f32 v217, 0x3a800000, v17
    s_cmp_lg_u32 s60, 0
    s_cbranch_scc1 pc_49
    v_add_f32 v180, v180, v184
    v_add_f32 v181, v181, v185
    v_add_f32 v182, v182, v186
    v_add_f32 v183, v183, v187
    v_add_f32 v180, v180, v188
    v_add_f32 v181, v181, v189
    v_add_f32 v182, v182, v190
    v_add_f32 v183, v183, v191
    v_add_f32 v180, v180, v192
    v_add_f32 v181, v181, v193
    v_add_f32 v182, v182, v194
    v_add_f32 v183, v183, v195
pc_49:
    s_waitcnt vmcnt(8)
    s_barrier
    buffer_load_dwordx4 v2, s[12:15], s39 offen sc1 lds
    buffer_load_dwordx4 v2, s[12:15], s39 offen offset:1024 sc1 lds
    s_add_u32 s19, s41, s42
    v_readlane_b32 s16, v248, s44
    s_nop 0
    s_add_u32 s16, s16, s38
    s_add_u32 s44, s44, 1
    s_and_b32 s44, s44, 15
    s_add_u32 s42, s42, 16384
    s_cmp_eq_u32 s42, 49152
    s_cselect_b32 s42, 0, s42
    s_add_u32 m0, m0, 2048
    s_add_u32 s39, s39, 65536
    buffer_load_dwordx4 v2, s[12:15], s39 offen sc1 lds
    buffer_load_dwordx4 v2, s[12:15], s39 offen offset:1024 sc1 lds
    s_add_u32 m0, m0, 2048
    s_add_u32 s39, s39, 65536
    buffer_load_dwordx4 v2, s[12:15], s39 offen sc1 lds
    buffer_load_dwordx4 v2, s[12:15], s39 offen offset:1024 sc1 lds
    s_add_u32 m0, m0, 2048
    s_add_u32 s39, s39, 65536
    buffer_load_dwordx4 v2, s[12:15], s39 offen sc1 lds
    buffer_load_dwordx4 v2, s[12:15], s39 offen offset:1024 sc1 lds
    s_mov_b32 m0, s19
    s_mov_b32 s39, s16
    v_fma_f32 v217, -v20, v20, v217
    v_max_f32 v217, 0, v217
    v_add_f32 v217, 0x3727c5ac, v217
    v_sqrt_f32 v217, v217
    s_nop 0
    v_mov_b32 v21, v217
    v_rcp_f32 v219, v217
    s_nop 0
    v_mul_f32 v22, 0xc0135761, v219
    v_mul_f32 v23, v219, v219
    v_mul_f32 v23, v23, v22
    v_mul_f32 v23, 0x3d372713, v23
    s_lshl_b32 s35, s35, 1
    s_add_u32 s35, s35, 160768
    v_add_u32 v220, s35, v2
    ds_write_b128 v220, v[20:23]
    s_waitcnt lgkmcnt(0)
    s_waitcnt vmcnt(8)
    s_barrier
    buffer_load_dwordx4 v2, s[12:15], s39 offen sc1 lds
    buffer_load_dwordx4 v2, s[12:15], s39 offen offset:1024 sc1 lds
    s_add_u32 m0, m0, 2048
    s_add_u32 s39, s39, 65536
    buffer_load_dwordx4 v2, s[12:15], s39 offen sc1 lds
    buffer_load_dwordx4 v2, s[12:15], s39 offen offset:1024 sc1 lds
    s_add_u32 m0, m0, 2048
    s_add_u32 s39, s39, 65536
    buffer_load_dwordx4 v2, s[12:15], s39 offen sc1 lds
    buffer_load_dwordx4 v2, s[12:15], s39 offen offset:1024 sc1 lds
    s_add_u32 m0, m0, 2048
    s_add_u32 s39, s39, 65536
    buffer_load_dwordx4 v2, s[12:15], s39 offen sc1 lds
    buffer_load_dwordx4 v2, s[12:15], s39 offen offset:1024 sc1 lds
    s_cmp_lg_u32 s60, 0
    s_cbranch_scc1 pc_51
    v_add_f32 v180, v180, v196
    v_add_f32 v181, v181, v197
    v_add_f32 v182, v182, v198
    v_add_f32 v183, v183, v199
    v_add_f32 v180, v180, v200
    v_add_f32 v181, v181, v201
    v_add_f32 v182, v182, v202
    v_add_f32 v183, v183, v203
    v_add_f32 v180, v180, v204
    v_add_f32 v181, v181, v205
    v_add_f32 v182, v182, v206
    v_add_f32 v183, v183, v207
    v_add_f32 v180, v180, v208
    v_add_f32 v181, v181, v209
    v_add_f32 v182, v182, v210
    v_add_f32 v183, v183, v211
pc_51:
    s_waitcnt vmcnt(8)
    s_barrier
    s_cmp_lg_u32 s60, 0
    s_cbranch_scc1 pc_52
    v_mov_b32 v184, v180
    v_mov_b32 v185, v181
    v_mov_b32 v186, v182
    v_mov_b32 v187, v183
    v_permlane32_swap_b32 v180, v184
    v_permlane32_swap_b32 v181, v185
    v_permlane32_swap_b32 v182, v186
    v_permlane32_swap_b32 v183, v187
    v_add_f32 v180, v180, v184
    v_add_f32 v181, v181, v185
    v_add_f32 v182, v182, v186
    v_add_f32 v183, v183, v187
    s_and_b32 s36, s30, 1
    s_mul_i32 s36, s36, 448
    s_add_u32 s36, s36, 159744
    v_add_u32 v179, s36, v2
    s_bfm_b64 exec, 28, 0
    ds_write_b128 v179, v[180:183]
    s_mov_b64 exec, -1
    s_waitcnt lgkmcnt(0)
pc_52:
    s_waitcnt vmcnt(0)
    s_barrier
    s_cmp_lg_u32 s60, 0
    s_cbranch_scc1 tw4_53
    s_load_dwordx2 s[48:49], s[0:1], 80
    s_lshl_b32 s45, s2, 1
    s_and_b32 s50, s30, 1
    s_add_u32 s45, s45, s50
    s_mul_i32 s45, s45, 14336
    s_mov_b32 s50, 7340032
    s_mov_b32 s51, 0x20000
    s_waitcnt lgkmcnt(0)
    buffer_load_dwordx4 v[20:23], v2, s[48:51], s45 offen offset:0
    buffer_load_dwordx4 v[20:23], v2, s[48:51], s45 offen offset:1024
    buffer_load_dwordx4 v[20:23], v2, s[48:51], s45 offen offset:2048
    buffer_load_dwordx4 v[20:23], v2, s[48:51], s45 offen offset:3072
    s_add_u32 s45, s45, 4096
    buffer_load_dwordx4 v[20:23], v2, s[48:51], s45 offen offset:0
    buffer_load_dwordx4 v[20:23], v2, s[48:51], s45 offen offset:1024
    buffer_load_dwordx4 v[20:23], v2, s[48:51], s45 offen offset:2048
    buffer_load_dwordx4 v[20:23], v2, s[48:51], s45 offen offset:3072
    s_add_u32 s45, s45, 4096
    buffer_load_dwordx4 v[20:23], v2, s[48:51], s45 offen offset:0
    buffer_load_dwordx4 v[20:23], v2, s[48:51], s45 offen offset:1024
    buffer_load_dwordx4 v[20:23], v2, s[48:51], s45 offen offset:2048
    buffer_load_dwordx4 v[20:23], v2, s[48:51], s45 offen offset:3072
    s_add_u32 s45, s45, 4096
    buffer_load_dwordx4 v[20:23], v2, s[48:51], s45 offen offset:0
    buffer_load_dwordx4 v[20:23], v2, s[48:51], s45 offen offset:1024
tw4_53:
    s_barrier
    s_cmp_lg_u32 s60, 0
    s_cbranch_scc1 rp_54
    s_call_b64 s[76:77], SUB_r_pre
rp_54:
    s_and_b32 s35, s30, 1
    s_add_u32 s12, s62, 0x400000
    s_addc_u32 s13, s63, 0
    s_mov_b32 s14, 0x1be000
    s_mov_b32 s15, 0x20000
    s_mul_i32 s38, s35, 917504
    s_mul_i32 s36, s31, 114688
    s_add_u32 s38, s38, s36
    s_lshl_b32 s41, s35, 13
    s_mov_b32 s42, 0
    s_mov_b32 s44, 0
    s_add_u32 s54, s55, 0x700
    s_lshl_b32 s53, s31, 7
    s_add_u32 s54, s54, s53
    v_mov_b32 v9, s54
    s_add_u32 s54, s55, 0x600
    s_lshl_b32 s53, s31, 7
    s_add_u32 s54, s54, s53
    v_mov_b32 v10, s54
    s_add_u32 s54, s55, 0x300
    s_lshl_b32 s53, s31, 7
    s_add_u32 s54, s54, s53
    v_mov_b32 v12, s54
    v_mov_b32 v13, 1
    s_and_b32 s51, s30, 1
    s_lshl_b32 s51, s51, 30
    s_lshl_b32 s54, s60, 2
    s_add_u32 s54, s54, 4
    v_mov_b32 v14, 162880
spin_55:
    s_sleep 2
    ds_read_b32 v15, v14
    s_waitcnt lgkmcnt(0)
    v_readfirstlane_b32 s53, v15
    s_nop 0
    s_cmp_ge_u32 s53, s54
    s_cbranch_scc0 spin_55
    s_mov_b64 exec, 1
    buffer_atomic_add v13, v9, s[56:59], s51 offen sc1
    s_mov_b64 exec, -1
    v_xor_b32 v15, 128, v12
    s_mov_b32 s44, 3
    s_call_b64 s[76:77], PREP_a_issue_4
    s_mov_b32 m0, s19
    s_mov_b32 s39, s16
    s_mov_b32 s40, s17
    s_waitcnt vmcnt(16)
    s_barrier
    s_mov_b64 exec, 1
    buffer_load_dword v8, v9, s[56:59], 0 offen sc1
    s_mov_b64 exec, -1
    s_waitcnt vmcnt(9)
    s_barrier
    s_waitcnt vmcnt(0)
    v_readfirstlane_b32 s53, v8
    s_add_u32 s54, s52, 8
    s_cmp_eq_u32 s53, s54
    s_cbranch_scc1 fok_56
    s_mov_b32 s53, 0
    s_add_u32 s54, s52, 8
    s_bfm_b64 exec, 1, 0
poll_57:
    buffer_load_dword v8, v9, s[56:59], 0 offen sc1
    s_waitcnt vmcnt(0)
    v_xor_b32 v8, s54, v8
    v_cmp_eq_u32 vcc, 0, v8
    s_nop 0
    s_cmp_eq_u64 vcc, exec
    s_cbranch_scc1 pok_58
    s_sleep 5
    s_add_u32 s53, s53, 1
    s_cmp_lt_u32 s53, s61
    s_cbranch_scc1 poll_57
    s_mov_b32 s61, 0
pok_58:
    s_mov_b64 exec, -1
fok_56:
    buffer_load_dwordx4 v2, s[12:15], s39 offen sc1 lds
    s_add_u32 m0, m0, 1024
    s_nop 0
    buffer_load_dwordx4 v2, s[12:15], s40 offen sc1 lds
    s_call_b64 s[76:77], PREP_a_issue_4
    s_add_u32 m0, m0, 1024
    s_add_u32 s39, s39, 229376
    buffer_load_dwordx4 v2, s[12:15], s39 offen sc1 lds
    s_add_u32 m0, m0, 1024
    s_add_u32 s40, s40, 229376
    buffer_load_dwordx4 v2, s[12:15], s40 offen sc1 lds
    s_add_u32 m0, m0, 1024
    s_add_u32 s39, s39, 229376
    buffer_load_dwordx4 v2, s[12:15], s39 offen sc1 lds
    s_add_u32 m0, m0, 1024
    s_add_u32 s40, s40, 229376
    buffer_load_dwordx4 v2, s[12:15], s40 offen sc1 lds
    s_add_u32 m0, m0, 1024
    s_add_u32 s39, s39, 229376
    buffer_load_dwordx4 v2, s[12:15], s39 offen sc1 lds
    s_add_u32 m0, m0, 1024
    s_add_u32 s40, s40, 229376
    buffer_load_dwordx4 v2, s[12:15], s40 offen sc1 lds
    s_mov_b32 m0, s19
    s_mov_b32 s39, s16
    s_mov_b32 s40, s17
    s_waitcnt vmcnt(9)
    s_barrier
    s_mov_b64 exec, 1
    buffer_atomic_add v13, v10, s[56:59], s51 offen sc1
    s_mov_b64 exec, -1
    buffer_load_dwordx4 v2, s[12:15], s39 offen sc1 lds
    s_add_u32 m0, m0, 1024
    s_nop 0
    buffer_load_dwordx4 v2, s[12:15], s40 offen sc1 lds
    s_call_b64 s[76:77], PREP_a_issue_4
    s_add_u32 m0, m0, 1024
    s_add_u32 s39, s39, 229376
    buffer_load_dwordx4 v2, s[12:15], s39 offen sc1 lds
    s_add_u32 m0, m0, 1024
    s_add_u32 s40, s40, 229376
    buffer_load_dwordx4 v2, s[12:15], s40 offen sc1 lds
    s_add_u32 m0, m0, 1024
    s_add_u32 s39, s39, 229376
    buffer_load_dwordx4 v2, s[12:15], s39 offen sc1 lds
    s_add_u32 m0, m0, 1024
    s_add_u32 s40, s40, 229376
    buffer_load_dwordx4 v2, s[12:15], s40 offen sc1 lds
    s_add_u32 m0, m0, 1024
    s_add_u32 s39, s39, 229376
    buffer_load_dwordx4 v2, s[12:15], s39 offen sc1 lds
    s_add_u32 m0, m0, 1024
    s_add_u32 s40, s40, 229376
    buffer_load_dwordx4 v2, s[12:15], s40 offen sc1 lds
    s_mov_b32 m0, s19
    s_mov_b32 s39, s16
    s_mov_b32 s40, s17
    s_waitcnt vmcnt(9)
    s_barrier
    buffer_load_dwordx4 v2, s[12:15], s39 offen sc1 lds
    s_add_u32 m0, m0, 1024
    s_nop 0
    buffer_load_dwordx4 v2, s[12:15], s40 offen sc1 lds
    s_call_b64 s[76:77], PREP_a_issue_4
    s_add_u32 m0, m0, 1024
    s_add_u32 s39, s39, 229376
    buffer_load_dwordx4 v2, s[12:15], s39 offen sc1 lds
    s_add_u32 m0, m0, 1024
    s_add_u32 s40, s40, 229376
    buffer_load_dwordx4 v2, s[12:15], s40 offen sc1 lds
    s_add_u32 m0, m0, 1024
    s_add_u32 s39, s39, 229376
    buffer_load_dwordx4 v2, s[12:15], s39 offen sc1 lds
    s_add_u32 m0, m0, 1024
    s_add_u32 s40, s40, 229376
    buffer_load_dwordx4 v2, s[12:15], s40 offen sc1 lds
    s_add_u32 m0, m0, 1024
    s_add_u32 s39, s39, 229376
    buffer_load_dwordx4 v2, s[12:15], s39 offen sc1 lds
    s_add_u32 m0, m0, 1024
    s_add_u32 s40, s40, 229376
    buffer_load_dwordx4 v2, s[12:15], s40 offen sc1 lds
    s_mov_b32 m0, s19
    s_mov_b32 s39, s16
    s_mov_b32 s40, s17
    s_waitcnt vmcnt(8)
    s_barrier
    buffer_load_dwordx4 v2, s[12:15], s39 offen sc1 lds
    s_add_u32 m0, m0, 1024
    s_nop 0
    buffer_load_dwordx4 v2, s[12:15], s40 offen sc1 lds
    s_mov_b64 exec, 1
    buffer_load_dword v11, v10, s[56:59], 0 offen sc1
    s_mov_b64 exec, -1
    s_call_b64 s[76:77], PREP_a_issue_4
    s_add_u32 m0, m0, 1024
    s_add_u32 s39, s39, 229376
    buffer_load_dwordx4 v2, s[12:15], s39 offen sc1 lds
    s_add_u32 m0, m0, 1024
    s_add_u32 s40, s40, 229376
    buffer_load_dwordx4 v2, s[12:15], s40 offen sc1 lds
    s_add_u32 m0, m0, 1024
    s_add_u32 s39, s39, 229376
    buffer_load_dwordx4 v2, s[12:15], s39 offen sc1 lds
    s_add_u32 m0, m0, 1024
    s_add_u32 s40, s40, 229376
    buffer_load_dwordx4 v2, s[12:15], s40 offen sc1 lds
    s_add_u32 m0, m0, 1024
    s_add_u32 s39, s39, 229376
    buffer_load_dwordx4 v2, s[12:15], s39 offen sc1 lds
    s_add_u32 m0, m0, 1024
    s_add_u32 s40, s40, 229376
    buffer_load_dwordx4 v2, s[12:15], s40 offen sc1 lds
    s_mov_b32 m0, s19
    s_mov_b32 s39, s16
    s_mov_b32 s40, s17
    s_waitcnt vmcnt(9)
    s_barrier
    s_mov_b64 exec, 1
    buffer_atomic_add v13, v12, s[56:59], s51 offen sc1
    s_mov_b64 exec, -1
    buffer_load_dwordx4 v2, s[12:15], s39 offen sc1 lds
    s_add_u32 m0, m0, 1024
    s_nop 0
    buffer_load_dwordx4 v2, s[12:15], s40 offen sc1 lds
    s_call_b64 s[76:77], PREP_a_issue_4
    s_add_u32 m0, m0, 1024
    s_add_u32 s39, s39, 229376
    buffer_load_dwordx4 v2, s[12:15], s39 offen sc1 lds
    s_add_u32 m0, m0, 1024
    s_add_u32 s40, s40, 229376
    buffer_load_dwordx4 v2, s[12:15], s40 offen sc1 lds
    s_add_u32 m0, m0, 1024
    s_add_u32 s39, s39, 229376
    buffer_load_dwordx4 v2, s[12:15], s39 offen sc1 lds
    s_add_u32 m0, m0, 1024
    s_add_u32 s40, s40, 229376
    buffer_load_dwordx4 v2, s[12:15], s40 offen sc1 lds
    s_add_u32 m0, m0, 1024
    s_add_u32 s39, s39, 229376
    buffer_load_dwordx4 v2, s[12:15], s39 offen sc1 lds
    s_add_u32 m0, m0, 1024
    s_add_u32 s40, s40, 229376
    buffer_load_dwordx4 v2, s[12:15], s40 offen sc1 lds
    s_mov_b32 m0, s19
    s_mov_b32 s39, s16
    s_mov_b32 s40, s17
    s_waitcnt vmcnt(9)
    s_barrier
    buffer_load_dwordx4 v2, s[12:15], s39 offen sc1 lds
    s_add_u32 m0, m0, 1024
    s_nop 0
    buffer_load_dwordx4 v2, s[12:15], s40 offen sc1 lds
    s_waitcnt vmcnt(17)
    v_readfirstlane_b32 s53, v11
    s_add_u32 s54, s52, 8
    s_cmp_eq_u32 s53, s54
    s_cbranch_scc1 fok_59
    s_mov_b32 s53, 0
    s_add_u32 s54, s52, 8
    s_bfm_b64 exec, 1, 0
poll_60:
    buffer_load_dword v11, v10, s[56:59], 0 offen sc1
    s_waitcnt vmcnt(0)
    v_xor_b32 v11, s54, v11
    v_cmp_eq_u32 vcc, 0, v11
    s_nop 0
    s_cmp_eq_u64 vcc, exec
    s_cbranch_scc1 pok_61
    s_sleep 5
    s_add_u32 s53, s53, 1
    s_cmp_lt_u32 s53, s61
    s_cbranch_scc1 poll_60
    s_mov_b32 s61, 0
pok_61:
    s_mov_b64 exec, -1
fok_59:
    s_call_b64 s[76:77], PREP_a_issue_4
    s_add_u32 m0, m0, 1024
    s_add_u32 s39, s39, 229376
    buffer_load_dwordx4 v2, s[12:15], s39 offen sc1 lds
    s_add_u32 m0, m0, 1024
    s_add_u32 s40, s40, 229376
    buffer_load_dwordx4 v2, s[12:15], s40 offen sc1 lds
    s_add_u32 m0, m0, 1024
    s_add_u32 s39, s39, 229376
    buffer_load_dwordx4 v2, s[12:15], s39 offen sc1 lds
    s_add_u32 m0, m0, 1024
    s_add_u32 s40, s40, 229376
    buffer_load_dwordx4 v2, s[12:15], s40 offen sc1 lds
    s_add_u32 m0, m0, 1024
    s_add_u32 s39, s39, 229376
    buffer_load_dwordx4 v2, s[12:15], s39 offen sc1 lds
    s_add_u32 m0, m0, 1024
    s_add_u32 s40, s40, 229376
    buffer_load_dwordx4 v2, s[12:15], s40 offen sc1 lds
    s_mov_b32 m0, s19
    s_mov_b32 s39, s16
    s_mov_b32 s40, s17
    s_waitcnt vmcnt(8)
    s_barrier
    buffer_load_dwordx4 v2, s[12:15], s39 offen sc1 lds
    s_add_u32 m0, m0, 1024
    s_nop 0
    buffer_load_dwordx4 v2, s[12:15], s40 offen sc1 lds
    s_mov_b32 s43, 1
ld_62:
    s_add_u32 s19, s41, s42
    v_readlane_b32 s16, v249, s44
    v_readlane_b32 s17, v250, s44
    s_add_u32 s16, s16, s38
    s_add_u32 s17, s17, s38
    s_add_u32 s44, s44, 1
    s_add_u32 s42, s42, 16384
    s_cmp_eq_u32 s42, 49152
    s_cselect_b32 s42, 0, s42
    s_add_u32 m0, m0, 1024
    s_add_u32 s39, s39, 229376
    buffer_load_dwordx4 v2, s[12:15], s39 offen sc1 lds
    s_add_u32 m0, m0, 1024
    s_add_u32 s40, s40, 229376
    buffer_load_dwordx4 v2, s[12:15], s40 offen sc1 lds
    s_add_u32 m0, m0, 1024
    s_add_u32 s39, s39, 229376
    buffer_load_dwordx4 v2, s[12:15], s39 offen sc1 lds
    s_add_u32 m0, m0, 1024
    s_add_u32 s40, s40, 229376
    buffer_load_dwordx4 v2, s[12:15], s40 offen sc1 lds
    s_add_u32 m0, m0, 1024
    s_add_u32 s39, s39, 229376
    buffer_load_dwordx4 v2, s[12:15], s39 offen sc1 lds
    s_add_u32 m0, m0, 1024
    s_add_u32 s40, s40, 229376
    buffer_load_dwordx4 v2, s[12:15], s40 offen sc1 lds
    s_mov_b32 m0, s19
    s_mov_b32 s39, s16
    s_mov_b32 s40, s17
    s_waitcnt vmcnt(8)
    s_barrier
    buffer_load_dwordx4 v2, s[12:15], s39 offen sc1 lds
    s_add_u32 m0, m0, 1024
    s_nop 0
    buffer_load_dwordx4 v2, s[12:15], s40 offen sc1 lds
    s_add_u32 s43, s43, 1
    s_cmp_lt_u32 s43, 4
    s_cbranch_scc1 ld_62
    s_call_b64 s[76:77], PREP_a_issue_4
    s_add_u32 m0, m0, 1024
    s_add_u32 s39, s39, 229376
    buffer_load_dwordx4 v2, s[12:15], s39 offen sc1 lds
    s_add_u32 m0, m0, 1024
    s_add_u32 s40, s40, 229376
    buffer_load_dwordx4 v2, s[12:15], s40 offen sc1 lds
    s_add_u32 m0, m0, 1024
    s_add_u32 s39, s39, 229376
    buffer_load_dwordx4 v2, s[12:15], s39 offen sc1 lds
    s_add_u32 m0, m0, 1024
    s_add_u32 s40, s40, 229376
    buffer_load_dwordx4 v2, s[12:15], s40 offen sc1 lds
    s_add_u32 m0, m0, 1024
    s_add_u32 s39, s39, 229376
    buffer_load_dwordx4 v2, s[12:15], s39 offen sc1 lds
    s_add_u32 m0, m0, 1024
    s_add_u32 s40, s40, 229376
    buffer_load_dwordx4 v2, s[12:15], s40 offen sc1 lds
    s_mov_b32 m0, s19
    s_mov_b32 s39, s16
    s_mov_b32 s40, s17
    s_waitcnt vmcnt(8)
    s_barrier
    buffer_load_dwordx4 v2, s[12:15], s39 offen sc1 lds
    s_add_u32 m0, m0, 1024
    s_nop 0
    buffer_load_dwordx4 v2, s[12:15], s40 offen sc1 lds
    s_mov_b64 exec, 1
    buffer_load_dword v11, v12, s[56:59], 0 offen sc1
    s_mov_b64 exec, -1
    s_call_b64 s[76:77], PREP_a_issue_4
    s_add_u32 m0, m0, 1024
    s_add_u32 s39, s39, 229376
    buffer_load_dwordx4 v2, s[12:15], s39 offen sc1 lds
    s_add_u32 m0, m0, 1024
    s_add_u32 s40, s40, 229376
    buffer_load_dwordx4 v2, s[12:15], s40 offen sc1 lds
    s_add_u32 m0, m0, 1024
    s_add_u32 s39, s39, 229376
    buffer_load_dwordx4 v2, s[12:15], s39 offen sc1 lds
    s_add_u32 m0, m0, 1024
    s_add_u32 s40, s40, 229376
    buffer_load_dwordx4 v2, s[12:15], s40 offen sc1 lds
    s_add_u32 m0, m0, 1024
    s_add_u32 s39, s39, 229376
    buffer_load_dwordx4 v2, s[12:15], s39 offen sc1 lds
    s_add_u32 m0, m0, 1024
    s_add_u32 s40, s40, 229376
    buffer_load_dwordx4 v2, s[12:15], s40 offen sc1 lds
    s_mov_b32 m0, s19
    s_mov_b32 s39, s16
    s_mov_b32 s40, s17
    s_waitcnt vmcnt(9)
    s_barrier
    buffer_load_dwordx4 v2, s[12:15], s39 offen sc1 lds
    s_add_u32 m0, m0, 1024
    s_nop 0
    buffer_load_dwordx4 v2, s[12:15], s40 offen sc1 lds
    s_call_b64 s[76:77], PREP_a_issue_4
    s_add_u32 m0, m0, 1024
    s_add_u32 s39, s39, 229376
    buffer_load_dwordx4 v2, s[12:15], s39 offen sc1 lds
    s_add_u32 m0, m0, 1024
    s_add_u32 s40, s40, 229376
    buffer_load_dwordx4 v2, s[12:15], s40 offen sc1 lds
    s_add_u32 m0, m0, 1024
    s_add_u32 s39, s39, 229376
    buffer_load_dwordx4 v2, s[12:15], s39 offen sc1 lds
    s_add_u32 m0, m0, 1024
    s_add_u32 s40, s40, 229376
    buffer_load_dwordx4 v2, s[12:15], s40 offen sc1 lds
    s_add_u32 m0, m0, 1024
    s_add_u32 s39, s39, 229376
    buffer_load_dwordx4 v2, s[12:15], s39 offen sc1 lds
    s_add_u32 m0, m0, 1024
    s_add_u32 s40, s40, 229376
    buffer_load_dwordx4 v2, s[12:15], s40 offen sc1 lds
    s_mov_b32 m0, s19
    s_mov_b32 s39, s16
    s_mov_b32 s40, s17
    s_waitcnt vmcnt(8)
    s_barrier
    buffer_load_dwordx4 v2, s[12:15], s39 offen sc1 lds
    s_add_u32 m0, m0, 1024
    s_nop 0
    buffer_load_dwordx4 v2, s[12:15], s40 offen sc1 lds
    s_waitcnt vmcnt(16)
    v_readfirstlane_b32 s53, v11
    s_add_u32 s54, s52, 8
    s_cmp_eq_u32 s53, s54
    s_cbranch_scc1 fok_63
    s_mov_b32 s53, 0
    s_add_u32 s54, s52, 8
    s_bfm_b64 exec, 1, 0
poll_64:
    buffer_load_dword v11, v12, s[56:59], 0 offen sc1
    s_waitcnt vmcnt(0)
    v_xor_b32 v11, s54, v11
    v_cmp_eq_u32 vcc, 0, v11
    s_nop 0
    s_cmp_eq_u64 vcc, exec
    s_cbranch_scc1 pok_65
    s_sleep 5
    s_add_u32 s53, s53, 1
    s_cmp_lt_u32 s53, s61
    s_cbranch_scc1 poll_64
    s_mov_b32 s61, 0
pok_65:
    s_mov_b64 exec, -1
fok_63:
    s_call_b64 s[76:77], PREP_a_issue_4
    s_add_u32 m0, m0, 1024
    s_add_u32 s39, s39, 229376
    buffer_load_dwordx4 v2, s[12:15], s39 offen sc1 lds
    s_add_u32 m0, m0, 1024
    s_add_u32 s40, s40, 229376
    buffer_load_dwordx4 v2, s[12:15], s40 offen sc1 lds
    s_add_u32 m0, m0, 1024
    s_add_u32 s39, s39, 229376
    buffer_load_dwordx4 v2, s[12:15], s39 offen sc1 lds
    s_add_u32 m0, m0, 1024
    s_add_u32 s40, s40, 229376
    buffer_load_dwordx4 v2, s[12:15], s40 offen sc1 lds
    s_add_u32 m0, m0, 1024
    s_add_u32 s39, s39, 229376
    buffer_load_dwordx4 v2, s[12:15], s39 offen sc1 lds
    s_add_u32 m0, m0, 1024
    s_add_u32 s40, s40, 229376
    buffer_load_dwordx4 v2, s[12:15], s40 offen sc1 lds
    s_mov_b32 m0, s19
    s_mov_b32 s39, s16
    s_mov_b32 s40, s17
    s_waitcnt vmcnt(8)
    s_barrier
    buffer_load_dwordx4 v2, s[12:15], s39 offen sc1 lds
    s_add_u32 m0, m0, 1024
    s_nop 0
    buffer_load_dwordx4 v2, s[12:15], s40 offen sc1 lds
    s_mov_b32 s43, 1
ld_66:
    s_add_u32 s19, s41, s42
    v_readlane_b32 s16, v249, s44
    v_readlane_b32 s17, v250, s44
    s_add_u32 s16, s16, s38
    s_add_u32 s17, s17, s38
    s_add_u32 s44, s44, 1
    s_add_u32 s42, s42, 16384
    s_cmp_eq_u32 s42, 49152
    s_cselect_b32 s42, 0, s42
    s_add_u32 m0, m0, 1024
    s_add_u32 s39, s39, 229376
    buffer_load_dwordx4 v2, s[12:15], s39 offen sc1 lds
    s_add_u32 m0, m0, 1024
    s_add_u32 s40, s40, 229376
    buffer_load_dwordx4 v2, s[12:15], s40 offen sc1 lds
    s_add_u32 m0, m0, 1024
    s_add_u32 s39, s39, 229376
    buffer_load_dwordx4 v2, s[12:15], s39 offen sc1 lds
    s_add_u32 m0, m0, 1024
    s_add_u32 s40, s40, 229376
    buffer_load_dwordx4 v2, s[12:15], s40 offen sc1 lds
    s_add_u32 m0, m0, 1024
    s_add_u32 s39, s39, 229376
    buffer_load_dwordx4 v2, s[12:15], s39 offen sc1 lds
    s_add_u32 m0, m0, 1024
    s_add_u32 s40, s40, 229376
    buffer_load_dwordx4 v2, s[12:15], s40 offen sc1 lds
    s_mov_b32 m0, s19
    s_mov_b32 s39, s16
    s_mov_b32 s40, s17
    s_waitcnt vmcnt(8)
    s_barrier
    buffer_load_dwordx4 v2, s[12:15], s39 offen sc1 lds
    s_add_u32 m0, m0, 1024
    s_nop 0
    buffer_load_dwordx4 v2, s[12:15], s40 offen sc1 lds
    s_add_u32 s43, s43, 1
    s_cmp_lt_u32 s43, 5
    s_cbranch_scc1 ld_66
    s_call_b64 s[76:77], PREP_a_issue_4
    s_add_u32 m0, m0, 1024
    s_add_u32 s39, s39, 229376
    buffer_load_dwordx4 v2, s[12:15], s39 offen sc1 lds
    s_add_u32 m0, m0, 1024
    s_add_u32 s40, s40, 229376
    buffer_load_dwordx4 v2, s[12:15], s40 offen sc1 lds
    s_add_u32 m0, m0, 1024
    s_add_u32 s39, s39, 229376
    buffer_load_dwordx4 v2, s[12:15], s39 offen sc1 lds
    s_add_u32 m0, m0, 1024
    s_add_u32 s40, s40, 229376
    buffer_load_dwordx4 v2, s[12:15], s40 offen sc1 lds
    s_add_u32 m0, m0, 1024
    s_add_u32 s39, s39, 229376
    buffer_load_dwordx4 v2, s[12:15], s39 offen sc1 lds
    s_add_u32 m0, m0, 1024
    s_add_u32 s40, s40, 229376
    buffer_load_dwordx4 v2, s[12:15], s40 offen sc1 lds
    s_mov_b32 m0, s19
    s_mov_b32 s39, s16
    s_mov_b32 s40, s17
    s_waitcnt vmcnt(8)
    s_barrier
    buffer_load_dwordx4 v2, s[12:15], s39 offen sc1 lds
    s_add_u32 m0, m0, 1024
    s_nop 0
    buffer_load_dwordx4 v2, s[12:15], s40 offen sc1 lds
    s_mov_b64 exec, 1
    buffer_load_dword v11, v15, s[56:59], 0 offen sc1
    s_mov_b64 exec, -1
    s_call_b64 s[76:77], PREP_a_issue_4
    s_add_u32 m0, m0, 1024
    s_add_u32 s39, s39, 229376
    buffer_load_dwordx4 v2, s[12:15], s39 offen sc1 lds
    s_add_u32 m0, m0, 1024
    s_add_u32 s40, s40, 229376
    buffer_load_dwordx4 v2, s[12:15], s40 offen sc1 lds
    s_add_u32 m0, m0, 1024
    s_add_u32 s39, s39, 229376
    buffer_load_dwordx4 v2, s[12:15], s39 offen sc1 lds
    s_add_u32 m0, m0, 1024
    s_add_u32 s40, s40, 229376
    buffer_load_dwordx4 v2, s[12:15], s40 offen sc1 lds
    s_add_u32 m0, m0, 1024
    s_add_u32 s39, s39, 229376
    buffer_load_dwordx4 v2, s[12:15], s39 offen sc1 lds
    s_add_u32 m0, m0, 1024
    s_add_u32 s40, s40, 229376
    buffer_load_dwordx4 v2, s[12:15], s40 offen sc1 lds
    s_mov_b32 m0, s19
    s_mov_b32 s39, s16
    s_mov_b32 s40, s17
    s_waitcnt vmcnt(9)
    s_barrier
    buffer_load_dwordx4 v2, s[12:15], s39 offen sc1 lds
    s_add_u32 m0, m0, 1024
    s_nop 0
    buffer_load_dwordx4 v2, s[12:15], s40 offen sc1 lds
    s_call_b64 s[76:77], PREP_a_issue_4
    s_add_u32 m0, m0, 1024
    s_add_u32 s39, s39, 229376
    buffer_load_dwordx4 v2, s[12:15], s39 offen sc1 lds
    s_add_u32 m0, m0, 1024
    s_add_u32 s40, s40, 229376
    buffer_load_dwordx4 v2, s[12:15], s40 offen sc1 lds
    s_add_u32 m0, m0, 1024
    s_add_u32 s39, s39, 229376
    buffer_load_dwordx4 v2, s[12:15], s39 offen sc1 lds
    s_add_u32 m0, m0, 1024
    s_add_u32 s40, s40, 229376
    buffer_load_dwordx4 v2, s[12:15], s40 offen sc1 lds
    s_add_u32 m0, m0, 1024
    s_add_u32 s39, s39, 229376
    buffer_load_dwordx4 v2, s[12:15], s39 offen sc1 lds
    s_add_u32 m0, m0, 1024
    s_add_u32 s40, s40, 229376
    buffer_load_dwordx4 v2, s[12:15], s40 offen sc1 lds
    s_mov_b32 m0, s19
    s_mov_b32 s39, s16
    s_mov_b32 s40, s17
    s_waitcnt vmcnt(8)
    s_barrier
    buffer_load_dwordx4 v2, s[12:15], s39 offen sc1 lds
    s_add_u32 m0, m0, 1024
    s_nop 0
    buffer_load_dwordx4 v2, s[12:15], s40 offen sc1 lds
    s_waitcnt vmcnt(16)
    v_readfirstlane_b32 s53, v11
    s_add_u32 s54, s52, 8
    s_cmp_eq_u32 s53, s54
    s_cbranch_scc1 fok_67
    s_mov_b32 s53, 0
    s_add_u32 s54, s52, 8
    s_bfm_b64 exec, 1, 0
poll_68:
    buffer_load_dword v11, v15, s[56:59], 0 offen sc1
    s_waitcnt vmcnt(0)
    v_xor_b32 v11, s54, v11
    v_cmp_eq_u32 vcc, 0, v11
    s_nop 0
    s_cmp_eq_u64 vcc, exec
    s_cbranch_scc1 pok_69
    s_sleep 5
    s_add_u32 s53, s53, 1
    s_cmp_lt_u32 s53, s61
    s_cbranch_scc1 poll_68
    s_mov_b32 s61, 0
pok_69:
    s_mov_b64 exec, -1
fok_67:
    s_call_b64 s[76:77], PREP_a_issue_4
    s_add_u32 m0, m0, 1024
    s_add_u32 s39, s39, 229376
    buffer_load_dwordx4 v2, s[12:15], s39 offen sc1 lds
    s_add_u32 m0, m0, 1024
    s_add_u32 s40, s40, 229376
    buffer_load_dwordx4 v2, s[12:15], s40 offen sc1 lds
    s_add_u32 m0, m0, 1024
    s_add_u32 s39, s39, 229376
    buffer_load_dwordx4 v2, s[12:15], s39 offen sc1 lds
    s_add_u32 m0, m0, 1024
    s_add_u32 s40, s40, 229376
    buffer_load_dwordx4 v2, s[12:15], s40 offen sc1 lds
    s_add_u32 m0, m0, 1024
    s_add_u32 s39, s39, 229376
    buffer_load_dwordx4 v2, s[12:15], s39 offen sc1 lds
    s_add_u32 m0, m0, 1024
    s_add_u32 s40, s40, 229376
    buffer_load_dwordx4 v2, s[12:15], s40 offen sc1 lds
    s_mov_b32 m0, s19
    s_mov_b32 s39, s16
    s_mov_b32 s40, s17
    s_waitcnt vmcnt(8)
    s_barrier
    buffer_load_dwordx4 v2, s[12:15], s39 offen sc1 lds
    s_add_u32 m0, m0, 1024
    s_nop 0
    buffer_load_dwordx4 v2, s[12:15], s40 offen sc1 lds
    s_mov_b32 s43, 1
ld_70:
    s_add_u32 s19, s41, s42
    v_readlane_b32 s16, v249, s44
    v_readlane_b32 s17, v250, s44
    s_add_u32 s16, s16, s38
    s_add_u32 s17, s17, s38
    s_add_u32 s44, s44, 1
    s_add_u32 s42, s42, 16384
    s_cmp_eq_u32 s42, 49152
    s_cselect_b32 s42, 0, s42
    s_add_u32 m0, m0, 1024
    s_add_u32 s39, s39, 229376
    buffer_load_dwordx4 v2, s[12:15], s39 offen sc1 lds
    s_add_u32 m0, m0, 1024
    s_add_u32 s40, s40, 229376
    buffer_load_dwordx4 v2, s[12:15], s40 offen sc1 lds
    s_add_u32 m0, m0, 1024
    s_add_u32 s39, s39, 229376
    buffer_load_dwordx4 v2, s[12:15], s39 offen sc1 lds
    s_add_u32 m0, m0, 1024
    s_add_u32 s40, s40, 229376
    buffer_load_dwordx4 v2, s[12:15], s40 offen sc1 lds
    s_add_u32 m0, m0, 1024
    s_add_u32 s39, s39, 229376
    buffer_load_dwordx4 v2, s[12:15], s39 offen sc1 lds
    s_add_u32 m0, m0, 1024
    s_add_u32 s40, s40, 229376
    buffer_load_dwordx4 v2, s[12:15], s40 offen sc1 lds
    s_mov_b32 m0, s19
    s_mov_b32 s39, s16
    s_mov_b32 s40, s17
    s_waitcnt vmcnt(8)
    s_barrier
    buffer_load_dwordx4 v2, s[12:15], s39 offen sc1 lds
    s_add_u32 m0, m0, 1024
    s_nop 0
    buffer_load_dwordx4 v2, s[12:15], s40 offen sc1 lds
    s_add_u32 s43, s43, 1
    s_cmp_lt_u32 s43, 3
    s_cbranch_scc1 ld_70
    s_call_b64 s[76:77], PREP_a_issue_4
    s_add_u32 m0, m0, 1024
    s_add_u32 s39, s39, 229376
    buffer_load_dwordx4 v2, s[12:15], s39 offen sc1 lds
    s_add_u32 m0, m0, 1024
    s_add_u32 s40, s40, 229376
    buffer_load_dwordx4 v2, s[12:15], s40 offen sc1 lds
    s_add_u32 m0, m0, 1024
    s_add_u32 s39, s39, 229376
    buffer_load_dwordx4 v2, s[12:15], s39 offen sc1 lds
    s_add_u32 m0, m0, 1024
    s_add_u32 s40, s40, 229376
    buffer_load_dwordx4 v2, s[12:15], s40 offen sc1 lds
    s_add_u32 m0, m0, 1024
    s_add_u32 s39, s39, 229376
    buffer_load_dwordx4 v2, s[12:15], s39 offen sc1 lds
    s_add_u32 m0, m0, 1024
    s_add_u32 s40, s40, 229376
    buffer_load_dwordx4 v2, s[12:15], s40 offen sc1 lds
    s_mov_b32 m0, s19
    s_mov_b32 s39, s16
    s_mov_b32 s40, s17
    s_waitcnt vmcnt(8)
    s_barrier
    buffer_load_dwordx4 v2, s[12:15], s39 offen sc1 lds
    s_add_u32 m0, m0, 1024
    s_nop 0
    buffer_load_dwordx4 v2, s[12:15], s40 offen sc1 lds
    s_add_u32 m0, m0, 1024
    s_add_u32 s39, s39, 229376
    buffer_load_dwordx4 v2, s[12:15], s39 offen sc1 lds
    s_add_u32 m0, m0, 1024
    s_add_u32 s40, s40, 229376
    buffer_load_dwordx4 v2, s[12:15], s40 offen sc1 lds
    s_add_u32 m0, m0, 1024
    s_add_u32 s39, s39, 229376
    buffer_load_dwordx4 v2, s[12:15], s39 offen sc1 lds
    s_add_u32 m0, m0, 1024
    s_add_u32 s40, s40, 229376
    buffer_load_dwordx4 v2, s[12:15], s40 offen sc1 lds
    s_add_u32 m0, m0, 1024
    s_add_u32 s39, s39, 229376
    buffer_load_dwordx4 v2, s[12:15], s39 offen sc1 lds
    s_add_u32 m0, m0, 1024
    s_add_u32 s40, s40, 229376
    buffer_load_dwordx4 v2, s[12:15], s40 offen sc1 lds
    s_waitcnt vmcnt(8)
    s_barrier
    s_waitcnt vmcnt(0)
    s_barrier
    s_cmp_eq_u32 s60, 1
    s_cbranch_scc1 K_fin
    s_barrier
    s_branch NEXT
WLOAD:
    s_cmp_eq_u32 s60, 1
    s_cbranch_scc1 WL_1
    s_mov_b64 s[12:13], s[68:69]
    s_mov_b32 s14, 2097152
    s_mov_b32 s15, 0x20000
    s_and_b32 s35, s30, 1
    s_mul_i32 s38, s99, 128
    s_mul_i32 s41, s35, 65536
    s_add_u32 s38, s38, s41
    s_mul_i32 s41, s35, 4096
    s_add_u32 s41, s41, 24576
    s_mov_b32 s42, 0
    s_mov_b32 s44, s67
    s_branch WL_2
WL_1:
    s_mov_b64 s[12:13], s[68:69]
    s_mov_b32 s14, 2097152
    s_mov_b32 s15, 0x20000
    s_and_b32 s35, s30, 1
    s_mul_i32 s38, s99, 128
    s_mul_i32 s41, s35, 65536
    s_add_u32 s38, s38, s41
    s_mul_i32 s41, s35, 4096
    s_add_u32 s41, s41, 24576
    s_mov_b32 s42, 0
    s_mov_b32 s44, s67
WL_2:
    s_waitcnt vmcnt(0)
    s_barrier
    s_call_b64 s[76:77], SUB_after_g1
    s_barrier
    s_waitcnt vmcnt(0)
    s_barrier
    s_call_b64 s[76:77], SUB_after_g2
    s_mov_b64 s[12:13], s[72:73]
    s_mov_b32 s14, 7340032
    s_mov_b32 s15, 0x20000
    s_and_b32 s35, s30, 1
    s_mul_i32 s38, s29, 448
    s_mul_i32 s41, s35, 229376
    s_add_u32 s38, s38, s41
    s_mul_i32 s41, s35, 14336
    s_add_u32 s41, s41, 73728
    s_mov_b32 s42, 0
    s_mov_b32 s44, 0
    s_mov_b32 s42, 28672
    s_mov_b32 s44, 2
    s_add_u32 s19, s41, s42
    v_readlane_b32 s16, v248, s44
    s_nop 0
    s_add_u32 s16, s16, s38
    s_add_u32 s44, s44, 1
    s_and_b32 s44, s44, 15
    s_add_u32 s42, s42, 28672
    s_cmp_eq_u32 s42, 86016
    s_cselect_b32 s42, 0, s42
    s_mov_b32 m0, s19
    s_mov_b32 s39, s16
    s_waitcnt vmcnt(63)
    s_barrier
    buffer_load_dwordx4 v241, s[12:15], s39 offen lds
    s_add_u32 m0, m0, 1024
    s_nop 0
    buffer_load_dwordx4 v242, s[12:15], s39 offen lds
    s_add_u32 m0, m0, 1024
    s_nop 0
    buffer_load_dwordx4 v243, s[12:15], s39 offen lds
    s_mov_b32 s43, 1
ld_71:
    s_add_u32 s19, s41, s42
    v_readlane_b32 s16, v248, s44
    s_nop 0
    s_add_u32 s16, s16, s38
    s_add_u32 s44, s44, 1
    s_and_b32 s44, s44, 15
    s_add_u32 s42, s42, 28672
    s_cmp_eq_u32 s42, 86016
    s_cselect_b32 s42, 0, s42
    s_add_u32 m0, m0, 1024
    s_nop 0
    buffer_load_dwordx4 v244, s[12:15], s39 offen lds
    s_add_u32 m0, m0, 1024
    s_nop 0
    buffer_load_dwordx4 v245, s[12:15], s39 offen lds
    s_add_u32 m0, m0, 1024
    s_nop 0
    buffer_load_dwordx4 v246, s[12:15], s39 offen lds
    s_add_u32 m0, m0, 1024
    s_nop 0
    buffer_load_dwordx4 v247, s[12:15], s39 offen lds
    s_add_u32 m0, m0, 1024
    s_add_u32 s39, s39, 114688
    buffer_load_dwordx4 v241, s[12:15], s39 offen lds
    s_add_u32 m0, m0, 1024
    s_nop 0
    buffer_load_dwordx4 v242, s[12:15], s39 offen lds
    s_add_u32 m0, m0, 1024
    s_nop 0
    buffer_load_dwordx4 v243, s[12:15], s39 offen lds
    s_add_u32 m0, m0, 1024
    s_nop 0
    buffer_load_dwordx4 v244, s[12:15], s39 offen lds
    s_add_u32 m0, m0, 1024
    s_nop 0
    buffer_load_dwordx4 v245, s[12:15], s39 offen lds
    s_add_u32 m0, m0, 1024
    s_nop 0
    buffer_load_dwordx4 v246, s[12:15], s39 offen lds
    s_add_u32 m0, m0, 1024
    s_nop 0
    buffer_load_dwordx4 v247, s[12:15], s39 offen lds
    s_mov_b32 m0, s19
    s_mov_b32 s39, s16
    s_waitcnt vmcnt(14)
    s_barrier
    buffer_load_dwordx4 v241, s[12:15], s39 offen lds
    s_add_u32 m0, m0, 1024
    s_nop 0
    buffer_load_dwordx4 v242, s[12:15], s39 offen lds
    s_add_u32 m0, m0, 1024
    s_nop 0
    buffer_load_dwordx4 v243, s[12:15], s39 offen lds
    s_add_u32 s43, s43, 1
    s_cmp_lt_u32 s43, 13
    s_cbranch_scc1 ld_71
    s_add_u32 s19, s41, s42
    v_readlane_b32 s16, v248, s44
    s_nop 0
    s_add_u32 s16, s16, s38
    s_add_u32 s44, s44, 1
    s_and_b32 s44, s44, 15
    s_add_u32 s42, s42, 28672
    s_cmp_eq_u32 s42, 86016
    s_cselect_b32 s42, 0, s42
    s_add_u32 m0, m0, 1024
    s_nop 0
    buffer_load_dwordx4 v244, s[12:15], s39 offen lds
    s_add_u32 m0, m0, 1024
    s_nop 0
    buffer_load_dwordx4 v245, s[12:15], s39 offen lds
    s_add_u32 m0, m0, 1024
    s_nop 0
    buffer_load_dwordx4 v246, s[12:15], s39 offen lds
    s_add_u32 m0, m0, 1024
    s_nop 0
    buffer_load_dwordx4 v247, s[12:15], s39 offen lds
    s_add_u32 m0, m0, 1024
    s_add_u32 s39, s39, 114688
    buffer_load_dwordx4 v241, s[12:15], s39 offen lds
    s_add_u32 m0, m0, 1024
    s_nop 0
    buffer_load_dwordx4 v242, s[12:15], s39 offen lds
    s_add_u32 m0, m0, 1024
    s_nop 0
    buffer_load_dwordx4 v243, s[12:15], s39 offen lds
    s_add_u32 m0, m0, 1024
    s_nop 0
    buffer_load_dwordx4 v244, s[12:15], s39 offen lds
    s_add_u32 m0, m0, 1024
    s_nop 0
    buffer_load_dwordx4 v245, s[12:15], s39 offen lds
    s_add_u32 m0, m0, 1024
    s_nop 0
    buffer_load_dwordx4 v246, s[12:15], s39 offen lds
    s_add_u32 m0, m0, 1024
    s_nop 0
    buffer_load_dwordx4 v247, s[12:15], s39 offen lds
    s_mov_b32 m0, s19
    s_mov_b32 s39, s16
    s_waitcnt vmcnt(14)
    s_barrier
    buffer_load_dwordx4 v241, s[12:15], s39 offen lds
    s_add_u32 m0, m0, 1024
    s_nop 0
    buffer_load_dwordx4 v242, s[12:15], s39 offen lds
    s_add_u32 m0, m0, 1024
    s_nop 0
    buffer_load_dwordx4 v243, s[12:15], s39 offen lds
    s_add_u32 m0, m0, 1024
    s_nop 0
    buffer_load_dwordx4 v244, s[12:15], s39 offen lds
    s_add_u32 m0, m0, 1024
    s_nop 0
    buffer_load_dwordx4 v245, s[12:15], s39 offen lds
    s_add_u32 m0, m0, 1024
    s_nop 0
    buffer_load_dwordx4 v246, s[12:15], s39 offen lds
    s_add_u32 m0, m0, 1024
    s_nop 0
    buffer_load_dwordx4 v247, s[12:15], s39 offen lds
    s_add_u32 m0, m0, 1024
    s_add_u32 s39, s39, 114688
    buffer_load_dwordx4 v241, s[12:15], s39 offen lds
    s_add_u32 m0, m0, 1024
    s_nop 0
    buffer_load_dwordx4 v242, s[12:15], s39 offen lds
    s_add_u32 m0, m0, 1024
    s_nop 0
    buffer_load_dwordx4 v243, s[12:15], s39 offen lds
    s_add_u32 m0, m0, 1024
    s_nop 0
    buffer_load_dwordx4 v244, s[12:15], s39 offen lds
    s_add_u32 m0, m0, 1024
    s_nop 0
    buffer_load_dwordx4 v245, s[12:15], s39 offen lds
    s_add_u32 m0, m0, 1024
    s_nop 0
    buffer_load_dwordx4 v246, s[12:15], s39 offen lds
    s_add_u32 m0, m0, 1024
    s_nop 0
    buffer_load_dwordx4 v247, s[12:15], s39 offen lds
    s_waitcnt vmcnt(14)
    s_barrier
    s_call_b64 s[76:77], SUB_r_pre0
    s_waitcnt vmcnt(4)
    s_barrier
    s_barrier
    s_mov_b64 s[12:13], s[74:75]
    s_mov_b32 s14, 7340032
    s_mov_b32 s15, 0x20000
    s_and_b32 s35, s30, 1
    s_mul_i32 s38, s33, 256
    s_mul_i32 s41, s31, 3670016
    s_add_u32 s38, s38, s41
    s_mul_i32 s41, s35, 8192
    s_add_u32 s41, s41, 49152
    s_mov_b32 s42, 0
    s_mov_b32 s44, 0
    s_mov_b32 s49, s44
    s_and_b32 s43, s28, 3
    s_mul_i32 s43, s43, 6
    s_lshr_b32 s43, s43, 2
    s_mov_b32 s50, 0
wpre_72:
    s_mul_i32 s42, s43, 16384
    s_add_u32 s44, s49, s43
    s_mov_b32 s45, 8192
    s_add_u32 s19, s41, s42
    v_readlane_b32 s16, v249, s44
    s_nop 0
    s_bitcmp1_b32 s16, 0
    s_cselect_b32 s17, 16384, s45
    s_cselect_b32 s18, -40960, s45
    s_andn2_b32 s16, s16, 1
    s_add_u32 s16, s16, s38
    s_add_u32 s44, s44, 1
    s_add_u32 s42, s42, 16384
    s_cmp_eq_u32 s42, 98304
    s_cselect_b32 s42, 0, s42
    s_mov_b32 m0, s19
    s_mov_b32 s39, s16
    s_mov_b32 s32, s17
    s_mov_b32 s3, s18
    buffer_load_dwordx4 v239, s[12:15], s39 offen lds
    s_add_u32 m0, m0, 1024
    s_add_u32 s39, s39, s32
    buffer_load_dwordx4 v240, s[12:15], s39 offen lds
    s_add_u32 m0, m0, 1024
    s_add_u32 s39, s39, s32
    buffer_load_dwordx4 v239, s[12:15], s39 offen lds
    s_add_u32 m0, m0, 1024
    s_add_u32 s39, s39, s32
    buffer_load_dwordx4 v240, s[12:15], s39 offen lds
    s_waitcnt vmcnt(6)
    s_add_u32 m0, m0, 1024
    s_add_u32 s39, s39, s3
    buffer_load_dwordx4 v239, s[12:15], s39 offen lds
    s_add_u32 m0, m0, 1024
    s_add_u32 s39, s39, s32
    buffer_load_dwordx4 v240, s[12:15], s39 offen lds
    s_add_u32 m0, m0, 1024
    s_add_u32 s39, s39, s32
    buffer_load_dwordx4 v239, s[12:15], s39 offen lds
    s_add_u32 m0, m0, 1024
    s_add_u32 s39, s39, s32
    buffer_load_dwordx4 v240, s[12:15], s39 offen lds
    s_waitcnt vmcnt(6)
    s_add_u32 s43, s43, 1
    s_cmp_eq_u32 s43, 6
    s_cselect_b32 s43, 0, s43
    s_add_u32 s50, s50, 1
    s_cmp_lt_u32 s50, 6
    s_cbranch_scc1 wpre_72
    s_mov_b32 s42, 0
    s_add_u32 s44, s49, 6
    s_cmp_eq_u32 s60, 1
    s_cbranch_scc1 WL_t1
    s_call_b64 s[76:77], PREP_w_issue_4
    s_mov_b32 m0, s19
    s_mov_b32 s39, s16
    s_mov_b32 s32, s17
    s_mov_b32 s3, s18
    s_waitcnt vmcnt(0)
    s_barrier
    s_waitcnt vmcnt(0)
    s_barrier
    buffer_load_dwordx4 v239, s[12:15], s39 offen lds
    s_add_u32 m0, m0, 1024
    s_add_u32 s39, s39, s32
    buffer_load_dwordx4 v240, s[12:15], s39 offen lds
    s_call_b64 s[76:77], PREP_w_issue_4
    s_add_u32 m0, m0, 1024
    s_add_u32 s39, s39, s32
    buffer_load_dwordx4 v239, s[12:15], s39 offen lds
    s_add_u32 m0, m0, 1024
    s_add_u32 s39, s39, s32
    buffer_load_dwordx4 v240, s[12:15], s39 offen lds
    s_add_u32 m0, m0, 1024
    s_add_u32 s39, s39, s3
    buffer_load_dwordx4 v239, s[12:15], s39 offen lds
    s_add_u32 m0, m0, 1024
    s_add_u32 s39, s39, s32
    buffer_load_dwordx4 v240, s[12:15], s39 offen lds
    s_add_u32 m0, m0, 1024
    s_add_u32 s39, s39, s32
    buffer_load_dwordx4 v239, s[12:15], s39 offen lds
    s_add_u32 m0, m0, 1024
    s_add_u32 s39, s39, s32
    buffer_load_dwordx4 v240, s[12:15], s39 offen lds
    s_mov_b32 m0, s19
    s_mov_b32 s39, s16
    s_mov_b32 s32, s17
    s_mov_b32 s3, s18
    s_waitcnt vmcnt(8)
    s_barrier
    buffer_load_dwordx4 v239, s[12:15], s39 offen lds
    s_add_u32 m0, m0, 1024
    s_add_u32 s39, s39, s32
    buffer_load_dwordx4 v240, s[12:15], s39 offen lds
    s_call_b64 s[76:77], PREP_w_issue_4
    s_add_u32 m0, m0, 1024
    s_add_u32 s39, s39, s32
    buffer_load_dwordx4 v239, s[12:15], s39 offen lds
    s_add_u32 m0, m0, 1024
    s_add_u32 s39, s39, s32
    buffer_load_dwordx4 v240, s[12:15], s39 offen lds
    s_add_u32 m0, m0, 1024
    s_add_u32 s39, s39, s3
    buffer_load_dwordx4 v239, s[12:15], s39 offen lds
    s_add_u32 m0, m0, 1024
    s_add_u32 s39, s39, s32
    buffer_load_dwordx4 v240, s[12:15], s39 offen lds
    s_add_u32 m0, m0, 1024
    s_add_u32 s39, s39, s32
    buffer_load_dwordx4 v239, s[12:15], s39 offen lds
    s_add_u32 m0, m0, 1024
    s_add_u32 s39, s39, s32
    buffer_load_dwordx4 v240, s[12:15], s39 offen lds
    s_mov_b32 m0, s19
    s_mov_b32 s39, s16
    s_mov_b32 s32, s17
    s_mov_b32 s3, s18
    s_waitcnt vmcnt(16)
    s_barrier
    buffer_load_dwordx4 v239, s[12:15], s39 offen lds
    s_add_u32 m0, m0, 1024
    s_add_u32 s39, s39, s32
    buffer_load_dwordx4 v240, s[12:15], s39 offen lds
    s_call_b64 s[76:77], PREP_w_issue_4
    s_add_u32 m0, m0, 1024
    s_add_u32 s39, s39, s32
    buffer_load_dwordx4 v239, s[12:15], s39 offen lds
    s_add_u32 m0, m0, 1024
    s_add_u32 s39, s39, s32
    buffer_load_dwordx4 v240, s[12:15], s39 offen lds
    s_add_u32 m0, m0, 1024
    s_add_u32 s39, s39, s3
    buffer_load_dwordx4 v239, s[12:15], s39 offen lds
    s_add_u32 m0, m0, 1024
    s_add_u32 s39, s39, s32
    buffer_load_dwordx4 v240, s[12:15], s39 offen lds
    s_add_u32 m0, m0, 1024
    s_add_u32 s39, s39, s32
    buffer_load_dwordx4 v239, s[12:15], s39 offen lds
    s_add_u32 m0, m0, 1024
    s_add_u32 s39, s39, s32
    buffer_load_dwordx4 v240, s[12:15], s39 offen lds
    s_mov_b32 m0, s19
    s_mov_b32 s39, s16
    s_mov_b32 s32, s17
    s_mov_b32 s3, s18
    s_waitcnt vmcnt(24)
    s_barrier
    buffer_load_dwordx4 v239, s[12:15], s39 offen lds
    s_add_u32 m0, m0, 1024
    s_add_u32 s39, s39, s32
    buffer_load_dwordx4 v240, s[12:15], s39 offen lds
    s_mov_b32 s43, 1
ld_73:
    s_mov_b32 s45, 8192
    s_add_u32 s19, s41, s42
    v_readlane_b32 s16, v249, s44
    s_nop 0
    s_bitcmp1_b32 s16, 0
    s_cselect_b32 s17, 16384, s45
    s_cselect_b32 s18, -40960, s45
    s_andn2_b32 s16, s16, 1
    s_add_u32 s16, s16, s38
    s_add_u32 s44, s44, 1
    s_add_u32 s42, s42, 16384
    s_cmp_eq_u32 s42, 98304
    s_cselect_b32 s42, 0, s42
    s_add_u32 m0, m0, 1024
    s_add_u32 s39, s39, s32
    buffer_load_dwordx4 v239, s[12:15], s39 offen lds
    s_add_u32 m0, m0, 1024
    s_add_u32 s39, s39, s32
    buffer_load_dwordx4 v240, s[12:15], s39 offen lds
    s_add_u32 m0, m0, 1024
    s_add_u32 s39, s39, s3
    buffer_load_dwordx4 v239, s[12:15], s39 offen lds
    s_add_u32 m0, m0, 1024
    s_add_u32 s39, s39, s32
    buffer_load_dwordx4 v240, s[12:15], s39 offen lds
    s_add_u32 m0, m0, 1024
    s_add_u32 s39, s39, s32
    buffer_load_dwordx4 v239, s[12:15], s39 offen lds
    s_add_u32 m0, m0, 1024
    s_add_u32 s39, s39, s32
    buffer_load_dwordx4 v240, s[12:15], s39 offen lds
    s_mov_b32 m0, s19
    s_mov_b32 s39, s16
    s_mov_b32 s32, s17
    s_mov_b32 s3, s18
    s_waitcnt vmcnt(32)
    s_barrier
    buffer_load_dwordx4 v239, s[12:15], s39 offen lds
    s_add_u32 m0, m0, 1024
    s_add_u32 s39, s39, s32
    buffer_load_dwordx4 v240, s[12:15], s39 offen lds
    s_add_u32 s43, s43, 1
    s_cmp_lt_u32 s43, 18
    s_cbranch_scc1 ld_73
    s_call_b64 s[76:77], PREP_w_issue_4
    s_add_u32 m0, m0, 1024
    s_add_u32 s39, s39, s32
    buffer_load_dwordx4 v239, s[12:15], s39 offen lds
    s_add_u32 m0, m0, 1024
    s_add_u32 s39, s39, s32
    buffer_load_dwordx4 v240, s[12:15], s39 offen lds
    s_add_u32 m0, m0, 1024
    s_add_u32 s39, s39, s3
    buffer_load_dwordx4 v239, s[12:15], s39 offen lds
    s_add_u32 m0, m0, 1024
    s_add_u32 s39, s39, s32
    buffer_load_dwordx4 v240, s[12:15], s39 offen lds
    s_add_u32 m0, m0, 1024
    s_add_u32 s39, s39, s32
    buffer_load_dwordx4 v239, s[12:15], s39 offen lds
    s_add_u32 m0, m0, 1024
    s_add_u32 s39, s39, s32
    buffer_load_dwordx4 v240, s[12:15], s39 offen lds
    s_mov_b32 m0, s19
    s_mov_b32 s39, s16
    s_mov_b32 s32, s17
    s_mov_b32 s3, s18
    s_waitcnt vmcnt(32)
    s_barrier
    buffer_load_dwordx4 v239, s[12:15], s39 offen lds
    s_add_u32 m0, m0, 1024
    s_add_u32 s39, s39, s32
    buffer_load_dwordx4 v240, s[12:15], s39 offen lds
    s_add_u32 m0, m0, 1024
    s_add_u32 s39, s39, s32
    buffer_load_dwordx4 v239, s[12:15], s39 offen lds
    s_add_u32 m0, m0, 1024
    s_add_u32 s39, s39, s32
    buffer_load_dwordx4 v240, s[12:15], s39 offen lds
    s_add_u32 m0, m0, 1024
    s_add_u32 s39, s39, s3
    buffer_load_dwordx4 v239, s[12:15], s39 offen lds
    s_add_u32 m0, m0, 1024
    s_add_u32 s39, s39, s32
    buffer_load_dwordx4 v240, s[12:15], s39 offen lds
    s_add_u32 m0, m0, 1024
    s_add_u32 s39, s39, s32
    buffer_load_dwordx4 v239, s[12:15], s39 offen lds
    s_add_u32 m0, m0, 1024
    s_add_u32 s39, s39, s32
    buffer_load_dwordx4 v240, s[12:15], s39 offen lds
    s_waitcnt vmcnt(32)
    s_barrier
    s_mov_b64 s[12:13], s[68:69]
    s_mov_b32 s14, 2097152
    s_mov_b32 s15, 0x20000
    s_and_b32 s35, s30, 1
    s_mul_i32 s38, s99, 128
    s_mul_i32 s41, s35, 65536
    s_add_u32 s38, s38, s41
    s_mul_i32 s41, s35, 4096
    s_add_u32 s41, s41, 24576
    s_mov_b32 s42, 0
    s_mov_b32 s44, s67
    s_mov_b32 s42, 90112
    s_mov_b32 s44, s67
    s_add_u32 s44, s44, 11
    s_and_b32 s44, s44, 15
    s_call_b64 s[76:77], SUB_w_issue_1
    s_mov_b32 s42, 98304
    s_mov_b32 s44, s67
    s_add_u32 s44, s44, 12
    s_and_b32 s44, s44, 15
    s_call_b64 s[76:77], SUB_w_issue_1
    s_mov_b32 s42, 122880
    s_mov_b32 s44, s67
    s_add_u32 s44, s44, 15
    s_and_b32 s44, s44, 15
    s_call_b64 s[76:77], SUB_w_issue_1
    s_add_u32 s39, s38, 1179648
    buffer_load_dwordx4 v[16:19], v238, s[12:15], s39 offen
    s_add_u32 s39, s39, 16384
    buffer_load_dwordx4 v[20:23], v238, s[12:15], s39 offen
    s_add_u32 s39, s39, 16384
    buffer_load_dwordx4 v[24:27], v238, s[12:15], s39 offen
    s_add_u32 s39, s39, 16384
    buffer_load_dwordx4 v[28:31], v238, s[12:15], s39 offen
    s_add_u32 s39, s39, 16384
    s_waitcnt vmcnt(40)
    s_barrier
    s_mov_b32 s42, 106496
    s_mov_b32 s44, s67
    s_add_u32 s44, s44, 13
    s_and_b32 s44, s44, 15
    s_call_b64 s[76:77], SUB_w_issue_1
    s_mov_b32 s42, 114688
    s_mov_b32 s44, s67
    s_add_u32 s44, s44, 14
    s_and_b32 s44, s44, 15
    s_call_b64 s[76:77], SUB_w_issue_1
    s_add_u32 s39, s38, 1310720
    buffer_load_dwordx4 v[32:35], v238, s[12:15], s39 offen
    s_add_u32 s39, s39, 16384
    buffer_load_dwordx4 v[36:39], v238, s[12:15], s39 offen
    s_add_u32 s39, s39, 16384
    buffer_load_dwordx4 v[40:43], v238, s[12:15], s39 offen
    s_add_u32 s39, s39, 16384
    buffer_load_dwordx4 v[44:47], v238, s[12:15], s39 offen
    s_add_u32 s39, s39, 16384
    s_waitcnt vmcnt(44)
    s_barrier
    s_mov_b32 s42, 24576
    s_mov_b32 s44, s67
    s_add_u32 s44, s44, 3
    s_and_b32 s44, s44, 15
    s_call_b64 s[76:77], SUB_w_issue_1
    s_mov_b32 s42, 32768
    s_mov_b32 s44, s67
    s_add_u32 s44, s44, 4
    s_and_b32 s44, s44, 15
    s_call_b64 s[76:77], SUB_w_issue_1
    s_waitcnt vmcnt(44)
    s_barrier
    s_mov_b32 s42, 40960
    s_mov_b32 s44, s67
    s_add_u32 s44, s44, 5
    s_and_b32 s44, s44, 15
    s_call_b64 s[76:77], SUB_w_issue_1
    s_mov_b32 s42, 49152
    s_mov_b32 s44, s67
    s_add_u32 s44, s44, 6
    s_and_b32 s44, s44, 15
    s_call_b64 s[76:77], SUB_w_issue_1
    s_mov_b32 s42, 0
    s_mov_b32 s44, s67
    s_add_u32 s44, s44, 0
    s_and_b32 s44, s44, 15
    s_call_b64 s[76:77], SUB_w_issue_1
    s_waitcnt vmcnt(48)
    s_barrier
    s_mov_b32 s42, 57344
    s_mov_b32 s44, s67
    s_add_u32 s44, s44, 7
    s_and_b32 s44, s44, 15
    s_call_b64 s[76:77], SUB_w_issue_1
    s_mov_b32 s42, 65536
    s_mov_b32 s44, s67
    s_add_u32 s44, s44, 8
    s_and_b32 s44, s44, 15
    s_call_b64 s[76:77], SUB_w_issue_1
    s_mov_b32 s42, 8192
    s_mov_b32 s44, s67
    s_add_u32 s44, s44, 1
    s_and_b32 s44, s44, 15
    s_call_b64 s[76:77], SUB_w_issue_1
    s_mov_b32 s42, 16384
    s_mov_b32 s44, s67
    s_add_u32 s44, s44, 2
    s_and_b32 s44, s44, 15
    s_call_b64 s[76:77], SUB_w_issue_1
    s_barrier
    s_add_u32 s36, s41, 73728
    v_add_u32 v6, s36, v2
    s_waitcnt vmcnt(0)
    ds_write_b128 v6, v[16:19] offset:0
    ds_write_b128 v6, v[20:23] offset:1024
    ds_write_b128 v6, v[24:27] offset:2048
    ds_write_b128 v6, v[28:31] offset:3072
    ds_write_b128 v6, v[32:35] offset:8192
    ds_write_b128 v6, v[36:39] offset:9216
    ds_write_b128 v6, v[40:43] offset:10240
    ds_write_b128 v6, v[44:47] offset:11264
    s_waitcnt lgkmcnt(0)
    s_branch NEXT
WL_t1:
    s_call_b64 s[76:77], PREP_w_issue_4
    s_mov_b32 m0, s19
    s_mov_b32 s39, s16
    s_mov_b32 s32, s17
    s_mov_b32 s3, s18
    s_waitcnt vmcnt(0)
    s_barrier
    s_waitcnt vmcnt(0)
    s_barrier
    s_waitcnt vmcnt(0)
    s_barrier
    s_waitcnt vmcnt(0)
    s_barrier
    s_waitcnt vmcnt(0)
    s_barrier
    buffer_load_dwordx4 v239, s[12:15], s39 offen lds
    s_add_u32 m0, m0, 1024
    s_add_u32 s39, s39, s32
    buffer_load_dwordx4 v240, s[12:15], s39 offen lds
    s_mov_b32 s43, 1
ld_74:
    s_mov_b32 s45, 8192
    s_add_u32 s19, s41, s42
    v_readlane_b32 s16, v249, s44
    s_nop 0
    s_bitcmp1_b32 s16, 0
    s_cselect_b32 s17, 16384, s45
    s_cselect_b32 s18, -40960, s45
    s_andn2_b32 s16, s16, 1
    s_add_u32 s16, s16, s38
    s_add_u32 s44, s44, 1
    s_add_u32 s42, s42, 16384
    s_cmp_eq_u32 s42, 98304
    s_cselect_b32 s42, 0, s42
    s_add_u32 m0, m0, 1024
    s_add_u32 s39, s39, s32
    buffer_load_dwordx4 v239, s[12:15], s39 offen lds
    s_add_u32 m0, m0, 1024
    s_add_u32 s39, s39, s32
    buffer_load_dwordx4 v240, s[12:15], s39 offen lds
    s_add_u32 m0, m0, 1024
    s_add_u32 s39, s39, s3
    buffer_load_dwordx4 v239, s[12:15], s39 offen lds
    s_add_u32 m0, m0, 1024
    s_add_u32 s39, s39, s32
    buffer_load_dwordx4 v240, s[12:15], s39 offen lds
    s_add_u32 m0, m0, 1024
    s_add_u32 s39, s39, s32
    buffer_load_dwordx4 v239, s[12:15], s39 offen lds
    s_add_u32 m0, m0, 1024
    s_add_u32 s39, s39, s32
    buffer_load_dwordx4 v240, s[12:15], s39 offen lds
    s_mov_b32 m0, s19
    s_mov_b32 s39, s16
    s_mov_b32 s32, s17
    s_mov_b32 s3, s18
    s_waitcnt vmcnt(8)
    s_barrier
    buffer_load_dwordx4 v239, s[12:15], s39 offen lds
    s_add_u32 m0, m0, 1024
    s_add_u32 s39, s39, s32
    buffer_load_dwordx4 v240, s[12:15], s39 offen lds
    s_add_u32 s43, s43, 1
    s_cmp_lt_u32 s43, 21
    s_cbranch_scc1 ld_74
    s_call_b64 s[76:77], PREP_w_issue_4
    s_add_u32 m0, m0, 1024
    s_add_u32 s39, s39, s32
    buffer_load_dwordx4 v239, s[12:15], s39 offen lds
    s_add_u32 m0, m0, 1024
    s_add_u32 s39, s39, s32
    buffer_load_dwordx4 v240, s[12:15], s39 offen lds
    s_add_u32 m0, m0, 1024
    s_add_u32 s39, s39, s3
    buffer_load_dwordx4 v239, s[12:15], s39 offen lds
    s_add_u32 m0, m0, 1024
    s_add_u32 s39, s39, s32
    buffer_load_dwordx4 v240, s[12:15], s39 offen lds
    s_add_u32 m0, m0, 1024
    s_add_u32 s39, s39, s32
    buffer_load_dwordx4 v239, s[12:15], s39 offen lds
    s_add_u32 m0, m0, 1024
    s_add_u32 s39, s39, s32
    buffer_load_dwordx4 v240, s[12:15], s39 offen lds
    s_mov_b32 m0, s19
    s_mov_b32 s39, s16
    s_mov_b32 s32, s17
    s_mov_b32 s3, s18
    s_waitcnt vmcnt(8)
    s_barrier
    buffer_load_dwordx4 v239, s[12:15], s39 offen lds
    s_add_u32 m0, m0, 1024
    s_add_u32 s39, s39, s32
    buffer_load_dwordx4 v240, s[12:15], s39 offen lds
    s_add_u32 m0, m0, 1024
    s_add_u32 s39, s39, s32
    buffer_load_dwordx4 v239, s[12:15], s39 offen lds
    s_add_u32 m0, m0, 1024
    s_add_u32 s39, s39, s32
    buffer_load_dwordx4 v240, s[12:15], s39 offen lds
    s_add_u32 m0, m0, 1024
    s_add_u32 s39, s39, s3
    buffer_load_dwordx4 v239, s[12:15], s39 offen lds
    s_add_u32 m0, m0, 1024
    s_add_u32 s39, s39, s32
    buffer_load_dwordx4 v240, s[12:15], s39 offen lds
    s_add_u32 m0, m0, 1024
    s_add_u32 s39, s39, s32
    buffer_load_dwordx4 v239, s[12:15], s39 offen lds
    s_add_u32 m0, m0, 1024
    s_add_u32 s39, s39, s32
    buffer_load_dwordx4 v240, s[12:15], s39 offen lds
    s_waitcnt vmcnt(8)
    s_barrier
    s_waitcnt vmcnt(0)
    s_barrier
    s_branch K_fin
NEXT:
    s_setprio 0
    s_add_u32 s60, s60, 1
    s_add_u32 s55, s55, 4194304
    s_add_u32 s62, s62, 4194304
    s_addc_u32 s63, s63, 0
    s_branch LAYER
K_fin:
    s_endpgm
SUB_w1_regs:
    s_mov_b64 s[12:13], s[68:69]
    s_mov_b32 s14, 2097152
    s_mov_b32 s15, 0x20000
    s_and_b32 s35, s30, 3
    s_mul_i32 s35, s35, 294912
    s_lshl_b32 s39, s99, 7
    s_add_u32 s39, s39, s35
    buffer_load_dwordx4 v[176:179], v238, s[12:15], s39 offen
    s_add_u32 s39, s39, 16384
    buffer_load_dwordx4 v[188:191], v238, s[12:15], s39 offen
    s_add_u32 s39, s39, 16384
    buffer_load_dwordx4 v[192:195], v238, s[12:15], s39 offen
    s_add_u32 s39, s39, 16384
    buffer_load_dwordx4 v[200:203], v238, s[12:15], s39 offen
    s_add_u32 s39, s39, 16384
    s_waitcnt vmcnt(8)
    buffer_load_dwordx4 v[204:207], v238, s[12:15], s39 offen
    s_add_u32 s39, s39, 16384
    buffer_load_dwordx4 v[208:211], v238, s[12:15], s39 offen
    s_add_u32 s39, s39, 16384
    buffer_load_dwordx4 v[212:215], v238, s[12:15], s39 offen
    s_add_u32 s39, s39, 16384
    buffer_load_dwordx4 v[216:219], v238, s[12:15], s39 offen
    s_add_u32 s39, s39, 16384
    s_waitcnt vmcnt(8)
    buffer_load_dwordx4 v[220:223], v238, s[12:15], s39 offen
    s_add_u32 s39, s39, 16384
    buffer_load_dwordx4 v[224:227], v238, s[12:15], s39 offen
    s_add_u32 s39, s39, 16384
    buffer_load_dwordx4 v[16:19], v238, s[12:15], s39 offen
    s_add_u32 s39, s39, 16384
    buffer_load_dwordx4 v[20:23], v238, s[12:15], s39 offen
    s_add_u32 s39, s39, 16384
    s_waitcnt vmcnt(8)
    buffer_load_dwordx4 v[24:27], v238, s[12:15], s39 offen
    s_add_u32 s39, s39, 16384
    buffer_load_dwordx4 v[28:31], v238, s[12:15], s39 offen
    s_add_u32 s39, s39, 16384
    buffer_load_dwordx4 v[32:35], v238, s[12:15], s39 offen
    s_add_u32 s39, s39, 16384
    buffer_load_dwordx4 v[36:39], v238, s[12:15], s39 offen
    s_add_u32 s39, s39, 16384
    s_waitcnt vmcnt(8)
    buffer_load_dwordx4 v[40:43], v238, s[12:15], s39 offen
    s_add_u32 s39, s39, 16384
    buffer_load_dwordx4 v[44:47], v238, s[12:15], s39 offen
    s_add_u32 s39, s39, 16384
    s_setpc_b64 s[76:77]
SUB_park:
    s_mov_b64 s[12:13], s[70:71]
    s_mov_b32 s14, 2097152
    s_mov_b32 s15, 0x20000
    s_and_b32 s35, s30, 3
    s_lshl_b32 s35, s35, 19
    s_lshl_b32 s39, s29, 7
    s_add_u32 s39, s39, s35
    buffer_load_dwordx4 v[48:51], v238, s[12:15], s39 offen
    s_add_u32 s39, s39, 16384
    buffer_load_dwordx4 v[52:55], v238, s[12:15], s39 offen
    s_add_u32 s39, s39, 16384
    buffer_load_dwordx4 v[56:59], v238, s[12:15], s39 offen
    s_add_u32 s39, s39, 16384
    buffer_load_dwordx4 v[60:63], v238, s[12:15], s39 offen
    s_add_u32 s39, s39, 16384
    s_waitcnt vmcnt(8)
    buffer_load_dwordx4 v[64:67], v238, s[12:15], s39 offen
    s_add_u32 s39, s39, 16384
    buffer_load_dwordx4 v[68:71], v238, s[12:15], s39 offen
    s_add_u32 s39, s39, 16384
    buffer_load_dwordx4 v[72:75], v238, s[12:15], s39 offen
    s_add_u32 s39, s39, 16384
    buffer_load_dwordx4 v[76:79], v238, s[12:15], s39 offen
    s_add_u32 s39, s39, 16384
    s_waitcnt vmcnt(8)
    buffer_load_dwordx4 v[80:83], v238, s[12:15], s39 offen
    s_add_u32 s39, s39, 16384
    buffer_load_dwordx4 v[84:87], v238, s[12:15], s39 offen
    s_add_u32 s39, s39, 16384
    buffer_load_dwordx4 v[88:91], v238, s[12:15], s39 offen
    s_add_u32 s39, s39, 16384
    buffer_load_dwordx4 v[92:95], v238, s[12:15], s39 offen
    s_add_u32 s39, s39, 16384
    s_waitcnt vmcnt(8)
    buffer_load_dwordx4 v[96:99], v238, s[12:15], s39 offen
    s_add_u32 s39, s39, 16384
    buffer_load_dwordx4 v[100:103], v238, s[12:15], s39 offen
    s_add_u32 s39, s39, 16384
    buffer_load_dwordx4 v[104:107], v238, s[12:15], s39 offen
    s_add_u32 s39, s39, 16384
    buffer_load_dwordx4 v[108:111], v238, s[12:15], s39 offen
    s_add_u32 s39, s39, 16384
    s_waitcnt vmcnt(8)
    buffer_load_dwordx4 v[112:115], v238, s[12:15], s39 offen
    s_add_u32 s39, s39, 16384
    buffer_load_dwordx4 v[116:119], v238, s[12:15], s39 offen
    s_add_u32 s39, s39, 16384
    buffer_load_dwordx4 v[120:123], v238, s[12:15], s39 offen
    s_add_u32 s39, s39, 16384
    buffer_load_dwordx4 v[124:127], v238, s[12:15], s39 offen
    s_add_u32 s39, s39, 16384
    s_waitcnt vmcnt(8)
    buffer_load_dwordx4 v[128:131], v238, s[12:15], s39 offen
    s_add_u32 s39, s39, 16384
    buffer_load_dwordx4 v[132:135], v238, s[12:15], s39 offen
    s_add_u32 s39, s39, 16384
    buffer_load_dwordx4 v[136:139], v238, s[12:15], s39 offen
    s_add_u32 s39, s39, 16384
    buffer_load_dwordx4 v[140:143], v238, s[12:15], s39 offen
    s_add_u32 s39, s39, 16384
    s_waitcnt vmcnt(8)
    buffer_load_dwordx4 v[144:147], v238, s[12:15], s39 offen
    s_add_u32 s39, s39, 16384
    buffer_load_dwordx4 v[148:151], v238, s[12:15], s39 offen
    s_add_u32 s39, s39, 16384
    buffer_load_dwordx4 v[152:155], v238, s[12:15], s39 offen
    s_add_u32 s39, s39, 16384
    buffer_load_dwordx4 v[156:159], v238, s[12:15], s39 offen
    s_add_u32 s39, s39, 16384
    s_waitcnt vmcnt(8)
    buffer_load_dwordx4 v[160:163], v238, s[12:15], s39 offen
    s_add_u32 s39, s39, 16384
    buffer_load_dwordx4 v[164:167], v238, s[12:15], s39 offen
    s_add_u32 s39, s39, 16384
    buffer_load_dwordx4 v[168:171], v238, s[12:15], s39 offen
    s_add_u32 s39, s39, 16384
    buffer_load_dwordx4 v[172:175], v238, s[12:15], s39 offen
    s_add_u32 s39, s39, 16384
    s_waitcnt vmcnt(8)
    s_setpc_b64 s[76:77]
SUB_w1_put:
    s_and_b32 s35, s30, 3
    s_mul_i32 s35, s35, 18432
    v_add_u32 v8, s35, v2
    v_mov_b32 v6, 162836
spin_75:
    s_sleep 2
    ds_read_b32 v7, v6
    s_waitcnt lgkmcnt(0)
    v_readfirstlane_b32 s53, v7
    s_nop 0
    s_cmp_ge_u32 s53, 8
    s_cbranch_scc0 spin_75
    s_waitcnt vmcnt(32)
    ds_write_b128 v8, v[176:179] offset:24576
    ds_write_b128 v8, v[188:191] offset:25600
    ds_write_b128 v8, v[192:195] offset:26624
    ds_write_b128 v8, v[200:203] offset:27648
    ds_write_b128 v8, v[204:207] offset:28672
    ds_write_b128 v8, v[208:211] offset:29696
    ds_write_b128 v8, v[212:215] offset:30720
    ds_write_b128 v8, v[216:219] offset:31744
    ds_write_b128 v8, v[220:223] offset:32768
    ds_write_b128 v8, v[224:227] offset:33792
    ds_write_b128 v8, v[16:19] offset:34816
    ds_write_b128 v8, v[20:23] offset:35840
    ds_write_b128 v8, v[24:27] offset:36864
    ds_write_b128 v8, v[28:31] offset:37888
    ds_write_b128 v8, v[32:35] offset:38912
    ds_write_b128 v8, v[36:39] offset:39936
    ds_write_b128 v8, v[40:43] offset:40960
    ds_write_b128 v8, v[44:47] offset:41984
    s_waitcnt lgkmcnt(0)
    s_setpc_b64 s[76:77]
SUB_after_g1:
    s_mov_b64 s[12:13], s[72:73]
    s_mov_b32 s14, 7340032
    s_mov_b32 s15, 0x20000
    v_readlane_b32 s36, v251, 0
    v_readlane_b32 s37, v251, 1
    v_readlane_b32 s34, v251, 2
    s_and_b32 s35, s30, 3
    s_mul_i32 s38, s35, 114688
    s_mul_i32 s39, s29, 448
    s_add_u32 s38, s38, s39
    s_and_b32 s36, s36, 15
    s_mul_i32 s36, s36, 458752
    s_add_u32 s36, s36, s38
    s_and_b32 s37, s37, 15
    s_mul_i32 s37, s37, 458752
    s_add_u32 s37, s37, s38
    s_and_b32 s34, s34, 15
    s_mul_i32 s34, s34, 458752
    s_add_u32 s34, s34, s38
    s_mul_i32 s39, s35, 7168
    s_add_u32 m0, s39, 131072
    s_nop 0
    buffer_load_dwordx4 v241, s[12:15], s36 offen lds
    s_add_u32 m0, m0, 1024
    s_nop 0
    buffer_load_dwordx4 v242, s[12:15], s36 offen lds
    s_add_u32 m0, m0, 1024
    s_nop 0
    buffer_load_dwordx4 v243, s[12:15], s36 offen lds
    s_add_u32 m0, m0, 1024
    s_nop 0
    buffer_load_dwordx4 v244, s[12:15], s36 offen lds
    s_add_u32 m0, m0, 1024
    s_nop 0
    buffer_load_dwordx4 v245, s[12:15], s36 offen lds
    s_add_u32 m0, m0, 1024
    s_nop 0
    buffer_load_dwordx4 v246, s[12:15], s36 offen lds
    s_add_u32 m0, m0, 1024
    s_nop 0
    buffer_load_dwordx4 v247, s[12:15], s36 offen lds
    buffer_load_dwordx4 v[176:179], v241, s[12:15], s37 offen
    buffer_load_dwordx4 v[180:183], v242, s[12:15], s37 offen
    buffer_load_dwordx4 v[184:187], v243, s[12:15], s37 offen
    buffer_load_dwordx4 v[188:191], v244, s[12:15], s37 offen
    buffer_load_dwordx4 v[192:195], v245, s[12:15], s37 offen
    buffer_load_dwordx4 v[196:199], v246, s[12:15], s37 offen
    buffer_load_dwordx4 v[200:203], v247, s[12:15], s37 offen
    s_lshr_b32 s36, s67, 2
    s_sub_u32 s36, s35, s36
    s_and_b32 s36, s36, 3
    s_lshl_b32 s36, s36, 15
    v_add_u32 v6, s36, v2
    s_waitcnt vmcnt(14)
    ds_write_b128 v6, v[48:51] offset:0
    ds_write_b128 v6, v[52:55] offset:1024
    ds_write_b128 v6, v[56:59] offset:2048
    ds_write_b128 v6, v[60:63] offset:3072
    ds_write_b128 v6, v[64:67] offset:4096
    ds_write_b128 v6, v[68:71] offset:5120
    ds_write_b128 v6, v[72:75] offset:6144
    ds_write_b128 v6, v[76:79] offset:7168
    ds_write_b128 v6, v[80:83] offset:8192
    ds_write_b128 v6, v[84:87] offset:9216
    ds_write_b128 v6, v[88:91] offset:10240
    ds_write_b128 v6, v[92:95] offset:11264
    ds_write_b128 v6, v[96:99] offset:12288
    ds_write_b128 v6, v[100:103] offset:13312
    ds_write_b128 v6, v[104:107] offset:14336
    ds_write_b128 v6, v[108:111] offset:15360
    ds_write_b128 v6, v[112:115] offset:16384
    ds_write_b128 v6, v[116:119] offset:17408
    ds_write_b128 v6, v[120:123] offset:18432
    ds_write_b128 v6, v[124:127] offset:19456
    ds_write_b128 v6, v[128:131] offset:20480
    ds_write_b128 v6, v[132:135] offset:21504
    ds_write_b128 v6, v[136:139] offset:22528
    ds_write_b128 v6, v[140:143] offset:23552
    ds_write_b128 v6, v[144:147] offset:24576
    ds_write_b128 v6, v[148:151] offset:25600
    ds_write_b128 v6, v[152:155] offset:26624
    ds_write_b128 v6, v[156:159] offset:27648
    ds_write_b128 v6, v[160:163] offset:28672
    ds_write_b128 v6, v[164:167] offset:29696
    ds_write_b128 v6, v[168:171] offset:30720
    ds_write_b128 v6, v[172:175] offset:31744
    s_waitcnt lgkmcnt(0)
    s_setpc_b64 s[76:77]
SUB_after_g2:
    s_and_b32 s35, s30, 3
    s_mul_i32 s39, s35, 7168
    s_add_u32 s39, s39, 73728
    v_add_u32 v7, s39, v2
    ds_write_b128 v7, v[176:179] offset:0
    ds_write_b128 v7, v[180:183] offset:1024
    ds_write_b128 v7, v[184:187] offset:2048
    ds_write_b128 v7, v[188:191] offset:3072
    ds_write_b128 v7, v[192:195] offset:4096
    ds_write_b128 v7, v[196:199] offset:5120
    ds_write_b128 v7, v[200:203] offset:6144
    s_waitcnt lgkmcnt(0)
    s_setpc_b64 s[76:77]
SUB_r_pre:
    v_and_b32 v199, 7, v0
    v_lshrrev_b32 v228, 6, v0
    v_lshlrev_b32 v228, 4, v228
    v_bfe_u32 v229, v0, 3, 3
    v_add_u32 v228, v228, v229
    s_lshr_b32 s78, s29, 1
    s_lshl_b32 s78, s78, 16
    s_and_b32 s79, s29, 1
    s_lshl_b32 s79, s79, 7
    s_add_u32 s78, s78, s79
    s_lshr_b32 s79, s30, 1
    s_lshl_b32 s79, s79, 13
    s_add_u32 s78, s78, s79
    v_lshlrev_b32 v196, 8, v228
    v_lshl_add_u32 v196, v199, 4, v196
    v_add_u32 v196, s78, v196
    s_mov_b32 s84, s62
    s_mov_b32 s85, s63
    s_mov_b32 s86, 0x7e000
    s_mov_b32 s87, 0x20000
    s_add_u32 s88, s62, 0x80000
    s_addc_u32 s89, s63, 0
    s_mov_b32 s90, 0x7e000
    s_mov_b32 s91, 0x20000
    buffer_load_dwordx4 v[180:183], v196, s[84:87], 0 offen offset:0 sc1
    buffer_load_dwordx4 v[188:191], v196, s[88:91], 0 offen offset:0 sc1
    buffer_load_dwordx4 v[184:187], v196, s[84:87], 0 offen offset:2048 sc1
    buffer_load_dwordx4 v[192:195], v196, s[88:91], 0 offen offset:2048 sc1
    s_setpc_b64 s[76:77]
SUB_r_pre0:
    v_and_b32 v199, 7, v0
    v_lshrrev_b32 v228, 6, v0
    v_lshlrev_b32 v228, 4, v228
    v_bfe_u32 v229, v0, 3, 3
    v_add_u32 v228, v228, v229
    s_lshr_b32 s78, s29, 1
    s_lshl_b32 s78, s78, 16
    s_and_b32 s79, s29, 1
    s_lshl_b32 s79, s79, 7
    s_add_u32 s78, s78, s79
    s_lshr_b32 s79, s30, 1
    s_lshl_b32 s79, s79, 13
    s_add_u32 s78, s78, s79
    v_lshlrev_b32 v196, 8, v228
    v_lshl_add_u32 v196, v199, 4, v196
    v_add_u32 v196, s78, v196
    s_mov_b32 s84, s62
    s_mov_b32 s85, s63
    s_mov_b32 s86, 0x7e000
    s_mov_b32 s87, 0x20000
    s_add_u32 s88, s62, 0x80000
    s_addc_u32 s89, s63, 0
    s_mov_b32 s90, 0x7e000
    s_mov_b32 s91, 0x20000
    s_cmp_eq_u32 s60, 0
    s_cselect_b64 exec, -1, 0
    buffer_load_dwordx4 v[180:183], v196, s[84:87], 0 offen offset:0 sc1
    buffer_load_dwordx4 v[188:191], v196, s[88:91], 0 offen offset:0 sc1
    buffer_load_dwordx4 v[184:187], v196, s[84:87], 0 offen offset:2048 sc1
    buffer_load_dwordx4 v[192:195], v196, s[88:91], 0 offen offset:2048 sc1
    s_mov_b64 exec, -1
    s_setpc_b64 s[76:77]
SUB_w_issue_1:
    s_add_u32 s19, s41, s42
    s_mul_i32 s16, s44, 131072
    s_add_u32 s16, s16, s38
    s_add_u32 s44, s44, 1
    s_and_b32 s44, s44, 15
    s_add_u32 s42, s42, 8192
    s_cmp_eq_u32 s42, 131072
    s_cselect_b32 s42, 0, s42
    s_mov_b32 m0, s19
    s_mov_b32 s39, s16
    buffer_load_dwordx4 v238, s[12:15], s39 offen lds
    s_add_u32 m0, m0, 1024
    s_add_u32 s39, s39, 16384
    buffer_load_dwordx4 v238, s[12:15], s39 offen lds
    s_add_u32 m0, m0, 1024
    s_add_u32 s39, s39, 16384
    buffer_load_dwordx4 v238, s[12:15], s39 offen lds
    s_add_u32 m0, m0, 1024
    s_add_u32 s39, s39, 16384
    buffer_load_dwordx4 v238, s[12:15], s39 offen lds
    s_setpc_b64 s[76:77]
PREP_a_issue_4:
    s_add_u32 s19, s41, s42
    v_readlane_b32 s16, v249, s44
    v_readlane_b32 s17, v250, s44
    s_add_u32 s16, s16, s38
    s_add_u32 s17, s17, s38
    s_add_u32 s44, s44, 1
    s_add_u32 s42, s42, 16384
    s_cmp_eq_u32 s42, 49152
    s_cselect_b32 s42, 0, s42
    s_setpc_b64 s[76:77]
PREP_w_issue_4:
    s_mov_b32 s45, 8192
    s_add_u32 s19, s41, s42
    v_readlane_b32 s16, v249, s44
    s_nop 0
    s_bitcmp1_b32 s16, 0
    s_cselect_b32 s17, 16384, s45
    s_cselect_b32 s18, -40960, s45
    s_andn2_b32 s16, s16, 1
    s_add_u32 s16, s16, s38
    s_add_u32 s44, s44, 1
    s_add_u32 s42, s42, 16384
    s_cmp_eq_u32 s42, 98304
    s_cselect_b32 s42, 0, s42
    s_setpc_b64 s[76:77]
K_end:
    s_endpgm
.p2align 6
K_tab:
.short 4096,5137,6178,11379,18660,25941,40502,33223,47784,55065,19706,12427,26988,34269,48830,41551,56096,9264,20736,10448,23824,25008,38384,35296,39568,49856,54128,52944,0,0,0,0
.short 4096,5137,6178,18659,11380,25941,33222,47783,40504,55065,12426,26987,19708,34269,41550,56111,48816,9264,10448,23824,20736,25008,35296,39568,38384,49856,52944,54128,0,0,0,0
.short 4096,5137,6178,11379,25940,18661,33222,40503,55064,47785,12426,19707,34268,26989,41550,48831,9264,56096,10448,20736,25008,23824,35296,38384,49856,39568,52944,54128,0,0,0,0
.short 4096,5137,6178,11379,18660,33221,25942,40503,47784,12425,55066,19707,26988,41549,34270,48831,56096,10448,9264,20736,23824,35296,25008,38384,39568,52944,49856,54128,0,0,0,0
.short 11377,12418,13459,18660,4101,25942,33223,47784,40505,55066,5147,26988,19709,34270,41551,56096,48816,6176,10288,23824,20736,25008,35296,39568,38384,49856,52944,54128,0,0,0,0
.short 11377,12418,13459,4100,25941,18662,33223,40504,55065,47786,5147,19708,34269,26990,41551,48816,6176,56096,10288,20736,25008,23824,35296,38384,49856,39568,52944,54128,0,0,0,0
.short 11377,12418,13459,4100,18661,33222,25943,40504,47785,5146,55067,19708,26989,41550,34271,48816,56096,10288,6176,20736,23824,35296,25008,38384,39568,52944,49856,54128,0,0,0,0
.short 11377,12418,13459,4100,18661,25942,40503,33224,47785,55066,19707,5148,26989,34270,48831,41536,56096,6176,20736,10288,23824,25008,38384,35296,39568,49856,54128,52944,0,0,0,0
.short 18658,19699,20740,4101,25942,11383,33224,40505,55066,47787,5148,12429,34270,26991,41536,48817,6176,56096,9264,10448,25008,23824,35296,38384,49856,39568,52944,54128,0,0,0,0
.short 18658,19699,20740,4101,11382,33223,25944,40505,47786,5147,55068,12429,26990,41551,34256,48817,56096,9264,6176,10448,23824,35296,25008,38384,39568,52944,49856,54128,0,0,0,0
.short 18658,19699,20740,4101,11382,25943,40504,33225,47786,55067,12428,5149,26990,34271,48816,41537,56096,6176,10448,9264,23824,25008,38384,35296,39568,49856,54128,52944,0,0,0,0
.short 18658,19699,20740,11381,4102,25943,33224,47785,40506,55067,5148,26989,12430,34271,41536,56097,48816,6176,9264,23824,10448,25008,35296,39568,38384,49856,52944,54128,0,0,0,0
.short 25939,26980,28021,4102,11383,33224,18665,40506,47787,5148,55069,12430,19711,41536,34257,48818,56096,9264,6176,10448,20736,35296,24848,38384,39568,52944,49856,54128,0,0,0,0
.short 25939,26980,28021,4102,11383,18664,40505,33226,47787,55068,12429,5150,19711,34256,48817,41538,56096,6176,10448,9264,20736,24848,38384,35296,39568,49856,54128,52944,0,0,0,0
.short 25939,26980,28021,11382,4103,18664,33225,47786,40507,55068,5149,19710,12431,34256,41537,56098,48816,6176,9264,20736,10448,24848,35296,39568,38384,49856,52944,54128,0,0,0,0
.short 25939,26980,28021,4102,18663,11384,33225,40506,55067,47788,5149,12430,34271,19696,41537,48818,6176,56096,9264,10448,24848,20736,35296,38384,49856,39568,52944,54128,0,0,0,0
.short 33220,34261,35302,4103,11384,18665,40506,25947,47788,55069,12430,5151,19696,26977,48818,41539,56096,6176,10448,9264,20736,23824,38384,25008,39568,49856,54128,52944,0,0,0,0
.short 33220,34261,35302,11383,4104,18665,25946,47787,40508,55069,5150,19711,12416,26977,41538,56099,48816,6176,9264,20736,10448,23824,25008,39568,38384,49856,52944,54128,0,0,0,0
.short 33220,34261,35302,4103,18664,11385,25946,40507,55068,47789,5150,12431,26976,19697,41538,48819,6176,56096,9264,10448,23824,20736,25008,38384,49856,39568,52944,54128,0,0,0,0
.short 33220,34261,35302,4103,11384,25945,18666,40507,47788,5149,55070,12431,19696,41537,26978,48819,56096,9264,6176,10448,20736,25008,23824,38384,39568,52944,49856,54128,0,0,0,0
.short 40501,41542,42583,11384,4105,18666,25947,47788,33229,55070,5151,19696,12417,26978,34259,56100,48816,6176,9264,20736,10448,23824,25008,39408,35296,49856,52944,54128,0,0,0,0
.short 40501,41542,42583,4104,18665,11386,25947,33228,55069,47790,5151,12416,26977,19698,34259,48820,6176,56096,9264,10448,23824,20736,25008,35296,49856,39408,52944,54128,0,0,0,0
.short 40501,41542,42583,4104,11385,25946,18667,33228,47789,5150,55071,12416,19697,34258,26979,48820,56096,9264,6176,10448,20736,25008,23824,35296,39408,52944,49856,54128,0,0,0,0
.short 40501,41542,42583,4104,11385,18666,33227,25948,47789,55070,12431,5136,19697,26978,48819,34260,56096,6176,10448,9264,20736,23824,35296,25008,39408,49856,54128,52944,0,0,0,0
.short 47782,48823,49864,4105,18666,11387,25948,33229,55070,40511,5136,12417,26978,19699,34260,41541,6176,56096,9264,10448,23824,20736,25008,35296,39568,38384,52944,54128,0,0,0,0
.short 47782,48823,49864,4105,11386,25947,18668,33229,40510,5151,55056,12417,19698,34259,26980,41541,56096,9264,6176,10448,20736,25008,23824,35296,38384,52944,39568,54128,0,0,0,0
.short 47782,48823,49864,4105,11386,18667,33228,25949,40510,55071,12416,5137,19698,26979,41540,34261,56096,6176,10448,9264,20736,23824,35296,25008,38384,39568,54128,52944,0,0,0,0
.short 47782,48823,49864,11385,4106,18667,25948,40509,33230,55071,5136,19697,12418,26979,34260,56101,41536,6176,9264,20736,10448,23824,25008,38384,35296,39568,52944,54128,0,0,0,0
.short 55063,56104,57145,4106,11387,25948,18669,33230,40511,5136,47777,12418,19699,34260,26981,41542,48816,9264,6176,10448,20736,25008,23824,35296,38384,49856,39568,53968,0,0,0,0
.short 55063,56104,57145,4106,11387,18668,33229,25950,40511,47776,12417,5138,19699,26980,41541,34262,48816,6176,10448,9264,20736,23824,35296,25008,38384,39568,53968,49856,0,0,0,0
.short 55063,56104,57145,11386,4107,18668,25949,40510,33231,47776,5137,19698,12419,26980,34261,48822,41536,6176,9264,20736,10448,23824,25008,38384,35296,39568,49856,53968,0,0,0,0
.short 55063,56104,57145,4106,18667,11388,25949,33230,47791,40496,5137,12418,26979,19700,34261,41542,6176,48816,9264,10448,23824,20736,25008,35296,39568,38384,49856,53968,0,0,0,0
.short 4104,5145,6186,11387,18668,25949,40510,33231,47776,55057,19698,12419,26980,34261,48822,41543,56096,9264,20736,10448,23824,25008,38384,35296,39568,49856,54128,52944,0,0,0,0
.short 4104,5145,6186,18667,11388,25949,33230,47791,40496,55057,12418,26979,19700,34261,41542,56103,48816,9264,10448,23824,20736,25008,35296,39568,38384,49856,52944,54128,0,0,0,0
.short 4104,5145,6186,11387,25948,18669,33230,40511,55056,47777,12418,19699,34260,26981,41542,48823,9264,56096,10448,20736,25008,23824,35296,38384,49856,39568,52944,54128,0,0,0,0
.short 4104,5145,6186,11387,18668,33229,25950,40511,47776,12417,55058,19699,26980,41541,34262,48823,56096,10448,9264,20736,23824,35296,25008,38384,39568,52944,49856,54128,0,0,0,0
.short 11385,12426,13467,18668,4109,25950,33231,47776,40497,55058,5139,26980,19701,34262,41543,56104,48816,6176,10288,23824,20736,25008,35296,39568,38384,49856,52944,54128,0,0,0,0
.short 11385,12426,13467,4108,25949,18670,33231,40496,55057,47778,5139,19700,34261,26982,41543,48824,6176,56096,10288,20736,25008,23824,35296,38384,49856,39568,52944,54128,0,0,0,0
.short 11385,12426,13467,4108,18669,33230,25951,40496,47777,5138,55059,19700,26981,41542,34263,48824,56096,10288,6176,20736,23824,35296,25008,38384,39568,52944,49856,54128,0,0,0,0
.short 11385,12426,13467,4108,18669,25950,40511,33216,47777,55058,19699,5140,26981,34262,48823,41544,56096,6176,20736,10288,23824,25008,38384,35296,39568,49856,54128,52944,0,0,0,0
.short 18666,19707,20748,4109,25950,11391,33216,40497,55058,47779,5140,12421,34262,26983,41544,48825,6176,56096,9264,10448,25008,23824,35296,38384,49856,39568,52944,54128,0,0,0,0
.short 18666,19707,20748,4109,11390,33231,25936,40497,47778,5139,55060,12421,26982,41543,34264,48825,56096,9264,6176,10448,23824,35296,25008,38384,39568,52944,49856,54128,0,0,0,0
.short 18666,19707,20748,4109,11390,25951,40496,33217,47778,55059,12420,5141,26982,34263,48824,41545,56096,6176,10448,9264,23824,25008,38384,35296,39568,49856,54128,52944,0,0,0,0
.short 18666,19707,20748,11389,4110,25951,33216,47777,40498,55059,5140,26981,12422,34263,41544,56105,48816,6176,9264,23824,10448,25008,35296,39568,38384,49856,52944,54128,0,0,0,0
.short 25947,26988,28029,4110,11391,33216,18657,40498,47779,5140,55061,12422,19703,41544,34265,48826,56096,9264,6176,10448,20736,35296,24848,38384,39568,52944,49856,54128,0,0,0,0
.short 25947,26988,28029,4110,11391,18656,40497,33218,47779,55060,12421,5142,19703,34264,48825,41546,56096,6176,10448,9264,20736,24848,38384,35296,39568,49856,54128,52944,0,0,0,0
.short 25947,26988,28029,11390,4111,18656,33217,47778,40499,55060,5141,19702,12423,34264,41545,56106,48816,6176,9264,20736,10448,24848,35296,39568,38384,49856,52944,54128,0,0,0,0
.short 25947,26988,28029,4110,18671,11376,33217,40498,55059,47780,5141,12422,34263,19704,41545,48826,6176,56096,9264,10448,24848,20736,35296,38384,49856,39568,52944,54128,0,0,0,0
.short 33228,34269,35310,4111,11376,18657,40498,25939,47780,55061,12422,5143,19704,26985,48826,41547,56096,6176,10448,9264,20736,23824,38384,25008,39568,49856,54128,52944,0,0,0,0
.short 33228,34269,35310,11391,4096,18657,25938,47779,40500,55061,5142,19703,12424,26985,41546,56107,48816,6176,9264,20736,10448,23824,25008,39568,38384,49856,52944,54128,0,0,0,0
.short 33228,34269,35310,4111,18656,11377,25938,40499,55060,47781,5142,12423,26984,19705,41546,48827,6176,56096,9264,10448,23824,20736,25008,38384,49856,39568,52944,54128,0,0,0,0
.short 33228,34269,35310,4111,11376,25937,18658,40499,47780,5141,55062,12423,19704,41545,26986,48827,56096,9264,6176,10448,20736,25008,23824,38384,39568,52944,49856,54128,0,0,0,0
.short 40509,41550,42591,11376,4097,18658,25939,47780,33221,55062,5143,19704,12425,26986,34267,56108,48816,6176,9264,20736,10448,23824,25008,39408,35296,49856,52944,54128,0,0,0,0
.short 40509,41550,42591,4096,18657,11378,25939,33220,55061,47782,5143,12424,26985,19706,34267,48828,6176,56096,9264,10448,23824,20736,25008,35296,49856,39408,52944,54128,0,0,0,0
.short 40509,41550,42591,4096,11377,25938,18659,33220,47781,5142,55063,12424,19705,34266,26987,48828,56096,9264,6176,10448,20736,25008,23824,35296,39408,52944,49856,54128,0,0,0,0
.short 40509,41550,42591,4096,11377,18658,33219,25940,47781,55062,12423,5144,19705,26986,48827,34268,56096,6176,10448,9264,20736,23824,35296,25008,39408,49856,54128,52944,0,0,0,0
.short 47790,48831,49856,4097,18658,11379,25940,33221,55062,40503,5144,12425,26986,19707,34268,41549,6176,56096,9264,10448,23824,20736,25008,35296,39568,38384,52944,54128,0,0,0,0
.short 47790,48831,49856,4097,11378,25939,18660,33221,40502,5143,55064,12425,19706,34267,26988,41549,56096,9264,6176,10448,20736,25008,23824,35296,38384,52944,39568,54128,0,0,0,0
.short 47790,48831,49856,4097,11378,18659,33220,25941,40502,55063,12424,5145,19706,26987,41548,34269,56096,6176,10448,9264,20736,23824,35296,25008,38384,39568,54128,52944,0,0,0,0
.short 47790,48831,49856,11377,4098,18659,25940,40501,33222,55063,5144,19705,12426,26987,34268,56109,41536,6176,9264,20736,10448,23824,25008,38384,35296,39568,52944,54128,0,0,0,0
.short 55071,56096,57137,4098,11379,25940,18661,33222,40503,5144,47785,12426,19707,34268,26989,41550,48816,9264,6176,10448,20736,25008,23824,35296,38384,49856,39568,53968,0,0,0,0
.short 55071,56096,57137,4098,11379,18660,33221,25942,40503,47784,12425,5146,19707,26988,41549,34270,48816,6176,10448,9264,20736,23824,35296,25008,38384,39568,53968,49856,0,0,0,0
.short 55071,56096,57137,11378,4099,18660,25941,40502,33223,47784,5145,19706,12427,26988,34269,48830,41536,6176,9264,20736,10448,23824,25008,38384,35296,39568,49856,53968,0,0,0,0
.short 55071,56096,57137,4098,18659,11380,25941,33222,47783,40504,5145,12426,26987,19708,34269,41550,6176,48816,9264,10448,23824,20736,25008,35296,39568,38384,49856,53968,0,0,0,0
.section .rodata,"a"
.p2align 6
.amdhsa_kernel interleave_layers__ssm_conv_h3__mixer_s_mlp__prompt_kernel
  .amdhsa_next_free_vgpr 256
  .amdhsa_next_free_sgpr 102
  .amdhsa_accum_offset 256
  .amdhsa_group_segment_fixed_size 0
  .amdhsa_kernarg_size 112
  .amdhsa_user_sgpr_count 2
  .amdhsa_user_sgpr_kernarg_segment_ptr 1
  .amdhsa_system_sgpr_workgroup_id_x 1
  .amdhsa_float_denorm_mode_32 3
.end_amdhsa_kernel
```

```asm
; @launch grid=(256,1,1) block=(512,1,1) lds=163840
.amdgcn_target "amdgcn-amd-amdhsa--gfx950"
.text
.globl interleave_layers__ssm_conv_h3__mixer_s_mlp__prompt_kernel
.p2align 8
.type interleave_layers__ssm_conv_h3__mixer_s_mlp__prompt_kernel,@function
interleave_layers__ssm_conv_h3__mixer_s_mlp__prompt_kernel:
    s_cmp_ge_u32 s2, 256
    s_cbranch_scc1 K_end
    s_load_dwordx8 s[8:15], s[0:1], 8
    s_load_dwordx2 s[6:7], s[0:1], 0
    s_load_dwordx8 s[68:75], s[0:1], 56
    s_load_dwordx2 s[4:5], s[0:1], 104
    s_load_dwordx2 s[84:85], s[0:1], 96
    s_memrealtime s[46:47]
    s_load_dwordx2 s[96:97], s[0:1], 40
    v_lshrrev_b32 v1, 6, v0
    s_nop 0
    v_readfirstlane_b32 s30, v1
    s_getpc_b64 s[48:49]
K_pc:
    s_lshr_b32 s36, s2, 3
    s_lshl_b32 s36, s36, 11
    v_lshlrev_b32 v4, 2, v0
    v_add_u32 v4, s36, v4
    v_cmp_gt_u32 vcc, K_end-K_pc-8, v4
    s_nop 0
    s_and_saveexec_b64 s[36:37], vcc
    s_cbranch_execz K_3
    v_mov_b32 v5, s49
    v_add_co_u32 v4, vcc, s48, v4
    s_nop 1
    v_addc_co_u32 v5, vcc, 0, v5, vcc
    global_load_dword v250, v[4:5], off
K_3:
    s_mov_b64 exec, -1
    v_and_b32 v6, 31, v0
    v_lshrrev_b32 v7, 5, v0
    s_and_b32 s34, s2, 7
    s_lshr_b32 s35, s2, 3
    s_lshl_b32 s36, s35, 17
    s_lshl_b32 s37, s34, 8
    s_add_u32 s36, s36, s37
    v_lshlrev_b32 v8, 13, v7
    v_lshl_add_u32 v8, v6, 3, v8
    v_add_u32 v12, s36, v8
    v_add_u32 v14, 4096, v12
    s_mov_b32 s18, 4194304
    s_mov_b32 s19, 0x20000
    s_mov_b32 s22, s18
    s_mov_b32 s23, s19
    s_waitcnt lgkmcnt(0)
    s_mov_b32 s86, 256
    s_mov_b32 s87, 0x20000
    v_mov_b32 v78, 0
    s_lshl_b32 s45, s2, 3
    s_add_u32 s45, s45, s30
    s_cmp_lg_u32 s45, 4
    s_cbranch_scc1 KV_t0
    s_getreg_b32 s45, hwreg(HW_REG_XCC_ID, 0, 3)
    s_lshl_b32 s45, s45, 1
    s_lshl_b32 s44, s46, 6
    s_or_b32 s44, s44, s45
    s_or_b32 s44, s44, 1
    v_mov_b32 v76, s44
    v_mov_b32 v77, 0
    s_mov_b64 exec, 1
    buffer_store_dwordx2 v[76:77], v78, s[84:87], 0 offen sc1
    s_mov_b64 exec, -1
KV_t0:
    s_mov_b64 s[16:17], s[8:9]
    s_mov_b64 s[20:21], s[10:11]
    buffer_load_dwordx2 v[28:29], v12, s[16:19], 0 offen offset:0 nt
    buffer_load_dwordx2 v[30:31], v12, s[16:19], 0 offen offset:2048 nt
    buffer_load_dwordx2 v[32:33], v14, s[16:19], 0 offen offset:0 nt
    buffer_load_dwordx2 v[34:35], v14, s[16:19], 0 offen offset:2048 nt
    buffer_load_dwordx2 v[36:37], v12, s[20:23], 0 offen offset:0 nt
    buffer_load_dwordx2 v[38:39], v12, s[20:23], 0 offen offset:2048 nt
    buffer_load_dwordx2 v[40:41], v14, s[20:23], 0 offen offset:0 nt
    buffer_load_dwordx2 v[42:43], v14, s[20:23], 0 offen offset:2048 nt
    v_subrev_u32 v9, 6144, v12
    v_subrev_u32 v10, 4096, v12
    v_subrev_u32 v11, 2048, v12
    s_lshl_b32 s37, s34, 10
    v_lshlrev_b32 v16, 5, v6
    v_add_u32 v16, s37, v16
    s_mov_b32 s24, s12
    s_mov_b32 s25, s13
    s_mov_b32 s26, 0x2000
    s_mov_b32 s27, 0x20000
    v_and_b32 v8, 1, v7
    v_lshl_add_u32 v16, v8, 4, v16
    buffer_load_dwordx4 v[44:47], v16, s[24:27], 0 offen
    s_cmp_lg_u32 s30, 4
    s_cbranch_scc1 KV_t2
    buffer_load_dword v76, v78, s[84:87], 0 offen sc1
KV_t2:
    s_bfm_b64 exec, 32, 0
    buffer_load_dwordx2 v[22:23], v9, s[16:19], 0 offen nt
    buffer_load_dwordx2 v[24:25], v10, s[16:19], 0 offen nt
    buffer_load_dwordx2 v[26:27], v11, s[16:19], 0 offen nt
    s_mov_b64 exec, -1
    v_and_b32 v1, 63, v0
    v_lshlrev_b32 v2, 4, v1
    v_lshlrev_b32 v3, 2, v1
    s_mov_b32 s67, 0
    s_mov_b32 s60, 0
    s_mov_b32 s61, 40000
    s_mov_b32 s52, 0
    s_mov_b32 s55, 0
    s_mov_b32 s92, 0
    s_mov_b32 s93, 0
    s_mov_b32 s94, 0
    s_mov_b32 s56, s4
    s_mov_b32 s57, s5
    s_mov_b32 s58, 0xa000000
    s_mov_b32 s59, 0x20000
    s_add_u32 s62, s4, 33554432
    s_addc_u32 s63, s5, 0
    s_and_b32 s41, s30, 3
    s_and_b32 s38, s2, 7
    s_lshl_b32 s38, s38, 5
    s_lshr_b32 s39, s2, 3
    s_add_u32 s38, s38, s39
    s_lshl_b32 s39, s38, 2
    s_add_u32 s39, s39, s41
    s_mul_i32 s40, s41, 24576
    s_lshr_b32 s36, s39, 1
    s_lshl_b32 s36, s36, 2
    s_load_dword s98, s[96:97], s36
    s_lshl_b32 s36, s39, 12
    s_add_u32 s12, s14, s36
    s_addc_u32 s13, s15, 0
    s_mov_b32 s14, 4096
    s_mov_b32 s15, 0x20000
    s_lshr_b32 s45, s30, 2
    s_lshl_b32 s45, s45, 11
    s_add_u32 s36, s45, 0xffffffc0
    v_add_u32 v70, s36, v2
    v_add_u32 v71, 16, v70
    s_add_u32 s36, s45, 0x3c0
    v_add_u32 v72, s36, v2
    v_add_u32 v73, 16, v72
    s_mov_b32 s36, 4032
    v_add_u32 v74, s36, v2
    v_add_u32 v75, 16, v74
    s_and_b32 s34, s2, 7
    s_lshr_b32 s35, s2, 3
    v_mov_b32 v80, 0
    v_mov_b32 v81, 0
    v_mov_b32 v82, 0
    v_mov_b32 v83, 0
    v_add_u32 v86, s40, v2
    ds_write_b128 v86, v[80:83] offset:22784
    s_bfm_b64 exec, 26, 0
    ds_write_b128 v86, v[80:83] offset:23808
    s_mov_b64 exec, -1
    v_lshlrev_b32 v8, 2, v7
    v_sub_u32 v8, 60, v8
    v_lshrrev_b32 v85, 3, v8
    v_bfe_u32 v84, v6, 1, 3
    v_xor_b32 v85, v85, v84
    v_lshlrev_b32 v85, 4, v85
    v_and_b32 v8, 7, v8
    v_lshl_add_u32 v85, v8, 1, v85
    v_lshl_add_u32 v84, v6, 9, v85
    v_add_u32 v84, 98304, v84
    s_waitcnt vmcnt(0)
    s_cmp_lg_u32 s30, 4
    s_cbranch_scc1 KV_t1
KV_t1:
    buffer_load_dwordx4 v[52:55], v70, s[12:15], 0 offen nt
    buffer_load_dwordx2 v[56:57], v71, s[12:15], 0 offen nt
    buffer_load_dwordx4 v[58:61], v72, s[12:15], 0 offen nt
    buffer_load_dwordx2 v[62:63], v73, s[12:15], 0 offen nt
    buffer_load_dwordx4 v[64:67], v74, s[12:15], 0 offen nt
    buffer_load_dwordx2 v[68:69], v75, s[12:15], 0 offen nt
    v_mov_b32 v48, v44
    v_mov_b32 v49, v45
    v_mov_b32 v50, v46
    v_mov_b32 v51, v47
    v_mov_b32 v126, v30
    v_mov_b32 v127, v31
    v_mov_b32 v128, v32
    v_mov_b32 v129, v33
    v_mov_b32 v130, v34
    v_mov_b32 v131, v35
    v_permlane32_swap_b32 v44, v48
    v_permlane32_swap_b32 v45, v49
    v_permlane32_swap_b32 v46, v50
    v_permlane32_swap_b32 v47, v51
    v_permlane32_swap_b32 v22, v126
    v_permlane32_swap_b32 v23, v127
    v_permlane32_swap_b32 v24, v128
    v_permlane32_swap_b32 v25, v129
    v_permlane32_swap_b32 v26, v130
    v_permlane32_swap_b32 v27, v131
    v_lshlrev_b32 v88, 16, v44
    v_and_b32 v90, 0xffff0000, v44
    v_lshlrev_b32 v92, 16, v45
    v_and_b32 v94, 0xffff0000, v45
    v_lshlrev_b32 v89, 16, v46
    v_and_b32 v91, 0xffff0000, v46
    v_lshlrev_b32 v93, 16, v47
    v_and_b32 v95, 0xffff0000, v47
    v_lshlrev_b32 v96, 16, v22
    v_and_b32 v97, 0xffff0000, v22
    v_lshlrev_b32 v98, 16, v24
    v_and_b32 v99, 0xffff0000, v24
    v_lshlrev_b32 v100, 16, v26
    v_and_b32 v101, 0xffff0000, v26
    v_lshlrev_b32 v102, 16, v28
    v_and_b32 v103, 0xffff0000, v28
    v_lshlrev_b32 v104, 16, v30
    v_and_b32 v105, 0xffff0000, v30
    v_lshlrev_b32 v106, 16, v32
    v_and_b32 v107, 0xffff0000, v32
    v_lshlrev_b32 v108, 16, v34
    v_and_b32 v109, 0xffff0000, v34
    v_lshlrev_b32 v110, 16, v36
    v_and_b32 v111, 0xffff0000, v36
    v_lshlrev_b32 v112, 16, v38
    v_and_b32 v113, 0xffff0000, v38
    v_lshlrev_b32 v114, 16, v40
    v_and_b32 v115, 0xffff0000, v40
    v_lshlrev_b32 v116, 16, v42
    v_and_b32 v117, 0xffff0000, v42
    v_pk_mul_f32 v[118:119], v[96:97], v[94:95]
    v_pk_mul_f32 v[120:121], v[98:99], v[94:95]
    v_pk_mul_f32 v[122:123], v[100:101], v[94:95]
    v_pk_mul_f32 v[124:125], v[102:103], v[94:95]
    v_pk_fma_f32 v[118:119], v[98:99], v[92:93], v[118:119]
    v_pk_fma_f32 v[120:121], v[100:101], v[92:93], v[120:121]
    v_pk_fma_f32 v[122:123], v[102:103], v[92:93], v[122:123]
    v_pk_fma_f32 v[124:125], v[104:105], v[92:93], v[124:125]
    v_pk_fma_f32 v[118:119], v[100:101], v[90:91], v[118:119]
    v_pk_fma_f32 v[120:121], v[102:103], v[90:91], v[120:121]
    v_pk_fma_f32 v[122:123], v[104:105], v[90:91], v[122:123]
    v_pk_fma_f32 v[124:125], v[106:107], v[90:91], v[124:125]
    v_pk_fma_f32 v[118:119], v[102:103], v[88:89], v[118:119]
    v_pk_fma_f32 v[120:121], v[104:105], v[88:89], v[120:121]
    v_pk_fma_f32 v[122:123], v[106:107], v[88:89], v[122:123]
    v_pk_fma_f32 v[124:125], v[108:109], v[88:89], v[124:125]
    v_pk_mul_f32 v[118:119], v[118:119], v[110:111]
    v_pk_mul_f32 v[120:121], v[120:121], v[112:113]
    v_pk_mul_f32 v[122:123], v[122:123], v[114:115]
    v_pk_mul_f32 v[124:125], v[124:125], v[116:117]
    v_cvt_pk_bf16_f32 v136, v124, v122
    v_cvt_pk_bf16_f32 v137, v120, v118
    ds_write_b64 v84, v[136:137] offset:0
    v_cvt_pk_bf16_f32 v138, v125, v123
    v_cvt_pk_bf16_f32 v139, v121, v119
    ds_write_b64 v84, v[138:139] offset:128
    v_lshlrev_b32 v88, 16, v48
    v_and_b32 v90, 0xffff0000, v48
    v_lshlrev_b32 v92, 16, v49
    v_and_b32 v94, 0xffff0000, v49
    v_lshlrev_b32 v89, 16, v50
    v_and_b32 v91, 0xffff0000, v50
    v_lshlrev_b32 v93, 16, v51
    v_and_b32 v95, 0xffff0000, v51
    v_lshlrev_b32 v96, 16, v23
    v_and_b32 v97, 0xffff0000, v23
    v_lshlrev_b32 v98, 16, v25
    v_and_b32 v99, 0xffff0000, v25
    v_lshlrev_b32 v100, 16, v27
    v_and_b32 v101, 0xffff0000, v27
    v_lshlrev_b32 v102, 16, v29
    v_and_b32 v103, 0xffff0000, v29
    v_lshlrev_b32 v104, 16, v31
    v_and_b32 v105, 0xffff0000, v31
    v_lshlrev_b32 v106, 16, v33
    v_and_b32 v107, 0xffff0000, v33
    v_lshlrev_b32 v108, 16, v35
    v_and_b32 v109, 0xffff0000, v35
    v_lshlrev_b32 v110, 16, v37
    v_and_b32 v111, 0xffff0000, v37
    v_lshlrev_b32 v112, 16, v39
    v_and_b32 v113, 0xffff0000, v39
    v_lshlrev_b32 v114, 16, v41
    v_and_b32 v115, 0xffff0000, v41
    v_lshlrev_b32 v116, 16, v43
    v_and_b32 v117, 0xffff0000, v43
    v_pk_mul_f32 v[118:119], v[96:97], v[94:95]
    v_pk_mul_f32 v[120:121], v[98:99], v[94:95]
    v_pk_mul_f32 v[122:123], v[100:101], v[94:95]
    v_pk_mul_f32 v[124:125], v[102:103], v[94:95]
    v_pk_fma_f32 v[118:119], v[98:99], v[92:93], v[118:119]
    v_pk_fma_f32 v[120:121], v[100:101], v[92:93], v[120:121]
    v_pk_fma_f32 v[122:123], v[102:103], v[92:93], v[122:123]
    v_pk_fma_f32 v[124:125], v[104:105], v[92:93], v[124:125]
    v_pk_fma_f32 v[118:119], v[100:101], v[90:91], v[118:119]
    v_pk_fma_f32 v[120:121], v[102:103], v[90:91], v[120:121]
    v_pk_fma_f32 v[122:123], v[104:105], v[90:91], v[122:123]
    v_pk_fma_f32 v[124:125], v[106:107], v[90:91], v[124:125]
    v_pk_fma_f32 v[118:119], v[102:103], v[88:89], v[118:119]
    v_pk_fma_f32 v[120:121], v[104:105], v[88:89], v[120:121]
    v_pk_fma_f32 v[122:123], v[106:107], v[88:89], v[122:123]
    v_pk_fma_f32 v[124:125], v[108:109], v[88:89], v[124:125]
    v_pk_mul_f32 v[118:119], v[118:119], v[110:111]
    v_pk_mul_f32 v[120:121], v[120:121], v[112:113]
    v_pk_mul_f32 v[122:123], v[122:123], v[114:115]
    v_pk_mul_f32 v[124:125], v[124:125], v[116:117]
    v_cvt_pk_bf16_f32 v140, v124, v122
    v_cvt_pk_bf16_f32 v141, v120, v118
    ds_write_b64 v84, v[140:141] offset:256
    v_cvt_pk_bf16_f32 v142, v125, v123
    v_cvt_pk_bf16_f32 v143, v121, v119
    ds_write_b64 v84, v[142:143] offset:384
    s_cmp_lg_u32 s30, 4
    s_cbranch_scc1 HB_2
    v_add_u32 v18, 162816, v3
    ds_write_b32 v18, v78
    s_mov_b32 s53, 0
    s_waitcnt vmcnt(6)
HB_p:
    v_readfirstlane_b32 s52, v76
    s_nop 0
    s_cmp_eq_u32 s52, 0
    s_cbranch_scc1 HB_r
    s_cmp_ge_u32 s53, 400
    s_cbranch_scc1 HB_q
    s_add_u32 s54, s46, 8192
    s_lshl_b32 s54, s54, 6
    s_sub_u32 s54, s54, s52
    s_cmp_lt_u32 s54, 786432
    s_cbranch_scc1 HB_q
HB_r:
    buffer_load_dword v76, v78, s[84:87], 0 offen sc1
    s_waitcnt vmcnt(0)
    s_add_u32 s53, s53, 1
    s_cmp_lt_u32 s53, s61
    s_cbranch_scc1 HB_p
    s_mov_b32 s52, 1
    s_mov_b32 s61, 0
HB_q:
    v_mov_b32 v18, 162828
    v_mov_b32 v19, s52
    s_waitcnt lgkmcnt(0)
    ds_write_b32 v18, v19
HB_2:
    s_add_u32 s16, s4, 0x2000000
    s_addc_u32 s17, s5, 0
    s_mov_b32 s18, 0x8000000
    s_mov_b32 s19, 0x20000
    v_lshrrev_b32 v8, 3, v0
    v_and_b32 v85, 7, v0
    v_lshlrev_b32 v149, 12, v8
    v_lshl_add_u32 v149, v85, 4, v149
    s_lshl_b32 s36, s34, 24
    s_sub_u32 s37, 31, s35
    s_lshl_b32 s37, s37, 7
    s_add_u32 s36, s36, s37
    s_add_u32 s37, s36, 262144
    v_lshrrev_b32 v148, 3, v8
    v_xor_b32 v148, v148, v85
    v_lshlrev_b32 v148, 4, v148
    v_lshl_add_u32 v148, v8, 7, v148
    v_add_u32 v148, 98304, v148
    v_mov_b32 v18, 162828
    s_waitcnt lgkmcnt(0)
    s_barrier
    ds_read_b128 v[152:155], v148 offset:0
    ds_read_b128 v[156:159], v148 offset:8192
    ds_read_b32 v19, v18
    s_waitcnt lgkmcnt(2)
    v_or_b32 v152, 1, v152
    buffer_store_dwordx4 v[152:155], v149, s[16:19], s36 offen sc1
    s_waitcnt lgkmcnt(1)
    v_or_b32 v156, 1, v156
    buffer_store_dwordx4 v[156:159], v149, s[16:19], s37 offen sc1
    s_waitcnt lgkmcnt(0)
    v_readfirstlane_b32 s52, v19
    s_cmp_lg_u32 s30, 0
    s_cbranch_scc1 KV_ni
    s_cmp_ge_u32 s35, 16
    s_cbranch_scc1 KV_ni
    v_mov_b32 v8, s52
    s_lshl_b32 s37, s34, 7
    s_lshl_b32 s53, s35, 10
    s_add_u32 s37, s37, s53
    s_add_u32 s37, s37, 23101440
    s_mov_b64 exec, 1
    buffer_store_dword v8, v78, s[56:59], s37 offen sc1
    s_mov_b64 exec, -1
KV_ni:
    s_cmp_ge_u32 s2, 32
    s_cbranch_scc1 KV_n3
    s_cmp_lg_u32 s30, 5
    s_cbranch_scc1 KV_n3
    s_and_b32 s42, s2, 7
    s_lshl_b32 s42, s42, 10
    s_lshr_b32 s43, s2, 3
    s_lshl_b32 s43, s43, 14
    s_add_u32 s42, s42, s43
    s_add_u32 s42, s42, 39714816
    v_lshrrev_b32 v8, 5, v1
    v_mul_u32_u24 v8, 7680, v8
    v_add_u32 v8, v8, v2
    buffer_store_dwordx4 v[80:83], v8, s[56:59], s42 offen sc1
KV_n3:
    s_bfe_u32 s32, s52, 0x30001
    s_add_u32 s32, s32, s2
    s_and_b32 s32, s32, 7
    s_lshr_b32 s33, s2, 3
    s_and_b32 s28, s32, 2
    s_lshr_b32 s53, s32, 2
    s_or_b32 s28, s28, s53
    s_lshl_b32 s28, s28, 2
    s_and_b32 s53, s33, 3
    s_add_u32 s28, s28, s53
    s_and_b32 s31, s32, 1
    s_lshr_b32 s33, s33, 2
    s_lshl_b32 s29, s31, 3
    s_add_u32 s29, s29, s33
    s_xor_b32 s99, s29, 1
    v_and_b32 v199, 7, v0
    v_lshrrev_b32 v228, 6, v0
    v_lshlrev_b32 v228, 4, v228
    v_bfe_u32 v229, v0, 3, 3
    v_add_u32 v228, v228, v229
    s_lshr_b32 s78, s29, 1
    s_lshl_b32 s78, s78, 16
    s_and_b32 s79, s29, 1
    s_lshl_b32 s79, s79, 7
    s_add_u32 s78, s78, s79
    s_lshr_b32 s79, s30, 1
    s_lshl_b32 s79, s79, 13
    s_add_u32 s78, s78, s79
    v_lshlrev_b32 v196, 8, v228
    v_lshl_add_u32 v196, v199, 4, v196
    v_add_u32 v196, s78, v196
    s_lshl_b32 s78, s28, 7
    s_lshl_b32 s79, s29, 3
    s_add_u32 s78, s78, s79
    v_add_u32 v197, s78, v199
    v_lshlrev_b32 v198, 11, v197
    v_lshrrev_b32 v229, 2, v228
    v_lshlrev_b32 v229, 3, v229
    v_and_b32 v228, 3, v228
    v_add_u32 v228, v228, v229
    v_lshl_add_u32 v198, v228, 3, v198
    v_and_b32 v197, 63, v197
    v_lshlrev_b32 v197, 3, v197
    v_and_b32 v229, 15, v228
    v_lshl_add_u32 v197, v229, 9, v197
    v_lshrrev_b32 v229, 4, v228
    v_lshl_add_u32 v197, v229, 14, v197
    s_lshr_b32 s78, s28, 3
    s_lshl_b32 s78, s78, 2
    s_and_b32 s79, s28, 3
    s_add_u32 s78, s78, s79
    s_lshl_b32 s78, s78, 24
    s_and_b32 s79, s28, 4
    s_lshl_b32 s79, s79, 11
    s_add_u32 s78, s78, s79
    s_lshl_b32 s79, s31, 18
    s_add_u32 s78, s78, s79
    v_add_u32 v197, s78, v197
    s_lshl_b32 s36, s34, 5
    s_add_u32 s36, s36, s35
    s_lshl_b32 s36, s36, 7
    s_add_u32 s36, s36, 23068672
    v_mov_b32 v18, 1
    v_mov_b32 v19, 162820
    v_mov_b32 v21, 0
    s_mov_b64 exec, 1
    s_waitcnt vmcnt(0)
    ds_add_rtn_u32 v20, v19, v18
    v_mov_b32 v19, s52
    s_waitcnt lgkmcnt(0)
    v_readfirstlane_b32 s54, v20
    s_nop 0
    s_and_b32 s54, s54, 7
    s_cmp_lg_u32 s54, 7
    s_cbranch_scc1 pub_1
    buffer_store_dword v19, v21, s[56:59], s36 offen sc1
pub_1:
    s_mov_b64 exec, -1
    s_mov_b32 s8, s6
    s_mov_b32 s9, s7
    s_mov_b32 s10, 0x400000
    s_mov_b32 s11, 0x20000
    buffer_load_dwordx2 v[180:181], v198, s[8:11], 0 offen offset:0 nt
    buffer_load_dwordx2 v[182:183], v198, s[8:11], 0 offen offset:32 nt
    buffer_load_dwordx2 v[184:185], v198, s[8:11], 0 offen offset:128 nt
    buffer_load_dwordx2 v[186:187], v198, s[8:11], 0 offen offset:160 nt
    v_add_u32 v160, s45, v86
    v_alignbit_b32 v88, v53, v52, 16
    v_mov_b32 v92, v53
    v_alignbit_b32 v96, v54, v53, 16
    v_alignbit_b32 v89, v54, v53, 16
    v_mov_b32 v93, v54
    v_alignbit_b32 v97, v55, v54, 16
    v_alignbit_b32 v90, v55, v54, 16
    v_mov_b32 v94, v55
    v_alignbit_b32 v98, v56, v55, 16
    v_alignbit_b32 v91, v56, v55, 16
    v_mov_b32 v95, v56
    v_alignbit_b32 v99, v57, v56, 16
    ds_write_b128 v160, v[88:91] offset:0
    ds_write_b128 v160, v[92:95] offset:4160
    ds_write_b128 v160, v[96:99] offset:8320
    ds_write_b128 v160, v[54:57] offset:12480
    v_alignbit_b32 v100, v59, v58, 16
    v_mov_b32 v104, v59
    v_alignbit_b32 v108, v60, v59, 16
    v_alignbit_b32 v101, v60, v59, 16
    v_mov_b32 v105, v60
    v_alignbit_b32 v109, v61, v60, 16
    v_alignbit_b32 v102, v61, v60, 16
    v_mov_b32 v106, v61
    v_alignbit_b32 v110, v62, v61, 16
    v_alignbit_b32 v103, v62, v61, 16
    v_mov_b32 v107, v62
    v_alignbit_b32 v111, v63, v62, 16
    ds_write_b128 v160, v[100:103] offset:1024
    ds_write_b128 v160, v[104:107] offset:5184
    ds_write_b128 v160, v[108:111] offset:9344
    ds_write_b128 v160, v[60:63] offset:13504
    v_alignbit_b32 v112, v65, v64, 16
    v_mov_b32 v116, v65
    v_alignbit_b32 v120, v66, v65, 16
    v_alignbit_b32 v113, v66, v65, 16
    v_mov_b32 v117, v66
    v_alignbit_b32 v121, v67, v66, 16
    v_alignbit_b32 v114, v67, v66, 16
    v_mov_b32 v118, v67
    v_alignbit_b32 v122, v68, v67, 16
    v_alignbit_b32 v115, v68, v67, 16
    v_mov_b32 v119, v68
    v_alignbit_b32 v123, v69, v68, 16
    s_mov_b64 exec, 0xf
    ds_write_b128 v86, v[112:115] offset:4096
    ds_write_b128 v86, v[116:119] offset:8256
    ds_write_b128 v86, v[120:123] offset:12416
    ds_write_b128 v86, v[66:69] offset:16576
    s_mov_b64 exec, -1
    s_waitcnt lgkmcnt(0)
    s_barrier
    v_mov_b32 v238, 0
    v_mov_b32 v239, 0
    v_mov_b32 v240, 0
    v_mov_b32 v241, 0
    v_mov_b32 v242, 0
    v_mov_b32 v243, 0
    v_mov_b32 v244, 0
    v_mov_b32 v245, 0
    v_mov_b32 v246, 0
    v_mov_b32 v247, 0
    s_cmp_ge_u32 s30, 4
    s_cbranch_scc1 FR_b
    s_and_b32 s38, s2, 7
    s_lshl_b32 s38, s38, 5
    s_lshr_b32 s39, s2, 3
    s_add_u32 s38, s38, s39
    s_lshl_b32 s39, s38, 2
    s_add_u32 s39, s39, s30
    s_mul_i32 s40, s30, 24576
    s_and_b32 s36, s39, 127
    s_lshl_b32 s36, s36, 12
    s_lshr_b32 s37, s39, 7
    s_lshl_b32 s37, s37, 24
    s_add_u32 s36, s36, s37
    s_add_u32 s36, s36, 33554432
    s_add_u32 s16, s4, s36
    s_addc_u32 s17, s5, 0
    s_mov_b32 s18, 4096
    s_mov_b32 s19, 0x20000
    v_lshrrev_b32 v6, 2, v1
    v_mul_u32_u24 v12, 96, v6
    v_and_b32 v6, 3, v1
    v_lshl_add_u32 v12, v6, 4, v12
    v_add_u32 v12, s40, v12
    v_and_b32 v35, 15, v1
    v_lshrrev_b32 v36, 4, v1
    v_and_b32 v6, 3, v35
    v_mul_u32_u24 v32, 4160, v6
    v_lshl_add_u32 v32, v36, 4, v32
    v_lshrrev_b32 v6, 2, v35
    v_lshl_add_u32 v32, v6, 3, v32
    v_add_u32 v32, s40, v32
    v_sub_u32 v6, 15, v35
    v_mul_u32_u24 v34, 96, v6
    v_add_u32 v34, s40, v34
    v_lshl_add_u32 v33, v36, 4, v34
    ds_read_b64 v[72:73], v32 offset:0
    ds_read_b64 v[74:75], v32 offset:8
    ds_read_b64 v[76:77], v32 offset:32
    ds_read_b64 v[78:79], v32 offset:40
    ds_read_b64 v[80:81], v32 offset:1024
    ds_read_b64 v[82:83], v32 offset:1032
    ds_read_b64 v[84:85], v32 offset:1056
    ds_read_b64 v[86:87], v32 offset:1064
    ds_read_b64 v[88:89], v32 offset:2048
    ds_read_b64 v[90:91], v32 offset:2056
    ds_read_b64 v[92:93], v32 offset:2080
    ds_read_b64 v[94:95], v32 offset:2088
    ds_read_b64 v[96:97], v32 offset:3072
    ds_read_b64 v[98:99], v32 offset:3080
    ds_read_b64 v[100:101], v32 offset:3104
    ds_read_b64 v[102:103], v32 offset:3112
    s_bitcmp1_b32 s39, 0
    s_cselect_b32 s36, 0, 16
    s_lshl_b32 s41, s98, s36
    s_and_b32 s41, s41, 0xffff0000
    s_lshr_b32 s36, s41, 16
    v_lshl_add_u32 v6, v36, 3, v35
    v_sub_u32 v6, 31, v6
    v_mov_b32 v10, s36
    v_mov_b32 v11, s41
    v_and_b32 v8, 1, v6
    v_cmp_eq_u32 vcc, 1, v8
    s_nop 1
    v_cndmask_b32 v10, v10, v11, vcc
    v_ashrrev_i32 v6, 1, v6
    v_cmp_eq_u32 vcc, 0, v6
    s_nop 1
    v_cndmask_b32 v152, 0, v10, vcc
    v_cmp_eq_u32 vcc, 1, v6
    s_nop 1
    v_cndmask_b32 v153, 0, v10, vcc
    v_cmp_eq_u32 vcc, 2, v6
    s_nop 1
    v_cndmask_b32 v154, 0, v10, vcc
    v_cmp_eq_u32 vcc, 3, v6
    s_nop 1
    v_cndmask_b32 v155, 0, v10, vcc
    v_cmp_eq_u32 vcc, 8, v6
    s_nop 1
    v_cndmask_b32 v156, 0, v10, vcc
    v_cmp_eq_u32 vcc, 9, v6
    s_nop 1
    v_cndmask_b32 v157, 0, v10, vcc
    v_cmp_eq_u32 vcc, 10, v6
    s_nop 1
    v_cndmask_b32 v158, 0, v10, vcc
    v_cmp_eq_u32 vcc, 11, v6
    s_nop 1
    v_cndmask_b32 v159, 0, v10, vcc
    s_add_u32 s12, s4, 0x2100000
    s_addc_u32 s13, s5, 0
    s_mov_b32 s14, 0x7f00000
    s_mov_b32 s15, 0x20000
    v_bfe_u32 v6, v1, 2, 2
    v_mul_u32_u24 v168, 24640, v6
    v_lshrrev_b32 v6, 1, v36
    v_mul_u32_u24 v6, 72, v6
    v_add_u32 v168, v168, v6
    v_and_b32 v6, 1, v36
    v_lshl_add_u32 v168, v6, 5, v168
    v_and_b32 v6, 3, v1
    v_lshl_add_u32 v168, v6, 3, v168
    s_mul_i32 s36, s30, 1152
    v_add_u32 v168, s36, v168
    v_lshlrev_b32 v169, 3, v1
    s_lshr_b32 s44, s38, 4
    s_lshl_b32 s44, s44, 14
    s_and_b32 s37, s38, 15
    s_lshl_b32 s37, s37, 9
    s_add_u32 s44, s44, s37
    s_and_b32 s37, s30, 1
    s_lshl_b32 s37, s37, 13
    s_add_u32 s44, s44, s37
    s_lshr_b32 s37, s30, 1
    s_lshl_b32 s37, s37, 26
    s_add_u32 s44, s44, s37
    v_not_b32 v34, v1
    v_and_b32 v34, 1, v34
    s_mul_i32 s36, s30, 24640
    v_mul_u32_u24 v170, 72, v35
    v_lshl_add_u32 v170, v36, 3, v170
    v_add_u32 v170, s36, v170
    v_mov_b32 v35, 0
    s_and_b32 s45, s2, 31
    s_lshl_b32 s45, s45, 7
    s_add_u32 s45, s45, 23117824
    s_cmp_lg_u32 s30, 0
    s_cbranch_scc1 CV_w
    s_and_b32 s36, s2, 7
    s_lshl_b32 s36, s36, 12
    s_add_u32 s36, s36, 23068672
    v_lshlrev_b32 v9, 7, v1
    v_add_u32 v9, s36, v9
    s_mov_b32 s53, 0
    s_add_u32 s54, s52, 0
    s_bfm_b64 exec, 32, 0
poll_2:
    buffer_load_dword v8, v9, s[56:59], 0 offen sc1
    s_waitcnt vmcnt(0)
    v_xor_b32 v8, s54, v8
    v_cmp_eq_u32 vcc, 0, v8
    s_nop 0
    s_cmp_eq_u64 vcc, exec
    s_cbranch_scc1 pok_3
    s_sleep 5
    s_add_u32 s53, s53, 1
    s_cmp_lt_u32 s53, s61
    s_cbranch_scc1 poll_2
    s_mov_b32 s61, 0
pok_3:
    s_mov_b64 exec, -1
    v_mov_b32 v8, 162832
    v_mov_b32 v9, 1
    s_waitcnt lgkmcnt(0)
    ds_write_b32 v8, v9
CV_w:
    v_mov_b32 v8, 162832
spin_4:
    ds_read_b32 v9, v8
    s_waitcnt lgkmcnt(0)
    v_readfirstlane_b32 s53, v9
    s_nop 0
    s_cmp_ge_u32 s53, 1
    s_cbranch_scc0 spin_4
    buffer_load_dwordx4 v[16:19], v2, s[16:19], 0 offen offset:0 sc1 nt
    buffer_load_dwordx4 v[20:23], v2, s[16:19], 0 offen offset:1024 sc1 nt
    buffer_load_dwordx4 v[24:27], v2, s[16:19], 0 offen offset:2048 sc1 nt
    buffer_load_dwordx4 v[28:31], v2, s[16:19], 0 offen offset:3072 sc1 nt
    s_waitcnt vmcnt(3)
    ds_write_b128 v12, v[16:19] offset:16640
    s_waitcnt vmcnt(2)
    ds_write_b128 v12, v[20:23] offset:18176
    s_waitcnt vmcnt(1)
    ds_write_b128 v12, v[24:27] offset:19712
    s_waitcnt vmcnt(0)
    ds_write_b128 v12, v[28:31] offset:21248
    v_mov_b32 v8, 162836
    v_mov_b32 v9, 1
    s_mov_b64 exec, 1
    ds_add_u32 v8, v9
    s_mov_b64 exec, -1
    s_waitcnt lgkmcnt(0)
    ds_read_b128 v[136:139], v33 offset:21248
    ds_read_b128 v[140:143], v33 offset:19712
    ds_read_b128 v[144:147], v33 offset:18176
    ds_read_b128 v[148:151], v33 offset:16640
    s_waitcnt lgkmcnt(3)
    v_mfma_f32_16x16x32_bf16 v[40:43], v[152:155], v[136:139], 0
    v_mfma_f32_16x16x32_bf16 v[44:47], v[156:159], v[136:139], 0
    s_waitcnt lgkmcnt(2)
    v_mfma_f32_16x16x32_bf16 v[48:51], v[152:155], v[140:143], 0
    v_mfma_f32_16x16x32_bf16 v[52:55], v[156:159], v[140:143], 0
    s_waitcnt lgkmcnt(1)
    v_mfma_f32_16x16x32_bf16 v[56:59], v[152:155], v[144:147], 0
    v_mfma_f32_16x16x32_bf16 v[60:63], v[156:159], v[144:147], 0
    s_waitcnt lgkmcnt(0)
    v_mfma_f32_16x16x32_bf16 v[64:67], v[152:155], v[148:151], 0
    v_mfma_f32_16x16x32_bf16 v[68:71], v[156:159], v[148:151], 0
    s_mov_b32 s43, 0
CV_r:
    s_waitcnt lgkmcnt(0)
    v_mfma_f32_16x16x32_bf16 v[40:43], v[72:75], v[136:139], v[40:43]
    v_mfma_f32_16x16x32_bf16 v[48:51], v[72:75], v[140:143], v[48:51]
    v_mfma_f32_16x16x32_bf16 v[56:59], v[72:75], v[144:147], v[56:59]
    v_mfma_f32_16x16x32_bf16 v[64:67], v[72:75], v[148:151], v[64:67]
    v_mfma_f32_16x16x32_bf16 v[44:47], v[76:79], v[136:139], v[44:47]
    v_mfma_f32_16x16x32_bf16 v[52:55], v[76:79], v[140:143], v[52:55]
    v_mfma_f32_16x16x32_bf16 v[60:63], v[76:79], v[144:147], v[60:63]
    v_mfma_f32_16x16x32_bf16 v[68:71], v[76:79], v[148:151], v[68:71]
    v_mfma_f32_16x16x32_bf16 v[48:51], v[80:83], v[136:139], v[48:51]
    v_mfma_f32_16x16x32_bf16 v[56:59], v[80:83], v[140:143], v[56:59]
    v_mfma_f32_16x16x32_bf16 v[64:67], v[80:83], v[144:147], v[64:67]
    v_mfma_f32_16x16x32_bf16 v[52:55], v[84:87], v[136:139], v[52:55]
    v_mfma_f32_16x16x32_bf16 v[60:63], v[84:87], v[140:143], v[60:63]
    v_mfma_f32_16x16x32_bf16 v[68:71], v[84:87], v[144:147], v[68:71]
    v_mfma_f32_16x16x32_bf16 v[56:59], v[88:91], v[136:139], v[56:59]
    v_mfma_f32_16x16x32_bf16 v[64:67], v[88:91], v[140:143], v[64:67]
    v_mfma_f32_16x16x32_bf16 v[60:63], v[92:95], v[136:139], v[60:63]
    v_mfma_f32_16x16x32_bf16 v[68:71], v[92:95], v[140:143], v[68:71]
    v_mfma_f32_16x16x32_bf16 v[64:67], v[96:99], v[136:139], v[64:67]
    v_mfma_f32_16x16x32_bf16 v[68:71], v[100:103], v[136:139], v[68:71]
    ds_read_b128 v[152:155], v33 offset:21344
    ds_read_b128 v[156:159], v33 offset:19808
    ds_read_b128 v[160:163], v33 offset:18272
    ds_read_b128 v[164:167], v33 offset:16736
    ds_read_b64 v[104:105], v32 offset:64
    ds_read_b64 v[106:107], v32 offset:72
    ds_read_b64 v[108:109], v32 offset:96
    ds_read_b64 v[110:111], v32 offset:104
    ds_read_b64 v[112:113], v32 offset:1088
    ds_read_b64 v[114:115], v32 offset:1096
    ds_read_b64 v[116:117], v32 offset:1120
    ds_read_b64 v[118:119], v32 offset:1128
    ds_read_b64 v[120:121], v32 offset:2112
    ds_read_b64 v[122:123], v32 offset:2120
    ds_read_b64 v[124:125], v32 offset:2144
    ds_read_b64 v[126:127], v32 offset:2152
    ds_read_b64 v[128:129], v32 offset:3136
    ds_read_b64 v[130:131], v32 offset:3144
    ds_read_b64 v[132:133], v32 offset:3168
    ds_read_b64 v[134:135], v32 offset:3176
    s_waitcnt lgkmcnt(0)
    v_mfma_f32_16x16x32_bf16 v[40:43], v[104:107], v[152:155], v[40:43]
    v_mfma_f32_16x16x32_bf16 v[48:51], v[104:107], v[156:159], v[48:51]
    v_mfma_f32_16x16x32_bf16 v[56:59], v[104:107], v[160:163], v[56:59]
    v_mfma_f32_16x16x32_bf16 v[64:67], v[104:107], v[164:167], v[64:67]
    v_mfma_f32_16x16x32_bf16 v[44:47], v[108:111], v[152:155], v[44:47]
    v_mfma_f32_16x16x32_bf16 v[52:55], v[108:111], v[156:159], v[52:55]
    v_mfma_f32_16x16x32_bf16 v[60:63], v[108:111], v[160:163], v[60:63]
    v_mfma_f32_16x16x32_bf16 v[68:71], v[108:111], v[164:167], v[68:71]
    v_mfma_f32_16x16x32_bf16 v[48:51], v[112:115], v[152:155], v[48:51]
    v_mfma_f32_16x16x32_bf16 v[56:59], v[112:115], v[156:159], v[56:59]
    v_mfma_f32_16x16x32_bf16 v[64:67], v[112:115], v[160:163], v[64:67]
    v_mfma_f32_16x16x32_bf16 v[52:55], v[116:119], v[152:155], v[52:55]
    v_mfma_f32_16x16x32_bf16 v[60:63], v[116:119], v[156:159], v[60:63]
    v_mfma_f32_16x16x32_bf16 v[68:71], v[116:119], v[160:163], v[68:71]
    v_mfma_f32_16x16x32_bf16 v[56:59], v[120:123], v[152:155], v[56:59]
    v_mfma_f32_16x16x32_bf16 v[64:67], v[120:123], v[156:159], v[64:67]
    v_mfma_f32_16x16x32_bf16 v[60:63], v[124:127], v[152:155], v[60:63]
    v_mfma_f32_16x16x32_bf16 v[68:71], v[124:127], v[156:159], v[68:71]
    v_mfma_f32_16x16x32_bf16 v[64:67], v[128:131], v[152:155], v[64:67]
    v_mfma_f32_16x16x32_bf16 v[68:71], v[132:135], v[152:155], v[68:71]
    ds_read_b128 v[136:139], v33 offset:21440
    ds_read_b128 v[140:143], v33 offset:19904
    ds_read_b128 v[144:147], v33 offset:18368
    ds_read_b128 v[148:151], v33 offset:16832
    ds_read_b64 v[72:73], v32 offset:128
    ds_read_b64 v[74:75], v32 offset:136
    ds_read_b64 v[76:77], v32 offset:160
    ds_read_b64 v[78:79], v32 offset:168
    ds_read_b64 v[80:81], v32 offset:1152
    ds_read_b64 v[82:83], v32 offset:1160
    ds_read_b64 v[84:85], v32 offset:1184
    ds_read_b64 v[86:87], v32 offset:1192
    ds_read_b64 v[88:89], v32 offset:2176
    ds_read_b64 v[90:91], v32 offset:2184
    ds_read_b64 v[92:93], v32 offset:2208
    ds_read_b64 v[94:95], v32 offset:2216
    ds_read_b64 v[96:97], v32 offset:3200
    ds_read_b64 v[98:99], v32 offset:3208
    ds_read_b64 v[100:101], v32 offset:3232
    ds_read_b64 v[102:103], v32 offset:3240
    v_add_u32 v32, 128, v32
    v_add_u32 v33, 192, v33
    s_add_u32 s43, s43, 1
    s_cmp_lt_u32 s43, 4
    s_cbranch_scc1 CV_r
CV_l:
    s_waitcnt lgkmcnt(10)
    v_mfma_f32_16x16x32_bf16 v[40:43], v[72:75], v[136:139], v[40:43]
    ds_read_b128 v[152:155], v33 offset:21344
    v_mfma_f32_16x16x32_bf16 v[48:51], v[72:75], v[140:143], v[48:51]
    ds_read_b128 v[156:159], v33 offset:19808
    s_cmp_eq_u32 s43, 5
    v_mfma_f32_16x16x32_bf16 v[56:59], v[72:75], v[144:147], v[56:59]
    ds_read_b128 v[160:163], v33 offset:18272
    s_cselect_b64 exec, 1, 0
    buffer_load_dword v12, v35, s[56:59], s45 offen sc1
    s_mov_b64 exec, -1
    v_mfma_f32_16x16x32_bf16 v[64:67], v[72:75], v[148:151], v[64:67]
    ds_read_b128 v[164:167], v33 offset:16736
    v_mfma_f32_16x16x32_bf16 v[44:47], v[76:79], v[136:139], v[44:47]
    ds_read_b64 v[104:105], v32 offset:64
    v_mfma_f32_16x16x32_bf16 v[52:55], v[76:79], v[140:143], v[52:55]
    ds_read_b64 v[106:107], v32 offset:72
    v_mfma_f32_16x16x32_bf16 v[60:63], v[76:79], v[144:147], v[60:63]
    ds_read_b64 v[108:109], v32 offset:96
    v_mfma_f32_16x16x32_bf16 v[68:71], v[76:79], v[148:151], v[68:71]
    ds_read_b64 v[110:111], v32 offset:104
    v_mfma_f32_16x16x32_bf16 v[48:51], v[80:83], v[136:139], v[48:51]
    ds_read_b64 v[112:113], v32 offset:1088
    v_mfma_f32_16x16x32_bf16 v[56:59], v[80:83], v[140:143], v[56:59]
    ds_read_b64 v[114:115], v32 offset:1096
    s_waitcnt lgkmcnt(10)
    v_mfma_f32_16x16x32_bf16 v[64:67], v[80:83], v[144:147], v[64:67]
    ds_read_b64 v[116:117], v32 offset:1120
    v_mfma_f32_16x16x32_bf16 v[52:55], v[84:87], v[136:139], v[52:55]
    ds_read_b64 v[118:119], v32 offset:1128
    v_mfma_f32_16x16x32_bf16 v[60:63], v[84:87], v[140:143], v[60:63]
    ds_read_b64 v[120:121], v32 offset:2112
    v_mfma_f32_16x16x32_bf16 v[68:71], v[84:87], v[144:147], v[68:71]
    ds_read_b64 v[122:123], v32 offset:2120
    v_mfma_f32_16x16x32_bf16 v[56:59], v[88:91], v[136:139], v[56:59]
    ds_read_b64 v[124:125], v32 offset:2144
    v_mfma_f32_16x16x32_bf16 v[64:67], v[88:91], v[140:143], v[64:67]
    ds_read_b64 v[126:127], v32 offset:2152
    v_mfma_f32_16x16x32_bf16 v[60:63], v[92:95], v[136:139], v[60:63]
    ds_read_b64 v[128:129], v32 offset:3136
    v_mfma_f32_16x16x32_bf16 v[68:71], v[92:95], v[140:143], v[68:71]
    ds_read_b64 v[130:131], v32 offset:3144
    v_mfma_f32_16x16x32_bf16 v[64:67], v[96:99], v[136:139], v[64:67]
    ds_read_b64 v[132:133], v32 offset:3168
    v_mfma_f32_16x16x32_bf16 v[68:71], v[100:103], v[136:139], v[68:71]
    ds_read_b64 v[134:135], v32 offset:3176
    s_waitcnt lgkmcnt(10)
    v_mfma_f32_16x16x32_bf16 v[40:43], v[104:107], v[152:155], v[40:43]
    ds_read_b128 v[136:139], v33 offset:21440
    v_mfma_f32_16x16x32_bf16 v[48:51], v[104:107], v[156:159], v[48:51]
    ds_read_b128 v[140:143], v33 offset:19904
    v_mfma_f32_16x16x32_bf16 v[56:59], v[104:107], v[160:163], v[56:59]
    ds_read_b128 v[144:147], v33 offset:18368
    v_mfma_f32_16x16x32_bf16 v[64:67], v[104:107], v[164:167], v[64:67]
    ds_read_b128 v[148:151], v33 offset:16832
    v_mfma_f32_16x16x32_bf16 v[44:47], v[108:111], v[152:155], v[44:47]
    ds_read_b64 v[72:73], v32 offset:128
    v_mfma_f32_16x16x32_bf16 v[52:55], v[108:111], v[156:159], v[52:55]
    ds_read_b64 v[74:75], v32 offset:136
    v_add_u32 v33, 192, v33
    v_mfma_f32_16x16x32_bf16 v[60:63], v[108:111], v[160:163], v[60:63]
    ds_read_b64 v[76:77], v32 offset:160
    s_add_u32 s43, s43, 1
    v_mfma_f32_16x16x32_bf16 v[68:71], v[108:111], v[164:167], v[68:71]
    ds_read_b64 v[78:79], v32 offset:168
    s_cmp_lt_u32 s43, 8
    v_mfma_f32_16x16x32_bf16 v[48:51], v[112:115], v[152:155], v[48:51]
    ds_read_b64 v[80:81], v32 offset:1152
    v_mfma_f32_16x16x32_bf16 v[56:59], v[112:115], v[156:159], v[56:59]
    ds_read_b64 v[82:83], v32 offset:1160
    s_waitcnt lgkmcnt(10)
    v_mfma_f32_16x16x32_bf16 v[64:67], v[112:115], v[160:163], v[64:67]
    ds_read_b64 v[84:85], v32 offset:1184
    v_mfma_f32_16x16x32_bf16 v[52:55], v[116:119], v[152:155], v[52:55]
    ds_read_b64 v[86:87], v32 offset:1192
    v_mfma_f32_16x16x32_bf16 v[60:63], v[116:119], v[156:159], v[60:63]
    ds_read_b64 v[88:89], v32 offset:2176
    v_mfma_f32_16x16x32_bf16 v[68:71], v[116:119], v[160:163], v[68:71]
    ds_read_b64 v[90:91], v32 offset:2184
    v_mfma_f32_16x16x32_bf16 v[56:59], v[120:123], v[152:155], v[56:59]
    ds_read_b64 v[92:93], v32 offset:2208
    v_mfma_f32_16x16x32_bf16 v[64:67], v[120:123], v[156:159], v[64:67]
    ds_read_b64 v[94:95], v32 offset:2216
    v_mfma_f32_16x16x32_bf16 v[60:63], v[124:127], v[152:155], v[60:63]
    ds_read_b64 v[96:97], v32 offset:3200
    v_mfma_f32_16x16x32_bf16 v[68:71], v[124:127], v[156:159], v[68:71]
    ds_read_b64 v[98:99], v32 offset:3208
    v_mfma_f32_16x16x32_bf16 v[64:67], v[128:131], v[152:155], v[64:67]
    ds_read_b64 v[100:101], v32 offset:3232
    v_mfma_f32_16x16x32_bf16 v[68:71], v[132:135], v[152:155], v[68:71]
    ds_read_b64 v[102:103], v32 offset:3240
    v_add_u32 v32, 128, v32
    s_cbranch_scc1 CV_l
    s_waitcnt lgkmcnt(0)
    v_cvt_pk_bf16_f32 v16, v40, v41
    v_cvt_pk_bf16_f32 v17, v42, v43
    ds_write_b64 v170, v[16:17] offset:0
    v_cvt_pk_bf16_f32 v18, v44, v45
    v_cvt_pk_bf16_f32 v19, v46, v47
    ds_write_b64 v170, v[18:19] offset:32
    v_cvt_pk_bf16_f32 v20, v48, v49
    v_cvt_pk_bf16_f32 v21, v50, v51
    ds_write_b64 v170, v[20:21] offset:1152
    v_cvt_pk_bf16_f32 v22, v52, v53
    v_cvt_pk_bf16_f32 v23, v54, v55
    ds_write_b64 v170, v[22:23] offset:1184
    v_cvt_pk_bf16_f32 v24, v56, v57
    v_cvt_pk_bf16_f32 v25, v58, v59
    ds_write_b64 v170, v[24:25] offset:2304
    v_cvt_pk_bf16_f32 v26, v60, v61
    v_cvt_pk_bf16_f32 v27, v62, v63
    ds_write_b64 v170, v[26:27] offset:2336
    v_cvt_pk_bf16_f32 v28, v64, v65
    v_cvt_pk_bf16_f32 v29, v66, v67
    ds_write_b64 v170, v[28:29] offset:3456
    v_cvt_pk_bf16_f32 v30, v68, v69
    v_cvt_pk_bf16_f32 v31, v70, v71
    ds_write_b64 v170, v[30:31] offset:3488
    s_mov_b32 s53, 0
    s_waitcnt vmcnt(0)
CV_v:
    v_readfirstlane_b32 s94, v12
    s_nop 0
    s_sub_u32 s94, s94, s52
    s_and_b32 s37, s94, 0xfffffe01
    s_cbranch_scc0 CV_k
    buffer_load_dword v12, v35, s[56:59], s45 offen sc1
    s_waitcnt vmcnt(0)
    s_add_u32 s53, s53, 1
    s_cmp_lt_u32 s53, s61
    s_cbranch_scc1 CV_v
    s_mov_b32 s61, 0
    s_mov_b32 s94, 0
CV_k:
    s_lshr_b32 s94, s94, 1
    s_add_u32 s37, s94, 65536
    v_mov_b32 v8, 162844
    v_mov_b32 v9, s37
    ds_write_b32 v8, v9
    s_cmp_gt_u32 s94, 10
    s_cselect_b32 s37, 0x2000, 0
    s_xor_b32 s44, s44, s37
    s_and_b32 s45, s44, 0x2000
    s_xor_b32 s45, s45, 8192
    s_lshr_b32 s37, s30, 1
    s_lshl_b32 s37, s37, 12
    s_add_u32 s45, s45, s37
    s_and_b32 s37, s2, 7
    s_lshl_b32 s37, s37, 7
    s_add_u32 s45, s45, s37
    s_add_u32 s45, s45, 23101440
    v_lshlrev_b32 v6, 10, v1
    v_mov_b32 v7, 1
    v_mov_b32 v8, 162824
    v_mov_b32 v9, 1
    s_waitcnt lgkmcnt(0)
    s_mov_b64 exec, 1
    ds_add_u32 v8, v9
    s_mov_b64 exec, -1
    v_mov_b32 v8, 162824
spin_5:
    ds_read_b32 v9, v8
    s_waitcnt lgkmcnt(0)
    v_readfirstlane_b32 s53, v9
    s_nop 0
    s_cmp_ge_u32 s53, 6
    s_cbranch_scc0 spin_5
    ds_read_b64_tr_b16 v[104:105], v168 offset:0
    ds_read_b64_tr_b16 v[106:107], v168 offset:144
    ds_read_b64_tr_b16 v[108:109], v168 offset:288
    ds_read_b64_tr_b16 v[110:111], v168 offset:432
    ds_read_b64_tr_b16 v[112:113], v168 offset:576
    ds_read_b64_tr_b16 v[114:115], v168 offset:720
    ds_read_b64_tr_b16 v[116:117], v168 offset:864
    ds_read_b64_tr_b16 v[118:119], v168 offset:1008
    s_waitcnt lgkmcnt(7)
    v_or_b32 v104, v34, v104
    buffer_store_dwordx2 v[104:105], v169, s[12:15], s44 offen sc1
    s_add_u32 s44, s44, 262144
    s_waitcnt lgkmcnt(6)
    v_or_b32 v106, v34, v106
    buffer_store_dwordx2 v[106:107], v169, s[12:15], s44 offen sc1
    s_add_u32 s44, s44, 16515072
    s_waitcnt lgkmcnt(5)
    v_or_b32 v108, v34, v108
    buffer_store_dwordx2 v[108:109], v169, s[12:15], s44 offen sc1
    s_add_u32 s44, s44, 262144
    s_waitcnt lgkmcnt(4)
    v_or_b32 v110, v34, v110
    buffer_store_dwordx2 v[110:111], v169, s[12:15], s44 offen sc1
    s_add_u32 s44, s44, 16515072
    s_waitcnt lgkmcnt(3)
    v_or_b32 v112, v34, v112
    buffer_store_dwordx2 v[112:113], v169, s[12:15], s44 offen sc1
    s_add_u32 s44, s44, 262144
    s_waitcnt lgkmcnt(2)
    v_or_b32 v114, v34, v114
    buffer_store_dwordx2 v[114:115], v169, s[12:15], s44 offen sc1
    s_add_u32 s44, s44, 16515072
    s_waitcnt lgkmcnt(1)
    v_or_b32 v116, v34, v116
    buffer_store_dwordx2 v[116:117], v169, s[12:15], s44 offen sc1
    s_add_u32 s44, s44, 262144
    s_waitcnt lgkmcnt(0)
    v_or_b32 v118, v34, v118
    buffer_store_dwordx2 v[118:119], v169, s[12:15], s44 offen sc1
    s_add_u32 s44, s44, 16515072
    v_mov_b32 v8, 162836
    v_mov_b32 v9, 1
    s_mov_b64 exec, 1
    ds_add_u32 v8, v9
    s_mov_b64 exec, -1
    s_mov_b64 exec, 0xf
    s_waitcnt vmcnt(0)
    buffer_atomic_add v7, v6, s[56:59], s45 offen sc1
    s_mov_b64 exec, -1
    s_branch FR_end
FR_b:
    s_cmp_ge_u32 s2, 32
    s_cbranch_scc1 FB_np
    s_cmp_lg_u32 s30, 5
    s_cbranch_scc1 FB_np
    s_and_b32 s42, s2, 7
    s_lshl_b32 s42, s42, 10
    s_lshr_b32 s43, s2, 3
    s_lshl_b32 s43, s43, 14
    s_add_u32 s42, s42, s43
    s_add_u32 s42, s42, 39714816
    v_mov_b32 v14, 0
    s_mov_b64 exec, 1
    s_mov_b32 s46, -1
    s_mov_b32 s47, -1
    s_add_u32 s48, s4, s42
    s_addc_u32 s49, s5, 0
    s_load_dword s101, s[48:49], 384
    s_waitcnt lgkmcnt(0)
    s_memtime s[34:35]
    s_waitcnt lgkmcnt(0)
    s_load_dword s101, s[48:49], 0
    s_waitcnt lgkmcnt(0)
    s_memtime s[36:37]
    s_waitcnt lgkmcnt(0)
    s_sub_u32 s43, s36, s34
    s_min_u32 s46, s46, s43
    s_load_dword s101, s[48:49], 8192
    s_waitcnt lgkmcnt(0)
    s_memtime s[34:35]
    s_waitcnt lgkmcnt(0)
    s_sub_u32 s43, s34, s36
    s_min_u32 s47, s47, s43
    s_load_dword s101, s[48:49], 128
    s_waitcnt lgkmcnt(0)
    s_memtime s[36:37]
    s_waitcnt lgkmcnt(0)
    s_sub_u32 s43, s36, s34
    s_min_u32 s46, s46, s43
    s_load_dword s101, s[48:49], 8320
    s_waitcnt lgkmcnt(0)
    s_memtime s[34:35]
    s_waitcnt lgkmcnt(0)
    s_sub_u32 s43, s34, s36
    s_min_u32 s47, s47, s43
    s_cmp_lt_u32 s47, s46
    s_cselect_b32 s45, 1, 0
    s_lshr_b32 s46, s28, 2
    s_xor_b32 s45, s45, s46
    s_and_b32 s45, s45, 1
    s_lshl_b32 s45, s45, 8
    s_or_b32 s43, s45, 1
    v_mov_b32 v12, s43
    buffer_atomic_add v12, v14, s[84:87], 0 offen offset:4 sc0 sc1
    s_waitcnt vmcnt(0)
    v_readfirstlane_b32 s36, v12
    s_nop 0
    s_add_u32 s36, s36, s43
    s_and_b32 s37, s36, 255
    s_cmp_lg_u32 s37, 21
    s_cbranch_scc1 FB_np
    s_lshr_b32 s36, s36, 8
    s_lshl_b32 s36, s36, 1
    s_add_u32 s36, s36, s52
    s_bfm_b64 exec, 32, 0
    v_mov_b32 v12, s36
    v_lshlrev_b32 v13, 7, v1
    s_mov_b32 s36, 23117824
    buffer_store_dword v12, v13, s[56:59], s36 offen sc1
FB_np:
    s_mov_b64 exec, -1
    s_getpc_b64 s[34:35]
K_tpc:
    s_lshl_b32 s36, s29, 2
    s_and_b32 s37, s28, 3
    s_add_u32 s36, s36, s37
    s_lshl_b32 s36, s36, 6
    s_add_u32 s36, s36, K_tab-K_tpc
    s_add_u32 s34, s34, s36
    s_addc_u32 s35, s35, 0
    v_and_b32 v248, 31, v1
    v_lshlrev_b32 v248, 1, v248
    global_load_ushort v251, v248, s[34:35]
    v_lshrrev_b32 v253, 3, v1
    v_lshlrev_b32 v238, 11, v253
    v_and_b32 v253, 6, v253
    v_and_b32 v254, 7, v1
    v_xor_b32 v253, v253, v254
    v_lshl_add_u32 v238, v253, 4, v238
    v_lshrrev_b32 v253, 4, v1
    v_lshlrev_b32 v239, 11, v253
    v_add_u32 v253, 0, v253
    v_lshlrev_b32 v253, 1, v253
    v_and_b32 v254, 15, v1
    v_xor_b32 v253, v253, v254
    v_lshl_add_u32 v239, v253, 4, v239
    v_lshrrev_b32 v253, 4, v1
    v_lshlrev_b32 v240, 11, v253
    v_add_u32 v253, 4, v253
    v_lshlrev_b32 v253, 1, v253
    v_and_b32 v254, 15, v1
    v_xor_b32 v253, v253, v254
    v_lshl_add_u32 v240, v253, 4, v240
    v_add_u32 v254, 0, v1
    v_mul_u32_u24 v253, 2341, v254
    v_lshrrev_b32 v253, 16, v253
    v_mul_u32_u24 v241, 28, v253
    v_sub_u32 v254, v254, v241
    v_mul_u32_u24 v241, 7168, v253
    v_lshrrev_b32 v253, 1, v253
    v_and_b32 v253, 2, v253
    v_xor_b32 v254, v254, v253
    v_lshl_add_u32 v241, v254, 4, v241
    v_add_u32 v254, 64, v1
    v_mul_u32_u24 v253, 2341, v254
    v_lshrrev_b32 v253, 16, v253
    v_mul_u32_u24 v242, 28, v253
    v_sub_u32 v254, v254, v242
    v_mul_u32_u24 v242, 7168, v253
    v_lshrrev_b32 v253, 1, v253
    v_and_b32 v253, 2, v253
    v_xor_b32 v254, v254, v253
    v_lshl_add_u32 v242, v254, 4, v242
    v_add_u32 v254, 128, v1
    v_mul_u32_u24 v253, 2341, v254
    v_lshrrev_b32 v253, 16, v253
    v_mul_u32_u24 v243, 28, v253
    v_sub_u32 v254, v254, v243
    v_mul_u32_u24 v243, 7168, v253
    v_lshrrev_b32 v253, 1, v253
    v_and_b32 v253, 2, v253
    v_xor_b32 v254, v254, v253
    v_lshl_add_u32 v243, v254, 4, v243
    v_add_u32 v254, 192, v1
    v_mul_u32_u24 v253, 2341, v254
    v_lshrrev_b32 v253, 16, v253
    v_mul_u32_u24 v244, 28, v253
    v_sub_u32 v254, v254, v244
    v_mul_u32_u24 v244, 7168, v253
    v_lshrrev_b32 v253, 1, v253
    v_and_b32 v253, 2, v253
    v_xor_b32 v254, v254, v253
    v_lshl_add_u32 v244, v254, 4, v244
    v_add_u32 v254, 256, v1
    v_mul_u32_u24 v253, 2341, v254
    v_lshrrev_b32 v253, 16, v253
    v_mul_u32_u24 v245, 28, v253
    v_sub_u32 v254, v254, v245
    v_mul_u32_u24 v245, 7168, v253
    v_lshrrev_b32 v253, 1, v253
    v_and_b32 v253, 2, v253
    v_xor_b32 v254, v254, v253
    v_lshl_add_u32 v245, v254, 4, v245
    v_add_u32 v254, 320, v1
    v_mul_u32_u24 v253, 2341, v254
    v_lshrrev_b32 v253, 16, v253
    v_mul_u32_u24 v246, 28, v253
    v_sub_u32 v254, v254, v246
    v_mul_u32_u24 v246, 7168, v253
    v_lshrrev_b32 v253, 1, v253
    v_and_b32 v253, 2, v253
    v_xor_b32 v254, v254, v253
    v_lshl_add_u32 v246, v254, 4, v246
    v_add_u32 v254, 384, v1
    v_mul_u32_u24 v253, 2341, v254
    v_lshrrev_b32 v253, 16, v253
    v_mul_u32_u24 v247, 28, v253
    v_sub_u32 v254, v254, v247
    v_mul_u32_u24 v247, 7168, v253
    v_lshrrev_b32 v253, 1, v253
    v_and_b32 v253, 2, v253
    v_xor_b32 v254, v254, v253
    v_lshl_add_u32 v247, v254, 4, v247
    s_cmp_ge_u32 s30, 6
    s_cbranch_scc1 FB_cs
    s_cmp_lg_u32 s30, 4
    s_cbranch_scc1 FB_ni
    v_mov_b32 v12, s52
    s_lshr_b32 s53, s28, 3
    s_lshl_b32 s53, s53, 2
    s_and_b32 s54, s28, 3
    s_add_u32 s53, s53, s54
    s_lshl_b32 s53, s53, 24
    s_lshr_b32 s54, s28, 2
    s_xor_b32 s54, s54, s94
    s_and_b32 s54, s54, 1
    s_lshl_b32 s54, s54, 13
    s_add_u32 s37, s53, s54
    s_add_u32 s37, s37, 33554432
    s_andn2_b32 s37, s37, 0x2000
    s_lshl_b32 s53, s29, 7
    s_add_u32 s37, s37, s53
    s_add_u32 s37, s37, 6029312
    v_and_b32 v13, 1, v1
    v_lshlrev_b32 v13, 13, v13
    v_lshrrev_b32 v14, 1, v1
    v_lshl_add_u32 v13, v14, 22, v13
    s_mov_b64 exec, 0xf
    buffer_store_dword v12, v13, s[56:59], s37 offen sc1
    s_cmp_lg_u32 s28, 0
    s_cbranch_scc1 FB_n2
    s_add_u32 s37, s53, 23121920
    s_mov_b64 exec, 1
    buffer_store_dword v12, v13, s[56:59], s37 offen sc1
FB_n2:
    s_mov_b64 exec, -1
FB_ni:
    v_mov_b32 v6, 162836
spin_7:
    s_sleep 2
    ds_read_b32 v7, v6
    s_waitcnt lgkmcnt(0)
    v_readfirstlane_b32 s53, v7
    s_nop 0
    s_cmp_ge_u32 s53, 4
    s_cbranch_scc0 spin_7
    s_load_dwordx2 s[48:49], s[0:1], 64
    s_lshl_b32 s45, s2, 1
    s_and_b32 s50, s30, 1
    s_add_u32 s45, s45, s50
    s_mul_i32 s45, s45, 4096
    s_mov_b32 s50, 2097152
    s_mov_b32 s51, 0x20000
    s_waitcnt lgkmcnt(0)
    buffer_load_dwordx4 v[20:23], v2, s[48:51], s45 offen offset:0
    buffer_load_dwordx4 v[20:23], v2, s[48:51], s45 offen offset:1024
    buffer_load_dwordx4 v[20:23], v2, s[48:51], s45 offen offset:2048
    buffer_load_dwordx4 v[20:23], v2, s[48:51], s45 offen offset:3072
    v_mov_b32 v6, 1
    v_mov_b32 v7, 162824
    s_mov_b64 exec, 1
    s_waitcnt vmcnt(0)
    ds_add_u32 v7, v6
    s_mov_b64 exec, -1
    v_bfe_u32 v252, v251, 2, 2
    v_lshlrev_b32 v248, 14, v252
    v_and_b32 v252, 3, v251
    v_lshl_add_u32 v248, v252, 11, v248
    v_bfe_u32 v252, v251, 7, 3
    v_lshlrev_b32 v249, 14, v252
    v_bfe_u32 v252, v251, 4, 3
    v_lshl_add_u32 v249, v252, 10, v249
    v_bfe_u32 v252, v251, 13, 3
    v_lshlrev_b32 v250, 14, v252
    v_bfe_u32 v252, v251, 10, 3
    v_lshl_add_u32 v250, v252, 10, v250
    v_mov_b32 v6, 162840
spin_9:
    s_sleep 4
    ds_read_b32 v7, v6
    s_waitcnt lgkmcnt(0)
    v_readfirstlane_b32 s53, v7
    s_nop 0
    s_cmp_ge_u32 s53, 2
    s_cbranch_scc0 spin_9
    s_call_b64 s[76:77], SUB_w1_regs
    s_call_b64 s[76:77], SUB_park
    v_mov_b32 v6, 162840
spin_10:
    s_sleep 3
    ds_read_b32 v7, v6
    s_waitcnt lgkmcnt(0)
    v_readfirstlane_b32 s53, v7
    s_nop 0
    s_cmp_ge_u32 s53, 4
    s_cbranch_scc0 spin_10
    s_mov_b64 s[12:13], s[68:69]
    s_mov_b32 s14, 2097152
    s_mov_b32 s15, 0x20000
    s_and_b32 s35, s30, 1
    s_mul_i32 s38, s99, 128
    s_mul_i32 s41, s35, 65536
    s_add_u32 s38, s38, s41
    s_mul_i32 s41, s35, 4096
    s_add_u32 s41, s41, 24576
    s_mov_b32 s42, 0
    s_mov_b32 s44, s67
    s_mov_b32 s42, 73728
    s_mov_b32 s44, s67
    s_add_u32 s44, s44, 9
    s_and_b32 s44, s44, 15
    s_call_b64 s[76:77], SUB_w_issue_1
    s_waitcnt vmcnt(8)
    s_mov_b32 s42, 81920
    s_mov_b32 s44, s67
    s_add_u32 s44, s44, 10
    s_and_b32 s44, s44, 15
    s_call_b64 s[76:77], SUB_w_issue_1
    s_waitcnt vmcnt(8)
    s_mov_b32 s42, 90112
    s_mov_b32 s44, s67
    s_add_u32 s44, s44, 11
    s_and_b32 s44, s44, 15
    s_call_b64 s[76:77], SUB_w_issue_1
    s_waitcnt vmcnt(8)
    s_and_b32 s36, s29, 6
    s_cmp_eq_u32 s36, 2
    s_cbranch_scc1 pr_11
    s_call_b64 s[76:77], SUB_park2
pr_11:
    s_call_b64 s[76:77], SUB_w1_put
    s_branch FR_end
FB_cs:
    v_and_b32 v164, 15, v1
    v_mov_b32 v165, 0x3f803f80
    v_cmp_eq_u32 vcc, 0, v164
    s_nop 1
    v_cndmask_b32 v16, 0, v165, vcc
    v_cndmask_b32 v17, 0, v165, vcc
    v_cndmask_b32 v18, 0, v165, vcc
    v_cndmask_b32 v19, 0, v165, vcc
    v_cmp_eq_u32 vcc, 1, v164
    s_nop 1
    v_cndmask_b32 v20, 0, v165, vcc
    v_cndmask_b32 v21, 0, v165, vcc
    v_cndmask_b32 v22, 0, v165, vcc
    v_cndmask_b32 v23, 0, v165, vcc
    v_cmp_eq_u32 vcc, 2, v164
    s_nop 1
    v_cndmask_b32 v24, 0, v165, vcc
    v_cndmask_b32 v25, 0, v165, vcc
    v_cndmask_b32 v26, 0, v165, vcc
    v_cndmask_b32 v27, 0, v165, vcc
    v_cmp_eq_u32 vcc, 3, v164
    s_nop 1
    v_cndmask_b32 v28, 0, v165, vcc
    v_cndmask_b32 v29, 0, v165, vcc
    v_cndmask_b32 v30, 0, v165, vcc
    v_cndmask_b32 v31, 0, v165, vcc
    v_cmp_eq_u32 vcc, 4, v164
    s_nop 1
    v_cndmask_b32 v32, 0, v165, vcc
    v_cndmask_b32 v33, 0, v165, vcc
    v_cndmask_b32 v34, 0, v165, vcc
    v_cndmask_b32 v35, 0, v165, vcc
    v_cmp_eq_u32 vcc, 5, v164
    s_nop 1
    v_cndmask_b32 v36, 0, v165, vcc
    v_cndmask_b32 v37, 0, v165, vcc
    v_cndmask_b32 v38, 0, v165, vcc
    v_cndmask_b32 v39, 0, v165, vcc
    v_cmp_eq_u32 vcc, 6, v164
    s_nop 1
    v_cndmask_b32 v40, 0, v165, vcc
    v_cndmask_b32 v41, 0, v165, vcc
    v_cndmask_b32 v42, 0, v165, vcc
    v_cndmask_b32 v43, 0, v165, vcc
    v_cmp_eq_u32 vcc, 7, v164
    s_nop 1
    v_cndmask_b32 v44, 0, v165, vcc
    v_cndmask_b32 v45, 0, v165, vcc
    v_cndmask_b32 v46, 0, v165, vcc
    v_cndmask_b32 v47, 0, v165, vcc
    v_cmp_eq_u32 vcc, 8, v164
    s_nop 1
    v_cndmask_b32 v48, 0, v165, vcc
    v_cndmask_b32 v49, 0, v165, vcc
    v_cndmask_b32 v50, 0, v165, vcc
    v_cndmask_b32 v51, 0, v165, vcc
    v_cmp_eq_u32 vcc, 9, v164
    s_nop 1
    v_cndmask_b32 v52, 0, v165, vcc
    v_cndmask_b32 v53, 0, v165, vcc
    v_cndmask_b32 v54, 0, v165, vcc
    v_cndmask_b32 v55, 0, v165, vcc
    v_cmp_eq_u32 vcc, 10, v164
    s_nop 1
    v_cndmask_b32 v56, 0, v165, vcc
    v_cndmask_b32 v57, 0, v165, vcc
    v_cndmask_b32 v58, 0, v165, vcc
    v_cndmask_b32 v59, 0, v165, vcc
    v_cmp_eq_u32 vcc, 11, v164
    s_nop 1
    v_cndmask_b32 v60, 0, v165, vcc
    v_cndmask_b32 v61, 0, v165, vcc
    v_cndmask_b32 v62, 0, v165, vcc
    v_cndmask_b32 v63, 0, v165, vcc
    v_cmp_eq_u32 vcc, 12, v164
    s_nop 1
    v_cndmask_b32 v64, 0, v165, vcc
    v_cndmask_b32 v65, 0, v165, vcc
    v_cndmask_b32 v66, 0, v165, vcc
    v_cndmask_b32 v67, 0, v165, vcc
    v_cmp_eq_u32 vcc, 13, v164
    s_nop 1
    v_cndmask_b32 v68, 0, v165, vcc
    v_cndmask_b32 v69, 0, v165, vcc
    v_cndmask_b32 v70, 0, v165, vcc
    v_cndmask_b32 v71, 0, v165, vcc
    s_mov_b32 s35, 0
    v_lshrrev_b32 v253, 2, v1
    v_mul_u32_u24 v144, 128, v253
    v_and_b32 v254, 3, v1
    v_lshl_add_u32 v144, v254, 3, v144
    v_add_u32 v144, 24576, v144
    v_bfe_u32 v253, v253, 1, 2
    s_mul_i32 s36, s35, 4
    s_add_u32 s36, s36, 3
    v_xor_b32 v254, s36, v253
    v_lshl_add_u32 v147, v254, 5, v144
    s_mul_i32 s36, s35, 4
    s_add_u32 s36, s36, 2
    v_xor_b32 v254, s36, v253
    v_lshl_add_u32 v146, v254, 5, v144
    s_mul_i32 s36, s35, 4
    s_add_u32 s36, s36, 1
    v_xor_b32 v254, s36, v253
    v_lshl_add_u32 v145, v254, 5, v144
    s_mul_i32 s36, s35, 4
    s_add_u32 s36, s36, 0
    v_xor_b32 v254, s36, v253
    v_lshl_add_u32 v144, v254, 5, v144
    s_and_b32 s35, s30, 1
    s_mul_i32 s35, s35, 4096
    s_add_u32 s35, s35, 73728
    v_add_u32 v144, s35, v144
    v_add_u32 v145, s35, v145
    v_add_u32 v146, s35, v146
    v_add_u32 v147, s35, v147
    s_mov_b32 s35, 0
    v_lshrrev_b32 v253, 2, v1
    v_mul_u32_u24 v148, 448, v253
    v_and_b32 v254, 3, v1
    v_lshl_add_u32 v148, v254, 3, v148
    v_add_u32 v148, 73728, v148
    s_mul_i32 s36, s35, 224
    v_add_u32 v148, s36, v148
    v_bfe_u32 v253, v1, 4, 1
    v_lshlrev_b32 v253, 5, v253
    s_cmp_eq_u32 s35, 0
    s_cselect_b32 s36, 1, -1
    v_mul_lo_u32 v253, v253, s36
    v_sub_u32 v149, v148, v253
    v_add_u32 v148, v148, v253
    s_and_b32 s35, s30, 1
    s_mul_i32 s35, s35, 14336
    s_add_u32 s35, s35, 32768
    v_add_u32 v148, s35, v148
    v_add_u32 v149, s35, v149
    s_mov_b32 s35, 1
    v_lshrrev_b32 v253, 2, v1
    v_mul_u32_u24 v150, 448, v253
    v_and_b32 v254, 3, v1
    v_lshl_add_u32 v150, v254, 3, v150
    v_add_u32 v150, 73728, v150
    s_mul_i32 s36, s35, 224
    v_add_u32 v150, s36, v150
    v_bfe_u32 v253, v1, 4, 1
    v_lshlrev_b32 v253, 5, v253
    s_cmp_eq_u32 s35, 0
    s_cselect_b32 s36, 1, -1
    v_mul_lo_u32 v253, v253, s36
    v_sub_u32 v151, v150, v253
    v_add_u32 v150, v150, v253
    s_and_b32 s35, s30, 1
    s_mul_i32 s35, s35, 14336
    s_add_u32 s35, s35, 32768
    v_add_u32 v150, s35, v150
    v_add_u32 v151, s35, v151
    v_mov_b32 v156, 0
    v_mov_b32 v157, 0
    v_mov_b32 v158, 0
    v_mov_b32 v159, 0
    v_mov_b32 v160, 0
    v_mov_b32 v161, 0
    v_mov_b32 v162, 0
    v_mov_b32 v163, 0
    v_lshrrev_b32 v166, 4, v1
    v_lshlrev_b32 v166, 4, v166
    v_lshl_add_u32 v166, v164, 6, v166
    v_mov_b32 v165, 0x7f000000
    v_cmp_gt_u32 vcc, 4, v164
    s_nop 1
    v_cndmask_b32 v167, v165, v166, vcc
    v_cmp_gt_u32 vcc, 14, v164
    s_nop 1
    v_cndmask_b32 v168, v165, v166, vcc
    v_mov_b32 v6, 162836
spin_12:
    s_sleep 2
    ds_read_b32 v7, v6
    s_waitcnt lgkmcnt(0)
    v_readfirstlane_b32 s53, v7
    s_nop 0
    s_cmp_ge_u32 s53, 4
    s_cbranch_scc0 spin_12
    s_mov_b64 s[12:13], s[68:69]
    s_mov_b32 s14, 2097152
    s_mov_b32 s15, 0x20000
    s_and_b32 s35, s30, 1
    s_mul_i32 s38, s99, 128
    s_mul_i32 s41, s35, 65536
    s_add_u32 s38, s38, s41
    s_mul_i32 s41, s35, 4096
    s_add_u32 s41, s41, 24576
    s_mov_b32 s42, 0
    s_mov_b32 s44, s67
    s_mov_b32 s42, 73728
    s_mov_b32 s44, s28
    s_add_u32 s19, s41, s42
    s_mul_i32 s16, s44, 131072
    s_add_u32 s16, s16, s38
    s_add_u32 s44, s44, 1
    s_and_b32 s44, s44, 15
    s_add_u32 s42, s42, 8192
    s_cmp_eq_u32 s42, 131072
    s_cselect_b32 s42, 0, s42
    s_mov_b32 m0, s19
    s_mov_b32 s39, s16
    buffer_load_dwordx4 v238, s[12:15], s39 offen lds
    s_add_u32 m0, m0, 1024
    s_add_u32 s39, s39, 16384
    buffer_load_dwordx4 v238, s[12:15], s39 offen lds
    s_add_u32 m0, m0, 1024
    s_add_u32 s39, s39, 16384
    buffer_load_dwordx4 v238, s[12:15], s39 offen lds
    s_add_u32 m0, m0, 1024
    s_add_u32 s39, s39, 16384
    buffer_load_dwordx4 v238, s[12:15], s39 offen lds
    s_mov_b64 s[12:13], s[72:73]
    s_mov_b32 s14, 7340032
    s_mov_b32 s15, 0x20000
    s_and_b32 s35, s30, 1
    s_mul_i32 s38, s29, 448
    s_mul_i32 s41, s35, 229376
    s_add_u32 s38, s38, s41
    s_mul_i32 s41, s35, 14336
    s_add_u32 s41, s41, 73728
    s_mov_b32 s42, 0
    s_mov_b32 s44, 0
    s_mov_b32 s42, 32768
    s_mov_b32 s44, s28
    s_add_u32 s19, s41, s42
    s_mul_i32 s16, s44, 458752
    s_add_u32 s16, s16, s38
    s_add_u32 s44, s44, 1
    s_and_b32 s44, s44, 15
    s_add_u32 s42, s42, 28672
    s_cmp_eq_u32 s42, 86016
    s_cselect_b32 s42, 0, s42
    s_mov_b32 m0, s19
    s_mov_b32 s39, s16
    buffer_load_dwordx4 v241, s[12:15], s39 offen lds
    s_add_u32 m0, m0, 1024
    s_nop 0
    buffer_load_dwordx4 v242, s[12:15], s39 offen lds
    s_add_u32 m0, m0, 1024
    s_nop 0
    buffer_load_dwordx4 v243, s[12:15], s39 offen lds
    s_add_u32 m0, m0, 1024
    s_nop 0
    buffer_load_dwordx4 v244, s[12:15], s39 offen lds
    s_add_u32 m0, m0, 1024
    s_nop 0
    buffer_load_dwordx4 v245, s[12:15], s39 offen lds
    s_add_u32 m0, m0, 1024
    s_nop 0
    buffer_load_dwordx4 v246, s[12:15], s39 offen lds
    s_add_u32 m0, m0, 1024
    s_nop 0
    buffer_load_dwordx4 v247, s[12:15], s39 offen lds
    s_add_u32 m0, m0, 1024
    s_add_u32 s39, s39, 114688
    buffer_load_dwordx4 v241, s[12:15], s39 offen lds
    s_add_u32 m0, m0, 1024
    s_nop 0
    buffer_load_dwordx4 v242, s[12:15], s39 offen lds
    s_add_u32 m0, m0, 1024
    s_nop 0
    buffer_load_dwordx4 v243, s[12:15], s39 offen lds
    s_add_u32 m0, m0, 1024
    s_nop 0
    buffer_load_dwordx4 v244, s[12:15], s39 offen lds
    s_add_u32 m0, m0, 1024
    s_nop 0
    buffer_load_dwordx4 v245, s[12:15], s39 offen lds
    s_add_u32 m0, m0, 1024
    s_nop 0
    buffer_load_dwordx4 v246, s[12:15], s39 offen lds
    s_add_u32 m0, m0, 1024
    s_nop 0
    buffer_load_dwordx4 v247, s[12:15], s39 offen lds
    s_waitcnt vmcnt(14)
    s_setprio 1
    ds_read_b64_tr_b16 v[128:129], v144 offset:0
    ds_read_b64_tr_b16 v[130:131], v144 offset:2048
    ds_read_b64_tr_b16 v[132:133], v145 offset:0
    ds_read_b64_tr_b16 v[134:135], v145 offset:2048
    ds_read_b64_tr_b16 v[136:137], v146 offset:0
    ds_read_b64_tr_b16 v[138:139], v146 offset:2048
    ds_read_b64_tr_b16 v[140:141], v147 offset:0
    ds_read_b64_tr_b16 v[142:143], v147 offset:2048
    s_add_u32 s20, s4, 0x1400000
    s_addc_u32 s21, s5, 0
    s_mov_b32 s22, 0x20000
    s_mov_b32 s23, 0x20000
    s_lshl_b32 s35, s28, 1
    s_and_b32 s36, s30, 1
    s_add_u32 s35, s35, s36
    s_mul_i32 s35, s35, 4096
    s_mul_i32 s36, s29, 256
    s_add_u32 s35, s35, s36
    s_waitcnt lgkmcnt(0)
    v_mfma_f32_16x16x32_bf16 v[160:163], v[128:131], v[16:19], v[160:163]
    v_mfma_f32_16x16x32_bf16 v[160:163], v[132:135], v[20:23], v[160:163]
    v_mfma_f32_16x16x32_bf16 v[160:163], v[136:139], v[24:27], v[160:163]
    v_mfma_f32_16x16x32_bf16 v[160:163], v[140:143], v[28:31], v[160:163]
    s_nop 7
    buffer_store_dwordx4 v[160:163], v167, s[20:23], s35 offen sc1
    s_waitcnt vmcnt(1)
    v_mov_b32 v6, 162840
    v_mov_b32 v7, 1
    s_mov_b64 exec, 1
    ds_add_u32 v6, v7
    s_mov_b64 exec, -1
    ds_read_b64_tr_b16 v[72:73], v148 offset:0
    ds_read_b64_tr_b16 v[74:75], v148 offset:7168
    ds_read_b64_tr_b16 v[76:77], v149 offset:32
    ds_read_b64_tr_b16 v[78:79], v149 offset:7200
    ds_read_b64_tr_b16 v[80:81], v148 offset:64
    ds_read_b64_tr_b16 v[82:83], v148 offset:7232
    ds_read_b64_tr_b16 v[84:85], v149 offset:96
    ds_read_b64_tr_b16 v[86:87], v149 offset:7264
    ds_read_b64_tr_b16 v[88:89], v148 offset:128
    ds_read_b64_tr_b16 v[90:91], v148 offset:7296
    ds_read_b64_tr_b16 v[92:93], v149 offset:160
    ds_read_b64_tr_b16 v[94:95], v149 offset:7328
    ds_read_b64_tr_b16 v[96:97], v148 offset:192
    ds_read_b64_tr_b16 v[98:99], v148 offset:7360
    ds_read_b64_tr_b16 v[100:101], v150 offset:0
    ds_read_b64_tr_b16 v[102:103], v150 offset:7168
    ds_read_b64_tr_b16 v[104:105], v151 offset:32
    ds_read_b64_tr_b16 v[106:107], v151 offset:7200
    ds_read_b64_tr_b16 v[108:109], v150 offset:64
    ds_read_b64_tr_b16 v[110:111], v150 offset:7232
    ds_read_b64_tr_b16 v[112:113], v151 offset:96
    ds_read_b64_tr_b16 v[114:115], v151 offset:7264
    ds_read_b64_tr_b16 v[116:117], v150 offset:128
    ds_read_b64_tr_b16 v[118:119], v150 offset:7296
    ds_read_b64_tr_b16 v[120:121], v151 offset:160
    ds_read_b64_tr_b16 v[122:123], v151 offset:7328
    ds_read_b64_tr_b16 v[124:125], v150 offset:192
    ds_read_b64_tr_b16 v[126:127], v150 offset:7360
    s_add_u32 s20, s4, 0x1420000
    s_addc_u32 s21, s5, 0
    s_mov_b32 s22, 0x70000
    s_mov_b32 s23, 0x20000
    s_lshl_b32 s35, s28, 1
    s_and_b32 s36, s30, 1
    s_add_u32 s35, s35, s36
    s_mul_i32 s35, s35, 14336
    s_mul_i32 s36, s29, 896
    s_add_u32 s35, s35, s36
    s_waitcnt lgkmcnt(0)
    v_mfma_f32_16x16x32_bf16 v[156:159], v[72:75], v[16:19], v[156:159]
    v_mfma_f32_16x16x32_bf16 v[156:159], v[76:79], v[20:23], v[156:159]
    v_mfma_f32_16x16x32_bf16 v[156:159], v[80:83], v[24:27], v[156:159]
    v_mfma_f32_16x16x32_bf16 v[156:159], v[84:87], v[28:31], v[156:159]
    v_mfma_f32_16x16x32_bf16 v[156:159], v[88:91], v[32:35], v[156:159]
    v_mfma_f32_16x16x32_bf16 v[156:159], v[92:95], v[36:39], v[156:159]
    v_mfma_f32_16x16x32_bf16 v[156:159], v[96:99], v[40:43], v[156:159]
    v_mfma_f32_16x16x32_bf16 v[156:159], v[100:103], v[44:47], v[156:159]
    v_mfma_f32_16x16x32_bf16 v[156:159], v[104:107], v[48:51], v[156:159]
    v_mfma_f32_16x16x32_bf16 v[156:159], v[108:111], v[52:55], v[156:159]
    v_mfma_f32_16x16x32_bf16 v[156:159], v[112:115], v[56:59], v[156:159]
    v_mfma_f32_16x16x32_bf16 v[156:159], v[116:119], v[60:63], v[156:159]
    v_mfma_f32_16x16x32_bf16 v[156:159], v[120:123], v[64:67], v[156:159]
    v_mfma_f32_16x16x32_bf16 v[156:159], v[124:127], v[68:71], v[156:159]
    s_nop 7
    buffer_store_dwordx4 v[156:159], v168, s[20:23], s35 offen sc1
    v_and_b32 v252, 15, v251
    v_mul_u32_u24 v248, 458752, v252
    s_and_b32 s36, s30, 1
    s_mul_i32 s36, s36, 6
    s_add_u32 s36, s36, 4
    v_bfe_u32 v252, v251, s36, 6
    v_mul_u32_u24 v250, 37, v252
    v_lshrrev_b32 v250, 8, v250
    v_mul_u32_u24 v250, 7, v250
    v_sub_u32 v250, v252, v250
    v_cmp_eq_u32 vcc, 3, v250
    s_nop 1
    v_cndmask_b32 v250, 0, 1, vcc
    v_lshl_add_u32 v249, v252, 16, v250
    v_mov_b32 v6, 162840
    v_mov_b32 v7, 1
    s_mov_b64 exec, 1
    ds_add_u32 v6, v7
    s_mov_b64 exec, -1
    s_setprio 0
    s_call_b64 s[76:77], SUB_w1_regs
    s_call_b64 s[76:77], SUB_park
    v_mov_b32 v6, 162840
spin_14:
    s_sleep 3
    ds_read_b32 v7, v6
    s_waitcnt lgkmcnt(0)
    v_readfirstlane_b32 s53, v7
    s_nop 0
    s_cmp_ge_u32 s53, 4
    s_cbranch_scc0 spin_14
    s_mov_b64 s[12:13], s[68:69]
    s_mov_b32 s14, 2097152
    s_mov_b32 s15, 0x20000
    s_and_b32 s35, s30, 1
    s_mul_i32 s38, s99, 128
    s_mul_i32 s41, s35, 65536
    s_add_u32 s38, s38, s41
    s_mul_i32 s41, s35, 4096
    s_add_u32 s41, s41, 24576
    s_mov_b32 s42, 0
    s_mov_b32 s44, s67
    s_mov_b32 s42, 98304
    s_mov_b32 s44, s67
    s_add_u32 s44, s44, 12
    s_and_b32 s44, s44, 15
    s_call_b64 s[76:77], SUB_w_issue_1
    s_waitcnt vmcnt(8)
    s_mov_b32 s42, 106496
    s_mov_b32 s44, s67
    s_add_u32 s44, s44, 13
    s_and_b32 s44, s44, 15
    s_call_b64 s[76:77], SUB_w_issue_1
    s_waitcnt vmcnt(8)
    s_mov_b32 s42, 114688
    s_mov_b32 s44, s67
    s_add_u32 s44, s44, 14
    s_and_b32 s44, s44, 15
    s_call_b64 s[76:77], SUB_w_issue_1
    s_waitcnt vmcnt(8)
    s_mov_b32 s42, 122880
    s_mov_b32 s44, s67
    s_add_u32 s44, s44, 15
    s_and_b32 s44, s44, 15
    s_call_b64 s[76:77], SUB_w_issue_1
    s_waitcnt vmcnt(8)
    s_and_b32 s36, s29, 6
    s_cmp_eq_u32 s36, 2
    s_cbranch_scc1 pr_15
    s_call_b64 s[76:77], SUB_park2
pr_15:
    s_call_b64 s[76:77], SUB_w1_put
FR_end:
LAYER:
    v_lshlrev_b32 v40, 6, v199
    v_add_u32 v40, 161792, v40
    s_lshl_b32 s35, s30, 3
    v_add_u32 v39, s35, v40
    s_cmp_eq_u32 s60, 0
    s_cbranch_scc1 R_l0
    s_sub_u32 s8, s62, 0x400000
    s_subb_u32 s9, s63, 0
    s_mov_b32 s10, 0x7e000
    s_mov_b32 s11, 0x20000
    s_sub_u32 s12, s62, 0x380000
    s_subb_u32 s13, s63, 0
    s_mov_b32 s14, 0x7e000
    s_mov_b32 s15, 0x20000
    s_mov_b32 s20, s62
    s_mov_b32 s21, s63
    s_mov_b32 s22, 0x7e000
    s_mov_b32 s23, 0x20000
    s_mov_b32 s78, 0x3f80
    s_mov_b32 s79, 0x3f800000
    v_lshlrev_b32 v222, 16, v230
    v_and_b32 v223, 0xffff0000, v230
    v_lshlrev_b32 v206, 16, v180
    v_and_b32 v207, 0xffff0000, v180
    v_lshlrev_b32 v12, 16, v188
    v_and_b32 v13, 0xffff0000, v188
    v_pk_add_f32 v[206:207], v[206:207], v[12:13]
    v_lshlrev_b32 v224, 16, v231
    v_and_b32 v225, 0xffff0000, v231
    v_lshlrev_b32 v208, 16, v181
    v_and_b32 v209, 0xffff0000, v181
    v_lshlrev_b32 v14, 16, v189
    v_and_b32 v15, 0xffff0000, v189
    v_pk_add_f32 v[208:209], v[208:209], v[14:15]
    v_lshlrev_b32 v226, 16, v232
    v_and_b32 v227, 0xffff0000, v232
    v_lshlrev_b32 v210, 16, v182
    v_and_b32 v211, 0xffff0000, v182
    v_lshlrev_b32 v16, 16, v190
    v_and_b32 v17, 0xffff0000, v190
    v_pk_add_f32 v[210:211], v[210:211], v[16:17]
    v_lshlrev_b32 v228, 16, v233
    v_and_b32 v229, 0xffff0000, v233
    v_lshlrev_b32 v212, 16, v183
    v_and_b32 v213, 0xffff0000, v183
    v_lshlrev_b32 v18, 16, v191
    v_and_b32 v19, 0xffff0000, v191
    v_pk_add_f32 v[212:213], v[212:213], v[18:19]
    v_lshlrev_b32 v230, 16, v234
    v_and_b32 v231, 0xffff0000, v234
    v_lshlrev_b32 v214, 16, v184
    v_and_b32 v215, 0xffff0000, v184
    v_lshlrev_b32 v20, 16, v192
    v_and_b32 v21, 0xffff0000, v192
    v_pk_add_f32 v[214:215], v[214:215], v[20:21]
    v_lshlrev_b32 v232, 16, v235
    v_and_b32 v233, 0xffff0000, v235
    v_lshlrev_b32 v216, 16, v185
    v_and_b32 v217, 0xffff0000, v185
    v_lshlrev_b32 v22, 16, v193
    v_and_b32 v23, 0xffff0000, v193
    v_pk_add_f32 v[216:217], v[216:217], v[22:23]
    v_lshlrev_b32 v234, 16, v236
    v_and_b32 v235, 0xffff0000, v236
    v_lshlrev_b32 v218, 16, v186
    v_and_b32 v219, 0xffff0000, v186
    v_lshlrev_b32 v24, 16, v194
    v_and_b32 v25, 0xffff0000, v194
    v_pk_add_f32 v[218:219], v[218:219], v[24:25]
    v_lshlrev_b32 v236, 16, v237
    v_and_b32 v237, 0xffff0000, v237
    v_lshlrev_b32 v220, 16, v187
    v_and_b32 v221, 0xffff0000, v187
    v_lshlrev_b32 v26, 16, v195
    v_and_b32 v27, 0xffff0000, v195
    v_pk_add_f32 v[220:221], v[220:221], v[26:27]
    s_mov_b32 s53, 0
    s_sleep 10
    s_cmp_ge_u32 s30, 6
    s_cbranch_scc1 dp_16
    s_sleep 14
dp_16:
    buffer_load_dwordx4 v[180:183], v196, s[8:11], 0 offen offset:0 sc1
    buffer_load_dwordx4 v[188:191], v196, s[12:15], 0 offen offset:0 sc1
    buffer_load_dwordx4 v[184:187], v196, s[8:11], 0 offen offset:2048 sc1
    buffer_load_dwordx4 v[192:195], v196, s[12:15], 0 offen offset:2048 sc1
    s_waitcnt vmcnt(0)
    v_bitop3_b32 v6, v180, v184, v188 bitop3:0x80
    v_bitop3_b32 v6, v6, v192, 1 bitop3:0x80
    v_cmp_eq_u32 vcc, 0, v6
    s_cbranch_vccz dq_17
    s_sleep 4
    s_add_u32 s53, s53, 1
    s_cmp_lt_u32 s53, s61
    s_cbranch_scc1 dp_16
    s_mov_b32 s61, 0
dq_17:
    v_dot2_f32_bf16 v206, v180, s78, v206
    v_dot2_f32_bf16 v207, v180, s79, v207
    v_dot2_f32_bf16 v208, v181, s78, v208
    v_dot2_f32_bf16 v209, v181, s79, v209
    v_dot2_f32_bf16 v210, v182, s78, v210
    v_dot2_f32_bf16 v211, v182, s79, v211
    v_dot2_f32_bf16 v212, v183, s78, v212
    v_dot2_f32_bf16 v213, v183, s79, v213
    v_dot2_f32_bf16 v214, v184, s78, v214
    v_dot2_f32_bf16 v215, v184, s79, v215
    v_dot2_f32_bf16 v216, v185, s78, v216
    v_dot2_f32_bf16 v217, v185, s79, v217
    v_dot2_f32_bf16 v218, v186, s78, v218
    v_dot2_f32_bf16 v219, v186, s79, v219
    v_dot2_f32_bf16 v220, v187, s78, v220
    v_dot2_f32_bf16 v221, v187, s79, v221
    v_dot2_f32_bf16 v206, v188, s78, v206
    v_dot2_f32_bf16 v207, v188, s79, v207
    v_dot2_f32_bf16 v208, v189, s78, v208
    v_dot2_f32_bf16 v209, v189, s79, v209
    v_dot2_f32_bf16 v210, v190, s78, v210
    v_dot2_f32_bf16 v211, v190, s79, v211
    v_dot2_f32_bf16 v212, v191, s78, v212
    v_dot2_f32_bf16 v213, v191, s79, v213
    v_dot2_f32_bf16 v214, v192, s78, v214
    v_dot2_f32_bf16 v215, v192, s79, v215
    v_dot2_f32_bf16 v216, v193, s78, v216
    v_dot2_f32_bf16 v217, v193, s79, v217
    v_dot2_f32_bf16 v218, v194, s78, v218
    v_dot2_f32_bf16 v219, v194, s79, v219
    v_dot2_f32_bf16 v220, v195, s78, v220
    v_dot2_f32_bf16 v221, v195, s79, v221
    s_nop 2
    v_pk_add_f32 v[32:33], v[206:207], v[208:209]
    v_pk_mul_f32 v[34:35], v[206:207], v[206:207]
    v_pk_fma_f32 v[34:35], v[208:209], v[208:209], v[34:35]
    v_pk_add_f32 v[32:33], v[32:33], v[210:211]
    v_pk_fma_f32 v[34:35], v[210:211], v[210:211], v[34:35]
    v_pk_add_f32 v[32:33], v[32:33], v[212:213]
    v_pk_fma_f32 v[34:35], v[212:213], v[212:213], v[34:35]
    v_pk_add_f32 v[32:33], v[32:33], v[214:215]
    v_pk_fma_f32 v[34:35], v[214:215], v[214:215], v[34:35]
    v_pk_add_f32 v[32:33], v[32:33], v[216:217]
    v_pk_fma_f32 v[34:35], v[216:217], v[216:217], v[34:35]
    v_pk_add_f32 v[32:33], v[32:33], v[218:219]
    v_pk_fma_f32 v[34:35], v[218:219], v[218:219], v[34:35]
    v_pk_add_f32 v[32:33], v[32:33], v[220:221]
    v_pk_fma_f32 v[34:35], v[220:221], v[220:221], v[34:35]
    v_add_f32 v30, v32, v33
    v_add_f32 v31, v34, v35
    s_nop 0
    v_add_f32_dpp v30, v30, v30 row_ror:8 row_mask:0xf bank_mask:0xf
    v_add_f32_dpp v31, v31, v31 row_ror:8 row_mask:0xf bank_mask:0xf
    v_mov_b32 v32, v30
    v_mov_b32 v33, v31
    s_nop 0
    v_permlane16_swap_b32 v30, v32
    v_permlane16_swap_b32 v31, v33
    v_pk_add_f32 v[30:31], v[30:31], v[32:33]
    v_mov_b32 v32, v30
    v_mov_b32 v33, v31
    s_nop 0
    v_permlane32_swap_b32 v30, v32
    v_permlane32_swap_b32 v31, v33
    v_pk_add_f32 v[30:31], v[30:31], v[32:33]
    ds_write_b64 v39, v[30:31] offset:0
    s_waitcnt lgkmcnt(0)
    s_barrier
    ds_read_b128 v[12:15], v40 offset:0
    ds_read_b128 v[16:19], v40 offset:16
    ds_read_b128 v[20:23], v40 offset:32
    ds_read_b128 v[24:27], v40 offset:48
    s_waitcnt lgkmcnt(0)
    v_pk_add_f32 v[12:13], v[12:13], v[14:15]
    v_pk_add_f32 v[16:17], v[16:17], v[18:19]
    v_pk_add_f32 v[20:21], v[20:21], v[22:23]
    v_pk_add_f32 v[24:25], v[24:25], v[26:27]
    v_pk_add_f32 v[12:13], v[12:13], v[16:17]
    v_pk_add_f32 v[20:21], v[20:21], v[24:25]
    v_pk_add_f32 v[12:13], v[12:13], v[20:21]
    v_mul_f32 v36, 0x3a800000, v12
    v_mul_f32 v38, 0x3a800000, v13
    v_fma_f32 v38, -v36, v36, v38
    v_max_f32 v38, 0, v38
    v_add_f32 v38, 0x3727c5ac, v38
    v_rsq_f32 v37, v38
    s_nop 0
    v_mul_f32 v36, v36, v37
    v_pk_fma_f32 v[12:13], v[206:207], v[36:37], v[36:37] op_sel:[0,1,0] op_sel_hi:[1,1,0] neg_lo:[0,0,1] neg_hi:[0,0,1]
    v_pk_fma_f32 v[14:15], v[208:209], v[36:37], v[36:37] op_sel:[0,1,0] op_sel_hi:[1,1,0] neg_lo:[0,0,1] neg_hi:[0,0,1]
    v_pk_fma_f32 v[16:17], v[210:211], v[36:37], v[36:37] op_sel:[0,1,0] op_sel_hi:[1,1,0] neg_lo:[0,0,1] neg_hi:[0,0,1]
    v_pk_fma_f32 v[18:19], v[212:213], v[36:37], v[36:37] op_sel:[0,1,0] op_sel_hi:[1,1,0] neg_lo:[0,0,1] neg_hi:[0,0,1]
    v_pk_fma_f32 v[20:21], v[214:215], v[36:37], v[36:37] op_sel:[0,1,0] op_sel_hi:[1,1,0] neg_lo:[0,0,1] neg_hi:[0,0,1]
    v_pk_fma_f32 v[22:23], v[216:217], v[36:37], v[36:37] op_sel:[0,1,0] op_sel_hi:[1,1,0] neg_lo:[0,0,1] neg_hi:[0,0,1]
    v_pk_fma_f32 v[24:25], v[218:219], v[36:37], v[36:37] op_sel:[0,1,0] op_sel_hi:[1,1,0] neg_lo:[0,0,1] neg_hi:[0,0,1]
    v_pk_fma_f32 v[26:27], v[220:221], v[36:37], v[36:37] op_sel:[0,1,0] op_sel_hi:[1,1,0] neg_lo:[0,0,1] neg_hi:[0,0,1]
    v_pk_fma_f32 v[206:207], v[12:13], v[222:223], v[206:207]
    v_cvt_pk_bf16_f32 v180, v206, v207
    v_pk_fma_f32 v[208:209], v[14:15], v[224:225], v[208:209]
    v_cvt_pk_bf16_f32 v181, v208, v209
    v_and_b32 v180, -2, v180
    v_pk_fma_f32 v[210:211], v[16:17], v[226:227], v[210:211]
    v_cvt_pk_bf16_f32 v182, v210, v211
    v_pk_fma_f32 v[212:213], v[18:19], v[228:229], v[212:213]
    v_cvt_pk_bf16_f32 v183, v212, v213
    buffer_store_dwordx4 v[180:183], v196, s[20:23], 0 offen offset:0 sc1
    v_pk_fma_f32 v[214:215], v[20:21], v[230:231], v[214:215]
    v_cvt_pk_bf16_f32 v184, v214, v215
    v_pk_fma_f32 v[216:217], v[22:23], v[232:233], v[216:217]
    v_cvt_pk_bf16_f32 v185, v216, v217
    v_and_b32 v184, -2, v184
    v_pk_fma_f32 v[218:219], v[24:25], v[234:235], v[218:219]
    v_cvt_pk_bf16_f32 v186, v218, v219
    v_pk_fma_f32 v[220:221], v[26:27], v[236:237], v[220:221]
    v_cvt_pk_bf16_f32 v187, v220, v221
    buffer_store_dwordx4 v[184:187], v196, s[20:23], 0 offen offset:2048 sc1
    s_branch R_s2
R_l0:
    v_lshlrev_b32 v206, 16, v180
    v_and_b32 v207, 0xffff0000, v180
    v_lshlrev_b32 v208, 16, v181
    v_and_b32 v209, 0xffff0000, v181
    v_lshlrev_b32 v210, 16, v182
    v_and_b32 v211, 0xffff0000, v182
    v_lshlrev_b32 v212, 16, v183
    v_and_b32 v213, 0xffff0000, v183
    v_lshlrev_b32 v214, 16, v184
    v_and_b32 v215, 0xffff0000, v184
    v_lshlrev_b32 v216, 16, v185
    v_and_b32 v217, 0xffff0000, v185
    v_lshlrev_b32 v218, 16, v186
    v_and_b32 v219, 0xffff0000, v186
    v_lshlrev_b32 v220, 16, v187
    v_and_b32 v221, 0xffff0000, v187
    v_pk_add_f32 v[32:33], v[206:207], v[208:209]
    v_pk_mul_f32 v[34:35], v[206:207], v[206:207]
    v_pk_fma_f32 v[34:35], v[208:209], v[208:209], v[34:35]
    v_pk_add_f32 v[32:33], v[32:33], v[210:211]
    v_pk_fma_f32 v[34:35], v[210:211], v[210:211], v[34:35]
    v_pk_add_f32 v[32:33], v[32:33], v[212:213]
    v_pk_fma_f32 v[34:35], v[212:213], v[212:213], v[34:35]
    v_pk_add_f32 v[32:33], v[32:33], v[214:215]
    v_pk_fma_f32 v[34:35], v[214:215], v[214:215], v[34:35]
    v_pk_add_f32 v[32:33], v[32:33], v[216:217]
    v_pk_fma_f32 v[34:35], v[216:217], v[216:217], v[34:35]
    v_pk_add_f32 v[32:33], v[32:33], v[218:219]
    v_pk_fma_f32 v[34:35], v[218:219], v[218:219], v[34:35]
    v_pk_add_f32 v[32:33], v[32:33], v[220:221]
    v_pk_fma_f32 v[34:35], v[220:221], v[220:221], v[34:35]
    v_add_f32 v30, v32, v33
    v_add_f32 v31, v34, v35
    s_nop 0
    v_add_f32_dpp v30, v30, v30 row_ror:8 row_mask:0xf bank_mask:0xf
    v_add_f32_dpp v31, v31, v31 row_ror:8 row_mask:0xf bank_mask:0xf
    v_mov_b32 v32, v30
    v_mov_b32 v33, v31
    s_nop 0
    v_permlane16_swap_b32 v30, v32
    v_permlane16_swap_b32 v31, v33
    v_pk_add_f32 v[30:31], v[30:31], v[32:33]
    v_mov_b32 v32, v30
    v_mov_b32 v33, v31
    s_nop 0
    v_permlane32_swap_b32 v30, v32
    v_permlane32_swap_b32 v31, v33
    v_pk_add_f32 v[30:31], v[30:31], v[32:33]
    ds_write_b64 v39, v[30:31] offset:0
    s_waitcnt lgkmcnt(0)
    v_mov_b32 v222, 162844
spin_18:
    ds_read_b32 v223, v222
    s_waitcnt lgkmcnt(0)
    v_readfirstlane_b32 s94, v223
    s_nop 0
    s_cmp_ge_u32 s94, 65536
    s_cbranch_scc0 spin_18
    s_cmp_gt_u32 s94, 65546
    s_cselect_b32 s94, 1, 0
    s_lshl_b32 s53, s94, 13
    v_xor_b32 v197, s53, v197
    s_lshr_b32 s53, s28, 3
    s_lshl_b32 s53, s53, 2
    s_and_b32 s54, s28, 3
    s_add_u32 s53, s53, s54
    s_lshl_b32 s53, s53, 24
    s_lshr_b32 s54, s28, 2
    s_xor_b32 s54, s54, s94
    s_and_b32 s54, s54, 1
    s_lshl_b32 s54, s54, 13
    s_add_u32 s36, s53, s54
    s_add_u32 s36, s36, 33554432
    s_lshr_b32 s53, s53, 14
    s_add_u32 s36, s53, s54
    s_xor_b32 s36, s36, 8192
    s_add_u32 s36, s36, 23101440
    s_lshl_b32 s53, s30, 7
    s_add_u32 s36, s36, s53
    v_mov_b32 v226, s36
    s_waitcnt vmcnt(0)
    s_barrier
    s_mov_b32 s53, 0
    s_add_u32 s54, s52, 32
    s_bfm_b64 exec, 1, 0
poll_19:
    buffer_load_dword v222, v226, s[56:59], 0 offen sc1
    s_waitcnt vmcnt(0)
    v_xor_b32 v222, s54, v222
    v_cmp_eq_u32 vcc, 0, v222
    s_nop 0
    s_cmp_eq_u64 vcc, exec
    s_cbranch_scc1 pok_20
    s_sleep 6
    s_add_u32 s53, s53, 1
    s_cmp_lt_u32 s53, s61
    s_cbranch_scc1 poll_19
    s_mov_b32 s61, 0
pok_20:
    s_mov_b64 exec, -1
    s_add_u32 s80, s4, 0x2100000
    s_addc_u32 s81, s5, 0
    s_mov_b32 s82, 0x7f00000
    s_mov_b32 s83, 0x20000
    s_mov_b32 s78, 0
    buffer_load_dwordx2 v[230:231], v197, s[80:83], s78 offen sc1
    s_mov_b32 s78, 2048
    buffer_load_dwordx2 v[232:233], v197, s[80:83], s78 offen sc1
    s_mov_b32 s78, 16384
    buffer_load_dwordx2 v[234:235], v197, s[80:83], s78 offen sc1
    s_mov_b32 s78, 18432
    buffer_load_dwordx2 v[236:237], v197, s[80:83], s78 offen sc1
    s_lshr_b32 s53, s28, 3
    s_lshl_b32 s53, s53, 2
    s_and_b32 s54, s28, 3
    s_add_u32 s53, s53, s54
    s_lshl_b32 s53, s53, 24
    s_lshr_b32 s54, s28, 2
    s_xor_b32 s54, s54, s94
    s_and_b32 s54, s54, 1
    s_lshl_b32 s54, s54, 13
    s_add_u32 s55, s53, s54
    s_add_u32 s55, s55, 33554432
    s_add_u32 s62, s4, s55
    s_addc_u32 s63, s5, 0
    s_sub_u32 s36, s28, 1
    s_max_i32 s36, s36, 0
    s_lshr_b32 s53, s36, 3
    s_lshl_b32 s53, s53, 2
    s_and_b32 s54, s36, 3
    s_add_u32 s53, s53, s54
    s_lshl_b32 s53, s53, 24
    s_lshr_b32 s54, s36, 2
    s_xor_b32 s54, s54, s94
    s_and_b32 s54, s54, 1
    s_lshl_b32 s54, s54, 13
    s_add_u32 s92, s53, s54
    s_add_u32 s92, s92, 33554432
    s_sub_u32 s92, s92, s55
    s_add_u32 s36, s28, 1
    s_min_u32 s36, s36, 15
    s_lshr_b32 s53, s36, 3
    s_lshl_b32 s53, s53, 2
    s_and_b32 s54, s36, 3
    s_add_u32 s53, s53, s54
    s_lshl_b32 s53, s53, 24
    s_lshr_b32 s54, s36, 2
    s_xor_b32 s54, s54, s94
    s_and_b32 s54, s54, 1
    s_lshl_b32 s54, s54, 13
    s_add_u32 s93, s53, s54
    s_add_u32 s93, s93, 33554432
    s_sub_u32 s93, s93, s55
    s_add_u32 s55, s55, 6029312
    s_mov_b32 s20, s62
    s_mov_b32 s21, s63
    s_mov_b32 s22, 0x7e000
    s_mov_b32 s23, 0x20000
    ds_read_b128 v[12:15], v40 offset:0
    ds_read_b128 v[16:19], v40 offset:16
    ds_read_b128 v[20:23], v40 offset:32
    ds_read_b128 v[24:27], v40 offset:48
    s_waitcnt lgkmcnt(0)
    v_pk_add_f32 v[12:13], v[12:13], v[14:15]
    v_pk_add_f32 v[16:17], v[16:17], v[18:19]
    v_pk_add_f32 v[20:21], v[20:21], v[22:23]
    v_pk_add_f32 v[24:25], v[24:25], v[26:27]
    v_pk_add_f32 v[12:13], v[12:13], v[16:17]
    v_pk_add_f32 v[20:21], v[20:21], v[24:25]
    v_pk_add_f32 v[12:13], v[12:13], v[20:21]
    v_mul_f32 v36, 0x3a800000, v12
    v_mul_f32 v38, 0x3a800000, v13
    v_fma_f32 v38, -v36, v36, v38
    v_max_f32 v38, 0, v38
    v_add_f32 v38, 0x3727c5ac, v38
    v_rsq_f32 v37, v38
    s_nop 0
    v_pk_add_f32 v[12:13], v[206:207], v[36:37] op_sel_hi:[1,0] neg_lo:[0,1] neg_hi:[0,1]
    v_pk_mul_f32 v[12:13], v[12:13], v[36:37] op_sel:[0,1] op_sel_hi:[1,1]
    v_pk_add_f32 v[14:15], v[208:209], v[36:37] op_sel_hi:[1,0] neg_lo:[0,1] neg_hi:[0,1]
    v_pk_mul_f32 v[14:15], v[14:15], v[36:37] op_sel:[0,1] op_sel_hi:[1,1]
    v_pk_add_f32 v[16:17], v[210:211], v[36:37] op_sel_hi:[1,0] neg_lo:[0,1] neg_hi:[0,1]
    v_pk_mul_f32 v[16:17], v[16:17], v[36:37] op_sel:[0,1] op_sel_hi:[1,1]
    v_pk_add_f32 v[18:19], v[212:213], v[36:37] op_sel_hi:[1,0] neg_lo:[0,1] neg_hi:[0,1]
    v_pk_mul_f32 v[18:19], v[18:19], v[36:37] op_sel:[0,1] op_sel_hi:[1,1]
    v_pk_add_f32 v[20:21], v[214:215], v[36:37] op_sel_hi:[1,0] neg_lo:[0,1] neg_hi:[0,1]
    v_pk_mul_f32 v[20:21], v[20:21], v[36:37] op_sel:[0,1] op_sel_hi:[1,1]
    v_pk_add_f32 v[22:23], v[216:217], v[36:37] op_sel_hi:[1,0] neg_lo:[0,1] neg_hi:[0,1]
    v_pk_mul_f32 v[22:23], v[22:23], v[36:37] op_sel:[0,1] op_sel_hi:[1,1]
    v_pk_add_f32 v[24:25], v[218:219], v[36:37] op_sel_hi:[1,0] neg_lo:[0,1] neg_hi:[0,1]
    v_pk_mul_f32 v[24:25], v[24:25], v[36:37] op_sel:[0,1] op_sel_hi:[1,1]
    v_pk_add_f32 v[26:27], v[220:221], v[36:37] op_sel_hi:[1,0] neg_lo:[0,1] neg_hi:[0,1]
    v_pk_mul_f32 v[26:27], v[26:27], v[36:37] op_sel:[0,1] op_sel_hi:[1,1]
    s_barrier
    s_waitcnt vmcnt(0)
    v_lshlrev_b32 v222, 16, v230
    v_and_b32 v223, 0xffff0000, v230
    v_pk_fma_f32 v[206:207], v[12:13], v[222:223], v[206:207]
    v_cvt_pk_bf16_f32 v180, v206, v207
    v_lshlrev_b32 v222, 16, v231
    v_and_b32 v223, 0xffff0000, v231
    v_pk_fma_f32 v[208:209], v[14:15], v[222:223], v[208:209]
    v_cvt_pk_bf16_f32 v181, v208, v209
    v_and_b32 v180, -2, v180
    v_lshlrev_b32 v222, 16, v232
    v_and_b32 v223, 0xffff0000, v232
    v_pk_fma_f32 v[210:211], v[16:17], v[222:223], v[210:211]
    v_cvt_pk_bf16_f32 v182, v210, v211
    v_lshlrev_b32 v222, 16, v233
    v_and_b32 v223, 0xffff0000, v233
    v_pk_fma_f32 v[212:213], v[18:19], v[222:223], v[212:213]
    v_cvt_pk_bf16_f32 v183, v212, v213
    buffer_store_dwordx4 v[180:183], v196, s[20:23], 0 offen offset:0 sc1
    v_lshlrev_b32 v222, 16, v234
    v_and_b32 v223, 0xffff0000, v234
    v_pk_fma_f32 v[214:215], v[20:21], v[222:223], v[214:215]
    v_cvt_pk_bf16_f32 v184, v214, v215
    v_lshlrev_b32 v222, 16, v235
    v_and_b32 v223, 0xffff0000, v235
    v_pk_fma_f32 v[216:217], v[22:23], v[222:223], v[216:217]
    v_cvt_pk_bf16_f32 v185, v216, v217
    v_and_b32 v184, -2, v184
    v_lshlrev_b32 v222, 16, v236
    v_and_b32 v223, 0xffff0000, v236
    v_pk_fma_f32 v[218:219], v[24:25], v[222:223], v[218:219]
    v_cvt_pk_bf16_f32 v186, v218, v219
    v_lshlrev_b32 v222, 16, v237
    v_and_b32 v223, 0xffff0000, v237
    v_pk_fma_f32 v[220:221], v[26:27], v[222:223], v[220:221]
    v_cvt_pk_bf16_f32 v187, v220, v221
    buffer_store_dwordx4 v[184:187], v196, s[20:23], 0 offen offset:2048 sc1
R_s2:
    v_lshlrev_b32 v206, 16, v180
    v_and_b32 v207, 0xffff0000, v180
    v_lshlrev_b32 v208, 16, v181
    v_and_b32 v209, 0xffff0000, v181
    v_lshlrev_b32 v210, 16, v182
    v_and_b32 v211, 0xffff0000, v182
    v_lshlrev_b32 v212, 16, v183
    v_and_b32 v213, 0xffff0000, v183
    v_lshlrev_b32 v214, 16, v184
    v_and_b32 v215, 0xffff0000, v184
    v_lshlrev_b32 v216, 16, v185
    v_and_b32 v217, 0xffff0000, v185
    v_lshlrev_b32 v218, 16, v186
    v_and_b32 v219, 0xffff0000, v186
    v_lshlrev_b32 v220, 16, v187
    v_and_b32 v221, 0xffff0000, v187
    v_pk_add_f32 v[32:33], v[206:207], v[208:209]
    v_pk_mul_f32 v[34:35], v[206:207], v[206:207]
    v_pk_fma_f32 v[34:35], v[208:209], v[208:209], v[34:35]
    v_pk_add_f32 v[32:33], v[32:33], v[210:211]
    v_pk_fma_f32 v[34:35], v[210:211], v[210:211], v[34:35]
    v_pk_add_f32 v[32:33], v[32:33], v[212:213]
    v_pk_fma_f32 v[34:35], v[212:213], v[212:213], v[34:35]
    v_pk_add_f32 v[32:33], v[32:33], v[214:215]
    v_pk_fma_f32 v[34:35], v[214:215], v[214:215], v[34:35]
    v_pk_add_f32 v[32:33], v[32:33], v[216:217]
    v_pk_fma_f32 v[34:35], v[216:217], v[216:217], v[34:35]
    v_pk_add_f32 v[32:33], v[32:33], v[218:219]
    v_pk_fma_f32 v[34:35], v[218:219], v[218:219], v[34:35]
    v_pk_add_f32 v[32:33], v[32:33], v[220:221]
    v_pk_fma_f32 v[34:35], v[220:221], v[220:221], v[34:35]
    v_add_f32 v30, v32, v33
    v_add_f32 v31, v34, v35
    s_nop 0
    v_add_f32_dpp v30, v30, v30 row_ror:8 row_mask:0xf bank_mask:0xf
    v_add_f32_dpp v31, v31, v31 row_ror:8 row_mask:0xf bank_mask:0xf
    v_mov_b32 v32, v30
    v_mov_b32 v33, v31
    s_nop 0
    v_permlane16_swap_b32 v30, v32
    v_permlane16_swap_b32 v31, v33
    v_pk_add_f32 v[30:31], v[30:31], v[32:33]
    v_mov_b32 v32, v30
    v_mov_b32 v33, v31
    s_nop 0
    v_permlane32_swap_b32 v30, v32
    v_permlane32_swap_b32 v31, v33
    v_pk_add_f32 v[30:31], v[30:31], v[32:33]
    ds_write_b64 v39, v[30:31] offset:512
    s_waitcnt lgkmcnt(0)
    s_barrier
    s_cmp_lg_u32 s30, 6
    s_cbranch_scc1 R_n6
    s_cmp_lg_u32 s60, 0
    s_cbranch_scc1 R_n6
    s_lshl_b32 s53, s29, 7
    s_add_u32 s53, s53, 23121920
    v_mov_b32 v8, 1
    v_mov_b32 v9, 0
    s_mov_b64 exec, 1
    buffer_atomic_add v8, v9, s[56:59], s53 offen sc1
    s_mov_b64 exec, -1
R_n6:
    s_cmp_lg_u32 s30, 7
    s_cbranch_scc1 R_nl
    ds_read_b128 v[12:15], v40 offset:512
    ds_read_b128 v[16:19], v40 offset:528
    ds_read_b128 v[20:23], v40 offset:544
    ds_read_b128 v[24:27], v40 offset:560
    s_waitcnt lgkmcnt(0)
    v_pk_add_f32 v[12:13], v[12:13], v[14:15]
    v_pk_add_f32 v[16:17], v[16:17], v[18:19]
    v_pk_add_f32 v[20:21], v[20:21], v[22:23]
    v_pk_add_f32 v[24:25], v[24:25], v[26:27]
    v_pk_add_f32 v[12:13], v[12:13], v[16:17]
    v_pk_add_f32 v[20:21], v[20:21], v[24:25]
    v_pk_add_f32 v[12:13], v[12:13], v[20:21]
    v_mul_f32 v36, 0x3a800000, v12
    v_mul_f32 v38, 0x3a800000, v13
    v_fma_f32 v38, -v36, v36, v38
    v_max_f32 v38, 0, v38
    v_mov_b32 v42, v36
    v_mov_b32 v43, v38
    v_add_f32 v38, 0x3727c5ac, v38
    v_sqrt_f32 v38, v38
    s_nop 0
    v_mov_b32 v41, v38
    v_rcp_f32 v37, v38
    v_sub_f32 v42, v42, v36
    v_mul_f32 v42, v42, v37
    v_mul_f32 v43, v43, v37
    v_mul_f32 v43, v43, v37
    v_add_f32 v43, 0x3727c5ac, v43
    v_rsq_f32 v44, v43
    v_mov_b32 v224, v36
    v_mov_b32 v225, v37
    v_fma_f32 v226, v42, v41, v36
    v_mul_f32 v227, v37, v44
    s_add_u32 s24, s62, 0x5d0000
    s_addc_u32 s25, s63, 0
    s_mov_b32 s26, 0x800
    s_mov_b32 s27, 0x20000
    s_lshl_b32 s36, s29, 3
    v_add_u32 v6, s36, v199
    v_lshlrev_b32 v6, 4, v6
    s_mov_b64 exec, 0xff
    buffer_store_dwordx4 v[224:227], v6, s[24:27], 0 offen sc1
    s_mov_b64 exec, -1
    s_add_u32 s53, s55, 1280
    v_mov_b32 v8, 1
    v_mov_b32 v9, 162816
    v_mov_b32 v11, 0
    s_mov_b64 exec, 1
    s_waitcnt vmcnt(0)
    buffer_atomic_add v8, v11, s[56:59], s53 offen sc1
pub_21:
    s_mov_b64 exec, -1
R_nl:
    s_cmp_ge_u32 s30, 4
    s_cbranch_scc1 LOADERS
    s_mov_b32 s8, s62
    s_mov_b32 s9, s63
    s_mov_b32 s10, 0x7e000
    s_mov_b32 s11, 0x20000
    v_add_u32 v126, 0, v2
    v_add_u32 v127, 65536, v2
    s_lshl_b32 s44, s30, 17
    s_mov_b32 s34, s30
    s_mov_b32 s35, 0
    v_and_b32 v22, 15, v1
    v_lshrrev_b32 v23, 4, v1
    s_mul_i32 s37, s34, 2
    s_mul_i32 s38, s99, 4
    s_mul_i32 s36, s35, 4
    s_add_u32 s38, s38, s36
    v_add_u32 v128, 4096, v2
    v_add_u32 v129, 69632, v2
    s_add_u32 s45, s44, 16384
    s_add_u32 s46, s44, 32768
    s_add_u32 s47, s44, 49152
    v_lshrrev_b32 v6, 2, v1
    v_mul_u32_u24 v13, 128, v6
    v_and_b32 v7, 3, v1
    v_lshl_add_u32 v13, v7, 3, v13
    v_add_u32 v13, 24576, v13
    v_bfe_u32 v6, v6, 1, 2
    s_mul_i32 s36, s35, 4
    s_add_u32 s36, s36, 3
    v_xor_b32 v7, s36, v6
    v_lshl_add_u32 v16, v7, 5, v13
    s_mul_i32 s36, s35, 4
    s_add_u32 s36, s36, 2
    v_xor_b32 v7, s36, v6
    v_lshl_add_u32 v15, v7, 5, v13
    s_mul_i32 s36, s35, 4
    s_add_u32 s36, s36, 1
    v_xor_b32 v7, s36, v6
    v_lshl_add_u32 v14, v7, 5, v13
    s_mul_i32 s36, s35, 4
    s_add_u32 s36, s36, 0
    v_xor_b32 v7, s36, v6
    v_lshl_add_u32 v13, v7, 5, v13
    v_pk_mov_b32 v[24:25], 0, 0
    v_pk_mov_b32 v[26:27], 0, 0
    v_pk_mov_b32 v[28:29], 0, 0
    v_pk_mov_b32 v[30:31], 0, 0
    v_pk_mov_b32 v[32:33], 0, 0
    v_pk_mov_b32 v[34:35], 0, 0
    v_pk_mov_b32 v[36:37], 0, 0
    v_pk_mov_b32 v[38:39], 0, 0
    v_pk_mov_b32 v[40:41], 0, 0
    v_pk_mov_b32 v[42:43], 0, 0
    v_pk_mov_b32 v[44:45], 0, 0
    v_pk_mov_b32 v[46:47], 0, 0
    v_pk_mov_b32 v[48:49], 0, 0
    v_pk_mov_b32 v[50:51], 0, 0
    v_pk_mov_b32 v[52:53], 0, 0
    v_pk_mov_b32 v[54:55], 0, 0
    s_mov_b32 s43, 0
    s_mul_i32 s36, s35, 256
    s_add_u32 s36, s36, 163328
    v_lshlrev_b32 v6, 4, v23
    v_add_u32 v6, s36, v6
    s_lshl_b32 s36, s37, 8
    s_add_u32 s36, s36, 160776
    v_lshlrev_b32 v7, 4, v22
    v_add_u32 v7, s36, v7
    s_add_u32 s16, s62, 0x100000
    s_addc_u32 s17, s63, 0
    s_mov_b32 s18, 0x7e000
    s_mov_b32 s19, 0x20000
    v_lshlrev_b32 v12, 11, v23
    v_lshl_add_u32 v12, v22, 4, v12
    s_lshl_b32 s39, s38, 13
    s_lshl_b32 s36, s37, 8
    s_add_u32 s39, s39, s36
    s_add_u32 s40, s39, 16384
    s_lshl_b32 s36, s29, 1
    s_lshr_b32 s53, s36, 3
    s_lshl_b32 s53, s53, 14
    s_and_b32 s41, s36, 7
    s_lshl_b32 s41, s41, 10
    s_add_u32 s41, s41, s53
    s_lshl_b32 s36, s37, 16
    s_add_u32 s41, s41, s36
    s_mov_b32 s53, 0
    s_mov_b32 s49, s44
    ds_read_b64_tr_b16 v[56:57], v13 offset:0
    ds_read_b64_tr_b16 v[58:59], v13 offset:2048
    ds_read_b64_tr_b16 v[60:61], v14 offset:0
    ds_read_b64_tr_b16 v[62:63], v14 offset:2048
    ds_read_b64_tr_b16 v[64:65], v15 offset:0
    ds_read_b64_tr_b16 v[66:67], v15 offset:2048
    ds_read_b64_tr_b16 v[68:69], v16 offset:0
    ds_read_b64_tr_b16 v[70:71], v16 offset:2048
    ds_read_b64_tr_b16 v[72:73], v13 offset:4096
    ds_read_b64_tr_b16 v[74:75], v13 offset:6144
    ds_read_b64_tr_b16 v[76:77], v14 offset:4096
    ds_read_b64_tr_b16 v[78:79], v14 offset:6144
    ds_read_b64_tr_b16 v[80:81], v15 offset:4096
    ds_read_b64_tr_b16 v[82:83], v15 offset:6144
    ds_read_b64_tr_b16 v[84:85], v16 offset:4096
    ds_read_b64_tr_b16 v[86:87], v16 offset:6144
dm_22p:
    buffer_load_dwordx4 v[164:167], v126, s[8:11], s44 offen offset:0 sc1
    buffer_load_dwordx4 v[168:171], v127, s[8:11], s44 offen offset:0 sc1
    buffer_load_dwordx4 v[172:175], v126, s[8:11], s44 offen offset:1024 sc1
    buffer_load_dwordx4 v[176:179], v127, s[8:11], s44 offen offset:1024 sc1
dm_22w:
    s_waitcnt vmcnt(0)
    v_or3_b32 v17, v164, v168, v172
    v_bitop3_b32 v17, v17, v176, 1 bitop3:0xa8
    v_cmp_ne_u32 vcc, 0, v17
    s_cbranch_vccz dm_22q
    s_sleep 2
    s_add_u32 s53, s53, 1
    s_cmp_lt_u32 s53, s61
    s_cbranch_scc1 dm_22p
    s_mov_b32 s61, 0
dm_22q:
    buffer_load_dwordx4 v[180:183], v126, s[8:11], s44 offen offset:2048 sc1
    buffer_load_dwordx4 v[184:187], v127, s[8:11], s44 offen offset:2048 sc1
    buffer_load_dwordx4 v[188:191], v126, s[8:11], s44 offen offset:3072 sc1
    buffer_load_dwordx4 v[192:195], v127, s[8:11], s44 offen offset:3072 sc1
    buffer_load_dwordx4 v[196:199], v128, s[8:11], s44 offen offset:0 sc1
    buffer_load_dwordx4 v[200:203], v129, s[8:11], s44 offen offset:0 sc1
    buffer_load_dwordx4 v[204:207], v128, s[8:11], s44 offen offset:1024 sc1
    buffer_load_dwordx4 v[208:211], v129, s[8:11], s44 offen offset:1024 sc1
    buffer_load_dwordx4 v[212:215], v128, s[8:11], s44 offen offset:2048 sc1
    buffer_load_dwordx4 v[216:219], v129, s[8:11], s44 offen offset:2048 sc1
    s_waitcnt lgkmcnt(0)
dm_22:
    v_mfma_f32_16x16x32_bf16 v[24:27], v[56:59], v[164:167], v[24:27]
    ds_read_b64_tr_b16 v[88:89], v13 offset:8192
    buffer_load_dwordx4 v[220:223], v128, s[8:11], s44 offen offset:3072 sc1
    v_mfma_f32_16x16x32_bf16 v[40:43], v[56:59], v[168:171], v[40:43]
    ds_read_b64_tr_b16 v[90:91], v13 offset:10240
    buffer_load_dwordx4 v[224:227], v129, s[8:11], s44 offen offset:3072 sc1
    v_mfma_f32_16x16x32_bf16 v[44:47], v[60:63], v[168:171], v[44:47]
    ds_read_b64_tr_b16 v[92:93], v14 offset:8192
    s_mov_b32 s44, s45
    v_mfma_f32_16x16x32_bf16 v[28:31], v[60:63], v[164:167], v[28:31]
    ds_read_b64_tr_b16 v[94:95], v14 offset:10240
    s_mov_b32 s45, s46
    v_mfma_f32_16x16x32_bf16 v[32:35], v[64:67], v[164:167], v[32:35]
    ds_read_b64_tr_b16 v[96:97], v15 offset:8192
    s_mov_b32 s46, s47
    v_mfma_f32_16x16x32_bf16 v[48:51], v[64:67], v[168:171], v[48:51]
    ds_read_b64_tr_b16 v[98:99], v15 offset:10240
    s_mov_b32 s47, 1048576
    v_mfma_f32_16x16x32_bf16 v[52:55], v[68:71], v[168:171], v[52:55]
    ds_read_b64_tr_b16 v[100:101], v16 offset:8192
    v_mfma_f32_16x16x32_bf16 v[36:39], v[68:71], v[164:167], v[36:39]
    ds_read_b64_tr_b16 v[102:103], v16 offset:10240
    s_waitcnt lgkmcnt(8)
    v_mfma_f32_16x16x32_bf16 v[24:27], v[72:75], v[172:175], v[24:27]
    ds_read_b64_tr_b16 v[104:105], v13 offset:12288
    buffer_load_dwordx4 v[164:167], v126, s[8:11], s44 offen offset:0 sc1
    v_mfma_f32_16x16x32_bf16 v[40:43], v[72:75], v[176:179], v[40:43]
    ds_read_b64_tr_b16 v[106:107], v13 offset:14336
    buffer_load_dwordx4 v[168:171], v127, s[8:11], s44 offen offset:0 sc1
    v_mfma_f32_16x16x32_bf16 v[44:47], v[76:79], v[176:179], v[44:47]
    ds_read_b64_tr_b16 v[108:109], v14 offset:12288
    s_waitcnt vmcnt(10)
    v_mfma_f32_16x16x32_bf16 v[28:31], v[76:79], v[172:175], v[28:31]
    ds_read_b64_tr_b16 v[110:111], v14 offset:14336
    v_or3_b32 v17, v180, v184, v188
    v_mfma_f32_16x16x32_bf16 v[32:35], v[80:83], v[172:175], v[32:35]
    ds_read_b64_tr_b16 v[112:113], v15 offset:12288
    v_bitop3_b32 v17, v17, v192, 1 bitop3:0xa8
    v_mfma_f32_16x16x32_bf16 v[48:51], v[80:83], v[176:179], v[48:51]
    ds_read_b64_tr_b16 v[114:115], v15 offset:14336
    v_cmp_ne_u32 vcc, 0, v17
    v_mfma_f32_16x16x32_bf16 v[52:55], v[84:87], v[176:179], v[52:55]
    ds_read_b64_tr_b16 v[116:117], v16 offset:12288
    ds_read_b64_tr_b16 v[118:119], v16 offset:14336
    v_mfma_f32_16x16x32_bf16 v[36:39], v[84:87], v[172:175], v[36:39]
    s_waitcnt lgkmcnt(8)
    s_cbranch_vccnz dm_22f0
dm_22g0:
    v_mfma_f32_16x16x32_bf16 v[24:27], v[88:91], v[180:183], v[24:27]
    ds_read_b64_tr_b16 v[56:57], v13 offset:16384
    buffer_load_dwordx4 v[172:175], v126, s[8:11], s44 offen offset:1024 sc1
    v_mfma_f32_16x16x32_bf16 v[40:43], v[88:91], v[184:187], v[40:43]
    ds_read_b64_tr_b16 v[58:59], v13 offset:18432
    buffer_load_dwordx4 v[176:179], v127, s[8:11], s44 offen offset:1024 sc1
    v_mfma_f32_16x16x32_bf16 v[44:47], v[92:95], v[184:187], v[44:47]
    ds_read_b64_tr_b16 v[60:61], v14 offset:16384
    v_mfma_f32_16x16x32_bf16 v[28:31], v[92:95], v[180:183], v[28:31]
    ds_read_b64_tr_b16 v[62:63], v14 offset:18432
    v_mfma_f32_16x16x32_bf16 v[32:35], v[96:99], v[180:183], v[32:35]
    ds_read_b64_tr_b16 v[64:65], v15 offset:16384
    v_mfma_f32_16x16x32_bf16 v[48:51], v[96:99], v[184:187], v[48:51]
    ds_read_b64_tr_b16 v[66:67], v15 offset:18432
    v_mfma_f32_16x16x32_bf16 v[52:55], v[100:103], v[184:187], v[52:55]
    ds_read_b64_tr_b16 v[68:69], v16 offset:16384
    v_mfma_f32_16x16x32_bf16 v[36:39], v[100:103], v[180:183], v[36:39]
    ds_read_b64_tr_b16 v[70:71], v16 offset:18432
    s_waitcnt lgkmcnt(8)
    v_mfma_f32_16x16x32_bf16 v[24:27], v[104:107], v[188:191], v[24:27]
    ds_read_b64_tr_b16 v[72:73], v13 offset:20480
    buffer_load_dwordx4 v[180:183], v126, s[8:11], s44 offen offset:2048 sc1
    v_mfma_f32_16x16x32_bf16 v[40:43], v[104:107], v[192:195], v[40:43]
    ds_read_b64_tr_b16 v[74:75], v13 offset:22528
    buffer_load_dwordx4 v[184:187], v127, s[8:11], s44 offen offset:2048 sc1
    v_mfma_f32_16x16x32_bf16 v[44:47], v[108:111], v[192:195], v[44:47]
    ds_read_b64_tr_b16 v[76:77], v14 offset:20480
    s_waitcnt vmcnt(10)
    v_mfma_f32_16x16x32_bf16 v[28:31], v[108:111], v[188:191], v[28:31]
    ds_read_b64_tr_b16 v[78:79], v14 offset:22528
    v_or3_b32 v17, v196, v200, v204
    v_mfma_f32_16x16x32_bf16 v[32:35], v[112:115], v[188:191], v[32:35]
    ds_read_b64_tr_b16 v[80:81], v15 offset:20480
    v_bitop3_b32 v17, v17, v208, 1 bitop3:0xa8
    v_mfma_f32_16x16x32_bf16 v[48:51], v[112:115], v[192:195], v[48:51]
    ds_read_b64_tr_b16 v[82:83], v15 offset:22528
    v_cmp_ne_u32 vcc, 0, v17
    v_mfma_f32_16x16x32_bf16 v[52:55], v[116:119], v[192:195], v[52:55]
    ds_read_b64_tr_b16 v[84:85], v16 offset:20480
    ds_read_b64_tr_b16 v[86:87], v16 offset:22528
    v_mfma_f32_16x16x32_bf16 v[36:39], v[116:119], v[188:191], v[36:39]
    s_waitcnt lgkmcnt(8)
    s_cbranch_vccnz dm_22f1
dm_22g1:
    v_mfma_f32_16x16x32_bf16 v[24:27], v[56:59], v[196:199], v[24:27]
    ds_read_b64_tr_b16 v[88:89], v13 offset:24576
    buffer_load_dwordx4 v[188:191], v126, s[8:11], s44 offen offset:3072 sc1
    v_mfma_f32_16x16x32_bf16 v[40:43], v[56:59], v[200:203], v[40:43]
    ds_read_b64_tr_b16 v[90:91], v13 offset:26624
    buffer_load_dwordx4 v[192:195], v127, s[8:11], s44 offen offset:3072 sc1
    v_mfma_f32_16x16x32_bf16 v[44:47], v[60:63], v[200:203], v[44:47]
    ds_read_b64_tr_b16 v[92:93], v14 offset:24576
    v_mfma_f32_16x16x32_bf16 v[28:31], v[60:63], v[196:199], v[28:31]
    ds_read_b64_tr_b16 v[94:95], v14 offset:26624
    v_mfma_f32_16x16x32_bf16 v[32:35], v[64:67], v[196:199], v[32:35]
    ds_read_b64_tr_b16 v[96:97], v15 offset:24576
    s_add_u32 s43, s43, 1
    v_mfma_f32_16x16x32_bf16 v[48:51], v[64:67], v[200:203], v[48:51]
    ds_read_b64_tr_b16 v[98:99], v15 offset:26624
    v_mfma_f32_16x16x32_bf16 v[52:55], v[68:71], v[200:203], v[52:55]
    ds_read_b64_tr_b16 v[100:101], v16 offset:24576
    v_mfma_f32_16x16x32_bf16 v[36:39], v[68:71], v[196:199], v[36:39]
    ds_read_b64_tr_b16 v[102:103], v16 offset:26624
    s_waitcnt lgkmcnt(8)
    v_mfma_f32_16x16x32_bf16 v[24:27], v[72:75], v[204:207], v[24:27]
    ds_read_b64_tr_b16 v[104:105], v13 offset:28672
    buffer_load_dwordx4 v[196:199], v128, s[8:11], s44 offen offset:0 sc1
    v_mfma_f32_16x16x32_bf16 v[40:43], v[72:75], v[208:211], v[40:43]
    ds_read_b64_tr_b16 v[106:107], v13 offset:30720
    buffer_load_dwordx4 v[200:203], v129, s[8:11], s44 offen offset:0 sc1
    v_mfma_f32_16x16x32_bf16 v[44:47], v[76:79], v[208:211], v[44:47]
    ds_read_b64_tr_b16 v[108:109], v14 offset:28672
    s_waitcnt vmcnt(10)
    v_mfma_f32_16x16x32_bf16 v[28:31], v[76:79], v[204:207], v[28:31]
    ds_read_b64_tr_b16 v[110:111], v14 offset:30720
    v_add_u32 v13, 32768, v13
    v_or3_b32 v17, v212, v216, v220
    v_mfma_f32_16x16x32_bf16 v[32:35], v[80:83], v[204:207], v[32:35]
    ds_read_b64_tr_b16 v[112:113], v15 offset:28672
    v_add_u32 v14, 32768, v14
    v_bitop3_b32 v17, v17, v224, 1 bitop3:0xa8
    v_mfma_f32_16x16x32_bf16 v[48:51], v[80:83], v[208:211], v[48:51]
    ds_read_b64_tr_b16 v[114:115], v15 offset:30720
    v_add_u32 v15, 32768, v15
    v_cmp_ne_u32 vcc, 0, v17
    v_mfma_f32_16x16x32_bf16 v[52:55], v[84:87], v[208:211], v[52:55]
    ds_read_b64_tr_b16 v[116:117], v16 offset:28672
    ds_read_b64_tr_b16 v[118:119], v16 offset:30720
    s_cmp_eq_u32 s43, 4
    v_mfma_f32_16x16x32_bf16 v[36:39], v[84:87], v[204:207], v[36:39]
    v_add_u32 v16, 32768, v16
    s_waitcnt lgkmcnt(8)
    s_cbranch_vccnz dm_22f2
dm_22g2:
    s_cbranch_scc1 dm_22x
    v_mfma_f32_16x16x32_bf16 v[24:27], v[88:91], v[212:215], v[24:27]
    ds_read_b64_tr_b16 v[56:57], v13 offset:0
    buffer_load_dwordx4 v[204:207], v128, s[8:11], s44 offen offset:1024 sc1
    v_mfma_f32_16x16x32_bf16 v[40:43], v[88:91], v[216:219], v[40:43]
    ds_read_b64_tr_b16 v[58:59], v13 offset:2048
    buffer_load_dwordx4 v[208:211], v129, s[8:11], s44 offen offset:1024 sc1
    v_mfma_f32_16x16x32_bf16 v[44:47], v[92:95], v[216:219], v[44:47]
    ds_read_b64_tr_b16 v[60:61], v14 offset:0
    s_mov_b32 s49, s44
    v_mfma_f32_16x16x32_bf16 v[28:31], v[92:95], v[212:215], v[28:31]
    ds_read_b64_tr_b16 v[62:63], v14 offset:2048
    v_mfma_f32_16x16x32_bf16 v[32:35], v[96:99], v[212:215], v[32:35]
    ds_read_b64_tr_b16 v[64:65], v15 offset:0
    v_mfma_f32_16x16x32_bf16 v[48:51], v[96:99], v[216:219], v[48:51]
    ds_read_b64_tr_b16 v[66:67], v15 offset:2048
    v_mfma_f32_16x16x32_bf16 v[52:55], v[100:103], v[216:219], v[52:55]
    ds_read_b64_tr_b16 v[68:69], v16 offset:0
    v_mfma_f32_16x16x32_bf16 v[36:39], v[100:103], v[212:215], v[36:39]
    ds_read_b64_tr_b16 v[70:71], v16 offset:2048
    s_waitcnt lgkmcnt(8)
    v_mfma_f32_16x16x32_bf16 v[24:27], v[104:107], v[220:223], v[24:27]
    ds_read_b64_tr_b16 v[72:73], v13 offset:4096
    buffer_load_dwordx4 v[212:215], v128, s[8:11], s44 offen offset:2048 sc1
    v_mfma_f32_16x16x32_bf16 v[40:43], v[104:107], v[224:227], v[40:43]
    ds_read_b64_tr_b16 v[74:75], v13 offset:6144
    buffer_load_dwordx4 v[216:219], v129, s[8:11], s44 offen offset:2048 sc1
    v_mfma_f32_16x16x32_bf16 v[44:47], v[108:111], v[224:227], v[44:47]
    ds_read_b64_tr_b16 v[76:77], v14 offset:4096
    s_waitcnt vmcnt(10)
    v_mfma_f32_16x16x32_bf16 v[28:31], v[108:111], v[220:223], v[28:31]
    ds_read_b64_tr_b16 v[78:79], v14 offset:6144
    v_or3_b32 v17, v164, v168, v172
    v_mfma_f32_16x16x32_bf16 v[32:35], v[112:115], v[220:223], v[32:35]
    ds_read_b64_tr_b16 v[80:81], v15 offset:4096
    v_bitop3_b32 v17, v17, v176, 1 bitop3:0xa8
    v_mfma_f32_16x16x32_bf16 v[48:51], v[112:115], v[224:227], v[48:51]
    ds_read_b64_tr_b16 v[82:83], v15 offset:6144
    v_cmp_ne_u32 vcc, 0, v17
    v_mfma_f32_16x16x32_bf16 v[52:55], v[116:119], v[224:227], v[52:55]
    ds_read_b64_tr_b16 v[84:85], v16 offset:4096
    ds_read_b64_tr_b16 v[86:87], v16 offset:6144
    v_mfma_f32_16x16x32_bf16 v[36:39], v[116:119], v[220:223], v[36:39]
    s_waitcnt lgkmcnt(8)
    s_cbranch_vccnz dm_22f3
dm_22g3:
    s_branch dm_22
dm_22f0:
    s_cselect_b32 s50, 1, 0
dm_22h0:
    s_sleep 2
    buffer_load_dwordx4 v[180:183], v126, s[8:11], s49 offen offset:2048 sc1
    buffer_load_dwordx4 v[184:187], v127, s[8:11], s49 offen offset:2048 sc1
    buffer_load_dwordx4 v[188:191], v126, s[8:11], s49 offen offset:3072 sc1
    buffer_load_dwordx4 v[192:195], v127, s[8:11], s49 offen offset:3072 sc1
    buffer_load_dwordx4 v[196:199], v128, s[8:11], s49 offen offset:0 sc1
    buffer_load_dwordx4 v[200:203], v129, s[8:11], s49 offen offset:0 sc1
    buffer_load_dwordx4 v[204:207], v128, s[8:11], s49 offen offset:1024 sc1
    buffer_load_dwordx4 v[208:211], v129, s[8:11], s49 offen offset:1024 sc1
    buffer_load_dwordx4 v[212:215], v128, s[8:11], s49 offen offset:2048 sc1
    buffer_load_dwordx4 v[216:219], v129, s[8:11], s49 offen offset:2048 sc1
    buffer_load_dwordx4 v[220:223], v128, s[8:11], s49 offen offset:3072 sc1
    buffer_load_dwordx4 v[224:227], v129, s[8:11], s49 offen offset:3072 sc1
    buffer_load_dwordx4 v[164:167], v126, s[8:11], s44 offen offset:0 sc1
    buffer_load_dwordx4 v[168:171], v127, s[8:11], s44 offen offset:0 sc1
    s_waitcnt vmcnt(10)
    v_or3_b32 v17, v180, v184, v188
    v_bitop3_b32 v17, v17, v192, 1 bitop3:0xa8
    v_cmp_ne_u32 vcc, 0, v17
    s_add_u32 s53, s53, 1
    s_cmp_ge_u32 s53, s61
    s_cselect_b32 s61, 0, s61
    s_cbranch_scc1 dm_22k0
    s_cbranch_vccnz dm_22h0
dm_22k0:
    s_cmp_eq_u32 s50, 1
    s_branch dm_22g0
dm_22f1:
    s_cselect_b32 s50, 1, 0
dm_22h1:
    s_sleep 2
    buffer_load_dwordx4 v[196:199], v128, s[8:11], s49 offen offset:0 sc1
    buffer_load_dwordx4 v[200:203], v129, s[8:11], s49 offen offset:0 sc1
    buffer_load_dwordx4 v[204:207], v128, s[8:11], s49 offen offset:1024 sc1
    buffer_load_dwordx4 v[208:211], v129, s[8:11], s49 offen offset:1024 sc1
    buffer_load_dwordx4 v[212:215], v128, s[8:11], s49 offen offset:2048 sc1
    buffer_load_dwordx4 v[216:219], v129, s[8:11], s49 offen offset:2048 sc1
    buffer_load_dwordx4 v[220:223], v128, s[8:11], s49 offen offset:3072 sc1
    buffer_load_dwordx4 v[224:227], v129, s[8:11], s49 offen offset:3072 sc1
    buffer_load_dwordx4 v[164:167], v126, s[8:11], s44 offen offset:0 sc1
    buffer_load_dwordx4 v[168:171], v127, s[8:11], s44 offen offset:0 sc1
    buffer_load_dwordx4 v[172:175], v126, s[8:11], s44 offen offset:1024 sc1
    buffer_load_dwordx4 v[176:179], v127, s[8:11], s44 offen offset:1024 sc1
    buffer_load_dwordx4 v[180:183], v126, s[8:11], s44 offen offset:2048 sc1
    buffer_load_dwordx4 v[184:187], v127, s[8:11], s44 offen offset:2048 sc1
    s_waitcnt vmcnt(10)
    v_or3_b32 v17, v196, v200, v204
    v_bitop3_b32 v17, v17, v208, 1 bitop3:0xa8
    v_cmp_ne_u32 vcc, 0, v17
    s_add_u32 s53, s53, 1
    s_cmp_ge_u32 s53, s61
    s_cselect_b32 s61, 0, s61
    s_cbranch_scc1 dm_22k1
    s_cbranch_vccnz dm_22h1
dm_22k1:
    s_cmp_eq_u32 s50, 1
    s_branch dm_22g1
dm_22f2:
    s_cselect_b32 s50, 1, 0
dm_22h2:
    s_sleep 2
    buffer_load_dwordx4 v[212:215], v128, s[8:11], s49 offen offset:2048 sc1
    buffer_load_dwordx4 v[216:219], v129, s[8:11], s49 offen offset:2048 sc1
    buffer_load_dwordx4 v[220:223], v128, s[8:11], s49 offen offset:3072 sc1
    buffer_load_dwordx4 v[224:227], v129, s[8:11], s49 offen offset:3072 sc1
    buffer_load_dwordx4 v[164:167], v126, s[8:11], s44 offen offset:0 sc1
    buffer_load_dwordx4 v[168:171], v127, s[8:11], s44 offen offset:0 sc1
    buffer_load_dwordx4 v[172:175], v126, s[8:11], s44 offen offset:1024 sc1
    buffer_load_dwordx4 v[176:179], v127, s[8:11], s44 offen offset:1024 sc1
    buffer_load_dwordx4 v[180:183], v126, s[8:11], s44 offen offset:2048 sc1
    buffer_load_dwordx4 v[184:187], v127, s[8:11], s44 offen offset:2048 sc1
    buffer_load_dwordx4 v[188:191], v126, s[8:11], s44 offen offset:3072 sc1
    buffer_load_dwordx4 v[192:195], v127, s[8:11], s44 offen offset:3072 sc1
    buffer_load_dwordx4 v[196:199], v128, s[8:11], s44 offen offset:0 sc1
    buffer_load_dwordx4 v[200:203], v129, s[8:11], s44 offen offset:0 sc1
    s_waitcnt vmcnt(10)
    v_or3_b32 v17, v212, v216, v220
    v_bitop3_b32 v17, v17, v224, 1 bitop3:0xa8
    v_cmp_ne_u32 vcc, 0, v17
    s_add_u32 s53, s53, 1
    s_cmp_ge_u32 s53, s61
    s_cselect_b32 s61, 0, s61
    s_cbranch_scc1 dm_22k2
    s_cbranch_vccnz dm_22h2
dm_22k2:
    s_cmp_eq_u32 s50, 1
    s_branch dm_22g2
dm_22f3:
    s_cselect_b32 s50, 1, 0
dm_22h3:
    s_sleep 2
    buffer_load_dwordx4 v[164:167], v126, s[8:11], s49 offen offset:0 sc1
    buffer_load_dwordx4 v[168:171], v127, s[8:11], s49 offen offset:0 sc1
    buffer_load_dwordx4 v[172:175], v126, s[8:11], s49 offen offset:1024 sc1
    buffer_load_dwordx4 v[176:179], v127, s[8:11], s49 offen offset:1024 sc1
    buffer_load_dwordx4 v[180:183], v126, s[8:11], s49 offen offset:2048 sc1
    buffer_load_dwordx4 v[184:187], v127, s[8:11], s49 offen offset:2048 sc1
    buffer_load_dwordx4 v[188:191], v126, s[8:11], s49 offen offset:3072 sc1
    buffer_load_dwordx4 v[192:195], v127, s[8:11], s49 offen offset:3072 sc1
    buffer_load_dwordx4 v[196:199], v128, s[8:11], s49 offen offset:0 sc1
    buffer_load_dwordx4 v[200:203], v129, s[8:11], s49 offen offset:0 sc1
    buffer_load_dwordx4 v[204:207], v128, s[8:11], s49 offen offset:1024 sc1
    buffer_load_dwordx4 v[208:211], v129, s[8:11], s49 offen offset:1024 sc1
    buffer_load_dwordx4 v[212:215], v128, s[8:11], s49 offen offset:2048 sc1
    buffer_load_dwordx4 v[216:219], v129, s[8:11], s49 offen offset:2048 sc1
    s_waitcnt vmcnt(10)
    v_or3_b32 v17, v164, v168, v172
    v_bitop3_b32 v17, v17, v176, 1 bitop3:0xa8
    v_cmp_ne_u32 vcc, 0, v17
    s_add_u32 s53, s53, 1
    s_cmp_ge_u32 s53, s61
    s_cselect_b32 s61, 0, s61
    s_cbranch_scc1 dm_22k3
    s_cbranch_vccnz dm_22h3
dm_22k3:
    s_cmp_eq_u32 s50, 1
    s_branch dm_22g3
dm_22x:
    v_mfma_f32_16x16x32_bf16 v[24:27], v[88:91], v[212:215], v[24:27]
    buffer_load_dwordx4 v[148:151], v126, s[8:11], s41 offen offset:0 sc1
    v_mfma_f32_16x16x32_bf16 v[40:43], v[88:91], v[216:219], v[40:43]
    v_mfma_f32_16x16x32_bf16 v[44:47], v[92:95], v[216:219], v[44:47]
    buffer_load_dwordx4 v[152:155], v126, s[8:11], s41 offen offset:1024 sc1
    v_mfma_f32_16x16x32_bf16 v[28:31], v[92:95], v[212:215], v[28:31]
    v_mfma_f32_16x16x32_bf16 v[32:35], v[96:99], v[212:215], v[32:35]
    buffer_load_dwordx4 v[156:159], v127, s[8:11], s41 offen offset:0 sc1
    v_mfma_f32_16x16x32_bf16 v[48:51], v[96:99], v[216:219], v[48:51]
    v_mfma_f32_16x16x32_bf16 v[52:55], v[100:103], v[216:219], v[52:55]
    buffer_load_dwordx4 v[160:163], v127, s[8:11], s41 offen offset:1024 sc1
    v_mfma_f32_16x16x32_bf16 v[36:39], v[100:103], v[212:215], v[36:39]
    s_waitcnt lgkmcnt(0)
    s_barrier
    v_mfma_f32_16x16x32_bf16 v[24:27], v[104:107], v[220:223], v[24:27]
    ds_read_b128 v[56:59], v6 offset:0
    v_mfma_f32_16x16x32_bf16 v[40:43], v[104:107], v[224:227], v[40:43]
    ds_read_b128 v[60:63], v6 offset:64
    v_mfma_f32_16x16x32_bf16 v[44:47], v[108:111], v[224:227], v[44:47]
    ds_read_b128 v[64:67], v6 offset:128
    v_mfma_f32_16x16x32_bf16 v[28:31], v[108:111], v[220:223], v[28:31]
    ds_read_b128 v[68:71], v6 offset:192
    v_mfma_f32_16x16x32_bf16 v[32:35], v[112:115], v[220:223], v[32:35]
    ds_read_b64 v[72:73], v7 offset:0
    v_mfma_f32_16x16x32_bf16 v[48:51], v[112:115], v[224:227], v[48:51]
    ds_read_b64 v[74:75], v7 offset:256
    v_mfma_f32_16x16x32_bf16 v[52:55], v[116:119], v[224:227], v[52:55]
    v_mfma_f32_16x16x32_bf16 v[36:39], v[116:119], v[220:223], v[36:39]
    s_waitcnt lgkmcnt(0)
    v_mul_f32 v134, 0xc0135761, v73
    v_mul_f32 v135, v73, v73
    v_mul_f32 v135, v135, v134
    v_mul_f32 v135, 0x3d372713, v135
    v_rcp_f32 v73, v73
    v_mul_f32 v136, 0xc0135761, v75
    v_mul_f32 v137, v75, v75
    v_mul_f32 v137, v137, v136
    v_mul_f32 v137, 0x3d372713, v137
    v_rcp_f32 v75, v75
    v_pk_fma_f32 v[24:25], v[72:73], v[56:57], v[24:25] op_sel_hi:[0,1,1] neg_lo:[1,0,0] neg_hi:[1,0,0]
    v_pk_fma_f32 v[26:27], v[72:73], v[58:59], v[26:27] op_sel_hi:[0,1,1] neg_lo:[1,0,0] neg_hi:[1,0,0]
    v_pk_mul_f32 v[122:123], v[24:25], v[24:25]
    v_pk_mul_f32 v[124:125], v[26:27], v[26:27]
    v_pk_fma_f32 v[122:123], v[122:123], v[134:135], v[134:135] op_sel:[0,1,0] op_sel_hi:[1,1,0]
    v_pk_fma_f32 v[124:125], v[124:125], v[134:135], v[134:135] op_sel:[0,1,0] op_sel_hi:[1,1,0]
    v_pk_mul_f32 v[122:123], v[122:123], v[24:25]
    v_pk_mul_f32 v[124:125], v[124:125], v[26:27]
    v_exp_f32 v122, v122
    v_exp_f32 v123, v123
    v_exp_f32 v124, v124
    v_exp_f32 v125, v125
    v_pk_fma_f32 v[122:123], v[122:123], v[72:73], v[72:73] op_sel:[0,1,1] op_sel_hi:[1,1,1]
    v_pk_fma_f32 v[124:125], v[124:125], v[72:73], v[72:73] op_sel:[0,1,1] op_sel_hi:[1,1,1]
    v_rcp_f32 v122, v122
    v_rcp_f32 v123, v123
    v_rcp_f32 v124, v124
    v_rcp_f32 v125, v125
    v_pk_mul_f32 v[24:25], v[24:25], v[122:123]
    v_pk_mul_f32 v[26:27], v[26:27], v[124:125]
    v_pk_fma_f32 v[28:29], v[72:73], v[60:61], v[28:29] op_sel_hi:[0,1,1] neg_lo:[1,0,0] neg_hi:[1,0,0]
    v_pk_fma_f32 v[30:31], v[72:73], v[62:63], v[30:31] op_sel_hi:[0,1,1] neg_lo:[1,0,0] neg_hi:[1,0,0]
    v_pk_mul_f32 v[122:123], v[28:29], v[28:29]
    v_pk_mul_f32 v[124:125], v[30:31], v[30:31]
    v_pk_fma_f32 v[122:123], v[122:123], v[134:135], v[134:135] op_sel:[0,1,0] op_sel_hi:[1,1,0]
    v_pk_fma_f32 v[124:125], v[124:125], v[134:135], v[134:135] op_sel:[0,1,0] op_sel_hi:[1,1,0]
    v_pk_mul_f32 v[122:123], v[122:123], v[28:29]
    v_pk_mul_f32 v[124:125], v[124:125], v[30:31]
    v_exp_f32 v122, v122
    v_exp_f32 v123, v123
    v_exp_f32 v124, v124
    v_exp_f32 v125, v125
    v_pk_fma_f32 v[122:123], v[122:123], v[72:73], v[72:73] op_sel:[0,1,1] op_sel_hi:[1,1,1]
    v_pk_fma_f32 v[124:125], v[124:125], v[72:73], v[72:73] op_sel:[0,1,1] op_sel_hi:[1,1,1]
    v_rcp_f32 v122, v122
    v_rcp_f32 v123, v123
    v_rcp_f32 v124, v124
    v_rcp_f32 v125, v125
    v_pk_mul_f32 v[28:29], v[28:29], v[122:123]
    v_pk_mul_f32 v[30:31], v[30:31], v[124:125]
    v_cvt_pk_bf16_f32 v24, v24, v25
    v_cvt_pk_bf16_f32 v25, v26, v27
    v_cvt_pk_bf16_f32 v26, v28, v29
    v_cvt_pk_bf16_f32 v27, v30, v31
    v_and_b32 v24, -2, v24
    buffer_store_dwordx4 v[24:27], v12, s[16:19], s39 offen offset:0 sc1
    v_pk_fma_f32 v[40:41], v[74:75], v[56:57], v[40:41] op_sel_hi:[0,1,1] neg_lo:[1,0,0] neg_hi:[1,0,0]
    v_pk_fma_f32 v[42:43], v[74:75], v[58:59], v[42:43] op_sel_hi:[0,1,1] neg_lo:[1,0,0] neg_hi:[1,0,0]
    v_pk_mul_f32 v[122:123], v[40:41], v[40:41]
    v_pk_mul_f32 v[124:125], v[42:43], v[42:43]
    v_pk_fma_f32 v[122:123], v[122:123], v[136:137], v[136:137] op_sel:[0,1,0] op_sel_hi:[1,1,0]
    v_pk_fma_f32 v[124:125], v[124:125], v[136:137], v[136:137] op_sel:[0,1,0] op_sel_hi:[1,1,0]
    v_pk_mul_f32 v[122:123], v[122:123], v[40:41]
    v_pk_mul_f32 v[124:125], v[124:125], v[42:43]
    v_exp_f32 v122, v122
    v_exp_f32 v123, v123
    v_exp_f32 v124, v124
    v_exp_f32 v125, v125
    v_pk_fma_f32 v[122:123], v[122:123], v[74:75], v[74:75] op_sel:[0,1,1] op_sel_hi:[1,1,1]
    v_pk_fma_f32 v[124:125], v[124:125], v[74:75], v[74:75] op_sel:[0,1,1] op_sel_hi:[1,1,1]
    v_rcp_f32 v122, v122
    v_rcp_f32 v123, v123
    v_rcp_f32 v124, v124
    v_rcp_f32 v125, v125
    v_pk_mul_f32 v[40:41], v[40:41], v[122:123]
    v_pk_mul_f32 v[42:43], v[42:43], v[124:125]
    v_pk_fma_f32 v[44:45], v[74:75], v[60:61], v[44:45] op_sel_hi:[0,1,1] neg_lo:[1,0,0] neg_hi:[1,0,0]
    v_pk_fma_f32 v[46:47], v[74:75], v[62:63], v[46:47] op_sel_hi:[0,1,1] neg_lo:[1,0,0] neg_hi:[1,0,0]
    v_pk_mul_f32 v[122:123], v[44:45], v[44:45]
    v_pk_mul_f32 v[124:125], v[46:47], v[46:47]
    v_pk_fma_f32 v[122:123], v[122:123], v[136:137], v[136:137] op_sel:[0,1,0] op_sel_hi:[1,1,0]
    v_pk_fma_f32 v[124:125], v[124:125], v[136:137], v[136:137] op_sel:[0,1,0] op_sel_hi:[1,1,0]
    v_pk_mul_f32 v[122:123], v[122:123], v[44:45]
    v_pk_mul_f32 v[124:125], v[124:125], v[46:47]
    v_exp_f32 v122, v122
    v_exp_f32 v123, v123
    v_exp_f32 v124, v124
    v_exp_f32 v125, v125
    v_pk_fma_f32 v[122:123], v[122:123], v[74:75], v[74:75] op_sel:[0,1,1] op_sel_hi:[1,1,1]
    v_pk_fma_f32 v[124:125], v[124:125], v[74:75], v[74:75] op_sel:[0,1,1] op_sel_hi:[1,1,1]
    v_rcp_f32 v122, v122
    v_rcp_f32 v123, v123
    v_rcp_f32 v124, v124
    v_rcp_f32 v125, v125
    v_pk_mul_f32 v[44:45], v[44:45], v[122:123]
    v_pk_mul_f32 v[46:47], v[46:47], v[124:125]
    v_cvt_pk_bf16_f32 v40, v40, v41
    v_cvt_pk_bf16_f32 v41, v42, v43
    v_cvt_pk_bf16_f32 v42, v44, v45
    v_cvt_pk_bf16_f32 v43, v46, v47
    v_and_b32 v40, -2, v40
    buffer_store_dwordx4 v[40:43], v12, s[16:19], s39 offen offset:256 sc1
    v_pk_fma_f32 v[32:33], v[72:73], v[64:65], v[32:33] op_sel_hi:[0,1,1] neg_lo:[1,0,0] neg_hi:[1,0,0]
    v_pk_fma_f32 v[34:35], v[72:73], v[66:67], v[34:35] op_sel_hi:[0,1,1] neg_lo:[1,0,0] neg_hi:[1,0,0]
    v_pk_mul_f32 v[122:123], v[32:33], v[32:33]
    v_pk_mul_f32 v[124:125], v[34:35], v[34:35]
    v_pk_fma_f32 v[122:123], v[122:123], v[134:135], v[134:135] op_sel:[0,1,0] op_sel_hi:[1,1,0]
    v_pk_fma_f32 v[124:125], v[124:125], v[134:135], v[134:135] op_sel:[0,1,0] op_sel_hi:[1,1,0]
    v_pk_mul_f32 v[122:123], v[122:123], v[32:33]
    v_pk_mul_f32 v[124:125], v[124:125], v[34:35]
    v_exp_f32 v122, v122
    v_exp_f32 v123, v123
    v_exp_f32 v124, v124
    v_exp_f32 v125, v125
    v_pk_fma_f32 v[122:123], v[122:123], v[72:73], v[72:73] op_sel:[0,1,1] op_sel_hi:[1,1,1]
    v_pk_fma_f32 v[124:125], v[124:125], v[72:73], v[72:73] op_sel:[0,1,1] op_sel_hi:[1,1,1]
    v_rcp_f32 v122, v122
    v_rcp_f32 v123, v123
    v_rcp_f32 v124, v124
    v_rcp_f32 v125, v125
    v_pk_mul_f32 v[32:33], v[32:33], v[122:123]
    v_pk_mul_f32 v[34:35], v[34:35], v[124:125]
    v_pk_fma_f32 v[36:37], v[72:73], v[68:69], v[36:37] op_sel_hi:[0,1,1] neg_lo:[1,0,0] neg_hi:[1,0,0]
    v_pk_fma_f32 v[38:39], v[72:73], v[70:71], v[38:39] op_sel_hi:[0,1,1] neg_lo:[1,0,0] neg_hi:[1,0,0]
    v_pk_mul_f32 v[122:123], v[36:37], v[36:37]
    v_pk_mul_f32 v[124:125], v[38:39], v[38:39]
    v_pk_fma_f32 v[122:123], v[122:123], v[134:135], v[134:135] op_sel:[0,1,0] op_sel_hi:[1,1,0]
    v_pk_fma_f32 v[124:125], v[124:125], v[134:135], v[134:135] op_sel:[0,1,0] op_sel_hi:[1,1,0]
    v_pk_mul_f32 v[122:123], v[122:123], v[36:37]
    v_pk_mul_f32 v[124:125], v[124:125], v[38:39]
    v_exp_f32 v122, v122
    v_exp_f32 v123, v123
    v_exp_f32 v124, v124
    v_exp_f32 v125, v125
    v_pk_fma_f32 v[122:123], v[122:123], v[72:73], v[72:73] op_sel:[0,1,1] op_sel_hi:[1,1,1]
    v_pk_fma_f32 v[124:125], v[124:125], v[72:73], v[72:73] op_sel:[0,1,1] op_sel_hi:[1,1,1]
    v_rcp_f32 v122, v122
    v_rcp_f32 v123, v123
    v_rcp_f32 v124, v124
    v_rcp_f32 v125, v125
    v_pk_mul_f32 v[36:37], v[36:37], v[122:123]
    v_pk_mul_f32 v[38:39], v[38:39], v[124:125]
    v_cvt_pk_bf16_f32 v32, v32, v33
    v_cvt_pk_bf16_f32 v33, v34, v35
    v_cvt_pk_bf16_f32 v34, v36, v37
    v_cvt_pk_bf16_f32 v35, v38, v39
    v_and_b32 v32, -2, v32
    buffer_store_dwordx4 v[32:35], v12, s[16:19], s40 offen offset:0 sc1
    v_pk_fma_f32 v[48:49], v[74:75], v[64:65], v[48:49] op_sel_hi:[0,1,1] neg_lo:[1,0,0] neg_hi:[1,0,0]
    v_pk_fma_f32 v[50:51], v[74:75], v[66:67], v[50:51] op_sel_hi:[0,1,1] neg_lo:[1,0,0] neg_hi:[1,0,0]
    v_pk_mul_f32 v[122:123], v[48:49], v[48:49]
    v_pk_mul_f32 v[124:125], v[50:51], v[50:51]
    v_pk_fma_f32 v[122:123], v[122:123], v[136:137], v[136:137] op_sel:[0,1,0] op_sel_hi:[1,1,0]
    v_pk_fma_f32 v[124:125], v[124:125], v[136:137], v[136:137] op_sel:[0,1,0] op_sel_hi:[1,1,0]
    v_pk_mul_f32 v[122:123], v[122:123], v[48:49]
    v_pk_mul_f32 v[124:125], v[124:125], v[50:51]
    v_exp_f32 v122, v122
    v_exp_f32 v123, v123
    v_exp_f32 v124, v124
    v_exp_f32 v125, v125
    v_pk_fma_f32 v[122:123], v[122:123], v[74:75], v[74:75] op_sel:[0,1,1] op_sel_hi:[1,1,1]
    v_pk_fma_f32 v[124:125], v[124:125], v[74:75], v[74:75] op_sel:[0,1,1] op_sel_hi:[1,1,1]
    v_rcp_f32 v122, v122
    v_rcp_f32 v123, v123
    v_rcp_f32 v124, v124
    v_rcp_f32 v125, v125
    v_pk_mul_f32 v[48:49], v[48:49], v[122:123]
    v_pk_mul_f32 v[50:51], v[50:51], v[124:125]
    v_pk_fma_f32 v[52:53], v[74:75], v[68:69], v[52:53] op_sel_hi:[0,1,1] neg_lo:[1,0,0] neg_hi:[1,0,0]
    v_pk_fma_f32 v[54:55], v[74:75], v[70:71], v[54:55] op_sel_hi:[0,1,1] neg_lo:[1,0,0] neg_hi:[1,0,0]
    v_pk_mul_f32 v[122:123], v[52:53], v[52:53]
    v_pk_mul_f32 v[124:125], v[54:55], v[54:55]
    v_pk_fma_f32 v[122:123], v[122:123], v[136:137], v[136:137] op_sel:[0,1,0] op_sel_hi:[1,1,0]
    v_pk_fma_f32 v[124:125], v[124:125], v[136:137], v[136:137] op_sel:[0,1,0] op_sel_hi:[1,1,0]
    v_pk_mul_f32 v[122:123], v[122:123], v[52:53]
    v_pk_mul_f32 v[124:125], v[124:125], v[54:55]
    v_exp_f32 v122, v122
    v_exp_f32 v123, v123
    v_exp_f32 v124, v124
    v_exp_f32 v125, v125
    v_pk_fma_f32 v[122:123], v[122:123], v[74:75], v[74:75] op_sel:[0,1,1] op_sel_hi:[1,1,1]
    v_pk_fma_f32 v[124:125], v[124:125], v[74:75], v[74:75] op_sel:[0,1,1] op_sel_hi:[1,1,1]
    v_rcp_f32 v122, v122
    v_rcp_f32 v123, v123
    v_rcp_f32 v124, v124
    v_rcp_f32 v125, v125
    v_pk_mul_f32 v[52:53], v[52:53], v[122:123]
    v_pk_mul_f32 v[54:55], v[54:55], v[124:125]
    v_cvt_pk_bf16_f32 v48, v48, v49
    v_cvt_pk_bf16_f32 v49, v50, v51
    v_cvt_pk_bf16_f32 v50, v52, v53
    v_cvt_pk_bf16_f32 v51, v54, v55
    v_and_b32 v48, -2, v48
    buffer_store_dwordx4 v[48:51], v12, s[16:19], s40 offen offset:256 sc1
    s_add_u32 s8, s4, 0x2100000
    s_addc_u32 s9, s5, 0
    s_mov_b32 s10, 0x8400000
    s_mov_b32 s11, 0x20000
    s_sub_u32 s47, s55, 39583744
    s_lshl_b32 s46, s30, 9
    s_add_u32 s47, s47, s46
    s_add_u32 s45, s92, 2048
    s_cmp_eq_u32 s28, 0
    s_cselect_b32 s45, 1073741824, s45
    s_cmp_eq_u32 s30, 0
    s_cselect_b32 s45, s45, 0
    s_add_u32 s53, s47, 0xfffffff0
    v_add_u32 v126, s53, v12
    v_add_u32 v127, 256, v126
    v_add_u32 v134, s45, v126
    v_cmp_gt_u32 vcc, 1, v22
    s_nop 1
    v_cndmask_b32 v126, v126, v134, vcc
    s_mov_b32 s34, s30
    s_mov_b32 s35, 0
    v_and_b32 v22, 15, v1
    v_lshrrev_b32 v23, 4, v1
    s_mul_i32 s37, s34, 2
    s_mul_i32 s38, s29, 4
    s_mul_i32 s36, s35, 4
    s_add_u32 s38, s38, s36
    s_lshr_b32 s36, s38, 1
    s_lshr_b32 s53, s36, 3
    s_lshl_b32 s53, s53, 14
    s_and_b32 s39, s36, 7
    s_lshl_b32 s39, s39, 10
    s_add_u32 s39, s39, s53
    s_lshl_b32 s36, s37, 16
    s_add_u32 s39, s39, s36
    s_sub_u32 s46, s93, 2048
    s_cmp_eq_u32 s28, 15
    s_cselect_b32 s46, 1073741824, s46
    s_cmp_eq_u32 s30, 3
    s_cselect_b32 s46, s46, 0
    s_add_u32 s53, s47, 0x10
    v_add_u32 v128, s53, v12
    v_add_u32 v129, 256, v128
    v_add_u32 v134, s46, v129
    v_cmp_le_u32 vcc, 15, v22
    s_nop 1
    v_cndmask_b32 v129, v129, v134, vcc
    s_add_u32 s53, s47, 0xffffffe0
    v_add_u32 v130, s53, v12
    v_add_u32 v131, 256, v130
    v_add_u32 v134, s45, v130
    v_cmp_gt_u32 vcc, 2, v22
    s_nop 1
    v_cndmask_b32 v130, v130, v134, vcc
    s_add_u32 s53, s47, 0x20
    v_add_u32 v132, s53, v12
    v_add_u32 v133, 256, v132
    v_add_u32 v134, s46, v133
    v_cmp_le_u32 vcc, 14, v22
    s_nop 1
    v_cndmask_b32 v133, v133, v134, vcc
    v_mov_b32 v134, v126
    v_mov_b32 v135, v127
    v_lshrrev_b32 v6, 2, v1
    v_mul_u32_u24 v13, 128, v6
    v_and_b32 v7, 3, v1
    v_lshl_add_u32 v13, v7, 3, v13
    v_add_u32 v13, 0, v13
    v_bfe_u32 v6, v6, 1, 2
    s_mul_i32 s36, s35, 4
    s_add_u32 s36, s36, 3
    v_xor_b32 v7, s36, v6
    v_lshl_add_u32 v16, v7, 5, v13
    s_mul_i32 s36, s35, 4
    s_add_u32 s36, s36, 2
    v_xor_b32 v7, s36, v6
    v_lshl_add_u32 v15, v7, 5, v13
    s_mul_i32 s36, s35, 4
    s_add_u32 s36, s36, 1
    v_xor_b32 v7, s36, v6
    v_lshl_add_u32 v14, v7, 5, v13
    s_mul_i32 s36, s35, 4
    s_add_u32 s36, s36, 0
    v_xor_b32 v7, s36, v6
    v_lshl_add_u32 v13, v7, 5, v13
    s_lshl_b32 s36, s37, 8
    s_add_u32 s36, s36, 160768
    v_lshlrev_b32 v7, 4, v22
    v_add_u32 v7, s36, v7
    ds_read_b64 v[56:57], v7 offset:0
    ds_read_b64 v[58:59], v7 offset:256
    s_waitcnt vmcnt(4) lgkmcnt(0)
    s_sleep 3
    s_cmp_lg_u32 s60, 0
    s_cbranch_scc1 G2_nd
    s_sleep 2
G2_nd:
    s_mov_b32 s44, 0
    buffer_load_dwordx4 v[164:167], v126, s[8:11], s44 offen sc1
    buffer_load_dwordx4 v[168:171], v127, s[8:11], s44 offen sc1
    s_add_u32 s44, s44, 16384
    buffer_load_dwordx4 v[172:175], v126, s[8:11], s44 offen sc1
    buffer_load_dwordx4 v[176:179], v127, s[8:11], s44 offen sc1
    s_add_u32 s44, s44, 16384
    v_lshlrev_b32 v24, 16, v148
    v_and_b32 v25, 0xffff0000, v148
    v_pk_add_f32 v[24:25], v[24:25], v[56:57] op_sel_hi:[1,0] neg_lo:[0,1] neg_hi:[0,1]
    v_pk_mul_f32 v[24:25], v[24:25], v[56:57] op_sel:[0,1] op_sel_hi:[1,1]
    v_lshlrev_b32 v26, 16, v149
    v_and_b32 v27, 0xffff0000, v149
    v_pk_add_f32 v[26:27], v[26:27], v[56:57] op_sel_hi:[1,0] neg_lo:[0,1] neg_hi:[0,1]
    v_pk_mul_f32 v[26:27], v[26:27], v[56:57] op_sel:[0,1] op_sel_hi:[1,1]
    v_lshlrev_b32 v28, 16, v150
    v_and_b32 v29, 0xffff0000, v150
    v_pk_add_f32 v[28:29], v[28:29], v[56:57] op_sel_hi:[1,0] neg_lo:[0,1] neg_hi:[0,1]
    v_pk_mul_f32 v[28:29], v[28:29], v[56:57] op_sel:[0,1] op_sel_hi:[1,1]
    v_lshlrev_b32 v30, 16, v151
    v_and_b32 v31, 0xffff0000, v151
    v_pk_add_f32 v[30:31], v[30:31], v[56:57] op_sel_hi:[1,0] neg_lo:[0,1] neg_hi:[0,1]
    v_pk_mul_f32 v[30:31], v[30:31], v[56:57] op_sel:[0,1] op_sel_hi:[1,1]
    v_lshlrev_b32 v32, 16, v152
    v_and_b32 v33, 0xffff0000, v152
    v_pk_add_f32 v[32:33], v[32:33], v[56:57] op_sel_hi:[1,0] neg_lo:[0,1] neg_hi:[0,1]
    v_pk_mul_f32 v[32:33], v[32:33], v[56:57] op_sel:[0,1] op_sel_hi:[1,1]
    v_lshlrev_b32 v34, 16, v153
    v_and_b32 v35, 0xffff0000, v153
    v_pk_add_f32 v[34:35], v[34:35], v[56:57] op_sel_hi:[1,0] neg_lo:[0,1] neg_hi:[0,1]
    v_pk_mul_f32 v[34:35], v[34:35], v[56:57] op_sel:[0,1] op_sel_hi:[1,1]
    v_lshlrev_b32 v36, 16, v154
    v_and_b32 v37, 0xffff0000, v154
    v_pk_add_f32 v[36:37], v[36:37], v[56:57] op_sel_hi:[1,0] neg_lo:[0,1] neg_hi:[0,1]
    v_pk_mul_f32 v[36:37], v[36:37], v[56:57] op_sel:[0,1] op_sel_hi:[1,1]
    v_lshlrev_b32 v38, 16, v155
    v_and_b32 v39, 0xffff0000, v155
    v_pk_add_f32 v[38:39], v[38:39], v[56:57] op_sel_hi:[1,0] neg_lo:[0,1] neg_hi:[0,1]
    v_pk_mul_f32 v[38:39], v[38:39], v[56:57] op_sel:[0,1] op_sel_hi:[1,1]
    v_lshlrev_b32 v40, 16, v156
    v_and_b32 v41, 0xffff0000, v156
    v_pk_add_f32 v[40:41], v[40:41], v[58:59] op_sel_hi:[1,0] neg_lo:[0,1] neg_hi:[0,1]
    v_pk_mul_f32 v[40:41], v[40:41], v[58:59] op_sel:[0,1] op_sel_hi:[1,1]
    v_lshlrev_b32 v42, 16, v157
    v_and_b32 v43, 0xffff0000, v157
    v_pk_add_f32 v[42:43], v[42:43], v[58:59] op_sel_hi:[1,0] neg_lo:[0,1] neg_hi:[0,1]
    v_pk_mul_f32 v[42:43], v[42:43], v[58:59] op_sel:[0,1] op_sel_hi:[1,1]
    v_lshlrev_b32 v44, 16, v158
    v_and_b32 v45, 0xffff0000, v158
    v_pk_add_f32 v[44:45], v[44:45], v[58:59] op_sel_hi:[1,0] neg_lo:[0,1] neg_hi:[0,1]
    v_pk_mul_f32 v[44:45], v[44:45], v[58:59] op_sel:[0,1] op_sel_hi:[1,1]
    v_lshlrev_b32 v46, 16, v159
    v_and_b32 v47, 0xffff0000, v159
    v_pk_add_f32 v[46:47], v[46:47], v[58:59] op_sel_hi:[1,0] neg_lo:[0,1] neg_hi:[0,1]
    v_pk_mul_f32 v[46:47], v[46:47], v[58:59] op_sel:[0,1] op_sel_hi:[1,1]
    v_lshlrev_b32 v48, 16, v160
    v_and_b32 v49, 0xffff0000, v160
    v_pk_add_f32 v[48:49], v[48:49], v[58:59] op_sel_hi:[1,0] neg_lo:[0,1] neg_hi:[0,1]
    v_pk_mul_f32 v[48:49], v[48:49], v[58:59] op_sel:[0,1] op_sel_hi:[1,1]
    v_lshlrev_b32 v50, 16, v161
    v_and_b32 v51, 0xffff0000, v161
    v_pk_add_f32 v[50:51], v[50:51], v[58:59] op_sel_hi:[1,0] neg_lo:[0,1] neg_hi:[0,1]
    v_pk_mul_f32 v[50:51], v[50:51], v[58:59] op_sel:[0,1] op_sel_hi:[1,1]
    v_lshlrev_b32 v52, 16, v162
    v_and_b32 v53, 0xffff0000, v162
    v_pk_add_f32 v[52:53], v[52:53], v[58:59] op_sel_hi:[1,0] neg_lo:[0,1] neg_hi:[0,1]
    v_pk_mul_f32 v[52:53], v[52:53], v[58:59] op_sel:[0,1] op_sel_hi:[1,1]
    v_lshlrev_b32 v54, 16, v163
    v_and_b32 v55, 0xffff0000, v163
    v_pk_add_f32 v[54:55], v[54:55], v[58:59] op_sel_hi:[1,0] neg_lo:[0,1] neg_hi:[0,1]
    v_pk_mul_f32 v[54:55], v[54:55], v[58:59] op_sel:[0,1] op_sel_hi:[1,1]
    s_mov_b32 s43, 0
    s_add_u32 s16, s62, 0x80000
    s_addc_u32 s17, s63, 0
    s_mov_b32 s18, 0x7e000
    s_mov_b32 s19, 0x20000
    s_mov_b32 s53, 0
    s_mov_b32 s49, s44
    s_barrier
    ds_read_b64_tr_b16 v[56:57], v13 offset:0
    ds_read_b64_tr_b16 v[58:59], v13 offset:2048
    ds_read_b64_tr_b16 v[60:61], v14 offset:0
    ds_read_b64_tr_b16 v[62:63], v14 offset:2048
    ds_read_b64_tr_b16 v[64:65], v15 offset:0
    ds_read_b64_tr_b16 v[66:67], v15 offset:2048
    ds_read_b64_tr_b16 v[68:69], v16 offset:0
    ds_read_b64_tr_b16 v[70:71], v16 offset:2048
    ds_read_b64_tr_b16 v[72:73], v13 offset:4096
    ds_read_b64_tr_b16 v[74:75], v13 offset:6144
    ds_read_b64_tr_b16 v[76:77], v14 offset:4096
    ds_read_b64_tr_b16 v[78:79], v14 offset:6144
    ds_read_b64_tr_b16 v[80:81], v15 offset:4096
    ds_read_b64_tr_b16 v[82:83], v15 offset:6144
    ds_read_b64_tr_b16 v[84:85], v16 offset:4096
    ds_read_b64_tr_b16 v[86:87], v16 offset:6144
    s_branch dm_23w
dm_23p:
    s_mov_b32 s44, 0
    buffer_load_dwordx4 v[164:167], v126, s[8:11], s44 offen sc1
    buffer_load_dwordx4 v[168:171], v127, s[8:11], s44 offen sc1
    s_add_u32 s44, s44, 16384
    buffer_load_dwordx4 v[172:175], v126, s[8:11], s44 offen sc1
    buffer_load_dwordx4 v[176:179], v127, s[8:11], s44 offen sc1
    s_add_u32 s44, s44, 16384
dm_23w:
    s_waitcnt vmcnt(0)
    v_or3_b32 v17, v164, v168, v172
    v_bitop3_b32 v17, v17, v176, 1 bitop3:0xa8
    v_cmp_ne_u32 vcc, 0, v17
    s_cbranch_vccz dm_23q
    s_sleep 2
    s_add_u32 s53, s53, 1
    s_cmp_lt_u32 s53, s61
    s_cbranch_scc1 dm_23p
    s_mov_b32 s61, 0
dm_23q:
    buffer_load_dwordx4 v[180:183], v126, s[8:11], s44 offen
    buffer_load_dwordx4 v[184:187], v127, s[8:11], s44 offen
    s_add_u32 s44, s44, 16384
    buffer_load_dwordx4 v[188:191], v126, s[8:11], s44 offen
    buffer_load_dwordx4 v[192:195], v127, s[8:11], s44 offen
    s_add_u32 s44, s44, 16384
    buffer_load_dwordx4 v[196:199], v126, s[8:11], s44 offen
    buffer_load_dwordx4 v[200:203], v127, s[8:11], s44 offen
    s_add_u32 s44, s44, 16384
    buffer_load_dwordx4 v[204:207], v126, s[8:11], s44 offen
    buffer_load_dwordx4 v[208:211], v127, s[8:11], s44 offen
    s_add_u32 s44, s44, 16384
    buffer_load_dwordx4 v[212:215], v126, s[8:11], s44 offen
    buffer_load_dwordx4 v[216:219], v127, s[8:11], s44 offen
    s_add_u32 s44, s44, 16384
    s_waitcnt lgkmcnt(0)
dm_23:
    v_mfma_f32_16x16x32_bf16 v[24:27], v[56:59], v[164:167], v[24:27]
    ds_read_b64_tr_b16 v[88:89], v13 offset:8192
    buffer_load_dwordx4 v[220:223], v126, s[8:11], s44 offen
    v_mfma_f32_16x16x32_bf16 v[40:43], v[56:59], v[168:171], v[40:43]
    ds_read_b64_tr_b16 v[90:91], v13 offset:10240
    buffer_load_dwordx4 v[224:227], v127, s[8:11], s44 offen
    v_mfma_f32_16x16x32_bf16 v[44:47], v[60:63], v[168:171], v[44:47]
    ds_read_b64_tr_b16 v[92:93], v14 offset:8192
    s_add_u32 s44, s44, 16384
    v_mfma_f32_16x16x32_bf16 v[28:31], v[60:63], v[164:167], v[28:31]
    ds_read_b64_tr_b16 v[94:95], v14 offset:10240
    v_mov_b32 v126, v128
    v_mfma_f32_16x16x32_bf16 v[32:35], v[64:67], v[164:167], v[32:35]
    ds_read_b64_tr_b16 v[96:97], v15 offset:8192
    v_mov_b32 v127, v129
    v_mfma_f32_16x16x32_bf16 v[48:51], v[64:67], v[168:171], v[48:51]
    ds_read_b64_tr_b16 v[98:99], v15 offset:10240
    v_mov_b32 v128, v130
    v_mfma_f32_16x16x32_bf16 v[52:55], v[68:71], v[168:171], v[52:55]
    ds_read_b64_tr_b16 v[100:101], v16 offset:8192
    v_mov_b32 v129, v131
    v_mfma_f32_16x16x32_bf16 v[36:39], v[68:71], v[164:167], v[36:39]
    ds_read_b64_tr_b16 v[102:103], v16 offset:10240
    s_waitcnt lgkmcnt(8)
    v_mfma_f32_16x16x32_bf16 v[24:27], v[72:75], v[172:175], v[24:27]
    ds_read_b64_tr_b16 v[104:105], v13 offset:12288
    buffer_load_dwordx4 v[164:167], v126, s[8:11], s44 offen
    v_mfma_f32_16x16x32_bf16 v[40:43], v[72:75], v[176:179], v[40:43]
    ds_read_b64_tr_b16 v[106:107], v13 offset:14336
    buffer_load_dwordx4 v[168:171], v127, s[8:11], s44 offen
    v_mfma_f32_16x16x32_bf16 v[44:47], v[76:79], v[176:179], v[44:47]
    ds_read_b64_tr_b16 v[108:109], v14 offset:12288
    s_add_u32 s44, s44, 16384
    s_waitcnt vmcnt(10)
    v_mfma_f32_16x16x32_bf16 v[28:31], v[76:79], v[172:175], v[28:31]
    ds_read_b64_tr_b16 v[110:111], v14 offset:14336
    v_or3_b32 v17, v180, v184, v188
    v_mfma_f32_16x16x32_bf16 v[32:35], v[80:83], v[172:175], v[32:35]
    ds_read_b64_tr_b16 v[112:113], v15 offset:12288
    v_bitop3_b32 v17, v17, v192, 1 bitop3:0xa8
    v_mfma_f32_16x16x32_bf16 v[48:51], v[80:83], v[176:179], v[48:51]
    ds_read_b64_tr_b16 v[114:115], v15 offset:14336
    v_cmp_ne_u32 vcc, 0, v17
    v_mfma_f32_16x16x32_bf16 v[52:55], v[84:87], v[176:179], v[52:55]
    ds_read_b64_tr_b16 v[116:117], v16 offset:12288
    ds_read_b64_tr_b16 v[118:119], v16 offset:14336
    v_mfma_f32_16x16x32_bf16 v[36:39], v[84:87], v[172:175], v[36:39]
    s_waitcnt lgkmcnt(8)
    s_cbranch_vccnz dm_23f0
dm_23g0:
    v_mfma_f32_16x16x32_bf16 v[24:27], v[88:91], v[180:183], v[24:27]
    ds_read_b64_tr_b16 v[56:57], v13 offset:16384
    buffer_load_dwordx4 v[172:175], v126, s[8:11], s44 offen
    v_mfma_f32_16x16x32_bf16 v[40:43], v[88:91], v[184:187], v[40:43]
    ds_read_b64_tr_b16 v[58:59], v13 offset:18432
    buffer_load_dwordx4 v[176:179], v127, s[8:11], s44 offen
    v_mfma_f32_16x16x32_bf16 v[44:47], v[92:95], v[184:187], v[44:47]
    ds_read_b64_tr_b16 v[60:61], v14 offset:16384
    s_add_u32 s44, s44, 16384
    v_mfma_f32_16x16x32_bf16 v[28:31], v[92:95], v[180:183], v[28:31]
    ds_read_b64_tr_b16 v[62:63], v14 offset:18432
    v_mov_b32 v130, v132
    v_mfma_f32_16x16x32_bf16 v[32:35], v[96:99], v[180:183], v[32:35]
    ds_read_b64_tr_b16 v[64:65], v15 offset:16384
    v_mov_b32 v131, v133
    v_mfma_f32_16x16x32_bf16 v[48:51], v[96:99], v[184:187], v[48:51]
    ds_read_b64_tr_b16 v[66:67], v15 offset:18432
    v_mov_b32 v132, 1073741824
    v_mfma_f32_16x16x32_bf16 v[52:55], v[100:103], v[184:187], v[52:55]
    ds_read_b64_tr_b16 v[68:69], v16 offset:16384
    v_mov_b32 v133, 1073741824
    v_mfma_f32_16x16x32_bf16 v[36:39], v[100:103], v[180:183], v[36:39]
    ds_read_b64_tr_b16 v[70:71], v16 offset:18432
    s_waitcnt lgkmcnt(8)
    v_mfma_f32_16x16x32_bf16 v[24:27], v[104:107], v[188:191], v[24:27]
    ds_read_b64_tr_b16 v[72:73], v13 offset:20480
    buffer_load_dwordx4 v[180:183], v126, s[8:11], s44 offen
    v_mfma_f32_16x16x32_bf16 v[40:43], v[104:107], v[192:195], v[40:43]
    ds_read_b64_tr_b16 v[74:75], v13 offset:22528
    buffer_load_dwordx4 v[184:187], v127, s[8:11], s44 offen
    v_mfma_f32_16x16x32_bf16 v[44:47], v[108:111], v[192:195], v[44:47]
    ds_read_b64_tr_b16 v[76:77], v14 offset:20480
    s_add_u32 s44, s44, 16384
    s_waitcnt vmcnt(10)
    v_mfma_f32_16x16x32_bf16 v[28:31], v[108:111], v[188:191], v[28:31]
    ds_read_b64_tr_b16 v[78:79], v14 offset:22528
    v_or3_b32 v17, v196, v200, v204
    v_mfma_f32_16x16x32_bf16 v[32:35], v[112:115], v[188:191], v[32:35]
    ds_read_b64_tr_b16 v[80:81], v15 offset:20480
    v_bitop3_b32 v17, v17, v208, 1 bitop3:0xa8
    v_mfma_f32_16x16x32_bf16 v[48:51], v[112:115], v[192:195], v[48:51]
    ds_read_b64_tr_b16 v[82:83], v15 offset:22528
    v_cmp_ne_u32 vcc, 0, v17
    v_mfma_f32_16x16x32_bf16 v[52:55], v[116:119], v[192:195], v[52:55]
    ds_read_b64_tr_b16 v[84:85], v16 offset:20480
    ds_read_b64_tr_b16 v[86:87], v16 offset:22528
    v_mfma_f32_16x16x32_bf16 v[36:39], v[116:119], v[188:191], v[36:39]
    s_waitcnt lgkmcnt(8)
    s_cbranch_vccnz dm_23f1
dm_23g1:
    v_mfma_f32_16x16x32_bf16 v[24:27], v[56:59], v[196:199], v[24:27]
    ds_read_b64_tr_b16 v[88:89], v13 offset:24576
    buffer_load_dwordx4 v[188:191], v126, s[8:11], s44 offen
    v_mfma_f32_16x16x32_bf16 v[40:43], v[56:59], v[200:203], v[40:43]
    ds_read_b64_tr_b16 v[90:91], v13 offset:26624
    buffer_load_dwordx4 v[192:195], v127, s[8:11], s44 offen
    v_mfma_f32_16x16x32_bf16 v[44:47], v[60:63], v[200:203], v[44:47]
    ds_read_b64_tr_b16 v[92:93], v14 offset:24576
    s_add_u32 s44, s44, 16384
    v_mfma_f32_16x16x32_bf16 v[28:31], v[60:63], v[196:199], v[28:31]
    ds_read_b64_tr_b16 v[94:95], v14 offset:26624
    v_mfma_f32_16x16x32_bf16 v[32:35], v[64:67], v[196:199], v[32:35]
    ds_read_b64_tr_b16 v[96:97], v15 offset:24576
    s_add_u32 s43, s43, 1
    v_mfma_f32_16x16x32_bf16 v[48:51], v[64:67], v[200:203], v[48:51]
    ds_read_b64_tr_b16 v[98:99], v15 offset:26624
    v_mfma_f32_16x16x32_bf16 v[52:55], v[68:71], v[200:203], v[52:55]
    ds_read_b64_tr_b16 v[100:101], v16 offset:24576
    v_mfma_f32_16x16x32_bf16 v[36:39], v[68:71], v[196:199], v[36:39]
    ds_read_b64_tr_b16 v[102:103], v16 offset:26624
    s_waitcnt lgkmcnt(8)
    v_mfma_f32_16x16x32_bf16 v[24:27], v[72:75], v[204:207], v[24:27]
    ds_read_b64_tr_b16 v[104:105], v13 offset:28672
    buffer_load_dwordx4 v[196:199], v126, s[8:11], s44 offen
    v_mfma_f32_16x16x32_bf16 v[40:43], v[72:75], v[208:211], v[40:43]
    ds_read_b64_tr_b16 v[106:107], v13 offset:30720
    buffer_load_dwordx4 v[200:203], v127, s[8:11], s44 offen
    v_mfma_f32_16x16x32_bf16 v[44:47], v[76:79], v[208:211], v[44:47]
    ds_read_b64_tr_b16 v[108:109], v14 offset:28672
    s_add_u32 s44, s44, 16384
    s_waitcnt vmcnt(10)
    v_mfma_f32_16x16x32_bf16 v[28:31], v[76:79], v[204:207], v[28:31]
    ds_read_b64_tr_b16 v[110:111], v14 offset:30720
    v_add_u32 v13, 32768, v13
    v_or3_b32 v17, v212, v216, v220
    v_mfma_f32_16x16x32_bf16 v[32:35], v[80:83], v[204:207], v[32:35]
    ds_read_b64_tr_b16 v[112:113], v15 offset:28672
    v_add_u32 v14, 32768, v14
    v_bitop3_b32 v17, v17, v224, 1 bitop3:0xa8
    v_mfma_f32_16x16x32_bf16 v[48:51], v[80:83], v[208:211], v[48:51]
    ds_read_b64_tr_b16 v[114:115], v15 offset:30720
    v_add_u32 v15, 32768, v15
    v_cmp_ne_u32 vcc, 0, v17
    v_mfma_f32_16x16x32_bf16 v[52:55], v[84:87], v[208:211], v[52:55]
    ds_read_b64_tr_b16 v[116:117], v16 offset:28672
    ds_read_b64_tr_b16 v[118:119], v16 offset:30720
    s_cmp_eq_u32 s43, 4
    v_mfma_f32_16x16x32_bf16 v[36:39], v[84:87], v[204:207], v[36:39]
    v_add_u32 v16, 32768, v16
    s_waitcnt lgkmcnt(8)
    s_cbranch_vccnz dm_23f2
dm_23g2:
    s_cbranch_scc1 dm_23x
    v_mfma_f32_16x16x32_bf16 v[24:27], v[88:91], v[212:215], v[24:27]
    ds_read_b64_tr_b16 v[56:57], v13 offset:0
    buffer_load_dwordx4 v[204:207], v126, s[8:11], s44 offen
    v_mfma_f32_16x16x32_bf16 v[40:43], v[88:91], v[216:219], v[40:43]
    ds_read_b64_tr_b16 v[58:59], v13 offset:2048
    buffer_load_dwordx4 v[208:211], v127, s[8:11], s44 offen
    v_mfma_f32_16x16x32_bf16 v[44:47], v[92:95], v[216:219], v[44:47]
    ds_read_b64_tr_b16 v[60:61], v14 offset:0
    s_add_u32 s44, s44, 16384
    v_mfma_f32_16x16x32_bf16 v[28:31], v[92:95], v[212:215], v[28:31]
    ds_read_b64_tr_b16 v[62:63], v14 offset:2048
    v_mov_b32 v134, v126
    v_mfma_f32_16x16x32_bf16 v[32:35], v[96:99], v[212:215], v[32:35]
    ds_read_b64_tr_b16 v[64:65], v15 offset:0
    v_mov_b32 v135, v127
    v_mfma_f32_16x16x32_bf16 v[48:51], v[96:99], v[216:219], v[48:51]
    ds_read_b64_tr_b16 v[66:67], v15 offset:2048
    v_mfma_f32_16x16x32_bf16 v[52:55], v[100:103], v[216:219], v[52:55]
    ds_read_b64_tr_b16 v[68:69], v16 offset:0
    v_mfma_f32_16x16x32_bf16 v[36:39], v[100:103], v[212:215], v[36:39]
    ds_read_b64_tr_b16 v[70:71], v16 offset:2048
    s_waitcnt lgkmcnt(8)
    v_mfma_f32_16x16x32_bf16 v[24:27], v[104:107], v[220:223], v[24:27]
    ds_read_b64_tr_b16 v[72:73], v13 offset:4096
    buffer_load_dwordx4 v[212:215], v126, s[8:11], s44 offen
    v_mfma_f32_16x16x32_bf16 v[40:43], v[104:107], v[224:227], v[40:43]
    ds_read_b64_tr_b16 v[74:75], v13 offset:6144
    buffer_load_dwordx4 v[216:219], v127, s[8:11], s44 offen
    v_mfma_f32_16x16x32_bf16 v[44:47], v[108:111], v[224:227], v[44:47]
    ds_read_b64_tr_b16 v[76:77], v14 offset:4096
    s_add_u32 s44, s44, 16384
    s_waitcnt vmcnt(10)
    v_mfma_f32_16x16x32_bf16 v[28:31], v[108:111], v[220:223], v[28:31]
    ds_read_b64_tr_b16 v[78:79], v14 offset:6144
    v_or3_b32 v17, v164, v168, v172
    v_mfma_f32_16x16x32_bf16 v[32:35], v[112:115], v[220:223], v[32:35]
    ds_read_b64_tr_b16 v[80:81], v15 offset:4096
    v_bitop3_b32 v17, v17, v176, 1 bitop3:0xa8
    v_mfma_f32_16x16x32_bf16 v[48:51], v[112:115], v[224:227], v[48:51]
    ds_read_b64_tr_b16 v[82:83], v15 offset:6144
    v_cmp_ne_u32 vcc, 0, v17
    v_mfma_f32_16x16x32_bf16 v[52:55], v[116:119], v[224:227], v[52:55]
    ds_read_b64_tr_b16 v[84:85], v16 offset:4096
    ds_read_b64_tr_b16 v[86:87], v16 offset:6144
    v_mfma_f32_16x16x32_bf16 v[36:39], v[116:119], v[220:223], v[36:39]
    s_waitcnt lgkmcnt(8)
    s_cbranch_vccnz dm_23f3
dm_23g3:
    s_branch dm_23
dm_23f0:
    s_cselect_b32 s50, 1, 0
dm_23h0:
    s_sleep 2
    s_sub_u32 s44, s44, 114688
    buffer_load_dwordx4 v[180:183], v134, s[8:11], s44 offen sc1
    buffer_load_dwordx4 v[184:187], v135, s[8:11], s44 offen sc1
    s_add_u32 s44, s44, 16384
    buffer_load_dwordx4 v[188:191], v134, s[8:11], s44 offen sc1
    buffer_load_dwordx4 v[192:195], v135, s[8:11], s44 offen sc1
    s_add_u32 s44, s44, 16384
    buffer_load_dwordx4 v[196:199], v134, s[8:11], s44 offen sc1
    buffer_load_dwordx4 v[200:203], v135, s[8:11], s44 offen sc1
    s_add_u32 s44, s44, 16384
    buffer_load_dwordx4 v[204:207], v134, s[8:11], s44 offen sc1
    buffer_load_dwordx4 v[208:211], v135, s[8:11], s44 offen sc1
    s_add_u32 s44, s44, 16384
    buffer_load_dwordx4 v[212:215], v134, s[8:11], s44 offen sc1
    buffer_load_dwordx4 v[216:219], v135, s[8:11], s44 offen sc1
    s_add_u32 s44, s44, 16384
    buffer_load_dwordx4 v[220:223], v134, s[8:11], s44 offen sc1
    buffer_load_dwordx4 v[224:227], v135, s[8:11], s44 offen sc1
    s_add_u32 s44, s44, 16384
    buffer_load_dwordx4 v[164:167], v126, s[8:11], s44 offen sc1
    buffer_load_dwordx4 v[168:171], v127, s[8:11], s44 offen sc1
    s_add_u32 s44, s44, 16384
    s_waitcnt vmcnt(10)
    v_or3_b32 v17, v180, v184, v188
    v_bitop3_b32 v17, v17, v192, 1 bitop3:0xa8
    v_cmp_ne_u32 vcc, 0, v17
    s_add_u32 s53, s53, 1
    s_cmp_ge_u32 s53, s61
    s_cselect_b32 s61, 0, s61
    s_cbranch_scc1 dm_23k0
    s_cbranch_vccnz dm_23h0
dm_23k0:
    s_cmp_eq_u32 s50, 1
    s_branch dm_23g0
dm_23f1:
    s_cselect_b32 s50, 1, 0
dm_23h1:
    s_sleep 2
    s_sub_u32 s44, s44, 114688
    buffer_load_dwordx4 v[196:199], v134, s[8:11], s44 offen sc1
    buffer_load_dwordx4 v[200:203], v135, s[8:11], s44 offen sc1
    s_add_u32 s44, s44, 16384
    buffer_load_dwordx4 v[204:207], v134, s[8:11], s44 offen sc1
    buffer_load_dwordx4 v[208:211], v135, s[8:11], s44 offen sc1
    s_add_u32 s44, s44, 16384
    buffer_load_dwordx4 v[212:215], v134, s[8:11], s44 offen sc1
    buffer_load_dwordx4 v[216:219], v135, s[8:11], s44 offen sc1
    s_add_u32 s44, s44, 16384
    buffer_load_dwordx4 v[220:223], v134, s[8:11], s44 offen sc1
    buffer_load_dwordx4 v[224:227], v135, s[8:11], s44 offen sc1
    s_add_u32 s44, s44, 16384
    buffer_load_dwordx4 v[164:167], v126, s[8:11], s44 offen sc1
    buffer_load_dwordx4 v[168:171], v127, s[8:11], s44 offen sc1
    s_add_u32 s44, s44, 16384
    buffer_load_dwordx4 v[172:175], v126, s[8:11], s44 offen sc1
    buffer_load_dwordx4 v[176:179], v127, s[8:11], s44 offen sc1
    s_add_u32 s44, s44, 16384
    buffer_load_dwordx4 v[180:183], v126, s[8:11], s44 offen sc1
    buffer_load_dwordx4 v[184:187], v127, s[8:11], s44 offen sc1
    s_add_u32 s44, s44, 16384
    s_waitcnt vmcnt(10)
    v_or3_b32 v17, v196, v200, v204
    v_bitop3_b32 v17, v17, v208, 1 bitop3:0xa8
    v_cmp_ne_u32 vcc, 0, v17
    s_add_u32 s53, s53, 1
    s_cmp_ge_u32 s53, s61
    s_cselect_b32 s61, 0, s61
    s_cbranch_scc1 dm_23k1
    s_cbranch_vccnz dm_23h1
dm_23k1:
    s_cmp_eq_u32 s50, 1
    s_branch dm_23g1
dm_23f2:
    s_cselect_b32 s50, 1, 0
dm_23h2:
    s_sleep 2
    s_sub_u32 s44, s44, 114688
    buffer_load_dwordx4 v[212:215], v134, s[8:11], s44 offen sc1
    buffer_load_dwordx4 v[216:219], v135, s[8:11], s44 offen sc1
    s_add_u32 s44, s44, 16384
    buffer_load_dwordx4 v[220:223], v134, s[8:11], s44 offen sc1
    buffer_load_dwordx4 v[224:227], v135, s[8:11], s44 offen sc1
    s_add_u32 s44, s44, 16384
    buffer_load_dwordx4 v[164:167], v126, s[8:11], s44 offen sc1
    buffer_load_dwordx4 v[168:171], v127, s[8:11], s44 offen sc1
    s_add_u32 s44, s44, 16384
    buffer_load_dwordx4 v[172:175], v126, s[8:11], s44 offen sc1
    buffer_load_dwordx4 v[176:179], v127, s[8:11], s44 offen sc1
    s_add_u32 s44, s44, 16384
    buffer_load_dwordx4 v[180:183], v126, s[8:11], s44 offen sc1
    buffer_load_dwordx4 v[184:187], v127, s[8:11], s44 offen sc1
    s_add_u32 s44, s44, 16384
    buffer_load_dwordx4 v[188:191], v126, s[8:11], s44 offen sc1
    buffer_load_dwordx4 v[192:195], v127, s[8:11], s44 offen sc1
    s_add_u32 s44, s44, 16384
    buffer_load_dwordx4 v[196:199], v126, s[8:11], s44 offen sc1
    buffer_load_dwordx4 v[200:203], v127, s[8:11], s44 offen sc1
    s_add_u32 s44, s44, 16384
    s_waitcnt vmcnt(10)
    v_or3_b32 v17, v212, v216, v220
    v_bitop3_b32 v17, v17, v224, 1 bitop3:0xa8
    v_cmp_ne_u32 vcc, 0, v17
    s_add_u32 s53, s53, 1
    s_cmp_ge_u32 s53, s61
    s_cselect_b32 s61, 0, s61
    s_cbranch_scc1 dm_23k2
    s_cbranch_vccnz dm_23h2
dm_23k2:
    s_cmp_eq_u32 s50, 1
    s_branch dm_23g2
dm_23f3:
    s_cselect_b32 s50, 1, 0
dm_23h3:
    s_sleep 2
    s_sub_u32 s44, s44, 114688
    buffer_load_dwordx4 v[164:167], v134, s[8:11], s44 offen sc1
    buffer_load_dwordx4 v[168:171], v135, s[8:11], s44 offen sc1
    s_add_u32 s44, s44, 16384
    buffer_load_dwordx4 v[172:175], v134, s[8:11], s44 offen sc1
    buffer_load_dwordx4 v[176:179], v135, s[8:11], s44 offen sc1
    s_add_u32 s44, s44, 16384
    buffer_load_dwordx4 v[180:183], v134, s[8:11], s44 offen sc1
    buffer_load_dwordx4 v[184:187], v135, s[8:11], s44 offen sc1
    s_add_u32 s44, s44, 16384
    buffer_load_dwordx4 v[188:191], v134, s[8:11], s44 offen sc1
    buffer_load_dwordx4 v[192:195], v135, s[8:11], s44 offen sc1
    s_add_u32 s44, s44, 16384
    buffer_load_dwordx4 v[196:199], v134, s[8:11], s44 offen sc1
    buffer_load_dwordx4 v[200:203], v135, s[8:11], s44 offen sc1
    s_add_u32 s44, s44, 16384
    buffer_load_dwordx4 v[204:207], v134, s[8:11], s44 offen sc1
    buffer_load_dwordx4 v[208:211], v135, s[8:11], s44 offen sc1
    s_add_u32 s44, s44, 16384
    buffer_load_dwordx4 v[212:215], v134, s[8:11], s44 offen sc1
    buffer_load_dwordx4 v[216:219], v135, s[8:11], s44 offen sc1
    s_add_u32 s44, s44, 16384
    s_waitcnt vmcnt(10)
    v_or3_b32 v17, v164, v168, v172
    v_bitop3_b32 v17, v17, v176, 1 bitop3:0xa8
    v_cmp_ne_u32 vcc, 0, v17
    s_add_u32 s53, s53, 1
    s_cmp_ge_u32 s53, s61
    s_cselect_b32 s61, 0, s61
    s_cbranch_scc1 dm_23k3
    s_cbranch_vccnz dm_23h3
dm_23k3:
    s_cmp_eq_u32 s50, 1
    s_branch dm_23g3
dm_23x:
    v_mfma_f32_16x16x32_bf16 v[24:27], v[88:91], v[212:215], v[24:27]
    v_mfma_f32_16x16x32_bf16 v[40:43], v[88:91], v[216:219], v[40:43]
    v_mfma_f32_16x16x32_bf16 v[44:47], v[92:95], v[216:219], v[44:47]
    v_mfma_f32_16x16x32_bf16 v[28:31], v[92:95], v[212:215], v[28:31]
    v_mfma_f32_16x16x32_bf16 v[32:35], v[96:99], v[212:215], v[32:35]
    v_mfma_f32_16x16x32_bf16 v[48:51], v[96:99], v[216:219], v[48:51]
    v_mfma_f32_16x16x32_bf16 v[52:55], v[100:103], v[216:219], v[52:55]
    v_mfma_f32_16x16x32_bf16 v[36:39], v[100:103], v[212:215], v[36:39]
    s_waitcnt lgkmcnt(0)
    v_mfma_f32_16x16x32_bf16 v[24:27], v[104:107], v[220:223], v[24:27]
    s_add_u32 s44, s62, 0x5c8000
    v_mfma_f32_16x16x32_bf16 v[40:43], v[104:107], v[224:227], v[40:43]
    s_addc_u32 s45, s63, 0
    v_mfma_f32_16x16x32_bf16 v[44:47], v[108:111], v[224:227], v[44:47]
    v_mfma_f32_16x16x32_bf16 v[28:31], v[108:111], v[220:223], v[28:31]
    s_mov_b32 s46, 0x6000
    v_mfma_f32_16x16x32_bf16 v[32:35], v[112:115], v[220:223], v[32:35]
    v_mfma_f32_16x16x32_bf16 v[48:51], v[112:115], v[224:227], v[48:51]
    s_mov_b32 s47, 0x20000
    v_mfma_f32_16x16x32_bf16 v[52:55], v[116:119], v[224:227], v[52:55]
    v_mfma_f32_16x16x32_bf16 v[36:39], v[116:119], v[220:223], v[36:39]
    s_add_u32 s36, s39, 0
    v_cvt_pk_bf16_f32 v148, v24, v25
    v_cvt_pk_bf16_f32 v149, v26, v27
    v_cvt_pk_bf16_f32 v150, v28, v29
    v_cvt_pk_bf16_f32 v151, v30, v31
    v_and_b32 v148, -2, v148
    buffer_store_dwordx4 v[148:151], v2, s[16:19], s36 offen offset:0 sc1
    v_cvt_pk_bf16_f32 v152, v32, v33
    v_cvt_pk_bf16_f32 v153, v34, v35
    v_cvt_pk_bf16_f32 v154, v36, v37
    v_cvt_pk_bf16_f32 v155, v38, v39
    v_and_b32 v152, -2, v152
    buffer_store_dwordx4 v[152:155], v2, s[16:19], s36 offen offset:1024 sc1
    s_add_u32 s36, s39, 65536
    v_cvt_pk_bf16_f32 v156, v40, v41
    v_cvt_pk_bf16_f32 v157, v42, v43
    v_cvt_pk_bf16_f32 v158, v44, v45
    v_cvt_pk_bf16_f32 v159, v46, v47
    v_and_b32 v156, -2, v156
    buffer_store_dwordx4 v[156:159], v2, s[16:19], s36 offen offset:0 sc1
    v_cvt_pk_bf16_f32 v160, v48, v49
    v_cvt_pk_bf16_f32 v161, v50, v51
    v_cvt_pk_bf16_f32 v162, v52, v53
    v_cvt_pk_bf16_f32 v163, v54, v55
    v_and_b32 v160, -2, v160
    buffer_store_dwordx4 v[160:163], v2, s[16:19], s36 offen offset:1024 sc1
    s_barrier
    s_lshl_b32 s36, s37, 11
    v_add_u32 v7, s36, v2
    ds_write_b128 v7, v[148:151] offset:0
    ds_write_b128 v7, v[152:155] offset:1024
    ds_write_b128 v7, v[156:159] offset:2048
    ds_write_b128 v7, v[160:163] offset:3072
    v_lshlrev_b32 v24, 16, v148
    v_and_b32 v25, 0xffff0000, v148
    v_lshlrev_b32 v26, 16, v149
    v_and_b32 v27, 0xffff0000, v149
    v_lshlrev_b32 v28, 16, v150
    v_and_b32 v29, 0xffff0000, v150
    v_lshlrev_b32 v30, 16, v151
    v_and_b32 v31, 0xffff0000, v151
    v_lshlrev_b32 v32, 16, v152
    v_and_b32 v33, 0xffff0000, v152
    v_lshlrev_b32 v34, 16, v153
    v_and_b32 v35, 0xffff0000, v153
    v_lshlrev_b32 v36, 16, v154
    v_and_b32 v37, 0xffff0000, v154
    v_lshlrev_b32 v38, 16, v155
    v_and_b32 v39, 0xffff0000, v155
    v_lshlrev_b32 v40, 16, v156
    v_and_b32 v41, 0xffff0000, v156
    v_lshlrev_b32 v42, 16, v157
    v_and_b32 v43, 0xffff0000, v157
    v_lshlrev_b32 v44, 16, v158
    v_and_b32 v45, 0xffff0000, v158
    v_lshlrev_b32 v46, 16, v159
    v_and_b32 v47, 0xffff0000, v159
    v_lshlrev_b32 v48, 16, v160
    v_and_b32 v49, 0xffff0000, v160
    v_lshlrev_b32 v50, 16, v161
    v_and_b32 v51, 0xffff0000, v161
    v_lshlrev_b32 v52, 16, v162
    v_and_b32 v53, 0xffff0000, v162
    v_lshlrev_b32 v54, 16, v163
    v_and_b32 v55, 0xffff0000, v163
    s_add_u32 s53, s55, 512
    v_mov_b32 v8, 1
    v_mov_b32 v9, 162816
    v_mov_b32 v11, 0
    s_mov_b64 exec, 1
    s_waitcnt vmcnt(0)
    ds_add_rtn_u32 v10, v9, v8
    s_waitcnt lgkmcnt(0)
    v_readfirstlane_b32 s54, v10
    s_nop 0
    s_and_b32 s54, s54, 3
    s_cmp_lg_u32 s54, 3
    s_cbranch_scc1 pub_24
    buffer_atomic_add v8, v11, s[56:59], s53 offen sc1
    v_mov_b32 v9, 162872
    ds_add_u32 v9, v8
pub_24:
    s_mov_b64 exec, -1
    s_waitcnt lgkmcnt(0)
    s_barrier
    v_pk_add_f32 v[142:143], v[24:25], v[26:27]
    v_pk_mul_f32 v[136:137], v[24:25], v[24:25]
    v_pk_fma_f32 v[136:137], v[26:27], v[26:27], v[136:137]
    v_pk_add_f32 v[142:143], v[142:143], v[28:29]
    v_pk_fma_f32 v[136:137], v[28:29], v[28:29], v[136:137]
    v_pk_add_f32 v[142:143], v[142:143], v[30:31]
    v_pk_fma_f32 v[136:137], v[30:31], v[30:31], v[136:137]
    v_pk_add_f32 v[142:143], v[142:143], v[32:33]
    v_pk_fma_f32 v[136:137], v[32:33], v[32:33], v[136:137]
    v_pk_add_f32 v[142:143], v[142:143], v[34:35]
    v_pk_fma_f32 v[136:137], v[34:35], v[34:35], v[136:137]
    v_pk_add_f32 v[142:143], v[142:143], v[36:37]
    v_pk_fma_f32 v[136:137], v[36:37], v[36:37], v[136:137]
    v_pk_add_f32 v[142:143], v[142:143], v[38:39]
    v_pk_fma_f32 v[136:137], v[38:39], v[38:39], v[136:137]
    v_add_f32 v138, v142, v143
    v_add_f32 v139, v136, v137
    v_mov_b32 v142, v138
    v_mov_b32 v143, v139
    s_nop 0
    v_permlane16_swap_b32 v138, v142
    v_permlane16_swap_b32 v139, v143
    v_pk_add_f32 v[138:139], v[138:139], v[142:143]
    v_mov_b32 v142, v138
    v_mov_b32 v143, v139
    s_nop 0
    v_permlane32_swap_b32 v138, v142
    v_permlane32_swap_b32 v139, v143
    v_pk_add_f32 v[138:139], v[138:139], v[142:143]
    v_pk_add_f32 v[142:143], v[40:41], v[42:43]
    v_pk_mul_f32 v[136:137], v[40:41], v[40:41]
    v_pk_fma_f32 v[136:137], v[42:43], v[42:43], v[136:137]
    v_pk_add_f32 v[142:143], v[142:143], v[44:45]
    v_pk_fma_f32 v[136:137], v[44:45], v[44:45], v[136:137]
    v_pk_add_f32 v[142:143], v[142:143], v[46:47]
    v_pk_fma_f32 v[136:137], v[46:47], v[46:47], v[136:137]
    v_pk_add_f32 v[142:143], v[142:143], v[48:49]
    v_pk_fma_f32 v[136:137], v[48:49], v[48:49], v[136:137]
    v_pk_add_f32 v[142:143], v[142:143], v[50:51]
    v_pk_fma_f32 v[136:137], v[50:51], v[50:51], v[136:137]
    v_pk_add_f32 v[142:143], v[142:143], v[52:53]
    v_pk_fma_f32 v[136:137], v[52:53], v[52:53], v[136:137]
    v_pk_add_f32 v[142:143], v[142:143], v[54:55]
    v_pk_fma_f32 v[136:137], v[54:55], v[54:55], v[136:137]
    v_add_f32 v140, v142, v143
    v_add_f32 v141, v136, v137
    v_mov_b32 v142, v140
    v_mov_b32 v143, v141
    s_nop 0
    v_permlane16_swap_b32 v140, v142
    v_permlane16_swap_b32 v141, v143
    v_pk_add_f32 v[140:141], v[140:141], v[142:143]
    v_mov_b32 v142, v140
    v_mov_b32 v143, v141
    s_nop 0
    v_permlane32_swap_b32 v140, v142
    v_permlane32_swap_b32 v141, v143
    v_pk_add_f32 v[140:141], v[140:141], v[142:143]
    v_cmp_eq_u32 vcc, 0, v23
    s_nop 1
    v_cndmask_b32 v138, v140, v138, vcc
    v_cndmask_b32 v139, v141, v139, vcc
    s_lshr_b32 s53, s29, 3
    s_lshl_b32 s53, s53, 14
    s_and_b32 s40, s29, 7
    s_lshl_b32 s40, s40, 10
    s_add_u32 s40, s40, s53
    s_lshl_b32 s36, s34, 8
    s_add_u32 s40, s40, s36
    v_lshlrev_b32 v7, 3, v1
    s_bfm_b64 exec, 32, 0
    buffer_store_dwordx2 v[138:139], v7, s[44:47], s40 offen sc1
    s_mov_b64 exec, -1
    s_lshr_b32 s34, s30, 1
    s_and_b32 s35, s30, 1
    v_and_b32 v22, 15, v1
    v_lshrrev_b32 v23, 4, v1
    s_mul_i32 s37, s34, 4
    s_mul_i32 s38, s29, 14
    s_mul_i32 s36, s35, 7
    s_add_u32 s38, s38, s36
    s_mul_i32 s36, s34, 8192
    v_add_u32 v12, s36, v2
    v_lshrrev_b32 v6, 2, v1
    v_mul_u32_u24 v13, 448, v6
    v_and_b32 v7, 3, v1
    v_lshl_add_u32 v13, v7, 3, v13
    v_add_u32 v13, 73728, v13
    s_mul_i32 s36, s35, 224
    v_add_u32 v13, s36, v13
    v_bfe_u32 v6, v1, 4, 1
    v_lshlrev_b32 v6, 5, v6
    s_cmp_eq_u32 s35, 0
    s_cselect_b32 s36, 1, -1
    v_mul_lo_u32 v6, v6, s36
    v_sub_u32 v14, v13, v6
    v_add_u32 v13, v13, v6
    v_mov_b32 v17, v12
    s_mov_b32 s42, 0
    s_mov_b32 s43, 0
    s_mov_b32 s48, 57344
    v_add_u32 v18, 57344, v13
    v_add_u32 v19, 57344, v14
    ds_read_b128 v[136:139], v17 offset:0
    ds_read_b128 v[140:143], v17 offset:2048
    ds_read_b128 v[144:147], v17 offset:4096
    ds_read_b128 v[148:151], v17 offset:6144
    ds_read_b64_tr_b16 v[152:153], v18 offset:0
    ds_read_b64_tr_b16 v[154:155], v18 offset:7168
    ds_read_b64_tr_b16 v[156:157], v19 offset:32
    ds_read_b64_tr_b16 v[158:159], v19 offset:7200
    ds_read_b64_tr_b16 v[160:161], v18 offset:64
    ds_read_b64_tr_b16 v[162:163], v18 offset:7232
    ds_read_b64_tr_b16 v[164:165], v19 offset:96
    ds_read_b64_tr_b16 v[166:167], v19 offset:7264
    ds_read_b64_tr_b16 v[168:169], v18 offset:128
    ds_read_b64_tr_b16 v[170:171], v18 offset:7296
    ds_read_b64_tr_b16 v[172:173], v19 offset:160
    ds_read_b64_tr_b16 v[174:175], v19 offset:7328
    ds_read_b64_tr_b16 v[176:177], v18 offset:192
    ds_read_b64_tr_b16 v[178:179], v18 offset:7360
    s_waitcnt lgkmcnt(12)
    v_mfma_f32_16x16x32_bf16 v[24:27], v[152:155], v[136:139], 0
    ds_read_b128 v[180:183], v17 offset:1024
    s_add_u32 s42, s42, 16384
    v_mfma_f32_16x16x32_bf16 v[52:55], v[152:155], v[140:143], 0
    ds_read_b128 v[184:187], v17 offset:3072
    s_cmp_eq_u32 s42, 49152
    v_mfma_f32_16x16x32_bf16 v[80:83], v[152:155], v[144:147], 0
    ds_read_b128 v[188:191], v17 offset:5120
    s_cselect_b32 s42, 0, s42
    v_mfma_f32_16x16x32_bf16 v[108:111], v[152:155], v[148:151], 0
    ds_read_b128 v[192:195], v17 offset:7168
    s_waitcnt lgkmcnt(14)
    v_mfma_f32_16x16x32_bf16 v[112:115], v[156:159], v[148:151], 0
    ds_read_b64_tr_b16 v[196:197], v18 offset:14336
    s_add_u32 s48, s48, 28672
    v_mfma_f32_16x16x32_bf16 v[84:87], v[156:159], v[144:147], 0
    ds_read_b64_tr_b16 v[198:199], v18 offset:21504
    s_cmp_eq_u32 s48, 86016
    v_mfma_f32_16x16x32_bf16 v[56:59], v[156:159], v[140:143], 0
    ds_read_b64_tr_b16 v[200:201], v19 offset:14368
    s_cselect_b32 s48, 0, s48
    v_mfma_f32_16x16x32_bf16 v[28:31], v[156:159], v[136:139], 0
    ds_read_b64_tr_b16 v[202:203], v19 offset:21536
    s_waitcnt lgkmcnt(8)
    v_mfma_f32_16x16x32_bf16 v[32:35], v[160:163], v[136:139], 0
    ds_read_b64_tr_b16 v[204:205], v18 offset:14400
    v_add_u32 v17, s42, v12
    v_mfma_f32_16x16x32_bf16 v[60:63], v[160:163], v[140:143], 0
    ds_read_b64_tr_b16 v[206:207], v18 offset:21568
    v_mfma_f32_16x16x32_bf16 v[88:91], v[160:163], v[144:147], 0
    ds_read_b64_tr_b16 v[208:209], v19 offset:14432
    v_mfma_f32_16x16x32_bf16 v[116:119], v[160:163], v[148:151], 0
    ds_read_b64_tr_b16 v[210:211], v19 offset:21600
    v_mfma_f32_16x16x32_bf16 v[120:123], v[164:167], v[148:151], 0
    ds_read_b64_tr_b16 v[212:213], v18 offset:14464
    v_mfma_f32_16x16x32_bf16 v[92:95], v[164:167], v[144:147], 0
    ds_read_b64_tr_b16 v[214:215], v18 offset:21632
    v_mfma_f32_16x16x32_bf16 v[64:67], v[164:167], v[140:143], 0
    ds_read_b64_tr_b16 v[216:217], v19 offset:14496
    v_mfma_f32_16x16x32_bf16 v[36:39], v[164:167], v[136:139], 0
    ds_read_b64_tr_b16 v[218:219], v19 offset:21664
    v_add_u32 v19, s48, v14
    v_mfma_f32_16x16x32_bf16 v[40:43], v[168:171], v[136:139], 0
    ds_read_b64_tr_b16 v[220:221], v18 offset:14528
    v_mfma_f32_16x16x32_bf16 v[68:71], v[168:171], v[140:143], 0
    ds_read_b64_tr_b16 v[222:223], v18 offset:21696
    v_add_u32 v18, s48, v13
    v_mfma_f32_16x16x32_bf16 v[96:99], v[168:171], v[144:147], 0
    v_mfma_f32_16x16x32_bf16 v[124:127], v[168:171], v[148:151], 0
    v_mfma_f32_16x16x32_bf16 v[128:131], v[172:175], v[148:151], 0
    v_mfma_f32_16x16x32_bf16 v[100:103], v[172:175], v[144:147], 0
    v_mfma_f32_16x16x32_bf16 v[72:75], v[172:175], v[140:143], 0
    v_mfma_f32_16x16x32_bf16 v[44:47], v[172:175], v[136:139], 0
    v_mfma_f32_16x16x32_bf16 v[48:51], v[176:179], v[136:139], 0
    v_mfma_f32_16x16x32_bf16 v[76:79], v[176:179], v[140:143], 0
    v_mfma_f32_16x16x32_bf16 v[104:107], v[176:179], v[144:147], 0
    v_mfma_f32_16x16x32_bf16 v[132:135], v[176:179], v[148:151], 0
    s_waitcnt lgkmcnt(12)
    v_mfma_f32_16x16x32_bf16 v[24:27], v[196:199], v[180:183], v[24:27]
    s_add_u32 s43, s43, 1
    s_mul_i32 s36, s35, 448
    s_add_u32 s36, s36, 159744
    v_lshlrev_b32 v6, 4, v23
    v_mfma_f32_16x16x32_bf16 v[52:55], v[196:199], v[184:187], v[52:55]
    v_add_u32 v6, s36, v6
    s_lshl_b32 s36, s37, 8
    s_add_u32 s36, s36, 160768
    v_lshlrev_b32 v7, 4, v22
    v_mfma_f32_16x16x32_bf16 v[80:83], v[196:199], v[188:191], v[80:83]
    v_add_u32 v7, s36, v7
    s_add_u32 s16, s62, 0x400000
    s_addc_u32 s17, s63, 0
    s_mov_b32 s18, 0x1be000
    v_mfma_f32_16x16x32_bf16 v[108:111], v[196:199], v[192:195], v[108:111]
    s_mov_b32 s19, 0x20000
    s_mul_i32 s39, s37, 229376
    s_lshr_b32 s36, s38, 1
    s_waitcnt lgkmcnt(0)
    v_mfma_f32_16x16x32_bf16 v[112:115], v[200:203], v[192:195], v[112:115]
    s_add_u32 s36, s36, 0
    s_lshr_b32 s53, s36, 3
    s_lshl_b32 s53, s53, 14
    s_and_b32 s44, s36, 7
    v_mfma_f32_16x16x32_bf16 v[84:87], v[200:203], v[188:191], v[84:87]
    s_lshl_b32 s44, s44, 10
    s_add_u32 s44, s44, s53
    s_add_u32 s44, s44, s39
    s_lshr_b32 s36, s38, 1
    v_mfma_f32_16x16x32_bf16 v[56:59], v[200:203], v[184:187], v[56:59]
    s_add_u32 s36, s36, 1
    s_lshr_b32 s53, s36, 3
    s_lshl_b32 s53, s53, 14
    s_and_b32 s45, s36, 7
    v_mfma_f32_16x16x32_bf16 v[28:31], v[200:203], v[180:183], v[28:31]
    s_lshl_b32 s45, s45, 10
    s_add_u32 s45, s45, s53
    s_add_u32 s45, s45, s39
    s_lshr_b32 s36, s38, 1
    v_mfma_f32_16x16x32_bf16 v[32:35], v[204:207], v[180:183], v[32:35]
    s_add_u32 s36, s36, 2
    s_lshr_b32 s53, s36, 3
    s_lshl_b32 s53, s53, 14
    s_and_b32 s46, s36, 7
    v_mfma_f32_16x16x32_bf16 v[60:63], v[204:207], v[184:187], v[60:63]
    s_lshl_b32 s46, s46, 10
    s_add_u32 s46, s46, s53
    s_add_u32 s46, s46, s39
    s_lshr_b32 s36, s38, 1
    v_mfma_f32_16x16x32_bf16 v[88:91], v[204:207], v[188:191], v[88:91]
    s_add_u32 s36, s36, 3
    s_lshr_b32 s53, s36, 3
    s_lshl_b32 s53, s53, 14
    s_and_b32 s47, s36, 7
    v_mfma_f32_16x16x32_bf16 v[116:119], v[204:207], v[192:195], v[116:119]
    s_lshl_b32 s47, s47, 10
    s_add_u32 s47, s47, s53
    s_add_u32 s47, s47, s39
    v_lshrrev_b32 v226, 2, v1
    v_mfma_f32_16x16x32_bf16 v[120:123], v[208:211], v[192:195], v[120:123]
    v_mul_u32_u24 v240, 256, v226
    v_and_b32 v227, 3, v1
    v_lshl_add_u32 v240, v227, 3, v240
    v_add_u32 v240, 49152, v240
    v_mfma_f32_16x16x32_bf16 v[92:95], v[208:211], v[188:191], v[92:95]
    v_and_b32 v226, 7, v226
    s_mul_i32 s36, s35, 4
    s_add_u32 s36, s36, 3
    v_xor_b32 v227, s36, v226
    v_mfma_f32_16x16x32_bf16 v[64:67], v[208:211], v[184:187], v[64:67]
    v_lshl_add_u32 v243, v227, 5, v240
    s_mul_i32 s36, s35, 4
    s_add_u32 s36, s36, 2
    v_xor_b32 v227, s36, v226
    v_mfma_f32_16x16x32_bf16 v[36:39], v[208:211], v[180:183], v[36:39]
    v_lshl_add_u32 v242, v227, 5, v240
    s_mul_i32 s36, s35, 4
    s_add_u32 s36, s36, 1
    v_xor_b32 v227, s36, v226
    v_mfma_f32_16x16x32_bf16 v[40:43], v[212:215], v[180:183], v[40:43]
    v_lshl_add_u32 v241, v227, 5, v240
    s_mul_i32 s36, s35, 4
    s_add_u32 s36, s36, 0
    v_xor_b32 v227, s36, v226
    v_mfma_f32_16x16x32_bf16 v[68:71], v[212:215], v[184:187], v[68:71]
    v_lshl_add_u32 v240, v227, 5, v240
    s_lshl_b32 s38, s33, 3
    s_lshl_b32 s36, s35, 2
    s_add_u32 s38, s38, s36
    v_mfma_f32_16x16x32_bf16 v[96:99], v[212:215], v[188:191], v[96:99]
    s_lshr_b32 s36, s38, 1
    s_lshr_b32 s53, s36, 3
    s_lshl_b32 s53, s53, 14
    s_and_b32 s39, s36, 7
    v_mfma_f32_16x16x32_bf16 v[124:127], v[212:215], v[192:195], v[124:127]
    s_lshl_b32 s39, s39, 10
    s_add_u32 s39, s39, s53
    s_lshl_b32 s36, s37, 16
    s_add_u32 s39, s39, s36
    v_mfma_f32_16x16x32_bf16 v[128:131], v[216:219], v[192:195], v[128:131]
    s_lshl_b32 s40, s31, 17
    s_add_u32 s40, s40, s39
    s_xor_b32 s41, s31, 1
    s_lshl_b32 s41, s41, 17
    v_mfma_f32_16x16x32_bf16 v[100:103], v[216:219], v[188:191], v[100:103]
    s_add_u32 s41, s41, s39
    s_mov_b32 s84, s62
    s_mov_b32 s85, s63
    s_mov_b32 s86, 0x7e000
    v_mfma_f32_16x16x32_bf16 v[72:75], v[216:219], v[184:187], v[72:75]
    s_mov_b32 s87, 0x20000
    s_add_u32 s88, s62, 0x80000
    s_addc_u32 s89, s63, 0
    s_mov_b32 s90, 0x7e000
    v_mfma_f32_16x16x32_bf16 v[44:47], v[216:219], v[180:183], v[44:47]
    s_mov_b32 s91, 0x20000
    s_lshl_b32 s36, s37, 1
    s_add_u32 s36, s36, s35
    s_lshl_b32 s36, s36, 10
    v_mfma_f32_16x16x32_bf16 v[48:51], v[220:223], v[180:183], v[48:51]
    v_add_u32 v244, s36, v2
    v_mov_b32 v245, 1
    v_mov_b32 v246, 162880
    v_lshrrev_b32 v238, 1, v23
    v_mfma_f32_16x16x32_bf16 v[76:79], v[220:223], v[184:187], v[76:79]
    v_lshlrev_b32 v238, 8, v238
    v_lshl_add_u32 v238, v22, 4, v238
    v_and_b32 v224, 1, v23
    v_lshl_add_u32 v238, v224, 3, v238
    v_mfma_f32_16x16x32_bf16 v[104:107], v[220:223], v[188:191], v[104:107]
    v_mfma_f32_16x16x32_bf16 v[132:135], v[220:223], v[192:195], v[132:135]
    s_add_u32 s53, s55, 1408
    v_mov_b32 v8, 1
    v_mov_b32 v9, 162864
    v_mov_b32 v11, 0
    s_mov_b64 exec, 1
    s_waitcnt vmcnt(0)
    ds_add_rtn_u32 v10, v9, v8
    s_waitcnt lgkmcnt(0)
    v_readfirstlane_b32 s54, v10
    s_nop 0
    s_and_b32 s54, s54, 3
    s_cmp_lg_u32 s54, 3
    s_cbranch_scc1 pub_25
    buffer_atomic_add v8, v11, s[56:59], s53 offen sc1
pub_25:
    s_mov_b64 exec, -1
    s_barrier
    ds_read_b128 v[136:139], v17 offset:0
    ds_read_b128 v[140:143], v17 offset:2048
    ds_read_b128 v[144:147], v17 offset:4096
    ds_read_b128 v[148:151], v17 offset:6144
    ds_read_b64_tr_b16 v[152:153], v18 offset:0
    ds_read_b64_tr_b16 v[154:155], v18 offset:7168
    ds_read_b64_tr_b16 v[156:157], v19 offset:32
    ds_read_b64_tr_b16 v[158:159], v19 offset:7200
    ds_read_b64_tr_b16 v[160:161], v18 offset:64
    ds_read_b64_tr_b16 v[162:163], v18 offset:7232
    ds_read_b64_tr_b16 v[164:165], v19 offset:96
    ds_read_b64_tr_b16 v[166:167], v19 offset:7264
    ds_read_b64_tr_b16 v[168:169], v18 offset:128
    ds_read_b64_tr_b16 v[170:171], v18 offset:7296
    ds_read_b64_tr_b16 v[172:173], v19 offset:160
    ds_read_b64_tr_b16 v[174:175], v19 offset:7328
    ds_read_b64_tr_b16 v[176:177], v18 offset:192
    ds_read_b64_tr_b16 v[178:179], v18 offset:7360
    s_waitcnt lgkmcnt(12)
mm_26:
    v_mfma_f32_16x16x32_bf16 v[24:27], v[152:155], v[136:139], v[24:27]
    ds_read_b128 v[180:183], v17 offset:1024
    s_add_u32 s42, s42, 16384
    v_mfma_f32_16x16x32_bf16 v[52:55], v[152:155], v[140:143], v[52:55]
    ds_read_b128 v[184:187], v17 offset:3072
    s_cmp_eq_u32 s42, 49152
    v_mfma_f32_16x16x32_bf16 v[80:83], v[152:155], v[144:147], v[80:83]
    ds_read_b128 v[188:191], v17 offset:5120
    s_cselect_b32 s42, 0, s42
    v_mfma_f32_16x16x32_bf16 v[108:111], v[152:155], v[148:151], v[108:111]
    ds_read_b128 v[192:195], v17 offset:7168
    s_waitcnt lgkmcnt(14)
    v_mfma_f32_16x16x32_bf16 v[112:115], v[156:159], v[148:151], v[112:115]
    ds_read_b64_tr_b16 v[196:197], v18 offset:14336
    s_add_u32 s48, s48, 28672
    v_mfma_f32_16x16x32_bf16 v[84:87], v[156:159], v[144:147], v[84:87]
    ds_read_b64_tr_b16 v[198:199], v18 offset:21504
    s_cmp_eq_u32 s48, 86016
    v_mfma_f32_16x16x32_bf16 v[56:59], v[156:159], v[140:143], v[56:59]
    ds_read_b64_tr_b16 v[200:201], v19 offset:14368
    s_cselect_b32 s48, 0, s48
    v_mfma_f32_16x16x32_bf16 v[28:31], v[156:159], v[136:139], v[28:31]
    ds_read_b64_tr_b16 v[202:203], v19 offset:21536
    s_waitcnt lgkmcnt(8)
    v_mfma_f32_16x16x32_bf16 v[32:35], v[160:163], v[136:139], v[32:35]
    ds_read_b64_tr_b16 v[204:205], v18 offset:14400
    v_add_u32 v17, s42, v12
    v_mfma_f32_16x16x32_bf16 v[60:63], v[160:163], v[140:143], v[60:63]
    ds_read_b64_tr_b16 v[206:207], v18 offset:21568
    v_mfma_f32_16x16x32_bf16 v[88:91], v[160:163], v[144:147], v[88:91]
    ds_read_b64_tr_b16 v[208:209], v19 offset:14432
    v_mfma_f32_16x16x32_bf16 v[116:119], v[160:163], v[148:151], v[116:119]
    ds_read_b64_tr_b16 v[210:211], v19 offset:21600
    v_mfma_f32_16x16x32_bf16 v[120:123], v[164:167], v[148:151], v[120:123]
    ds_read_b64_tr_b16 v[212:213], v18 offset:14464
    v_mfma_f32_16x16x32_bf16 v[92:95], v[164:167], v[144:147], v[92:95]
    ds_read_b64_tr_b16 v[214:215], v18 offset:21632
    v_mfma_f32_16x16x32_bf16 v[64:67], v[164:167], v[140:143], v[64:67]
    ds_read_b64_tr_b16 v[216:217], v19 offset:14496
    v_mfma_f32_16x16x32_bf16 v[36:39], v[164:167], v[136:139], v[36:39]
    ds_read_b64_tr_b16 v[218:219], v19 offset:21664
    v_add_u32 v19, s48, v14
    v_mfma_f32_16x16x32_bf16 v[40:43], v[168:171], v[136:139], v[40:43]
    ds_read_b64_tr_b16 v[220:221], v18 offset:14528
    v_mfma_f32_16x16x32_bf16 v[68:71], v[168:171], v[140:143], v[68:71]
    ds_read_b64_tr_b16 v[222:223], v18 offset:21696
    v_add_u32 v18, s48, v13
    v_mfma_f32_16x16x32_bf16 v[96:99], v[168:171], v[144:147], v[96:99]
    v_mfma_f32_16x16x32_bf16 v[124:127], v[168:171], v[148:151], v[124:127]
    v_mfma_f32_16x16x32_bf16 v[128:131], v[172:175], v[148:151], v[128:131]
    v_mfma_f32_16x16x32_bf16 v[100:103], v[172:175], v[144:147], v[100:103]
    v_mfma_f32_16x16x32_bf16 v[72:75], v[172:175], v[140:143], v[72:75]
    v_mfma_f32_16x16x32_bf16 v[44:47], v[172:175], v[136:139], v[44:47]
    v_mfma_f32_16x16x32_bf16 v[48:51], v[176:179], v[136:139], v[48:51]
    v_mfma_f32_16x16x32_bf16 v[76:79], v[176:179], v[140:143], v[76:79]
    v_mfma_f32_16x16x32_bf16 v[104:107], v[176:179], v[144:147], v[104:107]
    v_mfma_f32_16x16x32_bf16 v[132:135], v[176:179], v[148:151], v[132:135]
    s_waitcnt lgkmcnt(12)
    v_mfma_f32_16x16x32_bf16 v[24:27], v[196:199], v[180:183], v[24:27]
    s_add_u32 s43, s43, 1
    s_cmp_lt_u32 s43, 15
    v_mfma_f32_16x16x32_bf16 v[52:55], v[196:199], v[184:187], v[52:55]
    v_mfma_f32_16x16x32_bf16 v[80:83], v[196:199], v[188:191], v[80:83]
    v_mfma_f32_16x16x32_bf16 v[108:111], v[196:199], v[192:195], v[108:111]
    s_waitcnt lgkmcnt(0)
    s_barrier
    v_mfma_f32_16x16x32_bf16 v[112:115], v[200:203], v[192:195], v[112:115]
    ds_read_b128 v[136:139], v17 offset:0
    v_mfma_f32_16x16x32_bf16 v[84:87], v[200:203], v[188:191], v[84:87]
    ds_read_b128 v[140:143], v17 offset:2048
    v_mfma_f32_16x16x32_bf16 v[56:59], v[200:203], v[184:187], v[56:59]
    ds_read_b128 v[144:147], v17 offset:4096
    v_mfma_f32_16x16x32_bf16 v[28:31], v[200:203], v[180:183], v[28:31]
    ds_read_b128 v[148:151], v17 offset:6144
    v_mfma_f32_16x16x32_bf16 v[32:35], v[204:207], v[180:183], v[32:35]
    ds_read_b64_tr_b16 v[152:153], v18 offset:0
    v_mfma_f32_16x16x32_bf16 v[60:63], v[204:207], v[184:187], v[60:63]
    ds_read_b64_tr_b16 v[154:155], v18 offset:7168
    v_mfma_f32_16x16x32_bf16 v[88:91], v[204:207], v[188:191], v[88:91]
    ds_read_b64_tr_b16 v[156:157], v19 offset:32
    v_mfma_f32_16x16x32_bf16 v[116:119], v[204:207], v[192:195], v[116:119]
    ds_read_b64_tr_b16 v[158:159], v19 offset:7200
    v_mfma_f32_16x16x32_bf16 v[120:123], v[208:211], v[192:195], v[120:123]
    ds_read_b64_tr_b16 v[160:161], v18 offset:64
    v_mfma_f32_16x16x32_bf16 v[92:95], v[208:211], v[188:191], v[92:95]
    ds_read_b64_tr_b16 v[162:163], v18 offset:7232
    v_mfma_f32_16x16x32_bf16 v[64:67], v[208:211], v[184:187], v[64:67]
    ds_read_b64_tr_b16 v[164:165], v19 offset:96
    v_mfma_f32_16x16x32_bf16 v[36:39], v[208:211], v[180:183], v[36:39]
    ds_read_b64_tr_b16 v[166:167], v19 offset:7264
    v_mfma_f32_16x16x32_bf16 v[40:43], v[212:215], v[180:183], v[40:43]
    ds_read_b64_tr_b16 v[168:169], v18 offset:128
    v_mfma_f32_16x16x32_bf16 v[68:71], v[212:215], v[184:187], v[68:71]
    ds_read_b64_tr_b16 v[170:171], v18 offset:7296
    v_mfma_f32_16x16x32_bf16 v[96:99], v[212:215], v[188:191], v[96:99]
    ds_read_b64_tr_b16 v[172:173], v19 offset:160
    v_mfma_f32_16x16x32_bf16 v[124:127], v[212:215], v[192:195], v[124:127]
    ds_read_b64_tr_b16 v[174:175], v19 offset:7328
    v_mfma_f32_16x16x32_bf16 v[128:131], v[216:219], v[192:195], v[128:131]
    ds_read_b64_tr_b16 v[176:177], v18 offset:192
    v_mfma_f32_16x16x32_bf16 v[100:103], v[216:219], v[188:191], v[100:103]
    ds_read_b64_tr_b16 v[178:179], v18 offset:7360
    v_mfma_f32_16x16x32_bf16 v[72:75], v[216:219], v[184:187], v[72:75]
    v_mfma_f32_16x16x32_bf16 v[44:47], v[216:219], v[180:183], v[44:47]
    v_mfma_f32_16x16x32_bf16 v[48:51], v[220:223], v[180:183], v[48:51]
    v_mfma_f32_16x16x32_bf16 v[76:79], v[220:223], v[184:187], v[76:79]
    v_mfma_f32_16x16x32_bf16 v[104:107], v[220:223], v[188:191], v[104:107]
    v_mfma_f32_16x16x32_bf16 v[132:135], v[220:223], v[192:195], v[132:135]
    s_waitcnt lgkmcnt(12)
    s_cbranch_scc1 mm_26
    v_mfma_f32_16x16x32_bf16 v[24:27], v[152:155], v[136:139], v[24:27]
    ds_read_b128 v[180:183], v17 offset:1024
    v_mfma_f32_16x16x32_bf16 v[52:55], v[152:155], v[140:143], v[52:55]
    ds_read_b128 v[184:187], v17 offset:3072
    v_mfma_f32_16x16x32_bf16 v[80:83], v[152:155], v[144:147], v[80:83]
    ds_read_b128 v[188:191], v17 offset:5120
    v_mfma_f32_16x16x32_bf16 v[108:111], v[152:155], v[148:151], v[108:111]
    ds_read_b128 v[192:195], v17 offset:7168
    s_waitcnt lgkmcnt(14)
    v_mfma_f32_16x16x32_bf16 v[112:115], v[156:159], v[148:151], v[112:115]
    ds_read_b64_tr_b16 v[196:197], v18 offset:14336
    v_mfma_f32_16x16x32_bf16 v[84:87], v[156:159], v[144:147], v[84:87]
    ds_read_b64_tr_b16 v[198:199], v18 offset:21504
    v_mfma_f32_16x16x32_bf16 v[56:59], v[156:159], v[140:143], v[56:59]
    ds_read_b64_tr_b16 v[200:201], v19 offset:14368
    v_mfma_f32_16x16x32_bf16 v[28:31], v[156:159], v[136:139], v[28:31]
    ds_read_b64_tr_b16 v[202:203], v19 offset:21536
    s_waitcnt lgkmcnt(8)
    v_mfma_f32_16x16x32_bf16 v[32:35], v[160:163], v[136:139], v[32:35]
    ds_read_b64_tr_b16 v[204:205], v18 offset:14400
    v_mfma_f32_16x16x32_bf16 v[60:63], v[160:163], v[140:143], v[60:63]
    ds_read_b64_tr_b16 v[206:207], v18 offset:21568
    v_mfma_f32_16x16x32_bf16 v[88:91], v[160:163], v[144:147], v[88:91]
    ds_read_b64_tr_b16 v[208:209], v19 offset:14432
    v_mfma_f32_16x16x32_bf16 v[116:119], v[160:163], v[148:151], v[116:119]
    ds_read_b64_tr_b16 v[210:211], v19 offset:21600
    v_mfma_f32_16x16x32_bf16 v[120:123], v[164:167], v[148:151], v[120:123]
    ds_read_b64_tr_b16 v[212:213], v18 offset:14464
    v_mfma_f32_16x16x32_bf16 v[92:95], v[164:167], v[144:147], v[92:95]
    ds_read_b64_tr_b16 v[214:215], v18 offset:21632
    v_mfma_f32_16x16x32_bf16 v[64:67], v[164:167], v[140:143], v[64:67]
    ds_read_b64_tr_b16 v[216:217], v19 offset:14496
    v_mfma_f32_16x16x32_bf16 v[36:39], v[164:167], v[136:139], v[36:39]
    ds_read_b64_tr_b16 v[218:219], v19 offset:21664
    v_mfma_f32_16x16x32_bf16 v[40:43], v[168:171], v[136:139], v[40:43]
    ds_read_b64_tr_b16 v[220:221], v18 offset:14528
    v_mfma_f32_16x16x32_bf16 v[68:71], v[168:171], v[140:143], v[68:71]
    ds_read_b64_tr_b16 v[222:223], v18 offset:21696
    v_mfma_f32_16x16x32_bf16 v[96:99], v[168:171], v[144:147], v[96:99]
    v_mfma_f32_16x16x32_bf16 v[124:127], v[168:171], v[148:151], v[124:127]
    v_mfma_f32_16x16x32_bf16 v[128:131], v[172:175], v[148:151], v[128:131]
    v_mfma_f32_16x16x32_bf16 v[100:103], v[172:175], v[144:147], v[100:103]
    v_mfma_f32_16x16x32_bf16 v[72:75], v[172:175], v[140:143], v[72:75]
    v_mfma_f32_16x16x32_bf16 v[44:47], v[172:175], v[136:139], v[44:47]
    v_mfma_f32_16x16x32_bf16 v[48:51], v[176:179], v[136:139], v[48:51]
    v_mfma_f32_16x16x32_bf16 v[76:79], v[176:179], v[140:143], v[76:79]
    v_mfma_f32_16x16x32_bf16 v[104:107], v[176:179], v[144:147], v[104:107]
    v_mfma_f32_16x16x32_bf16 v[132:135], v[176:179], v[148:151], v[132:135]
    s_waitcnt lgkmcnt(0)
    s_barrier
    v_mfma_f32_16x16x32_bf16 v[24:27], v[196:199], v[180:183], v[24:27]
    ds_read_b128 v[136:139], v6 offset:0
    v_mfma_f32_16x16x32_bf16 v[52:55], v[196:199], v[184:187], v[52:55]
    ds_read_b128 v[140:143], v6 offset:64
    v_mfma_f32_16x16x32_bf16 v[80:83], v[196:199], v[188:191], v[80:83]
    ds_read_b128 v[144:147], v6 offset:128
    v_mfma_f32_16x16x32_bf16 v[108:111], v[196:199], v[192:195], v[108:111]
    ds_read_b128 v[148:151], v6 offset:192
    v_mfma_f32_16x16x32_bf16 v[112:115], v[200:203], v[192:195], v[112:115]
    ds_read_b128 v[152:155], v6 offset:256
    v_mfma_f32_16x16x32_bf16 v[84:87], v[200:203], v[188:191], v[84:87]
    ds_read_b128 v[156:159], v6 offset:320
    v_mfma_f32_16x16x32_bf16 v[56:59], v[200:203], v[184:187], v[56:59]
    ds_read_b128 v[160:163], v6 offset:384
    v_mfma_f32_16x16x32_bf16 v[28:31], v[200:203], v[180:183], v[28:31]
    ds_read_b128 v[164:167], v7 offset:0
    v_mfma_f32_16x16x32_bf16 v[32:35], v[204:207], v[180:183], v[32:35]
    ds_read_b128 v[168:171], v7 offset:256
    v_mfma_f32_16x16x32_bf16 v[60:63], v[204:207], v[184:187], v[60:63]
    ds_read_b128 v[172:175], v7 offset:512
    v_mfma_f32_16x16x32_bf16 v[88:91], v[204:207], v[188:191], v[88:91]
    ds_read_b128 v[176:179], v7 offset:768
    v_mov_b32 v13, v240
    v_mfma_f32_16x16x32_bf16 v[116:119], v[204:207], v[192:195], v[116:119]
    v_add_u32 v18, 0, v240
    v_mov_b32 v14, v241
    v_mfma_f32_16x16x32_bf16 v[120:123], v[208:211], v[192:195], v[120:123]
    v_add_u32 v19, 0, v241
    v_mov_b32 v15, v242
    v_mfma_f32_16x16x32_bf16 v[92:95], v[208:211], v[188:191], v[92:95]
    v_add_u32 v20, 0, v242
    v_mov_b32 v16, v243
    v_mfma_f32_16x16x32_bf16 v[64:67], v[208:211], v[184:187], v[64:67]
    v_add_u32 v21, 0, v243
    s_mov_b32 s42, 0
    s_mov_b32 s43, 0
    v_mfma_f32_16x16x32_bf16 v[36:39], v[208:211], v[180:183], v[36:39]
    s_mov_b32 s48, 0
    v_mov_b32 v17, v12
    v_and_b32 v199, 7, v0
    v_mfma_f32_16x16x32_bf16 v[40:43], v[212:215], v[180:183], v[40:43]
    v_lshrrev_b32 v228, 6, v0
    v_lshlrev_b32 v228, 4, v228
    v_mfma_f32_16x16x32_bf16 v[68:71], v[212:215], v[184:187], v[68:71]
    v_bfe_u32 v229, v0, 3, 3
    v_add_u32 v228, v228, v229
    s_lshr_b32 s78, s29, 1
    v_mfma_f32_16x16x32_bf16 v[96:99], v[212:215], v[188:191], v[96:99]
    s_lshl_b32 s78, s78, 16
    s_and_b32 s79, s29, 1
    s_lshl_b32 s79, s79, 7
    v_mfma_f32_16x16x32_bf16 v[124:127], v[212:215], v[192:195], v[124:127]
    s_add_u32 s78, s78, s79
    s_lshr_b32 s79, s30, 1
    s_lshl_b32 s79, s79, 13
    v_mfma_f32_16x16x32_bf16 v[128:131], v[216:219], v[192:195], v[128:131]
    s_add_u32 s78, s78, s79
    v_lshlrev_b32 v196, 8, v228
    v_lshl_add_u32 v196, v199, 4, v196
    v_mfma_f32_16x16x32_bf16 v[100:103], v[216:219], v[188:191], v[100:103]
    v_add_u32 v196, s78, v196
    v_mfma_f32_16x16x32_bf16 v[72:75], v[216:219], v[184:187], v[72:75]
    v_mfma_f32_16x16x32_bf16 v[44:47], v[216:219], v[180:183], v[44:47]
    v_mfma_f32_16x16x32_bf16 v[48:51], v[220:223], v[180:183], v[48:51]
    v_mfma_f32_16x16x32_bf16 v[76:79], v[220:223], v[184:187], v[76:79]
    v_mfma_f32_16x16x32_bf16 v[104:107], v[220:223], v[188:191], v[104:107]
    v_mfma_f32_16x16x32_bf16 v[132:135], v[220:223], v[192:195], v[132:135]
    s_waitcnt lgkmcnt(0)
    s_cmp_eq_u32 s35, 1
    s_cbranch_scc1 G3_e1
    v_pk_fma_f32 v[24:25], v[164:165], v[136:137], v[24:25] op_sel_hi:[0,1,1] neg_lo:[1,0,0] neg_hi:[1,0,0]
    v_pk_fma_f32 v[26:27], v[164:165], v[138:139], v[26:27] op_sel_hi:[0,1,1] neg_lo:[1,0,0] neg_hi:[1,0,0]
    v_pk_mul_f32 v[226:227], v[24:25], v[24:25]
    v_pk_mul_f32 v[228:229], v[26:27], v[26:27]
    v_pk_fma_f32 v[226:227], v[226:227], v[166:167], v[166:167] op_sel:[0,1,0] op_sel_hi:[1,1,0]
    v_pk_fma_f32 v[228:229], v[228:229], v[166:167], v[166:167] op_sel:[0,1,0] op_sel_hi:[1,1,0]
    v_pk_mul_f32 v[226:227], v[226:227], v[24:25]
    v_pk_mul_f32 v[228:229], v[228:229], v[26:27]
    v_exp_f32 v226, v226
    v_exp_f32 v227, v227
    v_exp_f32 v228, v228
    v_exp_f32 v229, v229
    v_pk_fma_f32 v[226:227], v[226:227], v[164:165], v[164:165] op_sel:[0,1,1] op_sel_hi:[1,1,1]
    v_pk_fma_f32 v[228:229], v[228:229], v[164:165], v[164:165] op_sel:[0,1,1] op_sel_hi:[1,1,1]
    v_rcp_f32 v226, v226
    v_rcp_f32 v227, v227
    v_rcp_f32 v228, v228
    v_rcp_f32 v229, v229
    v_pk_mul_f32 v[24:25], v[24:25], v[226:227]
    v_pk_mul_f32 v[26:27], v[26:27], v[228:229]
    v_pk_fma_f32 v[28:29], v[164:165], v[140:141], v[28:29] op_sel_hi:[0,1,1] neg_lo:[1,0,0] neg_hi:[1,0,0]
    v_pk_fma_f32 v[30:31], v[164:165], v[142:143], v[30:31] op_sel_hi:[0,1,1] neg_lo:[1,0,0] neg_hi:[1,0,0]
    v_pk_mul_f32 v[226:227], v[28:29], v[28:29]
    v_pk_mul_f32 v[228:229], v[30:31], v[30:31]
    v_pk_fma_f32 v[226:227], v[226:227], v[166:167], v[166:167] op_sel:[0,1,0] op_sel_hi:[1,1,0]
    v_pk_fma_f32 v[228:229], v[228:229], v[166:167], v[166:167] op_sel:[0,1,0] op_sel_hi:[1,1,0]
    v_pk_mul_f32 v[226:227], v[226:227], v[28:29]
    v_pk_mul_f32 v[228:229], v[228:229], v[30:31]
    v_exp_f32 v226, v226
    v_exp_f32 v227, v227
    v_exp_f32 v228, v228
    v_exp_f32 v229, v229
    v_pk_fma_f32 v[226:227], v[226:227], v[164:165], v[164:165] op_sel:[0,1,1] op_sel_hi:[1,1,1]
    v_pk_fma_f32 v[228:229], v[228:229], v[164:165], v[164:165] op_sel:[0,1,1] op_sel_hi:[1,1,1]
    v_rcp_f32 v226, v226
    v_rcp_f32 v227, v227
    v_rcp_f32 v228, v228
    v_rcp_f32 v229, v229
    v_pk_mul_f32 v[28:29], v[28:29], v[226:227]
    v_pk_mul_f32 v[30:31], v[30:31], v[228:229]
    v_cvt_pk_bf16_f32 v24, v24, v25
    v_cvt_pk_bf16_f32 v25, v26, v27
    v_cvt_pk_bf16_f32 v26, v28, v29
    v_cvt_pk_bf16_f32 v27, v30, v31
    v_or_b32 v24, 1, v24
    ds_write_b128 v244, v[24:27] offset:0
    s_add_u32 s36, s44, 0
    buffer_store_dwordx4 v[24:27], v2, s[16:19], s36 offen sc1
    v_pk_fma_f32 v[52:53], v[168:169], v[136:137], v[52:53] op_sel_hi:[0,1,1] neg_lo:[1,0,0] neg_hi:[1,0,0]
    v_pk_fma_f32 v[54:55], v[168:169], v[138:139], v[54:55] op_sel_hi:[0,1,1] neg_lo:[1,0,0] neg_hi:[1,0,0]
    v_pk_mul_f32 v[226:227], v[52:53], v[52:53]
    v_pk_mul_f32 v[228:229], v[54:55], v[54:55]
    v_pk_fma_f32 v[226:227], v[226:227], v[170:171], v[170:171] op_sel:[0,1,0] op_sel_hi:[1,1,0]
    v_pk_fma_f32 v[228:229], v[228:229], v[170:171], v[170:171] op_sel:[0,1,0] op_sel_hi:[1,1,0]
    v_pk_mul_f32 v[226:227], v[226:227], v[52:53]
    v_pk_mul_f32 v[228:229], v[228:229], v[54:55]
    v_exp_f32 v226, v226
    v_exp_f32 v227, v227
    v_exp_f32 v228, v228
    v_exp_f32 v229, v229
    v_pk_fma_f32 v[226:227], v[226:227], v[168:169], v[168:169] op_sel:[0,1,1] op_sel_hi:[1,1,1]
    v_pk_fma_f32 v[228:229], v[228:229], v[168:169], v[168:169] op_sel:[0,1,1] op_sel_hi:[1,1,1]
    v_rcp_f32 v226, v226
    v_rcp_f32 v227, v227
    v_rcp_f32 v228, v228
    v_rcp_f32 v229, v229
    v_pk_mul_f32 v[52:53], v[52:53], v[226:227]
    v_pk_mul_f32 v[54:55], v[54:55], v[228:229]
    v_pk_fma_f32 v[56:57], v[168:169], v[140:141], v[56:57] op_sel_hi:[0,1,1] neg_lo:[1,0,0] neg_hi:[1,0,0]
    v_pk_fma_f32 v[58:59], v[168:169], v[142:143], v[58:59] op_sel_hi:[0,1,1] neg_lo:[1,0,0] neg_hi:[1,0,0]
    v_pk_mul_f32 v[226:227], v[56:57], v[56:57]
    v_pk_mul_f32 v[228:229], v[58:59], v[58:59]
    v_pk_fma_f32 v[226:227], v[226:227], v[170:171], v[170:171] op_sel:[0,1,0] op_sel_hi:[1,1,0]
    v_pk_fma_f32 v[228:229], v[228:229], v[170:171], v[170:171] op_sel:[0,1,0] op_sel_hi:[1,1,0]
    v_pk_mul_f32 v[226:227], v[226:227], v[56:57]
    v_pk_mul_f32 v[228:229], v[228:229], v[58:59]
    v_exp_f32 v226, v226
    v_exp_f32 v227, v227
    v_exp_f32 v228, v228
    v_exp_f32 v229, v229
    v_pk_fma_f32 v[226:227], v[226:227], v[168:169], v[168:169] op_sel:[0,1,1] op_sel_hi:[1,1,1]
    v_pk_fma_f32 v[228:229], v[228:229], v[168:169], v[168:169] op_sel:[0,1,1] op_sel_hi:[1,1,1]
    v_rcp_f32 v226, v226
    v_rcp_f32 v227, v227
    v_rcp_f32 v228, v228
    v_rcp_f32 v229, v229
    v_pk_mul_f32 v[56:57], v[56:57], v[226:227]
    v_pk_mul_f32 v[58:59], v[58:59], v[228:229]
    v_cvt_pk_bf16_f32 v52, v52, v53
    v_cvt_pk_bf16_f32 v53, v54, v55
    v_cvt_pk_bf16_f32 v54, v56, v57
    v_cvt_pk_bf16_f32 v55, v58, v59
    v_or_b32 v52, 1, v52
    ds_write_b128 v244, v[52:55] offset:2048
    s_add_u32 s36, s44, 229376
    buffer_store_dwordx4 v[52:55], v2, s[16:19], s36 offen sc1
    v_pk_fma_f32 v[80:81], v[172:173], v[136:137], v[80:81] op_sel_hi:[0,1,1] neg_lo:[1,0,0] neg_hi:[1,0,0]
    v_pk_fma_f32 v[82:83], v[172:173], v[138:139], v[82:83] op_sel_hi:[0,1,1] neg_lo:[1,0,0] neg_hi:[1,0,0]
    v_pk_mul_f32 v[226:227], v[80:81], v[80:81]
    v_pk_mul_f32 v[228:229], v[82:83], v[82:83]
    v_pk_fma_f32 v[226:227], v[226:227], v[174:175], v[174:175] op_sel:[0,1,0] op_sel_hi:[1,1,0]
    v_pk_fma_f32 v[228:229], v[228:229], v[174:175], v[174:175] op_sel:[0,1,0] op_sel_hi:[1,1,0]
    v_pk_mul_f32 v[226:227], v[226:227], v[80:81]
    v_pk_mul_f32 v[228:229], v[228:229], v[82:83]
    v_exp_f32 v226, v226
    v_exp_f32 v227, v227
    v_exp_f32 v228, v228
    v_exp_f32 v229, v229
    v_pk_fma_f32 v[226:227], v[226:227], v[172:173], v[172:173] op_sel:[0,1,1] op_sel_hi:[1,1,1]
    v_pk_fma_f32 v[228:229], v[228:229], v[172:173], v[172:173] op_sel:[0,1,1] op_sel_hi:[1,1,1]
    v_rcp_f32 v226, v226
    v_rcp_f32 v227, v227
    v_rcp_f32 v228, v228
    v_rcp_f32 v229, v229
    v_pk_mul_f32 v[80:81], v[80:81], v[226:227]
    v_pk_mul_f32 v[82:83], v[82:83], v[228:229]
    v_pk_fma_f32 v[84:85], v[172:173], v[140:141], v[84:85] op_sel_hi:[0,1,1] neg_lo:[1,0,0] neg_hi:[1,0,0]
    v_pk_fma_f32 v[86:87], v[172:173], v[142:143], v[86:87] op_sel_hi:[0,1,1] neg_lo:[1,0,0] neg_hi:[1,0,0]
    v_pk_mul_f32 v[226:227], v[84:85], v[84:85]
    v_pk_mul_f32 v[228:229], v[86:87], v[86:87]
    v_pk_fma_f32 v[226:227], v[226:227], v[174:175], v[174:175] op_sel:[0,1,0] op_sel_hi:[1,1,0]
    v_pk_fma_f32 v[228:229], v[228:229], v[174:175], v[174:175] op_sel:[0,1,0] op_sel_hi:[1,1,0]
    v_pk_mul_f32 v[226:227], v[226:227], v[84:85]
    v_pk_mul_f32 v[228:229], v[228:229], v[86:87]
    v_exp_f32 v226, v226
    v_exp_f32 v227, v227
    v_exp_f32 v228, v228
    v_exp_f32 v229, v229
    v_pk_fma_f32 v[226:227], v[226:227], v[172:173], v[172:173] op_sel:[0,1,1] op_sel_hi:[1,1,1]
    v_pk_fma_f32 v[228:229], v[228:229], v[172:173], v[172:173] op_sel:[0,1,1] op_sel_hi:[1,1,1]
    v_rcp_f32 v226, v226
    v_rcp_f32 v227, v227
    v_rcp_f32 v228, v228
    v_rcp_f32 v229, v229
    v_pk_mul_f32 v[84:85], v[84:85], v[226:227]
    v_pk_mul_f32 v[86:87], v[86:87], v[228:229]
    v_cvt_pk_bf16_f32 v80, v80, v81
    v_cvt_pk_bf16_f32 v81, v82, v83
    v_cvt_pk_bf16_f32 v82, v84, v85
    v_cvt_pk_bf16_f32 v83, v86, v87
    v_or_b32 v80, 1, v80
    ds_write_b128 v244, v[80:83] offset:4096
    s_add_u32 s36, s44, 458752
    buffer_store_dwordx4 v[80:83], v2, s[16:19], s36 offen sc1
    v_pk_fma_f32 v[108:109], v[176:177], v[136:137], v[108:109] op_sel_hi:[0,1,1] neg_lo:[1,0,0] neg_hi:[1,0,0]
    v_pk_fma_f32 v[110:111], v[176:177], v[138:139], v[110:111] op_sel_hi:[0,1,1] neg_lo:[1,0,0] neg_hi:[1,0,0]
    v_pk_mul_f32 v[226:227], v[108:109], v[108:109]
    v_pk_mul_f32 v[228:229], v[110:111], v[110:111]
    v_pk_fma_f32 v[226:227], v[226:227], v[178:179], v[178:179] op_sel:[0,1,0] op_sel_hi:[1,1,0]
    v_pk_fma_f32 v[228:229], v[228:229], v[178:179], v[178:179] op_sel:[0,1,0] op_sel_hi:[1,1,0]
    v_pk_mul_f32 v[226:227], v[226:227], v[108:109]
    v_pk_mul_f32 v[228:229], v[228:229], v[110:111]
    v_exp_f32 v226, v226
    v_exp_f32 v227, v227
    v_exp_f32 v228, v228
    v_exp_f32 v229, v229
    v_pk_fma_f32 v[226:227], v[226:227], v[176:177], v[176:177] op_sel:[0,1,1] op_sel_hi:[1,1,1]
    v_pk_fma_f32 v[228:229], v[228:229], v[176:177], v[176:177] op_sel:[0,1,1] op_sel_hi:[1,1,1]
    v_rcp_f32 v226, v226
    v_rcp_f32 v227, v227
    v_rcp_f32 v228, v228
    v_rcp_f32 v229, v229
    v_pk_mul_f32 v[108:109], v[108:109], v[226:227]
    v_pk_mul_f32 v[110:111], v[110:111], v[228:229]
    v_pk_fma_f32 v[112:113], v[176:177], v[140:141], v[112:113] op_sel_hi:[0,1,1] neg_lo:[1,0,0] neg_hi:[1,0,0]
    v_pk_fma_f32 v[114:115], v[176:177], v[142:143], v[114:115] op_sel_hi:[0,1,1] neg_lo:[1,0,0] neg_hi:[1,0,0]
    v_pk_mul_f32 v[226:227], v[112:113], v[112:113]
    v_pk_mul_f32 v[228:229], v[114:115], v[114:115]
    v_pk_fma_f32 v[226:227], v[226:227], v[178:179], v[178:179] op_sel:[0,1,0] op_sel_hi:[1,1,0]
    v_pk_fma_f32 v[228:229], v[228:229], v[178:179], v[178:179] op_sel:[0,1,0] op_sel_hi:[1,1,0]
    v_pk_mul_f32 v[226:227], v[226:227], v[112:113]
    v_pk_mul_f32 v[228:229], v[228:229], v[114:115]
    v_exp_f32 v226, v226
    v_exp_f32 v227, v227
    v_exp_f32 v228, v228
    v_exp_f32 v229, v229
    v_pk_fma_f32 v[226:227], v[226:227], v[176:177], v[176:177] op_sel:[0,1,1] op_sel_hi:[1,1,1]
    v_pk_fma_f32 v[228:229], v[228:229], v[176:177], v[176:177] op_sel:[0,1,1] op_sel_hi:[1,1,1]
    v_rcp_f32 v226, v226
    v_rcp_f32 v227, v227
    v_rcp_f32 v228, v228
    v_rcp_f32 v229, v229
    v_pk_mul_f32 v[112:113], v[112:113], v[226:227]
    v_pk_mul_f32 v[114:115], v[114:115], v[228:229]
    v_cvt_pk_bf16_f32 v108, v108, v109
    v_cvt_pk_bf16_f32 v109, v110, v111
    v_cvt_pk_bf16_f32 v110, v112, v113
    v_cvt_pk_bf16_f32 v111, v114, v115
    ds_write_b128 v244, v[108:111] offset:6144
    s_add_u32 s36, s44, 688128
    buffer_store_dwordx4 v[108:111], v2, s[16:19], s36 offen sc1
    v_pk_fma_f32 v[32:33], v[164:165], v[144:145], v[32:33] op_sel_hi:[0,1,1] neg_lo:[1,0,0] neg_hi:[1,0,0]
    v_pk_fma_f32 v[34:35], v[164:165], v[146:147], v[34:35] op_sel_hi:[0,1,1] neg_lo:[1,0,0] neg_hi:[1,0,0]
    v_pk_mul_f32 v[226:227], v[32:33], v[32:33]
    v_pk_mul_f32 v[228:229], v[34:35], v[34:35]
    v_pk_fma_f32 v[226:227], v[226:227], v[166:167], v[166:167] op_sel:[0,1,0] op_sel_hi:[1,1,0]
    v_pk_fma_f32 v[228:229], v[228:229], v[166:167], v[166:167] op_sel:[0,1,0] op_sel_hi:[1,1,0]
    v_pk_mul_f32 v[226:227], v[226:227], v[32:33]
    v_pk_mul_f32 v[228:229], v[228:229], v[34:35]
    v_exp_f32 v226, v226
    v_exp_f32 v227, v227
    v_exp_f32 v228, v228
    v_exp_f32 v229, v229
    v_pk_fma_f32 v[226:227], v[226:227], v[164:165], v[164:165] op_sel:[0,1,1] op_sel_hi:[1,1,1]
    v_pk_fma_f32 v[228:229], v[228:229], v[164:165], v[164:165] op_sel:[0,1,1] op_sel_hi:[1,1,1]
    v_rcp_f32 v226, v226
    v_rcp_f32 v227, v227
    v_rcp_f32 v228, v228
    v_rcp_f32 v229, v229
    v_pk_mul_f32 v[32:33], v[32:33], v[226:227]
    v_pk_mul_f32 v[34:35], v[34:35], v[228:229]
    v_pk_fma_f32 v[36:37], v[164:165], v[148:149], v[36:37] op_sel_hi:[0,1,1] neg_lo:[1,0,0] neg_hi:[1,0,0]
    v_pk_fma_f32 v[38:39], v[164:165], v[150:151], v[38:39] op_sel_hi:[0,1,1] neg_lo:[1,0,0] neg_hi:[1,0,0]
    v_pk_mul_f32 v[226:227], v[36:37], v[36:37]
    v_pk_mul_f32 v[228:229], v[38:39], v[38:39]
    v_pk_fma_f32 v[226:227], v[226:227], v[166:167], v[166:167] op_sel:[0,1,0] op_sel_hi:[1,1,0]
    v_pk_fma_f32 v[228:229], v[228:229], v[166:167], v[166:167] op_sel:[0,1,0] op_sel_hi:[1,1,0]
    v_pk_mul_f32 v[226:227], v[226:227], v[36:37]
    v_pk_mul_f32 v[228:229], v[228:229], v[38:39]
    v_exp_f32 v226, v226
    v_exp_f32 v227, v227
    v_exp_f32 v228, v228
    v_exp_f32 v229, v229
    v_pk_fma_f32 v[226:227], v[226:227], v[164:165], v[164:165] op_sel:[0,1,1] op_sel_hi:[1,1,1]
    v_pk_fma_f32 v[228:229], v[228:229], v[164:165], v[164:165] op_sel:[0,1,1] op_sel_hi:[1,1,1]
    v_rcp_f32 v226, v226
    v_rcp_f32 v227, v227
    v_rcp_f32 v228, v228
    v_rcp_f32 v229, v229
    v_pk_mul_f32 v[36:37], v[36:37], v[226:227]
    v_pk_mul_f32 v[38:39], v[38:39], v[228:229]
    v_cvt_pk_bf16_f32 v32, v32, v33
    v_cvt_pk_bf16_f32 v33, v34, v35
    v_cvt_pk_bf16_f32 v34, v36, v37
    v_cvt_pk_bf16_f32 v35, v38, v39
    v_or_b32 v32, 1, v32
    ds_write_b128 v244, v[32:35] offset:16384
    v_pk_fma_f32 v[60:61], v[168:169], v[144:145], v[60:61] op_sel_hi:[0,1,1] neg_lo:[1,0,0] neg_hi:[1,0,0]
    v_pk_fma_f32 v[62:63], v[168:169], v[146:147], v[62:63] op_sel_hi:[0,1,1] neg_lo:[1,0,0] neg_hi:[1,0,0]
    v_pk_mul_f32 v[226:227], v[60:61], v[60:61]
    v_pk_mul_f32 v[228:229], v[62:63], v[62:63]
    v_pk_fma_f32 v[226:227], v[226:227], v[170:171], v[170:171] op_sel:[0,1,0] op_sel_hi:[1,1,0]
    v_pk_fma_f32 v[228:229], v[228:229], v[170:171], v[170:171] op_sel:[0,1,0] op_sel_hi:[1,1,0]
    v_pk_mul_f32 v[226:227], v[226:227], v[60:61]
    v_pk_mul_f32 v[228:229], v[228:229], v[62:63]
    v_exp_f32 v226, v226
    v_exp_f32 v227, v227
    v_exp_f32 v228, v228
    v_exp_f32 v229, v229
    v_pk_fma_f32 v[226:227], v[226:227], v[168:169], v[168:169] op_sel:[0,1,1] op_sel_hi:[1,1,1]
    v_pk_fma_f32 v[228:229], v[228:229], v[168:169], v[168:169] op_sel:[0,1,1] op_sel_hi:[1,1,1]
    v_rcp_f32 v226, v226
    v_rcp_f32 v227, v227
    v_rcp_f32 v228, v228
    v_rcp_f32 v229, v229
    v_pk_mul_f32 v[60:61], v[60:61], v[226:227]
    v_pk_mul_f32 v[62:63], v[62:63], v[228:229]
    v_pk_fma_f32 v[64:65], v[168:169], v[148:149], v[64:65] op_sel_hi:[0,1,1] neg_lo:[1,0,0] neg_hi:[1,0,0]
    v_pk_fma_f32 v[66:67], v[168:169], v[150:151], v[66:67] op_sel_hi:[0,1,1] neg_lo:[1,0,0] neg_hi:[1,0,0]
    v_pk_mul_f32 v[226:227], v[64:65], v[64:65]
    v_pk_mul_f32 v[228:229], v[66:67], v[66:67]
    v_pk_fma_f32 v[226:227], v[226:227], v[170:171], v[170:171] op_sel:[0,1,0] op_sel_hi:[1,1,0]
    v_pk_fma_f32 v[228:229], v[228:229], v[170:171], v[170:171] op_sel:[0,1,0] op_sel_hi:[1,1,0]
    v_pk_mul_f32 v[226:227], v[226:227], v[64:65]
    v_pk_mul_f32 v[228:229], v[228:229], v[66:67]
    v_exp_f32 v226, v226
    v_exp_f32 v227, v227
    v_exp_f32 v228, v228
    v_exp_f32 v229, v229
    v_pk_fma_f32 v[226:227], v[226:227], v[168:169], v[168:169] op_sel:[0,1,1] op_sel_hi:[1,1,1]
    v_pk_fma_f32 v[228:229], v[228:229], v[168:169], v[168:169] op_sel:[0,1,1] op_sel_hi:[1,1,1]
    v_rcp_f32 v226, v226
    v_rcp_f32 v227, v227
    v_rcp_f32 v228, v228
    v_rcp_f32 v229, v229
    v_pk_mul_f32 v[64:65], v[64:65], v[226:227]
    v_pk_mul_f32 v[66:67], v[66:67], v[228:229]
    v_cvt_pk_bf16_f32 v60, v60, v61
    v_cvt_pk_bf16_f32 v61, v62, v63
    v_cvt_pk_bf16_f32 v62, v64, v65
    v_cvt_pk_bf16_f32 v63, v66, v67
    v_or_b32 v60, 1, v60
    ds_write_b128 v244, v[60:63] offset:18432
    s_waitcnt vmcnt(0)
    s_mov_b64 exec, 1
    ds_add_u32 v246, v245
    s_mov_b64 exec, -1
    v_pk_fma_f32 v[88:89], v[172:173], v[144:145], v[88:89] op_sel_hi:[0,1,1] neg_lo:[1,0,0] neg_hi:[1,0,0]
    v_pk_fma_f32 v[90:91], v[172:173], v[146:147], v[90:91] op_sel_hi:[0,1,1] neg_lo:[1,0,0] neg_hi:[1,0,0]
    v_pk_mul_f32 v[226:227], v[88:89], v[88:89]
    v_pk_mul_f32 v[228:229], v[90:91], v[90:91]
    v_pk_fma_f32 v[226:227], v[226:227], v[174:175], v[174:175] op_sel:[0,1,0] op_sel_hi:[1,1,0]
    v_pk_fma_f32 v[228:229], v[228:229], v[174:175], v[174:175] op_sel:[0,1,0] op_sel_hi:[1,1,0]
    v_pk_mul_f32 v[226:227], v[226:227], v[88:89]
    v_pk_mul_f32 v[228:229], v[228:229], v[90:91]
    v_exp_f32 v226, v226
    v_exp_f32 v227, v227
    v_exp_f32 v228, v228
    v_exp_f32 v229, v229
    v_pk_fma_f32 v[226:227], v[226:227], v[172:173], v[172:173] op_sel:[0,1,1] op_sel_hi:[1,1,1]
    v_pk_fma_f32 v[228:229], v[228:229], v[172:173], v[172:173] op_sel:[0,1,1] op_sel_hi:[1,1,1]
    v_rcp_f32 v226, v226
    v_rcp_f32 v227, v227
    v_rcp_f32 v228, v228
    v_rcp_f32 v229, v229
    v_pk_mul_f32 v[88:89], v[88:89], v[226:227]
    v_pk_mul_f32 v[90:91], v[90:91], v[228:229]
    v_pk_fma_f32 v[92:93], v[172:173], v[148:149], v[92:93] op_sel_hi:[0,1,1] neg_lo:[1,0,0] neg_hi:[1,0,0]
    v_pk_fma_f32 v[94:95], v[172:173], v[150:151], v[94:95] op_sel_hi:[0,1,1] neg_lo:[1,0,0] neg_hi:[1,0,0]
    v_pk_mul_f32 v[226:227], v[92:93], v[92:93]
    v_pk_mul_f32 v[228:229], v[94:95], v[94:95]
    v_pk_fma_f32 v[226:227], v[226:227], v[174:175], v[174:175] op_sel:[0,1,0] op_sel_hi:[1,1,0]
    v_pk_fma_f32 v[228:229], v[228:229], v[174:175], v[174:175] op_sel:[0,1,0] op_sel_hi:[1,1,0]
    v_pk_mul_f32 v[226:227], v[226:227], v[92:93]
    v_pk_mul_f32 v[228:229], v[228:229], v[94:95]
    v_exp_f32 v226, v226
    v_exp_f32 v227, v227
    v_exp_f32 v228, v228
    v_exp_f32 v229, v229
    v_pk_fma_f32 v[226:227], v[226:227], v[172:173], v[172:173] op_sel:[0,1,1] op_sel_hi:[1,1,1]
    v_pk_fma_f32 v[228:229], v[228:229], v[172:173], v[172:173] op_sel:[0,1,1] op_sel_hi:[1,1,1]
    v_rcp_f32 v226, v226
    v_rcp_f32 v227, v227
    v_rcp_f32 v228, v228
    v_rcp_f32 v229, v229
    v_pk_mul_f32 v[92:93], v[92:93], v[226:227]
    v_pk_mul_f32 v[94:95], v[94:95], v[228:229]
    v_cvt_pk_bf16_f32 v88, v88, v89
    v_cvt_pk_bf16_f32 v89, v90, v91
    v_cvt_pk_bf16_f32 v90, v92, v93
    v_cvt_pk_bf16_f32 v91, v94, v95
    v_or_b32 v88, 1, v88
    ds_write_b128 v244, v[88:91] offset:20480
    s_cmp_eq_u32 s60, 1
    s_cbranch_scc1 G4_p10
    buffer_load_dwordx4 v[180:183], v196, s[84:87], 0 offen offset:0 sc1
    buffer_load_dwordx4 v[188:191], v196, s[88:91], 0 offen offset:0 sc1
    buffer_load_dwordx4 v[184:187], v196, s[84:87], 0 offen offset:2048 sc1
    buffer_load_dwordx4 v[192:195], v196, s[88:91], 0 offen offset:2048 sc1
    s_branch G4_p20
G4_p10:
    s_add_u32 s36, s40, 0
    buffer_load_dwordx4 v[180:183], v2, s[84:87], s36 offen offset:0 sc1
    buffer_load_dwordx4 v[184:187], v2, s[88:91], s36 offen offset:0 sc1
    buffer_load_dwordx4 v[188:191], v2, s[84:87], s36 offen offset:1024 sc1
    buffer_load_dwordx4 v[192:195], v2, s[88:91], s36 offen offset:1024 sc1
    s_add_u32 s36, s40, 65536
    buffer_load_dwordx4 v[196:199], v2, s[84:87], s36 offen offset:0 sc1
    buffer_load_dwordx4 v[230:233], v2, s[88:91], s36 offen offset:0 sc1
    buffer_load_dwordx4 v[234:237], v2, s[84:87], s36 offen offset:1024 sc1
    buffer_load_dwordx4 v[248:251], v2, s[88:91], s36 offen offset:1024 sc1
G4_p20:
    v_pk_fma_f32 v[116:117], v[176:177], v[144:145], v[116:117] op_sel_hi:[0,1,1] neg_lo:[1,0,0] neg_hi:[1,0,0]
    v_pk_fma_f32 v[118:119], v[176:177], v[146:147], v[118:119] op_sel_hi:[0,1,1] neg_lo:[1,0,0] neg_hi:[1,0,0]
    v_pk_mul_f32 v[226:227], v[116:117], v[116:117]
    v_pk_mul_f32 v[228:229], v[118:119], v[118:119]
    v_pk_fma_f32 v[226:227], v[226:227], v[178:179], v[178:179] op_sel:[0,1,0] op_sel_hi:[1,1,0]
    v_pk_fma_f32 v[228:229], v[228:229], v[178:179], v[178:179] op_sel:[0,1,0] op_sel_hi:[1,1,0]
    v_pk_mul_f32 v[226:227], v[226:227], v[116:117]
    v_pk_mul_f32 v[228:229], v[228:229], v[118:119]
    v_exp_f32 v226, v226
    v_exp_f32 v227, v227
    v_exp_f32 v228, v228
    v_exp_f32 v229, v229
    v_pk_fma_f32 v[226:227], v[226:227], v[176:177], v[176:177] op_sel:[0,1,1] op_sel_hi:[1,1,1]
    v_pk_fma_f32 v[228:229], v[228:229], v[176:177], v[176:177] op_sel:[0,1,1] op_sel_hi:[1,1,1]
    v_rcp_f32 v226, v226
    v_rcp_f32 v227, v227
    v_rcp_f32 v228, v228
    v_rcp_f32 v229, v229
    v_pk_mul_f32 v[116:117], v[116:117], v[226:227]
    v_pk_mul_f32 v[118:119], v[118:119], v[228:229]
    v_pk_fma_f32 v[120:121], v[176:177], v[148:149], v[120:121] op_sel_hi:[0,1,1] neg_lo:[1,0,0] neg_hi:[1,0,0]
    v_pk_fma_f32 v[122:123], v[176:177], v[150:151], v[122:123] op_sel_hi:[0,1,1] neg_lo:[1,0,0] neg_hi:[1,0,0]
    v_pk_mul_f32 v[226:227], v[120:121], v[120:121]
    v_pk_mul_f32 v[228:229], v[122:123], v[122:123]
    v_pk_fma_f32 v[226:227], v[226:227], v[178:179], v[178:179] op_sel:[0,1,0] op_sel_hi:[1,1,0]
    v_pk_fma_f32 v[228:229], v[228:229], v[178:179], v[178:179] op_sel:[0,1,0] op_sel_hi:[1,1,0]
    v_pk_mul_f32 v[226:227], v[226:227], v[120:121]
    v_pk_mul_f32 v[228:229], v[228:229], v[122:123]
    v_exp_f32 v226, v226
    v_exp_f32 v227, v227
    v_exp_f32 v228, v228
    v_exp_f32 v229, v229
    v_pk_fma_f32 v[226:227], v[226:227], v[176:177], v[176:177] op_sel:[0,1,1] op_sel_hi:[1,1,1]
    v_pk_fma_f32 v[228:229], v[228:229], v[176:177], v[176:177] op_sel:[0,1,1] op_sel_hi:[1,1,1]
    v_rcp_f32 v226, v226
    v_rcp_f32 v227, v227
    v_rcp_f32 v228, v228
    v_rcp_f32 v229, v229
    v_pk_mul_f32 v[120:121], v[120:121], v[226:227]
    v_pk_mul_f32 v[122:123], v[122:123], v[228:229]
    v_cvt_pk_bf16_f32 v116, v116, v117
    v_cvt_pk_bf16_f32 v117, v118, v119
    v_cvt_pk_bf16_f32 v118, v120, v121
    v_cvt_pk_bf16_f32 v119, v122, v123
    ds_write_b128 v244, v[116:119] offset:22528
    v_pk_fma_f32 v[40:41], v[164:165], v[152:153], v[40:41] op_sel_hi:[0,1,1] neg_lo:[1,0,0] neg_hi:[1,0,0]
    v_pk_fma_f32 v[42:43], v[164:165], v[154:155], v[42:43] op_sel_hi:[0,1,1] neg_lo:[1,0,0] neg_hi:[1,0,0]
    v_pk_mul_f32 v[226:227], v[40:41], v[40:41]
    v_pk_mul_f32 v[228:229], v[42:43], v[42:43]
    v_pk_fma_f32 v[226:227], v[226:227], v[166:167], v[166:167] op_sel:[0,1,0] op_sel_hi:[1,1,0]
    v_pk_fma_f32 v[228:229], v[228:229], v[166:167], v[166:167] op_sel:[0,1,0] op_sel_hi:[1,1,0]
    v_pk_mul_f32 v[226:227], v[226:227], v[40:41]
    v_pk_mul_f32 v[228:229], v[228:229], v[42:43]
    v_exp_f32 v226, v226
    v_exp_f32 v227, v227
    v_exp_f32 v228, v228
    v_exp_f32 v229, v229
    v_pk_fma_f32 v[226:227], v[226:227], v[164:165], v[164:165] op_sel:[0,1,1] op_sel_hi:[1,1,1]
    v_pk_fma_f32 v[228:229], v[228:229], v[164:165], v[164:165] op_sel:[0,1,1] op_sel_hi:[1,1,1]
    v_rcp_f32 v226, v226
    v_rcp_f32 v227, v227
    v_rcp_f32 v228, v228
    v_rcp_f32 v229, v229
    v_pk_mul_f32 v[40:41], v[40:41], v[226:227]
    v_pk_mul_f32 v[42:43], v[42:43], v[228:229]
    v_pk_fma_f32 v[44:45], v[164:165], v[156:157], v[44:45] op_sel_hi:[0,1,1] neg_lo:[1,0,0] neg_hi:[1,0,0]
    v_pk_fma_f32 v[46:47], v[164:165], v[158:159], v[46:47] op_sel_hi:[0,1,1] neg_lo:[1,0,0] neg_hi:[1,0,0]
    v_pk_mul_f32 v[226:227], v[44:45], v[44:45]
    v_pk_mul_f32 v[228:229], v[46:47], v[46:47]
    v_pk_fma_f32 v[226:227], v[226:227], v[166:167], v[166:167] op_sel:[0,1,0] op_sel_hi:[1,1,0]
    v_pk_fma_f32 v[228:229], v[228:229], v[166:167], v[166:167] op_sel:[0,1,0] op_sel_hi:[1,1,0]
    v_pk_mul_f32 v[226:227], v[226:227], v[44:45]
    v_pk_mul_f32 v[228:229], v[228:229], v[46:47]
    v_exp_f32 v226, v226
    v_exp_f32 v227, v227
    v_exp_f32 v228, v228
    v_exp_f32 v229, v229
    v_pk_fma_f32 v[226:227], v[226:227], v[164:165], v[164:165] op_sel:[0,1,1] op_sel_hi:[1,1,1]
    v_pk_fma_f32 v[228:229], v[228:229], v[164:165], v[164:165] op_sel:[0,1,1] op_sel_hi:[1,1,1]
    v_rcp_f32 v226, v226
    v_rcp_f32 v227, v227
    v_rcp_f32 v228, v228
    v_rcp_f32 v229, v229
    v_pk_mul_f32 v[44:45], v[44:45], v[226:227]
    v_pk_mul_f32 v[46:47], v[46:47], v[228:229]
    v_cvt_pk_bf16_f32 v200, v40, v41
    v_cvt_pk_bf16_f32 v201, v42, v43
    v_cvt_pk_bf16_f32 v202, v44, v45
    v_cvt_pk_bf16_f32 v203, v46, v47
    v_or_b32 v200, 1, v200
    ds_write_b128 v244, v[200:203] offset:32768
    v_pk_fma_f32 v[68:69], v[168:169], v[152:153], v[68:69] op_sel_hi:[0,1,1] neg_lo:[1,0,0] neg_hi:[1,0,0]
    v_pk_fma_f32 v[70:71], v[168:169], v[154:155], v[70:71] op_sel_hi:[0,1,1] neg_lo:[1,0,0] neg_hi:[1,0,0]
    v_pk_mul_f32 v[226:227], v[68:69], v[68:69]
    v_pk_mul_f32 v[228:229], v[70:71], v[70:71]
    v_pk_fma_f32 v[226:227], v[226:227], v[170:171], v[170:171] op_sel:[0,1,0] op_sel_hi:[1,1,0]
    v_pk_fma_f32 v[228:229], v[228:229], v[170:171], v[170:171] op_sel:[0,1,0] op_sel_hi:[1,1,0]
    v_pk_mul_f32 v[226:227], v[226:227], v[68:69]
    v_pk_mul_f32 v[228:229], v[228:229], v[70:71]
    v_exp_f32 v226, v226
    v_exp_f32 v227, v227
    v_exp_f32 v228, v228
    v_exp_f32 v229, v229
    v_pk_fma_f32 v[226:227], v[226:227], v[168:169], v[168:169] op_sel:[0,1,1] op_sel_hi:[1,1,1]
    v_pk_fma_f32 v[228:229], v[228:229], v[168:169], v[168:169] op_sel:[0,1,1] op_sel_hi:[1,1,1]
    v_rcp_f32 v226, v226
    v_rcp_f32 v227, v227
    v_rcp_f32 v228, v228
    v_rcp_f32 v229, v229
    v_pk_mul_f32 v[68:69], v[68:69], v[226:227]
    v_pk_mul_f32 v[70:71], v[70:71], v[228:229]
    v_pk_fma_f32 v[72:73], v[168:169], v[156:157], v[72:73] op_sel_hi:[0,1,1] neg_lo:[1,0,0] neg_hi:[1,0,0]
    v_pk_fma_f32 v[74:75], v[168:169], v[158:159], v[74:75] op_sel_hi:[0,1,1] neg_lo:[1,0,0] neg_hi:[1,0,0]
    v_pk_mul_f32 v[226:227], v[72:73], v[72:73]
    v_pk_mul_f32 v[228:229], v[74:75], v[74:75]
    v_pk_fma_f32 v[226:227], v[226:227], v[170:171], v[170:171] op_sel:[0,1,0] op_sel_hi:[1,1,0]
    v_pk_fma_f32 v[228:229], v[228:229], v[170:171], v[170:171] op_sel:[0,1,0] op_sel_hi:[1,1,0]
    v_pk_mul_f32 v[226:227], v[226:227], v[72:73]
    v_pk_mul_f32 v[228:229], v[228:229], v[74:75]
    v_exp_f32 v226, v226
    v_exp_f32 v227, v227
    v_exp_f32 v228, v228
    v_exp_f32 v229, v229
    v_pk_fma_f32 v[226:227], v[226:227], v[168:169], v[168:169] op_sel:[0,1,1] op_sel_hi:[1,1,1]
    v_pk_fma_f32 v[228:229], v[228:229], v[168:169], v[168:169] op_sel:[0,1,1] op_sel_hi:[1,1,1]
    v_rcp_f32 v226, v226
    v_rcp_f32 v227, v227
    v_rcp_f32 v228, v228
    v_rcp_f32 v229, v229
    v_pk_mul_f32 v[72:73], v[72:73], v[226:227]
    v_pk_mul_f32 v[74:75], v[74:75], v[228:229]
    v_cvt_pk_bf16_f32 v204, v68, v69
    v_cvt_pk_bf16_f32 v205, v70, v71
    v_cvt_pk_bf16_f32 v206, v72, v73
    v_cvt_pk_bf16_f32 v207, v74, v75
    v_or_b32 v204, 1, v204
    ds_write_b128 v244, v[204:207] offset:34816
    v_pk_fma_f32 v[96:97], v[172:173], v[152:153], v[96:97] op_sel_hi:[0,1,1] neg_lo:[1,0,0] neg_hi:[1,0,0]
    v_pk_fma_f32 v[98:99], v[172:173], v[154:155], v[98:99] op_sel_hi:[0,1,1] neg_lo:[1,0,0] neg_hi:[1,0,0]
    v_pk_mul_f32 v[226:227], v[96:97], v[96:97]
    v_pk_mul_f32 v[228:229], v[98:99], v[98:99]
    v_pk_fma_f32 v[226:227], v[226:227], v[174:175], v[174:175] op_sel:[0,1,0] op_sel_hi:[1,1,0]
    v_pk_fma_f32 v[228:229], v[228:229], v[174:175], v[174:175] op_sel:[0,1,0] op_sel_hi:[1,1,0]
    v_pk_mul_f32 v[226:227], v[226:227], v[96:97]
    v_pk_mul_f32 v[228:229], v[228:229], v[98:99]
    v_exp_f32 v226, v226
    v_exp_f32 v227, v227
    v_exp_f32 v228, v228
    v_exp_f32 v229, v229
    v_pk_fma_f32 v[226:227], v[226:227], v[172:173], v[172:173] op_sel:[0,1,1] op_sel_hi:[1,1,1]
    v_pk_fma_f32 v[228:229], v[228:229], v[172:173], v[172:173] op_sel:[0,1,1] op_sel_hi:[1,1,1]
    v_rcp_f32 v226, v226
    v_rcp_f32 v227, v227
    v_rcp_f32 v228, v228
    v_rcp_f32 v229, v229
    v_pk_mul_f32 v[96:97], v[96:97], v[226:227]
    v_pk_mul_f32 v[98:99], v[98:99], v[228:229]
    v_pk_fma_f32 v[100:101], v[172:173], v[156:157], v[100:101] op_sel_hi:[0,1,1] neg_lo:[1,0,0] neg_hi:[1,0,0]
    v_pk_fma_f32 v[102:103], v[172:173], v[158:159], v[102:103] op_sel_hi:[0,1,1] neg_lo:[1,0,0] neg_hi:[1,0,0]
    v_pk_mul_f32 v[226:227], v[100:101], v[100:101]
    v_pk_mul_f32 v[228:229], v[102:103], v[102:103]
    v_pk_fma_f32 v[226:227], v[226:227], v[174:175], v[174:175] op_sel:[0,1,0] op_sel_hi:[1,1,0]
    v_pk_fma_f32 v[228:229], v[228:229], v[174:175], v[174:175] op_sel:[0,1,0] op_sel_hi:[1,1,0]
    v_pk_mul_f32 v[226:227], v[226:227], v[100:101]
    v_pk_mul_f32 v[228:229], v[228:229], v[102:103]
    v_exp_f32 v226, v226
    v_exp_f32 v227, v227
    v_exp_f32 v228, v228
    v_exp_f32 v229, v229
    v_pk_fma_f32 v[226:227], v[226:227], v[172:173], v[172:173] op_sel:[0,1,1] op_sel_hi:[1,1,1]
    v_pk_fma_f32 v[228:229], v[228:229], v[172:173], v[172:173] op_sel:[0,1,1] op_sel_hi:[1,1,1]
    v_rcp_f32 v226, v226
    v_rcp_f32 v227, v227
    v_rcp_f32 v228, v228
    v_rcp_f32 v229, v229
    v_pk_mul_f32 v[100:101], v[100:101], v[226:227]
    v_pk_mul_f32 v[102:103], v[102:103], v[228:229]
    v_cvt_pk_bf16_f32 v208, v96, v97
    v_cvt_pk_bf16_f32 v209, v98, v99
    v_cvt_pk_bf16_f32 v210, v100, v101
    v_cvt_pk_bf16_f32 v211, v102, v103
    v_or_b32 v208, 1, v208
    ds_write_b128 v244, v[208:211] offset:36864
    v_pk_fma_f32 v[124:125], v[176:177], v[152:153], v[124:125] op_sel_hi:[0,1,1] neg_lo:[1,0,0] neg_hi:[1,0,0]
    v_pk_fma_f32 v[126:127], v[176:177], v[154:155], v[126:127] op_sel_hi:[0,1,1] neg_lo:[1,0,0] neg_hi:[1,0,0]
    v_pk_mul_f32 v[226:227], v[124:125], v[124:125]
    v_pk_mul_f32 v[228:229], v[126:127], v[126:127]
    v_pk_fma_f32 v[226:227], v[226:227], v[178:179], v[178:179] op_sel:[0,1,0] op_sel_hi:[1,1,0]
    v_pk_fma_f32 v[228:229], v[228:229], v[178:179], v[178:179] op_sel:[0,1,0] op_sel_hi:[1,1,0]
    v_pk_mul_f32 v[226:227], v[226:227], v[124:125]
    v_pk_mul_f32 v[228:229], v[228:229], v[126:127]
    v_exp_f32 v226, v226
    v_exp_f32 v227, v227
    v_exp_f32 v228, v228
    v_exp_f32 v229, v229
    v_pk_fma_f32 v[226:227], v[226:227], v[176:177], v[176:177] op_sel:[0,1,1] op_sel_hi:[1,1,1]
    v_pk_fma_f32 v[228:229], v[228:229], v[176:177], v[176:177] op_sel:[0,1,1] op_sel_hi:[1,1,1]
    v_rcp_f32 v226, v226
    v_rcp_f32 v227, v227
    v_rcp_f32 v228, v228
    v_rcp_f32 v229, v229
    v_pk_mul_f32 v[124:125], v[124:125], v[226:227]
    v_pk_mul_f32 v[126:127], v[126:127], v[228:229]
    v_pk_fma_f32 v[128:129], v[176:177], v[156:157], v[128:129] op_sel_hi:[0,1,1] neg_lo:[1,0,0] neg_hi:[1,0,0]
    v_pk_fma_f32 v[130:131], v[176:177], v[158:159], v[130:131] op_sel_hi:[0,1,1] neg_lo:[1,0,0] neg_hi:[1,0,0]
    v_pk_mul_f32 v[226:227], v[128:129], v[128:129]
    v_pk_mul_f32 v[228:229], v[130:131], v[130:131]
    v_pk_fma_f32 v[226:227], v[226:227], v[178:179], v[178:179] op_sel:[0,1,0] op_sel_hi:[1,1,0]
    v_pk_fma_f32 v[228:229], v[228:229], v[178:179], v[178:179] op_sel:[0,1,0] op_sel_hi:[1,1,0]
    v_pk_mul_f32 v[226:227], v[226:227], v[128:129]
    v_pk_mul_f32 v[228:229], v[228:229], v[130:131]
    v_exp_f32 v226, v226
    v_exp_f32 v227, v227
    v_exp_f32 v228, v228
    v_exp_f32 v229, v229
    v_pk_fma_f32 v[226:227], v[226:227], v[176:177], v[176:177] op_sel:[0,1,1] op_sel_hi:[1,1,1]
    v_pk_fma_f32 v[228:229], v[228:229], v[176:177], v[176:177] op_sel:[0,1,1] op_sel_hi:[1,1,1]
    v_rcp_f32 v226, v226
    v_rcp_f32 v227, v227
    v_rcp_f32 v228, v228
    v_rcp_f32 v229, v229
    v_pk_mul_f32 v[128:129], v[128:129], v[226:227]
    v_pk_mul_f32 v[130:131], v[130:131], v[228:229]
    v_cvt_pk_bf16_f32 v212, v124, v125
    v_cvt_pk_bf16_f32 v213, v126, v127
    v_cvt_pk_bf16_f32 v214, v128, v129
    v_cvt_pk_bf16_f32 v215, v130, v131
    ds_write_b128 v244, v[212:215] offset:38912
    v_pk_fma_f32 v[48:49], v[164:165], v[160:161], v[48:49] op_sel_hi:[0,1,1] neg_lo:[1,0,0] neg_hi:[1,0,0]
    v_pk_fma_f32 v[50:51], v[164:165], v[162:163], v[50:51] op_sel_hi:[0,1,1] neg_lo:[1,0,0] neg_hi:[1,0,0]
    v_pk_mul_f32 v[226:227], v[48:49], v[48:49]
    v_pk_mul_f32 v[228:229], v[50:51], v[50:51]
    v_pk_fma_f32 v[226:227], v[226:227], v[166:167], v[166:167] op_sel:[0,1,0] op_sel_hi:[1,1,0]
    v_pk_fma_f32 v[228:229], v[228:229], v[166:167], v[166:167] op_sel:[0,1,0] op_sel_hi:[1,1,0]
    v_pk_mul_f32 v[226:227], v[226:227], v[48:49]
    v_pk_mul_f32 v[228:229], v[228:229], v[50:51]
    v_exp_f32 v226, v226
    v_exp_f32 v227, v227
    v_exp_f32 v228, v228
    v_exp_f32 v229, v229
    v_pk_fma_f32 v[226:227], v[226:227], v[164:165], v[164:165] op_sel:[0,1,1] op_sel_hi:[1,1,1]
    v_pk_fma_f32 v[228:229], v[228:229], v[164:165], v[164:165] op_sel:[0,1,1] op_sel_hi:[1,1,1]
    v_rcp_f32 v226, v226
    v_rcp_f32 v227, v227
    v_rcp_f32 v228, v228
    v_rcp_f32 v229, v229
    v_pk_mul_f32 v[48:49], v[48:49], v[226:227]
    v_pk_mul_f32 v[50:51], v[50:51], v[228:229]
    v_cvt_pk_bf16_f32 v216, v48, v49
    v_cvt_pk_bf16_f32 v217, v50, v51
    v_or_b32 v216, 1, v216
    s_add_u32 s36, s45, 0
    buffer_store_dwordx4 v[32:35], v2, s[16:19], s36 offen sc1
    v_pk_fma_f32 v[76:77], v[168:169], v[160:161], v[76:77] op_sel_hi:[0,1,1] neg_lo:[1,0,0] neg_hi:[1,0,0]
    v_pk_fma_f32 v[78:79], v[168:169], v[162:163], v[78:79] op_sel_hi:[0,1,1] neg_lo:[1,0,0] neg_hi:[1,0,0]
    v_pk_mul_f32 v[226:227], v[76:77], v[76:77]
    v_pk_mul_f32 v[228:229], v[78:79], v[78:79]
    v_pk_fma_f32 v[226:227], v[226:227], v[170:171], v[170:171] op_sel:[0,1,0] op_sel_hi:[1,1,0]
    v_pk_fma_f32 v[228:229], v[228:229], v[170:171], v[170:171] op_sel:[0,1,0] op_sel_hi:[1,1,0]
    v_pk_mul_f32 v[226:227], v[226:227], v[76:77]
    v_pk_mul_f32 v[228:229], v[228:229], v[78:79]
    v_exp_f32 v226, v226
    v_exp_f32 v227, v227
    v_exp_f32 v228, v228
    v_exp_f32 v229, v229
    v_pk_fma_f32 v[226:227], v[226:227], v[168:169], v[168:169] op_sel:[0,1,1] op_sel_hi:[1,1,1]
    v_pk_fma_f32 v[228:229], v[228:229], v[168:169], v[168:169] op_sel:[0,1,1] op_sel_hi:[1,1,1]
    v_rcp_f32 v226, v226
    v_rcp_f32 v227, v227
    v_rcp_f32 v228, v228
    v_rcp_f32 v229, v229
    v_pk_mul_f32 v[76:77], v[76:77], v[226:227]
    v_pk_mul_f32 v[78:79], v[78:79], v[228:229]
    v_cvt_pk_bf16_f32 v218, v76, v77
    v_cvt_pk_bf16_f32 v219, v78, v79
    v_or_b32 v218, 1, v218
    s_add_u32 s36, s45, 229376
    buffer_store_dwordx4 v[60:63], v2, s[16:19], s36 offen sc1
    v_pk_fma_f32 v[104:105], v[172:173], v[160:161], v[104:105] op_sel_hi:[0,1,1] neg_lo:[1,0,0] neg_hi:[1,0,0]
    v_pk_fma_f32 v[106:107], v[172:173], v[162:163], v[106:107] op_sel_hi:[0,1,1] neg_lo:[1,0,0] neg_hi:[1,0,0]
    v_pk_mul_f32 v[226:227], v[104:105], v[104:105]
    v_pk_mul_f32 v[228:229], v[106:107], v[106:107]
    v_pk_fma_f32 v[226:227], v[226:227], v[174:175], v[174:175] op_sel:[0,1,0] op_sel_hi:[1,1,0]
    v_pk_fma_f32 v[228:229], v[228:229], v[174:175], v[174:175] op_sel:[0,1,0] op_sel_hi:[1,1,0]
    v_pk_mul_f32 v[226:227], v[226:227], v[104:105]
    v_pk_mul_f32 v[228:229], v[228:229], v[106:107]
    v_exp_f32 v226, v226
    v_exp_f32 v227, v227
    v_exp_f32 v228, v228
    v_exp_f32 v229, v229
    v_pk_fma_f32 v[226:227], v[226:227], v[172:173], v[172:173] op_sel:[0,1,1] op_sel_hi:[1,1,1]
    v_pk_fma_f32 v[228:229], v[228:229], v[172:173], v[172:173] op_sel:[0,1,1] op_sel_hi:[1,1,1]
    v_rcp_f32 v226, v226
    v_rcp_f32 v227, v227
    v_rcp_f32 v228, v228
    v_rcp_f32 v229, v229
    v_pk_mul_f32 v[104:105], v[104:105], v[226:227]
    v_pk_mul_f32 v[106:107], v[106:107], v[228:229]
    v_cvt_pk_bf16_f32 v220, v104, v105
    v_cvt_pk_bf16_f32 v221, v106, v107
    v_or_b32 v220, 1, v220
    s_add_u32 s36, s45, 458752
    buffer_store_dwordx4 v[88:91], v2, s[16:19], s36 offen sc1
    v_pk_fma_f32 v[132:133], v[176:177], v[160:161], v[132:133] op_sel_hi:[0,1,1] neg_lo:[1,0,0] neg_hi:[1,0,0]
    v_pk_fma_f32 v[134:135], v[176:177], v[162:163], v[134:135] op_sel_hi:[0,1,1] neg_lo:[1,0,0] neg_hi:[1,0,0]
    v_pk_mul_f32 v[226:227], v[132:133], v[132:133]
    v_pk_mul_f32 v[228:229], v[134:135], v[134:135]
    v_pk_fma_f32 v[226:227], v[226:227], v[178:179], v[178:179] op_sel:[0,1,0] op_sel_hi:[1,1,0]
    v_pk_fma_f32 v[228:229], v[228:229], v[178:179], v[178:179] op_sel:[0,1,0] op_sel_hi:[1,1,0]
    v_pk_mul_f32 v[226:227], v[226:227], v[132:133]
    v_pk_mul_f32 v[228:229], v[228:229], v[134:135]
    v_exp_f32 v226, v226
    v_exp_f32 v227, v227
    v_exp_f32 v228, v228
    v_exp_f32 v229, v229
    v_pk_fma_f32 v[226:227], v[226:227], v[176:177], v[176:177] op_sel:[0,1,1] op_sel_hi:[1,1,1]
    v_pk_fma_f32 v[228:229], v[228:229], v[176:177], v[176:177] op_sel:[0,1,1] op_sel_hi:[1,1,1]
    v_rcp_f32 v226, v226
    v_rcp_f32 v227, v227
    v_rcp_f32 v228, v228
    v_rcp_f32 v229, v229
    v_pk_mul_f32 v[132:133], v[132:133], v[226:227]
    v_pk_mul_f32 v[134:135], v[134:135], v[228:229]
    v_cvt_pk_bf16_f32 v222, v132, v133
    v_cvt_pk_bf16_f32 v223, v134, v135
    s_add_u32 s36, s45, 688128
    buffer_store_dwordx4 v[116:119], v2, s[16:19], s36 offen sc1
    s_waitcnt lgkmcnt(0)
    s_mov_b32 s44, s46
    s_mov_b32 s45, s47
    s_branch G3_e2
G3_e1:
    v_pk_fma_f32 v[28:29], v[164:165], v[140:141], v[28:29] op_sel_hi:[0,1,1] neg_lo:[1,0,0] neg_hi:[1,0,0]
    v_pk_fma_f32 v[30:31], v[164:165], v[142:143], v[30:31] op_sel_hi:[0,1,1] neg_lo:[1,0,0] neg_hi:[1,0,0]
    v_pk_mul_f32 v[226:227], v[28:29], v[28:29]
    v_pk_mul_f32 v[228:229], v[30:31], v[30:31]
    v_pk_fma_f32 v[226:227], v[226:227], v[166:167], v[166:167] op_sel:[0,1,0] op_sel_hi:[1,1,0]
    v_pk_fma_f32 v[228:229], v[228:229], v[166:167], v[166:167] op_sel:[0,1,0] op_sel_hi:[1,1,0]
    v_pk_mul_f32 v[226:227], v[226:227], v[28:29]
    v_pk_mul_f32 v[228:229], v[228:229], v[30:31]
    v_exp_f32 v226, v226
    v_exp_f32 v227, v227
    v_exp_f32 v228, v228
    v_exp_f32 v229, v229
    v_pk_fma_f32 v[226:227], v[226:227], v[164:165], v[164:165] op_sel:[0,1,1] op_sel_hi:[1,1,1]
    v_pk_fma_f32 v[228:229], v[228:229], v[164:165], v[164:165] op_sel:[0,1,1] op_sel_hi:[1,1,1]
    v_rcp_f32 v226, v226
    v_rcp_f32 v227, v227
    v_rcp_f32 v228, v228
    v_rcp_f32 v229, v229
    v_pk_mul_f32 v[28:29], v[28:29], v[226:227]
    v_pk_mul_f32 v[30:31], v[30:31], v[228:229]
    v_pk_fma_f32 v[32:33], v[164:165], v[144:145], v[32:33] op_sel_hi:[0,1,1] neg_lo:[1,0,0] neg_hi:[1,0,0]
    v_pk_fma_f32 v[34:35], v[164:165], v[146:147], v[34:35] op_sel_hi:[0,1,1] neg_lo:[1,0,0] neg_hi:[1,0,0]
    v_pk_mul_f32 v[226:227], v[32:33], v[32:33]
    v_pk_mul_f32 v[228:229], v[34:35], v[34:35]
    v_pk_fma_f32 v[226:227], v[226:227], v[166:167], v[166:167] op_sel:[0,1,0] op_sel_hi:[1,1,0]
    v_pk_fma_f32 v[228:229], v[228:229], v[166:167], v[166:167] op_sel:[0,1,0] op_sel_hi:[1,1,0]
    v_pk_mul_f32 v[226:227], v[226:227], v[32:33]
    v_pk_mul_f32 v[228:229], v[228:229], v[34:35]
    v_exp_f32 v226, v226
    v_exp_f32 v227, v227
    v_exp_f32 v228, v228
    v_exp_f32 v229, v229
    v_pk_fma_f32 v[226:227], v[226:227], v[164:165], v[164:165] op_sel:[0,1,1] op_sel_hi:[1,1,1]
    v_pk_fma_f32 v[228:229], v[228:229], v[164:165], v[164:165] op_sel:[0,1,1] op_sel_hi:[1,1,1]
    v_rcp_f32 v226, v226
    v_rcp_f32 v227, v227
    v_rcp_f32 v228, v228
    v_rcp_f32 v229, v229
    v_pk_mul_f32 v[32:33], v[32:33], v[226:227]
    v_pk_mul_f32 v[34:35], v[34:35], v[228:229]
    v_cvt_pk_bf16_f32 v28, v28, v29
    v_cvt_pk_bf16_f32 v29, v30, v31
    v_cvt_pk_bf16_f32 v30, v32, v33
    v_cvt_pk_bf16_f32 v31, v34, v35
    v_or_b32 v28, 1, v28
    ds_write_b128 v244, v[28:31] offset:0
    s_add_u32 s36, s45, 0
    buffer_store_dwordx4 v[28:31], v2, s[16:19], s36 offen sc1
    v_pk_fma_f32 v[56:57], v[168:169], v[140:141], v[56:57] op_sel_hi:[0,1,1] neg_lo:[1,0,0] neg_hi:[1,0,0]
    v_pk_fma_f32 v[58:59], v[168:169], v[142:143], v[58:59] op_sel_hi:[0,1,1] neg_lo:[1,0,0] neg_hi:[1,0,0]
    v_pk_mul_f32 v[226:227], v[56:57], v[56:57]
    v_pk_mul_f32 v[228:229], v[58:59], v[58:59]
    v_pk_fma_f32 v[226:227], v[226:227], v[170:171], v[170:171] op_sel:[0,1,0] op_sel_hi:[1,1,0]
    v_pk_fma_f32 v[228:229], v[228:229], v[170:171], v[170:171] op_sel:[0,1,0] op_sel_hi:[1,1,0]
    v_pk_mul_f32 v[226:227], v[226:227], v[56:57]
    v_pk_mul_f32 v[228:229], v[228:229], v[58:59]
    v_exp_f32 v226, v226
    v_exp_f32 v227, v227
    v_exp_f32 v228, v228
    v_exp_f32 v229, v229
    v_pk_fma_f32 v[226:227], v[226:227], v[168:169], v[168:169] op_sel:[0,1,1] op_sel_hi:[1,1,1]
    v_pk_fma_f32 v[228:229], v[228:229], v[168:169], v[168:169] op_sel:[0,1,1] op_sel_hi:[1,1,1]
    v_rcp_f32 v226, v226
    v_rcp_f32 v227, v227
    v_rcp_f32 v228, v228
    v_rcp_f32 v229, v229
    v_pk_mul_f32 v[56:57], v[56:57], v[226:227]
    v_pk_mul_f32 v[58:59], v[58:59], v[228:229]
    v_pk_fma_f32 v[60:61], v[168:169], v[144:145], v[60:61] op_sel_hi:[0,1,1] neg_lo:[1,0,0] neg_hi:[1,0,0]
    v_pk_fma_f32 v[62:63], v[168:169], v[146:147], v[62:63] op_sel_hi:[0,1,1] neg_lo:[1,0,0] neg_hi:[1,0,0]
    v_pk_mul_f32 v[226:227], v[60:61], v[60:61]
    v_pk_mul_f32 v[228:229], v[62:63], v[62:63]
    v_pk_fma_f32 v[226:227], v[226:227], v[170:171], v[170:171] op_sel:[0,1,0] op_sel_hi:[1,1,0]
    v_pk_fma_f32 v[228:229], v[228:229], v[170:171], v[170:171] op_sel:[0,1,0] op_sel_hi:[1,1,0]
    v_pk_mul_f32 v[226:227], v[226:227], v[60:61]
    v_pk_mul_f32 v[228:229], v[228:229], v[62:63]
    v_exp_f32 v226, v226
    v_exp_f32 v227, v227
    v_exp_f32 v228, v228
    v_exp_f32 v229, v229
    v_pk_fma_f32 v[226:227], v[226:227], v[168:169], v[168:169] op_sel:[0,1,1] op_sel_hi:[1,1,1]
    v_pk_fma_f32 v[228:229], v[228:229], v[168:169], v[168:169] op_sel:[0,1,1] op_sel_hi:[1,1,1]
    v_rcp_f32 v226, v226
    v_rcp_f32 v227, v227
    v_rcp_f32 v228, v228
    v_rcp_f32 v229, v229
    v_pk_mul_f32 v[60:61], v[60:61], v[226:227]
    v_pk_mul_f32 v[62:63], v[62:63], v[228:229]
    v_cvt_pk_bf16_f32 v56, v56, v57
    v_cvt_pk_bf16_f32 v57, v58, v59
    v_cvt_pk_bf16_f32 v58, v60, v61
    v_cvt_pk_bf16_f32 v59, v62, v63
    v_or_b32 v56, 1, v56
    ds_write_b128 v244, v[56:59] offset:2048
    s_add_u32 s36, s45, 229376
    buffer_store_dwordx4 v[56:59], v2, s[16:19], s36 offen sc1
    v_pk_fma_f32 v[84:85], v[172:173], v[140:141], v[84:85] op_sel_hi:[0,1,1] neg_lo:[1,0,0] neg_hi:[1,0,0]
    v_pk_fma_f32 v[86:87], v[172:173], v[142:143], v[86:87] op_sel_hi:[0,1,1] neg_lo:[1,0,0] neg_hi:[1,0,0]
    v_pk_mul_f32 v[226:227], v[84:85], v[84:85]
    v_pk_mul_f32 v[228:229], v[86:87], v[86:87]
    v_pk_fma_f32 v[226:227], v[226:227], v[174:175], v[174:175] op_sel:[0,1,0] op_sel_hi:[1,1,0]
    v_pk_fma_f32 v[228:229], v[228:229], v[174:175], v[174:175] op_sel:[0,1,0] op_sel_hi:[1,1,0]
    v_pk_mul_f32 v[226:227], v[226:227], v[84:85]
    v_pk_mul_f32 v[228:229], v[228:229], v[86:87]
    v_exp_f32 v226, v226
    v_exp_f32 v227, v227
    v_exp_f32 v228, v228
    v_exp_f32 v229, v229
    v_pk_fma_f32 v[226:227], v[226:227], v[172:173], v[172:173] op_sel:[0,1,1] op_sel_hi:[1,1,1]
    v_pk_fma_f32 v[228:229], v[228:229], v[172:173], v[172:173] op_sel:[0,1,1] op_sel_hi:[1,1,1]
    v_rcp_f32 v226, v226
    v_rcp_f32 v227, v227
    v_rcp_f32 v228, v228
    v_rcp_f32 v229, v229
    v_pk_mul_f32 v[84:85], v[84:85], v[226:227]
    v_pk_mul_f32 v[86:87], v[86:87], v[228:229]
    v_pk_fma_f32 v[88:89], v[172:173], v[144:145], v[88:89] op_sel_hi:[0,1,1] neg_lo:[1,0,0] neg_hi:[1,0,0]
    v_pk_fma_f32 v[90:91], v[172:173], v[146:147], v[90:91] op_sel_hi:[0,1,1] neg_lo:[1,0,0] neg_hi:[1,0,0]
    v_pk_mul_f32 v[226:227], v[88:89], v[88:89]
    v_pk_mul_f32 v[228:229], v[90:91], v[90:91]
    v_pk_fma_f32 v[226:227], v[226:227], v[174:175], v[174:175] op_sel:[0,1,0] op_sel_hi:[1,1,0]
    v_pk_fma_f32 v[228:229], v[228:229], v[174:175], v[174:175] op_sel:[0,1,0] op_sel_hi:[1,1,0]
    v_pk_mul_f32 v[226:227], v[226:227], v[88:89]
    v_pk_mul_f32 v[228:229], v[228:229], v[90:91]
    v_exp_f32 v226, v226
    v_exp_f32 v227, v227
    v_exp_f32 v228, v228
    v_exp_f32 v229, v229
    v_pk_fma_f32 v[226:227], v[226:227], v[172:173], v[172:173] op_sel:[0,1,1] op_sel_hi:[1,1,1]
    v_pk_fma_f32 v[228:229], v[228:229], v[172:173], v[172:173] op_sel:[0,1,1] op_sel_hi:[1,1,1]
    v_rcp_f32 v226, v226
    v_rcp_f32 v227, v227
    v_rcp_f32 v228, v228
    v_rcp_f32 v229, v229
    v_pk_mul_f32 v[88:89], v[88:89], v[226:227]
    v_pk_mul_f32 v[90:91], v[90:91], v[228:229]
    v_cvt_pk_bf16_f32 v84, v84, v85
    v_cvt_pk_bf16_f32 v85, v86, v87
    v_cvt_pk_bf16_f32 v86, v88, v89
    v_cvt_pk_bf16_f32 v87, v90, v91
    v_or_b32 v84, 1, v84
    ds_write_b128 v244, v[84:87] offset:4096
    s_add_u32 s36, s45, 458752
    buffer_store_dwordx4 v[84:87], v2, s[16:19], s36 offen sc1
    v_pk_fma_f32 v[112:113], v[176:177], v[140:141], v[112:113] op_sel_hi:[0,1,1] neg_lo:[1,0,0] neg_hi:[1,0,0]
    v_pk_fma_f32 v[114:115], v[176:177], v[142:143], v[114:115] op_sel_hi:[0,1,1] neg_lo:[1,0,0] neg_hi:[1,0,0]
    v_pk_mul_f32 v[226:227], v[112:113], v[112:113]
    v_pk_mul_f32 v[228:229], v[114:115], v[114:115]
    v_pk_fma_f32 v[226:227], v[226:227], v[178:179], v[178:179] op_sel:[0,1,0] op_sel_hi:[1,1,0]
    v_pk_fma_f32 v[228:229], v[228:229], v[178:179], v[178:179] op_sel:[0,1,0] op_sel_hi:[1,1,0]
    v_pk_mul_f32 v[226:227], v[226:227], v[112:113]
    v_pk_mul_f32 v[228:229], v[228:229], v[114:115]
    v_exp_f32 v226, v226
    v_exp_f32 v227, v227
    v_exp_f32 v228, v228
    v_exp_f32 v229, v229
    v_pk_fma_f32 v[226:227], v[226:227], v[176:177], v[176:177] op_sel:[0,1,1] op_sel_hi:[1,1,1]
    v_pk_fma_f32 v[228:229], v[228:229], v[176:177], v[176:177] op_sel:[0,1,1] op_sel_hi:[1,1,1]
    v_rcp_f32 v226, v226
    v_rcp_f32 v227, v227
    v_rcp_f32 v228, v228
    v_rcp_f32 v229, v229
    v_pk_mul_f32 v[112:113], v[112:113], v[226:227]
    v_pk_mul_f32 v[114:115], v[114:115], v[228:229]
    v_pk_fma_f32 v[116:117], v[176:177], v[144:145], v[116:117] op_sel_hi:[0,1,1] neg_lo:[1,0,0] neg_hi:[1,0,0]
    v_pk_fma_f32 v[118:119], v[176:177], v[146:147], v[118:119] op_sel_hi:[0,1,1] neg_lo:[1,0,0] neg_hi:[1,0,0]
    v_pk_mul_f32 v[226:227], v[116:117], v[116:117]
    v_pk_mul_f32 v[228:229], v[118:119], v[118:119]
    v_pk_fma_f32 v[226:227], v[226:227], v[178:179], v[178:179] op_sel:[0,1,0] op_sel_hi:[1,1,0]
    v_pk_fma_f32 v[228:229], v[228:229], v[178:179], v[178:179] op_sel:[0,1,0] op_sel_hi:[1,1,0]
    v_pk_mul_f32 v[226:227], v[226:227], v[116:117]
    v_pk_mul_f32 v[228:229], v[228:229], v[118:119]
    v_exp_f32 v226, v226
    v_exp_f32 v227, v227
    v_exp_f32 v228, v228
    v_exp_f32 v229, v229
    v_pk_fma_f32 v[226:227], v[226:227], v[176:177], v[176:177] op_sel:[0,1,1] op_sel_hi:[1,1,1]
    v_pk_fma_f32 v[228:229], v[228:229], v[176:177], v[176:177] op_sel:[0,1,1] op_sel_hi:[1,1,1]
    v_rcp_f32 v226, v226
    v_rcp_f32 v227, v227
    v_rcp_f32 v228, v228
    v_rcp_f32 v229, v229
    v_pk_mul_f32 v[116:117], v[116:117], v[226:227]
    v_pk_mul_f32 v[118:119], v[118:119], v[228:229]
    v_cvt_pk_bf16_f32 v112, v112, v113
    v_cvt_pk_bf16_f32 v113, v114, v115
    v_cvt_pk_bf16_f32 v114, v116, v117
    v_cvt_pk_bf16_f32 v115, v118, v119
    ds_write_b128 v244, v[112:115] offset:6144
    s_add_u32 s36, s45, 688128
    buffer_store_dwordx4 v[112:115], v2, s[16:19], s36 offen sc1
    v_pk_fma_f32 v[36:37], v[164:165], v[148:149], v[36:37] op_sel_hi:[0,1,1] neg_lo:[1,0,0] neg_hi:[1,0,0]
    v_pk_fma_f32 v[38:39], v[164:165], v[150:151], v[38:39] op_sel_hi:[0,1,1] neg_lo:[1,0,0] neg_hi:[1,0,0]
    v_pk_mul_f32 v[226:227], v[36:37], v[36:37]
    v_pk_mul_f32 v[228:229], v[38:39], v[38:39]
    v_pk_fma_f32 v[226:227], v[226:227], v[166:167], v[166:167] op_sel:[0,1,0] op_sel_hi:[1,1,0]
    v_pk_fma_f32 v[228:229], v[228:229], v[166:167], v[166:167] op_sel:[0,1,0] op_sel_hi:[1,1,0]
    v_pk_mul_f32 v[226:227], v[226:227], v[36:37]
    v_pk_mul_f32 v[228:229], v[228:229], v[38:39]
    v_exp_f32 v226, v226
    v_exp_f32 v227, v227
    v_exp_f32 v228, v228
    v_exp_f32 v229, v229
    v_pk_fma_f32 v[226:227], v[226:227], v[164:165], v[164:165] op_sel:[0,1,1] op_sel_hi:[1,1,1]
    v_pk_fma_f32 v[228:229], v[228:229], v[164:165], v[164:165] op_sel:[0,1,1] op_sel_hi:[1,1,1]
    v_rcp_f32 v226, v226
    v_rcp_f32 v227, v227
    v_rcp_f32 v228, v228
    v_rcp_f32 v229, v229
    v_pk_mul_f32 v[36:37], v[36:37], v[226:227]
    v_pk_mul_f32 v[38:39], v[38:39], v[228:229]
    v_pk_fma_f32 v[40:41], v[164:165], v[152:153], v[40:41] op_sel_hi:[0,1,1] neg_lo:[1,0,0] neg_hi:[1,0,0]
    v_pk_fma_f32 v[42:43], v[164:165], v[154:155], v[42:43] op_sel_hi:[0,1,1] neg_lo:[1,0,0] neg_hi:[1,0,0]
    v_pk_mul_f32 v[226:227], v[40:41], v[40:41]
    v_pk_mul_f32 v[228:229], v[42:43], v[42:43]
    v_pk_fma_f32 v[226:227], v[226:227], v[166:167], v[166:167] op_sel:[0,1,0] op_sel_hi:[1,1,0]
    v_pk_fma_f32 v[228:229], v[228:229], v[166:167], v[166:167] op_sel:[0,1,0] op_sel_hi:[1,1,0]
    v_pk_mul_f32 v[226:227], v[226:227], v[40:41]
    v_pk_mul_f32 v[228:229], v[228:229], v[42:43]
    v_exp_f32 v226, v226
    v_exp_f32 v227, v227
    v_exp_f32 v228, v228
    v_exp_f32 v229, v229
    v_pk_fma_f32 v[226:227], v[226:227], v[164:165], v[164:165] op_sel:[0,1,1] op_sel_hi:[1,1,1]
    v_pk_fma_f32 v[228:229], v[228:229], v[164:165], v[164:165] op_sel:[0,1,1] op_sel_hi:[1,1,1]
    v_rcp_f32 v226, v226
    v_rcp_f32 v227, v227
    v_rcp_f32 v228, v228
    v_rcp_f32 v229, v229
    v_pk_mul_f32 v[40:41], v[40:41], v[226:227]
    v_pk_mul_f32 v[42:43], v[42:43], v[228:229]
    v_cvt_pk_bf16_f32 v36, v36, v37
    v_cvt_pk_bf16_f32 v37, v38, v39
    v_cvt_pk_bf16_f32 v38, v40, v41
    v_cvt_pk_bf16_f32 v39, v42, v43
    v_or_b32 v36, 1, v36
    ds_write_b128 v244, v[36:39] offset:16384
    v_pk_fma_f32 v[64:65], v[168:169], v[148:149], v[64:65] op_sel_hi:[0,1,1] neg_lo:[1,0,0] neg_hi:[1,0,0]
    v_pk_fma_f32 v[66:67], v[168:169], v[150:151], v[66:67] op_sel_hi:[0,1,1] neg_lo:[1,0,0] neg_hi:[1,0,0]
    v_pk_mul_f32 v[226:227], v[64:65], v[64:65]
    v_pk_mul_f32 v[228:229], v[66:67], v[66:67]
    v_pk_fma_f32 v[226:227], v[226:227], v[170:171], v[170:171] op_sel:[0,1,0] op_sel_hi:[1,1,0]
    v_pk_fma_f32 v[228:229], v[228:229], v[170:171], v[170:171] op_sel:[0,1,0] op_sel_hi:[1,1,0]
    v_pk_mul_f32 v[226:227], v[226:227], v[64:65]
    v_pk_mul_f32 v[228:229], v[228:229], v[66:67]
    v_exp_f32 v226, v226
    v_exp_f32 v227, v227
    v_exp_f32 v228, v228
    v_exp_f32 v229, v229
    v_pk_fma_f32 v[226:227], v[226:227], v[168:169], v[168:169] op_sel:[0,1,1] op_sel_hi:[1,1,1]
    v_pk_fma_f32 v[228:229], v[228:229], v[168:169], v[168:169] op_sel:[0,1,1] op_sel_hi:[1,1,1]
    v_rcp_f32 v226, v226
    v_rcp_f32 v227, v227
    v_rcp_f32 v228, v228
    v_rcp_f32 v229, v229
    v_pk_mul_f32 v[64:65], v[64:65], v[226:227]
    v_pk_mul_f32 v[66:67], v[66:67], v[228:229]
    v_pk_fma_f32 v[68:69], v[168:169], v[152:153], v[68:69] op_sel_hi:[0,1,1] neg_lo:[1,0,0] neg_hi:[1,0,0]
    v_pk_fma_f32 v[70:71], v[168:169], v[154:155], v[70:71] op_sel_hi:[0,1,1] neg_lo:[1,0,0] neg_hi:[1,0,0]
    v_pk_mul_f32 v[226:227], v[68:69], v[68:69]
    v_pk_mul_f32 v[228:229], v[70:71], v[70:71]
    v_pk_fma_f32 v[226:227], v[226:227], v[170:171], v[170:171] op_sel:[0,1,0] op_sel_hi:[1,1,0]
    v_pk_fma_f32 v[228:229], v[228:229], v[170:171], v[170:171] op_sel:[0,1,0] op_sel_hi:[1,1,0]
    v_pk_mul_f32 v[226:227], v[226:227], v[68:69]
    v_pk_mul_f32 v[228:229], v[228:229], v[70:71]
    v_exp_f32 v226, v226
    v_exp_f32 v227, v227
    v_exp_f32 v228, v228
    v_exp_f32 v229, v229
    v_pk_fma_f32 v[226:227], v[226:227], v[168:169], v[168:169] op_sel:[0,1,1] op_sel_hi:[1,1,1]
    v_pk_fma_f32 v[228:229], v[228:229], v[168:169], v[168:169] op_sel:[0,1,1] op_sel_hi:[1,1,1]
    v_rcp_f32 v226, v226
    v_rcp_f32 v227, v227
    v_rcp_f32 v228, v228
    v_rcp_f32 v229, v229
    v_pk_mul_f32 v[68:69], v[68:69], v[226:227]
    v_pk_mul_f32 v[70:71], v[70:71], v[228:229]
    v_cvt_pk_bf16_f32 v64, v64, v65
    v_cvt_pk_bf16_f32 v65, v66, v67
    v_cvt_pk_bf16_f32 v66, v68, v69
    v_cvt_pk_bf16_f32 v67, v70, v71
    v_or_b32 v64, 1, v64
    ds_write_b128 v244, v[64:67] offset:18432
    s_waitcnt vmcnt(0)
    s_mov_b64 exec, 1
    ds_add_u32 v246, v245
    s_mov_b64 exec, -1
    v_pk_fma_f32 v[92:93], v[172:173], v[148:149], v[92:93] op_sel_hi:[0,1,1] neg_lo:[1,0,0] neg_hi:[1,0,0]
    v_pk_fma_f32 v[94:95], v[172:173], v[150:151], v[94:95] op_sel_hi:[0,1,1] neg_lo:[1,0,0] neg_hi:[1,0,0]
    v_pk_mul_f32 v[226:227], v[92:93], v[92:93]
    v_pk_mul_f32 v[228:229], v[94:95], v[94:95]
    v_pk_fma_f32 v[226:227], v[226:227], v[174:175], v[174:175] op_sel:[0,1,0] op_sel_hi:[1,1,0]
    v_pk_fma_f32 v[228:229], v[228:229], v[174:175], v[174:175] op_sel:[0,1,0] op_sel_hi:[1,1,0]
    v_pk_mul_f32 v[226:227], v[226:227], v[92:93]
    v_pk_mul_f32 v[228:229], v[228:229], v[94:95]
    v_exp_f32 v226, v226
    v_exp_f32 v227, v227
    v_exp_f32 v228, v228
    v_exp_f32 v229, v229
    v_pk_fma_f32 v[226:227], v[226:227], v[172:173], v[172:173] op_sel:[0,1,1] op_sel_hi:[1,1,1]
    v_pk_fma_f32 v[228:229], v[228:229], v[172:173], v[172:173] op_sel:[0,1,1] op_sel_hi:[1,1,1]
    v_rcp_f32 v226, v226
    v_rcp_f32 v227, v227
    v_rcp_f32 v228, v228
    v_rcp_f32 v229, v229
    v_pk_mul_f32 v[92:93], v[92:93], v[226:227]
    v_pk_mul_f32 v[94:95], v[94:95], v[228:229]
    v_pk_fma_f32 v[96:97], v[172:173], v[152:153], v[96:97] op_sel_hi:[0,1,1] neg_lo:[1,0,0] neg_hi:[1,0,0]
    v_pk_fma_f32 v[98:99], v[172:173], v[154:155], v[98:99] op_sel_hi:[0,1,1] neg_lo:[1,0,0] neg_hi:[1,0,0]
    v_pk_mul_f32 v[226:227], v[96:97], v[96:97]
    v_pk_mul_f32 v[228:229], v[98:99], v[98:99]
    v_pk_fma_f32 v[226:227], v[226:227], v[174:175], v[174:175] op_sel:[0,1,0] op_sel_hi:[1,1,0]
    v_pk_fma_f32 v[228:229], v[228:229], v[174:175], v[174:175] op_sel:[0,1,0] op_sel_hi:[1,1,0]
    v_pk_mul_f32 v[226:227], v[226:227], v[96:97]
    v_pk_mul_f32 v[228:229], v[228:229], v[98:99]
    v_exp_f32 v226, v226
    v_exp_f32 v227, v227
    v_exp_f32 v228, v228
    v_exp_f32 v229, v229
    v_pk_fma_f32 v[226:227], v[226:227], v[172:173], v[172:173] op_sel:[0,1,1] op_sel_hi:[1,1,1]
    v_pk_fma_f32 v[228:229], v[228:229], v[172:173], v[172:173] op_sel:[0,1,1] op_sel_hi:[1,1,1]
    v_rcp_f32 v226, v226
    v_rcp_f32 v227, v227
    v_rcp_f32 v228, v228
    v_rcp_f32 v229, v229
    v_pk_mul_f32 v[96:97], v[96:97], v[226:227]
    v_pk_mul_f32 v[98:99], v[98:99], v[228:229]
    v_cvt_pk_bf16_f32 v92, v92, v93
    v_cvt_pk_bf16_f32 v93, v94, v95
    v_cvt_pk_bf16_f32 v94, v96, v97
    v_cvt_pk_bf16_f32 v95, v98, v99
    v_or_b32 v92, 1, v92
    ds_write_b128 v244, v[92:95] offset:20480
    s_cmp_eq_u32 s60, 1
    s_cbranch_scc1 G4_p11
    buffer_load_dwordx4 v[180:183], v196, s[84:87], 0 offen offset:0 sc1
    buffer_load_dwordx4 v[188:191], v196, s[88:91], 0 offen offset:0 sc1
    buffer_load_dwordx4 v[184:187], v196, s[84:87], 0 offen offset:2048 sc1
    buffer_load_dwordx4 v[192:195], v196, s[88:91], 0 offen offset:2048 sc1
    s_branch G4_p21
G4_p11:
    s_add_u32 s36, s40, 0
    buffer_load_dwordx4 v[180:183], v2, s[84:87], s36 offen offset:0 sc1
    buffer_load_dwordx4 v[184:187], v2, s[88:91], s36 offen offset:0 sc1
    buffer_load_dwordx4 v[188:191], v2, s[84:87], s36 offen offset:1024 sc1
    buffer_load_dwordx4 v[192:195], v2, s[88:91], s36 offen offset:1024 sc1
    s_add_u32 s36, s40, 65536
    buffer_load_dwordx4 v[196:199], v2, s[84:87], s36 offen offset:0 sc1
    buffer_load_dwordx4 v[230:233], v2, s[88:91], s36 offen offset:0 sc1
    buffer_load_dwordx4 v[234:237], v2, s[84:87], s36 offen offset:1024 sc1
    buffer_load_dwordx4 v[248:251], v2, s[88:91], s36 offen offset:1024 sc1
G4_p21:
    v_pk_fma_f32 v[120:121], v[176:177], v[148:149], v[120:121] op_sel_hi:[0,1,1] neg_lo:[1,0,0] neg_hi:[1,0,0]
    v_pk_fma_f32 v[122:123], v[176:177], v[150:151], v[122:123] op_sel_hi:[0,1,1] neg_lo:[1,0,0] neg_hi:[1,0,0]
    v_pk_mul_f32 v[226:227], v[120:121], v[120:121]
    v_pk_mul_f32 v[228:229], v[122:123], v[122:123]
    v_pk_fma_f32 v[226:227], v[226:227], v[178:179], v[178:179] op_sel:[0,1,0] op_sel_hi:[1,1,0]
    v_pk_fma_f32 v[228:229], v[228:229], v[178:179], v[178:179] op_sel:[0,1,0] op_sel_hi:[1,1,0]
    v_pk_mul_f32 v[226:227], v[226:227], v[120:121]
    v_pk_mul_f32 v[228:229], v[228:229], v[122:123]
    v_exp_f32 v226, v226
    v_exp_f32 v227, v227
    v_exp_f32 v228, v228
    v_exp_f32 v229, v229
    v_pk_fma_f32 v[226:227], v[226:227], v[176:177], v[176:177] op_sel:[0,1,1] op_sel_hi:[1,1,1]
    v_pk_fma_f32 v[228:229], v[228:229], v[176:177], v[176:177] op_sel:[0,1,1] op_sel_hi:[1,1,1]
    v_rcp_f32 v226, v226
    v_rcp_f32 v227, v227
    v_rcp_f32 v228, v228
    v_rcp_f32 v229, v229
    v_pk_mul_f32 v[120:121], v[120:121], v[226:227]
    v_pk_mul_f32 v[122:123], v[122:123], v[228:229]
    v_pk_fma_f32 v[124:125], v[176:177], v[152:153], v[124:125] op_sel_hi:[0,1,1] neg_lo:[1,0,0] neg_hi:[1,0,0]
    v_pk_fma_f32 v[126:127], v[176:177], v[154:155], v[126:127] op_sel_hi:[0,1,1] neg_lo:[1,0,0] neg_hi:[1,0,0]
    v_pk_mul_f32 v[226:227], v[124:125], v[124:125]
    v_pk_mul_f32 v[228:229], v[126:127], v[126:127]
    v_pk_fma_f32 v[226:227], v[226:227], v[178:179], v[178:179] op_sel:[0,1,0] op_sel_hi:[1,1,0]
    v_pk_fma_f32 v[228:229], v[228:229], v[178:179], v[178:179] op_sel:[0,1,0] op_sel_hi:[1,1,0]
    v_pk_mul_f32 v[226:227], v[226:227], v[124:125]
    v_pk_mul_f32 v[228:229], v[228:229], v[126:127]
    v_exp_f32 v226, v226
    v_exp_f32 v227, v227
    v_exp_f32 v228, v228
    v_exp_f32 v229, v229
    v_pk_fma_f32 v[226:227], v[226:227], v[176:177], v[176:177] op_sel:[0,1,1] op_sel_hi:[1,1,1]
    v_pk_fma_f32 v[228:229], v[228:229], v[176:177], v[176:177] op_sel:[0,1,1] op_sel_hi:[1,1,1]
    v_rcp_f32 v226, v226
    v_rcp_f32 v227, v227
    v_rcp_f32 v228, v228
    v_rcp_f32 v229, v229
    v_pk_mul_f32 v[124:125], v[124:125], v[226:227]
    v_pk_mul_f32 v[126:127], v[126:127], v[228:229]
    v_cvt_pk_bf16_f32 v120, v120, v121
    v_cvt_pk_bf16_f32 v121, v122, v123
    v_cvt_pk_bf16_f32 v122, v124, v125
    v_cvt_pk_bf16_f32 v123, v126, v127
    ds_write_b128 v244, v[120:123] offset:22528
    v_pk_fma_f32 v[44:45], v[164:165], v[156:157], v[44:45] op_sel_hi:[0,1,1] neg_lo:[1,0,0] neg_hi:[1,0,0]
    v_pk_fma_f32 v[46:47], v[164:165], v[158:159], v[46:47] op_sel_hi:[0,1,1] neg_lo:[1,0,0] neg_hi:[1,0,0]
    v_pk_mul_f32 v[226:227], v[44:45], v[44:45]
    v_pk_mul_f32 v[228:229], v[46:47], v[46:47]
    v_pk_fma_f32 v[226:227], v[226:227], v[166:167], v[166:167] op_sel:[0,1,0] op_sel_hi:[1,1,0]
    v_pk_fma_f32 v[228:229], v[228:229], v[166:167], v[166:167] op_sel:[0,1,0] op_sel_hi:[1,1,0]
    v_pk_mul_f32 v[226:227], v[226:227], v[44:45]
    v_pk_mul_f32 v[228:229], v[228:229], v[46:47]
    v_exp_f32 v226, v226
    v_exp_f32 v227, v227
    v_exp_f32 v228, v228
    v_exp_f32 v229, v229
    v_pk_fma_f32 v[226:227], v[226:227], v[164:165], v[164:165] op_sel:[0,1,1] op_sel_hi:[1,1,1]
    v_pk_fma_f32 v[228:229], v[228:229], v[164:165], v[164:165] op_sel:[0,1,1] op_sel_hi:[1,1,1]
    v_rcp_f32 v226, v226
    v_rcp_f32 v227, v227
    v_rcp_f32 v228, v228
    v_rcp_f32 v229, v229
    v_pk_mul_f32 v[44:45], v[44:45], v[226:227]
    v_pk_mul_f32 v[46:47], v[46:47], v[228:229]
    v_pk_fma_f32 v[48:49], v[164:165], v[160:161], v[48:49] op_sel_hi:[0,1,1] neg_lo:[1,0,0] neg_hi:[1,0,0]
    v_pk_fma_f32 v[50:51], v[164:165], v[162:163], v[50:51] op_sel_hi:[0,1,1] neg_lo:[1,0,0] neg_hi:[1,0,0]
    v_pk_mul_f32 v[226:227], v[48:49], v[48:49]
    v_pk_mul_f32 v[228:229], v[50:51], v[50:51]
    v_pk_fma_f32 v[226:227], v[226:227], v[166:167], v[166:167] op_sel:[0,1,0] op_sel_hi:[1,1,0]
    v_pk_fma_f32 v[228:229], v[228:229], v[166:167], v[166:167] op_sel:[0,1,0] op_sel_hi:[1,1,0]
    v_pk_mul_f32 v[226:227], v[226:227], v[48:49]
    v_pk_mul_f32 v[228:229], v[228:229], v[50:51]
    v_exp_f32 v226, v226
    v_exp_f32 v227, v227
    v_exp_f32 v228, v228
    v_exp_f32 v229, v229
    v_pk_fma_f32 v[226:227], v[226:227], v[164:165], v[164:165] op_sel:[0,1,1] op_sel_hi:[1,1,1]
    v_pk_fma_f32 v[228:229], v[228:229], v[164:165], v[164:165] op_sel:[0,1,1] op_sel_hi:[1,1,1]
    v_rcp_f32 v226, v226
    v_rcp_f32 v227, v227
    v_rcp_f32 v228, v228
    v_rcp_f32 v229, v229
    v_pk_mul_f32 v[48:49], v[48:49], v[226:227]
    v_pk_mul_f32 v[50:51], v[50:51], v[228:229]
    v_cvt_pk_bf16_f32 v200, v44, v45
    v_cvt_pk_bf16_f32 v201, v46, v47
    v_cvt_pk_bf16_f32 v202, v48, v49
    v_cvt_pk_bf16_f32 v203, v50, v51
    v_or_b32 v200, 1, v200
    ds_write_b128 v244, v[200:203] offset:32768
    v_pk_fma_f32 v[72:73], v[168:169], v[156:157], v[72:73] op_sel_hi:[0,1,1] neg_lo:[1,0,0] neg_hi:[1,0,0]
    v_pk_fma_f32 v[74:75], v[168:169], v[158:159], v[74:75] op_sel_hi:[0,1,1] neg_lo:[1,0,0] neg_hi:[1,0,0]
    v_pk_mul_f32 v[226:227], v[72:73], v[72:73]
    v_pk_mul_f32 v[228:229], v[74:75], v[74:75]
    v_pk_fma_f32 v[226:227], v[226:227], v[170:171], v[170:171] op_sel:[0,1,0] op_sel_hi:[1,1,0]
    v_pk_fma_f32 v[228:229], v[228:229], v[170:171], v[170:171] op_sel:[0,1,0] op_sel_hi:[1,1,0]
    v_pk_mul_f32 v[226:227], v[226:227], v[72:73]
    v_pk_mul_f32 v[228:229], v[228:229], v[74:75]
    v_exp_f32 v226, v226
    v_exp_f32 v227, v227
    v_exp_f32 v228, v228
    v_exp_f32 v229, v229
    v_pk_fma_f32 v[226:227], v[226:227], v[168:169], v[168:169] op_sel:[0,1,1] op_sel_hi:[1,1,1]
    v_pk_fma_f32 v[228:229], v[228:229], v[168:169], v[168:169] op_sel:[0,1,1] op_sel_hi:[1,1,1]
    v_rcp_f32 v226, v226
    v_rcp_f32 v227, v227
    v_rcp_f32 v228, v228
    v_rcp_f32 v229, v229
    v_pk_mul_f32 v[72:73], v[72:73], v[226:227]
    v_pk_mul_f32 v[74:75], v[74:75], v[228:229]
    v_pk_fma_f32 v[76:77], v[168:169], v[160:161], v[76:77] op_sel_hi:[0,1,1] neg_lo:[1,0,0] neg_hi:[1,0,0]
    v_pk_fma_f32 v[78:79], v[168:169], v[162:163], v[78:79] op_sel_hi:[0,1,1] neg_lo:[1,0,0] neg_hi:[1,0,0]
    v_pk_mul_f32 v[226:227], v[76:77], v[76:77]
    v_pk_mul_f32 v[228:229], v[78:79], v[78:79]
    v_pk_fma_f32 v[226:227], v[226:227], v[170:171], v[170:171] op_sel:[0,1,0] op_sel_hi:[1,1,0]
    v_pk_fma_f32 v[228:229], v[228:229], v[170:171], v[170:171] op_sel:[0,1,0] op_sel_hi:[1,1,0]
    v_pk_mul_f32 v[226:227], v[226:227], v[76:77]
    v_pk_mul_f32 v[228:229], v[228:229], v[78:79]
    v_exp_f32 v226, v226
    v_exp_f32 v227, v227
    v_exp_f32 v228, v228
    v_exp_f32 v229, v229
    v_pk_fma_f32 v[226:227], v[226:227], v[168:169], v[168:169] op_sel:[0,1,1] op_sel_hi:[1,1,1]
    v_pk_fma_f32 v[228:229], v[228:229], v[168:169], v[168:169] op_sel:[0,1,1] op_sel_hi:[1,1,1]
    v_rcp_f32 v226, v226
    v_rcp_f32 v227, v227
    v_rcp_f32 v228, v228
    v_rcp_f32 v229, v229
    v_pk_mul_f32 v[76:77], v[76:77], v[226:227]
    v_pk_mul_f32 v[78:79], v[78:79], v[228:229]
    v_cvt_pk_bf16_f32 v204, v72, v73
    v_cvt_pk_bf16_f32 v205, v74, v75
    v_cvt_pk_bf16_f32 v206, v76, v77
    v_cvt_pk_bf16_f32 v207, v78, v79
    v_or_b32 v204, 1, v204
    ds_write_b128 v244, v[204:207] offset:34816
    v_pk_fma_f32 v[100:101], v[172:173], v[156:157], v[100:101] op_sel_hi:[0,1,1] neg_lo:[1,0,0] neg_hi:[1,0,0]
    v_pk_fma_f32 v[102:103], v[172:173], v[158:159], v[102:103] op_sel_hi:[0,1,1] neg_lo:[1,0,0] neg_hi:[1,0,0]
    v_pk_mul_f32 v[226:227], v[100:101], v[100:101]
    v_pk_mul_f32 v[228:229], v[102:103], v[102:103]
    v_pk_fma_f32 v[226:227], v[226:227], v[174:175], v[174:175] op_sel:[0,1,0] op_sel_hi:[1,1,0]
    v_pk_fma_f32 v[228:229], v[228:229], v[174:175], v[174:175] op_sel:[0,1,0] op_sel_hi:[1,1,0]
    v_pk_mul_f32 v[226:227], v[226:227], v[100:101]
    v_pk_mul_f32 v[228:229], v[228:229], v[102:103]
    v_exp_f32 v226, v226
    v_exp_f32 v227, v227
    v_exp_f32 v228, v228
    v_exp_f32 v229, v229
    v_pk_fma_f32 v[226:227], v[226:227], v[172:173], v[172:173] op_sel:[0,1,1] op_sel_hi:[1,1,1]
    v_pk_fma_f32 v[228:229], v[228:229], v[172:173], v[172:173] op_sel:[0,1,1] op_sel_hi:[1,1,1]
    v_rcp_f32 v226, v226
    v_rcp_f32 v227, v227
    v_rcp_f32 v228, v228
    v_rcp_f32 v229, v229
    v_pk_mul_f32 v[100:101], v[100:101], v[226:227]
    v_pk_mul_f32 v[102:103], v[102:103], v[228:229]
    v_pk_fma_f32 v[104:105], v[172:173], v[160:161], v[104:105] op_sel_hi:[0,1,1] neg_lo:[1,0,0] neg_hi:[1,0,0]
    v_pk_fma_f32 v[106:107], v[172:173], v[162:163], v[106:107] op_sel_hi:[0,1,1] neg_lo:[1,0,0] neg_hi:[1,0,0]
    v_pk_mul_f32 v[226:227], v[104:105], v[104:105]
    v_pk_mul_f32 v[228:229], v[106:107], v[106:107]
    v_pk_fma_f32 v[226:227], v[226:227], v[174:175], v[174:175] op_sel:[0,1,0] op_sel_hi:[1,1,0]
    v_pk_fma_f32 v[228:229], v[228:229], v[174:175], v[174:175] op_sel:[0,1,0] op_sel_hi:[1,1,0]
    v_pk_mul_f32 v[226:227], v[226:227], v[104:105]
    v_pk_mul_f32 v[228:229], v[228:229], v[106:107]
    v_exp_f32 v226, v226
    v_exp_f32 v227, v227
    v_exp_f32 v228, v228
    v_exp_f32 v229, v229
    v_pk_fma_f32 v[226:227], v[226:227], v[172:173], v[172:173] op_sel:[0,1,1] op_sel_hi:[1,1,1]
    v_pk_fma_f32 v[228:229], v[228:229], v[172:173], v[172:173] op_sel:[0,1,1] op_sel_hi:[1,1,1]
    v_rcp_f32 v226, v226
    v_rcp_f32 v227, v227
    v_rcp_f32 v228, v228
    v_rcp_f32 v229, v229
    v_pk_mul_f32 v[104:105], v[104:105], v[226:227]
    v_pk_mul_f32 v[106:107], v[106:107], v[228:229]
    v_cvt_pk_bf16_f32 v208, v100, v101
    v_cvt_pk_bf16_f32 v209, v102, v103
    v_cvt_pk_bf16_f32 v210, v104, v105
    v_cvt_pk_bf16_f32 v211, v106, v107
    v_or_b32 v208, 1, v208
    ds_write_b128 v244, v[208:211] offset:36864
    v_pk_fma_f32 v[128:129], v[176:177], v[156:157], v[128:129] op_sel_hi:[0,1,1] neg_lo:[1,0,0] neg_hi:[1,0,0]
    v_pk_fma_f32 v[130:131], v[176:177], v[158:159], v[130:131] op_sel_hi:[0,1,1] neg_lo:[1,0,0] neg_hi:[1,0,0]
    v_pk_mul_f32 v[226:227], v[128:129], v[128:129]
    v_pk_mul_f32 v[228:229], v[130:131], v[130:131]
    v_pk_fma_f32 v[226:227], v[226:227], v[178:179], v[178:179] op_sel:[0,1,0] op_sel_hi:[1,1,0]
    v_pk_fma_f32 v[228:229], v[228:229], v[178:179], v[178:179] op_sel:[0,1,0] op_sel_hi:[1,1,0]
    v_pk_mul_f32 v[226:227], v[226:227], v[128:129]
    v_pk_mul_f32 v[228:229], v[228:229], v[130:131]
    v_exp_f32 v226, v226
    v_exp_f32 v227, v227
    v_exp_f32 v228, v228
    v_exp_f32 v229, v229
    v_pk_fma_f32 v[226:227], v[226:227], v[176:177], v[176:177] op_sel:[0,1,1] op_sel_hi:[1,1,1]
    v_pk_fma_f32 v[228:229], v[228:229], v[176:177], v[176:177] op_sel:[0,1,1] op_sel_hi:[1,1,1]
    v_rcp_f32 v226, v226
    v_rcp_f32 v227, v227
    v_rcp_f32 v228, v228
    v_rcp_f32 v229, v229
    v_pk_mul_f32 v[128:129], v[128:129], v[226:227]
    v_pk_mul_f32 v[130:131], v[130:131], v[228:229]
    v_pk_fma_f32 v[132:133], v[176:177], v[160:161], v[132:133] op_sel_hi:[0,1,1] neg_lo:[1,0,0] neg_hi:[1,0,0]
    v_pk_fma_f32 v[134:135], v[176:177], v[162:163], v[134:135] op_sel_hi:[0,1,1] neg_lo:[1,0,0] neg_hi:[1,0,0]
    v_pk_mul_f32 v[226:227], v[132:133], v[132:133]
    v_pk_mul_f32 v[228:229], v[134:135], v[134:135]
    v_pk_fma_f32 v[226:227], v[226:227], v[178:179], v[178:179] op_sel:[0,1,0] op_sel_hi:[1,1,0]
    v_pk_fma_f32 v[228:229], v[228:229], v[178:179], v[178:179] op_sel:[0,1,0] op_sel_hi:[1,1,0]
    v_pk_mul_f32 v[226:227], v[226:227], v[132:133]
    v_pk_mul_f32 v[228:229], v[228:229], v[134:135]
    v_exp_f32 v226, v226
    v_exp_f32 v227, v227
    v_exp_f32 v228, v228
    v_exp_f32 v229, v229
    v_pk_fma_f32 v[226:227], v[226:227], v[176:177], v[176:177] op_sel:[0,1,1] op_sel_hi:[1,1,1]
    v_pk_fma_f32 v[228:229], v[228:229], v[176:177], v[176:177] op_sel:[0,1,1] op_sel_hi:[1,1,1]
    v_rcp_f32 v226, v226
    v_rcp_f32 v227, v227
    v_rcp_f32 v228, v228
    v_rcp_f32 v229, v229
    v_pk_mul_f32 v[132:133], v[132:133], v[226:227]
    v_pk_mul_f32 v[134:135], v[134:135], v[228:229]
    v_cvt_pk_bf16_f32 v212, v128, v129
    v_cvt_pk_bf16_f32 v213, v130, v131
    v_cvt_pk_bf16_f32 v214, v132, v133
    v_cvt_pk_bf16_f32 v215, v134, v135
    ds_write_b128 v244, v[212:215] offset:38912
    v_pk_fma_f32 v[24:25], v[164:165], v[136:137], v[24:25] op_sel_hi:[0,1,1] neg_lo:[1,0,0] neg_hi:[1,0,0]
    v_pk_fma_f32 v[26:27], v[164:165], v[138:139], v[26:27] op_sel_hi:[0,1,1] neg_lo:[1,0,0] neg_hi:[1,0,0]
    v_pk_mul_f32 v[226:227], v[24:25], v[24:25]
    v_pk_mul_f32 v[228:229], v[26:27], v[26:27]
    v_pk_fma_f32 v[226:227], v[226:227], v[166:167], v[166:167] op_sel:[0,1,0] op_sel_hi:[1,1,0]
    v_pk_fma_f32 v[228:229], v[228:229], v[166:167], v[166:167] op_sel:[0,1,0] op_sel_hi:[1,1,0]
    v_pk_mul_f32 v[226:227], v[226:227], v[24:25]
    v_pk_mul_f32 v[228:229], v[228:229], v[26:27]
    v_exp_f32 v226, v226
    v_exp_f32 v227, v227
    v_exp_f32 v228, v228
    v_exp_f32 v229, v229
    v_pk_fma_f32 v[226:227], v[226:227], v[164:165], v[164:165] op_sel:[0,1,1] op_sel_hi:[1,1,1]
    v_pk_fma_f32 v[228:229], v[228:229], v[164:165], v[164:165] op_sel:[0,1,1] op_sel_hi:[1,1,1]
    v_rcp_f32 v226, v226
    v_rcp_f32 v227, v227
    v_rcp_f32 v228, v228
    v_rcp_f32 v229, v229
    v_pk_mul_f32 v[24:25], v[24:25], v[226:227]
    v_pk_mul_f32 v[26:27], v[26:27], v[228:229]
    v_cvt_pk_bf16_f32 v216, v24, v25
    v_cvt_pk_bf16_f32 v217, v26, v27
    v_or_b32 v216, 1, v216
    s_add_u32 s36, s46, 0
    buffer_store_dwordx4 v[36:39], v2, s[16:19], s36 offen sc1
    v_pk_fma_f32 v[52:53], v[168:169], v[136:137], v[52:53] op_sel_hi:[0,1,1] neg_lo:[1,0,0] neg_hi:[1,0,0]
    v_pk_fma_f32 v[54:55], v[168:169], v[138:139], v[54:55] op_sel_hi:[0,1,1] neg_lo:[1,0,0] neg_hi:[1,0,0]
    v_pk_mul_f32 v[226:227], v[52:53], v[52:53]
    v_pk_mul_f32 v[228:229], v[54:55], v[54:55]
    v_pk_fma_f32 v[226:227], v[226:227], v[170:171], v[170:171] op_sel:[0,1,0] op_sel_hi:[1,1,0]
    v_pk_fma_f32 v[228:229], v[228:229], v[170:171], v[170:171] op_sel:[0,1,0] op_sel_hi:[1,1,0]
    v_pk_mul_f32 v[226:227], v[226:227], v[52:53]
    v_pk_mul_f32 v[228:229], v[228:229], v[54:55]
    v_exp_f32 v226, v226
    v_exp_f32 v227, v227
    v_exp_f32 v228, v228
    v_exp_f32 v229, v229
    v_pk_fma_f32 v[226:227], v[226:227], v[168:169], v[168:169] op_sel:[0,1,1] op_sel_hi:[1,1,1]
    v_pk_fma_f32 v[228:229], v[228:229], v[168:169], v[168:169] op_sel:[0,1,1] op_sel_hi:[1,1,1]
    v_rcp_f32 v226, v226
    v_rcp_f32 v227, v227
    v_rcp_f32 v228, v228
    v_rcp_f32 v229, v229
    v_pk_mul_f32 v[52:53], v[52:53], v[226:227]
    v_pk_mul_f32 v[54:55], v[54:55], v[228:229]
    v_cvt_pk_bf16_f32 v218, v52, v53
    v_cvt_pk_bf16_f32 v219, v54, v55
    v_or_b32 v218, 1, v218
    s_add_u32 s36, s46, 229376
    buffer_store_dwordx4 v[64:67], v2, s[16:19], s36 offen sc1
    v_pk_fma_f32 v[80:81], v[172:173], v[136:137], v[80:81] op_sel_hi:[0,1,1] neg_lo:[1,0,0] neg_hi:[1,0,0]
    v_pk_fma_f32 v[82:83], v[172:173], v[138:139], v[82:83] op_sel_hi:[0,1,1] neg_lo:[1,0,0] neg_hi:[1,0,0]
    v_pk_mul_f32 v[226:227], v[80:81], v[80:81]
    v_pk_mul_f32 v[228:229], v[82:83], v[82:83]
    v_pk_fma_f32 v[226:227], v[226:227], v[174:175], v[174:175] op_sel:[0,1,0] op_sel_hi:[1,1,0]
    v_pk_fma_f32 v[228:229], v[228:229], v[174:175], v[174:175] op_sel:[0,1,0] op_sel_hi:[1,1,0]
    v_pk_mul_f32 v[226:227], v[226:227], v[80:81]
    v_pk_mul_f32 v[228:229], v[228:229], v[82:83]
    v_exp_f32 v226, v226
    v_exp_f32 v227, v227
    v_exp_f32 v228, v228
    v_exp_f32 v229, v229
    v_pk_fma_f32 v[226:227], v[226:227], v[172:173], v[172:173] op_sel:[0,1,1] op_sel_hi:[1,1,1]
    v_pk_fma_f32 v[228:229], v[228:229], v[172:173], v[172:173] op_sel:[0,1,1] op_sel_hi:[1,1,1]
    v_rcp_f32 v226, v226
    v_rcp_f32 v227, v227
    v_rcp_f32 v228, v228
    v_rcp_f32 v229, v229
    v_pk_mul_f32 v[80:81], v[80:81], v[226:227]
    v_pk_mul_f32 v[82:83], v[82:83], v[228:229]
    v_cvt_pk_bf16_f32 v220, v80, v81
    v_cvt_pk_bf16_f32 v221, v82, v83
    v_or_b32 v220, 1, v220
    s_add_u32 s36, s46, 458752
    buffer_store_dwordx4 v[92:95], v2, s[16:19], s36 offen sc1
    v_pk_fma_f32 v[108:109], v[176:177], v[136:137], v[108:109] op_sel_hi:[0,1,1] neg_lo:[1,0,0] neg_hi:[1,0,0]
    v_pk_fma_f32 v[110:111], v[176:177], v[138:139], v[110:111] op_sel_hi:[0,1,1] neg_lo:[1,0,0] neg_hi:[1,0,0]
    v_pk_mul_f32 v[226:227], v[108:109], v[108:109]
    v_pk_mul_f32 v[228:229], v[110:111], v[110:111]
    v_pk_fma_f32 v[226:227], v[226:227], v[178:179], v[178:179] op_sel:[0,1,0] op_sel_hi:[1,1,0]
    v_pk_fma_f32 v[228:229], v[228:229], v[178:179], v[178:179] op_sel:[0,1,0] op_sel_hi:[1,1,0]
    v_pk_mul_f32 v[226:227], v[226:227], v[108:109]
    v_pk_mul_f32 v[228:229], v[228:229], v[110:111]
    v_exp_f32 v226, v226
    v_exp_f32 v227, v227
    v_exp_f32 v228, v228
    v_exp_f32 v229, v229
    v_pk_fma_f32 v[226:227], v[226:227], v[176:177], v[176:177] op_sel:[0,1,1] op_sel_hi:[1,1,1]
    v_pk_fma_f32 v[228:229], v[228:229], v[176:177], v[176:177] op_sel:[0,1,1] op_sel_hi:[1,1,1]
    v_rcp_f32 v226, v226
    v_rcp_f32 v227, v227
    v_rcp_f32 v228, v228
    v_rcp_f32 v229, v229
    v_pk_mul_f32 v[108:109], v[108:109], v[226:227]
    v_pk_mul_f32 v[110:111], v[110:111], v[228:229]
    v_cvt_pk_bf16_f32 v222, v108, v109
    v_cvt_pk_bf16_f32 v223, v110, v111
    s_add_u32 s36, s46, 688128
    buffer_store_dwordx4 v[120:123], v2, s[16:19], s36 offen sc1
    s_waitcnt lgkmcnt(0)
    s_add_u32 s45, s44, 512
    s_mov_b32 s44, s47
G3_e2:
    s_waitcnt lgkmcnt(0)
    s_barrier
    ds_read_b128 v[88:91], v17 offset:0
    ds_read_b128 v[92:95], v17 offset:2048
    ds_read_b128 v[96:99], v17 offset:4096
    ds_read_b128 v[100:103], v17 offset:6144
    ds_read_b64_tr_b16 v[104:105], v18 offset:0
    ds_read_b64_tr_b16 v[106:107], v18 offset:4096
    ds_read_b64_tr_b16 v[108:109], v19 offset:0
    ds_read_b64_tr_b16 v[110:111], v19 offset:4096
    ds_read_b64_tr_b16 v[112:113], v20 offset:0
    ds_read_b64_tr_b16 v[114:115], v20 offset:4096
    ds_read_b64_tr_b16 v[116:117], v21 offset:0
    ds_read_b64_tr_b16 v[118:119], v21 offset:4096
    s_waitcnt lgkmcnt(6)
    v_mfma_f32_16x16x32_bf16 v[24:27], v[104:107], v[88:91], 0
    ds_read_b128 v[120:123], v17 offset:1024
    s_add_u32 s42, s42, 16384
    v_mfma_f32_16x16x32_bf16 v[40:43], v[104:107], v[92:95], 0
    ds_read_b128 v[124:127], v17 offset:3072
    s_cmp_eq_u32 s42, 49152
    v_mfma_f32_16x16x32_bf16 v[56:59], v[104:107], v[96:99], 0
    ds_read_b128 v[128:131], v17 offset:5120
    s_cselect_b32 s42, 0, s42
    v_mfma_f32_16x16x32_bf16 v[72:75], v[104:107], v[100:103], 0
    ds_read_b128 v[132:135], v17 offset:7168
    s_waitcnt lgkmcnt(8)
    v_mfma_f32_16x16x32_bf16 v[76:79], v[108:111], v[100:103], 0
    ds_read_b64_tr_b16 v[136:137], v18 offset:8192
    s_add_u32 s48, s48, 16384
    v_mfma_f32_16x16x32_bf16 v[60:63], v[108:111], v[96:99], 0
    ds_read_b64_tr_b16 v[138:139], v18 offset:12288
    s_cmp_eq_u32 s48, 98304
    v_mfma_f32_16x16x32_bf16 v[44:47], v[108:111], v[92:95], 0
    ds_read_b64_tr_b16 v[140:141], v19 offset:8192
    s_cselect_b32 s48, 0, s48
    v_mfma_f32_16x16x32_bf16 v[28:31], v[108:111], v[88:91], 0
    ds_read_b64_tr_b16 v[142:143], v19 offset:12288
    s_waitcnt lgkmcnt(8)
    v_mfma_f32_16x16x32_bf16 v[32:35], v[112:115], v[88:91], 0
    ds_read_b64_tr_b16 v[144:145], v20 offset:8192
    v_add_u32 v17, s42, v12
    v_mfma_f32_16x16x32_bf16 v[48:51], v[112:115], v[92:95], 0
    ds_read_b64_tr_b16 v[146:147], v20 offset:12288
    s_add_u32 s36, s44, 0
    v_mfma_f32_16x16x32_bf16 v[64:67], v[112:115], v[96:99], 0
    ds_read_b64_tr_b16 v[148:149], v21 offset:8192
    buffer_store_dwordx4 v[200:203], v2, s[16:19], s36 offen sc1
    v_mfma_f32_16x16x32_bf16 v[80:83], v[112:115], v[100:103], 0
    ds_read_b64_tr_b16 v[150:151], v21 offset:12288
    s_add_u32 s36, s45, 0
    v_mfma_f32_16x16x32_bf16 v[84:87], v[116:119], v[100:103], 0
    buffer_store_dwordx2 v[216:217], v238, s[16:19], s36 offen sc1
    v_add_u32 v18, s48, v13
    v_mfma_f32_16x16x32_bf16 v[68:71], v[116:119], v[96:99], 0
    v_add_u32 v19, s48, v14
    v_mfma_f32_16x16x32_bf16 v[52:55], v[116:119], v[92:95], 0
    v_add_u32 v20, s48, v15
    v_mfma_f32_16x16x32_bf16 v[36:39], v[116:119], v[88:91], 0
    v_add_u32 v21, s48, v16
    s_waitcnt lgkmcnt(6)
    v_mfma_f32_16x16x32_bf16 v[24:27], v[136:139], v[120:123], v[24:27]
    v_mfma_f32_16x16x32_bf16 v[40:43], v[136:139], v[124:127], v[40:43]
    v_mfma_f32_16x16x32_bf16 v[56:59], v[136:139], v[128:131], v[56:59]
    s_waitcnt lgkmcnt(0)
    s_barrier
    v_mfma_f32_16x16x32_bf16 v[72:75], v[136:139], v[132:135], v[72:75]
    ds_read_b128 v[88:91], v17 offset:0
    s_add_u32 s36, s44, 229376
    v_mfma_f32_16x16x32_bf16 v[76:79], v[140:143], v[132:135], v[76:79]
    ds_read_b128 v[92:95], v17 offset:2048
    buffer_store_dwordx4 v[204:207], v2, s[16:19], s36 offen sc1
    v_mfma_f32_16x16x32_bf16 v[60:63], v[140:143], v[128:131], v[60:63]
    ds_read_b128 v[96:99], v17 offset:4096
    s_add_u32 s36, s45, 229376
    v_mfma_f32_16x16x32_bf16 v[44:47], v[140:143], v[124:127], v[44:47]
    ds_read_b128 v[100:103], v17 offset:6144
    buffer_store_dwordx2 v[218:219], v238, s[16:19], s36 offen sc1
    v_mfma_f32_16x16x32_bf16 v[28:31], v[140:143], v[120:123], v[28:31]
    ds_read_b64_tr_b16 v[104:105], v18 offset:0
    s_add_u32 s43, s43, 1
    v_mfma_f32_16x16x32_bf16 v[32:35], v[144:147], v[120:123], v[32:35]
    ds_read_b64_tr_b16 v[106:107], v18 offset:4096
    s_cmp_lt_u32 s43, 27
    v_mfma_f32_16x16x32_bf16 v[48:51], v[144:147], v[124:127], v[48:51]
    ds_read_b64_tr_b16 v[108:109], v19 offset:0
    v_mfma_f32_16x16x32_bf16 v[64:67], v[144:147], v[128:131], v[64:67]
    ds_read_b64_tr_b16 v[110:111], v19 offset:4096
    v_mfma_f32_16x16x32_bf16 v[80:83], v[144:147], v[132:135], v[80:83]
    ds_read_b64_tr_b16 v[112:113], v20 offset:0
    v_mfma_f32_16x16x32_bf16 v[84:87], v[148:151], v[132:135], v[84:87]
    ds_read_b64_tr_b16 v[114:115], v20 offset:4096
    v_mfma_f32_16x16x32_bf16 v[68:71], v[148:151], v[128:131], v[68:71]
    ds_read_b64_tr_b16 v[116:117], v21 offset:0
    v_mfma_f32_16x16x32_bf16 v[52:55], v[148:151], v[124:127], v[52:55]
    ds_read_b64_tr_b16 v[118:119], v21 offset:4096
    v_mfma_f32_16x16x32_bf16 v[36:39], v[148:151], v[120:123], v[36:39]
    s_waitcnt lgkmcnt(6)
    v_mfma_f32_16x16x32_bf16 v[24:27], v[104:107], v[88:91], v[24:27]
    ds_read_b128 v[120:123], v17 offset:1024
    s_add_u32 s42, s42, 16384
    v_mfma_f32_16x16x32_bf16 v[40:43], v[104:107], v[92:95], v[40:43]
    ds_read_b128 v[124:127], v17 offset:3072
    s_cmp_eq_u32 s42, 49152
    v_mfma_f32_16x16x32_bf16 v[56:59], v[104:107], v[96:99], v[56:59]
    ds_read_b128 v[128:131], v17 offset:5120
    s_cselect_b32 s42, 0, s42
    v_mfma_f32_16x16x32_bf16 v[72:75], v[104:107], v[100:103], v[72:75]
    ds_read_b128 v[132:135], v17 offset:7168
    s_waitcnt lgkmcnt(8)
    v_mfma_f32_16x16x32_bf16 v[76:79], v[108:111], v[100:103], v[76:79]
    ds_read_b64_tr_b16 v[136:137], v18 offset:8192
    s_add_u32 s48, s48, 16384
    v_mfma_f32_16x16x32_bf16 v[60:63], v[108:111], v[96:99], v[60:63]
    ds_read_b64_tr_b16 v[138:139], v18 offset:12288
    s_cmp_eq_u32 s48, 98304
    v_mfma_f32_16x16x32_bf16 v[44:47], v[108:111], v[92:95], v[44:47]
    ds_read_b64_tr_b16 v[140:141], v19 offset:8192
    s_cselect_b32 s48, 0, s48
    v_mfma_f32_16x16x32_bf16 v[28:31], v[108:111], v[88:91], v[28:31]
    ds_read_b64_tr_b16 v[142:143], v19 offset:12288
    s_waitcnt lgkmcnt(8)
    v_mfma_f32_16x16x32_bf16 v[32:35], v[112:115], v[88:91], v[32:35]
    ds_read_b64_tr_b16 v[144:145], v20 offset:8192
    v_add_u32 v17, s42, v12
    v_mfma_f32_16x16x32_bf16 v[48:51], v[112:115], v[92:95], v[48:51]
    ds_read_b64_tr_b16 v[146:147], v20 offset:12288
    s_add_u32 s36, s44, 458752
    v_mfma_f32_16x16x32_bf16 v[64:67], v[112:115], v[96:99], v[64:67]
    ds_read_b64_tr_b16 v[148:149], v21 offset:8192
    buffer_store_dwordx4 v[208:211], v2, s[16:19], s36 offen sc1
    v_mfma_f32_16x16x32_bf16 v[80:83], v[112:115], v[100:103], v[80:83]
    ds_read_b64_tr_b16 v[150:151], v21 offset:12288
    s_add_u32 s36, s45, 458752
    v_mfma_f32_16x16x32_bf16 v[84:87], v[116:119], v[100:103], v[84:87]
    buffer_store_dwordx2 v[220:221], v238, s[16:19], s36 offen sc1
    v_add_u32 v18, s48, v13
    v_mfma_f32_16x16x32_bf16 v[68:71], v[116:119], v[96:99], v[68:71]
    v_add_u32 v19, s48, v14
    v_mfma_f32_16x16x32_bf16 v[52:55], v[116:119], v[92:95], v[52:55]
    v_add_u32 v20, s48, v15
    v_mfma_f32_16x16x32_bf16 v[36:39], v[116:119], v[88:91], v[36:39]
    v_add_u32 v21, s48, v16
    s_waitcnt lgkmcnt(6)
    v_mfma_f32_16x16x32_bf16 v[24:27], v[136:139], v[120:123], v[24:27]
    v_mfma_f32_16x16x32_bf16 v[40:43], v[136:139], v[124:127], v[40:43]
    s_waitcnt vmcnt(6)
    v_mfma_f32_16x16x32_bf16 v[56:59], v[136:139], v[128:131], v[56:59]
    s_waitcnt lgkmcnt(0)
    s_barrier
    v_mfma_f32_16x16x32_bf16 v[72:75], v[136:139], v[132:135], v[72:75]
    ds_read_b128 v[88:91], v17 offset:0
    s_add_u32 s36, s44, 688128
    v_mfma_f32_16x16x32_bf16 v[76:79], v[140:143], v[132:135], v[76:79]
    ds_read_b128 v[92:95], v17 offset:2048
    buffer_store_dwordx4 v[212:215], v2, s[16:19], s36 offen sc1
    v_mfma_f32_16x16x32_bf16 v[60:63], v[140:143], v[128:131], v[60:63]
    ds_read_b128 v[96:99], v17 offset:4096
    s_add_u32 s36, s45, 688128
    v_mfma_f32_16x16x32_bf16 v[44:47], v[140:143], v[124:127], v[44:47]
    ds_read_b128 v[100:103], v17 offset:6144
    buffer_store_dwordx2 v[222:223], v238, s[16:19], s36 offen sc1
    v_mfma_f32_16x16x32_bf16 v[28:31], v[140:143], v[120:123], v[28:31]
    ds_read_b64_tr_b16 v[104:105], v18 offset:0
    s_add_u32 s43, s43, 1
    v_mfma_f32_16x16x32_bf16 v[32:35], v[144:147], v[120:123], v[32:35]
    ds_read_b64_tr_b16 v[106:107], v18 offset:4096
    s_cmp_lt_u32 s43, 27
    v_mfma_f32_16x16x32_bf16 v[48:51], v[144:147], v[124:127], v[48:51]
    ds_read_b64_tr_b16 v[108:109], v19 offset:0
    v_mfma_f32_16x16x32_bf16 v[64:67], v[144:147], v[128:131], v[64:67]
    ds_read_b64_tr_b16 v[110:111], v19 offset:4096
    v_mfma_f32_16x16x32_bf16 v[80:83], v[144:147], v[132:135], v[80:83]
    ds_read_b64_tr_b16 v[112:113], v20 offset:0
    v_mfma_f32_16x16x32_bf16 v[84:87], v[148:151], v[132:135], v[84:87]
    ds_read_b64_tr_b16 v[114:115], v20 offset:4096
    v_mfma_f32_16x16x32_bf16 v[68:71], v[148:151], v[128:131], v[68:71]
    ds_read_b64_tr_b16 v[116:117], v21 offset:0
    v_mfma_f32_16x16x32_bf16 v[52:55], v[148:151], v[124:127], v[52:55]
    ds_read_b64_tr_b16 v[118:119], v21 offset:4096
    v_mfma_f32_16x16x32_bf16 v[36:39], v[148:151], v[120:123], v[36:39]
    s_waitcnt lgkmcnt(6)
mm_27:
    v_mfma_f32_16x16x32_bf16 v[24:27], v[104:107], v[88:91], v[24:27]
    ds_read_b128 v[120:123], v17 offset:1024
    s_add_u32 s42, s42, 16384
    v_mfma_f32_16x16x32_bf16 v[40:43], v[104:107], v[92:95], v[40:43]
    ds_read_b128 v[124:127], v17 offset:3072
    s_cmp_eq_u32 s42, 49152
    v_mfma_f32_16x16x32_bf16 v[56:59], v[104:107], v[96:99], v[56:59]
    ds_read_b128 v[128:131], v17 offset:5120
    s_cselect_b32 s42, 0, s42
    v_mfma_f32_16x16x32_bf16 v[72:75], v[104:107], v[100:103], v[72:75]
    ds_read_b128 v[132:135], v17 offset:7168
    s_waitcnt lgkmcnt(8)
    v_mfma_f32_16x16x32_bf16 v[76:79], v[108:111], v[100:103], v[76:79]
    ds_read_b64_tr_b16 v[136:137], v18 offset:8192
    s_add_u32 s48, s48, 16384
    v_mfma_f32_16x16x32_bf16 v[60:63], v[108:111], v[96:99], v[60:63]
    ds_read_b64_tr_b16 v[138:139], v18 offset:12288
    s_cmp_eq_u32 s48, 98304
    v_mfma_f32_16x16x32_bf16 v[44:47], v[108:111], v[92:95], v[44:47]
    ds_read_b64_tr_b16 v[140:141], v19 offset:8192
    s_cselect_b32 s48, 0, s48
    v_mfma_f32_16x16x32_bf16 v[28:31], v[108:111], v[88:91], v[28:31]
    ds_read_b64_tr_b16 v[142:143], v19 offset:12288
    s_waitcnt lgkmcnt(8)
    v_mfma_f32_16x16x32_bf16 v[32:35], v[112:115], v[88:91], v[32:35]
    ds_read_b64_tr_b16 v[144:145], v20 offset:8192
    v_add_u32 v17, s42, v12
    v_mfma_f32_16x16x32_bf16 v[48:51], v[112:115], v[92:95], v[48:51]
    ds_read_b64_tr_b16 v[146:147], v20 offset:12288
    v_add_u32 v18, s48, v13
    v_mfma_f32_16x16x32_bf16 v[64:67], v[112:115], v[96:99], v[64:67]
    ds_read_b64_tr_b16 v[148:149], v21 offset:8192
    v_add_u32 v19, s48, v14
    v_mfma_f32_16x16x32_bf16 v[80:83], v[112:115], v[100:103], v[80:83]
    ds_read_b64_tr_b16 v[150:151], v21 offset:12288
    v_add_u32 v20, s48, v15
    v_mfma_f32_16x16x32_bf16 v[84:87], v[116:119], v[100:103], v[84:87]
    v_add_u32 v21, s48, v16
    v_mfma_f32_16x16x32_bf16 v[68:71], v[116:119], v[96:99], v[68:71]
    v_mfma_f32_16x16x32_bf16 v[52:55], v[116:119], v[92:95], v[52:55]
    v_mfma_f32_16x16x32_bf16 v[36:39], v[116:119], v[88:91], v[36:39]
    s_waitcnt lgkmcnt(6)
    v_mfma_f32_16x16x32_bf16 v[24:27], v[136:139], v[120:123], v[24:27]
    s_add_u32 s43, s43, 1
    s_cmp_lt_u32 s43, 4
    v_mfma_f32_16x16x32_bf16 v[40:43], v[136:139], v[124:127], v[40:43]
    v_mfma_f32_16x16x32_bf16 v[56:59], v[136:139], v[128:131], v[56:59]
    s_waitcnt lgkmcnt(0)
    s_barrier
    v_mfma_f32_16x16x32_bf16 v[72:75], v[136:139], v[132:135], v[72:75]
    ds_read_b128 v[88:91], v17 offset:0
    v_mfma_f32_16x16x32_bf16 v[76:79], v[140:143], v[132:135], v[76:79]
    ds_read_b128 v[92:95], v17 offset:2048
    v_mfma_f32_16x16x32_bf16 v[60:63], v[140:143], v[128:131], v[60:63]
    ds_read_b128 v[96:99], v17 offset:4096
    v_mfma_f32_16x16x32_bf16 v[44:47], v[140:143], v[124:127], v[44:47]
    ds_read_b128 v[100:103], v17 offset:6144
    v_mfma_f32_16x16x32_bf16 v[28:31], v[140:143], v[120:123], v[28:31]
    ds_read_b64_tr_b16 v[104:105], v18 offset:0
    v_mfma_f32_16x16x32_bf16 v[32:35], v[144:147], v[120:123], v[32:35]
    ds_read_b64_tr_b16 v[106:107], v18 offset:4096
    v_mfma_f32_16x16x32_bf16 v[48:51], v[144:147], v[124:127], v[48:51]
    ds_read_b64_tr_b16 v[108:109], v19 offset:0
    v_mfma_f32_16x16x32_bf16 v[64:67], v[144:147], v[128:131], v[64:67]
    ds_read_b64_tr_b16 v[110:111], v19 offset:4096
    v_mfma_f32_16x16x32_bf16 v[80:83], v[144:147], v[132:135], v[80:83]
    ds_read_b64_tr_b16 v[112:113], v20 offset:0
    v_mfma_f32_16x16x32_bf16 v[84:87], v[148:151], v[132:135], v[84:87]
    ds_read_b64_tr_b16 v[114:115], v20 offset:4096
    v_mfma_f32_16x16x32_bf16 v[68:71], v[148:151], v[128:131], v[68:71]
    ds_read_b64_tr_b16 v[116:117], v21 offset:0
    v_mfma_f32_16x16x32_bf16 v[52:55], v[148:151], v[124:127], v[52:55]
    ds_read_b64_tr_b16 v[118:119], v21 offset:4096
    v_mfma_f32_16x16x32_bf16 v[36:39], v[148:151], v[120:123], v[36:39]
    s_waitcnt lgkmcnt(6)
    s_cbranch_scc1 mm_27
mm_28:
    v_mfma_f32_16x16x32_bf16 v[24:27], v[104:107], v[88:91], v[24:27]
    ds_read_b128 v[120:123], v17 offset:1024
    s_add_u32 s42, s42, 16384
    v_mfma_f32_16x16x32_bf16 v[40:43], v[104:107], v[92:95], v[40:43]
    ds_read_b128 v[124:127], v17 offset:3072
    s_cmp_eq_u32 s42, 49152
    v_mfma_f32_16x16x32_bf16 v[56:59], v[104:107], v[96:99], v[56:59]
    ds_read_b128 v[128:131], v17 offset:5120
    s_cselect_b32 s42, 0, s42
    v_mfma_f32_16x16x32_bf16 v[72:75], v[104:107], v[100:103], v[72:75]
    ds_read_b128 v[132:135], v17 offset:7168
    s_waitcnt lgkmcnt(8)
    v_mfma_f32_16x16x32_bf16 v[76:79], v[108:111], v[100:103], v[76:79]
    ds_read_b64_tr_b16 v[136:137], v18 offset:8192
    s_add_u32 s48, s48, 16384
    v_mfma_f32_16x16x32_bf16 v[60:63], v[108:111], v[96:99], v[60:63]
    ds_read_b64_tr_b16 v[138:139], v18 offset:12288
    s_cmp_eq_u32 s48, 98304
    v_mfma_f32_16x16x32_bf16 v[44:47], v[108:111], v[92:95], v[44:47]
    ds_read_b64_tr_b16 v[140:141], v19 offset:8192
    s_cselect_b32 s48, 0, s48
    v_mfma_f32_16x16x32_bf16 v[28:31], v[108:111], v[88:91], v[28:31]
    ds_read_b64_tr_b16 v[142:143], v19 offset:12288
    s_waitcnt lgkmcnt(8)
    v_mfma_f32_16x16x32_bf16 v[32:35], v[112:115], v[88:91], v[32:35]
    ds_read_b64_tr_b16 v[144:145], v20 offset:8192
    v_add_u32 v17, s42, v12
    v_mfma_f32_16x16x32_bf16 v[48:51], v[112:115], v[92:95], v[48:51]
    ds_read_b64_tr_b16 v[146:147], v20 offset:12288
    v_add_u32 v18, s48, v13
    v_mfma_f32_16x16x32_bf16 v[64:67], v[112:115], v[96:99], v[64:67]
    ds_read_b64_tr_b16 v[148:149], v21 offset:8192
    v_add_u32 v19, s48, v14
    v_mfma_f32_16x16x32_bf16 v[80:83], v[112:115], v[100:103], v[80:83]
    ds_read_b64_tr_b16 v[150:151], v21 offset:12288
    v_add_u32 v20, s48, v15
    v_mfma_f32_16x16x32_bf16 v[84:87], v[116:119], v[100:103], v[84:87]
    v_add_u32 v21, s48, v16
    v_mfma_f32_16x16x32_bf16 v[68:71], v[116:119], v[96:99], v[68:71]
    v_mfma_f32_16x16x32_bf16 v[52:55], v[116:119], v[92:95], v[52:55]
    v_mfma_f32_16x16x32_bf16 v[36:39], v[116:119], v[88:91], v[36:39]
    s_waitcnt lgkmcnt(6)
    v_mfma_f32_16x16x32_bf16 v[24:27], v[136:139], v[120:123], v[24:27]
    s_add_u32 s43, s43, 1
    s_cmp_lt_u32 s43, 27
    v_mfma_f32_16x16x32_bf16 v[40:43], v[136:139], v[124:127], v[40:43]
    s_waitcnt vmcnt(0)
    v_mfma_f32_16x16x32_bf16 v[56:59], v[136:139], v[128:131], v[56:59]
    s_waitcnt lgkmcnt(0)
    s_barrier
    v_mfma_f32_16x16x32_bf16 v[72:75], v[136:139], v[132:135], v[72:75]
    ds_read_b128 v[88:91], v17 offset:0
    v_mfma_f32_16x16x32_bf16 v[76:79], v[140:143], v[132:135], v[76:79]
    ds_read_b128 v[92:95], v17 offset:2048
    v_mfma_f32_16x16x32_bf16 v[60:63], v[140:143], v[128:131], v[60:63]
    ds_read_b128 v[96:99], v17 offset:4096
    v_mfma_f32_16x16x32_bf16 v[44:47], v[140:143], v[124:127], v[44:47]
    ds_read_b128 v[100:103], v17 offset:6144
    v_mfma_f32_16x16x32_bf16 v[28:31], v[140:143], v[120:123], v[28:31]
    ds_read_b64_tr_b16 v[104:105], v18 offset:0
    v_mfma_f32_16x16x32_bf16 v[32:35], v[144:147], v[120:123], v[32:35]
    ds_read_b64_tr_b16 v[106:107], v18 offset:4096
    v_mfma_f32_16x16x32_bf16 v[48:51], v[144:147], v[124:127], v[48:51]
    ds_read_b64_tr_b16 v[108:109], v19 offset:0
    v_mfma_f32_16x16x32_bf16 v[64:67], v[144:147], v[128:131], v[64:67]
    ds_read_b64_tr_b16 v[110:111], v19 offset:4096
    v_mfma_f32_16x16x32_bf16 v[80:83], v[144:147], v[132:135], v[80:83]
    ds_read_b64_tr_b16 v[112:113], v20 offset:0
    v_mfma_f32_16x16x32_bf16 v[84:87], v[148:151], v[132:135], v[84:87]
    ds_read_b64_tr_b16 v[114:115], v20 offset:4096
    v_mfma_f32_16x16x32_bf16 v[68:71], v[148:151], v[128:131], v[68:71]
    ds_read_b64_tr_b16 v[116:117], v21 offset:0
    v_mfma_f32_16x16x32_bf16 v[52:55], v[148:151], v[124:127], v[52:55]
    ds_read_b64_tr_b16 v[118:119], v21 offset:4096
    v_mfma_f32_16x16x32_bf16 v[36:39], v[148:151], v[120:123], v[36:39]
    s_waitcnt lgkmcnt(6)
    s_cbranch_scc1 mm_28
    s_cmp_eq_u32 s60, 1
    s_cbranch_scc1 G4_last
    v_mfma_f32_16x16x32_bf16 v[24:27], v[104:107], v[88:91], v[24:27]
    ds_read_b128 v[120:123], v17 offset:1024
    v_mfma_f32_16x16x32_bf16 v[40:43], v[104:107], v[92:95], v[40:43]
    ds_read_b128 v[124:127], v17 offset:3072
    v_mfma_f32_16x16x32_bf16 v[56:59], v[104:107], v[96:99], v[56:59]
    ds_read_b128 v[128:131], v17 offset:5120
    v_mfma_f32_16x16x32_bf16 v[72:75], v[104:107], v[100:103], v[72:75]
    ds_read_b128 v[132:135], v17 offset:7168
    s_waitcnt lgkmcnt(8)
    v_mfma_f32_16x16x32_bf16 v[76:79], v[108:111], v[100:103], v[76:79]
    ds_read_b64_tr_b16 v[136:137], v18 offset:8192
    v_mfma_f32_16x16x32_bf16 v[60:63], v[108:111], v[96:99], v[60:63]
    ds_read_b64_tr_b16 v[138:139], v18 offset:12288
    v_mfma_f32_16x16x32_bf16 v[44:47], v[108:111], v[92:95], v[44:47]
    ds_read_b64_tr_b16 v[140:141], v19 offset:8192
    v_mfma_f32_16x16x32_bf16 v[28:31], v[108:111], v[88:91], v[28:31]
    ds_read_b64_tr_b16 v[142:143], v19 offset:12288
    s_waitcnt lgkmcnt(8)
    v_mfma_f32_16x16x32_bf16 v[32:35], v[112:115], v[88:91], v[32:35]
    ds_read_b64_tr_b16 v[144:145], v20 offset:8192
    v_mfma_f32_16x16x32_bf16 v[48:51], v[112:115], v[92:95], v[48:51]
    ds_read_b64_tr_b16 v[146:147], v20 offset:12288
    v_mfma_f32_16x16x32_bf16 v[64:67], v[112:115], v[96:99], v[64:67]
    ds_read_b64_tr_b16 v[148:149], v21 offset:8192
    v_mfma_f32_16x16x32_bf16 v[80:83], v[112:115], v[100:103], v[80:83]
    ds_read_b64_tr_b16 v[150:151], v21 offset:12288
    v_mfma_f32_16x16x32_bf16 v[84:87], v[116:119], v[100:103], v[84:87]
    v_mfma_f32_16x16x32_bf16 v[68:71], v[116:119], v[96:99], v[68:71]
    v_mfma_f32_16x16x32_bf16 v[52:55], v[116:119], v[92:95], v[52:55]
    v_mfma_f32_16x16x32_bf16 v[36:39], v[116:119], v[88:91], v[36:39]
    s_waitcnt lgkmcnt(0)
    v_mfma_f32_16x16x32_bf16 v[24:27], v[136:139], v[120:123], v[24:27]
    s_mul_i32 s36, s31, 524288
    s_add_u32 s36, s36, 0
    s_add_u32 s16, s62, s36
    v_mfma_f32_16x16x32_bf16 v[40:43], v[136:139], v[124:127], v[40:43]
    s_addc_u32 s17, s63, 0
    s_mov_b32 s18, 516096
    s_mov_b32 s19, 0x20000
    v_mfma_f32_16x16x32_bf16 v[56:59], v[136:139], v[128:131], v[56:59]
    v_mfma_f32_16x16x32_bf16 v[72:75], v[136:139], v[132:135], v[72:75]
    v_mfma_f32_16x16x32_bf16 v[76:79], v[140:143], v[132:135], v[76:79]
    v_mfma_f32_16x16x32_bf16 v[60:63], v[140:143], v[128:131], v[60:63]
    v_mfma_f32_16x16x32_bf16 v[44:47], v[140:143], v[124:127], v[44:47]
    v_mfma_f32_16x16x32_bf16 v[28:31], v[140:143], v[120:123], v[28:31]
    v_mfma_f32_16x16x32_bf16 v[32:35], v[144:147], v[120:123], v[32:35]
    v_mfma_f32_16x16x32_bf16 v[48:51], v[144:147], v[124:127], v[48:51]
    v_mfma_f32_16x16x32_bf16 v[64:67], v[144:147], v[128:131], v[64:67]
    v_mfma_f32_16x16x32_bf16 v[80:83], v[144:147], v[132:135], v[80:83]
    v_mfma_f32_16x16x32_bf16 v[84:87], v[148:151], v[132:135], v[84:87]
    v_mfma_f32_16x16x32_bf16 v[68:71], v[148:151], v[128:131], v[68:71]
    v_mfma_f32_16x16x32_bf16 v[52:55], v[148:151], v[124:127], v[52:55]
    v_mfma_f32_16x16x32_bf16 v[36:39], v[148:151], v[120:123], v[36:39]
    s_add_u32 s36, s39, 0
    v_cvt_pk_bf16_f32 v24, v24, v25
    v_cvt_pk_bf16_f32 v25, v26, v27
    v_cvt_pk_bf16_f32 v26, v28, v29
    v_cvt_pk_bf16_f32 v27, v30, v31
    v_or_b32 v24, 1, v24
    buffer_store_dwordx4 v[24:27], v2, s[16:19], s36 offen offset:0 sc1
    v_cvt_pk_bf16_f32 v32, v32, v33
    v_cvt_pk_bf16_f32 v33, v34, v35
    v_cvt_pk_bf16_f32 v34, v36, v37
    v_cvt_pk_bf16_f32 v35, v38, v39
    v_or_b32 v32, 1, v32
    buffer_store_dwordx4 v[32:35], v2, s[16:19], s36 offen offset:1024 sc1
    s_add_u32 s36, s39, 65536
    v_cvt_pk_bf16_f32 v40, v40, v41
    v_cvt_pk_bf16_f32 v41, v42, v43
    v_cvt_pk_bf16_f32 v42, v44, v45
    v_cvt_pk_bf16_f32 v43, v46, v47
    v_or_b32 v40, 1, v40
    buffer_store_dwordx4 v[40:43], v2, s[16:19], s36 offen offset:0 sc1
    v_cvt_pk_bf16_f32 v48, v48, v49
    v_cvt_pk_bf16_f32 v49, v50, v51
    v_cvt_pk_bf16_f32 v50, v52, v53
    v_cvt_pk_bf16_f32 v51, v54, v55
    v_or_b32 v48, 1, v48
    buffer_store_dwordx4 v[48:51], v2, s[16:19], s36 offen offset:1024 sc1
    s_add_u32 s36, s39, 131072
    v_cvt_pk_bf16_f32 v56, v56, v57
    v_cvt_pk_bf16_f32 v57, v58, v59
    v_cvt_pk_bf16_f32 v58, v60, v61
    v_cvt_pk_bf16_f32 v59, v62, v63
    v_or_b32 v56, 1, v56
    buffer_store_dwordx4 v[56:59], v2, s[16:19], s36 offen offset:0 sc1
    v_cvt_pk_bf16_f32 v64, v64, v65
    v_cvt_pk_bf16_f32 v65, v66, v67
    v_cvt_pk_bf16_f32 v66, v68, v69
    v_cvt_pk_bf16_f32 v67, v70, v71
    v_or_b32 v64, 1, v64
    buffer_store_dwordx4 v[64:67], v2, s[16:19], s36 offen offset:1024 sc1
    s_add_u32 s36, s39, 196608
    v_cvt_pk_bf16_f32 v72, v72, v73
    v_cvt_pk_bf16_f32 v73, v74, v75
    v_cvt_pk_bf16_f32 v74, v76, v77
    v_cvt_pk_bf16_f32 v75, v78, v79
    v_or_b32 v72, 1, v72
    buffer_store_dwordx4 v[72:75], v2, s[16:19], s36 offen offset:0 sc1
    v_cvt_pk_bf16_f32 v80, v80, v81
    v_cvt_pk_bf16_f32 v81, v82, v83
    v_cvt_pk_bf16_f32 v82, v84, v85
    v_cvt_pk_bf16_f32 v83, v86, v87
    v_or_b32 v80, 1, v80
    buffer_store_dwordx4 v[80:83], v2, s[16:19], s36 offen offset:1024 sc1
    s_barrier
    s_branch NEXT
G4_last:
    v_mfma_f32_16x16x32_bf16 v[24:27], v[104:107], v[88:91], v[24:27]
    ds_read_b128 v[120:123], v17 offset:1024
    v_mfma_f32_16x16x32_bf16 v[40:43], v[104:107], v[92:95], v[40:43]
    ds_read_b128 v[124:127], v17 offset:3072
    v_mfma_f32_16x16x32_bf16 v[56:59], v[104:107], v[96:99], v[56:59]
    ds_read_b128 v[128:131], v17 offset:5120
    v_mfma_f32_16x16x32_bf16 v[72:75], v[104:107], v[100:103], v[72:75]
    ds_read_b128 v[132:135], v17 offset:7168
    s_waitcnt lgkmcnt(8)
    v_mfma_f32_16x16x32_bf16 v[76:79], v[108:111], v[100:103], v[76:79]
    ds_read_b64_tr_b16 v[136:137], v18 offset:8192
    v_mfma_f32_16x16x32_bf16 v[60:63], v[108:111], v[96:99], v[60:63]
    ds_read_b64_tr_b16 v[138:139], v18 offset:12288
    v_mfma_f32_16x16x32_bf16 v[44:47], v[108:111], v[92:95], v[44:47]
    ds_read_b64_tr_b16 v[140:141], v19 offset:8192
    v_mfma_f32_16x16x32_bf16 v[28:31], v[108:111], v[88:91], v[28:31]
    ds_read_b64_tr_b16 v[142:143], v19 offset:12288
    s_waitcnt lgkmcnt(8)
    v_mfma_f32_16x16x32_bf16 v[32:35], v[112:115], v[88:91], v[32:35]
    ds_read_b64_tr_b16 v[144:145], v20 offset:8192
    v_mfma_f32_16x16x32_bf16 v[48:51], v[112:115], v[92:95], v[48:51]
    ds_read_b64_tr_b16 v[146:147], v20 offset:12288
    s_load_dwordx2 s[6:7], s[0:1], 88
    v_mfma_f32_16x16x32_bf16 v[64:67], v[112:115], v[96:99], v[64:67]
    ds_read_b64_tr_b16 v[148:149], v21 offset:8192
    v_mfma_f32_16x16x32_bf16 v[80:83], v[112:115], v[100:103], v[80:83]
    ds_read_b64_tr_b16 v[150:151], v21 offset:12288
    v_mfma_f32_16x16x32_bf16 v[84:87], v[116:119], v[100:103], v[84:87]
    v_mfma_f32_16x16x32_bf16 v[68:71], v[116:119], v[96:99], v[68:71]
    v_mfma_f32_16x16x32_bf16 v[52:55], v[116:119], v[92:95], v[52:55]
    v_mfma_f32_16x16x32_bf16 v[36:39], v[116:119], v[88:91], v[36:39]
    s_waitcnt lgkmcnt(0)
    v_mfma_f32_16x16x32_bf16 v[24:27], v[136:139], v[120:123], v[24:27]
    s_add_u32 s16, s62, 0x80000
    s_addc_u32 s17, s63, 0
    s_mov_b32 s18, 0x7e000
    v_mfma_f32_16x16x32_bf16 v[40:43], v[136:139], v[124:127], v[40:43]
    s_mov_b32 s19, 0x20000
    s_mov_b32 s20, s6
    s_mov_b32 s21, s7
    v_mfma_f32_16x16x32_bf16 v[56:59], v[136:139], v[128:131], v[56:59]
    s_mov_b32 s22, 0x400000
    s_mov_b32 s23, 0x20000
    s_add_u32 s44, s40, 65536
    v_mfma_f32_16x16x32_bf16 v[72:75], v[136:139], v[132:135], v[72:75]
    s_lshl_b32 s46, s28, 3
    s_add_u32 s46, s46, s37
    s_lshl_b32 s47, s31, 1
    v_mfma_f32_16x16x32_bf16 v[76:79], v[140:143], v[132:135], v[76:79]
    s_add_u32 s46, s46, s47
    s_lshl_b32 s46, s46, 15
    s_lshl_b32 s47, s38, 5
    v_mfma_f32_16x16x32_bf16 v[60:63], v[140:143], v[128:131], v[60:63]
    s_add_u32 s46, s46, s47
    s_add_u32 s47, s46, 32768
    v_and_b32 v225, 1, v23
    v_mfma_f32_16x16x32_bf16 v[44:47], v[140:143], v[124:127], v[44:47]
    v_lshlrev_b32 v224, 11, v22
    v_lshl_add_u32 v224, v225, 5, v224
    v_mfma_f32_16x16x32_bf16 v[28:31], v[140:143], v[120:123], v[28:31]
    v_lshrrev_b32 v225, 1, v23
    v_lshl_add_u32 v224, v225, 4, v224
    v_mfma_f32_16x16x32_bf16 v[32:35], v[144:147], v[120:123], v[32:35]
    v_lshrrev_b32 v225, 3, v22
    v_mul_u32_u24 v225, 16320, v225
    v_mfma_f32_16x16x32_bf16 v[48:51], v[144:147], v[124:127], v[48:51]
    v_sub_u32 v224, v224, v225
    v_add_u32 v225, 16384, v224
    v_mfma_f32_16x16x32_bf16 v[64:67], v[144:147], v[128:131], v[64:67]
    v_mfma_f32_16x16x32_bf16 v[80:83], v[144:147], v[132:135], v[80:83]
    v_mfma_f32_16x16x32_bf16 v[84:87], v[148:151], v[132:135], v[84:87]
    v_mfma_f32_16x16x32_bf16 v[68:71], v[148:151], v[128:131], v[68:71]
    v_mfma_f32_16x16x32_bf16 v[52:55], v[148:151], v[124:127], v[52:55]
    v_mfma_f32_16x16x32_bf16 v[36:39], v[148:151], v[120:123], v[36:39]
    s_cmp_eq_u32 s31, 0
    s_cbranch_scc1 G4_k0
    s_add_u32 s36, s41, 0
    v_cvt_pk_bf16_f32 v24, v24, v25
    v_cvt_pk_bf16_f32 v25, v26, v27
    v_cvt_pk_bf16_f32 v26, v28, v29
    v_cvt_pk_bf16_f32 v27, v30, v31
    v_or_b32 v24, 1, v24
    buffer_store_dwordx4 v[24:27], v2, s[16:19], s36 offen offset:0 sc1
    v_cvt_pk_bf16_f32 v32, v32, v33
    v_cvt_pk_bf16_f32 v33, v34, v35
    v_cvt_pk_bf16_f32 v34, v36, v37
    v_cvt_pk_bf16_f32 v35, v38, v39
    v_or_b32 v32, 1, v32
    buffer_store_dwordx4 v[32:35], v2, s[16:19], s36 offen offset:1024 sc1
    s_add_u32 s36, s41, 65536
    v_cvt_pk_bf16_f32 v40, v40, v41
    v_cvt_pk_bf16_f32 v41, v42, v43
    v_cvt_pk_bf16_f32 v42, v44, v45
    v_cvt_pk_bf16_f32 v43, v46, v47
    v_or_b32 v40, 1, v40
    buffer_store_dwordx4 v[40:43], v2, s[16:19], s36 offen offset:0 sc1
    v_cvt_pk_bf16_f32 v48, v48, v49
    v_cvt_pk_bf16_f32 v49, v50, v51
    v_cvt_pk_bf16_f32 v50, v52, v53
    v_cvt_pk_bf16_f32 v51, v54, v55
    v_or_b32 v48, 1, v48
    buffer_store_dwordx4 v[48:51], v2, s[16:19], s36 offen offset:1024 sc1
    v_pk_mov_b32 v[24:25], v[56:57], v[56:57] op_sel:[0,1]
    v_pk_mov_b32 v[26:27], v[58:59], v[58:59] op_sel:[0,1]
    v_pk_mov_b32 v[28:29], v[60:61], v[60:61] op_sel:[0,1]
    v_pk_mov_b32 v[30:31], v[62:63], v[62:63] op_sel:[0,1]
    v_pk_mov_b32 v[32:33], v[64:65], v[64:65] op_sel:[0,1]
    v_pk_mov_b32 v[34:35], v[66:67], v[66:67] op_sel:[0,1]
    v_pk_mov_b32 v[36:37], v[68:69], v[68:69] op_sel:[0,1]
    v_pk_mov_b32 v[38:39], v[70:71], v[70:71] op_sel:[0,1]
    v_pk_mov_b32 v[40:41], v[72:73], v[72:73] op_sel:[0,1]
    v_pk_mov_b32 v[42:43], v[74:75], v[74:75] op_sel:[0,1]
    v_pk_mov_b32 v[44:45], v[76:77], v[76:77] op_sel:[0,1]
    v_pk_mov_b32 v[46:47], v[78:79], v[78:79] op_sel:[0,1]
    v_pk_mov_b32 v[48:49], v[80:81], v[80:81] op_sel:[0,1]
    v_pk_mov_b32 v[50:51], v[82:83], v[82:83] op_sel:[0,1]
    v_pk_mov_b32 v[52:53], v[84:85], v[84:85] op_sel:[0,1]
    v_pk_mov_b32 v[54:55], v[86:87], v[86:87] op_sel:[0,1]
    s_branch G4_k1
G4_k0:
    s_add_u32 s36, s41, 0
    v_cvt_pk_bf16_f32 v56, v56, v57
    v_cvt_pk_bf16_f32 v57, v58, v59
    v_cvt_pk_bf16_f32 v58, v60, v61
    v_cvt_pk_bf16_f32 v59, v62, v63
    v_or_b32 v56, 1, v56
    buffer_store_dwordx4 v[56:59], v2, s[16:19], s36 offen offset:0 sc1
    v_cvt_pk_bf16_f32 v64, v64, v65
    v_cvt_pk_bf16_f32 v65, v66, v67
    v_cvt_pk_bf16_f32 v66, v68, v69
    v_cvt_pk_bf16_f32 v67, v70, v71
    v_or_b32 v64, 1, v64
    buffer_store_dwordx4 v[64:67], v2, s[16:19], s36 offen offset:1024 sc1
    s_add_u32 s36, s41, 65536
    v_cvt_pk_bf16_f32 v72, v72, v73
    v_cvt_pk_bf16_f32 v73, v74, v75
    v_cvt_pk_bf16_f32 v74, v76, v77
    v_cvt_pk_bf16_f32 v75, v78, v79
    v_or_b32 v72, 1, v72
    buffer_store_dwordx4 v[72:75], v2, s[16:19], s36 offen offset:0 sc1
    v_cvt_pk_bf16_f32 v80, v80, v81
    v_cvt_pk_bf16_f32 v81, v82, v83
    v_cvt_pk_bf16_f32 v82, v84, v85
    v_cvt_pk_bf16_f32 v83, v86, v87
    v_or_b32 v80, 1, v80
    buffer_store_dwordx4 v[80:83], v2, s[16:19], s36 offen offset:1024 sc1
G4_k1:
    s_mov_b32 s78, 0x3f80
    s_mov_b32 s79, 0x3f800000
    v_dot2_f32_bf16 v24, v180, s78, v24
    v_dot2_f32_bf16 v25, v180, s79, v25
    v_dot2_f32_bf16 v26, v181, s78, v26
    v_dot2_f32_bf16 v27, v181, s79, v27
    v_dot2_f32_bf16 v28, v182, s78, v28
    v_dot2_f32_bf16 v29, v182, s79, v29
    v_dot2_f32_bf16 v30, v183, s78, v30
    v_dot2_f32_bf16 v31, v183, s79, v31
    v_dot2_f32_bf16 v32, v188, s78, v32
    v_dot2_f32_bf16 v33, v188, s79, v33
    v_dot2_f32_bf16 v34, v189, s78, v34
    v_dot2_f32_bf16 v35, v189, s79, v35
    v_dot2_f32_bf16 v36, v190, s78, v36
    v_dot2_f32_bf16 v37, v190, s79, v37
    v_dot2_f32_bf16 v38, v191, s78, v38
    v_dot2_f32_bf16 v39, v191, s79, v39
    v_dot2_f32_bf16 v40, v196, s78, v40
    v_dot2_f32_bf16 v41, v196, s79, v41
    v_dot2_f32_bf16 v42, v197, s78, v42
    v_dot2_f32_bf16 v43, v197, s79, v43
    v_dot2_f32_bf16 v44, v198, s78, v44
    v_dot2_f32_bf16 v45, v198, s79, v45
    v_dot2_f32_bf16 v46, v199, s78, v46
    v_dot2_f32_bf16 v47, v199, s79, v47
    v_dot2_f32_bf16 v48, v234, s78, v48
    v_dot2_f32_bf16 v49, v234, s79, v49
    v_dot2_f32_bf16 v50, v235, s78, v50
    v_dot2_f32_bf16 v51, v235, s79, v51
    v_dot2_f32_bf16 v52, v236, s78, v52
    v_dot2_f32_bf16 v53, v236, s79, v53
    v_dot2_f32_bf16 v54, v237, s78, v54
    v_dot2_f32_bf16 v55, v237, s79, v55
    v_dot2_f32_bf16 v24, v184, s78, v24
    v_dot2_f32_bf16 v25, v184, s79, v25
    v_dot2_f32_bf16 v26, v185, s78, v26
    v_dot2_f32_bf16 v27, v185, s79, v27
    v_dot2_f32_bf16 v28, v186, s78, v28
    v_dot2_f32_bf16 v29, v186, s79, v29
    v_dot2_f32_bf16 v30, v187, s78, v30
    v_dot2_f32_bf16 v31, v187, s79, v31
    v_dot2_f32_bf16 v32, v192, s78, v32
    v_dot2_f32_bf16 v33, v192, s79, v33
    v_dot2_f32_bf16 v34, v193, s78, v34
    v_dot2_f32_bf16 v35, v193, s79, v35
    v_dot2_f32_bf16 v36, v194, s78, v36
    v_dot2_f32_bf16 v37, v194, s79, v37
    v_dot2_f32_bf16 v38, v195, s78, v38
    v_dot2_f32_bf16 v39, v195, s79, v39
    v_dot2_f32_bf16 v40, v230, s78, v40
    v_dot2_f32_bf16 v41, v230, s79, v41
    v_dot2_f32_bf16 v42, v231, s78, v42
    v_dot2_f32_bf16 v43, v231, s79, v43
    v_dot2_f32_bf16 v44, v232, s78, v44
    v_dot2_f32_bf16 v45, v232, s79, v45
    v_dot2_f32_bf16 v46, v233, s78, v46
    v_dot2_f32_bf16 v47, v233, s79, v47
    v_dot2_f32_bf16 v48, v248, s78, v48
    v_dot2_f32_bf16 v49, v248, s79, v49
    v_dot2_f32_bf16 v50, v249, s78, v50
    v_dot2_f32_bf16 v51, v249, s79, v51
    v_dot2_f32_bf16 v52, v250, s78, v52
    v_dot2_f32_bf16 v53, v250, s79, v53
    v_dot2_f32_bf16 v54, v251, s78, v54
    v_dot2_f32_bf16 v55, v251, s79, v55
    s_mov_b32 s53, 0
dp_29:
    buffer_load_dwordx4 v[208:211], v2, s[16:19], s40 offen offset:0 sc1
    buffer_load_dwordx4 v[212:215], v2, s[16:19], s40 offen offset:1024 sc1
    buffer_load_dwordx4 v[216:219], v2, s[16:19], s44 offen offset:0 sc1
    buffer_load_dwordx4 v[220:223], v2, s[16:19], s44 offen offset:1024 sc1
    s_waitcnt vmcnt(0)
    v_bitop3_b32 v6, v208, v212, v216 bitop3:0x80
    v_bitop3_b32 v6, v6, v220, 1 bitop3:0x80
    v_cmp_eq_u32 vcc, 0, v6
    s_cbranch_vccz dq_30
    s_sleep 2
    s_add_u32 s53, s53, 1
    s_cmp_lt_u32 s53, s61
    s_cbranch_scc1 dp_29
    s_mov_b32 s61, 0
dq_30:
    v_dot2_f32_bf16 v24, v208, s78, v24
    v_dot2_f32_bf16 v25, v208, s79, v25
    v_dot2_f32_bf16 v26, v209, s78, v26
    v_dot2_f32_bf16 v27, v209, s79, v27
    v_dot2_f32_bf16 v28, v210, s78, v28
    v_dot2_f32_bf16 v29, v210, s79, v29
    v_dot2_f32_bf16 v30, v211, s78, v30
    v_dot2_f32_bf16 v31, v211, s79, v31
    v_cvt_pk_bf16_f32 v24, v24, v25
    v_cvt_pk_bf16_f32 v25, v26, v27
    v_cvt_pk_bf16_f32 v26, v28, v29
    v_cvt_pk_bf16_f32 v27, v30, v31
    s_nop 0
    v_permlane16_swap_b32 v24, v26
    v_permlane16_swap_b32 v25, v27
    v_dot2_f32_bf16 v32, v212, s78, v32
    v_dot2_f32_bf16 v33, v212, s79, v33
    v_dot2_f32_bf16 v34, v213, s78, v34
    v_dot2_f32_bf16 v35, v213, s79, v35
    v_dot2_f32_bf16 v36, v214, s78, v36
    v_dot2_f32_bf16 v37, v214, s79, v37
    v_dot2_f32_bf16 v38, v215, s78, v38
    v_dot2_f32_bf16 v39, v215, s79, v39
    v_cvt_pk_bf16_f32 v32, v32, v33
    v_cvt_pk_bf16_f32 v33, v34, v35
    v_cvt_pk_bf16_f32 v34, v36, v37
    v_cvt_pk_bf16_f32 v35, v38, v39
    s_nop 0
    v_permlane16_swap_b32 v32, v34
    v_permlane16_swap_b32 v33, v35
    v_mov_b32 v36, v24
    v_mov_b32 v37, v25
    v_mov_b32 v38, v26
    v_mov_b32 v39, v27
    v_mov_b32_dpp v24, v32 row_ror:8 row_mask:0xf bank_mask:0xc
    v_mov_b32_dpp v25, v33 row_ror:8 row_mask:0xf bank_mask:0xc
    v_mov_b32_dpp v26, v34 row_ror:8 row_mask:0xf bank_mask:0xc
    v_mov_b32_dpp v27, v35 row_ror:8 row_mask:0xf bank_mask:0xc
    v_mov_b32_dpp v32, v36 row_ror:8 row_mask:0xf bank_mask:0x3
    v_mov_b32_dpp v33, v37 row_ror:8 row_mask:0xf bank_mask:0x3
    v_mov_b32_dpp v34, v38 row_ror:8 row_mask:0xf bank_mask:0x3
    v_mov_b32_dpp v35, v39 row_ror:8 row_mask:0xf bank_mask:0x3
    buffer_store_dwordx4 v[24:27], v224, s[20:23], s46 offen sc1
    buffer_store_dwordx4 v[32:35], v225, s[20:23], s46 offen sc1
    v_dot2_f32_bf16 v40, v216, s78, v40
    v_dot2_f32_bf16 v41, v216, s79, v41
    v_dot2_f32_bf16 v42, v217, s78, v42
    v_dot2_f32_bf16 v43, v217, s79, v43
    v_dot2_f32_bf16 v44, v218, s78, v44
    v_dot2_f32_bf16 v45, v218, s79, v45
    v_dot2_f32_bf16 v46, v219, s78, v46
    v_dot2_f32_bf16 v47, v219, s79, v47
    v_cvt_pk_bf16_f32 v40, v40, v41
    v_cvt_pk_bf16_f32 v41, v42, v43
    v_cvt_pk_bf16_f32 v42, v44, v45
    v_cvt_pk_bf16_f32 v43, v46, v47
    s_nop 0
    v_permlane16_swap_b32 v40, v42
    v_permlane16_swap_b32 v41, v43
    v_dot2_f32_bf16 v48, v220, s78, v48
    v_dot2_f32_bf16 v49, v220, s79, v49
    v_dot2_f32_bf16 v50, v221, s78, v50
    v_dot2_f32_bf16 v51, v221, s79, v51
    v_dot2_f32_bf16 v52, v222, s78, v52
    v_dot2_f32_bf16 v53, v222, s79, v53
    v_dot2_f32_bf16 v54, v223, s78, v54
    v_dot2_f32_bf16 v55, v223, s79, v55
    v_cvt_pk_bf16_f32 v48, v48, v49
    v_cvt_pk_bf16_f32 v49, v50, v51
    v_cvt_pk_bf16_f32 v50, v52, v53
    v_cvt_pk_bf16_f32 v51, v54, v55
    s_nop 0
    v_permlane16_swap_b32 v48, v50
    v_permlane16_swap_b32 v49, v51
    v_mov_b32 v52, v40
    v_mov_b32 v53, v41
    v_mov_b32 v54, v42
    v_mov_b32 v55, v43
    v_mov_b32_dpp v40, v48 row_ror:8 row_mask:0xf bank_mask:0xc
    v_mov_b32_dpp v41, v49 row_ror:8 row_mask:0xf bank_mask:0xc
    v_mov_b32_dpp v42, v50 row_ror:8 row_mask:0xf bank_mask:0xc
    v_mov_b32_dpp v43, v51 row_ror:8 row_mask:0xf bank_mask:0xc
    v_mov_b32_dpp v48, v52 row_ror:8 row_mask:0xf bank_mask:0x3
    v_mov_b32_dpp v49, v53 row_ror:8 row_mask:0xf bank_mask:0x3
    v_mov_b32_dpp v50, v54 row_ror:8 row_mask:0xf bank_mask:0x3
    v_mov_b32_dpp v51, v55 row_ror:8 row_mask:0xf bank_mask:0x3
    buffer_store_dwordx4 v[40:43], v224, s[20:23], s47 offen sc1
    buffer_store_dwordx4 v[48:51], v225, s[20:23], s47 offen sc1
    s_branch K_fin
LOADERS:
    s_cmp_lg_u32 s60, 0
    s_cbranch_scc1 pr_31
    s_and_b32 s36, s29, 6
    s_cmp_eq_u32 s36, 2
    s_cbranch_scc0 pr_31
    s_call_b64 s[76:77], SUB_park2
pr_31:
    s_cmp_ge_u32 s30, 6
    s_cbranch_scc1 WLOAD
    s_add_u32 s54, s55, 0x500
    v_mov_b32 v222, s54
    s_lshl_b32 s53, s29, 7
    s_add_u32 s53, s53, 23121920
    v_mov_b32 v226, s53
    s_sleep 30
    s_mov_b64 exec, 1
    buffer_load_dword v227, v226, s[56:59], 0 offen sc1
    s_mov_b64 exec, -1
    s_waitcnt vmcnt(0)
    v_readfirstlane_b32 s53, v227
    s_add_u32 s54, s52, 16
    s_cmp_eq_u32 s53, s54
    s_cbranch_scc1 fok_32
    s_mov_b32 s53, 0
    s_add_u32 s54, s52, 16
    s_bfm_b64 exec, 1, 0
poll_33:
    buffer_load_dword v227, v226, s[56:59], 0 offen sc1
    s_waitcnt vmcnt(0)
    v_xor_b32 v227, s54, v227
    v_cmp_eq_u32 vcc, 0, v227
    s_nop 0
    s_cmp_eq_u64 vcc, exec
    s_cbranch_scc1 pok_34
    s_sleep 5
    s_add_u32 s53, s53, 1
    s_cmp_lt_u32 s53, s61
    s_cbranch_scc1 poll_33
    s_mov_b32 s61, 0
pok_34:
    s_mov_b64 exec, -1
fok_32:
    s_add_u32 s24, s4, 0x1400000
    s_addc_u32 s25, s5, 0
    s_mov_b32 s26, 0x20000
    s_mov_b32 s27, 0x20000
    s_cmp_eq_u32 s60, 0
    s_cselect_b32 s26, s26, 0
    s_and_b32 s36, s30, 1
    s_mul_i32 s36, s36, 128
    s_mul_i32 s37, s29, 256
    s_add_u32 s37, s36, s37
    v_lshrrev_b32 v224, 3, v1
    v_mul_u32_u24 v224, 4096, v224
    v_and_b32 v23, 112, v2
    v_add_u32 v224, v224, v23
    s_cmp_eq_u32 s60, 0
    s_cselect_b64 exec, -1, 0
    buffer_load_dwordx4 v[24:27], v224, s[24:27], s37 offen sc1
    s_add_u32 s37, s37, 32768
    buffer_load_dwordx4 v[28:31], v224, s[24:27], s37 offen sc1
    s_add_u32 s37, s37, 32768
    buffer_load_dwordx4 v[32:35], v224, s[24:27], s37 offen sc1
    s_add_u32 s37, s37, 32768
    buffer_load_dwordx4 v[36:39], v224, s[24:27], s37 offen sc1
    s_add_u32 s37, s37, 32768
    s_mov_b64 exec, -1
    s_mov_b64 exec, 1
    buffer_load_dword v223, v222, s[56:59], 0 offen sc1
    s_mov_b64 exec, -1
    s_waitcnt vmcnt(0)
    v_readfirstlane_b32 s53, v223
    s_add_u32 s54, s52, 16
    s_cmp_eq_u32 s53, s54
    s_cbranch_scc1 fok_35
    s_mov_b32 s53, 0
    s_add_u32 s54, s52, 16
    s_bfm_b64 exec, 1, 0
poll_36:
    buffer_load_dword v223, v222, s[56:59], 0 offen sc1
    s_waitcnt vmcnt(0)
    v_xor_b32 v223, s54, v223
    v_cmp_eq_u32 vcc, 0, v223
    s_nop 0
    s_cmp_eq_u64 vcc, exec
    s_cbranch_scc1 pok_37
    s_sleep 5
    s_add_u32 s53, s53, 1
    s_cmp_lt_u32 s53, s61
    s_cbranch_scc1 poll_36
    s_mov_b32 s61, 0
pok_37:
    s_mov_b64 exec, -1
fok_35:
    s_add_u32 s20, s62, 0x5d0000
    s_addc_u32 s21, s63, 0
    s_mov_b32 s22, 0x800
    s_mov_b32 s23, 0x20000
    s_and_b32 s35, s30, 1
    s_lshl_b32 s35, s35, 10
    buffer_load_dwordx4 v[16:19], v2, s[20:23], s35 offen sc1
    s_cmp_lg_u32 s60, 0
    s_cbranch_scc1 pc_38
    v_add_f32 v24, v24, v28
    v_add_f32 v25, v25, v29
    v_add_f32 v26, v26, v30
    v_add_f32 v27, v27, v31
    v_add_f32 v24, v24, v32
    v_add_f32 v25, v25, v33
    v_add_f32 v26, v26, v34
    v_add_f32 v27, v27, v35
    v_add_f32 v24, v24, v36
    v_add_f32 v25, v25, v37
    v_add_f32 v26, v26, v38
    v_add_f32 v27, v27, v39
    v_add_f32_dpp v24, v24, v24 row_ror:8 row_mask:0xf bank_mask:0xf
    v_add_f32_dpp v25, v25, v25 row_ror:8 row_mask:0xf bank_mask:0xf
    v_add_f32_dpp v26, v26, v26 row_ror:8 row_mask:0xf bank_mask:0xf
    v_add_f32_dpp v27, v27, v27 row_ror:8 row_mask:0xf bank_mask:0xf
    v_mov_b32 v28, v24
    v_mov_b32 v29, v25
    v_mov_b32 v30, v26
    v_mov_b32 v31, v27
    v_permlane16_swap_b32 v24, v28
    v_permlane16_swap_b32 v25, v29
    v_permlane16_swap_b32 v26, v30
    v_permlane16_swap_b32 v27, v31
    v_add_f32 v24, v24, v28
    v_add_f32 v25, v25, v29
    v_add_f32 v26, v26, v30
    v_add_f32 v27, v27, v31
    v_mov_b32 v28, v24
    v_mov_b32 v29, v25
    v_mov_b32 v30, v26
    v_mov_b32 v31, v27
    v_permlane32_swap_b32 v24, v28
    v_permlane32_swap_b32 v25, v29
    v_permlane32_swap_b32 v26, v30
    v_permlane32_swap_b32 v27, v31
    v_add_f32 v24, v24, v28
    v_add_f32 v25, v25, v29
    v_add_f32 v26, v26, v30
    v_add_f32 v27, v27, v31
pc_38:
    s_cmp_lg_u32 s60, 0
    s_cbranch_scc1 pc_39
    s_and_b32 s36, s30, 1
    s_mul_i32 s36, s36, 128
    s_add_u32 s36, s36, 163328
    v_add_u32 v23, s36, v2
    s_bfm_b64 exec, 8, 0
    ds_write_b128 v23, v[24:27]
    s_mov_b64 exec, -1
    s_waitcnt lgkmcnt(0)
pc_39:
    s_waitcnt vmcnt(0)
    s_and_b32 s36, s30, 1
    s_lshl_b32 s36, s36, 10
    s_add_u32 s36, s36, 160768
    v_add_u32 v221, s36, v2
    ds_write_b128 v221, v[16:19]
    s_waitcnt lgkmcnt(0)
    s_cmp_lg_u32 s30, 4
    s_cbranch_scc1 AL_nw
    s_cmp_eq_u32 s60, 0
    s_cbranch_scc1 AL_nw
    s_add_u32 s54, s55, 0xffc00300
    s_add_u32 s53, s54, s92
    v_mov_b32 v9, s53
    s_add_u32 s53, s53, 128
    v_writelane_b32 v9, s53, 1
    s_add_u32 s53, s54, s93
    v_writelane_b32 v9, s53, 2
    s_add_u32 s53, s53, 128
    v_writelane_b32 v9, s53, 3
    s_mov_b32 s53, 0
    s_add_u32 s54, s52, 8
    s_bfm_b64 exec, 4, 0
poll_41:
    buffer_load_dword v8, v9, s[56:59], 0 offen sc1
    s_waitcnt vmcnt(0)
    v_xor_b32 v8, s54, v8
    v_cmp_eq_u32 vcc, 0, v8
    s_nop 0
    s_cmp_eq_u64 vcc, exec
    s_cbranch_scc1 pok_42
    s_sleep 5
    s_add_u32 s53, s53, 1
    s_cmp_lt_u32 s53, s61
    s_cbranch_scc1 poll_41
    s_mov_b32 s61, 0
pok_42:
    s_mov_b64 exec, -1
AL_nw:
    s_barrier
    s_call_b64 s[76:77], SUB_after_g1
    s_barrier
    s_waitcnt vmcnt(0)
    s_barrier
    s_call_b64 s[76:77], SUB_after_g2
    s_and_b32 s35, s30, 1
    s_add_u32 s12, s62, 0x80000
    s_addc_u32 s13, s63, 0
    s_mov_b32 s14, 0x7e000
    s_mov_b32 s15, 0x20000
    s_mul_i32 s38, s35, 262144
    s_lshl_b32 s41, s35, 13
    s_mov_b32 s42, 0
    s_mov_b32 s44, 0
    s_add_u32 s54, s55, 0x200
    v_mov_b32 v9, s54
    s_mov_b32 s44, 1
    s_mov_b32 s42, 16384
    s_add_u32 s54, s55, 0x580
    v_mov_b32 v222, s54
    v_lshlrev_b32 v221, 3, v1
    s_add_u32 s19, s41, s42
    v_readlane_b32 s16, v248, s44
    s_nop 0
    s_add_u32 s16, s16, s38
    s_add_u32 s44, s44, 1
    s_and_b32 s44, s44, 15
    s_add_u32 s42, s42, 16384
    s_cmp_eq_u32 s42, 49152
    s_cselect_b32 s42, 0, s42
    s_mov_b32 m0, s19
    s_mov_b32 s39, s16
    s_waitcnt vmcnt(63)
    s_barrier
    s_sleep 6
    s_mov_b32 s53, 0
    s_add_u32 s54, s52, 16
    s_bfm_b64 exec, 1, 0
poll_43:
    buffer_load_dword v8, v9, s[56:59], 0 offen sc1
    s_waitcnt vmcnt(0)
    v_xor_b32 v8, s54, v8
    v_cmp_eq_u32 vcc, 0, v8
    s_nop 0
    s_cmp_eq_u64 vcc, exec
    s_cbranch_scc1 pok_44
    s_sleep 5
    s_add_u32 s53, s53, 1
    s_cmp_lt_u32 s53, s61
    s_cbranch_scc1 poll_43
    s_mov_b32 s61, 0
pok_44:
    s_mov_b64 exec, -1
    buffer_load_dwordx4 v2, s[12:15], s39 offen sc1 lds
    buffer_load_dwordx4 v2, s[12:15], s39 offen offset:1024 sc1 lds
    s_add_u32 s19, s41, s42
    v_readlane_b32 s16, v248, s44
    s_nop 0
    s_add_u32 s16, s16, s38
    s_add_u32 s44, s44, 1
    s_and_b32 s44, s44, 15
    s_add_u32 s42, s42, 16384
    s_cmp_eq_u32 s42, 49152
    s_cselect_b32 s42, 0, s42
    s_add_u32 m0, m0, 2048
    s_add_u32 s39, s39, 65536
    buffer_load_dwordx4 v2, s[12:15], s39 offen sc1 lds
    buffer_load_dwordx4 v2, s[12:15], s39 offen offset:1024 sc1 lds
    s_add_u32 m0, m0, 2048
    s_add_u32 s39, s39, 65536
    buffer_load_dwordx4 v2, s[12:15], s39 offen sc1 lds
    buffer_load_dwordx4 v2, s[12:15], s39 offen offset:1024 sc1 lds
    s_add_u32 m0, m0, 2048
    s_add_u32 s39, s39, 65536
    buffer_load_dwordx4 v2, s[12:15], s39 offen sc1 lds
    buffer_load_dwordx4 v2, s[12:15], s39 offen offset:1024 sc1 lds
    s_mov_b32 m0, s19
    s_mov_b32 s39, s16
    buffer_load_dwordx4 v2, s[12:15], s39 offen sc1 lds
    buffer_load_dwordx4 v2, s[12:15], s39 offen offset:1024 sc1 lds
    s_add_u32 s19, s41, s42
    v_readlane_b32 s16, v248, s44
    s_nop 0
    s_add_u32 s16, s16, s38
    s_add_u32 s44, s44, 1
    s_and_b32 s44, s44, 15
    s_add_u32 s42, s42, 16384
    s_cmp_eq_u32 s42, 49152
    s_cselect_b32 s42, 0, s42
    s_add_u32 m0, m0, 2048
    s_add_u32 s39, s39, 65536
    buffer_load_dwordx4 v2, s[12:15], s39 offen sc1 lds
    buffer_load_dwordx4 v2, s[12:15], s39 offen offset:1024 sc1 lds
    s_add_u32 m0, m0, 2048
    s_add_u32 s39, s39, 65536
    buffer_load_dwordx4 v2, s[12:15], s39 offen sc1 lds
    buffer_load_dwordx4 v2, s[12:15], s39 offen offset:1024 sc1 lds
    s_add_u32 m0, m0, 2048
    s_add_u32 s39, s39, 65536
    buffer_load_dwordx4 v2, s[12:15], s39 offen sc1 lds
    buffer_load_dwordx4 v2, s[12:15], s39 offen offset:1024 sc1 lds
    s_mov_b32 m0, s19
    s_mov_b32 s39, s16
    s_waitcnt vmcnt(8)
    s_barrier
    buffer_load_dwordx4 v2, s[12:15], s39 offen sc1 lds
    buffer_load_dwordx4 v2, s[12:15], s39 offen offset:1024 sc1 lds
    s_add_u32 s19, s41, s42
    v_readlane_b32 s16, v248, s44
    s_nop 0
    s_add_u32 s16, s16, s38
    s_add_u32 s44, s44, 1
    s_and_b32 s44, s44, 15
    s_add_u32 s42, s42, 16384
    s_cmp_eq_u32 s42, 49152
    s_cselect_b32 s42, 0, s42
    s_add_u32 m0, m0, 2048
    s_add_u32 s39, s39, 65536
    buffer_load_dwordx4 v2, s[12:15], s39 offen sc1 lds
    buffer_load_dwordx4 v2, s[12:15], s39 offen offset:1024 sc1 lds
    s_add_u32 m0, m0, 2048
    s_add_u32 s39, s39, 65536
    buffer_load_dwordx4 v2, s[12:15], s39 offen sc1 lds
    buffer_load_dwordx4 v2, s[12:15], s39 offen offset:1024 sc1 lds
    s_add_u32 m0, m0, 2048
    s_add_u32 s39, s39, 65536
    buffer_load_dwordx4 v2, s[12:15], s39 offen sc1 lds
    buffer_load_dwordx4 v2, s[12:15], s39 offen offset:1024 sc1 lds
    s_mov_b32 m0, s19
    s_mov_b32 s39, s16
    s_add_u32 s24, s4, 0x1420000
    s_addc_u32 s25, s5, 0
    s_mov_b32 s26, 0x70000
    s_mov_b32 s27, 0x20000
    s_cmp_eq_u32 s60, 0
    s_cselect_b32 s26, s26, 0
    s_and_b32 s36, s30, 1
    s_mul_i32 s36, s36, 448
    s_mul_i32 s37, s29, 896
    s_add_u32 s37, s36, s37
    v_lshrrev_b32 v224, 5, v1
    v_mul_u32_u24 v224, 14336, v224
    v_and_b32 v179, 496, v2
    v_add_u32 v224, v224, v179
    s_cmp_eq_u32 s60, 0
    s_cselect_b64 exec, -1, 0
    buffer_load_dwordx4 v[180:183], v224, s[24:27], s37 offen sc1
    s_add_u32 s37, s37, 28672
    buffer_load_dwordx4 v[184:187], v224, s[24:27], s37 offen sc1
    s_add_u32 s37, s37, 28672
    buffer_load_dwordx4 v[188:191], v224, s[24:27], s37 offen sc1
    s_add_u32 s37, s37, 28672
    s_mov_b64 exec, -1
    s_waitcnt vmcnt(11)
    s_barrier
    buffer_load_dwordx4 v2, s[12:15], s39 offen sc1 lds
    buffer_load_dwordx4 v2, s[12:15], s39 offen offset:1024 sc1 lds
    s_add_u32 s19, s41, s42
    v_readlane_b32 s16, v248, s44
    s_nop 0
    s_add_u32 s16, s16, s38
    s_add_u32 s44, s44, 1
    s_and_b32 s44, s44, 15
    s_add_u32 s42, s42, 16384
    s_cmp_eq_u32 s42, 49152
    s_cselect_b32 s42, 0, s42
    s_add_u32 m0, m0, 2048
    s_add_u32 s39, s39, 65536
    buffer_load_dwordx4 v2, s[12:15], s39 offen sc1 lds
    buffer_load_dwordx4 v2, s[12:15], s39 offen offset:1024 sc1 lds
    s_add_u32 m0, m0, 2048
    s_add_u32 s39, s39, 65536
    buffer_load_dwordx4 v2, s[12:15], s39 offen sc1 lds
    buffer_load_dwordx4 v2, s[12:15], s39 offen offset:1024 sc1 lds
    s_add_u32 m0, m0, 2048
    s_add_u32 s39, s39, 65536
    buffer_load_dwordx4 v2, s[12:15], s39 offen sc1 lds
    buffer_load_dwordx4 v2, s[12:15], s39 offen offset:1024 sc1 lds
    s_mov_b32 m0, s19
    s_mov_b32 s39, s16
    s_cmp_eq_u32 s60, 0
    s_cselect_b64 exec, -1, 0
    buffer_load_dwordx4 v[192:195], v224, s[24:27], s37 offen sc1
    s_add_u32 s37, s37, 28672
    buffer_load_dwordx4 v[196:199], v224, s[24:27], s37 offen sc1
    s_add_u32 s37, s37, 28672
    buffer_load_dwordx4 v[200:203], v224, s[24:27], s37 offen sc1
    s_add_u32 s37, s37, 28672
    s_mov_b64 exec, -1
    s_waitcnt vmcnt(14)
    s_barrier
    buffer_load_dwordx4 v2, s[12:15], s39 offen sc1 lds
    buffer_load_dwordx4 v2, s[12:15], s39 offen offset:1024 sc1 lds
    s_add_u32 s19, s41, s42
    v_readlane_b32 s16, v248, s44
    s_nop 0
    s_add_u32 s16, s16, s38
    s_add_u32 s44, s44, 1
    s_and_b32 s44, s44, 15
    s_add_u32 s42, s42, 16384
    s_cmp_eq_u32 s42, 49152
    s_cselect_b32 s42, 0, s42
    s_add_u32 m0, m0, 2048
    s_add_u32 s39, s39, 65536
    buffer_load_dwordx4 v2, s[12:15], s39 offen sc1 lds
    buffer_load_dwordx4 v2, s[12:15], s39 offen offset:1024 sc1 lds
    s_add_u32 m0, m0, 2048
    s_add_u32 s39, s39, 65536
    buffer_load_dwordx4 v2, s[12:15], s39 offen sc1 lds
    buffer_load_dwordx4 v2, s[12:15], s39 offen offset:1024 sc1 lds
    s_add_u32 m0, m0, 2048
    s_add_u32 s39, s39, 65536
    buffer_load_dwordx4 v2, s[12:15], s39 offen sc1 lds
    buffer_load_dwordx4 v2, s[12:15], s39 offen offset:1024 sc1 lds
    s_mov_b32 m0, s19
    s_mov_b32 s39, s16
    s_cmp_eq_u32 s60, 0
    s_cselect_b64 exec, -1, 0
    buffer_load_dwordx4 v[204:207], v224, s[24:27], s37 offen sc1
    s_add_u32 s37, s37, 28672
    buffer_load_dwordx4 v[208:211], v224, s[24:27], s37 offen sc1
    s_add_u32 s37, s37, 28672
    buffer_load_dwordx4 v[212:215], v224, s[24:27], s37 offen sc1
    s_add_u32 s37, s37, 28672
    s_mov_b64 exec, -1
    s_mov_b64 exec, 1
    buffer_load_dword v223, v222, s[56:59], 0 offen sc1
    s_mov_b64 exec, -1
    s_waitcnt vmcnt(15)
    s_barrier
    buffer_load_dwordx4 v2, s[12:15], s39 offen sc1 lds
    buffer_load_dwordx4 v2, s[12:15], s39 offen offset:1024 sc1 lds
    s_add_u32 s19, s41, s42
    v_readlane_b32 s16, v248, s44
    s_nop 0
    s_add_u32 s16, s16, s38
    s_add_u32 s44, s44, 1
    s_and_b32 s44, s44, 15
    s_add_u32 s42, s42, 16384
    s_cmp_eq_u32 s42, 49152
    s_cselect_b32 s42, 0, s42
    s_add_u32 m0, m0, 2048
    s_add_u32 s39, s39, 65536
    buffer_load_dwordx4 v2, s[12:15], s39 offen sc1 lds
    buffer_load_dwordx4 v2, s[12:15], s39 offen offset:1024 sc1 lds
    s_add_u32 m0, m0, 2048
    s_add_u32 s39, s39, 65536
    buffer_load_dwordx4 v2, s[12:15], s39 offen sc1 lds
    buffer_load_dwordx4 v2, s[12:15], s39 offen offset:1024 sc1 lds
    s_add_u32 m0, m0, 2048
    s_add_u32 s39, s39, 65536
    buffer_load_dwordx4 v2, s[12:15], s39 offen sc1 lds
    buffer_load_dwordx4 v2, s[12:15], s39 offen offset:1024 sc1 lds
    s_mov_b32 m0, s19
    s_mov_b32 s39, s16
    s_waitcnt vmcnt(12)
    s_barrier
    buffer_load_dwordx4 v2, s[12:15], s39 offen sc1 lds
    buffer_load_dwordx4 v2, s[12:15], s39 offen offset:1024 sc1 lds
    s_add_u32 s19, s41, s42
    v_readlane_b32 s16, v248, s44
    s_nop 0
    s_add_u32 s16, s16, s38
    s_add_u32 s44, s44, 1
    s_and_b32 s44, s44, 15
    s_add_u32 s42, s42, 16384
    s_cmp_eq_u32 s42, 49152
    s_cselect_b32 s42, 0, s42
    s_add_u32 m0, m0, 2048
    s_add_u32 s39, s39, 65536
    buffer_load_dwordx4 v2, s[12:15], s39 offen sc1 lds
    buffer_load_dwordx4 v2, s[12:15], s39 offen offset:1024 sc1 lds
    s_add_u32 m0, m0, 2048
    s_add_u32 s39, s39, 65536
    buffer_load_dwordx4 v2, s[12:15], s39 offen sc1 lds
    buffer_load_dwordx4 v2, s[12:15], s39 offen offset:1024 sc1 lds
    s_add_u32 m0, m0, 2048
    s_add_u32 s39, s39, 65536
    buffer_load_dwordx4 v2, s[12:15], s39 offen sc1 lds
    buffer_load_dwordx4 v2, s[12:15], s39 offen offset:1024 sc1 lds
    s_mov_b32 m0, s19
    s_mov_b32 s39, s16
    s_waitcnt vmcnt(16)
    v_readfirstlane_b32 s53, v223
    s_add_u32 s54, s52, 16
    s_cmp_eq_u32 s53, s54
    s_cbranch_scc1 fok_45
    s_mov_b32 s53, 0
    s_add_u32 s54, s52, 16
    s_bfm_b64 exec, 1, 0
poll_46:
    buffer_load_dword v223, v222, s[56:59], 0 offen sc1
    s_waitcnt vmcnt(0)
    v_xor_b32 v223, s54, v223
    v_cmp_eq_u32 vcc, 0, v223
    s_nop 0
    s_cmp_eq_u64 vcc, exec
    s_cbranch_scc1 pok_47
    s_sleep 5
    s_add_u32 s53, s53, 1
    s_cmp_lt_u32 s53, s61
    s_cbranch_scc1 poll_46
    s_mov_b32 s61, 0
pok_47:
    s_mov_b64 exec, -1
fok_45:
    s_add_u32 s20, s62, 0x5c8000
    s_addc_u32 s21, s63, 0
    s_mov_b32 s22, 0x6000
    s_mov_b32 s23, 0x20000
    s_and_b32 s35, s30, 1
    s_lshl_b32 s35, s35, 9
    s_add_u32 s36, s35, 0
    buffer_load_dwordx2 v[16:17], v221, s[20:23], s36 offen offset:0 sc1
    buffer_load_dwordx2 v[18:19], v221, s[20:23], s36 offen offset:1024 sc1
    buffer_load_dwordx2 v[20:21], v221, s[20:23], s36 offen offset:2048 sc1
    buffer_load_dwordx2 v[22:23], v221, s[20:23], s36 offen offset:3072 sc1
    s_cmp_lg_u32 s60, 0
    s_cbranch_scc1 pc_48
    v_add_f32 v180, v180, v184
    v_add_f32 v181, v181, v185
    v_add_f32 v182, v182, v186
    v_add_f32 v183, v183, v187
    v_add_f32 v180, v180, v188
    v_add_f32 v181, v181, v189
    v_add_f32 v182, v182, v190
    v_add_f32 v183, v183, v191
    v_add_f32 v180, v180, v192
    v_add_f32 v181, v181, v193
    v_add_f32 v182, v182, v194
    v_add_f32 v183, v183, v195
    v_add_f32 v180, v180, v196
    v_add_f32 v181, v181, v197
    v_add_f32 v182, v182, v198
    v_add_f32 v183, v183, v199
pc_48:
    s_waitcnt vmcnt(12)
    s_barrier
    buffer_load_dwordx4 v2, s[12:15], s39 offen sc1 lds
    buffer_load_dwordx4 v2, s[12:15], s39 offen offset:1024 sc1 lds
    s_add_u32 s19, s41, s42
    v_readlane_b32 s16, v248, s44
    s_nop 0
    s_add_u32 s16, s16, s38
    s_add_u32 s44, s44, 1
    s_and_b32 s44, s44, 15
    s_add_u32 s42, s42, 16384
    s_cmp_eq_u32 s42, 49152
    s_cselect_b32 s42, 0, s42
    s_add_u32 m0, m0, 2048
    s_add_u32 s39, s39, 65536
    buffer_load_dwordx4 v2, s[12:15], s39 offen sc1 lds
    buffer_load_dwordx4 v2, s[12:15], s39 offen offset:1024 sc1 lds
    s_add_u32 m0, m0, 2048
    s_add_u32 s39, s39, 65536
    buffer_load_dwordx4 v2, s[12:15], s39 offen sc1 lds
    buffer_load_dwordx4 v2, s[12:15], s39 offen offset:1024 sc1 lds
    s_add_u32 m0, m0, 2048
    s_add_u32 s39, s39, 65536
    buffer_load_dwordx4 v2, s[12:15], s39 offen sc1 lds
    buffer_load_dwordx4 v2, s[12:15], s39 offen offset:1024 sc1 lds
    s_mov_b32 m0, s19
    s_mov_b32 s39, s16
    s_add_u32 s36, s35, 4096
    buffer_load_dwordx2 v[24:25], v221, s[20:23], s36 offen offset:0 sc1
    buffer_load_dwordx2 v[26:27], v221, s[20:23], s36 offen offset:1024 sc1
    buffer_load_dwordx2 v[28:29], v221, s[20:23], s36 offen offset:2048 sc1
    buffer_load_dwordx2 v[30:31], v221, s[20:23], s36 offen offset:3072 sc1
    s_cmp_lg_u32 s60, 0
    s_cbranch_scc1 pc_49
    v_add_f32 v180, v180, v200
    v_add_f32 v181, v181, v201
    v_add_f32 v182, v182, v202
    v_add_f32 v183, v183, v203
    v_add_f32 v180, v180, v204
    v_add_f32 v181, v181, v205
    v_add_f32 v182, v182, v206
    v_add_f32 v183, v183, v207
    v_add_f32 v180, v180, v208
    v_add_f32 v181, v181, v209
    v_add_f32 v182, v182, v210
    v_add_f32 v183, v183, v211
    v_add_f32 v180, v180, v212
    v_add_f32 v181, v181, v213
    v_add_f32 v182, v182, v214
    v_add_f32 v183, v183, v215
pc_49:
    s_cmp_eq_u32 s60, 0
    s_cselect_b64 exec, -1, 0
    buffer_load_dwordx4 v[184:187], v224, s[24:27], s37 offen sc1
    s_add_u32 s37, s37, 28672
    buffer_load_dwordx4 v[188:191], v224, s[24:27], s37 offen sc1
    s_add_u32 s37, s37, 28672
    buffer_load_dwordx4 v[192:195], v224, s[24:27], s37 offen sc1
    s_add_u32 s37, s37, 28672
    s_mov_b64 exec, -1
    s_waitcnt vmcnt(19)
    s_barrier
    buffer_load_dwordx4 v2, s[12:15], s39 offen sc1 lds
    buffer_load_dwordx4 v2, s[12:15], s39 offen offset:1024 sc1 lds
    s_add_u32 s19, s41, s42
    v_readlane_b32 s16, v248, s44
    s_nop 0
    s_add_u32 s16, s16, s38
    s_add_u32 s44, s44, 1
    s_and_b32 s44, s44, 15
    s_add_u32 s42, s42, 16384
    s_cmp_eq_u32 s42, 49152
    s_cselect_b32 s42, 0, s42
    s_add_u32 m0, m0, 2048
    s_add_u32 s39, s39, 65536
    buffer_load_dwordx4 v2, s[12:15], s39 offen sc1 lds
    buffer_load_dwordx4 v2, s[12:15], s39 offen offset:1024 sc1 lds
    s_add_u32 m0, m0, 2048
    s_add_u32 s39, s39, 65536
    buffer_load_dwordx4 v2, s[12:15], s39 offen sc1 lds
    buffer_load_dwordx4 v2, s[12:15], s39 offen offset:1024 sc1 lds
    s_add_u32 m0, m0, 2048
    s_add_u32 s39, s39, 65536
    buffer_load_dwordx4 v2, s[12:15], s39 offen sc1 lds
    buffer_load_dwordx4 v2, s[12:15], s39 offen offset:1024 sc1 lds
    s_mov_b32 m0, s19
    s_mov_b32 s39, s16
    s_add_u32 s36, s35, 16384
    buffer_load_dwordx2 v[32:33], v221, s[20:23], s36 offen offset:0 sc1
    buffer_load_dwordx2 v[34:35], v221, s[20:23], s36 offen offset:1024 sc1
    buffer_load_dwordx2 v[36:37], v221, s[20:23], s36 offen offset:2048 sc1
    buffer_load_dwordx2 v[38:39], v221, s[20:23], s36 offen offset:3072 sc1
    s_cmp_eq_u32 s60, 0
    s_cselect_b64 exec, -1, 0
    buffer_load_dwordx4 v[196:199], v224, s[24:27], s37 offen sc1
    s_add_u32 s37, s37, 28672
    buffer_load_dwordx4 v[200:203], v224, s[24:27], s37 offen sc1
    s_add_u32 s37, s37, 28672
    s_mov_b64 exec, -1
    s_waitcnt vmcnt(21)
    s_barrier
    buffer_load_dwordx4 v2, s[12:15], s39 offen sc1 lds
    buffer_load_dwordx4 v2, s[12:15], s39 offen offset:1024 sc1 lds
    s_add_u32 s19, s41, s42
    v_readlane_b32 s16, v248, s44
    s_nop 0
    s_add_u32 s16, s16, s38
    s_add_u32 s44, s44, 1
    s_and_b32 s44, s44, 15
    s_add_u32 s42, s42, 16384
    s_cmp_eq_u32 s42, 49152
    s_cselect_b32 s42, 0, s42
    s_add_u32 m0, m0, 2048
    s_add_u32 s39, s39, 65536
    buffer_load_dwordx4 v2, s[12:15], s39 offen sc1 lds
    buffer_load_dwordx4 v2, s[12:15], s39 offen offset:1024 sc1 lds
    s_add_u32 m0, m0, 2048
    s_add_u32 s39, s39, 65536
    buffer_load_dwordx4 v2, s[12:15], s39 offen sc1 lds
    buffer_load_dwordx4 v2, s[12:15], s39 offen offset:1024 sc1 lds
    s_add_u32 m0, m0, 2048
    s_add_u32 s39, s39, 65536
    buffer_load_dwordx4 v2, s[12:15], s39 offen sc1 lds
    buffer_load_dwordx4 v2, s[12:15], s39 offen offset:1024 sc1 lds
    s_mov_b32 m0, s19
    s_mov_b32 s39, s16
    s_add_u32 s36, s35, 20480
    buffer_load_dwordx2 v[40:41], v221, s[20:23], s36 offen offset:0 sc1
    buffer_load_dwordx2 v[42:43], v221, s[20:23], s36 offen offset:1024 sc1
    buffer_load_dwordx2 v[44:45], v221, s[20:23], s36 offen offset:2048 sc1
    buffer_load_dwordx2 v[46:47], v221, s[20:23], s36 offen offset:3072 sc1
    s_cmp_eq_u32 s60, 0
    s_cselect_b64 exec, -1, 0
    buffer_load_dwordx4 v[204:207], v224, s[24:27], s37 offen sc1
    s_add_u32 s37, s37, 28672
    buffer_load_dwordx4 v[208:211], v224, s[24:27], s37 offen sc1
    s_add_u32 s37, s37, 28672
    s_mov_b64 exec, -1
    s_waitcnt vmcnt(20)
    s_barrier
    buffer_load_dwordx4 v2, s[12:15], s39 offen sc1 lds
    buffer_load_dwordx4 v2, s[12:15], s39 offen offset:1024 sc1 lds
    s_add_u32 s19, s41, s42
    v_readlane_b32 s16, v248, s44
    s_nop 0
    s_add_u32 s16, s16, s38
    s_add_u32 s44, s44, 1
    s_and_b32 s44, s44, 15
    s_add_u32 s42, s42, 16384
    s_cmp_eq_u32 s42, 49152
    s_cselect_b32 s42, 0, s42
    s_add_u32 m0, m0, 2048
    s_add_u32 s39, s39, 65536
    buffer_load_dwordx4 v2, s[12:15], s39 offen sc1 lds
    buffer_load_dwordx4 v2, s[12:15], s39 offen offset:1024 sc1 lds
    s_add_u32 m0, m0, 2048
    s_add_u32 s39, s39, 65536
    buffer_load_dwordx4 v2, s[12:15], s39 offen sc1 lds
    buffer_load_dwordx4 v2, s[12:15], s39 offen offset:1024 sc1 lds
    s_add_u32 m0, m0, 2048
    s_add_u32 s39, s39, 65536
    buffer_load_dwordx4 v2, s[12:15], s39 offen sc1 lds
    buffer_load_dwordx4 v2, s[12:15], s39 offen offset:1024 sc1 lds
    s_mov_b32 m0, s19
    s_mov_b32 s39, s16
    s_waitcnt vmcnt(14)
    s_barrier
    buffer_load_dwordx4 v2, s[12:15], s39 offen sc1 lds
    buffer_load_dwordx4 v2, s[12:15], s39 offen offset:1024 sc1 lds
    s_add_u32 s19, s41, s42
    v_readlane_b32 s16, v248, s44
    s_nop 0
    s_add_u32 s16, s16, s38
    s_add_u32 s44, s44, 1
    s_and_b32 s44, s44, 15
    s_add_u32 s42, s42, 16384
    s_cmp_eq_u32 s42, 49152
    s_cselect_b32 s42, 0, s42
    s_add_u32 m0, m0, 2048
    s_add_u32 s39, s39, 65536
    buffer_load_dwordx4 v2, s[12:15], s39 offen sc1 lds
    buffer_load_dwordx4 v2, s[12:15], s39 offen offset:1024 sc1 lds
    s_add_u32 m0, m0, 2048
    s_add_u32 s39, s39, 65536
    buffer_load_dwordx4 v2, s[12:15], s39 offen sc1 lds
    buffer_load_dwordx4 v2, s[12:15], s39 offen offset:1024 sc1 lds
    s_add_u32 m0, m0, 2048
    s_add_u32 s39, s39, 65536
    buffer_load_dwordx4 v2, s[12:15], s39 offen sc1 lds
    buffer_load_dwordx4 v2, s[12:15], s39 offen offset:1024 sc1 lds
    s_mov_b32 m0, s19
    s_mov_b32 s39, s16
    s_waitcnt vmcnt(16)
    v_add_f32 v16, v16, v32
    v_add_f32 v17, v17, v33
    v_add_f32 v18, v18, v34
    v_add_f32 v19, v19, v35
    v_add_f32 v20, v20, v36
    v_add_f32 v21, v21, v37
    v_add_f32 v22, v22, v38
    v_add_f32 v23, v23, v39
    v_add_f32 v24, v24, v40
    v_add_f32 v25, v25, v41
    v_add_f32 v26, v26, v42
    v_add_f32 v27, v27, v43
    v_add_f32 v28, v28, v44
    v_add_f32 v29, v29, v45
    v_add_f32 v30, v30, v46
    v_add_f32 v31, v31, v47
    s_waitcnt vmcnt(8)
    s_barrier
    buffer_load_dwordx4 v2, s[12:15], s39 offen sc1 lds
    buffer_load_dwordx4 v2, s[12:15], s39 offen offset:1024 sc1 lds
    s_add_u32 s19, s41, s42
    v_readlane_b32 s16, v248, s44
    s_nop 0
    s_add_u32 s16, s16, s38
    s_add_u32 s44, s44, 1
    s_and_b32 s44, s44, 15
    s_add_u32 s42, s42, 16384
    s_cmp_eq_u32 s42, 49152
    s_cselect_b32 s42, 0, s42
    s_add_u32 m0, m0, 2048
    s_add_u32 s39, s39, 65536
    buffer_load_dwordx4 v2, s[12:15], s39 offen sc1 lds
    buffer_load_dwordx4 v2, s[12:15], s39 offen offset:1024 sc1 lds
    s_add_u32 m0, m0, 2048
    s_add_u32 s39, s39, 65536
    buffer_load_dwordx4 v2, s[12:15], s39 offen sc1 lds
    buffer_load_dwordx4 v2, s[12:15], s39 offen offset:1024 sc1 lds
    s_add_u32 m0, m0, 2048
    s_add_u32 s39, s39, 65536
    buffer_load_dwordx4 v2, s[12:15], s39 offen sc1 lds
    buffer_load_dwordx4 v2, s[12:15], s39 offen offset:1024 sc1 lds
    s_mov_b32 m0, s19
    s_mov_b32 s39, s16
    v_add_f32 v16, v16, v24
    v_add_f32 v17, v17, v25
    v_add_f32 v18, v18, v26
    v_add_f32 v19, v19, v27
    v_add_f32 v20, v20, v28
    v_add_f32 v21, v21, v29
    v_add_f32 v22, v22, v30
    v_add_f32 v23, v23, v31
    v_add_f32 v16, v16, v20
    v_add_f32 v17, v17, v21
    v_add_f32 v18, v18, v22
    v_add_f32 v19, v19, v23
    v_add_f32 v16, v16, v18
    v_add_f32 v17, v17, v19
    v_mul_f32 v20, 0x3a800000, v16
    v_mul_f32 v217, 0x3a800000, v17
    s_cmp_lg_u32 s60, 0
    s_cbranch_scc1 pc_52
    v_add_f32 v180, v180, v184
    v_add_f32 v181, v181, v185
    v_add_f32 v182, v182, v186
    v_add_f32 v183, v183, v187
    v_add_f32 v180, v180, v188
    v_add_f32 v181, v181, v189
    v_add_f32 v182, v182, v190
    v_add_f32 v183, v183, v191
    v_add_f32 v180, v180, v192
    v_add_f32 v181, v181, v193
    v_add_f32 v182, v182, v194
    v_add_f32 v183, v183, v195
pc_52:
    s_waitcnt vmcnt(8)
    s_barrier
    buffer_load_dwordx4 v2, s[12:15], s39 offen sc1 lds
    buffer_load_dwordx4 v2, s[12:15], s39 offen offset:1024 sc1 lds
    s_add_u32 s19, s41, s42
    v_readlane_b32 s16, v248, s44
    s_nop 0
    s_add_u32 s16, s16, s38
    s_add_u32 s44, s44, 1
    s_and_b32 s44, s44, 15
    s_add_u32 s42, s42, 16384
    s_cmp_eq_u32 s42, 49152
    s_cselect_b32 s42, 0, s42
    s_add_u32 m0, m0, 2048
    s_add_u32 s39, s39, 65536
    buffer_load_dwordx4 v2, s[12:15], s39 offen sc1 lds
    buffer_load_dwordx4 v2, s[12:15], s39 offen offset:1024 sc1 lds
    s_add_u32 m0, m0, 2048
    s_add_u32 s39, s39, 65536
    buffer_load_dwordx4 v2, s[12:15], s39 offen sc1 lds
    buffer_load_dwordx4 v2, s[12:15], s39 offen offset:1024 sc1 lds
    s_add_u32 m0, m0, 2048
    s_add_u32 s39, s39, 65536
    buffer_load_dwordx4 v2, s[12:15], s39 offen sc1 lds
    buffer_load_dwordx4 v2, s[12:15], s39 offen offset:1024 sc1 lds
    s_mov_b32 m0, s19
    s_mov_b32 s39, s16
    v_fma_f32 v217, -v20, v20, v217
    v_max_f32 v217, 0, v217
    v_add_f32 v217, 0x3727c5ac, v217
    v_sqrt_f32 v217, v217
    s_nop 0
    v_mov_b32 v21, v217
    v_rcp_f32 v219, v217
    s_nop 0
    v_mul_f32 v22, 0xc0135761, v219
    v_mul_f32 v23, v219, v219
    v_mul_f32 v23, v23, v22
    v_mul_f32 v23, 0x3d372713, v23
    s_lshl_b32 s35, s35, 1
    s_add_u32 s35, s35, 160768
    v_add_u32 v220, s35, v2
    ds_write_b128 v220, v[20:23]
    s_waitcnt lgkmcnt(0)
    s_waitcnt vmcnt(8)
    s_barrier
    buffer_load_dwordx4 v2, s[12:15], s39 offen sc1 lds
    buffer_load_dwordx4 v2, s[12:15], s39 offen offset:1024 sc1 lds
    s_add_u32 m0, m0, 2048
    s_add_u32 s39, s39, 65536
    buffer_load_dwordx4 v2, s[12:15], s39 offen sc1 lds
    buffer_load_dwordx4 v2, s[12:15], s39 offen offset:1024 sc1 lds
    s_add_u32 m0, m0, 2048
    s_add_u32 s39, s39, 65536
    buffer_load_dwordx4 v2, s[12:15], s39 offen sc1 lds
    buffer_load_dwordx4 v2, s[12:15], s39 offen offset:1024 sc1 lds
    s_add_u32 m0, m0, 2048
    s_add_u32 s39, s39, 65536
    buffer_load_dwordx4 v2, s[12:15], s39 offen sc1 lds
    buffer_load_dwordx4 v2, s[12:15], s39 offen offset:1024 sc1 lds
    s_cmp_lg_u32 s60, 0
    s_cbranch_scc1 pc_54
    v_add_f32 v180, v180, v196
    v_add_f32 v181, v181, v197
    v_add_f32 v182, v182, v198
    v_add_f32 v183, v183, v199
    v_add_f32 v180, v180, v200
    v_add_f32 v181, v181, v201
    v_add_f32 v182, v182, v202
    v_add_f32 v183, v183, v203
    v_add_f32 v180, v180, v204
    v_add_f32 v181, v181, v205
    v_add_f32 v182, v182, v206
    v_add_f32 v183, v183, v207
    v_add_f32 v180, v180, v208
    v_add_f32 v181, v181, v209
    v_add_f32 v182, v182, v210
    v_add_f32 v183, v183, v211
pc_54:
    s_waitcnt vmcnt(8)
    s_barrier
    s_cmp_lg_u32 s60, 0
    s_cbranch_scc1 pc_55
    v_mov_b32 v184, v180
    v_mov_b32 v185, v181
    v_mov_b32 v186, v182
    v_mov_b32 v187, v183
    v_permlane32_swap_b32 v180, v184
    v_permlane32_swap_b32 v181, v185
    v_permlane32_swap_b32 v182, v186
    v_permlane32_swap_b32 v183, v187
    v_add_f32 v180, v180, v184
    v_add_f32 v181, v181, v185
    v_add_f32 v182, v182, v186
    v_add_f32 v183, v183, v187
    s_and_b32 s36, s30, 1
    s_mul_i32 s36, s36, 448
    s_add_u32 s36, s36, 159744
    v_add_u32 v179, s36, v2
    s_bfm_b64 exec, 28, 0
    ds_write_b128 v179, v[180:183]
    s_mov_b64 exec, -1
    s_waitcnt lgkmcnt(0)
pc_55:
    s_waitcnt vmcnt(0)
    s_barrier
    s_cmp_lg_u32 s60, 0
    s_cbranch_scc1 tw4_56
    s_load_dwordx2 s[48:49], s[0:1], 80
    s_lshl_b32 s45, s2, 1
    s_and_b32 s50, s30, 1
    s_add_u32 s45, s45, s50
    s_mul_i32 s45, s45, 14336
    s_mov_b32 s50, 7340032
    s_mov_b32 s51, 0x20000
    s_waitcnt lgkmcnt(0)
    buffer_load_dwordx4 v[20:23], v2, s[48:51], s45 offen offset:0
    buffer_load_dwordx4 v[20:23], v2, s[48:51], s45 offen offset:1024
    buffer_load_dwordx4 v[20:23], v2, s[48:51], s45 offen offset:2048
    buffer_load_dwordx4 v[20:23], v2, s[48:51], s45 offen offset:3072
    s_add_u32 s45, s45, 4096
    buffer_load_dwordx4 v[20:23], v2, s[48:51], s45 offen offset:0
    buffer_load_dwordx4 v[20:23], v2, s[48:51], s45 offen offset:1024
    buffer_load_dwordx4 v[20:23], v2, s[48:51], s45 offen offset:2048
    buffer_load_dwordx4 v[20:23], v2, s[48:51], s45 offen offset:3072
    s_add_u32 s45, s45, 4096
    buffer_load_dwordx4 v[20:23], v2, s[48:51], s45 offen offset:0
    buffer_load_dwordx4 v[20:23], v2, s[48:51], s45 offen offset:1024
    buffer_load_dwordx4 v[20:23], v2, s[48:51], s45 offen offset:2048
    buffer_load_dwordx4 v[20:23], v2, s[48:51], s45 offen offset:3072
    s_add_u32 s45, s45, 4096
    buffer_load_dwordx4 v[20:23], v2, s[48:51], s45 offen offset:0
    buffer_load_dwordx4 v[20:23], v2, s[48:51], s45 offen offset:1024
tw4_56:
    s_barrier
    s_cmp_lg_u32 s60, 0
    s_cbranch_scc1 rp_57
    s_call_b64 s[76:77], SUB_r_pre
rp_57:
    s_and_b32 s35, s30, 1
    s_add_u32 s12, s62, 0x400000
    s_addc_u32 s13, s63, 0
    s_mov_b32 s14, 0x1be000
    s_mov_b32 s15, 0x20000
    s_mul_i32 s38, s35, 917504
    s_mul_i32 s36, s31, 114688
    s_add_u32 s38, s38, s36
    s_lshl_b32 s41, s35, 13
    s_mov_b32 s42, 0
    s_mov_b32 s44, 0
    s_add_u32 s54, s55, 0x700
    s_lshl_b32 s53, s31, 7
    s_add_u32 s54, s54, s53
    v_mov_b32 v9, s54
    s_add_u32 s54, s55, 0x600
    s_lshl_b32 s53, s31, 7
    s_add_u32 s54, s54, s53
    v_mov_b32 v10, s54
    s_add_u32 s54, s55, 0x300
    s_lshl_b32 s53, s31, 7
    s_add_u32 s54, s54, s53
    v_mov_b32 v12, s54
    v_mov_b32 v13, 1
    s_and_b32 s51, s30, 1
    s_lshl_b32 s51, s51, 30
    s_lshl_b32 s54, s60, 2
    s_add_u32 s54, s54, 4
    v_mov_b32 v14, 162880
spin_58:
    s_sleep 2
    ds_read_b32 v15, v14
    s_waitcnt lgkmcnt(0)
    v_readfirstlane_b32 s53, v15
    s_nop 0
    s_cmp_ge_u32 s53, s54
    s_cbranch_scc0 spin_58
    s_mov_b64 exec, 1
    buffer_atomic_add v13, v9, s[56:59], s51 offen sc1
    s_mov_b64 exec, -1
    v_xor_b32 v15, 128, v12
    s_mov_b32 s44, 3
    s_call_b64 s[76:77], PREP_a_issue_4
    s_mov_b32 m0, s19
    s_mov_b32 s39, s16
    s_mov_b32 s40, s17
    s_waitcnt vmcnt(16)
    s_barrier
    s_mov_b64 exec, 1
    buffer_load_dword v8, v9, s[56:59], 0 offen sc1
    s_mov_b64 exec, -1
    s_waitcnt vmcnt(9)
    s_barrier
    s_waitcnt vmcnt(0)
    v_readfirstlane_b32 s53, v8
    s_add_u32 s54, s52, 8
    s_cmp_eq_u32 s53, s54
    s_cbranch_scc1 fok_59
    s_mov_b32 s53, 0
    s_add_u32 s54, s52, 8
    s_bfm_b64 exec, 1, 0
poll_60:
    buffer_load_dword v8, v9, s[56:59], 0 offen sc1
    s_waitcnt vmcnt(0)
    v_xor_b32 v8, s54, v8
    v_cmp_eq_u32 vcc, 0, v8
    s_nop 0
    s_cmp_eq_u64 vcc, exec
    s_cbranch_scc1 pok_61
    s_sleep 5
    s_add_u32 s53, s53, 1
    s_cmp_lt_u32 s53, s61
    s_cbranch_scc1 poll_60
    s_mov_b32 s61, 0
pok_61:
    s_mov_b64 exec, -1
fok_59:
    buffer_load_dwordx4 v2, s[12:15], s39 offen sc1 lds
    s_add_u32 m0, m0, 1024
    s_nop 0
    buffer_load_dwordx4 v2, s[12:15], s40 offen sc1 lds
    s_call_b64 s[76:77], PREP_a_issue_4
    s_add_u32 m0, m0, 1024
    s_add_u32 s39, s39, 229376
    buffer_load_dwordx4 v2, s[12:15], s39 offen sc1 lds
    s_add_u32 m0, m0, 1024
    s_add_u32 s40, s40, 229376
    buffer_load_dwordx4 v2, s[12:15], s40 offen sc1 lds
    s_add_u32 m0, m0, 1024
    s_add_u32 s39, s39, 229376
    buffer_load_dwordx4 v2, s[12:15], s39 offen sc1 lds
    s_add_u32 m0, m0, 1024
    s_add_u32 s40, s40, 229376
    buffer_load_dwordx4 v2, s[12:15], s40 offen sc1 lds
    s_add_u32 m0, m0, 1024
    s_add_u32 s39, s39, 229376
    buffer_load_dwordx4 v2, s[12:15], s39 offen sc1 lds
    s_add_u32 m0, m0, 1024
    s_add_u32 s40, s40, 229376
    buffer_load_dwordx4 v2, s[12:15], s40 offen sc1 lds
    s_mov_b32 m0, s19
    s_mov_b32 s39, s16
    s_mov_b32 s40, s17
    s_waitcnt vmcnt(9)
    s_barrier
    s_mov_b64 exec, 1
    buffer_atomic_add v13, v10, s[56:59], s51 offen sc1
    s_mov_b64 exec, -1
    buffer_load_dwordx4 v2, s[12:15], s39 offen sc1 lds
    s_add_u32 m0, m0, 1024
    s_nop 0
    buffer_load_dwordx4 v2, s[12:15], s40 offen sc1 lds
    s_call_b64 s[76:77], PREP_a_issue_4
    s_add_u32 m0, m0, 1024
    s_add_u32 s39, s39, 229376
    buffer_load_dwordx4 v2, s[12:15], s39 offen sc1 lds
    s_add_u32 m0, m0, 1024
    s_add_u32 s40, s40, 229376
    buffer_load_dwordx4 v2, s[12:15], s40 offen sc1 lds
    s_add_u32 m0, m0, 1024
    s_add_u32 s39, s39, 229376
    buffer_load_dwordx4 v2, s[12:15], s39 offen sc1 lds
    s_add_u32 m0, m0, 1024
    s_add_u32 s40, s40, 229376
    buffer_load_dwordx4 v2, s[12:15], s40 offen sc1 lds
    s_add_u32 m0, m0, 1024
    s_add_u32 s39, s39, 229376
    buffer_load_dwordx4 v2, s[12:15], s39 offen sc1 lds
    s_add_u32 m0, m0, 1024
    s_add_u32 s40, s40, 229376
    buffer_load_dwordx4 v2, s[12:15], s40 offen sc1 lds
    s_mov_b32 m0, s19
    s_mov_b32 s39, s16
    s_mov_b32 s40, s17
    s_waitcnt vmcnt(9)
    s_barrier
    buffer_load_dwordx4 v2, s[12:15], s39 offen sc1 lds
    s_add_u32 m0, m0, 1024
    s_nop 0
    buffer_load_dwordx4 v2, s[12:15], s40 offen sc1 lds
    s_call_b64 s[76:77], PREP_a_issue_4
    s_add_u32 m0, m0, 1024
    s_add_u32 s39, s39, 229376
    buffer_load_dwordx4 v2, s[12:15], s39 offen sc1 lds
    s_add_u32 m0, m0, 1024
    s_add_u32 s40, s40, 229376
    buffer_load_dwordx4 v2, s[12:15], s40 offen sc1 lds
    s_add_u32 m0, m0, 1024
    s_add_u32 s39, s39, 229376
    buffer_load_dwordx4 v2, s[12:15], s39 offen sc1 lds
    s_add_u32 m0, m0, 1024
    s_add_u32 s40, s40, 229376
    buffer_load_dwordx4 v2, s[12:15], s40 offen sc1 lds
    s_add_u32 m0, m0, 1024
    s_add_u32 s39, s39, 229376
    buffer_load_dwordx4 v2, s[12:15], s39 offen sc1 lds
    s_add_u32 m0, m0, 1024
    s_add_u32 s40, s40, 229376
    buffer_load_dwordx4 v2, s[12:15], s40 offen sc1 lds
    s_mov_b32 m0, s19
    s_mov_b32 s39, s16
    s_mov_b32 s40, s17
    s_waitcnt vmcnt(8)
    s_barrier
    buffer_load_dwordx4 v2, s[12:15], s39 offen sc1 lds
    s_add_u32 m0, m0, 1024
    s_nop 0
    buffer_load_dwordx4 v2, s[12:15], s40 offen sc1 lds
    s_mov_b64 exec, 1
    buffer_load_dword v11, v10, s[56:59], 0 offen sc1
    s_mov_b64 exec, -1
    s_call_b64 s[76:77], PREP_a_issue_4
    s_add_u32 m0, m0, 1024
    s_add_u32 s39, s39, 229376
    buffer_load_dwordx4 v2, s[12:15], s39 offen sc1 lds
    s_add_u32 m0, m0, 1024
    s_add_u32 s40, s40, 229376
    buffer_load_dwordx4 v2, s[12:15], s40 offen sc1 lds
    s_add_u32 m0, m0, 1024
    s_add_u32 s39, s39, 229376
    buffer_load_dwordx4 v2, s[12:15], s39 offen sc1 lds
    s_add_u32 m0, m0, 1024
    s_add_u32 s40, s40, 229376
    buffer_load_dwordx4 v2, s[12:15], s40 offen sc1 lds
    s_add_u32 m0, m0, 1024
    s_add_u32 s39, s39, 229376
    buffer_load_dwordx4 v2, s[12:15], s39 offen sc1 lds
    s_add_u32 m0, m0, 1024
    s_add_u32 s40, s40, 229376
    buffer_load_dwordx4 v2, s[12:15], s40 offen sc1 lds
    s_mov_b32 m0, s19
    s_mov_b32 s39, s16
    s_mov_b32 s40, s17
    s_waitcnt vmcnt(9)
    s_barrier
    s_mov_b64 exec, 1
    buffer_atomic_add v13, v12, s[56:59], s51 offen sc1
    s_mov_b64 exec, -1
    buffer_load_dwordx4 v2, s[12:15], s39 offen sc1 lds
    s_add_u32 m0, m0, 1024
    s_nop 0
    buffer_load_dwordx4 v2, s[12:15], s40 offen sc1 lds
    s_call_b64 s[76:77], PREP_a_issue_4
    s_add_u32 m0, m0, 1024
    s_add_u32 s39, s39, 229376
    buffer_load_dwordx4 v2, s[12:15], s39 offen sc1 lds
    s_add_u32 m0, m0, 1024
    s_add_u32 s40, s40, 229376
    buffer_load_dwordx4 v2, s[12:15], s40 offen sc1 lds
    s_add_u32 m0, m0, 1024
    s_add_u32 s39, s39, 229376
    buffer_load_dwordx4 v2, s[12:15], s39 offen sc1 lds
    s_add_u32 m0, m0, 1024
    s_add_u32 s40, s40, 229376
    buffer_load_dwordx4 v2, s[12:15], s40 offen sc1 lds
    s_add_u32 m0, m0, 1024
    s_add_u32 s39, s39, 229376
    buffer_load_dwordx4 v2, s[12:15], s39 offen sc1 lds
    s_add_u32 m0, m0, 1024
    s_add_u32 s40, s40, 229376
    buffer_load_dwordx4 v2, s[12:15], s40 offen sc1 lds
    s_mov_b32 m0, s19
    s_mov_b32 s39, s16
    s_mov_b32 s40, s17
    s_waitcnt vmcnt(9)
    s_barrier
    buffer_load_dwordx4 v2, s[12:15], s39 offen sc1 lds
    s_add_u32 m0, m0, 1024
    s_nop 0
    buffer_load_dwordx4 v2, s[12:15], s40 offen sc1 lds
    s_waitcnt vmcnt(17)
    v_readfirstlane_b32 s53, v11
    s_add_u32 s54, s52, 8
    s_cmp_eq_u32 s53, s54
    s_cbranch_scc1 fok_62
    s_mov_b32 s53, 0
    s_add_u32 s54, s52, 8
    s_bfm_b64 exec, 1, 0
poll_63:
    buffer_load_dword v11, v10, s[56:59], 0 offen sc1
    s_waitcnt vmcnt(0)
    v_xor_b32 v11, s54, v11
    v_cmp_eq_u32 vcc, 0, v11
    s_nop 0
    s_cmp_eq_u64 vcc, exec
    s_cbranch_scc1 pok_64
    s_sleep 5
    s_add_u32 s53, s53, 1
    s_cmp_lt_u32 s53, s61
    s_cbranch_scc1 poll_63
    s_mov_b32 s61, 0
pok_64:
    s_mov_b64 exec, -1
fok_62:
    s_call_b64 s[76:77], PREP_a_issue_4
    s_add_u32 m0, m0, 1024
    s_add_u32 s39, s39, 229376
    buffer_load_dwordx4 v2, s[12:15], s39 offen sc1 lds
    s_add_u32 m0, m0, 1024
    s_add_u32 s40, s40, 229376
    buffer_load_dwordx4 v2, s[12:15], s40 offen sc1 lds
    s_add_u32 m0, m0, 1024
    s_add_u32 s39, s39, 229376
    buffer_load_dwordx4 v2, s[12:15], s39 offen sc1 lds
    s_add_u32 m0, m0, 1024
    s_add_u32 s40, s40, 229376
    buffer_load_dwordx4 v2, s[12:15], s40 offen sc1 lds
    s_add_u32 m0, m0, 1024
    s_add_u32 s39, s39, 229376
    buffer_load_dwordx4 v2, s[12:15], s39 offen sc1 lds
    s_add_u32 m0, m0, 1024
    s_add_u32 s40, s40, 229376
    buffer_load_dwordx4 v2, s[12:15], s40 offen sc1 lds
    s_mov_b32 m0, s19
    s_mov_b32 s39, s16
    s_mov_b32 s40, s17
    s_waitcnt vmcnt(8)
    s_barrier
    buffer_load_dwordx4 v2, s[12:15], s39 offen sc1 lds
    s_add_u32 m0, m0, 1024
    s_nop 0
    buffer_load_dwordx4 v2, s[12:15], s40 offen sc1 lds
    s_mov_b32 s43, 1
ld_65:
    s_add_u32 s19, s41, s42
    v_readlane_b32 s16, v249, s44
    v_readlane_b32 s17, v250, s44
    s_add_u32 s16, s16, s38
    s_add_u32 s17, s17, s38
    s_add_u32 s44, s44, 1
    s_add_u32 s42, s42, 16384
    s_cmp_eq_u32 s42, 49152
    s_cselect_b32 s42, 0, s42
    s_add_u32 m0, m0, 1024
    s_add_u32 s39, s39, 229376
    buffer_load_dwordx4 v2, s[12:15], s39 offen sc1 lds
    s_add_u32 m0, m0, 1024
    s_add_u32 s40, s40, 229376
    buffer_load_dwordx4 v2, s[12:15], s40 offen sc1 lds
    s_add_u32 m0, m0, 1024
    s_add_u32 s39, s39, 229376
    buffer_load_dwordx4 v2, s[12:15], s39 offen sc1 lds
    s_add_u32 m0, m0, 1024
    s_add_u32 s40, s40, 229376
    buffer_load_dwordx4 v2, s[12:15], s40 offen sc1 lds
    s_add_u32 m0, m0, 1024
    s_add_u32 s39, s39, 229376
    buffer_load_dwordx4 v2, s[12:15], s39 offen sc1 lds
    s_add_u32 m0, m0, 1024
    s_add_u32 s40, s40, 229376
    buffer_load_dwordx4 v2, s[12:15], s40 offen sc1 lds
    s_mov_b32 m0, s19
    s_mov_b32 s39, s16
    s_mov_b32 s40, s17
    s_waitcnt vmcnt(8)
    s_barrier
    buffer_load_dwordx4 v2, s[12:15], s39 offen sc1 lds
    s_add_u32 m0, m0, 1024
    s_nop 0
    buffer_load_dwordx4 v2, s[12:15], s40 offen sc1 lds
    s_add_u32 s43, s43, 1
    s_cmp_lt_u32 s43, 4
    s_cbranch_scc1 ld_65
    s_call_b64 s[76:77], PREP_a_issue_4
    s_add_u32 m0, m0, 1024
    s_add_u32 s39, s39, 229376
    buffer_load_dwordx4 v2, s[12:15], s39 offen sc1 lds
    s_add_u32 m0, m0, 1024
    s_add_u32 s40, s40, 229376
    buffer_load_dwordx4 v2, s[12:15], s40 offen sc1 lds
    s_add_u32 m0, m0, 1024
    s_add_u32 s39, s39, 229376
    buffer_load_dwordx4 v2, s[12:15], s39 offen sc1 lds
    s_add_u32 m0, m0, 1024
    s_add_u32 s40, s40, 229376
    buffer_load_dwordx4 v2, s[12:15], s40 offen sc1 lds
    s_add_u32 m0, m0, 1024
    s_add_u32 s39, s39, 229376
    buffer_load_dwordx4 v2, s[12:15], s39 offen sc1 lds
    s_add_u32 m0, m0, 1024
    s_add_u32 s40, s40, 229376
    buffer_load_dwordx4 v2, s[12:15], s40 offen sc1 lds
    s_mov_b32 m0, s19
    s_mov_b32 s39, s16
    s_mov_b32 s40, s17
    s_waitcnt vmcnt(8)
    s_barrier
    buffer_load_dwordx4 v2, s[12:15], s39 offen sc1 lds
    s_add_u32 m0, m0, 1024
    s_nop 0
    buffer_load_dwordx4 v2, s[12:15], s40 offen sc1 lds
    s_mov_b64 exec, 1
    buffer_load_dword v11, v12, s[56:59], 0 offen sc1
    s_mov_b64 exec, -1
    s_call_b64 s[76:77], PREP_a_issue_4
    s_add_u32 m0, m0, 1024
    s_add_u32 s39, s39, 229376
    buffer_load_dwordx4 v2, s[12:15], s39 offen sc1 lds
    s_add_u32 m0, m0, 1024
    s_add_u32 s40, s40, 229376
    buffer_load_dwordx4 v2, s[12:15], s40 offen sc1 lds
    s_add_u32 m0, m0, 1024
    s_add_u32 s39, s39, 229376
    buffer_load_dwordx4 v2, s[12:15], s39 offen sc1 lds
    s_add_u32 m0, m0, 1024
    s_add_u32 s40, s40, 229376
    buffer_load_dwordx4 v2, s[12:15], s40 offen sc1 lds
    s_add_u32 m0, m0, 1024
    s_add_u32 s39, s39, 229376
    buffer_load_dwordx4 v2, s[12:15], s39 offen sc1 lds
    s_add_u32 m0, m0, 1024
    s_add_u32 s40, s40, 229376
    buffer_load_dwordx4 v2, s[12:15], s40 offen sc1 lds
    s_mov_b32 m0, s19
    s_mov_b32 s39, s16
    s_mov_b32 s40, s17
    s_waitcnt vmcnt(9)
    s_barrier
    buffer_load_dwordx4 v2, s[12:15], s39 offen sc1 lds
    s_add_u32 m0, m0, 1024
    s_nop 0
    buffer_load_dwordx4 v2, s[12:15], s40 offen sc1 lds
    s_call_b64 s[76:77], PREP_a_issue_4
    s_add_u32 m0, m0, 1024
    s_add_u32 s39, s39, 229376
    buffer_load_dwordx4 v2, s[12:15], s39 offen sc1 lds
    s_add_u32 m0, m0, 1024
    s_add_u32 s40, s40, 229376
    buffer_load_dwordx4 v2, s[12:15], s40 offen sc1 lds
    s_add_u32 m0, m0, 1024
    s_add_u32 s39, s39, 229376
    buffer_load_dwordx4 v2, s[12:15], s39 offen sc1 lds
    s_add_u32 m0, m0, 1024
    s_add_u32 s40, s40, 229376
    buffer_load_dwordx4 v2, s[12:15], s40 offen sc1 lds
    s_add_u32 m0, m0, 1024
    s_add_u32 s39, s39, 229376
    buffer_load_dwordx4 v2, s[12:15], s39 offen sc1 lds
    s_add_u32 m0, m0, 1024
    s_add_u32 s40, s40, 229376
    buffer_load_dwordx4 v2, s[12:15], s40 offen sc1 lds
    s_mov_b32 m0, s19
    s_mov_b32 s39, s16
    s_mov_b32 s40, s17
    s_waitcnt vmcnt(8)
    s_barrier
    buffer_load_dwordx4 v2, s[12:15], s39 offen sc1 lds
    s_add_u32 m0, m0, 1024
    s_nop 0
    buffer_load_dwordx4 v2, s[12:15], s40 offen sc1 lds
    s_waitcnt vmcnt(16)
    v_readfirstlane_b32 s53, v11
    s_add_u32 s54, s52, 8
    s_cmp_eq_u32 s53, s54
    s_cbranch_scc1 fok_66
    s_mov_b32 s53, 0
    s_add_u32 s54, s52, 8
    s_bfm_b64 exec, 1, 0
poll_67:
    buffer_load_dword v11, v12, s[56:59], 0 offen sc1
    s_waitcnt vmcnt(0)
    v_xor_b32 v11, s54, v11
    v_cmp_eq_u32 vcc, 0, v11
    s_nop 0
    s_cmp_eq_u64 vcc, exec
    s_cbranch_scc1 pok_68
    s_sleep 5
    s_add_u32 s53, s53, 1
    s_cmp_lt_u32 s53, s61
    s_cbranch_scc1 poll_67
    s_mov_b32 s61, 0
pok_68:
    s_mov_b64 exec, -1
fok_66:
    s_call_b64 s[76:77], PREP_a_issue_4
    s_add_u32 m0, m0, 1024
    s_add_u32 s39, s39, 229376
    buffer_load_dwordx4 v2, s[12:15], s39 offen sc1 lds
    s_add_u32 m0, m0, 1024
    s_add_u32 s40, s40, 229376
    buffer_load_dwordx4 v2, s[12:15], s40 offen sc1 lds
    s_add_u32 m0, m0, 1024
    s_add_u32 s39, s39, 229376
    buffer_load_dwordx4 v2, s[12:15], s39 offen sc1 lds
    s_add_u32 m0, m0, 1024
    s_add_u32 s40, s40, 229376
    buffer_load_dwordx4 v2, s[12:15], s40 offen sc1 lds
    s_add_u32 m0, m0, 1024
    s_add_u32 s39, s39, 229376
    buffer_load_dwordx4 v2, s[12:15], s39 offen sc1 lds
    s_add_u32 m0, m0, 1024
    s_add_u32 s40, s40, 229376
    buffer_load_dwordx4 v2, s[12:15], s40 offen sc1 lds
    s_mov_b32 m0, s19
    s_mov_b32 s39, s16
    s_mov_b32 s40, s17
    s_waitcnt vmcnt(8)
    s_barrier
    buffer_load_dwordx4 v2, s[12:15], s39 offen sc1 lds
    s_add_u32 m0, m0, 1024
    s_nop 0
    buffer_load_dwordx4 v2, s[12:15], s40 offen sc1 lds
    s_mov_b32 s43, 1
ld_69:
    s_add_u32 s19, s41, s42
    v_readlane_b32 s16, v249, s44
    v_readlane_b32 s17, v250, s44
    s_add_u32 s16, s16, s38
    s_add_u32 s17, s17, s38
    s_add_u32 s44, s44, 1
    s_add_u32 s42, s42, 16384
    s_cmp_eq_u32 s42, 49152
    s_cselect_b32 s42, 0, s42
    s_add_u32 m0, m0, 1024
    s_add_u32 s39, s39, 229376
    buffer_load_dwordx4 v2, s[12:15], s39 offen sc1 lds
    s_add_u32 m0, m0, 1024
    s_add_u32 s40, s40, 229376
    buffer_load_dwordx4 v2, s[12:15], s40 offen sc1 lds
    s_add_u32 m0, m0, 1024
    s_add_u32 s39, s39, 229376
    buffer_load_dwordx4 v2, s[12:15], s39 offen sc1 lds
    s_add_u32 m0, m0, 1024
    s_add_u32 s40, s40, 229376
    buffer_load_dwordx4 v2, s[12:15], s40 offen sc1 lds
    s_add_u32 m0, m0, 1024
    s_add_u32 s39, s39, 229376
    buffer_load_dwordx4 v2, s[12:15], s39 offen sc1 lds
    s_add_u32 m0, m0, 1024
    s_add_u32 s40, s40, 229376
    buffer_load_dwordx4 v2, s[12:15], s40 offen sc1 lds
    s_mov_b32 m0, s19
    s_mov_b32 s39, s16
    s_mov_b32 s40, s17
    s_waitcnt vmcnt(8)
    s_barrier
    buffer_load_dwordx4 v2, s[12:15], s39 offen sc1 lds
    s_add_u32 m0, m0, 1024
    s_nop 0
    buffer_load_dwordx4 v2, s[12:15], s40 offen sc1 lds
    s_add_u32 s43, s43, 1
    s_cmp_lt_u32 s43, 5
    s_cbranch_scc1 ld_69
    s_call_b64 s[76:77], PREP_a_issue_4
    s_add_u32 m0, m0, 1024
    s_add_u32 s39, s39, 229376
    buffer_load_dwordx4 v2, s[12:15], s39 offen sc1 lds
    s_add_u32 m0, m0, 1024
    s_add_u32 s40, s40, 229376
    buffer_load_dwordx4 v2, s[12:15], s40 offen sc1 lds
    s_add_u32 m0, m0, 1024
    s_add_u32 s39, s39, 229376
    buffer_load_dwordx4 v2, s[12:15], s39 offen sc1 lds
    s_add_u32 m0, m0, 1024
    s_add_u32 s40, s40, 229376
    buffer_load_dwordx4 v2, s[12:15], s40 offen sc1 lds
    s_add_u32 m0, m0, 1024
    s_add_u32 s39, s39, 229376
    buffer_load_dwordx4 v2, s[12:15], s39 offen sc1 lds
    s_add_u32 m0, m0, 1024
    s_add_u32 s40, s40, 229376
    buffer_load_dwordx4 v2, s[12:15], s40 offen sc1 lds
    s_mov_b32 m0, s19
    s_mov_b32 s39, s16
    s_mov_b32 s40, s17
    s_waitcnt vmcnt(8)
    s_barrier
    buffer_load_dwordx4 v2, s[12:15], s39 offen sc1 lds
    s_add_u32 m0, m0, 1024
    s_nop 0
    buffer_load_dwordx4 v2, s[12:15], s40 offen sc1 lds
    s_mov_b64 exec, 1
    buffer_load_dword v11, v15, s[56:59], 0 offen sc1
    s_mov_b64 exec, -1
    s_call_b64 s[76:77], PREP_a_issue_4
    s_add_u32 m0, m0, 1024
    s_add_u32 s39, s39, 229376
    buffer_load_dwordx4 v2, s[12:15], s39 offen sc1 lds
    s_add_u32 m0, m0, 1024
    s_add_u32 s40, s40, 229376
    buffer_load_dwordx4 v2, s[12:15], s40 offen sc1 lds
    s_add_u32 m0, m0, 1024
    s_add_u32 s39, s39, 229376
    buffer_load_dwordx4 v2, s[12:15], s39 offen sc1 lds
    s_add_u32 m0, m0, 1024
    s_add_u32 s40, s40, 229376
    buffer_load_dwordx4 v2, s[12:15], s40 offen sc1 lds
    s_add_u32 m0, m0, 1024
    s_add_u32 s39, s39, 229376
    buffer_load_dwordx4 v2, s[12:15], s39 offen sc1 lds
    s_add_u32 m0, m0, 1024
    s_add_u32 s40, s40, 229376
    buffer_load_dwordx4 v2, s[12:15], s40 offen sc1 lds
    s_mov_b32 m0, s19
    s_mov_b32 s39, s16
    s_mov_b32 s40, s17
    s_waitcnt vmcnt(9)
    s_barrier
    buffer_load_dwordx4 v2, s[12:15], s39 offen sc1 lds
    s_add_u32 m0, m0, 1024
    s_nop 0
    buffer_load_dwordx4 v2, s[12:15], s40 offen sc1 lds
    s_call_b64 s[76:77], PREP_a_issue_4
    s_add_u32 m0, m0, 1024
    s_add_u32 s39, s39, 229376
    buffer_load_dwordx4 v2, s[12:15], s39 offen sc1 lds
    s_add_u32 m0, m0, 1024
    s_add_u32 s40, s40, 229376
    buffer_load_dwordx4 v2, s[12:15], s40 offen sc1 lds
    s_add_u32 m0, m0, 1024
    s_add_u32 s39, s39, 229376
    buffer_load_dwordx4 v2, s[12:15], s39 offen sc1 lds
    s_add_u32 m0, m0, 1024
    s_add_u32 s40, s40, 229376
    buffer_load_dwordx4 v2, s[12:15], s40 offen sc1 lds
    s_add_u32 m0, m0, 1024
    s_add_u32 s39, s39, 229376
    buffer_load_dwordx4 v2, s[12:15], s39 offen sc1 lds
    s_add_u32 m0, m0, 1024
    s_add_u32 s40, s40, 229376
    buffer_load_dwordx4 v2, s[12:15], s40 offen sc1 lds
    s_mov_b32 m0, s19
    s_mov_b32 s39, s16
    s_mov_b32 s40, s17
    s_waitcnt vmcnt(8)
    s_barrier
    buffer_load_dwordx4 v2, s[12:15], s39 offen sc1 lds
    s_add_u32 m0, m0, 1024
    s_nop 0
    buffer_load_dwordx4 v2, s[12:15], s40 offen sc1 lds
    s_waitcnt vmcnt(16)
    v_readfirstlane_b32 s53, v11
    s_add_u32 s54, s52, 8
    s_cmp_eq_u32 s53, s54
    s_cbranch_scc1 fok_70
    s_mov_b32 s53, 0
    s_add_u32 s54, s52, 8
    s_bfm_b64 exec, 1, 0
poll_71:
    buffer_load_dword v11, v15, s[56:59], 0 offen sc1
    s_waitcnt vmcnt(0)
    v_xor_b32 v11, s54, v11
    v_cmp_eq_u32 vcc, 0, v11
    s_nop 0
    s_cmp_eq_u64 vcc, exec
    s_cbranch_scc1 pok_72
    s_sleep 5
    s_add_u32 s53, s53, 1
    s_cmp_lt_u32 s53, s61
    s_cbranch_scc1 poll_71
    s_mov_b32 s61, 0
pok_72:
    s_mov_b64 exec, -1
fok_70:
    s_call_b64 s[76:77], PREP_a_issue_4
    s_add_u32 m0, m0, 1024
    s_add_u32 s39, s39, 229376
    buffer_load_dwordx4 v2, s[12:15], s39 offen sc1 lds
    s_add_u32 m0, m0, 1024
    s_add_u32 s40, s40, 229376
    buffer_load_dwordx4 v2, s[12:15], s40 offen sc1 lds
    s_add_u32 m0, m0, 1024
    s_add_u32 s39, s39, 229376
    buffer_load_dwordx4 v2, s[12:15], s39 offen sc1 lds
    s_add_u32 m0, m0, 1024
    s_add_u32 s40, s40, 229376
    buffer_load_dwordx4 v2, s[12:15], s40 offen sc1 lds
    s_add_u32 m0, m0, 1024
    s_add_u32 s39, s39, 229376
    buffer_load_dwordx4 v2, s[12:15], s39 offen sc1 lds
    s_add_u32 m0, m0, 1024
    s_add_u32 s40, s40, 229376
    buffer_load_dwordx4 v2, s[12:15], s40 offen sc1 lds
    s_mov_b32 m0, s19
    s_mov_b32 s39, s16
    s_mov_b32 s40, s17
    s_waitcnt vmcnt(8)
    s_barrier
    buffer_load_dwordx4 v2, s[12:15], s39 offen sc1 lds
    s_add_u32 m0, m0, 1024
    s_nop 0
    buffer_load_dwordx4 v2, s[12:15], s40 offen sc1 lds
    s_mov_b32 s43, 1
ld_73:
    s_add_u32 s19, s41, s42
    v_readlane_b32 s16, v249, s44
    v_readlane_b32 s17, v250, s44
    s_add_u32 s16, s16, s38
    s_add_u32 s17, s17, s38
    s_add_u32 s44, s44, 1
    s_add_u32 s42, s42, 16384
    s_cmp_eq_u32 s42, 49152
    s_cselect_b32 s42, 0, s42
    s_add_u32 m0, m0, 1024
    s_add_u32 s39, s39, 229376
    buffer_load_dwordx4 v2, s[12:15], s39 offen sc1 lds
    s_add_u32 m0, m0, 1024
    s_add_u32 s40, s40, 229376
    buffer_load_dwordx4 v2, s[12:15], s40 offen sc1 lds
    s_add_u32 m0, m0, 1024
    s_add_u32 s39, s39, 229376
    buffer_load_dwordx4 v2, s[12:15], s39 offen sc1 lds
    s_add_u32 m0, m0, 1024
    s_add_u32 s40, s40, 229376
    buffer_load_dwordx4 v2, s[12:15], s40 offen sc1 lds
    s_add_u32 m0, m0, 1024
    s_add_u32 s39, s39, 229376
    buffer_load_dwordx4 v2, s[12:15], s39 offen sc1 lds
    s_add_u32 m0, m0, 1024
    s_add_u32 s40, s40, 229376
    buffer_load_dwordx4 v2, s[12:15], s40 offen sc1 lds
    s_mov_b32 m0, s19
    s_mov_b32 s39, s16
    s_mov_b32 s40, s17
    s_waitcnt vmcnt(8)
    s_barrier
    buffer_load_dwordx4 v2, s[12:15], s39 offen sc1 lds
    s_add_u32 m0, m0, 1024
    s_nop 0
    buffer_load_dwordx4 v2, s[12:15], s40 offen sc1 lds
    s_add_u32 s43, s43, 1
    s_cmp_lt_u32 s43, 3
    s_cbranch_scc1 ld_73
    s_call_b64 s[76:77], PREP_a_issue_4
    s_add_u32 m0, m0, 1024
    s_add_u32 s39, s39, 229376
    buffer_load_dwordx4 v2, s[12:15], s39 offen sc1 lds
    s_add_u32 m0, m0, 1024
    s_add_u32 s40, s40, 229376
    buffer_load_dwordx4 v2, s[12:15], s40 offen sc1 lds
    s_add_u32 m0, m0, 1024
    s_add_u32 s39, s39, 229376
    buffer_load_dwordx4 v2, s[12:15], s39 offen sc1 lds
    s_add_u32 m0, m0, 1024
    s_add_u32 s40, s40, 229376
    buffer_load_dwordx4 v2, s[12:15], s40 offen sc1 lds
    s_add_u32 m0, m0, 1024
    s_add_u32 s39, s39, 229376
    buffer_load_dwordx4 v2, s[12:15], s39 offen sc1 lds
    s_add_u32 m0, m0, 1024
    s_add_u32 s40, s40, 229376
    buffer_load_dwordx4 v2, s[12:15], s40 offen sc1 lds
    s_mov_b32 m0, s19
    s_mov_b32 s39, s16
    s_mov_b32 s40, s17
    s_waitcnt vmcnt(8)
    s_barrier
    buffer_load_dwordx4 v2, s[12:15], s39 offen sc1 lds
    s_add_u32 m0, m0, 1024
    s_nop 0
    buffer_load_dwordx4 v2, s[12:15], s40 offen sc1 lds
    s_add_u32 m0, m0, 1024
    s_add_u32 s39, s39, 229376
    buffer_load_dwordx4 v2, s[12:15], s39 offen sc1 lds
    s_add_u32 m0, m0, 1024
    s_add_u32 s40, s40, 229376
    buffer_load_dwordx4 v2, s[12:15], s40 offen sc1 lds
    s_add_u32 m0, m0, 1024
    s_add_u32 s39, s39, 229376
    buffer_load_dwordx4 v2, s[12:15], s39 offen sc1 lds
    s_add_u32 m0, m0, 1024
    s_add_u32 s40, s40, 229376
    buffer_load_dwordx4 v2, s[12:15], s40 offen sc1 lds
    s_add_u32 m0, m0, 1024
    s_add_u32 s39, s39, 229376
    buffer_load_dwordx4 v2, s[12:15], s39 offen sc1 lds
    s_add_u32 m0, m0, 1024
    s_add_u32 s40, s40, 229376
    buffer_load_dwordx4 v2, s[12:15], s40 offen sc1 lds
    s_waitcnt vmcnt(8)
    s_barrier
    s_waitcnt vmcnt(0)
    s_barrier
    s_cmp_eq_u32 s60, 1
    s_cbranch_scc1 K_fin
    s_barrier
    s_branch NEXT
WLOAD:
    s_cmp_eq_u32 s60, 1
    s_cbranch_scc1 WL_1
    s_mov_b64 s[12:13], s[68:69]
    s_mov_b32 s14, 2097152
    s_mov_b32 s15, 0x20000
    s_and_b32 s35, s30, 1
    s_mul_i32 s38, s99, 128
    s_mul_i32 s41, s35, 65536
    s_add_u32 s38, s38, s41
    s_mul_i32 s41, s35, 4096
    s_add_u32 s41, s41, 24576
    s_mov_b32 s42, 0
    s_mov_b32 s44, s67
    s_branch WL_2
WL_1:
    s_mov_b64 s[12:13], s[68:69]
    s_mov_b32 s14, 2097152
    s_mov_b32 s15, 0x20000
    s_and_b32 s35, s30, 1
    s_mul_i32 s38, s99, 128
    s_mul_i32 s41, s35, 65536
    s_add_u32 s38, s38, s41
    s_mul_i32 s41, s35, 4096
    s_add_u32 s41, s41, 24576
    s_mov_b32 s42, 0
    s_mov_b32 s44, s67
WL_2:
    s_waitcnt vmcnt(0)
    s_barrier
    s_call_b64 s[76:77], SUB_after_g1
    s_barrier
    s_waitcnt vmcnt(0)
    s_barrier
    s_call_b64 s[76:77], SUB_after_g2
    s_mov_b64 s[12:13], s[72:73]
    s_mov_b32 s14, 7340032
    s_mov_b32 s15, 0x20000
    s_and_b32 s35, s30, 1
    s_mul_i32 s38, s29, 448
    s_mul_i32 s41, s35, 229376
    s_add_u32 s38, s38, s41
    s_mul_i32 s41, s35, 14336
    s_add_u32 s41, s41, 73728
    s_mov_b32 s42, 0
    s_mov_b32 s44, 0
    s_mov_b32 s42, 28672
    s_mov_b32 s44, 2
    s_add_u32 s19, s41, s42
    v_readlane_b32 s16, v248, s44
    s_nop 0
    s_add_u32 s16, s16, s38
    s_add_u32 s44, s44, 1
    s_and_b32 s44, s44, 15
    s_add_u32 s42, s42, 28672
    s_cmp_eq_u32 s42, 86016
    s_cselect_b32 s42, 0, s42
    s_mov_b32 m0, s19
    s_mov_b32 s39, s16
    s_waitcnt vmcnt(63)
    s_barrier
    buffer_load_dwordx4 v241, s[12:15], s39 offen lds
    s_add_u32 m0, m0, 1024
    s_nop 0
    buffer_load_dwordx4 v242, s[12:15], s39 offen lds
    s_add_u32 m0, m0, 1024
    s_nop 0
    buffer_load_dwordx4 v243, s[12:15], s39 offen lds
    s_mov_b32 s43, 1
ld_74:
    s_add_u32 s19, s41, s42
    v_readlane_b32 s16, v248, s44
    s_nop 0
    s_add_u32 s16, s16, s38
    s_add_u32 s44, s44, 1
    s_and_b32 s44, s44, 15
    s_add_u32 s42, s42, 28672
    s_cmp_eq_u32 s42, 86016
    s_cselect_b32 s42, 0, s42
    s_add_u32 m0, m0, 1024
    s_nop 0
    buffer_load_dwordx4 v244, s[12:15], s39 offen lds
    s_add_u32 m0, m0, 1024
    s_nop 0
    buffer_load_dwordx4 v245, s[12:15], s39 offen lds
    s_add_u32 m0, m0, 1024
    s_nop 0
    buffer_load_dwordx4 v246, s[12:15], s39 offen lds
    s_add_u32 m0, m0, 1024
    s_nop 0
    buffer_load_dwordx4 v247, s[12:15], s39 offen lds
    s_add_u32 m0, m0, 1024
    s_add_u32 s39, s39, 114688
    buffer_load_dwordx4 v241, s[12:15], s39 offen lds
    s_add_u32 m0, m0, 1024
    s_nop 0
    buffer_load_dwordx4 v242, s[12:15], s39 offen lds
    s_add_u32 m0, m0, 1024
    s_nop 0
    buffer_load_dwordx4 v243, s[12:15], s39 offen lds
    s_add_u32 m0, m0, 1024
    s_nop 0
    buffer_load_dwordx4 v244, s[12:15], s39 offen lds
    s_add_u32 m0, m0, 1024
    s_nop 0
    buffer_load_dwordx4 v245, s[12:15], s39 offen lds
    s_add_u32 m0, m0, 1024
    s_nop 0
    buffer_load_dwordx4 v246, s[12:15], s39 offen lds
    s_add_u32 m0, m0, 1024
    s_nop 0
    buffer_load_dwordx4 v247, s[12:15], s39 offen lds
    s_mov_b32 m0, s19
    s_mov_b32 s39, s16
    s_waitcnt vmcnt(14)
    s_barrier
    buffer_load_dwordx4 v241, s[12:15], s39 offen lds
    s_add_u32 m0, m0, 1024
    s_nop 0
    buffer_load_dwordx4 v242, s[12:15], s39 offen lds
    s_add_u32 m0, m0, 1024
    s_nop 0
    buffer_load_dwordx4 v243, s[12:15], s39 offen lds
    s_add_u32 s43, s43, 1
    s_cmp_lt_u32 s43, 13
    s_cbranch_scc1 ld_74
    s_add_u32 s19, s41, s42
    v_readlane_b32 s16, v248, s44
    s_nop 0
    s_add_u32 s16, s16, s38
    s_add_u32 s44, s44, 1
    s_and_b32 s44, s44, 15
    s_add_u32 s42, s42, 28672
    s_cmp_eq_u32 s42, 86016
    s_cselect_b32 s42, 0, s42
    s_add_u32 m0, m0, 1024
    s_nop 0
    buffer_load_dwordx4 v244, s[12:15], s39 offen lds
    s_add_u32 m0, m0, 1024
    s_nop 0
    buffer_load_dwordx4 v245, s[12:15], s39 offen lds
    s_add_u32 m0, m0, 1024
    s_nop 0
    buffer_load_dwordx4 v246, s[12:15], s39 offen lds
    s_add_u32 m0, m0, 1024
    s_nop 0
    buffer_load_dwordx4 v247, s[12:15], s39 offen lds
    s_add_u32 m0, m0, 1024
    s_add_u32 s39, s39, 114688
    buffer_load_dwordx4 v241, s[12:15], s39 offen lds
    s_add_u32 m0, m0, 1024
    s_nop 0
    buffer_load_dwordx4 v242, s[12:15], s39 offen lds
    s_add_u32 m0, m0, 1024
    s_nop 0
    buffer_load_dwordx4 v243, s[12:15], s39 offen lds
    s_add_u32 m0, m0, 1024
    s_nop 0
    buffer_load_dwordx4 v244, s[12:15], s39 offen lds
    s_add_u32 m0, m0, 1024
    s_nop 0
    buffer_load_dwordx4 v245, s[12:15], s39 offen lds
    s_add_u32 m0, m0, 1024
    s_nop 0
    buffer_load_dwordx4 v246, s[12:15], s39 offen lds
    s_add_u32 m0, m0, 1024
    s_nop 0
    buffer_load_dwordx4 v247, s[12:15], s39 offen lds
    s_mov_b32 m0, s19
    s_mov_b32 s39, s16
    s_waitcnt vmcnt(14)
    s_barrier
    buffer_load_dwordx4 v241, s[12:15], s39 offen lds
    s_add_u32 m0, m0, 1024
    s_nop 0
    buffer_load_dwordx4 v242, s[12:15], s39 offen lds
    s_add_u32 m0, m0, 1024
    s_nop 0
    buffer_load_dwordx4 v243, s[12:15], s39 offen lds
    s_add_u32 m0, m0, 1024
    s_nop 0
    buffer_load_dwordx4 v244, s[12:15], s39 offen lds
    s_add_u32 m0, m0, 1024
    s_nop 0
    buffer_load_dwordx4 v245, s[12:15], s39 offen lds
    s_add_u32 m0, m0, 1024
    s_nop 0
    buffer_load_dwordx4 v246, s[12:15], s39 offen lds
    s_add_u32 m0, m0, 1024
    s_nop 0
    buffer_load_dwordx4 v247, s[12:15], s39 offen lds
    s_add_u32 m0, m0, 1024
    s_add_u32 s39, s39, 114688
    buffer_load_dwordx4 v241, s[12:15], s39 offen lds
    s_add_u32 m0, m0, 1024
    s_nop 0
    buffer_load_dwordx4 v242, s[12:15], s39 offen lds
    s_add_u32 m0, m0, 1024
    s_nop 0
    buffer_load_dwordx4 v243, s[12:15], s39 offen lds
    s_add_u32 m0, m0, 1024
    s_nop 0
    buffer_load_dwordx4 v244, s[12:15], s39 offen lds
    s_add_u32 m0, m0, 1024
    s_nop 0
    buffer_load_dwordx4 v245, s[12:15], s39 offen lds
    s_add_u32 m0, m0, 1024
    s_nop 0
    buffer_load_dwordx4 v246, s[12:15], s39 offen lds
    s_add_u32 m0, m0, 1024
    s_nop 0
    buffer_load_dwordx4 v247, s[12:15], s39 offen lds
    s_waitcnt vmcnt(14)
    s_barrier
    s_call_b64 s[76:77], SUB_r_pre0
    s_waitcnt vmcnt(4)
    s_barrier
    s_barrier
    s_mov_b64 s[12:13], s[74:75]
    s_mov_b32 s14, 7340032
    s_mov_b32 s15, 0x20000
    s_and_b32 s35, s30, 1
    s_mul_i32 s38, s33, 256
    s_mul_i32 s41, s31, 3670016
    s_add_u32 s38, s38, s41
    s_mul_i32 s41, s35, 8192
    s_add_u32 s41, s41, 49152
    s_mov_b32 s42, 0
    s_mov_b32 s44, 0
    s_mov_b32 s49, s44
    s_and_b32 s43, s28, 3
    s_mul_i32 s43, s43, 6
    s_lshr_b32 s43, s43, 2
    s_mov_b32 s50, 0
wpre_75:
    s_mul_i32 s42, s43, 16384
    s_add_u32 s44, s49, s43
    s_mov_b32 s45, 8192
    s_add_u32 s19, s41, s42
    v_readlane_b32 s16, v249, s44
    s_nop 0
    s_bitcmp1_b32 s16, 0
    s_cselect_b32 s17, 16384, s45
    s_cselect_b32 s18, -40960, s45
    s_andn2_b32 s16, s16, 1
    s_add_u32 s16, s16, s38
    s_add_u32 s44, s44, 1
    s_add_u32 s42, s42, 16384
    s_cmp_eq_u32 s42, 98304
    s_cselect_b32 s42, 0, s42
    s_mov_b32 m0, s19
    s_mov_b32 s39, s16
    s_mov_b32 s32, s17
    s_mov_b32 s3, s18
    buffer_load_dwordx4 v239, s[12:15], s39 offen lds
    s_add_u32 m0, m0, 1024
    s_add_u32 s39, s39, s32
    buffer_load_dwordx4 v240, s[12:15], s39 offen lds
    s_add_u32 m0, m0, 1024
    s_add_u32 s39, s39, s32
    buffer_load_dwordx4 v239, s[12:15], s39 offen lds
    s_add_u32 m0, m0, 1024
    s_add_u32 s39, s39, s32
    buffer_load_dwordx4 v240, s[12:15], s39 offen lds
    s_waitcnt vmcnt(6)
    s_add_u32 m0, m0, 1024
    s_add_u32 s39, s39, s3
    buffer_load_dwordx4 v239, s[12:15], s39 offen lds
    s_add_u32 m0, m0, 1024
    s_add_u32 s39, s39, s32
    buffer_load_dwordx4 v240, s[12:15], s39 offen lds
    s_add_u32 m0, m0, 1024
    s_add_u32 s39, s39, s32
    buffer_load_dwordx4 v239, s[12:15], s39 offen lds
    s_add_u32 m0, m0, 1024
    s_add_u32 s39, s39, s32
    buffer_load_dwordx4 v240, s[12:15], s39 offen lds
    s_waitcnt vmcnt(6)
    s_add_u32 s43, s43, 1
    s_cmp_eq_u32 s43, 6
    s_cselect_b32 s43, 0, s43
    s_add_u32 s50, s50, 1
    s_cmp_lt_u32 s50, 6
    s_cbranch_scc1 wpre_75
    s_mov_b32 s42, 0
    s_add_u32 s44, s49, 6
    s_cmp_eq_u32 s60, 1
    s_cbranch_scc1 WL_t1
    s_call_b64 s[76:77], PREP_w_issue_4
    s_mov_b32 m0, s19
    s_mov_b32 s39, s16
    s_mov_b32 s32, s17
    s_mov_b32 s3, s18
    s_waitcnt vmcnt(0)
    s_barrier
    s_waitcnt vmcnt(0)
    s_barrier
    buffer_load_dwordx4 v239, s[12:15], s39 offen lds
    s_add_u32 m0, m0, 1024
    s_add_u32 s39, s39, s32
    buffer_load_dwordx4 v240, s[12:15], s39 offen lds
    s_call_b64 s[76:77], PREP_w_issue_4
    s_add_u32 m0, m0, 1024
    s_add_u32 s39, s39, s32
    buffer_load_dwordx4 v239, s[12:15], s39 offen lds
    s_add_u32 m0, m0, 1024
    s_add_u32 s39, s39, s32
    buffer_load_dwordx4 v240, s[12:15], s39 offen lds
    s_add_u32 m0, m0, 1024
    s_add_u32 s39, s39, s3
    buffer_load_dwordx4 v239, s[12:15], s39 offen lds
    s_add_u32 m0, m0, 1024
    s_add_u32 s39, s39, s32
    buffer_load_dwordx4 v240, s[12:15], s39 offen lds
    s_add_u32 m0, m0, 1024
    s_add_u32 s39, s39, s32
    buffer_load_dwordx4 v239, s[12:15], s39 offen lds
    s_add_u32 m0, m0, 1024
    s_add_u32 s39, s39, s32
    buffer_load_dwordx4 v240, s[12:15], s39 offen lds
    s_mov_b32 m0, s19
    s_mov_b32 s39, s16
    s_mov_b32 s32, s17
    s_mov_b32 s3, s18
    s_waitcnt vmcnt(8)
    s_barrier
    buffer_load_dwordx4 v239, s[12:15], s39 offen lds
    s_add_u32 m0, m0, 1024
    s_add_u32 s39, s39, s32
    buffer_load_dwordx4 v240, s[12:15], s39 offen lds
    s_call_b64 s[76:77], PREP_w_issue_4
    s_add_u32 m0, m0, 1024
    s_add_u32 s39, s39, s32
    buffer_load_dwordx4 v239, s[12:15], s39 offen lds
    s_add_u32 m0, m0, 1024
    s_add_u32 s39, s39, s32
    buffer_load_dwordx4 v240, s[12:15], s39 offen lds
    s_add_u32 m0, m0, 1024
    s_add_u32 s39, s39, s3
    buffer_load_dwordx4 v239, s[12:15], s39 offen lds
    s_add_u32 m0, m0, 1024
    s_add_u32 s39, s39, s32
    buffer_load_dwordx4 v240, s[12:15], s39 offen lds
    s_add_u32 m0, m0, 1024
    s_add_u32 s39, s39, s32
    buffer_load_dwordx4 v239, s[12:15], s39 offen lds
    s_add_u32 m0, m0, 1024
    s_add_u32 s39, s39, s32
    buffer_load_dwordx4 v240, s[12:15], s39 offen lds
    s_mov_b32 m0, s19
    s_mov_b32 s39, s16
    s_mov_b32 s32, s17
    s_mov_b32 s3, s18
    s_waitcnt vmcnt(16)
    s_barrier
    buffer_load_dwordx4 v239, s[12:15], s39 offen lds
    s_add_u32 m0, m0, 1024
    s_add_u32 s39, s39, s32
    buffer_load_dwordx4 v240, s[12:15], s39 offen lds
    s_call_b64 s[76:77], PREP_w_issue_4
    s_add_u32 m0, m0, 1024
    s_add_u32 s39, s39, s32
    buffer_load_dwordx4 v239, s[12:15], s39 offen lds
    s_add_u32 m0, m0, 1024
    s_add_u32 s39, s39, s32
    buffer_load_dwordx4 v240, s[12:15], s39 offen lds
    s_add_u32 m0, m0, 1024
    s_add_u32 s39, s39, s3
    buffer_load_dwordx4 v239, s[12:15], s39 offen lds
    s_add_u32 m0, m0, 1024
    s_add_u32 s39, s39, s32
    buffer_load_dwordx4 v240, s[12:15], s39 offen lds
    s_add_u32 m0, m0, 1024
    s_add_u32 s39, s39, s32
    buffer_load_dwordx4 v239, s[12:15], s39 offen lds
    s_add_u32 m0, m0, 1024
    s_add_u32 s39, s39, s32
    buffer_load_dwordx4 v240, s[12:15], s39 offen lds
    s_mov_b32 m0, s19
    s_mov_b32 s39, s16
    s_mov_b32 s32, s17
    s_mov_b32 s3, s18
    s_waitcnt vmcnt(24)
    s_barrier
    buffer_load_dwordx4 v239, s[12:15], s39 offen lds
    s_add_u32 m0, m0, 1024
    s_add_u32 s39, s39, s32
    buffer_load_dwordx4 v240, s[12:15], s39 offen lds
    s_mov_b32 s43, 1
ld_76:
    s_mov_b32 s45, 8192
    s_add_u32 s19, s41, s42
    v_readlane_b32 s16, v249, s44
    s_nop 0
    s_bitcmp1_b32 s16, 0
    s_cselect_b32 s17, 16384, s45
    s_cselect_b32 s18, -40960, s45
    s_andn2_b32 s16, s16, 1
    s_add_u32 s16, s16, s38
    s_add_u32 s44, s44, 1
    s_add_u32 s42, s42, 16384
    s_cmp_eq_u32 s42, 98304
    s_cselect_b32 s42, 0, s42
    s_add_u32 m0, m0, 1024
    s_add_u32 s39, s39, s32
    buffer_load_dwordx4 v239, s[12:15], s39 offen lds
    s_add_u32 m0, m0, 1024
    s_add_u32 s39, s39, s32
    buffer_load_dwordx4 v240, s[12:15], s39 offen lds
    s_add_u32 m0, m0, 1024
    s_add_u32 s39, s39, s3
    buffer_load_dwordx4 v239, s[12:15], s39 offen lds
    s_add_u32 m0, m0, 1024
    s_add_u32 s39, s39, s32
    buffer_load_dwordx4 v240, s[12:15], s39 offen lds
    s_add_u32 m0, m0, 1024
    s_add_u32 s39, s39, s32
    buffer_load_dwordx4 v239, s[12:15], s39 offen lds
    s_add_u32 m0, m0, 1024
    s_add_u32 s39, s39, s32
    buffer_load_dwordx4 v240, s[12:15], s39 offen lds
    s_mov_b32 m0, s19
    s_mov_b32 s39, s16
    s_mov_b32 s32, s17
    s_mov_b32 s3, s18
    s_waitcnt vmcnt(32)
    s_barrier
    buffer_load_dwordx4 v239, s[12:15], s39 offen lds
    s_add_u32 m0, m0, 1024
    s_add_u32 s39, s39, s32
    buffer_load_dwordx4 v240, s[12:15], s39 offen lds
    s_add_u32 s43, s43, 1
    s_cmp_lt_u32 s43, 18
    s_cbranch_scc1 ld_76
    s_call_b64 s[76:77], PREP_w_issue_4
    s_add_u32 m0, m0, 1024
    s_add_u32 s39, s39, s32
    buffer_load_dwordx4 v239, s[12:15], s39 offen lds
    s_add_u32 m0, m0, 1024
    s_add_u32 s39, s39, s32
    buffer_load_dwordx4 v240, s[12:15], s39 offen lds
    s_add_u32 m0, m0, 1024
    s_add_u32 s39, s39, s3
    buffer_load_dwordx4 v239, s[12:15], s39 offen lds
    s_add_u32 m0, m0, 1024
    s_add_u32 s39, s39, s32
    buffer_load_dwordx4 v240, s[12:15], s39 offen lds
    s_add_u32 m0, m0, 1024
    s_add_u32 s39, s39, s32
    buffer_load_dwordx4 v239, s[12:15], s39 offen lds
    s_add_u32 m0, m0, 1024
    s_add_u32 s39, s39, s32
    buffer_load_dwordx4 v240, s[12:15], s39 offen lds
    s_mov_b32 m0, s19
    s_mov_b32 s39, s16
    s_mov_b32 s32, s17
    s_mov_b32 s3, s18
    s_waitcnt vmcnt(32)
    s_barrier
    buffer_load_dwordx4 v239, s[12:15], s39 offen lds
    s_add_u32 m0, m0, 1024
    s_add_u32 s39, s39, s32
    buffer_load_dwordx4 v240, s[12:15], s39 offen lds
    s_add_u32 m0, m0, 1024
    s_add_u32 s39, s39, s32
    buffer_load_dwordx4 v239, s[12:15], s39 offen lds
    s_add_u32 m0, m0, 1024
    s_add_u32 s39, s39, s32
    buffer_load_dwordx4 v240, s[12:15], s39 offen lds
    s_add_u32 m0, m0, 1024
    s_add_u32 s39, s39, s3
    buffer_load_dwordx4 v239, s[12:15], s39 offen lds
    s_add_u32 m0, m0, 1024
    s_add_u32 s39, s39, s32
    buffer_load_dwordx4 v240, s[12:15], s39 offen lds
    s_add_u32 m0, m0, 1024
    s_add_u32 s39, s39, s32
    buffer_load_dwordx4 v239, s[12:15], s39 offen lds
    s_add_u32 m0, m0, 1024
    s_add_u32 s39, s39, s32
    buffer_load_dwordx4 v240, s[12:15], s39 offen lds
    s_waitcnt vmcnt(32)
    s_barrier
    s_mov_b64 s[12:13], s[68:69]
    s_mov_b32 s14, 2097152
    s_mov_b32 s15, 0x20000
    s_and_b32 s35, s30, 1
    s_mul_i32 s38, s99, 128
    s_mul_i32 s41, s35, 65536
    s_add_u32 s38, s38, s41
    s_mul_i32 s41, s35, 4096
    s_add_u32 s41, s41, 24576
    s_mov_b32 s42, 0
    s_mov_b32 s44, s67
    s_and_b32 s36, s99, 7
    s_cmp_eq_u32 s36, 3
    s_cselect_b64 s[50:51], 0, -1
    s_mov_b32 s42, 90112
    s_mov_b32 s44, s67
    s_add_u32 s44, s44, 11
    s_and_b32 s44, s44, 15
    s_call_b64 s[76:77], SUB_w_issue_1
    s_mov_b32 s42, 98304
    s_mov_b32 s44, s67
    s_add_u32 s44, s44, 12
    s_and_b32 s44, s44, 15
    s_call_b64 s[76:77], SUB_w_issue_1
    s_mov_b32 s42, 122880
    s_mov_b32 s44, s67
    s_add_u32 s44, s44, 15
    s_and_b32 s44, s44, 15
    s_call_b64 s[76:77], SUB_w_issue_1
    s_add_u32 s39, s38, 1179648
    buffer_load_dwordx4 v[16:19], v238, s[12:15], s39 offen
    s_add_u32 s39, s39, 16384
    buffer_load_dwordx4 v[20:23], v238, s[12:15], s39 offen
    s_add_u32 s39, s39, 16384
    buffer_load_dwordx4 v[24:27], v238, s[12:15], s39 offen
    s_add_u32 s39, s39, 16384
    buffer_load_dwordx4 v[28:31], v238, s[12:15], s39 offen
    s_add_u32 s39, s39, 16384
    s_waitcnt vmcnt(40)
    s_barrier
    s_mov_b32 s42, 106496
    s_mov_b32 s44, s67
    s_add_u32 s44, s44, 13
    s_and_b32 s44, s44, 15
    s_call_b64 s[76:77], SUB_w_issue_1
    s_mov_b32 s42, 114688
    s_mov_b32 s44, s67
    s_add_u32 s44, s44, 14
    s_and_b32 s44, s44, 15
    s_call_b64 s[76:77], SUB_w_issue_1
    s_add_u32 s39, s38, 1310720
    buffer_load_dwordx4 v[32:35], v238, s[12:15], s39 offen
    s_add_u32 s39, s39, 16384
    buffer_load_dwordx4 v[36:39], v238, s[12:15], s39 offen
    s_add_u32 s39, s39, 16384
    buffer_load_dwordx4 v[40:43], v238, s[12:15], s39 offen
    s_add_u32 s39, s39, 16384
    buffer_load_dwordx4 v[44:47], v238, s[12:15], s39 offen
    s_add_u32 s39, s39, 16384
    s_waitcnt vmcnt(44)
    s_barrier
    s_mov_b32 s42, 24576
    s_mov_b32 s44, s67
    s_add_u32 s44, s44, 3
    s_and_b32 s44, s44, 15
    s_call_b64 s[76:77], SUB_w_issue_1
    s_mov_b32 s42, 32768
    s_mov_b32 s44, s67
    s_add_u32 s44, s44, 4
    s_and_b32 s44, s44, 15
    s_call_b64 s[76:77], SUB_w_issue_1
    s_waitcnt vmcnt(44)
    s_barrier
    s_mov_b32 s42, 40960
    s_mov_b32 s44, s67
    s_add_u32 s44, s44, 5
    s_and_b32 s44, s44, 15
    s_call_b64 s[76:77], SUB_w_issue_1
    s_mov_b32 s42, 49152
    s_mov_b32 s44, s67
    s_add_u32 s44, s44, 6
    s_and_b32 s44, s44, 15
    s_call_b64 s[76:77], SUB_w_issue_1
    s_mov_b32 s42, 0
    s_mov_b32 s44, s67
    s_add_u32 s44, s44, 0
    s_and_b32 s44, s44, 15
    s_call_b64 s[76:77], SUB_w_issue_1
    s_waitcnt vmcnt(48)
    s_barrier
    s_mov_b32 s42, 57344
    s_mov_b32 s44, s67
    s_add_u32 s44, s44, 7
    s_and_b32 s44, s44, 15
    s_call_b64 s[76:77], SUB_w_issue_1
    s_mov_b32 s42, 65536
    s_mov_b32 s44, s67
    s_add_u32 s44, s44, 8
    s_and_b32 s44, s44, 15
    s_call_b64 s[76:77], SUB_w_issue_1
    s_mov_b32 s42, 8192
    s_mov_b32 s44, s67
    s_add_u32 s44, s44, 1
    s_and_b32 s44, s44, 15
    s_call_b64 s[76:77], SUB_w_issue_1
    s_mov_b32 s42, 16384
    s_mov_b32 s44, s67
    s_add_u32 s44, s44, 2
    s_and_b32 s44, s44, 15
    s_call_b64 s[76:77], SUB_w_issue_1
    s_barrier
    s_add_u32 s36, s41, 73728
    v_add_u32 v6, s36, v2
    s_waitcnt vmcnt(36)
    ds_write_b128 v6, v[16:19] offset:0
    ds_write_b128 v6, v[20:23] offset:1024
    ds_write_b128 v6, v[24:27] offset:2048
    ds_write_b128 v6, v[28:31] offset:3072
    ds_write_b128 v6, v[32:35] offset:8192
    ds_write_b128 v6, v[36:39] offset:9216
    ds_write_b128 v6, v[40:43] offset:10240
    ds_write_b128 v6, v[44:47] offset:11264
    s_waitcnt lgkmcnt(0)
    s_branch NEXT
WL_t1:
    s_call_b64 s[76:77], PREP_w_issue_4
    s_mov_b32 m0, s19
    s_mov_b32 s39, s16
    s_mov_b32 s32, s17
    s_mov_b32 s3, s18
    s_waitcnt vmcnt(0)
    s_barrier
    s_waitcnt vmcnt(0)
    s_barrier
    s_waitcnt vmcnt(0)
    s_barrier
    s_waitcnt vmcnt(0)
    s_barrier
    s_waitcnt vmcnt(0)
    s_barrier
    buffer_load_dwordx4 v239, s[12:15], s39 offen lds
    s_add_u32 m0, m0, 1024
    s_add_u32 s39, s39, s32
    buffer_load_dwordx4 v240, s[12:15], s39 offen lds
    s_mov_b32 s43, 1
ld_77:
    s_mov_b32 s45, 8192
    s_add_u32 s19, s41, s42
    v_readlane_b32 s16, v249, s44
    s_nop 0
    s_bitcmp1_b32 s16, 0
    s_cselect_b32 s17, 16384, s45
    s_cselect_b32 s18, -40960, s45
    s_andn2_b32 s16, s16, 1
    s_add_u32 s16, s16, s38
    s_add_u32 s44, s44, 1
    s_add_u32 s42, s42, 16384
    s_cmp_eq_u32 s42, 98304
    s_cselect_b32 s42, 0, s42
    s_add_u32 m0, m0, 1024
    s_add_u32 s39, s39, s32
    buffer_load_dwordx4 v239, s[12:15], s39 offen lds
    s_add_u32 m0, m0, 1024
    s_add_u32 s39, s39, s32
    buffer_load_dwordx4 v240, s[12:15], s39 offen lds
    s_add_u32 m0, m0, 1024
    s_add_u32 s39, s39, s3
    buffer_load_dwordx4 v239, s[12:15], s39 offen lds
    s_add_u32 m0, m0, 1024
    s_add_u32 s39, s39, s32
    buffer_load_dwordx4 v240, s[12:15], s39 offen lds
    s_add_u32 m0, m0, 1024
    s_add_u32 s39, s39, s32
    buffer_load_dwordx4 v239, s[12:15], s39 offen lds
    s_add_u32 m0, m0, 1024
    s_add_u32 s39, s39, s32
    buffer_load_dwordx4 v240, s[12:15], s39 offen lds
    s_mov_b32 m0, s19
    s_mov_b32 s39, s16
    s_mov_b32 s32, s17
    s_mov_b32 s3, s18
    s_waitcnt vmcnt(8)
    s_barrier
    buffer_load_dwordx4 v239, s[12:15], s39 offen lds
    s_add_u32 m0, m0, 1024
    s_add_u32 s39, s39, s32
    buffer_load_dwordx4 v240, s[12:15], s39 offen lds
    s_add_u32 s43, s43, 1
    s_cmp_lt_u32 s43, 21
    s_cbranch_scc1 ld_77
    s_call_b64 s[76:77], PREP_w_issue_4
    s_add_u32 m0, m0, 1024
    s_add_u32 s39, s39, s32
    buffer_load_dwordx4 v239, s[12:15], s39 offen lds
    s_add_u32 m0, m0, 1024
    s_add_u32 s39, s39, s32
    buffer_load_dwordx4 v240, s[12:15], s39 offen lds
    s_add_u32 m0, m0, 1024
    s_add_u32 s39, s39, s3
    buffer_load_dwordx4 v239, s[12:15], s39 offen lds
    s_add_u32 m0, m0, 1024
    s_add_u32 s39, s39, s32
    buffer_load_dwordx4 v240, s[12:15], s39 offen lds
    s_add_u32 m0, m0, 1024
    s_add_u32 s39, s39, s32
    buffer_load_dwordx4 v239, s[12:15], s39 offen lds
    s_add_u32 m0, m0, 1024
    s_add_u32 s39, s39, s32
    buffer_load_dwordx4 v240, s[12:15], s39 offen lds
    s_mov_b32 m0, s19
    s_mov_b32 s39, s16
    s_mov_b32 s32, s17
    s_mov_b32 s3, s18
    s_waitcnt vmcnt(8)
    s_barrier
    buffer_load_dwordx4 v239, s[12:15], s39 offen lds
    s_add_u32 m0, m0, 1024
    s_add_u32 s39, s39, s32
    buffer_load_dwordx4 v240, s[12:15], s39 offen lds
    s_add_u32 m0, m0, 1024
    s_add_u32 s39, s39, s32
    buffer_load_dwordx4 v239, s[12:15], s39 offen lds
    s_add_u32 m0, m0, 1024
    s_add_u32 s39, s39, s32
    buffer_load_dwordx4 v240, s[12:15], s39 offen lds
    s_add_u32 m0, m0, 1024
    s_add_u32 s39, s39, s3
    buffer_load_dwordx4 v239, s[12:15], s39 offen lds
    s_add_u32 m0, m0, 1024
    s_add_u32 s39, s39, s32
    buffer_load_dwordx4 v240, s[12:15], s39 offen lds
    s_add_u32 m0, m0, 1024
    s_add_u32 s39, s39, s32
    buffer_load_dwordx4 v239, s[12:15], s39 offen lds
    s_add_u32 m0, m0, 1024
    s_add_u32 s39, s39, s32
    buffer_load_dwordx4 v240, s[12:15], s39 offen lds
    s_waitcnt vmcnt(8)
    s_barrier
    s_waitcnt vmcnt(0)
    s_barrier
    s_branch K_fin
NEXT:
    s_setprio 0
    s_add_u32 s60, s60, 1
    s_add_u32 s55, s55, 4194304
    s_add_u32 s62, s62, 4194304
    s_addc_u32 s63, s63, 0
    s_branch LAYER
K_fin:
    s_endpgm
SUB_w1_regs:
    s_mov_b64 s[12:13], s[68:69]
    s_mov_b32 s14, 2097152
    s_mov_b32 s15, 0x20000
    s_and_b32 s35, s30, 3
    s_mul_i32 s35, s35, 294912
    s_lshl_b32 s39, s99, 7
    s_add_u32 s39, s39, s35
    buffer_load_dwordx4 v[176:179], v238, s[12:15], s39 offen
    s_add_u32 s39, s39, 16384
    buffer_load_dwordx4 v[188:191], v238, s[12:15], s39 offen
    s_add_u32 s39, s39, 16384
    buffer_load_dwordx4 v[192:195], v238, s[12:15], s39 offen
    s_add_u32 s39, s39, 16384
    buffer_load_dwordx4 v[200:203], v238, s[12:15], s39 offen
    s_add_u32 s39, s39, 16384
    s_waitcnt vmcnt(8)
    buffer_load_dwordx4 v[204:207], v238, s[12:15], s39 offen
    s_add_u32 s39, s39, 16384
    buffer_load_dwordx4 v[208:211], v238, s[12:15], s39 offen
    s_add_u32 s39, s39, 16384
    buffer_load_dwordx4 v[212:215], v238, s[12:15], s39 offen
    s_add_u32 s39, s39, 16384
    buffer_load_dwordx4 v[216:219], v238, s[12:15], s39 offen
    s_add_u32 s39, s39, 16384
    s_waitcnt vmcnt(8)
    buffer_load_dwordx4 v[220:223], v238, s[12:15], s39 offen
    s_add_u32 s39, s39, 16384
    buffer_load_dwordx4 v[224:227], v238, s[12:15], s39 offen
    s_add_u32 s39, s39, 16384
    buffer_load_dwordx4 v[16:19], v238, s[12:15], s39 offen
    s_add_u32 s39, s39, 16384
    buffer_load_dwordx4 v[20:23], v238, s[12:15], s39 offen
    s_add_u32 s39, s39, 16384
    s_waitcnt vmcnt(8)
    buffer_load_dwordx4 v[24:27], v238, s[12:15], s39 offen
    s_add_u32 s39, s39, 16384
    buffer_load_dwordx4 v[28:31], v238, s[12:15], s39 offen
    s_add_u32 s39, s39, 16384
    buffer_load_dwordx4 v[32:35], v238, s[12:15], s39 offen
    s_add_u32 s39, s39, 16384
    buffer_load_dwordx4 v[36:39], v238, s[12:15], s39 offen
    s_add_u32 s39, s39, 16384
    s_waitcnt vmcnt(8)
    buffer_load_dwordx4 v[40:43], v238, s[12:15], s39 offen
    s_add_u32 s39, s39, 16384
    buffer_load_dwordx4 v[44:47], v238, s[12:15], s39 offen
    s_add_u32 s39, s39, 16384
    s_setpc_b64 s[76:77]
SUB_park:
    s_mov_b64 s[12:13], s[70:71]
    s_mov_b32 s14, 2097152
    s_mov_b32 s15, 0x20000
    s_and_b32 s35, s30, 3
    s_lshl_b32 s35, s35, 19
    s_lshl_b32 s39, s29, 7
    s_add_u32 s39, s39, s35
    buffer_load_dwordx4 v[48:51], v238, s[12:15], s39 offen
    s_add_u32 s39, s39, 16384
    buffer_load_dwordx4 v[52:55], v238, s[12:15], s39 offen
    s_add_u32 s39, s39, 16384
    buffer_load_dwordx4 v[56:59], v238, s[12:15], s39 offen
    s_add_u32 s39, s39, 16384
    buffer_load_dwordx4 v[60:63], v238, s[12:15], s39 offen
    s_add_u32 s39, s39, 16384
    s_waitcnt vmcnt(8)
    buffer_load_dwordx4 v[64:67], v238, s[12:15], s39 offen
    s_add_u32 s39, s39, 16384
    buffer_load_dwordx4 v[68:71], v238, s[12:15], s39 offen
    s_add_u32 s39, s39, 16384
    buffer_load_dwordx4 v[72:75], v238, s[12:15], s39 offen
    s_add_u32 s39, s39, 16384
    buffer_load_dwordx4 v[76:79], v238, s[12:15], s39 offen
    s_add_u32 s39, s39, 16384
    s_waitcnt vmcnt(8)
    buffer_load_dwordx4 v[80:83], v238, s[12:15], s39 offen
    s_add_u32 s39, s39, 16384
    buffer_load_dwordx4 v[84:87], v238, s[12:15], s39 offen
    s_add_u32 s39, s39, 16384
    buffer_load_dwordx4 v[88:91], v238, s[12:15], s39 offen
    s_add_u32 s39, s39, 16384
    buffer_load_dwordx4 v[92:95], v238, s[12:15], s39 offen
    s_add_u32 s39, s39, 16384
    s_waitcnt vmcnt(8)
    buffer_load_dwordx4 v[96:99], v238, s[12:15], s39 offen
    s_add_u32 s39, s39, 16384
    buffer_load_dwordx4 v[100:103], v238, s[12:15], s39 offen
    s_add_u32 s39, s39, 16384
    buffer_load_dwordx4 v[104:107], v238, s[12:15], s39 offen
    s_add_u32 s39, s39, 16384
    buffer_load_dwordx4 v[108:111], v238, s[12:15], s39 offen
    s_add_u32 s39, s39, 16384
    s_waitcnt vmcnt(8)
    buffer_load_dwordx4 v[112:115], v238, s[12:15], s39 offen
    s_add_u32 s39, s39, 16384
    buffer_load_dwordx4 v[116:119], v238, s[12:15], s39 offen
    s_add_u32 s39, s39, 16384
    buffer_load_dwordx4 v[120:123], v238, s[12:15], s39 offen
    s_add_u32 s39, s39, 16384
    buffer_load_dwordx4 v[124:127], v238, s[12:15], s39 offen
    s_add_u32 s39, s39, 16384
    s_waitcnt vmcnt(8)
    buffer_load_dwordx4 v[128:131], v238, s[12:15], s39 offen
    s_add_u32 s39, s39, 16384
    buffer_load_dwordx4 v[132:135], v238, s[12:15], s39 offen
    s_add_u32 s39, s39, 16384
    buffer_load_dwordx4 v[136:139], v238, s[12:15], s39 offen
    s_add_u32 s39, s39, 16384
    buffer_load_dwordx4 v[140:143], v238, s[12:15], s39 offen
    s_add_u32 s39, s39, 16384
    s_waitcnt vmcnt(8)
    s_setpc_b64 s[76:77]
SUB_park2:
    s_mov_b64 s[12:13], s[70:71]
    s_mov_b32 s14, 2097152
    s_mov_b32 s15, 0x20000
    s_and_b32 s35, s30, 3
    s_lshl_b32 s35, s35, 19
    s_lshl_b32 s39, s29, 7
    s_add_u32 s39, s39, s35
    s_add_u32 s39, s39, 393216
    buffer_load_dwordx4 v[144:147], v238, s[12:15], s39 offen
    s_add_u32 s39, s39, 16384
    buffer_load_dwordx4 v[148:151], v238, s[12:15], s39 offen
    s_add_u32 s39, s39, 16384
    buffer_load_dwordx4 v[152:155], v238, s[12:15], s39 offen
    s_add_u32 s39, s39, 16384
    buffer_load_dwordx4 v[156:159], v238, s[12:15], s39 offen
    s_add_u32 s39, s39, 16384
    s_waitcnt vmcnt(8)
    buffer_load_dwordx4 v[160:163], v238, s[12:15], s39 offen
    s_add_u32 s39, s39, 16384
    buffer_load_dwordx4 v[164:167], v238, s[12:15], s39 offen
    s_add_u32 s39, s39, 16384
    buffer_load_dwordx4 v[168:171], v238, s[12:15], s39 offen
    s_add_u32 s39, s39, 16384
    buffer_load_dwordx4 v[172:175], v238, s[12:15], s39 offen
    s_add_u32 s39, s39, 16384
    s_waitcnt vmcnt(8)
    s_setpc_b64 s[76:77]
SUB_w1_put:
    s_and_b32 s35, s30, 3
    s_mul_i32 s35, s35, 18432
    v_add_u32 v8, s35, v2
    v_mov_b32 v6, 162836
spin_78:
    s_sleep 2
    ds_read_b32 v7, v6
    s_waitcnt lgkmcnt(0)
    v_readfirstlane_b32 s53, v7
    s_nop 0
    s_cmp_ge_u32 s53, 8
    s_cbranch_scc0 spin_78
    s_waitcnt vmcnt(24)
    ds_write_b128 v8, v[176:179] offset:24576
    ds_write_b128 v8, v[188:191] offset:25600
    ds_write_b128 v8, v[192:195] offset:26624
    ds_write_b128 v8, v[200:203] offset:27648
    ds_write_b128 v8, v[204:207] offset:28672
    ds_write_b128 v8, v[208:211] offset:29696
    ds_write_b128 v8, v[212:215] offset:30720
    ds_write_b128 v8, v[216:219] offset:31744
    ds_write_b128 v8, v[220:223] offset:32768
    ds_write_b128 v8, v[224:227] offset:33792
    ds_write_b128 v8, v[16:19] offset:34816
    ds_write_b128 v8, v[20:23] offset:35840
    ds_write_b128 v8, v[24:27] offset:36864
    ds_write_b128 v8, v[28:31] offset:37888
    ds_write_b128 v8, v[32:35] offset:38912
    ds_write_b128 v8, v[36:39] offset:39936
    ds_write_b128 v8, v[40:43] offset:40960
    ds_write_b128 v8, v[44:47] offset:41984
    s_waitcnt lgkmcnt(0)
    s_setpc_b64 s[76:77]
SUB_after_g1:
    s_mov_b64 s[12:13], s[72:73]
    s_mov_b32 s14, 7340032
    s_mov_b32 s15, 0x20000
    v_readlane_b32 s36, v251, 0
    v_readlane_b32 s37, v251, 1
    v_readlane_b32 s34, v251, 2
    s_and_b32 s35, s30, 3
    s_mul_i32 s38, s35, 114688
    s_mul_i32 s39, s29, 448
    s_add_u32 s38, s38, s39
    s_and_b32 s36, s36, 15
    s_mul_i32 s36, s36, 458752
    s_add_u32 s36, s36, s38
    s_and_b32 s37, s37, 15
    s_mul_i32 s37, s37, 458752
    s_add_u32 s37, s37, s38
    s_and_b32 s34, s34, 15
    s_mul_i32 s34, s34, 458752
    s_add_u32 s34, s34, s38
    s_mul_i32 s39, s35, 7168
    s_add_u32 m0, s39, 131072
    s_nop 0
    buffer_load_dwordx4 v241, s[12:15], s36 offen lds
    s_add_u32 m0, m0, 1024
    s_nop 0
    buffer_load_dwordx4 v242, s[12:15], s36 offen lds
    s_add_u32 m0, m0, 1024
    s_nop 0
    buffer_load_dwordx4 v243, s[12:15], s36 offen lds
    s_add_u32 m0, m0, 1024
    s_nop 0
    buffer_load_dwordx4 v244, s[12:15], s36 offen lds
    s_add_u32 m0, m0, 1024
    s_nop 0
    buffer_load_dwordx4 v245, s[12:15], s36 offen lds
    s_add_u32 m0, m0, 1024
    s_nop 0
    buffer_load_dwordx4 v246, s[12:15], s36 offen lds
    s_add_u32 m0, m0, 1024
    s_nop 0
    buffer_load_dwordx4 v247, s[12:15], s36 offen lds
    buffer_load_dwordx4 v[176:179], v241, s[12:15], s37 offen
    buffer_load_dwordx4 v[180:183], v242, s[12:15], s37 offen
    buffer_load_dwordx4 v[184:187], v243, s[12:15], s37 offen
    buffer_load_dwordx4 v[188:191], v244, s[12:15], s37 offen
    buffer_load_dwordx4 v[192:195], v245, s[12:15], s37 offen
    buffer_load_dwordx4 v[196:199], v246, s[12:15], s37 offen
    buffer_load_dwordx4 v[200:203], v247, s[12:15], s37 offen
    s_lshr_b32 s36, s67, 2
    s_sub_u32 s36, s35, s36
    s_and_b32 s36, s36, 3
    s_lshl_b32 s36, s36, 15
    v_add_u32 v6, s36, v2
    s_waitcnt vmcnt(14)
    ds_write_b128 v6, v[48:51] offset:0
    ds_write_b128 v6, v[52:55] offset:1024
    ds_write_b128 v6, v[56:59] offset:2048
    ds_write_b128 v6, v[60:63] offset:3072
    ds_write_b128 v6, v[64:67] offset:4096
    ds_write_b128 v6, v[68:71] offset:5120
    ds_write_b128 v6, v[72:75] offset:6144
    ds_write_b128 v6, v[76:79] offset:7168
    ds_write_b128 v6, v[80:83] offset:8192
    ds_write_b128 v6, v[84:87] offset:9216
    ds_write_b128 v6, v[88:91] offset:10240
    ds_write_b128 v6, v[92:95] offset:11264
    ds_write_b128 v6, v[96:99] offset:12288
    ds_write_b128 v6, v[100:103] offset:13312
    ds_write_b128 v6, v[104:107] offset:14336
    ds_write_b128 v6, v[108:111] offset:15360
    ds_write_b128 v6, v[112:115] offset:16384
    ds_write_b128 v6, v[116:119] offset:17408
    ds_write_b128 v6, v[120:123] offset:18432
    ds_write_b128 v6, v[124:127] offset:19456
    ds_write_b128 v6, v[128:131] offset:20480
    ds_write_b128 v6, v[132:135] offset:21504
    ds_write_b128 v6, v[136:139] offset:22528
    ds_write_b128 v6, v[140:143] offset:23552
    ds_write_b128 v6, v[144:147] offset:24576
    ds_write_b128 v6, v[148:151] offset:25600
    ds_write_b128 v6, v[152:155] offset:26624
    ds_write_b128 v6, v[156:159] offset:27648
    ds_write_b128 v6, v[160:163] offset:28672
    ds_write_b128 v6, v[164:167] offset:29696
    ds_write_b128 v6, v[168:171] offset:30720
    ds_write_b128 v6, v[172:175] offset:31744
    s_waitcnt lgkmcnt(0)
    s_setpc_b64 s[76:77]
SUB_after_g2:
    s_and_b32 s35, s30, 3
    s_mul_i32 s39, s35, 7168
    s_add_u32 s39, s39, 73728
    v_add_u32 v7, s39, v2
    ds_write_b128 v7, v[176:179] offset:0
    ds_write_b128 v7, v[180:183] offset:1024
    ds_write_b128 v7, v[184:187] offset:2048
    ds_write_b128 v7, v[188:191] offset:3072
    ds_write_b128 v7, v[192:195] offset:4096
    ds_write_b128 v7, v[196:199] offset:5120
    ds_write_b128 v7, v[200:203] offset:6144
    s_waitcnt lgkmcnt(0)
    s_setpc_b64 s[76:77]
SUB_r_pre:
    v_and_b32 v199, 7, v0
    v_lshrrev_b32 v228, 6, v0
    v_lshlrev_b32 v228, 4, v228
    v_bfe_u32 v229, v0, 3, 3
    v_add_u32 v228, v228, v229
    s_lshr_b32 s78, s29, 1
    s_lshl_b32 s78, s78, 16
    s_and_b32 s79, s29, 1
    s_lshl_b32 s79, s79, 7
    s_add_u32 s78, s78, s79
    s_lshr_b32 s79, s30, 1
    s_lshl_b32 s79, s79, 13
    s_add_u32 s78, s78, s79
    v_lshlrev_b32 v196, 8, v228
    v_lshl_add_u32 v196, v199, 4, v196
    v_add_u32 v196, s78, v196
    s_mov_b32 s84, s62
    s_mov_b32 s85, s63
    s_mov_b32 s86, 0x7e000
    s_mov_b32 s87, 0x20000
    s_add_u32 s88, s62, 0x80000
    s_addc_u32 s89, s63, 0
    s_mov_b32 s90, 0x7e000
    s_mov_b32 s91, 0x20000
    buffer_load_dwordx4 v[180:183], v196, s[84:87], 0 offen offset:0 sc1
    buffer_load_dwordx4 v[188:191], v196, s[88:91], 0 offen offset:0 sc1
    buffer_load_dwordx4 v[184:187], v196, s[84:87], 0 offen offset:2048 sc1
    buffer_load_dwordx4 v[192:195], v196, s[88:91], 0 offen offset:2048 sc1
    s_setpc_b64 s[76:77]
SUB_r_pre0:
    v_and_b32 v199, 7, v0
    v_lshrrev_b32 v228, 6, v0
    v_lshlrev_b32 v228, 4, v228
    v_bfe_u32 v229, v0, 3, 3
    v_add_u32 v228, v228, v229
    s_lshr_b32 s78, s29, 1
    s_lshl_b32 s78, s78, 16
    s_and_b32 s79, s29, 1
    s_lshl_b32 s79, s79, 7
    s_add_u32 s78, s78, s79
    s_lshr_b32 s79, s30, 1
    s_lshl_b32 s79, s79, 13
    s_add_u32 s78, s78, s79
    v_lshlrev_b32 v196, 8, v228
    v_lshl_add_u32 v196, v199, 4, v196
    v_add_u32 v196, s78, v196
    s_mov_b32 s84, s62
    s_mov_b32 s85, s63
    s_mov_b32 s86, 0x7e000
    s_mov_b32 s87, 0x20000
    s_add_u32 s88, s62, 0x80000
    s_addc_u32 s89, s63, 0
    s_mov_b32 s90, 0x7e000
    s_mov_b32 s91, 0x20000
    s_cmp_eq_u32 s60, 0
    s_cselect_b64 exec, -1, 0
    buffer_load_dwordx4 v[180:183], v196, s[84:87], 0 offen offset:0 sc1
    buffer_load_dwordx4 v[188:191], v196, s[88:91], 0 offen offset:0 sc1
    buffer_load_dwordx4 v[184:187], v196, s[84:87], 0 offen offset:2048 sc1
    buffer_load_dwordx4 v[192:195], v196, s[88:91], 0 offen offset:2048 sc1
    s_mov_b64 exec, -1
    s_setpc_b64 s[76:77]
SUB_w_issue_1:
    s_add_u32 s19, s41, s42
    s_mul_i32 s16, s44, 131072
    s_add_u32 s16, s16, s38
    s_add_u32 s44, s44, 1
    s_and_b32 s44, s44, 15
    s_add_u32 s42, s42, 8192
    s_cmp_eq_u32 s42, 131072
    s_cselect_b32 s42, 0, s42
    s_mov_b32 m0, s19
    s_mov_b32 s39, s16
    buffer_load_dwordx4 v238, s[12:15], s39 offen lds
    s_add_u32 m0, m0, 1024
    s_add_u32 s39, s39, 16384
    buffer_load_dwordx4 v238, s[12:15], s39 offen lds
    s_add_u32 m0, m0, 1024
    s_add_u32 s39, s39, 16384
    buffer_load_dwordx4 v238, s[12:15], s39 offen lds
    s_add_u32 m0, m0, 1024
    s_add_u32 s39, s39, 16384
    buffer_load_dwordx4 v238, s[12:15], s39 offen lds
    s_setpc_b64 s[76:77]
PREP_a_issue_4:
    s_add_u32 s19, s41, s42
    v_readlane_b32 s16, v249, s44
    v_readlane_b32 s17, v250, s44
    s_add_u32 s16, s16, s38
    s_add_u32 s17, s17, s38
    s_add_u32 s44, s44, 1
    s_add_u32 s42, s42, 16384
    s_cmp_eq_u32 s42, 49152
    s_cselect_b32 s42, 0, s42
    s_setpc_b64 s[76:77]
PREP_w_issue_4:
    s_mov_b32 s45, 8192
    s_add_u32 s19, s41, s42
    v_readlane_b32 s16, v249, s44
    s_nop 0
    s_bitcmp1_b32 s16, 0
    s_cselect_b32 s17, 16384, s45
    s_cselect_b32 s18, -40960, s45
    s_andn2_b32 s16, s16, 1
    s_add_u32 s16, s16, s38
    s_add_u32 s44, s44, 1
    s_add_u32 s42, s42, 16384
    s_cmp_eq_u32 s42, 98304
    s_cselect_b32 s42, 0, s42
    s_setpc_b64 s[76:77]
K_end:
    s_endpgm
.p2align 6
K_tab:
.short 4096,5137,6178,11379,18660,25941,40502,33223,47784,55065,19706,12427,26988,34269,48830,41551,56096,9264,20736,10448,23824,25008,38384,35296,39568,49856,54128,52944,0,0,0,0
.short 4096,5137,6178,18659,11380,25941,33222,47783,40504,55065,12426,26987,19708,34269,41550,56111,48816,9264,10448,23824,20736,25008,35296,39568,38384,49856,52944,54128,0,0,0,0
.short 4096,5137,6178,11379,25940,18661,33222,40503,55064,47785,12426,19707,34268,26989,41550,48831,9264,56096,10448,20736,25008,23824,35296,38384,49856,39568,52944,54128,0,0,0,0
.short 4096,5137,6178,11379,18660,33221,25942,40503,47784,12425,55066,19707,26988,41549,34270,48831,56096,10448,9264,20736,23824,35296,25008,38384,39568,52944,49856,54128,0,0,0,0
.short 11377,12418,13459,18660,4101,25942,33223,47784,40505,55066,5147,26988,19709,34270,41551,56096,48816,6176,10288,23824,20736,25008,35296,39568,38384,49856,52944,54128,0,0,0,0
.short 11377,12418,13459,4100,25941,18662,33223,40504,55065,47786,5147,19708,34269,26990,41551,48816,6176,56096,10288,20736,25008,23824,35296,38384,49856,39568,52944,54128,0,0,0,0
.short 11377,12418,13459,4100,18661,33222,25943,40504,47785,5146,55067,19708,26989,41550,34271,48816,56096,10288,6176,20736,23824,35296,25008,38384,39568,52944,49856,54128,0,0,0,0
.short 11377,12418,13459,4100,18661,25942,40503,33224,47785,55066,19707,5148,26989,34270,48831,41536,56096,6176,20736,10288,23824,25008,38384,35296,39568,49856,54128,52944,0,0,0,0
.short 18658,19699,20740,4101,25942,11383,33224,40505,55066,47787,5148,12429,34270,26991,41536,48817,6176,56096,9264,10448,25008,23824,35296,38384,49856,39568,52944,54128,0,0,0,0
.short 18658,19699,20740,4101,11382,33223,25944,40505,47786,5147,55068,12429,26990,41551,34256,48817,56096,9264,6176,10448,23824,35296,25008,38384,39568,52944,49856,54128,0,0,0,0
.short 18658,19699,20740,4101,11382,25943,40504,33225,47786,55067,12428,5149,26990,34271,48816,41537,56096,6176,10448,9264,23824,25008,38384,35296,39568,49856,54128,52944,0,0,0,0
.short 18658,19699,20740,11381,4102,25943,33224,47785,40506,55067,5148,26989,12430,34271,41536,56097,48816,6176,9264,23824,10448,25008,35296,39568,38384,49856,52944,54128,0,0,0,0
.short 25939,26980,28021,4102,11383,33224,18665,40506,47787,5148,55069,12430,19711,41536,34257,48818,56096,9264,6176,10448,20736,35296,24848,38384,39568,52944,49856,54128,0,0,0,0
.short 25939,26980,28021,4102,11383,18664,40505,33226,47787,55068,12429,5150,19711,34256,48817,41538,56096,6176,10448,9264,20736,24848,38384,35296,39568,49856,54128,52944,0,0,0,0
.short 25939,26980,28021,11382,4103,18664,33225,47786,40507,55068,5149,19710,12431,34256,41537,56098,48816,6176,9264,20736,10448,24848,35296,39568,38384,49856,52944,54128,0,0,0,0
.short 25939,26980,28021,4102,18663,11384,33225,40506,55067,47788,5149,12430,34271,19696,41537,48818,6176,56096,9264,10448,24848,20736,35296,38384,49856,39568,52944,54128,0,0,0,0
.short 33220,34261,35302,4103,11384,18665,40506,25947,47788,55069,12430,5151,19696,26977,48818,41539,56096,6176,10448,9264,20736,23824,38384,25008,39568,49856,54128,52944,0,0,0,0
.short 33220,34261,35302,11383,4104,18665,25946,47787,40508,55069,5150,19711,12416,26977,41538,56099,48816,6176,9264,20736,10448,23824,25008,39568,38384,49856,52944,54128,0,0,0,0
.short 33220,34261,35302,4103,18664,11385,25946,40507,55068,47789,5150,12431,26976,19697,41538,48819,6176,56096,9264,10448,23824,20736,25008,38384,49856,39568,52944,54128,0,0,0,0
.short 33220,34261,35302,4103,11384,25945,18666,40507,47788,5149,55070,12431,19696,41537,26978,48819,56096,9264,6176,10448,20736,25008,23824,38384,39568,52944,49856,54128,0,0,0,0
.short 40501,41542,42583,11384,4105,18666,25947,47788,33229,55070,5151,19696,12417,26978,34259,56100,48816,6176,9264,20736,10448,23824,25008,39408,35296,49856,52944,54128,0,0,0,0
.short 40501,41542,42583,4104,18665,11386,25947,33228,55069,47790,5151,12416,26977,19698,34259,48820,6176,56096,9264,10448,23824,20736,25008,35296,49856,39408,52944,54128,0,0,0,0
.short 40501,41542,42583,4104,11385,25946,18667,33228,47789,5150,55071,12416,19697,34258,26979,48820,56096,9264,6176,10448,20736,25008,23824,35296,39408,52944,49856,54128,0,0,0,0
.short 40501,41542,42583,4104,11385,18666,33227,25948,47789,55070,12431,5136,19697,26978,48819,34260,56096,6176,10448,9264,20736,23824,35296,25008,39408,49856,54128,52944,0,0,0,0
.short 47782,48823,49864,4105,18666,11387,25948,33229,55070,40511,5136,12417,26978,19699,34260,41541,6176,56096,9264,10448,23824,20736,25008,35296,39568,38384,52944,54128,0,0,0,0
.short 47782,48823,49864,4105,11386,25947,18668,33229,40510,5151,55056,12417,19698,34259,26980,41541,56096,9264,6176,10448,20736,25008,23824,35296,38384,52944,39568,54128,0,0,0,0
.short 47782,48823,49864,4105,11386,18667,33228,25949,40510,55071,12416,5137,19698,26979,41540,34261,56096,6176,10448,9264,20736,23824,35296,25008,38384,39568,54128,52944,0,0,0,0
.short 47782,48823,49864,11385,4106,18667,25948,40509,33230,55071,5136,19697,12418,26979,34260,56101,41536,6176,9264,20736,10448,23824,25008,38384,35296,39568,52944,54128,0,0,0,0
.short 55063,56104,57145,4106,11387,25948,18669,33230,40511,5136,47777,12418,19699,34260,26981,41542,48816,9264,6176,10448,20736,25008,23824,35296,38384,49856,39568,53968,0,0,0,0
.short 55063,56104,57145,4106,11387,18668,33229,25950,40511,47776,12417,5138,19699,26980,41541,34262,48816,6176,10448,9264,20736,23824,35296,25008,38384,39568,53968,49856,0,0,0,0
.short 55063,56104,57145,11386,4107,18668,25949,40510,33231,47776,5137,19698,12419,26980,34261,48822,41536,6176,9264,20736,10448,23824,25008,38384,35296,39568,49856,53968,0,0,0,0
.short 55063,56104,57145,4106,18667,11388,25949,33230,47791,40496,5137,12418,26979,19700,34261,41542,6176,48816,9264,10448,23824,20736,25008,35296,39568,38384,49856,53968,0,0,0,0
.short 4104,5145,6186,11387,18668,25949,40510,33231,47776,55057,19698,12419,26980,34261,48822,41543,56096,9264,20736,10448,23824,25008,38384,35296,39568,49856,54128,52944,0,0,0,0
.short 4104,5145,6186,18667,11388,25949,33230,47791,40496,55057,12418,26979,19700,34261,41542,56103,48816,9264,10448,23824,20736,25008,35296,39568,38384,49856,52944,54128,0,0,0,0
.short 4104,5145,6186,11387,25948,18669,33230,40511,55056,47777,12418,19699,34260,26981,41542,48823,9264,56096,10448,20736,25008,23824,35296,38384,49856,39568,52944,54128,0,0,0,0
.short 4104,5145,6186,11387,18668,33229,25950,40511,47776,12417,55058,19699,26980,41541,34262,48823,56096,10448,9264,20736,23824,35296,25008,38384,39568,52944,49856,54128,0,0,0,0
.short 11385,12426,13467,18668,4109,25950,33231,47776,40497,55058,5139,26980,19701,34262,41543,56104,48816,6176,10288,23824,20736,25008,35296,39568,38384,49856,52944,54128,0,0,0,0
.short 11385,12426,13467,4108,25949,18670,33231,40496,55057,47778,5139,19700,34261,26982,41543,48824,6176,56096,10288,20736,25008,23824,35296,38384,49856,39568,52944,54128,0,0,0,0
.short 11385,12426,13467,4108,18669,33230,25951,40496,47777,5138,55059,19700,26981,41542,34263,48824,56096,10288,6176,20736,23824,35296,25008,38384,39568,52944,49856,54128,0,0,0,0
.short 11385,12426,13467,4108,18669,25950,40511,33216,47777,55058,19699,5140,26981,34262,48823,41544,56096,6176,20736,10288,23824,25008,38384,35296,39568,49856,54128,52944,0,0,0,0
.short 18666,19707,20748,4109,25950,11391,33216,40497,55058,47779,5140,12421,34262,26983,41544,48825,6176,56096,9264,10448,25008,23824,35296,38384,49856,39568,52944,54128,0,0,0,0
.short 18666,19707,20748,4109,11390,33231,25936,40497,47778,5139,55060,12421,26982,41543,34264,48825,56096,9264,6176,10448,23824,35296,25008,38384,39568,52944,49856,54128,0,0,0,0
.short 18666,19707,20748,4109,11390,25951,40496,33217,47778,55059,12420,5141,26982,34263,48824,41545,56096,6176,10448,9264,23824,25008,38384,35296,39568,49856,54128,52944,0,0,0,0
.short 18666,19707,20748,11389,4110,25951,33216,47777,40498,55059,5140,26981,12422,34263,41544,56105,48816,6176,9264,23824,10448,25008,35296,39568,38384,49856,52944,54128,0,0,0,0
.short 25947,26988,28029,4110,11391,33216,18657,40498,47779,5140,55061,12422,19703,41544,34265,48826,56096,9264,6176,10448,20736,35296,24848,38384,39568,52944,49856,54128,0,0,0,0
.short 25947,26988,28029,4110,11391,18656,40497,33218,47779,55060,12421,5142,19703,34264,48825,41546,56096,6176,10448,9264,20736,24848,38384,35296,39568,49856,54128,52944,0,0,0,0
.short 25947,26988,28029,11390,4111,18656,33217,47778,40499,55060,5141,19702,12423,34264,41545,56106,48816,6176,9264,20736,10448,24848,35296,39568,38384,49856,52944,54128,0,0,0,0
.short 25947,26988,28029,4110,18671,11376,33217,40498,55059,47780,5141,12422,34263,19704,41545,48826,6176,56096,9264,10448,24848,20736,35296,38384,49856,39568,52944,54128,0,0,0,0
.short 33228,34269,35310,4111,11376,18657,40498,25939,47780,55061,12422,5143,19704,26985,48826,41547,56096,6176,10448,9264,20736,23824,38384,25008,39568,49856,54128,52944,0,0,0,0
.short 33228,34269,35310,11391,4096,18657,25938,47779,40500,55061,5142,19703,12424,26985,41546,56107,48816,6176,9264,20736,10448,23824,25008,39568,38384,49856,52944,54128,0,0,0,0
.short 33228,34269,35310,4111,18656,11377,25938,40499,55060,47781,5142,12423,26984,19705,41546,48827,6176,56096,9264,10448,23824,20736,25008,38384,49856,39568,52944,54128,0,0,0,0
.short 33228,34269,35310,4111,11376,25937,18658,40499,47780,5141,55062,12423,19704,41545,26986,48827,56096,9264,6176,10448,20736,25008,23824,38384,39568,52944,49856,54128,0,0,0,0
.short 40509,41550,42591,11376,4097,18658,25939,47780,33221,55062,5143,19704,12425,26986,34267,56108,48816,6176,9264,20736,10448,23824,25008,39408,35296,49856,52944,54128,0,0,0,0
.short 40509,41550,42591,4096,18657,11378,25939,33220,55061,47782,5143,12424,26985,19706,34267,48828,6176,56096,9264,10448,23824,20736,25008,35296,49856,39408,52944,54128,0,0,0,0
.short 40509,41550,42591,4096,11377,25938,18659,33220,47781,5142,55063,12424,19705,34266,26987,48828,56096,9264,6176,10448,20736,25008,23824,35296,39408,52944,49856,54128,0,0,0,0
.short 40509,41550,42591,4096,11377,18658,33219,25940,47781,55062,12423,5144,19705,26986,48827,34268,56096,6176,10448,9264,20736,23824,35296,25008,39408,49856,54128,52944,0,0,0,0
.short 47790,48831,49856,4097,18658,11379,25940,33221,55062,40503,5144,12425,26986,19707,34268,41549,6176,56096,9264,10448,23824,20736,25008,35296,39568,38384,52944,54128,0,0,0,0
.short 47790,48831,49856,4097,11378,25939,18660,33221,40502,5143,55064,12425,19706,34267,26988,41549,56096,9264,6176,10448,20736,25008,23824,35296,38384,52944,39568,54128,0,0,0,0
.short 47790,48831,49856,4097,11378,18659,33220,25941,40502,55063,12424,5145,19706,26987,41548,34269,56096,6176,10448,9264,20736,23824,35296,25008,38384,39568,54128,52944,0,0,0,0
.short 47790,48831,49856,11377,4098,18659,25940,40501,33222,55063,5144,19705,12426,26987,34268,56109,41536,6176,9264,20736,10448,23824,25008,38384,35296,39568,52944,54128,0,0,0,0
.short 55071,56096,57137,4098,11379,25940,18661,33222,40503,5144,47785,12426,19707,34268,26989,41550,48816,9264,6176,10448,20736,25008,23824,35296,38384,49856,39568,53968,0,0,0,0
.short 55071,56096,57137,4098,11379,18660,33221,25942,40503,47784,12425,5146,19707,26988,41549,34270,48816,6176,10448,9264,20736,23824,35296,25008,38384,39568,53968,49856,0,0,0,0
.short 55071,56096,57137,11378,4099,18660,25941,40502,33223,47784,5145,19706,12427,26988,34269,48830,41536,6176,9264,20736,10448,23824,25008,38384,35296,39568,49856,53968,0,0,0,0
.short 55071,56096,57137,4098,18659,11380,25941,33222,47783,40504,5145,12426,26987,19708,34269,41550,6176,48816,9264,10448,23824,20736,25008,35296,39568,38384,49856,53968,0,0,0,0
.section .rodata,"a"
.p2align 6
.amdhsa_kernel interleave_layers__ssm_conv_h3__mixer_s_mlp__prompt_kernel
  .amdhsa_next_free_vgpr 256
  .amdhsa_next_free_sgpr 102
  .amdhsa_accum_offset 256
  .amdhsa_group_segment_fixed_size 0
  .amdhsa_kernarg_size 112
  .amdhsa_user_sgpr_count 2
  .amdhsa_user_sgpr_kernarg_segment_ptr 1
  .amdhsa_system_sgpr_workgroup_id_x 1
  .amdhsa_float_denorm_mode_32 3
.end_amdhsa_kernel
```

```asm
; @launch grid=(256,1,1) block=(512,1,1) lds=163840
.amdgcn_target "amdgcn-amd-amdhsa--gfx950"
.text
.globl interleave_layers__ssm_conv_h3__mixer_s_mlp__prompt_kernel
.p2align 8
.type interleave_layers__ssm_conv_h3__mixer_s_mlp__prompt_kernel,@function
interleave_layers__ssm_conv_h3__mixer_s_mlp__prompt_kernel:
    s_cmp_ge_u32 s2, 256
    s_cbranch_scc1 K_end
    s_load_dwordx8 s[8:15], s[0:1], 8
    s_load_dwordx2 s[6:7], s[0:1], 0
    s_load_dwordx8 s[68:75], s[0:1], 56
    s_load_dwordx2 s[4:5], s[0:1], 104
    s_load_dwordx2 s[84:85], s[0:1], 96
    s_memrealtime s[46:47]
    s_load_dwordx2 s[96:97], s[0:1], 40
    v_lshrrev_b32 v1, 6, v0
    s_nop 0
    v_readfirstlane_b32 s30, v1
    s_getpc_b64 s[48:49]
K_pc:
    s_lshr_b32 s36, s2, 3
    s_lshl_b32 s36, s36, 11
    v_lshlrev_b32 v4, 2, v0
    v_add_u32 v4, s36, v4
    v_cmp_gt_u32 vcc, K_end-K_pc-8, v4
    s_nop 0
    s_and_saveexec_b64 s[36:37], vcc
    s_cbranch_execz K_3
    v_mov_b32 v5, s49
    v_add_co_u32 v4, vcc, s48, v4
    s_nop 1
    v_addc_co_u32 v5, vcc, 0, v5, vcc
    global_load_dword v250, v[4:5], off
K_3:
    s_mov_b64 exec, -1
    v_and_b32 v6, 31, v0
    v_lshrrev_b32 v7, 5, v0
    s_and_b32 s34, s2, 7
    s_lshr_b32 s35, s2, 3
    s_lshl_b32 s36, s35, 17
    s_lshl_b32 s37, s34, 8
    s_add_u32 s36, s36, s37
    v_lshlrev_b32 v8, 13, v7
    v_lshl_add_u32 v8, v6, 3, v8
    v_add_u32 v12, s36, v8
    v_add_u32 v14, 4096, v12
    s_mov_b32 s18, 4194304
    s_mov_b32 s19, 0x20000
    s_mov_b32 s22, s18
    s_mov_b32 s23, s19
    s_waitcnt lgkmcnt(0)
    s_mov_b32 s86, 256
    s_mov_b32 s87, 0x20000
    v_mov_b32 v78, 0
    s_lshl_b32 s45, s2, 3
    s_add_u32 s45, s45, s30
    s_cmp_lg_u32 s45, 4
    s_cbranch_scc1 KV_t0
    s_getreg_b32 s45, hwreg(HW_REG_XCC_ID, 0, 3)
    s_lshl_b32 s45, s45, 1
    s_lshl_b32 s44, s46, 6
    s_or_b32 s44, s44, s45
    s_or_b32 s44, s44, 1
    v_mov_b32 v76, s44
    v_mov_b32 v77, 0
    s_mov_b64 exec, 1
    buffer_store_dwordx2 v[76:77], v78, s[84:87], 0 offen sc1
    s_mov_b64 exec, -1
KV_t0:
    s_mov_b64 s[16:17], s[8:9]
    s_mov_b64 s[20:21], s[10:11]
    buffer_load_dwordx2 v[28:29], v12, s[16:19], 0 offen offset:0 nt
    buffer_load_dwordx2 v[30:31], v12, s[16:19], 0 offen offset:2048 nt
    buffer_load_dwordx2 v[32:33], v14, s[16:19], 0 offen offset:0 nt
    buffer_load_dwordx2 v[34:35], v14, s[16:19], 0 offen offset:2048 nt
    buffer_load_dwordx2 v[36:37], v12, s[20:23], 0 offen offset:0 nt
    buffer_load_dwordx2 v[38:39], v12, s[20:23], 0 offen offset:2048 nt
    buffer_load_dwordx2 v[40:41], v14, s[20:23], 0 offen offset:0 nt
    buffer_load_dwordx2 v[42:43], v14, s[20:23], 0 offen offset:2048 nt
    v_subrev_u32 v9, 6144, v12
    v_subrev_u32 v10, 4096, v12
    v_subrev_u32 v11, 2048, v12
    s_lshl_b32 s37, s34, 10
    v_lshlrev_b32 v16, 5, v6
    v_add_u32 v16, s37, v16
    s_mov_b32 s24, s12
    s_mov_b32 s25, s13
    s_mov_b32 s26, 0x2000
    s_mov_b32 s27, 0x20000
    v_and_b32 v8, 1, v7
    v_lshl_add_u32 v16, v8, 4, v16
    buffer_load_dwordx4 v[44:47], v16, s[24:27], 0 offen
    s_cmp_lg_u32 s30, 4
    s_cbranch_scc1 KV_t2
    buffer_load_dword v76, v78, s[84:87], 0 offen sc1
KV_t2:
    s_bfm_b64 exec, 32, 0
    buffer_load_dwordx2 v[22:23], v9, s[16:19], 0 offen nt
    buffer_load_dwordx2 v[24:25], v10, s[16:19], 0 offen nt
    buffer_load_dwordx2 v[26:27], v11, s[16:19], 0 offen nt
    s_mov_b64 exec, -1
    v_and_b32 v1, 63, v0
    v_lshlrev_b32 v2, 4, v1
    v_lshlrev_b32 v3, 2, v1
    s_mov_b32 s67, 0
    s_mov_b32 s60, 0
    s_mov_b32 s61, 40000
    s_mov_b32 s52, 0
    s_mov_b32 s55, 0
    s_mov_b32 s92, 0
    s_mov_b32 s93, 0
    s_mov_b32 s94, 0
    s_mov_b32 s56, s4
    s_mov_b32 s57, s5
    s_mov_b32 s58, 0xa000000
    s_mov_b32 s59, 0x20000
    s_add_u32 s62, s4, 33554432
    s_addc_u32 s63, s5, 0
    s_and_b32 s41, s30, 3
    s_and_b32 s38, s2, 7
    s_lshl_b32 s38, s38, 5
    s_lshr_b32 s39, s2, 3
    s_add_u32 s38, s38, s39
    s_lshl_b32 s39, s38, 2
    s_add_u32 s39, s39, s41
    s_mul_i32 s40, s41, 24576
    s_lshr_b32 s36, s39, 1
    s_lshl_b32 s36, s36, 2
    s_load_dword s98, s[96:97], s36
    s_lshl_b32 s36, s39, 12
    s_add_u32 s12, s14, s36
    s_addc_u32 s13, s15, 0
    s_mov_b32 s14, 4096
    s_mov_b32 s15, 0x20000
    s_lshr_b32 s45, s30, 2
    s_lshl_b32 s45, s45, 11
    s_add_u32 s36, s45, 0xffffffc0
    v_add_u32 v70, s36, v2
    v_add_u32 v71, 16, v70
    s_add_u32 s36, s45, 0x3c0
    v_add_u32 v72, s36, v2
    v_add_u32 v73, 16, v72
    s_mov_b32 s36, 4032
    v_add_u32 v74, s36, v2
    v_add_u32 v75, 16, v74
    s_and_b32 s34, s2, 7
    s_lshr_b32 s35, s2, 3
    v_mov_b32 v80, 0
    v_mov_b32 v81, 0
    v_mov_b32 v82, 0
    v_mov_b32 v83, 0
    v_add_u32 v86, s40, v2
    ds_write_b128 v86, v[80:83] offset:22784
    s_bfm_b64 exec, 26, 0
    ds_write_b128 v86, v[80:83] offset:23808
    s_mov_b64 exec, -1
    v_lshlrev_b32 v8, 2, v7
    v_sub_u32 v8, 60, v8
    v_lshrrev_b32 v85, 3, v8
    v_bfe_u32 v84, v6, 1, 3
    v_xor_b32 v85, v85, v84
    v_lshlrev_b32 v85, 4, v85
    v_and_b32 v8, 7, v8
    v_lshl_add_u32 v85, v8, 1, v85
    v_lshl_add_u32 v84, v6, 9, v85
    v_add_u32 v84, 98304, v84
    s_waitcnt vmcnt(0)
    s_cmp_lg_u32 s30, 4
    s_cbranch_scc1 KV_t1
KV_t1:
    buffer_load_dwordx4 v[52:55], v70, s[12:15], 0 offen nt
    buffer_load_dwordx2 v[56:57], v71, s[12:15], 0 offen nt
    buffer_load_dwordx4 v[58:61], v72, s[12:15], 0 offen nt
    buffer_load_dwordx2 v[62:63], v73, s[12:15], 0 offen nt
    buffer_load_dwordx4 v[64:67], v74, s[12:15], 0 offen nt
    buffer_load_dwordx2 v[68:69], v75, s[12:15], 0 offen nt
    v_mov_b32 v48, v44
    v_mov_b32 v49, v45
    v_mov_b32 v50, v46
    v_mov_b32 v51, v47
    v_mov_b32 v126, v30
    v_mov_b32 v127, v31
    v_mov_b32 v128, v32
    v_mov_b32 v129, v33
    v_mov_b32 v130, v34
    v_mov_b32 v131, v35
    v_permlane32_swap_b32 v44, v48
    v_permlane32_swap_b32 v45, v49
    v_permlane32_swap_b32 v46, v50
    v_permlane32_swap_b32 v47, v51
    v_permlane32_swap_b32 v22, v126
    v_permlane32_swap_b32 v23, v127
    v_permlane32_swap_b32 v24, v128
    v_permlane32_swap_b32 v25, v129
    v_permlane32_swap_b32 v26, v130
    v_permlane32_swap_b32 v27, v131
    v_lshlrev_b32 v88, 16, v44
    v_and_b32 v90, 0xffff0000, v44
    v_lshlrev_b32 v92, 16, v45
    v_and_b32 v94, 0xffff0000, v45
    v_lshlrev_b32 v89, 16, v46
    v_and_b32 v91, 0xffff0000, v46
    v_lshlrev_b32 v93, 16, v47
    v_and_b32 v95, 0xffff0000, v47
    v_lshlrev_b32 v96, 16, v22
    v_and_b32 v97, 0xffff0000, v22
    v_lshlrev_b32 v98, 16, v24
    v_and_b32 v99, 0xffff0000, v24
    v_lshlrev_b32 v100, 16, v26
    v_and_b32 v101, 0xffff0000, v26
    v_lshlrev_b32 v102, 16, v28
    v_and_b32 v103, 0xffff0000, v28
    v_lshlrev_b32 v104, 16, v30
    v_and_b32 v105, 0xffff0000, v30
    v_lshlrev_b32 v106, 16, v32
    v_and_b32 v107, 0xffff0000, v32
    v_lshlrev_b32 v108, 16, v34
    v_and_b32 v109, 0xffff0000, v34
    v_lshlrev_b32 v110, 16, v36
    v_and_b32 v111, 0xffff0000, v36
    v_lshlrev_b32 v112, 16, v38
    v_and_b32 v113, 0xffff0000, v38
    v_lshlrev_b32 v114, 16, v40
    v_and_b32 v115, 0xffff0000, v40
    v_lshlrev_b32 v116, 16, v42
    v_and_b32 v117, 0xffff0000, v42
    v_pk_mul_f32 v[118:119], v[96:97], v[94:95]
    v_pk_mul_f32 v[120:121], v[98:99], v[94:95]
    v_pk_mul_f32 v[122:123], v[100:101], v[94:95]
    v_pk_mul_f32 v[124:125], v[102:103], v[94:95]
    v_pk_fma_f32 v[118:119], v[98:99], v[92:93], v[118:119]
    v_pk_fma_f32 v[120:121], v[100:101], v[92:93], v[120:121]
    v_pk_fma_f32 v[122:123], v[102:103], v[92:93], v[122:123]
    v_pk_fma_f32 v[124:125], v[104:105], v[92:93], v[124:125]
    v_pk_fma_f32 v[118:119], v[100:101], v[90:91], v[118:119]
    v_pk_fma_f32 v[120:121], v[102:103], v[90:91], v[120:121]
    v_pk_fma_f32 v[122:123], v[104:105], v[90:91], v[122:123]
    v_pk_fma_f32 v[124:125], v[106:107], v[90:91], v[124:125]
    v_pk_fma_f32 v[118:119], v[102:103], v[88:89], v[118:119]
    v_pk_fma_f32 v[120:121], v[104:105], v[88:89], v[120:121]
    v_pk_fma_f32 v[122:123], v[106:107], v[88:89], v[122:123]
    v_pk_fma_f32 v[124:125], v[108:109], v[88:89], v[124:125]
    v_pk_mul_f32 v[118:119], v[118:119], v[110:111]
    v_pk_mul_f32 v[120:121], v[120:121], v[112:113]
    v_pk_mul_f32 v[122:123], v[122:123], v[114:115]
    v_pk_mul_f32 v[124:125], v[124:125], v[116:117]
    v_cvt_pk_bf16_f32 v136, v124, v122
    v_cvt_pk_bf16_f32 v137, v120, v118
    ds_write_b64 v84, v[136:137] offset:0
    v_cvt_pk_bf16_f32 v138, v125, v123
    v_cvt_pk_bf16_f32 v139, v121, v119
    ds_write_b64 v84, v[138:139] offset:128
    v_lshlrev_b32 v88, 16, v48
    v_and_b32 v90, 0xffff0000, v48
    v_lshlrev_b32 v92, 16, v49
    v_and_b32 v94, 0xffff0000, v49
    v_lshlrev_b32 v89, 16, v50
    v_and_b32 v91, 0xffff0000, v50
    v_lshlrev_b32 v93, 16, v51
    v_and_b32 v95, 0xffff0000, v51
    v_lshlrev_b32 v96, 16, v23
    v_and_b32 v97, 0xffff0000, v23
    v_lshlrev_b32 v98, 16, v25
    v_and_b32 v99, 0xffff0000, v25
    v_lshlrev_b32 v100, 16, v27
    v_and_b32 v101, 0xffff0000, v27
    v_lshlrev_b32 v102, 16, v29
    v_and_b32 v103, 0xffff0000, v29
    v_lshlrev_b32 v104, 16, v31
    v_and_b32 v105, 0xffff0000, v31
    v_lshlrev_b32 v106, 16, v33
    v_and_b32 v107, 0xffff0000, v33
    v_lshlrev_b32 v108, 16, v35
    v_and_b32 v109, 0xffff0000, v35
    v_lshlrev_b32 v110, 16, v37
    v_and_b32 v111, 0xffff0000, v37
    v_lshlrev_b32 v112, 16, v39
    v_and_b32 v113, 0xffff0000, v39
    v_lshlrev_b32 v114, 16, v41
    v_and_b32 v115, 0xffff0000, v41
    v_lshlrev_b32 v116, 16, v43
    v_and_b32 v117, 0xffff0000, v43
    v_pk_mul_f32 v[118:119], v[96:97], v[94:95]
    v_pk_mul_f32 v[120:121], v[98:99], v[94:95]
    v_pk_mul_f32 v[122:123], v[100:101], v[94:95]
    v_pk_mul_f32 v[124:125], v[102:103], v[94:95]
    v_pk_fma_f32 v[118:119], v[98:99], v[92:93], v[118:119]
    v_pk_fma_f32 v[120:121], v[100:101], v[92:93], v[120:121]
    v_pk_fma_f32 v[122:123], v[102:103], v[92:93], v[122:123]
    v_pk_fma_f32 v[124:125], v[104:105], v[92:93], v[124:125]
    v_pk_fma_f32 v[118:119], v[100:101], v[90:91], v[118:119]
    v_pk_fma_f32 v[120:121], v[102:103], v[90:91], v[120:121]
    v_pk_fma_f32 v[122:123], v[104:105], v[90:91], v[122:123]
    v_pk_fma_f32 v[124:125], v[106:107], v[90:91], v[124:125]
    v_pk_fma_f32 v[118:119], v[102:103], v[88:89], v[118:119]
    v_pk_fma_f32 v[120:121], v[104:105], v[88:89], v[120:121]
    v_pk_fma_f32 v[122:123], v[106:107], v[88:89], v[122:123]
    v_pk_fma_f32 v[124:125], v[108:109], v[88:89], v[124:125]
    v_pk_mul_f32 v[118:119], v[118:119], v[110:111]
    v_pk_mul_f32 v[120:121], v[120:121], v[112:113]
    v_pk_mul_f32 v[122:123], v[122:123], v[114:115]
    v_pk_mul_f32 v[124:125], v[124:125], v[116:117]
    v_cvt_pk_bf16_f32 v140, v124, v122
    v_cvt_pk_bf16_f32 v141, v120, v118
    ds_write_b64 v84, v[140:141] offset:256
    v_cvt_pk_bf16_f32 v142, v125, v123
    v_cvt_pk_bf16_f32 v143, v121, v119
    ds_write_b64 v84, v[142:143] offset:384
    s_cmp_lg_u32 s30, 4
    s_cbranch_scc1 HB_2
    v_add_u32 v18, 162816, v3
    ds_write_b32 v18, v78
    s_mov_b32 s53, 0
    s_waitcnt vmcnt(6)
HB_p:
    v_readfirstlane_b32 s52, v76
    s_nop 0
    s_cmp_eq_u32 s52, 0
    s_cbranch_scc1 HB_r
    s_cmp_ge_u32 s53, 400
    s_cbranch_scc1 HB_q
    s_add_u32 s54, s46, 8192
    s_lshl_b32 s54, s54, 6
    s_sub_u32 s54, s54, s52
    s_cmp_lt_u32 s54, 786432
    s_cbranch_scc1 HB_q
HB_r:
    buffer_load_dword v76, v78, s[84:87], 0 offen sc1
    s_waitcnt vmcnt(0)
    s_add_u32 s53, s53, 1
    s_cmp_lt_u32 s53, s61
    s_cbranch_scc1 HB_p
    s_mov_b32 s52, 1
    s_mov_b32 s61, 0
HB_q:
    v_mov_b32 v18, 162828
    v_mov_b32 v19, s52
    s_waitcnt lgkmcnt(0)
    ds_write_b32 v18, v19
HB_2:
    s_add_u32 s16, s4, 0x2000000
    s_addc_u32 s17, s5, 0
    s_mov_b32 s18, 0x8000000
    s_mov_b32 s19, 0x20000
    v_lshrrev_b32 v8, 3, v0
    v_and_b32 v85, 7, v0
    v_lshlrev_b32 v149, 12, v8
    v_lshl_add_u32 v149, v85, 4, v149
    s_lshl_b32 s36, s34, 24
    s_sub_u32 s37, 31, s35
    s_lshl_b32 s37, s37, 7
    s_add_u32 s36, s36, s37
    s_add_u32 s37, s36, 262144
    v_lshrrev_b32 v148, 3, v8
    v_xor_b32 v148, v148, v85
    v_lshlrev_b32 v148, 4, v148
    v_lshl_add_u32 v148, v8, 7, v148
    v_add_u32 v148, 98304, v148
    v_mov_b32 v18, 162828
    s_waitcnt lgkmcnt(0)
    s_barrier
    ds_read_b128 v[152:155], v148 offset:0
    ds_read_b128 v[156:159], v148 offset:8192
    ds_read_b32 v19, v18
    s_waitcnt lgkmcnt(2)
    v_or_b32 v152, 1, v152
    buffer_store_dwordx4 v[152:155], v149, s[16:19], s36 offen sc1
    s_waitcnt lgkmcnt(1)
    v_or_b32 v156, 1, v156
    buffer_store_dwordx4 v[156:159], v149, s[16:19], s37 offen sc1
    s_waitcnt lgkmcnt(0)
    v_readfirstlane_b32 s52, v19
    s_cmp_lg_u32 s30, 0
    s_cbranch_scc1 KV_ni
    s_cmp_ge_u32 s35, 16
    s_cbranch_scc1 KV_ni
    v_mov_b32 v8, s52
    s_lshl_b32 s37, s34, 7
    s_lshl_b32 s53, s35, 10
    s_add_u32 s37, s37, s53
    s_add_u32 s37, s37, 23101440
    s_mov_b64 exec, 1
    buffer_store_dword v8, v78, s[56:59], s37 offen sc1
    s_mov_b64 exec, -1
KV_ni:
    s_cmp_ge_u32 s2, 32
    s_cbranch_scc1 KV_n3
    s_cmp_lg_u32 s30, 5
    s_cbranch_scc1 KV_n3
    s_and_b32 s42, s2, 7
    s_lshl_b32 s42, s42, 10
    s_lshr_b32 s43, s2, 3
    s_lshl_b32 s43, s43, 14
    s_add_u32 s42, s42, s43
    s_add_u32 s42, s42, 39714816
    v_lshrrev_b32 v8, 5, v1
    v_mul_u32_u24 v8, 7680, v8
    v_add_u32 v8, v8, v2
    buffer_store_dwordx4 v[80:83], v8, s[56:59], s42 offen sc1
KV_n3:
    s_bfe_u32 s32, s52, 0x30001
    s_add_u32 s32, s32, s2
    s_and_b32 s32, s32, 7
    s_lshr_b32 s33, s2, 3
    s_and_b32 s28, s32, 2
    s_lshr_b32 s53, s32, 2
    s_or_b32 s28, s28, s53
    s_lshl_b32 s28, s28, 2
    s_and_b32 s53, s33, 3
    s_add_u32 s28, s28, s53
    s_and_b32 s31, s32, 1
    s_lshr_b32 s33, s33, 2
    s_lshl_b32 s29, s31, 3
    s_add_u32 s29, s29, s33
    s_xor_b32 s99, s29, 1
    v_and_b32 v199, 7, v0
    v_lshrrev_b32 v228, 6, v0
    v_lshlrev_b32 v228, 4, v228
    v_bfe_u32 v229, v0, 3, 3
    v_add_u32 v228, v228, v229
    s_lshr_b32 s78, s29, 1
    s_lshl_b32 s78, s78, 16
    s_and_b32 s79, s29, 1
    s_lshl_b32 s79, s79, 7
    s_add_u32 s78, s78, s79
    s_lshr_b32 s79, s30, 1
    s_lshl_b32 s79, s79, 13
    s_add_u32 s78, s78, s79
    v_lshlrev_b32 v196, 8, v228
    v_lshl_add_u32 v196, v199, 4, v196
    v_add_u32 v196, s78, v196
    s_lshl_b32 s78, s28, 7
    s_lshl_b32 s79, s29, 3
    s_add_u32 s78, s78, s79
    v_add_u32 v197, s78, v199
    v_lshlrev_b32 v198, 11, v197
    v_lshrrev_b32 v229, 2, v228
    v_lshlrev_b32 v229, 3, v229
    v_and_b32 v228, 3, v228
    v_add_u32 v228, v228, v229
    v_lshl_add_u32 v198, v228, 3, v198
    v_and_b32 v197, 15, v197
    v_lshlrev_b32 v197, 4, v197
    v_and_b32 v229, 15, v228
    v_lshl_add_u32 v197, v229, 9, v197
    v_lshrrev_b32 v229, 4, v228
    v_lshl_add_u32 v197, v229, 14, v197
    s_lshr_b32 s78, s28, 3
    s_lshl_b32 s78, s78, 2
    s_and_b32 s79, s28, 3
    s_add_u32 s78, s78, s79
    s_lshl_b32 s78, s78, 24
    s_and_b32 s79, s28, 4
    s_lshl_b32 s79, s79, 11
    s_add_u32 s78, s78, s79
    s_and_b32 s79, s29, 4
    s_lshl_b32 s79, s79, 6
    s_add_u32 s78, s78, s79
    s_and_b32 s79, s29, 2
    s_lshl_b32 s79, s79, 2
    s_add_u32 s78, s78, s79
    s_lshl_b32 s79, s31, 18
    s_add_u32 s78, s78, s79
    v_add_u32 v197, s78, v197
    s_lshl_b32 s36, s34, 5
    s_add_u32 s36, s36, s35
    s_lshl_b32 s36, s36, 7
    s_add_u32 s36, s36, 23068672
    v_mov_b32 v18, 1
    v_mov_b32 v19, 162820
    v_mov_b32 v21, 0
    s_mov_b64 exec, 1
    s_waitcnt vmcnt(0)
    ds_add_rtn_u32 v20, v19, v18
    v_mov_b32 v19, s52
    s_waitcnt lgkmcnt(0)
    v_readfirstlane_b32 s54, v20
    s_nop 0
    s_and_b32 s54, s54, 7
    s_cmp_lg_u32 s54, 7
    s_cbranch_scc1 pub_1
    buffer_store_dword v19, v21, s[56:59], s36 offen sc1
pub_1:
    s_mov_b64 exec, -1
    s_mov_b32 s8, s6
    s_mov_b32 s9, s7
    s_mov_b32 s10, 0x400000
    s_mov_b32 s11, 0x20000
    buffer_load_dwordx2 v[180:181], v198, s[8:11], 0 offen offset:0 nt
    buffer_load_dwordx2 v[182:183], v198, s[8:11], 0 offen offset:32 nt
    buffer_load_dwordx2 v[184:185], v198, s[8:11], 0 offen offset:128 nt
    buffer_load_dwordx2 v[186:187], v198, s[8:11], 0 offen offset:160 nt
    v_add_u32 v160, s45, v86
    v_alignbit_b32 v88, v53, v52, 16
    v_mov_b32 v92, v53
    v_alignbit_b32 v96, v54, v53, 16
    v_alignbit_b32 v89, v54, v53, 16
    v_mov_b32 v93, v54
    v_alignbit_b32 v97, v55, v54, 16
    v_alignbit_b32 v90, v55, v54, 16
    v_mov_b32 v94, v55
    v_alignbit_b32 v98, v56, v55, 16
    v_alignbit_b32 v91, v56, v55, 16
    v_mov_b32 v95, v56
    v_alignbit_b32 v99, v57, v56, 16
    ds_write_b128 v160, v[88:91] offset:0
    ds_write_b128 v160, v[92:95] offset:4160
    ds_write_b128 v160, v[96:99] offset:8320
    ds_write_b128 v160, v[54:57] offset:12480
    v_alignbit_b32 v100, v59, v58, 16
    v_mov_b32 v104, v59
    v_alignbit_b32 v108, v60, v59, 16
    v_alignbit_b32 v101, v60, v59, 16
    v_mov_b32 v105, v60
    v_alignbit_b32 v109, v61, v60, 16
    v_alignbit_b32 v102, v61, v60, 16
    v_mov_b32 v106, v61
    v_alignbit_b32 v110, v62, v61, 16
    v_alignbit_b32 v103, v62, v61, 16
    v_mov_b32 v107, v62
    v_alignbit_b32 v111, v63, v62, 16
    ds_write_b128 v160, v[100:103] offset:1024
    ds_write_b128 v160, v[104:107] offset:5184
    ds_write_b128 v160, v[108:111] offset:9344
    ds_write_b128 v160, v[60:63] offset:13504
    v_alignbit_b32 v112, v65, v64, 16
    v_mov_b32 v116, v65
    v_alignbit_b32 v120, v66, v65, 16
    v_alignbit_b32 v113, v66, v65, 16
    v_mov_b32 v117, v66
    v_alignbit_b32 v121, v67, v66, 16
    v_alignbit_b32 v114, v67, v66, 16
    v_mov_b32 v118, v67
    v_alignbit_b32 v122, v68, v67, 16
    v_alignbit_b32 v115, v68, v67, 16
    v_mov_b32 v119, v68
    v_alignbit_b32 v123, v69, v68, 16
    s_mov_b64 exec, 0xf
    ds_write_b128 v86, v[112:115] offset:4096
    ds_write_b128 v86, v[116:119] offset:8256
    ds_write_b128 v86, v[120:123] offset:12416
    ds_write_b128 v86, v[66:69] offset:16576
    s_mov_b64 exec, -1
    s_waitcnt lgkmcnt(0)
    s_barrier
    v_mov_b32 v238, 0
    v_mov_b32 v239, 0
    v_mov_b32 v240, 0
    v_mov_b32 v241, 0
    v_mov_b32 v242, 0
    v_mov_b32 v243, 0
    v_mov_b32 v244, 0
    v_mov_b32 v245, 0
    v_mov_b32 v246, 0
    v_mov_b32 v247, 0
    s_cmp_ge_u32 s30, 4
    s_cbranch_scc1 FR_b
    s_and_b32 s38, s2, 7
    s_lshl_b32 s38, s38, 5
    s_lshr_b32 s39, s2, 3
    s_add_u32 s38, s38, s39
    s_lshl_b32 s39, s38, 2
    s_add_u32 s39, s39, s30
    s_mul_i32 s40, s30, 24576
    s_and_b32 s36, s39, 127
    s_lshl_b32 s36, s36, 12
    s_lshr_b32 s37, s39, 7
    s_lshl_b32 s37, s37, 24
    s_add_u32 s36, s36, s37
    s_add_u32 s36, s36, 33554432
    s_add_u32 s16, s4, s36
    s_addc_u32 s17, s5, 0
    s_mov_b32 s18, 4096
    s_mov_b32 s19, 0x20000
    v_lshrrev_b32 v6, 2, v1
    v_mul_u32_u24 v12, 96, v6
    v_and_b32 v6, 3, v1
    v_lshl_add_u32 v12, v6, 4, v12
    v_add_u32 v12, s40, v12
    v_and_b32 v35, 15, v1
    v_lshrrev_b32 v36, 4, v1
    v_and_b32 v6, 3, v35
    v_mul_u32_u24 v32, 4160, v6
    v_lshl_add_u32 v32, v36, 4, v32
    v_lshrrev_b32 v6, 2, v35
    v_lshl_add_u32 v32, v6, 3, v32
    v_add_u32 v32, s40, v32
    v_sub_u32 v6, 15, v35
    v_mul_u32_u24 v34, 96, v6
    v_add_u32 v34, s40, v34
    v_lshl_add_u32 v33, v36, 4, v34
    ds_read_b64 v[72:73], v32 offset:0
    ds_read_b64 v[74:75], v32 offset:8
    ds_read_b64 v[76:77], v32 offset:32
    ds_read_b64 v[78:79], v32 offset:40
    ds_read_b64 v[80:81], v32 offset:1024
    ds_read_b64 v[82:83], v32 offset:1032
    ds_read_b64 v[84:85], v32 offset:1056
    ds_read_b64 v[86:87], v32 offset:1064
    ds_read_b64 v[88:89], v32 offset:2048
    ds_read_b64 v[90:91], v32 offset:2056
    ds_read_b64 v[92:93], v32 offset:2080
    ds_read_b64 v[94:95], v32 offset:2088
    ds_read_b64 v[96:97], v32 offset:3072
    ds_read_b64 v[98:99], v32 offset:3080
    ds_read_b64 v[100:101], v32 offset:3104
    ds_read_b64 v[102:103], v32 offset:3112
    s_bitcmp1_b32 s39, 0
    s_cselect_b32 s36, 0, 16
    s_lshl_b32 s41, s98, s36
    s_and_b32 s41, s41, 0xffff0000
    s_lshr_b32 s36, s41, 16
    v_lshl_add_u32 v6, v36, 3, v35
    v_sub_u32 v6, 31, v6
    v_mov_b32 v10, s36
    v_mov_b32 v11, s41
    v_and_b32 v8, 1, v6
    v_cmp_eq_u32 vcc, 1, v8
    s_nop 1
    v_cndmask_b32 v10, v10, v11, vcc
    v_ashrrev_i32 v6, 1, v6
    v_cmp_eq_u32 vcc, 0, v6
    s_nop 1
    v_cndmask_b32 v152, 0, v10, vcc
    v_cmp_eq_u32 vcc, 1, v6
    s_nop 1
    v_cndmask_b32 v153, 0, v10, vcc
    v_cmp_eq_u32 vcc, 2, v6
    s_nop 1
    v_cndmask_b32 v154, 0, v10, vcc
    v_cmp_eq_u32 vcc, 3, v6
    s_nop 1
    v_cndmask_b32 v155, 0, v10, vcc
    v_cmp_eq_u32 vcc, 8, v6
    s_nop 1
    v_cndmask_b32 v156, 0, v10, vcc
    v_cmp_eq_u32 vcc, 9, v6
    s_nop 1
    v_cndmask_b32 v157, 0, v10, vcc
    v_cmp_eq_u32 vcc, 10, v6
    s_nop 1
    v_cndmask_b32 v158, 0, v10, vcc
    v_cmp_eq_u32 vcc, 11, v6
    s_nop 1
    v_cndmask_b32 v159, 0, v10, vcc
    s_add_u32 s12, s4, 0x2100000
    s_addc_u32 s13, s5, 0
    s_mov_b32 s14, 0x7f00000
    s_mov_b32 s15, 0x20000
    v_bfe_u32 v6, v1, 2, 2
    v_mul_u32_u24 v168, 24640, v6
    v_mul_u32_u24 v6, 72, v36
    v_add_u32 v168, v168, v6
    v_and_b32 v6, 3, v1
    v_lshl_add_u32 v168, v6, 3, v168
    s_mul_i32 s36, s30, 1152
    v_add_u32 v168, s36, v168
    v_lshrrev_b32 v6, 5, v1
    v_mul_u32_u24 v169, 261632, v6
    v_add_u32 v169, v169, v2
    s_lshr_b32 s44, s38, 4
    s_lshl_b32 s44, s44, 14
    s_and_b32 s37, s38, 15
    s_lshl_b32 s37, s37, 9
    s_add_u32 s44, s44, s37
    s_and_b32 s37, s30, 1
    s_lshl_b32 s37, s37, 13
    s_add_u32 s44, s44, s37
    s_lshr_b32 s37, s30, 1
    s_lshl_b32 s37, s37, 26
    s_add_u32 s44, s44, s37
    s_and_b32 s47, s44, 0x2000
    s_xor_b32 s47, s47, 8192
    s_lshr_b32 s37, s30, 1
    s_lshl_b32 s37, s37, 12
    s_add_u32 s47, s47, s37
    s_and_b32 s37, s2, 7
    s_lshl_b32 s37, s37, 7
    s_add_u32 s47, s47, s37
    v_mov_b32 v34, 162824
    v_mov_b32 v7, 1
    s_mul_i32 s36, s30, 24640
    v_mul_u32_u24 v170, 72, v35
    v_lshl_add_u32 v170, v36, 3, v170
    v_add_u32 v170, s36, v170
    v_lshlrev_b32 v6, 10, v1
    v_mov_b32 v35, 0
    s_and_b32 s45, s2, 31
    s_lshl_b32 s45, s45, 7
    s_add_u32 s45, s45, 23117824
    s_cmp_lg_u32 s30, 0
    s_cbranch_scc1 CV_w
    s_and_b32 s36, s2, 7
    s_lshl_b32 s36, s36, 12
    s_add_u32 s36, s36, 23068672
    v_lshlrev_b32 v9, 7, v1
    v_add_u32 v9, s36, v9
    s_mov_b32 s53, 0
    s_add_u32 s54, s52, 0
    s_bfm_b64 exec, 32, 0
poll_2:
    buffer_load_dword v8, v9, s[56:59], 0 offen sc1
    s_waitcnt vmcnt(0)
    v_xor_b32 v8, s54, v8
    v_cmp_eq_u32 vcc, 0, v8
    s_nop 0
    s_cmp_eq_u64 vcc, exec
    s_cbranch_scc1 pok_3
    s_sleep 5
    s_add_u32 s53, s53, 1
    s_cmp_lt_u32 s53, s61
    s_cbranch_scc1 poll_2
    s_mov_b32 s61, 0
pok_3:
    s_mov_b64 exec, -1
    v_mov_b32 v8, 162832
    v_mov_b32 v9, 1
    s_waitcnt lgkmcnt(0)
    ds_write_b32 v8, v9
CV_w:
    v_mov_b32 v8, 162832
spin_4:
    ds_read_b32 v9, v8
    s_waitcnt lgkmcnt(0)
    v_readfirstlane_b32 s53, v9
    s_nop 0
    s_cmp_ge_u32 s53, 1
    s_cbranch_scc0 spin_4
    buffer_load_dwordx4 v[16:19], v2, s[16:19], 0 offen offset:0 sc1 nt
    buffer_load_dwordx4 v[20:23], v2, s[16:19], 0 offen offset:1024 sc1 nt
    buffer_load_dwordx4 v[24:27], v2, s[16:19], 0 offen offset:2048 sc1 nt
    buffer_load_dwordx4 v[28:31], v2, s[16:19], 0 offen offset:3072 sc1 nt
    s_waitcnt vmcnt(3)
    ds_write_b128 v12, v[16:19] offset:16640
    s_waitcnt vmcnt(2)
    ds_write_b128 v12, v[20:23] offset:18176
    s_waitcnt vmcnt(1)
    ds_write_b128 v12, v[24:27] offset:19712
    s_waitcnt vmcnt(0)
    ds_write_b128 v12, v[28:31] offset:21248
    v_mov_b32 v8, 162836
    v_mov_b32 v9, 1
    s_mov_b64 exec, 1
    ds_add_u32 v8, v9
    s_mov_b64 exec, -1
    s_waitcnt lgkmcnt(0)
    ds_read_b128 v[136:139], v33 offset:21248
    ds_read_b128 v[140:143], v33 offset:19712
    ds_read_b128 v[144:147], v33 offset:18176
    ds_read_b128 v[148:151], v33 offset:16640
    s_waitcnt lgkmcnt(3)
    v_mfma_f32_16x16x32_bf16 v[40:43], v[152:155], v[136:139], 0
    v_mfma_f32_16x16x32_bf16 v[44:47], v[156:159], v[136:139], 0
    s_waitcnt lgkmcnt(2)
    v_mfma_f32_16x16x32_bf16 v[48:51], v[152:155], v[140:143], 0
    v_mfma_f32_16x16x32_bf16 v[52:55], v[156:159], v[140:143], 0
    s_waitcnt lgkmcnt(1)
    v_mfma_f32_16x16x32_bf16 v[56:59], v[152:155], v[144:147], 0
    v_mfma_f32_16x16x32_bf16 v[60:63], v[156:159], v[144:147], 0
    s_waitcnt lgkmcnt(0)
    v_mfma_f32_16x16x32_bf16 v[64:67], v[152:155], v[148:151], 0
    v_mfma_f32_16x16x32_bf16 v[68:71], v[156:159], v[148:151], 0
    s_mov_b32 s43, 0
CV_r:
    s_waitcnt lgkmcnt(0)
    v_mfma_f32_16x16x32_bf16 v[40:43], v[72:75], v[136:139], v[40:43]
    v_mfma_f32_16x16x32_bf16 v[48:51], v[72:75], v[140:143], v[48:51]
    v_mfma_f32_16x16x32_bf16 v[56:59], v[72:75], v[144:147], v[56:59]
    v_mfma_f32_16x16x32_bf16 v[64:67], v[72:75], v[148:151], v[64:67]
    v_mfma_f32_16x16x32_bf16 v[44:47], v[76:79], v[136:139], v[44:47]
    v_mfma_f32_16x16x32_bf16 v[52:55], v[76:79], v[140:143], v[52:55]
    v_mfma_f32_16x16x32_bf16 v[60:63], v[76:79], v[144:147], v[60:63]
    v_mfma_f32_16x16x32_bf16 v[68:71], v[76:79], v[148:151], v[68:71]
    v_mfma_f32_16x16x32_bf16 v[48:51], v[80:83], v[136:139], v[48:51]
    v_mfma_f32_16x16x32_bf16 v[56:59], v[80:83], v[140:143], v[56:59]
    v_mfma_f32_16x16x32_bf16 v[64:67], v[80:83], v[144:147], v[64:67]
    v_mfma_f32_16x16x32_bf16 v[52:55], v[84:87], v[136:139], v[52:55]
    v_mfma_f32_16x16x32_bf16 v[60:63], v[84:87], v[140:143], v[60:63]
    v_mfma_f32_16x16x32_bf16 v[68:71], v[84:87], v[144:147], v[68:71]
    v_mfma_f32_16x16x32_bf16 v[56:59], v[88:91], v[136:139], v[56:59]
    v_mfma_f32_16x16x32_bf16 v[64:67], v[88:91], v[140:143], v[64:67]
    v_mfma_f32_16x16x32_bf16 v[60:63], v[92:95], v[136:139], v[60:63]
    v_mfma_f32_16x16x32_bf16 v[68:71], v[92:95], v[140:143], v[68:71]
    v_mfma_f32_16x16x32_bf16 v[64:67], v[96:99], v[136:139], v[64:67]
    v_mfma_f32_16x16x32_bf16 v[68:71], v[100:103], v[136:139], v[68:71]
    ds_read_b128 v[152:155], v33 offset:21344
    ds_read_b128 v[156:159], v33 offset:19808
    ds_read_b128 v[160:163], v33 offset:18272
    ds_read_b128 v[164:167], v33 offset:16736
    ds_read_b64 v[104:105], v32 offset:64
    ds_read_b64 v[106:107], v32 offset:72
    ds_read_b64 v[108:109], v32 offset:96
    ds_read_b64 v[110:111], v32 offset:104
    ds_read_b64 v[112:113], v32 offset:1088
    ds_read_b64 v[114:115], v32 offset:1096
    ds_read_b64 v[116:117], v32 offset:1120
    ds_read_b64 v[118:119], v32 offset:1128
    ds_read_b64 v[120:121], v32 offset:2112
    ds_read_b64 v[122:123], v32 offset:2120
    ds_read_b64 v[124:125], v32 offset:2144
    ds_read_b64 v[126:127], v32 offset:2152
    ds_read_b64 v[128:129], v32 offset:3136
    ds_read_b64 v[130:131], v32 offset:3144
    ds_read_b64 v[132:133], v32 offset:3168
    ds_read_b64 v[134:135], v32 offset:3176
    s_waitcnt lgkmcnt(0)
    v_mfma_f32_16x16x32_bf16 v[40:43], v[104:107], v[152:155], v[40:43]
    v_mfma_f32_16x16x32_bf16 v[48:51], v[104:107], v[156:159], v[48:51]
    v_mfma_f32_16x16x32_bf16 v[56:59], v[104:107], v[160:163], v[56:59]
    v_mfma_f32_16x16x32_bf16 v[64:67], v[104:107], v[164:167], v[64:67]
    v_mfma_f32_16x16x32_bf16 v[44:47], v[108:111], v[152:155], v[44:47]
    v_mfma_f32_16x16x32_bf16 v[52:55], v[108:111], v[156:159], v[52:55]
    v_mfma_f32_16x16x32_bf16 v[60:63], v[108:111], v[160:163], v[60:63]
    v_mfma_f32_16x16x32_bf16 v[68:71], v[108:111], v[164:167], v[68:71]
    v_mfma_f32_16x16x32_bf16 v[48:51], v[112:115], v[152:155], v[48:51]
    v_mfma_f32_16x16x32_bf16 v[56:59], v[112:115], v[156:159], v[56:59]
    v_mfma_f32_16x16x32_bf16 v[64:67], v[112:115], v[160:163], v[64:67]
    v_mfma_f32_16x16x32_bf16 v[52:55], v[116:119], v[152:155], v[52:55]
    v_mfma_f32_16x16x32_bf16 v[60:63], v[116:119], v[156:159], v[60:63]
    v_mfma_f32_16x16x32_bf16 v[68:71], v[116:119], v[160:163], v[68:71]
    v_mfma_f32_16x16x32_bf16 v[56:59], v[120:123], v[152:155], v[56:59]
    v_mfma_f32_16x16x32_bf16 v[64:67], v[120:123], v[156:159], v[64:67]
    v_mfma_f32_16x16x32_bf16 v[60:63], v[124:127], v[152:155], v[60:63]
    v_mfma_f32_16x16x32_bf16 v[68:71], v[124:127], v[156:159], v[68:71]
    v_mfma_f32_16x16x32_bf16 v[64:67], v[128:131], v[152:155], v[64:67]
    v_mfma_f32_16x16x32_bf16 v[68:71], v[132:135], v[152:155], v[68:71]
    ds_read_b128 v[136:139], v33 offset:21440
    ds_read_b128 v[140:143], v33 offset:19904
    ds_read_b128 v[144:147], v33 offset:18368
    ds_read_b128 v[148:151], v33 offset:16832
    ds_read_b64 v[72:73], v32 offset:128
    ds_read_b64 v[74:75], v32 offset:136
    ds_read_b64 v[76:77], v32 offset:160
    ds_read_b64 v[78:79], v32 offset:168
    ds_read_b64 v[80:81], v32 offset:1152
    ds_read_b64 v[82:83], v32 offset:1160
    ds_read_b64 v[84:85], v32 offset:1184
    ds_read_b64 v[86:87], v32 offset:1192
    ds_read_b64 v[88:89], v32 offset:2176
    ds_read_b64 v[90:91], v32 offset:2184
    ds_read_b64 v[92:93], v32 offset:2208
    ds_read_b64 v[94:95], v32 offset:2216
    ds_read_b64 v[96:97], v32 offset:3200
    ds_read_b64 v[98:99], v32 offset:3208
    ds_read_b64 v[100:101], v32 offset:3232
    ds_read_b64 v[102:103], v32 offset:3240
    v_add_u32 v32, 128, v32
    v_add_u32 v33, 192, v33
    s_add_u32 s43, s43, 1
    s_cmp_lt_u32 s43, 4
    s_cbranch_scc1 CV_r
CV_l:
    s_waitcnt lgkmcnt(10)
    v_mfma_f32_16x16x32_bf16 v[40:43], v[72:75], v[136:139], v[40:43]
    ds_read_b128 v[152:155], v33 offset:21344
    v_mfma_f32_16x16x32_bf16 v[48:51], v[72:75], v[140:143], v[48:51]
    ds_read_b128 v[156:159], v33 offset:19808
    s_cmp_eq_u32 s43, 5
    v_mfma_f32_16x16x32_bf16 v[56:59], v[72:75], v[144:147], v[56:59]
    ds_read_b128 v[160:163], v33 offset:18272
    s_cselect_b64 exec, 1, 0
    buffer_load_dword v12, v35, s[56:59], s45 offen sc1
    s_mov_b64 exec, -1
    v_mfma_f32_16x16x32_bf16 v[64:67], v[72:75], v[148:151], v[64:67]
    ds_read_b128 v[164:167], v33 offset:16736
    v_mfma_f32_16x16x32_bf16 v[44:47], v[76:79], v[136:139], v[44:47]
    ds_read_b64 v[104:105], v32 offset:64
    v_mfma_f32_16x16x32_bf16 v[52:55], v[76:79], v[140:143], v[52:55]
    ds_read_b64 v[106:107], v32 offset:72
    v_mfma_f32_16x16x32_bf16 v[60:63], v[76:79], v[144:147], v[60:63]
    ds_read_b64 v[108:109], v32 offset:96
    v_mfma_f32_16x16x32_bf16 v[68:71], v[76:79], v[148:151], v[68:71]
    ds_read_b64 v[110:111], v32 offset:104
    v_mfma_f32_16x16x32_bf16 v[48:51], v[80:83], v[136:139], v[48:51]
    ds_read_b64 v[112:113], v32 offset:1088
    v_mfma_f32_16x16x32_bf16 v[56:59], v[80:83], v[140:143], v[56:59]
    ds_read_b64 v[114:115], v32 offset:1096
    s_waitcnt lgkmcnt(10)
    v_mfma_f32_16x16x32_bf16 v[64:67], v[80:83], v[144:147], v[64:67]
    ds_read_b64 v[116:117], v32 offset:1120
    v_mfma_f32_16x16x32_bf16 v[52:55], v[84:87], v[136:139], v[52:55]
    ds_read_b64 v[118:119], v32 offset:1128
    v_mfma_f32_16x16x32_bf16 v[60:63], v[84:87], v[140:143], v[60:63]
    ds_read_b64 v[120:121], v32 offset:2112
    v_mfma_f32_16x16x32_bf16 v[68:71], v[84:87], v[144:147], v[68:71]
    ds_read_b64 v[122:123], v32 offset:2120
    v_mfma_f32_16x16x32_bf16 v[56:59], v[88:91], v[136:139], v[56:59]
    ds_read_b64 v[124:125], v32 offset:2144
    v_mfma_f32_16x16x32_bf16 v[64:67], v[88:91], v[140:143], v[64:67]
    ds_read_b64 v[126:127], v32 offset:2152
    v_mfma_f32_16x16x32_bf16 v[60:63], v[92:95], v[136:139], v[60:63]
    ds_read_b64 v[128:129], v32 offset:3136
    v_mfma_f32_16x16x32_bf16 v[68:71], v[92:95], v[140:143], v[68:71]
    ds_read_b64 v[130:131], v32 offset:3144
    v_mfma_f32_16x16x32_bf16 v[64:67], v[96:99], v[136:139], v[64:67]
    ds_read_b64 v[132:133], v32 offset:3168
    v_mfma_f32_16x16x32_bf16 v[68:71], v[100:103], v[136:139], v[68:71]
    ds_read_b64 v[134:135], v32 offset:3176
    s_waitcnt lgkmcnt(10)
    v_mfma_f32_16x16x32_bf16 v[40:43], v[104:107], v[152:155], v[40:43]
    ds_read_b128 v[136:139], v33 offset:21440
    v_mfma_f32_16x16x32_bf16 v[48:51], v[104:107], v[156:159], v[48:51]
    ds_read_b128 v[140:143], v33 offset:19904
    v_mfma_f32_16x16x32_bf16 v[56:59], v[104:107], v[160:163], v[56:59]
    ds_read_b128 v[144:147], v33 offset:18368
    v_mfma_f32_16x16x32_bf16 v[64:67], v[104:107], v[164:167], v[64:67]
    ds_read_b128 v[148:151], v33 offset:16832
    v_mfma_f32_16x16x32_bf16 v[44:47], v[108:111], v[152:155], v[44:47]
    ds_read_b64 v[72:73], v32 offset:128
    v_mfma_f32_16x16x32_bf16 v[52:55], v[108:111], v[156:159], v[52:55]
    ds_read_b64 v[74:75], v32 offset:136
    v_add_u32 v33, 192, v33
    v_mfma_f32_16x16x32_bf16 v[60:63], v[108:111], v[160:163], v[60:63]
    ds_read_b64 v[76:77], v32 offset:160
    s_add_u32 s43, s43, 1
    v_mfma_f32_16x16x32_bf16 v[68:71], v[108:111], v[164:167], v[68:71]
    ds_read_b64 v[78:79], v32 offset:168
    s_cmp_lt_u32 s43, 8
    v_mfma_f32_16x16x32_bf16 v[48:51], v[112:115], v[152:155], v[48:51]
    ds_read_b64 v[80:81], v32 offset:1152
    v_mfma_f32_16x16x32_bf16 v[56:59], v[112:115], v[156:159], v[56:59]
    ds_read_b64 v[82:83], v32 offset:1160
    s_waitcnt lgkmcnt(10)
    v_mfma_f32_16x16x32_bf16 v[64:67], v[112:115], v[160:163], v[64:67]
    ds_read_b64 v[84:85], v32 offset:1184
    v_mfma_f32_16x16x32_bf16 v[52:55], v[116:119], v[152:155], v[52:55]
    ds_read_b64 v[86:87], v32 offset:1192
    v_mfma_f32_16x16x32_bf16 v[60:63], v[116:119], v[156:159], v[60:63]
    ds_read_b64 v[88:89], v32 offset:2176
    v_mfma_f32_16x16x32_bf16 v[68:71], v[116:119], v[160:163], v[68:71]
    ds_read_b64 v[90:91], v32 offset:2184
    v_mfma_f32_16x16x32_bf16 v[56:59], v[120:123], v[152:155], v[56:59]
    ds_read_b64 v[92:93], v32 offset:2208
    v_mfma_f32_16x16x32_bf16 v[64:67], v[120:123], v[156:159], v[64:67]
    ds_read_b64 v[94:95], v32 offset:2216
    v_mfma_f32_16x16x32_bf16 v[60:63], v[124:127], v[152:155], v[60:63]
    ds_read_b64 v[96:97], v32 offset:3200
    v_mfma_f32_16x16x32_bf16 v[68:71], v[124:127], v[156:159], v[68:71]
    ds_read_b64 v[98:99], v32 offset:3208
    v_mfma_f32_16x16x32_bf16 v[64:67], v[128:131], v[152:155], v[64:67]
    ds_read_b64 v[100:101], v32 offset:3232
    v_mfma_f32_16x16x32_bf16 v[68:71], v[132:135], v[152:155], v[68:71]
    ds_read_b64 v[102:103], v32 offset:3240
    v_add_u32 v32, 128, v32
    s_cbranch_scc1 CV_l
    v_cvt_pk_bf16_f32 v16, v40, v41
    v_cvt_pk_bf16_f32 v17, v42, v43
    ds_write_b64 v170, v[16:17] offset:0
    v_cvt_pk_bf16_f32 v18, v44, v45
    v_cvt_pk_bf16_f32 v19, v46, v47
    ds_write_b64 v170, v[18:19] offset:32
    v_cvt_pk_bf16_f32 v20, v48, v49
    v_cvt_pk_bf16_f32 v21, v50, v51
    ds_write_b64 v170, v[20:21] offset:1152
    v_cvt_pk_bf16_f32 v22, v52, v53
    v_cvt_pk_bf16_f32 v23, v54, v55
    ds_write_b64 v170, v[22:23] offset:1184
    v_cvt_pk_bf16_f32 v24, v56, v57
    v_cvt_pk_bf16_f32 v25, v58, v59
    ds_write_b64 v170, v[24:25] offset:2304
    v_cvt_pk_bf16_f32 v26, v60, v61
    v_cvt_pk_bf16_f32 v27, v62, v63
    ds_write_b64 v170, v[26:27] offset:2336
    v_cvt_pk_bf16_f32 v28, v64, v65
    v_cvt_pk_bf16_f32 v29, v66, v67
    ds_write_b64 v170, v[28:29] offset:3456
    v_cvt_pk_bf16_f32 v30, v68, v69
    v_cvt_pk_bf16_f32 v31, v70, v71
    ds_write_b64 v170, v[30:31] offset:3488
    s_mov_b64 exec, 1
    ds_add_u32 v34, v7
    s_mov_b64 exec, -1
    s_mov_b32 s53, 0
    s_waitcnt vmcnt(0)
CV_v:
    v_readfirstlane_b32 s94, v12
    s_nop 0
    s_sub_u32 s94, s94, s52
    s_and_b32 s37, s94, 0xfffffe01
    s_cbranch_scc0 CV_k
    buffer_load_dword v12, v35, s[56:59], s45 offen sc1
    s_waitcnt vmcnt(0)
    s_add_u32 s53, s53, 1
    s_cmp_lt_u32 s53, s61
    s_cbranch_scc1 CV_v
    s_mov_b32 s61, 0
    s_mov_b32 s94, 0
CV_k:
    s_lshr_b32 s94, s94, 1
    s_add_u32 s37, s94, 65536
    v_mov_b32 v8, 162844
    v_mov_b32 v9, s37
    ds_write_b32 v8, v9
    s_cmp_gt_u32 s94, 10
    s_cselect_b32 s37, 0x2000, 0
    s_xor_b32 s44, s44, s37
    s_xor_b32 s45, s47, s37
    s_add_u32 s45, s45, 23101440
    v_mov_b32 v8, 162824
spin_5:
    ds_read_b32 v9, v8
    s_waitcnt lgkmcnt(0)
    v_readfirstlane_b32 s53, v9
    s_nop 0
    s_cmp_ge_u32 s53, 6
    s_cbranch_scc0 spin_5
    ds_read_b64_tr_b16 v[104:105], v168 offset:0
    ds_read_b64_tr_b16 v[106:107], v168 offset:32
    ds_read_b64_tr_b16 v[108:109], v168 offset:288
    ds_read_b64_tr_b16 v[110:111], v168 offset:320
    ds_read_b64_tr_b16 v[112:113], v168 offset:576
    ds_read_b64_tr_b16 v[114:115], v168 offset:608
    ds_read_b64_tr_b16 v[116:117], v168 offset:864
    ds_read_b64_tr_b16 v[118:119], v168 offset:896
    s_waitcnt lgkmcnt(6)
    v_or_b32 v104, 1, v104
    buffer_store_dwordx4 v[104:107], v169, s[12:15], s44 offen sc1
    s_add_u32 s44, s44, 16777216
    s_waitcnt lgkmcnt(4)
    v_or_b32 v108, 1, v108
    buffer_store_dwordx4 v[108:111], v169, s[12:15], s44 offen sc1
    s_add_u32 s44, s44, 16777216
    s_waitcnt lgkmcnt(2)
    v_or_b32 v112, 1, v112
    buffer_store_dwordx4 v[112:115], v169, s[12:15], s44 offen sc1
    s_add_u32 s44, s44, 16777216
    s_waitcnt lgkmcnt(0)
    v_or_b32 v116, 1, v116
    buffer_store_dwordx4 v[116:119], v169, s[12:15], s44 offen sc1
    s_add_u32 s44, s44, 16777216
    v_mov_b32 v8, 162836
    v_mov_b32 v9, 1
    s_mov_b64 exec, 1
    ds_add_u32 v8, v9
    s_mov_b64 exec, -1
    s_mov_b64 exec, 0xf
    s_waitcnt vmcnt(0)
    buffer_atomic_add v7, v6, s[56:59], s45 offen sc1
    s_mov_b64 exec, -1
    s_branch FR_end
FR_b:
    s_cmp_ge_u32 s2, 32
    s_cbranch_scc1 FB_np
    s_cmp_lg_u32 s30, 5
    s_cbranch_scc1 FB_np
    s_and_b32 s42, s2, 7
    s_lshl_b32 s42, s42, 10
    s_lshr_b32 s43, s2, 3
    s_lshl_b32 s43, s43, 14
    s_add_u32 s42, s42, s43
    s_add_u32 s42, s42, 39714816
    v_mov_b32 v14, 0
    s_mov_b64 exec, 1
    s_mov_b32 s46, -1
    s_mov_b32 s47, -1
    s_add_u32 s48, s4, s42
    s_addc_u32 s49, s5, 0
    s_load_dword s101, s[48:49], 384
    s_waitcnt lgkmcnt(0)
    s_memtime s[34:35]
    s_waitcnt lgkmcnt(0)
    s_load_dword s101, s[48:49], 0
    s_waitcnt lgkmcnt(0)
    s_memtime s[36:37]
    s_waitcnt lgkmcnt(0)
    s_sub_u32 s43, s36, s34
    s_min_u32 s46, s46, s43
    s_load_dword s101, s[48:49], 8192
    s_waitcnt lgkmcnt(0)
    s_memtime s[34:35]
    s_waitcnt lgkmcnt(0)
    s_sub_u32 s43, s34, s36
    s_min_u32 s47, s47, s43
    s_load_dword s101, s[48:49], 128
    s_waitcnt lgkmcnt(0)
    s_memtime s[36:37]
    s_waitcnt lgkmcnt(0)
    s_sub_u32 s43, s36, s34
    s_min_u32 s46, s46, s43
    s_load_dword s101, s[48:49], 8320
    s_waitcnt lgkmcnt(0)
    s_memtime s[34:35]
    s_waitcnt lgkmcnt(0)
    s_sub_u32 s43, s34, s36
    s_min_u32 s47, s47, s43
    s_cmp_lt_u32 s47, s46
    s_cselect_b32 s45, 1, 0
    s_lshr_b32 s46, s28, 2
    s_xor_b32 s45, s45, s46
    s_and_b32 s45, s45, 1
    s_lshl_b32 s45, s45, 8
    s_or_b32 s43, s45, 1
    v_mov_b32 v12, s43
    buffer_atomic_add v12, v14, s[84:87], 0 offen offset:4 sc0 sc1
    s_waitcnt vmcnt(0)
    v_readfirstlane_b32 s36, v12
    s_nop 0
    s_add_u32 s36, s36, s43
    s_and_b32 s37, s36, 255
    s_cmp_lg_u32 s37, 21
    s_cbranch_scc1 FB_np
    s_lshr_b32 s36, s36, 8
    s_lshl_b32 s36, s36, 1
    s_add_u32 s36, s36, s52
    s_bfm_b64 exec, 32, 0
    v_mov_b32 v12, s36
    v_lshlrev_b32 v13, 7, v1
    s_mov_b32 s36, 23117824
    buffer_store_dword v12, v13, s[56:59], s36 offen sc1
FB_np:
    s_mov_b64 exec, -1
    s_getpc_b64 s[34:35]
K_tpc:
    s_lshl_b32 s36, s29, 2
    s_and_b32 s37, s28, 3
    s_add_u32 s36, s36, s37
    s_lshl_b32 s36, s36, 6
    s_add_u32 s36, s36, K_tab-K_tpc
    s_add_u32 s34, s34, s36
    s_addc_u32 s35, s35, 0
    v_and_b32 v248, 31, v1
    v_lshlrev_b32 v248, 1, v248
    global_load_ushort v251, v248, s[34:35]
    v_lshrrev_b32 v253, 3, v1
    v_lshlrev_b32 v238, 11, v253
    v_and_b32 v253, 6, v253
    v_and_b32 v254, 7, v1
    v_xor_b32 v253, v253, v254
    v_lshl_add_u32 v238, v253, 4, v238
    v_lshrrev_b32 v253, 4, v1
    v_lshlrev_b32 v239, 11, v253
    v_add_u32 v253, 0, v253
    v_lshlrev_b32 v253, 1, v253
    v_and_b32 v254, 15, v1
    v_xor_b32 v253, v253, v254
    v_lshl_add_u32 v239, v253, 4, v239
    v_lshrrev_b32 v253, 4, v1
    v_lshlrev_b32 v240, 11, v253
    v_add_u32 v253, 4, v253
    v_lshlrev_b32 v253, 1, v253
    v_and_b32 v254, 15, v1
    v_xor_b32 v253, v253, v254
    v_lshl_add_u32 v240, v253, 4, v240
    v_add_u32 v254, 0, v1
    v_mul_u32_u24 v253, 2341, v254
    v_lshrrev_b32 v253, 16, v253
    v_mul_u32_u24 v241, 28, v253
    v_sub_u32 v254, v254, v241
    v_mul_u32_u24 v241, 7168, v253
    v_lshrrev_b32 v253, 1, v253
    v_and_b32 v253, 2, v253
    v_xor_b32 v254, v254, v253
    v_lshl_add_u32 v241, v254, 4, v241
    v_add_u32 v254, 64, v1
    v_mul_u32_u24 v253, 2341, v254
    v_lshrrev_b32 v253, 16, v253
    v_mul_u32_u24 v242, 28, v253
    v_sub_u32 v254, v254, v242
    v_mul_u32_u24 v242, 7168, v253
    v_lshrrev_b32 v253, 1, v253
    v_and_b32 v253, 2, v253
    v_xor_b32 v254, v254, v253
    v_lshl_add_u32 v242, v254, 4, v242
    v_add_u32 v254, 128, v1
    v_mul_u32_u24 v253, 2341, v254
    v_lshrrev_b32 v253, 16, v253
    v_mul_u32_u24 v243, 28, v253
    v_sub_u32 v254, v254, v243
    v_mul_u32_u24 v243, 7168, v253
    v_lshrrev_b32 v253, 1, v253
    v_and_b32 v253, 2, v253
    v_xor_b32 v254, v254, v253
    v_lshl_add_u32 v243, v254, 4, v243
    v_add_u32 v254, 192, v1
    v_mul_u32_u24 v253, 2341, v254
    v_lshrrev_b32 v253, 16, v253
    v_mul_u32_u24 v244, 28, v253
    v_sub_u32 v254, v254, v244
    v_mul_u32_u24 v244, 7168, v253
    v_lshrrev_b32 v253, 1, v253
    v_and_b32 v253, 2, v253
    v_xor_b32 v254, v254, v253
    v_lshl_add_u32 v244, v254, 4, v244
    v_add_u32 v254, 256, v1
    v_mul_u32_u24 v253, 2341, v254
    v_lshrrev_b32 v253, 16, v253
    v_mul_u32_u24 v245, 28, v253
    v_sub_u32 v254, v254, v245
    v_mul_u32_u24 v245, 7168, v253
    v_lshrrev_b32 v253, 1, v253
    v_and_b32 v253, 2, v253
    v_xor_b32 v254, v254, v253
    v_lshl_add_u32 v245, v254, 4, v245
    v_add_u32 v254, 320, v1
    v_mul_u32_u24 v253, 2341, v254
    v_lshrrev_b32 v253, 16, v253
    v_mul_u32_u24 v246, 28, v253
    v_sub_u32 v254, v254, v246
    v_mul_u32_u24 v246, 7168, v253
    v_lshrrev_b32 v253, 1, v253
    v_and_b32 v253, 2, v253
    v_xor_b32 v254, v254, v253
    v_lshl_add_u32 v246, v254, 4, v246
    v_add_u32 v254, 384, v1
    v_mul_u32_u24 v253, 2341, v254
    v_lshrrev_b32 v253, 16, v253
    v_mul_u32_u24 v247, 28, v253
    v_sub_u32 v254, v254, v247
    v_mul_u32_u24 v247, 7168, v253
    v_lshrrev_b32 v253, 1, v253
    v_and_b32 v253, 2, v253
    v_xor_b32 v254, v254, v253
    v_lshl_add_u32 v247, v254, 4, v247
    s_cmp_ge_u32 s30, 6
    s_cbranch_scc1 FB_cs
    s_cmp_lg_u32 s30, 4
    s_cbranch_scc1 FB_ni
    v_mov_b32 v12, s52
    s_lshr_b32 s53, s28, 3
    s_lshl_b32 s53, s53, 2
    s_and_b32 s54, s28, 3
    s_add_u32 s53, s53, s54
    s_lshl_b32 s53, s53, 24
    s_lshr_b32 s54, s28, 2
    s_xor_b32 s54, s54, s94
    s_and_b32 s54, s54, 1
    s_lshl_b32 s54, s54, 13
    s_add_u32 s37, s53, s54
    s_add_u32 s37, s37, 33554432
    s_andn2_b32 s37, s37, 0x2000
    s_lshl_b32 s53, s29, 7
    s_add_u32 s37, s37, s53
    s_add_u32 s37, s37, 6029312
    v_and_b32 v13, 1, v1
    v_lshlrev_b32 v13, 13, v13
    v_lshrrev_b32 v14, 1, v1
    v_lshl_add_u32 v13, v14, 22, v13
    s_mov_b64 exec, 0xf
    buffer_store_dword v12, v13, s[56:59], s37 offen sc1
    s_cmp_lg_u32 s28, 0
    s_cbranch_scc1 FB_n2
    s_add_u32 s37, s53, 23121920
    s_mov_b64 exec, 1
    buffer_store_dword v12, v13, s[56:59], s37 offen sc1
FB_n2:
    s_mov_b64 exec, -1
FB_ni:
    s_waitcnt vmcnt(0)
    v_bfe_u32 v252, v251, 2, 2
    v_lshlrev_b32 v248, 14, v252
    v_and_b32 v252, 3, v251
    v_lshl_add_u32 v248, v252, 11, v248
    v_bfe_u32 v252, v251, 7, 3
    v_lshlrev_b32 v249, 14, v252
    v_bfe_u32 v252, v251, 4, 3
    v_lshl_add_u32 v249, v252, 10, v249
    v_bfe_u32 v252, v251, 13, 3
    v_lshlrev_b32 v250, 14, v252
    v_bfe_u32 v252, v251, 10, 3
    v_lshl_add_u32 v250, v252, 10, v250
    v_mov_b32 v6, 162836
spin_7:
    s_sleep 2
    ds_read_b32 v7, v6
    s_waitcnt lgkmcnt(0)
    v_readfirstlane_b32 s53, v7
    s_nop 0
    s_cmp_ge_u32 s53, 4
    s_cbranch_scc0 spin_7
    s_load_dwordx2 s[48:49], s[0:1], 64
    s_lshl_b32 s45, s2, 1
    s_and_b32 s50, s30, 1
    s_add_u32 s45, s45, s50
    s_mul_i32 s45, s45, 4096
    s_mov_b32 s50, 2097152
    s_mov_b32 s51, 0x20000
    s_waitcnt lgkmcnt(0)
    buffer_load_dwordx4 v[20:23], v2, s[48:51], s45 offen offset:0
    buffer_load_dwordx4 v[20:23], v2, s[48:51], s45 offen offset:1024
    buffer_load_dwordx4 v[20:23], v2, s[48:51], s45 offen offset:2048
    buffer_load_dwordx4 v[20:23], v2, s[48:51], s45 offen offset:3072
    v_mov_b32 v6, 1
    v_mov_b32 v7, 162824
    s_mov_b64 exec, 1
    s_waitcnt vmcnt(0)
    ds_add_u32 v7, v6
    s_mov_b64 exec, -1
    v_mov_b32 v6, 162840
spin_9:
    s_sleep 4
    ds_read_b32 v7, v6
    s_waitcnt lgkmcnt(0)
    v_readfirstlane_b32 s53, v7
    s_nop 0
    s_cmp_ge_u32 s53, 2
    s_cbranch_scc0 spin_9
    s_call_b64 s[76:77], SUB_w1_regs
    s_call_b64 s[76:77], SUB_park
    v_mov_b32 v6, 162840
spin_10:
    s_sleep 3
    ds_read_b32 v7, v6
    s_waitcnt lgkmcnt(0)
    v_readfirstlane_b32 s53, v7
    s_nop 0
    s_cmp_ge_u32 s53, 4
    s_cbranch_scc0 spin_10
    s_mov_b64 s[12:13], s[68:69]
    s_mov_b32 s14, 2097152
    s_mov_b32 s15, 0x20000
    s_and_b32 s35, s30, 1
    s_mul_i32 s38, s99, 128
    s_mul_i32 s41, s35, 65536
    s_add_u32 s38, s38, s41
    s_mul_i32 s41, s35, 4096
    s_add_u32 s41, s41, 24576
    s_mov_b32 s42, 0
    s_mov_b32 s44, s67
    s_mov_b32 s42, 73728
    s_mov_b32 s44, s67
    s_add_u32 s44, s44, 9
    s_and_b32 s44, s44, 15
    s_call_b64 s[76:77], SUB_w_issue_1
    s_waitcnt vmcnt(8)
    s_mov_b32 s42, 81920
    s_mov_b32 s44, s67
    s_add_u32 s44, s44, 10
    s_and_b32 s44, s44, 15
    s_call_b64 s[76:77], SUB_w_issue_1
    s_waitcnt vmcnt(8)
    s_mov_b32 s42, 90112
    s_mov_b32 s44, s67
    s_add_u32 s44, s44, 11
    s_and_b32 s44, s44, 15
    s_call_b64 s[76:77], SUB_w_issue_1
    s_waitcnt vmcnt(8)
    s_and_b32 s36, s29, 6
    s_cmp_eq_u32 s36, 2
    s_cbranch_scc1 pr_11
    s_call_b64 s[76:77], SUB_park2
pr_11:
    s_call_b64 s[76:77], SUB_w1_put
    s_branch FR_end
FB_cs:
    v_and_b32 v164, 15, v1
    v_mov_b32 v165, 0x3f803f80
    v_cmp_eq_u32 vcc, 0, v164
    s_nop 1
    v_cndmask_b32 v16, 0, v165, vcc
    v_cndmask_b32 v17, 0, v165, vcc
    v_cndmask_b32 v18, 0, v165, vcc
    v_cndmask_b32 v19, 0, v165, vcc
    v_cmp_eq_u32 vcc, 1, v164
    s_nop 1
    v_cndmask_b32 v20, 0, v165, vcc
    v_cndmask_b32 v21, 0, v165, vcc
    v_cndmask_b32 v22, 0, v165, vcc
    v_cndmask_b32 v23, 0, v165, vcc
    v_cmp_eq_u32 vcc, 2, v164
    s_nop 1
    v_cndmask_b32 v24, 0, v165, vcc
    v_cndmask_b32 v25, 0, v165, vcc
    v_cndmask_b32 v26, 0, v165, vcc
    v_cndmask_b32 v27, 0, v165, vcc
    v_cmp_eq_u32 vcc, 3, v164
    s_nop 1
    v_cndmask_b32 v28, 0, v165, vcc
    v_cndmask_b32 v29, 0, v165, vcc
    v_cndmask_b32 v30, 0, v165, vcc
    v_cndmask_b32 v31, 0, v165, vcc
    v_cmp_eq_u32 vcc, 4, v164
    s_nop 1
    v_cndmask_b32 v32, 0, v165, vcc
    v_cndmask_b32 v33, 0, v165, vcc
    v_cndmask_b32 v34, 0, v165, vcc
    v_cndmask_b32 v35, 0, v165, vcc
    v_cmp_eq_u32 vcc, 5, v164
    s_nop 1
    v_cndmask_b32 v36, 0, v165, vcc
    v_cndmask_b32 v37, 0, v165, vcc
    v_cndmask_b32 v38, 0, v165, vcc
    v_cndmask_b32 v39, 0, v165, vcc
    v_cmp_eq_u32 vcc, 6, v164
    s_nop 1
    v_cndmask_b32 v40, 0, v165, vcc
    v_cndmask_b32 v41, 0, v165, vcc
    v_cndmask_b32 v42, 0, v165, vcc
    v_cndmask_b32 v43, 0, v165, vcc
    v_cmp_eq_u32 vcc, 7, v164
    s_nop 1
    v_cndmask_b32 v44, 0, v165, vcc
    v_cndmask_b32 v45, 0, v165, vcc
    v_cndmask_b32 v46, 0, v165, vcc
    v_cndmask_b32 v47, 0, v165, vcc
    v_cmp_eq_u32 vcc, 8, v164
    s_nop 1
    v_cndmask_b32 v48, 0, v165, vcc
    v_cndmask_b32 v49, 0, v165, vcc
    v_cndmask_b32 v50, 0, v165, vcc
    v_cndmask_b32 v51, 0, v165, vcc
    v_cmp_eq_u32 vcc, 9, v164
    s_nop 1
    v_cndmask_b32 v52, 0, v165, vcc
    v_cndmask_b32 v53, 0, v165, vcc
    v_cndmask_b32 v54, 0, v165, vcc
    v_cndmask_b32 v55, 0, v165, vcc
    v_cmp_eq_u32 vcc, 10, v164
    s_nop 1
    v_cndmask_b32 v56, 0, v165, vcc
    v_cndmask_b32 v57, 0, v165, vcc
    v_cndmask_b32 v58, 0, v165, vcc
    v_cndmask_b32 v59, 0, v165, vcc
    v_cmp_eq_u32 vcc, 11, v164
    s_nop 1
    v_cndmask_b32 v60, 0, v165, vcc
    v_cndmask_b32 v61, 0, v165, vcc
    v_cndmask_b32 v62, 0, v165, vcc
    v_cndmask_b32 v63, 0, v165, vcc
    v_cmp_eq_u32 vcc, 12, v164
    s_nop 1
    v_cndmask_b32 v64, 0, v165, vcc
    v_cndmask_b32 v65, 0, v165, vcc
    v_cndmask_b32 v66, 0, v165, vcc
    v_cndmask_b32 v67, 0, v165, vcc
    v_cmp_eq_u32 vcc, 13, v164
    s_nop 1
    v_cndmask_b32 v68, 0, v165, vcc
    v_cndmask_b32 v69, 0, v165, vcc
    v_cndmask_b32 v70, 0, v165, vcc
    v_cndmask_b32 v71, 0, v165, vcc
    s_mov_b32 s35, 0
    v_lshrrev_b32 v253, 2, v1
    v_mul_u32_u24 v144, 128, v253
    v_and_b32 v254, 3, v1
    v_lshl_add_u32 v144, v254, 3, v144
    v_add_u32 v144, 24576, v144
    v_bfe_u32 v253, v253, 1, 2
    s_mul_i32 s36, s35, 4
    s_add_u32 s36, s36, 3
    v_xor_b32 v254, s36, v253
    v_lshl_add_u32 v147, v254, 5, v144
    s_mul_i32 s36, s35, 4
    s_add_u32 s36, s36, 2
    v_xor_b32 v254, s36, v253
    v_lshl_add_u32 v146, v254, 5, v144
    s_mul_i32 s36, s35, 4
    s_add_u32 s36, s36, 1
    v_xor_b32 v254, s36, v253
    v_lshl_add_u32 v145, v254, 5, v144
    s_mul_i32 s36, s35, 4
    s_add_u32 s36, s36, 0
    v_xor_b32 v254, s36, v253
    v_lshl_add_u32 v144, v254, 5, v144
    s_and_b32 s35, s30, 1
    s_mul_i32 s35, s35, 4096
    s_add_u32 s35, s35, 73728
    v_add_u32 v144, s35, v144
    v_add_u32 v145, s35, v145
    v_add_u32 v146, s35, v146
    v_add_u32 v147, s35, v147
    s_mov_b32 s35, 0
    v_lshrrev_b32 v253, 2, v1
    v_mul_u32_u24 v148, 448, v253
    v_and_b32 v254, 3, v1
    v_lshl_add_u32 v148, v254, 3, v148
    v_add_u32 v148, 73728, v148
    s_mul_i32 s36, s35, 224
    v_add_u32 v148, s36, v148
    v_bfe_u32 v253, v1, 4, 1
    v_lshlrev_b32 v253, 5, v253
    s_cmp_eq_u32 s35, 0
    s_cselect_b32 s36, 1, -1
    v_mul_lo_u32 v253, v253, s36
    v_sub_u32 v149, v148, v253
    v_add_u32 v148, v148, v253
    s_and_b32 s35, s30, 1
    s_mul_i32 s35, s35, 14336
    s_add_u32 s35, s35, 32768
    v_add_u32 v148, s35, v148
    v_add_u32 v149, s35, v149
    s_mov_b32 s35, 1
    v_lshrrev_b32 v253, 2, v1
    v_mul_u32_u24 v150, 448, v253
    v_and_b32 v254, 3, v1
    v_lshl_add_u32 v150, v254, 3, v150
    v_add_u32 v150, 73728, v150
    s_mul_i32 s36, s35, 224
    v_add_u32 v150, s36, v150
    v_bfe_u32 v253, v1, 4, 1
    v_lshlrev_b32 v253, 5, v253
    s_cmp_eq_u32 s35, 0
    s_cselect_b32 s36, 1, -1
    v_mul_lo_u32 v253, v253, s36
    v_sub_u32 v151, v150, v253
    v_add_u32 v150, v150, v253
    s_and_b32 s35, s30, 1
    s_mul_i32 s35, s35, 14336
    s_add_u32 s35, s35, 32768
    v_add_u32 v150, s35, v150
    v_add_u32 v151, s35, v151
    v_mov_b32 v156, 0
    v_mov_b32 v157, 0
    v_mov_b32 v158, 0
    v_mov_b32 v159, 0
    v_mov_b32 v160, 0
    v_mov_b32 v161, 0
    v_mov_b32 v162, 0
    v_mov_b32 v163, 0
    v_lshrrev_b32 v166, 4, v1
    v_lshlrev_b32 v166, 4, v166
    v_lshl_add_u32 v166, v164, 6, v166
    v_mov_b32 v165, 0x7f000000
    v_cmp_gt_u32 vcc, 4, v164
    s_nop 1
    v_cndmask_b32 v167, v165, v166, vcc
    v_cmp_gt_u32 vcc, 14, v164
    s_nop 1
    v_cndmask_b32 v168, v165, v166, vcc
    s_waitcnt vmcnt(0)
    v_and_b32 v252, 15, v251
    v_mul_u32_u24 v248, 458752, v252
    s_and_b32 s36, s30, 1
    s_mul_i32 s36, s36, 6
    s_add_u32 s36, s36, 4
    v_bfe_u32 v252, v251, s36, 6
    v_mul_u32_u24 v250, 37, v252
    v_lshrrev_b32 v250, 8, v250
    v_mul_u32_u24 v250, 7, v250
    v_sub_u32 v250, v252, v250
    v_cmp_eq_u32 vcc, 3, v250
    s_nop 1
    v_cndmask_b32 v250, 0, 1, vcc
    v_lshl_add_u32 v249, v252, 16, v250
    v_mov_b32 v6, 162836
spin_12:
    s_sleep 2
    ds_read_b32 v7, v6
    s_waitcnt lgkmcnt(0)
    v_readfirstlane_b32 s53, v7
    s_nop 0
    s_cmp_ge_u32 s53, 4
    s_cbranch_scc0 spin_12
    s_mov_b64 s[12:13], s[68:69]
    s_mov_b32 s14, 2097152
    s_mov_b32 s15, 0x20000
    s_and_b32 s35, s30, 1
    s_mul_i32 s38, s99, 128
    s_mul_i32 s41, s35, 65536
    s_add_u32 s38, s38, s41
    s_mul_i32 s41, s35, 4096
    s_add_u32 s41, s41, 24576
    s_mov_b32 s42, 0
    s_mov_b32 s44, s67
    s_mov_b32 s42, 73728
    s_mov_b32 s44, s28
    s_add_u32 s19, s41, s42
    s_mul_i32 s16, s44, 131072
    s_add_u32 s16, s16, s38
    s_add_u32 s44, s44, 1
    s_and_b32 s44, s44, 15
    s_add_u32 s42, s42, 8192
    s_cmp_eq_u32 s42, 131072
    s_cselect_b32 s42, 0, s42
    s_mov_b32 m0, s19
    s_mov_b32 s39, s16
    buffer_load_dwordx4 v238, s[12:15], s39 offen lds
    s_add_u32 m0, m0, 1024
    s_add_u32 s39, s39, 16384
    buffer_load_dwordx4 v238, s[12:15], s39 offen lds
    s_add_u32 m0, m0, 1024
    s_add_u32 s39, s39, 16384
    buffer_load_dwordx4 v238, s[12:15], s39 offen lds
    s_add_u32 m0, m0, 1024
    s_add_u32 s39, s39, 16384
    buffer_load_dwordx4 v238, s[12:15], s39 offen lds
    s_mov_b64 s[12:13], s[72:73]
    s_mov_b32 s14, 7340032
    s_mov_b32 s15, 0x20000
    s_and_b32 s35, s30, 1
    s_mul_i32 s38, s29, 448
    s_mul_i32 s41, s35, 229376
    s_add_u32 s38, s38, s41
    s_mul_i32 s41, s35, 14336
    s_add_u32 s41, s41, 73728
    s_mov_b32 s42, 0
    s_mov_b32 s44, 0
    s_mov_b32 s42, 32768
    s_mov_b32 s44, s28
    s_add_u32 s19, s41, s42
    s_mul_i32 s16, s44, 458752
    s_add_u32 s16, s16, s38
    s_add_u32 s44, s44, 1
    s_and_b32 s44, s44, 15
    s_add_u32 s42, s42, 28672
    s_cmp_eq_u32 s42, 86016
    s_cselect_b32 s42, 0, s42
    s_mov_b32 m0, s19
    s_mov_b32 s39, s16
    buffer_load_dwordx4 v241, s[12:15], s39 offen lds
    s_add_u32 m0, m0, 1024
    s_nop 0
    buffer_load_dwordx4 v242, s[12:15], s39 offen lds
    s_add_u32 m0, m0, 1024
    s_nop 0
    buffer_load_dwordx4 v243, s[12:15], s39 offen lds
    s_add_u32 m0, m0, 1024
    s_nop 0
    buffer_load_dwordx4 v244, s[12:15], s39 offen lds
    s_add_u32 m0, m0, 1024
    s_nop 0
    buffer_load_dwordx4 v245, s[12:15], s39 offen lds
    s_add_u32 m0, m0, 1024
    s_nop 0
    buffer_load_dwordx4 v246, s[12:15], s39 offen lds
    s_add_u32 m0, m0, 1024
    s_nop 0
    buffer_load_dwordx4 v247, s[12:15], s39 offen lds
    s_add_u32 m0, m0, 1024
    s_add_u32 s39, s39, 114688
    buffer_load_dwordx4 v241, s[12:15], s39 offen lds
    s_add_u32 m0, m0, 1024
    s_nop 0
    buffer_load_dwordx4 v242, s[12:15], s39 offen lds
    s_add_u32 m0, m0, 1024
    s_nop 0
    buffer_load_dwordx4 v243, s[12:15], s39 offen lds
    s_add_u32 m0, m0, 1024
    s_nop 0
    buffer_load_dwordx4 v244, s[12:15], s39 offen lds
    s_add_u32 m0, m0, 1024
    s_nop 0
    buffer_load_dwordx4 v245, s[12:15], s39 offen lds
    s_add_u32 m0, m0, 1024
    s_nop 0
    buffer_load_dwordx4 v246, s[12:15], s39 offen lds
    s_add_u32 m0, m0, 1024
    s_nop 0
    buffer_load_dwordx4 v247, s[12:15], s39 offen lds
    s_waitcnt vmcnt(14)
    s_setprio 1
    ds_read_b64_tr_b16 v[128:129], v144 offset:0
    ds_read_b64_tr_b16 v[130:131], v144 offset:2048
    ds_read_b64_tr_b16 v[132:133], v145 offset:0
    ds_read_b64_tr_b16 v[134:135], v145 offset:2048
    ds_read_b64_tr_b16 v[136:137], v146 offset:0
    ds_read_b64_tr_b16 v[138:139], v146 offset:2048
    ds_read_b64_tr_b16 v[140:141], v147 offset:0
    ds_read_b64_tr_b16 v[142:143], v147 offset:2048
    s_add_u32 s20, s4, 0x1400000
    s_addc_u32 s21, s5, 0
    s_mov_b32 s22, 0x20000
    s_mov_b32 s23, 0x20000
    s_lshl_b32 s35, s28, 1
    s_and_b32 s36, s30, 1
    s_add_u32 s35, s35, s36
    s_mul_i32 s35, s35, 4096
    s_mul_i32 s36, s29, 256
    s_add_u32 s35, s35, s36
    s_waitcnt lgkmcnt(0)
    v_mfma_f32_16x16x32_bf16 v[160:163], v[128:131], v[16:19], v[160:163]
    v_mfma_f32_16x16x32_bf16 v[160:163], v[132:135], v[20:23], v[160:163]
    v_mfma_f32_16x16x32_bf16 v[160:163], v[136:139], v[24:27], v[160:163]
    v_mfma_f32_16x16x32_bf16 v[160:163], v[140:143], v[28:31], v[160:163]
    s_nop 7
    buffer_store_dwordx4 v[160:163], v167, s[20:23], s35 offen sc1
    s_waitcnt vmcnt(1)
    v_mov_b32 v6, 162840
    v_mov_b32 v7, 1
    s_mov_b64 exec, 1
    ds_add_u32 v6, v7
    s_mov_b64 exec, -1
    ds_read_b64_tr_b16 v[72:73], v148 offset:0
    ds_read_b64_tr_b16 v[74:75], v148 offset:7168
    ds_read_b64_tr_b16 v[76:77], v149 offset:32
    ds_read_b64_tr_b16 v[78:79], v149 offset:7200
    ds_read_b64_tr_b16 v[80:81], v148 offset:64
    ds_read_b64_tr_b16 v[82:83], v148 offset:7232
    ds_read_b64_tr_b16 v[84:85], v149 offset:96
    ds_read_b64_tr_b16 v[86:87], v149 offset:7264
    ds_read_b64_tr_b16 v[88:89], v148 offset:128
    ds_read_b64_tr_b16 v[90:91], v148 offset:7296
    ds_read_b64_tr_b16 v[92:93], v149 offset:160
    ds_read_b64_tr_b16 v[94:95], v149 offset:7328
    ds_read_b64_tr_b16 v[96:97], v148 offset:192
    ds_read_b64_tr_b16 v[98:99], v148 offset:7360
    ds_read_b64_tr_b16 v[100:101], v150 offset:0
    ds_read_b64_tr_b16 v[102:103], v150 offset:7168
    ds_read_b64_tr_b16 v[104:105], v151 offset:32
    ds_read_b64_tr_b16 v[106:107], v151 offset:7200
    ds_read_b64_tr_b16 v[108:109], v150 offset:64
    ds_read_b64_tr_b16 v[110:111], v150 offset:7232
    ds_read_b64_tr_b16 v[112:113], v151 offset:96
    ds_read_b64_tr_b16 v[114:115], v151 offset:7264
    ds_read_b64_tr_b16 v[116:117], v150 offset:128
    ds_read_b64_tr_b16 v[118:119], v150 offset:7296
    ds_read_b64_tr_b16 v[120:121], v151 offset:160
    ds_read_b64_tr_b16 v[122:123], v151 offset:7328
    ds_read_b64_tr_b16 v[124:125], v150 offset:192
    ds_read_b64_tr_b16 v[126:127], v150 offset:7360
    s_add_u32 s20, s4, 0x1420000
    s_addc_u32 s21, s5, 0
    s_mov_b32 s22, 0x70000
    s_mov_b32 s23, 0x20000
    s_lshl_b32 s35, s28, 1
    s_and_b32 s36, s30, 1
    s_add_u32 s35, s35, s36
    s_mul_i32 s35, s35, 14336
    s_mul_i32 s36, s29, 896
    s_add_u32 s35, s35, s36
    s_waitcnt lgkmcnt(0)
    v_mfma_f32_16x16x32_bf16 v[156:159], v[72:75], v[16:19], v[156:159]
    v_mfma_f32_16x16x32_bf16 v[156:159], v[76:79], v[20:23], v[156:159]
    v_mfma_f32_16x16x32_bf16 v[156:159], v[80:83], v[24:27], v[156:159]
    v_mfma_f32_16x16x32_bf16 v[156:159], v[84:87], v[28:31], v[156:159]
    v_mfma_f32_16x16x32_bf16 v[156:159], v[88:91], v[32:35], v[156:159]
    v_mfma_f32_16x16x32_bf16 v[156:159], v[92:95], v[36:39], v[156:159]
    v_mfma_f32_16x16x32_bf16 v[156:159], v[96:99], v[40:43], v[156:159]
    v_mfma_f32_16x16x32_bf16 v[156:159], v[100:103], v[44:47], v[156:159]
    v_mfma_f32_16x16x32_bf16 v[156:159], v[104:107], v[48:51], v[156:159]
    v_mfma_f32_16x16x32_bf16 v[156:159], v[108:111], v[52:55], v[156:159]
    v_mfma_f32_16x16x32_bf16 v[156:159], v[112:115], v[56:59], v[156:159]
    v_mfma_f32_16x16x32_bf16 v[156:159], v[116:119], v[60:63], v[156:159]
    v_mfma_f32_16x16x32_bf16 v[156:159], v[120:123], v[64:67], v[156:159]
    v_mfma_f32_16x16x32_bf16 v[156:159], v[124:127], v[68:71], v[156:159]
    s_nop 7
    buffer_store_dwordx4 v[156:159], v168, s[20:23], s35 offen sc1
    v_mov_b32 v6, 162840
    v_mov_b32 v7, 1
    s_mov_b64 exec, 1
    ds_add_u32 v6, v7
    s_mov_b64 exec, -1
    s_setprio 0
    s_call_b64 s[76:77], SUB_w1_regs
    s_call_b64 s[76:77], SUB_park
    v_mov_b32 v6, 162840
spin_14:
    s_sleep 3
    ds_read_b32 v7, v6
    s_waitcnt lgkmcnt(0)
    v_readfirstlane_b32 s53, v7
    s_nop 0
    s_cmp_ge_u32 s53, 4
    s_cbranch_scc0 spin_14
    s_mov_b64 s[12:13], s[68:69]
    s_mov_b32 s14, 2097152
    s_mov_b32 s15, 0x20000
    s_and_b32 s35, s30, 1
    s_mul_i32 s38, s99, 128
    s_mul_i32 s41, s35, 65536
    s_add_u32 s38, s38, s41
    s_mul_i32 s41, s35, 4096
    s_add_u32 s41, s41, 24576
    s_mov_b32 s42, 0
    s_mov_b32 s44, s67
    s_mov_b32 s42, 98304
    s_mov_b32 s44, s67
    s_add_u32 s44, s44, 12
    s_and_b32 s44, s44, 15
    s_call_b64 s[76:77], SUB_w_issue_1
    s_waitcnt vmcnt(8)
    s_mov_b32 s42, 106496
    s_mov_b32 s44, s67
    s_add_u32 s44, s44, 13
    s_and_b32 s44, s44, 15
    s_call_b64 s[76:77], SUB_w_issue_1
    s_waitcnt vmcnt(8)
    s_mov_b32 s42, 114688
    s_mov_b32 s44, s67
    s_add_u32 s44, s44, 14
    s_and_b32 s44, s44, 15
    s_call_b64 s[76:77], SUB_w_issue_1
    s_waitcnt vmcnt(8)
    s_mov_b32 s42, 122880
    s_mov_b32 s44, s67
    s_add_u32 s44, s44, 15
    s_and_b32 s44, s44, 15
    s_call_b64 s[76:77], SUB_w_issue_1
    s_waitcnt vmcnt(8)
    s_and_b32 s36, s29, 6
    s_cmp_eq_u32 s36, 2
    s_cbranch_scc1 pr_15
    s_call_b64 s[76:77], SUB_park2
pr_15:
    s_call_b64 s[76:77], SUB_w1_put
FR_end:
LAYER:
    v_lshlrev_b32 v40, 6, v199
    v_add_u32 v40, 161792, v40
    s_lshl_b32 s35, s30, 3
    v_add_u32 v39, s35, v40
    s_cmp_eq_u32 s60, 0
    s_cbranch_scc1 R_l0
    s_sub_u32 s8, s62, 0x400000
    s_subb_u32 s9, s63, 0
    s_mov_b32 s10, 0x7e000
    s_mov_b32 s11, 0x20000
    s_sub_u32 s12, s62, 0x380000
    s_subb_u32 s13, s63, 0
    s_mov_b32 s14, 0x7e000
    s_mov_b32 s15, 0x20000
    s_mov_b32 s20, s62
    s_mov_b32 s21, s63
    s_mov_b32 s22, 0x7e000
    s_mov_b32 s23, 0x20000
    s_mov_b32 s78, 0x3f80
    s_mov_b32 s79, 0x3f800000
    v_lshlrev_b32 v222, 16, v230
    v_and_b32 v223, 0xffff0000, v230
    v_lshlrev_b32 v206, 16, v180
    v_and_b32 v207, 0xffff0000, v180
    v_lshlrev_b32 v12, 16, v188
    v_and_b32 v13, 0xffff0000, v188
    v_pk_add_f32 v[206:207], v[206:207], v[12:13]
    v_lshlrev_b32 v224, 16, v231
    v_and_b32 v225, 0xffff0000, v231
    v_lshlrev_b32 v208, 16, v181
    v_and_b32 v209, 0xffff0000, v181
    v_lshlrev_b32 v14, 16, v189
    v_and_b32 v15, 0xffff0000, v189
    v_pk_add_f32 v[208:209], v[208:209], v[14:15]
    v_lshlrev_b32 v226, 16, v232
    v_and_b32 v227, 0xffff0000, v232
    v_lshlrev_b32 v210, 16, v182
    v_and_b32 v211, 0xffff0000, v182
    v_lshlrev_b32 v16, 16, v190
    v_and_b32 v17, 0xffff0000, v190
    v_pk_add_f32 v[210:211], v[210:211], v[16:17]
    v_lshlrev_b32 v228, 16, v233
    v_and_b32 v229, 0xffff0000, v233
    v_lshlrev_b32 v212, 16, v183
    v_and_b32 v213, 0xffff0000, v183
    v_lshlrev_b32 v18, 16, v191
    v_and_b32 v19, 0xffff0000, v191
    v_pk_add_f32 v[212:213], v[212:213], v[18:19]
    v_lshlrev_b32 v230, 16, v234
    v_and_b32 v231, 0xffff0000, v234
    v_lshlrev_b32 v214, 16, v184
    v_and_b32 v215, 0xffff0000, v184
    v_lshlrev_b32 v20, 16, v192
    v_and_b32 v21, 0xffff0000, v192
    v_pk_add_f32 v[214:215], v[214:215], v[20:21]
    v_lshlrev_b32 v232, 16, v235
    v_and_b32 v233, 0xffff0000, v235
    v_lshlrev_b32 v216, 16, v185
    v_and_b32 v217, 0xffff0000, v185
    v_lshlrev_b32 v22, 16, v193
    v_and_b32 v23, 0xffff0000, v193
    v_pk_add_f32 v[216:217], v[216:217], v[22:23]
    v_lshlrev_b32 v234, 16, v236
    v_and_b32 v235, 0xffff0000, v236
    v_lshlrev_b32 v218, 16, v186
    v_and_b32 v219, 0xffff0000, v186
    v_lshlrev_b32 v24, 16, v194
    v_and_b32 v25, 0xffff0000, v194
    v_pk_add_f32 v[218:219], v[218:219], v[24:25]
    v_lshlrev_b32 v236, 16, v237
    v_and_b32 v237, 0xffff0000, v237
    v_lshlrev_b32 v220, 16, v187
    v_and_b32 v221, 0xffff0000, v187
    v_lshlrev_b32 v26, 16, v195
    v_and_b32 v27, 0xffff0000, v195
    v_pk_add_f32 v[220:221], v[220:221], v[26:27]
    s_mov_b32 s53, 0
    s_sleep 10
    s_cmp_ge_u32 s30, 6
    s_cbranch_scc1 dp_16
    s_sleep 14
dp_16:
    buffer_load_dwordx4 v[180:183], v196, s[8:11], 0 offen offset:0 sc1
    buffer_load_dwordx4 v[188:191], v196, s[12:15], 0 offen offset:0 sc1
    buffer_load_dwordx4 v[184:187], v196, s[8:11], 0 offen offset:2048 sc1
    buffer_load_dwordx4 v[192:195], v196, s[12:15], 0 offen offset:2048 sc1
    s_waitcnt vmcnt(0)
    v_bitop3_b32 v6, v180, v184, v188 bitop3:0x80
    v_bitop3_b32 v6, v6, v192, 1 bitop3:0x80
    v_cmp_eq_u32 vcc, 0, v6
    s_cbranch_vccz dq_17
    s_sleep 4
    s_add_u32 s53, s53, 1
    s_cmp_lt_u32 s53, s61
    s_cbranch_scc1 dp_16
    s_mov_b32 s61, 0
dq_17:
    v_dot2_f32_bf16 v206, v180, s78, v206
    v_dot2_f32_bf16 v207, v180, s79, v207
    v_dot2_f32_bf16 v208, v181, s78, v208
    v_dot2_f32_bf16 v209, v181, s79, v209
    v_dot2_f32_bf16 v210, v182, s78, v210
    v_dot2_f32_bf16 v211, v182, s79, v211
    v_dot2_f32_bf16 v212, v183, s78, v212
    v_dot2_f32_bf16 v213, v183, s79, v213
    v_dot2_f32_bf16 v214, v184, s78, v214
    v_dot2_f32_bf16 v215, v184, s79, v215
    v_dot2_f32_bf16 v216, v185, s78, v216
    v_dot2_f32_bf16 v217, v185, s79, v217
    v_dot2_f32_bf16 v218, v186, s78, v218
    v_dot2_f32_bf16 v219, v186, s79, v219
    v_dot2_f32_bf16 v220, v187, s78, v220
    v_dot2_f32_bf16 v221, v187, s79, v221
    v_dot2_f32_bf16 v206, v188, s78, v206
    v_dot2_f32_bf16 v207, v188, s79, v207
    v_dot2_f32_bf16 v208, v189, s78, v208
    v_dot2_f32_bf16 v209, v189, s79, v209
    v_dot2_f32_bf16 v210, v190, s78, v210
    v_dot2_f32_bf16 v211, v190, s79, v211
    v_dot2_f32_bf16 v212, v191, s78, v212
    v_dot2_f32_bf16 v213, v191, s79, v213
    v_dot2_f32_bf16 v214, v192, s78, v214
    v_dot2_f32_bf16 v215, v192, s79, v215
    v_dot2_f32_bf16 v216, v193, s78, v216
    v_dot2_f32_bf16 v217, v193, s79, v217
    v_dot2_f32_bf16 v218, v194, s78, v218
    v_dot2_f32_bf16 v219, v194, s79, v219
    v_dot2_f32_bf16 v220, v195, s78, v220
    v_dot2_f32_bf16 v221, v195, s79, v221
    s_nop 2
    v_pk_add_f32 v[32:33], v[206:207], v[208:209]
    v_pk_mul_f32 v[34:35], v[206:207], v[206:207]
    v_pk_fma_f32 v[34:35], v[208:209], v[208:209], v[34:35]
    v_pk_add_f32 v[32:33], v[32:33], v[210:211]
    v_pk_fma_f32 v[34:35], v[210:211], v[210:211], v[34:35]
    v_pk_add_f32 v[32:33], v[32:33], v[212:213]
    v_pk_fma_f32 v[34:35], v[212:213], v[212:213], v[34:35]
    v_pk_add_f32 v[32:33], v[32:33], v[214:215]
    v_pk_fma_f32 v[34:35], v[214:215], v[214:215], v[34:35]
    v_pk_add_f32 v[32:33], v[32:33], v[216:217]
    v_pk_fma_f32 v[34:35], v[216:217], v[216:217], v[34:35]
    v_pk_add_f32 v[32:33], v[32:33], v[218:219]
    v_pk_fma_f32 v[34:35], v[218:219], v[218:219], v[34:35]
    v_pk_add_f32 v[32:33], v[32:33], v[220:221]
    v_pk_fma_f32 v[34:35], v[220:221], v[220:221], v[34:35]
    v_add_f32 v30, v32, v33
    v_add_f32 v31, v34, v35
    s_nop 0
    v_add_f32_dpp v30, v30, v30 row_ror:8 row_mask:0xf bank_mask:0xf
    v_add_f32_dpp v31, v31, v31 row_ror:8 row_mask:0xf bank_mask:0xf
    v_mov_b32 v32, v30
    v_mov_b32 v33, v31
    s_nop 0
    v_permlane16_swap_b32 v30, v32
    v_permlane16_swap_b32 v31, v33
    v_pk_add_f32 v[30:31], v[30:31], v[32:33]
    v_mov_b32 v32, v30
    v_mov_b32 v33, v31
    s_nop 0
    v_permlane32_swap_b32 v30, v32
    v_permlane32_swap_b32 v31, v33
    v_pk_add_f32 v[30:31], v[30:31], v[32:33]
    ds_write_b64 v39, v[30:31] offset:0
    s_waitcnt lgkmcnt(0)
    s_barrier
    ds_read_b128 v[12:15], v40 offset:0
    ds_read_b128 v[16:19], v40 offset:16
    ds_read_b128 v[20:23], v40 offset:32
    ds_read_b128 v[24:27], v40 offset:48
    s_waitcnt lgkmcnt(0)
    v_pk_add_f32 v[12:13], v[12:13], v[14:15]
    v_pk_add_f32 v[16:17], v[16:17], v[18:19]
    v_pk_add_f32 v[20:21], v[20:21], v[22:23]
    v_pk_add_f32 v[24:25], v[24:25], v[26:27]
    v_pk_add_f32 v[12:13], v[12:13], v[16:17]
    v_pk_add_f32 v[20:21], v[20:21], v[24:25]
    v_pk_add_f32 v[12:13], v[12:13], v[20:21]
    v_mul_f32 v36, 0x3a800000, v12
    v_mul_f32 v38, 0x3a800000, v13
    v_fma_f32 v38, -v36, v36, v38
    v_max_f32 v38, 0, v38
    v_add_f32 v38, 0x3727c5ac, v38
    v_rsq_f32 v37, v38
    s_nop 0
    v_mul_f32 v36, v36, v37
    v_pk_fma_f32 v[12:13], v[206:207], v[36:37], v[36:37] op_sel:[0,1,0] op_sel_hi:[1,1,0] neg_lo:[0,0,1] neg_hi:[0,0,1]
    v_pk_fma_f32 v[14:15], v[208:209], v[36:37], v[36:37] op_sel:[0,1,0] op_sel_hi:[1,1,0] neg_lo:[0,0,1] neg_hi:[0,0,1]
    v_pk_fma_f32 v[16:17], v[210:211], v[36:37], v[36:37] op_sel:[0,1,0] op_sel_hi:[1,1,0] neg_lo:[0,0,1] neg_hi:[0,0,1]
    v_pk_fma_f32 v[18:19], v[212:213], v[36:37], v[36:37] op_sel:[0,1,0] op_sel_hi:[1,1,0] neg_lo:[0,0,1] neg_hi:[0,0,1]
    v_pk_fma_f32 v[20:21], v[214:215], v[36:37], v[36:37] op_sel:[0,1,0] op_sel_hi:[1,1,0] neg_lo:[0,0,1] neg_hi:[0,0,1]
    v_pk_fma_f32 v[22:23], v[216:217], v[36:37], v[36:37] op_sel:[0,1,0] op_sel_hi:[1,1,0] neg_lo:[0,0,1] neg_hi:[0,0,1]
    v_pk_fma_f32 v[24:25], v[218:219], v[36:37], v[36:37] op_sel:[0,1,0] op_sel_hi:[1,1,0] neg_lo:[0,0,1] neg_hi:[0,0,1]
    v_pk_fma_f32 v[26:27], v[220:221], v[36:37], v[36:37] op_sel:[0,1,0] op_sel_hi:[1,1,0] neg_lo:[0,0,1] neg_hi:[0,0,1]
    v_pk_fma_f32 v[206:207], v[12:13], v[222:223], v[206:207]
    v_cvt_pk_bf16_f32 v180, v206, v207
    v_pk_fma_f32 v[208:209], v[14:15], v[224:225], v[208:209]
    v_cvt_pk_bf16_f32 v181, v208, v209
    v_and_b32 v180, -2, v180
    v_pk_fma_f32 v[210:211], v[16:17], v[226:227], v[210:211]
    v_cvt_pk_bf16_f32 v182, v210, v211
    v_pk_fma_f32 v[212:213], v[18:19], v[228:229], v[212:213]
    v_cvt_pk_bf16_f32 v183, v212, v213
    buffer_store_dwordx4 v[180:183], v196, s[20:23], 0 offen offset:0 sc1
    v_pk_fma_f32 v[214:215], v[20:21], v[230:231], v[214:215]
    v_cvt_pk_bf16_f32 v184, v214, v215
    v_pk_fma_f32 v[216:217], v[22:23], v[232:233], v[216:217]
    v_cvt_pk_bf16_f32 v185, v216, v217
    v_and_b32 v184, -2, v184
    v_pk_fma_f32 v[218:219], v[24:25], v[234:235], v[218:219]
    v_cvt_pk_bf16_f32 v186, v218, v219
    v_pk_fma_f32 v[220:221], v[26:27], v[236:237], v[220:221]
    v_cvt_pk_bf16_f32 v187, v220, v221
    buffer_store_dwordx4 v[184:187], v196, s[20:23], 0 offen offset:2048 sc1
    s_branch R_s2
R_l0:
    v_lshlrev_b32 v206, 16, v180
    v_and_b32 v207, 0xffff0000, v180
    v_lshlrev_b32 v208, 16, v181
    v_and_b32 v209, 0xffff0000, v181
    v_lshlrev_b32 v210, 16, v182
    v_and_b32 v211, 0xffff0000, v182
    v_lshlrev_b32 v212, 16, v183
    v_and_b32 v213, 0xffff0000, v183
    v_lshlrev_b32 v214, 16, v184
    v_and_b32 v215, 0xffff0000, v184
    v_lshlrev_b32 v216, 16, v185
    v_and_b32 v217, 0xffff0000, v185
    v_lshlrev_b32 v218, 16, v186
    v_and_b32 v219, 0xffff0000, v186
    v_lshlrev_b32 v220, 16, v187
    v_and_b32 v221, 0xffff0000, v187
    v_pk_add_f32 v[32:33], v[206:207], v[208:209]
    v_pk_mul_f32 v[34:35], v[206:207], v[206:207]
    v_pk_fma_f32 v[34:35], v[208:209], v[208:209], v[34:35]
    v_pk_add_f32 v[32:33], v[32:33], v[210:211]
    v_pk_fma_f32 v[34:35], v[210:211], v[210:211], v[34:35]
    v_pk_add_f32 v[32:33], v[32:33], v[212:213]
    v_pk_fma_f32 v[34:35], v[212:213], v[212:213], v[34:35]
    v_pk_add_f32 v[32:33], v[32:33], v[214:215]
    v_pk_fma_f32 v[34:35], v[214:215], v[214:215], v[34:35]
    v_pk_add_f32 v[32:33], v[32:33], v[216:217]
    v_pk_fma_f32 v[34:35], v[216:217], v[216:217], v[34:35]
    v_pk_add_f32 v[32:33], v[32:33], v[218:219]
    v_pk_fma_f32 v[34:35], v[218:219], v[218:219], v[34:35]
    v_pk_add_f32 v[32:33], v[32:33], v[220:221]
    v_pk_fma_f32 v[34:35], v[220:221], v[220:221], v[34:35]
    v_add_f32 v30, v32, v33
    v_add_f32 v31, v34, v35
    s_nop 0
    v_add_f32_dpp v30, v30, v30 row_ror:8 row_mask:0xf bank_mask:0xf
    v_add_f32_dpp v31, v31, v31 row_ror:8 row_mask:0xf bank_mask:0xf
    v_mov_b32 v32, v30
    v_mov_b32 v33, v31
    s_nop 0
    v_permlane16_swap_b32 v30, v32
    v_permlane16_swap_b32 v31, v33
    v_pk_add_f32 v[30:31], v[30:31], v[32:33]
    v_mov_b32 v32, v30
    v_mov_b32 v33, v31
    s_nop 0
    v_permlane32_swap_b32 v30, v32
    v_permlane32_swap_b32 v31, v33
    v_pk_add_f32 v[30:31], v[30:31], v[32:33]
    ds_write_b64 v39, v[30:31] offset:0
    s_waitcnt lgkmcnt(0)
    v_mov_b32 v222, 162844
spin_18:
    ds_read_b32 v223, v222
    s_waitcnt lgkmcnt(0)
    v_readfirstlane_b32 s94, v223
    s_nop 0
    s_cmp_ge_u32 s94, 65536
    s_cbranch_scc0 spin_18
    s_cmp_gt_u32 s94, 65546
    s_cselect_b32 s94, 1, 0
    s_lshl_b32 s53, s94, 13
    v_xor_b32 v197, s53, v197
    s_lshr_b32 s53, s28, 3
    s_lshl_b32 s53, s53, 2
    s_and_b32 s54, s28, 3
    s_add_u32 s53, s53, s54
    s_lshl_b32 s53, s53, 24
    s_lshr_b32 s54, s28, 2
    s_xor_b32 s54, s54, s94
    s_and_b32 s54, s54, 1
    s_lshl_b32 s54, s54, 13
    s_add_u32 s36, s53, s54
    s_add_u32 s36, s36, 33554432
    s_lshr_b32 s53, s53, 14
    s_add_u32 s36, s53, s54
    s_xor_b32 s36, s36, 8192
    s_add_u32 s36, s36, 23101440
    s_lshl_b32 s53, s30, 7
    s_add_u32 s36, s36, s53
    v_mov_b32 v226, s36
    s_waitcnt vmcnt(0)
    s_barrier
    s_mov_b32 s53, 0
    s_add_u32 s54, s52, 32
    s_bfm_b64 exec, 1, 0
poll_19:
    buffer_load_dword v222, v226, s[56:59], 0 offen sc1
    s_waitcnt vmcnt(0)
    v_xor_b32 v222, s54, v222
    v_cmp_eq_u32 vcc, 0, v222
    s_nop 0
    s_cmp_eq_u64 vcc, exec
    s_cbranch_scc1 pok_20
    s_sleep 6
    s_add_u32 s53, s53, 1
    s_cmp_lt_u32 s53, s61
    s_cbranch_scc1 poll_19
    s_mov_b32 s61, 0
pok_20:
    s_mov_b64 exec, -1
    s_add_u32 s80, s4, 0x2100000
    s_addc_u32 s81, s5, 0
    s_mov_b32 s82, 0x7f00000
    s_mov_b32 s83, 0x20000
    s_mov_b32 s78, 0
    buffer_load_dwordx2 v[230:231], v197, s[80:83], s78 offen sc1
    s_mov_b32 s78, 2048
    buffer_load_dwordx2 v[232:233], v197, s[80:83], s78 offen sc1
    s_mov_b32 s78, 16384
    buffer_load_dwordx2 v[234:235], v197, s[80:83], s78 offen sc1
    s_mov_b32 s78, 18432
    buffer_load_dwordx2 v[236:237], v197, s[80:83], s78 offen sc1
    s_lshr_b32 s53, s28, 3
    s_lshl_b32 s53, s53, 2
    s_and_b32 s54, s28, 3
    s_add_u32 s53, s53, s54
    s_lshl_b32 s53, s53, 24
    s_lshr_b32 s54, s28, 2
    s_xor_b32 s54, s54, s94
    s_and_b32 s54, s54, 1
    s_lshl_b32 s54, s54, 13
    s_add_u32 s55, s53, s54
    s_add_u32 s55, s55, 33554432
    s_add_u32 s62, s4, s55
    s_addc_u32 s63, s5, 0
    s_sub_u32 s36, s28, 1
    s_max_i32 s36, s36, 0
    s_lshr_b32 s53, s36, 3
    s_lshl_b32 s53, s53, 2
    s_and_b32 s54, s36, 3
    s_add_u32 s53, s53, s54
    s_lshl_b32 s53, s53, 24
    s_lshr_b32 s54, s36, 2
    s_xor_b32 s54, s54, s94
    s_and_b32 s54, s54, 1
    s_lshl_b32 s54, s54, 13
    s_add_u32 s92, s53, s54
    s_add_u32 s92, s92, 33554432
    s_sub_u32 s92, s92, s55
    s_add_u32 s36, s28, 1
    s_min_u32 s36, s36, 15
    s_lshr_b32 s53, s36, 3
    s_lshl_b32 s53, s53, 2
    s_and_b32 s54, s36, 3
    s_add_u32 s53, s53, s54
    s_lshl_b32 s53, s53, 24
    s_lshr_b32 s54, s36, 2
    s_xor_b32 s54, s54, s94
    s_and_b32 s54, s54, 1
    s_lshl_b32 s54, s54, 13
    s_add_u32 s93, s53, s54
    s_add_u32 s93, s93, 33554432
    s_sub_u32 s93, s93, s55
    s_add_u32 s55, s55, 6029312
    s_mov_b32 s20, s62
    s_mov_b32 s21, s63
    s_mov_b32 s22, 0x7e000
    s_mov_b32 s23, 0x20000
    ds_read_b128 v[12:15], v40 offset:0
    ds_read_b128 v[16:19], v40 offset:16
    ds_read_b128 v[20:23], v40 offset:32
    ds_read_b128 v[24:27], v40 offset:48
    s_waitcnt lgkmcnt(0)
    v_pk_add_f32 v[12:13], v[12:13], v[14:15]
    v_pk_add_f32 v[16:17], v[16:17], v[18:19]
    v_pk_add_f32 v[20:21], v[20:21], v[22:23]
    v_pk_add_f32 v[24:25], v[24:25], v[26:27]
    v_pk_add_f32 v[12:13], v[12:13], v[16:17]
    v_pk_add_f32 v[20:21], v[20:21], v[24:25]
    v_pk_add_f32 v[12:13], v[12:13], v[20:21]
    v_mul_f32 v36, 0x3a800000, v12
    v_mul_f32 v38, 0x3a800000, v13
    v_fma_f32 v38, -v36, v36, v38
    v_max_f32 v38, 0, v38
    v_add_f32 v38, 0x3727c5ac, v38
    v_rsq_f32 v37, v38
    s_nop 0
    v_pk_add_f32 v[12:13], v[206:207], v[36:37] op_sel_hi:[1,0] neg_lo:[0,1] neg_hi:[0,1]
    v_pk_mul_f32 v[12:13], v[12:13], v[36:37] op_sel:[0,1] op_sel_hi:[1,1]
    v_pk_add_f32 v[14:15], v[208:209], v[36:37] op_sel_hi:[1,0] neg_lo:[0,1] neg_hi:[0,1]
    v_pk_mul_f32 v[14:15], v[14:15], v[36:37] op_sel:[0,1] op_sel_hi:[1,1]
    v_pk_add_f32 v[16:17], v[210:211], v[36:37] op_sel_hi:[1,0] neg_lo:[0,1] neg_hi:[0,1]
    v_pk_mul_f32 v[16:17], v[16:17], v[36:37] op_sel:[0,1] op_sel_hi:[1,1]
    v_pk_add_f32 v[18:19], v[212:213], v[36:37] op_sel_hi:[1,0] neg_lo:[0,1] neg_hi:[0,1]
    v_pk_mul_f32 v[18:19], v[18:19], v[36:37] op_sel:[0,1] op_sel_hi:[1,1]
    v_pk_add_f32 v[20:21], v[214:215], v[36:37] op_sel_hi:[1,0] neg_lo:[0,1] neg_hi:[0,1]
    v_pk_mul_f32 v[20:21], v[20:21], v[36:37] op_sel:[0,1] op_sel_hi:[1,1]
    v_pk_add_f32 v[22:23], v[216:217], v[36:37] op_sel_hi:[1,0] neg_lo:[0,1] neg_hi:[0,1]
    v_pk_mul_f32 v[22:23], v[22:23], v[36:37] op_sel:[0,1] op_sel_hi:[1,1]
    v_pk_add_f32 v[24:25], v[218:219], v[36:37] op_sel_hi:[1,0] neg_lo:[0,1] neg_hi:[0,1]
    v_pk_mul_f32 v[24:25], v[24:25], v[36:37] op_sel:[0,1] op_sel_hi:[1,1]
    v_pk_add_f32 v[26:27], v[220:221], v[36:37] op_sel_hi:[1,0] neg_lo:[0,1] neg_hi:[0,1]
    v_pk_mul_f32 v[26:27], v[26:27], v[36:37] op_sel:[0,1] op_sel_hi:[1,1]
    s_barrier
    s_waitcnt vmcnt(0)
    v_lshlrev_b32 v222, 16, v230
    v_and_b32 v223, 0xffff0000, v230
    v_pk_fma_f32 v[206:207], v[12:13], v[222:223], v[206:207]
    v_cvt_pk_bf16_f32 v180, v206, v207
    v_lshlrev_b32 v222, 16, v231
    v_and_b32 v223, 0xffff0000, v231
    v_pk_fma_f32 v[208:209], v[14:15], v[222:223], v[208:209]
    v_cvt_pk_bf16_f32 v181, v208, v209
    v_and_b32 v180, -2, v180
    v_lshlrev_b32 v222, 16, v232
    v_and_b32 v223, 0xffff0000, v232
    v_pk_fma_f32 v[210:211], v[16:17], v[222:223], v[210:211]
    v_cvt_pk_bf16_f32 v182, v210, v211
    v_lshlrev_b32 v222, 16, v233
    v_and_b32 v223, 0xffff0000, v233
    v_pk_fma_f32 v[212:213], v[18:19], v[222:223], v[212:213]
    v_cvt_pk_bf16_f32 v183, v212, v213
    buffer_store_dwordx4 v[180:183], v196, s[20:23], 0 offen offset:0 sc1
    v_lshlrev_b32 v222, 16, v234
    v_and_b32 v223, 0xffff0000, v234
    v_pk_fma_f32 v[214:215], v[20:21], v[222:223], v[214:215]
    v_cvt_pk_bf16_f32 v184, v214, v215
    v_lshlrev_b32 v222, 16, v235
    v_and_b32 v223, 0xffff0000, v235
    v_pk_fma_f32 v[216:217], v[22:23], v[222:223], v[216:217]
    v_cvt_pk_bf16_f32 v185, v216, v217
    v_and_b32 v184, -2, v184
    v_lshlrev_b32 v222, 16, v236
    v_and_b32 v223, 0xffff0000, v236
    v_pk_fma_f32 v[218:219], v[24:25], v[222:223], v[218:219]
    v_cvt_pk_bf16_f32 v186, v218, v219
    v_lshlrev_b32 v222, 16, v237
    v_and_b32 v223, 0xffff0000, v237
    v_pk_fma_f32 v[220:221], v[26:27], v[222:223], v[220:221]
    v_cvt_pk_bf16_f32 v187, v220, v221
    buffer_store_dwordx4 v[184:187], v196, s[20:23], 0 offen offset:2048 sc1
R_s2:
    v_lshlrev_b32 v206, 16, v180
    v_and_b32 v207, 0xffff0000, v180
    v_lshlrev_b32 v208, 16, v181
    v_and_b32 v209, 0xffff0000, v181
    v_lshlrev_b32 v210, 16, v182
    v_and_b32 v211, 0xffff0000, v182
    v_lshlrev_b32 v212, 16, v183
    v_and_b32 v213, 0xffff0000, v183
    v_lshlrev_b32 v214, 16, v184
    v_and_b32 v215, 0xffff0000, v184
    v_lshlrev_b32 v216, 16, v185
    v_and_b32 v217, 0xffff0000, v185
    v_lshlrev_b32 v218, 16, v186
    v_and_b32 v219, 0xffff0000, v186
    v_lshlrev_b32 v220, 16, v187
    v_and_b32 v221, 0xffff0000, v187
    v_pk_add_f32 v[32:33], v[206:207], v[208:209]
    v_pk_mul_f32 v[34:35], v[206:207], v[206:207]
    v_pk_fma_f32 v[34:35], v[208:209], v[208:209], v[34:35]
    v_pk_add_f32 v[32:33], v[32:33], v[210:211]
    v_pk_fma_f32 v[34:35], v[210:211], v[210:211], v[34:35]
    v_pk_add_f32 v[32:33], v[32:33], v[212:213]
    v_pk_fma_f32 v[34:35], v[212:213], v[212:213], v[34:35]
    v_pk_add_f32 v[32:33], v[32:33], v[214:215]
    v_pk_fma_f32 v[34:35], v[214:215], v[214:215], v[34:35]
    v_pk_add_f32 v[32:33], v[32:33], v[216:217]
    v_pk_fma_f32 v[34:35], v[216:217], v[216:217], v[34:35]
    v_pk_add_f32 v[32:33], v[32:33], v[218:219]
    v_pk_fma_f32 v[34:35], v[218:219], v[218:219], v[34:35]
    v_pk_add_f32 v[32:33], v[32:33], v[220:221]
    v_pk_fma_f32 v[34:35], v[220:221], v[220:221], v[34:35]
    v_add_f32 v30, v32, v33
    v_add_f32 v31, v34, v35
    s_nop 0
    v_add_f32_dpp v30, v30, v30 row_ror:8 row_mask:0xf bank_mask:0xf
    v_add_f32_dpp v31, v31, v31 row_ror:8 row_mask:0xf bank_mask:0xf
    v_mov_b32 v32, v30
    v_mov_b32 v33, v31
    s_nop 0
    v_permlane16_swap_b32 v30, v32
    v_permlane16_swap_b32 v31, v33
    v_pk_add_f32 v[30:31], v[30:31], v[32:33]
    v_mov_b32 v32, v30
    v_mov_b32 v33, v31
    s_nop 0
    v_permlane32_swap_b32 v30, v32
    v_permlane32_swap_b32 v31, v33
    v_pk_add_f32 v[30:31], v[30:31], v[32:33]
    ds_write_b64 v39, v[30:31] offset:512
    s_waitcnt lgkmcnt(0)
    s_barrier
    s_cmp_lg_u32 s30, 6
    s_cbranch_scc1 R_n6
    s_cmp_lg_u32 s60, 0
    s_cbranch_scc1 R_n6
    s_lshl_b32 s53, s29, 7
    s_add_u32 s53, s53, 23121920
    v_mov_b32 v8, 1
    v_mov_b32 v9, 0
    s_mov_b64 exec, 1
    buffer_atomic_add v8, v9, s[56:59], s53 offen sc1
    s_mov_b64 exec, -1
R_n6:
    s_cmp_lg_u32 s30, 7
    s_cbranch_scc1 R_nl
    ds_read_b128 v[12:15], v40 offset:512
    ds_read_b128 v[16:19], v40 offset:528
    ds_read_b128 v[20:23], v40 offset:544
    ds_read_b128 v[24:27], v40 offset:560
    s_waitcnt lgkmcnt(0)
    v_pk_add_f32 v[12:13], v[12:13], v[14:15]
    v_pk_add_f32 v[16:17], v[16:17], v[18:19]
    v_pk_add_f32 v[20:21], v[20:21], v[22:23]
    v_pk_add_f32 v[24:25], v[24:25], v[26:27]
    v_pk_add_f32 v[12:13], v[12:13], v[16:17]
    v_pk_add_f32 v[20:21], v[20:21], v[24:25]
    v_pk_add_f32 v[12:13], v[12:13], v[20:21]
    v_mul_f32 v36, 0x3a800000, v12
    v_mul_f32 v38, 0x3a800000, v13
    v_fma_f32 v38, -v36, v36, v38
    v_max_f32 v38, 0, v38
    v_mov_b32 v42, v36
    v_mov_b32 v43, v38
    v_add_f32 v38, 0x3727c5ac, v38
    v_sqrt_f32 v38, v38
    s_nop 0
    v_mov_b32 v41, v38
    v_rcp_f32 v37, v38
    v_sub_f32 v42, v42, v36
    v_mul_f32 v42, v42, v37
    v_mul_f32 v43, v43, v37
    v_mul_f32 v43, v43, v37
    v_add_f32 v43, 0x3727c5ac, v43
    v_rsq_f32 v44, v43
    v_mov_b32 v224, v36
    v_mov_b32 v225, v37
    v_fma_f32 v226, v42, v41, v36
    v_mul_f32 v227, v37, v44
    s_add_u32 s24, s62, 0x5d0000
    s_addc_u32 s25, s63, 0
    s_mov_b32 s26, 0x800
    s_mov_b32 s27, 0x20000
    s_lshl_b32 s36, s29, 3
    v_add_u32 v6, s36, v199
    v_lshlrev_b32 v6, 4, v6
    s_mov_b64 exec, 0xff
    buffer_store_dwordx4 v[224:227], v6, s[24:27], 0 offen sc1
    s_mov_b64 exec, -1
    s_add_u32 s53, s55, 1280
    v_mov_b32 v8, 1
    v_mov_b32 v9, 162816
    v_mov_b32 v11, 0
    s_mov_b64 exec, 1
    s_waitcnt vmcnt(0)
    buffer_atomic_add v8, v11, s[56:59], s53 offen sc1
pub_21:
    s_mov_b64 exec, -1
R_nl:
    s_cmp_ge_u32 s30, 4
    s_cbranch_scc1 LOADERS
    s_mov_b32 s8, s62
    s_mov_b32 s9, s63
    s_mov_b32 s10, 0x7e000
    s_mov_b32 s11, 0x20000
    v_add_u32 v126, 0, v2
    v_add_u32 v127, 65536, v2
    s_lshl_b32 s44, s30, 17
    s_mov_b32 s34, s30
    s_mov_b32 s35, 0
    v_and_b32 v22, 15, v1
    v_lshrrev_b32 v23, 4, v1
    s_mul_i32 s37, s34, 2
    s_mul_i32 s38, s99, 4
    s_mul_i32 s36, s35, 4
    s_add_u32 s38, s38, s36
    v_add_u32 v128, 4096, v2
    v_add_u32 v129, 69632, v2
    s_add_u32 s45, s44, 16384
    s_add_u32 s46, s44, 32768
    s_add_u32 s47, s44, 49152
    v_lshrrev_b32 v6, 2, v1
    v_mul_u32_u24 v13, 128, v6
    v_and_b32 v7, 3, v1
    v_lshl_add_u32 v13, v7, 3, v13
    v_add_u32 v13, 24576, v13
    v_bfe_u32 v6, v6, 1, 2
    s_mul_i32 s36, s35, 4
    s_add_u32 s36, s36, 3
    v_xor_b32 v7, s36, v6
    v_lshl_add_u32 v16, v7, 5, v13
    s_mul_i32 s36, s35, 4
    s_add_u32 s36, s36, 2
    v_xor_b32 v7, s36, v6
    v_lshl_add_u32 v15, v7, 5, v13
    s_mul_i32 s36, s35, 4
    s_add_u32 s36, s36, 1
    v_xor_b32 v7, s36, v6
    v_lshl_add_u32 v14, v7, 5, v13
    s_mul_i32 s36, s35, 4
    s_add_u32 s36, s36, 0
    v_xor_b32 v7, s36, v6
    v_lshl_add_u32 v13, v7, 5, v13
    v_pk_mov_b32 v[24:25], 0, 0
    v_pk_mov_b32 v[26:27], 0, 0
    v_pk_mov_b32 v[28:29], 0, 0
    v_pk_mov_b32 v[30:31], 0, 0
    v_pk_mov_b32 v[32:33], 0, 0
    v_pk_mov_b32 v[34:35], 0, 0
    v_pk_mov_b32 v[36:37], 0, 0
    v_pk_mov_b32 v[38:39], 0, 0
    v_pk_mov_b32 v[40:41], 0, 0
    v_pk_mov_b32 v[42:43], 0, 0
    v_pk_mov_b32 v[44:45], 0, 0
    v_pk_mov_b32 v[46:47], 0, 0
    v_pk_mov_b32 v[48:49], 0, 0
    v_pk_mov_b32 v[50:51], 0, 0
    v_pk_mov_b32 v[52:53], 0, 0
    v_pk_mov_b32 v[54:55], 0, 0
    s_mov_b32 s43, 0
    s_mul_i32 s36, s35, 256
    s_add_u32 s36, s36, 163328
    v_lshlrev_b32 v6, 4, v23
    v_add_u32 v6, s36, v6
    s_lshl_b32 s36, s37, 8
    s_add_u32 s36, s36, 160776
    v_lshlrev_b32 v7, 4, v22
    v_add_u32 v7, s36, v7
    s_add_u32 s16, s62, 0x100000
    s_addc_u32 s17, s63, 0
    s_mov_b32 s18, 0x7e000
    s_mov_b32 s19, 0x20000
    v_lshlrev_b32 v12, 11, v23
    v_lshl_add_u32 v12, v22, 4, v12
    s_lshl_b32 s39, s38, 13
    s_lshl_b32 s36, s37, 8
    s_add_u32 s39, s39, s36
    s_add_u32 s40, s39, 16384
    s_lshl_b32 s36, s29, 1
    s_lshr_b32 s53, s36, 3
    s_lshl_b32 s53, s53, 14
    s_and_b32 s41, s36, 7
    s_lshl_b32 s41, s41, 10
    s_add_u32 s41, s41, s53
    s_lshl_b32 s36, s37, 16
    s_add_u32 s41, s41, s36
    s_mov_b32 s53, 0
    s_mov_b32 s49, s44
    ds_read_b64_tr_b16 v[56:57], v13 offset:0
    ds_read_b64_tr_b16 v[58:59], v13 offset:2048
    ds_read_b64_tr_b16 v[60:61], v14 offset:0
    ds_read_b64_tr_b16 v[62:63], v14 offset:2048
    ds_read_b64_tr_b16 v[64:65], v15 offset:0
    ds_read_b64_tr_b16 v[66:67], v15 offset:2048
    ds_read_b64_tr_b16 v[68:69], v16 offset:0
    ds_read_b64_tr_b16 v[70:71], v16 offset:2048
    ds_read_b64_tr_b16 v[72:73], v13 offset:4096
    ds_read_b64_tr_b16 v[74:75], v13 offset:6144
    ds_read_b64_tr_b16 v[76:77], v14 offset:4096
    ds_read_b64_tr_b16 v[78:79], v14 offset:6144
    ds_read_b64_tr_b16 v[80:81], v15 offset:4096
    ds_read_b64_tr_b16 v[82:83], v15 offset:6144
    ds_read_b64_tr_b16 v[84:85], v16 offset:4096
    ds_read_b64_tr_b16 v[86:87], v16 offset:6144
dm_22p:
    buffer_load_dwordx4 v[164:167], v126, s[8:11], s44 offen offset:0 sc1
    buffer_load_dwordx4 v[168:171], v127, s[8:11], s44 offen offset:0 sc1
    buffer_load_dwordx4 v[172:175], v126, s[8:11], s44 offen offset:1024 sc1
    buffer_load_dwordx4 v[176:179], v127, s[8:11], s44 offen offset:1024 sc1
dm_22w:
    s_waitcnt vmcnt(0)
    v_or3_b32 v17, v164, v168, v172
    v_bitop3_b32 v17, v17, v176, 1 bitop3:0xa8
    v_cmp_ne_u32 vcc, 0, v17
    s_cbranch_vccz dm_22q
    s_sleep 2
    s_add_u32 s53, s53, 1
    s_cmp_lt_u32 s53, s61
    s_cbranch_scc1 dm_22p
    s_mov_b32 s61, 0
dm_22q:
    buffer_load_dwordx4 v[180:183], v126, s[8:11], s44 offen offset:2048 sc1
    buffer_load_dwordx4 v[184:187], v127, s[8:11], s44 offen offset:2048 sc1
    buffer_load_dwordx4 v[188:191], v126, s[8:11], s44 offen offset:3072 sc1
    buffer_load_dwordx4 v[192:195], v127, s[8:11], s44 offen offset:3072 sc1
    buffer_load_dwordx4 v[196:199], v128, s[8:11], s44 offen offset:0 sc1
    buffer_load_dwordx4 v[200:203], v129, s[8:11], s44 offen offset:0 sc1
    buffer_load_dwordx4 v[204:207], v128, s[8:11], s44 offen offset:1024 sc1
    buffer_load_dwordx4 v[208:211], v129, s[8:11], s44 offen offset:1024 sc1
    buffer_load_dwordx4 v[212:215], v128, s[8:11], s44 offen offset:2048 sc1
    buffer_load_dwordx4 v[216:219], v129, s[8:11], s44 offen offset:2048 sc1
    s_waitcnt lgkmcnt(0)
dm_22:
    v_mfma_f32_16x16x32_bf16 v[24:27], v[56:59], v[164:167], v[24:27]
    ds_read_b64_tr_b16 v[88:89], v13 offset:8192
    buffer_load_dwordx4 v[220:223], v128, s[8:11], s44 offen offset:3072 sc1
    v_mfma_f32_16x16x32_bf16 v[40:43], v[56:59], v[168:171], v[40:43]
    ds_read_b64_tr_b16 v[90:91], v13 offset:10240
    buffer_load_dwordx4 v[224:227], v129, s[8:11], s44 offen offset:3072 sc1
    v_mfma_f32_16x16x32_bf16 v[44:47], v[60:63], v[168:171], v[44:47]
    ds_read_b64_tr_b16 v[92:93], v14 offset:8192
    s_mov_b32 s44, s45
    v_mfma_f32_16x16x32_bf16 v[28:31], v[60:63], v[164:167], v[28:31]
    ds_read_b64_tr_b16 v[94:95], v14 offset:10240
    s_mov_b32 s45, s46
    v_mfma_f32_16x16x32_bf16 v[32:35], v[64:67], v[164:167], v[32:35]
    ds_read_b64_tr_b16 v[96:97], v15 offset:8192
    s_mov_b32 s46, s47
    v_mfma_f32_16x16x32_bf16 v[48:51], v[64:67], v[168:171], v[48:51]
    ds_read_b64_tr_b16 v[98:99], v15 offset:10240
    s_mov_b32 s47, 1048576
    v_mfma_f32_16x16x32_bf16 v[52:55], v[68:71], v[168:171], v[52:55]
    ds_read_b64_tr_b16 v[100:101], v16 offset:8192
    v_mfma_f32_16x16x32_bf16 v[36:39], v[68:71], v[164:167], v[36:39]
    ds_read_b64_tr_b16 v[102:103], v16 offset:10240
    s_waitcnt lgkmcnt(8)
    v_mfma_f32_16x16x32_bf16 v[24:27], v[72:75], v[172:175], v[24:27]
    ds_read_b64_tr_b16 v[104:105], v13 offset:12288
    buffer_load_dwordx4 v[164:167], v126, s[8:11], s44 offen offset:0 sc1
    v_mfma_f32_16x16x32_bf16 v[40:43], v[72:75], v[176:179], v[40:43]
    ds_read_b64_tr_b16 v[106:107], v13 offset:14336
    buffer_load_dwordx4 v[168:171], v127, s[8:11], s44 offen offset:0 sc1
    v_mfma_f32_16x16x32_bf16 v[44:47], v[76:79], v[176:179], v[44:47]
    ds_read_b64_tr_b16 v[108:109], v14 offset:12288
    s_waitcnt vmcnt(10)
    v_mfma_f32_16x16x32_bf16 v[28:31], v[76:79], v[172:175], v[28:31]
    ds_read_b64_tr_b16 v[110:111], v14 offset:14336
    v_or3_b32 v17, v180, v184, v188
    v_mfma_f32_16x16x32_bf16 v[32:35], v[80:83], v[172:175], v[32:35]
    ds_read_b64_tr_b16 v[112:113], v15 offset:12288
    v_bitop3_b32 v17, v17, v192, 1 bitop3:0xa8
    v_mfma_f32_16x16x32_bf16 v[48:51], v[80:83], v[176:179], v[48:51]
    ds_read_b64_tr_b16 v[114:115], v15 offset:14336
    v_cmp_ne_u32 vcc, 0, v17
    v_mfma_f32_16x16x32_bf16 v[52:55], v[84:87], v[176:179], v[52:55]
    ds_read_b64_tr_b16 v[116:117], v16 offset:12288
    ds_read_b64_tr_b16 v[118:119], v16 offset:14336
    v_mfma_f32_16x16x32_bf16 v[36:39], v[84:87], v[172:175], v[36:39]
    s_waitcnt lgkmcnt(8)
    s_cbranch_vccnz dm_22f0
dm_22g0:
    v_mfma_f32_16x16x32_bf16 v[24:27], v[88:91], v[180:183], v[24:27]
    ds_read_b64_tr_b16 v[56:57], v13 offset:16384
    buffer_load_dwordx4 v[172:175], v126, s[8:11], s44 offen offset:1024 sc1
    v_mfma_f32_16x16x32_bf16 v[40:43], v[88:91], v[184:187], v[40:43]
    ds_read_b64_tr_b16 v[58:59], v13 offset:18432
    buffer_load_dwordx4 v[176:179], v127, s[8:11], s44 offen offset:1024 sc1
    v_mfma_f32_16x16x32_bf16 v[44:47], v[92:95], v[184:187], v[44:47]
    ds_read_b64_tr_b16 v[60:61], v14 offset:16384
    v_mfma_f32_16x16x32_bf16 v[28:31], v[92:95], v[180:183], v[28:31]
    ds_read_b64_tr_b16 v[62:63], v14 offset:18432
    v_mfma_f32_16x16x32_bf16 v[32:35], v[96:99], v[180:183], v[32:35]
    ds_read_b64_tr_b16 v[64:65], v15 offset:16384
    v_mfma_f32_16x16x32_bf16 v[48:51], v[96:99], v[184:187], v[48:51]
    ds_read_b64_tr_b16 v[66:67], v15 offset:18432
    v_mfma_f32_16x16x32_bf16 v[52:55], v[100:103], v[184:187], v[52:55]
    ds_read_b64_tr_b16 v[68:69], v16 offset:16384
    v_mfma_f32_16x16x32_bf16 v[36:39], v[100:103], v[180:183], v[36:39]
    ds_read_b64_tr_b16 v[70:71], v16 offset:18432
    s_waitcnt lgkmcnt(8)
    v_mfma_f32_16x16x32_bf16 v[24:27], v[104:107], v[188:191], v[24:27]
    ds_read_b64_tr_b16 v[72:73], v13 offset:20480
    buffer_load_dwordx4 v[180:183], v126, s[8:11], s44 offen offset:2048 sc1
    v_mfma_f32_16x16x32_bf16 v[40:43], v[104:107], v[192:195], v[40:43]
    ds_read_b64_tr_b16 v[74:75], v13 offset:22528
    buffer_load_dwordx4 v[184:187], v127, s[8:11], s44 offen offset:2048 sc1
    v_mfma_f32_16x16x32_bf16 v[44:47], v[108:111], v[192:195], v[44:47]
    ds_read_b64_tr_b16 v[76:77], v14 offset:20480
    s_waitcnt vmcnt(10)
    v_mfma_f32_16x16x32_bf16 v[28:31], v[108:111], v[188:191], v[28:31]
    ds_read_b64_tr_b16 v[78:79], v14 offset:22528
    v_or3_b32 v17, v196, v200, v204
    v_mfma_f32_16x16x32_bf16 v[32:35], v[112:115], v[188:191], v[32:35]
    ds_read_b64_tr_b16 v[80:81], v15 offset:20480
    v_bitop3_b32 v17, v17, v208, 1 bitop3:0xa8
    v_mfma_f32_16x16x32_bf16 v[48:51], v[112:115], v[192:195], v[48:51]
    ds_read_b64_tr_b16 v[82:83], v15 offset:22528
    v_cmp_ne_u32 vcc, 0, v17
    v_mfma_f32_16x16x32_bf16 v[52:55], v[116:119], v[192:195], v[52:55]
    ds_read_b64_tr_b16 v[84:85], v16 offset:20480
    ds_read_b64_tr_b16 v[86:87], v16 offset:22528
    v_mfma_f32_16x16x32_bf16 v[36:39], v[116:119], v[188:191], v[36:39]
    s_waitcnt lgkmcnt(8)
    s_cbranch_vccnz dm_22f1
dm_22g1:
    v_mfma_f32_16x16x32_bf16 v[24:27], v[56:59], v[196:199], v[24:27]
    ds_read_b64_tr_b16 v[88:89], v13 offset:24576
    buffer_load_dwordx4 v[188:191], v126, s[8:11], s44 offen offset:3072 sc1
    v_mfma_f32_16x16x32_bf16 v[40:43], v[56:59], v[200:203], v[40:43]
    ds_read_b64_tr_b16 v[90:91], v13 offset:26624
    buffer_load_dwordx4 v[192:195], v127, s[8:11], s44 offen offset:3072 sc1
    v_mfma_f32_16x16x32_bf16 v[44:47], v[60:63], v[200:203], v[44:47]
    ds_read_b64_tr_b16 v[92:93], v14 offset:24576
    v_mfma_f32_16x16x32_bf16 v[28:31], v[60:63], v[196:199], v[28:31]
    ds_read_b64_tr_b16 v[94:95], v14 offset:26624
    v_mfma_f32_16x16x32_bf16 v[32:35], v[64:67], v[196:199], v[32:35]
    ds_read_b64_tr_b16 v[96:97], v15 offset:24576
    s_add_u32 s43, s43, 1
    v_mfma_f32_16x16x32_bf16 v[48:51], v[64:67], v[200:203], v[48:51]
    ds_read_b64_tr_b16 v[98:99], v15 offset:26624
    v_mfma_f32_16x16x32_bf16 v[52:55], v[68:71], v[200:203], v[52:55]
    ds_read_b64_tr_b16 v[100:101], v16 offset:24576
    v_mfma_f32_16x16x32_bf16 v[36:39], v[68:71], v[196:199], v[36:39]
    ds_read_b64_tr_b16 v[102:103], v16 offset:26624
    s_waitcnt lgkmcnt(8)
    v_mfma_f32_16x16x32_bf16 v[24:27], v[72:75], v[204:207], v[24:27]
    ds_read_b64_tr_b16 v[104:105], v13 offset:28672
    buffer_load_dwordx4 v[196:199], v128, s[8:11], s44 offen offset:0 sc1
    v_mfma_f32_16x16x32_bf16 v[40:43], v[72:75], v[208:211], v[40:43]
    ds_read_b64_tr_b16 v[106:107], v13 offset:30720
    buffer_load_dwordx4 v[200:203], v129, s[8:11], s44 offen offset:0 sc1
    v_mfma_f32_16x16x32_bf16 v[44:47], v[76:79], v[208:211], v[44:47]
    ds_read_b64_tr_b16 v[108:109], v14 offset:28672
    s_waitcnt vmcnt(10)
    v_mfma_f32_16x16x32_bf16 v[28:31], v[76:79], v[204:207], v[28:31]
    ds_read_b64_tr_b16 v[110:111], v14 offset:30720
    v_add_u32 v13, 32768, v13
    v_or3_b32 v17, v212, v216, v220
    v_mfma_f32_16x16x32_bf16 v[32:35], v[80:83], v[204:207], v[32:35]
    ds_read_b64_tr_b16 v[112:113], v15 offset:28672
    v_add_u32 v14, 32768, v14
    v_bitop3_b32 v17, v17, v224, 1 bitop3:0xa8
    v_mfma_f32_16x16x32_bf16 v[48:51], v[80:83], v[208:211], v[48:51]
    ds_read_b64_tr_b16 v[114:115], v15 offset:30720
    v_add_u32 v15, 32768, v15
    v_cmp_ne_u32 vcc, 0, v17
    v_mfma_f32_16x16x32_bf16 v[52:55], v[84:87], v[208:211], v[52:55]
    ds_read_b64_tr_b16 v[116:117], v16 offset:28672
    ds_read_b64_tr_b16 v[118:119], v16 offset:30720
    s_cmp_eq_u32 s43, 4
    v_mfma_f32_16x16x32_bf16 v[36:39], v[84:87], v[204:207], v[36:39]
    v_add_u32 v16, 32768, v16
    s_waitcnt lgkmcnt(8)
    s_cbranch_vccnz dm_22f2
dm_22g2:
    s_cbranch_scc1 dm_22x
    v_mfma_f32_16x16x32_bf16 v[24:27], v[88:91], v[212:215], v[24:27]
    ds_read_b64_tr_b16 v[56:57], v13 offset:0
    buffer_load_dwordx4 v[204:207], v128, s[8:11], s44 offen offset:1024 sc1
    v_mfma_f32_16x16x32_bf16 v[40:43], v[88:91], v[216:219], v[40:43]
    ds_read_b64_tr_b16 v[58:59], v13 offset:2048
    buffer_load_dwordx4 v[208:211], v129, s[8:11], s44 offen offset:1024 sc1
    v_mfma_f32_16x16x32_bf16 v[44:47], v[92:95], v[216:219], v[44:47]
    ds_read_b64_tr_b16 v[60:61], v14 offset:0
    s_mov_b32 s49, s44
    v_mfma_f32_16x16x32_bf16 v[28:31], v[92:95], v[212:215], v[28:31]
    ds_read_b64_tr_b16 v[62:63], v14 offset:2048
    v_mfma_f32_16x16x32_bf16 v[32:35], v[96:99], v[212:215], v[32:35]
    ds_read_b64_tr_b16 v[64:65], v15 offset:0
    v_mfma_f32_16x16x32_bf16 v[48:51], v[96:99], v[216:219], v[48:51]
    ds_read_b64_tr_b16 v[66:67], v15 offset:2048
    v_mfma_f32_16x16x32_bf16 v[52:55], v[100:103], v[216:219], v[52:55]
    ds_read_b64_tr_b16 v[68:69], v16 offset:0
    v_mfma_f32_16x16x32_bf16 v[36:39], v[100:103], v[212:215], v[36:39]
    ds_read_b64_tr_b16 v[70:71], v16 offset:2048
    s_waitcnt lgkmcnt(8)
    v_mfma_f32_16x16x32_bf16 v[24:27], v[104:107], v[220:223], v[24:27]
    ds_read_b64_tr_b16 v[72:73], v13 offset:4096
    buffer_load_dwordx4 v[212:215], v128, s[8:11], s44 offen offset:2048 sc1
    v_mfma_f32_16x16x32_bf16 v[40:43], v[104:107], v[224:227], v[40:43]
    ds_read_b64_tr_b16 v[74:75], v13 offset:6144
    buffer_load_dwordx4 v[216:219], v129, s[8:11], s44 offen offset:2048 sc1
    v_mfma_f32_16x16x32_bf16 v[44:47], v[108:111], v[224:227], v[44:47]
    ds_read_b64_tr_b16 v[76:77], v14 offset:4096
    s_waitcnt vmcnt(10)
    v_mfma_f32_16x16x32_bf16 v[28:31], v[108:111], v[220:223], v[28:31]
    ds_read_b64_tr_b16 v[78:79], v14 offset:6144
    v_or3_b32 v17, v164, v168, v172
    v_mfma_f32_16x16x32_bf16 v[32:35], v[112:115], v[220:223], v[32:35]
    ds_read_b64_tr_b16 v[80:81], v15 offset:4096
    v_bitop3_b32 v17, v17, v176, 1 bitop3:0xa8
    v_mfma_f32_16x16x32_bf16 v[48:51], v[112:115], v[224:227], v[48:51]
    ds_read_b64_tr_b16 v[82:83], v15 offset:6144
    v_cmp_ne_u32 vcc, 0, v17
    v_mfma_f32_16x16x32_bf16 v[52:55], v[116:119], v[224:227], v[52:55]
    ds_read_b64_tr_b16 v[84:85], v16 offset:4096
    ds_read_b64_tr_b16 v[86:87], v16 offset:6144
    v_mfma_f32_16x16x32_bf16 v[36:39], v[116:119], v[220:223], v[36:39]
    s_waitcnt lgkmcnt(8)
    s_cbranch_vccnz dm_22f3
dm_22g3:
    s_branch dm_22
dm_22f0:
    s_cselect_b32 s50, 1, 0
dm_22h0:
    s_sleep 2
    buffer_load_dwordx4 v[180:183], v126, s[8:11], s49 offen offset:2048 sc1
    buffer_load_dwordx4 v[184:187], v127, s[8:11], s49 offen offset:2048 sc1
    buffer_load_dwordx4 v[188:191], v126, s[8:11], s49 offen offset:3072 sc1
    buffer_load_dwordx4 v[192:195], v127, s[8:11], s49 offen offset:3072 sc1
    buffer_load_dwordx4 v[196:199], v128, s[8:11], s49 offen offset:0 sc1
    buffer_load_dwordx4 v[200:203], v129, s[8:11], s49 offen offset:0 sc1
    buffer_load_dwordx4 v[204:207], v128, s[8:11], s49 offen offset:1024 sc1
    buffer_load_dwordx4 v[208:211], v129, s[8:11], s49 offen offset:1024 sc1
    buffer_load_dwordx4 v[212:215], v128, s[8:11], s49 offen offset:2048 sc1
    buffer_load_dwordx4 v[216:219], v129, s[8:11], s49 offen offset:2048 sc1
    buffer_load_dwordx4 v[220:223], v128, s[8:11], s49 offen offset:3072 sc1
    buffer_load_dwordx4 v[224:227], v129, s[8:11], s49 offen offset:3072 sc1
    buffer_load_dwordx4 v[164:167], v126, s[8:11], s44 offen offset:0 sc1
    buffer_load_dwordx4 v[168:171], v127, s[8:11], s44 offen offset:0 sc1
    s_waitcnt vmcnt(10)
    v_or3_b32 v17, v180, v184, v188
    v_bitop3_b32 v17, v17, v192, 1 bitop3:0xa8
    v_cmp_ne_u32 vcc, 0, v17
    s_add_u32 s53, s53, 1
    s_cmp_ge_u32 s53, s61
    s_cselect_b32 s61, 0, s61
    s_cbranch_scc1 dm_22k0
    s_cbranch_vccnz dm_22h0
dm_22k0:
    s_cmp_eq_u32 s50, 1
    s_branch dm_22g0
dm_22f1:
    s_cselect_b32 s50, 1, 0
dm_22h1:
    s_sleep 2
    buffer_load_dwordx4 v[196:199], v128, s[8:11], s49 offen offset:0 sc1
    buffer_load_dwordx4 v[200:203], v129, s[8:11], s49 offen offset:0 sc1
    buffer_load_dwordx4 v[204:207], v128, s[8:11], s49 offen offset:1024 sc1
    buffer_load_dwordx4 v[208:211], v129, s[8:11], s49 offen offset:1024 sc1
    buffer_load_dwordx4 v[212:215], v128, s[8:11], s49 offen offset:2048 sc1
    buffer_load_dwordx4 v[216:219], v129, s[8:11], s49 offen offset:2048 sc1
    buffer_load_dwordx4 v[220:223], v128, s[8:11], s49 offen offset:3072 sc1
    buffer_load_dwordx4 v[224:227], v129, s[8:11], s49 offen offset:3072 sc1
    buffer_load_dwordx4 v[164:167], v126, s[8:11], s44 offen offset:0 sc1
    buffer_load_dwordx4 v[168:171], v127, s[8:11], s44 offen offset:0 sc1
    buffer_load_dwordx4 v[172:175], v126, s[8:11], s44 offen offset:1024 sc1
    buffer_load_dwordx4 v[176:179], v127, s[8:11], s44 offen offset:1024 sc1
    buffer_load_dwordx4 v[180:183], v126, s[8:11], s44 offen offset:2048 sc1
    buffer_load_dwordx4 v[184:187], v127, s[8:11], s44 offen offset:2048 sc1
    s_waitcnt vmcnt(10)
    v_or3_b32 v17, v196, v200, v204
    v_bitop3_b32 v17, v17, v208, 1 bitop3:0xa8
    v_cmp_ne_u32 vcc, 0, v17
    s_add_u32 s53, s53, 1
    s_cmp_ge_u32 s53, s61
    s_cselect_b32 s61, 0, s61
    s_cbranch_scc1 dm_22k1
    s_cbranch_vccnz dm_22h1
dm_22k1:
    s_cmp_eq_u32 s50, 1
    s_branch dm_22g1
dm_22f2:
    s_cselect_b32 s50, 1, 0
dm_22h2:
    s_sleep 2
    buffer_load_dwordx4 v[212:215], v128, s[8:11], s49 offen offset:2048 sc1
    buffer_load_dwordx4 v[216:219], v129, s[8:11], s49 offen offset:2048 sc1
    buffer_load_dwordx4 v[220:223], v128, s[8:11], s49 offen offset:3072 sc1
    buffer_load_dwordx4 v[224:227], v129, s[8:11], s49 offen offset:3072 sc1
    buffer_load_dwordx4 v[164:167], v126, s[8:11], s44 offen offset:0 sc1
    buffer_load_dwordx4 v[168:171], v127, s[8:11], s44 offen offset:0 sc1
    buffer_load_dwordx4 v[172:175], v126, s[8:11], s44 offen offset:1024 sc1
    buffer_load_dwordx4 v[176:179], v127, s[8:11], s44 offen offset:1024 sc1
    buffer_load_dwordx4 v[180:183], v126, s[8:11], s44 offen offset:2048 sc1
    buffer_load_dwordx4 v[184:187], v127, s[8:11], s44 offen offset:2048 sc1
    buffer_load_dwordx4 v[188:191], v126, s[8:11], s44 offen offset:3072 sc1
    buffer_load_dwordx4 v[192:195], v127, s[8:11], s44 offen offset:3072 sc1
    buffer_load_dwordx4 v[196:199], v128, s[8:11], s44 offen offset:0 sc1
    buffer_load_dwordx4 v[200:203], v129, s[8:11], s44 offen offset:0 sc1
    s_waitcnt vmcnt(10)
    v_or3_b32 v17, v212, v216, v220
    v_bitop3_b32 v17, v17, v224, 1 bitop3:0xa8
    v_cmp_ne_u32 vcc, 0, v17
    s_add_u32 s53, s53, 1
    s_cmp_ge_u32 s53, s61
    s_cselect_b32 s61, 0, s61
    s_cbranch_scc1 dm_22k2
    s_cbranch_vccnz dm_22h2
dm_22k2:
    s_cmp_eq_u32 s50, 1
    s_branch dm_22g2
dm_22f3:
    s_cselect_b32 s50, 1, 0
dm_22h3:
    s_sleep 2
    buffer_load_dwordx4 v[164:167], v126, s[8:11], s49 offen offset:0 sc1
    buffer_load_dwordx4 v[168:171], v127, s[8:11], s49 offen offset:0 sc1
    buffer_load_dwordx4 v[172:175], v126, s[8:11], s49 offen offset:1024 sc1
    buffer_load_dwordx4 v[176:179], v127, s[8:11], s49 offen offset:1024 sc1
    buffer_load_dwordx4 v[180:183], v126, s[8:11], s49 offen offset:2048 sc1
    buffer_load_dwordx4 v[184:187], v127, s[8:11], s49 offen offset:2048 sc1
    buffer_load_dwordx4 v[188:191], v126, s[8:11], s49 offen offset:3072 sc1
    buffer_load_dwordx4 v[192:195], v127, s[8:11], s49 offen offset:3072 sc1
    buffer_load_dwordx4 v[196:199], v128, s[8:11], s49 offen offset:0 sc1
    buffer_load_dwordx4 v[200:203], v129, s[8:11], s49 offen offset:0 sc1
    buffer_load_dwordx4 v[204:207], v128, s[8:11], s49 offen offset:1024 sc1
    buffer_load_dwordx4 v[208:211], v129, s[8:11], s49 offen offset:1024 sc1
    buffer_load_dwordx4 v[212:215], v128, s[8:11], s49 offen offset:2048 sc1
    buffer_load_dwordx4 v[216:219], v129, s[8:11], s49 offen offset:2048 sc1
    s_waitcnt vmcnt(10)
    v_or3_b32 v17, v164, v168, v172
    v_bitop3_b32 v17, v17, v176, 1 bitop3:0xa8
    v_cmp_ne_u32 vcc, 0, v17
    s_add_u32 s53, s53, 1
    s_cmp_ge_u32 s53, s61
    s_cselect_b32 s61, 0, s61
    s_cbranch_scc1 dm_22k3
    s_cbranch_vccnz dm_22h3
dm_22k3:
    s_cmp_eq_u32 s50, 1
    s_branch dm_22g3
dm_22x:
    v_mfma_f32_16x16x32_bf16 v[24:27], v[88:91], v[212:215], v[24:27]
    buffer_load_dwordx4 v[148:151], v126, s[8:11], s41 offen offset:0 sc1
    v_mfma_f32_16x16x32_bf16 v[40:43], v[88:91], v[216:219], v[40:43]
    v_mfma_f32_16x16x32_bf16 v[44:47], v[92:95], v[216:219], v[44:47]
    buffer_load_dwordx4 v[152:155], v126, s[8:11], s41 offen offset:1024 sc1
    v_mfma_f32_16x16x32_bf16 v[28:31], v[92:95], v[212:215], v[28:31]
    v_mfma_f32_16x16x32_bf16 v[32:35], v[96:99], v[212:215], v[32:35]
    buffer_load_dwordx4 v[156:159], v127, s[8:11], s41 offen offset:0 sc1
    v_mfma_f32_16x16x32_bf16 v[48:51], v[96:99], v[216:219], v[48:51]
    v_mfma_f32_16x16x32_bf16 v[52:55], v[100:103], v[216:219], v[52:55]
    buffer_load_dwordx4 v[160:163], v127, s[8:11], s41 offen offset:1024 sc1
    v_mfma_f32_16x16x32_bf16 v[36:39], v[100:103], v[212:215], v[36:39]
    s_waitcnt lgkmcnt(0)
    s_barrier
    v_mfma_f32_16x16x32_bf16 v[24:27], v[104:107], v[220:223], v[24:27]
    ds_read_b128 v[56:59], v6 offset:0
    v_mfma_f32_16x16x32_bf16 v[40:43], v[104:107], v[224:227], v[40:43]
    ds_read_b128 v[60:63], v6 offset:64
    v_mfma_f32_16x16x32_bf16 v[44:47], v[108:111], v[224:227], v[44:47]
    ds_read_b128 v[64:67], v6 offset:128
    v_mfma_f32_16x16x32_bf16 v[28:31], v[108:111], v[220:223], v[28:31]
    ds_read_b128 v[68:71], v6 offset:192
    v_mfma_f32_16x16x32_bf16 v[32:35], v[112:115], v[220:223], v[32:35]
    ds_read_b64 v[72:73], v7 offset:0
    v_mfma_f32_16x16x32_bf16 v[48:51], v[112:115], v[224:227], v[48:51]
    ds_read_b64 v[74:75], v7 offset:256
    v_mfma_f32_16x16x32_bf16 v[52:55], v[116:119], v[224:227], v[52:55]
    v_mfma_f32_16x16x32_bf16 v[36:39], v[116:119], v[220:223], v[36:39]
    s_waitcnt lgkmcnt(0)
    v_mul_f32 v134, 0xc0135761, v73
    v_mul_f32 v135, v73, v73
    v_mul_f32 v135, v135, v134
    v_mul_f32 v135, 0x3d372713, v135
    v_rcp_f32 v73, v73
    v_mul_f32 v136, 0xc0135761, v75
    v_mul_f32 v137, v75, v75
    v_mul_f32 v137, v137, v136
    v_mul_f32 v137, 0x3d372713, v137
    v_rcp_f32 v75, v75
    v_pk_fma_f32 v[24:25], v[72:73], v[56:57], v[24:25] op_sel_hi:[0,1,1] neg_lo:[1,0,0] neg_hi:[1,0,0]
    v_pk_fma_f32 v[26:27], v[72:73], v[58:59], v[26:27] op_sel_hi:[0,1,1] neg_lo:[1,0,0] neg_hi:[1,0,0]
    v_pk_mul_f32 v[122:123], v[24:25], v[24:25]
    v_pk_mul_f32 v[124:125], v[26:27], v[26:27]
    v_pk_fma_f32 v[122:123], v[122:123], v[134:135], v[134:135] op_sel:[0,1,0] op_sel_hi:[1,1,0]
    v_pk_fma_f32 v[124:125], v[124:125], v[134:135], v[134:135] op_sel:[0,1,0] op_sel_hi:[1,1,0]
    v_pk_mul_f32 v[122:123], v[122:123], v[24:25]
    v_pk_mul_f32 v[124:125], v[124:125], v[26:27]
    v_exp_f32 v122, v122
    v_exp_f32 v123, v123
    v_exp_f32 v124, v124
    v_exp_f32 v125, v125
    v_pk_fma_f32 v[122:123], v[122:123], v[72:73], v[72:73] op_sel:[0,1,1] op_sel_hi:[1,1,1]
    v_pk_fma_f32 v[124:125], v[124:125], v[72:73], v[72:73] op_sel:[0,1,1] op_sel_hi:[1,1,1]
    v_rcp_f32 v122, v122
    v_rcp_f32 v123, v123
    v_rcp_f32 v124, v124
    v_rcp_f32 v125, v125
    v_pk_mul_f32 v[24:25], v[24:25], v[122:123]
    v_pk_mul_f32 v[26:27], v[26:27], v[124:125]
    v_pk_fma_f32 v[28:29], v[72:73], v[60:61], v[28:29] op_sel_hi:[0,1,1] neg_lo:[1,0,0] neg_hi:[1,0,0]
    v_pk_fma_f32 v[30:31], v[72:73], v[62:63], v[30:31] op_sel_hi:[0,1,1] neg_lo:[1,0,0] neg_hi:[1,0,0]
    v_pk_mul_f32 v[122:123], v[28:29], v[28:29]
    v_pk_mul_f32 v[124:125], v[30:31], v[30:31]
    v_pk_fma_f32 v[122:123], v[122:123], v[134:135], v[134:135] op_sel:[0,1,0] op_sel_hi:[1,1,0]
    v_pk_fma_f32 v[124:125], v[124:125], v[134:135], v[134:135] op_sel:[0,1,0] op_sel_hi:[1,1,0]
    v_pk_mul_f32 v[122:123], v[122:123], v[28:29]
    v_pk_mul_f32 v[124:125], v[124:125], v[30:31]
    v_exp_f32 v122, v122
    v_exp_f32 v123, v123
    v_exp_f32 v124, v124
    v_exp_f32 v125, v125
    v_pk_fma_f32 v[122:123], v[122:123], v[72:73], v[72:73] op_sel:[0,1,1] op_sel_hi:[1,1,1]
    v_pk_fma_f32 v[124:125], v[124:125], v[72:73], v[72:73] op_sel:[0,1,1] op_sel_hi:[1,1,1]
    v_rcp_f32 v122, v122
    v_rcp_f32 v123, v123
    v_rcp_f32 v124, v124
    v_rcp_f32 v125, v125
    v_pk_mul_f32 v[28:29], v[28:29], v[122:123]
    v_pk_mul_f32 v[30:31], v[30:31], v[124:125]
    v_cvt_pk_bf16_f32 v24, v24, v25
    v_cvt_pk_bf16_f32 v25, v26, v27
    v_cvt_pk_bf16_f32 v26, v28, v29
    v_cvt_pk_bf16_f32 v27, v30, v31
    v_and_b32 v24, -2, v24
    buffer_store_dwordx4 v[24:27], v12, s[16:19], s39 offen offset:0 sc1
    v_pk_fma_f32 v[40:41], v[74:75], v[56:57], v[40:41] op_sel_hi:[0,1,1] neg_lo:[1,0,0] neg_hi:[1,0,0]
    v_pk_fma_f32 v[42:43], v[74:75], v[58:59], v[42:43] op_sel_hi:[0,1,1] neg_lo:[1,0,0] neg_hi:[1,0,0]
    v_pk_mul_f32 v[122:123], v[40:41], v[40:41]
    v_pk_mul_f32 v[124:125], v[42:43], v[42:43]
    v_pk_fma_f32 v[122:123], v[122:123], v[136:137], v[136:137] op_sel:[0,1,0] op_sel_hi:[1,1,0]
    v_pk_fma_f32 v[124:125], v[124:125], v[136:137], v[136:137] op_sel:[0,1,0] op_sel_hi:[1,1,0]
    v_pk_mul_f32 v[122:123], v[122:123], v[40:41]
    v_pk_mul_f32 v[124:125], v[124:125], v[42:43]
    v_exp_f32 v122, v122
    v_exp_f32 v123, v123
    v_exp_f32 v124, v124
    v_exp_f32 v125, v125
    v_pk_fma_f32 v[122:123], v[122:123], v[74:75], v[74:75] op_sel:[0,1,1] op_sel_hi:[1,1,1]
    v_pk_fma_f32 v[124:125], v[124:125], v[74:75], v[74:75] op_sel:[0,1,1] op_sel_hi:[1,1,1]
    v_rcp_f32 v122, v122
    v_rcp_f32 v123, v123
    v_rcp_f32 v124, v124
    v_rcp_f32 v125, v125
    v_pk_mul_f32 v[40:41], v[40:41], v[122:123]
    v_pk_mul_f32 v[42:43], v[42:43], v[124:125]
    v_pk_fma_f32 v[44:45], v[74:75], v[60:61], v[44:45] op_sel_hi:[0,1,1] neg_lo:[1,0,0] neg_hi:[1,0,0]
    v_pk_fma_f32 v[46:47], v[74:75], v[62:63], v[46:47] op_sel_hi:[0,1,1] neg_lo:[1,0,0] neg_hi:[1,0,0]
    v_pk_mul_f32 v[122:123], v[44:45], v[44:45]
    v_pk_mul_f32 v[124:125], v[46:47], v[46:47]
    v_pk_fma_f32 v[122:123], v[122:123], v[136:137], v[136:137] op_sel:[0,1,0] op_sel_hi:[1,1,0]
    v_pk_fma_f32 v[124:125], v[124:125], v[136:137], v[136:137] op_sel:[0,1,0] op_sel_hi:[1,1,0]
    v_pk_mul_f32 v[122:123], v[122:123], v[44:45]
    v_pk_mul_f32 v[124:125], v[124:125], v[46:47]
    v_exp_f32 v122, v122
    v_exp_f32 v123, v123
    v_exp_f32 v124, v124
    v_exp_f32 v125, v125
    v_pk_fma_f32 v[122:123], v[122:123], v[74:75], v[74:75] op_sel:[0,1,1] op_sel_hi:[1,1,1]
    v_pk_fma_f32 v[124:125], v[124:125], v[74:75], v[74:75] op_sel:[0,1,1] op_sel_hi:[1,1,1]
    v_rcp_f32 v122, v122
    v_rcp_f32 v123, v123
    v_rcp_f32 v124, v124
    v_rcp_f32 v125, v125
    v_pk_mul_f32 v[44:45], v[44:45], v[122:123]
    v_pk_mul_f32 v[46:47], v[46:47], v[124:125]
    v_cvt_pk_bf16_f32 v40, v40, v41
    v_cvt_pk_bf16_f32 v41, v42, v43
    v_cvt_pk_bf16_f32 v42, v44, v45
    v_cvt_pk_bf16_f32 v43, v46, v47
    v_and_b32 v40, -2, v40
    buffer_store_dwordx4 v[40:43], v12, s[16:19], s39 offen offset:256 sc1
    v_pk_fma_f32 v[32:33], v[72:73], v[64:65], v[32:33] op_sel_hi:[0,1,1] neg_lo:[1,0,0] neg_hi:[1,0,0]
    v_pk_fma_f32 v[34:35], v[72:73], v[66:67], v[34:35] op_sel_hi:[0,1,1] neg_lo:[1,0,0] neg_hi:[1,0,0]
    v_pk_mul_f32 v[122:123], v[32:33], v[32:33]
    v_pk_mul_f32 v[124:125], v[34:35], v[34:35]
    v_pk_fma_f32 v[122:123], v[122:123], v[134:135], v[134:135] op_sel:[0,1,0] op_sel_hi:[1,1,0]
    v_pk_fma_f32 v[124:125], v[124:125], v[134:135], v[134:135] op_sel:[0,1,0] op_sel_hi:[1,1,0]
    v_pk_mul_f32 v[122:123], v[122:123], v[32:33]
    v_pk_mul_f32 v[124:125], v[124:125], v[34:35]
    v_exp_f32 v122, v122
    v_exp_f32 v123, v123
    v_exp_f32 v124, v124
    v_exp_f32 v125, v125
    v_pk_fma_f32 v[122:123], v[122:123], v[72:73], v[72:73] op_sel:[0,1,1] op_sel_hi:[1,1,1]
    v_pk_fma_f32 v[124:125], v[124:125], v[72:73], v[72:73] op_sel:[0,1,1] op_sel_hi:[1,1,1]
    v_rcp_f32 v122, v122
    v_rcp_f32 v123, v123
    v_rcp_f32 v124, v124
    v_rcp_f32 v125, v125
    v_pk_mul_f32 v[32:33], v[32:33], v[122:123]
    v_pk_mul_f32 v[34:35], v[34:35], v[124:125]
    v_pk_fma_f32 v[36:37], v[72:73], v[68:69], v[36:37] op_sel_hi:[0,1,1] neg_lo:[1,0,0] neg_hi:[1,0,0]
    v_pk_fma_f32 v[38:39], v[72:73], v[70:71], v[38:39] op_sel_hi:[0,1,1] neg_lo:[1,0,0] neg_hi:[1,0,0]
    v_pk_mul_f32 v[122:123], v[36:37], v[36:37]
    v_pk_mul_f32 v[124:125], v[38:39], v[38:39]
    v_pk_fma_f32 v[122:123], v[122:123], v[134:135], v[134:135] op_sel:[0,1,0] op_sel_hi:[1,1,0]
    v_pk_fma_f32 v[124:125], v[124:125], v[134:135], v[134:135] op_sel:[0,1,0] op_sel_hi:[1,1,0]
    v_pk_mul_f32 v[122:123], v[122:123], v[36:37]
    v_pk_mul_f32 v[124:125], v[124:125], v[38:39]
    v_exp_f32 v122, v122
    v_exp_f32 v123, v123
    v_exp_f32 v124, v124
    v_exp_f32 v125, v125
    v_pk_fma_f32 v[122:123], v[122:123], v[72:73], v[72:73] op_sel:[0,1,1] op_sel_hi:[1,1,1]
    v_pk_fma_f32 v[124:125], v[124:125], v[72:73], v[72:73] op_sel:[0,1,1] op_sel_hi:[1,1,1]
    v_rcp_f32 v122, v122
    v_rcp_f32 v123, v123
    v_rcp_f32 v124, v124
    v_rcp_f32 v125, v125
    v_pk_mul_f32 v[36:37], v[36:37], v[122:123]
    v_pk_mul_f32 v[38:39], v[38:39], v[124:125]
    v_cvt_pk_bf16_f32 v32, v32, v33
    v_cvt_pk_bf16_f32 v33, v34, v35
    v_cvt_pk_bf16_f32 v34, v36, v37
    v_cvt_pk_bf16_f32 v35, v38, v39
    v_and_b32 v32, -2, v32
    buffer_store_dwordx4 v[32:35], v12, s[16:19], s40 offen offset:0 sc1
    v_pk_fma_f32 v[48:49], v[74:75], v[64:65], v[48:49] op_sel_hi:[0,1,1] neg_lo:[1,0,0] neg_hi:[1,0,0]
    v_pk_fma_f32 v[50:51], v[74:75], v[66:67], v[50:51] op_sel_hi:[0,1,1] neg_lo:[1,0,0] neg_hi:[1,0,0]
    v_pk_mul_f32 v[122:123], v[48:49], v[48:49]
    v_pk_mul_f32 v[124:125], v[50:51], v[50:51]
    v_pk_fma_f32 v[122:123], v[122:123], v[136:137], v[136:137] op_sel:[0,1,0] op_sel_hi:[1,1,0]
    v_pk_fma_f32 v[124:125], v[124:125], v[136:137], v[136:137] op_sel:[0,1,0] op_sel_hi:[1,1,0]
    v_pk_mul_f32 v[122:123], v[122:123], v[48:49]
    v_pk_mul_f32 v[124:125], v[124:125], v[50:51]
    v_exp_f32 v122, v122
    v_exp_f32 v123, v123
    v_exp_f32 v124, v124
    v_exp_f32 v125, v125
    v_pk_fma_f32 v[122:123], v[122:123], v[74:75], v[74:75] op_sel:[0,1,1] op_sel_hi:[1,1,1]
    v_pk_fma_f32 v[124:125], v[124:125], v[74:75], v[74:75] op_sel:[0,1,1] op_sel_hi:[1,1,1]
    v_rcp_f32 v122, v122
    v_rcp_f32 v123, v123
    v_rcp_f32 v124, v124
    v_rcp_f32 v125, v125
    v_pk_mul_f32 v[48:49], v[48:49], v[122:123]
    v_pk_mul_f32 v[50:51], v[50:51], v[124:125]
    v_pk_fma_f32 v[52:53], v[74:75], v[68:69], v[52:53] op_sel_hi:[0,1,1] neg_lo:[1,0,0] neg_hi:[1,0,0]
    v_pk_fma_f32 v[54:55], v[74:75], v[70:71], v[54:55] op_sel_hi:[0,1,1] neg_lo:[1,0,0] neg_hi:[1,0,0]
    v_pk_mul_f32 v[122:123], v[52:53], v[52:53]
    v_pk_mul_f32 v[124:125], v[54:55], v[54:55]
    v_pk_fma_f32 v[122:123], v[122:123], v[136:137], v[136:137] op_sel:[0,1,0] op_sel_hi:[1,1,0]
    v_pk_fma_f32 v[124:125], v[124:125], v[136:137], v[136:137] op_sel:[0,1,0] op_sel_hi:[1,1,0]
    v_pk_mul_f32 v[122:123], v[122:123], v[52:53]
    v_pk_mul_f32 v[124:125], v[124:125], v[54:55]
    v_exp_f32 v122, v122
    v_exp_f32 v123, v123
    v_exp_f32 v124, v124
    v_exp_f32 v125, v125
    v_pk_fma_f32 v[122:123], v[122:123], v[74:75], v[74:75] op_sel:[0,1,1] op_sel_hi:[1,1,1]
    v_pk_fma_f32 v[124:125], v[124:125], v[74:75], v[74:75] op_sel:[0,1,1] op_sel_hi:[1,1,1]
    v_rcp_f32 v122, v122
    v_rcp_f32 v123, v123
    v_rcp_f32 v124, v124
    v_rcp_f32 v125, v125
    v_pk_mul_f32 v[52:53], v[52:53], v[122:123]
    v_pk_mul_f32 v[54:55], v[54:55], v[124:125]
    v_cvt_pk_bf16_f32 v48, v48, v49
    v_cvt_pk_bf16_f32 v49, v50, v51
    v_cvt_pk_bf16_f32 v50, v52, v53
    v_cvt_pk_bf16_f32 v51, v54, v55
    v_and_b32 v48, -2, v48
    buffer_store_dwordx4 v[48:51], v12, s[16:19], s40 offen offset:256 sc1
    s_add_u32 s8, s4, 0x2100000
    s_addc_u32 s9, s5, 0
    s_mov_b32 s10, 0x8400000
    s_mov_b32 s11, 0x20000
    s_sub_u32 s47, s55, 39583744
    s_lshl_b32 s46, s30, 9
    s_add_u32 s47, s47, s46
    s_add_u32 s45, s92, 2048
    s_cmp_eq_u32 s28, 0
    s_cselect_b32 s45, 1073741824, s45
    s_cmp_eq_u32 s30, 0
    s_cselect_b32 s45, s45, 0
    s_add_u32 s53, s47, 0xfffffff0
    v_add_u32 v126, s53, v12
    v_add_u32 v127, 256, v126
    v_add_u32 v134, s45, v126
    v_cmp_gt_u32 vcc, 1, v22
    s_nop 1
    v_cndmask_b32 v126, v126, v134, vcc
    s_mov_b32 s34, s30
    s_mov_b32 s35, 0
    v_and_b32 v22, 15, v1
    v_lshrrev_b32 v23, 4, v1
    s_mul_i32 s37, s34, 2
    s_mul_i32 s38, s29, 4
    s_mul_i32 s36, s35, 4
    s_add_u32 s38, s38, s36
    s_lshr_b32 s36, s38, 1
    s_lshr_b32 s53, s36, 3
    s_lshl_b32 s53, s53, 14
    s_and_b32 s39, s36, 7
    s_lshl_b32 s39, s39, 10
    s_add_u32 s39, s39, s53
    s_lshl_b32 s36, s37, 16
    s_add_u32 s39, s39, s36
    s_sub_u32 s46, s93, 2048
    s_cmp_eq_u32 s28, 15
    s_cselect_b32 s46, 1073741824, s46
    s_cmp_eq_u32 s30, 3
    s_cselect_b32 s46, s46, 0
    s_add_u32 s53, s47, 0x10
    v_add_u32 v128, s53, v12
    v_add_u32 v129, 256, v128
    v_add_u32 v134, s46, v129
    v_cmp_le_u32 vcc, 15, v22
    s_nop 1
    v_cndmask_b32 v129, v129, v134, vcc
    s_add_u32 s53, s47, 0xffffffe0
    v_add_u32 v130, s53, v12
    v_add_u32 v131, 256, v130
    v_add_u32 v134, s45, v130
    v_cmp_gt_u32 vcc, 2, v22
    s_nop 1
    v_cndmask_b32 v130, v130, v134, vcc
    s_add_u32 s53, s47, 0x20
    v_add_u32 v132, s53, v12
    v_add_u32 v133, 256, v132
    v_add_u32 v134, s46, v133
    v_cmp_le_u32 vcc, 14, v22
    s_nop 1
    v_cndmask_b32 v133, v133, v134, vcc
    v_mov_b32 v134, v126
    v_mov_b32 v135, v127
    v_lshrrev_b32 v6, 2, v1
    v_mul_u32_u24 v13, 128, v6
    v_and_b32 v7, 3, v1
    v_lshl_add_u32 v13, v7, 3, v13
    v_add_u32 v13, 0, v13
    v_bfe_u32 v6, v6, 1, 2
    s_mul_i32 s36, s35, 4
    s_add_u32 s36, s36, 3
    v_xor_b32 v7, s36, v6
    v_lshl_add_u32 v16, v7, 5, v13
    s_mul_i32 s36, s35, 4
    s_add_u32 s36, s36, 2
    v_xor_b32 v7, s36, v6
    v_lshl_add_u32 v15, v7, 5, v13
    s_mul_i32 s36, s35, 4
    s_add_u32 s36, s36, 1
    v_xor_b32 v7, s36, v6
    v_lshl_add_u32 v14, v7, 5, v13
    s_mul_i32 s36, s35, 4
    s_add_u32 s36, s36, 0
    v_xor_b32 v7, s36, v6
    v_lshl_add_u32 v13, v7, 5, v13
    s_lshl_b32 s36, s37, 8
    s_add_u32 s36, s36, 160768
    v_lshlrev_b32 v7, 4, v22
    v_add_u32 v7, s36, v7
    ds_read_b64 v[56:57], v7 offset:0
    ds_read_b64 v[58:59], v7 offset:256
    s_waitcnt vmcnt(4) lgkmcnt(0)
    s_sleep 3
    s_cmp_lg_u32 s60, 0
    s_cbranch_scc1 G2_nd
    s_sleep 2
G2_nd:
    s_mov_b32 s44, 0
    buffer_load_dwordx4 v[164:167], v126, s[8:11], s44 offen sc1
    buffer_load_dwordx4 v[168:171], v127, s[8:11], s44 offen sc1
    s_add_u32 s44, s44, 16384
    buffer_load_dwordx4 v[172:175], v126, s[8:11], s44 offen sc1
    buffer_load_dwordx4 v[176:179], v127, s[8:11], s44 offen sc1
    s_add_u32 s44, s44, 16384
    v_lshlrev_b32 v24, 16, v148
    v_and_b32 v25, 0xffff0000, v148
    v_pk_add_f32 v[24:25], v[24:25], v[56:57] op_sel_hi:[1,0] neg_lo:[0,1] neg_hi:[0,1]
    v_pk_mul_f32 v[24:25], v[24:25], v[56:57] op_sel:[0,1] op_sel_hi:[1,1]
    v_lshlrev_b32 v26, 16, v149
    v_and_b32 v27, 0xffff0000, v149
    v_pk_add_f32 v[26:27], v[26:27], v[56:57] op_sel_hi:[1,0] neg_lo:[0,1] neg_hi:[0,1]
    v_pk_mul_f32 v[26:27], v[26:27], v[56:57] op_sel:[0,1] op_sel_hi:[1,1]
    v_lshlrev_b32 v28, 16, v150
    v_and_b32 v29, 0xffff0000, v150
    v_pk_add_f32 v[28:29], v[28:29], v[56:57] op_sel_hi:[1,0] neg_lo:[0,1] neg_hi:[0,1]
    v_pk_mul_f32 v[28:29], v[28:29], v[56:57] op_sel:[0,1] op_sel_hi:[1,1]
    v_lshlrev_b32 v30, 16, v151
    v_and_b32 v31, 0xffff0000, v151
    v_pk_add_f32 v[30:31], v[30:31], v[56:57] op_sel_hi:[1,0] neg_lo:[0,1] neg_hi:[0,1]
    v_pk_mul_f32 v[30:31], v[30:31], v[56:57] op_sel:[0,1] op_sel_hi:[1,1]
    v_lshlrev_b32 v32, 16, v152
    v_and_b32 v33, 0xffff0000, v152
    v_pk_add_f32 v[32:33], v[32:33], v[56:57] op_sel_hi:[1,0] neg_lo:[0,1] neg_hi:[0,1]
    v_pk_mul_f32 v[32:33], v[32:33], v[56:57] op_sel:[0,1] op_sel_hi:[1,1]
    v_lshlrev_b32 v34, 16, v153
    v_and_b32 v35, 0xffff0000, v153
    v_pk_add_f32 v[34:35], v[34:35], v[56:57] op_sel_hi:[1,0] neg_lo:[0,1] neg_hi:[0,1]
    v_pk_mul_f32 v[34:35], v[34:35], v[56:57] op_sel:[0,1] op_sel_hi:[1,1]
    v_lshlrev_b32 v36, 16, v154
    v_and_b32 v37, 0xffff0000, v154
    v_pk_add_f32 v[36:37], v[36:37], v[56:57] op_sel_hi:[1,0] neg_lo:[0,1] neg_hi:[0,1]
    v_pk_mul_f32 v[36:37], v[36:37], v[56:57] op_sel:[0,1] op_sel_hi:[1,1]
    v_lshlrev_b32 v38, 16, v155
    v_and_b32 v39, 0xffff0000, v155
    v_pk_add_f32 v[38:39], v[38:39], v[56:57] op_sel_hi:[1,0] neg_lo:[0,1] neg_hi:[0,1]
    v_pk_mul_f32 v[38:39], v[38:39], v[56:57] op_sel:[0,1] op_sel_hi:[1,1]
    v_lshlrev_b32 v40, 16, v156
    v_and_b32 v41, 0xffff0000, v156
    v_pk_add_f32 v[40:41], v[40:41], v[58:59] op_sel_hi:[1,0] neg_lo:[0,1] neg_hi:[0,1]
    v_pk_mul_f32 v[40:41], v[40:41], v[58:59] op_sel:[0,1] op_sel_hi:[1,1]
    v_lshlrev_b32 v42, 16, v157
    v_and_b32 v43, 0xffff0000, v157
    v_pk_add_f32 v[42:43], v[42:43], v[58:59] op_sel_hi:[1,0] neg_lo:[0,1] neg_hi:[0,1]
    v_pk_mul_f32 v[42:43], v[42:43], v[58:59] op_sel:[0,1] op_sel_hi:[1,1]
    v_lshlrev_b32 v44, 16, v158
    v_and_b32 v45, 0xffff0000, v158
    v_pk_add_f32 v[44:45], v[44:45], v[58:59] op_sel_hi:[1,0] neg_lo:[0,1] neg_hi:[0,1]
    v_pk_mul_f32 v[44:45], v[44:45], v[58:59] op_sel:[0,1] op_sel_hi:[1,1]
    v_lshlrev_b32 v46, 16, v159
    v_and_b32 v47, 0xffff0000, v159
    v_pk_add_f32 v[46:47], v[46:47], v[58:59] op_sel_hi:[1,0] neg_lo:[0,1] neg_hi:[0,1]
    v_pk_mul_f32 v[46:47], v[46:47], v[58:59] op_sel:[0,1] op_sel_hi:[1,1]
    v_lshlrev_b32 v48, 16, v160
    v_and_b32 v49, 0xffff0000, v160
    v_pk_add_f32 v[48:49], v[48:49], v[58:59] op_sel_hi:[1,0] neg_lo:[0,1] neg_hi:[0,1]
    v_pk_mul_f32 v[48:49], v[48:49], v[58:59] op_sel:[0,1] op_sel_hi:[1,1]
    v_lshlrev_b32 v50, 16, v161
    v_and_b32 v51, 0xffff0000, v161
    v_pk_add_f32 v[50:51], v[50:51], v[58:59] op_sel_hi:[1,0] neg_lo:[0,1] neg_hi:[0,1]
    v_pk_mul_f32 v[50:51], v[50:51], v[58:59] op_sel:[0,1] op_sel_hi:[1,1]
    v_lshlrev_b32 v52, 16, v162
    v_and_b32 v53, 0xffff0000, v162
    v_pk_add_f32 v[52:53], v[52:53], v[58:59] op_sel_hi:[1,0] neg_lo:[0,1] neg_hi:[0,1]
    v_pk_mul_f32 v[52:53], v[52:53], v[58:59] op_sel:[0,1] op_sel_hi:[1,1]
    v_lshlrev_b32 v54, 16, v163
    v_and_b32 v55, 0xffff0000, v163
    v_pk_add_f32 v[54:55], v[54:55], v[58:59] op_sel_hi:[1,0] neg_lo:[0,1] neg_hi:[0,1]
    v_pk_mul_f32 v[54:55], v[54:55], v[58:59] op_sel:[0,1] op_sel_hi:[1,1]
    s_mov_b32 s43, 0
    s_add_u32 s16, s62, 0x80000
    s_addc_u32 s17, s63, 0
    s_mov_b32 s18, 0x7e000
    s_mov_b32 s19, 0x20000
    s_mov_b32 s53, 0
    s_mov_b32 s49, s44
    s_barrier
    ds_read_b64_tr_b16 v[56:57], v13 offset:0
    ds_read_b64_tr_b16 v[58:59], v13 offset:2048
    ds_read_b64_tr_b16 v[60:61], v14 offset:0
    ds_read_b64_tr_b16 v[62:63], v14 offset:2048
    ds_read_b64_tr_b16 v[64:65], v15 offset:0
    ds_read_b64_tr_b16 v[66:67], v15 offset:2048
    ds_read_b64_tr_b16 v[68:69], v16 offset:0
    ds_read_b64_tr_b16 v[70:71], v16 offset:2048
    ds_read_b64_tr_b16 v[72:73], v13 offset:4096
    ds_read_b64_tr_b16 v[74:75], v13 offset:6144
    ds_read_b64_tr_b16 v[76:77], v14 offset:4096
    ds_read_b64_tr_b16 v[78:79], v14 offset:6144
    ds_read_b64_tr_b16 v[80:81], v15 offset:4096
    ds_read_b64_tr_b16 v[82:83], v15 offset:6144
    ds_read_b64_tr_b16 v[84:85], v16 offset:4096
    ds_read_b64_tr_b16 v[86:87], v16 offset:6144
    s_branch dm_23w
dm_23p:
    s_mov_b32 s44, 0
    buffer_load_dwordx4 v[164:167], v126, s[8:11], s44 offen sc1
    buffer_load_dwordx4 v[168:171], v127, s[8:11], s44 offen sc1
    s_add_u32 s44, s44, 16384
    buffer_load_dwordx4 v[172:175], v126, s[8:11], s44 offen sc1
    buffer_load_dwordx4 v[176:179], v127, s[8:11], s44 offen sc1
    s_add_u32 s44, s44, 16384
dm_23w:
    s_waitcnt vmcnt(0)
    v_or3_b32 v17, v164, v168, v172
    v_bitop3_b32 v17, v17, v176, 1 bitop3:0xa8
    v_cmp_ne_u32 vcc, 0, v17
    s_cbranch_vccz dm_23q
    s_sleep 2
    s_add_u32 s53, s53, 1
    s_cmp_lt_u32 s53, s61
    s_cbranch_scc1 dm_23p
    s_mov_b32 s61, 0
dm_23q:
    buffer_load_dwordx4 v[180:183], v126, s[8:11], s44 offen
    buffer_load_dwordx4 v[184:187], v127, s[8:11], s44 offen
    s_add_u32 s44, s44, 16384
    buffer_load_dwordx4 v[188:191], v126, s[8:11], s44 offen
    buffer_load_dwordx4 v[192:195], v127, s[8:11], s44 offen
    s_add_u32 s44, s44, 16384
    buffer_load_dwordx4 v[196:199], v126, s[8:11], s44 offen
    buffer_load_dwordx4 v[200:203], v127, s[8:11], s44 offen
    s_add_u32 s44, s44, 16384
    buffer_load_dwordx4 v[204:207], v126, s[8:11], s44 offen
    buffer_load_dwordx4 v[208:211], v127, s[8:11], s44 offen
    s_add_u32 s44, s44, 16384
    buffer_load_dwordx4 v[212:215], v126, s[8:11], s44 offen
    buffer_load_dwordx4 v[216:219], v127, s[8:11], s44 offen
    s_add_u32 s44, s44, 16384
    s_waitcnt lgkmcnt(0)
dm_23:
    v_mfma_f32_16x16x32_bf16 v[24:27], v[56:59], v[164:167], v[24:27]
    ds_read_b64_tr_b16 v[88:89], v13 offset:8192
    buffer_load_dwordx4 v[220:223], v126, s[8:11], s44 offen
    v_mfma_f32_16x16x32_bf16 v[40:43], v[56:59], v[168:171], v[40:43]
    ds_read_b64_tr_b16 v[90:91], v13 offset:10240
    buffer_load_dwordx4 v[224:227], v127, s[8:11], s44 offen
    v_mfma_f32_16x16x32_bf16 v[44:47], v[60:63], v[168:171], v[44:47]
    ds_read_b64_tr_b16 v[92:93], v14 offset:8192
    s_add_u32 s44, s44, 16384
    v_mfma_f32_16x16x32_bf16 v[28:31], v[60:63], v[164:167], v[28:31]
    ds_read_b64_tr_b16 v[94:95], v14 offset:10240
    v_mov_b32 v126, v128
    v_mfma_f32_16x16x32_bf16 v[32:35], v[64:67], v[164:167], v[32:35]
    ds_read_b64_tr_b16 v[96:97], v15 offset:8192
    v_mov_b32 v127, v129
    v_mfma_f32_16x16x32_bf16 v[48:51], v[64:67], v[168:171], v[48:51]
    ds_read_b64_tr_b16 v[98:99], v15 offset:10240
    v_mov_b32 v128, v130
    v_mfma_f32_16x16x32_bf16 v[52:55], v[68:71], v[168:171], v[52:55]
    ds_read_b64_tr_b16 v[100:101], v16 offset:8192
    v_mov_b32 v129, v131
    v_mfma_f32_16x16x32_bf16 v[36:39], v[68:71], v[164:167], v[36:39]
    ds_read_b64_tr_b16 v[102:103], v16 offset:10240
    s_waitcnt lgkmcnt(8)
    v_mfma_f32_16x16x32_bf16 v[24:27], v[72:75], v[172:175], v[24:27]
    ds_read_b64_tr_b16 v[104:105], v13 offset:12288
    buffer_load_dwordx4 v[164:167], v126, s[8:11], s44 offen
    v_mfma_f32_16x16x32_bf16 v[40:43], v[72:75], v[176:179], v[40:43]
    ds_read_b64_tr_b16 v[106:107], v13 offset:14336
    buffer_load_dwordx4 v[168:171], v127, s[8:11], s44 offen
    v_mfma_f32_16x16x32_bf16 v[44:47], v[76:79], v[176:179], v[44:47]
    ds_read_b64_tr_b16 v[108:109], v14 offset:12288
    s_add_u32 s44, s44, 16384
    s_waitcnt vmcnt(10)
    v_mfma_f32_16x16x32_bf16 v[28:31], v[76:79], v[172:175], v[28:31]
    ds_read_b64_tr_b16 v[110:111], v14 offset:14336
    v_or3_b32 v17, v180, v184, v188
    v_mfma_f32_16x16x32_bf16 v[32:35], v[80:83], v[172:175], v[32:35]
    ds_read_b64_tr_b16 v[112:113], v15 offset:12288
    v_bitop3_b32 v17, v17, v192, 1 bitop3:0xa8
    v_mfma_f32_16x16x32_bf16 v[48:51], v[80:83], v[176:179], v[48:51]
    ds_read_b64_tr_b16 v[114:115], v15 offset:14336
    v_cmp_ne_u32 vcc, 0, v17
    v_mfma_f32_16x16x32_bf16 v[52:55], v[84:87], v[176:179], v[52:55]
    ds_read_b64_tr_b16 v[116:117], v16 offset:12288
    ds_read_b64_tr_b16 v[118:119], v16 offset:14336
    v_mfma_f32_16x16x32_bf16 v[36:39], v[84:87], v[172:175], v[36:39]
    s_waitcnt lgkmcnt(8)
    s_cbranch_vccnz dm_23f0
dm_23g0:
    v_mfma_f32_16x16x32_bf16 v[24:27], v[88:91], v[180:183], v[24:27]
    ds_read_b64_tr_b16 v[56:57], v13 offset:16384
    buffer_load_dwordx4 v[172:175], v126, s[8:11], s44 offen
    v_mfma_f32_16x16x32_bf16 v[40:43], v[88:91], v[184:187], v[40:43]
    ds_read_b64_tr_b16 v[58:59], v13 offset:18432
    buffer_load_dwordx4 v[176:179], v127, s[8:11], s44 offen
    v_mfma_f32_16x16x32_bf16 v[44:47], v[92:95], v[184:187], v[44:47]
    ds_read_b64_tr_b16 v[60:61], v14 offset:16384
    s_add_u32 s44, s44, 16384
    v_mfma_f32_16x16x32_bf16 v[28:31], v[92:95], v[180:183], v[28:31]
    ds_read_b64_tr_b16 v[62:63], v14 offset:18432
    v_mov_b32 v130, v132
    v_mfma_f32_16x16x32_bf16 v[32:35], v[96:99], v[180:183], v[32:35]
    ds_read_b64_tr_b16 v[64:65], v15 offset:16384
    v_mov_b32 v131, v133
    v_mfma_f32_16x16x32_bf16 v[48:51], v[96:99], v[184:187], v[48:51]
    ds_read_b64_tr_b16 v[66:67], v15 offset:18432
    v_mov_b32 v132, 1073741824
    v_mfma_f32_16x16x32_bf16 v[52:55], v[100:103], v[184:187], v[52:55]
    ds_read_b64_tr_b16 v[68:69], v16 offset:16384
    v_mov_b32 v133, 1073741824
    v_mfma_f32_16x16x32_bf16 v[36:39], v[100:103], v[180:183], v[36:39]
    ds_read_b64_tr_b16 v[70:71], v16 offset:18432
    s_waitcnt lgkmcnt(8)
    v_mfma_f32_16x16x32_bf16 v[24:27], v[104:107], v[188:191], v[24:27]
    ds_read_b64_tr_b16 v[72:73], v13 offset:20480
    buffer_load_dwordx4 v[180:183], v126, s[8:11], s44 offen
    v_mfma_f32_16x16x32_bf16 v[40:43], v[104:107], v[192:195], v[40:43]
    ds_read_b64_tr_b16 v[74:75], v13 offset:22528
    buffer_load_dwordx4 v[184:187], v127, s[8:11], s44 offen
    v_mfma_f32_16x16x32_bf16 v[44:47], v[108:111], v[192:195], v[44:47]
    ds_read_b64_tr_b16 v[76:77], v14 offset:20480
    s_add_u32 s44, s44, 16384
    s_waitcnt vmcnt(10)
    v_mfma_f32_16x16x32_bf16 v[28:31], v[108:111], v[188:191], v[28:31]
    ds_read_b64_tr_b16 v[78:79], v14 offset:22528
    v_or3_b32 v17, v196, v200, v204
    v_mfma_f32_16x16x32_bf16 v[32:35], v[112:115], v[188:191], v[32:35]
    ds_read_b64_tr_b16 v[80:81], v15 offset:20480
    v_bitop3_b32 v17, v17, v208, 1 bitop3:0xa8
    v_mfma_f32_16x16x32_bf16 v[48:51], v[112:115], v[192:195], v[48:51]
    ds_read_b64_tr_b16 v[82:83], v15 offset:22528
    v_cmp_ne_u32 vcc, 0, v17
    v_mfma_f32_16x16x32_bf16 v[52:55], v[116:119], v[192:195], v[52:55]
    ds_read_b64_tr_b16 v[84:85], v16 offset:20480
    ds_read_b64_tr_b16 v[86:87], v16 offset:22528
    v_mfma_f32_16x16x32_bf16 v[36:39], v[116:119], v[188:191], v[36:39]
    s_waitcnt lgkmcnt(8)
    s_cbranch_vccnz dm_23f1
dm_23g1:
    v_mfma_f32_16x16x32_bf16 v[24:27], v[56:59], v[196:199], v[24:27]
    ds_read_b64_tr_b16 v[88:89], v13 offset:24576
    buffer_load_dwordx4 v[188:191], v126, s[8:11], s44 offen
    v_mfma_f32_16x16x32_bf16 v[40:43], v[56:59], v[200:203], v[40:43]
    ds_read_b64_tr_b16 v[90:91], v13 offset:26624
    buffer_load_dwordx4 v[192:195], v127, s[8:11], s44 offen
    v_mfma_f32_16x16x32_bf16 v[44:47], v[60:63], v[200:203], v[44:47]
    ds_read_b64_tr_b16 v[92:93], v14 offset:24576
    s_add_u32 s44, s44, 16384
    v_mfma_f32_16x16x32_bf16 v[28:31], v[60:63], v[196:199], v[28:31]
    ds_read_b64_tr_b16 v[94:95], v14 offset:26624
    v_mfma_f32_16x16x32_bf16 v[32:35], v[64:67], v[196:199], v[32:35]
    ds_read_b64_tr_b16 v[96:97], v15 offset:24576
    s_add_u32 s43, s43, 1
    v_mfma_f32_16x16x32_bf16 v[48:51], v[64:67], v[200:203], v[48:51]
    ds_read_b64_tr_b16 v[98:99], v15 offset:26624
    v_mfma_f32_16x16x32_bf16 v[52:55], v[68:71], v[200:203], v[52:55]
    ds_read_b64_tr_b16 v[100:101], v16 offset:24576
    v_mfma_f32_16x16x32_bf16 v[36:39], v[68:71], v[196:199], v[36:39]
    ds_read_b64_tr_b16 v[102:103], v16 offset:26624
    s_waitcnt lgkmcnt(8)
    v_mfma_f32_16x16x32_bf16 v[24:27], v[72:75], v[204:207], v[24:27]
    ds_read_b64_tr_b16 v[104:105], v13 offset:28672
    buffer_load_dwordx4 v[196:199], v126, s[8:11], s44 offen
    v_mfma_f32_16x16x32_bf16 v[40:43], v[72:75], v[208:211], v[40:43]
    ds_read_b64_tr_b16 v[106:107], v13 offset:30720
    buffer_load_dwordx4 v[200:203], v127, s[8:11], s44 offen
    v_mfma_f32_16x16x32_bf16 v[44:47], v[76:79], v[208:211], v[44:47]
    ds_read_b64_tr_b16 v[108:109], v14 offset:28672
    s_add_u32 s44, s44, 16384
    s_waitcnt vmcnt(10)
    v_mfma_f32_16x16x32_bf16 v[28:31], v[76:79], v[204:207], v[28:31]
    ds_read_b64_tr_b16 v[110:111], v14 offset:30720
    v_add_u32 v13, 32768, v13
    v_or3_b32 v17, v212, v216, v220
    v_mfma_f32_16x16x32_bf16 v[32:35], v[80:83], v[204:207], v[32:35]
    ds_read_b64_tr_b16 v[112:113], v15 offset:28672
    v_add_u32 v14, 32768, v14
    v_bitop3_b32 v17, v17, v224, 1 bitop3:0xa8
    v_mfma_f32_16x16x32_bf16 v[48:51], v[80:83], v[208:211], v[48:51]
    ds_read_b64_tr_b16 v[114:115], v15 offset:30720
    v_add_u32 v15, 32768, v15
    v_cmp_ne_u32 vcc, 0, v17
    v_mfma_f32_16x16x32_bf16 v[52:55], v[84:87], v[208:211], v[52:55]
    ds_read_b64_tr_b16 v[116:117], v16 offset:28672
    ds_read_b64_tr_b16 v[118:119], v16 offset:30720
    s_cmp_eq_u32 s43, 4
    v_mfma_f32_16x16x32_bf16 v[36:39], v[84:87], v[204:207], v[36:39]
    v_add_u32 v16, 32768, v16
    s_waitcnt lgkmcnt(8)
    s_cbranch_vccnz dm_23f2
dm_23g2:
    s_cbranch_scc1 dm_23x
    v_mfma_f32_16x16x32_bf16 v[24:27], v[88:91], v[212:215], v[24:27]
    ds_read_b64_tr_b16 v[56:57], v13 offset:0
    buffer_load_dwordx4 v[204:207], v126, s[8:11], s44 offen
    v_mfma_f32_16x16x32_bf16 v[40:43], v[88:91], v[216:219], v[40:43]
    ds_read_b64_tr_b16 v[58:59], v13 offset:2048
    buffer_load_dwordx4 v[208:211], v127, s[8:11], s44 offen
    v_mfma_f32_16x16x32_bf16 v[44:47], v[92:95], v[216:219], v[44:47]
    ds_read_b64_tr_b16 v[60:61], v14 offset:0
    s_add_u32 s44, s44, 16384
    v_mfma_f32_16x16x32_bf16 v[28:31], v[92:95], v[212:215], v[28:31]
    ds_read_b64_tr_b16 v[62:63], v14 offset:2048
    v_mov_b32 v134, v126
    v_mfma_f32_16x16x32_bf16 v[32:35], v[96:99], v[212:215], v[32:35]
    ds_read_b64_tr_b16 v[64:65], v15 offset:0
    v_mov_b32 v135, v127
    v_mfma_f32_16x16x32_bf16 v[48:51], v[96:99], v[216:219], v[48:51]
    ds_read_b64_tr_b16 v[66:67], v15 offset:2048
    v_mfma_f32_16x16x32_bf16 v[52:55], v[100:103], v[216:219], v[52:55]
    ds_read_b64_tr_b16 v[68:69], v16 offset:0
    v_mfma_f32_16x16x32_bf16 v[36:39], v[100:103], v[212:215], v[36:39]
    ds_read_b64_tr_b16 v[70:71], v16 offset:2048
    s_waitcnt lgkmcnt(8)
    v_mfma_f32_16x16x32_bf16 v[24:27], v[104:107], v[220:223], v[24:27]
    ds_read_b64_tr_b16 v[72:73], v13 offset:4096
    buffer_load_dwordx4 v[212:215], v126, s[8:11], s44 offen
    v_mfma_f32_16x16x32_bf16 v[40:43], v[104:107], v[224:227], v[40:43]
    ds_read_b64_tr_b16 v[74:75], v13 offset:6144
    buffer_load_dwordx4 v[216:219], v127, s[8:11], s44 offen
    v_mfma_f32_16x16x32_bf16 v[44:47], v[108:111], v[224:227], v[44:47]
    ds_read_b64_tr_b16 v[76:77], v14 offset:4096
    s_add_u32 s44, s44, 16384
    s_waitcnt vmcnt(10)
    v_mfma_f32_16x16x32_bf16 v[28:31], v[108:111], v[220:223], v[28:31]
    ds_read_b64_tr_b16 v[78:79], v14 offset:6144
    v_or3_b32 v17, v164, v168, v172
    v_mfma_f32_16x16x32_bf16 v[32:35], v[112:115], v[220:223], v[32:35]
    ds_read_b64_tr_b16 v[80:81], v15 offset:4096
    v_bitop3_b32 v17, v17, v176, 1 bitop3:0xa8
    v_mfma_f32_16x16x32_bf16 v[48:51], v[112:115], v[224:227], v[48:51]
    ds_read_b64_tr_b16 v[82:83], v15 offset:6144
    v_cmp_ne_u32 vcc, 0, v17
    v_mfma_f32_16x16x32_bf16 v[52:55], v[116:119], v[224:227], v[52:55]
    ds_read_b64_tr_b16 v[84:85], v16 offset:4096
    ds_read_b64_tr_b16 v[86:87], v16 offset:6144
    v_mfma_f32_16x16x32_bf16 v[36:39], v[116:119], v[220:223], v[36:39]
    s_waitcnt lgkmcnt(8)
    s_cbranch_vccnz dm_23f3
dm_23g3:
    s_branch dm_23
dm_23f0:
    s_cselect_b32 s50, 1, 0
dm_23h0:
    s_sleep 2
    s_sub_u32 s44, s44, 114688
    buffer_load_dwordx4 v[180:183], v134, s[8:11], s44 offen sc1
    buffer_load_dwordx4 v[184:187], v135, s[8:11], s44 offen sc1
    s_add_u32 s44, s44, 16384
    buffer_load_dwordx4 v[188:191], v134, s[8:11], s44 offen sc1
    buffer_load_dwordx4 v[192:195], v135, s[8:11], s44 offen sc1
    s_add_u32 s44, s44, 16384
    buffer_load_dwordx4 v[196:199], v134, s[8:11], s44 offen sc1
    buffer_load_dwordx4 v[200:203], v135, s[8:11], s44 offen sc1
    s_add_u32 s44, s44, 16384
    buffer_load_dwordx4 v[204:207], v134, s[8:11], s44 offen sc1
    buffer_load_dwordx4 v[208:211], v135, s[8:11], s44 offen sc1
    s_add_u32 s44, s44, 16384
    buffer_load_dwordx4 v[212:215], v134, s[8:11], s44 offen sc1
    buffer_load_dwordx4 v[216:219], v135, s[8:11], s44 offen sc1
    s_add_u32 s44, s44, 16384
    buffer_load_dwordx4 v[220:223], v134, s[8:11], s44 offen sc1
    buffer_load_dwordx4 v[224:227], v135, s[8:11], s44 offen sc1
    s_add_u32 s44, s44, 16384
    buffer_load_dwordx4 v[164:167], v126, s[8:11], s44 offen sc1
    buffer_load_dwordx4 v[168:171], v127, s[8:11], s44 offen sc1
    s_add_u32 s44, s44, 16384
    s_waitcnt vmcnt(10)
    v_or3_b32 v17, v180, v184, v188
    v_bitop3_b32 v17, v17, v192, 1 bitop3:0xa8
    v_cmp_ne_u32 vcc, 0, v17
    s_add_u32 s53, s53, 1
    s_cmp_ge_u32 s53, s61
    s_cselect_b32 s61, 0, s61
    s_cbranch_scc1 dm_23k0
    s_cbranch_vccnz dm_23h0
dm_23k0:
    s_cmp_eq_u32 s50, 1
    s_branch dm_23g0
dm_23f1:
    s_cselect_b32 s50, 1, 0
dm_23h1:
    s_sleep 2
    s_sub_u32 s44, s44, 114688
    buffer_load_dwordx4 v[196:199], v134, s[8:11], s44 offen sc1
    buffer_load_dwordx4 v[200:203], v135, s[8:11], s44 offen sc1
    s_add_u32 s44, s44, 16384
    buffer_load_dwordx4 v[204:207], v134, s[8:11], s44 offen sc1
    buffer_load_dwordx4 v[208:211], v135, s[8:11], s44 offen sc1
    s_add_u32 s44, s44, 16384
    buffer_load_dwordx4 v[212:215], v134, s[8:11], s44 offen sc1
    buffer_load_dwordx4 v[216:219], v135, s[8:11], s44 offen sc1
    s_add_u32 s44, s44, 16384
    buffer_load_dwordx4 v[220:223], v134, s[8:11], s44 offen sc1
    buffer_load_dwordx4 v[224:227], v135, s[8:11], s44 offen sc1
    s_add_u32 s44, s44, 16384
    buffer_load_dwordx4 v[164:167], v126, s[8:11], s44 offen sc1
    buffer_load_dwordx4 v[168:171], v127, s[8:11], s44 offen sc1
    s_add_u32 s44, s44, 16384
    buffer_load_dwordx4 v[172:175], v126, s[8:11], s44 offen sc1
    buffer_load_dwordx4 v[176:179], v127, s[8:11], s44 offen sc1
    s_add_u32 s44, s44, 16384
    buffer_load_dwordx4 v[180:183], v126, s[8:11], s44 offen sc1
    buffer_load_dwordx4 v[184:187], v127, s[8:11], s44 offen sc1
    s_add_u32 s44, s44, 16384
    s_waitcnt vmcnt(10)
    v_or3_b32 v17, v196, v200, v204
    v_bitop3_b32 v17, v17, v208, 1 bitop3:0xa8
    v_cmp_ne_u32 vcc, 0, v17
    s_add_u32 s53, s53, 1
    s_cmp_ge_u32 s53, s61
    s_cselect_b32 s61, 0, s61
    s_cbranch_scc1 dm_23k1
    s_cbranch_vccnz dm_23h1
dm_23k1:
    s_cmp_eq_u32 s50, 1
    s_branch dm_23g1
dm_23f2:
    s_cselect_b32 s50, 1, 0
dm_23h2:
    s_sleep 2
    s_sub_u32 s44, s44, 114688
    buffer_load_dwordx4 v[212:215], v134, s[8:11], s44 offen sc1
    buffer_load_dwordx4 v[216:219], v135, s[8:11], s44 offen sc1
    s_add_u32 s44, s44, 16384
    buffer_load_dwordx4 v[220:223], v134, s[8:11], s44 offen sc1
    buffer_load_dwordx4 v[224:227], v135, s[8:11], s44 offen sc1
    s_add_u32 s44, s44, 16384
    buffer_load_dwordx4 v[164:167], v126, s[8:11], s44 offen sc1
    buffer_load_dwordx4 v[168:171], v127, s[8:11], s44 offen sc1
    s_add_u32 s44, s44, 16384
    buffer_load_dwordx4 v[172:175], v126, s[8:11], s44 offen sc1
    buffer_load_dwordx4 v[176:179], v127, s[8:11], s44 offen sc1
    s_add_u32 s44, s44, 16384
    buffer_load_dwordx4 v[180:183], v126, s[8:11], s44 offen sc1
    buffer_load_dwordx4 v[184:187], v127, s[8:11], s44 offen sc1
    s_add_u32 s44, s44, 16384
    buffer_load_dwordx4 v[188:191], v126, s[8:11], s44 offen sc1
    buffer_load_dwordx4 v[192:195], v127, s[8:11], s44 offen sc1
    s_add_u32 s44, s44, 16384
    buffer_load_dwordx4 v[196:199], v126, s[8:11], s44 offen sc1
    buffer_load_dwordx4 v[200:203], v127, s[8:11], s44 offen sc1
    s_add_u32 s44, s44, 16384
    s_waitcnt vmcnt(10)
    v_or3_b32 v17, v212, v216, v220
    v_bitop3_b32 v17, v17, v224, 1 bitop3:0xa8
    v_cmp_ne_u32 vcc, 0, v17
    s_add_u32 s53, s53, 1
    s_cmp_ge_u32 s53, s61
    s_cselect_b32 s61, 0, s61
    s_cbranch_scc1 dm_23k2
    s_cbranch_vccnz dm_23h2
dm_23k2:
    s_cmp_eq_u32 s50, 1
    s_branch dm_23g2
dm_23f3:
    s_cselect_b32 s50, 1, 0
dm_23h3:
    s_sleep 2
    s_sub_u32 s44, s44, 114688
    buffer_load_dwordx4 v[164:167], v134, s[8:11], s44 offen sc1
    buffer_load_dwordx4 v[168:171], v135, s[8:11], s44 offen sc1
    s_add_u32 s44, s44, 16384
    buffer_load_dwordx4 v[172:175], v134, s[8:11], s44 offen sc1
    buffer_load_dwordx4 v[176:179], v135, s[8:11], s44 offen sc1
    s_add_u32 s44, s44, 16384
    buffer_load_dwordx4 v[180:183], v134, s[8:11], s44 offen sc1
    buffer_load_dwordx4 v[184:187], v135, s[8:11], s44 offen sc1
    s_add_u32 s44, s44, 16384
    buffer_load_dwordx4 v[188:191], v134, s[8:11], s44 offen sc1
    buffer_load_dwordx4 v[192:195], v135, s[8:11], s44 offen sc1
    s_add_u32 s44, s44, 16384
    buffer_load_dwordx4 v[196:199], v134, s[8:11], s44 offen sc1
    buffer_load_dwordx4 v[200:203], v135, s[8:11], s44 offen sc1
    s_add_u32 s44, s44, 16384
    buffer_load_dwordx4 v[204:207], v134, s[8:11], s44 offen sc1
    buffer_load_dwordx4 v[208:211], v135, s[8:11], s44 offen sc1
    s_add_u32 s44, s44, 16384
    buffer_load_dwordx4 v[212:215], v134, s[8:11], s44 offen sc1
    buffer_load_dwordx4 v[216:219], v135, s[8:11], s44 offen sc1
    s_add_u32 s44, s44, 16384
    s_waitcnt vmcnt(10)
    v_or3_b32 v17, v164, v168, v172
    v_bitop3_b32 v17, v17, v176, 1 bitop3:0xa8
    v_cmp_ne_u32 vcc, 0, v17
    s_add_u32 s53, s53, 1
    s_cmp_ge_u32 s53, s61
    s_cselect_b32 s61, 0, s61
    s_cbranch_scc1 dm_23k3
    s_cbranch_vccnz dm_23h3
dm_23k3:
    s_cmp_eq_u32 s50, 1
    s_branch dm_23g3
dm_23x:
    v_mfma_f32_16x16x32_bf16 v[24:27], v[88:91], v[212:215], v[24:27]
    v_mfma_f32_16x16x32_bf16 v[40:43], v[88:91], v[216:219], v[40:43]
    v_mfma_f32_16x16x32_bf16 v[44:47], v[92:95], v[216:219], v[44:47]
    v_mfma_f32_16x16x32_bf16 v[28:31], v[92:95], v[212:215], v[28:31]
    v_mfma_f32_16x16x32_bf16 v[32:35], v[96:99], v[212:215], v[32:35]
    v_mfma_f32_16x16x32_bf16 v[48:51], v[96:99], v[216:219], v[48:51]
    v_mfma_f32_16x16x32_bf16 v[52:55], v[100:103], v[216:219], v[52:55]
    v_mfma_f32_16x16x32_bf16 v[36:39], v[100:103], v[212:215], v[36:39]
    s_waitcnt lgkmcnt(0)
    v_mfma_f32_16x16x32_bf16 v[24:27], v[104:107], v[220:223], v[24:27]
    s_add_u32 s44, s62, 0x5c8000
    v_mfma_f32_16x16x32_bf16 v[40:43], v[104:107], v[224:227], v[40:43]
    s_addc_u32 s45, s63, 0
    v_mfma_f32_16x16x32_bf16 v[44:47], v[108:111], v[224:227], v[44:47]
    v_mfma_f32_16x16x32_bf16 v[28:31], v[108:111], v[220:223], v[28:31]
    s_mov_b32 s46, 0x6000
    v_mfma_f32_16x16x32_bf16 v[32:35], v[112:115], v[220:223], v[32:35]
    v_mfma_f32_16x16x32_bf16 v[48:51], v[112:115], v[224:227], v[48:51]
    s_mov_b32 s47, 0x20000
    v_mfma_f32_16x16x32_bf16 v[52:55], v[116:119], v[224:227], v[52:55]
    v_mfma_f32_16x16x32_bf16 v[36:39], v[116:119], v[220:223], v[36:39]
    s_add_u32 s36, s39, 0
    v_cvt_pk_bf16_f32 v148, v24, v25
    v_cvt_pk_bf16_f32 v149, v26, v27
    v_cvt_pk_bf16_f32 v150, v28, v29
    v_cvt_pk_bf16_f32 v151, v30, v31
    v_and_b32 v148, -2, v148
    buffer_store_dwordx4 v[148:151], v2, s[16:19], s36 offen offset:0 sc1
    v_cvt_pk_bf16_f32 v152, v32, v33
    v_cvt_pk_bf16_f32 v153, v34, v35
    v_cvt_pk_bf16_f32 v154, v36, v37
    v_cvt_pk_bf16_f32 v155, v38, v39
    v_and_b32 v152, -2, v152
    buffer_store_dwordx4 v[152:155], v2, s[16:19], s36 offen offset:1024 sc1
    s_add_u32 s36, s39, 65536
    v_cvt_pk_bf16_f32 v156, v40, v41
    v_cvt_pk_bf16_f32 v157, v42, v43
    v_cvt_pk_bf16_f32 v158, v44, v45
    v_cvt_pk_bf16_f32 v159, v46, v47
    v_and_b32 v156, -2, v156
    buffer_store_dwordx4 v[156:159], v2, s[16:19], s36 offen offset:0 sc1
    v_cvt_pk_bf16_f32 v160, v48, v49
    v_cvt_pk_bf16_f32 v161, v50, v51
    v_cvt_pk_bf16_f32 v162, v52, v53
    v_cvt_pk_bf16_f32 v163, v54, v55
    v_and_b32 v160, -2, v160
    buffer_store_dwordx4 v[160:163], v2, s[16:19], s36 offen offset:1024 sc1
    s_barrier
    s_lshl_b32 s36, s37, 11
    v_add_u32 v7, s36, v2
    ds_write_b128 v7, v[148:151] offset:0
    ds_write_b128 v7, v[152:155] offset:1024
    ds_write_b128 v7, v[156:159] offset:2048
    ds_write_b128 v7, v[160:163] offset:3072
    v_lshlrev_b32 v24, 16, v148
    v_and_b32 v25, 0xffff0000, v148
    v_lshlrev_b32 v26, 16, v149
    v_and_b32 v27, 0xffff0000, v149
    v_lshlrev_b32 v28, 16, v150
    v_and_b32 v29, 0xffff0000, v150
    v_lshlrev_b32 v30, 16, v151
    v_and_b32 v31, 0xffff0000, v151
    v_lshlrev_b32 v32, 16, v152
    v_and_b32 v33, 0xffff0000, v152
    v_lshlrev_b32 v34, 16, v153
    v_and_b32 v35, 0xffff0000, v153
    v_lshlrev_b32 v36, 16, v154
    v_and_b32 v37, 0xffff0000, v154
    v_lshlrev_b32 v38, 16, v155
    v_and_b32 v39, 0xffff0000, v155
    v_lshlrev_b32 v40, 16, v156
    v_and_b32 v41, 0xffff0000, v156
    v_lshlrev_b32 v42, 16, v157
    v_and_b32 v43, 0xffff0000, v157
    v_lshlrev_b32 v44, 16, v158
    v_and_b32 v45, 0xffff0000, v158
    v_lshlrev_b32 v46, 16, v159
    v_and_b32 v47, 0xffff0000, v159
    v_lshlrev_b32 v48, 16, v160
    v_and_b32 v49, 0xffff0000, v160
    v_lshlrev_b32 v50, 16, v161
    v_and_b32 v51, 0xffff0000, v161
    v_lshlrev_b32 v52, 16, v162
    v_and_b32 v53, 0xffff0000, v162
    v_lshlrev_b32 v54, 16, v163
    v_and_b32 v55, 0xffff0000, v163
    s_add_u32 s53, s55, 512
    v_mov_b32 v8, 1
    v_mov_b32 v9, 162816
    v_mov_b32 v11, 0
    s_mov_b64 exec, 1
    s_waitcnt vmcnt(0)
    ds_add_rtn_u32 v10, v9, v8
    s_waitcnt lgkmcnt(0)
    v_readfirstlane_b32 s54, v10
    s_nop 0
    s_and_b32 s54, s54, 3
    s_cmp_lg_u32 s54, 3
    s_cbranch_scc1 pub_24
    buffer_atomic_add v8, v11, s[56:59], s53 offen sc1
    v_mov_b32 v9, 162872
    ds_add_u32 v9, v8
pub_24:
    s_mov_b64 exec, -1
    s_waitcnt lgkmcnt(0)
    s_barrier
    v_pk_add_f32 v[142:143], v[24:25], v[26:27]
    v_pk_mul_f32 v[136:137], v[24:25], v[24:25]
    v_pk_fma_f32 v[136:137], v[26:27], v[26:27], v[136:137]
    v_pk_add_f32 v[142:143], v[142:143], v[28:29]
    v_pk_fma_f32 v[136:137], v[28:29], v[28:29], v[136:137]
    v_pk_add_f32 v[142:143], v[142:143], v[30:31]
    v_pk_fma_f32 v[136:137], v[30:31], v[30:31], v[136:137]
    v_pk_add_f32 v[142:143], v[142:143], v[32:33]
    v_pk_fma_f32 v[136:137], v[32:33], v[32:33], v[136:137]
    v_pk_add_f32 v[142:143], v[142:143], v[34:35]
    v_pk_fma_f32 v[136:137], v[34:35], v[34:35], v[136:137]
    v_pk_add_f32 v[142:143], v[142:143], v[36:37]
    v_pk_fma_f32 v[136:137], v[36:37], v[36:37], v[136:137]
    v_pk_add_f32 v[142:143], v[142:143], v[38:39]
    v_pk_fma_f32 v[136:137], v[38:39], v[38:39], v[136:137]
    v_add_f32 v138, v142, v143
    v_add_f32 v139, v136, v137
    v_mov_b32 v142, v138
    v_mov_b32 v143, v139
    s_nop 0
    v_permlane16_swap_b32 v138, v142
    v_permlane16_swap_b32 v139, v143
    v_pk_add_f32 v[138:139], v[138:139], v[142:143]
    v_mov_b32 v142, v138
    v_mov_b32 v143, v139
    s_nop 0
    v_permlane32_swap_b32 v138, v142
    v_permlane32_swap_b32 v139, v143
    v_pk_add_f32 v[138:139], v[138:139], v[142:143]
    v_pk_add_f32 v[142:143], v[40:41], v[42:43]
    v_pk_mul_f32 v[136:137], v[40:41], v[40:41]
    v_pk_fma_f32 v[136:137], v[42:43], v[42:43], v[136:137]
    v_pk_add_f32 v[142:143], v[142:143], v[44:45]
    v_pk_fma_f32 v[136:137], v[44:45], v[44:45], v[136:137]
    v_pk_add_f32 v[142:143], v[142:143], v[46:47]
    v_pk_fma_f32 v[136:137], v[46:47], v[46:47], v[136:137]
    v_pk_add_f32 v[142:143], v[142:143], v[48:49]
    v_pk_fma_f32 v[136:137], v[48:49], v[48:49], v[136:137]
    v_pk_add_f32 v[142:143], v[142:143], v[50:51]
    v_pk_fma_f32 v[136:137], v[50:51], v[50:51], v[136:137]
    v_pk_add_f32 v[142:143], v[142:143], v[52:53]
    v_pk_fma_f32 v[136:137], v[52:53], v[52:53], v[136:137]
    v_pk_add_f32 v[142:143], v[142:143], v[54:55]
    v_pk_fma_f32 v[136:137], v[54:55], v[54:55], v[136:137]
    v_add_f32 v140, v142, v143
    v_add_f32 v141, v136, v137
    v_mov_b32 v142, v140
    v_mov_b32 v143, v141
    s_nop 0
    v_permlane16_swap_b32 v140, v142
    v_permlane16_swap_b32 v141, v143
    v_pk_add_f32 v[140:141], v[140:141], v[142:143]
    v_mov_b32 v142, v140
    v_mov_b32 v143, v141
    s_nop 0
    v_permlane32_swap_b32 v140, v142
    v_permlane32_swap_b32 v141, v143
    v_pk_add_f32 v[140:141], v[140:141], v[142:143]
    v_cmp_eq_u32 vcc, 0, v23
    s_nop 1
    v_cndmask_b32 v138, v140, v138, vcc
    v_cndmask_b32 v139, v141, v139, vcc
    s_lshr_b32 s53, s29, 3
    s_lshl_b32 s53, s53, 14
    s_and_b32 s40, s29, 7
    s_lshl_b32 s40, s40, 10
    s_add_u32 s40, s40, s53
    s_lshl_b32 s36, s34, 8
    s_add_u32 s40, s40, s36
    v_lshlrev_b32 v7, 3, v1
    s_bfm_b64 exec, 32, 0
    buffer_store_dwordx2 v[138:139], v7, s[44:47], s40 offen sc1
    s_mov_b64 exec, -1
    s_lshr_b32 s34, s30, 1
    s_and_b32 s35, s30, 1
    v_and_b32 v22, 15, v1
    v_lshrrev_b32 v23, 4, v1
    s_mul_i32 s37, s34, 4
    s_mul_i32 s38, s29, 14
    s_mul_i32 s36, s35, 7
    s_add_u32 s38, s38, s36
    s_mul_i32 s36, s34, 8192
    v_add_u32 v12, s36, v2
    v_lshrrev_b32 v6, 2, v1
    v_mul_u32_u24 v13, 448, v6
    v_and_b32 v7, 3, v1
    v_lshl_add_u32 v13, v7, 3, v13
    v_add_u32 v13, 73728, v13
    s_mul_i32 s36, s35, 224
    v_add_u32 v13, s36, v13
    v_bfe_u32 v6, v1, 4, 1
    v_lshlrev_b32 v6, 5, v6
    s_cmp_eq_u32 s35, 0
    s_cselect_b32 s36, 1, -1
    v_mul_lo_u32 v6, v6, s36
    v_sub_u32 v14, v13, v6
    v_add_u32 v13, v13, v6
    v_mov_b32 v17, v12
    s_mov_b32 s42, 0
    s_mov_b32 s43, 0
    s_mov_b32 s48, 57344
    v_add_u32 v18, 57344, v13
    v_add_u32 v19, 57344, v14
    ds_read_b128 v[136:139], v17 offset:0
    ds_read_b128 v[140:143], v17 offset:2048
    ds_read_b128 v[144:147], v17 offset:4096
    ds_read_b128 v[148:151], v17 offset:6144
    ds_read_b64_tr_b16 v[152:153], v18 offset:0
    ds_read_b64_tr_b16 v[154:155], v18 offset:7168
    ds_read_b64_tr_b16 v[156:157], v19 offset:32
    ds_read_b64_tr_b16 v[158:159], v19 offset:7200
    ds_read_b64_tr_b16 v[160:161], v18 offset:64
    ds_read_b64_tr_b16 v[162:163], v18 offset:7232
    ds_read_b64_tr_b16 v[164:165], v19 offset:96
    ds_read_b64_tr_b16 v[166:167], v19 offset:7264
    ds_read_b64_tr_b16 v[168:169], v18 offset:128
    ds_read_b64_tr_b16 v[170:171], v18 offset:7296
    ds_read_b64_tr_b16 v[172:173], v19 offset:160
    ds_read_b64_tr_b16 v[174:175], v19 offset:7328
    ds_read_b64_tr_b16 v[176:177], v18 offset:192
    ds_read_b64_tr_b16 v[178:179], v18 offset:7360
    s_waitcnt lgkmcnt(12)
    v_mfma_f32_16x16x32_bf16 v[24:27], v[152:155], v[136:139], 0
    ds_read_b128 v[180:183], v17 offset:1024
    s_add_u32 s42, s42, 16384
    v_mfma_f32_16x16x32_bf16 v[52:55], v[152:155], v[140:143], 0
    ds_read_b128 v[184:187], v17 offset:3072
    s_cmp_eq_u32 s42, 49152
    v_mfma_f32_16x16x32_bf16 v[80:83], v[152:155], v[144:147], 0
    ds_read_b128 v[188:191], v17 offset:5120
    s_cselect_b32 s42, 0, s42
    v_mfma_f32_16x16x32_bf16 v[108:111], v[152:155], v[148:151], 0
    ds_read_b128 v[192:195], v17 offset:7168
    s_waitcnt lgkmcnt(14)
    v_mfma_f32_16x16x32_bf16 v[112:115], v[156:159], v[148:151], 0
    ds_read_b64_tr_b16 v[196:197], v18 offset:14336
    s_add_u32 s48, s48, 28672
    v_mfma_f32_16x16x32_bf16 v[84:87], v[156:159], v[144:147], 0
    ds_read_b64_tr_b16 v[198:199], v18 offset:21504
    s_cmp_eq_u32 s48, 86016
    v_mfma_f32_16x16x32_bf16 v[56:59], v[156:159], v[140:143], 0
    ds_read_b64_tr_b16 v[200:201], v19 offset:14368
    s_cselect_b32 s48, 0, s48
    v_mfma_f32_16x16x32_bf16 v[28:31], v[156:159], v[136:139], 0
    ds_read_b64_tr_b16 v[202:203], v19 offset:21536
    s_waitcnt lgkmcnt(8)
    v_mfma_f32_16x16x32_bf16 v[32:35], v[160:163], v[136:139], 0
    ds_read_b64_tr_b16 v[204:205], v18 offset:14400
    v_add_u32 v17, s42, v12
    v_mfma_f32_16x16x32_bf16 v[60:63], v[160:163], v[140:143], 0
    ds_read_b64_tr_b16 v[206:207], v18 offset:21568
    v_mfma_f32_16x16x32_bf16 v[88:91], v[160:163], v[144:147], 0
    ds_read_b64_tr_b16 v[208:209], v19 offset:14432
    v_mfma_f32_16x16x32_bf16 v[116:119], v[160:163], v[148:151], 0
    ds_read_b64_tr_b16 v[210:211], v19 offset:21600
    v_mfma_f32_16x16x32_bf16 v[120:123], v[164:167], v[148:151], 0
    ds_read_b64_tr_b16 v[212:213], v18 offset:14464
    v_mfma_f32_16x16x32_bf16 v[92:95], v[164:167], v[144:147], 0
    ds_read_b64_tr_b16 v[214:215], v18 offset:21632
    v_mfma_f32_16x16x32_bf16 v[64:67], v[164:167], v[140:143], 0
    ds_read_b64_tr_b16 v[216:217], v19 offset:14496
    v_mfma_f32_16x16x32_bf16 v[36:39], v[164:167], v[136:139], 0
    ds_read_b64_tr_b16 v[218:219], v19 offset:21664
    v_add_u32 v19, s48, v14
    v_mfma_f32_16x16x32_bf16 v[40:43], v[168:171], v[136:139], 0
    ds_read_b64_tr_b16 v[220:221], v18 offset:14528
    v_mfma_f32_16x16x32_bf16 v[68:71], v[168:171], v[140:143], 0
    ds_read_b64_tr_b16 v[222:223], v18 offset:21696
    v_add_u32 v18, s48, v13
    v_mfma_f32_16x16x32_bf16 v[96:99], v[168:171], v[144:147], 0
    v_mfma_f32_16x16x32_bf16 v[124:127], v[168:171], v[148:151], 0
    v_mfma_f32_16x16x32_bf16 v[128:131], v[172:175], v[148:151], 0
    v_mfma_f32_16x16x32_bf16 v[100:103], v[172:175], v[144:147], 0
    v_mfma_f32_16x16x32_bf16 v[72:75], v[172:175], v[140:143], 0
    v_mfma_f32_16x16x32_bf16 v[44:47], v[172:175], v[136:139], 0
    v_mfma_f32_16x16x32_bf16 v[48:51], v[176:179], v[136:139], 0
    v_mfma_f32_16x16x32_bf16 v[76:79], v[176:179], v[140:143], 0
    v_mfma_f32_16x16x32_bf16 v[104:107], v[176:179], v[144:147], 0
    v_mfma_f32_16x16x32_bf16 v[132:135], v[176:179], v[148:151], 0
    s_waitcnt lgkmcnt(12)
    v_mfma_f32_16x16x32_bf16 v[24:27], v[196:199], v[180:183], v[24:27]
    s_add_u32 s43, s43, 1
    s_mul_i32 s36, s35, 448
    s_add_u32 s36, s36, 159744
    v_lshlrev_b32 v6, 4, v23
    v_mfma_f32_16x16x32_bf16 v[52:55], v[196:199], v[184:187], v[52:55]
    v_add_u32 v6, s36, v6
    s_lshl_b32 s36, s37, 8
    s_add_u32 s36, s36, 160768
    v_lshlrev_b32 v7, 4, v22
    v_mfma_f32_16x16x32_bf16 v[80:83], v[196:199], v[188:191], v[80:83]
    v_add_u32 v7, s36, v7
    s_add_u32 s16, s62, 0x400000
    s_addc_u32 s17, s63, 0
    s_mov_b32 s18, 0x1be000
    v_mfma_f32_16x16x32_bf16 v[108:111], v[196:199], v[192:195], v[108:111]
    s_mov_b32 s19, 0x20000
    s_mul_i32 s39, s37, 229376
    s_lshr_b32 s36, s38, 1
    s_waitcnt lgkmcnt(0)
    v_mfma_f32_16x16x32_bf16 v[112:115], v[200:203], v[192:195], v[112:115]
    s_add_u32 s36, s36, 0
    s_lshr_b32 s53, s36, 3
    s_lshl_b32 s53, s53, 14
    s_and_b32 s44, s36, 7
    v_mfma_f32_16x16x32_bf16 v[84:87], v[200:203], v[188:191], v[84:87]
    s_lshl_b32 s44, s44, 10
    s_add_u32 s44, s44, s53
    s_add_u32 s44, s44, s39
    s_lshr_b32 s36, s38, 1
    v_mfma_f32_16x16x32_bf16 v[56:59], v[200:203], v[184:187], v[56:59]
    s_add_u32 s36, s36, 1
    s_lshr_b32 s53, s36, 3
    s_lshl_b32 s53, s53, 14
    s_and_b32 s45, s36, 7
    v_mfma_f32_16x16x32_bf16 v[28:31], v[200:203], v[180:183], v[28:31]
    s_lshl_b32 s45, s45, 10
    s_add_u32 s45, s45, s53
    s_add_u32 s45, s45, s39
    s_lshr_b32 s36, s38, 1
    v_mfma_f32_16x16x32_bf16 v[32:35], v[204:207], v[180:183], v[32:35]
    s_add_u32 s36, s36, 2
    s_lshr_b32 s53, s36, 3
    s_lshl_b32 s53, s53, 14
    s_and_b32 s46, s36, 7
    v_mfma_f32_16x16x32_bf16 v[60:63], v[204:207], v[184:187], v[60:63]
    s_lshl_b32 s46, s46, 10
    s_add_u32 s46, s46, s53
    s_add_u32 s46, s46, s39
    s_lshr_b32 s36, s38, 1
    v_mfma_f32_16x16x32_bf16 v[88:91], v[204:207], v[188:191], v[88:91]
    s_add_u32 s36, s36, 3
    s_lshr_b32 s53, s36, 3
    s_lshl_b32 s53, s53, 14
    s_and_b32 s47, s36, 7
    v_mfma_f32_16x16x32_bf16 v[116:119], v[204:207], v[192:195], v[116:119]
    s_lshl_b32 s47, s47, 10
    s_add_u32 s47, s47, s53
    s_add_u32 s47, s47, s39
    v_lshrrev_b32 v226, 2, v1
    v_mfma_f32_16x16x32_bf16 v[120:123], v[208:211], v[192:195], v[120:123]
    v_mul_u32_u24 v240, 256, v226
    v_and_b32 v227, 3, v1
    v_lshl_add_u32 v240, v227, 3, v240
    v_add_u32 v240, 49152, v240
    v_mfma_f32_16x16x32_bf16 v[92:95], v[208:211], v[188:191], v[92:95]
    v_and_b32 v226, 7, v226
    s_mul_i32 s36, s35, 4
    s_add_u32 s36, s36, 3
    v_xor_b32 v227, s36, v226
    v_mfma_f32_16x16x32_bf16 v[64:67], v[208:211], v[184:187], v[64:67]
    v_lshl_add_u32 v243, v227, 5, v240
    s_mul_i32 s36, s35, 4
    s_add_u32 s36, s36, 2
    v_xor_b32 v227, s36, v226
    v_mfma_f32_16x16x32_bf16 v[36:39], v[208:211], v[180:183], v[36:39]
    v_lshl_add_u32 v242, v227, 5, v240
    s_mul_i32 s36, s35, 4
    s_add_u32 s36, s36, 1
    v_xor_b32 v227, s36, v226
    v_mfma_f32_16x16x32_bf16 v[40:43], v[212:215], v[180:183], v[40:43]
    v_lshl_add_u32 v241, v227, 5, v240
    s_mul_i32 s36, s35, 4
    s_add_u32 s36, s36, 0
    v_xor_b32 v227, s36, v226
    v_mfma_f32_16x16x32_bf16 v[68:71], v[212:215], v[184:187], v[68:71]
    v_lshl_add_u32 v240, v227, 5, v240
    s_lshl_b32 s38, s33, 3
    s_lshl_b32 s36, s35, 2
    s_add_u32 s38, s38, s36
    v_mfma_f32_16x16x32_bf16 v[96:99], v[212:215], v[188:191], v[96:99]
    s_lshr_b32 s36, s38, 1
    s_lshr_b32 s53, s36, 3
    s_lshl_b32 s53, s53, 14
    s_and_b32 s39, s36, 7
    v_mfma_f32_16x16x32_bf16 v[124:127], v[212:215], v[192:195], v[124:127]
    s_lshl_b32 s39, s39, 10
    s_add_u32 s39, s39, s53
    s_lshl_b32 s36, s37, 16
    s_add_u32 s39, s39, s36
    v_mfma_f32_16x16x32_bf16 v[128:131], v[216:219], v[192:195], v[128:131]
    s_lshl_b32 s40, s31, 17
    s_add_u32 s40, s40, s39
    s_xor_b32 s41, s31, 1
    s_lshl_b32 s41, s41, 17
    v_mfma_f32_16x16x32_bf16 v[100:103], v[216:219], v[188:191], v[100:103]
    s_add_u32 s41, s41, s39
    s_mov_b32 s84, s62
    s_mov_b32 s85, s63
    s_mov_b32 s86, 0x7e000
    v_mfma_f32_16x16x32_bf16 v[72:75], v[216:219], v[184:187], v[72:75]
    s_mov_b32 s87, 0x20000
    s_add_u32 s88, s62, 0x80000
    s_addc_u32 s89, s63, 0
    s_mov_b32 s90, 0x7e000
    v_mfma_f32_16x16x32_bf16 v[44:47], v[216:219], v[180:183], v[44:47]
    s_mov_b32 s91, 0x20000
    s_lshl_b32 s36, s37, 1
    s_add_u32 s36, s36, s35
    s_lshl_b32 s36, s36, 10
    v_mfma_f32_16x16x32_bf16 v[48:51], v[220:223], v[180:183], v[48:51]
    v_add_u32 v244, s36, v2
    v_mov_b32 v245, 1
    v_mov_b32 v246, 162880
    v_lshrrev_b32 v238, 1, v23
    v_mfma_f32_16x16x32_bf16 v[76:79], v[220:223], v[184:187], v[76:79]
    v_lshlrev_b32 v238, 8, v238
    v_lshl_add_u32 v238, v22, 4, v238
    v_and_b32 v224, 1, v23
    v_lshl_add_u32 v238, v224, 3, v238
    v_mfma_f32_16x16x32_bf16 v[104:107], v[220:223], v[188:191], v[104:107]
    v_mfma_f32_16x16x32_bf16 v[132:135], v[220:223], v[192:195], v[132:135]
    s_add_u32 s53, s55, 1408
    v_mov_b32 v8, 1
    v_mov_b32 v9, 162864
    v_mov_b32 v11, 0
    s_mov_b64 exec, 1
    s_waitcnt vmcnt(0)
    ds_add_rtn_u32 v10, v9, v8
    s_waitcnt lgkmcnt(0)
    v_readfirstlane_b32 s54, v10
    s_nop 0
    s_and_b32 s54, s54, 3
    s_cmp_lg_u32 s54, 3
    s_cbranch_scc1 pub_25
    buffer_atomic_add v8, v11, s[56:59], s53 offen sc1
pub_25:
    s_mov_b64 exec, -1
    s_barrier
    ds_read_b128 v[136:139], v17 offset:0
    ds_read_b128 v[140:143], v17 offset:2048
    ds_read_b128 v[144:147], v17 offset:4096
    ds_read_b128 v[148:151], v17 offset:6144
    ds_read_b64_tr_b16 v[152:153], v18 offset:0
    ds_read_b64_tr_b16 v[154:155], v18 offset:7168
    ds_read_b64_tr_b16 v[156:157], v19 offset:32
    ds_read_b64_tr_b16 v[158:159], v19 offset:7200
    ds_read_b64_tr_b16 v[160:161], v18 offset:64
    ds_read_b64_tr_b16 v[162:163], v18 offset:7232
    ds_read_b64_tr_b16 v[164:165], v19 offset:96
    ds_read_b64_tr_b16 v[166:167], v19 offset:7264
    ds_read_b64_tr_b16 v[168:169], v18 offset:128
    ds_read_b64_tr_b16 v[170:171], v18 offset:7296
    ds_read_b64_tr_b16 v[172:173], v19 offset:160
    ds_read_b64_tr_b16 v[174:175], v19 offset:7328
    ds_read_b64_tr_b16 v[176:177], v18 offset:192
    ds_read_b64_tr_b16 v[178:179], v18 offset:7360
    s_waitcnt lgkmcnt(12)
mm_26:
    v_mfma_f32_16x16x32_bf16 v[24:27], v[152:155], v[136:139], v[24:27]
    ds_read_b128 v[180:183], v17 offset:1024
    s_add_u32 s42, s42, 16384
    v_mfma_f32_16x16x32_bf16 v[52:55], v[152:155], v[140:143], v[52:55]
    ds_read_b128 v[184:187], v17 offset:3072
    s_cmp_eq_u32 s42, 49152
    v_mfma_f32_16x16x32_bf16 v[80:83], v[152:155], v[144:147], v[80:83]
    ds_read_b128 v[188:191], v17 offset:5120
    s_cselect_b32 s42, 0, s42
    v_mfma_f32_16x16x32_bf16 v[108:111], v[152:155], v[148:151], v[108:111]
    ds_read_b128 v[192:195], v17 offset:7168
    s_waitcnt lgkmcnt(14)
    v_mfma_f32_16x16x32_bf16 v[112:115], v[156:159], v[148:151], v[112:115]
    ds_read_b64_tr_b16 v[196:197], v18 offset:14336
    s_add_u32 s48, s48, 28672
    v_mfma_f32_16x16x32_bf16 v[84:87], v[156:159], v[144:147], v[84:87]
    ds_read_b64_tr_b16 v[198:199], v18 offset:21504
    s_cmp_eq_u32 s48, 86016
    v_mfma_f32_16x16x32_bf16 v[56:59], v[156:159], v[140:143], v[56:59]
    ds_read_b64_tr_b16 v[200:201], v19 offset:14368
    s_cselect_b32 s48, 0, s48
    v_mfma_f32_16x16x32_bf16 v[28:31], v[156:159], v[136:139], v[28:31]
    ds_read_b64_tr_b16 v[202:203], v19 offset:21536
    s_waitcnt lgkmcnt(8)
    v_mfma_f32_16x16x32_bf16 v[32:35], v[160:163], v[136:139], v[32:35]
    ds_read_b64_tr_b16 v[204:205], v18 offset:14400
    v_add_u32 v17, s42, v12
    v_mfma_f32_16x16x32_bf16 v[60:63], v[160:163], v[140:143], v[60:63]
    ds_read_b64_tr_b16 v[206:207], v18 offset:21568
    v_mfma_f32_16x16x32_bf16 v[88:91], v[160:163], v[144:147], v[88:91]
    ds_read_b64_tr_b16 v[208:209], v19 offset:14432
    v_mfma_f32_16x16x32_bf16 v[116:119], v[160:163], v[148:151], v[116:119]
    ds_read_b64_tr_b16 v[210:211], v19 offset:21600
    v_mfma_f32_16x16x32_bf16 v[120:123], v[164:167], v[148:151], v[120:123]
    ds_read_b64_tr_b16 v[212:213], v18 offset:14464
    v_mfma_f32_16x16x32_bf16 v[92:95], v[164:167], v[144:147], v[92:95]
    ds_read_b64_tr_b16 v[214:215], v18 offset:21632
    v_mfma_f32_16x16x32_bf16 v[64:67], v[164:167], v[140:143], v[64:67]
    ds_read_b64_tr_b16 v[216:217], v19 offset:14496
    v_mfma_f32_16x16x32_bf16 v[36:39], v[164:167], v[136:139], v[36:39]
    ds_read_b64_tr_b16 v[218:219], v19 offset:21664
    v_add_u32 v19, s48, v14
    v_mfma_f32_16x16x32_bf16 v[40:43], v[168:171], v[136:139], v[40:43]
    ds_read_b64_tr_b16 v[220:221], v18 offset:14528
    v_mfma_f32_16x16x32_bf16 v[68:71], v[168:171], v[140:143], v[68:71]
    ds_read_b64_tr_b16 v[222:223], v18 offset:21696
    v_add_u32 v18, s48, v13
    v_mfma_f32_16x16x32_bf16 v[96:99], v[168:171], v[144:147], v[96:99]
    v_mfma_f32_16x16x32_bf16 v[124:127], v[168:171], v[148:151], v[124:127]
    v_mfma_f32_16x16x32_bf16 v[128:131], v[172:175], v[148:151], v[128:131]
    v_mfma_f32_16x16x32_bf16 v[100:103], v[172:175], v[144:147], v[100:103]
    v_mfma_f32_16x16x32_bf16 v[72:75], v[172:175], v[140:143], v[72:75]
    v_mfma_f32_16x16x32_bf16 v[44:47], v[172:175], v[136:139], v[44:47]
    v_mfma_f32_16x16x32_bf16 v[48:51], v[176:179], v[136:139], v[48:51]
    v_mfma_f32_16x16x32_bf16 v[76:79], v[176:179], v[140:143], v[76:79]
    v_mfma_f32_16x16x32_bf16 v[104:107], v[176:179], v[144:147], v[104:107]
    v_mfma_f32_16x16x32_bf16 v[132:135], v[176:179], v[148:151], v[132:135]
    s_waitcnt lgkmcnt(12)
    v_mfma_f32_16x16x32_bf16 v[24:27], v[196:199], v[180:183], v[24:27]
    s_add_u32 s43, s43, 1
    s_cmp_lt_u32 s43, 15
    v_mfma_f32_16x16x32_bf16 v[52:55], v[196:199], v[184:187], v[52:55]
    v_mfma_f32_16x16x32_bf16 v[80:83], v[196:199], v[188:191], v[80:83]
    v_mfma_f32_16x16x32_bf16 v[108:111], v[196:199], v[192:195], v[108:111]
    s_waitcnt lgkmcnt(0)
    s_barrier
    v_mfma_f32_16x16x32_bf16 v[112:115], v[200:203], v[192:195], v[112:115]
    ds_read_b128 v[136:139], v17 offset:0
    v_mfma_f32_16x16x32_bf16 v[84:87], v[200:203], v[188:191], v[84:87]
    ds_read_b128 v[140:143], v17 offset:2048
    v_mfma_f32_16x16x32_bf16 v[56:59], v[200:203], v[184:187], v[56:59]
    ds_read_b128 v[144:147], v17 offset:4096
    v_mfma_f32_16x16x32_bf16 v[28:31], v[200:203], v[180:183], v[28:31]
    ds_read_b128 v[148:151], v17 offset:6144
    v_mfma_f32_16x16x32_bf16 v[32:35], v[204:207], v[180:183], v[32:35]
    ds_read_b64_tr_b16 v[152:153], v18 offset:0
    v_mfma_f32_16x16x32_bf16 v[60:63], v[204:207], v[184:187], v[60:63]
    ds_read_b64_tr_b16 v[154:155], v18 offset:7168
    v_mfma_f32_16x16x32_bf16 v[88:91], v[204:207], v[188:191], v[88:91]
    ds_read_b64_tr_b16 v[156:157], v19 offset:32
    v_mfma_f32_16x16x32_bf16 v[116:119], v[204:207], v[192:195], v[116:119]
    ds_read_b64_tr_b16 v[158:159], v19 offset:7200
    v_mfma_f32_16x16x32_bf16 v[120:123], v[208:211], v[192:195], v[120:123]
    ds_read_b64_tr_b16 v[160:161], v18 offset:64
    v_mfma_f32_16x16x32_bf16 v[92:95], v[208:211], v[188:191], v[92:95]
    ds_read_b64_tr_b16 v[162:163], v18 offset:7232
    v_mfma_f32_16x16x32_bf16 v[64:67], v[208:211], v[184:187], v[64:67]
    ds_read_b64_tr_b16 v[164:165], v19 offset:96
    v_mfma_f32_16x16x32_bf16 v[36:39], v[208:211], v[180:183], v[36:39]
    ds_read_b64_tr_b16 v[166:167], v19 offset:7264
    v_mfma_f32_16x16x32_bf16 v[40:43], v[212:215], v[180:183], v[40:43]
    ds_read_b64_tr_b16 v[168:169], v18 offset:128
    v_mfma_f32_16x16x32_bf16 v[68:71], v[212:215], v[184:187], v[68:71]
    ds_read_b64_tr_b16 v[170:171], v18 offset:7296
    v_mfma_f32_16x16x32_bf16 v[96:99], v[212:215], v[188:191], v[96:99]
    ds_read_b64_tr_b16 v[172:173], v19 offset:160
    v_mfma_f32_16x16x32_bf16 v[124:127], v[212:215], v[192:195], v[124:127]
    ds_read_b64_tr_b16 v[174:175], v19 offset:7328
    v_mfma_f32_16x16x32_bf16 v[128:131], v[216:219], v[192:195], v[128:131]
    ds_read_b64_tr_b16 v[176:177], v18 offset:192
    v_mfma_f32_16x16x32_bf16 v[100:103], v[216:219], v[188:191], v[100:103]
    ds_read_b64_tr_b16 v[178:179], v18 offset:7360
    v_mfma_f32_16x16x32_bf16 v[72:75], v[216:219], v[184:187], v[72:75]
    v_mfma_f32_16x16x32_bf16 v[44:47], v[216:219], v[180:183], v[44:47]
    v_mfma_f32_16x16x32_bf16 v[48:51], v[220:223], v[180:183], v[48:51]
    v_mfma_f32_16x16x32_bf16 v[76:79], v[220:223], v[184:187], v[76:79]
    v_mfma_f32_16x16x32_bf16 v[104:107], v[220:223], v[188:191], v[104:107]
    v_mfma_f32_16x16x32_bf16 v[132:135], v[220:223], v[192:195], v[132:135]
    s_waitcnt lgkmcnt(12)
    s_cbranch_scc1 mm_26
    v_mfma_f32_16x16x32_bf16 v[24:27], v[152:155], v[136:139], v[24:27]
    ds_read_b128 v[180:183], v17 offset:1024
    v_mfma_f32_16x16x32_bf16 v[52:55], v[152:155], v[140:143], v[52:55]
    ds_read_b128 v[184:187], v17 offset:3072
    v_mfma_f32_16x16x32_bf16 v[80:83], v[152:155], v[144:147], v[80:83]
    ds_read_b128 v[188:191], v17 offset:5120
    v_mfma_f32_16x16x32_bf16 v[108:111], v[152:155], v[148:151], v[108:111]
    ds_read_b128 v[192:195], v17 offset:7168
    s_waitcnt lgkmcnt(14)
    v_mfma_f32_16x16x32_bf16 v[112:115], v[156:159], v[148:151], v[112:115]
    ds_read_b64_tr_b16 v[196:197], v18 offset:14336
    v_mfma_f32_16x16x32_bf16 v[84:87], v[156:159], v[144:147], v[84:87]
    ds_read_b64_tr_b16 v[198:199], v18 offset:21504
    v_mfma_f32_16x16x32_bf16 v[56:59], v[156:159], v[140:143], v[56:59]
    ds_read_b64_tr_b16 v[200:201], v19 offset:14368
    v_mfma_f32_16x16x32_bf16 v[28:31], v[156:159], v[136:139], v[28:31]
    ds_read_b64_tr_b16 v[202:203], v19 offset:21536
    s_waitcnt lgkmcnt(8)
    v_mfma_f32_16x16x32_bf16 v[32:35], v[160:163], v[136:139], v[32:35]
    ds_read_b64_tr_b16 v[204:205], v18 offset:14400
    v_mfma_f32_16x16x32_bf16 v[60:63], v[160:163], v[140:143], v[60:63]
    ds_read_b64_tr_b16 v[206:207], v18 offset:21568
    v_mfma_f32_16x16x32_bf16 v[88:91], v[160:163], v[144:147], v[88:91]
    ds_read_b64_tr_b16 v[208:209], v19 offset:14432
    v_mfma_f32_16x16x32_bf16 v[116:119], v[160:163], v[148:151], v[116:119]
    ds_read_b64_tr_b16 v[210:211], v19 offset:21600
    v_mfma_f32_16x16x32_bf16 v[120:123], v[164:167], v[148:151], v[120:123]
    ds_read_b64_tr_b16 v[212:213], v18 offset:14464
    v_mfma_f32_16x16x32_bf16 v[92:95], v[164:167], v[144:147], v[92:95]
    ds_read_b64_tr_b16 v[214:215], v18 offset:21632
    v_mfma_f32_16x16x32_bf16 v[64:67], v[164:167], v[140:143], v[64:67]
    ds_read_b64_tr_b16 v[216:217], v19 offset:14496
    v_mfma_f32_16x16x32_bf16 v[36:39], v[164:167], v[136:139], v[36:39]
    ds_read_b64_tr_b16 v[218:219], v19 offset:21664
    v_mfma_f32_16x16x32_bf16 v[40:43], v[168:171], v[136:139], v[40:43]
    ds_read_b64_tr_b16 v[220:221], v18 offset:14528
    v_mfma_f32_16x16x32_bf16 v[68:71], v[168:171], v[140:143], v[68:71]
    ds_read_b64_tr_b16 v[222:223], v18 offset:21696
    v_mfma_f32_16x16x32_bf16 v[96:99], v[168:171], v[144:147], v[96:99]
    v_mfma_f32_16x16x32_bf16 v[124:127], v[168:171], v[148:151], v[124:127]
    v_mfma_f32_16x16x32_bf16 v[128:131], v[172:175], v[148:151], v[128:131]
    v_mfma_f32_16x16x32_bf16 v[100:103], v[172:175], v[144:147], v[100:103]
    v_mfma_f32_16x16x32_bf16 v[72:75], v[172:175], v[140:143], v[72:75]
    v_mfma_f32_16x16x32_bf16 v[44:47], v[172:175], v[136:139], v[44:47]
    v_mfma_f32_16x16x32_bf16 v[48:51], v[176:179], v[136:139], v[48:51]
    v_mfma_f32_16x16x32_bf16 v[76:79], v[176:179], v[140:143], v[76:79]
    v_mfma_f32_16x16x32_bf16 v[104:107], v[176:179], v[144:147], v[104:107]
    v_mfma_f32_16x16x32_bf16 v[132:135], v[176:179], v[148:151], v[132:135]
    s_waitcnt lgkmcnt(0)
    s_barrier
    v_mfma_f32_16x16x32_bf16 v[24:27], v[196:199], v[180:183], v[24:27]
    ds_read_b128 v[136:139], v6 offset:0
    v_mfma_f32_16x16x32_bf16 v[52:55], v[196:199], v[184:187], v[52:55]
    ds_read_b128 v[140:143], v6 offset:64
    v_mfma_f32_16x16x32_bf16 v[80:83], v[196:199], v[188:191], v[80:83]
    ds_read_b128 v[144:147], v6 offset:128
    v_mfma_f32_16x16x32_bf16 v[108:111], v[196:199], v[192:195], v[108:111]
    ds_read_b128 v[148:151], v6 offset:192
    v_mfma_f32_16x16x32_bf16 v[112:115], v[200:203], v[192:195], v[112:115]
    ds_read_b128 v[152:155], v6 offset:256
    v_mfma_f32_16x16x32_bf16 v[84:87], v[200:203], v[188:191], v[84:87]
    ds_read_b128 v[156:159], v6 offset:320
    v_mfma_f32_16x16x32_bf16 v[56:59], v[200:203], v[184:187], v[56:59]
    ds_read_b128 v[160:163], v6 offset:384
    v_mfma_f32_16x16x32_bf16 v[28:31], v[200:203], v[180:183], v[28:31]
    ds_read_b128 v[164:167], v7 offset:0
    v_mfma_f32_16x16x32_bf16 v[32:35], v[204:207], v[180:183], v[32:35]
    ds_read_b128 v[168:171], v7 offset:256
    v_mfma_f32_16x16x32_bf16 v[60:63], v[204:207], v[184:187], v[60:63]
    ds_read_b128 v[172:175], v7 offset:512
    v_mfma_f32_16x16x32_bf16 v[88:91], v[204:207], v[188:191], v[88:91]
    ds_read_b128 v[176:179], v7 offset:768
    v_mov_b32 v13, v240
    v_mfma_f32_16x16x32_bf16 v[116:119], v[204:207], v[192:195], v[116:119]
    v_add_u32 v18, 0, v240
    v_mov_b32 v14, v241
    v_mfma_f32_16x16x32_bf16 v[120:123], v[208:211], v[192:195], v[120:123]
    v_add_u32 v19, 0, v241
    v_mov_b32 v15, v242
    v_mfma_f32_16x16x32_bf16 v[92:95], v[208:211], v[188:191], v[92:95]
    v_add_u32 v20, 0, v242
    v_mov_b32 v16, v243
    v_mfma_f32_16x16x32_bf16 v[64:67], v[208:211], v[184:187], v[64:67]
    v_add_u32 v21, 0, v243
    s_mov_b32 s42, 0
    s_mov_b32 s43, 0
    v_mfma_f32_16x16x32_bf16 v[36:39], v[208:211], v[180:183], v[36:39]
    s_mov_b32 s48, 0
    v_mov_b32 v17, v12
    v_and_b32 v199, 7, v0
    v_mfma_f32_16x16x32_bf16 v[40:43], v[212:215], v[180:183], v[40:43]
    v_lshrrev_b32 v228, 6, v0
    v_lshlrev_b32 v228, 4, v228
    v_mfma_f32_16x16x32_bf16 v[68:71], v[212:215], v[184:187], v[68:71]
    v_bfe_u32 v229, v0, 3, 3
    v_add_u32 v228, v228, v229
    s_lshr_b32 s78, s29, 1
    v_mfma_f32_16x16x32_bf16 v[96:99], v[212:215], v[188:191], v[96:99]
    s_lshl_b32 s78, s78, 16
    s_and_b32 s79, s29, 1
    s_lshl_b32 s79, s79, 7
    v_mfma_f32_16x16x32_bf16 v[124:127], v[212:215], v[192:195], v[124:127]
    s_add_u32 s78, s78, s79
    s_lshr_b32 s79, s30, 1
    s_lshl_b32 s79, s79, 13
    v_mfma_f32_16x16x32_bf16 v[128:131], v[216:219], v[192:195], v[128:131]
    s_add_u32 s78, s78, s79
    v_lshlrev_b32 v196, 8, v228
    v_lshl_add_u32 v196, v199, 4, v196
    v_mfma_f32_16x16x32_bf16 v[100:103], v[216:219], v[188:191], v[100:103]
    v_add_u32 v196, s78, v196
    v_mfma_f32_16x16x32_bf16 v[72:75], v[216:219], v[184:187], v[72:75]
    v_mfma_f32_16x16x32_bf16 v[44:47], v[216:219], v[180:183], v[44:47]
    v_mfma_f32_16x16x32_bf16 v[48:51], v[220:223], v[180:183], v[48:51]
    v_mfma_f32_16x16x32_bf16 v[76:79], v[220:223], v[184:187], v[76:79]
    v_mfma_f32_16x16x32_bf16 v[104:107], v[220:223], v[188:191], v[104:107]
    v_mfma_f32_16x16x32_bf16 v[132:135], v[220:223], v[192:195], v[132:135]
    s_waitcnt lgkmcnt(0)
    s_cmp_eq_u32 s35, 1
    s_cbranch_scc1 G3_e1
    v_pk_fma_f32 v[24:25], v[164:165], v[136:137], v[24:25] op_sel_hi:[0,1,1] neg_lo:[1,0,0] neg_hi:[1,0,0]
    v_pk_fma_f32 v[26:27], v[164:165], v[138:139], v[26:27] op_sel_hi:[0,1,1] neg_lo:[1,0,0] neg_hi:[1,0,0]
    v_pk_mul_f32 v[226:227], v[24:25], v[24:25]
    v_pk_mul_f32 v[228:229], v[26:27], v[26:27]
    v_pk_fma_f32 v[226:227], v[226:227], v[166:167], v[166:167] op_sel:[0,1,0] op_sel_hi:[1,1,0]
    v_pk_fma_f32 v[228:229], v[228:229], v[166:167], v[166:167] op_sel:[0,1,0] op_sel_hi:[1,1,0]
    v_pk_mul_f32 v[226:227], v[226:227], v[24:25]
    v_pk_mul_f32 v[228:229], v[228:229], v[26:27]
    v_exp_f32 v226, v226
    v_exp_f32 v227, v227
    v_exp_f32 v228, v228
    v_exp_f32 v229, v229
    v_pk_fma_f32 v[226:227], v[226:227], v[164:165], v[164:165] op_sel:[0,1,1] op_sel_hi:[1,1,1]
    v_pk_fma_f32 v[228:229], v[228:229], v[164:165], v[164:165] op_sel:[0,1,1] op_sel_hi:[1,1,1]
    v_rcp_f32 v226, v226
    v_rcp_f32 v227, v227
    v_rcp_f32 v228, v228
    v_rcp_f32 v229, v229
    v_pk_mul_f32 v[24:25], v[24:25], v[226:227]
    v_pk_mul_f32 v[26:27], v[26:27], v[228:229]
    v_pk_fma_f32 v[28:29], v[164:165], v[140:141], v[28:29] op_sel_hi:[0,1,1] neg_lo:[1,0,0] neg_hi:[1,0,0]
    v_pk_fma_f32 v[30:31], v[164:165], v[142:143], v[30:31] op_sel_hi:[0,1,1] neg_lo:[1,0,0] neg_hi:[1,0,0]
    v_pk_mul_f32 v[226:227], v[28:29], v[28:29]
    v_pk_mul_f32 v[228:229], v[30:31], v[30:31]
    v_pk_fma_f32 v[226:227], v[226:227], v[166:167], v[166:167] op_sel:[0,1,0] op_sel_hi:[1,1,0]
    v_pk_fma_f32 v[228:229], v[228:229], v[166:167], v[166:167] op_sel:[0,1,0] op_sel_hi:[1,1,0]
    v_pk_mul_f32 v[226:227], v[226:227], v[28:29]
    v_pk_mul_f32 v[228:229], v[228:229], v[30:31]
    v_exp_f32 v226, v226
    v_exp_f32 v227, v227
    v_exp_f32 v228, v228
    v_exp_f32 v229, v229
    v_pk_fma_f32 v[226:227], v[226:227], v[164:165], v[164:165] op_sel:[0,1,1] op_sel_hi:[1,1,1]
    v_pk_fma_f32 v[228:229], v[228:229], v[164:165], v[164:165] op_sel:[0,1,1] op_sel_hi:[1,1,1]
    v_rcp_f32 v226, v226
    v_rcp_f32 v227, v227
    v_rcp_f32 v228, v228
    v_rcp_f32 v229, v229
    v_pk_mul_f32 v[28:29], v[28:29], v[226:227]
    v_pk_mul_f32 v[30:31], v[30:31], v[228:229]
    v_cvt_pk_bf16_f32 v24, v24, v25
    v_cvt_pk_bf16_f32 v25, v26, v27
    v_cvt_pk_bf16_f32 v26, v28, v29
    v_cvt_pk_bf16_f32 v27, v30, v31
    v_or_b32 v24, 1, v24
    ds_write_b128 v244, v[24:27] offset:0
    s_add_u32 s36, s44, 0
    buffer_store_dwordx4 v[24:27], v2, s[16:19], s36 offen sc1
    v_pk_fma_f32 v[52:53], v[168:169], v[136:137], v[52:53] op_sel_hi:[0,1,1] neg_lo:[1,0,0] neg_hi:[1,0,0]
    v_pk_fma_f32 v[54:55], v[168:169], v[138:139], v[54:55] op_sel_hi:[0,1,1] neg_lo:[1,0,0] neg_hi:[1,0,0]
    v_pk_mul_f32 v[226:227], v[52:53], v[52:53]
    v_pk_mul_f32 v[228:229], v[54:55], v[54:55]
    v_pk_fma_f32 v[226:227], v[226:227], v[170:171], v[170:171] op_sel:[0,1,0] op_sel_hi:[1,1,0]
    v_pk_fma_f32 v[228:229], v[228:229], v[170:171], v[170:171] op_sel:[0,1,0] op_sel_hi:[1,1,0]
    v_pk_mul_f32 v[226:227], v[226:227], v[52:53]
    v_pk_mul_f32 v[228:229], v[228:229], v[54:55]
    v_exp_f32 v226, v226
    v_exp_f32 v227, v227
    v_exp_f32 v228, v228
    v_exp_f32 v229, v229
    v_pk_fma_f32 v[226:227], v[226:227], v[168:169], v[168:169] op_sel:[0,1,1] op_sel_hi:[1,1,1]
    v_pk_fma_f32 v[228:229], v[228:229], v[168:169], v[168:169] op_sel:[0,1,1] op_sel_hi:[1,1,1]
    v_rcp_f32 v226, v226
    v_rcp_f32 v227, v227
    v_rcp_f32 v228, v228
    v_rcp_f32 v229, v229
    v_pk_mul_f32 v[52:53], v[52:53], v[226:227]
    v_pk_mul_f32 v[54:55], v[54:55], v[228:229]
    v_pk_fma_f32 v[56:57], v[168:169], v[140:141], v[56:57] op_sel_hi:[0,1,1] neg_lo:[1,0,0] neg_hi:[1,0,0]
    v_pk_fma_f32 v[58:59], v[168:169], v[142:143], v[58:59] op_sel_hi:[0,1,1] neg_lo:[1,0,0] neg_hi:[1,0,0]
    v_pk_mul_f32 v[226:227], v[56:57], v[56:57]
    v_pk_mul_f32 v[228:229], v[58:59], v[58:59]
    v_pk_fma_f32 v[226:227], v[226:227], v[170:171], v[170:171] op_sel:[0,1,0] op_sel_hi:[1,1,0]
    v_pk_fma_f32 v[228:229], v[228:229], v[170:171], v[170:171] op_sel:[0,1,0] op_sel_hi:[1,1,0]
    v_pk_mul_f32 v[226:227], v[226:227], v[56:57]
    v_pk_mul_f32 v[228:229], v[228:229], v[58:59]
    v_exp_f32 v226, v226
    v_exp_f32 v227, v227
    v_exp_f32 v228, v228
    v_exp_f32 v229, v229
    v_pk_fma_f32 v[226:227], v[226:227], v[168:169], v[168:169] op_sel:[0,1,1] op_sel_hi:[1,1,1]
    v_pk_fma_f32 v[228:229], v[228:229], v[168:169], v[168:169] op_sel:[0,1,1] op_sel_hi:[1,1,1]
    v_rcp_f32 v226, v226
    v_rcp_f32 v227, v227
    v_rcp_f32 v228, v228
    v_rcp_f32 v229, v229
    v_pk_mul_f32 v[56:57], v[56:57], v[226:227]
    v_pk_mul_f32 v[58:59], v[58:59], v[228:229]
    v_cvt_pk_bf16_f32 v52, v52, v53
    v_cvt_pk_bf16_f32 v53, v54, v55
    v_cvt_pk_bf16_f32 v54, v56, v57
    v_cvt_pk_bf16_f32 v55, v58, v59
    v_or_b32 v52, 1, v52
    ds_write_b128 v244, v[52:55] offset:2048
    s_add_u32 s36, s44, 229376
    buffer_store_dwordx4 v[52:55], v2, s[16:19], s36 offen sc1
    v_pk_fma_f32 v[80:81], v[172:173], v[136:137], v[80:81] op_sel_hi:[0,1,1] neg_lo:[1,0,0] neg_hi:[1,0,0]
    v_pk_fma_f32 v[82:83], v[172:173], v[138:139], v[82:83] op_sel_hi:[0,1,1] neg_lo:[1,0,0] neg_hi:[1,0,0]
    v_pk_mul_f32 v[226:227], v[80:81], v[80:81]
    v_pk_mul_f32 v[228:229], v[82:83], v[82:83]
    v_pk_fma_f32 v[226:227], v[226:227], v[174:175], v[174:175] op_sel:[0,1,0] op_sel_hi:[1,1,0]
    v_pk_fma_f32 v[228:229], v[228:229], v[174:175], v[174:175] op_sel:[0,1,0] op_sel_hi:[1,1,0]
    v_pk_mul_f32 v[226:227], v[226:227], v[80:81]
    v_pk_mul_f32 v[228:229], v[228:229], v[82:83]
    v_exp_f32 v226, v226
    v_exp_f32 v227, v227
    v_exp_f32 v228, v228
    v_exp_f32 v229, v229
    v_pk_fma_f32 v[226:227], v[226:227], v[172:173], v[172:173] op_sel:[0,1,1] op_sel_hi:[1,1,1]
    v_pk_fma_f32 v[228:229], v[228:229], v[172:173], v[172:173] op_sel:[0,1,1] op_sel_hi:[1,1,1]
    v_rcp_f32 v226, v226
    v_rcp_f32 v227, v227
    v_rcp_f32 v228, v228
    v_rcp_f32 v229, v229
    v_pk_mul_f32 v[80:81], v[80:81], v[226:227]
    v_pk_mul_f32 v[82:83], v[82:83], v[228:229]
    v_pk_fma_f32 v[84:85], v[172:173], v[140:141], v[84:85] op_sel_hi:[0,1,1] neg_lo:[1,0,0] neg_hi:[1,0,0]
    v_pk_fma_f32 v[86:87], v[172:173], v[142:143], v[86:87] op_sel_hi:[0,1,1] neg_lo:[1,0,0] neg_hi:[1,0,0]
    v_pk_mul_f32 v[226:227], v[84:85], v[84:85]
    v_pk_mul_f32 v[228:229], v[86:87], v[86:87]
    v_pk_fma_f32 v[226:227], v[226:227], v[174:175], v[174:175] op_sel:[0,1,0] op_sel_hi:[1,1,0]
    v_pk_fma_f32 v[228:229], v[228:229], v[174:175], v[174:175] op_sel:[0,1,0] op_sel_hi:[1,1,0]
    v_pk_mul_f32 v[226:227], v[226:227], v[84:85]
    v_pk_mul_f32 v[228:229], v[228:229], v[86:87]
    v_exp_f32 v226, v226
    v_exp_f32 v227, v227
    v_exp_f32 v228, v228
    v_exp_f32 v229, v229
    v_pk_fma_f32 v[226:227], v[226:227], v[172:173], v[172:173] op_sel:[0,1,1] op_sel_hi:[1,1,1]
    v_pk_fma_f32 v[228:229], v[228:229], v[172:173], v[172:173] op_sel:[0,1,1] op_sel_hi:[1,1,1]
    v_rcp_f32 v226, v226
    v_rcp_f32 v227, v227
    v_rcp_f32 v228, v228
    v_rcp_f32 v229, v229
    v_pk_mul_f32 v[84:85], v[84:85], v[226:227]
    v_pk_mul_f32 v[86:87], v[86:87], v[228:229]
    v_cvt_pk_bf16_f32 v80, v80, v81
    v_cvt_pk_bf16_f32 v81, v82, v83
    v_cvt_pk_bf16_f32 v82, v84, v85
    v_cvt_pk_bf16_f32 v83, v86, v87
    v_or_b32 v80, 1, v80
    ds_write_b128 v244, v[80:83] offset:4096
    s_add_u32 s36, s44, 458752
    buffer_store_dwordx4 v[80:83], v2, s[16:19], s36 offen sc1
    v_pk_fma_f32 v[108:109], v[176:177], v[136:137], v[108:109] op_sel_hi:[0,1,1] neg_lo:[1,0,0] neg_hi:[1,0,0]
    v_pk_fma_f32 v[110:111], v[176:177], v[138:139], v[110:111] op_sel_hi:[0,1,1] neg_lo:[1,0,0] neg_hi:[1,0,0]
    v_pk_mul_f32 v[226:227], v[108:109], v[108:109]
    v_pk_mul_f32 v[228:229], v[110:111], v[110:111]
    v_pk_fma_f32 v[226:227], v[226:227], v[178:179], v[178:179] op_sel:[0,1,0] op_sel_hi:[1,1,0]
    v_pk_fma_f32 v[228:229], v[228:229], v[178:179], v[178:179] op_sel:[0,1,0] op_sel_hi:[1,1,0]
    v_pk_mul_f32 v[226:227], v[226:227], v[108:109]
    v_pk_mul_f32 v[228:229], v[228:229], v[110:111]
    v_exp_f32 v226, v226
    v_exp_f32 v227, v227
    v_exp_f32 v228, v228
    v_exp_f32 v229, v229
    v_pk_fma_f32 v[226:227], v[226:227], v[176:177], v[176:177] op_sel:[0,1,1] op_sel_hi:[1,1,1]
    v_pk_fma_f32 v[228:229], v[228:229], v[176:177], v[176:177] op_sel:[0,1,1] op_sel_hi:[1,1,1]
    v_rcp_f32 v226, v226
    v_rcp_f32 v227, v227
    v_rcp_f32 v228, v228
    v_rcp_f32 v229, v229
    v_pk_mul_f32 v[108:109], v[108:109], v[226:227]
    v_pk_mul_f32 v[110:111], v[110:111], v[228:229]
    v_pk_fma_f32 v[112:113], v[176:177], v[140:141], v[112:113] op_sel_hi:[0,1,1] neg_lo:[1,0,0] neg_hi:[1,0,0]
    v_pk_fma_f32 v[114:115], v[176:177], v[142:143], v[114:115] op_sel_hi:[0,1,1] neg_lo:[1,0,0] neg_hi:[1,0,0]
    v_pk_mul_f32 v[226:227], v[112:113], v[112:113]
    v_pk_mul_f32 v[228:229], v[114:115], v[114:115]
    v_pk_fma_f32 v[226:227], v[226:227], v[178:179], v[178:179] op_sel:[0,1,0] op_sel_hi:[1,1,0]
    v_pk_fma_f32 v[228:229], v[228:229], v[178:179], v[178:179] op_sel:[0,1,0] op_sel_hi:[1,1,0]
    v_pk_mul_f32 v[226:227], v[226:227], v[112:113]
    v_pk_mul_f32 v[228:229], v[228:229], v[114:115]
    v_exp_f32 v226, v226
    v_exp_f32 v227, v227
    v_exp_f32 v228, v228
    v_exp_f32 v229, v229
    v_pk_fma_f32 v[226:227], v[226:227], v[176:177], v[176:177] op_sel:[0,1,1] op_sel_hi:[1,1,1]
    v_pk_fma_f32 v[228:229], v[228:229], v[176:177], v[176:177] op_sel:[0,1,1] op_sel_hi:[1,1,1]
    v_rcp_f32 v226, v226
    v_rcp_f32 v227, v227
    v_rcp_f32 v228, v228
    v_rcp_f32 v229, v229
    v_pk_mul_f32 v[112:113], v[112:113], v[226:227]
    v_pk_mul_f32 v[114:115], v[114:115], v[228:229]
    v_cvt_pk_bf16_f32 v108, v108, v109
    v_cvt_pk_bf16_f32 v109, v110, v111
    v_cvt_pk_bf16_f32 v110, v112, v113
    v_cvt_pk_bf16_f32 v111, v114, v115
    ds_write_b128 v244, v[108:111] offset:6144
    s_add_u32 s36, s44, 688128
    buffer_store_dwordx4 v[108:111], v2, s[16:19], s36 offen sc1
    v_pk_fma_f32 v[32:33], v[164:165], v[144:145], v[32:33] op_sel_hi:[0,1,1] neg_lo:[1,0,0] neg_hi:[1,0,0]
    v_pk_fma_f32 v[34:35], v[164:165], v[146:147], v[34:35] op_sel_hi:[0,1,1] neg_lo:[1,0,0] neg_hi:[1,0,0]
    v_pk_mul_f32 v[226:227], v[32:33], v[32:33]
    v_pk_mul_f32 v[228:229], v[34:35], v[34:35]
    v_pk_fma_f32 v[226:227], v[226:227], v[166:167], v[166:167] op_sel:[0,1,0] op_sel_hi:[1,1,0]
    v_pk_fma_f32 v[228:229], v[228:229], v[166:167], v[166:167] op_sel:[0,1,0] op_sel_hi:[1,1,0]
    v_pk_mul_f32 v[226:227], v[226:227], v[32:33]
    v_pk_mul_f32 v[228:229], v[228:229], v[34:35]
    v_exp_f32 v226, v226
    v_exp_f32 v227, v227
    v_exp_f32 v228, v228
    v_exp_f32 v229, v229
    v_pk_fma_f32 v[226:227], v[226:227], v[164:165], v[164:165] op_sel:[0,1,1] op_sel_hi:[1,1,1]
    v_pk_fma_f32 v[228:229], v[228:229], v[164:165], v[164:165] op_sel:[0,1,1] op_sel_hi:[1,1,1]
    v_rcp_f32 v226, v226
    v_rcp_f32 v227, v227
    v_rcp_f32 v228, v228
    v_rcp_f32 v229, v229
    v_pk_mul_f32 v[32:33], v[32:33], v[226:227]
    v_pk_mul_f32 v[34:35], v[34:35], v[228:229]
    v_pk_fma_f32 v[36:37], v[164:165], v[148:149], v[36:37] op_sel_hi:[0,1,1] neg_lo:[1,0,0] neg_hi:[1,0,0]
    v_pk_fma_f32 v[38:39], v[164:165], v[150:151], v[38:39] op_sel_hi:[0,1,1] neg_lo:[1,0,0] neg_hi:[1,0,0]
    v_pk_mul_f32 v[226:227], v[36:37], v[36:37]
    v_pk_mul_f32 v[228:229], v[38:39], v[38:39]
    v_pk_fma_f32 v[226:227], v[226:227], v[166:167], v[166:167] op_sel:[0,1,0] op_sel_hi:[1,1,0]
    v_pk_fma_f32 v[228:229], v[228:229], v[166:167], v[166:167] op_sel:[0,1,0] op_sel_hi:[1,1,0]
    v_pk_mul_f32 v[226:227], v[226:227], v[36:37]
    v_pk_mul_f32 v[228:229], v[228:229], v[38:39]
    v_exp_f32 v226, v226
    v_exp_f32 v227, v227
    v_exp_f32 v228, v228
    v_exp_f32 v229, v229
    v_pk_fma_f32 v[226:227], v[226:227], v[164:165], v[164:165] op_sel:[0,1,1] op_sel_hi:[1,1,1]
    v_pk_fma_f32 v[228:229], v[228:229], v[164:165], v[164:165] op_sel:[0,1,1] op_sel_hi:[1,1,1]
    v_rcp_f32 v226, v226
    v_rcp_f32 v227, v227
    v_rcp_f32 v228, v228
    v_rcp_f32 v229, v229
    v_pk_mul_f32 v[36:37], v[36:37], v[226:227]
    v_pk_mul_f32 v[38:39], v[38:39], v[228:229]
    v_cvt_pk_bf16_f32 v32, v32, v33
    v_cvt_pk_bf16_f32 v33, v34, v35
    v_cvt_pk_bf16_f32 v34, v36, v37
    v_cvt_pk_bf16_f32 v35, v38, v39
    v_or_b32 v32, 1, v32
    ds_write_b128 v244, v[32:35] offset:16384
    v_pk_fma_f32 v[60:61], v[168:169], v[144:145], v[60:61] op_sel_hi:[0,1,1] neg_lo:[1,0,0] neg_hi:[1,0,0]
    v_pk_fma_f32 v[62:63], v[168:169], v[146:147], v[62:63] op_sel_hi:[0,1,1] neg_lo:[1,0,0] neg_hi:[1,0,0]
    v_pk_mul_f32 v[226:227], v[60:61], v[60:61]
    v_pk_mul_f32 v[228:229], v[62:63], v[62:63]
    v_pk_fma_f32 v[226:227], v[226:227], v[170:171], v[170:171] op_sel:[0,1,0] op_sel_hi:[1,1,0]
    v_pk_fma_f32 v[228:229], v[228:229], v[170:171], v[170:171] op_sel:[0,1,0] op_sel_hi:[1,1,0]
    v_pk_mul_f32 v[226:227], v[226:227], v[60:61]
    v_pk_mul_f32 v[228:229], v[228:229], v[62:63]
    v_exp_f32 v226, v226
    v_exp_f32 v227, v227
    v_exp_f32 v228, v228
    v_exp_f32 v229, v229
    v_pk_fma_f32 v[226:227], v[226:227], v[168:169], v[168:169] op_sel:[0,1,1] op_sel_hi:[1,1,1]
    v_pk_fma_f32 v[228:229], v[228:229], v[168:169], v[168:169] op_sel:[0,1,1] op_sel_hi:[1,1,1]
    v_rcp_f32 v226, v226
    v_rcp_f32 v227, v227
    v_rcp_f32 v228, v228
    v_rcp_f32 v229, v229
    v_pk_mul_f32 v[60:61], v[60:61], v[226:227]
    v_pk_mul_f32 v[62:63], v[62:63], v[228:229]
    v_pk_fma_f32 v[64:65], v[168:169], v[148:149], v[64:65] op_sel_hi:[0,1,1] neg_lo:[1,0,0] neg_hi:[1,0,0]
    v_pk_fma_f32 v[66:67], v[168:169], v[150:151], v[66:67] op_sel_hi:[0,1,1] neg_lo:[1,0,0] neg_hi:[1,0,0]
    v_pk_mul_f32 v[226:227], v[64:65], v[64:65]
    v_pk_mul_f32 v[228:229], v[66:67], v[66:67]
    v_pk_fma_f32 v[226:227], v[226:227], v[170:171], v[170:171] op_sel:[0,1,0] op_sel_hi:[1,1,0]
    v_pk_fma_f32 v[228:229], v[228:229], v[170:171], v[170:171] op_sel:[0,1,0] op_sel_hi:[1,1,0]
    v_pk_mul_f32 v[226:227], v[226:227], v[64:65]
    v_pk_mul_f32 v[228:229], v[228:229], v[66:67]
    v_exp_f32 v226, v226
    v_exp_f32 v227, v227
    v_exp_f32 v228, v228
    v_exp_f32 v229, v229
    v_pk_fma_f32 v[226:227], v[226:227], v[168:169], v[168:169] op_sel:[0,1,1] op_sel_hi:[1,1,1]
    v_pk_fma_f32 v[228:229], v[228:229], v[168:169], v[168:169] op_sel:[0,1,1] op_sel_hi:[1,1,1]
    v_rcp_f32 v226, v226
    v_rcp_f32 v227, v227
    v_rcp_f32 v228, v228
    v_rcp_f32 v229, v229
    v_pk_mul_f32 v[64:65], v[64:65], v[226:227]
    v_pk_mul_f32 v[66:67], v[66:67], v[228:229]
    v_cvt_pk_bf16_f32 v60, v60, v61
    v_cvt_pk_bf16_f32 v61, v62, v63
    v_cvt_pk_bf16_f32 v62, v64, v65
    v_cvt_pk_bf16_f32 v63, v66, v67
    v_or_b32 v60, 1, v60
    ds_write_b128 v244, v[60:63] offset:18432
    s_waitcnt vmcnt(0)
    s_mov_b64 exec, 1
    ds_add_u32 v246, v245
    s_mov_b64 exec, -1
    v_pk_fma_f32 v[88:89], v[172:173], v[144:145], v[88:89] op_sel_hi:[0,1,1] neg_lo:[1,0,0] neg_hi:[1,0,0]
    v_pk_fma_f32 v[90:91], v[172:173], v[146:147], v[90:91] op_sel_hi:[0,1,1] neg_lo:[1,0,0] neg_hi:[1,0,0]
    v_pk_mul_f32 v[226:227], v[88:89], v[88:89]
    v_pk_mul_f32 v[228:229], v[90:91], v[90:91]
    v_pk_fma_f32 v[226:227], v[226:227], v[174:175], v[174:175] op_sel:[0,1,0] op_sel_hi:[1,1,0]
    v_pk_fma_f32 v[228:229], v[228:229], v[174:175], v[174:175] op_sel:[0,1,0] op_sel_hi:[1,1,0]
    v_pk_mul_f32 v[226:227], v[226:227], v[88:89]
    v_pk_mul_f32 v[228:229], v[228:229], v[90:91]
    v_exp_f32 v226, v226
    v_exp_f32 v227, v227
    v_exp_f32 v228, v228
    v_exp_f32 v229, v229
    v_pk_fma_f32 v[226:227], v[226:227], v[172:173], v[172:173] op_sel:[0,1,1] op_sel_hi:[1,1,1]
    v_pk_fma_f32 v[228:229], v[228:229], v[172:173], v[172:173] op_sel:[0,1,1] op_sel_hi:[1,1,1]
    v_rcp_f32 v226, v226
    v_rcp_f32 v227, v227
    v_rcp_f32 v228, v228
    v_rcp_f32 v229, v229
    v_pk_mul_f32 v[88:89], v[88:89], v[226:227]
    v_pk_mul_f32 v[90:91], v[90:91], v[228:229]
    v_pk_fma_f32 v[92:93], v[172:173], v[148:149], v[92:93] op_sel_hi:[0,1,1] neg_lo:[1,0,0] neg_hi:[1,0,0]
    v_pk_fma_f32 v[94:95], v[172:173], v[150:151], v[94:95] op_sel_hi:[0,1,1] neg_lo:[1,0,0] neg_hi:[1,0,0]
    v_pk_mul_f32 v[226:227], v[92:93], v[92:93]
    v_pk_mul_f32 v[228:229], v[94:95], v[94:95]
    v_pk_fma_f32 v[226:227], v[226:227], v[174:175], v[174:175] op_sel:[0,1,0] op_sel_hi:[1,1,0]
    v_pk_fma_f32 v[228:229], v[228:229], v[174:175], v[174:175] op_sel:[0,1,0] op_sel_hi:[1,1,0]
    v_pk_mul_f32 v[226:227], v[226:227], v[92:93]
    v_pk_mul_f32 v[228:229], v[228:229], v[94:95]
    v_exp_f32 v226, v226
    v_exp_f32 v227, v227
    v_exp_f32 v228, v228
    v_exp_f32 v229, v229
    v_pk_fma_f32 v[226:227], v[226:227], v[172:173], v[172:173] op_sel:[0,1,1] op_sel_hi:[1,1,1]
    v_pk_fma_f32 v[228:229], v[228:229], v[172:173], v[172:173] op_sel:[0,1,1] op_sel_hi:[1,1,1]
    v_rcp_f32 v226, v226
    v_rcp_f32 v227, v227
    v_rcp_f32 v228, v228
    v_rcp_f32 v229, v229
    v_pk_mul_f32 v[92:93], v[92:93], v[226:227]
    v_pk_mul_f32 v[94:95], v[94:95], v[228:229]
    v_cvt_pk_bf16_f32 v88, v88, v89
    v_cvt_pk_bf16_f32 v89, v90, v91
    v_cvt_pk_bf16_f32 v90, v92, v93
    v_cvt_pk_bf16_f32 v91, v94, v95
    v_or_b32 v88, 1, v88
    ds_write_b128 v244, v[88:91] offset:20480
    s_cmp_eq_u32 s60, 1
    s_cbranch_scc1 G4_p10
    buffer_load_dwordx4 v[180:183], v196, s[84:87], 0 offen offset:0 sc1
    buffer_load_dwordx4 v[188:191], v196, s[88:91], 0 offen offset:0 sc1
    buffer_load_dwordx4 v[184:187], v196, s[84:87], 0 offen offset:2048 sc1
    buffer_load_dwordx4 v[192:195], v196, s[88:91], 0 offen offset:2048 sc1
    s_branch G4_p20
G4_p10:
    s_add_u32 s36, s40, 0
    buffer_load_dwordx4 v[180:183], v2, s[84:87], s36 offen offset:0 sc1
    buffer_load_dwordx4 v[184:187], v2, s[88:91], s36 offen offset:0 sc1
    buffer_load_dwordx4 v[188:191], v2, s[84:87], s36 offen offset:1024 sc1
    buffer_load_dwordx4 v[192:195], v2, s[88:91], s36 offen offset:1024 sc1
    s_add_u32 s36, s40, 65536
    buffer_load_dwordx4 v[196:199], v2, s[84:87], s36 offen offset:0 sc1
    buffer_load_dwordx4 v[230:233], v2, s[88:91], s36 offen offset:0 sc1
    buffer_load_dwordx4 v[234:237], v2, s[84:87], s36 offen offset:1024 sc1
    buffer_load_dwordx4 v[248:251], v2, s[88:91], s36 offen offset:1024 sc1
G4_p20:
    v_pk_fma_f32 v[116:117], v[176:177], v[144:145], v[116:117] op_sel_hi:[0,1,1] neg_lo:[1,0,0] neg_hi:[1,0,0]
    v_pk_fma_f32 v[118:119], v[176:177], v[146:147], v[118:119] op_sel_hi:[0,1,1] neg_lo:[1,0,0] neg_hi:[1,0,0]
    v_pk_mul_f32 v[226:227], v[116:117], v[116:117]
    v_pk_mul_f32 v[228:229], v[118:119], v[118:119]
    v_pk_fma_f32 v[226:227], v[226:227], v[178:179], v[178:179] op_sel:[0,1,0] op_sel_hi:[1,1,0]
    v_pk_fma_f32 v[228:229], v[228:229], v[178:179], v[178:179] op_sel:[0,1,0] op_sel_hi:[1,1,0]
    v_pk_mul_f32 v[226:227], v[226:227], v[116:117]
    v_pk_mul_f32 v[228:229], v[228:229], v[118:119]
    v_exp_f32 v226, v226
    v_exp_f32 v227, v227
    v_exp_f32 v228, v228
    v_exp_f32 v229, v229
    v_pk_fma_f32 v[226:227], v[226:227], v[176:177], v[176:177] op_sel:[0,1,1] op_sel_hi:[1,1,1]
    v_pk_fma_f32 v[228:229], v[228:229], v[176:177], v[176:177] op_sel:[0,1,1] op_sel_hi:[1,1,1]
    v_rcp_f32 v226, v226
    v_rcp_f32 v227, v227
    v_rcp_f32 v228, v228
    v_rcp_f32 v229, v229
    v_pk_mul_f32 v[116:117], v[116:117], v[226:227]
    v_pk_mul_f32 v[118:119], v[118:119], v[228:229]
    v_pk_fma_f32 v[120:121], v[176:177], v[148:149], v[120:121] op_sel_hi:[0,1,1] neg_lo:[1,0,0] neg_hi:[1,0,0]
    v_pk_fma_f32 v[122:123], v[176:177], v[150:151], v[122:123] op_sel_hi:[0,1,1] neg_lo:[1,0,0] neg_hi:[1,0,0]
    v_pk_mul_f32 v[226:227], v[120:121], v[120:121]
    v_pk_mul_f32 v[228:229], v[122:123], v[122:123]
    v_pk_fma_f32 v[226:227], v[226:227], v[178:179], v[178:179] op_sel:[0,1,0] op_sel_hi:[1,1,0]
    v_pk_fma_f32 v[228:229], v[228:229], v[178:179], v[178:179] op_sel:[0,1,0] op_sel_hi:[1,1,0]
    v_pk_mul_f32 v[226:227], v[226:227], v[120:121]
    v_pk_mul_f32 v[228:229], v[228:229], v[122:123]
    v_exp_f32 v226, v226
    v_exp_f32 v227, v227
    v_exp_f32 v228, v228
    v_exp_f32 v229, v229
    v_pk_fma_f32 v[226:227], v[226:227], v[176:177], v[176:177] op_sel:[0,1,1] op_sel_hi:[1,1,1]
    v_pk_fma_f32 v[228:229], v[228:229], v[176:177], v[176:177] op_sel:[0,1,1] op_sel_hi:[1,1,1]
    v_rcp_f32 v226, v226
    v_rcp_f32 v227, v227
    v_rcp_f32 v228, v228
    v_rcp_f32 v229, v229
    v_pk_mul_f32 v[120:121], v[120:121], v[226:227]
    v_pk_mul_f32 v[122:123], v[122:123], v[228:229]
    v_cvt_pk_bf16_f32 v116, v116, v117
    v_cvt_pk_bf16_f32 v117, v118, v119
    v_cvt_pk_bf16_f32 v118, v120, v121
    v_cvt_pk_bf16_f32 v119, v122, v123
    ds_write_b128 v244, v[116:119] offset:22528
    v_pk_fma_f32 v[40:41], v[164:165], v[152:153], v[40:41] op_sel_hi:[0,1,1] neg_lo:[1,0,0] neg_hi:[1,0,0]
    v_pk_fma_f32 v[42:43], v[164:165], v[154:155], v[42:43] op_sel_hi:[0,1,1] neg_lo:[1,0,0] neg_hi:[1,0,0]
    v_pk_mul_f32 v[226:227], v[40:41], v[40:41]
    v_pk_mul_f32 v[228:229], v[42:43], v[42:43]
    v_pk_fma_f32 v[226:227], v[226:227], v[166:167], v[166:167] op_sel:[0,1,0] op_sel_hi:[1,1,0]
    v_pk_fma_f32 v[228:229], v[228:229], v[166:167], v[166:167] op_sel:[0,1,0] op_sel_hi:[1,1,0]
    v_pk_mul_f32 v[226:227], v[226:227], v[40:41]
    v_pk_mul_f32 v[228:229], v[228:229], v[42:43]
    v_exp_f32 v226, v226
    v_exp_f32 v227, v227
    v_exp_f32 v228, v228
    v_exp_f32 v229, v229
    v_pk_fma_f32 v[226:227], v[226:227], v[164:165], v[164:165] op_sel:[0,1,1] op_sel_hi:[1,1,1]
    v_pk_fma_f32 v[228:229], v[228:229], v[164:165], v[164:165] op_sel:[0,1,1] op_sel_hi:[1,1,1]
    v_rcp_f32 v226, v226
    v_rcp_f32 v227, v227
    v_rcp_f32 v228, v228
    v_rcp_f32 v229, v229
    v_pk_mul_f32 v[40:41], v[40:41], v[226:227]
    v_pk_mul_f32 v[42:43], v[42:43], v[228:229]
    v_pk_fma_f32 v[44:45], v[164:165], v[156:157], v[44:45] op_sel_hi:[0,1,1] neg_lo:[1,0,0] neg_hi:[1,0,0]
    v_pk_fma_f32 v[46:47], v[164:165], v[158:159], v[46:47] op_sel_hi:[0,1,1] neg_lo:[1,0,0] neg_hi:[1,0,0]
    v_pk_mul_f32 v[226:227], v[44:45], v[44:45]
    v_pk_mul_f32 v[228:229], v[46:47], v[46:47]
    v_pk_fma_f32 v[226:227], v[226:227], v[166:167], v[166:167] op_sel:[0,1,0] op_sel_hi:[1,1,0]
    v_pk_fma_f32 v[228:229], v[228:229], v[166:167], v[166:167] op_sel:[0,1,0] op_sel_hi:[1,1,0]
    v_pk_mul_f32 v[226:227], v[226:227], v[44:45]
    v_pk_mul_f32 v[228:229], v[228:229], v[46:47]
    v_exp_f32 v226, v226
    v_exp_f32 v227, v227
    v_exp_f32 v228, v228
    v_exp_f32 v229, v229
    v_pk_fma_f32 v[226:227], v[226:227], v[164:165], v[164:165] op_sel:[0,1,1] op_sel_hi:[1,1,1]
    v_pk_fma_f32 v[228:229], v[228:229], v[164:165], v[164:165] op_sel:[0,1,1] op_sel_hi:[1,1,1]
    v_rcp_f32 v226, v226
    v_rcp_f32 v227, v227
    v_rcp_f32 v228, v228
    v_rcp_f32 v229, v229
    v_pk_mul_f32 v[44:45], v[44:45], v[226:227]
    v_pk_mul_f32 v[46:47], v[46:47], v[228:229]
    v_cvt_pk_bf16_f32 v200, v40, v41
    v_cvt_pk_bf16_f32 v201, v42, v43
    v_cvt_pk_bf16_f32 v202, v44, v45
    v_cvt_pk_bf16_f32 v203, v46, v47
    v_or_b32 v200, 1, v200
    ds_write_b128 v244, v[200:203] offset:32768
    v_pk_fma_f32 v[68:69], v[168:169], v[152:153], v[68:69] op_sel_hi:[0,1,1] neg_lo:[1,0,0] neg_hi:[1,0,0]
    v_pk_fma_f32 v[70:71], v[168:169], v[154:155], v[70:71] op_sel_hi:[0,1,1] neg_lo:[1,0,0] neg_hi:[1,0,0]
    v_pk_mul_f32 v[226:227], v[68:69], v[68:69]
    v_pk_mul_f32 v[228:229], v[70:71], v[70:71]
    v_pk_fma_f32 v[226:227], v[226:227], v[170:171], v[170:171] op_sel:[0,1,0] op_sel_hi:[1,1,0]
    v_pk_fma_f32 v[228:229], v[228:229], v[170:171], v[170:171] op_sel:[0,1,0] op_sel_hi:[1,1,0]
    v_pk_mul_f32 v[226:227], v[226:227], v[68:69]
    v_pk_mul_f32 v[228:229], v[228:229], v[70:71]
    v_exp_f32 v226, v226
    v_exp_f32 v227, v227
    v_exp_f32 v228, v228
    v_exp_f32 v229, v229
    v_pk_fma_f32 v[226:227], v[226:227], v[168:169], v[168:169] op_sel:[0,1,1] op_sel_hi:[1,1,1]
    v_pk_fma_f32 v[228:229], v[228:229], v[168:169], v[168:169] op_sel:[0,1,1] op_sel_hi:[1,1,1]
    v_rcp_f32 v226, v226
    v_rcp_f32 v227, v227
    v_rcp_f32 v228, v228
    v_rcp_f32 v229, v229
    v_pk_mul_f32 v[68:69], v[68:69], v[226:227]
    v_pk_mul_f32 v[70:71], v[70:71], v[228:229]
    v_pk_fma_f32 v[72:73], v[168:169], v[156:157], v[72:73] op_sel_hi:[0,1,1] neg_lo:[1,0,0] neg_hi:[1,0,0]
    v_pk_fma_f32 v[74:75], v[168:169], v[158:159], v[74:75] op_sel_hi:[0,1,1] neg_lo:[1,0,0] neg_hi:[1,0,0]
    v_pk_mul_f32 v[226:227], v[72:73], v[72:73]
    v_pk_mul_f32 v[228:229], v[74:75], v[74:75]
    v_pk_fma_f32 v[226:227], v[226:227], v[170:171], v[170:171] op_sel:[0,1,0] op_sel_hi:[1,1,0]
    v_pk_fma_f32 v[228:229], v[228:229], v[170:171], v[170:171] op_sel:[0,1,0] op_sel_hi:[1,1,0]
    v_pk_mul_f32 v[226:227], v[226:227], v[72:73]
    v_pk_mul_f32 v[228:229], v[228:229], v[74:75]
    v_exp_f32 v226, v226
    v_exp_f32 v227, v227
    v_exp_f32 v228, v228
    v_exp_f32 v229, v229
    v_pk_fma_f32 v[226:227], v[226:227], v[168:169], v[168:169] op_sel:[0,1,1] op_sel_hi:[1,1,1]
    v_pk_fma_f32 v[228:229], v[228:229], v[168:169], v[168:169] op_sel:[0,1,1] op_sel_hi:[1,1,1]
    v_rcp_f32 v226, v226
    v_rcp_f32 v227, v227
    v_rcp_f32 v228, v228
    v_rcp_f32 v229, v229
    v_pk_mul_f32 v[72:73], v[72:73], v[226:227]
    v_pk_mul_f32 v[74:75], v[74:75], v[228:229]
    v_cvt_pk_bf16_f32 v204, v68, v69
    v_cvt_pk_bf16_f32 v205, v70, v71
    v_cvt_pk_bf16_f32 v206, v72, v73
    v_cvt_pk_bf16_f32 v207, v74, v75
    v_or_b32 v204, 1, v204
    ds_write_b128 v244, v[204:207] offset:34816
    v_pk_fma_f32 v[96:97], v[172:173], v[152:153], v[96:97] op_sel_hi:[0,1,1] neg_lo:[1,0,0] neg_hi:[1,0,0]
    v_pk_fma_f32 v[98:99], v[172:173], v[154:155], v[98:99] op_sel_hi:[0,1,1] neg_lo:[1,0,0] neg_hi:[1,0,0]
    v_pk_mul_f32 v[226:227], v[96:97], v[96:97]
    v_pk_mul_f32 v[228:229], v[98:99], v[98:99]
    v_pk_fma_f32 v[226:227], v[226:227], v[174:175], v[174:175] op_sel:[0,1,0] op_sel_hi:[1,1,0]
    v_pk_fma_f32 v[228:229], v[228:229], v[174:175], v[174:175] op_sel:[0,1,0] op_sel_hi:[1,1,0]
    v_pk_mul_f32 v[226:227], v[226:227], v[96:97]
    v_pk_mul_f32 v[228:229], v[228:229], v[98:99]
    v_exp_f32 v226, v226
    v_exp_f32 v227, v227
    v_exp_f32 v228, v228
    v_exp_f32 v229, v229
    v_pk_fma_f32 v[226:227], v[226:227], v[172:173], v[172:173] op_sel:[0,1,1] op_sel_hi:[1,1,1]
    v_pk_fma_f32 v[228:229], v[228:229], v[172:173], v[172:173] op_sel:[0,1,1] op_sel_hi:[1,1,1]
    v_rcp_f32 v226, v226
    v_rcp_f32 v227, v227
    v_rcp_f32 v228, v228
    v_rcp_f32 v229, v229
    v_pk_mul_f32 v[96:97], v[96:97], v[226:227]
    v_pk_mul_f32 v[98:99], v[98:99], v[228:229]
    v_pk_fma_f32 v[100:101], v[172:173], v[156:157], v[100:101] op_sel_hi:[0,1,1] neg_lo:[1,0,0] neg_hi:[1,0,0]
    v_pk_fma_f32 v[102:103], v[172:173], v[158:159], v[102:103] op_sel_hi:[0,1,1] neg_lo:[1,0,0] neg_hi:[1,0,0]
    v_pk_mul_f32 v[226:227], v[100:101], v[100:101]
    v_pk_mul_f32 v[228:229], v[102:103], v[102:103]
    v_pk_fma_f32 v[226:227], v[226:227], v[174:175], v[174:175] op_sel:[0,1,0] op_sel_hi:[1,1,0]
    v_pk_fma_f32 v[228:229], v[228:229], v[174:175], v[174:175] op_sel:[0,1,0] op_sel_hi:[1,1,0]
    v_pk_mul_f32 v[226:227], v[226:227], v[100:101]
    v_pk_mul_f32 v[228:229], v[228:229], v[102:103]
    v_exp_f32 v226, v226
    v_exp_f32 v227, v227
    v_exp_f32 v228, v228
    v_exp_f32 v229, v229
    v_pk_fma_f32 v[226:227], v[226:227], v[172:173], v[172:173] op_sel:[0,1,1] op_sel_hi:[1,1,1]
    v_pk_fma_f32 v[228:229], v[228:229], v[172:173], v[172:173] op_sel:[0,1,1] op_sel_hi:[1,1,1]
    v_rcp_f32 v226, v226
    v_rcp_f32 v227, v227
    v_rcp_f32 v228, v228
    v_rcp_f32 v229, v229
    v_pk_mul_f32 v[100:101], v[100:101], v[226:227]
    v_pk_mul_f32 v[102:103], v[102:103], v[228:229]
    v_cvt_pk_bf16_f32 v208, v96, v97
    v_cvt_pk_bf16_f32 v209, v98, v99
    v_cvt_pk_bf16_f32 v210, v100, v101
    v_cvt_pk_bf16_f32 v211, v102, v103
    v_or_b32 v208, 1, v208
    ds_write_b128 v244, v[208:211] offset:36864
    v_pk_fma_f32 v[124:125], v[176:177], v[152:153], v[124:125] op_sel_hi:[0,1,1] neg_lo:[1,0,0] neg_hi:[1,0,0]
    v_pk_fma_f32 v[126:127], v[176:177], v[154:155], v[126:127] op_sel_hi:[0,1,1] neg_lo:[1,0,0] neg_hi:[1,0,0]
    v_pk_mul_f32 v[226:227], v[124:125], v[124:125]
    v_pk_mul_f32 v[228:229], v[126:127], v[126:127]
    v_pk_fma_f32 v[226:227], v[226:227], v[178:179], v[178:179] op_sel:[0,1,0] op_sel_hi:[1,1,0]
    v_pk_fma_f32 v[228:229], v[228:229], v[178:179], v[178:179] op_sel:[0,1,0] op_sel_hi:[1,1,0]
    v_pk_mul_f32 v[226:227], v[226:227], v[124:125]
    v_pk_mul_f32 v[228:229], v[228:229], v[126:127]
    v_exp_f32 v226, v226
    v_exp_f32 v227, v227
    v_exp_f32 v228, v228
    v_exp_f32 v229, v229
    v_pk_fma_f32 v[226:227], v[226:227], v[176:177], v[176:177] op_sel:[0,1,1] op_sel_hi:[1,1,1]
    v_pk_fma_f32 v[228:229], v[228:229], v[176:177], v[176:177] op_sel:[0,1,1] op_sel_hi:[1,1,1]
    v_rcp_f32 v226, v226
    v_rcp_f32 v227, v227
    v_rcp_f32 v228, v228
    v_rcp_f32 v229, v229
    v_pk_mul_f32 v[124:125], v[124:125], v[226:227]
    v_pk_mul_f32 v[126:127], v[126:127], v[228:229]
    v_pk_fma_f32 v[128:129], v[176:177], v[156:157], v[128:129] op_sel_hi:[0,1,1] neg_lo:[1,0,0] neg_hi:[1,0,0]
    v_pk_fma_f32 v[130:131], v[176:177], v[158:159], v[130:131] op_sel_hi:[0,1,1] neg_lo:[1,0,0] neg_hi:[1,0,0]
    v_pk_mul_f32 v[226:227], v[128:129], v[128:129]
    v_pk_mul_f32 v[228:229], v[130:131], v[130:131]
    v_pk_fma_f32 v[226:227], v[226:227], v[178:179], v[178:179] op_sel:[0,1,0] op_sel_hi:[1,1,0]
    v_pk_fma_f32 v[228:229], v[228:229], v[178:179], v[178:179] op_sel:[0,1,0] op_sel_hi:[1,1,0]
    v_pk_mul_f32 v[226:227], v[226:227], v[128:129]
    v_pk_mul_f32 v[228:229], v[228:229], v[130:131]
    v_exp_f32 v226, v226
    v_exp_f32 v227, v227
    v_exp_f32 v228, v228
    v_exp_f32 v229, v229
    v_pk_fma_f32 v[226:227], v[226:227], v[176:177], v[176:177] op_sel:[0,1,1] op_sel_hi:[1,1,1]
    v_pk_fma_f32 v[228:229], v[228:229], v[176:177], v[176:177] op_sel:[0,1,1] op_sel_hi:[1,1,1]
    v_rcp_f32 v226, v226
    v_rcp_f32 v227, v227
    v_rcp_f32 v228, v228
    v_rcp_f32 v229, v229
    v_pk_mul_f32 v[128:129], v[128:129], v[226:227]
    v_pk_mul_f32 v[130:131], v[130:131], v[228:229]
    v_cvt_pk_bf16_f32 v212, v124, v125
    v_cvt_pk_bf16_f32 v213, v126, v127
    v_cvt_pk_bf16_f32 v214, v128, v129
    v_cvt_pk_bf16_f32 v215, v130, v131
    ds_write_b128 v244, v[212:215] offset:38912
    v_pk_fma_f32 v[48:49], v[164:165], v[160:161], v[48:49] op_sel_hi:[0,1,1] neg_lo:[1,0,0] neg_hi:[1,0,0]
    v_pk_fma_f32 v[50:51], v[164:165], v[162:163], v[50:51] op_sel_hi:[0,1,1] neg_lo:[1,0,0] neg_hi:[1,0,0]
    v_pk_mul_f32 v[226:227], v[48:49], v[48:49]
    v_pk_mul_f32 v[228:229], v[50:51], v[50:51]
    v_pk_fma_f32 v[226:227], v[226:227], v[166:167], v[166:167] op_sel:[0,1,0] op_sel_hi:[1,1,0]
    v_pk_fma_f32 v[228:229], v[228:229], v[166:167], v[166:167] op_sel:[0,1,0] op_sel_hi:[1,1,0]
    v_pk_mul_f32 v[226:227], v[226:227], v[48:49]
    v_pk_mul_f32 v[228:229], v[228:229], v[50:51]
    v_exp_f32 v226, v226
    v_exp_f32 v227, v227
    v_exp_f32 v228, v228
    v_exp_f32 v229, v229
    v_pk_fma_f32 v[226:227], v[226:227], v[164:165], v[164:165] op_sel:[0,1,1] op_sel_hi:[1,1,1]
    v_pk_fma_f32 v[228:229], v[228:229], v[164:165], v[164:165] op_sel:[0,1,1] op_sel_hi:[1,1,1]
    v_rcp_f32 v226, v226
    v_rcp_f32 v227, v227
    v_rcp_f32 v228, v228
    v_rcp_f32 v229, v229
    v_pk_mul_f32 v[48:49], v[48:49], v[226:227]
    v_pk_mul_f32 v[50:51], v[50:51], v[228:229]
    v_cvt_pk_bf16_f32 v216, v48, v49
    v_cvt_pk_bf16_f32 v217, v50, v51
    v_or_b32 v216, 1, v216
    s_add_u32 s36, s45, 0
    buffer_store_dwordx4 v[32:35], v2, s[16:19], s36 offen sc1
    v_pk_fma_f32 v[76:77], v[168:169], v[160:161], v[76:77] op_sel_hi:[0,1,1] neg_lo:[1,0,0] neg_hi:[1,0,0]
    v_pk_fma_f32 v[78:79], v[168:169], v[162:163], v[78:79] op_sel_hi:[0,1,1] neg_lo:[1,0,0] neg_hi:[1,0,0]
    v_pk_mul_f32 v[226:227], v[76:77], v[76:77]
    v_pk_mul_f32 v[228:229], v[78:79], v[78:79]
    v_pk_fma_f32 v[226:227], v[226:227], v[170:171], v[170:171] op_sel:[0,1,0] op_sel_hi:[1,1,0]
    v_pk_fma_f32 v[228:229], v[228:229], v[170:171], v[170:171] op_sel:[0,1,0] op_sel_hi:[1,1,0]
    v_pk_mul_f32 v[226:227], v[226:227], v[76:77]
    v_pk_mul_f32 v[228:229], v[228:229], v[78:79]
    v_exp_f32 v226, v226
    v_exp_f32 v227, v227
    v_exp_f32 v228, v228
    v_exp_f32 v229, v229
    v_pk_fma_f32 v[226:227], v[226:227], v[168:169], v[168:169] op_sel:[0,1,1] op_sel_hi:[1,1,1]
    v_pk_fma_f32 v[228:229], v[228:229], v[168:169], v[168:169] op_sel:[0,1,1] op_sel_hi:[1,1,1]
    v_rcp_f32 v226, v226
    v_rcp_f32 v227, v227
    v_rcp_f32 v228, v228
    v_rcp_f32 v229, v229
    v_pk_mul_f32 v[76:77], v[76:77], v[226:227]
    v_pk_mul_f32 v[78:79], v[78:79], v[228:229]
    v_cvt_pk_bf16_f32 v218, v76, v77
    v_cvt_pk_bf16_f32 v219, v78, v79
    v_or_b32 v218, 1, v218
    s_add_u32 s36, s45, 229376
    buffer_store_dwordx4 v[60:63], v2, s[16:19], s36 offen sc1
    v_pk_fma_f32 v[104:105], v[172:173], v[160:161], v[104:105] op_sel_hi:[0,1,1] neg_lo:[1,0,0] neg_hi:[1,0,0]
    v_pk_fma_f32 v[106:107], v[172:173], v[162:163], v[106:107] op_sel_hi:[0,1,1] neg_lo:[1,0,0] neg_hi:[1,0,0]
    v_pk_mul_f32 v[226:227], v[104:105], v[104:105]
    v_pk_mul_f32 v[228:229], v[106:107], v[106:107]
    v_pk_fma_f32 v[226:227], v[226:227], v[174:175], v[174:175] op_sel:[0,1,0] op_sel_hi:[1,1,0]
    v_pk_fma_f32 v[228:229], v[228:229], v[174:175], v[174:175] op_sel:[0,1,0] op_sel_hi:[1,1,0]
    v_pk_mul_f32 v[226:227], v[226:227], v[104:105]
    v_pk_mul_f32 v[228:229], v[228:229], v[106:107]
    v_exp_f32 v226, v226
    v_exp_f32 v227, v227
    v_exp_f32 v228, v228
    v_exp_f32 v229, v229
    v_pk_fma_f32 v[226:227], v[226:227], v[172:173], v[172:173] op_sel:[0,1,1] op_sel_hi:[1,1,1]
    v_pk_fma_f32 v[228:229], v[228:229], v[172:173], v[172:173] op_sel:[0,1,1] op_sel_hi:[1,1,1]
    v_rcp_f32 v226, v226
    v_rcp_f32 v227, v227
    v_rcp_f32 v228, v228
    v_rcp_f32 v229, v229
    v_pk_mul_f32 v[104:105], v[104:105], v[226:227]
    v_pk_mul_f32 v[106:107], v[106:107], v[228:229]
    v_cvt_pk_bf16_f32 v220, v104, v105
    v_cvt_pk_bf16_f32 v221, v106, v107
    v_or_b32 v220, 1, v220
    s_add_u32 s36, s45, 458752
    buffer_store_dwordx4 v[88:91], v2, s[16:19], s36 offen sc1
    v_pk_fma_f32 v[132:133], v[176:177], v[160:161], v[132:133] op_sel_hi:[0,1,1] neg_lo:[1,0,0] neg_hi:[1,0,0]
    v_pk_fma_f32 v[134:135], v[176:177], v[162:163], v[134:135] op_sel_hi:[0,1,1] neg_lo:[1,0,0] neg_hi:[1,0,0]
    v_pk_mul_f32 v[226:227], v[132:133], v[132:133]
    v_pk_mul_f32 v[228:229], v[134:135], v[134:135]
    v_pk_fma_f32 v[226:227], v[226:227], v[178:179], v[178:179] op_sel:[0,1,0] op_sel_hi:[1,1,0]
    v_pk_fma_f32 v[228:229], v[228:229], v[178:179], v[178:179] op_sel:[0,1,0] op_sel_hi:[1,1,0]
    v_pk_mul_f32 v[226:227], v[226:227], v[132:133]
    v_pk_mul_f32 v[228:229], v[228:229], v[134:135]
    v_exp_f32 v226, v226
    v_exp_f32 v227, v227
    v_exp_f32 v228, v228
    v_exp_f32 v229, v229
    v_pk_fma_f32 v[226:227], v[226:227], v[176:177], v[176:177] op_sel:[0,1,1] op_sel_hi:[1,1,1]
    v_pk_fma_f32 v[228:229], v[228:229], v[176:177], v[176:177] op_sel:[0,1,1] op_sel_hi:[1,1,1]
    v_rcp_f32 v226, v226
    v_rcp_f32 v227, v227
    v_rcp_f32 v228, v228
    v_rcp_f32 v229, v229
    v_pk_mul_f32 v[132:133], v[132:133], v[226:227]
    v_pk_mul_f32 v[134:135], v[134:135], v[228:229]
    v_cvt_pk_bf16_f32 v222, v132, v133
    v_cvt_pk_bf16_f32 v223, v134, v135
    s_add_u32 s36, s45, 688128
    buffer_store_dwordx4 v[116:119], v2, s[16:19], s36 offen sc1
    s_waitcnt lgkmcnt(0)
    s_mov_b32 s44, s46
    s_mov_b32 s45, s47
    s_branch G3_e2
G3_e1:
    v_pk_fma_f32 v[28:29], v[164:165], v[140:141], v[28:29] op_sel_hi:[0,1,1] neg_lo:[1,0,0] neg_hi:[1,0,0]
    v_pk_fma_f32 v[30:31], v[164:165], v[142:143], v[30:31] op_sel_hi:[0,1,1] neg_lo:[1,0,0] neg_hi:[1,0,0]
    v_pk_mul_f32 v[226:227], v[28:29], v[28:29]
    v_pk_mul_f32 v[228:229], v[30:31], v[30:31]
    v_pk_fma_f32 v[226:227], v[226:227], v[166:167], v[166:167] op_sel:[0,1,0] op_sel_hi:[1,1,0]
    v_pk_fma_f32 v[228:229], v[228:229], v[166:167], v[166:167] op_sel:[0,1,0] op_sel_hi:[1,1,0]
    v_pk_mul_f32 v[226:227], v[226:227], v[28:29]
    v_pk_mul_f32 v[228:229], v[228:229], v[30:31]
    v_exp_f32 v226, v226
    v_exp_f32 v227, v227
    v_exp_f32 v228, v228
    v_exp_f32 v229, v229
    v_pk_fma_f32 v[226:227], v[226:227], v[164:165], v[164:165] op_sel:[0,1,1] op_sel_hi:[1,1,1]
    v_pk_fma_f32 v[228:229], v[228:229], v[164:165], v[164:165] op_sel:[0,1,1] op_sel_hi:[1,1,1]
    v_rcp_f32 v226, v226
    v_rcp_f32 v227, v227
    v_rcp_f32 v228, v228
    v_rcp_f32 v229, v229
    v_pk_mul_f32 v[28:29], v[28:29], v[226:227]
    v_pk_mul_f32 v[30:31], v[30:31], v[228:229]
    v_pk_fma_f32 v[32:33], v[164:165], v[144:145], v[32:33] op_sel_hi:[0,1,1] neg_lo:[1,0,0] neg_hi:[1,0,0]
    v_pk_fma_f32 v[34:35], v[164:165], v[146:147], v[34:35] op_sel_hi:[0,1,1] neg_lo:[1,0,0] neg_hi:[1,0,0]
    v_pk_mul_f32 v[226:227], v[32:33], v[32:33]
    v_pk_mul_f32 v[228:229], v[34:35], v[34:35]
    v_pk_fma_f32 v[226:227], v[226:227], v[166:167], v[166:167] op_sel:[0,1,0] op_sel_hi:[1,1,0]
    v_pk_fma_f32 v[228:229], v[228:229], v[166:167], v[166:167] op_sel:[0,1,0] op_sel_hi:[1,1,0]
    v_pk_mul_f32 v[226:227], v[226:227], v[32:33]
    v_pk_mul_f32 v[228:229], v[228:229], v[34:35]
    v_exp_f32 v226, v226
    v_exp_f32 v227, v227
    v_exp_f32 v228, v228
    v_exp_f32 v229, v229
    v_pk_fma_f32 v[226:227], v[226:227], v[164:165], v[164:165] op_sel:[0,1,1] op_sel_hi:[1,1,1]
    v_pk_fma_f32 v[228:229], v[228:229], v[164:165], v[164:165] op_sel:[0,1,1] op_sel_hi:[1,1,1]
    v_rcp_f32 v226, v226
    v_rcp_f32 v227, v227
    v_rcp_f32 v228, v228
    v_rcp_f32 v229, v229
    v_pk_mul_f32 v[32:33], v[32:33], v[226:227]
    v_pk_mul_f32 v[34:35], v[34:35], v[228:229]
    v_cvt_pk_bf16_f32 v28, v28, v29
    v_cvt_pk_bf16_f32 v29, v30, v31
    v_cvt_pk_bf16_f32 v30, v32, v33
    v_cvt_pk_bf16_f32 v31, v34, v35
    v_or_b32 v28, 1, v28
    ds_write_b128 v244, v[28:31] offset:0
    s_add_u32 s36, s45, 0
    buffer_store_dwordx4 v[28:31], v2, s[16:19], s36 offen sc1
    v_pk_fma_f32 v[56:57], v[168:169], v[140:141], v[56:57] op_sel_hi:[0,1,1] neg_lo:[1,0,0] neg_hi:[1,0,0]
    v_pk_fma_f32 v[58:59], v[168:169], v[142:143], v[58:59] op_sel_hi:[0,1,1] neg_lo:[1,0,0] neg_hi:[1,0,0]
    v_pk_mul_f32 v[226:227], v[56:57], v[56:57]
    v_pk_mul_f32 v[228:229], v[58:59], v[58:59]
    v_pk_fma_f32 v[226:227], v[226:227], v[170:171], v[170:171] op_sel:[0,1,0] op_sel_hi:[1,1,0]
    v_pk_fma_f32 v[228:229], v[228:229], v[170:171], v[170:171] op_sel:[0,1,0] op_sel_hi:[1,1,0]
    v_pk_mul_f32 v[226:227], v[226:227], v[56:57]
    v_pk_mul_f32 v[228:229], v[228:229], v[58:59]
    v_exp_f32 v226, v226
    v_exp_f32 v227, v227
    v_exp_f32 v228, v228
    v_exp_f32 v229, v229
    v_pk_fma_f32 v[226:227], v[226:227], v[168:169], v[168:169] op_sel:[0,1,1] op_sel_hi:[1,1,1]
    v_pk_fma_f32 v[228:229], v[228:229], v[168:169], v[168:169] op_sel:[0,1,1] op_sel_hi:[1,1,1]
    v_rcp_f32 v226, v226
    v_rcp_f32 v227, v227
    v_rcp_f32 v228, v228
    v_rcp_f32 v229, v229
    v_pk_mul_f32 v[56:57], v[56:57], v[226:227]
    v_pk_mul_f32 v[58:59], v[58:59], v[228:229]
    v_pk_fma_f32 v[60:61], v[168:169], v[144:145], v[60:61] op_sel_hi:[0,1,1] neg_lo:[1,0,0] neg_hi:[1,0,0]
    v_pk_fma_f32 v[62:63], v[168:169], v[146:147], v[62:63] op_sel_hi:[0,1,1] neg_lo:[1,0,0] neg_hi:[1,0,0]
    v_pk_mul_f32 v[226:227], v[60:61], v[60:61]
    v_pk_mul_f32 v[228:229], v[62:63], v[62:63]
    v_pk_fma_f32 v[226:227], v[226:227], v[170:171], v[170:171] op_sel:[0,1,0] op_sel_hi:[1,1,0]
    v_pk_fma_f32 v[228:229], v[228:229], v[170:171], v[170:171] op_sel:[0,1,0] op_sel_hi:[1,1,0]
    v_pk_mul_f32 v[226:227], v[226:227], v[60:61]
    v_pk_mul_f32 v[228:229], v[228:229], v[62:63]
    v_exp_f32 v226, v226
    v_exp_f32 v227, v227
    v_exp_f32 v228, v228
    v_exp_f32 v229, v229
    v_pk_fma_f32 v[226:227], v[226:227], v[168:169], v[168:169] op_sel:[0,1,1] op_sel_hi:[1,1,1]
    v_pk_fma_f32 v[228:229], v[228:229], v[168:169], v[168:169] op_sel:[0,1,1] op_sel_hi:[1,1,1]
    v_rcp_f32 v226, v226
    v_rcp_f32 v227, v227
    v_rcp_f32 v228, v228
    v_rcp_f32 v229, v229
    v_pk_mul_f32 v[60:61], v[60:61], v[226:227]
    v_pk_mul_f32 v[62:63], v[62:63], v[228:229]
    v_cvt_pk_bf16_f32 v56, v56, v57
    v_cvt_pk_bf16_f32 v57, v58, v59
    v_cvt_pk_bf16_f32 v58, v60, v61
    v_cvt_pk_bf16_f32 v59, v62, v63
    v_or_b32 v56, 1, v56
    ds_write_b128 v244, v[56:59] offset:2048
    s_add_u32 s36, s45, 229376
    buffer_store_dwordx4 v[56:59], v2, s[16:19], s36 offen sc1
    v_pk_fma_f32 v[84:85], v[172:173], v[140:141], v[84:85] op_sel_hi:[0,1,1] neg_lo:[1,0,0] neg_hi:[1,0,0]
    v_pk_fma_f32 v[86:87], v[172:173], v[142:143], v[86:87] op_sel_hi:[0,1,1] neg_lo:[1,0,0] neg_hi:[1,0,0]
    v_pk_mul_f32 v[226:227], v[84:85], v[84:85]
    v_pk_mul_f32 v[228:229], v[86:87], v[86:87]
    v_pk_fma_f32 v[226:227], v[226:227], v[174:175], v[174:175] op_sel:[0,1,0] op_sel_hi:[1,1,0]
    v_pk_fma_f32 v[228:229], v[228:229], v[174:175], v[174:175] op_sel:[0,1,0] op_sel_hi:[1,1,0]
    v_pk_mul_f32 v[226:227], v[226:227], v[84:85]
    v_pk_mul_f32 v[228:229], v[228:229], v[86:87]
    v_exp_f32 v226, v226
    v_exp_f32 v227, v227
    v_exp_f32 v228, v228
    v_exp_f32 v229, v229
    v_pk_fma_f32 v[226:227], v[226:227], v[172:173], v[172:173] op_sel:[0,1,1] op_sel_hi:[1,1,1]
    v_pk_fma_f32 v[228:229], v[228:229], v[172:173], v[172:173] op_sel:[0,1,1] op_sel_hi:[1,1,1]
    v_rcp_f32 v226, v226
    v_rcp_f32 v227, v227
    v_rcp_f32 v228, v228
    v_rcp_f32 v229, v229
    v_pk_mul_f32 v[84:85], v[84:85], v[226:227]
    v_pk_mul_f32 v[86:87], v[86:87], v[228:229]
    v_pk_fma_f32 v[88:89], v[172:173], v[144:145], v[88:89] op_sel_hi:[0,1,1] neg_lo:[1,0,0] neg_hi:[1,0,0]
    v_pk_fma_f32 v[90:91], v[172:173], v[146:147], v[90:91] op_sel_hi:[0,1,1] neg_lo:[1,0,0] neg_hi:[1,0,0]
    v_pk_mul_f32 v[226:227], v[88:89], v[88:89]
    v_pk_mul_f32 v[228:229], v[90:91], v[90:91]
    v_pk_fma_f32 v[226:227], v[226:227], v[174:175], v[174:175] op_sel:[0,1,0] op_sel_hi:[1,1,0]
    v_pk_fma_f32 v[228:229], v[228:229], v[174:175], v[174:175] op_sel:[0,1,0] op_sel_hi:[1,1,0]
    v_pk_mul_f32 v[226:227], v[226:227], v[88:89]
    v_pk_mul_f32 v[228:229], v[228:229], v[90:91]
    v_exp_f32 v226, v226
    v_exp_f32 v227, v227
    v_exp_f32 v228, v228
    v_exp_f32 v229, v229
    v_pk_fma_f32 v[226:227], v[226:227], v[172:173], v[172:173] op_sel:[0,1,1] op_sel_hi:[1,1,1]
    v_pk_fma_f32 v[228:229], v[228:229], v[172:173], v[172:173] op_sel:[0,1,1] op_sel_hi:[1,1,1]
    v_rcp_f32 v226, v226
    v_rcp_f32 v227, v227
    v_rcp_f32 v228, v228
    v_rcp_f32 v229, v229
    v_pk_mul_f32 v[88:89], v[88:89], v[226:227]
    v_pk_mul_f32 v[90:91], v[90:91], v[228:229]
    v_cvt_pk_bf16_f32 v84, v84, v85
    v_cvt_pk_bf16_f32 v85, v86, v87
    v_cvt_pk_bf16_f32 v86, v88, v89
    v_cvt_pk_bf16_f32 v87, v90, v91
    v_or_b32 v84, 1, v84
    ds_write_b128 v244, v[84:87] offset:4096
    s_add_u32 s36, s45, 458752
    buffer_store_dwordx4 v[84:87], v2, s[16:19], s36 offen sc1
    v_pk_fma_f32 v[112:113], v[176:177], v[140:141], v[112:113] op_sel_hi:[0,1,1] neg_lo:[1,0,0] neg_hi:[1,0,0]
    v_pk_fma_f32 v[114:115], v[176:177], v[142:143], v[114:115] op_sel_hi:[0,1,1] neg_lo:[1,0,0] neg_hi:[1,0,0]
    v_pk_mul_f32 v[226:227], v[112:113], v[112:113]
    v_pk_mul_f32 v[228:229], v[114:115], v[114:115]
    v_pk_fma_f32 v[226:227], v[226:227], v[178:179], v[178:179] op_sel:[0,1,0] op_sel_hi:[1,1,0]
    v_pk_fma_f32 v[228:229], v[228:229], v[178:179], v[178:179] op_sel:[0,1,0] op_sel_hi:[1,1,0]
    v_pk_mul_f32 v[226:227], v[226:227], v[112:113]
    v_pk_mul_f32 v[228:229], v[228:229], v[114:115]
    v_exp_f32 v226, v226
    v_exp_f32 v227, v227
    v_exp_f32 v228, v228
    v_exp_f32 v229, v229
    v_pk_fma_f32 v[226:227], v[226:227], v[176:177], v[176:177] op_sel:[0,1,1] op_sel_hi:[1,1,1]
    v_pk_fma_f32 v[228:229], v[228:229], v[176:177], v[176:177] op_sel:[0,1,1] op_sel_hi:[1,1,1]
    v_rcp_f32 v226, v226
    v_rcp_f32 v227, v227
    v_rcp_f32 v228, v228
    v_rcp_f32 v229, v229
    v_pk_mul_f32 v[112:113], v[112:113], v[226:227]
    v_pk_mul_f32 v[114:115], v[114:115], v[228:229]
    v_pk_fma_f32 v[116:117], v[176:177], v[144:145], v[116:117] op_sel_hi:[0,1,1] neg_lo:[1,0,0] neg_hi:[1,0,0]
    v_pk_fma_f32 v[118:119], v[176:177], v[146:147], v[118:119] op_sel_hi:[0,1,1] neg_lo:[1,0,0] neg_hi:[1,0,0]
    v_pk_mul_f32 v[226:227], v[116:117], v[116:117]
    v_pk_mul_f32 v[228:229], v[118:119], v[118:119]
    v_pk_fma_f32 v[226:227], v[226:227], v[178:179], v[178:179] op_sel:[0,1,0] op_sel_hi:[1,1,0]
    v_pk_fma_f32 v[228:229], v[228:229], v[178:179], v[178:179] op_sel:[0,1,0] op_sel_hi:[1,1,0]
    v_pk_mul_f32 v[226:227], v[226:227], v[116:117]
    v_pk_mul_f32 v[228:229], v[228:229], v[118:119]
    v_exp_f32 v226, v226
    v_exp_f32 v227, v227
    v_exp_f32 v228, v228
    v_exp_f32 v229, v229
    v_pk_fma_f32 v[226:227], v[226:227], v[176:177], v[176:177] op_sel:[0,1,1] op_sel_hi:[1,1,1]
    v_pk_fma_f32 v[228:229], v[228:229], v[176:177], v[176:177] op_sel:[0,1,1] op_sel_hi:[1,1,1]
    v_rcp_f32 v226, v226
    v_rcp_f32 v227, v227
    v_rcp_f32 v228, v228
    v_rcp_f32 v229, v229
    v_pk_mul_f32 v[116:117], v[116:117], v[226:227]
    v_pk_mul_f32 v[118:119], v[118:119], v[228:229]
    v_cvt_pk_bf16_f32 v112, v112, v113
    v_cvt_pk_bf16_f32 v113, v114, v115
    v_cvt_pk_bf16_f32 v114, v116, v117
    v_cvt_pk_bf16_f32 v115, v118, v119
    ds_write_b128 v244, v[112:115] offset:6144
    s_add_u32 s36, s45, 688128
    buffer_store_dwordx4 v[112:115], v2, s[16:19], s36 offen sc1
    v_pk_fma_f32 v[36:37], v[164:165], v[148:149], v[36:37] op_sel_hi:[0,1,1] neg_lo:[1,0,0] neg_hi:[1,0,0]
    v_pk_fma_f32 v[38:39], v[164:165], v[150:151], v[38:39] op_sel_hi:[0,1,1] neg_lo:[1,0,0] neg_hi:[1,0,0]
    v_pk_mul_f32 v[226:227], v[36:37], v[36:37]
    v_pk_mul_f32 v[228:229], v[38:39], v[38:39]
    v_pk_fma_f32 v[226:227], v[226:227], v[166:167], v[166:167] op_sel:[0,1,0] op_sel_hi:[1,1,0]
    v_pk_fma_f32 v[228:229], v[228:229], v[166:167], v[166:167] op_sel:[0,1,0] op_sel_hi:[1,1,0]
    v_pk_mul_f32 v[226:227], v[226:227], v[36:37]
    v_pk_mul_f32 v[228:229], v[228:229], v[38:39]
    v_exp_f32 v226, v226
    v_exp_f32 v227, v227
    v_exp_f32 v228, v228
    v_exp_f32 v229, v229
    v_pk_fma_f32 v[226:227], v[226:227], v[164:165], v[164:165] op_sel:[0,1,1] op_sel_hi:[1,1,1]
    v_pk_fma_f32 v[228:229], v[228:229], v[164:165], v[164:165] op_sel:[0,1,1] op_sel_hi:[1,1,1]
    v_rcp_f32 v226, v226
    v_rcp_f32 v227, v227
    v_rcp_f32 v228, v228
    v_rcp_f32 v229, v229
    v_pk_mul_f32 v[36:37], v[36:37], v[226:227]
    v_pk_mul_f32 v[38:39], v[38:39], v[228:229]
    v_pk_fma_f32 v[40:41], v[164:165], v[152:153], v[40:41] op_sel_hi:[0,1,1] neg_lo:[1,0,0] neg_hi:[1,0,0]
    v_pk_fma_f32 v[42:43], v[164:165], v[154:155], v[42:43] op_sel_hi:[0,1,1] neg_lo:[1,0,0] neg_hi:[1,0,0]
    v_pk_mul_f32 v[226:227], v[40:41], v[40:41]
    v_pk_mul_f32 v[228:229], v[42:43], v[42:43]
    v_pk_fma_f32 v[226:227], v[226:227], v[166:167], v[166:167] op_sel:[0,1,0] op_sel_hi:[1,1,0]
    v_pk_fma_f32 v[228:229], v[228:229], v[166:167], v[166:167] op_sel:[0,1,0] op_sel_hi:[1,1,0]
    v_pk_mul_f32 v[226:227], v[226:227], v[40:41]
    v_pk_mul_f32 v[228:229], v[228:229], v[42:43]
    v_exp_f32 v226, v226
    v_exp_f32 v227, v227
    v_exp_f32 v228, v228
    v_exp_f32 v229, v229
    v_pk_fma_f32 v[226:227], v[226:227], v[164:165], v[164:165] op_sel:[0,1,1] op_sel_hi:[1,1,1]
    v_pk_fma_f32 v[228:229], v[228:229], v[164:165], v[164:165] op_sel:[0,1,1] op_sel_hi:[1,1,1]
    v_rcp_f32 v226, v226
    v_rcp_f32 v227, v227
    v_rcp_f32 v228, v228
    v_rcp_f32 v229, v229
    v_pk_mul_f32 v[40:41], v[40:41], v[226:227]
    v_pk_mul_f32 v[42:43], v[42:43], v[228:229]
    v_cvt_pk_bf16_f32 v36, v36, v37
    v_cvt_pk_bf16_f32 v37, v38, v39
    v_cvt_pk_bf16_f32 v38, v40, v41
    v_cvt_pk_bf16_f32 v39, v42, v43
    v_or_b32 v36, 1, v36
    ds_write_b128 v244, v[36:39] offset:16384
    v_pk_fma_f32 v[64:65], v[168:169], v[148:149], v[64:65] op_sel_hi:[0,1,1] neg_lo:[1,0,0] neg_hi:[1,0,0]
    v_pk_fma_f32 v[66:67], v[168:169], v[150:151], v[66:67] op_sel_hi:[0,1,1] neg_lo:[1,0,0] neg_hi:[1,0,0]
    v_pk_mul_f32 v[226:227], v[64:65], v[64:65]
    v_pk_mul_f32 v[228:229], v[66:67], v[66:67]
    v_pk_fma_f32 v[226:227], v[226:227], v[170:171], v[170:171] op_sel:[0,1,0] op_sel_hi:[1,1,0]
    v_pk_fma_f32 v[228:229], v[228:229], v[170:171], v[170:171] op_sel:[0,1,0] op_sel_hi:[1,1,0]
    v_pk_mul_f32 v[226:227], v[226:227], v[64:65]
    v_pk_mul_f32 v[228:229], v[228:229], v[66:67]
    v_exp_f32 v226, v226
    v_exp_f32 v227, v227
    v_exp_f32 v228, v228
    v_exp_f32 v229, v229
    v_pk_fma_f32 v[226:227], v[226:227], v[168:169], v[168:169] op_sel:[0,1,1] op_sel_hi:[1,1,1]
    v_pk_fma_f32 v[228:229], v[228:229], v[168:169], v[168:169] op_sel:[0,1,1] op_sel_hi:[1,1,1]
    v_rcp_f32 v226, v226
    v_rcp_f32 v227, v227
    v_rcp_f32 v228, v228
    v_rcp_f32 v229, v229
    v_pk_mul_f32 v[64:65], v[64:65], v[226:227]
    v_pk_mul_f32 v[66:67], v[66:67], v[228:229]
    v_pk_fma_f32 v[68:69], v[168:169], v[152:153], v[68:69] op_sel_hi:[0,1,1] neg_lo:[1,0,0] neg_hi:[1,0,0]
    v_pk_fma_f32 v[70:71], v[168:169], v[154:155], v[70:71] op_sel_hi:[0,1,1] neg_lo:[1,0,0] neg_hi:[1,0,0]
    v_pk_mul_f32 v[226:227], v[68:69], v[68:69]
    v_pk_mul_f32 v[228:229], v[70:71], v[70:71]
    v_pk_fma_f32 v[226:227], v[226:227], v[170:171], v[170:171] op_sel:[0,1,0] op_sel_hi:[1,1,0]
    v_pk_fma_f32 v[228:229], v[228:229], v[170:171], v[170:171] op_sel:[0,1,0] op_sel_hi:[1,1,0]
    v_pk_mul_f32 v[226:227], v[226:227], v[68:69]
    v_pk_mul_f32 v[228:229], v[228:229], v[70:71]
    v_exp_f32 v226, v226
    v_exp_f32 v227, v227
    v_exp_f32 v228, v228
    v_exp_f32 v229, v229
    v_pk_fma_f32 v[226:227], v[226:227], v[168:169], v[168:169] op_sel:[0,1,1] op_sel_hi:[1,1,1]
    v_pk_fma_f32 v[228:229], v[228:229], v[168:169], v[168:169] op_sel:[0,1,1] op_sel_hi:[1,1,1]
    v_rcp_f32 v226, v226
    v_rcp_f32 v227, v227
    v_rcp_f32 v228, v228
    v_rcp_f32 v229, v229
    v_pk_mul_f32 v[68:69], v[68:69], v[226:227]
    v_pk_mul_f32 v[70:71], v[70:71], v[228:229]
    v_cvt_pk_bf16_f32 v64, v64, v65
    v_cvt_pk_bf16_f32 v65, v66, v67
    v_cvt_pk_bf16_f32 v66, v68, v69
    v_cvt_pk_bf16_f32 v67, v70, v71
    v_or_b32 v64, 1, v64
    ds_write_b128 v244, v[64:67] offset:18432
    s_waitcnt vmcnt(0)
    s_mov_b64 exec, 1
    ds_add_u32 v246, v245
    s_mov_b64 exec, -1
    v_pk_fma_f32 v[92:93], v[172:173], v[148:149], v[92:93] op_sel_hi:[0,1,1] neg_lo:[1,0,0] neg_hi:[1,0,0]
    v_pk_fma_f32 v[94:95], v[172:173], v[150:151], v[94:95] op_sel_hi:[0,1,1] neg_lo:[1,0,0] neg_hi:[1,0,0]
    v_pk_mul_f32 v[226:227], v[92:93], v[92:93]
    v_pk_mul_f32 v[228:229], v[94:95], v[94:95]
    v_pk_fma_f32 v[226:227], v[226:227], v[174:175], v[174:175] op_sel:[0,1,0] op_sel_hi:[1,1,0]
    v_pk_fma_f32 v[228:229], v[228:229], v[174:175], v[174:175] op_sel:[0,1,0] op_sel_hi:[1,1,0]
    v_pk_mul_f32 v[226:227], v[226:227], v[92:93]
    v_pk_mul_f32 v[228:229], v[228:229], v[94:95]
    v_exp_f32 v226, v226
    v_exp_f32 v227, v227
    v_exp_f32 v228, v228
    v_exp_f32 v229, v229
    v_pk_fma_f32 v[226:227], v[226:227], v[172:173], v[172:173] op_sel:[0,1,1] op_sel_hi:[1,1,1]
    v_pk_fma_f32 v[228:229], v[228:229], v[172:173], v[172:173] op_sel:[0,1,1] op_sel_hi:[1,1,1]
    v_rcp_f32 v226, v226
    v_rcp_f32 v227, v227
    v_rcp_f32 v228, v228
    v_rcp_f32 v229, v229
    v_pk_mul_f32 v[92:93], v[92:93], v[226:227]
    v_pk_mul_f32 v[94:95], v[94:95], v[228:229]
    v_pk_fma_f32 v[96:97], v[172:173], v[152:153], v[96:97] op_sel_hi:[0,1,1] neg_lo:[1,0,0] neg_hi:[1,0,0]
    v_pk_fma_f32 v[98:99], v[172:173], v[154:155], v[98:99] op_sel_hi:[0,1,1] neg_lo:[1,0,0] neg_hi:[1,0,0]
    v_pk_mul_f32 v[226:227], v[96:97], v[96:97]
    v_pk_mul_f32 v[228:229], v[98:99], v[98:99]
    v_pk_fma_f32 v[226:227], v[226:227], v[174:175], v[174:175] op_sel:[0,1,0] op_sel_hi:[1,1,0]
    v_pk_fma_f32 v[228:229], v[228:229], v[174:175], v[174:175] op_sel:[0,1,0] op_sel_hi:[1,1,0]
    v_pk_mul_f32 v[226:227], v[226:227], v[96:97]
    v_pk_mul_f32 v[228:229], v[228:229], v[98:99]
    v_exp_f32 v226, v226
    v_exp_f32 v227, v227
    v_exp_f32 v228, v228
    v_exp_f32 v229, v229
    v_pk_fma_f32 v[226:227], v[226:227], v[172:173], v[172:173] op_sel:[0,1,1] op_sel_hi:[1,1,1]
    v_pk_fma_f32 v[228:229], v[228:229], v[172:173], v[172:173] op_sel:[0,1,1] op_sel_hi:[1,1,1]
    v_rcp_f32 v226, v226
    v_rcp_f32 v227, v227
    v_rcp_f32 v228, v228
    v_rcp_f32 v229, v229
    v_pk_mul_f32 v[96:97], v[96:97], v[226:227]
    v_pk_mul_f32 v[98:99], v[98:99], v[228:229]
    v_cvt_pk_bf16_f32 v92, v92, v93
    v_cvt_pk_bf16_f32 v93, v94, v95
    v_cvt_pk_bf16_f32 v94, v96, v97
    v_cvt_pk_bf16_f32 v95, v98, v99
    v_or_b32 v92, 1, v92
    ds_write_b128 v244, v[92:95] offset:20480
    s_cmp_eq_u32 s60, 1
    s_cbranch_scc1 G4_p11
    buffer_load_dwordx4 v[180:183], v196, s[84:87], 0 offen offset:0 sc1
    buffer_load_dwordx4 v[188:191], v196, s[88:91], 0 offen offset:0 sc1
    buffer_load_dwordx4 v[184:187], v196, s[84:87], 0 offen offset:2048 sc1
    buffer_load_dwordx4 v[192:195], v196, s[88:91], 0 offen offset:2048 sc1
    s_branch G4_p21
G4_p11:
    s_add_u32 s36, s40, 0
    buffer_load_dwordx4 v[180:183], v2, s[84:87], s36 offen offset:0 sc1
    buffer_load_dwordx4 v[184:187], v2, s[88:91], s36 offen offset:0 sc1
    buffer_load_dwordx4 v[188:191], v2, s[84:87], s36 offen offset:1024 sc1
    buffer_load_dwordx4 v[192:195], v2, s[88:91], s36 offen offset:1024 sc1
    s_add_u32 s36, s40, 65536
    buffer_load_dwordx4 v[196:199], v2, s[84:87], s36 offen offset:0 sc1
    buffer_load_dwordx4 v[230:233], v2, s[88:91], s36 offen offset:0 sc1
    buffer_load_dwordx4 v[234:237], v2, s[84:87], s36 offen offset:1024 sc1
    buffer_load_dwordx4 v[248:251], v2, s[88:91], s36 offen offset:1024 sc1
G4_p21:
    v_pk_fma_f32 v[120:121], v[176:177], v[148:149], v[120:121] op_sel_hi:[0,1,1] neg_lo:[1,0,0] neg_hi:[1,0,0]
    v_pk_fma_f32 v[122:123], v[176:177], v[150:151], v[122:123] op_sel_hi:[0,1,1] neg_lo:[1,0,0] neg_hi:[1,0,0]
    v_pk_mul_f32 v[226:227], v[120:121], v[120:121]
    v_pk_mul_f32 v[228:229], v[122:123], v[122:123]
    v_pk_fma_f32 v[226:227], v[226:227], v[178:179], v[178:179] op_sel:[0,1,0] op_sel_hi:[1,1,0]
    v_pk_fma_f32 v[228:229], v[228:229], v[178:179], v[178:179] op_sel:[0,1,0] op_sel_hi:[1,1,0]
    v_pk_mul_f32 v[226:227], v[226:227], v[120:121]
    v_pk_mul_f32 v[228:229], v[228:229], v[122:123]
    v_exp_f32 v226, v226
    v_exp_f32 v227, v227
    v_exp_f32 v228, v228
    v_exp_f32 v229, v229
    v_pk_fma_f32 v[226:227], v[226:227], v[176:177], v[176:177] op_sel:[0,1,1] op_sel_hi:[1,1,1]
    v_pk_fma_f32 v[228:229], v[228:229], v[176:177], v[176:177] op_sel:[0,1,1] op_sel_hi:[1,1,1]
    v_rcp_f32 v226, v226
    v_rcp_f32 v227, v227
    v_rcp_f32 v228, v228
    v_rcp_f32 v229, v229
    v_pk_mul_f32 v[120:121], v[120:121], v[226:227]
    v_pk_mul_f32 v[122:123], v[122:123], v[228:229]
    v_pk_fma_f32 v[124:125], v[176:177], v[152:153], v[124:125] op_sel_hi:[0,1,1] neg_lo:[1,0,0] neg_hi:[1,0,0]
    v_pk_fma_f32 v[126:127], v[176:177], v[154:155], v[126:127] op_sel_hi:[0,1,1] neg_lo:[1,0,0] neg_hi:[1,0,0]
    v_pk_mul_f32 v[226:227], v[124:125], v[124:125]
    v_pk_mul_f32 v[228:229], v[126:127], v[126:127]
    v_pk_fma_f32 v[226:227], v[226:227], v[178:179], v[178:179] op_sel:[0,1,0] op_sel_hi:[1,1,0]
    v_pk_fma_f32 v[228:229], v[228:229], v[178:179], v[178:179] op_sel:[0,1,0] op_sel_hi:[1,1,0]
    v_pk_mul_f32 v[226:227], v[226:227], v[124:125]
    v_pk_mul_f32 v[228:229], v[228:229], v[126:127]
    v_exp_f32 v226, v226
    v_exp_f32 v227, v227
    v_exp_f32 v228, v228
    v_exp_f32 v229, v229
    v_pk_fma_f32 v[226:227], v[226:227], v[176:177], v[176:177] op_sel:[0,1,1] op_sel_hi:[1,1,1]
    v_pk_fma_f32 v[228:229], v[228:229], v[176:177], v[176:177] op_sel:[0,1,1] op_sel_hi:[1,1,1]
    v_rcp_f32 v226, v226
    v_rcp_f32 v227, v227
    v_rcp_f32 v228, v228
    v_rcp_f32 v229, v229
    v_pk_mul_f32 v[124:125], v[124:125], v[226:227]
    v_pk_mul_f32 v[126:127], v[126:127], v[228:229]
    v_cvt_pk_bf16_f32 v120, v120, v121
    v_cvt_pk_bf16_f32 v121, v122, v123
    v_cvt_pk_bf16_f32 v122, v124, v125
    v_cvt_pk_bf16_f32 v123, v126, v127
    ds_write_b128 v244, v[120:123] offset:22528
    v_pk_fma_f32 v[44:45], v[164:165], v[156:157], v[44:45] op_sel_hi:[0,1,1] neg_lo:[1,0,0] neg_hi:[1,0,0]
    v_pk_fma_f32 v[46:47], v[164:165], v[158:159], v[46:47] op_sel_hi:[0,1,1] neg_lo:[1,0,0] neg_hi:[1,0,0]
    v_pk_mul_f32 v[226:227], v[44:45], v[44:45]
    v_pk_mul_f32 v[228:229], v[46:47], v[46:47]
    v_pk_fma_f32 v[226:227], v[226:227], v[166:167], v[166:167] op_sel:[0,1,0] op_sel_hi:[1,1,0]
    v_pk_fma_f32 v[228:229], v[228:229], v[166:167], v[166:167] op_sel:[0,1,0] op_sel_hi:[1,1,0]
    v_pk_mul_f32 v[226:227], v[226:227], v[44:45]
    v_pk_mul_f32 v[228:229], v[228:229], v[46:47]
    v_exp_f32 v226, v226
    v_exp_f32 v227, v227
    v_exp_f32 v228, v228
    v_exp_f32 v229, v229
    v_pk_fma_f32 v[226:227], v[226:227], v[164:165], v[164:165] op_sel:[0,1,1] op_sel_hi:[1,1,1]
    v_pk_fma_f32 v[228:229], v[228:229], v[164:165], v[164:165] op_sel:[0,1,1] op_sel_hi:[1,1,1]
    v_rcp_f32 v226, v226
    v_rcp_f32 v227, v227
    v_rcp_f32 v228, v228
    v_rcp_f32 v229, v229
    v_pk_mul_f32 v[44:45], v[44:45], v[226:227]
    v_pk_mul_f32 v[46:47], v[46:47], v[228:229]
    v_pk_fma_f32 v[48:49], v[164:165], v[160:161], v[48:49] op_sel_hi:[0,1,1] neg_lo:[1,0,0] neg_hi:[1,0,0]
    v_pk_fma_f32 v[50:51], v[164:165], v[162:163], v[50:51] op_sel_hi:[0,1,1] neg_lo:[1,0,0] neg_hi:[1,0,0]
    v_pk_mul_f32 v[226:227], v[48:49], v[48:49]
    v_pk_mul_f32 v[228:229], v[50:51], v[50:51]
    v_pk_fma_f32 v[226:227], v[226:227], v[166:167], v[166:167] op_sel:[0,1,0] op_sel_hi:[1,1,0]
    v_pk_fma_f32 v[228:229], v[228:229], v[166:167], v[166:167] op_sel:[0,1,0] op_sel_hi:[1,1,0]
    v_pk_mul_f32 v[226:227], v[226:227], v[48:49]
    v_pk_mul_f32 v[228:229], v[228:229], v[50:51]
    v_exp_f32 v226, v226
    v_exp_f32 v227, v227
    v_exp_f32 v228, v228
    v_exp_f32 v229, v229
    v_pk_fma_f32 v[226:227], v[226:227], v[164:165], v[164:165] op_sel:[0,1,1] op_sel_hi:[1,1,1]
    v_pk_fma_f32 v[228:229], v[228:229], v[164:165], v[164:165] op_sel:[0,1,1] op_sel_hi:[1,1,1]
    v_rcp_f32 v226, v226
    v_rcp_f32 v227, v227
    v_rcp_f32 v228, v228
    v_rcp_f32 v229, v229
    v_pk_mul_f32 v[48:49], v[48:49], v[226:227]
    v_pk_mul_f32 v[50:51], v[50:51], v[228:229]
    v_cvt_pk_bf16_f32 v200, v44, v45
    v_cvt_pk_bf16_f32 v201, v46, v47
    v_cvt_pk_bf16_f32 v202, v48, v49
    v_cvt_pk_bf16_f32 v203, v50, v51
    v_or_b32 v200, 1, v200
    ds_write_b128 v244, v[200:203] offset:32768
    v_pk_fma_f32 v[72:73], v[168:169], v[156:157], v[72:73] op_sel_hi:[0,1,1] neg_lo:[1,0,0] neg_hi:[1,0,0]
    v_pk_fma_f32 v[74:75], v[168:169], v[158:159], v[74:75] op_sel_hi:[0,1,1] neg_lo:[1,0,0] neg_hi:[1,0,0]
    v_pk_mul_f32 v[226:227], v[72:73], v[72:73]
    v_pk_mul_f32 v[228:229], v[74:75], v[74:75]
    v_pk_fma_f32 v[226:227], v[226:227], v[170:171], v[170:171] op_sel:[0,1,0] op_sel_hi:[1,1,0]
    v_pk_fma_f32 v[228:229], v[228:229], v[170:171], v[170:171] op_sel:[0,1,0] op_sel_hi:[1,1,0]
    v_pk_mul_f32 v[226:227], v[226:227], v[72:73]
    v_pk_mul_f32 v[228:229], v[228:229], v[74:75]
    v_exp_f32 v226, v226
    v_exp_f32 v227, v227
    v_exp_f32 v228, v228
    v_exp_f32 v229, v229
    v_pk_fma_f32 v[226:227], v[226:227], v[168:169], v[168:169] op_sel:[0,1,1] op_sel_hi:[1,1,1]
    v_pk_fma_f32 v[228:229], v[228:229], v[168:169], v[168:169] op_sel:[0,1,1] op_sel_hi:[1,1,1]
    v_rcp_f32 v226, v226
    v_rcp_f32 v227, v227
    v_rcp_f32 v228, v228
    v_rcp_f32 v229, v229
    v_pk_mul_f32 v[72:73], v[72:73], v[226:227]
    v_pk_mul_f32 v[74:75], v[74:75], v[228:229]
    v_pk_fma_f32 v[76:77], v[168:169], v[160:161], v[76:77] op_sel_hi:[0,1,1] neg_lo:[1,0,0] neg_hi:[1,0,0]
    v_pk_fma_f32 v[78:79], v[168:169], v[162:163], v[78:79] op_sel_hi:[0,1,1] neg_lo:[1,0,0] neg_hi:[1,0,0]
    v_pk_mul_f32 v[226:227], v[76:77], v[76:77]
    v_pk_mul_f32 v[228:229], v[78:79], v[78:79]
    v_pk_fma_f32 v[226:227], v[226:227], v[170:171], v[170:171] op_sel:[0,1,0] op_sel_hi:[1,1,0]
    v_pk_fma_f32 v[228:229], v[228:229], v[170:171], v[170:171] op_sel:[0,1,0] op_sel_hi:[1,1,0]
    v_pk_mul_f32 v[226:227], v[226:227], v[76:77]
    v_pk_mul_f32 v[228:229], v[228:229], v[78:79]
    v_exp_f32 v226, v226
    v_exp_f32 v227, v227
    v_exp_f32 v228, v228
    v_exp_f32 v229, v229
    v_pk_fma_f32 v[226:227], v[226:227], v[168:169], v[168:169] op_sel:[0,1,1] op_sel_hi:[1,1,1]
    v_pk_fma_f32 v[228:229], v[228:229], v[168:169], v[168:169] op_sel:[0,1,1] op_sel_hi:[1,1,1]
    v_rcp_f32 v226, v226
    v_rcp_f32 v227, v227
    v_rcp_f32 v228, v228
    v_rcp_f32 v229, v229
    v_pk_mul_f32 v[76:77], v[76:77], v[226:227]
    v_pk_mul_f32 v[78:79], v[78:79], v[228:229]
    v_cvt_pk_bf16_f32 v204, v72, v73
    v_cvt_pk_bf16_f32 v205, v74, v75
    v_cvt_pk_bf16_f32 v206, v76, v77
    v_cvt_pk_bf16_f32 v207, v78, v79
    v_or_b32 v204, 1, v204
    ds_write_b128 v244, v[204:207] offset:34816
    v_pk_fma_f32 v[100:101], v[172:173], v[156:157], v[100:101] op_sel_hi:[0,1,1] neg_lo:[1,0,0] neg_hi:[1,0,0]
    v_pk_fma_f32 v[102:103], v[172:173], v[158:159], v[102:103] op_sel_hi:[0,1,1] neg_lo:[1,0,0] neg_hi:[1,0,0]
    v_pk_mul_f32 v[226:227], v[100:101], v[100:101]
    v_pk_mul_f32 v[228:229], v[102:103], v[102:103]
    v_pk_fma_f32 v[226:227], v[226:227], v[174:175], v[174:175] op_sel:[0,1,0] op_sel_hi:[1,1,0]
    v_pk_fma_f32 v[228:229], v[228:229], v[174:175], v[174:175] op_sel:[0,1,0] op_sel_hi:[1,1,0]
    v_pk_mul_f32 v[226:227], v[226:227], v[100:101]
    v_pk_mul_f32 v[228:229], v[228:229], v[102:103]
    v_exp_f32 v226, v226
    v_exp_f32 v227, v227
    v_exp_f32 v228, v228
    v_exp_f32 v229, v229
    v_pk_fma_f32 v[226:227], v[226:227], v[172:173], v[172:173] op_sel:[0,1,1] op_sel_hi:[1,1,1]
    v_pk_fma_f32 v[228:229], v[228:229], v[172:173], v[172:173] op_sel:[0,1,1] op_sel_hi:[1,1,1]
    v_rcp_f32 v226, v226
    v_rcp_f32 v227, v227
    v_rcp_f32 v228, v228
    v_rcp_f32 v229, v229
    v_pk_mul_f32 v[100:101], v[100:101], v[226:227]
    v_pk_mul_f32 v[102:103], v[102:103], v[228:229]
    v_pk_fma_f32 v[104:105], v[172:173], v[160:161], v[104:105] op_sel_hi:[0,1,1] neg_lo:[1,0,0] neg_hi:[1,0,0]
    v_pk_fma_f32 v[106:107], v[172:173], v[162:163], v[106:107] op_sel_hi:[0,1,1] neg_lo:[1,0,0] neg_hi:[1,0,0]
    v_pk_mul_f32 v[226:227], v[104:105], v[104:105]
    v_pk_mul_f32 v[228:229], v[106:107], v[106:107]
    v_pk_fma_f32 v[226:227], v[226:227], v[174:175], v[174:175] op_sel:[0,1,0] op_sel_hi:[1,1,0]
    v_pk_fma_f32 v[228:229], v[228:229], v[174:175], v[174:175] op_sel:[0,1,0] op_sel_hi:[1,1,0]
    v_pk_mul_f32 v[226:227], v[226:227], v[104:105]
    v_pk_mul_f32 v[228:229], v[228:229], v[106:107]
    v_exp_f32 v226, v226
    v_exp_f32 v227, v227
    v_exp_f32 v228, v228
    v_exp_f32 v229, v229
    v_pk_fma_f32 v[226:227], v[226:227], v[172:173], v[172:173] op_sel:[0,1,1] op_sel_hi:[1,1,1]
    v_pk_fma_f32 v[228:229], v[228:229], v[172:173], v[172:173] op_sel:[0,1,1] op_sel_hi:[1,1,1]
    v_rcp_f32 v226, v226
    v_rcp_f32 v227, v227
    v_rcp_f32 v228, v228
    v_rcp_f32 v229, v229
    v_pk_mul_f32 v[104:105], v[104:105], v[226:227]
    v_pk_mul_f32 v[106:107], v[106:107], v[228:229]
    v_cvt_pk_bf16_f32 v208, v100, v101
    v_cvt_pk_bf16_f32 v209, v102, v103
    v_cvt_pk_bf16_f32 v210, v104, v105
    v_cvt_pk_bf16_f32 v211, v106, v107
    v_or_b32 v208, 1, v208
    ds_write_b128 v244, v[208:211] offset:36864
    v_pk_fma_f32 v[128:129], v[176:177], v[156:157], v[128:129] op_sel_hi:[0,1,1] neg_lo:[1,0,0] neg_hi:[1,0,0]
    v_pk_fma_f32 v[130:131], v[176:177], v[158:159], v[130:131] op_sel_hi:[0,1,1] neg_lo:[1,0,0] neg_hi:[1,0,0]
    v_pk_mul_f32 v[226:227], v[128:129], v[128:129]
    v_pk_mul_f32 v[228:229], v[130:131], v[130:131]
    v_pk_fma_f32 v[226:227], v[226:227], v[178:179], v[178:179] op_sel:[0,1,0] op_sel_hi:[1,1,0]
    v_pk_fma_f32 v[228:229], v[228:229], v[178:179], v[178:179] op_sel:[0,1,0] op_sel_hi:[1,1,0]
    v_pk_mul_f32 v[226:227], v[226:227], v[128:129]
    v_pk_mul_f32 v[228:229], v[228:229], v[130:131]
    v_exp_f32 v226, v226
    v_exp_f32 v227, v227
    v_exp_f32 v228, v228
    v_exp_f32 v229, v229
    v_pk_fma_f32 v[226:227], v[226:227], v[176:177], v[176:177] op_sel:[0,1,1] op_sel_hi:[1,1,1]
    v_pk_fma_f32 v[228:229], v[228:229], v[176:177], v[176:177] op_sel:[0,1,1] op_sel_hi:[1,1,1]
    v_rcp_f32 v226, v226
    v_rcp_f32 v227, v227
    v_rcp_f32 v228, v228
    v_rcp_f32 v229, v229
    v_pk_mul_f32 v[128:129], v[128:129], v[226:227]
    v_pk_mul_f32 v[130:131], v[130:131], v[228:229]
    v_pk_fma_f32 v[132:133], v[176:177], v[160:161], v[132:133] op_sel_hi:[0,1,1] neg_lo:[1,0,0] neg_hi:[1,0,0]
    v_pk_fma_f32 v[134:135], v[176:177], v[162:163], v[134:135] op_sel_hi:[0,1,1] neg_lo:[1,0,0] neg_hi:[1,0,0]
    v_pk_mul_f32 v[226:227], v[132:133], v[132:133]
    v_pk_mul_f32 v[228:229], v[134:135], v[134:135]
    v_pk_fma_f32 v[226:227], v[226:227], v[178:179], v[178:179] op_sel:[0,1,0] op_sel_hi:[1,1,0]
    v_pk_fma_f32 v[228:229], v[228:229], v[178:179], v[178:179] op_sel:[0,1,0] op_sel_hi:[1,1,0]
    v_pk_mul_f32 v[226:227], v[226:227], v[132:133]
    v_pk_mul_f32 v[228:229], v[228:229], v[134:135]
    v_exp_f32 v226, v226
    v_exp_f32 v227, v227
    v_exp_f32 v228, v228
    v_exp_f32 v229, v229
    v_pk_fma_f32 v[226:227], v[226:227], v[176:177], v[176:177] op_sel:[0,1,1] op_sel_hi:[1,1,1]
    v_pk_fma_f32 v[228:229], v[228:229], v[176:177], v[176:177] op_sel:[0,1,1] op_sel_hi:[1,1,1]
    v_rcp_f32 v226, v226
    v_rcp_f32 v227, v227
    v_rcp_f32 v228, v228
    v_rcp_f32 v229, v229
    v_pk_mul_f32 v[132:133], v[132:133], v[226:227]
    v_pk_mul_f32 v[134:135], v[134:135], v[228:229]
    v_cvt_pk_bf16_f32 v212, v128, v129
    v_cvt_pk_bf16_f32 v213, v130, v131
    v_cvt_pk_bf16_f32 v214, v132, v133
    v_cvt_pk_bf16_f32 v215, v134, v135
    ds_write_b128 v244, v[212:215] offset:38912
    v_pk_fma_f32 v[24:25], v[164:165], v[136:137], v[24:25] op_sel_hi:[0,1,1] neg_lo:[1,0,0] neg_hi:[1,0,0]
    v_pk_fma_f32 v[26:27], v[164:165], v[138:139], v[26:27] op_sel_hi:[0,1,1] neg_lo:[1,0,0] neg_hi:[1,0,0]
    v_pk_mul_f32 v[226:227], v[24:25], v[24:25]
    v_pk_mul_f32 v[228:229], v[26:27], v[26:27]
    v_pk_fma_f32 v[226:227], v[226:227], v[166:167], v[166:167] op_sel:[0,1,0] op_sel_hi:[1,1,0]
    v_pk_fma_f32 v[228:229], v[228:229], v[166:167], v[166:167] op_sel:[0,1,0] op_sel_hi:[1,1,0]
    v_pk_mul_f32 v[226:227], v[226:227], v[24:25]
    v_pk_mul_f32 v[228:229], v[228:229], v[26:27]
    v_exp_f32 v226, v226
    v_exp_f32 v227, v227
    v_exp_f32 v228, v228
    v_exp_f32 v229, v229
    v_pk_fma_f32 v[226:227], v[226:227], v[164:165], v[164:165] op_sel:[0,1,1] op_sel_hi:[1,1,1]
    v_pk_fma_f32 v[228:229], v[228:229], v[164:165], v[164:165] op_sel:[0,1,1] op_sel_hi:[1,1,1]
    v_rcp_f32 v226, v226
    v_rcp_f32 v227, v227
    v_rcp_f32 v228, v228
    v_rcp_f32 v229, v229
    v_pk_mul_f32 v[24:25], v[24:25], v[226:227]
    v_pk_mul_f32 v[26:27], v[26:27], v[228:229]
    v_cvt_pk_bf16_f32 v216, v24, v25
    v_cvt_pk_bf16_f32 v217, v26, v27
    v_or_b32 v216, 1, v216
    s_add_u32 s36, s46, 0
    buffer_store_dwordx4 v[36:39], v2, s[16:19], s36 offen sc1
    v_pk_fma_f32 v[52:53], v[168:169], v[136:137], v[52:53] op_sel_hi:[0,1,1] neg_lo:[1,0,0] neg_hi:[1,0,0]
    v_pk_fma_f32 v[54:55], v[168:169], v[138:139], v[54:55] op_sel_hi:[0,1,1] neg_lo:[1,0,0] neg_hi:[1,0,0]
    v_pk_mul_f32 v[226:227], v[52:53], v[52:53]
    v_pk_mul_f32 v[228:229], v[54:55], v[54:55]
    v_pk_fma_f32 v[226:227], v[226:227], v[170:171], v[170:171] op_sel:[0,1,0] op_sel_hi:[1,1,0]
    v_pk_fma_f32 v[228:229], v[228:229], v[170:171], v[170:171] op_sel:[0,1,0] op_sel_hi:[1,1,0]
    v_pk_mul_f32 v[226:227], v[226:227], v[52:53]
    v_pk_mul_f32 v[228:229], v[228:229], v[54:55]
    v_exp_f32 v226, v226
    v_exp_f32 v227, v227
    v_exp_f32 v228, v228
    v_exp_f32 v229, v229
    v_pk_fma_f32 v[226:227], v[226:227], v[168:169], v[168:169] op_sel:[0,1,1] op_sel_hi:[1,1,1]
    v_pk_fma_f32 v[228:229], v[228:229], v[168:169], v[168:169] op_sel:[0,1,1] op_sel_hi:[1,1,1]
    v_rcp_f32 v226, v226
    v_rcp_f32 v227, v227
    v_rcp_f32 v228, v228
    v_rcp_f32 v229, v229
    v_pk_mul_f32 v[52:53], v[52:53], v[226:227]
    v_pk_mul_f32 v[54:55], v[54:55], v[228:229]
    v_cvt_pk_bf16_f32 v218, v52, v53
    v_cvt_pk_bf16_f32 v219, v54, v55
    v_or_b32 v218, 1, v218
    s_add_u32 s36, s46, 229376
    buffer_store_dwordx4 v[64:67], v2, s[16:19], s36 offen sc1
    v_pk_fma_f32 v[80:81], v[172:173], v[136:137], v[80:81] op_sel_hi:[0,1,1] neg_lo:[1,0,0] neg_hi:[1,0,0]
    v_pk_fma_f32 v[82:83], v[172:173], v[138:139], v[82:83] op_sel_hi:[0,1,1] neg_lo:[1,0,0] neg_hi:[1,0,0]
    v_pk_mul_f32 v[226:227], v[80:81], v[80:81]
    v_pk_mul_f32 v[228:229], v[82:83], v[82:83]
    v_pk_fma_f32 v[226:227], v[226:227], v[174:175], v[174:175] op_sel:[0,1,0] op_sel_hi:[1,1,0]
    v_pk_fma_f32 v[228:229], v[228:229], v[174:175], v[174:175] op_sel:[0,1,0] op_sel_hi:[1,1,0]
    v_pk_mul_f32 v[226:227], v[226:227], v[80:81]
    v_pk_mul_f32 v[228:229], v[228:229], v[82:83]
    v_exp_f32 v226, v226
    v_exp_f32 v227, v227
    v_exp_f32 v228, v228
    v_exp_f32 v229, v229
    v_pk_fma_f32 v[226:227], v[226:227], v[172:173], v[172:173] op_sel:[0,1,1] op_sel_hi:[1,1,1]
    v_pk_fma_f32 v[228:229], v[228:229], v[172:173], v[172:173] op_sel:[0,1,1] op_sel_hi:[1,1,1]
    v_rcp_f32 v226, v226
    v_rcp_f32 v227, v227
    v_rcp_f32 v228, v228
    v_rcp_f32 v229, v229
    v_pk_mul_f32 v[80:81], v[80:81], v[226:227]
    v_pk_mul_f32 v[82:83], v[82:83], v[228:229]
    v_cvt_pk_bf16_f32 v220, v80, v81
    v_cvt_pk_bf16_f32 v221, v82, v83
    v_or_b32 v220, 1, v220
    s_add_u32 s36, s46, 458752
    buffer_store_dwordx4 v[92:95], v2, s[16:19], s36 offen sc1
    v_pk_fma_f32 v[108:109], v[176:177], v[136:137], v[108:109] op_sel_hi:[0,1,1] neg_lo:[1,0,0] neg_hi:[1,0,0]
    v_pk_fma_f32 v[110:111], v[176:177], v[138:139], v[110:111] op_sel_hi:[0,1,1] neg_lo:[1,0,0] neg_hi:[1,0,0]
    v_pk_mul_f32 v[226:227], v[108:109], v[108:109]
    v_pk_mul_f32 v[228:229], v[110:111], v[110:111]
    v_pk_fma_f32 v[226:227], v[226:227], v[178:179], v[178:179] op_sel:[0,1,0] op_sel_hi:[1,1,0]
    v_pk_fma_f32 v[228:229], v[228:229], v[178:179], v[178:179] op_sel:[0,1,0] op_sel_hi:[1,1,0]
    v_pk_mul_f32 v[226:227], v[226:227], v[108:109]
    v_pk_mul_f32 v[228:229], v[228:229], v[110:111]
    v_exp_f32 v226, v226
    v_exp_f32 v227, v227
    v_exp_f32 v228, v228
    v_exp_f32 v229, v229
    v_pk_fma_f32 v[226:227], v[226:227], v[176:177], v[176:177] op_sel:[0,1,1] op_sel_hi:[1,1,1]
    v_pk_fma_f32 v[228:229], v[228:229], v[176:177], v[176:177] op_sel:[0,1,1] op_sel_hi:[1,1,1]
    v_rcp_f32 v226, v226
    v_rcp_f32 v227, v227
    v_rcp_f32 v228, v228
    v_rcp_f32 v229, v229
    v_pk_mul_f32 v[108:109], v[108:109], v[226:227]
    v_pk_mul_f32 v[110:111], v[110:111], v[228:229]
    v_cvt_pk_bf16_f32 v222, v108, v109
    v_cvt_pk_bf16_f32 v223, v110, v111
    s_add_u32 s36, s46, 688128
    buffer_store_dwordx4 v[120:123], v2, s[16:19], s36 offen sc1
    s_waitcnt lgkmcnt(0)
    s_add_u32 s45, s44, 512
    s_mov_b32 s44, s47
G3_e2:
    s_waitcnt lgkmcnt(0)
    s_barrier
    ds_read_b128 v[88:91], v17 offset:0
    ds_read_b128 v[92:95], v17 offset:2048
    ds_read_b128 v[96:99], v17 offset:4096
    ds_read_b128 v[100:103], v17 offset:6144
    ds_read_b64_tr_b16 v[104:105], v18 offset:0
    ds_read_b64_tr_b16 v[106:107], v18 offset:4096
    ds_read_b64_tr_b16 v[108:109], v19 offset:0
    ds_read_b64_tr_b16 v[110:111], v19 offset:4096
    ds_read_b64_tr_b16 v[112:113], v20 offset:0
    ds_read_b64_tr_b16 v[114:115], v20 offset:4096
    ds_read_b64_tr_b16 v[116:117], v21 offset:0
    ds_read_b64_tr_b16 v[118:119], v21 offset:4096
    s_waitcnt lgkmcnt(6)
    v_mfma_f32_16x16x32_bf16 v[24:27], v[104:107], v[88:91], 0
    ds_read_b128 v[120:123], v17 offset:1024
    s_add_u32 s42, s42, 16384
    v_mfma_f32_16x16x32_bf16 v[40:43], v[104:107], v[92:95], 0
    ds_read_b128 v[124:127], v17 offset:3072
    s_cmp_eq_u32 s42, 49152
    v_mfma_f32_16x16x32_bf16 v[56:59], v[104:107], v[96:99], 0
    ds_read_b128 v[128:131], v17 offset:5120
    s_cselect_b32 s42, 0, s42
    v_mfma_f32_16x16x32_bf16 v[72:75], v[104:107], v[100:103], 0
    ds_read_b128 v[132:135], v17 offset:7168
    s_waitcnt lgkmcnt(8)
    v_mfma_f32_16x16x32_bf16 v[76:79], v[108:111], v[100:103], 0
    ds_read_b64_tr_b16 v[136:137], v18 offset:8192
    s_add_u32 s48, s48, 16384
    v_mfma_f32_16x16x32_bf16 v[60:63], v[108:111], v[96:99], 0
    ds_read_b64_tr_b16 v[138:139], v18 offset:12288
    s_cmp_eq_u32 s48, 98304
    v_mfma_f32_16x16x32_bf16 v[44:47], v[108:111], v[92:95], 0
    ds_read_b64_tr_b16 v[140:141], v19 offset:8192
    s_cselect_b32 s48, 0, s48
    v_mfma_f32_16x16x32_bf16 v[28:31], v[108:111], v[88:91], 0
    ds_read_b64_tr_b16 v[142:143], v19 offset:12288
    s_waitcnt lgkmcnt(8)
    v_mfma_f32_16x16x32_bf16 v[32:35], v[112:115], v[88:91], 0
    ds_read_b64_tr_b16 v[144:145], v20 offset:8192
    v_add_u32 v17, s42, v12
    v_mfma_f32_16x16x32_bf16 v[48:51], v[112:115], v[92:95], 0
    ds_read_b64_tr_b16 v[146:147], v20 offset:12288
    s_add_u32 s36, s44, 0
    v_mfma_f32_16x16x32_bf16 v[64:67], v[112:115], v[96:99], 0
    ds_read_b64_tr_b16 v[148:149], v21 offset:8192
    buffer_store_dwordx4 v[200:203], v2, s[16:19], s36 offen sc1
    v_mfma_f32_16x16x32_bf16 v[80:83], v[112:115], v[100:103], 0
    ds_read_b64_tr_b16 v[150:151], v21 offset:12288
    s_add_u32 s36, s45, 0
    v_mfma_f32_16x16x32_bf16 v[84:87], v[116:119], v[100:103], 0
    buffer_store_dwordx2 v[216:217], v238, s[16:19], s36 offen sc1
    v_add_u32 v18, s48, v13
    v_mfma_f32_16x16x32_bf16 v[68:71], v[116:119], v[96:99], 0
    v_add_u32 v19, s48, v14
    v_mfma_f32_16x16x32_bf16 v[52:55], v[116:119], v[92:95], 0
    v_add_u32 v20, s48, v15
    v_mfma_f32_16x16x32_bf16 v[36:39], v[116:119], v[88:91], 0
    v_add_u32 v21, s48, v16
    s_waitcnt lgkmcnt(6)
    v_mfma_f32_16x16x32_bf16 v[24:27], v[136:139], v[120:123], v[24:27]
    v_mfma_f32_16x16x32_bf16 v[40:43], v[136:139], v[124:127], v[40:43]
    v_mfma_f32_16x16x32_bf16 v[56:59], v[136:139], v[128:131], v[56:59]
    s_waitcnt lgkmcnt(0)
    s_barrier
    v_mfma_f32_16x16x32_bf16 v[72:75], v[136:139], v[132:135], v[72:75]
    ds_read_b128 v[88:91], v17 offset:0
    s_add_u32 s36, s44, 229376
    v_mfma_f32_16x16x32_bf16 v[76:79], v[140:143], v[132:135], v[76:79]
    ds_read_b128 v[92:95], v17 offset:2048
    buffer_store_dwordx4 v[204:207], v2, s[16:19], s36 offen sc1
    v_mfma_f32_16x16x32_bf16 v[60:63], v[140:143], v[128:131], v[60:63]
    ds_read_b128 v[96:99], v17 offset:4096
    s_add_u32 s36, s45, 229376
    v_mfma_f32_16x16x32_bf16 v[44:47], v[140:143], v[124:127], v[44:47]
    ds_read_b128 v[100:103], v17 offset:6144
    buffer_store_dwordx2 v[218:219], v238, s[16:19], s36 offen sc1
    v_mfma_f32_16x16x32_bf16 v[28:31], v[140:143], v[120:123], v[28:31]
    ds_read_b64_tr_b16 v[104:105], v18 offset:0
    s_add_u32 s43, s43, 1
    v_mfma_f32_16x16x32_bf16 v[32:35], v[144:147], v[120:123], v[32:35]
    ds_read_b64_tr_b16 v[106:107], v18 offset:4096
    s_cmp_lt_u32 s43, 27
    v_mfma_f32_16x16x32_bf16 v[48:51], v[144:147], v[124:127], v[48:51]
    ds_read_b64_tr_b16 v[108:109], v19 offset:0
    v_mfma_f32_16x16x32_bf16 v[64:67], v[144:147], v[128:131], v[64:67]
    ds_read_b64_tr_b16 v[110:111], v19 offset:4096
    v_mfma_f32_16x16x32_bf16 v[80:83], v[144:147], v[132:135], v[80:83]
    ds_read_b64_tr_b16 v[112:113], v20 offset:0
    v_mfma_f32_16x16x32_bf16 v[84:87], v[148:151], v[132:135], v[84:87]
    ds_read_b64_tr_b16 v[114:115], v20 offset:4096
    v_mfma_f32_16x16x32_bf16 v[68:71], v[148:151], v[128:131], v[68:71]
    ds_read_b64_tr_b16 v[116:117], v21 offset:0
    v_mfma_f32_16x16x32_bf16 v[52:55], v[148:151], v[124:127], v[52:55]
    ds_read_b64_tr_b16 v[118:119], v21 offset:4096
    v_mfma_f32_16x16x32_bf16 v[36:39], v[148:151], v[120:123], v[36:39]
    s_waitcnt lgkmcnt(6)
    v_mfma_f32_16x16x32_bf16 v[24:27], v[104:107], v[88:91], v[24:27]
    ds_read_b128 v[120:123], v17 offset:1024
    s_add_u32 s42, s42, 16384
    v_mfma_f32_16x16x32_bf16 v[40:43], v[104:107], v[92:95], v[40:43]
    ds_read_b128 v[124:127], v17 offset:3072
    s_cmp_eq_u32 s42, 49152
    v_mfma_f32_16x16x32_bf16 v[56:59], v[104:107], v[96:99], v[56:59]
    ds_read_b128 v[128:131], v17 offset:5120
    s_cselect_b32 s42, 0, s42
    v_mfma_f32_16x16x32_bf16 v[72:75], v[104:107], v[100:103], v[72:75]
    ds_read_b128 v[132:135], v17 offset:7168
    s_waitcnt lgkmcnt(8)
    v_mfma_f32_16x16x32_bf16 v[76:79], v[108:111], v[100:103], v[76:79]
    ds_read_b64_tr_b16 v[136:137], v18 offset:8192
    s_add_u32 s48, s48, 16384
    v_mfma_f32_16x16x32_bf16 v[60:63], v[108:111], v[96:99], v[60:63]
    ds_read_b64_tr_b16 v[138:139], v18 offset:12288
    s_cmp_eq_u32 s48, 98304
    v_mfma_f32_16x16x32_bf16 v[44:47], v[108:111], v[92:95], v[44:47]
    ds_read_b64_tr_b16 v[140:141], v19 offset:8192
    s_cselect_b32 s48, 0, s48
    v_mfma_f32_16x16x32_bf16 v[28:31], v[108:111], v[88:91], v[28:31]
    ds_read_b64_tr_b16 v[142:143], v19 offset:12288
    s_waitcnt lgkmcnt(8)
    v_mfma_f32_16x16x32_bf16 v[32:35], v[112:115], v[88:91], v[32:35]
    ds_read_b64_tr_b16 v[144:145], v20 offset:8192
    v_add_u32 v17, s42, v12
    v_mfma_f32_16x16x32_bf16 v[48:51], v[112:115], v[92:95], v[48:51]
    ds_read_b64_tr_b16 v[146:147], v20 offset:12288
    s_add_u32 s36, s44, 458752
    v_mfma_f32_16x16x32_bf16 v[64:67], v[112:115], v[96:99], v[64:67]
    ds_read_b64_tr_b16 v[148:149], v21 offset:8192
    buffer_store_dwordx4 v[208:211], v2, s[16:19], s36 offen sc1
    v_mfma_f32_16x16x32_bf16 v[80:83], v[112:115], v[100:103], v[80:83]
    ds_read_b64_tr_b16 v[150:151], v21 offset:12288
    s_add_u32 s36, s45, 458752
    v_mfma_f32_16x16x32_bf16 v[84:87], v[116:119], v[100:103], v[84:87]
    buffer_store_dwordx2 v[220:221], v238, s[16:19], s36 offen sc1
    v_add_u32 v18, s48, v13
    v_mfma_f32_16x16x32_bf16 v[68:71], v[116:119], v[96:99], v[68:71]
    v_add_u32 v19, s48, v14
    v_mfma_f32_16x16x32_bf16 v[52:55], v[116:119], v[92:95], v[52:55]
    v_add_u32 v20, s48, v15
    v_mfma_f32_16x16x32_bf16 v[36:39], v[116:119], v[88:91], v[36:39]
    v_add_u32 v21, s48, v16
    s_waitcnt lgkmcnt(6)
    v_mfma_f32_16x16x32_bf16 v[24:27], v[136:139], v[120:123], v[24:27]
    v_mfma_f32_16x16x32_bf16 v[40:43], v[136:139], v[124:127], v[40:43]
    s_waitcnt vmcnt(6)
    v_mfma_f32_16x16x32_bf16 v[56:59], v[136:139], v[128:131], v[56:59]
    s_waitcnt lgkmcnt(0)
    s_barrier
    v_mfma_f32_16x16x32_bf16 v[72:75], v[136:139], v[132:135], v[72:75]
    ds_read_b128 v[88:91], v17 offset:0
    s_add_u32 s36, s44, 688128
    v_mfma_f32_16x16x32_bf16 v[76:79], v[140:143], v[132:135], v[76:79]
    ds_read_b128 v[92:95], v17 offset:2048
    buffer_store_dwordx4 v[212:215], v2, s[16:19], s36 offen sc1
    v_mfma_f32_16x16x32_bf16 v[60:63], v[140:143], v[128:131], v[60:63]
    ds_read_b128 v[96:99], v17 offset:4096
    s_add_u32 s36, s45, 688128
    v_mfma_f32_16x16x32_bf16 v[44:47], v[140:143], v[124:127], v[44:47]
    ds_read_b128 v[100:103], v17 offset:6144
    buffer_store_dwordx2 v[222:223], v238, s[16:19], s36 offen sc1
    v_mfma_f32_16x16x32_bf16 v[28:31], v[140:143], v[120:123], v[28:31]
    ds_read_b64_tr_b16 v[104:105], v18 offset:0
    s_add_u32 s43, s43, 1
    v_mfma_f32_16x16x32_bf16 v[32:35], v[144:147], v[120:123], v[32:35]
    ds_read_b64_tr_b16 v[106:107], v18 offset:4096
    s_cmp_lt_u32 s43, 27
    v_mfma_f32_16x16x32_bf16 v[48:51], v[144:147], v[124:127], v[48:51]
    ds_read_b64_tr_b16 v[108:109], v19 offset:0
    v_mfma_f32_16x16x32_bf16 v[64:67], v[144:147], v[128:131], v[64:67]
    ds_read_b64_tr_b16 v[110:111], v19 offset:4096
    v_mfma_f32_16x16x32_bf16 v[80:83], v[144:147], v[132:135], v[80:83]
    ds_read_b64_tr_b16 v[112:113], v20 offset:0
    v_mfma_f32_16x16x32_bf16 v[84:87], v[148:151], v[132:135], v[84:87]
    ds_read_b64_tr_b16 v[114:115], v20 offset:4096
    v_mfma_f32_16x16x32_bf16 v[68:71], v[148:151], v[128:131], v[68:71]
    ds_read_b64_tr_b16 v[116:117], v21 offset:0
    v_mfma_f32_16x16x32_bf16 v[52:55], v[148:151], v[124:127], v[52:55]
    ds_read_b64_tr_b16 v[118:119], v21 offset:4096
    v_mfma_f32_16x16x32_bf16 v[36:39], v[148:151], v[120:123], v[36:39]
    s_waitcnt lgkmcnt(6)
mm_27:
    v_mfma_f32_16x16x32_bf16 v[24:27], v[104:107], v[88:91], v[24:27]
    ds_read_b128 v[120:123], v17 offset:1024
    s_add_u32 s42, s42, 16384
    v_mfma_f32_16x16x32_bf16 v[40:43], v[104:107], v[92:95], v[40:43]
    ds_read_b128 v[124:127], v17 offset:3072
    s_cmp_eq_u32 s42, 49152
    v_mfma_f32_16x16x32_bf16 v[56:59], v[104:107], v[96:99], v[56:59]
    ds_read_b128 v[128:131], v17 offset:5120
    s_cselect_b32 s42, 0, s42
    v_mfma_f32_16x16x32_bf16 v[72:75], v[104:107], v[100:103], v[72:75]
    ds_read_b128 v[132:135], v17 offset:7168
    s_waitcnt lgkmcnt(8)
    v_mfma_f32_16x16x32_bf16 v[76:79], v[108:111], v[100:103], v[76:79]
    ds_read_b64_tr_b16 v[136:137], v18 offset:8192
    s_add_u32 s48, s48, 16384
    v_mfma_f32_16x16x32_bf16 v[60:63], v[108:111], v[96:99], v[60:63]
    ds_read_b64_tr_b16 v[138:139], v18 offset:12288
    s_cmp_eq_u32 s48, 98304
    v_mfma_f32_16x16x32_bf16 v[44:47], v[108:111], v[92:95], v[44:47]
    ds_read_b64_tr_b16 v[140:141], v19 offset:8192
    s_cselect_b32 s48, 0, s48
    v_mfma_f32_16x16x32_bf16 v[28:31], v[108:111], v[88:91], v[28:31]
    ds_read_b64_tr_b16 v[142:143], v19 offset:12288
    s_waitcnt lgkmcnt(8)
    v_mfma_f32_16x16x32_bf16 v[32:35], v[112:115], v[88:91], v[32:35]
    ds_read_b64_tr_b16 v[144:145], v20 offset:8192
    v_add_u32 v17, s42, v12
    v_mfma_f32_16x16x32_bf16 v[48:51], v[112:115], v[92:95], v[48:51]
    ds_read_b64_tr_b16 v[146:147], v20 offset:12288
    v_add_u32 v18, s48, v13
    v_mfma_f32_16x16x32_bf16 v[64:67], v[112:115], v[96:99], v[64:67]
    ds_read_b64_tr_b16 v[148:149], v21 offset:8192
    v_add_u32 v19, s48, v14
    v_mfma_f32_16x16x32_bf16 v[80:83], v[112:115], v[100:103], v[80:83]
    ds_read_b64_tr_b16 v[150:151], v21 offset:12288
    v_add_u32 v20, s48, v15
    v_mfma_f32_16x16x32_bf16 v[84:87], v[116:119], v[100:103], v[84:87]
    v_add_u32 v21, s48, v16
    v_mfma_f32_16x16x32_bf16 v[68:71], v[116:119], v[96:99], v[68:71]
    v_mfma_f32_16x16x32_bf16 v[52:55], v[116:119], v[92:95], v[52:55]
    v_mfma_f32_16x16x32_bf16 v[36:39], v[116:119], v[88:91], v[36:39]
    s_waitcnt lgkmcnt(6)
    v_mfma_f32_16x16x32_bf16 v[24:27], v[136:139], v[120:123], v[24:27]
    s_add_u32 s43, s43, 1
    s_cmp_lt_u32 s43, 4
    v_mfma_f32_16x16x32_bf16 v[40:43], v[136:139], v[124:127], v[40:43]
    v_mfma_f32_16x16x32_bf16 v[56:59], v[136:139], v[128:131], v[56:59]
    s_waitcnt lgkmcnt(0)
    s_barrier
    v_mfma_f32_16x16x32_bf16 v[72:75], v[136:139], v[132:135], v[72:75]
    ds_read_b128 v[88:91], v17 offset:0
    v_mfma_f32_16x16x32_bf16 v[76:79], v[140:143], v[132:135], v[76:79]
    ds_read_b128 v[92:95], v17 offset:2048
    v_mfma_f32_16x16x32_bf16 v[60:63], v[140:143], v[128:131], v[60:63]
    ds_read_b128 v[96:99], v17 offset:4096
    v_mfma_f32_16x16x32_bf16 v[44:47], v[140:143], v[124:127], v[44:47]
    ds_read_b128 v[100:103], v17 offset:6144
    v_mfma_f32_16x16x32_bf16 v[28:31], v[140:143], v[120:123], v[28:31]
    ds_read_b64_tr_b16 v[104:105], v18 offset:0
    v_mfma_f32_16x16x32_bf16 v[32:35], v[144:147], v[120:123], v[32:35]
    ds_read_b64_tr_b16 v[106:107], v18 offset:4096
    v_mfma_f32_16x16x32_bf16 v[48:51], v[144:147], v[124:127], v[48:51]
    ds_read_b64_tr_b16 v[108:109], v19 offset:0
    v_mfma_f32_16x16x32_bf16 v[64:67], v[144:147], v[128:131], v[64:67]
    ds_read_b64_tr_b16 v[110:111], v19 offset:4096
    v_mfma_f32_16x16x32_bf16 v[80:83], v[144:147], v[132:135], v[80:83]
    ds_read_b64_tr_b16 v[112:113], v20 offset:0
    v_mfma_f32_16x16x32_bf16 v[84:87], v[148:151], v[132:135], v[84:87]
    ds_read_b64_tr_b16 v[114:115], v20 offset:4096
    v_mfma_f32_16x16x32_bf16 v[68:71], v[148:151], v[128:131], v[68:71]
    ds_read_b64_tr_b16 v[116:117], v21 offset:0
    v_mfma_f32_16x16x32_bf16 v[52:55], v[148:151], v[124:127], v[52:55]
    ds_read_b64_tr_b16 v[118:119], v21 offset:4096
    v_mfma_f32_16x16x32_bf16 v[36:39], v[148:151], v[120:123], v[36:39]
    s_waitcnt lgkmcnt(6)
    s_cbranch_scc1 mm_27
mm_28:
    v_mfma_f32_16x16x32_bf16 v[24:27], v[104:107], v[88:91], v[24:27]
    ds_read_b128 v[120:123], v17 offset:1024
    s_add_u32 s42, s42, 16384
    v_mfma_f32_16x16x32_bf16 v[40:43], v[104:107], v[92:95], v[40:43]
    ds_read_b128 v[124:127], v17 offset:3072
    s_cmp_eq_u32 s42, 49152
    v_mfma_f32_16x16x32_bf16 v[56:59], v[104:107], v[96:99], v[56:59]
    ds_read_b128 v[128:131], v17 offset:5120
    s_cselect_b32 s42, 0, s42
    v_mfma_f32_16x16x32_bf16 v[72:75], v[104:107], v[100:103], v[72:75]
    ds_read_b128 v[132:135], v17 offset:7168
    s_waitcnt lgkmcnt(8)
    v_mfma_f32_16x16x32_bf16 v[76:79], v[108:111], v[100:103], v[76:79]
    ds_read_b64_tr_b16 v[136:137], v18 offset:8192
    s_add_u32 s48, s48, 16384
    v_mfma_f32_16x16x32_bf16 v[60:63], v[108:111], v[96:99], v[60:63]
    ds_read_b64_tr_b16 v[138:139], v18 offset:12288
    s_cmp_eq_u32 s48, 98304
    v_mfma_f32_16x16x32_bf16 v[44:47], v[108:111], v[92:95], v[44:47]
    ds_read_b64_tr_b16 v[140:141], v19 offset:8192
    s_cselect_b32 s48, 0, s48
    v_mfma_f32_16x16x32_bf16 v[28:31], v[108:111], v[88:91], v[28:31]
    ds_read_b64_tr_b16 v[142:143], v19 offset:12288
    s_waitcnt lgkmcnt(8)
    v_mfma_f32_16x16x32_bf16 v[32:35], v[112:115], v[88:91], v[32:35]
    ds_read_b64_tr_b16 v[144:145], v20 offset:8192
    v_add_u32 v17, s42, v12
    v_mfma_f32_16x16x32_bf16 v[48:51], v[112:115], v[92:95], v[48:51]
    ds_read_b64_tr_b16 v[146:147], v20 offset:12288
    v_add_u32 v18, s48, v13
    v_mfma_f32_16x16x32_bf16 v[64:67], v[112:115], v[96:99], v[64:67]
    ds_read_b64_tr_b16 v[148:149], v21 offset:8192
    v_add_u32 v19, s48, v14
    v_mfma_f32_16x16x32_bf16 v[80:83], v[112:115], v[100:103], v[80:83]
    ds_read_b64_tr_b16 v[150:151], v21 offset:12288
    v_add_u32 v20, s48, v15
    v_mfma_f32_16x16x32_bf16 v[84:87], v[116:119], v[100:103], v[84:87]
    v_add_u32 v21, s48, v16
    v_mfma_f32_16x16x32_bf16 v[68:71], v[116:119], v[96:99], v[68:71]
    v_mfma_f32_16x16x32_bf16 v[52:55], v[116:119], v[92:95], v[52:55]
    v_mfma_f32_16x16x32_bf16 v[36:39], v[116:119], v[88:91], v[36:39]
    s_waitcnt lgkmcnt(6)
    v_mfma_f32_16x16x32_bf16 v[24:27], v[136:139], v[120:123], v[24:27]
    s_add_u32 s43, s43, 1
    s_cmp_lt_u32 s43, 27
    v_mfma_f32_16x16x32_bf16 v[40:43], v[136:139], v[124:127], v[40:43]
    s_waitcnt vmcnt(0)
    v_mfma_f32_16x16x32_bf16 v[56:59], v[136:139], v[128:131], v[56:59]
    s_waitcnt lgkmcnt(0)
    s_barrier
    v_mfma_f32_16x16x32_bf16 v[72:75], v[136:139], v[132:135], v[72:75]
    ds_read_b128 v[88:91], v17 offset:0
    v_mfma_f32_16x16x32_bf16 v[76:79], v[140:143], v[132:135], v[76:79]
    ds_read_b128 v[92:95], v17 offset:2048
    v_mfma_f32_16x16x32_bf16 v[60:63], v[140:143], v[128:131], v[60:63]
    ds_read_b128 v[96:99], v17 offset:4096
    v_mfma_f32_16x16x32_bf16 v[44:47], v[140:143], v[124:127], v[44:47]
    ds_read_b128 v[100:103], v17 offset:6144
    v_mfma_f32_16x16x32_bf16 v[28:31], v[140:143], v[120:123], v[28:31]
    ds_read_b64_tr_b16 v[104:105], v18 offset:0
    v_mfma_f32_16x16x32_bf16 v[32:35], v[144:147], v[120:123], v[32:35]
    ds_read_b64_tr_b16 v[106:107], v18 offset:4096
    v_mfma_f32_16x16x32_bf16 v[48:51], v[144:147], v[124:127], v[48:51]
    ds_read_b64_tr_b16 v[108:109], v19 offset:0
    v_mfma_f32_16x16x32_bf16 v[64:67], v[144:147], v[128:131], v[64:67]
    ds_read_b64_tr_b16 v[110:111], v19 offset:4096
    v_mfma_f32_16x16x32_bf16 v[80:83], v[144:147], v[132:135], v[80:83]
    ds_read_b64_tr_b16 v[112:113], v20 offset:0
    v_mfma_f32_16x16x32_bf16 v[84:87], v[148:151], v[132:135], v[84:87]
    ds_read_b64_tr_b16 v[114:115], v20 offset:4096
    v_mfma_f32_16x16x32_bf16 v[68:71], v[148:151], v[128:131], v[68:71]
    ds_read_b64_tr_b16 v[116:117], v21 offset:0
    v_mfma_f32_16x16x32_bf16 v[52:55], v[148:151], v[124:127], v[52:55]
    ds_read_b64_tr_b16 v[118:119], v21 offset:4096
    v_mfma_f32_16x16x32_bf16 v[36:39], v[148:151], v[120:123], v[36:39]
    s_waitcnt lgkmcnt(6)
    s_cbranch_scc1 mm_28
    s_cmp_eq_u32 s60, 1
    s_cbranch_scc1 G4_last
    v_mfma_f32_16x16x32_bf16 v[24:27], v[104:107], v[88:91], v[24:27]
    ds_read_b128 v[120:123], v17 offset:1024
    v_mfma_f32_16x16x32_bf16 v[40:43], v[104:107], v[92:95], v[40:43]
    ds_read_b128 v[124:127], v17 offset:3072
    v_mfma_f32_16x16x32_bf16 v[56:59], v[104:107], v[96:99], v[56:59]
    ds_read_b128 v[128:131], v17 offset:5120
    v_mfma_f32_16x16x32_bf16 v[72:75], v[104:107], v[100:103], v[72:75]
    ds_read_b128 v[132:135], v17 offset:7168
    s_waitcnt lgkmcnt(8)
    v_mfma_f32_16x16x32_bf16 v[76:79], v[108:111], v[100:103], v[76:79]
    ds_read_b64_tr_b16 v[136:137], v18 offset:8192
    v_mfma_f32_16x16x32_bf16 v[60:63], v[108:111], v[96:99], v[60:63]
    ds_read_b64_tr_b16 v[138:139], v18 offset:12288
    v_mfma_f32_16x16x32_bf16 v[44:47], v[108:111], v[92:95], v[44:47]
    ds_read_b64_tr_b16 v[140:141], v19 offset:8192
    v_mfma_f32_16x16x32_bf16 v[28:31], v[108:111], v[88:91], v[28:31]
    ds_read_b64_tr_b16 v[142:143], v19 offset:12288
    s_waitcnt lgkmcnt(8)
    v_mfma_f32_16x16x32_bf16 v[32:35], v[112:115], v[88:91], v[32:35]
    ds_read_b64_tr_b16 v[144:145], v20 offset:8192
    v_mfma_f32_16x16x32_bf16 v[48:51], v[112:115], v[92:95], v[48:51]
    ds_read_b64_tr_b16 v[146:147], v20 offset:12288
    v_mfma_f32_16x16x32_bf16 v[64:67], v[112:115], v[96:99], v[64:67]
    ds_read_b64_tr_b16 v[148:149], v21 offset:8192
    v_mfma_f32_16x16x32_bf16 v[80:83], v[112:115], v[100:103], v[80:83]
    ds_read_b64_tr_b16 v[150:151], v21 offset:12288
    v_mfma_f32_16x16x32_bf16 v[84:87], v[116:119], v[100:103], v[84:87]
    v_mfma_f32_16x16x32_bf16 v[68:71], v[116:119], v[96:99], v[68:71]
    v_mfma_f32_16x16x32_bf16 v[52:55], v[116:119], v[92:95], v[52:55]
    v_mfma_f32_16x16x32_bf16 v[36:39], v[116:119], v[88:91], v[36:39]
    s_waitcnt lgkmcnt(0)
    v_mfma_f32_16x16x32_bf16 v[24:27], v[136:139], v[120:123], v[24:27]
    s_mul_i32 s36, s31, 524288
    s_add_u32 s36, s36, 0
    s_add_u32 s16, s62, s36
    v_mfma_f32_16x16x32_bf16 v[40:43], v[136:139], v[124:127], v[40:43]
    s_addc_u32 s17, s63, 0
    s_mov_b32 s18, 516096
    s_mov_b32 s19, 0x20000
    v_mfma_f32_16x16x32_bf16 v[56:59], v[136:139], v[128:131], v[56:59]
    v_mfma_f32_16x16x32_bf16 v[72:75], v[136:139], v[132:135], v[72:75]
    v_mfma_f32_16x16x32_bf16 v[76:79], v[140:143], v[132:135], v[76:79]
    v_mfma_f32_16x16x32_bf16 v[60:63], v[140:143], v[128:131], v[60:63]
    v_mfma_f32_16x16x32_bf16 v[44:47], v[140:143], v[124:127], v[44:47]
    v_mfma_f32_16x16x32_bf16 v[28:31], v[140:143], v[120:123], v[28:31]
    v_mfma_f32_16x16x32_bf16 v[32:35], v[144:147], v[120:123], v[32:35]
    v_mfma_f32_16x16x32_bf16 v[48:51], v[144:147], v[124:127], v[48:51]
    v_mfma_f32_16x16x32_bf16 v[64:67], v[144:147], v[128:131], v[64:67]
    v_mfma_f32_16x16x32_bf16 v[80:83], v[144:147], v[132:135], v[80:83]
    v_mfma_f32_16x16x32_bf16 v[84:87], v[148:151], v[132:135], v[84:87]
    v_mfma_f32_16x16x32_bf16 v[68:71], v[148:151], v[128:131], v[68:71]
    v_mfma_f32_16x16x32_bf16 v[52:55], v[148:151], v[124:127], v[52:55]
    v_mfma_f32_16x16x32_bf16 v[36:39], v[148:151], v[120:123], v[36:39]
    s_add_u32 s36, s39, 0
    v_cvt_pk_bf16_f32 v24, v24, v25
    v_cvt_pk_bf16_f32 v25, v26, v27
    v_cvt_pk_bf16_f32 v26, v28, v29
    v_cvt_pk_bf16_f32 v27, v30, v31
    v_or_b32 v24, 1, v24
    buffer_store_dwordx4 v[24:27], v2, s[16:19], s36 offen offset:0 sc1
    v_cvt_pk_bf16_f32 v32, v32, v33
    v_cvt_pk_bf16_f32 v33, v34, v35
    v_cvt_pk_bf16_f32 v34, v36, v37
    v_cvt_pk_bf16_f32 v35, v38, v39
    v_or_b32 v32, 1, v32
    buffer_store_dwordx4 v[32:35], v2, s[16:19], s36 offen offset:1024 sc1
    s_add_u32 s36, s39, 65536
    v_cvt_pk_bf16_f32 v40, v40, v41
    v_cvt_pk_bf16_f32 v41, v42, v43
    v_cvt_pk_bf16_f32 v42, v44, v45
    v_cvt_pk_bf16_f32 v43, v46, v47
    v_or_b32 v40, 1, v40
    buffer_store_dwordx4 v[40:43], v2, s[16:19], s36 offen offset:0 sc1
    v_cvt_pk_bf16_f32 v48, v48, v49
    v_cvt_pk_bf16_f32 v49, v50, v51
    v_cvt_pk_bf16_f32 v50, v52, v53
    v_cvt_pk_bf16_f32 v51, v54, v55
    v_or_b32 v48, 1, v48
    buffer_store_dwordx4 v[48:51], v2, s[16:19], s36 offen offset:1024 sc1
    s_add_u32 s36, s39, 131072
    v_cvt_pk_bf16_f32 v56, v56, v57
    v_cvt_pk_bf16_f32 v57, v58, v59
    v_cvt_pk_bf16_f32 v58, v60, v61
    v_cvt_pk_bf16_f32 v59, v62, v63
    v_or_b32 v56, 1, v56
    buffer_store_dwordx4 v[56:59], v2, s[16:19], s36 offen offset:0 sc1
    v_cvt_pk_bf16_f32 v64, v64, v65
    v_cvt_pk_bf16_f32 v65, v66, v67
    v_cvt_pk_bf16_f32 v66, v68, v69
    v_cvt_pk_bf16_f32 v67, v70, v71
    v_or_b32 v64, 1, v64
    buffer_store_dwordx4 v[64:67], v2, s[16:19], s36 offen offset:1024 sc1
    s_add_u32 s36, s39, 196608
    v_cvt_pk_bf16_f32 v72, v72, v73
    v_cvt_pk_bf16_f32 v73, v74, v75
    v_cvt_pk_bf16_f32 v74, v76, v77
    v_cvt_pk_bf16_f32 v75, v78, v79
    v_or_b32 v72, 1, v72
    buffer_store_dwordx4 v[72:75], v2, s[16:19], s36 offen offset:0 sc1
    v_cvt_pk_bf16_f32 v80, v80, v81
    v_cvt_pk_bf16_f32 v81, v82, v83
    v_cvt_pk_bf16_f32 v82, v84, v85
    v_cvt_pk_bf16_f32 v83, v86, v87
    v_or_b32 v80, 1, v80
    buffer_store_dwordx4 v[80:83], v2, s[16:19], s36 offen offset:1024 sc1
    s_barrier
    s_branch NEXT
G4_last:
    v_mfma_f32_16x16x32_bf16 v[24:27], v[104:107], v[88:91], v[24:27]
    ds_read_b128 v[120:123], v17 offset:1024
    v_mfma_f32_16x16x32_bf16 v[40:43], v[104:107], v[92:95], v[40:43]
    ds_read_b128 v[124:127], v17 offset:3072
    v_mfma_f32_16x16x32_bf16 v[56:59], v[104:107], v[96:99], v[56:59]
    ds_read_b128 v[128:131], v17 offset:5120
    v_mfma_f32_16x16x32_bf16 v[72:75], v[104:107], v[100:103], v[72:75]
    ds_read_b128 v[132:135], v17 offset:7168
    s_waitcnt lgkmcnt(8)
    v_mfma_f32_16x16x32_bf16 v[76:79], v[108:111], v[100:103], v[76:79]
    ds_read_b64_tr_b16 v[136:137], v18 offset:8192
    v_mfma_f32_16x16x32_bf16 v[60:63], v[108:111], v[96:99], v[60:63]
    ds_read_b64_tr_b16 v[138:139], v18 offset:12288
    v_mfma_f32_16x16x32_bf16 v[44:47], v[108:111], v[92:95], v[44:47]
    ds_read_b64_tr_b16 v[140:141], v19 offset:8192
    v_mfma_f32_16x16x32_bf16 v[28:31], v[108:111], v[88:91], v[28:31]
    ds_read_b64_tr_b16 v[142:143], v19 offset:12288
    s_waitcnt lgkmcnt(8)
    v_mfma_f32_16x16x32_bf16 v[32:35], v[112:115], v[88:91], v[32:35]
    ds_read_b64_tr_b16 v[144:145], v20 offset:8192
    v_mfma_f32_16x16x32_bf16 v[48:51], v[112:115], v[92:95], v[48:51]
    ds_read_b64_tr_b16 v[146:147], v20 offset:12288
    s_load_dwordx2 s[6:7], s[0:1], 88
    v_mfma_f32_16x16x32_bf16 v[64:67], v[112:115], v[96:99], v[64:67]
    ds_read_b64_tr_b16 v[148:149], v21 offset:8192
    v_mfma_f32_16x16x32_bf16 v[80:83], v[112:115], v[100:103], v[80:83]
    ds_read_b64_tr_b16 v[150:151], v21 offset:12288
    v_mfma_f32_16x16x32_bf16 v[84:87], v[116:119], v[100:103], v[84:87]
    v_mfma_f32_16x16x32_bf16 v[68:71], v[116:119], v[96:99], v[68:71]
    v_mfma_f32_16x16x32_bf16 v[52:55], v[116:119], v[92:95], v[52:55]
    v_mfma_f32_16x16x32_bf16 v[36:39], v[116:119], v[88:91], v[36:39]
    s_waitcnt lgkmcnt(0)
    v_mfma_f32_16x16x32_bf16 v[24:27], v[136:139], v[120:123], v[24:27]
    s_add_u32 s16, s62, 0x80000
    s_addc_u32 s17, s63, 0
    s_mov_b32 s18, 0x7e000
    v_mfma_f32_16x16x32_bf16 v[40:43], v[136:139], v[124:127], v[40:43]
    s_mov_b32 s19, 0x20000
    s_mov_b32 s20, s6
    s_mov_b32 s21, s7
    v_mfma_f32_16x16x32_bf16 v[56:59], v[136:139], v[128:131], v[56:59]
    s_mov_b32 s22, 0x400000
    s_mov_b32 s23, 0x20000
    s_add_u32 s44, s40, 65536
    v_mfma_f32_16x16x32_bf16 v[72:75], v[136:139], v[132:135], v[72:75]
    s_lshl_b32 s46, s28, 3
    s_add_u32 s46, s46, s37
    s_lshl_b32 s47, s31, 1
    v_mfma_f32_16x16x32_bf16 v[76:79], v[140:143], v[132:135], v[76:79]
    s_add_u32 s46, s46, s47
    s_lshl_b32 s46, s46, 15
    s_lshl_b32 s47, s38, 5
    v_mfma_f32_16x16x32_bf16 v[60:63], v[140:143], v[128:131], v[60:63]
    s_add_u32 s46, s46, s47
    s_add_u32 s47, s46, 32768
    v_and_b32 v225, 1, v23
    v_mfma_f32_16x16x32_bf16 v[44:47], v[140:143], v[124:127], v[44:47]
    v_lshlrev_b32 v224, 11, v22
    v_lshl_add_u32 v224, v225, 5, v224
    v_mfma_f32_16x16x32_bf16 v[28:31], v[140:143], v[120:123], v[28:31]
    v_lshrrev_b32 v225, 1, v23
    v_lshl_add_u32 v224, v225, 4, v224
    v_mfma_f32_16x16x32_bf16 v[32:35], v[144:147], v[120:123], v[32:35]
    v_lshrrev_b32 v225, 3, v22
    v_mul_u32_u24 v225, 16320, v225
    v_mfma_f32_16x16x32_bf16 v[48:51], v[144:147], v[124:127], v[48:51]
    v_sub_u32 v224, v224, v225
    v_add_u32 v225, 16384, v224
    v_mfma_f32_16x16x32_bf16 v[64:67], v[144:147], v[128:131], v[64:67]
    v_mfma_f32_16x16x32_bf16 v[80:83], v[144:147], v[132:135], v[80:83]
    v_mfma_f32_16x16x32_bf16 v[84:87], v[148:151], v[132:135], v[84:87]
    v_mfma_f32_16x16x32_bf16 v[68:71], v[148:151], v[128:131], v[68:71]
    v_mfma_f32_16x16x32_bf16 v[52:55], v[148:151], v[124:127], v[52:55]
    v_mfma_f32_16x16x32_bf16 v[36:39], v[148:151], v[120:123], v[36:39]
    s_cmp_eq_u32 s31, 0
    s_cbranch_scc1 G4_k0
    s_add_u32 s36, s41, 0
    v_cvt_pk_bf16_f32 v24, v24, v25
    v_cvt_pk_bf16_f32 v25, v26, v27
    v_cvt_pk_bf16_f32 v26, v28, v29
    v_cvt_pk_bf16_f32 v27, v30, v31
    v_or_b32 v24, 1, v24
    buffer_store_dwordx4 v[24:27], v2, s[16:19], s36 offen offset:0 sc1
    v_cvt_pk_bf16_f32 v32, v32, v33
    v_cvt_pk_bf16_f32 v33, v34, v35
    v_cvt_pk_bf16_f32 v34, v36, v37
    v_cvt_pk_bf16_f32 v35, v38, v39
    v_or_b32 v32, 1, v32
    buffer_store_dwordx4 v[32:35], v2, s[16:19], s36 offen offset:1024 sc1
    s_add_u32 s36, s41, 65536
    v_cvt_pk_bf16_f32 v40, v40, v41
    v_cvt_pk_bf16_f32 v41, v42, v43
    v_cvt_pk_bf16_f32 v42, v44, v45
    v_cvt_pk_bf16_f32 v43, v46, v47
    v_or_b32 v40, 1, v40
    buffer_store_dwordx4 v[40:43], v2, s[16:19], s36 offen offset:0 sc1
    v_cvt_pk_bf16_f32 v48, v48, v49
    v_cvt_pk_bf16_f32 v49, v50, v51
    v_cvt_pk_bf16_f32 v50, v52, v53
    v_cvt_pk_bf16_f32 v51, v54, v55
    v_or_b32 v48, 1, v48
    buffer_store_dwordx4 v[48:51], v2, s[16:19], s36 offen offset:1024 sc1
    v_pk_mov_b32 v[24:25], v[56:57], v[56:57] op_sel:[0,1]
    v_pk_mov_b32 v[26:27], v[58:59], v[58:59] op_sel:[0,1]
    v_pk_mov_b32 v[28:29], v[60:61], v[60:61] op_sel:[0,1]
    v_pk_mov_b32 v[30:31], v[62:63], v[62:63] op_sel:[0,1]
    v_pk_mov_b32 v[32:33], v[64:65], v[64:65] op_sel:[0,1]
    v_pk_mov_b32 v[34:35], v[66:67], v[66:67] op_sel:[0,1]
    v_pk_mov_b32 v[36:37], v[68:69], v[68:69] op_sel:[0,1]
    v_pk_mov_b32 v[38:39], v[70:71], v[70:71] op_sel:[0,1]
    v_pk_mov_b32 v[40:41], v[72:73], v[72:73] op_sel:[0,1]
    v_pk_mov_b32 v[42:43], v[74:75], v[74:75] op_sel:[0,1]
    v_pk_mov_b32 v[44:45], v[76:77], v[76:77] op_sel:[0,1]
    v_pk_mov_b32 v[46:47], v[78:79], v[78:79] op_sel:[0,1]
    v_pk_mov_b32 v[48:49], v[80:81], v[80:81] op_sel:[0,1]
    v_pk_mov_b32 v[50:51], v[82:83], v[82:83] op_sel:[0,1]
    v_pk_mov_b32 v[52:53], v[84:85], v[84:85] op_sel:[0,1]
    v_pk_mov_b32 v[54:55], v[86:87], v[86:87] op_sel:[0,1]
    s_branch G4_k1
G4_k0:
    s_add_u32 s36, s41, 0
    v_cvt_pk_bf16_f32 v56, v56, v57
    v_cvt_pk_bf16_f32 v57, v58, v59
    v_cvt_pk_bf16_f32 v58, v60, v61
    v_cvt_pk_bf16_f32 v59, v62, v63
    v_or_b32 v56, 1, v56
    buffer_store_dwordx4 v[56:59], v2, s[16:19], s36 offen offset:0 sc1
    v_cvt_pk_bf16_f32 v64, v64, v65
    v_cvt_pk_bf16_f32 v65, v66, v67
    v_cvt_pk_bf16_f32 v66, v68, v69
    v_cvt_pk_bf16_f32 v67, v70, v71
    v_or_b32 v64, 1, v64
    buffer_store_dwordx4 v[64:67], v2, s[16:19], s36 offen offset:1024 sc1
    s_add_u32 s36, s41, 65536
    v_cvt_pk_bf16_f32 v72, v72, v73
    v_cvt_pk_bf16_f32 v73, v74, v75
    v_cvt_pk_bf16_f32 v74, v76, v77
    v_cvt_pk_bf16_f32 v75, v78, v79
    v_or_b32 v72, 1, v72
    buffer_store_dwordx4 v[72:75], v2, s[16:19], s36 offen offset:0 sc1
    v_cvt_pk_bf16_f32 v80, v80, v81
    v_cvt_pk_bf16_f32 v81, v82, v83
    v_cvt_pk_bf16_f32 v82, v84, v85
    v_cvt_pk_bf16_f32 v83, v86, v87
    v_or_b32 v80, 1, v80
    buffer_store_dwordx4 v[80:83], v2, s[16:19], s36 offen offset:1024 sc1
G4_k1:
    s_mov_b32 s78, 0x3f80
    s_mov_b32 s79, 0x3f800000
    v_dot2_f32_bf16 v24, v180, s78, v24
    v_dot2_f32_bf16 v25, v180, s79, v25
    v_dot2_f32_bf16 v26, v181, s78, v26
    v_dot2_f32_bf16 v27, v181, s79, v27
    v_dot2_f32_bf16 v28, v182, s78, v28
    v_dot2_f32_bf16 v29, v182, s79, v29
    v_dot2_f32_bf16 v30, v183, s78, v30
    v_dot2_f32_bf16 v31, v183, s79, v31
    v_dot2_f32_bf16 v32, v188, s78, v32
    v_dot2_f32_bf16 v33, v188, s79, v33
    v_dot2_f32_bf16 v34, v189, s78, v34
    v_dot2_f32_bf16 v35, v189, s79, v35
    v_dot2_f32_bf16 v36, v190, s78, v36
    v_dot2_f32_bf16 v37, v190, s79, v37
    v_dot2_f32_bf16 v38, v191, s78, v38
    v_dot2_f32_bf16 v39, v191, s79, v39
    v_dot2_f32_bf16 v40, v196, s78, v40
    v_dot2_f32_bf16 v41, v196, s79, v41
    v_dot2_f32_bf16 v42, v197, s78, v42
    v_dot2_f32_bf16 v43, v197, s79, v43
    v_dot2_f32_bf16 v44, v198, s78, v44
    v_dot2_f32_bf16 v45, v198, s79, v45
    v_dot2_f32_bf16 v46, v199, s78, v46
    v_dot2_f32_bf16 v47, v199, s79, v47
    v_dot2_f32_bf16 v48, v234, s78, v48
    v_dot2_f32_bf16 v49, v234, s79, v49
    v_dot2_f32_bf16 v50, v235, s78, v50
    v_dot2_f32_bf16 v51, v235, s79, v51
    v_dot2_f32_bf16 v52, v236, s78, v52
    v_dot2_f32_bf16 v53, v236, s79, v53
    v_dot2_f32_bf16 v54, v237, s78, v54
    v_dot2_f32_bf16 v55, v237, s79, v55
    v_dot2_f32_bf16 v24, v184, s78, v24
    v_dot2_f32_bf16 v25, v184, s79, v25
    v_dot2_f32_bf16 v26, v185, s78, v26
    v_dot2_f32_bf16 v27, v185, s79, v27
    v_dot2_f32_bf16 v28, v186, s78, v28
    v_dot2_f32_bf16 v29, v186, s79, v29
    v_dot2_f32_bf16 v30, v187, s78, v30
    v_dot2_f32_bf16 v31, v187, s79, v31
    v_dot2_f32_bf16 v32, v192, s78, v32
    v_dot2_f32_bf16 v33, v192, s79, v33
    v_dot2_f32_bf16 v34, v193, s78, v34
    v_dot2_f32_bf16 v35, v193, s79, v35
    v_dot2_f32_bf16 v36, v194, s78, v36
    v_dot2_f32_bf16 v37, v194, s79, v37
    v_dot2_f32_bf16 v38, v195, s78, v38
    v_dot2_f32_bf16 v39, v195, s79, v39
    v_dot2_f32_bf16 v40, v230, s78, v40
    v_dot2_f32_bf16 v41, v230, s79, v41
    v_dot2_f32_bf16 v42, v231, s78, v42
    v_dot2_f32_bf16 v43, v231, s79, v43
    v_dot2_f32_bf16 v44, v232, s78, v44
    v_dot2_f32_bf16 v45, v232, s79, v45
    v_dot2_f32_bf16 v46, v233, s78, v46
    v_dot2_f32_bf16 v47, v233, s79, v47
    v_dot2_f32_bf16 v48, v248, s78, v48
    v_dot2_f32_bf16 v49, v248, s79, v49
    v_dot2_f32_bf16 v50, v249, s78, v50
    v_dot2_f32_bf16 v51, v249, s79, v51
    v_dot2_f32_bf16 v52, v250, s78, v52
    v_dot2_f32_bf16 v53, v250, s79, v53
    v_dot2_f32_bf16 v54, v251, s78, v54
    v_dot2_f32_bf16 v55, v251, s79, v55
    s_mov_b32 s53, 0
dp_29:
    buffer_load_dwordx4 v[208:211], v2, s[16:19], s40 offen offset:0 sc1
    buffer_load_dwordx4 v[212:215], v2, s[16:19], s40 offen offset:1024 sc1
    buffer_load_dwordx4 v[216:219], v2, s[16:19], s44 offen offset:0 sc1
    buffer_load_dwordx4 v[220:223], v2, s[16:19], s44 offen offset:1024 sc1
    s_waitcnt vmcnt(0)
    v_bitop3_b32 v6, v208, v212, v216 bitop3:0x80
    v_bitop3_b32 v6, v6, v220, 1 bitop3:0x80
    v_cmp_eq_u32 vcc, 0, v6
    s_cbranch_vccz dq_30
    s_sleep 2
    s_add_u32 s53, s53, 1
    s_cmp_lt_u32 s53, s61
    s_cbranch_scc1 dp_29
    s_mov_b32 s61, 0
dq_30:
    v_dot2_f32_bf16 v24, v208, s78, v24
    v_dot2_f32_bf16 v25, v208, s79, v25
    v_dot2_f32_bf16 v26, v209, s78, v26
    v_dot2_f32_bf16 v27, v209, s79, v27
    v_dot2_f32_bf16 v28, v210, s78, v28
    v_dot2_f32_bf16 v29, v210, s79, v29
    v_dot2_f32_bf16 v30, v211, s78, v30
    v_dot2_f32_bf16 v31, v211, s79, v31
    v_cvt_pk_bf16_f32 v24, v24, v25
    v_cvt_pk_bf16_f32 v25, v26, v27
    v_cvt_pk_bf16_f32 v26, v28, v29
    v_cvt_pk_bf16_f32 v27, v30, v31
    s_nop 0
    v_permlane16_swap_b32 v24, v26
    v_permlane16_swap_b32 v25, v27
    v_dot2_f32_bf16 v32, v212, s78, v32
    v_dot2_f32_bf16 v33, v212, s79, v33
    v_dot2_f32_bf16 v34, v213, s78, v34
    v_dot2_f32_bf16 v35, v213, s79, v35
    v_dot2_f32_bf16 v36, v214, s78, v36
    v_dot2_f32_bf16 v37, v214, s79, v37
    v_dot2_f32_bf16 v38, v215, s78, v38
    v_dot2_f32_bf16 v39, v215, s79, v39
    v_cvt_pk_bf16_f32 v32, v32, v33
    v_cvt_pk_bf16_f32 v33, v34, v35
    v_cvt_pk_bf16_f32 v34, v36, v37
    v_cvt_pk_bf16_f32 v35, v38, v39
    s_nop 0
    v_permlane16_swap_b32 v32, v34
    v_permlane16_swap_b32 v33, v35
    v_mov_b32 v36, v24
    v_mov_b32 v37, v25
    v_mov_b32 v38, v26
    v_mov_b32 v39, v27
    v_mov_b32_dpp v24, v32 row_ror:8 row_mask:0xf bank_mask:0xc
    v_mov_b32_dpp v25, v33 row_ror:8 row_mask:0xf bank_mask:0xc
    v_mov_b32_dpp v26, v34 row_ror:8 row_mask:0xf bank_mask:0xc
    v_mov_b32_dpp v27, v35 row_ror:8 row_mask:0xf bank_mask:0xc
    v_mov_b32_dpp v32, v36 row_ror:8 row_mask:0xf bank_mask:0x3
    v_mov_b32_dpp v33, v37 row_ror:8 row_mask:0xf bank_mask:0x3
    v_mov_b32_dpp v34, v38 row_ror:8 row_mask:0xf bank_mask:0x3
    v_mov_b32_dpp v35, v39 row_ror:8 row_mask:0xf bank_mask:0x3
    buffer_store_dwordx4 v[24:27], v224, s[20:23], s46 offen sc1
    buffer_store_dwordx4 v[32:35], v225, s[20:23], s46 offen sc1
    v_dot2_f32_bf16 v40, v216, s78, v40
    v_dot2_f32_bf16 v41, v216, s79, v41
    v_dot2_f32_bf16 v42, v217, s78, v42
    v_dot2_f32_bf16 v43, v217, s79, v43
    v_dot2_f32_bf16 v44, v218, s78, v44
    v_dot2_f32_bf16 v45, v218, s79, v45
    v_dot2_f32_bf16 v46, v219, s78, v46
    v_dot2_f32_bf16 v47, v219, s79, v47
    v_cvt_pk_bf16_f32 v40, v40, v41
    v_cvt_pk_bf16_f32 v41, v42, v43
    v_cvt_pk_bf16_f32 v42, v44, v45
    v_cvt_pk_bf16_f32 v43, v46, v47
    s_nop 0
    v_permlane16_swap_b32 v40, v42
    v_permlane16_swap_b32 v41, v43
    v_dot2_f32_bf16 v48, v220, s78, v48
    v_dot2_f32_bf16 v49, v220, s79, v49
    v_dot2_f32_bf16 v50, v221, s78, v50
    v_dot2_f32_bf16 v51, v221, s79, v51
    v_dot2_f32_bf16 v52, v222, s78, v52
    v_dot2_f32_bf16 v53, v222, s79, v53
    v_dot2_f32_bf16 v54, v223, s78, v54
    v_dot2_f32_bf16 v55, v223, s79, v55
    v_cvt_pk_bf16_f32 v48, v48, v49
    v_cvt_pk_bf16_f32 v49, v50, v51
    v_cvt_pk_bf16_f32 v50, v52, v53
    v_cvt_pk_bf16_f32 v51, v54, v55
    s_nop 0
    v_permlane16_swap_b32 v48, v50
    v_permlane16_swap_b32 v49, v51
    v_mov_b32 v52, v40
    v_mov_b32 v53, v41
    v_mov_b32 v54, v42
    v_mov_b32 v55, v43
    v_mov_b32_dpp v40, v48 row_ror:8 row_mask:0xf bank_mask:0xc
    v_mov_b32_dpp v41, v49 row_ror:8 row_mask:0xf bank_mask:0xc
    v_mov_b32_dpp v42, v50 row_ror:8 row_mask:0xf bank_mask:0xc
    v_mov_b32_dpp v43, v51 row_ror:8 row_mask:0xf bank_mask:0xc
    v_mov_b32_dpp v48, v52 row_ror:8 row_mask:0xf bank_mask:0x3
    v_mov_b32_dpp v49, v53 row_ror:8 row_mask:0xf bank_mask:0x3
    v_mov_b32_dpp v50, v54 row_ror:8 row_mask:0xf bank_mask:0x3
    v_mov_b32_dpp v51, v55 row_ror:8 row_mask:0xf bank_mask:0x3
    buffer_store_dwordx4 v[40:43], v224, s[20:23], s47 offen sc1
    buffer_store_dwordx4 v[48:51], v225, s[20:23], s47 offen sc1
    s_branch K_fin
LOADERS:
    s_cmp_lg_u32 s60, 0
    s_cbranch_scc1 pr_31
    s_and_b32 s36, s29, 6
    s_cmp_eq_u32 s36, 2
    s_cbranch_scc0 pr_31
    s_call_b64 s[76:77], SUB_park2
pr_31:
    s_cmp_ge_u32 s30, 6
    s_cbranch_scc1 WLOAD
    s_add_u32 s54, s55, 0x500
    v_mov_b32 v222, s54
    s_lshl_b32 s53, s29, 7
    s_add_u32 s53, s53, 23121920
    v_mov_b32 v226, s53
    s_sleep 30
    s_mov_b64 exec, 1
    buffer_load_dword v227, v226, s[56:59], 0 offen sc1
    s_mov_b64 exec, -1
    s_waitcnt vmcnt(0)
    v_readfirstlane_b32 s53, v227
    s_add_u32 s54, s52, 16
    s_cmp_eq_u32 s53, s54
    s_cbranch_scc1 fok_32
    s_mov_b32 s53, 0
    s_add_u32 s54, s52, 16
    s_bfm_b64 exec, 1, 0
poll_33:
    buffer_load_dword v227, v226, s[56:59], 0 offen sc1
    s_waitcnt vmcnt(0)
    v_xor_b32 v227, s54, v227
    v_cmp_eq_u32 vcc, 0, v227
    s_nop 0
    s_cmp_eq_u64 vcc, exec
    s_cbranch_scc1 pok_34
    s_sleep 5
    s_add_u32 s53, s53, 1
    s_cmp_lt_u32 s53, s61
    s_cbranch_scc1 poll_33
    s_mov_b32 s61, 0
pok_34:
    s_mov_b64 exec, -1
fok_32:
    s_add_u32 s24, s4, 0x1400000
    s_addc_u32 s25, s5, 0
    s_mov_b32 s26, 0x20000
    s_mov_b32 s27, 0x20000
    s_cmp_eq_u32 s60, 0
    s_cselect_b32 s26, s26, 0
    s_and_b32 s36, s30, 1
    s_mul_i32 s36, s36, 128
    s_mul_i32 s37, s29, 256
    s_add_u32 s37, s36, s37
    v_lshrrev_b32 v224, 3, v1
    v_mul_u32_u24 v224, 4096, v224
    v_and_b32 v23, 112, v2
    v_add_u32 v224, v224, v23
    s_cmp_eq_u32 s60, 0
    s_cselect_b64 exec, -1, 0
    buffer_load_dwordx4 v[24:27], v224, s[24:27], s37 offen sc1
    s_add_u32 s37, s37, 32768
    buffer_load_dwordx4 v[28:31], v224, s[24:27], s37 offen sc1
    s_add_u32 s37, s37, 32768
    buffer_load_dwordx4 v[32:35], v224, s[24:27], s37 offen sc1
    s_add_u32 s37, s37, 32768
    buffer_load_dwordx4 v[36:39], v224, s[24:27], s37 offen sc1
    s_add_u32 s37, s37, 32768
    s_mov_b64 exec, -1
    s_mov_b64 exec, 1
    buffer_load_dword v223, v222, s[56:59], 0 offen sc1
    s_mov_b64 exec, -1
    s_waitcnt vmcnt(0)
    v_readfirstlane_b32 s53, v223
    s_add_u32 s54, s52, 16
    s_cmp_eq_u32 s53, s54
    s_cbranch_scc1 fok_35
    s_mov_b32 s53, 0
    s_add_u32 s54, s52, 16
    s_bfm_b64 exec, 1, 0
poll_36:
    buffer_load_dword v223, v222, s[56:59], 0 offen sc1
    s_waitcnt vmcnt(0)
    v_xor_b32 v223, s54, v223
    v_cmp_eq_u32 vcc, 0, v223
    s_nop 0
    s_cmp_eq_u64 vcc, exec
    s_cbranch_scc1 pok_37
    s_sleep 5
    s_add_u32 s53, s53, 1
    s_cmp_lt_u32 s53, s61
    s_cbranch_scc1 poll_36
    s_mov_b32 s61, 0
pok_37:
    s_mov_b64 exec, -1
fok_35:
    s_add_u32 s20, s62, 0x5d0000
    s_addc_u32 s21, s63, 0
    s_mov_b32 s22, 0x800
    s_mov_b32 s23, 0x20000
    s_and_b32 s35, s30, 1
    s_lshl_b32 s35, s35, 10
    buffer_load_dwordx4 v[16:19], v2, s[20:23], s35 offen sc1
    s_cmp_lg_u32 s60, 0
    s_cbranch_scc1 pc_38
    v_add_f32 v24, v24, v28
    v_add_f32 v25, v25, v29
    v_add_f32 v26, v26, v30
    v_add_f32 v27, v27, v31
    v_add_f32 v24, v24, v32
    v_add_f32 v25, v25, v33
    v_add_f32 v26, v26, v34
    v_add_f32 v27, v27, v35
    v_add_f32 v24, v24, v36
    v_add_f32 v25, v25, v37
    v_add_f32 v26, v26, v38
    v_add_f32 v27, v27, v39
    v_add_f32_dpp v24, v24, v24 row_ror:8 row_mask:0xf bank_mask:0xf
    v_add_f32_dpp v25, v25, v25 row_ror:8 row_mask:0xf bank_mask:0xf
    v_add_f32_dpp v26, v26, v26 row_ror:8 row_mask:0xf bank_mask:0xf
    v_add_f32_dpp v27, v27, v27 row_ror:8 row_mask:0xf bank_mask:0xf
    v_mov_b32 v28, v24
    v_mov_b32 v29, v25
    v_mov_b32 v30, v26
    v_mov_b32 v31, v27
    v_permlane16_swap_b32 v24, v28
    v_permlane16_swap_b32 v25, v29
    v_permlane16_swap_b32 v26, v30
    v_permlane16_swap_b32 v27, v31
    v_add_f32 v24, v24, v28
    v_add_f32 v25, v25, v29
    v_add_f32 v26, v26, v30
    v_add_f32 v27, v27, v31
    v_mov_b32 v28, v24
    v_mov_b32 v29, v25
    v_mov_b32 v30, v26
    v_mov_b32 v31, v27
    v_permlane32_swap_b32 v24, v28
    v_permlane32_swap_b32 v25, v29
    v_permlane32_swap_b32 v26, v30
    v_permlane32_swap_b32 v27, v31
    v_add_f32 v24, v24, v28
    v_add_f32 v25, v25, v29
    v_add_f32 v26, v26, v30
    v_add_f32 v27, v27, v31
pc_38:
    s_cmp_lg_u32 s60, 0
    s_cbranch_scc1 pc_39
    s_and_b32 s36, s30, 1
    s_mul_i32 s36, s36, 128
    s_add_u32 s36, s36, 163328
    v_add_u32 v23, s36, v2
    s_bfm_b64 exec, 8, 0
    ds_write_b128 v23, v[24:27]
    s_mov_b64 exec, -1
    s_waitcnt lgkmcnt(0)
pc_39:
    s_waitcnt vmcnt(0)
    s_and_b32 s36, s30, 1
    s_lshl_b32 s36, s36, 10
    s_add_u32 s36, s36, 160768
    v_add_u32 v221, s36, v2
    ds_write_b128 v221, v[16:19]
    s_waitcnt lgkmcnt(0)
    s_cmp_lg_u32 s30, 4
    s_cbranch_scc1 AL_nw
    s_cmp_eq_u32 s60, 0
    s_cbranch_scc1 AL_nw
    s_add_u32 s54, s55, 0xffc00300
    s_add_u32 s53, s54, s92
    v_mov_b32 v9, s53
    s_add_u32 s53, s53, 128
    v_writelane_b32 v9, s53, 1
    s_add_u32 s53, s54, s93
    v_writelane_b32 v9, s53, 2
    s_add_u32 s53, s53, 128
    v_writelane_b32 v9, s53, 3
    s_mov_b32 s53, 0
    s_add_u32 s54, s52, 8
    s_bfm_b64 exec, 4, 0
poll_41:
    buffer_load_dword v8, v9, s[56:59], 0 offen sc1
    s_waitcnt vmcnt(0)
    v_xor_b32 v8, s54, v8
    v_cmp_eq_u32 vcc, 0, v8
    s_nop 0
    s_cmp_eq_u64 vcc, exec
    s_cbranch_scc1 pok_42
    s_sleep 5
    s_add_u32 s53, s53, 1
    s_cmp_lt_u32 s53, s61
    s_cbranch_scc1 poll_41
    s_mov_b32 s61, 0
pok_42:
    s_mov_b64 exec, -1
AL_nw:
    s_barrier
    s_call_b64 s[76:77], SUB_after_g1
    s_barrier
    s_waitcnt vmcnt(0)
    s_barrier
    s_call_b64 s[76:77], SUB_after_g2
    s_and_b32 s35, s30, 1
    s_add_u32 s12, s62, 0x80000
    s_addc_u32 s13, s63, 0
    s_mov_b32 s14, 0x7e000
    s_mov_b32 s15, 0x20000
    s_mul_i32 s38, s35, 262144
    s_lshl_b32 s41, s35, 13
    s_mov_b32 s42, 0
    s_mov_b32 s44, 0
    s_add_u32 s54, s55, 0x200
    v_mov_b32 v9, s54
    s_mov_b32 s44, 1
    s_mov_b32 s42, 16384
    s_add_u32 s54, s55, 0x580
    v_mov_b32 v222, s54
    v_lshlrev_b32 v221, 3, v1
    s_add_u32 s19, s41, s42
    v_readlane_b32 s16, v248, s44
    s_nop 0
    s_add_u32 s16, s16, s38
    s_add_u32 s44, s44, 1
    s_and_b32 s44, s44, 15
    s_add_u32 s42, s42, 16384
    s_cmp_eq_u32 s42, 49152
    s_cselect_b32 s42, 0, s42
    s_mov_b32 m0, s19
    s_mov_b32 s39, s16
    s_waitcnt vmcnt(63)
    s_barrier
    s_sleep 6
    s_mov_b32 s53, 0
    s_add_u32 s54, s52, 16
    s_bfm_b64 exec, 1, 0
poll_43:
    buffer_load_dword v8, v9, s[56:59], 0 offen sc1
    s_waitcnt vmcnt(0)
    v_xor_b32 v8, s54, v8
    v_cmp_eq_u32 vcc, 0, v8
    s_nop 0
    s_cmp_eq_u64 vcc, exec
    s_cbranch_scc1 pok_44
    s_sleep 5
    s_add_u32 s53, s53, 1
    s_cmp_lt_u32 s53, s61
    s_cbranch_scc1 poll_43
    s_mov_b32 s61, 0
pok_44:
    s_mov_b64 exec, -1
    buffer_load_dwordx4 v2, s[12:15], s39 offen sc1 lds
    buffer_load_dwordx4 v2, s[12:15], s39 offen offset:1024 sc1 lds
    s_add_u32 s19, s41, s42
    v_readlane_b32 s16, v248, s44
    s_nop 0
    s_add_u32 s16, s16, s38
    s_add_u32 s44, s44, 1
    s_and_b32 s44, s44, 15
    s_add_u32 s42, s42, 16384
    s_cmp_eq_u32 s42, 49152
    s_cselect_b32 s42, 0, s42
    s_add_u32 m0, m0, 2048
    s_add_u32 s39, s39, 65536
    buffer_load_dwordx4 v2, s[12:15], s39 offen sc1 lds
    buffer_load_dwordx4 v2, s[12:15], s39 offen offset:1024 sc1 lds
    s_add_u32 m0, m0, 2048
    s_add_u32 s39, s39, 65536
    buffer_load_dwordx4 v2, s[12:15], s39 offen sc1 lds
    buffer_load_dwordx4 v2, s[12:15], s39 offen offset:1024 sc1 lds
    s_add_u32 m0, m0, 2048
    s_add_u32 s39, s39, 65536
    buffer_load_dwordx4 v2, s[12:15], s39 offen sc1 lds
    buffer_load_dwordx4 v2, s[12:15], s39 offen offset:1024 sc1 lds
    s_mov_b32 m0, s19
    s_mov_b32 s39, s16
    buffer_load_dwordx4 v2, s[12:15], s39 offen sc1 lds
    buffer_load_dwordx4 v2, s[12:15], s39 offen offset:1024 sc1 lds
    s_add_u32 s19, s41, s42
    v_readlane_b32 s16, v248, s44
    s_nop 0
    s_add_u32 s16, s16, s38
    s_add_u32 s44, s44, 1
    s_and_b32 s44, s44, 15
    s_add_u32 s42, s42, 16384
    s_cmp_eq_u32 s42, 49152
    s_cselect_b32 s42, 0, s42
    s_add_u32 m0, m0, 2048
    s_add_u32 s39, s39, 65536
    buffer_load_dwordx4 v2, s[12:15], s39 offen sc1 lds
    buffer_load_dwordx4 v2, s[12:15], s39 offen offset:1024 sc1 lds
    s_add_u32 m0, m0, 2048
    s_add_u32 s39, s39, 65536
    buffer_load_dwordx4 v2, s[12:15], s39 offen sc1 lds
    buffer_load_dwordx4 v2, s[12:15], s39 offen offset:1024 sc1 lds
    s_add_u32 m0, m0, 2048
    s_add_u32 s39, s39, 65536
    buffer_load_dwordx4 v2, s[12:15], s39 offen sc1 lds
    buffer_load_dwordx4 v2, s[12:15], s39 offen offset:1024 sc1 lds
    s_mov_b32 m0, s19
    s_mov_b32 s39, s16
    s_waitcnt vmcnt(8)
    s_barrier
    buffer_load_dwordx4 v2, s[12:15], s39 offen sc1 lds
    buffer_load_dwordx4 v2, s[12:15], s39 offen offset:1024 sc1 lds
    s_add_u32 s19, s41, s42
    v_readlane_b32 s16, v248, s44
    s_nop 0
    s_add_u32 s16, s16, s38
    s_add_u32 s44, s44, 1
    s_and_b32 s44, s44, 15
    s_add_u32 s42, s42, 16384
    s_cmp_eq_u32 s42, 49152
    s_cselect_b32 s42, 0, s42
    s_add_u32 m0, m0, 2048
    s_add_u32 s39, s39, 65536
    buffer_load_dwordx4 v2, s[12:15], s39 offen sc1 lds
    buffer_load_dwordx4 v2, s[12:15], s39 offen offset:1024 sc1 lds
    s_add_u32 m0, m0, 2048
    s_add_u32 s39, s39, 65536
    buffer_load_dwordx4 v2, s[12:15], s39 offen sc1 lds
    buffer_load_dwordx4 v2, s[12:15], s39 offen offset:1024 sc1 lds
    s_add_u32 m0, m0, 2048
    s_add_u32 s39, s39, 65536
    buffer_load_dwordx4 v2, s[12:15], s39 offen sc1 lds
    buffer_load_dwordx4 v2, s[12:15], s39 offen offset:1024 sc1 lds
    s_mov_b32 m0, s19
    s_mov_b32 s39, s16
    s_add_u32 s24, s4, 0x1420000
    s_addc_u32 s25, s5, 0
    s_mov_b32 s26, 0x70000
    s_mov_b32 s27, 0x20000
    s_cmp_eq_u32 s60, 0
    s_cselect_b32 s26, s26, 0
    s_and_b32 s36, s30, 1
    s_mul_i32 s36, s36, 448
    s_mul_i32 s37, s29, 896
    s_add_u32 s37, s36, s37
    v_lshrrev_b32 v224, 5, v1
    v_mul_u32_u24 v224, 14336, v224
    v_and_b32 v179, 496, v2
    v_add_u32 v224, v224, v179
    s_cmp_eq_u32 s60, 0
    s_cselect_b64 exec, -1, 0
    buffer_load_dwordx4 v[180:183], v224, s[24:27], s37 offen sc1
    s_add_u32 s37, s37, 28672
    buffer_load_dwordx4 v[184:187], v224, s[24:27], s37 offen sc1
    s_add_u32 s37, s37, 28672
    buffer_load_dwordx4 v[188:191], v224, s[24:27], s37 offen sc1
    s_add_u32 s37, s37, 28672
    s_mov_b64 exec, -1
    s_waitcnt vmcnt(11)
    s_barrier
    buffer_load_dwordx4 v2, s[12:15], s39 offen sc1 lds
    buffer_load_dwordx4 v2, s[12:15], s39 offen offset:1024 sc1 lds
    s_add_u32 s19, s41, s42
    v_readlane_b32 s16, v248, s44
    s_nop 0
    s_add_u32 s16, s16, s38
    s_add_u32 s44, s44, 1
    s_and_b32 s44, s44, 15
    s_add_u32 s42, s42, 16384
    s_cmp_eq_u32 s42, 49152
    s_cselect_b32 s42, 0, s42
    s_add_u32 m0, m0, 2048
    s_add_u32 s39, s39, 65536
    buffer_load_dwordx4 v2, s[12:15], s39 offen sc1 lds
    buffer_load_dwordx4 v2, s[12:15], s39 offen offset:1024 sc1 lds
    s_add_u32 m0, m0, 2048
    s_add_u32 s39, s39, 65536
    buffer_load_dwordx4 v2, s[12:15], s39 offen sc1 lds
    buffer_load_dwordx4 v2, s[12:15], s39 offen offset:1024 sc1 lds
    s_add_u32 m0, m0, 2048
    s_add_u32 s39, s39, 65536
    buffer_load_dwordx4 v2, s[12:15], s39 offen sc1 lds
    buffer_load_dwordx4 v2, s[12:15], s39 offen offset:1024 sc1 lds
    s_mov_b32 m0, s19
    s_mov_b32 s39, s16
    s_cmp_eq_u32 s60, 0
    s_cselect_b64 exec, -1, 0
    buffer_load_dwordx4 v[192:195], v224, s[24:27], s37 offen sc1
    s_add_u32 s37, s37, 28672
    buffer_load_dwordx4 v[196:199], v224, s[24:27], s37 offen sc1
    s_add_u32 s37, s37, 28672
    buffer_load_dwordx4 v[200:203], v224, s[24:27], s37 offen sc1
    s_add_u32 s37, s37, 28672
    s_mov_b64 exec, -1
    s_waitcnt vmcnt(14)
    s_barrier
    buffer_load_dwordx4 v2, s[12:15], s39 offen sc1 lds
    buffer_load_dwordx4 v2, s[12:15], s39 offen offset:1024 sc1 lds
    s_add_u32 s19, s41, s42
    v_readlane_b32 s16, v248, s44
    s_nop 0
    s_add_u32 s16, s16, s38
    s_add_u32 s44, s44, 1
    s_and_b32 s44, s44, 15
    s_add_u32 s42, s42, 16384
    s_cmp_eq_u32 s42, 49152
    s_cselect_b32 s42, 0, s42
    s_add_u32 m0, m0, 2048
    s_add_u32 s39, s39, 65536
    buffer_load_dwordx4 v2, s[12:15], s39 offen sc1 lds
    buffer_load_dwordx4 v2, s[12:15], s39 offen offset:1024 sc1 lds
    s_add_u32 m0, m0, 2048
    s_add_u32 s39, s39, 65536
    buffer_load_dwordx4 v2, s[12:15], s39 offen sc1 lds
    buffer_load_dwordx4 v2, s[12:15], s39 offen offset:1024 sc1 lds
    s_add_u32 m0, m0, 2048
    s_add_u32 s39, s39, 65536
    buffer_load_dwordx4 v2, s[12:15], s39 offen sc1 lds
    buffer_load_dwordx4 v2, s[12:15], s39 offen offset:1024 sc1 lds
    s_mov_b32 m0, s19
    s_mov_b32 s39, s16
    s_cmp_eq_u32 s60, 0
    s_cselect_b64 exec, -1, 0
    buffer_load_dwordx4 v[204:207], v224, s[24:27], s37 offen sc1
    s_add_u32 s37, s37, 28672
    buffer_load_dwordx4 v[208:211], v224, s[24:27], s37 offen sc1
    s_add_u32 s37, s37, 28672
    buffer_load_dwordx4 v[212:215], v224, s[24:27], s37 offen sc1
    s_add_u32 s37, s37, 28672
    s_mov_b64 exec, -1
    s_mov_b64 exec, 1
    buffer_load_dword v223, v222, s[56:59], 0 offen sc1
    s_mov_b64 exec, -1
    s_waitcnt vmcnt(15)
    s_barrier
    buffer_load_dwordx4 v2, s[12:15], s39 offen sc1 lds
    buffer_load_dwordx4 v2, s[12:15], s39 offen offset:1024 sc1 lds
    s_add_u32 s19, s41, s42
    v_readlane_b32 s16, v248, s44
    s_nop 0
    s_add_u32 s16, s16, s38
    s_add_u32 s44, s44, 1
    s_and_b32 s44, s44, 15
    s_add_u32 s42, s42, 16384
    s_cmp_eq_u32 s42, 49152
    s_cselect_b32 s42, 0, s42
    s_add_u32 m0, m0, 2048
    s_add_u32 s39, s39, 65536
    buffer_load_dwordx4 v2, s[12:15], s39 offen sc1 lds
    buffer_load_dwordx4 v2, s[12:15], s39 offen offset:1024 sc1 lds
    s_add_u32 m0, m0, 2048
    s_add_u32 s39, s39, 65536
    buffer_load_dwordx4 v2, s[12:15], s39 offen sc1 lds
    buffer_load_dwordx4 v2, s[12:15], s39 offen offset:1024 sc1 lds
    s_add_u32 m0, m0, 2048
    s_add_u32 s39, s39, 65536
    buffer_load_dwordx4 v2, s[12:15], s39 offen sc1 lds
    buffer_load_dwordx4 v2, s[12:15], s39 offen offset:1024 sc1 lds
    s_mov_b32 m0, s19
    s_mov_b32 s39, s16
    s_waitcnt vmcnt(12)
    s_barrier
    buffer_load_dwordx4 v2, s[12:15], s39 offen sc1 lds
    buffer_load_dwordx4 v2, s[12:15], s39 offen offset:1024 sc1 lds
    s_add_u32 s19, s41, s42
    v_readlane_b32 s16, v248, s44
    s_nop 0
    s_add_u32 s16, s16, s38
    s_add_u32 s44, s44, 1
    s_and_b32 s44, s44, 15
    s_add_u32 s42, s42, 16384
    s_cmp_eq_u32 s42, 49152
    s_cselect_b32 s42, 0, s42
    s_add_u32 m0, m0, 2048
    s_add_u32 s39, s39, 65536
    buffer_load_dwordx4 v2, s[12:15], s39 offen sc1 lds
    buffer_load_dwordx4 v2, s[12:15], s39 offen offset:1024 sc1 lds
    s_add_u32 m0, m0, 2048
    s_add_u32 s39, s39, 65536
    buffer_load_dwordx4 v2, s[12:15], s39 offen sc1 lds
    buffer_load_dwordx4 v2, s[12:15], s39 offen offset:1024 sc1 lds
    s_add_u32 m0, m0, 2048
    s_add_u32 s39, s39, 65536
    buffer_load_dwordx4 v2, s[12:15], s39 offen sc1 lds
    buffer_load_dwordx4 v2, s[12:15], s39 offen offset:1024 sc1 lds
    s_mov_b32 m0, s19
    s_mov_b32 s39, s16
    s_waitcnt vmcnt(16)
    v_readfirstlane_b32 s53, v223
    s_add_u32 s54, s52, 16
    s_cmp_eq_u32 s53, s54
    s_cbranch_scc1 fok_45
    s_mov_b32 s53, 0
    s_add_u32 s54, s52, 16
    s_bfm_b64 exec, 1, 0
poll_46:
    buffer_load_dword v223, v222, s[56:59], 0 offen sc1
    s_waitcnt vmcnt(0)
    v_xor_b32 v223, s54, v223
    v_cmp_eq_u32 vcc, 0, v223
    s_nop 0
    s_cmp_eq_u64 vcc, exec
    s_cbranch_scc1 pok_47
    s_sleep 5
    s_add_u32 s53, s53, 1
    s_cmp_lt_u32 s53, s61
    s_cbranch_scc1 poll_46
    s_mov_b32 s61, 0
pok_47:
    s_mov_b64 exec, -1
fok_45:
    s_add_u32 s20, s62, 0x5c8000
    s_addc_u32 s21, s63, 0
    s_mov_b32 s22, 0x6000
    s_mov_b32 s23, 0x20000
    s_and_b32 s35, s30, 1
    s_lshl_b32 s35, s35, 9
    s_add_u32 s36, s35, 0
    buffer_load_dwordx2 v[16:17], v221, s[20:23], s36 offen offset:0 sc1
    buffer_load_dwordx2 v[18:19], v221, s[20:23], s36 offen offset:1024 sc1
    buffer_load_dwordx2 v[20:21], v221, s[20:23], s36 offen offset:2048 sc1
    buffer_load_dwordx2 v[22:23], v221, s[20:23], s36 offen offset:3072 sc1
    s_cmp_lg_u32 s60, 0
    s_cbranch_scc1 pc_48
    v_add_f32 v180, v180, v184
    v_add_f32 v181, v181, v185
    v_add_f32 v182, v182, v186
    v_add_f32 v183, v183, v187
    v_add_f32 v180, v180, v188
    v_add_f32 v181, v181, v189
    v_add_f32 v182, v182, v190
    v_add_f32 v183, v183, v191
    v_add_f32 v180, v180, v192
    v_add_f32 v181, v181, v193
    v_add_f32 v182, v182, v194
    v_add_f32 v183, v183, v195
    v_add_f32 v180, v180, v196
    v_add_f32 v181, v181, v197
    v_add_f32 v182, v182, v198
    v_add_f32 v183, v183, v199
pc_48:
    s_waitcnt vmcnt(12)
    s_barrier
    buffer_load_dwordx4 v2, s[12:15], s39 offen sc1 lds
    buffer_load_dwordx4 v2, s[12:15], s39 offen offset:1024 sc1 lds
    s_add_u32 s19, s41, s42
    v_readlane_b32 s16, v248, s44
    s_nop 0
    s_add_u32 s16, s16, s38
    s_add_u32 s44, s44, 1
    s_and_b32 s44, s44, 15
    s_add_u32 s42, s42, 16384
    s_cmp_eq_u32 s42, 49152
    s_cselect_b32 s42, 0, s42
    s_add_u32 m0, m0, 2048
    s_add_u32 s39, s39, 65536
    buffer_load_dwordx4 v2, s[12:15], s39 offen sc1 lds
    buffer_load_dwordx4 v2, s[12:15], s39 offen offset:1024 sc1 lds
    s_add_u32 m0, m0, 2048
    s_add_u32 s39, s39, 65536
    buffer_load_dwordx4 v2, s[12:15], s39 offen sc1 lds
    buffer_load_dwordx4 v2, s[12:15], s39 offen offset:1024 sc1 lds
    s_add_u32 m0, m0, 2048
    s_add_u32 s39, s39, 65536
    buffer_load_dwordx4 v2, s[12:15], s39 offen sc1 lds
    buffer_load_dwordx4 v2, s[12:15], s39 offen offset:1024 sc1 lds
    s_mov_b32 m0, s19
    s_mov_b32 s39, s16
    s_add_u32 s36, s35, 4096
    buffer_load_dwordx2 v[24:25], v221, s[20:23], s36 offen offset:0 sc1
    buffer_load_dwordx2 v[26:27], v221, s[20:23], s36 offen offset:1024 sc1
    buffer_load_dwordx2 v[28:29], v221, s[20:23], s36 offen offset:2048 sc1
    buffer_load_dwordx2 v[30:31], v221, s[20:23], s36 offen offset:3072 sc1
    s_cmp_lg_u32 s60, 0
    s_cbranch_scc1 pc_49
    v_add_f32 v180, v180, v200
    v_add_f32 v181, v181, v201
    v_add_f32 v182, v182, v202
    v_add_f32 v183, v183, v203
    v_add_f32 v180, v180, v204
    v_add_f32 v181, v181, v205
    v_add_f32 v182, v182, v206
    v_add_f32 v183, v183, v207
    v_add_f32 v180, v180, v208
    v_add_f32 v181, v181, v209
    v_add_f32 v182, v182, v210
    v_add_f32 v183, v183, v211
    v_add_f32 v180, v180, v212
    v_add_f32 v181, v181, v213
    v_add_f32 v182, v182, v214
    v_add_f32 v183, v183, v215
pc_49:
    s_cmp_eq_u32 s60, 0
    s_cselect_b64 exec, -1, 0
    buffer_load_dwordx4 v[184:187], v224, s[24:27], s37 offen sc1
    s_add_u32 s37, s37, 28672
    buffer_load_dwordx4 v[188:191], v224, s[24:27], s37 offen sc1
    s_add_u32 s37, s37, 28672
    buffer_load_dwordx4 v[192:195], v224, s[24:27], s37 offen sc1
    s_add_u32 s37, s37, 28672
    s_mov_b64 exec, -1
    s_waitcnt vmcnt(19)
    s_barrier
    buffer_load_dwordx4 v2, s[12:15], s39 offen sc1 lds
    buffer_load_dwordx4 v2, s[12:15], s39 offen offset:1024 sc1 lds
    s_add_u32 s19, s41, s42
    v_readlane_b32 s16, v248, s44
    s_nop 0
    s_add_u32 s16, s16, s38
    s_add_u32 s44, s44, 1
    s_and_b32 s44, s44, 15
    s_add_u32 s42, s42, 16384
    s_cmp_eq_u32 s42, 49152
    s_cselect_b32 s42, 0, s42
    s_add_u32 m0, m0, 2048
    s_add_u32 s39, s39, 65536
    buffer_load_dwordx4 v2, s[12:15], s39 offen sc1 lds
    buffer_load_dwordx4 v2, s[12:15], s39 offen offset:1024 sc1 lds
    s_add_u32 m0, m0, 2048
    s_add_u32 s39, s39, 65536
    buffer_load_dwordx4 v2, s[12:15], s39 offen sc1 lds
    buffer_load_dwordx4 v2, s[12:15], s39 offen offset:1024 sc1 lds
    s_add_u32 m0, m0, 2048
    s_add_u32 s39, s39, 65536
    buffer_load_dwordx4 v2, s[12:15], s39 offen sc1 lds
    buffer_load_dwordx4 v2, s[12:15], s39 offen offset:1024 sc1 lds
    s_mov_b32 m0, s19
    s_mov_b32 s39, s16
    s_add_u32 s36, s35, 16384
    buffer_load_dwordx2 v[32:33], v221, s[20:23], s36 offen offset:0 sc1
    buffer_load_dwordx2 v[34:35], v221, s[20:23], s36 offen offset:1024 sc1
    buffer_load_dwordx2 v[36:37], v221, s[20:23], s36 offen offset:2048 sc1
    buffer_load_dwordx2 v[38:39], v221, s[20:23], s36 offen offset:3072 sc1
    s_cmp_eq_u32 s60, 0
    s_cselect_b64 exec, -1, 0
    buffer_load_dwordx4 v[196:199], v224, s[24:27], s37 offen sc1
    s_add_u32 s37, s37, 28672
    buffer_load_dwordx4 v[200:203], v224, s[24:27], s37 offen sc1
    s_add_u32 s37, s37, 28672
    s_mov_b64 exec, -1
    s_waitcnt vmcnt(21)
    s_barrier
    buffer_load_dwordx4 v2, s[12:15], s39 offen sc1 lds
    buffer_load_dwordx4 v2, s[12:15], s39 offen offset:1024 sc1 lds
    s_add_u32 s19, s41, s42
    v_readlane_b32 s16, v248, s44
    s_nop 0
    s_add_u32 s16, s16, s38
    s_add_u32 s44, s44, 1
    s_and_b32 s44, s44, 15
    s_add_u32 s42, s42, 16384
    s_cmp_eq_u32 s42, 49152
    s_cselect_b32 s42, 0, s42
    s_add_u32 m0, m0, 2048
    s_add_u32 s39, s39, 65536
    buffer_load_dwordx4 v2, s[12:15], s39 offen sc1 lds
    buffer_load_dwordx4 v2, s[12:15], s39 offen offset:1024 sc1 lds
    s_add_u32 m0, m0, 2048
    s_add_u32 s39, s39, 65536
    buffer_load_dwordx4 v2, s[12:15], s39 offen sc1 lds
    buffer_load_dwordx4 v2, s[12:15], s39 offen offset:1024 sc1 lds
    s_add_u32 m0, m0, 2048
    s_add_u32 s39, s39, 65536
    buffer_load_dwordx4 v2, s[12:15], s39 offen sc1 lds
    buffer_load_dwordx4 v2, s[12:15], s39 offen offset:1024 sc1 lds
    s_mov_b32 m0, s19
    s_mov_b32 s39, s16
    s_add_u32 s36, s35, 20480
    buffer_load_dwordx2 v[40:41], v221, s[20:23], s36 offen offset:0 sc1
    buffer_load_dwordx2 v[42:43], v221, s[20:23], s36 offen offset:1024 sc1
    buffer_load_dwordx2 v[44:45], v221, s[20:23], s36 offen offset:2048 sc1
    buffer_load_dwordx2 v[46:47], v221, s[20:23], s36 offen offset:3072 sc1
    s_cmp_eq_u32 s60, 0
    s_cselect_b64 exec, -1, 0
    buffer_load_dwordx4 v[204:207], v224, s[24:27], s37 offen sc1
    s_add_u32 s37, s37, 28672
    buffer_load_dwordx4 v[208:211], v224, s[24:27], s37 offen sc1
    s_add_u32 s37, s37, 28672
    s_mov_b64 exec, -1
    s_waitcnt vmcnt(20)
    s_barrier
    buffer_load_dwordx4 v2, s[12:15], s39 offen sc1 lds
    buffer_load_dwordx4 v2, s[12:15], s39 offen offset:1024 sc1 lds
    s_add_u32 s19, s41, s42
    v_readlane_b32 s16, v248, s44
    s_nop 0
    s_add_u32 s16, s16, s38
    s_add_u32 s44, s44, 1
    s_and_b32 s44, s44, 15
    s_add_u32 s42, s42, 16384
    s_cmp_eq_u32 s42, 49152
    s_cselect_b32 s42, 0, s42
    s_add_u32 m0, m0, 2048
    s_add_u32 s39, s39, 65536
    buffer_load_dwordx4 v2, s[12:15], s39 offen sc1 lds
    buffer_load_dwordx4 v2, s[12:15], s39 offen offset:1024 sc1 lds
    s_add_u32 m0, m0, 2048
    s_add_u32 s39, s39, 65536
    buffer_load_dwordx4 v2, s[12:15], s39 offen sc1 lds
    buffer_load_dwordx4 v2, s[12:15], s39 offen offset:1024 sc1 lds
    s_add_u32 m0, m0, 2048
    s_add_u32 s39, s39, 65536
    buffer_load_dwordx4 v2, s[12:15], s39 offen sc1 lds
    buffer_load_dwordx4 v2, s[12:15], s39 offen offset:1024 sc1 lds
    s_mov_b32 m0, s19
    s_mov_b32 s39, s16
    s_waitcnt vmcnt(14)
    s_barrier
    buffer_load_dwordx4 v2, s[12:15], s39 offen sc1 lds
    buffer_load_dwordx4 v2, s[12:15], s39 offen offset:1024 sc1 lds
    s_add_u32 s19, s41, s42
    v_readlane_b32 s16, v248, s44
    s_nop 0
    s_add_u32 s16, s16, s38
    s_add_u32 s44, s44, 1
    s_and_b32 s44, s44, 15
    s_add_u32 s42, s42, 16384
    s_cmp_eq_u32 s42, 49152
    s_cselect_b32 s42, 0, s42
    s_add_u32 m0, m0, 2048
    s_add_u32 s39, s39, 65536
    buffer_load_dwordx4 v2, s[12:15], s39 offen sc1 lds
    buffer_load_dwordx4 v2, s[12:15], s39 offen offset:1024 sc1 lds
    s_add_u32 m0, m0, 2048
    s_add_u32 s39, s39, 65536
    buffer_load_dwordx4 v2, s[12:15], s39 offen sc1 lds
    buffer_load_dwordx4 v2, s[12:15], s39 offen offset:1024 sc1 lds
    s_add_u32 m0, m0, 2048
    s_add_u32 s39, s39, 65536
    buffer_load_dwordx4 v2, s[12:15], s39 offen sc1 lds
    buffer_load_dwordx4 v2, s[12:15], s39 offen offset:1024 sc1 lds
    s_mov_b32 m0, s19
    s_mov_b32 s39, s16
    s_waitcnt vmcnt(16)
    v_add_f32 v16, v16, v32
    v_add_f32 v17, v17, v33
    v_add_f32 v18, v18, v34
    v_add_f32 v19, v19, v35
    v_add_f32 v20, v20, v36
    v_add_f32 v21, v21, v37
    v_add_f32 v22, v22, v38
    v_add_f32 v23, v23, v39
    v_add_f32 v24, v24, v40
    v_add_f32 v25, v25, v41
    v_add_f32 v26, v26, v42
    v_add_f32 v27, v27, v43
    v_add_f32 v28, v28, v44
    v_add_f32 v29, v29, v45
    v_add_f32 v30, v30, v46
    v_add_f32 v31, v31, v47
    s_waitcnt vmcnt(8)
    s_barrier
    buffer_load_dwordx4 v2, s[12:15], s39 offen sc1 lds
    buffer_load_dwordx4 v2, s[12:15], s39 offen offset:1024 sc1 lds
    s_add_u32 s19, s41, s42
    v_readlane_b32 s16, v248, s44
    s_nop 0
    s_add_u32 s16, s16, s38
    s_add_u32 s44, s44, 1
    s_and_b32 s44, s44, 15
    s_add_u32 s42, s42, 16384
    s_cmp_eq_u32 s42, 49152
    s_cselect_b32 s42, 0, s42
    s_add_u32 m0, m0, 2048
    s_add_u32 s39, s39, 65536
    buffer_load_dwordx4 v2, s[12:15], s39 offen sc1 lds
    buffer_load_dwordx4 v2, s[12:15], s39 offen offset:1024 sc1 lds
    s_add_u32 m0, m0, 2048
    s_add_u32 s39, s39, 65536
    buffer_load_dwordx4 v2, s[12:15], s39 offen sc1 lds
    buffer_load_dwordx4 v2, s[12:15], s39 offen offset:1024 sc1 lds
    s_add_u32 m0, m0, 2048
    s_add_u32 s39, s39, 65536
    buffer_load_dwordx4 v2, s[12:15], s39 offen sc1 lds
    buffer_load_dwordx4 v2, s[12:15], s39 offen offset:1024 sc1 lds
    s_mov_b32 m0, s19
    s_mov_b32 s39, s16
    v_add_f32 v16, v16, v24
    v_add_f32 v17, v17, v25
    v_add_f32 v18, v18, v26
    v_add_f32 v19, v19, v27
    v_add_f32 v20, v20, v28
    v_add_f32 v21, v21, v29
    v_add_f32 v22, v22, v30
    v_add_f32 v23, v23, v31
    v_add_f32 v16, v16, v20
    v_add_f32 v17, v17, v21
    v_add_f32 v18, v18, v22
    v_add_f32 v19, v19, v23
    v_add_f32 v16, v16, v18
    v_add_f32 v17, v17, v19
    v_mul_f32 v20, 0x3a800000, v16
    v_mul_f32 v217, 0x3a800000, v17
    s_cmp_lg_u32 s60, 0
    s_cbranch_scc1 pc_52
    v_add_f32 v180, v180, v184
    v_add_f32 v181, v181, v185
    v_add_f32 v182, v182, v186
    v_add_f32 v183, v183, v187
    v_add_f32 v180, v180, v188
    v_add_f32 v181, v181, v189
    v_add_f32 v182, v182, v190
    v_add_f32 v183, v183, v191
    v_add_f32 v180, v180, v192
    v_add_f32 v181, v181, v193
    v_add_f32 v182, v182, v194
    v_add_f32 v183, v183, v195
pc_52:
    s_waitcnt vmcnt(8)
    s_barrier
    buffer_load_dwordx4 v2, s[12:15], s39 offen sc1 lds
    buffer_load_dwordx4 v2, s[12:15], s39 offen offset:1024 sc1 lds
    s_add_u32 s19, s41, s42
    v_readlane_b32 s16, v248, s44
    s_nop 0
    s_add_u32 s16, s16, s38
    s_add_u32 s44, s44, 1
    s_and_b32 s44, s44, 15
    s_add_u32 s42, s42, 16384
    s_cmp_eq_u32 s42, 49152
    s_cselect_b32 s42, 0, s42
    s_add_u32 m0, m0, 2048
    s_add_u32 s39, s39, 65536
    buffer_load_dwordx4 v2, s[12:15], s39 offen sc1 lds
    buffer_load_dwordx4 v2, s[12:15], s39 offen offset:1024 sc1 lds
    s_add_u32 m0, m0, 2048
    s_add_u32 s39, s39, 65536
    buffer_load_dwordx4 v2, s[12:15], s39 offen sc1 lds
    buffer_load_dwordx4 v2, s[12:15], s39 offen offset:1024 sc1 lds
    s_add_u32 m0, m0, 2048
    s_add_u32 s39, s39, 65536
    buffer_load_dwordx4 v2, s[12:15], s39 offen sc1 lds
    buffer_load_dwordx4 v2, s[12:15], s39 offen offset:1024 sc1 lds
    s_mov_b32 m0, s19
    s_mov_b32 s39, s16
    v_fma_f32 v217, -v20, v20, v217
    v_max_f32 v217, 0, v217
    v_add_f32 v217, 0x3727c5ac, v217
    v_sqrt_f32 v217, v217
    s_nop 0
    v_mov_b32 v21, v217
    v_rcp_f32 v219, v217
    s_nop 0
    v_mul_f32 v22, 0xc0135761, v219
    v_mul_f32 v23, v219, v219
    v_mul_f32 v23, v23, v22
    v_mul_f32 v23, 0x3d372713, v23
    s_lshl_b32 s35, s35, 1
    s_add_u32 s35, s35, 160768
    v_add_u32 v220, s35, v2
    ds_write_b128 v220, v[20:23]
    s_waitcnt lgkmcnt(0)
    s_waitcnt vmcnt(8)
    s_barrier
    buffer_load_dwordx4 v2, s[12:15], s39 offen sc1 lds
    buffer_load_dwordx4 v2, s[12:15], s39 offen offset:1024 sc1 lds
    s_add_u32 m0, m0, 2048
    s_add_u32 s39, s39, 65536
    buffer_load_dwordx4 v2, s[12:15], s39 offen sc1 lds
    buffer_load_dwordx4 v2, s[12:15], s39 offen offset:1024 sc1 lds
    s_add_u32 m0, m0, 2048
    s_add_u32 s39, s39, 65536
    buffer_load_dwordx4 v2, s[12:15], s39 offen sc1 lds
    buffer_load_dwordx4 v2, s[12:15], s39 offen offset:1024 sc1 lds
    s_add_u32 m0, m0, 2048
    s_add_u32 s39, s39, 65536
    buffer_load_dwordx4 v2, s[12:15], s39 offen sc1 lds
    buffer_load_dwordx4 v2, s[12:15], s39 offen offset:1024 sc1 lds
    s_cmp_lg_u32 s60, 0
    s_cbranch_scc1 pc_54
    v_add_f32 v180, v180, v196
    v_add_f32 v181, v181, v197
    v_add_f32 v182, v182, v198
    v_add_f32 v183, v183, v199
    v_add_f32 v180, v180, v200
    v_add_f32 v181, v181, v201
    v_add_f32 v182, v182, v202
    v_add_f32 v183, v183, v203
    v_add_f32 v180, v180, v204
    v_add_f32 v181, v181, v205
    v_add_f32 v182, v182, v206
    v_add_f32 v183, v183, v207
    v_add_f32 v180, v180, v208
    v_add_f32 v181, v181, v209
    v_add_f32 v182, v182, v210
    v_add_f32 v183, v183, v211
pc_54:
    s_waitcnt vmcnt(8)
    s_barrier
    s_cmp_lg_u32 s60, 0
    s_cbranch_scc1 pc_55
    v_mov_b32 v184, v180
    v_mov_b32 v185, v181
    v_mov_b32 v186, v182
    v_mov_b32 v187, v183
    v_permlane32_swap_b32 v180, v184
    v_permlane32_swap_b32 v181, v185
    v_permlane32_swap_b32 v182, v186
    v_permlane32_swap_b32 v183, v187
    v_add_f32 v180, v180, v184
    v_add_f32 v181, v181, v185
    v_add_f32 v182, v182, v186
    v_add_f32 v183, v183, v187
    s_and_b32 s36, s30, 1
    s_mul_i32 s36, s36, 448
    s_add_u32 s36, s36, 159744
    v_add_u32 v179, s36, v2
    s_bfm_b64 exec, 28, 0
    ds_write_b128 v179, v[180:183]
    s_mov_b64 exec, -1
    s_waitcnt lgkmcnt(0)
pc_55:
    s_waitcnt vmcnt(0)
    s_barrier
    s_cmp_lg_u32 s60, 0
    s_cbranch_scc1 tw4_56
    s_load_dwordx2 s[48:49], s[0:1], 80
    s_lshl_b32 s45, s2, 1
    s_and_b32 s50, s30, 1
    s_add_u32 s45, s45, s50
    s_mul_i32 s45, s45, 14336
    s_mov_b32 s50, 7340032
    s_mov_b32 s51, 0x20000
    s_waitcnt lgkmcnt(0)
    buffer_load_dwordx4 v[20:23], v2, s[48:51], s45 offen offset:0
    buffer_load_dwordx4 v[20:23], v2, s[48:51], s45 offen offset:1024
    buffer_load_dwordx4 v[20:23], v2, s[48:51], s45 offen offset:2048
    buffer_load_dwordx4 v[20:23], v2, s[48:51], s45 offen offset:3072
    s_add_u32 s45, s45, 4096
    buffer_load_dwordx4 v[20:23], v2, s[48:51], s45 offen offset:0
    buffer_load_dwordx4 v[20:23], v2, s[48:51], s45 offen offset:1024
    buffer_load_dwordx4 v[20:23], v2, s[48:51], s45 offen offset:2048
    buffer_load_dwordx4 v[20:23], v2, s[48:51], s45 offen offset:3072
    s_add_u32 s45, s45, 4096
    buffer_load_dwordx4 v[20:23], v2, s[48:51], s45 offen offset:0
    buffer_load_dwordx4 v[20:23], v2, s[48:51], s45 offen offset:1024
    buffer_load_dwordx4 v[20:23], v2, s[48:51], s45 offen offset:2048
    buffer_load_dwordx4 v[20:23], v2, s[48:51], s45 offen offset:3072
    s_add_u32 s45, s45, 4096
    buffer_load_dwordx4 v[20:23], v2, s[48:51], s45 offen offset:0
    buffer_load_dwordx4 v[20:23], v2, s[48:51], s45 offen offset:1024
tw4_56:
    s_barrier
    s_cmp_lg_u32 s60, 0
    s_cbranch_scc1 rp_57
    s_call_b64 s[76:77], SUB_r_pre
rp_57:
    s_and_b32 s35, s30, 1
    s_add_u32 s12, s62, 0x400000
    s_addc_u32 s13, s63, 0
    s_mov_b32 s14, 0x1be000
    s_mov_b32 s15, 0x20000
    s_mul_i32 s38, s35, 917504
    s_mul_i32 s36, s31, 114688
    s_add_u32 s38, s38, s36
    s_lshl_b32 s41, s35, 13
    s_mov_b32 s42, 0
    s_mov_b32 s44, 0
    s_add_u32 s54, s55, 0x700
    s_lshl_b32 s53, s31, 7
    s_add_u32 s54, s54, s53
    v_mov_b32 v9, s54
    s_add_u32 s54, s55, 0x600
    s_lshl_b32 s53, s31, 7
    s_add_u32 s54, s54, s53
    v_mov_b32 v10, s54
    s_add_u32 s54, s55, 0x300
    s_lshl_b32 s53, s31, 7
    s_add_u32 s54, s54, s53
    v_mov_b32 v12, s54
    v_mov_b32 v13, 1
    s_and_b32 s51, s30, 1
    s_lshl_b32 s51, s51, 30
    s_lshl_b32 s54, s60, 2
    s_add_u32 s54, s54, 4
    v_mov_b32 v14, 162880
spin_58:
    s_sleep 2
    ds_read_b32 v15, v14
    s_waitcnt lgkmcnt(0)
    v_readfirstlane_b32 s53, v15
    s_nop 0
    s_cmp_ge_u32 s53, s54
    s_cbranch_scc0 spin_58
    s_mov_b64 exec, 1
    buffer_atomic_add v13, v9, s[56:59], s51 offen sc1
    s_mov_b64 exec, -1
    v_xor_b32 v15, 128, v12
    s_mov_b32 s44, 3
    s_call_b64 s[76:77], PREP_a_issue_4
    s_mov_b32 m0, s19
    s_mov_b32 s39, s16
    s_mov_b32 s40, s17
    s_waitcnt vmcnt(16)
    s_barrier
    s_mov_b64 exec, 1
    buffer_load_dword v8, v9, s[56:59], 0 offen sc1
    s_mov_b64 exec, -1
    s_waitcnt vmcnt(9)
    s_barrier
    s_waitcnt vmcnt(0)
    v_readfirstlane_b32 s53, v8
    s_add_u32 s54, s52, 8
    s_cmp_eq_u32 s53, s54
    s_cbranch_scc1 fok_59
    s_mov_b32 s53, 0
    s_add_u32 s54, s52, 8
    s_bfm_b64 exec, 1, 0
poll_60:
    buffer_load_dword v8, v9, s[56:59], 0 offen sc1
    s_waitcnt vmcnt(0)
    v_xor_b32 v8, s54, v8
    v_cmp_eq_u32 vcc, 0, v8
    s_nop 0
    s_cmp_eq_u64 vcc, exec
    s_cbranch_scc1 pok_61
    s_sleep 5
    s_add_u32 s53, s53, 1
    s_cmp_lt_u32 s53, s61
    s_cbranch_scc1 poll_60
    s_mov_b32 s61, 0
pok_61:
    s_mov_b64 exec, -1
fok_59:
    buffer_load_dwordx4 v2, s[12:15], s39 offen sc1 lds
    s_add_u32 m0, m0, 1024
    s_nop 0
    buffer_load_dwordx4 v2, s[12:15], s40 offen sc1 lds
    s_call_b64 s[76:77], PREP_a_issue_4
    s_add_u32 m0, m0, 1024
    s_add_u32 s39, s39, 229376
    buffer_load_dwordx4 v2, s[12:15], s39 offen sc1 lds
    s_add_u32 m0, m0, 1024
    s_add_u32 s40, s40, 229376
    buffer_load_dwordx4 v2, s[12:15], s40 offen sc1 lds
    s_add_u32 m0, m0, 1024
    s_add_u32 s39, s39, 229376
    buffer_load_dwordx4 v2, s[12:15], s39 offen sc1 lds
    s_add_u32 m0, m0, 1024
    s_add_u32 s40, s40, 229376
    buffer_load_dwordx4 v2, s[12:15], s40 offen sc1 lds
    s_add_u32 m0, m0, 1024
    s_add_u32 s39, s39, 229376
    buffer_load_dwordx4 v2, s[12:15], s39 offen sc1 lds
    s_add_u32 m0, m0, 1024
    s_add_u32 s40, s40, 229376
    buffer_load_dwordx4 v2, s[12:15], s40 offen sc1 lds
    s_mov_b32 m0, s19
    s_mov_b32 s39, s16
    s_mov_b32 s40, s17
    s_waitcnt vmcnt(9)
    s_barrier
    s_mov_b64 exec, 1
    buffer_atomic_add v13, v10, s[56:59], s51 offen sc1
    s_mov_b64 exec, -1
    buffer_load_dwordx4 v2, s[12:15], s39 offen sc1 lds
    s_add_u32 m0, m0, 1024
    s_nop 0
    buffer_load_dwordx4 v2, s[12:15], s40 offen sc1 lds
    s_call_b64 s[76:77], PREP_a_issue_4
    s_add_u32 m0, m0, 1024
    s_add_u32 s39, s39, 229376
    buffer_load_dwordx4 v2, s[12:15], s39 offen sc1 lds
    s_add_u32 m0, m0, 1024
    s_add_u32 s40, s40, 229376
    buffer_load_dwordx4 v2, s[12:15], s40 offen sc1 lds
    s_add_u32 m0, m0, 1024
    s_add_u32 s39, s39, 229376
    buffer_load_dwordx4 v2, s[12:15], s39 offen sc1 lds
    s_add_u32 m0, m0, 1024
    s_add_u32 s40, s40, 229376
    buffer_load_dwordx4 v2, s[12:15], s40 offen sc1 lds
    s_add_u32 m0, m0, 1024
    s_add_u32 s39, s39, 229376
    buffer_load_dwordx4 v2, s[12:15], s39 offen sc1 lds
    s_add_u32 m0, m0, 1024
    s_add_u32 s40, s40, 229376
    buffer_load_dwordx4 v2, s[12:15], s40 offen sc1 lds
    s_mov_b32 m0, s19
    s_mov_b32 s39, s16
    s_mov_b32 s40, s17
    s_waitcnt vmcnt(9)
    s_barrier
    buffer_load_dwordx4 v2, s[12:15], s39 offen sc1 lds
    s_add_u32 m0, m0, 1024
    s_nop 0
    buffer_load_dwordx4 v2, s[12:15], s40 offen sc1 lds
    s_call_b64 s[76:77], PREP_a_issue_4
    s_add_u32 m0, m0, 1024
    s_add_u32 s39, s39, 229376
    buffer_load_dwordx4 v2, s[12:15], s39 offen sc1 lds
    s_add_u32 m0, m0, 1024
    s_add_u32 s40, s40, 229376
    buffer_load_dwordx4 v2, s[12:15], s40 offen sc1 lds
    s_add_u32 m0, m0, 1024
    s_add_u32 s39, s39, 229376
    buffer_load_dwordx4 v2, s[12:15], s39 offen sc1 lds
    s_add_u32 m0, m0, 1024
    s_add_u32 s40, s40, 229376
    buffer_load_dwordx4 v2, s[12:15], s40 offen sc1 lds
    s_add_u32 m0, m0, 1024
    s_add_u32 s39, s39, 229376
    buffer_load_dwordx4 v2, s[12:15], s39 offen sc1 lds
    s_add_u32 m0, m0, 1024
    s_add_u32 s40, s40, 229376
    buffer_load_dwordx4 v2, s[12:15], s40 offen sc1 lds
    s_mov_b32 m0, s19
    s_mov_b32 s39, s16
    s_mov_b32 s40, s17
    s_waitcnt vmcnt(8)
    s_barrier
    buffer_load_dwordx4 v2, s[12:15], s39 offen sc1 lds
    s_add_u32 m0, m0, 1024
    s_nop 0
    buffer_load_dwordx4 v2, s[12:15], s40 offen sc1 lds
    s_mov_b64 exec, 1
    buffer_load_dword v11, v10, s[56:59], 0 offen sc1
    s_mov_b64 exec, -1
    s_call_b64 s[76:77], PREP_a_issue_4
    s_add_u32 m0, m0, 1024
    s_add_u32 s39, s39, 229376
    buffer_load_dwordx4 v2, s[12:15], s39 offen sc1 lds
    s_add_u32 m0, m0, 1024
    s_add_u32 s40, s40, 229376
    buffer_load_dwordx4 v2, s[12:15], s40 offen sc1 lds
    s_add_u32 m0, m0, 1024
    s_add_u32 s39, s39, 229376
    buffer_load_dwordx4 v2, s[12:15], s39 offen sc1 lds
    s_add_u32 m0, m0, 1024
    s_add_u32 s40, s40, 229376
    buffer_load_dwordx4 v2, s[12:15], s40 offen sc1 lds
    s_add_u32 m0, m0, 1024
    s_add_u32 s39, s39, 229376
    buffer_load_dwordx4 v2, s[12:15], s39 offen sc1 lds
    s_add_u32 m0, m0, 1024
    s_add_u32 s40, s40, 229376
    buffer_load_dwordx4 v2, s[12:15], s40 offen sc1 lds
    s_mov_b32 m0, s19
    s_mov_b32 s39, s16
    s_mov_b32 s40, s17
    s_waitcnt vmcnt(9)
    s_barrier
    s_mov_b64 exec, 1
    buffer_atomic_add v13, v12, s[56:59], s51 offen sc1
    s_mov_b64 exec, -1
    buffer_load_dwordx4 v2, s[12:15], s39 offen sc1 lds
    s_add_u32 m0, m0, 1024
    s_nop 0
    buffer_load_dwordx4 v2, s[12:15], s40 offen sc1 lds
    s_call_b64 s[76:77], PREP_a_issue_4
    s_add_u32 m0, m0, 1024
    s_add_u32 s39, s39, 229376
    buffer_load_dwordx4 v2, s[12:15], s39 offen sc1 lds
    s_add_u32 m0, m0, 1024
    s_add_u32 s40, s40, 229376
    buffer_load_dwordx4 v2, s[12:15], s40 offen sc1 lds
    s_add_u32 m0, m0, 1024
    s_add_u32 s39, s39, 229376
    buffer_load_dwordx4 v2, s[12:15], s39 offen sc1 lds
    s_add_u32 m0, m0, 1024
    s_add_u32 s40, s40, 229376
    buffer_load_dwordx4 v2, s[12:15], s40 offen sc1 lds
    s_add_u32 m0, m0, 1024
    s_add_u32 s39, s39, 229376
    buffer_load_dwordx4 v2, s[12:15], s39 offen sc1 lds
    s_add_u32 m0, m0, 1024
    s_add_u32 s40, s40, 229376
    buffer_load_dwordx4 v2, s[12:15], s40 offen sc1 lds
    s_mov_b32 m0, s19
    s_mov_b32 s39, s16
    s_mov_b32 s40, s17
    s_waitcnt vmcnt(9)
    s_barrier
    buffer_load_dwordx4 v2, s[12:15], s39 offen sc1 lds
    s_add_u32 m0, m0, 1024
    s_nop 0
    buffer_load_dwordx4 v2, s[12:15], s40 offen sc1 lds
    s_waitcnt vmcnt(17)
    v_readfirstlane_b32 s53, v11
    s_add_u32 s54, s52, 8
    s_cmp_eq_u32 s53, s54
    s_cbranch_scc1 fok_62
    s_mov_b32 s53, 0
    s_add_u32 s54, s52, 8
    s_bfm_b64 exec, 1, 0
poll_63:
    buffer_load_dword v11, v10, s[56:59], 0 offen sc1
    s_waitcnt vmcnt(0)
    v_xor_b32 v11, s54, v11
    v_cmp_eq_u32 vcc, 0, v11
    s_nop 0
    s_cmp_eq_u64 vcc, exec
    s_cbranch_scc1 pok_64
    s_sleep 5
    s_add_u32 s53, s53, 1
    s_cmp_lt_u32 s53, s61
    s_cbranch_scc1 poll_63
    s_mov_b32 s61, 0
pok_64:
    s_mov_b64 exec, -1
fok_62:
    s_call_b64 s[76:77], PREP_a_issue_4
    s_add_u32 m0, m0, 1024
    s_add_u32 s39, s39, 229376
    buffer_load_dwordx4 v2, s[12:15], s39 offen sc1 lds
    s_add_u32 m0, m0, 1024
    s_add_u32 s40, s40, 229376
    buffer_load_dwordx4 v2, s[12:15], s40 offen sc1 lds
    s_add_u32 m0, m0, 1024
    s_add_u32 s39, s39, 229376
    buffer_load_dwordx4 v2, s[12:15], s39 offen sc1 lds
    s_add_u32 m0, m0, 1024
    s_add_u32 s40, s40, 229376
    buffer_load_dwordx4 v2, s[12:15], s40 offen sc1 lds
    s_add_u32 m0, m0, 1024
    s_add_u32 s39, s39, 229376
    buffer_load_dwordx4 v2, s[12:15], s39 offen sc1 lds
    s_add_u32 m0, m0, 1024
    s_add_u32 s40, s40, 229376
    buffer_load_dwordx4 v2, s[12:15], s40 offen sc1 lds
    s_mov_b32 m0, s19
    s_mov_b32 s39, s16
    s_mov_b32 s40, s17
    s_waitcnt vmcnt(8)
    s_barrier
    buffer_load_dwordx4 v2, s[12:15], s39 offen sc1 lds
    s_add_u32 m0, m0, 1024
    s_nop 0
    buffer_load_dwordx4 v2, s[12:15], s40 offen sc1 lds
    s_mov_b32 s43, 1
ld_65:
    s_add_u32 s19, s41, s42
    v_readlane_b32 s16, v249, s44
    v_readlane_b32 s17, v250, s44
    s_add_u32 s16, s16, s38
    s_add_u32 s17, s17, s38
    s_add_u32 s44, s44, 1
    s_add_u32 s42, s42, 16384
    s_cmp_eq_u32 s42, 49152
    s_cselect_b32 s42, 0, s42
    s_add_u32 m0, m0, 1024
    s_add_u32 s39, s39, 229376
    buffer_load_dwordx4 v2, s[12:15], s39 offen sc1 lds
    s_add_u32 m0, m0, 1024
    s_add_u32 s40, s40, 229376
    buffer_load_dwordx4 v2, s[12:15], s40 offen sc1 lds
    s_add_u32 m0, m0, 1024
    s_add_u32 s39, s39, 229376
    buffer_load_dwordx4 v2, s[12:15], s39 offen sc1 lds
    s_add_u32 m0, m0, 1024
    s_add_u32 s40, s40, 229376
    buffer_load_dwordx4 v2, s[12:15], s40 offen sc1 lds
    s_add_u32 m0, m0, 1024
    s_add_u32 s39, s39, 229376
    buffer_load_dwordx4 v2, s[12:15], s39 offen sc1 lds
    s_add_u32 m0, m0, 1024
    s_add_u32 s40, s40, 229376
    buffer_load_dwordx4 v2, s[12:15], s40 offen sc1 lds
    s_mov_b32 m0, s19
    s_mov_b32 s39, s16
    s_mov_b32 s40, s17
    s_waitcnt vmcnt(8)
    s_barrier
    buffer_load_dwordx4 v2, s[12:15], s39 offen sc1 lds
    s_add_u32 m0, m0, 1024
    s_nop 0
    buffer_load_dwordx4 v2, s[12:15], s40 offen sc1 lds
    s_add_u32 s43, s43, 1
    s_cmp_lt_u32 s43, 4
    s_cbranch_scc1 ld_65
    s_call_b64 s[76:77], PREP_a_issue_4
    s_add_u32 m0, m0, 1024
    s_add_u32 s39, s39, 229376
    buffer_load_dwordx4 v2, s[12:15], s39 offen sc1 lds
    s_add_u32 m0, m0, 1024
    s_add_u32 s40, s40, 229376
    buffer_load_dwordx4 v2, s[12:15], s40 offen sc1 lds
    s_add_u32 m0, m0, 1024
    s_add_u32 s39, s39, 229376
    buffer_load_dwordx4 v2, s[12:15], s39 offen sc1 lds
    s_add_u32 m0, m0, 1024
    s_add_u32 s40, s40, 229376
    buffer_load_dwordx4 v2, s[12:15], s40 offen sc1 lds
    s_add_u32 m0, m0, 1024
    s_add_u32 s39, s39, 229376
    buffer_load_dwordx4 v2, s[12:15], s39 offen sc1 lds
    s_add_u32 m0, m0, 1024
    s_add_u32 s40, s40, 229376
    buffer_load_dwordx4 v2, s[12:15], s40 offen sc1 lds
    s_mov_b32 m0, s19
    s_mov_b32 s39, s16
    s_mov_b32 s40, s17
    s_waitcnt vmcnt(8)
    s_barrier
    buffer_load_dwordx4 v2, s[12:15], s39 offen sc1 lds
    s_add_u32 m0, m0, 1024
    s_nop 0
    buffer_load_dwordx4 v2, s[12:15], s40 offen sc1 lds
    s_mov_b64 exec, 1
    buffer_load_dword v11, v12, s[56:59], 0 offen sc1
    s_mov_b64 exec, -1
    s_call_b64 s[76:77], PREP_a_issue_4
    s_add_u32 m0, m0, 1024
    s_add_u32 s39, s39, 229376
    buffer_load_dwordx4 v2, s[12:15], s39 offen sc1 lds
    s_add_u32 m0, m0, 1024
    s_add_u32 s40, s40, 229376
    buffer_load_dwordx4 v2, s[12:15], s40 offen sc1 lds
    s_add_u32 m0, m0, 1024
    s_add_u32 s39, s39, 229376
    buffer_load_dwordx4 v2, s[12:15], s39 offen sc1 lds
    s_add_u32 m0, m0, 1024
    s_add_u32 s40, s40, 229376
    buffer_load_dwordx4 v2, s[12:15], s40 offen sc1 lds
    s_add_u32 m0, m0, 1024
    s_add_u32 s39, s39, 229376
    buffer_load_dwordx4 v2, s[12:15], s39 offen sc1 lds
    s_add_u32 m0, m0, 1024
    s_add_u32 s40, s40, 229376
    buffer_load_dwordx4 v2, s[12:15], s40 offen sc1 lds
    s_mov_b32 m0, s19
    s_mov_b32 s39, s16
    s_mov_b32 s40, s17
    s_waitcnt vmcnt(9)
    s_barrier
    buffer_load_dwordx4 v2, s[12:15], s39 offen sc1 lds
    s_add_u32 m0, m0, 1024
    s_nop 0
    buffer_load_dwordx4 v2, s[12:15], s40 offen sc1 lds
    s_call_b64 s[76:77], PREP_a_issue_4
    s_add_u32 m0, m0, 1024
    s_add_u32 s39, s39, 229376
    buffer_load_dwordx4 v2, s[12:15], s39 offen sc1 lds
    s_add_u32 m0, m0, 1024
    s_add_u32 s40, s40, 229376
    buffer_load_dwordx4 v2, s[12:15], s40 offen sc1 lds
    s_add_u32 m0, m0, 1024
    s_add_u32 s39, s39, 229376
    buffer_load_dwordx4 v2, s[12:15], s39 offen sc1 lds
    s_add_u32 m0, m0, 1024
    s_add_u32 s40, s40, 229376
    buffer_load_dwordx4 v2, s[12:15], s40 offen sc1 lds
    s_add_u32 m0, m0, 1024
    s_add_u32 s39, s39, 229376
    buffer_load_dwordx4 v2, s[12:15], s39 offen sc1 lds
    s_add_u32 m0, m0, 1024
    s_add_u32 s40, s40, 229376
    buffer_load_dwordx4 v2, s[12:15], s40 offen sc1 lds
    s_mov_b32 m0, s19
    s_mov_b32 s39, s16
    s_mov_b32 s40, s17
    s_waitcnt vmcnt(8)
    s_barrier
    buffer_load_dwordx4 v2, s[12:15], s39 offen sc1 lds
    s_add_u32 m0, m0, 1024
    s_nop 0
    buffer_load_dwordx4 v2, s[12:15], s40 offen sc1 lds
    s_waitcnt vmcnt(16)
    v_readfirstlane_b32 s53, v11
    s_add_u32 s54, s52, 8
    s_cmp_eq_u32 s53, s54
    s_cbranch_scc1 fok_66
    s_mov_b32 s53, 0
    s_add_u32 s54, s52, 8
    s_bfm_b64 exec, 1, 0
poll_67:
    buffer_load_dword v11, v12, s[56:59], 0 offen sc1
    s_waitcnt vmcnt(0)
    v_xor_b32 v11, s54, v11
    v_cmp_eq_u32 vcc, 0, v11
    s_nop 0
    s_cmp_eq_u64 vcc, exec
    s_cbranch_scc1 pok_68
    s_sleep 5
    s_add_u32 s53, s53, 1
    s_cmp_lt_u32 s53, s61
    s_cbranch_scc1 poll_67
    s_mov_b32 s61, 0
pok_68:
    s_mov_b64 exec, -1
fok_66:
    s_call_b64 s[76:77], PREP_a_issue_4
    s_add_u32 m0, m0, 1024
    s_add_u32 s39, s39, 229376
    buffer_load_dwordx4 v2, s[12:15], s39 offen sc1 lds
    s_add_u32 m0, m0, 1024
    s_add_u32 s40, s40, 229376
    buffer_load_dwordx4 v2, s[12:15], s40 offen sc1 lds
    s_add_u32 m0, m0, 1024
    s_add_u32 s39, s39, 229376
    buffer_load_dwordx4 v2, s[12:15], s39 offen sc1 lds
    s_add_u32 m0, m0, 1024
    s_add_u32 s40, s40, 229376
    buffer_load_dwordx4 v2, s[12:15], s40 offen sc1 lds
    s_add_u32 m0, m0, 1024
    s_add_u32 s39, s39, 229376
    buffer_load_dwordx4 v2, s[12:15], s39 offen sc1 lds
    s_add_u32 m0, m0, 1024
    s_add_u32 s40, s40, 229376
    buffer_load_dwordx4 v2, s[12:15], s40 offen sc1 lds
    s_mov_b32 m0, s19
    s_mov_b32 s39, s16
    s_mov_b32 s40, s17
    s_waitcnt vmcnt(8)
    s_barrier
    buffer_load_dwordx4 v2, s[12:15], s39 offen sc1 lds
    s_add_u32 m0, m0, 1024
    s_nop 0
    buffer_load_dwordx4 v2, s[12:15], s40 offen sc1 lds
    s_mov_b32 s43, 1
ld_69:
    s_add_u32 s19, s41, s42
    v_readlane_b32 s16, v249, s44
    v_readlane_b32 s17, v250, s44
    s_add_u32 s16, s16, s38
    s_add_u32 s17, s17, s38
    s_add_u32 s44, s44, 1
    s_add_u32 s42, s42, 16384
    s_cmp_eq_u32 s42, 49152
    s_cselect_b32 s42, 0, s42
    s_add_u32 m0, m0, 1024
    s_add_u32 s39, s39, 229376
    buffer_load_dwordx4 v2, s[12:15], s39 offen sc1 lds
    s_add_u32 m0, m0, 1024
    s_add_u32 s40, s40, 229376
    buffer_load_dwordx4 v2, s[12:15], s40 offen sc1 lds
    s_add_u32 m0, m0, 1024
    s_add_u32 s39, s39, 229376
    buffer_load_dwordx4 v2, s[12:15], s39 offen sc1 lds
    s_add_u32 m0, m0, 1024
    s_add_u32 s40, s40, 229376
    buffer_load_dwordx4 v2, s[12:15], s40 offen sc1 lds
    s_add_u32 m0, m0, 1024
    s_add_u32 s39, s39, 229376
    buffer_load_dwordx4 v2, s[12:15], s39 offen sc1 lds
    s_add_u32 m0, m0, 1024
    s_add_u32 s40, s40, 229376
    buffer_load_dwordx4 v2, s[12:15], s40 offen sc1 lds
    s_mov_b32 m0, s19
    s_mov_b32 s39, s16
    s_mov_b32 s40, s17
    s_waitcnt vmcnt(8)
    s_barrier
    buffer_load_dwordx4 v2, s[12:15], s39 offen sc1 lds
    s_add_u32 m0, m0, 1024
    s_nop 0
    buffer_load_dwordx4 v2, s[12:15], s40 offen sc1 lds
    s_add_u32 s43, s43, 1
    s_cmp_lt_u32 s43, 5
    s_cbranch_scc1 ld_69
    s_call_b64 s[76:77], PREP_a_issue_4
    s_add_u32 m0, m0, 1024
    s_add_u32 s39, s39, 229376
    buffer_load_dwordx4 v2, s[12:15], s39 offen sc1 lds
    s_add_u32 m0, m0, 1024
    s_add_u32 s40, s40, 229376
    buffer_load_dwordx4 v2, s[12:15], s40 offen sc1 lds
    s_add_u32 m0, m0, 1024
    s_add_u32 s39, s39, 229376
    buffer_load_dwordx4 v2, s[12:15], s39 offen sc1 lds
    s_add_u32 m0, m0, 1024
    s_add_u32 s40, s40, 229376
    buffer_load_dwordx4 v2, s[12:15], s40 offen sc1 lds
    s_add_u32 m0, m0, 1024
    s_add_u32 s39, s39, 229376
    buffer_load_dwordx4 v2, s[12:15], s39 offen sc1 lds
    s_add_u32 m0, m0, 1024
    s_add_u32 s40, s40, 229376
    buffer_load_dwordx4 v2, s[12:15], s40 offen sc1 lds
    s_mov_b32 m0, s19
    s_mov_b32 s39, s16
    s_mov_b32 s40, s17
    s_waitcnt vmcnt(8)
    s_barrier
    buffer_load_dwordx4 v2, s[12:15], s39 offen sc1 lds
    s_add_u32 m0, m0, 1024
    s_nop 0
    buffer_load_dwordx4 v2, s[12:15], s40 offen sc1 lds
    s_mov_b64 exec, 1
    buffer_load_dword v11, v15, s[56:59], 0 offen sc1
    s_mov_b64 exec, -1
    s_call_b64 s[76:77], PREP_a_issue_4
    s_add_u32 m0, m0, 1024
    s_add_u32 s39, s39, 229376
    buffer_load_dwordx4 v2, s[12:15], s39 offen sc1 lds
    s_add_u32 m0, m0, 1024
    s_add_u32 s40, s40, 229376
    buffer_load_dwordx4 v2, s[12:15], s40 offen sc1 lds
    s_add_u32 m0, m0, 1024
    s_add_u32 s39, s39, 229376
    buffer_load_dwordx4 v2, s[12:15], s39 offen sc1 lds
    s_add_u32 m0, m0, 1024
    s_add_u32 s40, s40, 229376
    buffer_load_dwordx4 v2, s[12:15], s40 offen sc1 lds
    s_add_u32 m0, m0, 1024
    s_add_u32 s39, s39, 229376
    buffer_load_dwordx4 v2, s[12:15], s39 offen sc1 lds
    s_add_u32 m0, m0, 1024
    s_add_u32 s40, s40, 229376
    buffer_load_dwordx4 v2, s[12:15], s40 offen sc1 lds
    s_mov_b32 m0, s19
    s_mov_b32 s39, s16
    s_mov_b32 s40, s17
    s_waitcnt vmcnt(9)
    s_barrier
    buffer_load_dwordx4 v2, s[12:15], s39 offen sc1 lds
    s_add_u32 m0, m0, 1024
    s_nop 0
    buffer_load_dwordx4 v2, s[12:15], s40 offen sc1 lds
    s_call_b64 s[76:77], PREP_a_issue_4
    s_add_u32 m0, m0, 1024
    s_add_u32 s39, s39, 229376
    buffer_load_dwordx4 v2, s[12:15], s39 offen sc1 lds
    s_add_u32 m0, m0, 1024
    s_add_u32 s40, s40, 229376
    buffer_load_dwordx4 v2, s[12:15], s40 offen sc1 lds
    s_add_u32 m0, m0, 1024
    s_add_u32 s39, s39, 229376
    buffer_load_dwordx4 v2, s[12:15], s39 offen sc1 lds
    s_add_u32 m0, m0, 1024
    s_add_u32 s40, s40, 229376
    buffer_load_dwordx4 v2, s[12:15], s40 offen sc1 lds
    s_add_u32 m0, m0, 1024
    s_add_u32 s39, s39, 229376
    buffer_load_dwordx4 v2, s[12:15], s39 offen sc1 lds
    s_add_u32 m0, m0, 1024
    s_add_u32 s40, s40, 229376
    buffer_load_dwordx4 v2, s[12:15], s40 offen sc1 lds
    s_mov_b32 m0, s19
    s_mov_b32 s39, s16
    s_mov_b32 s40, s17
    s_waitcnt vmcnt(8)
    s_barrier
    buffer_load_dwordx4 v2, s[12:15], s39 offen sc1 lds
    s_add_u32 m0, m0, 1024
    s_nop 0
    buffer_load_dwordx4 v2, s[12:15], s40 offen sc1 lds
    s_waitcnt vmcnt(16)
    v_readfirstlane_b32 s53, v11
    s_add_u32 s54, s52, 8
    s_cmp_eq_u32 s53, s54
    s_cbranch_scc1 fok_70
    s_mov_b32 s53, 0
    s_add_u32 s54, s52, 8
    s_bfm_b64 exec, 1, 0
poll_71:
    buffer_load_dword v11, v15, s[56:59], 0 offen sc1
    s_waitcnt vmcnt(0)
    v_xor_b32 v11, s54, v11
    v_cmp_eq_u32 vcc, 0, v11
    s_nop 0
    s_cmp_eq_u64 vcc, exec
    s_cbranch_scc1 pok_72
    s_sleep 5
    s_add_u32 s53, s53, 1
    s_cmp_lt_u32 s53, s61
    s_cbranch_scc1 poll_71
    s_mov_b32 s61, 0
pok_72:
    s_mov_b64 exec, -1
fok_70:
    s_call_b64 s[76:77], PREP_a_issue_4
    s_add_u32 m0, m0, 1024
    s_add_u32 s39, s39, 229376
    buffer_load_dwordx4 v2, s[12:15], s39 offen sc1 lds
    s_add_u32 m0, m0, 1024
    s_add_u32 s40, s40, 229376
    buffer_load_dwordx4 v2, s[12:15], s40 offen sc1 lds
    s_add_u32 m0, m0, 1024
    s_add_u32 s39, s39, 229376
    buffer_load_dwordx4 v2, s[12:15], s39 offen sc1 lds
    s_add_u32 m0, m0, 1024
    s_add_u32 s40, s40, 229376
    buffer_load_dwordx4 v2, s[12:15], s40 offen sc1 lds
    s_add_u32 m0, m0, 1024
    s_add_u32 s39, s39, 229376
    buffer_load_dwordx4 v2, s[12:15], s39 offen sc1 lds
    s_add_u32 m0, m0, 1024
    s_add_u32 s40, s40, 229376
    buffer_load_dwordx4 v2, s[12:15], s40 offen sc1 lds
    s_mov_b32 m0, s19
    s_mov_b32 s39, s16
    s_mov_b32 s40, s17
    s_waitcnt vmcnt(8)
    s_barrier
    buffer_load_dwordx4 v2, s[12:15], s39 offen sc1 lds
    s_add_u32 m0, m0, 1024
    s_nop 0
    buffer_load_dwordx4 v2, s[12:15], s40 offen sc1 lds
    s_mov_b32 s43, 1
ld_73:
    s_add_u32 s19, s41, s42
    v_readlane_b32 s16, v249, s44
    v_readlane_b32 s17, v250, s44
    s_add_u32 s16, s16, s38
    s_add_u32 s17, s17, s38
    s_add_u32 s44, s44, 1
    s_add_u32 s42, s42, 16384
    s_cmp_eq_u32 s42, 49152
    s_cselect_b32 s42, 0, s42
    s_add_u32 m0, m0, 1024
    s_add_u32 s39, s39, 229376
    buffer_load_dwordx4 v2, s[12:15], s39 offen sc1 lds
    s_add_u32 m0, m0, 1024
    s_add_u32 s40, s40, 229376
    buffer_load_dwordx4 v2, s[12:15], s40 offen sc1 lds
    s_add_u32 m0, m0, 1024
    s_add_u32 s39, s39, 229376
    buffer_load_dwordx4 v2, s[12:15], s39 offen sc1 lds
    s_add_u32 m0, m0, 1024
    s_add_u32 s40, s40, 229376
    buffer_load_dwordx4 v2, s[12:15], s40 offen sc1 lds
    s_add_u32 m0, m0, 1024
    s_add_u32 s39, s39, 229376
    buffer_load_dwordx4 v2, s[12:15], s39 offen sc1 lds
    s_add_u32 m0, m0, 1024
    s_add_u32 s40, s40, 229376
    buffer_load_dwordx4 v2, s[12:15], s40 offen sc1 lds
    s_mov_b32 m0, s19
    s_mov_b32 s39, s16
    s_mov_b32 s40, s17
    s_waitcnt vmcnt(8)
    s_barrier
    buffer_load_dwordx4 v2, s[12:15], s39 offen sc1 lds
    s_add_u32 m0, m0, 1024
    s_nop 0
    buffer_load_dwordx4 v2, s[12:15], s40 offen sc1 lds
    s_add_u32 s43, s43, 1
    s_cmp_lt_u32 s43, 3
    s_cbranch_scc1 ld_73
    s_call_b64 s[76:77], PREP_a_issue_4
    s_add_u32 m0, m0, 1024
    s_add_u32 s39, s39, 229376
    buffer_load_dwordx4 v2, s[12:15], s39 offen sc1 lds
    s_add_u32 m0, m0, 1024
    s_add_u32 s40, s40, 229376
    buffer_load_dwordx4 v2, s[12:15], s40 offen sc1 lds
    s_add_u32 m0, m0, 1024
    s_add_u32 s39, s39, 229376
    buffer_load_dwordx4 v2, s[12:15], s39 offen sc1 lds
    s_add_u32 m0, m0, 1024
    s_add_u32 s40, s40, 229376
    buffer_load_dwordx4 v2, s[12:15], s40 offen sc1 lds
    s_add_u32 m0, m0, 1024
    s_add_u32 s39, s39, 229376
    buffer_load_dwordx4 v2, s[12:15], s39 offen sc1 lds
    s_add_u32 m0, m0, 1024
    s_add_u32 s40, s40, 229376
    buffer_load_dwordx4 v2, s[12:15], s40 offen sc1 lds
    s_mov_b32 m0, s19
    s_mov_b32 s39, s16
    s_mov_b32 s40, s17
    s_waitcnt vmcnt(8)
    s_barrier
    buffer_load_dwordx4 v2, s[12:15], s39 offen sc1 lds
    s_add_u32 m0, m0, 1024
    s_nop 0
    buffer_load_dwordx4 v2, s[12:15], s40 offen sc1 lds
    s_add_u32 m0, m0, 1024
    s_add_u32 s39, s39, 229376
    buffer_load_dwordx4 v2, s[12:15], s39 offen sc1 lds
    s_add_u32 m0, m0, 1024
    s_add_u32 s40, s40, 229376
    buffer_load_dwordx4 v2, s[12:15], s40 offen sc1 lds
    s_add_u32 m0, m0, 1024
    s_add_u32 s39, s39, 229376
    buffer_load_dwordx4 v2, s[12:15], s39 offen sc1 lds
    s_add_u32 m0, m0, 1024
    s_add_u32 s40, s40, 229376
    buffer_load_dwordx4 v2, s[12:15], s40 offen sc1 lds
    s_add_u32 m0, m0, 1024
    s_add_u32 s39, s39, 229376
    buffer_load_dwordx4 v2, s[12:15], s39 offen sc1 lds
    s_add_u32 m0, m0, 1024
    s_add_u32 s40, s40, 229376
    buffer_load_dwordx4 v2, s[12:15], s40 offen sc1 lds
    s_waitcnt vmcnt(8)
    s_barrier
    s_waitcnt vmcnt(0)
    s_barrier
    s_cmp_eq_u32 s60, 1
    s_cbranch_scc1 K_fin
    s_barrier
    s_branch NEXT
WLOAD:
    s_cmp_eq_u32 s60, 1
    s_cbranch_scc1 WL_1
    s_mov_b64 s[12:13], s[68:69]
    s_mov_b32 s14, 2097152
    s_mov_b32 s15, 0x20000
    s_and_b32 s35, s30, 1
    s_mul_i32 s38, s99, 128
    s_mul_i32 s41, s35, 65536
    s_add_u32 s38, s38, s41
    s_mul_i32 s41, s35, 4096
    s_add_u32 s41, s41, 24576
    s_mov_b32 s42, 0
    s_mov_b32 s44, s67
    s_branch WL_2
WL_1:
    s_mov_b64 s[12:13], s[68:69]
    s_mov_b32 s14, 2097152
    s_mov_b32 s15, 0x20000
    s_and_b32 s35, s30, 1
    s_mul_i32 s38, s99, 128
    s_mul_i32 s41, s35, 65536
    s_add_u32 s38, s38, s41
    s_mul_i32 s41, s35, 4096
    s_add_u32 s41, s41, 24576
    s_mov_b32 s42, 0
    s_mov_b32 s44, s67
WL_2:
    s_waitcnt vmcnt(0)
    s_barrier
    s_call_b64 s[76:77], SUB_after_g1
    s_barrier
    s_waitcnt vmcnt(0)
    s_barrier
    s_call_b64 s[76:77], SUB_after_g2
    s_mov_b64 s[12:13], s[72:73]
    s_mov_b32 s14, 7340032
    s_mov_b32 s15, 0x20000
    s_and_b32 s35, s30, 1
    s_mul_i32 s38, s29, 448
    s_mul_i32 s41, s35, 229376
    s_add_u32 s38, s38, s41
    s_mul_i32 s41, s35, 14336
    s_add_u32 s41, s41, 73728
    s_mov_b32 s42, 0
    s_mov_b32 s44, 0
    s_mov_b32 s42, 28672
    s_mov_b32 s44, 2
    s_add_u32 s19, s41, s42
    v_readlane_b32 s16, v248, s44
    s_nop 0
    s_add_u32 s16, s16, s38
    s_add_u32 s44, s44, 1
    s_and_b32 s44, s44, 15
    s_add_u32 s42, s42, 28672
    s_cmp_eq_u32 s42, 86016
    s_cselect_b32 s42, 0, s42
    s_mov_b32 m0, s19
    s_mov_b32 s39, s16
    s_waitcnt vmcnt(63)
    s_barrier
    buffer_load_dwordx4 v241, s[12:15], s39 offen lds
    s_add_u32 m0, m0, 1024
    s_nop 0
    buffer_load_dwordx4 v242, s[12:15], s39 offen lds
    s_add_u32 m0, m0, 1024
    s_nop 0
    buffer_load_dwordx4 v243, s[12:15], s39 offen lds
    s_mov_b32 s43, 1
ld_74:
    s_add_u32 s19, s41, s42
    v_readlane_b32 s16, v248, s44
    s_nop 0
    s_add_u32 s16, s16, s38
    s_add_u32 s44, s44, 1
    s_and_b32 s44, s44, 15
    s_add_u32 s42, s42, 28672
    s_cmp_eq_u32 s42, 86016
    s_cselect_b32 s42, 0, s42
    s_add_u32 m0, m0, 1024
    s_nop 0
    buffer_load_dwordx4 v244, s[12:15], s39 offen lds
    s_add_u32 m0, m0, 1024
    s_nop 0
    buffer_load_dwordx4 v245, s[12:15], s39 offen lds
    s_add_u32 m0, m0, 1024
    s_nop 0
    buffer_load_dwordx4 v246, s[12:15], s39 offen lds
    s_add_u32 m0, m0, 1024
    s_nop 0
    buffer_load_dwordx4 v247, s[12:15], s39 offen lds
    s_add_u32 m0, m0, 1024
    s_add_u32 s39, s39, 114688
    buffer_load_dwordx4 v241, s[12:15], s39 offen lds
    s_add_u32 m0, m0, 1024
    s_nop 0
    buffer_load_dwordx4 v242, s[12:15], s39 offen lds
    s_add_u32 m0, m0, 1024
    s_nop 0
    buffer_load_dwordx4 v243, s[12:15], s39 offen lds
    s_add_u32 m0, m0, 1024
    s_nop 0
    buffer_load_dwordx4 v244, s[12:15], s39 offen lds
    s_add_u32 m0, m0, 1024
    s_nop 0
    buffer_load_dwordx4 v245, s[12:15], s39 offen lds
    s_add_u32 m0, m0, 1024
    s_nop 0
    buffer_load_dwordx4 v246, s[12:15], s39 offen lds
    s_add_u32 m0, m0, 1024
    s_nop 0
    buffer_load_dwordx4 v247, s[12:15], s39 offen lds
    s_mov_b32 m0, s19
    s_mov_b32 s39, s16
    s_waitcnt vmcnt(14)
    s_barrier
    buffer_load_dwordx4 v241, s[12:15], s39 offen lds
    s_add_u32 m0, m0, 1024
    s_nop 0
    buffer_load_dwordx4 v242, s[12:15], s39 offen lds
    s_add_u32 m0, m0, 1024
    s_nop 0
    buffer_load_dwordx4 v243, s[12:15], s39 offen lds
    s_add_u32 s43, s43, 1
    s_cmp_lt_u32 s43, 13
    s_cbranch_scc1 ld_74
    s_add_u32 s19, s41, s42
    v_readlane_b32 s16, v248, s44
    s_nop 0
    s_add_u32 s16, s16, s38
    s_add_u32 s44, s44, 1
    s_and_b32 s44, s44, 15
    s_add_u32 s42, s42, 28672
    s_cmp_eq_u32 s42, 86016
    s_cselect_b32 s42, 0, s42
    s_add_u32 m0, m0, 1024
    s_nop 0
    buffer_load_dwordx4 v244, s[12:15], s39 offen lds
    s_add_u32 m0, m0, 1024
    s_nop 0
    buffer_load_dwordx4 v245, s[12:15], s39 offen lds
    s_add_u32 m0, m0, 1024
    s_nop 0
    buffer_load_dwordx4 v246, s[12:15], s39 offen lds
    s_add_u32 m0, m0, 1024
    s_nop 0
    buffer_load_dwordx4 v247, s[12:15], s39 offen lds
    s_add_u32 m0, m0, 1024
    s_add_u32 s39, s39, 114688
    buffer_load_dwordx4 v241, s[12:15], s39 offen lds
    s_add_u32 m0, m0, 1024
    s_nop 0
    buffer_load_dwordx4 v242, s[12:15], s39 offen lds
    s_add_u32 m0, m0, 1024
    s_nop 0
    buffer_load_dwordx4 v243, s[12:15], s39 offen lds
    s_add_u32 m0, m0, 1024
    s_nop 0
    buffer_load_dwordx4 v244, s[12:15], s39 offen lds
    s_add_u32 m0, m0, 1024
    s_nop 0
    buffer_load_dwordx4 v245, s[12:15], s39 offen lds
    s_add_u32 m0, m0, 1024
    s_nop 0
    buffer_load_dwordx4 v246, s[12:15], s39 offen lds
    s_add_u32 m0, m0, 1024
    s_nop 0
    buffer_load_dwordx4 v247, s[12:15], s39 offen lds
    s_mov_b32 m0, s19
    s_mov_b32 s39, s16
    s_waitcnt vmcnt(14)
    s_barrier
    buffer_load_dwordx4 v241, s[12:15], s39 offen lds
    s_add_u32 m0, m0, 1024
    s_nop 0
    buffer_load_dwordx4 v242, s[12:15], s39 offen lds
    s_add_u32 m0, m0, 1024
    s_nop 0
    buffer_load_dwordx4 v243, s[12:15], s39 offen lds
    s_add_u32 m0, m0, 1024
    s_nop 0
    buffer_load_dwordx4 v244, s[12:15], s39 offen lds
    s_add_u32 m0, m0, 1024
    s_nop 0
    buffer_load_dwordx4 v245, s[12:15], s39 offen lds
    s_add_u32 m0, m0, 1024
    s_nop 0
    buffer_load_dwordx4 v246, s[12:15], s39 offen lds
    s_add_u32 m0, m0, 1024
    s_nop 0
    buffer_load_dwordx4 v247, s[12:15], s39 offen lds
    s_add_u32 m0, m0, 1024
    s_add_u32 s39, s39, 114688
    buffer_load_dwordx4 v241, s[12:15], s39 offen lds
    s_add_u32 m0, m0, 1024
    s_nop 0
    buffer_load_dwordx4 v242, s[12:15], s39 offen lds
    s_add_u32 m0, m0, 1024
    s_nop 0
    buffer_load_dwordx4 v243, s[12:15], s39 offen lds
    s_add_u32 m0, m0, 1024
    s_nop 0
    buffer_load_dwordx4 v244, s[12:15], s39 offen lds
    s_add_u32 m0, m0, 1024
    s_nop 0
    buffer_load_dwordx4 v245, s[12:15], s39 offen lds
    s_add_u32 m0, m0, 1024
    s_nop 0
    buffer_load_dwordx4 v246, s[12:15], s39 offen lds
    s_add_u32 m0, m0, 1024
    s_nop 0
    buffer_load_dwordx4 v247, s[12:15], s39 offen lds
    s_waitcnt vmcnt(14)
    s_barrier
    s_call_b64 s[76:77], SUB_r_pre0
    s_waitcnt vmcnt(4)
    s_barrier
    s_barrier
    s_mov_b64 s[12:13], s[74:75]
    s_mov_b32 s14, 7340032
    s_mov_b32 s15, 0x20000
    s_and_b32 s35, s30, 1
    s_mul_i32 s38, s33, 256
    s_mul_i32 s41, s31, 3670016
    s_add_u32 s38, s38, s41
    s_mul_i32 s41, s35, 8192
    s_add_u32 s41, s41, 49152
    s_mov_b32 s42, 0
    s_mov_b32 s44, 0
    s_mov_b32 s49, s44
    s_and_b32 s43, s28, 3
    s_mul_i32 s43, s43, 6
    s_lshr_b32 s43, s43, 2
    s_mov_b32 s50, 0
wpre_75:
    s_mul_i32 s42, s43, 16384
    s_add_u32 s44, s49, s43
    s_mov_b32 s45, 8192
    s_add_u32 s19, s41, s42
    v_readlane_b32 s16, v249, s44
    s_nop 0
    s_bitcmp1_b32 s16, 0
    s_cselect_b32 s17, 16384, s45
    s_cselect_b32 s18, -40960, s45
    s_andn2_b32 s16, s16, 1
    s_add_u32 s16, s16, s38
    s_add_u32 s44, s44, 1
    s_add_u32 s42, s42, 16384
    s_cmp_eq_u32 s42, 98304
    s_cselect_b32 s42, 0, s42
    s_mov_b32 m0, s19
    s_mov_b32 s39, s16
    s_mov_b32 s32, s17
    s_mov_b32 s3, s18
    buffer_load_dwordx4 v239, s[12:15], s39 offen lds
    s_add_u32 m0, m0, 1024
    s_add_u32 s39, s39, s32
    buffer_load_dwordx4 v240, s[12:15], s39 offen lds
    s_add_u32 m0, m0, 1024
    s_add_u32 s39, s39, s32
    buffer_load_dwordx4 v239, s[12:15], s39 offen lds
    s_add_u32 m0, m0, 1024
    s_add_u32 s39, s39, s32
    buffer_load_dwordx4 v240, s[12:15], s39 offen lds
    s_waitcnt vmcnt(6)
    s_add_u32 m0, m0, 1024
    s_add_u32 s39, s39, s3
    buffer_load_dwordx4 v239, s[12:15], s39 offen lds
    s_add_u32 m0, m0, 1024
    s_add_u32 s39, s39, s32
    buffer_load_dwordx4 v240, s[12:15], s39 offen lds
    s_add_u32 m0, m0, 1024
    s_add_u32 s39, s39, s32
    buffer_load_dwordx4 v239, s[12:15], s39 offen lds
    s_add_u32 m0, m0, 1024
    s_add_u32 s39, s39, s32
    buffer_load_dwordx4 v240, s[12:15], s39 offen lds
    s_waitcnt vmcnt(6)
    s_add_u32 s43, s43, 1
    s_cmp_eq_u32 s43, 6
    s_cselect_b32 s43, 0, s43
    s_add_u32 s50, s50, 1
    s_cmp_lt_u32 s50, 6
    s_cbranch_scc1 wpre_75
    s_mov_b32 s42, 0
    s_add_u32 s44, s49, 6
    s_cmp_eq_u32 s60, 1
    s_cbranch_scc1 WL_t1
    s_call_b64 s[76:77], PREP_w_issue_4
    s_mov_b32 m0, s19
    s_mov_b32 s39, s16
    s_mov_b32 s32, s17
    s_mov_b32 s3, s18
    s_waitcnt vmcnt(0)
    s_barrier
    s_waitcnt vmcnt(0)
    s_barrier
    buffer_load_dwordx4 v239, s[12:15], s39 offen lds
    s_add_u32 m0, m0, 1024
    s_add_u32 s39, s39, s32
    buffer_load_dwordx4 v240, s[12:15], s39 offen lds
    s_call_b64 s[76:77], PREP_w_issue_4
    s_add_u32 m0, m0, 1024
    s_add_u32 s39, s39, s32
    buffer_load_dwordx4 v239, s[12:15], s39 offen lds
    s_add_u32 m0, m0, 1024
    s_add_u32 s39, s39, s32
    buffer_load_dwordx4 v240, s[12:15], s39 offen lds
    s_add_u32 m0, m0, 1024
    s_add_u32 s39, s39, s3
    buffer_load_dwordx4 v239, s[12:15], s39 offen lds
    s_add_u32 m0, m0, 1024
    s_add_u32 s39, s39, s32
    buffer_load_dwordx4 v240, s[12:15], s39 offen lds
    s_add_u32 m0, m0, 1024
    s_add_u32 s39, s39, s32
    buffer_load_dwordx4 v239, s[12:15], s39 offen lds
    s_add_u32 m0, m0, 1024
    s_add_u32 s39, s39, s32
    buffer_load_dwordx4 v240, s[12:15], s39 offen lds
    s_mov_b32 m0, s19
    s_mov_b32 s39, s16
    s_mov_b32 s32, s17
    s_mov_b32 s3, s18
    s_waitcnt vmcnt(8)
    s_barrier
    buffer_load_dwordx4 v239, s[12:15], s39 offen lds
    s_add_u32 m0, m0, 1024
    s_add_u32 s39, s39, s32
    buffer_load_dwordx4 v240, s[12:15], s39 offen lds
    s_call_b64 s[76:77], PREP_w_issue_4
    s_add_u32 m0, m0, 1024
    s_add_u32 s39, s39, s32
    buffer_load_dwordx4 v239, s[12:15], s39 offen lds
    s_add_u32 m0, m0, 1024
    s_add_u32 s39, s39, s32
    buffer_load_dwordx4 v240, s[12:15], s39 offen lds
    s_add_u32 m0, m0, 1024
    s_add_u32 s39, s39, s3
    buffer_load_dwordx4 v239, s[12:15], s39 offen lds
    s_add_u32 m0, m0, 1024
    s_add_u32 s39, s39, s32
    buffer_load_dwordx4 v240, s[12:15], s39 offen lds
    s_add_u32 m0, m0, 1024
    s_add_u32 s39, s39, s32
    buffer_load_dwordx4 v239, s[12:15], s39 offen lds
    s_add_u32 m0, m0, 1024
    s_add_u32 s39, s39, s32
    buffer_load_dwordx4 v240, s[12:15], s39 offen lds
    s_mov_b32 m0, s19
    s_mov_b32 s39, s16
    s_mov_b32 s32, s17
    s_mov_b32 s3, s18
    s_waitcnt vmcnt(16)
    s_barrier
    buffer_load_dwordx4 v239, s[12:15], s39 offen lds
    s_add_u32 m0, m0, 1024
    s_add_u32 s39, s39, s32
    buffer_load_dwordx4 v240, s[12:15], s39 offen lds
    s_call_b64 s[76:77], PREP_w_issue_4
    s_add_u32 m0, m0, 1024
    s_add_u32 s39, s39, s32
    buffer_load_dwordx4 v239, s[12:15], s39 offen lds
    s_add_u32 m0, m0, 1024
    s_add_u32 s39, s39, s32
    buffer_load_dwordx4 v240, s[12:15], s39 offen lds
    s_add_u32 m0, m0, 1024
    s_add_u32 s39, s39, s3
    buffer_load_dwordx4 v239, s[12:15], s39 offen lds
    s_add_u32 m0, m0, 1024
    s_add_u32 s39, s39, s32
    buffer_load_dwordx4 v240, s[12:15], s39 offen lds
    s_add_u32 m0, m0, 1024
    s_add_u32 s39, s39, s32
    buffer_load_dwordx4 v239, s[12:15], s39 offen lds
    s_add_u32 m0, m0, 1024
    s_add_u32 s39, s39, s32
    buffer_load_dwordx4 v240, s[12:15], s39 offen lds
    s_mov_b32 m0, s19
    s_mov_b32 s39, s16
    s_mov_b32 s32, s17
    s_mov_b32 s3, s18
    s_waitcnt vmcnt(24)
    s_barrier
    buffer_load_dwordx4 v239, s[12:15], s39 offen lds
    s_add_u32 m0, m0, 1024
    s_add_u32 s39, s39, s32
    buffer_load_dwordx4 v240, s[12:15], s39 offen lds
    s_mov_b32 s43, 1
ld_76:
    s_mov_b32 s45, 8192
    s_add_u32 s19, s41, s42
    v_readlane_b32 s16, v249, s44
    s_nop 0
    s_bitcmp1_b32 s16, 0
    s_cselect_b32 s17, 16384, s45
    s_cselect_b32 s18, -40960, s45
    s_andn2_b32 s16, s16, 1
    s_add_u32 s16, s16, s38
    s_add_u32 s44, s44, 1
    s_add_u32 s42, s42, 16384
    s_cmp_eq_u32 s42, 98304
    s_cselect_b32 s42, 0, s42
    s_add_u32 m0, m0, 1024
    s_add_u32 s39, s39, s32
    buffer_load_dwordx4 v239, s[12:15], s39 offen lds
    s_add_u32 m0, m0, 1024
    s_add_u32 s39, s39, s32
    buffer_load_dwordx4 v240, s[12:15], s39 offen lds
    s_add_u32 m0, m0, 1024
    s_add_u32 s39, s39, s3
    buffer_load_dwordx4 v239, s[12:15], s39 offen lds
    s_add_u32 m0, m0, 1024
    s_add_u32 s39, s39, s32
    buffer_load_dwordx4 v240, s[12:15], s39 offen lds
    s_add_u32 m0, m0, 1024
    s_add_u32 s39, s39, s32
    buffer_load_dwordx4 v239, s[12:15], s39 offen lds
    s_add_u32 m0, m0, 1024
    s_add_u32 s39, s39, s32
    buffer_load_dwordx4 v240, s[12:15], s39 offen lds
    s_mov_b32 m0, s19
    s_mov_b32 s39, s16
    s_mov_b32 s32, s17
    s_mov_b32 s3, s18
    s_waitcnt vmcnt(32)
    s_barrier
    buffer_load_dwordx4 v239, s[12:15], s39 offen lds
    s_add_u32 m0, m0, 1024
    s_add_u32 s39, s39, s32
    buffer_load_dwordx4 v240, s[12:15], s39 offen lds
    s_add_u32 s43, s43, 1
    s_cmp_lt_u32 s43, 18
    s_cbranch_scc1 ld_76
    s_call_b64 s[76:77], PREP_w_issue_4
    s_add_u32 m0, m0, 1024
    s_add_u32 s39, s39, s32
    buffer_load_dwordx4 v239, s[12:15], s39 offen lds
    s_add_u32 m0, m0, 1024
    s_add_u32 s39, s39, s32
    buffer_load_dwordx4 v240, s[12:15], s39 offen lds
    s_add_u32 m0, m0, 1024
    s_add_u32 s39, s39, s3
    buffer_load_dwordx4 v239, s[12:15], s39 offen lds
    s_add_u32 m0, m0, 1024
    s_add_u32 s39, s39, s32
    buffer_load_dwordx4 v240, s[12:15], s39 offen lds
    s_add_u32 m0, m0, 1024
    s_add_u32 s39, s39, s32
    buffer_load_dwordx4 v239, s[12:15], s39 offen lds
    s_add_u32 m0, m0, 1024
    s_add_u32 s39, s39, s32
    buffer_load_dwordx4 v240, s[12:15], s39 offen lds
    s_mov_b32 m0, s19
    s_mov_b32 s39, s16
    s_mov_b32 s32, s17
    s_mov_b32 s3, s18
    s_waitcnt vmcnt(32)
    s_barrier
    buffer_load_dwordx4 v239, s[12:15], s39 offen lds
    s_add_u32 m0, m0, 1024
    s_add_u32 s39, s39, s32
    buffer_load_dwordx4 v240, s[12:15], s39 offen lds
    s_add_u32 m0, m0, 1024
    s_add_u32 s39, s39, s32
    buffer_load_dwordx4 v239, s[12:15], s39 offen lds
    s_add_u32 m0, m0, 1024
    s_add_u32 s39, s39, s32
    buffer_load_dwordx4 v240, s[12:15], s39 offen lds
    s_add_u32 m0, m0, 1024
    s_add_u32 s39, s39, s3
    buffer_load_dwordx4 v239, s[12:15], s39 offen lds
    s_add_u32 m0, m0, 1024
    s_add_u32 s39, s39, s32
    buffer_load_dwordx4 v240, s[12:15], s39 offen lds
    s_add_u32 m0, m0, 1024
    s_add_u32 s39, s39, s32
    buffer_load_dwordx4 v239, s[12:15], s39 offen lds
    s_add_u32 m0, m0, 1024
    s_add_u32 s39, s39, s32
    buffer_load_dwordx4 v240, s[12:15], s39 offen lds
    s_waitcnt vmcnt(32)
    s_barrier
    s_mov_b64 s[12:13], s[68:69]
    s_mov_b32 s14, 2097152
    s_mov_b32 s15, 0x20000
    s_and_b32 s35, s30, 1
    s_mul_i32 s38, s99, 128
    s_mul_i32 s41, s35, 65536
    s_add_u32 s38, s38, s41
    s_mul_i32 s41, s35, 4096
    s_add_u32 s41, s41, 24576
    s_mov_b32 s42, 0
    s_mov_b32 s44, s67
    s_and_b32 s36, s99, 7
    s_cmp_eq_u32 s36, 3
    s_cselect_b64 s[50:51], 0, -1
    s_mov_b32 s42, 90112
    s_mov_b32 s44, s67
    s_add_u32 s44, s44, 11
    s_and_b32 s44, s44, 15
    s_call_b64 s[76:77], SUB_w_issue_1
    s_mov_b32 s42, 98304
    s_mov_b32 s44, s67
    s_add_u32 s44, s44, 12
    s_and_b32 s44, s44, 15
    s_call_b64 s[76:77], SUB_w_issue_1
    s_mov_b32 s42, 122880
    s_mov_b32 s44, s67
    s_add_u32 s44, s44, 15
    s_and_b32 s44, s44, 15
    s_call_b64 s[76:77], SUB_w_issue_1
    s_add_u32 s39, s38, 1179648
    buffer_load_dwordx4 v[16:19], v238, s[12:15], s39 offen
    s_add_u32 s39, s39, 16384
    buffer_load_dwordx4 v[20:23], v238, s[12:15], s39 offen
    s_add_u32 s39, s39, 16384
    buffer_load_dwordx4 v[24:27], v238, s[12:15], s39 offen
    s_add_u32 s39, s39, 16384
    buffer_load_dwordx4 v[28:31], v238, s[12:15], s39 offen
    s_add_u32 s39, s39, 16384
    s_waitcnt vmcnt(40)
    s_barrier
    s_mov_b32 s42, 106496
    s_mov_b32 s44, s67
    s_add_u32 s44, s44, 13
    s_and_b32 s44, s44, 15
    s_call_b64 s[76:77], SUB_w_issue_1
    s_mov_b32 s42, 114688
    s_mov_b32 s44, s67
    s_add_u32 s44, s44, 14
    s_and_b32 s44, s44, 15
    s_call_b64 s[76:77], SUB_w_issue_1
    s_add_u32 s39, s38, 1310720
    buffer_load_dwordx4 v[32:35], v238, s[12:15], s39 offen
    s_add_u32 s39, s39, 16384
    buffer_load_dwordx4 v[36:39], v238, s[12:15], s39 offen
    s_add_u32 s39, s39, 16384
    buffer_load_dwordx4 v[40:43], v238, s[12:15], s39 offen
    s_add_u32 s39, s39, 16384
    buffer_load_dwordx4 v[44:47], v238, s[12:15], s39 offen
    s_add_u32 s39, s39, 16384
    s_waitcnt vmcnt(44)
    s_barrier
    s_mov_b32 s42, 24576
    s_mov_b32 s44, s67
    s_add_u32 s44, s44, 3
    s_and_b32 s44, s44, 15
    s_call_b64 s[76:77], SUB_w_issue_1
    s_mov_b32 s42, 32768
    s_mov_b32 s44, s67
    s_add_u32 s44, s44, 4
    s_and_b32 s44, s44, 15
    s_call_b64 s[76:77], SUB_w_issue_1
    s_waitcnt vmcnt(44)
    s_barrier
    s_mov_b32 s42, 40960
    s_mov_b32 s44, s67
    s_add_u32 s44, s44, 5
    s_and_b32 s44, s44, 15
    s_call_b64 s[76:77], SUB_w_issue_1
    s_mov_b32 s42, 49152
    s_mov_b32 s44, s67
    s_add_u32 s44, s44, 6
    s_and_b32 s44, s44, 15
    s_call_b64 s[76:77], SUB_w_issue_1
    s_mov_b32 s42, 0
    s_mov_b32 s44, s67
    s_add_u32 s44, s44, 0
    s_and_b32 s44, s44, 15
    s_call_b64 s[76:77], SUB_w_issue_1
    s_waitcnt vmcnt(48)
    s_barrier
    s_mov_b32 s42, 57344
    s_mov_b32 s44, s67
    s_add_u32 s44, s44, 7
    s_and_b32 s44, s44, 15
    s_call_b64 s[76:77], SUB_w_issue_1
    s_mov_b32 s42, 65536
    s_mov_b32 s44, s67
    s_add_u32 s44, s44, 8
    s_and_b32 s44, s44, 15
    s_call_b64 s[76:77], SUB_w_issue_1
    s_mov_b32 s42, 8192
    s_mov_b32 s44, s67
    s_add_u32 s44, s44, 1
    s_and_b32 s44, s44, 15
    s_call_b64 s[76:77], SUB_w_issue_1
    s_mov_b32 s42, 16384
    s_mov_b32 s44, s67
    s_add_u32 s44, s44, 2
    s_and_b32 s44, s44, 15
    s_call_b64 s[76:77], SUB_w_issue_1
    s_barrier
    s_add_u32 s36, s41, 73728
    v_add_u32 v6, s36, v2
    s_waitcnt vmcnt(36)
    ds_write_b128 v6, v[16:19] offset:0
    ds_write_b128 v6, v[20:23] offset:1024
    ds_write_b128 v6, v[24:27] offset:2048
    ds_write_b128 v6, v[28:31] offset:3072
    ds_write_b128 v6, v[32:35] offset:8192
    ds_write_b128 v6, v[36:39] offset:9216
    ds_write_b128 v6, v[40:43] offset:10240
    ds_write_b128 v6, v[44:47] offset:11264
    s_waitcnt lgkmcnt(0)
    s_branch NEXT
WL_t1:
    s_call_b64 s[76:77], PREP_w_issue_4
    s_mov_b32 m0, s19
    s_mov_b32 s39, s16
    s_mov_b32 s32, s17
    s_mov_b32 s3, s18
    s_waitcnt vmcnt(0)
    s_barrier
    s_waitcnt vmcnt(0)
    s_barrier
    s_waitcnt vmcnt(0)
    s_barrier
    s_waitcnt vmcnt(0)
    s_barrier
    s_waitcnt vmcnt(0)
    s_barrier
    buffer_load_dwordx4 v239, s[12:15], s39 offen lds
    s_add_u32 m0, m0, 1024
    s_add_u32 s39, s39, s32
    buffer_load_dwordx4 v240, s[12:15], s39 offen lds
    s_mov_b32 s43, 1
ld_77:
    s_mov_b32 s45, 8192
    s_add_u32 s19, s41, s42
    v_readlane_b32 s16, v249, s44
    s_nop 0
    s_bitcmp1_b32 s16, 0
    s_cselect_b32 s17, 16384, s45
    s_cselect_b32 s18, -40960, s45
    s_andn2_b32 s16, s16, 1
    s_add_u32 s16, s16, s38
    s_add_u32 s44, s44, 1
    s_add_u32 s42, s42, 16384
    s_cmp_eq_u32 s42, 98304
    s_cselect_b32 s42, 0, s42
    s_add_u32 m0, m0, 1024
    s_add_u32 s39, s39, s32
    buffer_load_dwordx4 v239, s[12:15], s39 offen lds
    s_add_u32 m0, m0, 1024
    s_add_u32 s39, s39, s32
    buffer_load_dwordx4 v240, s[12:15], s39 offen lds
    s_add_u32 m0, m0, 1024
    s_add_u32 s39, s39, s3
    buffer_load_dwordx4 v239, s[12:15], s39 offen lds
    s_add_u32 m0, m0, 1024
    s_add_u32 s39, s39, s32
    buffer_load_dwordx4 v240, s[12:15], s39 offen lds
    s_add_u32 m0, m0, 1024
    s_add_u32 s39, s39, s32
    buffer_load_dwordx4 v239, s[12:15], s39 offen lds
    s_add_u32 m0, m0, 1024
    s_add_u32 s39, s39, s32
    buffer_load_dwordx4 v240, s[12:15], s39 offen lds
    s_mov_b32 m0, s19
    s_mov_b32 s39, s16
    s_mov_b32 s32, s17
    s_mov_b32 s3, s18
    s_waitcnt vmcnt(8)
    s_barrier
    buffer_load_dwordx4 v239, s[12:15], s39 offen lds
    s_add_u32 m0, m0, 1024
    s_add_u32 s39, s39, s32
    buffer_load_dwordx4 v240, s[12:15], s39 offen lds
    s_add_u32 s43, s43, 1
    s_cmp_lt_u32 s43, 21
    s_cbranch_scc1 ld_77
    s_call_b64 s[76:77], PREP_w_issue_4
    s_add_u32 m0, m0, 1024
    s_add_u32 s39, s39, s32
    buffer_load_dwordx4 v239, s[12:15], s39 offen lds
    s_add_u32 m0, m0, 1024
    s_add_u32 s39, s39, s32
    buffer_load_dwordx4 v240, s[12:15], s39 offen lds
    s_add_u32 m0, m0, 1024
    s_add_u32 s39, s39, s3
    buffer_load_dwordx4 v239, s[12:15], s39 offen lds
    s_add_u32 m0, m0, 1024
    s_add_u32 s39, s39, s32
    buffer_load_dwordx4 v240, s[12:15], s39 offen lds
    s_add_u32 m0, m0, 1024
    s_add_u32 s39, s39, s32
    buffer_load_dwordx4 v239, s[12:15], s39 offen lds
    s_add_u32 m0, m0, 1024
    s_add_u32 s39, s39, s32
    buffer_load_dwordx4 v240, s[12:15], s39 offen lds
    s_mov_b32 m0, s19
    s_mov_b32 s39, s16
    s_mov_b32 s32, s17
    s_mov_b32 s3, s18
    s_waitcnt vmcnt(8)
    s_barrier
    buffer_load_dwordx4 v239, s[12:15], s39 offen lds
    s_add_u32 m0, m0, 1024
    s_add_u32 s39, s39, s32
    buffer_load_dwordx4 v240, s[12:15], s39 offen lds
    s_add_u32 m0, m0, 1024
    s_add_u32 s39, s39, s32
    buffer_load_dwordx4 v239, s[12:15], s39 offen lds
    s_add_u32 m0, m0, 1024
    s_add_u32 s39, s39, s32
    buffer_load_dwordx4 v240, s[12:15], s39 offen lds
    s_add_u32 m0, m0, 1024
    s_add_u32 s39, s39, s3
    buffer_load_dwordx4 v239, s[12:15], s39 offen lds
    s_add_u32 m0, m0, 1024
    s_add_u32 s39, s39, s32
    buffer_load_dwordx4 v240, s[12:15], s39 offen lds
    s_add_u32 m0, m0, 1024
    s_add_u32 s39, s39, s32
    buffer_load_dwordx4 v239, s[12:15], s39 offen lds
    s_add_u32 m0, m0, 1024
    s_add_u32 s39, s39, s32
    buffer_load_dwordx4 v240, s[12:15], s39 offen lds
    s_waitcnt vmcnt(8)
    s_barrier
    s_waitcnt vmcnt(0)
    s_barrier
    s_branch K_fin
NEXT:
    s_setprio 0
    s_add_u32 s60, s60, 1
    s_add_u32 s55, s55, 4194304
    s_add_u32 s62, s62, 4194304
    s_addc_u32 s63, s63, 0
    s_branch LAYER
K_fin:
    s_endpgm
SUB_w1_regs:
    s_mov_b64 s[12:13], s[68:69]
    s_mov_b32 s14, 2097152
    s_mov_b32 s15, 0x20000
    s_and_b32 s35, s30, 3
    s_mul_i32 s35, s35, 294912
    s_lshl_b32 s39, s99, 7
    s_add_u32 s39, s39, s35
    buffer_load_dwordx4 v[176:179], v238, s[12:15], s39 offen
    s_add_u32 s39, s39, 16384
    buffer_load_dwordx4 v[188:191], v238, s[12:15], s39 offen
    s_add_u32 s39, s39, 16384
    buffer_load_dwordx4 v[192:195], v238, s[12:15], s39 offen
    s_add_u32 s39, s39, 16384
    buffer_load_dwordx4 v[200:203], v238, s[12:15], s39 offen
    s_add_u32 s39, s39, 16384
    s_waitcnt vmcnt(8)
    buffer_load_dwordx4 v[204:207], v238, s[12:15], s39 offen
    s_add_u32 s39, s39, 16384
    buffer_load_dwordx4 v[208:211], v238, s[12:15], s39 offen
    s_add_u32 s39, s39, 16384
    buffer_load_dwordx4 v[212:215], v238, s[12:15], s39 offen
    s_add_u32 s39, s39, 16384
    buffer_load_dwordx4 v[216:219], v238, s[12:15], s39 offen
    s_add_u32 s39, s39, 16384
    s_waitcnt vmcnt(8)
    buffer_load_dwordx4 v[220:223], v238, s[12:15], s39 offen
    s_add_u32 s39, s39, 16384
    buffer_load_dwordx4 v[224:227], v238, s[12:15], s39 offen
    s_add_u32 s39, s39, 16384
    buffer_load_dwordx4 v[16:19], v238, s[12:15], s39 offen
    s_add_u32 s39, s39, 16384
    buffer_load_dwordx4 v[20:23], v238, s[12:15], s39 offen
    s_add_u32 s39, s39, 16384
    s_waitcnt vmcnt(8)
    buffer_load_dwordx4 v[24:27], v238, s[12:15], s39 offen
    s_add_u32 s39, s39, 16384
    buffer_load_dwordx4 v[28:31], v238, s[12:15], s39 offen
    s_add_u32 s39, s39, 16384
    buffer_load_dwordx4 v[32:35], v238, s[12:15], s39 offen
    s_add_u32 s39, s39, 16384
    buffer_load_dwordx4 v[36:39], v238, s[12:15], s39 offen
    s_add_u32 s39, s39, 16384
    s_waitcnt vmcnt(8)
    buffer_load_dwordx4 v[40:43], v238, s[12:15], s39 offen
    s_add_u32 s39, s39, 16384
    buffer_load_dwordx4 v[44:47], v238, s[12:15], s39 offen
    s_add_u32 s39, s39, 16384
    s_setpc_b64 s[76:77]
SUB_park:
    s_mov_b64 s[12:13], s[70:71]
    s_mov_b32 s14, 2097152
    s_mov_b32 s15, 0x20000
    s_and_b32 s35, s30, 3
    s_lshl_b32 s35, s35, 19
    s_lshl_b32 s39, s29, 7
    s_add_u32 s39, s39, s35
    buffer_load_dwordx4 v[48:51], v238, s[12:15], s39 offen
    s_add_u32 s39, s39, 16384
    buffer_load_dwordx4 v[52:55], v238, s[12:15], s39 offen
    s_add_u32 s39, s39, 16384
    buffer_load_dwordx4 v[56:59], v238, s[12:15], s39 offen
    s_add_u32 s39, s39, 16384
    buffer_load_dwordx4 v[60:63], v238, s[12:15], s39 offen
    s_add_u32 s39, s39, 16384
    s_waitcnt vmcnt(8)
    buffer_load_dwordx4 v[64:67], v238, s[12:15], s39 offen
    s_add_u32 s39, s39, 16384
    buffer_load_dwordx4 v[68:71], v238, s[12:15], s39 offen
    s_add_u32 s39, s39, 16384
    buffer_load_dwordx4 v[72:75], v238, s[12:15], s39 offen
    s_add_u32 s39, s39, 16384
    buffer_load_dwordx4 v[76:79], v238, s[12:15], s39 offen
    s_add_u32 s39, s39, 16384
    s_waitcnt vmcnt(8)
    buffer_load_dwordx4 v[80:83], v238, s[12:15], s39 offen
    s_add_u32 s39, s39, 16384
    buffer_load_dwordx4 v[84:87], v238, s[12:15], s39 offen
    s_add_u32 s39, s39, 16384
    buffer_load_dwordx4 v[88:91], v238, s[12:15], s39 offen
    s_add_u32 s39, s39, 16384
    buffer_load_dwordx4 v[92:95], v238, s[12:15], s39 offen
    s_add_u32 s39, s39, 16384
    s_waitcnt vmcnt(8)
    buffer_load_dwordx4 v[96:99], v238, s[12:15], s39 offen
    s_add_u32 s39, s39, 16384
    buffer_load_dwordx4 v[100:103], v238, s[12:15], s39 offen
    s_add_u32 s39, s39, 16384
    buffer_load_dwordx4 v[104:107], v238, s[12:15], s39 offen
    s_add_u32 s39, s39, 16384
    buffer_load_dwordx4 v[108:111], v238, s[12:15], s39 offen
    s_add_u32 s39, s39, 16384
    s_waitcnt vmcnt(8)
    buffer_load_dwordx4 v[112:115], v238, s[12:15], s39 offen
    s_add_u32 s39, s39, 16384
    buffer_load_dwordx4 v[116:119], v238, s[12:15], s39 offen
    s_add_u32 s39, s39, 16384
    buffer_load_dwordx4 v[120:123], v238, s[12:15], s39 offen
    s_add_u32 s39, s39, 16384
    buffer_load_dwordx4 v[124:127], v238, s[12:15], s39 offen
    s_add_u32 s39, s39, 16384
    s_waitcnt vmcnt(8)
    buffer_load_dwordx4 v[128:131], v238, s[12:15], s39 offen
    s_add_u32 s39, s39, 16384
    buffer_load_dwordx4 v[132:135], v238, s[12:15], s39 offen
    s_add_u32 s39, s39, 16384
    buffer_load_dwordx4 v[136:139], v238, s[12:15], s39 offen
    s_add_u32 s39, s39, 16384
    buffer_load_dwordx4 v[140:143], v238, s[12:15], s39 offen
    s_add_u32 s39, s39, 16384
    s_waitcnt vmcnt(8)
    s_setpc_b64 s[76:77]
SUB_park2:
    s_mov_b64 s[12:13], s[70:71]
    s_mov_b32 s14, 2097152
    s_mov_b32 s15, 0x20000
    s_and_b32 s35, s30, 3
    s_lshl_b32 s35, s35, 19
    s_lshl_b32 s39, s29, 7
    s_add_u32 s39, s39, s35
    s_add_u32 s39, s39, 393216
    buffer_load_dwordx4 v[144:147], v238, s[12:15], s39 offen
    s_add_u32 s39, s39, 16384
    buffer_load_dwordx4 v[148:151], v238, s[12:15], s39 offen
    s_add_u32 s39, s39, 16384
    buffer_load_dwordx4 v[152:155], v238, s[12:15], s39 offen
    s_add_u32 s39, s39, 16384
    buffer_load_dwordx4 v[156:159], v238, s[12:15], s39 offen
    s_add_u32 s39, s39, 16384
    s_waitcnt vmcnt(8)
    buffer_load_dwordx4 v[160:163], v238, s[12:15], s39 offen
    s_add_u32 s39, s39, 16384
    buffer_load_dwordx4 v[164:167], v238, s[12:15], s39 offen
    s_add_u32 s39, s39, 16384
    buffer_load_dwordx4 v[168:171], v238, s[12:15], s39 offen
    s_add_u32 s39, s39, 16384
    buffer_load_dwordx4 v[172:175], v238, s[12:15], s39 offen
    s_add_u32 s39, s39, 16384
    s_waitcnt vmcnt(8)
    s_setpc_b64 s[76:77]
SUB_w1_put:
    s_and_b32 s35, s30, 3
    s_mul_i32 s35, s35, 18432
    v_add_u32 v8, s35, v2
    v_mov_b32 v6, 162836
spin_78:
    s_sleep 2
    ds_read_b32 v7, v6
    s_waitcnt lgkmcnt(0)
    v_readfirstlane_b32 s53, v7
    s_nop 0
    s_cmp_ge_u32 s53, 8
    s_cbranch_scc0 spin_78
    s_waitcnt vmcnt(24)
    ds_write_b128 v8, v[176:179] offset:24576
    ds_write_b128 v8, v[188:191] offset:25600
    ds_write_b128 v8, v[192:195] offset:26624
    ds_write_b128 v8, v[200:203] offset:27648
    ds_write_b128 v8, v[204:207] offset:28672
    ds_write_b128 v8, v[208:211] offset:29696
    ds_write_b128 v8, v[212:215] offset:30720
    ds_write_b128 v8, v[216:219] offset:31744
    ds_write_b128 v8, v[220:223] offset:32768
    ds_write_b128 v8, v[224:227] offset:33792
    ds_write_b128 v8, v[16:19] offset:34816
    ds_write_b128 v8, v[20:23] offset:35840
    ds_write_b128 v8, v[24:27] offset:36864
    ds_write_b128 v8, v[28:31] offset:37888
    ds_write_b128 v8, v[32:35] offset:38912
    ds_write_b128 v8, v[36:39] offset:39936
    ds_write_b128 v8, v[40:43] offset:40960
    ds_write_b128 v8, v[44:47] offset:41984
    s_waitcnt lgkmcnt(0)
    s_setpc_b64 s[76:77]
SUB_after_g1:
    s_mov_b64 s[12:13], s[72:73]
    s_mov_b32 s14, 7340032
    s_mov_b32 s15, 0x20000
    v_readlane_b32 s36, v251, 0
    v_readlane_b32 s37, v251, 1
    v_readlane_b32 s34, v251, 2
    s_and_b32 s35, s30, 3
    s_mul_i32 s38, s35, 114688
    s_mul_i32 s39, s29, 448
    s_add_u32 s38, s38, s39
    s_and_b32 s36, s36, 15
    s_mul_i32 s36, s36, 458752
    s_add_u32 s36, s36, s38
    s_and_b32 s37, s37, 15
    s_mul_i32 s37, s37, 458752
    s_add_u32 s37, s37, s38
    s_and_b32 s34, s34, 15
    s_mul_i32 s34, s34, 458752
    s_add_u32 s34, s34, s38
    s_mul_i32 s39, s35, 7168
    s_add_u32 m0, s39, 131072
    s_nop 0
    buffer_load_dwordx4 v241, s[12:15], s36 offen lds
    s_add_u32 m0, m0, 1024
    s_nop 0
    buffer_load_dwordx4 v242, s[12:15], s36 offen lds
    s_add_u32 m0, m0, 1024
    s_nop 0
    buffer_load_dwordx4 v243, s[12:15], s36 offen lds
    s_add_u32 m0, m0, 1024
    s_nop 0
    buffer_load_dwordx4 v244, s[12:15], s36 offen lds
    s_add_u32 m0, m0, 1024
    s_nop 0
    buffer_load_dwordx4 v245, s[12:15], s36 offen lds
    s_add_u32 m0, m0, 1024
    s_nop 0
    buffer_load_dwordx4 v246, s[12:15], s36 offen lds
    s_add_u32 m0, m0, 1024
    s_nop 0
    buffer_load_dwordx4 v247, s[12:15], s36 offen lds
    buffer_load_dwordx4 v[176:179], v241, s[12:15], s37 offen
    buffer_load_dwordx4 v[180:183], v242, s[12:15], s37 offen
    buffer_load_dwordx4 v[184:187], v243, s[12:15], s37 offen
    buffer_load_dwordx4 v[188:191], v244, s[12:15], s37 offen
    buffer_load_dwordx4 v[192:195], v245, s[12:15], s37 offen
    buffer_load_dwordx4 v[196:199], v246, s[12:15], s37 offen
    buffer_load_dwordx4 v[200:203], v247, s[12:15], s37 offen
    s_lshr_b32 s36, s67, 2
    s_sub_u32 s36, s35, s36
    s_and_b32 s36, s36, 3
    s_lshl_b32 s36, s36, 15
    v_add_u32 v6, s36, v2
    s_waitcnt vmcnt(14)
    ds_write_b128 v6, v[48:51] offset:0
    ds_write_b128 v6, v[52:55] offset:1024
    ds_write_b128 v6, v[56:59] offset:2048
    ds_write_b128 v6, v[60:63] offset:3072
    ds_write_b128 v6, v[64:67] offset:4096
    ds_write_b128 v6, v[68:71] offset:5120
    ds_write_b128 v6, v[72:75] offset:6144
    ds_write_b128 v6, v[76:79] offset:7168
    ds_write_b128 v6, v[80:83] offset:8192
    ds_write_b128 v6, v[84:87] offset:9216
    ds_write_b128 v6, v[88:91] offset:10240
    ds_write_b128 v6, v[92:95] offset:11264
    ds_write_b128 v6, v[96:99] offset:12288
    ds_write_b128 v6, v[100:103] offset:13312
    ds_write_b128 v6, v[104:107] offset:14336
    ds_write_b128 v6, v[108:111] offset:15360
    ds_write_b128 v6, v[112:115] offset:16384
    ds_write_b128 v6, v[116:119] offset:17408
    ds_write_b128 v6, v[120:123] offset:18432
    ds_write_b128 v6, v[124:127] offset:19456
    ds_write_b128 v6, v[128:131] offset:20480
    ds_write_b128 v6, v[132:135] offset:21504
    ds_write_b128 v6, v[136:139] offset:22528
    ds_write_b128 v6, v[140:143] offset:23552
    ds_write_b128 v6, v[144:147] offset:24576
    ds_write_b128 v6, v[148:151] offset:25600
    ds_write_b128 v6, v[152:155] offset:26624
    ds_write_b128 v6, v[156:159] offset:27648
    ds_write_b128 v6, v[160:163] offset:28672
    ds_write_b128 v6, v[164:167] offset:29696
    ds_write_b128 v6, v[168:171] offset:30720
    ds_write_b128 v6, v[172:175] offset:31744
    s_waitcnt lgkmcnt(0)
    s_setpc_b64 s[76:77]
SUB_after_g2:
    s_and_b32 s35, s30, 3
    s_mul_i32 s39, s35, 7168
    s_add_u32 s39, s39, 73728
    v_add_u32 v7, s39, v2
    ds_write_b128 v7, v[176:179] offset:0
    ds_write_b128 v7, v[180:183] offset:1024
    ds_write_b128 v7, v[184:187] offset:2048
    ds_write_b128 v7, v[188:191] offset:3072
    ds_write_b128 v7, v[192:195] offset:4096
    ds_write_b128 v7, v[196:199] offset:5120
    ds_write_b128 v7, v[200:203] offset:6144
    s_waitcnt lgkmcnt(0)
    s_setpc_b64 s[76:77]
SUB_r_pre:
    v_and_b32 v199, 7, v0
    v_lshrrev_b32 v228, 6, v0
    v_lshlrev_b32 v228, 4, v228
    v_bfe_u32 v229, v0, 3, 3
    v_add_u32 v228, v228, v229
    s_lshr_b32 s78, s29, 1
    s_lshl_b32 s78, s78, 16
    s_and_b32 s79, s29, 1
    s_lshl_b32 s79, s79, 7
    s_add_u32 s78, s78, s79
    s_lshr_b32 s79, s30, 1
    s_lshl_b32 s79, s79, 13
    s_add_u32 s78, s78, s79
    v_lshlrev_b32 v196, 8, v228
    v_lshl_add_u32 v196, v199, 4, v196
    v_add_u32 v196, s78, v196
    s_mov_b32 s84, s62
    s_mov_b32 s85, s63
    s_mov_b32 s86, 0x7e000
    s_mov_b32 s87, 0x20000
    s_add_u32 s88, s62, 0x80000
    s_addc_u32 s89, s63, 0
    s_mov_b32 s90, 0x7e000
    s_mov_b32 s91, 0x20000
    buffer_load_dwordx4 v[180:183], v196, s[84:87], 0 offen offset:0 sc1
    buffer_load_dwordx4 v[188:191], v196, s[88:91], 0 offen offset:0 sc1
    buffer_load_dwordx4 v[184:187], v196, s[84:87], 0 offen offset:2048 sc1
    buffer_load_dwordx4 v[192:195], v196, s[88:91], 0 offen offset:2048 sc1
    s_setpc_b64 s[76:77]
SUB_r_pre0:
    v_and_b32 v199, 7, v0
    v_lshrrev_b32 v228, 6, v0
    v_lshlrev_b32 v228, 4, v228
    v_bfe_u32 v229, v0, 3, 3
    v_add_u32 v228, v228, v229
    s_lshr_b32 s78, s29, 1
    s_lshl_b32 s78, s78, 16
    s_and_b32 s79, s29, 1
    s_lshl_b32 s79, s79, 7
    s_add_u32 s78, s78, s79
    s_lshr_b32 s79, s30, 1
    s_lshl_b32 s79, s79, 13
    s_add_u32 s78, s78, s79
    v_lshlrev_b32 v196, 8, v228
    v_lshl_add_u32 v196, v199, 4, v196
    v_add_u32 v196, s78, v196
    s_mov_b32 s84, s62
    s_mov_b32 s85, s63
    s_mov_b32 s86, 0x7e000
    s_mov_b32 s87, 0x20000
    s_add_u32 s88, s62, 0x80000
    s_addc_u32 s89, s63, 0
    s_mov_b32 s90, 0x7e000
    s_mov_b32 s91, 0x20000
    s_cmp_eq_u32 s60, 0
    s_cselect_b64 exec, -1, 0
    buffer_load_dwordx4 v[180:183], v196, s[84:87], 0 offen offset:0 sc1
    buffer_load_dwordx4 v[188:191], v196, s[88:91], 0 offen offset:0 sc1
    buffer_load_dwordx4 v[184:187], v196, s[84:87], 0 offen offset:2048 sc1
    buffer_load_dwordx4 v[192:195], v196, s[88:91], 0 offen offset:2048 sc1
    s_mov_b64 exec, -1
    s_setpc_b64 s[76:77]
SUB_w_issue_1:
    s_add_u32 s19, s41, s42
    s_mul_i32 s16, s44, 131072
    s_add_u32 s16, s16, s38
    s_add_u32 s44, s44, 1
    s_and_b32 s44, s44, 15
    s_add_u32 s42, s42, 8192
    s_cmp_eq_u32 s42, 131072
    s_cselect_b32 s42, 0, s42
    s_mov_b32 m0, s19
    s_mov_b32 s39, s16
    buffer_load_dwordx4 v238, s[12:15], s39 offen lds
    s_add_u32 m0, m0, 1024
    s_add_u32 s39, s39, 16384
    buffer_load_dwordx4 v238, s[12:15], s39 offen lds
    s_add_u32 m0, m0, 1024
    s_add_u32 s39, s39, 16384
    buffer_load_dwordx4 v238, s[12:15], s39 offen lds
    s_add_u32 m0, m0, 1024
    s_add_u32 s39, s39, 16384
    buffer_load_dwordx4 v238, s[12:15], s39 offen lds
    s_setpc_b64 s[76:77]
PREP_a_issue_4:
    s_add_u32 s19, s41, s42
    v_readlane_b32 s16, v249, s44
    v_readlane_b32 s17, v250, s44
    s_add_u32 s16, s16, s38
    s_add_u32 s17, s17, s38
    s_add_u32 s44, s44, 1
    s_add_u32 s42, s42, 16384
    s_cmp_eq_u32 s42, 49152
    s_cselect_b32 s42, 0, s42
    s_setpc_b64 s[76:77]
PREP_w_issue_4:
    s_mov_b32 s45, 8192
    s_add_u32 s19, s41, s42
    v_readlane_b32 s16, v249, s44
    s_nop 0
    s_bitcmp1_b32 s16, 0
    s_cselect_b32 s17, 16384, s45
    s_cselect_b32 s18, -40960, s45
    s_andn2_b32 s16, s16, 1
    s_add_u32 s16, s16, s38
    s_add_u32 s44, s44, 1
    s_add_u32 s42, s42, 16384
    s_cmp_eq_u32 s42, 98304
    s_cselect_b32 s42, 0, s42
    s_setpc_b64 s[76:77]
K_end:
    s_endpgm
.p2align 6
K_tab:
.short 4096,5137,6178,11379,18660,25941,40502,33223,47784,55065,19706,12427,26988,34269,48830,41551,56096,9264,20736,10448,23824,25008,38384,35296,39568,49856,54128,52944,0,0,0,0
.short 4096,5137,6178,18659,11380,25941,33222,47783,40504,55065,12426,26987,19708,34269,41550,56111,48816,9264,10448,23824,20736,25008,35296,39568,38384,49856,52944,54128,0,0,0,0
.short 4096,5137,6178,11379,25940,18661,33222,40503,55064,47785,12426,19707,34268,26989,41550,48831,9264,56096,10448,20736,25008,23824,35296,38384,49856,39568,52944,54128,0,0,0,0
.short 4096,5137,6178,11379,18660,33221,25942,40503,47784,12425,55066,19707,26988,41549,34270,48831,56096,10448,9264,20736,23824,35296,25008,38384,39568,52944,49856,54128,0,0,0,0
.short 11377,12418,13459,18660,4101,25942,33223,47784,40505,55066,5147,26988,19709,34270,41551,56096,48816,6176,10288,23824,20736,25008,35296,39568,38384,49856,52944,54128,0,0,0,0
.short 11377,12418,13459,4100,25941,18662,33223,40504,55065,47786,5147,19708,34269,26990,41551,48816,6176,56096,10288,20736,25008,23824,35296,38384,49856,39568,52944,54128,0,0,0,0
.short 11377,12418,13459,4100,18661,33222,25943,40504,47785,5146,55067,19708,26989,41550,34271,48816,56096,10288,6176,20736,23824,35296,25008,38384,39568,52944,49856,54128,0,0,0,0
.short 11377,12418,13459,4100,18661,25942,40503,33224,47785,55066,19707,5148,26989,34270,48831,41536,56096,6176,20736,10288,23824,25008,38384,35296,39568,49856,54128,52944,0,0,0,0
.short 18658,19699,20740,4101,25942,11383,33224,40505,55066,47787,5148,12429,34270,26991,41536,48817,6176,56096,9264,10448,25008,23824,35296,38384,49856,39568,52944,54128,0,0,0,0
.short 18658,19699,20740,4101,11382,33223,25944,40505,47786,5147,55068,12429,26990,41551,34256,48817,56096,9264,6176,10448,23824,35296,25008,38384,39568,52944,49856,54128,0,0,0,0
.short 18658,19699,20740,4101,11382,25943,40504,33225,47786,55067,12428,5149,26990,34271,48816,41537,56096,6176,10448,9264,23824,25008,38384,35296,39568,49856,54128,52944,0,0,0,0
.short 18658,19699,20740,11381,4102,25943,33224,47785,40506,55067,5148,26989,12430,34271,41536,56097,48816,6176,9264,23824,10448,25008,35296,39568,38384,49856,52944,54128,0,0,0,0
.short 25939,26980,28021,4102,11383,33224,18665,40506,47787,5148,55069,12430,19711,41536,34257,48818,56096,9264,6176,10448,20736,35296,24848,38384,39568,52944,49856,54128,0,0,0,0
.short 25939,26980,28021,4102,11383,18664,40505,33226,47787,55068,12429,5150,19711,34256,48817,41538,56096,6176,10448,9264,20736,24848,38384,35296,39568,49856,54128,52944,0,0,0,0
.short 25939,26980,28021,11382,4103,18664,33225,47786,40507,55068,5149,19710,12431,34256,41537,56098,48816,6176,9264,20736,10448,24848,35296,39568,38384,49856,52944,54128,0,0,0,0
.short 25939,26980,28021,4102,18663,11384,33225,40506,55067,47788,5149,12430,34271,19696,41537,48818,6176,56096,9264,10448,24848,20736,35296,38384,49856,39568,52944,54128,0,0,0,0
.short 33220,34261,35302,4103,11384,18665,40506,25947,47788,55069,12430,5151,19696,26977,48818,41539,56096,6176,10448,9264,20736,23824,38384,25008,39568,49856,54128,52944,0,0,0,0
.short 33220,34261,35302,11383,4104,18665,25946,47787,40508,55069,5150,19711,12416,26977,41538,56099,48816,6176,9264,20736,10448,23824,25008,39568,38384,49856,52944,54128,0,0,0,0
.short 33220,34261,35302,4103,18664,11385,25946,40507,55068,47789,5150,12431,26976,19697,41538,48819,6176,56096,9264,10448,23824,20736,25008,38384,49856,39568,52944,54128,0,0,0,0
.short 33220,34261,35302,4103,11384,25945,18666,40507,47788,5149,55070,12431,19696,41537,26978,48819,56096,9264,6176,10448,20736,25008,23824,38384,39568,52944,49856,54128,0,0,0,0
.short 40501,41542,42583,11384,4105,18666,25947,47788,33229,55070,5151,19696,12417,26978,34259,56100,48816,6176,9264,20736,10448,23824,25008,39408,35296,49856,52944,54128,0,0,0,0
.short 40501,41542,42583,4104,18665,11386,25947,33228,55069,47790,5151,12416,26977,19698,34259,48820,6176,56096,9264,10448,23824,20736,25008,35296,49856,39408,52944,54128,0,0,0,0
.short 40501,41542,42583,4104,11385,25946,18667,33228,47789,5150,55071,12416,19697,34258,26979,48820,56096,9264,6176,10448,20736,25008,23824,35296,39408,52944,49856,54128,0,0,0,0
.short 40501,41542,42583,4104,11385,18666,33227,25948,47789,55070,12431,5136,19697,26978,48819,34260,56096,6176,10448,9264,20736,23824,35296,25008,39408,49856,54128,52944,0,0,0,0
.short 47782,48823,49864,4105,18666,11387,25948,33229,55070,40511,5136,12417,26978,19699,34260,41541,6176,56096,9264,10448,23824,20736,25008,35296,39568,38384,52944,54128,0,0,0,0
.short 47782,48823,49864,4105,11386,25947,18668,33229,40510,5151,55056,12417,19698,34259,26980,41541,56096,9264,6176,10448,20736,25008,23824,35296,38384,52944,39568,54128,0,0,0,0
.short 47782,48823,49864,4105,11386,18667,33228,25949,40510,55071,12416,5137,19698,26979,41540,34261,56096,6176,10448,9264,20736,23824,35296,25008,38384,39568,54128,52944,0,0,0,0
.short 47782,48823,49864,11385,4106,18667,25948,40509,33230,55071,5136,19697,12418,26979,34260,56101,41536,6176,9264,20736,10448,23824,25008,38384,35296,39568,52944,54128,0,0,0,0
.short 55063,56104,57145,4106,11387,25948,18669,33230,40511,5136,47777,12418,19699,34260,26981,41542,48816,9264,6176,10448,20736,25008,23824,35296,38384,49856,39568,53968,0,0,0,0
.short 55063,56104,57145,4106,11387,18668,33229,25950,40511,47776,12417,5138,19699,26980,41541,34262,48816,6176,10448,9264,20736,23824,35296,25008,38384,39568,53968,49856,0,0,0,0
.short 55063,56104,57145,11386,4107,18668,25949,40510,33231,47776,5137,19698,12419,26980,34261,48822,41536,6176,9264,20736,10448,23824,25008,38384,35296,39568,49856,53968,0,0,0,0
.short 55063,56104,57145,4106,18667,11388,25949,33230,47791,40496,5137,12418,26979,19700,34261,41542,6176,48816,9264,10448,23824,20736,25008,35296,39568,38384,49856,53968,0,0,0,0
.short 4104,5145,6186,11387,18668,25949,40510,33231,47776,55057,19698,12419,26980,34261,48822,41543,56096,9264,20736,10448,23824,25008,38384,35296,39568,49856,54128,52944,0,0,0,0
.short 4104,5145,6186,18667,11388,25949,33230,47791,40496,55057,12418,26979,19700,34261,41542,56103,48816,9264,10448,23824,20736,25008,35296,39568,38384,49856,52944,54128,0,0,0,0
.short 4104,5145,6186,11387,25948,18669,33230,40511,55056,47777,12418,19699,34260,26981,41542,48823,9264,56096,10448,20736,25008,23824,35296,38384,49856,39568,52944,54128,0,0,0,0
.short 4104,5145,6186,11387,18668,33229,25950,40511,47776,12417,55058,19699,26980,41541,34262,48823,56096,10448,9264,20736,23824,35296,25008,38384,39568,52944,49856,54128,0,0,0,0
.short 11385,12426,13467,18668,4109,25950,33231,47776,40497,55058,5139,26980,19701,34262,41543,56104,48816,6176,10288,23824,20736,25008,35296,39568,38384,49856,52944,54128,0,0,0,0
.short 11385,12426,13467,4108,25949,18670,33231,40496,55057,47778,5139,19700,34261,26982,41543,48824,6176,56096,10288,20736,25008,23824,35296,38384,49856,39568,52944,54128,0,0,0,0
.short 11385,12426,13467,4108,18669,33230,25951,40496,47777,5138,55059,19700,26981,41542,34263,48824,56096,10288,6176,20736,23824,35296,25008,38384,39568,52944,49856,54128,0,0,0,0
.short 11385,12426,13467,4108,18669,25950,40511,33216,47777,55058,19699,5140,26981,34262,48823,41544,56096,6176,20736,10288,23824,25008,38384,35296,39568,49856,54128,52944,0,0,0,0
.short 18666,19707,20748,4109,25950,11391,33216,40497,55058,47779,5140,12421,34262,26983,41544,48825,6176,56096,9264,10448,25008,23824,35296,38384,49856,39568,52944,54128,0,0,0,0
.short 18666,19707,20748,4109,11390,33231,25936,40497,47778,5139,55060,12421,26982,41543,34264,48825,56096,9264,6176,10448,23824,35296,25008,38384,39568,52944,49856,54128,0,0,0,0
.short 18666,19707,20748,4109,11390,25951,40496,33217,47778,55059,12420,5141,26982,34263,48824,41545,56096,6176,10448,9264,23824,25008,38384,35296,39568,49856,54128,52944,0,0,0,0
.short 18666,19707,20748,11389,4110,25951,33216,47777,40498,55059,5140,26981,12422,34263,41544,56105,48816,6176,9264,23824,10448,25008,35296,39568,38384,49856,52944,54128,0,0,0,0
.short 25947,26988,28029,4110,11391,33216,18657,40498,47779,5140,55061,12422,19703,41544,34265,48826,56096,9264,6176,10448,20736,35296,24848,38384,39568,52944,49856,54128,0,0,0,0
.short 25947,26988,28029,4110,11391,18656,40497,33218,47779,55060,12421,5142,19703,34264,48825,41546,56096,6176,10448,9264,20736,24848,38384,35296,39568,49856,54128,52944,0,0,0,0
.short 25947,26988,28029,11390,4111,18656,33217,47778,40499,55060,5141,19702,12423,34264,41545,56106,48816,6176,9264,20736,10448,24848,35296,39568,38384,49856,52944,54128,0,0,0,0
.short 25947,26988,28029,4110,18671,11376,33217,40498,55059,47780,5141,12422,34263,19704,41545,48826,6176,56096,9264,10448,24848,20736,35296,38384,49856,39568,52944,54128,0,0,0,0
.short 33228,34269,35310,4111,11376,18657,40498,25939,47780,55061,12422,5143,19704,26985,48826,41547,56096,6176,10448,9264,20736,23824,38384,25008,39568,49856,54128,52944,0,0,0,0
.short 33228,34269,35310,11391,4096,18657,25938,47779,40500,55061,5142,19703,12424,26985,41546,56107,48816,6176,9264,20736,10448,23824,25008,39568,38384,49856,52944,54128,0,0,0,0
.short 33228,34269,35310,4111,18656,11377,25938,40499,55060,47781,5142,12423,26984,19705,41546,48827,6176,56096,9264,10448,23824,20736,25008,38384,49856,39568,52944,54128,0,0,0,0
.short 33228,34269,35310,4111,11376,25937,18658,40499,47780,5141,55062,12423,19704,41545,26986,48827,56096,9264,6176,10448,20736,25008,23824,38384,39568,52944,49856,54128,0,0,0,0
.short 40509,41550,42591,11376,4097,18658,25939,47780,33221,55062,5143,19704,12425,26986,34267,56108,48816,6176,9264,20736,10448,23824,25008,39408,35296,49856,52944,54128,0,0,0,0
.short 40509,41550,42591,4096,18657,11378,25939,33220,55061,47782,5143,12424,26985,19706,34267,48828,6176,56096,9264,10448,23824,20736,25008,35296,49856,39408,52944,54128,0,0,0,0
.short 40509,41550,42591,4096,11377,25938,18659,33220,47781,5142,55063,12424,19705,34266,26987,48828,56096,9264,6176,10448,20736,25008,23824,35296,39408,52944,49856,54128,0,0,0,0
.short 40509,41550,42591,4096,11377,18658,33219,25940,47781,55062,12423,5144,19705,26986,48827,34268,56096,6176,10448,9264,20736,23824,35296,25008,39408,49856,54128,52944,0,0,0,0
.short 47790,48831,49856,4097,18658,11379,25940,33221,55062,40503,5144,12425,26986,19707,34268,41549,6176,56096,9264,10448,23824,20736,25008,35296,39568,38384,52944,54128,0,0,0,0
.short 47790,48831,49856,4097,11378,25939,18660,33221,40502,5143,55064,12425,19706,34267,26988,41549,56096,9264,6176,10448,20736,25008,23824,35296,38384,52944,39568,54128,0,0,0,0
.short 47790,48831,49856,4097,11378,18659,33220,25941,40502,55063,12424,5145,19706,26987,41548,34269,56096,6176,10448,9264,20736,23824,35296,25008,38384,39568,54128,52944,0,0,0,0
.short 47790,48831,49856,11377,4098,18659,25940,40501,33222,55063,5144,19705,12426,26987,34268,56109,41536,6176,9264,20736,10448,23824,25008,38384,35296,39568,52944,54128,0,0,0,0
.short 55071,56096,57137,4098,11379,25940,18661,33222,40503,5144,47785,12426,19707,34268,26989,41550,48816,9264,6176,10448,20736,25008,23824,35296,38384,49856,39568,53968,0,0,0,0
.short 55071,56096,57137,4098,11379,18660,33221,25942,40503,47784,12425,5146,19707,26988,41549,34270,48816,6176,10448,9264,20736,23824,35296,25008,38384,39568,53968,49856,0,0,0,0
.short 55071,56096,57137,11378,4099,18660,25941,40502,33223,47784,5145,19706,12427,26988,34269,48830,41536,6176,9264,20736,10448,23824,25008,38384,35296,39568,49856,53968,0,0,0,0
.short 55071,56096,57137,4098,18659,11380,25941,33222,47783,40504,5145,12426,26987,19708,34269,41550,6176,48816,9264,10448,23824,20736,25008,35296,39568,38384,49856,53968,0,0,0,0
.section .rodata,"a"
.p2align 6
.amdhsa_kernel interleave_layers__ssm_conv_h3__mixer_s_mlp__prompt_kernel
  .amdhsa_next_free_vgpr 256
  .amdhsa_next_free_sgpr 102
  .amdhsa_accum_offset 256
  .amdhsa_group_segment_fixed_size 0
  .amdhsa_kernarg_size 112
  .amdhsa_user_sgpr_count 2
  .amdhsa_user_sgpr_kernarg_segment_ptr 1
  .amdhsa_system_sgpr_workgroup_id_x 1
  .amdhsa_float_denorm_mode_32 3
.end_amdhsa_kernel
```

```asm
; @launch grid=(256,1,1) block=(512,1,1) lds=163840
.amdgcn_target "amdgcn-amd-amdhsa--gfx950"
.text
.globl interleave_layers__ssm_conv_h3__mixer_s_mlp__prompt_kernel
.p2align 8
.type interleave_layers__ssm_conv_h3__mixer_s_mlp__prompt_kernel,@function
interleave_layers__ssm_conv_h3__mixer_s_mlp__prompt_kernel:
    s_cmp_ge_u32 s2, 256
    s_cbranch_scc1 K_end
    s_load_dwordx8 s[8:15], s[0:1], 8
    s_load_dwordx2 s[6:7], s[0:1], 0
    s_load_dwordx8 s[68:75], s[0:1], 56
    s_load_dwordx2 s[4:5], s[0:1], 104
    s_load_dwordx2 s[84:85], s[0:1], 96
    s_memrealtime s[46:47]
    s_load_dwordx2 s[96:97], s[0:1], 40
    v_lshrrev_b32 v1, 6, v0
    s_nop 0
    v_readfirstlane_b32 s30, v1
    s_getpc_b64 s[48:49]
K_pc:
    s_lshr_b32 s36, s2, 3
    s_lshl_b32 s36, s36, 11
    v_lshlrev_b32 v4, 2, v0
    v_add_u32 v4, s36, v4
    v_cmp_gt_u32 vcc, K_end-K_pc-8, v4
    s_nop 0
    s_and_saveexec_b64 s[36:37], vcc
    s_cbranch_execz K_3
    v_mov_b32 v5, s49
    v_add_co_u32 v4, vcc, s48, v4
    s_nop 1
    v_addc_co_u32 v5, vcc, 0, v5, vcc
    global_load_dword v250, v[4:5], off
K_3:
    s_mov_b64 exec, -1
    v_and_b32 v6, 31, v0
    v_lshrrev_b32 v7, 5, v0
    s_and_b32 s34, s2, 7
    s_lshr_b32 s35, s2, 3
    s_lshl_b32 s36, s35, 17
    s_lshl_b32 s37, s34, 8
    s_add_u32 s36, s36, s37
    v_lshlrev_b32 v8, 13, v7
    v_lshl_add_u32 v8, v6, 3, v8
    v_add_u32 v12, s36, v8
    v_add_u32 v14, 4096, v12
    s_mov_b32 s18, 4194304
    s_mov_b32 s19, 0x20000
    s_mov_b32 s22, s18
    s_mov_b32 s23, s19
    s_waitcnt lgkmcnt(0)
    s_mov_b32 s86, 256
    s_mov_b32 s87, 0x20000
    v_mov_b32 v78, 0
    s_lshl_b32 s45, s2, 3
    s_add_u32 s45, s45, s30
    s_cmp_lg_u32 s45, 4
    s_cbranch_scc1 KV_t0
    s_getreg_b32 s45, hwreg(HW_REG_XCC_ID, 0, 3)
    s_lshl_b32 s45, s45, 1
    s_lshl_b32 s44, s46, 6
    s_or_b32 s44, s44, s45
    s_or_b32 s44, s44, 1
    v_mov_b32 v76, s44
    v_mov_b32 v77, 0
    s_mov_b64 exec, 1
    buffer_store_dwordx2 v[76:77], v78, s[84:87], 0 offen sc1
    s_mov_b64 exec, -1
KV_t0:
    s_mov_b64 s[16:17], s[8:9]
    s_mov_b64 s[20:21], s[10:11]
    buffer_load_dwordx2 v[28:29], v12, s[16:19], 0 offen offset:0 nt
    buffer_load_dwordx2 v[30:31], v12, s[16:19], 0 offen offset:2048 nt
    buffer_load_dwordx2 v[32:33], v14, s[16:19], 0 offen offset:0 nt
    buffer_load_dwordx2 v[34:35], v14, s[16:19], 0 offen offset:2048 nt
    buffer_load_dwordx2 v[36:37], v12, s[20:23], 0 offen offset:0 nt
    buffer_load_dwordx2 v[38:39], v12, s[20:23], 0 offen offset:2048 nt
    buffer_load_dwordx2 v[40:41], v14, s[20:23], 0 offen offset:0 nt
    buffer_load_dwordx2 v[42:43], v14, s[20:23], 0 offen offset:2048 nt
    v_subrev_u32 v9, 6144, v12
    v_subrev_u32 v10, 4096, v12
    v_subrev_u32 v11, 2048, v12
    s_lshl_b32 s37, s34, 10
    v_lshlrev_b32 v16, 5, v6
    v_add_u32 v16, s37, v16
    s_mov_b32 s24, s12
    s_mov_b32 s25, s13
    s_mov_b32 s26, 0x2000
    s_mov_b32 s27, 0x20000
    v_and_b32 v8, 1, v7
    v_lshl_add_u32 v16, v8, 4, v16
    buffer_load_dwordx4 v[44:47], v16, s[24:27], 0 offen
    s_cmp_lg_u32 s30, 4
    s_cbranch_scc1 KV_t2
    buffer_load_dword v76, v78, s[84:87], 0 offen sc1
KV_t2:
    s_bfm_b64 exec, 32, 0
    buffer_load_dwordx2 v[22:23], v9, s[16:19], 0 offen nt
    buffer_load_dwordx2 v[24:25], v10, s[16:19], 0 offen nt
    buffer_load_dwordx2 v[26:27], v11, s[16:19], 0 offen nt
    s_mov_b64 exec, -1
    v_and_b32 v1, 63, v0
    v_lshlrev_b32 v2, 4, v1
    v_lshlrev_b32 v3, 2, v1
    s_mov_b32 s67, 0
    s_mov_b32 s60, 0
    s_mov_b32 s61, 40000
    s_mov_b32 s52, 0
    s_mov_b32 s55, 0
    s_mov_b32 s92, 0
    s_mov_b32 s93, 0
    s_mov_b32 s94, 0
    s_mov_b32 s56, s4
    s_mov_b32 s57, s5
    s_mov_b32 s58, 0xa000000
    s_mov_b32 s59, 0x20000
    s_add_u32 s62, s4, 33554432
    s_addc_u32 s63, s5, 0
    s_and_b32 s41, s30, 3
    s_and_b32 s38, s2, 7
    s_lshl_b32 s38, s38, 5
    s_lshr_b32 s39, s2, 3
    s_add_u32 s38, s38, s39
    s_lshl_b32 s39, s38, 2
    s_add_u32 s39, s39, s41
    s_mul_i32 s40, s41, 24576
    s_lshr_b32 s36, s39, 1
    s_lshl_b32 s36, s36, 2
    s_load_dword s98, s[96:97], s36
    s_lshl_b32 s36, s39, 12
    s_add_u32 s12, s14, s36
    s_addc_u32 s13, s15, 0
    s_mov_b32 s14, 4096
    s_mov_b32 s15, 0x20000
    s_lshr_b32 s45, s30, 2
    s_lshl_b32 s45, s45, 11
    s_add_u32 s36, s45, 0xffffffc0
    v_add_u32 v70, s36, v2
    v_add_u32 v71, 16, v70
    s_add_u32 s36, s45, 0x3c0
    v_add_u32 v72, s36, v2
    v_add_u32 v73, 16, v72
    s_mov_b32 s36, 4032
    v_add_u32 v74, s36, v2
    v_add_u32 v75, 16, v74
    s_and_b32 s34, s2, 7
    s_lshr_b32 s35, s2, 3
    v_mov_b32 v80, 0
    v_mov_b32 v81, 0
    v_mov_b32 v82, 0
    v_mov_b32 v83, 0
    v_add_u32 v86, s40, v2
    ds_write_b128 v86, v[80:83] offset:22784
    s_bfm_b64 exec, 26, 0
    ds_write_b128 v86, v[80:83] offset:23808
    s_mov_b64 exec, -1
    v_lshlrev_b32 v8, 2, v7
    v_sub_u32 v8, 60, v8
    v_lshrrev_b32 v85, 3, v8
    v_bfe_u32 v84, v6, 1, 3
    v_xor_b32 v85, v85, v84
    v_lshlrev_b32 v85, 4, v85
    v_and_b32 v8, 7, v8
    v_lshl_add_u32 v85, v8, 1, v85
    v_lshl_add_u32 v84, v6, 9, v85
    v_add_u32 v84, 98304, v84
    s_waitcnt vmcnt(0)
    s_cmp_lg_u32 s30, 4
    s_cbranch_scc1 KV_t1
KV_t1:
    buffer_load_dwordx4 v[52:55], v70, s[12:15], 0 offen nt
    buffer_load_dwordx2 v[56:57], v71, s[12:15], 0 offen nt
    buffer_load_dwordx4 v[58:61], v72, s[12:15], 0 offen nt
    buffer_load_dwordx2 v[62:63], v73, s[12:15], 0 offen nt
    buffer_load_dwordx4 v[64:67], v74, s[12:15], 0 offen nt
    buffer_load_dwordx2 v[68:69], v75, s[12:15], 0 offen nt
    v_mov_b32 v48, v44
    v_mov_b32 v49, v45
    v_mov_b32 v50, v46
    v_mov_b32 v51, v47
    v_mov_b32 v126, v30
    v_mov_b32 v127, v31
    v_mov_b32 v128, v32
    v_mov_b32 v129, v33
    v_mov_b32 v130, v34
    v_mov_b32 v131, v35
    v_permlane32_swap_b32 v44, v48
    v_permlane32_swap_b32 v45, v49
    v_permlane32_swap_b32 v46, v50
    v_permlane32_swap_b32 v47, v51
    v_permlane32_swap_b32 v22, v126
    v_permlane32_swap_b32 v23, v127
    v_permlane32_swap_b32 v24, v128
    v_permlane32_swap_b32 v25, v129
    v_permlane32_swap_b32 v26, v130
    v_permlane32_swap_b32 v27, v131
    v_lshlrev_b32 v88, 16, v44
    v_and_b32 v90, 0xffff0000, v44
    v_lshlrev_b32 v92, 16, v45
    v_and_b32 v94, 0xffff0000, v45
    v_lshlrev_b32 v89, 16, v46
    v_and_b32 v91, 0xffff0000, v46
    v_lshlrev_b32 v93, 16, v47
    v_and_b32 v95, 0xffff0000, v47
    v_lshlrev_b32 v96, 16, v22
    v_and_b32 v97, 0xffff0000, v22
    v_lshlrev_b32 v98, 16, v24
    v_and_b32 v99, 0xffff0000, v24
    v_lshlrev_b32 v100, 16, v26
    v_and_b32 v101, 0xffff0000, v26
    v_lshlrev_b32 v102, 16, v28
    v_and_b32 v103, 0xffff0000, v28
    v_lshlrev_b32 v104, 16, v30
    v_and_b32 v105, 0xffff0000, v30
    v_lshlrev_b32 v106, 16, v32
    v_and_b32 v107, 0xffff0000, v32
    v_lshlrev_b32 v108, 16, v34
    v_and_b32 v109, 0xffff0000, v34
    v_lshlrev_b32 v110, 16, v36
    v_and_b32 v111, 0xffff0000, v36
    v_lshlrev_b32 v112, 16, v38
    v_and_b32 v113, 0xffff0000, v38
    v_lshlrev_b32 v114, 16, v40
    v_and_b32 v115, 0xffff0000, v40
    v_lshlrev_b32 v116, 16, v42
    v_and_b32 v117, 0xffff0000, v42
    v_pk_mul_f32 v[118:119], v[96:97], v[94:95]
    v_pk_mul_f32 v[120:121], v[98:99], v[94:95]
    v_pk_mul_f32 v[122:123], v[100:101], v[94:95]
    v_pk_mul_f32 v[124:125], v[102:103], v[94:95]
    v_pk_fma_f32 v[118:119], v[98:99], v[92:93], v[118:119]
    v_pk_fma_f32 v[120:121], v[100:101], v[92:93], v[120:121]
    v_pk_fma_f32 v[122:123], v[102:103], v[92:93], v[122:123]
    v_pk_fma_f32 v[124:125], v[104:105], v[92:93], v[124:125]
    v_pk_fma_f32 v[118:119], v[100:101], v[90:91], v[118:119]
    v_pk_fma_f32 v[120:121], v[102:103], v[90:91], v[120:121]
    v_pk_fma_f32 v[122:123], v[104:105], v[90:91], v[122:123]
    v_pk_fma_f32 v[124:125], v[106:107], v[90:91], v[124:125]
    v_pk_fma_f32 v[118:119], v[102:103], v[88:89], v[118:119]
    v_pk_fma_f32 v[120:121], v[104:105], v[88:89], v[120:121]
    v_pk_fma_f32 v[122:123], v[106:107], v[88:89], v[122:123]
    v_pk_fma_f32 v[124:125], v[108:109], v[88:89], v[124:125]
    v_pk_mul_f32 v[118:119], v[118:119], v[110:111]
    v_pk_mul_f32 v[120:121], v[120:121], v[112:113]
    v_pk_mul_f32 v[122:123], v[122:123], v[114:115]
    v_pk_mul_f32 v[124:125], v[124:125], v[116:117]
    v_cvt_pk_bf16_f32 v136, v124, v122
    v_cvt_pk_bf16_f32 v137, v120, v118
    ds_write_b64 v84, v[136:137] offset:0
    v_cvt_pk_bf16_f32 v138, v125, v123
    v_cvt_pk_bf16_f32 v139, v121, v119
    ds_write_b64 v84, v[138:139] offset:128
    v_lshlrev_b32 v88, 16, v48
    v_and_b32 v90, 0xffff0000, v48
    v_lshlrev_b32 v92, 16, v49
    v_and_b32 v94, 0xffff0000, v49
    v_lshlrev_b32 v89, 16, v50
    v_and_b32 v91, 0xffff0000, v50
    v_lshlrev_b32 v93, 16, v51
    v_and_b32 v95, 0xffff0000, v51
    v_lshlrev_b32 v96, 16, v23
    v_and_b32 v97, 0xffff0000, v23
    v_lshlrev_b32 v98, 16, v25
    v_and_b32 v99, 0xffff0000, v25
    v_lshlrev_b32 v100, 16, v27
    v_and_b32 v101, 0xffff0000, v27
    v_lshlrev_b32 v102, 16, v29
    v_and_b32 v103, 0xffff0000, v29
    v_lshlrev_b32 v104, 16, v31
    v_and_b32 v105, 0xffff0000, v31
    v_lshlrev_b32 v106, 16, v33
    v_and_b32 v107, 0xffff0000, v33
    v_lshlrev_b32 v108, 16, v35
    v_and_b32 v109, 0xffff0000, v35
    v_lshlrev_b32 v110, 16, v37
    v_and_b32 v111, 0xffff0000, v37
    v_lshlrev_b32 v112, 16, v39
    v_and_b32 v113, 0xffff0000, v39
    v_lshlrev_b32 v114, 16, v41
    v_and_b32 v115, 0xffff0000, v41
    v_lshlrev_b32 v116, 16, v43
    v_and_b32 v117, 0xffff0000, v43
    v_pk_mul_f32 v[118:119], v[96:97], v[94:95]
    v_pk_mul_f32 v[120:121], v[98:99], v[94:95]
    v_pk_mul_f32 v[122:123], v[100:101], v[94:95]
    v_pk_mul_f32 v[124:125], v[102:103], v[94:95]
    v_pk_fma_f32 v[118:119], v[98:99], v[92:93], v[118:119]
    v_pk_fma_f32 v[120:121], v[100:101], v[92:93], v[120:121]
    v_pk_fma_f32 v[122:123], v[102:103], v[92:93], v[122:123]
    v_pk_fma_f32 v[124:125], v[104:105], v[92:93], v[124:125]
    v_pk_fma_f32 v[118:119], v[100:101], v[90:91], v[118:119]
    v_pk_fma_f32 v[120:121], v[102:103], v[90:91], v[120:121]
    v_pk_fma_f32 v[122:123], v[104:105], v[90:91], v[122:123]
    v_pk_fma_f32 v[124:125], v[106:107], v[90:91], v[124:125]
    v_pk_fma_f32 v[118:119], v[102:103], v[88:89], v[118:119]
    v_pk_fma_f32 v[120:121], v[104:105], v[88:89], v[120:121]
    v_pk_fma_f32 v[122:123], v[106:107], v[88:89], v[122:123]
    v_pk_fma_f32 v[124:125], v[108:109], v[88:89], v[124:125]
    v_pk_mul_f32 v[118:119], v[118:119], v[110:111]
    v_pk_mul_f32 v[120:121], v[120:121], v[112:113]
    v_pk_mul_f32 v[122:123], v[122:123], v[114:115]
    v_pk_mul_f32 v[124:125], v[124:125], v[116:117]
    v_cvt_pk_bf16_f32 v140, v124, v122
    v_cvt_pk_bf16_f32 v141, v120, v118
    ds_write_b64 v84, v[140:141] offset:256
    v_cvt_pk_bf16_f32 v142, v125, v123
    v_cvt_pk_bf16_f32 v143, v121, v119
    ds_write_b64 v84, v[142:143] offset:384
    s_cmp_lg_u32 s30, 4
    s_cbranch_scc1 HB_2
    v_add_u32 v18, 162816, v3
    ds_write_b32 v18, v78
    s_mov_b32 s53, 0
    s_waitcnt vmcnt(6)
HB_p:
    v_readfirstlane_b32 s52, v76
    s_nop 0
    s_cmp_eq_u32 s52, 0
    s_cbranch_scc1 HB_r
    s_cmp_ge_u32 s53, 60
    s_cbranch_scc1 HB_q
    s_add_u32 s54, s46, 8192
    s_lshl_b32 s54, s54, 6
    s_sub_u32 s54, s54, s52
    s_cmp_lt_u32 s54, 786432
    s_cbranch_scc1 HB_q
HB_r:
    buffer_load_dword v76, v78, s[84:87], 0 offen sc1
    s_waitcnt vmcnt(0)
    s_add_u32 s53, s53, 1
    s_cmp_lt_u32 s53, s61
    s_cbranch_scc1 HB_p
    s_mov_b32 s52, 1
    s_mov_b32 s61, 0
HB_q:
    v_mov_b32 v18, 162828
    v_mov_b32 v19, s52
    s_waitcnt lgkmcnt(0)
    ds_write_b32 v18, v19
HB_2:
    s_add_u32 s16, s4, 0x2000000
    s_addc_u32 s17, s5, 0
    s_mov_b32 s18, 0x8000000
    s_mov_b32 s19, 0x20000
    v_lshrrev_b32 v8, 3, v0
    v_and_b32 v85, 7, v0
    v_lshlrev_b32 v149, 12, v8
    v_lshl_add_u32 v149, v85, 4, v149
    s_lshl_b32 s36, s34, 24
    s_sub_u32 s37, 31, s35
    s_lshl_b32 s37, s37, 7
    s_add_u32 s36, s36, s37
    s_add_u32 s37, s36, 262144
    v_lshrrev_b32 v148, 3, v8
    v_xor_b32 v148, v148, v85
    v_lshlrev_b32 v148, 4, v148
    v_lshl_add_u32 v148, v8, 7, v148
    v_add_u32 v148, 98304, v148
    v_mov_b32 v18, 162828
    s_waitcnt lgkmcnt(0)
    s_barrier
    ds_read_b128 v[152:155], v148 offset:0
    ds_read_b128 v[156:159], v148 offset:8192
    ds_read_b32 v19, v18
    s_waitcnt lgkmcnt(2)
    v_or_b32 v152, 1, v152
    buffer_store_dwordx4 v[152:155], v149, s[16:19], s36 offen sc1
    s_waitcnt lgkmcnt(1)
    v_or_b32 v156, 1, v156
    buffer_store_dwordx4 v[156:159], v149, s[16:19], s37 offen sc1
    s_waitcnt lgkmcnt(0)
    v_readfirstlane_b32 s52, v19
    s_cmp_lg_u32 s30, 0
    s_cbranch_scc1 KV_ni
    s_cmp_ge_u32 s35, 16
    s_cbranch_scc1 KV_ni
    v_mov_b32 v8, s52
    s_lshl_b32 s37, s34, 7
    s_lshl_b32 s53, s35, 10
    s_add_u32 s37, s37, s53
    s_add_u32 s37, s37, 23101440
    s_mov_b64 exec, 1
    buffer_store_dword v8, v78, s[56:59], s37 offen sc1
    s_mov_b64 exec, -1
KV_ni:
    s_cmp_ge_u32 s2, 32
    s_cbranch_scc1 KV_n3
    s_cmp_lg_u32 s30, 5
    s_cbranch_scc1 KV_n3
    s_and_b32 s42, s2, 7
    s_lshl_b32 s42, s42, 10
    s_lshr_b32 s43, s2, 3
    s_lshl_b32 s43, s43, 14
    s_add_u32 s42, s42, s43
    s_add_u32 s42, s42, 39714816
    v_lshrrev_b32 v8, 5, v1
    v_mul_u32_u24 v8, 7680, v8
    v_add_u32 v8, v8, v2
    buffer_store_dwordx4 v[80:83], v8, s[56:59], s42 offen sc1
KV_n3:
    s_bfe_u32 s32, s52, 0x30001
    s_add_u32 s32, s32, s2
    s_and_b32 s32, s32, 7
    s_lshr_b32 s33, s2, 3
    s_and_b32 s28, s32, 2
    s_lshr_b32 s53, s32, 2
    s_or_b32 s28, s28, s53
    s_lshl_b32 s28, s28, 2
    s_and_b32 s53, s33, 3
    s_add_u32 s28, s28, s53
    s_and_b32 s31, s32, 1
    s_lshr_b32 s33, s33, 2
    s_lshl_b32 s29, s31, 3
    s_add_u32 s29, s29, s33
    s_xor_b32 s99, s29, 1
    v_and_b32 v199, 7, v0
    v_lshrrev_b32 v228, 6, v0
    v_lshlrev_b32 v228, 4, v228
    v_bfe_u32 v229, v0, 3, 3
    v_add_u32 v228, v228, v229
    s_lshr_b32 s78, s29, 1
    s_lshl_b32 s78, s78, 16
    s_and_b32 s79, s29, 1
    s_lshl_b32 s79, s79, 7
    s_add_u32 s78, s78, s79
    s_lshr_b32 s79, s30, 1
    s_lshl_b32 s79, s79, 13
    s_add_u32 s78, s78, s79
    v_lshlrev_b32 v196, 8, v228
    v_lshl_add_u32 v196, v199, 4, v196
    v_add_u32 v196, s78, v196
    s_lshl_b32 s78, s28, 7
    s_lshl_b32 s79, s29, 3
    s_add_u32 s78, s78, s79
    v_add_u32 v197, s78, v199
    v_lshlrev_b32 v198, 11, v197
    v_lshrrev_b32 v229, 2, v228
    v_lshlrev_b32 v229, 3, v229
    v_and_b32 v228, 3, v228
    v_add_u32 v228, v228, v229
    v_lshl_add_u32 v198, v228, 3, v198
    v_and_b32 v197, 15, v197
    v_lshlrev_b32 v197, 4, v197
    v_and_b32 v229, 15, v228
    v_lshl_add_u32 v197, v229, 9, v197
    v_lshrrev_b32 v229, 4, v228
    v_lshl_add_u32 v197, v229, 14, v197
    s_lshr_b32 s78, s28, 3
    s_lshl_b32 s78, s78, 2
    s_and_b32 s79, s28, 3
    s_add_u32 s78, s78, s79
    s_lshl_b32 s78, s78, 24
    s_and_b32 s79, s28, 4
    s_lshl_b32 s79, s79, 11
    s_add_u32 s78, s78, s79
    s_and_b32 s79, s29, 4
    s_lshl_b32 s79, s79, 6
    s_add_u32 s78, s78, s79
    s_and_b32 s79, s29, 2
    s_lshl_b32 s79, s79, 2
    s_add_u32 s78, s78, s79
    s_lshl_b32 s79, s31, 18
    s_add_u32 s78, s78, s79
    v_add_u32 v197, s78, v197
    s_lshl_b32 s36, s34, 5
    s_add_u32 s36, s36, s35
    s_lshl_b32 s36, s36, 7
    s_add_u32 s36, s36, 23068672
    v_mov_b32 v18, 1
    v_mov_b32 v19, 162820
    v_mov_b32 v21, 0
    s_mov_b64 exec, 1
    s_waitcnt vmcnt(0)
    ds_add_rtn_u32 v20, v19, v18
    v_mov_b32 v19, s52
    s_waitcnt lgkmcnt(0)
    v_readfirstlane_b32 s54, v20
    s_nop 0
    s_and_b32 s54, s54, 7
    s_cmp_lg_u32 s54, 7
    s_cbranch_scc1 pub_1
    buffer_store_dword v19, v21, s[56:59], s36 offen sc1
pub_1:
    s_mov_b64 exec, -1
    s_mov_b32 s8, s6
    s_mov_b32 s9, s7
    s_mov_b32 s10, 0x400000
    s_mov_b32 s11, 0x20000
    buffer_load_dwordx2 v[180:181], v198, s[8:11], 0 offen offset:0 nt
    buffer_load_dwordx2 v[182:183], v198, s[8:11], 0 offen offset:32 nt
    buffer_load_dwordx2 v[184:185], v198, s[8:11], 0 offen offset:128 nt
    buffer_load_dwordx2 v[186:187], v198, s[8:11], 0 offen offset:160 nt
    v_add_u32 v160, s45, v86
    v_alignbit_b32 v88, v53, v52, 16
    v_mov_b32 v92, v53
    v_alignbit_b32 v96, v54, v53, 16
    v_alignbit_b32 v89, v54, v53, 16
    v_mov_b32 v93, v54
    v_alignbit_b32 v97, v55, v54, 16
    v_alignbit_b32 v90, v55, v54, 16
    v_mov_b32 v94, v55
    v_alignbit_b32 v98, v56, v55, 16
    v_alignbit_b32 v91, v56, v55, 16
    v_mov_b32 v95, v56
    v_alignbit_b32 v99, v57, v56, 16
    ds_write_b128 v160, v[88:91] offset:0
    ds_write_b128 v160, v[92:95] offset:4160
    ds_write_b128 v160, v[96:99] offset:8320
    ds_write_b128 v160, v[54:57] offset:12480
    v_alignbit_b32 v100, v59, v58, 16
    v_mov_b32 v104, v59
    v_alignbit_b32 v108, v60, v59, 16
    v_alignbit_b32 v101, v60, v59, 16
    v_mov_b32 v105, v60
    v_alignbit_b32 v109, v61, v60, 16
    v_alignbit_b32 v102, v61, v60, 16
    v_mov_b32 v106, v61
    v_alignbit_b32 v110, v62, v61, 16
    v_alignbit_b32 v103, v62, v61, 16
    v_mov_b32 v107, v62
    v_alignbit_b32 v111, v63, v62, 16
    ds_write_b128 v160, v[100:103] offset:1024
    ds_write_b128 v160, v[104:107] offset:5184
    ds_write_b128 v160, v[108:111] offset:9344
    ds_write_b128 v160, v[60:63] offset:13504
    v_alignbit_b32 v112, v65, v64, 16
    v_mov_b32 v116, v65
    v_alignbit_b32 v120, v66, v65, 16
    v_alignbit_b32 v113, v66, v65, 16
    v_mov_b32 v117, v66
    v_alignbit_b32 v121, v67, v66, 16
    v_alignbit_b32 v114, v67, v66, 16
    v_mov_b32 v118, v67
    v_alignbit_b32 v122, v68, v67, 16
    v_alignbit_b32 v115, v68, v67, 16
    v_mov_b32 v119, v68
    v_alignbit_b32 v123, v69, v68, 16
    s_mov_b64 exec, 0xf
    ds_write_b128 v86, v[112:115] offset:4096
    ds_write_b128 v86, v[116:119] offset:8256
    ds_write_b128 v86, v[120:123] offset:12416
    ds_write_b128 v86, v[66:69] offset:16576
    s_mov_b64 exec, -1
    s_waitcnt lgkmcnt(0)
    s_barrier
    v_mov_b32 v238, 0
    v_mov_b32 v239, 0
    v_mov_b32 v240, 0
    v_mov_b32 v241, 0
    v_mov_b32 v242, 0
    v_mov_b32 v243, 0
    v_mov_b32 v244, 0
    v_mov_b32 v245, 0
    v_mov_b32 v246, 0
    v_mov_b32 v247, 0
    s_cmp_ge_u32 s30, 4
    s_cbranch_scc1 FR_b
    s_and_b32 s38, s2, 7
    s_lshl_b32 s38, s38, 5
    s_lshr_b32 s39, s2, 3
    s_add_u32 s38, s38, s39
    s_lshl_b32 s39, s38, 2
    s_add_u32 s39, s39, s30
    s_mul_i32 s40, s30, 24576
    s_and_b32 s36, s39, 127
    s_lshl_b32 s36, s36, 12
    s_lshr_b32 s37, s39, 7
    s_lshl_b32 s37, s37, 24
    s_add_u32 s36, s36, s37
    s_add_u32 s36, s36, 33554432
    s_add_u32 s16, s4, s36
    s_addc_u32 s17, s5, 0
    s_mov_b32 s18, 4096
    s_mov_b32 s19, 0x20000
    v_lshrrev_b32 v6, 2, v1
    v_mul_u32_u24 v12, 96, v6
    v_and_b32 v6, 3, v1
    v_lshl_add_u32 v12, v6, 4, v12
    v_add_u32 v12, s40, v12
    v_and_b32 v35, 15, v1
    v_lshrrev_b32 v36, 4, v1
    v_and_b32 v6, 3, v35
    v_mul_u32_u24 v32, 4160, v6
    v_lshl_add_u32 v32, v36, 4, v32
    v_lshrrev_b32 v6, 2, v35
    v_lshl_add_u32 v32, v6, 3, v32
    v_add_u32 v32, s40, v32
    v_sub_u32 v6, 15, v35
    v_mul_u32_u24 v34, 96, v6
    v_add_u32 v34, s40, v34
    v_lshl_add_u32 v33, v36, 4, v34
    ds_read_b64 v[72:73], v32 offset:0
    ds_read_b64 v[74:75], v32 offset:8
    ds_read_b64 v[76:77], v32 offset:32
    ds_read_b64 v[78:79], v32 offset:40
    ds_read_b64 v[80:81], v32 offset:1024
    ds_read_b64 v[82:83], v32 offset:1032
    ds_read_b64 v[84:85], v32 offset:1056
    ds_read_b64 v[86:87], v32 offset:1064
    ds_read_b64 v[88:89], v32 offset:2048
    ds_read_b64 v[90:91], v32 offset:2056
    ds_read_b64 v[92:93], v32 offset:2080
    ds_read_b64 v[94:95], v32 offset:2088
    ds_read_b64 v[96:97], v32 offset:3072
    ds_read_b64 v[98:99], v32 offset:3080
    ds_read_b64 v[100:101], v32 offset:3104
    ds_read_b64 v[102:103], v32 offset:3112
    s_bitcmp1_b32 s39, 0
    s_cselect_b32 s36, 0, 16
    s_lshl_b32 s41, s98, s36
    s_and_b32 s41, s41, 0xffff0000
    s_lshr_b32 s36, s41, 16
    v_lshl_add_u32 v6, v36, 3, v35
    v_sub_u32 v6, 31, v6
    v_mov_b32 v10, s36
    v_mov_b32 v11, s41
    v_and_b32 v8, 1, v6
    v_cmp_eq_u32 vcc, 1, v8
    s_nop 1
    v_cndmask_b32 v10, v10, v11, vcc
    v_ashrrev_i32 v6, 1, v6
    v_cmp_eq_u32 vcc, 0, v6
    s_nop 1
    v_cndmask_b32 v152, 0, v10, vcc
    v_cmp_eq_u32 vcc, 1, v6
    s_nop 1
    v_cndmask_b32 v153, 0, v10, vcc
    v_cmp_eq_u32 vcc, 2, v6
    s_nop 1
    v_cndmask_b32 v154, 0, v10, vcc
    v_cmp_eq_u32 vcc, 3, v6
    s_nop 1
    v_cndmask_b32 v155, 0, v10, vcc
    v_cmp_eq_u32 vcc, 8, v6
    s_nop 1
    v_cndmask_b32 v156, 0, v10, vcc
    v_cmp_eq_u32 vcc, 9, v6
    s_nop 1
    v_cndmask_b32 v157, 0, v10, vcc
    v_cmp_eq_u32 vcc, 10, v6
    s_nop 1
    v_cndmask_b32 v158, 0, v10, vcc
    v_cmp_eq_u32 vcc, 11, v6
    s_nop 1
    v_cndmask_b32 v159, 0, v10, vcc
    s_add_u32 s12, s4, 0x2100000
    s_addc_u32 s13, s5, 0
    s_mov_b32 s14, 0x7f00000
    s_mov_b32 s15, 0x20000
    v_bfe_u32 v6, v1, 2, 2
    v_mul_u32_u24 v168, 24640, v6
    v_mul_u32_u24 v6, 72, v36
    v_add_u32 v168, v168, v6
    v_and_b32 v6, 3, v1
    v_lshl_add_u32 v168, v6, 3, v168
    s_mul_i32 s36, s30, 1152
    v_add_u32 v168, s36, v168
    v_lshrrev_b32 v6, 5, v1
    v_mul_u32_u24 v169, 261632, v6
    v_add_u32 v169, v169, v2
    s_lshr_b32 s44, s38, 4
    s_lshl_b32 s44, s44, 14
    s_and_b32 s37, s38, 15
    s_lshl_b32 s37, s37, 9
    s_add_u32 s44, s44, s37
    s_and_b32 s37, s30, 1
    s_lshl_b32 s37, s37, 13
    s_add_u32 s44, s44, s37
    s_lshr_b32 s37, s30, 1
    s_lshl_b32 s37, s37, 26
    s_add_u32 s44, s44, s37
    s_and_b32 s47, s44, 0x2000
    s_xor_b32 s47, s47, 8192
    s_lshr_b32 s37, s30, 1
    s_lshl_b32 s37, s37, 12
    s_add_u32 s47, s47, s37
    s_and_b32 s37, s2, 7
    s_lshl_b32 s37, s37, 7
    s_add_u32 s47, s47, s37
    v_mov_b32 v34, 162824
    v_mov_b32 v7, 1
    s_mul_i32 s36, s30, 24640
    v_mul_u32_u24 v170, 72, v35
    v_lshl_add_u32 v170, v36, 3, v170
    v_add_u32 v170, s36, v170
    v_lshlrev_b32 v6, 10, v1
    v_mov_b32 v35, 0
    s_and_b32 s45, s2, 31
    s_lshl_b32 s45, s45, 7
    s_add_u32 s45, s45, 23117824
    s_cmp_lg_u32 s30, 0
    s_cbranch_scc1 CV_w
    s_and_b32 s36, s2, 7
    s_lshl_b32 s36, s36, 12
    s_add_u32 s36, s36, 23068672
    v_lshlrev_b32 v9, 7, v1
    v_add_u32 v9, s36, v9
    s_mov_b32 s53, 0
    s_add_u32 s54, s52, 0
    s_bfm_b64 exec, 32, 0
poll_2:
    buffer_load_dword v8, v9, s[56:59], 0 offen sc1
    s_waitcnt vmcnt(0)
    v_xor_b32 v8, s54, v8
    v_cmp_eq_u32 vcc, 0, v8
    s_nop 0
    s_cmp_eq_u64 vcc, exec
    s_cbranch_scc1 pok_3
    s_sleep 5
    s_add_u32 s53, s53, 1
    s_cmp_lt_u32 s53, s61
    s_cbranch_scc1 poll_2
    s_mov_b32 s61, 0
pok_3:
    s_mov_b64 exec, -1
    v_mov_b32 v8, 162832
    v_mov_b32 v9, 1
    s_waitcnt lgkmcnt(0)
    ds_write_b32 v8, v9
CV_w:
    v_mov_b32 v8, 162832
spin_4:
    ds_read_b32 v9, v8
    s_waitcnt lgkmcnt(0)
    v_readfirstlane_b32 s53, v9
    s_nop 0
    s_cmp_ge_u32 s53, 1
    s_cbranch_scc0 spin_4
    buffer_load_dwordx4 v[16:19], v2, s[16:19], 0 offen offset:0 sc1 nt
    buffer_load_dwordx4 v[20:23], v2, s[16:19], 0 offen offset:1024 sc1 nt
    buffer_load_dwordx4 v[24:27], v2, s[16:19], 0 offen offset:2048 sc1 nt
    buffer_load_dwordx4 v[28:31], v2, s[16:19], 0 offen offset:3072 sc1 nt
    s_waitcnt vmcnt(3)
    ds_write_b128 v12, v[16:19] offset:16640
    s_waitcnt vmcnt(2)
    ds_write_b128 v12, v[20:23] offset:18176
    s_waitcnt vmcnt(1)
    ds_write_b128 v12, v[24:27] offset:19712
    s_waitcnt vmcnt(0)
    ds_write_b128 v12, v[28:31] offset:21248
    v_mov_b32 v8, 162836
    v_mov_b32 v9, 1
    s_mov_b64 exec, 1
    ds_add_u32 v8, v9
    s_mov_b64 exec, -1
    s_waitcnt lgkmcnt(0)
    ds_read_b128 v[136:139], v33 offset:21248
    ds_read_b128 v[140:143], v33 offset:19712
    ds_read_b128 v[144:147], v33 offset:18176
    ds_read_b128 v[148:151], v33 offset:16640
    s_waitcnt lgkmcnt(3)
    v_mfma_f32_16x16x32_bf16 v[40:43], v[152:155], v[136:139], 0
    v_mfma_f32_16x16x32_bf16 v[44:47], v[156:159], v[136:139], 0
    s_waitcnt lgkmcnt(2)
    v_mfma_f32_16x16x32_bf16 v[48:51], v[152:155], v[140:143], 0
    v_mfma_f32_16x16x32_bf16 v[52:55], v[156:159], v[140:143], 0
    s_waitcnt lgkmcnt(1)
    v_mfma_f32_16x16x32_bf16 v[56:59], v[152:155], v[144:147], 0
    v_mfma_f32_16x16x32_bf16 v[60:63], v[156:159], v[144:147], 0
    s_waitcnt lgkmcnt(0)
    v_mfma_f32_16x16x32_bf16 v[64:67], v[152:155], v[148:151], 0
    v_mfma_f32_16x16x32_bf16 v[68:71], v[156:159], v[148:151], 0
    s_mov_b32 s43, 0
CV_r:
    s_waitcnt lgkmcnt(0)
    v_mfma_f32_16x16x32_bf16 v[40:43], v[72:75], v[136:139], v[40:43]
    v_mfma_f32_16x16x32_bf16 v[48:51], v[72:75], v[140:143], v[48:51]
    v_mfma_f32_16x16x32_bf16 v[56:59], v[72:75], v[144:147], v[56:59]
    v_mfma_f32_16x16x32_bf16 v[64:67], v[72:75], v[148:151], v[64:67]
    v_mfma_f32_16x16x32_bf16 v[44:47], v[76:79], v[136:139], v[44:47]
    v_mfma_f32_16x16x32_bf16 v[52:55], v[76:79], v[140:143], v[52:55]
    v_mfma_f32_16x16x32_bf16 v[60:63], v[76:79], v[144:147], v[60:63]
    v_mfma_f32_16x16x32_bf16 v[68:71], v[76:79], v[148:151], v[68:71]
    v_mfma_f32_16x16x32_bf16 v[48:51], v[80:83], v[136:139], v[48:51]
    v_mfma_f32_16x16x32_bf16 v[56:59], v[80:83], v[140:143], v[56:59]
    v_mfma_f32_16x16x32_bf16 v[64:67], v[80:83], v[144:147], v[64:67]
    v_mfma_f32_16x16x32_bf16 v[52:55], v[84:87], v[136:139], v[52:55]
    v_mfma_f32_16x16x32_bf16 v[60:63], v[84:87], v[140:143], v[60:63]
    v_mfma_f32_16x16x32_bf16 v[68:71], v[84:87], v[144:147], v[68:71]
    v_mfma_f32_16x16x32_bf16 v[56:59], v[88:91], v[136:139], v[56:59]
    v_mfma_f32_16x16x32_bf16 v[64:67], v[88:91], v[140:143], v[64:67]
    v_mfma_f32_16x16x32_bf16 v[60:63], v[92:95], v[136:139], v[60:63]
    v_mfma_f32_16x16x32_bf16 v[68:71], v[92:95], v[140:143], v[68:71]
    v_mfma_f32_16x16x32_bf16 v[64:67], v[96:99], v[136:139], v[64:67]
    v_mfma_f32_16x16x32_bf16 v[68:71], v[100:103], v[136:139], v[68:71]
    ds_read_b128 v[152:155], v33 offset:21344
    ds_read_b128 v[156:159], v33 offset:19808
    ds_read_b128 v[160:163], v33 offset:18272
    ds_read_b128 v[164:167], v33 offset:16736
    ds_read_b64 v[104:105], v32 offset:64
    ds_read_b64 v[106:107], v32 offset:72
    ds_read_b64 v[108:109], v32 offset:96
    ds_read_b64 v[110:111], v32 offset:104
    ds_read_b64 v[112:113], v32 offset:1088
    ds_read_b64 v[114:115], v32 offset:1096
    ds_read_b64 v[116:117], v32 offset:1120
    ds_read_b64 v[118:119], v32 offset:1128
    ds_read_b64 v[120:121], v32 offset:2112
    ds_read_b64 v[122:123], v32 offset:2120
    ds_read_b64 v[124:125], v32 offset:2144
    ds_read_b64 v[126:127], v32 offset:2152
    ds_read_b64 v[128:129], v32 offset:3136
    ds_read_b64 v[130:131], v32 offset:3144
    ds_read_b64 v[132:133], v32 offset:3168
    ds_read_b64 v[134:135], v32 offset:3176
    s_waitcnt lgkmcnt(0)
    v_mfma_f32_16x16x32_bf16 v[40:43], v[104:107], v[152:155], v[40:43]
    v_mfma_f32_16x16x32_bf16 v[48:51], v[104:107], v[156:159], v[48:51]
    v_mfma_f32_16x16x32_bf16 v[56:59], v[104:107], v[160:163], v[56:59]
    v_mfma_f32_16x16x32_bf16 v[64:67], v[104:107], v[164:167], v[64:67]
    v_mfma_f32_16x16x32_bf16 v[44:47], v[108:111], v[152:155], v[44:47]
    v_mfma_f32_16x16x32_bf16 v[52:55], v[108:111], v[156:159], v[52:55]
    v_mfma_f32_16x16x32_bf16 v[60:63], v[108:111], v[160:163], v[60:63]
    v_mfma_f32_16x16x32_bf16 v[68:71], v[108:111], v[164:167], v[68:71]
    v_mfma_f32_16x16x32_bf16 v[48:51], v[112:115], v[152:155], v[48:51]
    v_mfma_f32_16x16x32_bf16 v[56:59], v[112:115], v[156:159], v[56:59]
    v_mfma_f32_16x16x32_bf16 v[64:67], v[112:115], v[160:163], v[64:67]
    v_mfma_f32_16x16x32_bf16 v[52:55], v[116:119], v[152:155], v[52:55]
    v_mfma_f32_16x16x32_bf16 v[60:63], v[116:119], v[156:159], v[60:63]
    v_mfma_f32_16x16x32_bf16 v[68:71], v[116:119], v[160:163], v[68:71]
    v_mfma_f32_16x16x32_bf16 v[56:59], v[120:123], v[152:155], v[56:59]
    v_mfma_f32_16x16x32_bf16 v[64:67], v[120:123], v[156:159], v[64:67]
    v_mfma_f32_16x16x32_bf16 v[60:63], v[124:127], v[152:155], v[60:63]
    v_mfma_f32_16x16x32_bf16 v[68:71], v[124:127], v[156:159], v[68:71]
    v_mfma_f32_16x16x32_bf16 v[64:67], v[128:131], v[152:155], v[64:67]
    v_mfma_f32_16x16x32_bf16 v[68:71], v[132:135], v[152:155], v[68:71]
    ds_read_b128 v[136:139], v33 offset:21440
    ds_read_b128 v[140:143], v33 offset:19904
    ds_read_b128 v[144:147], v33 offset:18368
    ds_read_b128 v[148:151], v33 offset:16832
    ds_read_b64 v[72:73], v32 offset:128
    ds_read_b64 v[74:75], v32 offset:136
    ds_read_b64 v[76:77], v32 offset:160
    ds_read_b64 v[78:79], v32 offset:168
    ds_read_b64 v[80:81], v32 offset:1152
    ds_read_b64 v[82:83], v32 offset:1160
    ds_read_b64 v[84:85], v32 offset:1184
    ds_read_b64 v[86:87], v32 offset:1192
    ds_read_b64 v[88:89], v32 offset:2176
    ds_read_b64 v[90:91], v32 offset:2184
    ds_read_b64 v[92:93], v32 offset:2208
    ds_read_b64 v[94:95], v32 offset:2216
    ds_read_b64 v[96:97], v32 offset:3200
    ds_read_b64 v[98:99], v32 offset:3208
    ds_read_b64 v[100:101], v32 offset:3232
    ds_read_b64 v[102:103], v32 offset:3240
    v_add_u32 v32, 128, v32
    v_add_u32 v33, 192, v33
    s_add_u32 s43, s43, 1
    s_cmp_lt_u32 s43, 4
    s_cbranch_scc1 CV_r
CV_l:
    s_waitcnt lgkmcnt(10)
    v_mfma_f32_16x16x32_bf16 v[40:43], v[72:75], v[136:139], v[40:43]
    ds_read_b128 v[152:155], v33 offset:21344
    v_mfma_f32_16x16x32_bf16 v[48:51], v[72:75], v[140:143], v[48:51]
    ds_read_b128 v[156:159], v33 offset:19808
    s_cmp_eq_u32 s43, 5
    v_mfma_f32_16x16x32_bf16 v[56:59], v[72:75], v[144:147], v[56:59]
    ds_read_b128 v[160:163], v33 offset:18272
    s_cselect_b64 exec, 1, 0
    buffer_load_dword v12, v35, s[56:59], s45 offen sc1
    s_mov_b64 exec, -1
    v_mfma_f32_16x16x32_bf16 v[64:67], v[72:75], v[148:151], v[64:67]
    ds_read_b128 v[164:167], v33 offset:16736
    v_mfma_f32_16x16x32_bf16 v[44:47], v[76:79], v[136:139], v[44:47]
    ds_read_b64 v[104:105], v32 offset:64
    v_mfma_f32_16x16x32_bf16 v[52:55], v[76:79], v[140:143], v[52:55]
    ds_read_b64 v[106:107], v32 offset:72
    v_mfma_f32_16x16x32_bf16 v[60:63], v[76:79], v[144:147], v[60:63]
    ds_read_b64 v[108:109], v32 offset:96
    v_mfma_f32_16x16x32_bf16 v[68:71], v[76:79], v[148:151], v[68:71]
    ds_read_b64 v[110:111], v32 offset:104
    v_mfma_f32_16x16x32_bf16 v[48:51], v[80:83], v[136:139], v[48:51]
    ds_read_b64 v[112:113], v32 offset:1088
    v_mfma_f32_16x16x32_bf16 v[56:59], v[80:83], v[140:143], v[56:59]
    ds_read_b64 v[114:115], v32 offset:1096
    s_waitcnt lgkmcnt(10)
    v_mfma_f32_16x16x32_bf16 v[64:67], v[80:83], v[144:147], v[64:67]
    ds_read_b64 v[116:117], v32 offset:1120
    v_mfma_f32_16x16x32_bf16 v[52:55], v[84:87], v[136:139], v[52:55]
    ds_read_b64 v[118:119], v32 offset:1128
    v_mfma_f32_16x16x32_bf16 v[60:63], v[84:87], v[140:143], v[60:63]
    ds_read_b64 v[120:121], v32 offset:2112
    v_mfma_f32_16x16x32_bf16 v[68:71], v[84:87], v[144:147], v[68:71]
    ds_read_b64 v[122:123], v32 offset:2120
    v_mfma_f32_16x16x32_bf16 v[56:59], v[88:91], v[136:139], v[56:59]
    ds_read_b64 v[124:125], v32 offset:2144
    v_mfma_f32_16x16x32_bf16 v[64:67], v[88:91], v[140:143], v[64:67]
    ds_read_b64 v[126:127], v32 offset:2152
    v_mfma_f32_16x16x32_bf16 v[60:63], v[92:95], v[136:139], v[60:63]
    ds_read_b64 v[128:129], v32 offset:3136
    v_mfma_f32_16x16x32_bf16 v[68:71], v[92:95], v[140:143], v[68:71]
    ds_read_b64 v[130:131], v32 offset:3144
    v_mfma_f32_16x16x32_bf16 v[64:67], v[96:99], v[136:139], v[64:67]
    ds_read_b64 v[132:133], v32 offset:3168
    v_mfma_f32_16x16x32_bf16 v[68:71], v[100:103], v[136:139], v[68:71]
    ds_read_b64 v[134:135], v32 offset:3176
    s_waitcnt lgkmcnt(10)
    v_mfma_f32_16x16x32_bf16 v[40:43], v[104:107], v[152:155], v[40:43]
    ds_read_b128 v[136:139], v33 offset:21440
    v_mfma_f32_16x16x32_bf16 v[48:51], v[104:107], v[156:159], v[48:51]
    ds_read_b128 v[140:143], v33 offset:19904
    v_mfma_f32_16x16x32_bf16 v[56:59], v[104:107], v[160:163], v[56:59]
    ds_read_b128 v[144:147], v33 offset:18368
    v_mfma_f32_16x16x32_bf16 v[64:67], v[104:107], v[164:167], v[64:67]
    ds_read_b128 v[148:151], v33 offset:16832
    v_mfma_f32_16x16x32_bf16 v[44:47], v[108:111], v[152:155], v[44:47]
    ds_read_b64 v[72:73], v32 offset:128
    v_mfma_f32_16x16x32_bf16 v[52:55], v[108:111], v[156:159], v[52:55]
    ds_read_b64 v[74:75], v32 offset:136
    v_add_u32 v33, 192, v33
    v_mfma_f32_16x16x32_bf16 v[60:63], v[108:111], v[160:163], v[60:63]
    ds_read_b64 v[76:77], v32 offset:160
    s_add_u32 s43, s43, 1
    v_mfma_f32_16x16x32_bf16 v[68:71], v[108:111], v[164:167], v[68:71]
    ds_read_b64 v[78:79], v32 offset:168
    s_cmp_lt_u32 s43, 8
    v_mfma_f32_16x16x32_bf16 v[48:51], v[112:115], v[152:155], v[48:51]
    ds_read_b64 v[80:81], v32 offset:1152
    v_mfma_f32_16x16x32_bf16 v[56:59], v[112:115], v[156:159], v[56:59]
    ds_read_b64 v[82:83], v32 offset:1160
    s_waitcnt lgkmcnt(10)
    v_mfma_f32_16x16x32_bf16 v[64:67], v[112:115], v[160:163], v[64:67]
    ds_read_b64 v[84:85], v32 offset:1184
    v_mfma_f32_16x16x32_bf16 v[52:55], v[116:119], v[152:155], v[52:55]
    ds_read_b64 v[86:87], v32 offset:1192
    v_mfma_f32_16x16x32_bf16 v[60:63], v[116:119], v[156:159], v[60:63]
    ds_read_b64 v[88:89], v32 offset:2176
    v_mfma_f32_16x16x32_bf16 v[68:71], v[116:119], v[160:163], v[68:71]
    ds_read_b64 v[90:91], v32 offset:2184
    v_mfma_f32_16x16x32_bf16 v[56:59], v[120:123], v[152:155], v[56:59]
    ds_read_b64 v[92:93], v32 offset:2208
    v_mfma_f32_16x16x32_bf16 v[64:67], v[120:123], v[156:159], v[64:67]
    ds_read_b64 v[94:95], v32 offset:2216
    v_mfma_f32_16x16x32_bf16 v[60:63], v[124:127], v[152:155], v[60:63]
    ds_read_b64 v[96:97], v32 offset:3200
    v_mfma_f32_16x16x32_bf16 v[68:71], v[124:127], v[156:159], v[68:71]
    ds_read_b64 v[98:99], v32 offset:3208
    v_mfma_f32_16x16x32_bf16 v[64:67], v[128:131], v[152:155], v[64:67]
    ds_read_b64 v[100:101], v32 offset:3232
    v_mfma_f32_16x16x32_bf16 v[68:71], v[132:135], v[152:155], v[68:71]
    ds_read_b64 v[102:103], v32 offset:3240
    v_add_u32 v32, 128, v32
    s_cbranch_scc1 CV_l
    v_cvt_pk_bf16_f32 v16, v40, v41
    v_cvt_pk_bf16_f32 v17, v42, v43
    ds_write_b64 v170, v[16:17] offset:0
    v_cvt_pk_bf16_f32 v18, v44, v45
    v_cvt_pk_bf16_f32 v19, v46, v47
    ds_write_b64 v170, v[18:19] offset:32
    v_cvt_pk_bf16_f32 v20, v48, v49
    v_cvt_pk_bf16_f32 v21, v50, v51
    ds_write_b64 v170, v[20:21] offset:1152
    v_cvt_pk_bf16_f32 v22, v52, v53
    v_cvt_pk_bf16_f32 v23, v54, v55
    ds_write_b64 v170, v[22:23] offset:1184
    v_cvt_pk_bf16_f32 v24, v56, v57
    v_cvt_pk_bf16_f32 v25, v58, v59
    ds_write_b64 v170, v[24:25] offset:2304
    v_cvt_pk_bf16_f32 v26, v60, v61
    v_cvt_pk_bf16_f32 v27, v62, v63
    ds_write_b64 v170, v[26:27] offset:2336
    v_cvt_pk_bf16_f32 v28, v64, v65
    v_cvt_pk_bf16_f32 v29, v66, v67
    ds_write_b64 v170, v[28:29] offset:3456
    v_cvt_pk_bf16_f32 v30, v68, v69
    v_cvt_pk_bf16_f32 v31, v70, v71
    ds_write_b64 v170, v[30:31] offset:3488
    s_mov_b64 exec, 1
    ds_add_u32 v34, v7
    s_mov_b64 exec, -1
    s_mov_b32 s53, 0
    s_waitcnt vmcnt(0)
CV_v:
    v_readfirstlane_b32 s94, v12
    s_nop 0
    s_sub_u32 s94, s94, s52
    s_and_b32 s37, s94, 0xfffffe01
    s_cbranch_scc0 CV_k
    buffer_load_dword v12, v35, s[56:59], s45 offen sc1
    s_waitcnt vmcnt(0)
    s_add_u32 s53, s53, 1
    s_cmp_lt_u32 s53, s61
    s_cbranch_scc1 CV_v
    s_mov_b32 s61, 0
    s_mov_b32 s94, 0
CV_k:
    s_lshr_b32 s94, s94, 1
    s_add_u32 s37, s94, 65536
    v_mov_b32 v8, 162844
    v_mov_b32 v9, s37
    ds_write_b32 v8, v9
    s_cmp_gt_u32 s94, 10
    s_cselect_b32 s37, 0x2000, 0
    s_xor_b32 s44, s44, s37
    s_xor_b32 s45, s47, s37
    s_add_u32 s45, s45, 23101440
    v_mov_b32 v8, 162824
spin_5:
    ds_read_b32 v9, v8
    s_waitcnt lgkmcnt(0)
    v_readfirstlane_b32 s53, v9
    s_nop 0
    s_cmp_ge_u32 s53, 6
    s_cbranch_scc0 spin_5
    ds_read_b64_tr_b16 v[104:105], v168 offset:0
    ds_read_b64_tr_b16 v[106:107], v168 offset:32
    ds_read_b64_tr_b16 v[108:109], v168 offset:288
    ds_read_b64_tr_b16 v[110:111], v168 offset:320
    ds_read_b64_tr_b16 v[112:113], v168 offset:576
    ds_read_b64_tr_b16 v[114:115], v168 offset:608
    ds_read_b64_tr_b16 v[116:117], v168 offset:864
    ds_read_b64_tr_b16 v[118:119], v168 offset:896
    s_waitcnt lgkmcnt(6)
    v_or_b32 v104, 1, v104
    buffer_store_dwordx4 v[104:107], v169, s[12:15], s44 offen sc1
    s_add_u32 s44, s44, 16777216
    s_waitcnt lgkmcnt(4)
    v_or_b32 v108, 1, v108
    buffer_store_dwordx4 v[108:111], v169, s[12:15], s44 offen sc1
    s_add_u32 s44, s44, 16777216
    s_waitcnt lgkmcnt(2)
    v_or_b32 v112, 1, v112
    buffer_store_dwordx4 v[112:115], v169, s[12:15], s44 offen sc1
    s_add_u32 s44, s44, 16777216
    s_waitcnt lgkmcnt(0)
    v_or_b32 v116, 1, v116
    buffer_store_dwordx4 v[116:119], v169, s[12:15], s44 offen sc1
    s_add_u32 s44, s44, 16777216
    v_mov_b32 v8, 162836
    v_mov_b32 v9, 1
    s_mov_b64 exec, 1
    ds_add_u32 v8, v9
    s_mov_b64 exec, -1
    s_mov_b64 exec, 0xf
    s_waitcnt vmcnt(0)
    buffer_atomic_add v7, v6, s[56:59], s45 offen sc1
    s_mov_b64 exec, -1
    s_branch FR_end
FR_b:
    s_cmp_ge_u32 s2, 32
    s_cbranch_scc1 FB_np
    s_cmp_lg_u32 s30, 5
    s_cbranch_scc1 FB_np
    s_and_b32 s42, s2, 7
    s_lshl_b32 s42, s42, 10
    s_lshr_b32 s43, s2, 3
    s_lshl_b32 s43, s43, 14
    s_add_u32 s42, s42, s43
    s_add_u32 s42, s42, 39714816
    v_mov_b32 v14, 0
    s_mov_b64 exec, 1
    s_mov_b32 s46, -1
    s_mov_b32 s47, -1
    s_add_u32 s48, s4, s42
    s_addc_u32 s49, s5, 0
    s_load_dword s101, s[48:49], 384
    s_waitcnt lgkmcnt(0)
    s_memtime s[34:35]
    s_waitcnt lgkmcnt(0)
    s_load_dword s101, s[48:49], 0
    s_waitcnt lgkmcnt(0)
    s_memtime s[36:37]
    s_waitcnt lgkmcnt(0)
    s_sub_u32 s43, s36, s34
    s_min_u32 s46, s46, s43
    s_load_dword s101, s[48:49], 8192
    s_waitcnt lgkmcnt(0)
    s_memtime s[34:35]
    s_waitcnt lgkmcnt(0)
    s_sub_u32 s43, s34, s36
    s_min_u32 s47, s47, s43
    s_load_dword s101, s[48:49], 128
    s_waitcnt lgkmcnt(0)
    s_memtime s[36:37]
    s_waitcnt lgkmcnt(0)
    s_sub_u32 s43, s36, s34
    s_min_u32 s46, s46, s43
    s_load_dword s101, s[48:49], 8320
    s_waitcnt lgkmcnt(0)
    s_memtime s[34:35]
    s_waitcnt lgkmcnt(0)
    s_sub_u32 s43, s34, s36
    s_min_u32 s47, s47, s43
    s_cmp_lt_u32 s47, s46
    s_cselect_b32 s45, 1, 0
    s_lshr_b32 s46, s28, 2
    s_xor_b32 s45, s45, s46
    s_and_b32 s45, s45, 1
    s_lshl_b32 s45, s45, 8
    s_or_b32 s43, s45, 1
    v_mov_b32 v12, s43
    buffer_atomic_add v12, v14, s[84:87], 0 offen offset:4 sc0 sc1
    s_waitcnt vmcnt(0)
    v_readfirstlane_b32 s36, v12
    s_nop 0
    s_add_u32 s36, s36, s43
    s_and_b32 s37, s36, 255
    s_cmp_lg_u32 s37, 21
    s_cbranch_scc1 FB_np
    s_lshr_b32 s36, s36, 8
    s_lshl_b32 s36, s36, 1
    s_add_u32 s36, s36, s52
    s_bfm_b64 exec, 32, 0
    v_mov_b32 v12, s36
    v_lshlrev_b32 v13, 7, v1
    s_mov_b32 s36, 23117824
    buffer_store_dword v12, v13, s[56:59], s36 offen sc1
FB_np:
    s_mov_b64 exec, -1
    s_getpc_b64 s[34:35]
K_tpc:
    s_lshl_b32 s36, s29, 2
    s_and_b32 s37, s28, 3
    s_add_u32 s36, s36, s37
    s_lshl_b32 s36, s36, 6
    s_add_u32 s36, s36, K_tab-K_tpc
    s_add_u32 s34, s34, s36
    s_addc_u32 s35, s35, 0
    v_and_b32 v248, 31, v1
    v_lshlrev_b32 v248, 1, v248
    global_load_ushort v251, v248, s[34:35]
    v_lshrrev_b32 v253, 3, v1
    v_lshlrev_b32 v238, 11, v253
    v_and_b32 v253, 6, v253
    v_and_b32 v254, 7, v1
    v_xor_b32 v253, v253, v254
    v_lshl_add_u32 v238, v253, 4, v238
    v_lshrrev_b32 v253, 4, v1
    v_lshlrev_b32 v239, 11, v253
    v_add_u32 v253, 0, v253
    v_lshlrev_b32 v253, 1, v253
    v_and_b32 v254, 15, v1
    v_xor_b32 v253, v253, v254
    v_lshl_add_u32 v239, v253, 4, v239
    v_lshrrev_b32 v253, 4, v1
    v_lshlrev_b32 v240, 11, v253
    v_add_u32 v253, 4, v253
    v_lshlrev_b32 v253, 1, v253
    v_and_b32 v254, 15, v1
    v_xor_b32 v253, v253, v254
    v_lshl_add_u32 v240, v253, 4, v240
    v_add_u32 v254, 0, v1
    v_mul_u32_u24 v253, 2341, v254
    v_lshrrev_b32 v253, 16, v253
    v_mul_u32_u24 v241, 28, v253
    v_sub_u32 v254, v254, v241
    v_mul_u32_u24 v241, 7168, v253
    v_lshrrev_b32 v253, 1, v253
    v_and_b32 v253, 2, v253
    v_xor_b32 v254, v254, v253
    v_lshl_add_u32 v241, v254, 4, v241
    v_add_u32 v254, 64, v1
    v_mul_u32_u24 v253, 2341, v254
    v_lshrrev_b32 v253, 16, v253
    v_mul_u32_u24 v242, 28, v253
    v_sub_u32 v254, v254, v242
    v_mul_u32_u24 v242, 7168, v253
    v_lshrrev_b32 v253, 1, v253
    v_and_b32 v253, 2, v253
    v_xor_b32 v254, v254, v253
    v_lshl_add_u32 v242, v254, 4, v242
    v_add_u32 v254, 128, v1
    v_mul_u32_u24 v253, 2341, v254
    v_lshrrev_b32 v253, 16, v253
    v_mul_u32_u24 v243, 28, v253
    v_sub_u32 v254, v254, v243
    v_mul_u32_u24 v243, 7168, v253
    v_lshrrev_b32 v253, 1, v253
    v_and_b32 v253, 2, v253
    v_xor_b32 v254, v254, v253
    v_lshl_add_u32 v243, v254, 4, v243
    v_add_u32 v254, 192, v1
    v_mul_u32_u24 v253, 2341, v254
    v_lshrrev_b32 v253, 16, v253
    v_mul_u32_u24 v244, 28, v253
    v_sub_u32 v254, v254, v244
    v_mul_u32_u24 v244, 7168, v253
    v_lshrrev_b32 v253, 1, v253
    v_and_b32 v253, 2, v253
    v_xor_b32 v254, v254, v253
    v_lshl_add_u32 v244, v254, 4, v244
    v_add_u32 v254, 256, v1
    v_mul_u32_u24 v253, 2341, v254
    v_lshrrev_b32 v253, 16, v253
    v_mul_u32_u24 v245, 28, v253
    v_sub_u32 v254, v254, v245
    v_mul_u32_u24 v245, 7168, v253
    v_lshrrev_b32 v253, 1, v253
    v_and_b32 v253, 2, v253
    v_xor_b32 v254, v254, v253
    v_lshl_add_u32 v245, v254, 4, v245
    v_add_u32 v254, 320, v1
    v_mul_u32_u24 v253, 2341, v254
    v_lshrrev_b32 v253, 16, v253
    v_mul_u32_u24 v246, 28, v253
    v_sub_u32 v254, v254, v246
    v_mul_u32_u24 v246, 7168, v253
    v_lshrrev_b32 v253, 1, v253
    v_and_b32 v253, 2, v253
    v_xor_b32 v254, v254, v253
    v_lshl_add_u32 v246, v254, 4, v246
    v_add_u32 v254, 384, v1
    v_mul_u32_u24 v253, 2341, v254
    v_lshrrev_b32 v253, 16, v253
    v_mul_u32_u24 v247, 28, v253
    v_sub_u32 v254, v254, v247
    v_mul_u32_u24 v247, 7168, v253
    v_lshrrev_b32 v253, 1, v253
    v_and_b32 v253, 2, v253
    v_xor_b32 v254, v254, v253
    v_lshl_add_u32 v247, v254, 4, v247
    s_cmp_ge_u32 s30, 6
    s_cbranch_scc1 FB_cs
    s_cmp_lg_u32 s30, 4
    s_cbranch_scc1 FB_ni
    v_mov_b32 v12, s52
    s_lshr_b32 s53, s28, 3
    s_lshl_b32 s53, s53, 2
    s_and_b32 s54, s28, 3
    s_add_u32 s53, s53, s54
    s_lshl_b32 s53, s53, 24
    s_lshr_b32 s54, s28, 2
    s_xor_b32 s54, s54, s94
    s_and_b32 s54, s54, 1
    s_lshl_b32 s54, s54, 13
    s_add_u32 s37, s53, s54
    s_add_u32 s37, s37, 33554432
    s_andn2_b32 s37, s37, 0x2000
    s_lshl_b32 s53, s29, 7
    s_add_u32 s37, s37, s53
    s_add_u32 s37, s37, 6029312
    v_and_b32 v13, 1, v1
    v_lshlrev_b32 v13, 13, v13
    v_lshrrev_b32 v14, 1, v1
    v_lshl_add_u32 v13, v14, 22, v13
    s_mov_b64 exec, 0xf
    buffer_store_dword v12, v13, s[56:59], s37 offen sc1
    s_cmp_lg_u32 s28, 0
    s_cbranch_scc1 FB_n2
    s_add_u32 s37, s53, 23121920
    s_mov_b64 exec, 1
    buffer_store_dword v12, v13, s[56:59], s37 offen sc1
FB_n2:
    s_mov_b64 exec, -1
FB_ni:
    s_waitcnt vmcnt(0)
    v_bfe_u32 v252, v251, 2, 2
    v_lshlrev_b32 v248, 14, v252
    v_and_b32 v252, 3, v251
    v_lshl_add_u32 v248, v252, 11, v248
    v_bfe_u32 v252, v251, 7, 3
    v_lshlrev_b32 v249, 14, v252
    v_bfe_u32 v252, v251, 4, 3
    v_lshl_add_u32 v249, v252, 10, v249
    v_bfe_u32 v252, v251, 13, 3
    v_lshlrev_b32 v250, 14, v252
    v_bfe_u32 v252, v251, 10, 3
    v_lshl_add_u32 v250, v252, 10, v250
    v_mov_b32 v6, 162836
spin_7:
    s_sleep 2
    ds_read_b32 v7, v6
    s_waitcnt lgkmcnt(0)
    v_readfirstlane_b32 s53, v7
    s_nop 0
    s_cmp_ge_u32 s53, 4
    s_cbranch_scc0 spin_7
    s_load_dwordx2 s[48:49], s[0:1], 64
    s_lshl_b32 s45, s2, 1
    s_and_b32 s50, s30, 1
    s_add_u32 s45, s45, s50
    s_mul_i32 s45, s45, 4096
    s_mov_b32 s50, 2097152
    s_mov_b32 s51, 0x20000
    s_waitcnt lgkmcnt(0)
    buffer_load_dwordx4 v[20:23], v2, s[48:51], s45 offen offset:0
    buffer_load_dwordx4 v[20:23], v2, s[48:51], s45 offen offset:1024
    buffer_load_dwordx4 v[20:23], v2, s[48:51], s45 offen offset:2048
    buffer_load_dwordx4 v[20:23], v2, s[48:51], s45 offen offset:3072
    v_mov_b32 v6, 1
    v_mov_b32 v7, 162824
    s_mov_b64 exec, 1
    s_waitcnt vmcnt(0)
    ds_add_u32 v7, v6
    s_mov_b64 exec, -1
    v_mov_b32 v6, 162840
spin_9:
    s_sleep 4
    ds_read_b32 v7, v6
    s_waitcnt lgkmcnt(0)
    v_readfirstlane_b32 s53, v7
    s_nop 0
    s_cmp_ge_u32 s53, 2
    s_cbranch_scc0 spin_9
    s_call_b64 s[76:77], SUB_w1_regs
    s_call_b64 s[76:77], SUB_park
    v_mov_b32 v6, 162840
spin_10:
    s_sleep 3
    ds_read_b32 v7, v6
    s_waitcnt lgkmcnt(0)
    v_readfirstlane_b32 s53, v7
    s_nop 0
    s_cmp_ge_u32 s53, 4
    s_cbranch_scc0 spin_10
    s_mov_b64 s[12:13], s[68:69]
    s_mov_b32 s14, 2097152
    s_mov_b32 s15, 0x20000
    s_and_b32 s35, s30, 1
    s_mul_i32 s38, s99, 128
    s_mul_i32 s41, s35, 65536
    s_add_u32 s38, s38, s41
    s_mul_i32 s41, s35, 4096
    s_add_u32 s41, s41, 24576
    s_mov_b32 s42, 0
    s_mov_b32 s44, s67
    s_mov_b32 s42, 73728
    s_mov_b32 s44, s67
    s_add_u32 s44, s44, 9
    s_and_b32 s44, s44, 15
    s_call_b64 s[76:77], SUB_w_issue_1
    s_waitcnt vmcnt(8)
    s_mov_b32 s42, 81920
    s_mov_b32 s44, s67
    s_add_u32 s44, s44, 10
    s_and_b32 s44, s44, 15
    s_call_b64 s[76:77], SUB_w_issue_1
    s_waitcnt vmcnt(8)
    s_mov_b32 s42, 90112
    s_mov_b32 s44, s67
    s_add_u32 s44, s44, 11
    s_and_b32 s44, s44, 15
    s_call_b64 s[76:77], SUB_w_issue_1
    s_waitcnt vmcnt(8)
    s_and_b32 s36, s29, 6
    s_cmp_eq_u32 s36, 2
    s_cbranch_scc1 pr_11
    s_call_b64 s[76:77], SUB_park2
pr_11:
    s_call_b64 s[76:77], SUB_w1_put
    s_branch FR_end
FB_cs:
    v_and_b32 v164, 15, v1
    v_mov_b32 v165, 0x3f803f80
    v_cmp_eq_u32 vcc, 0, v164
    s_nop 1
    v_cndmask_b32 v16, 0, v165, vcc
    v_cndmask_b32 v17, 0, v165, vcc
    v_cndmask_b32 v18, 0, v165, vcc
    v_cndmask_b32 v19, 0, v165, vcc
    v_cmp_eq_u32 vcc, 1, v164
    s_nop 1
    v_cndmask_b32 v20, 0, v165, vcc
    v_cndmask_b32 v21, 0, v165, vcc
    v_cndmask_b32 v22, 0, v165, vcc
    v_cndmask_b32 v23, 0, v165, vcc
    v_cmp_eq_u32 vcc, 2, v164
    s_nop 1
    v_cndmask_b32 v24, 0, v165, vcc
    v_cndmask_b32 v25, 0, v165, vcc
    v_cndmask_b32 v26, 0, v165, vcc
    v_cndmask_b32 v27, 0, v165, vcc
    v_cmp_eq_u32 vcc, 3, v164
    s_nop 1
    v_cndmask_b32 v28, 0, v165, vcc
    v_cndmask_b32 v29, 0, v165, vcc
    v_cndmask_b32 v30, 0, v165, vcc
    v_cndmask_b32 v31, 0, v165, vcc
    v_cmp_eq_u32 vcc, 4, v164
    s_nop 1
    v_cndmask_b32 v32, 0, v165, vcc
    v_cndmask_b32 v33, 0, v165, vcc
    v_cndmask_b32 v34, 0, v165, vcc
    v_cndmask_b32 v35, 0, v165, vcc
    v_cmp_eq_u32 vcc, 5, v164
    s_nop 1
    v_cndmask_b32 v36, 0, v165, vcc
    v_cndmask_b32 v37, 0, v165, vcc
    v_cndmask_b32 v38, 0, v165, vcc
    v_cndmask_b32 v39, 0, v165, vcc
    v_cmp_eq_u32 vcc, 6, v164
    s_nop 1
    v_cndmask_b32 v40, 0, v165, vcc
    v_cndmask_b32 v41, 0, v165, vcc
    v_cndmask_b32 v42, 0, v165, vcc
    v_cndmask_b32 v43, 0, v165, vcc
    v_cmp_eq_u32 vcc, 7, v164
    s_nop 1
    v_cndmask_b32 v44, 0, v165, vcc
    v_cndmask_b32 v45, 0, v165, vcc
    v_cndmask_b32 v46, 0, v165, vcc
    v_cndmask_b32 v47, 0, v165, vcc
    v_cmp_eq_u32 vcc, 8, v164
    s_nop 1
    v_cndmask_b32 v48, 0, v165, vcc
    v_cndmask_b32 v49, 0, v165, vcc
    v_cndmask_b32 v50, 0, v165, vcc
    v_cndmask_b32 v51, 0, v165, vcc
    v_cmp_eq_u32 vcc, 9, v164
    s_nop 1
    v_cndmask_b32 v52, 0, v165, vcc
    v_cndmask_b32 v53, 0, v165, vcc
    v_cndmask_b32 v54, 0, v165, vcc
    v_cndmask_b32 v55, 0, v165, vcc
    v_cmp_eq_u32 vcc, 10, v164
    s_nop 1
    v_cndmask_b32 v56, 0, v165, vcc
    v_cndmask_b32 v57, 0, v165, vcc
    v_cndmask_b32 v58, 0, v165, vcc
    v_cndmask_b32 v59, 0, v165, vcc
    v_cmp_eq_u32 vcc, 11, v164
    s_nop 1
    v_cndmask_b32 v60, 0, v165, vcc
    v_cndmask_b32 v61, 0, v165, vcc
    v_cndmask_b32 v62, 0, v165, vcc
    v_cndmask_b32 v63, 0, v165, vcc
    v_cmp_eq_u32 vcc, 12, v164
    s_nop 1
    v_cndmask_b32 v64, 0, v165, vcc
    v_cndmask_b32 v65, 0, v165, vcc
    v_cndmask_b32 v66, 0, v165, vcc
    v_cndmask_b32 v67, 0, v165, vcc
    v_cmp_eq_u32 vcc, 13, v164
    s_nop 1
    v_cndmask_b32 v68, 0, v165, vcc
    v_cndmask_b32 v69, 0, v165, vcc
    v_cndmask_b32 v70, 0, v165, vcc
    v_cndmask_b32 v71, 0, v165, vcc
    s_mov_b32 s35, 0
    v_lshrrev_b32 v253, 2, v1
    v_mul_u32_u24 v144, 128, v253
    v_and_b32 v254, 3, v1
    v_lshl_add_u32 v144, v254, 3, v144
    v_add_u32 v144, 24576, v144
    v_bfe_u32 v253, v253, 1, 2
    s_mul_i32 s36, s35, 4
    s_add_u32 s36, s36, 3
    v_xor_b32 v254, s36, v253
    v_lshl_add_u32 v147, v254, 5, v144
    s_mul_i32 s36, s35, 4
    s_add_u32 s36, s36, 2
    v_xor_b32 v254, s36, v253
    v_lshl_add_u32 v146, v254, 5, v144
    s_mul_i32 s36, s35, 4
    s_add_u32 s36, s36, 1
    v_xor_b32 v254, s36, v253
    v_lshl_add_u32 v145, v254, 5, v144
    s_mul_i32 s36, s35, 4
    s_add_u32 s36, s36, 0
    v_xor_b32 v254, s36, v253
    v_lshl_add_u32 v144, v254, 5, v144
    s_and_b32 s35, s30, 1
    s_mul_i32 s35, s35, 4096
    s_add_u32 s35, s35, 73728
    v_add_u32 v144, s35, v144
    v_add_u32 v145, s35, v145
    v_add_u32 v146, s35, v146
    v_add_u32 v147, s35, v147
    s_mov_b32 s35, 0
    v_lshrrev_b32 v253, 2, v1
    v_mul_u32_u24 v148, 448, v253
    v_and_b32 v254, 3, v1
    v_lshl_add_u32 v148, v254, 3, v148
    v_add_u32 v148, 73728, v148
    s_mul_i32 s36, s35, 224
    v_add_u32 v148, s36, v148
    v_bfe_u32 v253, v1, 4, 1
    v_lshlrev_b32 v253, 5, v253
    s_cmp_eq_u32 s35, 0
    s_cselect_b32 s36, 1, -1
    v_mul_lo_u32 v253, v253, s36
    v_sub_u32 v149, v148, v253
    v_add_u32 v148, v148, v253
    s_and_b32 s35, s30, 1
    s_mul_i32 s35, s35, 14336
    s_add_u32 s35, s35, 32768
    v_add_u32 v148, s35, v148
    v_add_u32 v149, s35, v149
    s_mov_b32 s35, 1
    v_lshrrev_b32 v253, 2, v1
    v_mul_u32_u24 v150, 448, v253
    v_and_b32 v254, 3, v1
    v_lshl_add_u32 v150, v254, 3, v150
    v_add_u32 v150, 73728, v150
    s_mul_i32 s36, s35, 224
    v_add_u32 v150, s36, v150
    v_bfe_u32 v253, v1, 4, 1
    v_lshlrev_b32 v253, 5, v253
    s_cmp_eq_u32 s35, 0
    s_cselect_b32 s36, 1, -1
    v_mul_lo_u32 v253, v253, s36
    v_sub_u32 v151, v150, v253
    v_add_u32 v150, v150, v253
    s_and_b32 s35, s30, 1
    s_mul_i32 s35, s35, 14336
    s_add_u32 s35, s35, 32768
    v_add_u32 v150, s35, v150
    v_add_u32 v151, s35, v151
    v_mov_b32 v156, 0
    v_mov_b32 v157, 0
    v_mov_b32 v158, 0
    v_mov_b32 v159, 0
    v_mov_b32 v160, 0
    v_mov_b32 v161, 0
    v_mov_b32 v162, 0
    v_mov_b32 v163, 0
    v_lshrrev_b32 v166, 4, v1
    v_lshlrev_b32 v166, 4, v166
    v_lshl_add_u32 v166, v164, 6, v166
    v_mov_b32 v165, 0x7f000000
    v_cmp_gt_u32 vcc, 4, v164
    s_nop 1
    v_cndmask_b32 v167, v165, v166, vcc
    v_cmp_gt_u32 vcc, 14, v164
    s_nop 1
    v_cndmask_b32 v168, v165, v166, vcc
    s_waitcnt vmcnt(0)
    v_and_b32 v252, 15, v251
    v_mul_u32_u24 v248, 458752, v252
    s_and_b32 s36, s30, 1
    s_mul_i32 s36, s36, 6
    s_add_u32 s36, s36, 4
    v_bfe_u32 v252, v251, s36, 6
    v_mul_u32_u24 v250, 37, v252
    v_lshrrev_b32 v250, 8, v250
    v_mul_u32_u24 v250, 7, v250
    v_sub_u32 v250, v252, v250
    v_cmp_eq_u32 vcc, 3, v250
    s_nop 1
    v_cndmask_b32 v250, 0, 1, vcc
    v_lshl_add_u32 v249, v252, 16, v250
    v_mov_b32 v6, 162836
spin_12:
    s_sleep 2
    ds_read_b32 v7, v6
    s_waitcnt lgkmcnt(0)
    v_readfirstlane_b32 s53, v7
    s_nop 0
    s_cmp_ge_u32 s53, 4
    s_cbranch_scc0 spin_12
    s_mov_b64 s[12:13], s[68:69]
    s_mov_b32 s14, 2097152
    s_mov_b32 s15, 0x20000
    s_and_b32 s35, s30, 1
    s_mul_i32 s38, s99, 128
    s_mul_i32 s41, s35, 65536
    s_add_u32 s38, s38, s41
    s_mul_i32 s41, s35, 4096
    s_add_u32 s41, s41, 24576
    s_mov_b32 s42, 0
    s_mov_b32 s44, s67
    s_mov_b32 s42, 73728
    s_mov_b32 s44, s28
    s_add_u32 s19, s41, s42
    s_mul_i32 s16, s44, 131072
    s_add_u32 s16, s16, s38
    s_add_u32 s44, s44, 1
    s_and_b32 s44, s44, 15
    s_add_u32 s42, s42, 8192
    s_cmp_eq_u32 s42, 131072
    s_cselect_b32 s42, 0, s42
    s_mov_b32 m0, s19
    s_mov_b32 s39, s16
    buffer_load_dwordx4 v238, s[12:15], s39 offen lds
    s_add_u32 m0, m0, 1024
    s_add_u32 s39, s39, 16384
    buffer_load_dwordx4 v238, s[12:15], s39 offen lds
    s_add_u32 m0, m0, 1024
    s_add_u32 s39, s39, 16384
    buffer_load_dwordx4 v238, s[12:15], s39 offen lds
    s_add_u32 m0, m0, 1024
    s_add_u32 s39, s39, 16384
    buffer_load_dwordx4 v238, s[12:15], s39 offen lds
    s_mov_b64 s[12:13], s[72:73]
    s_mov_b32 s14, 7340032
    s_mov_b32 s15, 0x20000
    s_and_b32 s35, s30, 1
    s_mul_i32 s38, s29, 448
    s_mul_i32 s41, s35, 229376
    s_add_u32 s38, s38, s41
    s_mul_i32 s41, s35, 14336
    s_add_u32 s41, s41, 73728
    s_mov_b32 s42, 0
    s_mov_b32 s44, 0
    s_mov_b32 s42, 32768
    s_mov_b32 s44, s28
    s_add_u32 s19, s41, s42
    s_mul_i32 s16, s44, 458752
    s_add_u32 s16, s16, s38
    s_add_u32 s44, s44, 1
    s_and_b32 s44, s44, 15
    s_add_u32 s42, s42, 28672
    s_cmp_eq_u32 s42, 86016
    s_cselect_b32 s42, 0, s42
    s_mov_b32 m0, s19
    s_mov_b32 s39, s16
    buffer_load_dwordx4 v241, s[12:15], s39 offen lds
    s_add_u32 m0, m0, 1024
    s_nop 0
    buffer_load_dwordx4 v242, s[12:15], s39 offen lds
    s_add_u32 m0, m0, 1024
    s_nop 0
    buffer_load_dwordx4 v243, s[12:15], s39 offen lds
    s_add_u32 m0, m0, 1024
    s_nop 0
    buffer_load_dwordx4 v244, s[12:15], s39 offen lds
    s_add_u32 m0, m0, 1024
    s_nop 0
    buffer_load_dwordx4 v245, s[12:15], s39 offen lds
    s_add_u32 m0, m0, 1024
    s_nop 0
    buffer_load_dwordx4 v246, s[12:15], s39 offen lds
    s_add_u32 m0, m0, 1024
    s_nop 0
    buffer_load_dwordx4 v247, s[12:15], s39 offen lds
    s_add_u32 m0, m0, 1024
    s_add_u32 s39, s39, 114688
    buffer_load_dwordx4 v241, s[12:15], s39 offen lds
    s_add_u32 m0, m0, 1024
    s_nop 0
    buffer_load_dwordx4 v242, s[12:15], s39 offen lds
    s_add_u32 m0, m0, 1024
    s_nop 0
    buffer_load_dwordx4 v243, s[12:15], s39 offen lds
    s_add_u32 m0, m0, 1024
    s_nop 0
    buffer_load_dwordx4 v244, s[12:15], s39 offen lds
    s_add_u32 m0, m0, 1024
    s_nop 0
    buffer_load_dwordx4 v245, s[12:15], s39 offen lds
    s_add_u32 m0, m0, 1024
    s_nop 0
    buffer_load_dwordx4 v246, s[12:15], s39 offen lds
    s_add_u32 m0, m0, 1024
    s_nop 0
    buffer_load_dwordx4 v247, s[12:15], s39 offen lds
    s_waitcnt vmcnt(14)
    s_setprio 1
    ds_read_b64_tr_b16 v[128:129], v144 offset:0
    ds_read_b64_tr_b16 v[130:131], v144 offset:2048
    ds_read_b64_tr_b16 v[132:133], v145 offset:0
    ds_read_b64_tr_b16 v[134:135], v145 offset:2048
    ds_read_b64_tr_b16 v[136:137], v146 offset:0
    ds_read_b64_tr_b16 v[138:139], v146 offset:2048
    ds_read_b64_tr_b16 v[140:141], v147 offset:0
    ds_read_b64_tr_b16 v[142:143], v147 offset:2048
    s_add_u32 s20, s4, 0x1400000
    s_addc_u32 s21, s5, 0
    s_mov_b32 s22, 0x20000
    s_mov_b32 s23, 0x20000
    s_lshl_b32 s35, s28, 1
    s_and_b32 s36, s30, 1
    s_add_u32 s35, s35, s36
    s_mul_i32 s35, s35, 4096
    s_mul_i32 s36, s29, 256
    s_add_u32 s35, s35, s36
    s_waitcnt lgkmcnt(0)
    v_mfma_f32_16x16x32_bf16 v[160:163], v[128:131], v[16:19], v[160:163]
    v_mfma_f32_16x16x32_bf16 v[160:163], v[132:135], v[20:23], v[160:163]
    v_mfma_f32_16x16x32_bf16 v[160:163], v[136:139], v[24:27], v[160:163]
    v_mfma_f32_16x16x32_bf16 v[160:163], v[140:143], v[28:31], v[160:163]
    s_nop 7
    buffer_store_dwordx4 v[160:163], v167, s[20:23], s35 offen sc1
    s_waitcnt vmcnt(1)
    v_mov_b32 v6, 162840
    v_mov_b32 v7, 1
    s_mov_b64 exec, 1
    ds_add_u32 v6, v7
    s_mov_b64 exec, -1
    ds_read_b64_tr_b16 v[72:73], v148 offset:0
    ds_read_b64_tr_b16 v[74:75], v148 offset:7168
    ds_read_b64_tr_b16 v[76:77], v149 offset:32
    ds_read_b64_tr_b16 v[78:79], v149 offset:7200
    ds_read_b64_tr_b16 v[80:81], v148 offset:64
    ds_read_b64_tr_b16 v[82:83], v148 offset:7232
    ds_read_b64_tr_b16 v[84:85], v149 offset:96
    ds_read_b64_tr_b16 v[86:87], v149 offset:7264
    ds_read_b64_tr_b16 v[88:89], v148 offset:128
    ds_read_b64_tr_b16 v[90:91], v148 offset:7296
    ds_read_b64_tr_b16 v[92:93], v149 offset:160
    ds_read_b64_tr_b16 v[94:95], v149 offset:7328
    ds_read_b64_tr_b16 v[96:97], v148 offset:192
    ds_read_b64_tr_b16 v[98:99], v148 offset:7360
    ds_read_b64_tr_b16 v[100:101], v150 offset:0
    ds_read_b64_tr_b16 v[102:103], v150 offset:7168
    ds_read_b64_tr_b16 v[104:105], v151 offset:32
    ds_read_b64_tr_b16 v[106:107], v151 offset:7200
    ds_read_b64_tr_b16 v[108:109], v150 offset:64
    ds_read_b64_tr_b16 v[110:111], v150 offset:7232
    ds_read_b64_tr_b16 v[112:113], v151 offset:96
    ds_read_b64_tr_b16 v[114:115], v151 offset:7264
    ds_read_b64_tr_b16 v[116:117], v150 offset:128
    ds_read_b64_tr_b16 v[118:119], v150 offset:7296
    ds_read_b64_tr_b16 v[120:121], v151 offset:160
    ds_read_b64_tr_b16 v[122:123], v151 offset:7328
    ds_read_b64_tr_b16 v[124:125], v150 offset:192
    ds_read_b64_tr_b16 v[126:127], v150 offset:7360
    s_add_u32 s20, s4, 0x1420000
    s_addc_u32 s21, s5, 0
    s_mov_b32 s22, 0x70000
    s_mov_b32 s23, 0x20000
    s_lshl_b32 s35, s28, 1
    s_and_b32 s36, s30, 1
    s_add_u32 s35, s35, s36
    s_mul_i32 s35, s35, 14336
    s_mul_i32 s36, s29, 896
    s_add_u32 s35, s35, s36
    s_waitcnt lgkmcnt(0)
    v_mfma_f32_16x16x32_bf16 v[156:159], v[72:75], v[16:19], v[156:159]
    v_mfma_f32_16x16x32_bf16 v[156:159], v[76:79], v[20:23], v[156:159]
    v_mfma_f32_16x16x32_bf16 v[156:159], v[80:83], v[24:27], v[156:159]
    v_mfma_f32_16x16x32_bf16 v[156:159], v[84:87], v[28:31], v[156:159]
    v_mfma_f32_16x16x32_bf16 v[156:159], v[88:91], v[32:35], v[156:159]
    v_mfma_f32_16x16x32_bf16 v[156:159], v[92:95], v[36:39], v[156:159]
    v_mfma_f32_16x16x32_bf16 v[156:159], v[96:99], v[40:43], v[156:159]
    v_mfma_f32_16x16x32_bf16 v[156:159], v[100:103], v[44:47], v[156:159]
    v_mfma_f32_16x16x32_bf16 v[156:159], v[104:107], v[48:51], v[156:159]
    v_mfma_f32_16x16x32_bf16 v[156:159], v[108:111], v[52:55], v[156:159]
    v_mfma_f32_16x16x32_bf16 v[156:159], v[112:115], v[56:59], v[156:159]
    v_mfma_f32_16x16x32_bf16 v[156:159], v[116:119], v[60:63], v[156:159]
    v_mfma_f32_16x16x32_bf16 v[156:159], v[120:123], v[64:67], v[156:159]
    v_mfma_f32_16x16x32_bf16 v[156:159], v[124:127], v[68:71], v[156:159]
    s_nop 7
    buffer_store_dwordx4 v[156:159], v168, s[20:23], s35 offen sc1
    v_mov_b32 v6, 162840
    v_mov_b32 v7, 1
    s_mov_b64 exec, 1
    ds_add_u32 v6, v7
    s_mov_b64 exec, -1
    s_setprio 0
    s_call_b64 s[76:77], SUB_w1_regs
    s_call_b64 s[76:77], SUB_park
    v_mov_b32 v6, 162840
spin_14:
    s_sleep 3
    ds_read_b32 v7, v6
    s_waitcnt lgkmcnt(0)
    v_readfirstlane_b32 s53, v7
    s_nop 0
    s_cmp_ge_u32 s53, 4
    s_cbranch_scc0 spin_14
    s_mov_b64 s[12:13], s[68:69]
    s_mov_b32 s14, 2097152
    s_mov_b32 s15, 0x20000
    s_and_b32 s35, s30, 1
    s_mul_i32 s38, s99, 128
    s_mul_i32 s41, s35, 65536
    s_add_u32 s38, s38, s41
    s_mul_i32 s41, s35, 4096
    s_add_u32 s41, s41, 24576
    s_mov_b32 s42, 0
    s_mov_b32 s44, s67
    s_mov_b32 s42, 98304
    s_mov_b32 s44, s67
    s_add_u32 s44, s44, 12
    s_and_b32 s44, s44, 15
    s_call_b64 s[76:77], SUB_w_issue_1
    s_waitcnt vmcnt(8)
    s_mov_b32 s42, 106496
    s_mov_b32 s44, s67
    s_add_u32 s44, s44, 13
    s_and_b32 s44, s44, 15
    s_call_b64 s[76:77], SUB_w_issue_1
    s_waitcnt vmcnt(8)
    s_mov_b32 s42, 114688
    s_mov_b32 s44, s67
    s_add_u32 s44, s44, 14
    s_and_b32 s44, s44, 15
    s_call_b64 s[76:77], SUB_w_issue_1
    s_waitcnt vmcnt(8)
    s_mov_b32 s42, 122880
    s_mov_b32 s44, s67
    s_add_u32 s44, s44, 15
    s_and_b32 s44, s44, 15
    s_call_b64 s[76:77], SUB_w_issue_1
    s_waitcnt vmcnt(8)
    s_and_b32 s36, s29, 6
    s_cmp_eq_u32 s36, 2
    s_cbranch_scc1 pr_15
    s_call_b64 s[76:77], SUB_park2
pr_15:
    s_call_b64 s[76:77], SUB_w1_put
FR_end:
LAYER:
    v_lshlrev_b32 v40, 6, v199
    v_add_u32 v40, 161792, v40
    s_lshl_b32 s35, s30, 3
    v_add_u32 v39, s35, v40
    s_cmp_eq_u32 s60, 0
    s_cbranch_scc1 R_l0
    s_sub_u32 s8, s62, 0x400000
    s_subb_u32 s9, s63, 0
    s_mov_b32 s10, 0x7e000
    s_mov_b32 s11, 0x20000
    s_sub_u32 s12, s62, 0x380000
    s_subb_u32 s13, s63, 0
    s_mov_b32 s14, 0x7e000
    s_mov_b32 s15, 0x20000
    s_mov_b32 s20, s62
    s_mov_b32 s21, s63
    s_mov_b32 s22, 0x7e000
    s_mov_b32 s23, 0x20000
    s_mov_b32 s78, 0x3f80
    s_mov_b32 s79, 0x3f800000
    v_lshlrev_b32 v222, 16, v230
    v_and_b32 v223, 0xffff0000, v230
    v_lshlrev_b32 v206, 16, v180
    v_and_b32 v207, 0xffff0000, v180
    v_lshlrev_b32 v12, 16, v188
    v_and_b32 v13, 0xffff0000, v188
    v_pk_add_f32 v[206:207], v[206:207], v[12:13]
    v_lshlrev_b32 v224, 16, v231
    v_and_b32 v225, 0xffff0000, v231
    v_lshlrev_b32 v208, 16, v181
    v_and_b32 v209, 0xffff0000, v181
    v_lshlrev_b32 v14, 16, v189
    v_and_b32 v15, 0xffff0000, v189
    v_pk_add_f32 v[208:209], v[208:209], v[14:15]
    v_lshlrev_b32 v226, 16, v232
    v_and_b32 v227, 0xffff0000, v232
    v_lshlrev_b32 v210, 16, v182
    v_and_b32 v211, 0xffff0000, v182
    v_lshlrev_b32 v16, 16, v190
    v_and_b32 v17, 0xffff0000, v190
    v_pk_add_f32 v[210:211], v[210:211], v[16:17]
    v_lshlrev_b32 v228, 16, v233
    v_and_b32 v229, 0xffff0000, v233
    v_lshlrev_b32 v212, 16, v183
    v_and_b32 v213, 0xffff0000, v183
    v_lshlrev_b32 v18, 16, v191
    v_and_b32 v19, 0xffff0000, v191
    v_pk_add_f32 v[212:213], v[212:213], v[18:19]
    v_lshlrev_b32 v230, 16, v234
    v_and_b32 v231, 0xffff0000, v234
    v_lshlrev_b32 v214, 16, v184
    v_and_b32 v215, 0xffff0000, v184
    v_lshlrev_b32 v20, 16, v192
    v_and_b32 v21, 0xffff0000, v192
    v_pk_add_f32 v[214:215], v[214:215], v[20:21]
    v_lshlrev_b32 v232, 16, v235
    v_and_b32 v233, 0xffff0000, v235
    v_lshlrev_b32 v216, 16, v185
    v_and_b32 v217, 0xffff0000, v185
    v_lshlrev_b32 v22, 16, v193
    v_and_b32 v23, 0xffff0000, v193
    v_pk_add_f32 v[216:217], v[216:217], v[22:23]
    v_lshlrev_b32 v234, 16, v236
    v_and_b32 v235, 0xffff0000, v236
    v_lshlrev_b32 v218, 16, v186
    v_and_b32 v219, 0xffff0000, v186
    v_lshlrev_b32 v24, 16, v194
    v_and_b32 v25, 0xffff0000, v194
    v_pk_add_f32 v[218:219], v[218:219], v[24:25]
    v_lshlrev_b32 v236, 16, v237
    v_and_b32 v237, 0xffff0000, v237
    v_lshlrev_b32 v220, 16, v187
    v_and_b32 v221, 0xffff0000, v187
    v_lshlrev_b32 v26, 16, v195
    v_and_b32 v27, 0xffff0000, v195
    v_pk_add_f32 v[220:221], v[220:221], v[26:27]
    s_mov_b32 s53, 0
    s_sleep 10
    s_cmp_ge_u32 s30, 6
    s_cbranch_scc1 dp_16
    s_sleep 14
dp_16:
    buffer_load_dwordx4 v[180:183], v196, s[8:11], 0 offen offset:0 sc1
    buffer_load_dwordx4 v[188:191], v196, s[12:15], 0 offen offset:0 sc1
    buffer_load_dwordx4 v[184:187], v196, s[8:11], 0 offen offset:2048 sc1
    buffer_load_dwordx4 v[192:195], v196, s[12:15], 0 offen offset:2048 sc1
    s_waitcnt vmcnt(0)
    v_bitop3_b32 v6, v180, v184, v188 bitop3:0x80
    v_bitop3_b32 v6, v6, v192, 1 bitop3:0x80
    v_cmp_eq_u32 vcc, 0, v6
    s_cbranch_vccz dq_17
    s_sleep 4
    s_add_u32 s53, s53, 1
    s_cmp_lt_u32 s53, s61
    s_cbranch_scc1 dp_16
    s_mov_b32 s61, 0
dq_17:
    v_dot2_f32_bf16 v206, v180, s78, v206
    v_dot2_f32_bf16 v207, v180, s79, v207
    v_dot2_f32_bf16 v208, v181, s78, v208
    v_dot2_f32_bf16 v209, v181, s79, v209
    v_dot2_f32_bf16 v210, v182, s78, v210
    v_dot2_f32_bf16 v211, v182, s79, v211
    v_dot2_f32_bf16 v212, v183, s78, v212
    v_dot2_f32_bf16 v213, v183, s79, v213
    v_dot2_f32_bf16 v214, v184, s78, v214
    v_dot2_f32_bf16 v215, v184, s79, v215
    v_dot2_f32_bf16 v216, v185, s78, v216
    v_dot2_f32_bf16 v217, v185, s79, v217
    v_dot2_f32_bf16 v218, v186, s78, v218
    v_dot2_f32_bf16 v219, v186, s79, v219
    v_dot2_f32_bf16 v220, v187, s78, v220
    v_dot2_f32_bf16 v221, v187, s79, v221
    v_dot2_f32_bf16 v206, v188, s78, v206
    v_dot2_f32_bf16 v207, v188, s79, v207
    v_dot2_f32_bf16 v208, v189, s78, v208
    v_dot2_f32_bf16 v209, v189, s79, v209
    v_dot2_f32_bf16 v210, v190, s78, v210
    v_dot2_f32_bf16 v211, v190, s79, v211
    v_dot2_f32_bf16 v212, v191, s78, v212
    v_dot2_f32_bf16 v213, v191, s79, v213
    v_dot2_f32_bf16 v214, v192, s78, v214
    v_dot2_f32_bf16 v215, v192, s79, v215
    v_dot2_f32_bf16 v216, v193, s78, v216
    v_dot2_f32_bf16 v217, v193, s79, v217
    v_dot2_f32_bf16 v218, v194, s78, v218
    v_dot2_f32_bf16 v219, v194, s79, v219
    v_dot2_f32_bf16 v220, v195, s78, v220
    v_dot2_f32_bf16 v221, v195, s79, v221
    s_nop 2
    v_pk_add_f32 v[32:33], v[206:207], v[208:209]
    v_pk_mul_f32 v[34:35], v[206:207], v[206:207]
    v_pk_fma_f32 v[34:35], v[208:209], v[208:209], v[34:35]
    v_pk_add_f32 v[32:33], v[32:33], v[210:211]
    v_pk_fma_f32 v[34:35], v[210:211], v[210:211], v[34:35]
    v_pk_add_f32 v[32:33], v[32:33], v[212:213]
    v_pk_fma_f32 v[34:35], v[212:213], v[212:213], v[34:35]
    v_pk_add_f32 v[32:33], v[32:33], v[214:215]
    v_pk_fma_f32 v[34:35], v[214:215], v[214:215], v[34:35]
    v_pk_add_f32 v[32:33], v[32:33], v[216:217]
    v_pk_fma_f32 v[34:35], v[216:217], v[216:217], v[34:35]
    v_pk_add_f32 v[32:33], v[32:33], v[218:219]
    v_pk_fma_f32 v[34:35], v[218:219], v[218:219], v[34:35]
    v_pk_add_f32 v[32:33], v[32:33], v[220:221]
    v_pk_fma_f32 v[34:35], v[220:221], v[220:221], v[34:35]
    v_add_f32 v30, v32, v33
    v_add_f32 v31, v34, v35
    s_nop 0
    v_add_f32_dpp v30, v30, v30 row_ror:8 row_mask:0xf bank_mask:0xf
    v_add_f32_dpp v31, v31, v31 row_ror:8 row_mask:0xf bank_mask:0xf
    v_mov_b32 v32, v30
    v_mov_b32 v33, v31
    s_nop 0
    v_permlane16_swap_b32 v30, v32
    v_permlane16_swap_b32 v31, v33
    v_pk_add_f32 v[30:31], v[30:31], v[32:33]
    v_mov_b32 v32, v30
    v_mov_b32 v33, v31
    s_nop 0
    v_permlane32_swap_b32 v30, v32
    v_permlane32_swap_b32 v31, v33
    v_pk_add_f32 v[30:31], v[30:31], v[32:33]
    ds_write_b64 v39, v[30:31] offset:0
    s_waitcnt lgkmcnt(0)
    s_barrier
    ds_read_b128 v[12:15], v40 offset:0
    ds_read_b128 v[16:19], v40 offset:16
    ds_read_b128 v[20:23], v40 offset:32
    ds_read_b128 v[24:27], v40 offset:48
    s_waitcnt lgkmcnt(0)
    v_pk_add_f32 v[12:13], v[12:13], v[14:15]
    v_pk_add_f32 v[16:17], v[16:17], v[18:19]
    v_pk_add_f32 v[20:21], v[20:21], v[22:23]
    v_pk_add_f32 v[24:25], v[24:25], v[26:27]
    v_pk_add_f32 v[12:13], v[12:13], v[16:17]
    v_pk_add_f32 v[20:21], v[20:21], v[24:25]
    v_pk_add_f32 v[12:13], v[12:13], v[20:21]
    v_mul_f32 v36, 0x3a800000, v12
    v_mul_f32 v38, 0x3a800000, v13
    v_fma_f32 v38, -v36, v36, v38
    v_max_f32 v38, 0, v38
    v_add_f32 v38, 0x3727c5ac, v38
    v_rsq_f32 v37, v38
    s_nop 0
    v_mul_f32 v36, v36, v37
    v_pk_fma_f32 v[12:13], v[206:207], v[36:37], v[36:37] op_sel:[0,1,0] op_sel_hi:[1,1,0] neg_lo:[0,0,1] neg_hi:[0,0,1]
    v_pk_fma_f32 v[14:15], v[208:209], v[36:37], v[36:37] op_sel:[0,1,0] op_sel_hi:[1,1,0] neg_lo:[0,0,1] neg_hi:[0,0,1]
    v_pk_fma_f32 v[16:17], v[210:211], v[36:37], v[36:37] op_sel:[0,1,0] op_sel_hi:[1,1,0] neg_lo:[0,0,1] neg_hi:[0,0,1]
    v_pk_fma_f32 v[18:19], v[212:213], v[36:37], v[36:37] op_sel:[0,1,0] op_sel_hi:[1,1,0] neg_lo:[0,0,1] neg_hi:[0,0,1]
    v_pk_fma_f32 v[20:21], v[214:215], v[36:37], v[36:37] op_sel:[0,1,0] op_sel_hi:[1,1,0] neg_lo:[0,0,1] neg_hi:[0,0,1]
    v_pk_fma_f32 v[22:23], v[216:217], v[36:37], v[36:37] op_sel:[0,1,0] op_sel_hi:[1,1,0] neg_lo:[0,0,1] neg_hi:[0,0,1]
    v_pk_fma_f32 v[24:25], v[218:219], v[36:37], v[36:37] op_sel:[0,1,0] op_sel_hi:[1,1,0] neg_lo:[0,0,1] neg_hi:[0,0,1]
    v_pk_fma_f32 v[26:27], v[220:221], v[36:37], v[36:37] op_sel:[0,1,0] op_sel_hi:[1,1,0] neg_lo:[0,0,1] neg_hi:[0,0,1]
    v_pk_fma_f32 v[206:207], v[12:13], v[222:223], v[206:207]
    v_cvt_pk_bf16_f32 v180, v206, v207
    v_pk_fma_f32 v[208:209], v[14:15], v[224:225], v[208:209]
    v_cvt_pk_bf16_f32 v181, v208, v209
    v_and_b32 v180, -2, v180
    v_pk_fma_f32 v[210:211], v[16:17], v[226:227], v[210:211]
    v_cvt_pk_bf16_f32 v182, v210, v211
    v_pk_fma_f32 v[212:213], v[18:19], v[228:229], v[212:213]
    v_cvt_pk_bf16_f32 v183, v212, v213
    buffer_store_dwordx4 v[180:183], v196, s[20:23], 0 offen offset:0 sc1
    v_pk_fma_f32 v[214:215], v[20:21], v[230:231], v[214:215]
    v_cvt_pk_bf16_f32 v184, v214, v215
    v_pk_fma_f32 v[216:217], v[22:23], v[232:233], v[216:217]
    v_cvt_pk_bf16_f32 v185, v216, v217
    v_and_b32 v184, -2, v184
    v_pk_fma_f32 v[218:219], v[24:25], v[234:235], v[218:219]
    v_cvt_pk_bf16_f32 v186, v218, v219
    v_pk_fma_f32 v[220:221], v[26:27], v[236:237], v[220:221]
    v_cvt_pk_bf16_f32 v187, v220, v221
    buffer_store_dwordx4 v[184:187], v196, s[20:23], 0 offen offset:2048 sc1
    s_branch R_s2
R_l0:
    v_lshlrev_b32 v206, 16, v180
    v_and_b32 v207, 0xffff0000, v180
    v_lshlrev_b32 v208, 16, v181
    v_and_b32 v209, 0xffff0000, v181
    v_lshlrev_b32 v210, 16, v182
    v_and_b32 v211, 0xffff0000, v182
    v_lshlrev_b32 v212, 16, v183
    v_and_b32 v213, 0xffff0000, v183
    v_lshlrev_b32 v214, 16, v184
    v_and_b32 v215, 0xffff0000, v184
    v_lshlrev_b32 v216, 16, v185
    v_and_b32 v217, 0xffff0000, v185
    v_lshlrev_b32 v218, 16, v186
    v_and_b32 v219, 0xffff0000, v186
    v_lshlrev_b32 v220, 16, v187
    v_and_b32 v221, 0xffff0000, v187
    v_pk_add_f32 v[32:33], v[206:207], v[208:209]
    v_pk_mul_f32 v[34:35], v[206:207], v[206:207]
    v_pk_fma_f32 v[34:35], v[208:209], v[208:209], v[34:35]
    v_pk_add_f32 v[32:33], v[32:33], v[210:211]
    v_pk_fma_f32 v[34:35], v[210:211], v[210:211], v[34:35]
    v_pk_add_f32 v[32:33], v[32:33], v[212:213]
    v_pk_fma_f32 v[34:35], v[212:213], v[212:213], v[34:35]
    v_pk_add_f32 v[32:33], v[32:33], v[214:215]
    v_pk_fma_f32 v[34:35], v[214:215], v[214:215], v[34:35]
    v_pk_add_f32 v[32:33], v[32:33], v[216:217]
    v_pk_fma_f32 v[34:35], v[216:217], v[216:217], v[34:35]
    v_pk_add_f32 v[32:33], v[32:33], v[218:219]
    v_pk_fma_f32 v[34:35], v[218:219], v[218:219], v[34:35]
    v_pk_add_f32 v[32:33], v[32:33], v[220:221]
    v_pk_fma_f32 v[34:35], v[220:221], v[220:221], v[34:35]
    v_add_f32 v30, v32, v33
    v_add_f32 v31, v34, v35
    s_nop 0
    v_add_f32_dpp v30, v30, v30 row_ror:8 row_mask:0xf bank_mask:0xf
    v_add_f32_dpp v31, v31, v31 row_ror:8 row_mask:0xf bank_mask:0xf
    v_mov_b32 v32, v30
    v_mov_b32 v33, v31
    s_nop 0
    v_permlane16_swap_b32 v30, v32
    v_permlane16_swap_b32 v31, v33
    v_pk_add_f32 v[30:31], v[30:31], v[32:33]
    v_mov_b32 v32, v30
    v_mov_b32 v33, v31
    s_nop 0
    v_permlane32_swap_b32 v30, v32
    v_permlane32_swap_b32 v31, v33
    v_pk_add_f32 v[30:31], v[30:31], v[32:33]
    ds_write_b64 v39, v[30:31] offset:0
    s_waitcnt lgkmcnt(0)
    v_mov_b32 v222, 162844
spin_18:
    ds_read_b32 v223, v222
    s_waitcnt lgkmcnt(0)
    v_readfirstlane_b32 s94, v223
    s_nop 0
    s_cmp_ge_u32 s94, 65536
    s_cbranch_scc0 spin_18
    s_cmp_gt_u32 s94, 65546
    s_cselect_b32 s94, 1, 0
    s_lshl_b32 s53, s94, 13
    v_xor_b32 v197, s53, v197
    s_lshr_b32 s53, s28, 3
    s_lshl_b32 s53, s53, 2
    s_and_b32 s54, s28, 3
    s_add_u32 s53, s53, s54
    s_lshl_b32 s53, s53, 24
    s_lshr_b32 s54, s28, 2
    s_xor_b32 s54, s54, s94
    s_and_b32 s54, s54, 1
    s_lshl_b32 s54, s54, 13
    s_add_u32 s36, s53, s54
    s_add_u32 s36, s36, 33554432
    s_lshr_b32 s53, s53, 14
    s_add_u32 s36, s53, s54
    s_xor_b32 s36, s36, 8192
    s_add_u32 s36, s36, 23101440
    s_lshl_b32 s53, s30, 7
    s_add_u32 s36, s36, s53
    v_mov_b32 v226, s36
    s_waitcnt vmcnt(0)
    s_barrier
    s_mov_b32 s53, 0
    s_add_u32 s54, s52, 32
    s_bfm_b64 exec, 1, 0
poll_19:
    buffer_load_dword v222, v226, s[56:59], 0 offen sc1
    s_waitcnt vmcnt(0)
    v_xor_b32 v222, s54, v222
    v_cmp_eq_u32 vcc, 0, v222
    s_nop 0
    s_cmp_eq_u64 vcc, exec
    s_cbranch_scc1 pok_20
    s_sleep 6
    s_add_u32 s53, s53, 1
    s_cmp_lt_u32 s53, s61
    s_cbranch_scc1 poll_19
    s_mov_b32 s61, 0
pok_20:
    s_mov_b64 exec, -1
    s_add_u32 s80, s4, 0x2100000
    s_addc_u32 s81, s5, 0
    s_mov_b32 s82, 0x7f00000
    s_mov_b32 s83, 0x20000
    s_mov_b32 s78, 0
    buffer_load_dwordx2 v[230:231], v197, s[80:83], s78 offen sc1
    s_mov_b32 s78, 2048
    buffer_load_dwordx2 v[232:233], v197, s[80:83], s78 offen sc1
    s_mov_b32 s78, 16384
    buffer_load_dwordx2 v[234:235], v197, s[80:83], s78 offen sc1
    s_mov_b32 s78, 18432
    buffer_load_dwordx2 v[236:237], v197, s[80:83], s78 offen sc1
    s_lshr_b32 s53, s28, 3
    s_lshl_b32 s53, s53, 2
    s_and_b32 s54, s28, 3
    s_add_u32 s53, s53, s54
    s_lshl_b32 s53, s53, 24
    s_lshr_b32 s54, s28, 2
    s_xor_b32 s54, s54, s94
    s_and_b32 s54, s54, 1
    s_lshl_b32 s54, s54, 13
    s_add_u32 s55, s53, s54
    s_add_u32 s55, s55, 33554432
    s_add_u32 s62, s4, s55
    s_addc_u32 s63, s5, 0
    s_sub_u32 s36, s28, 1
    s_max_i32 s36, s36, 0
    s_lshr_b32 s53, s36, 3
    s_lshl_b32 s53, s53, 2
    s_and_b32 s54, s36, 3
    s_add_u32 s53, s53, s54
    s_lshl_b32 s53, s53, 24
    s_lshr_b32 s54, s36, 2
    s_xor_b32 s54, s54, s94
    s_and_b32 s54, s54, 1
    s_lshl_b32 s54, s54, 13
    s_add_u32 s92, s53, s54
    s_add_u32 s92, s92, 33554432
    s_sub_u32 s92, s92, s55
    s_add_u32 s36, s28, 1
    s_min_u32 s36, s36, 15
    s_lshr_b32 s53, s36, 3
    s_lshl_b32 s53, s53, 2
    s_and_b32 s54, s36, 3
    s_add_u32 s53, s53, s54
    s_lshl_b32 s53, s53, 24
    s_lshr_b32 s54, s36, 2
    s_xor_b32 s54, s54, s94
    s_and_b32 s54, s54, 1
    s_lshl_b32 s54, s54, 13
    s_add_u32 s93, s53, s54
    s_add_u32 s93, s93, 33554432
    s_sub_u32 s93, s93, s55
    s_add_u32 s55, s55, 6029312
    s_mov_b32 s20, s62
    s_mov_b32 s21, s63
    s_mov_b32 s22, 0x7e000
    s_mov_b32 s23, 0x20000
    ds_read_b128 v[12:15], v40 offset:0
    ds_read_b128 v[16:19], v40 offset:16
    ds_read_b128 v[20:23], v40 offset:32
    ds_read_b128 v[24:27], v40 offset:48
    s_waitcnt lgkmcnt(0)
    v_pk_add_f32 v[12:13], v[12:13], v[14:15]
    v_pk_add_f32 v[16:17], v[16:17], v[18:19]
    v_pk_add_f32 v[20:21], v[20:21], v[22:23]
    v_pk_add_f32 v[24:25], v[24:25], v[26:27]
    v_pk_add_f32 v[12:13], v[12:13], v[16:17]
    v_pk_add_f32 v[20:21], v[20:21], v[24:25]
    v_pk_add_f32 v[12:13], v[12:13], v[20:21]
    v_mul_f32 v36, 0x3a800000, v12
    v_mul_f32 v38, 0x3a800000, v13
    v_fma_f32 v38, -v36, v36, v38
    v_max_f32 v38, 0, v38
    v_add_f32 v38, 0x3727c5ac, v38
    v_rsq_f32 v37, v38
    s_nop 0
    v_pk_add_f32 v[12:13], v[206:207], v[36:37] op_sel_hi:[1,0] neg_lo:[0,1] neg_hi:[0,1]
    v_pk_mul_f32 v[12:13], v[12:13], v[36:37] op_sel:[0,1] op_sel_hi:[1,1]
    v_pk_add_f32 v[14:15], v[208:209], v[36:37] op_sel_hi:[1,0] neg_lo:[0,1] neg_hi:[0,1]
    v_pk_mul_f32 v[14:15], v[14:15], v[36:37] op_sel:[0,1] op_sel_hi:[1,1]
    v_pk_add_f32 v[16:17], v[210:211], v[36:37] op_sel_hi:[1,0] neg_lo:[0,1] neg_hi:[0,1]
    v_pk_mul_f32 v[16:17], v[16:17], v[36:37] op_sel:[0,1] op_sel_hi:[1,1]
    v_pk_add_f32 v[18:19], v[212:213], v[36:37] op_sel_hi:[1,0] neg_lo:[0,1] neg_hi:[0,1]
    v_pk_mul_f32 v[18:19], v[18:19], v[36:37] op_sel:[0,1] op_sel_hi:[1,1]
    v_pk_add_f32 v[20:21], v[214:215], v[36:37] op_sel_hi:[1,0] neg_lo:[0,1] neg_hi:[0,1]
    v_pk_mul_f32 v[20:21], v[20:21], v[36:37] op_sel:[0,1] op_sel_hi:[1,1]
    v_pk_add_f32 v[22:23], v[216:217], v[36:37] op_sel_hi:[1,0] neg_lo:[0,1] neg_hi:[0,1]
    v_pk_mul_f32 v[22:23], v[22:23], v[36:37] op_sel:[0,1] op_sel_hi:[1,1]
    v_pk_add_f32 v[24:25], v[218:219], v[36:37] op_sel_hi:[1,0] neg_lo:[0,1] neg_hi:[0,1]
    v_pk_mul_f32 v[24:25], v[24:25], v[36:37] op_sel:[0,1] op_sel_hi:[1,1]
    v_pk_add_f32 v[26:27], v[220:221], v[36:37] op_sel_hi:[1,0] neg_lo:[0,1] neg_hi:[0,1]
    v_pk_mul_f32 v[26:27], v[26:27], v[36:37] op_sel:[0,1] op_sel_hi:[1,1]
    s_barrier
    s_waitcnt vmcnt(0)
    v_lshlrev_b32 v222, 16, v230
    v_and_b32 v223, 0xffff0000, v230
    v_pk_fma_f32 v[206:207], v[12:13], v[222:223], v[206:207]
    v_cvt_pk_bf16_f32 v180, v206, v207
    v_lshlrev_b32 v222, 16, v231
    v_and_b32 v223, 0xffff0000, v231
    v_pk_fma_f32 v[208:209], v[14:15], v[222:223], v[208:209]
    v_cvt_pk_bf16_f32 v181, v208, v209
    v_and_b32 v180, -2, v180
    v_lshlrev_b32 v222, 16, v232
    v_and_b32 v223, 0xffff0000, v232
    v_pk_fma_f32 v[210:211], v[16:17], v[222:223], v[210:211]
    v_cvt_pk_bf16_f32 v182, v210, v211
    v_lshlrev_b32 v222, 16, v233
    v_and_b32 v223, 0xffff0000, v233
    v_pk_fma_f32 v[212:213], v[18:19], v[222:223], v[212:213]
    v_cvt_pk_bf16_f32 v183, v212, v213
    buffer_store_dwordx4 v[180:183], v196, s[20:23], 0 offen offset:0 sc1
    v_lshlrev_b32 v222, 16, v234
    v_and_b32 v223, 0xffff0000, v234
    v_pk_fma_f32 v[214:215], v[20:21], v[222:223], v[214:215]
    v_cvt_pk_bf16_f32 v184, v214, v215
    v_lshlrev_b32 v222, 16, v235
    v_and_b32 v223, 0xffff0000, v235
    v_pk_fma_f32 v[216:217], v[22:23], v[222:223], v[216:217]
    v_cvt_pk_bf16_f32 v185, v216, v217
    v_and_b32 v184, -2, v184
    v_lshlrev_b32 v222, 16, v236
    v_and_b32 v223, 0xffff0000, v236
    v_pk_fma_f32 v[218:219], v[24:25], v[222:223], v[218:219]
    v_cvt_pk_bf16_f32 v186, v218, v219
    v_lshlrev_b32 v222, 16, v237
    v_and_b32 v223, 0xffff0000, v237
    v_pk_fma_f32 v[220:221], v[26:27], v[222:223], v[220:221]
    v_cvt_pk_bf16_f32 v187, v220, v221
    buffer_store_dwordx4 v[184:187], v196, s[20:23], 0 offen offset:2048 sc1
R_s2:
    v_lshlrev_b32 v206, 16, v180
    v_and_b32 v207, 0xffff0000, v180
    v_lshlrev_b32 v208, 16, v181
    v_and_b32 v209, 0xffff0000, v181
    v_lshlrev_b32 v210, 16, v182
    v_and_b32 v211, 0xffff0000, v182
    v_lshlrev_b32 v212, 16, v183
    v_and_b32 v213, 0xffff0000, v183
    v_lshlrev_b32 v214, 16, v184
    v_and_b32 v215, 0xffff0000, v184
    v_lshlrev_b32 v216, 16, v185
    v_and_b32 v217, 0xffff0000, v185
    v_lshlrev_b32 v218, 16, v186
    v_and_b32 v219, 0xffff0000, v186
    v_lshlrev_b32 v220, 16, v187
    v_and_b32 v221, 0xffff0000, v187
    v_pk_add_f32 v[32:33], v[206:207], v[208:209]
    v_pk_mul_f32 v[34:35], v[206:207], v[206:207]
    v_pk_fma_f32 v[34:35], v[208:209], v[208:209], v[34:35]
    v_pk_add_f32 v[32:33], v[32:33], v[210:211]
    v_pk_fma_f32 v[34:35], v[210:211], v[210:211], v[34:35]
    v_pk_add_f32 v[32:33], v[32:33], v[212:213]
    v_pk_fma_f32 v[34:35], v[212:213], v[212:213], v[34:35]
    v_pk_add_f32 v[32:33], v[32:33], v[214:215]
    v_pk_fma_f32 v[34:35], v[214:215], v[214:215], v[34:35]
    v_pk_add_f32 v[32:33], v[32:33], v[216:217]
    v_pk_fma_f32 v[34:35], v[216:217], v[216:217], v[34:35]
    v_pk_add_f32 v[32:33], v[32:33], v[218:219]
    v_pk_fma_f32 v[34:35], v[218:219], v[218:219], v[34:35]
    v_pk_add_f32 v[32:33], v[32:33], v[220:221]
    v_pk_fma_f32 v[34:35], v[220:221], v[220:221], v[34:35]
    v_add_f32 v30, v32, v33
    v_add_f32 v31, v34, v35
    s_nop 0
    v_add_f32_dpp v30, v30, v30 row_ror:8 row_mask:0xf bank_mask:0xf
    v_add_f32_dpp v31, v31, v31 row_ror:8 row_mask:0xf bank_mask:0xf
    v_mov_b32 v32, v30
    v_mov_b32 v33, v31
    s_nop 0
    v_permlane16_swap_b32 v30, v32
    v_permlane16_swap_b32 v31, v33
    v_pk_add_f32 v[30:31], v[30:31], v[32:33]
    v_mov_b32 v32, v30
    v_mov_b32 v33, v31
    s_nop 0
    v_permlane32_swap_b32 v30, v32
    v_permlane32_swap_b32 v31, v33
    v_pk_add_f32 v[30:31], v[30:31], v[32:33]
    ds_write_b64 v39, v[30:31] offset:512
    s_waitcnt lgkmcnt(0)
    s_barrier
    s_cmp_lg_u32 s30, 6
    s_cbranch_scc1 R_n6
    s_cmp_lg_u32 s60, 0
    s_cbranch_scc1 R_n6
    s_lshl_b32 s53, s29, 7
    s_add_u32 s53, s53, 23121920
    v_mov_b32 v8, 1
    v_mov_b32 v9, 0
    s_mov_b64 exec, 1
    buffer_atomic_add v8, v9, s[56:59], s53 offen sc1
    s_mov_b64 exec, -1
R_n6:
    s_cmp_lg_u32 s30, 7
    s_cbranch_scc1 R_nl
    ds_read_b128 v[12:15], v40 offset:512
    ds_read_b128 v[16:19], v40 offset:528
    ds_read_b128 v[20:23], v40 offset:544
    ds_read_b128 v[24:27], v40 offset:560
    s_waitcnt lgkmcnt(0)
    v_pk_add_f32 v[12:13], v[12:13], v[14:15]
    v_pk_add_f32 v[16:17], v[16:17], v[18:19]
    v_pk_add_f32 v[20:21], v[20:21], v[22:23]
    v_pk_add_f32 v[24:25], v[24:25], v[26:27]
    v_pk_add_f32 v[12:13], v[12:13], v[16:17]
    v_pk_add_f32 v[20:21], v[20:21], v[24:25]
    v_pk_add_f32 v[12:13], v[12:13], v[20:21]
    v_mul_f32 v36, 0x3a800000, v12
    v_mul_f32 v38, 0x3a800000, v13
    v_fma_f32 v38, -v36, v36, v38
    v_max_f32 v38, 0, v38
    v_mov_b32 v42, v36
    v_mov_b32 v43, v38
    v_add_f32 v38, 0x3727c5ac, v38
    v_sqrt_f32 v38, v38
    s_nop 0
    v_mov_b32 v41, v38
    v_rcp_f32 v37, v38
    v_sub_f32 v42, v42, v36
    v_mul_f32 v42, v42, v37
    v_mul_f32 v43, v43, v37
    v_mul_f32 v43, v43, v37
    v_add_f32 v43, 0x3727c5ac, v43
    v_rsq_f32 v44, v43
    v_mov_b32 v224, v36
    v_mov_b32 v225, v37
    v_fma_f32 v226, v42, v41, v36
    v_mul_f32 v227, v37, v44
    s_add_u32 s24, s62, 0x5d0000
    s_addc_u32 s25, s63, 0
    s_mov_b32 s26, 0x800
    s_mov_b32 s27, 0x20000
    s_lshl_b32 s36, s29, 3
    v_add_u32 v6, s36, v199
    v_lshlrev_b32 v6, 4, v6
    s_mov_b64 exec, 0xff
    buffer_store_dwordx4 v[224:227], v6, s[24:27], 0 offen sc1
    s_mov_b64 exec, -1
    s_add_u32 s53, s55, 1280
    v_mov_b32 v8, 1
    v_mov_b32 v9, 162816
    v_mov_b32 v11, 0
    s_mov_b64 exec, 1
    s_waitcnt vmcnt(0)
    buffer_atomic_add v8, v11, s[56:59], s53 offen sc1
pub_21:
    s_mov_b64 exec, -1
R_nl:
    s_cmp_ge_u32 s30, 4
    s_cbranch_scc1 LOADERS
    s_mov_b32 s8, s62
    s_mov_b32 s9, s63
    s_mov_b32 s10, 0x7e000
    s_mov_b32 s11, 0x20000
    v_add_u32 v126, 0, v2
    v_add_u32 v127, 65536, v2
    s_lshl_b32 s44, s30, 17
    s_mov_b32 s34, s30
    s_mov_b32 s35, 0
    v_and_b32 v22, 15, v1
    v_lshrrev_b32 v23, 4, v1
    s_mul_i32 s37, s34, 2
    s_mul_i32 s38, s99, 4
    s_mul_i32 s36, s35, 4
    s_add_u32 s38, s38, s36
    v_add_u32 v128, 4096, v2
    v_add_u32 v129, 69632, v2
    s_add_u32 s45, s44, 16384
    s_add_u32 s46, s44, 32768
    s_add_u32 s47, s44, 49152
    v_lshrrev_b32 v6, 2, v1
    v_mul_u32_u24 v13, 128, v6
    v_and_b32 v7, 3, v1
    v_lshl_add_u32 v13, v7, 3, v13
    v_add_u32 v13, 24576, v13
    v_bfe_u32 v6, v6, 1, 2
    s_mul_i32 s36, s35, 4
    s_add_u32 s36, s36, 3
    v_xor_b32 v7, s36, v6
    v_lshl_add_u32 v16, v7, 5, v13
    s_mul_i32 s36, s35, 4
    s_add_u32 s36, s36, 2
    v_xor_b32 v7, s36, v6
    v_lshl_add_u32 v15, v7, 5, v13
    s_mul_i32 s36, s35, 4
    s_add_u32 s36, s36, 1
    v_xor_b32 v7, s36, v6
    v_lshl_add_u32 v14, v7, 5, v13
    s_mul_i32 s36, s35, 4
    s_add_u32 s36, s36, 0
    v_xor_b32 v7, s36, v6
    v_lshl_add_u32 v13, v7, 5, v13
    v_pk_mov_b32 v[24:25], 0, 0
    v_pk_mov_b32 v[26:27], 0, 0
    v_pk_mov_b32 v[28:29], 0, 0
    v_pk_mov_b32 v[30:31], 0, 0
    v_pk_mov_b32 v[32:33], 0, 0
    v_pk_mov_b32 v[34:35], 0, 0
    v_pk_mov_b32 v[36:37], 0, 0
    v_pk_mov_b32 v[38:39], 0, 0
    v_pk_mov_b32 v[40:41], 0, 0
    v_pk_mov_b32 v[42:43], 0, 0
    v_pk_mov_b32 v[44:45], 0, 0
    v_pk_mov_b32 v[46:47], 0, 0
    v_pk_mov_b32 v[48:49], 0, 0
    v_pk_mov_b32 v[50:51], 0, 0
    v_pk_mov_b32 v[52:53], 0, 0
    v_pk_mov_b32 v[54:55], 0, 0
    s_mov_b32 s43, 0
    s_mul_i32 s36, s35, 256
    s_add_u32 s36, s36, 163328
    v_lshlrev_b32 v6, 4, v23
    v_add_u32 v6, s36, v6
    s_lshl_b32 s36, s37, 8
    s_add_u32 s36, s36, 160776
    v_lshlrev_b32 v7, 4, v22
    v_add_u32 v7, s36, v7
    s_add_u32 s16, s62, 0x100000
    s_addc_u32 s17, s63, 0
    s_mov_b32 s18, 0x7e000
    s_mov_b32 s19, 0x20000
    v_lshlrev_b32 v12, 11, v23
    v_lshl_add_u32 v12, v22, 4, v12
    s_lshl_b32 s39, s38, 13
    s_lshl_b32 s36, s37, 8
    s_add_u32 s39, s39, s36
    s_add_u32 s40, s39, 16384
    s_lshl_b32 s36, s29, 1
    s_lshr_b32 s53, s36, 3
    s_lshl_b32 s53, s53, 14
    s_and_b32 s41, s36, 7
    s_lshl_b32 s41, s41, 10
    s_add_u32 s41, s41, s53
    s_lshl_b32 s36, s37, 16
    s_add_u32 s41, s41, s36
    s_mov_b32 s53, 0
    s_mov_b32 s49, s44
    ds_read_b64_tr_b16 v[56:57], v13 offset:0
    ds_read_b64_tr_b16 v[58:59], v13 offset:2048
    ds_read_b64_tr_b16 v[60:61], v14 offset:0
    ds_read_b64_tr_b16 v[62:63], v14 offset:2048
    ds_read_b64_tr_b16 v[64:65], v15 offset:0
    ds_read_b64_tr_b16 v[66:67], v15 offset:2048
    ds_read_b64_tr_b16 v[68:69], v16 offset:0
    ds_read_b64_tr_b16 v[70:71], v16 offset:2048
    ds_read_b64_tr_b16 v[72:73], v13 offset:4096
    ds_read_b64_tr_b16 v[74:75], v13 offset:6144
    ds_read_b64_tr_b16 v[76:77], v14 offset:4096
    ds_read_b64_tr_b16 v[78:79], v14 offset:6144
    ds_read_b64_tr_b16 v[80:81], v15 offset:4096
    ds_read_b64_tr_b16 v[82:83], v15 offset:6144
    ds_read_b64_tr_b16 v[84:85], v16 offset:4096
    ds_read_b64_tr_b16 v[86:87], v16 offset:6144
dm_22p:
    buffer_load_dwordx4 v[164:167], v126, s[8:11], s44 offen offset:0 sc1
    buffer_load_dwordx4 v[168:171], v127, s[8:11], s44 offen offset:0 sc1
    buffer_load_dwordx4 v[172:175], v126, s[8:11], s44 offen offset:1024 sc1
    buffer_load_dwordx4 v[176:179], v127, s[8:11], s44 offen offset:1024 sc1
    buffer_load_dwordx4 v[180:183], v126, s[8:11], s44 offen offset:2048 sc1
    buffer_load_dwordx4 v[184:187], v127, s[8:11], s44 offen offset:2048 sc1
    buffer_load_dwordx4 v[188:191], v126, s[8:11], s44 offen offset:3072 sc1
    buffer_load_dwordx4 v[192:195], v127, s[8:11], s44 offen offset:3072 sc1
dm_22w:
    s_waitcnt vmcnt(4)
    v_or3_b32 v17, v164, v168, v172
    v_bitop3_b32 v17, v17, v176, 1 bitop3:0xa8
    v_cmp_ne_u32 vcc, 0, v17
    s_cbranch_vccz dm_22q
dm_22r:
    s_sleep 2
    buffer_load_dwordx4 v[164:167], v126, s[8:11], s44 offen offset:0 sc1
    buffer_load_dwordx4 v[168:171], v127, s[8:11], s44 offen offset:0 sc1
    buffer_load_dwordx4 v[172:175], v126, s[8:11], s44 offen offset:1024 sc1
    buffer_load_dwordx4 v[176:179], v127, s[8:11], s44 offen offset:1024 sc1
    buffer_load_dwordx4 v[180:183], v126, s[8:11], s44 offen offset:2048 sc1
    buffer_load_dwordx4 v[184:187], v127, s[8:11], s44 offen offset:2048 sc1
    buffer_load_dwordx4 v[188:191], v126, s[8:11], s44 offen offset:3072 sc1
    buffer_load_dwordx4 v[192:195], v127, s[8:11], s44 offen offset:3072 sc1
    s_waitcnt vmcnt(4)
    v_or3_b32 v17, v164, v168, v172
    v_bitop3_b32 v17, v17, v176, 1 bitop3:0xa8
    v_cmp_ne_u32 vcc, 0, v17
    s_cbranch_vccz dm_22t
    s_add_u32 s53, s53, 1
    s_cmp_lt_u32 s53, s61
    s_cbranch_scc1 dm_22r
    s_mov_b32 s61, 0
    s_branch dm_22t
dm_22q:
dm_22t:
    buffer_load_dwordx4 v[196:199], v128, s[8:11], s44 offen offset:0 sc1
    buffer_load_dwordx4 v[200:203], v129, s[8:11], s44 offen offset:0 sc1
    buffer_load_dwordx4 v[204:207], v128, s[8:11], s44 offen offset:1024 sc1
    buffer_load_dwordx4 v[208:211], v129, s[8:11], s44 offen offset:1024 sc1
    buffer_load_dwordx4 v[212:215], v128, s[8:11], s44 offen offset:2048 sc1
    buffer_load_dwordx4 v[216:219], v129, s[8:11], s44 offen offset:2048 sc1
    s_waitcnt lgkmcnt(0)
dm_22:
    v_mfma_f32_16x16x32_bf16 v[24:27], v[56:59], v[164:167], v[24:27]
    ds_read_b64_tr_b16 v[88:89], v13 offset:8192
    buffer_load_dwordx4 v[220:223], v128, s[8:11], s44 offen offset:3072 sc1
    v_mfma_f32_16x16x32_bf16 v[40:43], v[56:59], v[168:171], v[40:43]
    ds_read_b64_tr_b16 v[90:91], v13 offset:10240
    buffer_load_dwordx4 v[224:227], v129, s[8:11], s44 offen offset:3072 sc1
    v_mfma_f32_16x16x32_bf16 v[44:47], v[60:63], v[168:171], v[44:47]
    ds_read_b64_tr_b16 v[92:93], v14 offset:8192
    s_mov_b32 s44, s45
    v_mfma_f32_16x16x32_bf16 v[28:31], v[60:63], v[164:167], v[28:31]
    ds_read_b64_tr_b16 v[94:95], v14 offset:10240
    s_mov_b32 s45, s46
    v_mfma_f32_16x16x32_bf16 v[32:35], v[64:67], v[164:167], v[32:35]
    ds_read_b64_tr_b16 v[96:97], v15 offset:8192
    s_mov_b32 s46, s47
    v_mfma_f32_16x16x32_bf16 v[48:51], v[64:67], v[168:171], v[48:51]
    ds_read_b64_tr_b16 v[98:99], v15 offset:10240
    s_mov_b32 s47, 1048576
    v_mfma_f32_16x16x32_bf16 v[52:55], v[68:71], v[168:171], v[52:55]
    ds_read_b64_tr_b16 v[100:101], v16 offset:8192
    v_mfma_f32_16x16x32_bf16 v[36:39], v[68:71], v[164:167], v[36:39]
    ds_read_b64_tr_b16 v[102:103], v16 offset:10240
    s_waitcnt lgkmcnt(8)
    v_mfma_f32_16x16x32_bf16 v[24:27], v[72:75], v[172:175], v[24:27]
    ds_read_b64_tr_b16 v[104:105], v13 offset:12288
    buffer_load_dwordx4 v[164:167], v126, s[8:11], s44 offen offset:0 sc1
    v_mfma_f32_16x16x32_bf16 v[40:43], v[72:75], v[176:179], v[40:43]
    ds_read_b64_tr_b16 v[106:107], v13 offset:14336
    buffer_load_dwordx4 v[168:171], v127, s[8:11], s44 offen offset:0 sc1
    v_mfma_f32_16x16x32_bf16 v[44:47], v[76:79], v[176:179], v[44:47]
    ds_read_b64_tr_b16 v[108:109], v14 offset:12288
    s_waitcnt vmcnt(10)
    v_mfma_f32_16x16x32_bf16 v[28:31], v[76:79], v[172:175], v[28:31]
    ds_read_b64_tr_b16 v[110:111], v14 offset:14336
    v_or3_b32 v17, v180, v184, v188
    v_mfma_f32_16x16x32_bf16 v[32:35], v[80:83], v[172:175], v[32:35]
    ds_read_b64_tr_b16 v[112:113], v15 offset:12288
    v_bitop3_b32 v17, v17, v192, 1 bitop3:0xa8
    v_mfma_f32_16x16x32_bf16 v[48:51], v[80:83], v[176:179], v[48:51]
    ds_read_b64_tr_b16 v[114:115], v15 offset:14336
    v_cmp_ne_u32 vcc, 0, v17
    v_mfma_f32_16x16x32_bf16 v[52:55], v[84:87], v[176:179], v[52:55]
    ds_read_b64_tr_b16 v[116:117], v16 offset:12288
    ds_read_b64_tr_b16 v[118:119], v16 offset:14336
    v_mfma_f32_16x16x32_bf16 v[36:39], v[84:87], v[172:175], v[36:39]
    s_waitcnt lgkmcnt(8)
    s_cbranch_vccnz dm_22f0
dm_22g0:
    v_mfma_f32_16x16x32_bf16 v[24:27], v[88:91], v[180:183], v[24:27]
    ds_read_b64_tr_b16 v[56:57], v13 offset:16384
    buffer_load_dwordx4 v[172:175], v126, s[8:11], s44 offen offset:1024 sc1
    v_mfma_f32_16x16x32_bf16 v[40:43], v[88:91], v[184:187], v[40:43]
    ds_read_b64_tr_b16 v[58:59], v13 offset:18432
    buffer_load_dwordx4 v[176:179], v127, s[8:11], s44 offen offset:1024 sc1
    v_mfma_f32_16x16x32_bf16 v[44:47], v[92:95], v[184:187], v[44:47]
    ds_read_b64_tr_b16 v[60:61], v14 offset:16384
    v_mfma_f32_16x16x32_bf16 v[28:31], v[92:95], v[180:183], v[28:31]
    ds_read_b64_tr_b16 v[62:63], v14 offset:18432
    v_mfma_f32_16x16x32_bf16 v[32:35], v[96:99], v[180:183], v[32:35]
    ds_read_b64_tr_b16 v[64:65], v15 offset:16384
    v_mfma_f32_16x16x32_bf16 v[48:51], v[96:99], v[184:187], v[48:51]
    ds_read_b64_tr_b16 v[66:67], v15 offset:18432
    v_mfma_f32_16x16x32_bf16 v[52:55], v[100:103], v[184:187], v[52:55]
    ds_read_b64_tr_b16 v[68:69], v16 offset:16384
    v_mfma_f32_16x16x32_bf16 v[36:39], v[100:103], v[180:183], v[36:39]
    ds_read_b64_tr_b16 v[70:71], v16 offset:18432
    s_waitcnt lgkmcnt(8)
    v_mfma_f32_16x16x32_bf16 v[24:27], v[104:107], v[188:191], v[24:27]
    ds_read_b64_tr_b16 v[72:73], v13 offset:20480
    buffer_load_dwordx4 v[180:183], v126, s[8:11], s44 offen offset:2048 sc1
    v_mfma_f32_16x16x32_bf16 v[40:43], v[104:107], v[192:195], v[40:43]
    ds_read_b64_tr_b16 v[74:75], v13 offset:22528
    buffer_load_dwordx4 v[184:187], v127, s[8:11], s44 offen offset:2048 sc1
    v_mfma_f32_16x16x32_bf16 v[44:47], v[108:111], v[192:195], v[44:47]
    ds_read_b64_tr_b16 v[76:77], v14 offset:20480
    s_waitcnt vmcnt(10)
    v_mfma_f32_16x16x32_bf16 v[28:31], v[108:111], v[188:191], v[28:31]
    ds_read_b64_tr_b16 v[78:79], v14 offset:22528
    v_or3_b32 v17, v196, v200, v204
    v_mfma_f32_16x16x32_bf16 v[32:35], v[112:115], v[188:191], v[32:35]
    ds_read_b64_tr_b16 v[80:81], v15 offset:20480
    v_bitop3_b32 v17, v17, v208, 1 bitop3:0xa8
    v_mfma_f32_16x16x32_bf16 v[48:51], v[112:115], v[192:195], v[48:51]
    ds_read_b64_tr_b16 v[82:83], v15 offset:22528
    v_cmp_ne_u32 vcc, 0, v17
    v_mfma_f32_16x16x32_bf16 v[52:55], v[116:119], v[192:195], v[52:55]
    ds_read_b64_tr_b16 v[84:85], v16 offset:20480
    ds_read_b64_tr_b16 v[86:87], v16 offset:22528
    v_mfma_f32_16x16x32_bf16 v[36:39], v[116:119], v[188:191], v[36:39]
    s_waitcnt lgkmcnt(8)
    s_cbranch_vccnz dm_22f1
dm_22g1:
    v_mfma_f32_16x16x32_bf16 v[24:27], v[56:59], v[196:199], v[24:27]
    ds_read_b64_tr_b16 v[88:89], v13 offset:24576
    buffer_load_dwordx4 v[188:191], v126, s[8:11], s44 offen offset:3072 sc1
    v_mfma_f32_16x16x32_bf16 v[40:43], v[56:59], v[200:203], v[40:43]
    ds_read_b64_tr_b16 v[90:91], v13 offset:26624
    buffer_load_dwordx4 v[192:195], v127, s[8:11], s44 offen offset:3072 sc1
    v_mfma_f32_16x16x32_bf16 v[44:47], v[60:63], v[200:203], v[44:47]
    ds_read_b64_tr_b16 v[92:93], v14 offset:24576
    v_mfma_f32_16x16x32_bf16 v[28:31], v[60:63], v[196:199], v[28:31]
    ds_read_b64_tr_b16 v[94:95], v14 offset:26624
    v_mfma_f32_16x16x32_bf16 v[32:35], v[64:67], v[196:199], v[32:35]
    ds_read_b64_tr_b16 v[96:97], v15 offset:24576
    s_add_u32 s43, s43, 1
    v_mfma_f32_16x16x32_bf16 v[48:51], v[64:67], v[200:203], v[48:51]
    ds_read_b64_tr_b16 v[98:99], v15 offset:26624
    v_mfma_f32_16x16x32_bf16 v[52:55], v[68:71], v[200:203], v[52:55]
    ds_read_b64_tr_b16 v[100:101], v16 offset:24576
    v_mfma_f32_16x16x32_bf16 v[36:39], v[68:71], v[196:199], v[36:39]
    ds_read_b64_tr_b16 v[102:103], v16 offset:26624
    s_waitcnt lgkmcnt(8)
    v_mfma_f32_16x16x32_bf16 v[24:27], v[72:75], v[204:207], v[24:27]
    ds_read_b64_tr_b16 v[104:105], v13 offset:28672
    buffer_load_dwordx4 v[196:199], v128, s[8:11], s44 offen offset:0 sc1
    v_mfma_f32_16x16x32_bf16 v[40:43], v[72:75], v[208:211], v[40:43]
    ds_read_b64_tr_b16 v[106:107], v13 offset:30720
    buffer_load_dwordx4 v[200:203], v129, s[8:11], s44 offen offset:0 sc1
    v_mfma_f32_16x16x32_bf16 v[44:47], v[76:79], v[208:211], v[44:47]
    ds_read_b64_tr_b16 v[108:109], v14 offset:28672
    s_waitcnt vmcnt(10)
    v_mfma_f32_16x16x32_bf16 v[28:31], v[76:79], v[204:207], v[28:31]
    ds_read_b64_tr_b16 v[110:111], v14 offset:30720
    v_add_u32 v13, 32768, v13
    v_or3_b32 v17, v212, v216, v220
    v_mfma_f32_16x16x32_bf16 v[32:35], v[80:83], v[204:207], v[32:35]
    ds_read_b64_tr_b16 v[112:113], v15 offset:28672
    v_add_u32 v14, 32768, v14
    v_bitop3_b32 v17, v17, v224, 1 bitop3:0xa8
    v_mfma_f32_16x16x32_bf16 v[48:51], v[80:83], v[208:211], v[48:51]
    ds_read_b64_tr_b16 v[114:115], v15 offset:30720
    v_add_u32 v15, 32768, v15
    v_cmp_ne_u32 vcc, 0, v17
    v_mfma_f32_16x16x32_bf16 v[52:55], v[84:87], v[208:211], v[52:55]
    ds_read_b64_tr_b16 v[116:117], v16 offset:28672
    ds_read_b64_tr_b16 v[118:119], v16 offset:30720
    s_cmp_eq_u32 s43, 4
    v_mfma_f32_16x16x32_bf16 v[36:39], v[84:87], v[204:207], v[36:39]
    v_add_u32 v16, 32768, v16
    s_waitcnt lgkmcnt(8)
    s_cbranch_vccnz dm_22f2
dm_22g2:
    s_cbranch_scc1 dm_22x
    v_mfma_f32_16x16x32_bf16 v[24:27], v[88:91], v[212:215], v[24:27]
    ds_read_b64_tr_b16 v[56:57], v13 offset:0
    buffer_load_dwordx4 v[204:207], v128, s[8:11], s44 offen offset:1024 sc1
    v_mfma_f32_16x16x32_bf16 v[40:43], v[88:91], v[216:219], v[40:43]
    ds_read_b64_tr_b16 v[58:59], v13 offset:2048
    buffer_load_dwordx4 v[208:211], v129, s[8:11], s44 offen offset:1024 sc1
    v_mfma_f32_16x16x32_bf16 v[44:47], v[92:95], v[216:219], v[44:47]
    ds_read_b64_tr_b16 v[60:61], v14 offset:0
    s_mov_b32 s49, s44
    v_mfma_f32_16x16x32_bf16 v[28:31], v[92:95], v[212:215], v[28:31]
    ds_read_b64_tr_b16 v[62:63], v14 offset:2048
    v_mfma_f32_16x16x32_bf16 v[32:35], v[96:99], v[212:215], v[32:35]
    ds_read_b64_tr_b16 v[64:65], v15 offset:0
    v_mfma_f32_16x16x32_bf16 v[48:51], v[96:99], v[216:219], v[48:51]
    ds_read_b64_tr_b16 v[66:67], v15 offset:2048
    v_mfma_f32_16x16x32_bf16 v[52:55], v[100:103], v[216:219], v[52:55]
    ds_read_b64_tr_b16 v[68:69], v16 offset:0
    v_mfma_f32_16x16x32_bf16 v[36:39], v[100:103], v[212:215], v[36:39]
    ds_read_b64_tr_b16 v[70:71], v16 offset:2048
    s_waitcnt lgkmcnt(8)
    v_mfma_f32_16x16x32_bf16 v[24:27], v[104:107], v[220:223], v[24:27]
    ds_read_b64_tr_b16 v[72:73], v13 offset:4096
    buffer_load_dwordx4 v[212:215], v128, s[8:11], s44 offen offset:2048 sc1
    v_mfma_f32_16x16x32_bf16 v[40:43], v[104:107], v[224:227], v[40:43]
    ds_read_b64_tr_b16 v[74:75], v13 offset:6144
    buffer_load_dwordx4 v[216:219], v129, s[8:11], s44 offen offset:2048 sc1
    v_mfma_f32_16x16x32_bf16 v[44:47], v[108:111], v[224:227], v[44:47]
    ds_read_b64_tr_b16 v[76:77], v14 offset:4096
    s_waitcnt vmcnt(10)
    v_mfma_f32_16x16x32_bf16 v[28:31], v[108:111], v[220:223], v[28:31]
    ds_read_b64_tr_b16 v[78:79], v14 offset:6144
    v_or3_b32 v17, v164, v168, v172
    v_mfma_f32_16x16x32_bf16 v[32:35], v[112:115], v[220:223], v[32:35]
    ds_read_b64_tr_b16 v[80:81], v15 offset:4096
    v_bitop3_b32 v17, v17, v176, 1 bitop3:0xa8
    v_mfma_f32_16x16x32_bf16 v[48:51], v[112:115], v[224:227], v[48:51]
    ds_read_b64_tr_b16 v[82:83], v15 offset:6144
    v_cmp_ne_u32 vcc, 0, v17
    v_mfma_f32_16x16x32_bf16 v[52:55], v[116:119], v[224:227], v[52:55]
    ds_read_b64_tr_b16 v[84:85], v16 offset:4096
    ds_read_b64_tr_b16 v[86:87], v16 offset:6144
    v_mfma_f32_16x16x32_bf16 v[36:39], v[116:119], v[220:223], v[36:39]
    s_waitcnt lgkmcnt(8)
    s_cbranch_vccnz dm_22f3
dm_22g3:
    s_branch dm_22
dm_22f0:
    s_cselect_b32 s50, 1, 0
dm_22h0:
    s_sleep 2
    buffer_load_dwordx4 v[180:183], v126, s[8:11], s49 offen offset:2048 sc1
    buffer_load_dwordx4 v[184:187], v127, s[8:11], s49 offen offset:2048 sc1
    buffer_load_dwordx4 v[188:191], v126, s[8:11], s49 offen offset:3072 sc1
    buffer_load_dwordx4 v[192:195], v127, s[8:11], s49 offen offset:3072 sc1
    buffer_load_dwordx4 v[196:199], v128, s[8:11], s49 offen offset:0 sc1
    buffer_load_dwordx4 v[200:203], v129, s[8:11], s49 offen offset:0 sc1
    buffer_load_dwordx4 v[204:207], v128, s[8:11], s49 offen offset:1024 sc1
    buffer_load_dwordx4 v[208:211], v129, s[8:11], s49 offen offset:1024 sc1
    buffer_load_dwordx4 v[212:215], v128, s[8:11], s49 offen offset:2048 sc1
    buffer_load_dwordx4 v[216:219], v129, s[8:11], s49 offen offset:2048 sc1
    buffer_load_dwordx4 v[220:223], v128, s[8:11], s49 offen offset:3072 sc1
    buffer_load_dwordx4 v[224:227], v129, s[8:11], s49 offen offset:3072 sc1
    buffer_load_dwordx4 v[164:167], v126, s[8:11], s44 offen offset:0 sc1
    buffer_load_dwordx4 v[168:171], v127, s[8:11], s44 offen offset:0 sc1
    s_waitcnt vmcnt(10)
    v_or3_b32 v17, v180, v184, v188
    v_bitop3_b32 v17, v17, v192, 1 bitop3:0xa8
    v_cmp_ne_u32 vcc, 0, v17
    s_add_u32 s53, s53, 1
    s_cmp_ge_u32 s53, s61
    s_cselect_b32 s61, 0, s61
    s_cbranch_scc1 dm_22k0
    s_cbranch_vccnz dm_22h0
dm_22k0:
    s_cmp_eq_u32 s50, 1
    s_branch dm_22g0
dm_22f1:
    s_cselect_b32 s50, 1, 0
dm_22h1:
    s_sleep 2
    buffer_load_dwordx4 v[196:199], v128, s[8:11], s49 offen offset:0 sc1
    buffer_load_dwordx4 v[200:203], v129, s[8:11], s49 offen offset:0 sc1
    buffer_load_dwordx4 v[204:207], v128, s[8:11], s49 offen offset:1024 sc1
    buffer_load_dwordx4 v[208:211], v129, s[8:11], s49 offen offset:1024 sc1
    buffer_load_dwordx4 v[212:215], v128, s[8:11], s49 offen offset:2048 sc1
    buffer_load_dwordx4 v[216:219], v129, s[8:11], s49 offen offset:2048 sc1
    buffer_load_dwordx4 v[220:223], v128, s[8:11], s49 offen offset:3072 sc1
    buffer_load_dwordx4 v[224:227], v129, s[8:11], s49 offen offset:3072 sc1
    buffer_load_dwordx4 v[164:167], v126, s[8:11], s44 offen offset:0 sc1
    buffer_load_dwordx4 v[168:171], v127, s[8:11], s44 offen offset:0 sc1
    buffer_load_dwordx4 v[172:175], v126, s[8:11], s44 offen offset:1024 sc1
    buffer_load_dwordx4 v[176:179], v127, s[8:11], s44 offen offset:1024 sc1
    buffer_load_dwordx4 v[180:183], v126, s[8:11], s44 offen offset:2048 sc1
    buffer_load_dwordx4 v[184:187], v127, s[8:11], s44 offen offset:2048 sc1
    s_waitcnt vmcnt(10)
    v_or3_b32 v17, v196, v200, v204
    v_bitop3_b32 v17, v17, v208, 1 bitop3:0xa8
    v_cmp_ne_u32 vcc, 0, v17
    s_add_u32 s53, s53, 1
    s_cmp_ge_u32 s53, s61
    s_cselect_b32 s61, 0, s61
    s_cbranch_scc1 dm_22k1
    s_cbranch_vccnz dm_22h1
dm_22k1:
    s_cmp_eq_u32 s50, 1
    s_branch dm_22g1
dm_22f2:
    s_cselect_b32 s50, 1, 0
dm_22h2:
    s_sleep 2
    buffer_load_dwordx4 v[212:215], v128, s[8:11], s49 offen offset:2048 sc1
    buffer_load_dwordx4 v[216:219], v129, s[8:11], s49 offen offset:2048 sc1
    buffer_load_dwordx4 v[220:223], v128, s[8:11], s49 offen offset:3072 sc1
    buffer_load_dwordx4 v[224:227], v129, s[8:11], s49 offen offset:3072 sc1
    buffer_load_dwordx4 v[164:167], v126, s[8:11], s44 offen offset:0 sc1
    buffer_load_dwordx4 v[168:171], v127, s[8:11], s44 offen offset:0 sc1
    buffer_load_dwordx4 v[172:175], v126, s[8:11], s44 offen offset:1024 sc1
    buffer_load_dwordx4 v[176:179], v127, s[8:11], s44 offen offset:1024 sc1
    buffer_load_dwordx4 v[180:183], v126, s[8:11], s44 offen offset:2048 sc1
    buffer_load_dwordx4 v[184:187], v127, s[8:11], s44 offen offset:2048 sc1
    buffer_load_dwordx4 v[188:191], v126, s[8:11], s44 offen offset:3072 sc1
    buffer_load_dwordx4 v[192:195], v127, s[8:11], s44 offen offset:3072 sc1
    buffer_load_dwordx4 v[196:199], v128, s[8:11], s44 offen offset:0 sc1
    buffer_load_dwordx4 v[200:203], v129, s[8:11], s44 offen offset:0 sc1
    s_waitcnt vmcnt(10)
    v_or3_b32 v17, v212, v216, v220
    v_bitop3_b32 v17, v17, v224, 1 bitop3:0xa8
    v_cmp_ne_u32 vcc, 0, v17
    s_add_u32 s53, s53, 1
    s_cmp_ge_u32 s53, s61
    s_cselect_b32 s61, 0, s61
    s_cbranch_scc1 dm_22k2
    s_cbranch_vccnz dm_22h2
dm_22k2:
    s_cmp_eq_u32 s50, 1
    s_branch dm_22g2
dm_22f3:
    s_cselect_b32 s50, 1, 0
dm_22h3:
    s_sleep 2
    buffer_load_dwordx4 v[164:167], v126, s[8:11], s49 offen offset:0 sc1
    buffer_load_dwordx4 v[168:171], v127, s[8:11], s49 offen offset:0 sc1
    buffer_load_dwordx4 v[172:175], v126, s[8:11], s49 offen offset:1024 sc1
    buffer_load_dwordx4 v[176:179], v127, s[8:11], s49 offen offset:1024 sc1
    buffer_load_dwordx4 v[180:183], v126, s[8:11], s49 offen offset:2048 sc1
    buffer_load_dwordx4 v[184:187], v127, s[8:11], s49 offen offset:2048 sc1
    buffer_load_dwordx4 v[188:191], v126, s[8:11], s49 offen offset:3072 sc1
    buffer_load_dwordx4 v[192:195], v127, s[8:11], s49 offen offset:3072 sc1
    buffer_load_dwordx4 v[196:199], v128, s[8:11], s49 offen offset:0 sc1
    buffer_load_dwordx4 v[200:203], v129, s[8:11], s49 offen offset:0 sc1
    buffer_load_dwordx4 v[204:207], v128, s[8:11], s49 offen offset:1024 sc1
    buffer_load_dwordx4 v[208:211], v129, s[8:11], s49 offen offset:1024 sc1
    buffer_load_dwordx4 v[212:215], v128, s[8:11], s49 offen offset:2048 sc1
    buffer_load_dwordx4 v[216:219], v129, s[8:11], s49 offen offset:2048 sc1
    s_waitcnt vmcnt(10)
    v_or3_b32 v17, v164, v168, v172
    v_bitop3_b32 v17, v17, v176, 1 bitop3:0xa8
    v_cmp_ne_u32 vcc, 0, v17
    s_add_u32 s53, s53, 1
    s_cmp_ge_u32 s53, s61
    s_cselect_b32 s61, 0, s61
    s_cbranch_scc1 dm_22k3
    s_cbranch_vccnz dm_22h3
dm_22k3:
    s_cmp_eq_u32 s50, 1
    s_branch dm_22g3
dm_22x:
    v_mfma_f32_16x16x32_bf16 v[24:27], v[88:91], v[212:215], v[24:27]
    buffer_load_dwordx4 v[148:151], v126, s[8:11], s41 offen offset:0 sc1
    v_mfma_f32_16x16x32_bf16 v[40:43], v[88:91], v[216:219], v[40:43]
    v_mfma_f32_16x16x32_bf16 v[44:47], v[92:95], v[216:219], v[44:47]
    buffer_load_dwordx4 v[152:155], v126, s[8:11], s41 offen offset:1024 sc1
    v_mfma_f32_16x16x32_bf16 v[28:31], v[92:95], v[212:215], v[28:31]
    v_mfma_f32_16x16x32_bf16 v[32:35], v[96:99], v[212:215], v[32:35]
    buffer_load_dwordx4 v[156:159], v127, s[8:11], s41 offen offset:0 sc1
    v_mfma_f32_16x16x32_bf16 v[48:51], v[96:99], v[216:219], v[48:51]
    v_mfma_f32_16x16x32_bf16 v[52:55], v[100:103], v[216:219], v[52:55]
    buffer_load_dwordx4 v[160:163], v127, s[8:11], s41 offen offset:1024 sc1
    v_mfma_f32_16x16x32_bf16 v[36:39], v[100:103], v[212:215], v[36:39]
    s_waitcnt lgkmcnt(0)
    s_barrier
    v_mfma_f32_16x16x32_bf16 v[24:27], v[104:107], v[220:223], v[24:27]
    ds_read_b128 v[56:59], v6 offset:0
    v_mfma_f32_16x16x32_bf16 v[40:43], v[104:107], v[224:227], v[40:43]
    ds_read_b128 v[60:63], v6 offset:64
    v_mfma_f32_16x16x32_bf16 v[44:47], v[108:111], v[224:227], v[44:47]
    ds_read_b128 v[64:67], v6 offset:128
    v_mfma_f32_16x16x32_bf16 v[28:31], v[108:111], v[220:223], v[28:31]
    ds_read_b128 v[68:71], v6 offset:192
    v_mfma_f32_16x16x32_bf16 v[32:35], v[112:115], v[220:223], v[32:35]
    ds_read_b64 v[72:73], v7 offset:0
    v_mfma_f32_16x16x32_bf16 v[48:51], v[112:115], v[224:227], v[48:51]
    ds_read_b64 v[74:75], v7 offset:256
    v_mfma_f32_16x16x32_bf16 v[52:55], v[116:119], v[224:227], v[52:55]
    v_mfma_f32_16x16x32_bf16 v[36:39], v[116:119], v[220:223], v[36:39]
    s_waitcnt lgkmcnt(0)
    v_mul_f32 v134, 0xc0135761, v73
    v_mul_f32 v135, v73, v73
    v_mul_f32 v135, v135, v134
    v_mul_f32 v135, 0x3d372713, v135
    v_rcp_f32 v73, v73
    v_mul_f32 v136, 0xc0135761, v75
    v_mul_f32 v137, v75, v75
    v_mul_f32 v137, v137, v136
    v_mul_f32 v137, 0x3d372713, v137
    v_rcp_f32 v75, v75
    v_pk_fma_f32 v[24:25], v[72:73], v[56:57], v[24:25] op_sel_hi:[0,1,1] neg_lo:[1,0,0] neg_hi:[1,0,0]
    v_pk_fma_f32 v[26:27], v[72:73], v[58:59], v[26:27] op_sel_hi:[0,1,1] neg_lo:[1,0,0] neg_hi:[1,0,0]
    v_pk_mul_f32 v[122:123], v[24:25], v[24:25]
    v_pk_mul_f32 v[124:125], v[26:27], v[26:27]
    v_pk_fma_f32 v[122:123], v[122:123], v[134:135], v[134:135] op_sel:[0,1,0] op_sel_hi:[1,1,0]
    v_pk_fma_f32 v[124:125], v[124:125], v[134:135], v[134:135] op_sel:[0,1,0] op_sel_hi:[1,1,0]
    v_pk_mul_f32 v[122:123], v[122:123], v[24:25]
    v_pk_mul_f32 v[124:125], v[124:125], v[26:27]
    v_exp_f32 v122, v122
    v_exp_f32 v123, v123
    v_exp_f32 v124, v124
    v_exp_f32 v125, v125
    v_pk_fma_f32 v[122:123], v[122:123], v[72:73], v[72:73] op_sel:[0,1,1] op_sel_hi:[1,1,1]
    v_pk_fma_f32 v[124:125], v[124:125], v[72:73], v[72:73] op_sel:[0,1,1] op_sel_hi:[1,1,1]
    v_rcp_f32 v122, v122
    v_rcp_f32 v123, v123
    v_rcp_f32 v124, v124
    v_rcp_f32 v125, v125
    v_pk_mul_f32 v[24:25], v[24:25], v[122:123]
    v_pk_mul_f32 v[26:27], v[26:27], v[124:125]
    v_pk_fma_f32 v[28:29], v[72:73], v[60:61], v[28:29] op_sel_hi:[0,1,1] neg_lo:[1,0,0] neg_hi:[1,0,0]
    v_pk_fma_f32 v[30:31], v[72:73], v[62:63], v[30:31] op_sel_hi:[0,1,1] neg_lo:[1,0,0] neg_hi:[1,0,0]
    v_pk_mul_f32 v[122:123], v[28:29], v[28:29]
    v_pk_mul_f32 v[124:125], v[30:31], v[30:31]
    v_pk_fma_f32 v[122:123], v[122:123], v[134:135], v[134:135] op_sel:[0,1,0] op_sel_hi:[1,1,0]
    v_pk_fma_f32 v[124:125], v[124:125], v[134:135], v[134:135] op_sel:[0,1,0] op_sel_hi:[1,1,0]
    v_pk_mul_f32 v[122:123], v[122:123], v[28:29]
    v_pk_mul_f32 v[124:125], v[124:125], v[30:31]
    v_exp_f32 v122, v122
    v_exp_f32 v123, v123
    v_exp_f32 v124, v124
    v_exp_f32 v125, v125
    v_pk_fma_f32 v[122:123], v[122:123], v[72:73], v[72:73] op_sel:[0,1,1] op_sel_hi:[1,1,1]
    v_pk_fma_f32 v[124:125], v[124:125], v[72:73], v[72:73] op_sel:[0,1,1] op_sel_hi:[1,1,1]
    v_rcp_f32 v122, v122
    v_rcp_f32 v123, v123
    v_rcp_f32 v124, v124
    v_rcp_f32 v125, v125
    v_pk_mul_f32 v[28:29], v[28:29], v[122:123]
    v_pk_mul_f32 v[30:31], v[30:31], v[124:125]
    v_cvt_pk_bf16_f32 v24, v24, v25
    v_cvt_pk_bf16_f32 v25, v26, v27
    v_cvt_pk_bf16_f32 v26, v28, v29
    v_cvt_pk_bf16_f32 v27, v30, v31
    v_and_b32 v24, -2, v24
    buffer_store_dwordx4 v[24:27], v12, s[16:19], s39 offen offset:0 sc1
    v_pk_fma_f32 v[40:41], v[74:75], v[56:57], v[40:41] op_sel_hi:[0,1,1] neg_lo:[1,0,0] neg_hi:[1,0,0]
    v_pk_fma_f32 v[42:43], v[74:75], v[58:59], v[42:43] op_sel_hi:[0,1,1] neg_lo:[1,0,0] neg_hi:[1,0,0]
    v_pk_mul_f32 v[122:123], v[40:41], v[40:41]
    v_pk_mul_f32 v[124:125], v[42:43], v[42:43]
    v_pk_fma_f32 v[122:123], v[122:123], v[136:137], v[136:137] op_sel:[0,1,0] op_sel_hi:[1,1,0]
    v_pk_fma_f32 v[124:125], v[124:125], v[136:137], v[136:137] op_sel:[0,1,0] op_sel_hi:[1,1,0]
    v_pk_mul_f32 v[122:123], v[122:123], v[40:41]
    v_pk_mul_f32 v[124:125], v[124:125], v[42:43]
    v_exp_f32 v122, v122
    v_exp_f32 v123, v123
    v_exp_f32 v124, v124
    v_exp_f32 v125, v125
    v_pk_fma_f32 v[122:123], v[122:123], v[74:75], v[74:75] op_sel:[0,1,1] op_sel_hi:[1,1,1]
    v_pk_fma_f32 v[124:125], v[124:125], v[74:75], v[74:75] op_sel:[0,1,1] op_sel_hi:[1,1,1]
    v_rcp_f32 v122, v122
    v_rcp_f32 v123, v123
    v_rcp_f32 v124, v124
    v_rcp_f32 v125, v125
    v_pk_mul_f32 v[40:41], v[40:41], v[122:123]
    v_pk_mul_f32 v[42:43], v[42:43], v[124:125]
    v_pk_fma_f32 v[44:45], v[74:75], v[60:61], v[44:45] op_sel_hi:[0,1,1] neg_lo:[1,0,0] neg_hi:[1,0,0]
    v_pk_fma_f32 v[46:47], v[74:75], v[62:63], v[46:47] op_sel_hi:[0,1,1] neg_lo:[1,0,0] neg_hi:[1,0,0]
    v_pk_mul_f32 v[122:123], v[44:45], v[44:45]
    v_pk_mul_f32 v[124:125], v[46:47], v[46:47]
    v_pk_fma_f32 v[122:123], v[122:123], v[136:137], v[136:137] op_sel:[0,1,0] op_sel_hi:[1,1,0]
    v_pk_fma_f32 v[124:125], v[124:125], v[136:137], v[136:137] op_sel:[0,1,0] op_sel_hi:[1,1,0]
    v_pk_mul_f32 v[122:123], v[122:123], v[44:45]
    v_pk_mul_f32 v[124:125], v[124:125], v[46:47]
    v_exp_f32 v122, v122
    v_exp_f32 v123, v123
    v_exp_f32 v124, v124
    v_exp_f32 v125, v125
    v_pk_fma_f32 v[122:123], v[122:123], v[74:75], v[74:75] op_sel:[0,1,1] op_sel_hi:[1,1,1]
    v_pk_fma_f32 v[124:125], v[124:125], v[74:75], v[74:75] op_sel:[0,1,1] op_sel_hi:[1,1,1]
    v_rcp_f32 v122, v122
    v_rcp_f32 v123, v123
    v_rcp_f32 v124, v124
    v_rcp_f32 v125, v125
    v_pk_mul_f32 v[44:45], v[44:45], v[122:123]
    v_pk_mul_f32 v[46:47], v[46:47], v[124:125]
    v_cvt_pk_bf16_f32 v40, v40, v41
    v_cvt_pk_bf16_f32 v41, v42, v43
    v_cvt_pk_bf16_f32 v42, v44, v45
    v_cvt_pk_bf16_f32 v43, v46, v47
    v_and_b32 v40, -2, v40
    buffer_store_dwordx4 v[40:43], v12, s[16:19], s39 offen offset:256 sc1
    v_pk_fma_f32 v[32:33], v[72:73], v[64:65], v[32:33] op_sel_hi:[0,1,1] neg_lo:[1,0,0] neg_hi:[1,0,0]
    v_pk_fma_f32 v[34:35], v[72:73], v[66:67], v[34:35] op_sel_hi:[0,1,1] neg_lo:[1,0,0] neg_hi:[1,0,0]
    v_pk_mul_f32 v[122:123], v[32:33], v[32:33]
    v_pk_mul_f32 v[124:125], v[34:35], v[34:35]
    v_pk_fma_f32 v[122:123], v[122:123], v[134:135], v[134:135] op_sel:[0,1,0] op_sel_hi:[1,1,0]
    v_pk_fma_f32 v[124:125], v[124:125], v[134:135], v[134:135] op_sel:[0,1,0] op_sel_hi:[1,1,0]
    v_pk_mul_f32 v[122:123], v[122:123], v[32:33]
    v_pk_mul_f32 v[124:125], v[124:125], v[34:35]
    v_exp_f32 v122, v122
    v_exp_f32 v123, v123
    v_exp_f32 v124, v124
    v_exp_f32 v125, v125
    v_pk_fma_f32 v[122:123], v[122:123], v[72:73], v[72:73] op_sel:[0,1,1] op_sel_hi:[1,1,1]
    v_pk_fma_f32 v[124:125], v[124:125], v[72:73], v[72:73] op_sel:[0,1,1] op_sel_hi:[1,1,1]
    v_rcp_f32 v122, v122
    v_rcp_f32 v123, v123
    v_rcp_f32 v124, v124
    v_rcp_f32 v125, v125
    v_pk_mul_f32 v[32:33], v[32:33], v[122:123]
    v_pk_mul_f32 v[34:35], v[34:35], v[124:125]
    v_pk_fma_f32 v[36:37], v[72:73], v[68:69], v[36:37] op_sel_hi:[0,1,1] neg_lo:[1,0,0] neg_hi:[1,0,0]
    v_pk_fma_f32 v[38:39], v[72:73], v[70:71], v[38:39] op_sel_hi:[0,1,1] neg_lo:[1,0,0] neg_hi:[1,0,0]
    v_pk_mul_f32 v[122:123], v[36:37], v[36:37]
    v_pk_mul_f32 v[124:125], v[38:39], v[38:39]
    v_pk_fma_f32 v[122:123], v[122:123], v[134:135], v[134:135] op_sel:[0,1,0] op_sel_hi:[1,1,0]
    v_pk_fma_f32 v[124:125], v[124:125], v[134:135], v[134:135] op_sel:[0,1,0] op_sel_hi:[1,1,0]
    v_pk_mul_f32 v[122:123], v[122:123], v[36:37]
    v_pk_mul_f32 v[124:125], v[124:125], v[38:39]
    v_exp_f32 v122, v122
    v_exp_f32 v123, v123
    v_exp_f32 v124, v124
    v_exp_f32 v125, v125
    v_pk_fma_f32 v[122:123], v[122:123], v[72:73], v[72:73] op_sel:[0,1,1] op_sel_hi:[1,1,1]
    v_pk_fma_f32 v[124:125], v[124:125], v[72:73], v[72:73] op_sel:[0,1,1] op_sel_hi:[1,1,1]
    v_rcp_f32 v122, v122
    v_rcp_f32 v123, v123
    v_rcp_f32 v124, v124
    v_rcp_f32 v125, v125
    v_pk_mul_f32 v[36:37], v[36:37], v[122:123]
    v_pk_mul_f32 v[38:39], v[38:39], v[124:125]
    v_cvt_pk_bf16_f32 v32, v32, v33
    v_cvt_pk_bf16_f32 v33, v34, v35
    v_cvt_pk_bf16_f32 v34, v36, v37
    v_cvt_pk_bf16_f32 v35, v38, v39
    v_and_b32 v32, -2, v32
    buffer_store_dwordx4 v[32:35], v12, s[16:19], s40 offen offset:0 sc1
    v_pk_fma_f32 v[48:49], v[74:75], v[64:65], v[48:49] op_sel_hi:[0,1,1] neg_lo:[1,0,0] neg_hi:[1,0,0]
    v_pk_fma_f32 v[50:51], v[74:75], v[66:67], v[50:51] op_sel_hi:[0,1,1] neg_lo:[1,0,0] neg_hi:[1,0,0]
    v_pk_mul_f32 v[122:123], v[48:49], v[48:49]
    v_pk_mul_f32 v[124:125], v[50:51], v[50:51]
    v_pk_fma_f32 v[122:123], v[122:123], v[136:137], v[136:137] op_sel:[0,1,0] op_sel_hi:[1,1,0]
    v_pk_fma_f32 v[124:125], v[124:125], v[136:137], v[136:137] op_sel:[0,1,0] op_sel_hi:[1,1,0]
    v_pk_mul_f32 v[122:123], v[122:123], v[48:49]
    v_pk_mul_f32 v[124:125], v[124:125], v[50:51]
    v_exp_f32 v122, v122
    v_exp_f32 v123, v123
    v_exp_f32 v124, v124
    v_exp_f32 v125, v125
    v_pk_fma_f32 v[122:123], v[122:123], v[74:75], v[74:75] op_sel:[0,1,1] op_sel_hi:[1,1,1]
    v_pk_fma_f32 v[124:125], v[124:125], v[74:75], v[74:75] op_sel:[0,1,1] op_sel_hi:[1,1,1]
    v_rcp_f32 v122, v122
    v_rcp_f32 v123, v123
    v_rcp_f32 v124, v124
    v_rcp_f32 v125, v125
    v_pk_mul_f32 v[48:49], v[48:49], v[122:123]
    v_pk_mul_f32 v[50:51], v[50:51], v[124:125]
    v_pk_fma_f32 v[52:53], v[74:75], v[68:69], v[52:53] op_sel_hi:[0,1,1] neg_lo:[1,0,0] neg_hi:[1,0,0]
    v_pk_fma_f32 v[54:55], v[74:75], v[70:71], v[54:55] op_sel_hi:[0,1,1] neg_lo:[1,0,0] neg_hi:[1,0,0]
    v_pk_mul_f32 v[122:123], v[52:53], v[52:53]
    v_pk_mul_f32 v[124:125], v[54:55], v[54:55]
    v_pk_fma_f32 v[122:123], v[122:123], v[136:137], v[136:137] op_sel:[0,1,0] op_sel_hi:[1,1,0]
    v_pk_fma_f32 v[124:125], v[124:125], v[136:137], v[136:137] op_sel:[0,1,0] op_sel_hi:[1,1,0]
    v_pk_mul_f32 v[122:123], v[122:123], v[52:53]
    v_pk_mul_f32 v[124:125], v[124:125], v[54:55]
    v_exp_f32 v122, v122
    v_exp_f32 v123, v123
    v_exp_f32 v124, v124
    v_exp_f32 v125, v125
    v_pk_fma_f32 v[122:123], v[122:123], v[74:75], v[74:75] op_sel:[0,1,1] op_sel_hi:[1,1,1]
    v_pk_fma_f32 v[124:125], v[124:125], v[74:75], v[74:75] op_sel:[0,1,1] op_sel_hi:[1,1,1]
    v_rcp_f32 v122, v122
    v_rcp_f32 v123, v123
    v_rcp_f32 v124, v124
    v_rcp_f32 v125, v125
    v_pk_mul_f32 v[52:53], v[52:53], v[122:123]
    v_pk_mul_f32 v[54:55], v[54:55], v[124:125]
    v_cvt_pk_bf16_f32 v48, v48, v49
    v_cvt_pk_bf16_f32 v49, v50, v51
    v_cvt_pk_bf16_f32 v50, v52, v53
    v_cvt_pk_bf16_f32 v51, v54, v55
    v_and_b32 v48, -2, v48
    buffer_store_dwordx4 v[48:51], v12, s[16:19], s40 offen offset:256 sc1
    s_add_u32 s8, s4, 0x2100000
    s_addc_u32 s9, s5, 0
    s_mov_b32 s10, 0x8400000
    s_mov_b32 s11, 0x20000
    s_sub_u32 s47, s55, 39583744
    s_lshl_b32 s46, s30, 9
    s_add_u32 s47, s47, s46
    s_add_u32 s45, s92, 2048
    s_cmp_eq_u32 s28, 0
    s_cselect_b32 s45, 1073741824, s45
    s_cmp_eq_u32 s30, 0
    s_cselect_b32 s45, s45, 0
    s_add_u32 s53, s47, 0xfffffff0
    v_add_u32 v126, s53, v12
    v_add_u32 v127, 256, v126
    v_add_u32 v134, s45, v126
    v_cmp_gt_u32 vcc, 1, v22
    s_nop 1
    v_cndmask_b32 v126, v126, v134, vcc
    s_mov_b32 s34, s30
    s_mov_b32 s35, 0
    v_and_b32 v22, 15, v1
    v_lshrrev_b32 v23, 4, v1
    s_mul_i32 s37, s34, 2
    s_mul_i32 s38, s29, 4
    s_mul_i32 s36, s35, 4
    s_add_u32 s38, s38, s36
    s_lshr_b32 s36, s38, 1
    s_lshr_b32 s53, s36, 3
    s_lshl_b32 s53, s53, 14
    s_and_b32 s39, s36, 7
    s_lshl_b32 s39, s39, 10
    s_add_u32 s39, s39, s53
    s_lshl_b32 s36, s37, 16
    s_add_u32 s39, s39, s36
    s_sub_u32 s46, s93, 2048
    s_cmp_eq_u32 s28, 15
    s_cselect_b32 s46, 1073741824, s46
    s_cmp_eq_u32 s30, 3
    s_cselect_b32 s46, s46, 0
    s_add_u32 s53, s47, 0x10
    v_add_u32 v128, s53, v12
    v_add_u32 v129, 256, v128
    v_add_u32 v134, s46, v129
    v_cmp_le_u32 vcc, 15, v22
    s_nop 1
    v_cndmask_b32 v129, v129, v134, vcc
    s_add_u32 s53, s47, 0xffffffe0
    v_add_u32 v130, s53, v12
    v_add_u32 v131, 256, v130
    v_add_u32 v134, s45, v130
    v_cmp_gt_u32 vcc, 2, v22
    s_nop 1
    v_cndmask_b32 v130, v130, v134, vcc
    s_add_u32 s53, s47, 0x20
    v_add_u32 v132, s53, v12
    v_add_u32 v133, 256, v132
    v_add_u32 v134, s46, v133
    v_cmp_le_u32 vcc, 14, v22
    s_nop 1
    v_cndmask_b32 v133, v133, v134, vcc
    v_mov_b32 v134, v126
    v_mov_b32 v135, v127
    v_lshrrev_b32 v6, 2, v1
    v_mul_u32_u24 v13, 128, v6
    v_and_b32 v7, 3, v1
    v_lshl_add_u32 v13, v7, 3, v13
    v_add_u32 v13, 0, v13
    v_bfe_u32 v6, v6, 1, 2
    s_mul_i32 s36, s35, 4
    s_add_u32 s36, s36, 3
    v_xor_b32 v7, s36, v6
    v_lshl_add_u32 v16, v7, 5, v13
    s_mul_i32 s36, s35, 4
    s_add_u32 s36, s36, 2
    v_xor_b32 v7, s36, v6
    v_lshl_add_u32 v15, v7, 5, v13
    s_mul_i32 s36, s35, 4
    s_add_u32 s36, s36, 1
    v_xor_b32 v7, s36, v6
    v_lshl_add_u32 v14, v7, 5, v13
    s_mul_i32 s36, s35, 4
    s_add_u32 s36, s36, 0
    v_xor_b32 v7, s36, v6
    v_lshl_add_u32 v13, v7, 5, v13
    s_lshl_b32 s36, s37, 8
    s_add_u32 s36, s36, 160768
    v_lshlrev_b32 v7, 4, v22
    v_add_u32 v7, s36, v7
    ds_read_b64 v[56:57], v7 offset:0
    ds_read_b64 v[58:59], v7 offset:256
    s_waitcnt vmcnt(4) lgkmcnt(0)
    s_sleep 6
    s_cmp_lg_u32 s60, 0
    s_cbranch_scc1 G2_nd
    s_sleep 2
G2_nd:
    s_mov_b32 s44, 0
    buffer_load_dwordx4 v[164:167], v126, s[8:11], s44 offen sc1
    buffer_load_dwordx4 v[168:171], v127, s[8:11], s44 offen sc1
    s_add_u32 s44, s44, 16384
    buffer_load_dwordx4 v[172:175], v126, s[8:11], s44 offen sc1
    buffer_load_dwordx4 v[176:179], v127, s[8:11], s44 offen sc1
    s_add_u32 s44, s44, 16384
    buffer_load_dwordx4 v[180:183], v126, s[8:11], s44 offen
    buffer_load_dwordx4 v[184:187], v127, s[8:11], s44 offen
    s_add_u32 s44, s44, 16384
    buffer_load_dwordx4 v[188:191], v126, s[8:11], s44 offen
    buffer_load_dwordx4 v[192:195], v127, s[8:11], s44 offen
    s_add_u32 s44, s44, 16384
    v_lshlrev_b32 v24, 16, v148
    v_and_b32 v25, 0xffff0000, v148
    v_pk_add_f32 v[24:25], v[24:25], v[56:57] op_sel_hi:[1,0] neg_lo:[0,1] neg_hi:[0,1]
    v_pk_mul_f32 v[24:25], v[24:25], v[56:57] op_sel:[0,1] op_sel_hi:[1,1]
    v_lshlrev_b32 v26, 16, v149
    v_and_b32 v27, 0xffff0000, v149
    v_pk_add_f32 v[26:27], v[26:27], v[56:57] op_sel_hi:[1,0] neg_lo:[0,1] neg_hi:[0,1]
    v_pk_mul_f32 v[26:27], v[26:27], v[56:57] op_sel:[0,1] op_sel_hi:[1,1]
    v_lshlrev_b32 v28, 16, v150
    v_and_b32 v29, 0xffff0000, v150
    v_pk_add_f32 v[28:29], v[28:29], v[56:57] op_sel_hi:[1,0] neg_lo:[0,1] neg_hi:[0,1]
    v_pk_mul_f32 v[28:29], v[28:29], v[56:57] op_sel:[0,1] op_sel_hi:[1,1]
    v_lshlrev_b32 v30, 16, v151
    v_and_b32 v31, 0xffff0000, v151
    v_pk_add_f32 v[30:31], v[30:31], v[56:57] op_sel_hi:[1,0] neg_lo:[0,1] neg_hi:[0,1]
    v_pk_mul_f32 v[30:31], v[30:31], v[56:57] op_sel:[0,1] op_sel_hi:[1,1]
    v_lshlrev_b32 v32, 16, v152
    v_and_b32 v33, 0xffff0000, v152
    v_pk_add_f32 v[32:33], v[32:33], v[56:57] op_sel_hi:[1,0] neg_lo:[0,1] neg_hi:[0,1]
    v_pk_mul_f32 v[32:33], v[32:33], v[56:57] op_sel:[0,1] op_sel_hi:[1,1]
    v_lshlrev_b32 v34, 16, v153
    v_and_b32 v35, 0xffff0000, v153
    v_pk_add_f32 v[34:35], v[34:35], v[56:57] op_sel_hi:[1,0] neg_lo:[0,1] neg_hi:[0,1]
    v_pk_mul_f32 v[34:35], v[34:35], v[56:57] op_sel:[0,1] op_sel_hi:[1,1]
    v_lshlrev_b32 v36, 16, v154
    v_and_b32 v37, 0xffff0000, v154
    v_pk_add_f32 v[36:37], v[36:37], v[56:57] op_sel_hi:[1,0] neg_lo:[0,1] neg_hi:[0,1]
    v_pk_mul_f32 v[36:37], v[36:37], v[56:57] op_sel:[0,1] op_sel_hi:[1,1]
    v_lshlrev_b32 v38, 16, v155
    v_and_b32 v39, 0xffff0000, v155
    v_pk_add_f32 v[38:39], v[38:39], v[56:57] op_sel_hi:[1,0] neg_lo:[0,1] neg_hi:[0,1]
    v_pk_mul_f32 v[38:39], v[38:39], v[56:57] op_sel:[0,1] op_sel_hi:[1,1]
    v_lshlrev_b32 v40, 16, v156
    v_and_b32 v41, 0xffff0000, v156
    v_pk_add_f32 v[40:41], v[40:41], v[58:59] op_sel_hi:[1,0] neg_lo:[0,1] neg_hi:[0,1]
    v_pk_mul_f32 v[40:41], v[40:41], v[58:59] op_sel:[0,1] op_sel_hi:[1,1]
    v_lshlrev_b32 v42, 16, v157
    v_and_b32 v43, 0xffff0000, v157
    v_pk_add_f32 v[42:43], v[42:43], v[58:59] op_sel_hi:[1,0] neg_lo:[0,1] neg_hi:[0,1]
    v_pk_mul_f32 v[42:43], v[42:43], v[58:59] op_sel:[0,1] op_sel_hi:[1,1]
    v_lshlrev_b32 v44, 16, v158
    v_and_b32 v45, 0xffff0000, v158
    v_pk_add_f32 v[44:45], v[44:45], v[58:59] op_sel_hi:[1,0] neg_lo:[0,1] neg_hi:[0,1]
    v_pk_mul_f32 v[44:45], v[44:45], v[58:59] op_sel:[0,1] op_sel_hi:[1,1]
    v_lshlrev_b32 v46, 16, v159
    v_and_b32 v47, 0xffff0000, v159
    v_pk_add_f32 v[46:47], v[46:47], v[58:59] op_sel_hi:[1,0] neg_lo:[0,1] neg_hi:[0,1]
    v_pk_mul_f32 v[46:47], v[46:47], v[58:59] op_sel:[0,1] op_sel_hi:[1,1]
    v_lshlrev_b32 v48, 16, v160
    v_and_b32 v49, 0xffff0000, v160
    v_pk_add_f32 v[48:49], v[48:49], v[58:59] op_sel_hi:[1,0] neg_lo:[0,1] neg_hi:[0,1]
    v_pk_mul_f32 v[48:49], v[48:49], v[58:59] op_sel:[0,1] op_sel_hi:[1,1]
    v_lshlrev_b32 v50, 16, v161
    v_and_b32 v51, 0xffff0000, v161
    v_pk_add_f32 v[50:51], v[50:51], v[58:59] op_sel_hi:[1,0] neg_lo:[0,1] neg_hi:[0,1]
    v_pk_mul_f32 v[50:51], v[50:51], v[58:59] op_sel:[0,1] op_sel_hi:[1,1]
    v_lshlrev_b32 v52, 16, v162
    v_and_b32 v53, 0xffff0000, v162
    v_pk_add_f32 v[52:53], v[52:53], v[58:59] op_sel_hi:[1,0] neg_lo:[0,1] neg_hi:[0,1]
    v_pk_mul_f32 v[52:53], v[52:53], v[58:59] op_sel:[0,1] op_sel_hi:[1,1]
    v_lshlrev_b32 v54, 16, v163
    v_and_b32 v55, 0xffff0000, v163
    v_pk_add_f32 v[54:55], v[54:55], v[58:59] op_sel_hi:[1,0] neg_lo:[0,1] neg_hi:[0,1]
    v_pk_mul_f32 v[54:55], v[54:55], v[58:59] op_sel:[0,1] op_sel_hi:[1,1]
    s_mov_b32 s43, 0
    s_add_u32 s16, s62, 0x80000
    s_addc_u32 s17, s63, 0
    s_mov_b32 s18, 0x7e000
    s_mov_b32 s19, 0x20000
    s_mov_b32 s53, 0
    s_mov_b32 s49, s44
    s_barrier
    ds_read_b64_tr_b16 v[56:57], v13 offset:0
    ds_read_b64_tr_b16 v[58:59], v13 offset:2048
    ds_read_b64_tr_b16 v[60:61], v14 offset:0
    ds_read_b64_tr_b16 v[62:63], v14 offset:2048
    ds_read_b64_tr_b16 v[64:65], v15 offset:0
    ds_read_b64_tr_b16 v[66:67], v15 offset:2048
    ds_read_b64_tr_b16 v[68:69], v16 offset:0
    ds_read_b64_tr_b16 v[70:71], v16 offset:2048
    ds_read_b64_tr_b16 v[72:73], v13 offset:4096
    ds_read_b64_tr_b16 v[74:75], v13 offset:6144
    ds_read_b64_tr_b16 v[76:77], v14 offset:4096
    ds_read_b64_tr_b16 v[78:79], v14 offset:6144
    ds_read_b64_tr_b16 v[80:81], v15 offset:4096
    ds_read_b64_tr_b16 v[82:83], v15 offset:6144
    ds_read_b64_tr_b16 v[84:85], v16 offset:4096
    ds_read_b64_tr_b16 v[86:87], v16 offset:6144
    s_branch dm_23w
dm_23p:
    s_mov_b32 s44, 0
    buffer_load_dwordx4 v[164:167], v126, s[8:11], s44 offen sc1
    buffer_load_dwordx4 v[168:171], v127, s[8:11], s44 offen sc1
    s_add_u32 s44, s44, 16384
    buffer_load_dwordx4 v[172:175], v126, s[8:11], s44 offen sc1
    buffer_load_dwordx4 v[176:179], v127, s[8:11], s44 offen sc1
    s_add_u32 s44, s44, 16384
    buffer_load_dwordx4 v[180:183], v126, s[8:11], s44 offen
    buffer_load_dwordx4 v[184:187], v127, s[8:11], s44 offen
    s_add_u32 s44, s44, 16384
    buffer_load_dwordx4 v[188:191], v126, s[8:11], s44 offen
    buffer_load_dwordx4 v[192:195], v127, s[8:11], s44 offen
    s_add_u32 s44, s44, 16384
dm_23w:
    s_waitcnt vmcnt(4)
    v_or3_b32 v17, v164, v168, v172
    v_bitop3_b32 v17, v17, v176, 1 bitop3:0xa8
    v_cmp_ne_u32 vcc, 0, v17
    s_cbranch_vccz dm_23q
dm_23r:
    s_sleep 2
    s_mov_b32 s44, 0
    buffer_load_dwordx4 v[164:167], v126, s[8:11], s44 offen sc1
    buffer_load_dwordx4 v[168:171], v127, s[8:11], s44 offen sc1
    s_add_u32 s44, s44, 16384
    buffer_load_dwordx4 v[172:175], v126, s[8:11], s44 offen sc1
    buffer_load_dwordx4 v[176:179], v127, s[8:11], s44 offen sc1
    s_add_u32 s44, s44, 16384
    buffer_load_dwordx4 v[180:183], v126, s[8:11], s44 offen sc1
    buffer_load_dwordx4 v[184:187], v127, s[8:11], s44 offen sc1
    s_add_u32 s44, s44, 16384
    buffer_load_dwordx4 v[188:191], v126, s[8:11], s44 offen sc1
    buffer_load_dwordx4 v[192:195], v127, s[8:11], s44 offen sc1
    s_add_u32 s44, s44, 16384
    s_waitcnt vmcnt(4)
    v_or3_b32 v17, v164, v168, v172
    v_bitop3_b32 v17, v17, v176, 1 bitop3:0xa8
    v_cmp_ne_u32 vcc, 0, v17
    s_cbranch_vccz dm_23t
    s_add_u32 s53, s53, 1
    s_cmp_lt_u32 s53, s61
    s_cbranch_scc1 dm_23r
    s_mov_b32 s61, 0
    s_branch dm_23t
dm_23q:
dm_23t:
    buffer_load_dwordx4 v[196:199], v126, s[8:11], s44 offen
    buffer_load_dwordx4 v[200:203], v127, s[8:11], s44 offen
    s_add_u32 s44, s44, 16384
    buffer_load_dwordx4 v[204:207], v126, s[8:11], s44 offen
    buffer_load_dwordx4 v[208:211], v127, s[8:11], s44 offen
    s_add_u32 s44, s44, 16384
    buffer_load_dwordx4 v[212:215], v126, s[8:11], s44 offen
    buffer_load_dwordx4 v[216:219], v127, s[8:11], s44 offen
    s_add_u32 s44, s44, 16384
    s_waitcnt lgkmcnt(0)
dm_23:
    v_mfma_f32_16x16x32_bf16 v[24:27], v[56:59], v[164:167], v[24:27]
    ds_read_b64_tr_b16 v[88:89], v13 offset:8192
    buffer_load_dwordx4 v[220:223], v126, s[8:11], s44 offen
    v_mfma_f32_16x16x32_bf16 v[40:43], v[56:59], v[168:171], v[40:43]
    ds_read_b64_tr_b16 v[90:91], v13 offset:10240
    buffer_load_dwordx4 v[224:227], v127, s[8:11], s44 offen
    v_mfma_f32_16x16x32_bf16 v[44:47], v[60:63], v[168:171], v[44:47]
    ds_read_b64_tr_b16 v[92:93], v14 offset:8192
    s_add_u32 s44, s44, 16384
    v_mfma_f32_16x16x32_bf16 v[28:31], v[60:63], v[164:167], v[28:31]
    ds_read_b64_tr_b16 v[94:95], v14 offset:10240
    v_mov_b32 v126, v128
    v_mfma_f32_16x16x32_bf16 v[32:35], v[64:67], v[164:167], v[32:35]
    ds_read_b64_tr_b16 v[96:97], v15 offset:8192
    v_mov_b32 v127, v129
    v_mfma_f32_16x16x32_bf16 v[48:51], v[64:67], v[168:171], v[48:51]
    ds_read_b64_tr_b16 v[98:99], v15 offset:10240
    v_mov_b32 v128, v130
    v_mfma_f32_16x16x32_bf16 v[52:55], v[68:71], v[168:171], v[52:55]
    ds_read_b64_tr_b16 v[100:101], v16 offset:8192
    v_mov_b32 v129, v131
    v_mfma_f32_16x16x32_bf16 v[36:39], v[68:71], v[164:167], v[36:39]
    ds_read_b64_tr_b16 v[102:103], v16 offset:10240
    s_waitcnt lgkmcnt(8)
    v_mfma_f32_16x16x32_bf16 v[24:27], v[72:75], v[172:175], v[24:27]
    ds_read_b64_tr_b16 v[104:105], v13 offset:12288
    buffer_load_dwordx4 v[164:167], v126, s[8:11], s44 offen
    v_mfma_f32_16x16x32_bf16 v[40:43], v[72:75], v[176:179], v[40:43]
    ds_read_b64_tr_b16 v[106:107], v13 offset:14336
    buffer_load_dwordx4 v[168:171], v127, s[8:11], s44 offen
    v_mfma_f32_16x16x32_bf16 v[44:47], v[76:79], v[176:179], v[44:47]
    ds_read_b64_tr_b16 v[108:109], v14 offset:12288
    s_add_u32 s44, s44, 16384
    s_waitcnt vmcnt(10)
    v_mfma_f32_16x16x32_bf16 v[28:31], v[76:79], v[172:175], v[28:31]
    ds_read_b64_tr_b16 v[110:111], v14 offset:14336
    v_or3_b32 v17, v180, v184, v188
    v_mfma_f32_16x16x32_bf16 v[32:35], v[80:83], v[172:175], v[32:35]
    ds_read_b64_tr_b16 v[112:113], v15 offset:12288
    v_bitop3_b32 v17, v17, v192, 1 bitop3:0xa8
    v_mfma_f32_16x16x32_bf16 v[48:51], v[80:83], v[176:179], v[48:51]
    ds_read_b64_tr_b16 v[114:115], v15 offset:14336
    v_cmp_ne_u32 vcc, 0, v17
    v_mfma_f32_16x16x32_bf16 v[52:55], v[84:87], v[176:179], v[52:55]
    ds_read_b64_tr_b16 v[116:117], v16 offset:12288
    ds_read_b64_tr_b16 v[118:119], v16 offset:14336
    v_mfma_f32_16x16x32_bf16 v[36:39], v[84:87], v[172:175], v[36:39]
    s_waitcnt lgkmcnt(8)
    s_cbranch_vccnz dm_23f0
dm_23g0:
    v_mfma_f32_16x16x32_bf16 v[24:27], v[88:91], v[180:183], v[24:27]
    ds_read_b64_tr_b16 v[56:57], v13 offset:16384
    buffer_load_dwordx4 v[172:175], v126, s[8:11], s44 offen
    v_mfma_f32_16x16x32_bf16 v[40:43], v[88:91], v[184:187], v[40:43]
    ds_read_b64_tr_b16 v[58:59], v13 offset:18432
    buffer_load_dwordx4 v[176:179], v127, s[8:11], s44 offen
    v_mfma_f32_16x16x32_bf16 v[44:47], v[92:95], v[184:187], v[44:47]
    ds_read_b64_tr_b16 v[60:61], v14 offset:16384
    s_add_u32 s44, s44, 16384
    v_mfma_f32_16x16x32_bf16 v[28:31], v[92:95], v[180:183], v[28:31]
    ds_read_b64_tr_b16 v[62:63], v14 offset:18432
    v_mov_b32 v130, v132
    v_mfma_f32_16x16x32_bf16 v[32:35], v[96:99], v[180:183], v[32:35]
    ds_read_b64_tr_b16 v[64:65], v15 offset:16384
    v_mov_b32 v131, v133
    v_mfma_f32_16x16x32_bf16 v[48:51], v[96:99], v[184:187], v[48:51]
    ds_read_b64_tr_b16 v[66:67], v15 offset:18432
    v_mov_b32 v132, 1073741824
    v_mfma_f32_16x16x32_bf16 v[52:55], v[100:103], v[184:187], v[52:55]
    ds_read_b64_tr_b16 v[68:69], v16 offset:16384
    v_mov_b32 v133, 1073741824
    v_mfma_f32_16x16x32_bf16 v[36:39], v[100:103], v[180:183], v[36:39]
    ds_read_b64_tr_b16 v[70:71], v16 offset:18432
    s_waitcnt lgkmcnt(8)
    v_mfma_f32_16x16x32_bf16 v[24:27], v[104:107], v[188:191], v[24:27]
    ds_read_b64_tr_b16 v[72:73], v13 offset:20480
    buffer_load_dwordx4 v[180:183], v126, s[8:11], s44 offen
    v_mfma_f32_16x16x32_bf16 v[40:43], v[104:107], v[192:195], v[40:43]
    ds_read_b64_tr_b16 v[74:75], v13 offset:22528
    buffer_load_dwordx4 v[184:187], v127, s[8:11], s44 offen
    v_mfma_f32_16x16x32_bf16 v[44:47], v[108:111], v[192:195], v[44:47]
    ds_read_b64_tr_b16 v[76:77], v14 offset:20480
    s_add_u32 s44, s44, 16384
    s_waitcnt vmcnt(10)
    v_mfma_f32_16x16x32_bf16 v[28:31], v[108:111], v[188:191], v[28:31]
    ds_read_b64_tr_b16 v[78:79], v14 offset:22528
    v_or3_b32 v17, v196, v200, v204
    v_mfma_f32_16x16x32_bf16 v[32:35], v[112:115], v[188:191], v[32:35]
    ds_read_b64_tr_b16 v[80:81], v15 offset:20480
    v_bitop3_b32 v17, v17, v208, 1 bitop3:0xa8
    v_mfma_f32_16x16x32_bf16 v[48:51], v[112:115], v[192:195], v[48:51]
    ds_read_b64_tr_b16 v[82:83], v15 offset:22528
    v_cmp_ne_u32 vcc, 0, v17
    v_mfma_f32_16x16x32_bf16 v[52:55], v[116:119], v[192:195], v[52:55]
    ds_read_b64_tr_b16 v[84:85], v16 offset:20480
    ds_read_b64_tr_b16 v[86:87], v16 offset:22528
    v_mfma_f32_16x16x32_bf16 v[36:39], v[116:119], v[188:191], v[36:39]
    s_waitcnt lgkmcnt(8)
    s_cbranch_vccnz dm_23f1
dm_23g1:
    v_mfma_f32_16x16x32_bf16 v[24:27], v[56:59], v[196:199], v[24:27]
    ds_read_b64_tr_b16 v[88:89], v13 offset:24576
    buffer_load_dwordx4 v[188:191], v126, s[8:11], s44 offen
    v_mfma_f32_16x16x32_bf16 v[40:43], v[56:59], v[200:203], v[40:43]
    ds_read_b64_tr_b16 v[90:91], v13 offset:26624
    buffer_load_dwordx4 v[192:195], v127, s[8:11], s44 offen
    v_mfma_f32_16x16x32_bf16 v[44:47], v[60:63], v[200:203], v[44:47]
    ds_read_b64_tr_b16 v[92:93], v14 offset:24576
    s_add_u32 s44, s44, 16384
    v_mfma_f32_16x16x32_bf16 v[28:31], v[60:63], v[196:199], v[28:31]
    ds_read_b64_tr_b16 v[94:95], v14 offset:26624
    v_mfma_f32_16x16x32_bf16 v[32:35], v[64:67], v[196:199], v[32:35]
    ds_read_b64_tr_b16 v[96:97], v15 offset:24576
    s_add_u32 s43, s43, 1
    v_mfma_f32_16x16x32_bf16 v[48:51], v[64:67], v[200:203], v[48:51]
    ds_read_b64_tr_b16 v[98:99], v15 offset:26624
    v_mfma_f32_16x16x32_bf16 v[52:55], v[68:71], v[200:203], v[52:55]
    ds_read_b64_tr_b16 v[100:101], v16 offset:24576
    v_mfma_f32_16x16x32_bf16 v[36:39], v[68:71], v[196:199], v[36:39]
    ds_read_b64_tr_b16 v[102:103], v16 offset:26624
    s_waitcnt lgkmcnt(8)
    v_mfma_f32_16x16x32_bf16 v[24:27], v[72:75], v[204:207], v[24:27]
    ds_read_b64_tr_b16 v[104:105], v13 offset:28672
    buffer_load_dwordx4 v[196:199], v126, s[8:11], s44 offen
    v_mfma_f32_16x16x32_bf16 v[40:43], v[72:75], v[208:211], v[40:43]
    ds_read_b64_tr_b16 v[106:107], v13 offset:30720
    buffer_load_dwordx4 v[200:203], v127, s[8:11], s44 offen
    v_mfma_f32_16x16x32_bf16 v[44:47], v[76:79], v[208:211], v[44:47]
    ds_read_b64_tr_b16 v[108:109], v14 offset:28672
    s_add_u32 s44, s44, 16384
    s_waitcnt vmcnt(10)
    v_mfma_f32_16x16x32_bf16 v[28:31], v[76:79], v[204:207], v[28:31]
    ds_read_b64_tr_b16 v[110:111], v14 offset:30720
    v_add_u32 v13, 32768, v13
    v_or3_b32 v17, v212, v216, v220
    v_mfma_f32_16x16x32_bf16 v[32:35], v[80:83], v[204:207], v[32:35]
    ds_read_b64_tr_b16 v[112:113], v15 offset:28672
    v_add_u32 v14, 32768, v14
    v_bitop3_b32 v17, v17, v224, 1 bitop3:0xa8
    v_mfma_f32_16x16x32_bf16 v[48:51], v[80:83], v[208:211], v[48:51]
    ds_read_b64_tr_b16 v[114:115], v15 offset:30720
    v_add_u32 v15, 32768, v15
    v_cmp_ne_u32 vcc, 0, v17
    v_mfma_f32_16x16x32_bf16 v[52:55], v[84:87], v[208:211], v[52:55]
    ds_read_b64_tr_b16 v[116:117], v16 offset:28672
    ds_read_b64_tr_b16 v[118:119], v16 offset:30720
    s_cmp_eq_u32 s43, 4
    v_mfma_f32_16x16x32_bf16 v[36:39], v[84:87], v[204:207], v[36:39]
    v_add_u32 v16, 32768, v16
    s_waitcnt lgkmcnt(8)
    s_cbranch_vccnz dm_23f2
dm_23g2:
    s_cbranch_scc1 dm_23x
    v_mfma_f32_16x16x32_bf16 v[24:27], v[88:91], v[212:215], v[24:27]
    ds_read_b64_tr_b16 v[56:57], v13 offset:0
    buffer_load_dwordx4 v[204:207], v126, s[8:11], s44 offen
    v_mfma_f32_16x16x32_bf16 v[40:43], v[88:91], v[216:219], v[40:43]
    ds_read_b64_tr_b16 v[58:59], v13 offset:2048
    buffer_load_dwordx4 v[208:211], v127, s[8:11], s44 offen
    v_mfma_f32_16x16x32_bf16 v[44:47], v[92:95], v[216:219], v[44:47]
    ds_read_b64_tr_b16 v[60:61], v14 offset:0
    s_add_u32 s44, s44, 16384
    v_mfma_f32_16x16x32_bf16 v[28:31], v[92:95], v[212:215], v[28:31]
    ds_read_b64_tr_b16 v[62:63], v14 offset:2048
    v_mov_b32 v134, v126
    v_mfma_f32_16x16x32_bf16 v[32:35], v[96:99], v[212:215], v[32:35]
    ds_read_b64_tr_b16 v[64:65], v15 offset:0
    v_mov_b32 v135, v127
    v_mfma_f32_16x16x32_bf16 v[48:51], v[96:99], v[216:219], v[48:51]
    ds_read_b64_tr_b16 v[66:67], v15 offset:2048
    v_mfma_f32_16x16x32_bf16 v[52:55], v[100:103], v[216:219], v[52:55]
    ds_read_b64_tr_b16 v[68:69], v16 offset:0
    v_mfma_f32_16x16x32_bf16 v[36:39], v[100:103], v[212:215], v[36:39]
    ds_read_b64_tr_b16 v[70:71], v16 offset:2048
    s_waitcnt lgkmcnt(8)
    v_mfma_f32_16x16x32_bf16 v[24:27], v[104:107], v[220:223], v[24:27]
    ds_read_b64_tr_b16 v[72:73], v13 offset:4096
    buffer_load_dwordx4 v[212:215], v126, s[8:11], s44 offen
    v_mfma_f32_16x16x32_bf16 v[40:43], v[104:107], v[224:227], v[40:43]
    ds_read_b64_tr_b16 v[74:75], v13 offset:6144
    buffer_load_dwordx4 v[216:219], v127, s[8:11], s44 offen
    v_mfma_f32_16x16x32_bf16 v[44:47], v[108:111], v[224:227], v[44:47]
    ds_read_b64_tr_b16 v[76:77], v14 offset:4096
    s_add_u32 s44, s44, 16384
    s_waitcnt vmcnt(10)
    v_mfma_f32_16x16x32_bf16 v[28:31], v[108:111], v[220:223], v[28:31]
    ds_read_b64_tr_b16 v[78:79], v14 offset:6144
    v_or3_b32 v17, v164, v168, v172
    v_mfma_f32_16x16x32_bf16 v[32:35], v[112:115], v[220:223], v[32:35]
    ds_read_b64_tr_b16 v[80:81], v15 offset:4096
    v_bitop3_b32 v17, v17, v176, 1 bitop3:0xa8
    v_mfma_f32_16x16x32_bf16 v[48:51], v[112:115], v[224:227], v[48:51]
    ds_read_b64_tr_b16 v[82:83], v15 offset:6144
    v_cmp_ne_u32 vcc, 0, v17
    v_mfma_f32_16x16x32_bf16 v[52:55], v[116:119], v[224:227], v[52:55]
    ds_read_b64_tr_b16 v[84:85], v16 offset:4096
    ds_read_b64_tr_b16 v[86:87], v16 offset:6144
    v_mfma_f32_16x16x32_bf16 v[36:39], v[116:119], v[220:223], v[36:39]
    s_waitcnt lgkmcnt(8)
    s_cbranch_vccnz dm_23f3
dm_23g3:
    s_branch dm_23
dm_23f0:
    s_cselect_b32 s50, 1, 0
dm_23h0:
    s_sleep 2
    s_sub_u32 s44, s44, 114688
    buffer_load_dwordx4 v[180:183], v134, s[8:11], s44 offen sc1
    buffer_load_dwordx4 v[184:187], v135, s[8:11], s44 offen sc1
    s_add_u32 s44, s44, 16384
    buffer_load_dwordx4 v[188:191], v134, s[8:11], s44 offen sc1
    buffer_load_dwordx4 v[192:195], v135, s[8:11], s44 offen sc1
    s_add_u32 s44, s44, 16384
    buffer_load_dwordx4 v[196:199], v134, s[8:11], s44 offen sc1
    buffer_load_dwordx4 v[200:203], v135, s[8:11], s44 offen sc1
    s_add_u32 s44, s44, 16384
    buffer_load_dwordx4 v[204:207], v134, s[8:11], s44 offen sc1
    buffer_load_dwordx4 v[208:211], v135, s[8:11], s44 offen sc1
    s_add_u32 s44, s44, 16384
    buffer_load_dwordx4 v[212:215], v134, s[8:11], s44 offen sc1
    buffer_load_dwordx4 v[216:219], v135, s[8:11], s44 offen sc1
    s_add_u32 s44, s44, 16384
    buffer_load_dwordx4 v[220:223], v134, s[8:11], s44 offen sc1
    buffer_load_dwordx4 v[224:227], v135, s[8:11], s44 offen sc1
    s_add_u32 s44, s44, 16384
    buffer_load_dwordx4 v[164:167], v126, s[8:11], s44 offen sc1
    buffer_load_dwordx4 v[168:171], v127, s[8:11], s44 offen sc1
    s_add_u32 s44, s44, 16384
    s_waitcnt vmcnt(10)
    v_or3_b32 v17, v180, v184, v188
    v_bitop3_b32 v17, v17, v192, 1 bitop3:0xa8
    v_cmp_ne_u32 vcc, 0, v17
    s_add_u32 s53, s53, 1
    s_cmp_ge_u32 s53, s61
    s_cselect_b32 s61, 0, s61
    s_cbranch_scc1 dm_23k0
    s_cbranch_vccnz dm_23h0
dm_23k0:
    s_cmp_eq_u32 s50, 1
    s_branch dm_23g0
dm_23f1:
    s_cselect_b32 s50, 1, 0
dm_23h1:
    s_sleep 2
    s_sub_u32 s44, s44, 114688
    buffer_load_dwordx4 v[196:199], v134, s[8:11], s44 offen sc1
    buffer_load_dwordx4 v[200:203], v135, s[8:11], s44 offen sc1
    s_add_u32 s44, s44, 16384
    buffer_load_dwordx4 v[204:207], v134, s[8:11], s44 offen sc1
    buffer_load_dwordx4 v[208:211], v135, s[8:11], s44 offen sc1
    s_add_u32 s44, s44, 16384
    buffer_load_dwordx4 v[212:215], v134, s[8:11], s44 offen sc1
    buffer_load_dwordx4 v[216:219], v135, s[8:11], s44 offen sc1
    s_add_u32 s44, s44, 16384
    buffer_load_dwordx4 v[220:223], v134, s[8:11], s44 offen sc1
    buffer_load_dwordx4 v[224:227], v135, s[8:11], s44 offen sc1
    s_add_u32 s44, s44, 16384
    buffer_load_dwordx4 v[164:167], v126, s[8:11], s44 offen sc1
    buffer_load_dwordx4 v[168:171], v127, s[8:11], s44 offen sc1
    s_add_u32 s44, s44, 16384
    buffer_load_dwordx4 v[172:175], v126, s[8:11], s44 offen sc1
    buffer_load_dwordx4 v[176:179], v127, s[8:11], s44 offen sc1
    s_add_u32 s44, s44, 16384
    buffer_load_dwordx4 v[180:183], v126, s[8:11], s44 offen sc1
    buffer_load_dwordx4 v[184:187], v127, s[8:11], s44 offen sc1
    s_add_u32 s44, s44, 16384
    s_waitcnt vmcnt(10)
    v_or3_b32 v17, v196, v200, v204
    v_bitop3_b32 v17, v17, v208, 1 bitop3:0xa8
    v_cmp_ne_u32 vcc, 0, v17
    s_add_u32 s53, s53, 1
    s_cmp_ge_u32 s53, s61
    s_cselect_b32 s61, 0, s61
    s_cbranch_scc1 dm_23k1
    s_cbranch_vccnz dm_23h1
dm_23k1:
    s_cmp_eq_u32 s50, 1
    s_branch dm_23g1
dm_23f2:
    s_cselect_b32 s50, 1, 0
dm_23h2:
    s_sleep 2
    s_sub_u32 s44, s44, 114688
    buffer_load_dwordx4 v[212:215], v134, s[8:11], s44 offen sc1
    buffer_load_dwordx4 v[216:219], v135, s[8:11], s44 offen sc1
    s_add_u32 s44, s44, 16384
    buffer_load_dwordx4 v[220:223], v134, s[8:11], s44 offen sc1
    buffer_load_dwordx4 v[224:227], v135, s[8:11], s44 offen sc1
    s_add_u32 s44, s44, 16384
    buffer_load_dwordx4 v[164:167], v126, s[8:11], s44 offen sc1
    buffer_load_dwordx4 v[168:171], v127, s[8:11], s44 offen sc1
    s_add_u32 s44, s44, 16384
    buffer_load_dwordx4 v[172:175], v126, s[8:11], s44 offen sc1
    buffer_load_dwordx4 v[176:179], v127, s[8:11], s44 offen sc1
    s_add_u32 s44, s44, 16384
    buffer_load_dwordx4 v[180:183], v126, s[8:11], s44 offen sc1
    buffer_load_dwordx4 v[184:187], v127, s[8:11], s44 offen sc1
    s_add_u32 s44, s44, 16384
    buffer_load_dwordx4 v[188:191], v126, s[8:11], s44 offen sc1
    buffer_load_dwordx4 v[192:195], v127, s[8:11], s44 offen sc1
    s_add_u32 s44, s44, 16384
    buffer_load_dwordx4 v[196:199], v126, s[8:11], s44 offen sc1
    buffer_load_dwordx4 v[200:203], v127, s[8:11], s44 offen sc1
    s_add_u32 s44, s44, 16384
    s_waitcnt vmcnt(10)
    v_or3_b32 v17, v212, v216, v220
    v_bitop3_b32 v17, v17, v224, 1 bitop3:0xa8
    v_cmp_ne_u32 vcc, 0, v17
    s_add_u32 s53, s53, 1
    s_cmp_ge_u32 s53, s61
    s_cselect_b32 s61, 0, s61
    s_cbranch_scc1 dm_23k2
    s_cbranch_vccnz dm_23h2
dm_23k2:
    s_cmp_eq_u32 s50, 1
    s_branch dm_23g2
dm_23f3:
    s_cselect_b32 s50, 1, 0
dm_23h3:
    s_sleep 2
    s_sub_u32 s44, s44, 114688
    buffer_load_dwordx4 v[164:167], v134, s[8:11], s44 offen sc1
    buffer_load_dwordx4 v[168:171], v135, s[8:11], s44 offen sc1
    s_add_u32 s44, s44, 16384
    buffer_load_dwordx4 v[172:175], v134, s[8:11], s44 offen sc1
    buffer_load_dwordx4 v[176:179], v135, s[8:11], s44 offen sc1
    s_add_u32 s44, s44, 16384
    buffer_load_dwordx4 v[180:183], v134, s[8:11], s44 offen sc1
    buffer_load_dwordx4 v[184:187], v135, s[8:11], s44 offen sc1
    s_add_u32 s44, s44, 16384
    buffer_load_dwordx4 v[188:191], v134, s[8:11], s44 offen sc1
    buffer_load_dwordx4 v[192:195], v135, s[8:11], s44 offen sc1
    s_add_u32 s44, s44, 16384
    buffer_load_dwordx4 v[196:199], v134, s[8:11], s44 offen sc1
    buffer_load_dwordx4 v[200:203], v135, s[8:11], s44 offen sc1
    s_add_u32 s44, s44, 16384
    buffer_load_dwordx4 v[204:207], v134, s[8:11], s44 offen sc1
    buffer_load_dwordx4 v[208:211], v135, s[8:11], s44 offen sc1
    s_add_u32 s44, s44, 16384
    buffer_load_dwordx4 v[212:215], v134, s[8:11], s44 offen sc1
    buffer_load_dwordx4 v[216:219], v135, s[8:11], s44 offen sc1
    s_add_u32 s44, s44, 16384
    s_waitcnt vmcnt(10)
    v_or3_b32 v17, v164, v168, v172
    v_bitop3_b32 v17, v17, v176, 1 bitop3:0xa8
    v_cmp_ne_u32 vcc, 0, v17
    s_add_u32 s53, s53, 1
    s_cmp_ge_u32 s53, s61
    s_cselect_b32 s61, 0, s61
    s_cbranch_scc1 dm_23k3
    s_cbranch_vccnz dm_23h3
dm_23k3:
    s_cmp_eq_u32 s50, 1
    s_branch dm_23g3
dm_23x:
    v_mfma_f32_16x16x32_bf16 v[24:27], v[88:91], v[212:215], v[24:27]
    v_mfma_f32_16x16x32_bf16 v[40:43], v[88:91], v[216:219], v[40:43]
    v_mfma_f32_16x16x32_bf16 v[44:47], v[92:95], v[216:219], v[44:47]
    v_mfma_f32_16x16x32_bf16 v[28:31], v[92:95], v[212:215], v[28:31]
    v_mfma_f32_16x16x32_bf16 v[32:35], v[96:99], v[212:215], v[32:35]
    v_mfma_f32_16x16x32_bf16 v[48:51], v[96:99], v[216:219], v[48:51]
    v_mfma_f32_16x16x32_bf16 v[52:55], v[100:103], v[216:219], v[52:55]
    v_mfma_f32_16x16x32_bf16 v[36:39], v[100:103], v[212:215], v[36:39]
    s_waitcnt lgkmcnt(0)
    v_mfma_f32_16x16x32_bf16 v[24:27], v[104:107], v[220:223], v[24:27]
    s_add_u32 s44, s62, 0x5c8000
    v_mfma_f32_16x16x32_bf16 v[40:43], v[104:107], v[224:227], v[40:43]
    s_addc_u32 s45, s63, 0
    v_mfma_f32_16x16x32_bf16 v[44:47], v[108:111], v[224:227], v[44:47]
    v_mfma_f32_16x16x32_bf16 v[28:31], v[108:111], v[220:223], v[28:31]
    s_mov_b32 s46, 0x6000
    v_mfma_f32_16x16x32_bf16 v[32:35], v[112:115], v[220:223], v[32:35]
    v_mfma_f32_16x16x32_bf16 v[48:51], v[112:115], v[224:227], v[48:51]
    s_mov_b32 s47, 0x20000
    v_mfma_f32_16x16x32_bf16 v[52:55], v[116:119], v[224:227], v[52:55]
    v_mfma_f32_16x16x32_bf16 v[36:39], v[116:119], v[220:223], v[36:39]
    s_add_u32 s36, s39, 0
    v_cvt_pk_bf16_f32 v148, v24, v25
    v_cvt_pk_bf16_f32 v149, v26, v27
    v_cvt_pk_bf16_f32 v150, v28, v29
    v_cvt_pk_bf16_f32 v151, v30, v31
    v_and_b32 v148, -2, v148
    buffer_store_dwordx4 v[148:151], v2, s[16:19], s36 offen offset:0 sc1
    v_cvt_pk_bf16_f32 v152, v32, v33
    v_cvt_pk_bf16_f32 v153, v34, v35
    v_cvt_pk_bf16_f32 v154, v36, v37
    v_cvt_pk_bf16_f32 v155, v38, v39
    v_and_b32 v152, -2, v152
    buffer_store_dwordx4 v[152:155], v2, s[16:19], s36 offen offset:1024 sc1
    s_add_u32 s36, s39, 65536
    v_cvt_pk_bf16_f32 v156, v40, v41
    v_cvt_pk_bf16_f32 v157, v42, v43
    v_cvt_pk_bf16_f32 v158, v44, v45
    v_cvt_pk_bf16_f32 v159, v46, v47
    v_and_b32 v156, -2, v156
    buffer_store_dwordx4 v[156:159], v2, s[16:19], s36 offen offset:0 sc1
    v_cvt_pk_bf16_f32 v160, v48, v49
    v_cvt_pk_bf16_f32 v161, v50, v51
    v_cvt_pk_bf16_f32 v162, v52, v53
    v_cvt_pk_bf16_f32 v163, v54, v55
    v_and_b32 v160, -2, v160
    buffer_store_dwordx4 v[160:163], v2, s[16:19], s36 offen offset:1024 sc1
    s_barrier
    s_lshl_b32 s36, s37, 11
    v_add_u32 v7, s36, v2
    ds_write_b128 v7, v[148:151] offset:0
    ds_write_b128 v7, v[152:155] offset:1024
    ds_write_b128 v7, v[156:159] offset:2048
    ds_write_b128 v7, v[160:163] offset:3072
    v_lshlrev_b32 v24, 16, v148
    v_and_b32 v25, 0xffff0000, v148
    v_lshlrev_b32 v26, 16, v149
    v_and_b32 v27, 0xffff0000, v149
    v_lshlrev_b32 v28, 16, v150
    v_and_b32 v29, 0xffff0000, v150
    v_lshlrev_b32 v30, 16, v151
    v_and_b32 v31, 0xffff0000, v151
    v_lshlrev_b32 v32, 16, v152
    v_and_b32 v33, 0xffff0000, v152
    v_lshlrev_b32 v34, 16, v153
    v_and_b32 v35, 0xffff0000, v153
    v_lshlrev_b32 v36, 16, v154
    v_and_b32 v37, 0xffff0000, v154
    v_lshlrev_b32 v38, 16, v155
    v_and_b32 v39, 0xffff0000, v155
    v_lshlrev_b32 v40, 16, v156
    v_and_b32 v41, 0xffff0000, v156
    v_lshlrev_b32 v42, 16, v157
    v_and_b32 v43, 0xffff0000, v157
    v_lshlrev_b32 v44, 16, v158
    v_and_b32 v45, 0xffff0000, v158
    v_lshlrev_b32 v46, 16, v159
    v_and_b32 v47, 0xffff0000, v159
    v_lshlrev_b32 v48, 16, v160
    v_and_b32 v49, 0xffff0000, v160
    v_lshlrev_b32 v50, 16, v161
    v_and_b32 v51, 0xffff0000, v161
    v_lshlrev_b32 v52, 16, v162
    v_and_b32 v53, 0xffff0000, v162
    v_lshlrev_b32 v54, 16, v163
    v_and_b32 v55, 0xffff0000, v163
    s_add_u32 s53, s55, 512
    v_mov_b32 v8, 1
    v_mov_b32 v9, 162816
    v_mov_b32 v11, 0
    s_mov_b64 exec, 1
    s_waitcnt vmcnt(0)
    ds_add_rtn_u32 v10, v9, v8
    s_waitcnt lgkmcnt(0)
    v_readfirstlane_b32 s54, v10
    s_nop 0
    s_and_b32 s54, s54, 3
    s_cmp_lg_u32 s54, 3
    s_cbranch_scc1 pub_24
    buffer_atomic_add v8, v11, s[56:59], s53 offen sc1
    v_mov_b32 v9, 162872
    ds_add_u32 v9, v8
pub_24:
    s_mov_b64 exec, -1
    s_waitcnt lgkmcnt(0)
    s_barrier
    v_pk_add_f32 v[142:143], v[24:25], v[26:27]
    v_pk_mul_f32 v[136:137], v[24:25], v[24:25]
    v_pk_fma_f32 v[136:137], v[26:27], v[26:27], v[136:137]
    v_pk_add_f32 v[142:143], v[142:143], v[28:29]
    v_pk_fma_f32 v[136:137], v[28:29], v[28:29], v[136:137]
    v_pk_add_f32 v[142:143], v[142:143], v[30:31]
    v_pk_fma_f32 v[136:137], v[30:31], v[30:31], v[136:137]
    v_pk_add_f32 v[142:143], v[142:143], v[32:33]
    v_pk_fma_f32 v[136:137], v[32:33], v[32:33], v[136:137]
    v_pk_add_f32 v[142:143], v[142:143], v[34:35]
    v_pk_fma_f32 v[136:137], v[34:35], v[34:35], v[136:137]
    v_pk_add_f32 v[142:143], v[142:143], v[36:37]
    v_pk_fma_f32 v[136:137], v[36:37], v[36:37], v[136:137]
    v_pk_add_f32 v[142:143], v[142:143], v[38:39]
    v_pk_fma_f32 v[136:137], v[38:39], v[38:39], v[136:137]
    v_add_f32 v138, v142, v143
    v_add_f32 v139, v136, v137
    v_mov_b32 v142, v138
    v_mov_b32 v143, v139
    s_nop 0
    v_permlane16_swap_b32 v138, v142
    v_permlane16_swap_b32 v139, v143
    v_pk_add_f32 v[138:139], v[138:139], v[142:143]
    v_mov_b32 v142, v138
    v_mov_b32 v143, v139
    s_nop 0
    v_permlane32_swap_b32 v138, v142
    v_permlane32_swap_b32 v139, v143
    v_pk_add_f32 v[138:139], v[138:139], v[142:143]
    v_pk_add_f32 v[142:143], v[40:41], v[42:43]
    v_pk_mul_f32 v[136:137], v[40:41], v[40:41]
    v_pk_fma_f32 v[136:137], v[42:43], v[42:43], v[136:137]
    v_pk_add_f32 v[142:143], v[142:143], v[44:45]
    v_pk_fma_f32 v[136:137], v[44:45], v[44:45], v[136:137]
    v_pk_add_f32 v[142:143], v[142:143], v[46:47]
    v_pk_fma_f32 v[136:137], v[46:47], v[46:47], v[136:137]
    v_pk_add_f32 v[142:143], v[142:143], v[48:49]
    v_pk_fma_f32 v[136:137], v[48:49], v[48:49], v[136:137]
    v_pk_add_f32 v[142:143], v[142:143], v[50:51]
    v_pk_fma_f32 v[136:137], v[50:51], v[50:51], v[136:137]
    v_pk_add_f32 v[142:143], v[142:143], v[52:53]
    v_pk_fma_f32 v[136:137], v[52:53], v[52:53], v[136:137]
    v_pk_add_f32 v[142:143], v[142:143], v[54:55]
    v_pk_fma_f32 v[136:137], v[54:55], v[54:55], v[136:137]
    v_add_f32 v140, v142, v143
    v_add_f32 v141, v136, v137
    v_mov_b32 v142, v140
    v_mov_b32 v143, v141
    s_nop 0
    v_permlane16_swap_b32 v140, v142
    v_permlane16_swap_b32 v141, v143
    v_pk_add_f32 v[140:141], v[140:141], v[142:143]
    v_mov_b32 v142, v140
    v_mov_b32 v143, v141
    s_nop 0
    v_permlane32_swap_b32 v140, v142
    v_permlane32_swap_b32 v141, v143
    v_pk_add_f32 v[140:141], v[140:141], v[142:143]
    v_cmp_eq_u32 vcc, 0, v23
    s_nop 1
    v_cndmask_b32 v138, v140, v138, vcc
    v_cndmask_b32 v139, v141, v139, vcc
    s_lshr_b32 s53, s29, 3
    s_lshl_b32 s53, s53, 14
    s_and_b32 s40, s29, 7
    s_lshl_b32 s40, s40, 10
    s_add_u32 s40, s40, s53
    s_lshl_b32 s36, s34, 8
    s_add_u32 s40, s40, s36
    v_lshlrev_b32 v7, 3, v1
    s_bfm_b64 exec, 32, 0
    buffer_store_dwordx2 v[138:139], v7, s[44:47], s40 offen sc1
    s_mov_b64 exec, -1
    s_lshr_b32 s34, s30, 1
    s_and_b32 s35, s30, 1
    v_and_b32 v22, 15, v1
    v_lshrrev_b32 v23, 4, v1
    s_mul_i32 s37, s34, 4
    s_mul_i32 s38, s29, 14
    s_mul_i32 s36, s35, 7
    s_add_u32 s38, s38, s36
    s_mul_i32 s36, s34, 8192
    v_add_u32 v12, s36, v2
    v_lshrrev_b32 v6, 2, v1
    v_mul_u32_u24 v13, 448, v6
    v_and_b32 v7, 3, v1
    v_lshl_add_u32 v13, v7, 3, v13
    v_add_u32 v13, 73728, v13
    s_mul_i32 s36, s35, 224
    v_add_u32 v13, s36, v13
    v_bfe_u32 v6, v1, 4, 1
    v_lshlrev_b32 v6, 5, v6
    s_cmp_eq_u32 s35, 0
    s_cselect_b32 s36, 1, -1
    v_mul_lo_u32 v6, v6, s36
    v_sub_u32 v14, v13, v6
    v_add_u32 v13, v13, v6
    v_mov_b32 v17, v12
    s_mov_b32 s42, 0
    s_mov_b32 s43, 0
    s_mov_b32 s48, 57344
    v_add_u32 v18, 57344, v13
    v_add_u32 v19, 57344, v14
    ds_read_b128 v[136:139], v17 offset:0
    ds_read_b128 v[140:143], v17 offset:2048
    ds_read_b128 v[144:147], v17 offset:4096
    ds_read_b128 v[148:151], v17 offset:6144
    ds_read_b64_tr_b16 v[152:153], v18 offset:0
    ds_read_b64_tr_b16 v[154:155], v18 offset:7168
    ds_read_b64_tr_b16 v[156:157], v19 offset:32
    ds_read_b64_tr_b16 v[158:159], v19 offset:7200
    ds_read_b64_tr_b16 v[160:161], v18 offset:64
    ds_read_b64_tr_b16 v[162:163], v18 offset:7232
    ds_read_b64_tr_b16 v[164:165], v19 offset:96
    ds_read_b64_tr_b16 v[166:167], v19 offset:7264
    ds_read_b64_tr_b16 v[168:169], v18 offset:128
    ds_read_b64_tr_b16 v[170:171], v18 offset:7296
    ds_read_b64_tr_b16 v[172:173], v19 offset:160
    ds_read_b64_tr_b16 v[174:175], v19 offset:7328
    ds_read_b64_tr_b16 v[176:177], v18 offset:192
    ds_read_b64_tr_b16 v[178:179], v18 offset:7360
    s_waitcnt lgkmcnt(12)
    v_mfma_f32_16x16x32_bf16 v[24:27], v[152:155], v[136:139], 0
    ds_read_b128 v[180:183], v17 offset:1024
    s_add_u32 s42, s42, 16384
    v_mfma_f32_16x16x32_bf16 v[52:55], v[152:155], v[140:143], 0
    ds_read_b128 v[184:187], v17 offset:3072
    s_cmp_eq_u32 s42, 49152
    v_mfma_f32_16x16x32_bf16 v[80:83], v[152:155], v[144:147], 0
    ds_read_b128 v[188:191], v17 offset:5120
    s_cselect_b32 s42, 0, s42
    v_mfma_f32_16x16x32_bf16 v[108:111], v[152:155], v[148:151], 0
    ds_read_b128 v[192:195], v17 offset:7168
    s_waitcnt lgkmcnt(14)
    v_mfma_f32_16x16x32_bf16 v[112:115], v[156:159], v[148:151], 0
    ds_read_b64_tr_b16 v[196:197], v18 offset:14336
    s_add_u32 s48, s48, 28672
    v_mfma_f32_16x16x32_bf16 v[84:87], v[156:159], v[144:147], 0
    ds_read_b64_tr_b16 v[198:199], v18 offset:21504
    s_cmp_eq_u32 s48, 86016
    v_mfma_f32_16x16x32_bf16 v[56:59], v[156:159], v[140:143], 0
    ds_read_b64_tr_b16 v[200:201], v19 offset:14368
    s_cselect_b32 s48, 0, s48
    v_mfma_f32_16x16x32_bf16 v[28:31], v[156:159], v[136:139], 0
    ds_read_b64_tr_b16 v[202:203], v19 offset:21536
    s_waitcnt lgkmcnt(8)
    v_mfma_f32_16x16x32_bf16 v[32:35], v[160:163], v[136:139], 0
    ds_read_b64_tr_b16 v[204:205], v18 offset:14400
    v_add_u32 v17, s42, v12
    v_mfma_f32_16x16x32_bf16 v[60:63], v[160:163], v[140:143], 0
    ds_read_b64_tr_b16 v[206:207], v18 offset:21568
    v_mfma_f32_16x16x32_bf16 v[88:91], v[160:163], v[144:147], 0
    ds_read_b64_tr_b16 v[208:209], v19 offset:14432
    v_mfma_f32_16x16x32_bf16 v[116:119], v[160:163], v[148:151], 0
    ds_read_b64_tr_b16 v[210:211], v19 offset:21600
    v_mfma_f32_16x16x32_bf16 v[120:123], v[164:167], v[148:151], 0
    ds_read_b64_tr_b16 v[212:213], v18 offset:14464
    v_mfma_f32_16x16x32_bf16 v[92:95], v[164:167], v[144:147], 0
    ds_read_b64_tr_b16 v[214:215], v18 offset:21632
    v_mfma_f32_16x16x32_bf16 v[64:67], v[164:167], v[140:143], 0
    ds_read_b64_tr_b16 v[216:217], v19 offset:14496
    v_mfma_f32_16x16x32_bf16 v[36:39], v[164:167], v[136:139], 0
    ds_read_b64_tr_b16 v[218:219], v19 offset:21664
    v_add_u32 v19, s48, v14
    v_mfma_f32_16x16x32_bf16 v[40:43], v[168:171], v[136:139], 0
    ds_read_b64_tr_b16 v[220:221], v18 offset:14528
    v_mfma_f32_16x16x32_bf16 v[68:71], v[168:171], v[140:143], 0
    ds_read_b64_tr_b16 v[222:223], v18 offset:21696
    v_add_u32 v18, s48, v13
    v_mfma_f32_16x16x32_bf16 v[96:99], v[168:171], v[144:147], 0
    v_mfma_f32_16x16x32_bf16 v[124:127], v[168:171], v[148:151], 0
    v_mfma_f32_16x16x32_bf16 v[128:131], v[172:175], v[148:151], 0
    v_mfma_f32_16x16x32_bf16 v[100:103], v[172:175], v[144:147], 0
    v_mfma_f32_16x16x32_bf16 v[72:75], v[172:175], v[140:143], 0
    v_mfma_f32_16x16x32_bf16 v[44:47], v[172:175], v[136:139], 0
    v_mfma_f32_16x16x32_bf16 v[48:51], v[176:179], v[136:139], 0
    v_mfma_f32_16x16x32_bf16 v[76:79], v[176:179], v[140:143], 0
    v_mfma_f32_16x16x32_bf16 v[104:107], v[176:179], v[144:147], 0
    v_mfma_f32_16x16x32_bf16 v[132:135], v[176:179], v[148:151], 0
    s_waitcnt lgkmcnt(12)
    v_mfma_f32_16x16x32_bf16 v[24:27], v[196:199], v[180:183], v[24:27]
    s_add_u32 s43, s43, 1
    s_mul_i32 s36, s35, 448
    s_add_u32 s36, s36, 159744
    v_lshlrev_b32 v6, 4, v23
    v_mfma_f32_16x16x32_bf16 v[52:55], v[196:199], v[184:187], v[52:55]
    v_add_u32 v6, s36, v6
    s_lshl_b32 s36, s37, 8
    s_add_u32 s36, s36, 160768
    v_lshlrev_b32 v7, 4, v22
    v_mfma_f32_16x16x32_bf16 v[80:83], v[196:199], v[188:191], v[80:83]
    v_add_u32 v7, s36, v7
    s_add_u32 s16, s62, 0x400000
    s_addc_u32 s17, s63, 0
    s_mov_b32 s18, 0x1be000
    v_mfma_f32_16x16x32_bf16 v[108:111], v[196:199], v[192:195], v[108:111]
    s_mov_b32 s19, 0x20000
    s_mul_i32 s39, s37, 229376
    s_lshr_b32 s36, s38, 1
    s_waitcnt lgkmcnt(0)
    v_mfma_f32_16x16x32_bf16 v[112:115], v[200:203], v[192:195], v[112:115]
    s_add_u32 s36, s36, 0
    s_lshr_b32 s53, s36, 3
    s_lshl_b32 s53, s53, 14
    s_and_b32 s44, s36, 7
    v_mfma_f32_16x16x32_bf16 v[84:87], v[200:203], v[188:191], v[84:87]
    s_lshl_b32 s44, s44, 10
    s_add_u32 s44, s44, s53
    s_add_u32 s44, s44, s39
    s_lshr_b32 s36, s38, 1
    v_mfma_f32_16x16x32_bf16 v[56:59], v[200:203], v[184:187], v[56:59]
    s_add_u32 s36, s36, 1
    s_lshr_b32 s53, s36, 3
    s_lshl_b32 s53, s53, 14
    s_and_b32 s45, s36, 7
    v_mfma_f32_16x16x32_bf16 v[28:31], v[200:203], v[180:183], v[28:31]
    s_lshl_b32 s45, s45, 10
    s_add_u32 s45, s45, s53
    s_add_u32 s45, s45, s39
    s_lshr_b32 s36, s38, 1
    v_mfma_f32_16x16x32_bf16 v[32:35], v[204:207], v[180:183], v[32:35]
    s_add_u32 s36, s36, 2
    s_lshr_b32 s53, s36, 3
    s_lshl_b32 s53, s53, 14
    s_and_b32 s46, s36, 7
    v_mfma_f32_16x16x32_bf16 v[60:63], v[204:207], v[184:187], v[60:63]
    s_lshl_b32 s46, s46, 10
    s_add_u32 s46, s46, s53
    s_add_u32 s46, s46, s39
    s_lshr_b32 s36, s38, 1
    v_mfma_f32_16x16x32_bf16 v[88:91], v[204:207], v[188:191], v[88:91]
    s_add_u32 s36, s36, 3
    s_lshr_b32 s53, s36, 3
    s_lshl_b32 s53, s53, 14
    s_and_b32 s47, s36, 7
    v_mfma_f32_16x16x32_bf16 v[116:119], v[204:207], v[192:195], v[116:119]
    s_lshl_b32 s47, s47, 10
    s_add_u32 s47, s47, s53
    s_add_u32 s47, s47, s39
    v_lshrrev_b32 v226, 2, v1
    v_mfma_f32_16x16x32_bf16 v[120:123], v[208:211], v[192:195], v[120:123]
    v_mul_u32_u24 v240, 256, v226
    v_and_b32 v227, 3, v1
    v_lshl_add_u32 v240, v227, 3, v240
    v_add_u32 v240, 49152, v240
    v_mfma_f32_16x16x32_bf16 v[92:95], v[208:211], v[188:191], v[92:95]
    v_and_b32 v226, 7, v226
    s_mul_i32 s36, s35, 4
    s_add_u32 s36, s36, 3
    v_xor_b32 v227, s36, v226
    v_mfma_f32_16x16x32_bf16 v[64:67], v[208:211], v[184:187], v[64:67]
    v_lshl_add_u32 v243, v227, 5, v240
    s_mul_i32 s36, s35, 4
    s_add_u32 s36, s36, 2
    v_xor_b32 v227, s36, v226
    v_mfma_f32_16x16x32_bf16 v[36:39], v[208:211], v[180:183], v[36:39]
    v_lshl_add_u32 v242, v227, 5, v240
    s_mul_i32 s36, s35, 4
    s_add_u32 s36, s36, 1
    v_xor_b32 v227, s36, v226
    v_mfma_f32_16x16x32_bf16 v[40:43], v[212:215], v[180:183], v[40:43]
    v_lshl_add_u32 v241, v227, 5, v240
    s_mul_i32 s36, s35, 4
    s_add_u32 s36, s36, 0
    v_xor_b32 v227, s36, v226
    v_mfma_f32_16x16x32_bf16 v[68:71], v[212:215], v[184:187], v[68:71]
    v_lshl_add_u32 v240, v227, 5, v240
    s_lshl_b32 s38, s33, 3
    s_lshl_b32 s36, s35, 2
    s_add_u32 s38, s38, s36
    v_mfma_f32_16x16x32_bf16 v[96:99], v[212:215], v[188:191], v[96:99]
    s_lshr_b32 s36, s38, 1
    s_lshr_b32 s53, s36, 3
    s_lshl_b32 s53, s53, 14
    s_and_b32 s39, s36, 7
    v_mfma_f32_16x16x32_bf16 v[124:127], v[212:215], v[192:195], v[124:127]
    s_lshl_b32 s39, s39, 10
    s_add_u32 s39, s39, s53
    s_lshl_b32 s36, s37, 16
    s_add_u32 s39, s39, s36
    v_mfma_f32_16x16x32_bf16 v[128:131], v[216:219], v[192:195], v[128:131]
    s_lshl_b32 s40, s31, 17
    s_add_u32 s40, s40, s39
    s_xor_b32 s41, s31, 1
    s_lshl_b32 s41, s41, 17
    v_mfma_f32_16x16x32_bf16 v[100:103], v[216:219], v[188:191], v[100:103]
    s_add_u32 s41, s41, s39
    s_mov_b32 s84, s62
    s_mov_b32 s85, s63
    s_mov_b32 s86, 0x7e000
    v_mfma_f32_16x16x32_bf16 v[72:75], v[216:219], v[184:187], v[72:75]
    s_mov_b32 s87, 0x20000
    s_add_u32 s88, s62, 0x80000
    s_addc_u32 s89, s63, 0
    s_mov_b32 s90, 0x7e000
    v_mfma_f32_16x16x32_bf16 v[44:47], v[216:219], v[180:183], v[44:47]
    s_mov_b32 s91, 0x20000
    s_lshl_b32 s36, s37, 1
    s_add_u32 s36, s36, s35
    s_lshl_b32 s36, s36, 10
    v_mfma_f32_16x16x32_bf16 v[48:51], v[220:223], v[180:183], v[48:51]
    v_add_u32 v244, s36, v2
    v_mov_b32 v245, 1
    v_mov_b32 v246, 162880
    v_lshrrev_b32 v238, 1, v23
    v_mfma_f32_16x16x32_bf16 v[76:79], v[220:223], v[184:187], v[76:79]
    v_lshlrev_b32 v238, 8, v238
    v_lshl_add_u32 v238, v22, 4, v238
    v_and_b32 v224, 1, v23
    v_lshl_add_u32 v238, v224, 3, v238
    v_mfma_f32_16x16x32_bf16 v[104:107], v[220:223], v[188:191], v[104:107]
    v_mfma_f32_16x16x32_bf16 v[132:135], v[220:223], v[192:195], v[132:135]
    s_add_u32 s53, s55, 1408
    v_mov_b32 v8, 1
    v_mov_b32 v9, 162864
    v_mov_b32 v11, 0
    s_mov_b64 exec, 1
    s_waitcnt vmcnt(0)
    ds_add_rtn_u32 v10, v9, v8
    s_waitcnt lgkmcnt(0)
    v_readfirstlane_b32 s54, v10
    s_nop 0
    s_and_b32 s54, s54, 3
    s_cmp_lg_u32 s54, 3
    s_cbranch_scc1 pub_25
    buffer_atomic_add v8, v11, s[56:59], s53 offen sc1
pub_25:
    s_mov_b64 exec, -1
    s_barrier
    ds_read_b128 v[136:139], v17 offset:0
    ds_read_b128 v[140:143], v17 offset:2048
    ds_read_b128 v[144:147], v17 offset:4096
    ds_read_b128 v[148:151], v17 offset:6144
    ds_read_b64_tr_b16 v[152:153], v18 offset:0
    ds_read_b64_tr_b16 v[154:155], v18 offset:7168
    ds_read_b64_tr_b16 v[156:157], v19 offset:32
    ds_read_b64_tr_b16 v[158:159], v19 offset:7200
    ds_read_b64_tr_b16 v[160:161], v18 offset:64
    ds_read_b64_tr_b16 v[162:163], v18 offset:7232
    ds_read_b64_tr_b16 v[164:165], v19 offset:96
    ds_read_b64_tr_b16 v[166:167], v19 offset:7264
    ds_read_b64_tr_b16 v[168:169], v18 offset:128
    ds_read_b64_tr_b16 v[170:171], v18 offset:7296
    ds_read_b64_tr_b16 v[172:173], v19 offset:160
    ds_read_b64_tr_b16 v[174:175], v19 offset:7328
    ds_read_b64_tr_b16 v[176:177], v18 offset:192
    ds_read_b64_tr_b16 v[178:179], v18 offset:7360
    s_waitcnt lgkmcnt(12)
mm_26:
    v_mfma_f32_16x16x32_bf16 v[24:27], v[152:155], v[136:139], v[24:27]
    ds_read_b128 v[180:183], v17 offset:1024
    s_add_u32 s42, s42, 16384
    v_mfma_f32_16x16x32_bf16 v[52:55], v[152:155], v[140:143], v[52:55]
    ds_read_b128 v[184:187], v17 offset:3072
    s_cmp_eq_u32 s42, 49152
    v_mfma_f32_16x16x32_bf16 v[80:83], v[152:155], v[144:147], v[80:83]
    ds_read_b128 v[188:191], v17 offset:5120
    s_cselect_b32 s42, 0, s42
    v_mfma_f32_16x16x32_bf16 v[108:111], v[152:155], v[148:151], v[108:111]
    ds_read_b128 v[192:195], v17 offset:7168
    s_waitcnt lgkmcnt(14)
    v_mfma_f32_16x16x32_bf16 v[112:115], v[156:159], v[148:151], v[112:115]
    ds_read_b64_tr_b16 v[196:197], v18 offset:14336
    s_add_u32 s48, s48, 28672
    v_mfma_f32_16x16x32_bf16 v[84:87], v[156:159], v[144:147], v[84:87]
    ds_read_b64_tr_b16 v[198:199], v18 offset:21504
    s_cmp_eq_u32 s48, 86016
    v_mfma_f32_16x16x32_bf16 v[56:59], v[156:159], v[140:143], v[56:59]
    ds_read_b64_tr_b16 v[200:201], v19 offset:14368
    s_cselect_b32 s48, 0, s48
    v_mfma_f32_16x16x32_bf16 v[28:31], v[156:159], v[136:139], v[28:31]
    ds_read_b64_tr_b16 v[202:203], v19 offset:21536
    s_waitcnt lgkmcnt(8)
    v_mfma_f32_16x16x32_bf16 v[32:35], v[160:163], v[136:139], v[32:35]
    ds_read_b64_tr_b16 v[204:205], v18 offset:14400
    v_add_u32 v17, s42, v12
    v_mfma_f32_16x16x32_bf16 v[60:63], v[160:163], v[140:143], v[60:63]
    ds_read_b64_tr_b16 v[206:207], v18 offset:21568
    v_mfma_f32_16x16x32_bf16 v[88:91], v[160:163], v[144:147], v[88:91]
    ds_read_b64_tr_b16 v[208:209], v19 offset:14432
    v_mfma_f32_16x16x32_bf16 v[116:119], v[160:163], v[148:151], v[116:119]
    ds_read_b64_tr_b16 v[210:211], v19 offset:21600
    v_mfma_f32_16x16x32_bf16 v[120:123], v[164:167], v[148:151], v[120:123]
    ds_read_b64_tr_b16 v[212:213], v18 offset:14464
    v_mfma_f32_16x16x32_bf16 v[92:95], v[164:167], v[144:147], v[92:95]
    ds_read_b64_tr_b16 v[214:215], v18 offset:21632
    v_mfma_f32_16x16x32_bf16 v[64:67], v[164:167], v[140:143], v[64:67]
    ds_read_b64_tr_b16 v[216:217], v19 offset:14496
    v_mfma_f32_16x16x32_bf16 v[36:39], v[164:167], v[136:139], v[36:39]
    ds_read_b64_tr_b16 v[218:219], v19 offset:21664
    v_add_u32 v19, s48, v14
    v_mfma_f32_16x16x32_bf16 v[40:43], v[168:171], v[136:139], v[40:43]
    ds_read_b64_tr_b16 v[220:221], v18 offset:14528
    v_mfma_f32_16x16x32_bf16 v[68:71], v[168:171], v[140:143], v[68:71]
    ds_read_b64_tr_b16 v[222:223], v18 offset:21696
    v_add_u32 v18, s48, v13
    v_mfma_f32_16x16x32_bf16 v[96:99], v[168:171], v[144:147], v[96:99]
    v_mfma_f32_16x16x32_bf16 v[124:127], v[168:171], v[148:151], v[124:127]
    v_mfma_f32_16x16x32_bf16 v[128:131], v[172:175], v[148:151], v[128:131]
    v_mfma_f32_16x16x32_bf16 v[100:103], v[172:175], v[144:147], v[100:103]
    v_mfma_f32_16x16x32_bf16 v[72:75], v[172:175], v[140:143], v[72:75]
    v_mfma_f32_16x16x32_bf16 v[44:47], v[172:175], v[136:139], v[44:47]
    v_mfma_f32_16x16x32_bf16 v[48:51], v[176:179], v[136:139], v[48:51]
    v_mfma_f32_16x16x32_bf16 v[76:79], v[176:179], v[140:143], v[76:79]
    v_mfma_f32_16x16x32_bf16 v[104:107], v[176:179], v[144:147], v[104:107]
    v_mfma_f32_16x16x32_bf16 v[132:135], v[176:179], v[148:151], v[132:135]
    s_waitcnt lgkmcnt(12)
    v_mfma_f32_16x16x32_bf16 v[24:27], v[196:199], v[180:183], v[24:27]
    s_add_u32 s43, s43, 1
    s_cmp_lt_u32 s43, 15
    v_mfma_f32_16x16x32_bf16 v[52:55], v[196:199], v[184:187], v[52:55]
    v_mfma_f32_16x16x32_bf16 v[80:83], v[196:199], v[188:191], v[80:83]
    v_mfma_f32_16x16x32_bf16 v[108:111], v[196:199], v[192:195], v[108:111]
    s_waitcnt lgkmcnt(0)
    s_barrier
    v_mfma_f32_16x16x32_bf16 v[112:115], v[200:203], v[192:195], v[112:115]
    ds_read_b128 v[136:139], v17 offset:0
    v_mfma_f32_16x16x32_bf16 v[84:87], v[200:203], v[188:191], v[84:87]
    ds_read_b128 v[140:143], v17 offset:2048
    v_mfma_f32_16x16x32_bf16 v[56:59], v[200:203], v[184:187], v[56:59]
    ds_read_b128 v[144:147], v17 offset:4096
    v_mfma_f32_16x16x32_bf16 v[28:31], v[200:203], v[180:183], v[28:31]
    ds_read_b128 v[148:151], v17 offset:6144
    v_mfma_f32_16x16x32_bf16 v[32:35], v[204:207], v[180:183], v[32:35]
    ds_read_b64_tr_b16 v[152:153], v18 offset:0
    v_mfma_f32_16x16x32_bf16 v[60:63], v[204:207], v[184:187], v[60:63]
    ds_read_b64_tr_b16 v[154:155], v18 offset:7168
    v_mfma_f32_16x16x32_bf16 v[88:91], v[204:207], v[188:191], v[88:91]
    ds_read_b64_tr_b16 v[156:157], v19 offset:32
    v_mfma_f32_16x16x32_bf16 v[116:119], v[204:207], v[192:195], v[116:119]
    ds_read_b64_tr_b16 v[158:159], v19 offset:7200
    v_mfma_f32_16x16x32_bf16 v[120:123], v[208:211], v[192:195], v[120:123]
    ds_read_b64_tr_b16 v[160:161], v18 offset:64
    v_mfma_f32_16x16x32_bf16 v[92:95], v[208:211], v[188:191], v[92:95]
    ds_read_b64_tr_b16 v[162:163], v18 offset:7232
    v_mfma_f32_16x16x32_bf16 v[64:67], v[208:211], v[184:187], v[64:67]
    ds_read_b64_tr_b16 v[164:165], v19 offset:96
    v_mfma_f32_16x16x32_bf16 v[36:39], v[208:211], v[180:183], v[36:39]
    ds_read_b64_tr_b16 v[166:167], v19 offset:7264
    v_mfma_f32_16x16x32_bf16 v[40:43], v[212:215], v[180:183], v[40:43]
    ds_read_b64_tr_b16 v[168:169], v18 offset:128
    v_mfma_f32_16x16x32_bf16 v[68:71], v[212:215], v[184:187], v[68:71]
    ds_read_b64_tr_b16 v[170:171], v18 offset:7296
    v_mfma_f32_16x16x32_bf16 v[96:99], v[212:215], v[188:191], v[96:99]
    ds_read_b64_tr_b16 v[172:173], v19 offset:160
    v_mfma_f32_16x16x32_bf16 v[124:127], v[212:215], v[192:195], v[124:127]
    ds_read_b64_tr_b16 v[174:175], v19 offset:7328
    v_mfma_f32_16x16x32_bf16 v[128:131], v[216:219], v[192:195], v[128:131]
    ds_read_b64_tr_b16 v[176:177], v18 offset:192
    v_mfma_f32_16x16x32_bf16 v[100:103], v[216:219], v[188:191], v[100:103]
    ds_read_b64_tr_b16 v[178:179], v18 offset:7360
    v_mfma_f32_16x16x32_bf16 v[72:75], v[216:219], v[184:187], v[72:75]
    v_mfma_f32_16x16x32_bf16 v[44:47], v[216:219], v[180:183], v[44:47]
    v_mfma_f32_16x16x32_bf16 v[48:51], v[220:223], v[180:183], v[48:51]
    v_mfma_f32_16x16x32_bf16 v[76:79], v[220:223], v[184:187], v[76:79]
    v_mfma_f32_16x16x32_bf16 v[104:107], v[220:223], v[188:191], v[104:107]
    v_mfma_f32_16x16x32_bf16 v[132:135], v[220:223], v[192:195], v[132:135]
    s_waitcnt lgkmcnt(12)
    s_cbranch_scc1 mm_26
    v_mfma_f32_16x16x32_bf16 v[24:27], v[152:155], v[136:139], v[24:27]
    ds_read_b128 v[180:183], v17 offset:1024
    v_mfma_f32_16x16x32_bf16 v[52:55], v[152:155], v[140:143], v[52:55]
    ds_read_b128 v[184:187], v17 offset:3072
    v_mfma_f32_16x16x32_bf16 v[80:83], v[152:155], v[144:147], v[80:83]
    ds_read_b128 v[188:191], v17 offset:5120
    v_mfma_f32_16x16x32_bf16 v[108:111], v[152:155], v[148:151], v[108:111]
    ds_read_b128 v[192:195], v17 offset:7168
    s_waitcnt lgkmcnt(14)
    v_mfma_f32_16x16x32_bf16 v[112:115], v[156:159], v[148:151], v[112:115]
    ds_read_b64_tr_b16 v[196:197], v18 offset:14336
    v_mfma_f32_16x16x32_bf16 v[84:87], v[156:159], v[144:147], v[84:87]
    ds_read_b64_tr_b16 v[198:199], v18 offset:21504
    v_mfma_f32_16x16x32_bf16 v[56:59], v[156:159], v[140:143], v[56:59]
    ds_read_b64_tr_b16 v[200:201], v19 offset:14368
    v_mfma_f32_16x16x32_bf16 v[28:31], v[156:159], v[136:139], v[28:31]
    ds_read_b64_tr_b16 v[202:203], v19 offset:21536
    s_waitcnt lgkmcnt(8)
    v_mfma_f32_16x16x32_bf16 v[32:35], v[160:163], v[136:139], v[32:35]
    ds_read_b64_tr_b16 v[204:205], v18 offset:14400
    v_mfma_f32_16x16x32_bf16 v[60:63], v[160:163], v[140:143], v[60:63]
    ds_read_b64_tr_b16 v[206:207], v18 offset:21568
    v_mfma_f32_16x16x32_bf16 v[88:91], v[160:163], v[144:147], v[88:91]
    ds_read_b64_tr_b16 v[208:209], v19 offset:14432
    v_mfma_f32_16x16x32_bf16 v[116:119], v[160:163], v[148:151], v[116:119]
    ds_read_b64_tr_b16 v[210:211], v19 offset:21600
    v_mfma_f32_16x16x32_bf16 v[120:123], v[164:167], v[148:151], v[120:123]
    ds_read_b64_tr_b16 v[212:213], v18 offset:14464
    v_mfma_f32_16x16x32_bf16 v[92:95], v[164:167], v[144:147], v[92:95]
    ds_read_b64_tr_b16 v[214:215], v18 offset:21632
    v_mfma_f32_16x16x32_bf16 v[64:67], v[164:167], v[140:143], v[64:67]
    ds_read_b64_tr_b16 v[216:217], v19 offset:14496
    v_mfma_f32_16x16x32_bf16 v[36:39], v[164:167], v[136:139], v[36:39]
    ds_read_b64_tr_b16 v[218:219], v19 offset:21664
    v_mfma_f32_16x16x32_bf16 v[40:43], v[168:171], v[136:139], v[40:43]
    ds_read_b64_tr_b16 v[220:221], v18 offset:14528
    v_mfma_f32_16x16x32_bf16 v[68:71], v[168:171], v[140:143], v[68:71]
    ds_read_b64_tr_b16 v[222:223], v18 offset:21696
    v_mfma_f32_16x16x32_bf16 v[96:99], v[168:171], v[144:147], v[96:99]
    v_mfma_f32_16x16x32_bf16 v[124:127], v[168:171], v[148:151], v[124:127]
    v_mfma_f32_16x16x32_bf16 v[128:131], v[172:175], v[148:151], v[128:131]
    v_mfma_f32_16x16x32_bf16 v[100:103], v[172:175], v[144:147], v[100:103]
    v_mfma_f32_16x16x32_bf16 v[72:75], v[172:175], v[140:143], v[72:75]
    v_mfma_f32_16x16x32_bf16 v[44:47], v[172:175], v[136:139], v[44:47]
    v_mfma_f32_16x16x32_bf16 v[48:51], v[176:179], v[136:139], v[48:51]
    v_mfma_f32_16x16x32_bf16 v[76:79], v[176:179], v[140:143], v[76:79]
    v_mfma_f32_16x16x32_bf16 v[104:107], v[176:179], v[144:147], v[104:107]
    v_mfma_f32_16x16x32_bf16 v[132:135], v[176:179], v[148:151], v[132:135]
    s_waitcnt lgkmcnt(0)
    s_barrier
    v_mfma_f32_16x16x32_bf16 v[24:27], v[196:199], v[180:183], v[24:27]
    ds_read_b128 v[136:139], v6 offset:0
    v_mfma_f32_16x16x32_bf16 v[52:55], v[196:199], v[184:187], v[52:55]
    ds_read_b128 v[140:143], v6 offset:64
    v_mfma_f32_16x16x32_bf16 v[80:83], v[196:199], v[188:191], v[80:83]
    ds_read_b128 v[144:147], v6 offset:128
    v_mfma_f32_16x16x32_bf16 v[108:111], v[196:199], v[192:195], v[108:111]
    ds_read_b128 v[148:151], v6 offset:192
    v_mfma_f32_16x16x32_bf16 v[112:115], v[200:203], v[192:195], v[112:115]
    ds_read_b128 v[152:155], v6 offset:256
    v_mfma_f32_16x16x32_bf16 v[84:87], v[200:203], v[188:191], v[84:87]
    ds_read_b128 v[156:159], v6 offset:320
    v_mfma_f32_16x16x32_bf16 v[56:59], v[200:203], v[184:187], v[56:59]
    ds_read_b128 v[160:163], v6 offset:384
    v_mfma_f32_16x16x32_bf16 v[28:31], v[200:203], v[180:183], v[28:31]
    ds_read_b128 v[164:167], v7 offset:0
    v_mfma_f32_16x16x32_bf16 v[32:35], v[204:207], v[180:183], v[32:35]
    ds_read_b128 v[168:171], v7 offset:256
    v_mfma_f32_16x16x32_bf16 v[60:63], v[204:207], v[184:187], v[60:63]
    ds_read_b128 v[172:175], v7 offset:512
    v_mfma_f32_16x16x32_bf16 v[88:91], v[204:207], v[188:191], v[88:91]
    ds_read_b128 v[176:179], v7 offset:768
    v_mov_b32 v13, v240
    v_mfma_f32_16x16x32_bf16 v[116:119], v[204:207], v[192:195], v[116:119]
    v_add_u32 v18, 0, v240
    v_mov_b32 v14, v241
    v_mfma_f32_16x16x32_bf16 v[120:123], v[208:211], v[192:195], v[120:123]
    v_add_u32 v19, 0, v241
    v_mov_b32 v15, v242
    v_mfma_f32_16x16x32_bf16 v[92:95], v[208:211], v[188:191], v[92:95]
    v_add_u32 v20, 0, v242
    v_mov_b32 v16, v243
    v_mfma_f32_16x16x32_bf16 v[64:67], v[208:211], v[184:187], v[64:67]
    v_add_u32 v21, 0, v243
    s_mov_b32 s42, 0
    s_mov_b32 s43, 0
    v_mfma_f32_16x16x32_bf16 v[36:39], v[208:211], v[180:183], v[36:39]
    s_mov_b32 s48, 0
    v_mov_b32 v17, v12
    v_and_b32 v199, 7, v0
    v_mfma_f32_16x16x32_bf16 v[40:43], v[212:215], v[180:183], v[40:43]
    v_lshrrev_b32 v228, 6, v0
    v_lshlrev_b32 v228, 4, v228
    v_mfma_f32_16x16x32_bf16 v[68:71], v[212:215], v[184:187], v[68:71]
    v_bfe_u32 v229, v0, 3, 3
    v_add_u32 v228, v228, v229
    s_lshr_b32 s78, s29, 1
    v_mfma_f32_16x16x32_bf16 v[96:99], v[212:215], v[188:191], v[96:99]
    s_lshl_b32 s78, s78, 16
    s_and_b32 s79, s29, 1
    s_lshl_b32 s79, s79, 7
    v_mfma_f32_16x16x32_bf16 v[124:127], v[212:215], v[192:195], v[124:127]
    s_add_u32 s78, s78, s79
    s_lshr_b32 s79, s30, 1
    s_lshl_b32 s79, s79, 13
    v_mfma_f32_16x16x32_bf16 v[128:131], v[216:219], v[192:195], v[128:131]
    s_add_u32 s78, s78, s79
    v_lshlrev_b32 v196, 8, v228
    v_lshl_add_u32 v196, v199, 4, v196
    v_mfma_f32_16x16x32_bf16 v[100:103], v[216:219], v[188:191], v[100:103]
    v_add_u32 v196, s78, v196
    v_mfma_f32_16x16x32_bf16 v[72:75], v[216:219], v[184:187], v[72:75]
    v_mfma_f32_16x16x32_bf16 v[44:47], v[216:219], v[180:183], v[44:47]
    v_mfma_f32_16x16x32_bf16 v[48:51], v[220:223], v[180:183], v[48:51]
    v_mfma_f32_16x16x32_bf16 v[76:79], v[220:223], v[184:187], v[76:79]
    v_mfma_f32_16x16x32_bf16 v[104:107], v[220:223], v[188:191], v[104:107]
    v_mfma_f32_16x16x32_bf16 v[132:135], v[220:223], v[192:195], v[132:135]
    s_waitcnt lgkmcnt(0)
    s_cmp_eq_u32 s35, 1
    s_cbranch_scc1 G3_e1
    v_pk_fma_f32 v[24:25], v[164:165], v[136:137], v[24:25] op_sel_hi:[0,1,1] neg_lo:[1,0,0] neg_hi:[1,0,0]
    v_pk_fma_f32 v[26:27], v[164:165], v[138:139], v[26:27] op_sel_hi:[0,1,1] neg_lo:[1,0,0] neg_hi:[1,0,0]
    v_pk_mul_f32 v[226:227], v[24:25], v[24:25]
    v_pk_mul_f32 v[228:229], v[26:27], v[26:27]
    v_pk_fma_f32 v[226:227], v[226:227], v[166:167], v[166:167] op_sel:[0,1,0] op_sel_hi:[1,1,0]
    v_pk_fma_f32 v[228:229], v[228:229], v[166:167], v[166:167] op_sel:[0,1,0] op_sel_hi:[1,1,0]
    v_pk_mul_f32 v[226:227], v[226:227], v[24:25]
    v_pk_mul_f32 v[228:229], v[228:229], v[26:27]
    v_exp_f32 v226, v226
    v_exp_f32 v227, v227
    v_exp_f32 v228, v228
    v_exp_f32 v229, v229
    v_pk_fma_f32 v[226:227], v[226:227], v[164:165], v[164:165] op_sel:[0,1,1] op_sel_hi:[1,1,1]
    v_pk_fma_f32 v[228:229], v[228:229], v[164:165], v[164:165] op_sel:[0,1,1] op_sel_hi:[1,1,1]
    v_rcp_f32 v226, v226
    v_rcp_f32 v227, v227
    v_rcp_f32 v228, v228
    v_rcp_f32 v229, v229
    v_pk_mul_f32 v[24:25], v[24:25], v[226:227]
    v_pk_mul_f32 v[26:27], v[26:27], v[228:229]
    v_pk_fma_f32 v[28:29], v[164:165], v[140:141], v[28:29] op_sel_hi:[0,1,1] neg_lo:[1,0,0] neg_hi:[1,0,0]
    v_pk_fma_f32 v[30:31], v[164:165], v[142:143], v[30:31] op_sel_hi:[0,1,1] neg_lo:[1,0,0] neg_hi:[1,0,0]
    v_pk_mul_f32 v[226:227], v[28:29], v[28:29]
    v_pk_mul_f32 v[228:229], v[30:31], v[30:31]
    v_pk_fma_f32 v[226:227], v[226:227], v[166:167], v[166:167] op_sel:[0,1,0] op_sel_hi:[1,1,0]
    v_pk_fma_f32 v[228:229], v[228:229], v[166:167], v[166:167] op_sel:[0,1,0] op_sel_hi:[1,1,0]
    v_pk_mul_f32 v[226:227], v[226:227], v[28:29]
    v_pk_mul_f32 v[228:229], v[228:229], v[30:31]
    v_exp_f32 v226, v226
    v_exp_f32 v227, v227
    v_exp_f32 v228, v228
    v_exp_f32 v229, v229
    v_pk_fma_f32 v[226:227], v[226:227], v[164:165], v[164:165] op_sel:[0,1,1] op_sel_hi:[1,1,1]
    v_pk_fma_f32 v[228:229], v[228:229], v[164:165], v[164:165] op_sel:[0,1,1] op_sel_hi:[1,1,1]
    v_rcp_f32 v226, v226
    v_rcp_f32 v227, v227
    v_rcp_f32 v228, v228
    v_rcp_f32 v229, v229
    v_pk_mul_f32 v[28:29], v[28:29], v[226:227]
    v_pk_mul_f32 v[30:31], v[30:31], v[228:229]
    v_cvt_pk_bf16_f32 v24, v24, v25
    v_cvt_pk_bf16_f32 v25, v26, v27
    v_cvt_pk_bf16_f32 v26, v28, v29
    v_cvt_pk_bf16_f32 v27, v30, v31
    v_or_b32 v24, 1, v24
    ds_write_b128 v244, v[24:27] offset:0
    s_add_u32 s36, s44, 0
    buffer_store_dwordx4 v[24:27], v2, s[16:19], s36 offen sc1
    v_pk_fma_f32 v[52:53], v[168:169], v[136:137], v[52:53] op_sel_hi:[0,1,1] neg_lo:[1,0,0] neg_hi:[1,0,0]
    v_pk_fma_f32 v[54:55], v[168:169], v[138:139], v[54:55] op_sel_hi:[0,1,1] neg_lo:[1,0,0] neg_hi:[1,0,0]
    v_pk_mul_f32 v[226:227], v[52:53], v[52:53]
    v_pk_mul_f32 v[228:229], v[54:55], v[54:55]
    v_pk_fma_f32 v[226:227], v[226:227], v[170:171], v[170:171] op_sel:[0,1,0] op_sel_hi:[1,1,0]
    v_pk_fma_f32 v[228:229], v[228:229], v[170:171], v[170:171] op_sel:[0,1,0] op_sel_hi:[1,1,0]
    v_pk_mul_f32 v[226:227], v[226:227], v[52:53]
    v_pk_mul_f32 v[228:229], v[228:229], v[54:55]
    v_exp_f32 v226, v226
    v_exp_f32 v227, v227
    v_exp_f32 v228, v228
    v_exp_f32 v229, v229
    v_pk_fma_f32 v[226:227], v[226:227], v[168:169], v[168:169] op_sel:[0,1,1] op_sel_hi:[1,1,1]
    v_pk_fma_f32 v[228:229], v[228:229], v[168:169], v[168:169] op_sel:[0,1,1] op_sel_hi:[1,1,1]
    v_rcp_f32 v226, v226
    v_rcp_f32 v227, v227
    v_rcp_f32 v228, v228
    v_rcp_f32 v229, v229
    v_pk_mul_f32 v[52:53], v[52:53], v[226:227]
    v_pk_mul_f32 v[54:55], v[54:55], v[228:229]
    v_pk_fma_f32 v[56:57], v[168:169], v[140:141], v[56:57] op_sel_hi:[0,1,1] neg_lo:[1,0,0] neg_hi:[1,0,0]
    v_pk_fma_f32 v[58:59], v[168:169], v[142:143], v[58:59] op_sel_hi:[0,1,1] neg_lo:[1,0,0] neg_hi:[1,0,0]
    v_pk_mul_f32 v[226:227], v[56:57], v[56:57]
    v_pk_mul_f32 v[228:229], v[58:59], v[58:59]
    v_pk_fma_f32 v[226:227], v[226:227], v[170:171], v[170:171] op_sel:[0,1,0] op_sel_hi:[1,1,0]
    v_pk_fma_f32 v[228:229], v[228:229], v[170:171], v[170:171] op_sel:[0,1,0] op_sel_hi:[1,1,0]
    v_pk_mul_f32 v[226:227], v[226:227], v[56:57]
    v_pk_mul_f32 v[228:229], v[228:229], v[58:59]
    v_exp_f32 v226, v226
    v_exp_f32 v227, v227
    v_exp_f32 v228, v228
    v_exp_f32 v229, v229
    v_pk_fma_f32 v[226:227], v[226:227], v[168:169], v[168:169] op_sel:[0,1,1] op_sel_hi:[1,1,1]
    v_pk_fma_f32 v[228:229], v[228:229], v[168:169], v[168:169] op_sel:[0,1,1] op_sel_hi:[1,1,1]
    v_rcp_f32 v226, v226
    v_rcp_f32 v227, v227
    v_rcp_f32 v228, v228
    v_rcp_f32 v229, v229
    v_pk_mul_f32 v[56:57], v[56:57], v[226:227]
    v_pk_mul_f32 v[58:59], v[58:59], v[228:229]
    v_cvt_pk_bf16_f32 v52, v52, v53
    v_cvt_pk_bf16_f32 v53, v54, v55
    v_cvt_pk_bf16_f32 v54, v56, v57
    v_cvt_pk_bf16_f32 v55, v58, v59
    v_or_b32 v52, 1, v52
    ds_write_b128 v244, v[52:55] offset:2048
    s_add_u32 s36, s44, 229376
    buffer_store_dwordx4 v[52:55], v2, s[16:19], s36 offen sc1
    v_pk_fma_f32 v[80:81], v[172:173], v[136:137], v[80:81] op_sel_hi:[0,1,1] neg_lo:[1,0,0] neg_hi:[1,0,0]
    v_pk_fma_f32 v[82:83], v[172:173], v[138:139], v[82:83] op_sel_hi:[0,1,1] neg_lo:[1,0,0] neg_hi:[1,0,0]
    v_pk_mul_f32 v[226:227], v[80:81], v[80:81]
    v_pk_mul_f32 v[228:229], v[82:83], v[82:83]
    v_pk_fma_f32 v[226:227], v[226:227], v[174:175], v[174:175] op_sel:[0,1,0] op_sel_hi:[1,1,0]
    v_pk_fma_f32 v[228:229], v[228:229], v[174:175], v[174:175] op_sel:[0,1,0] op_sel_hi:[1,1,0]
    v_pk_mul_f32 v[226:227], v[226:227], v[80:81]
    v_pk_mul_f32 v[228:229], v[228:229], v[82:83]
    v_exp_f32 v226, v226
    v_exp_f32 v227, v227
    v_exp_f32 v228, v228
    v_exp_f32 v229, v229
    v_pk_fma_f32 v[226:227], v[226:227], v[172:173], v[172:173] op_sel:[0,1,1] op_sel_hi:[1,1,1]
    v_pk_fma_f32 v[228:229], v[228:229], v[172:173], v[172:173] op_sel:[0,1,1] op_sel_hi:[1,1,1]
    v_rcp_f32 v226, v226
    v_rcp_f32 v227, v227
    v_rcp_f32 v228, v228
    v_rcp_f32 v229, v229
    v_pk_mul_f32 v[80:81], v[80:81], v[226:227]
    v_pk_mul_f32 v[82:83], v[82:83], v[228:229]
    v_pk_fma_f32 v[84:85], v[172:173], v[140:141], v[84:85] op_sel_hi:[0,1,1] neg_lo:[1,0,0] neg_hi:[1,0,0]
    v_pk_fma_f32 v[86:87], v[172:173], v[142:143], v[86:87] op_sel_hi:[0,1,1] neg_lo:[1,0,0] neg_hi:[1,0,0]
    v_pk_mul_f32 v[226:227], v[84:85], v[84:85]
    v_pk_mul_f32 v[228:229], v[86:87], v[86:87]
    v_pk_fma_f32 v[226:227], v[226:227], v[174:175], v[174:175] op_sel:[0,1,0] op_sel_hi:[1,1,0]
    v_pk_fma_f32 v[228:229], v[228:229], v[174:175], v[174:175] op_sel:[0,1,0] op_sel_hi:[1,1,0]
    v_pk_mul_f32 v[226:227], v[226:227], v[84:85]
    v_pk_mul_f32 v[228:229], v[228:229], v[86:87]
    v_exp_f32 v226, v226
    v_exp_f32 v227, v227
    v_exp_f32 v228, v228
    v_exp_f32 v229, v229
    v_pk_fma_f32 v[226:227], v[226:227], v[172:173], v[172:173] op_sel:[0,1,1] op_sel_hi:[1,1,1]
    v_pk_fma_f32 v[228:229], v[228:229], v[172:173], v[172:173] op_sel:[0,1,1] op_sel_hi:[1,1,1]
    v_rcp_f32 v226, v226
    v_rcp_f32 v227, v227
    v_rcp_f32 v228, v228
    v_rcp_f32 v229, v229
    v_pk_mul_f32 v[84:85], v[84:85], v[226:227]
    v_pk_mul_f32 v[86:87], v[86:87], v[228:229]
    v_cvt_pk_bf16_f32 v80, v80, v81
    v_cvt_pk_bf16_f32 v81, v82, v83
    v_cvt_pk_bf16_f32 v82, v84, v85
    v_cvt_pk_bf16_f32 v83, v86, v87
    v_or_b32 v80, 1, v80
    ds_write_b128 v244, v[80:83] offset:4096
    s_add_u32 s36, s44, 458752
    buffer_store_dwordx4 v[80:83], v2, s[16:19], s36 offen sc1
    v_pk_fma_f32 v[108:109], v[176:177], v[136:137], v[108:109] op_sel_hi:[0,1,1] neg_lo:[1,0,0] neg_hi:[1,0,0]
    v_pk_fma_f32 v[110:111], v[176:177], v[138:139], v[110:111] op_sel_hi:[0,1,1] neg_lo:[1,0,0] neg_hi:[1,0,0]
    v_pk_mul_f32 v[226:227], v[108:109], v[108:109]
    v_pk_mul_f32 v[228:229], v[110:111], v[110:111]
    v_pk_fma_f32 v[226:227], v[226:227], v[178:179], v[178:179] op_sel:[0,1,0] op_sel_hi:[1,1,0]
    v_pk_fma_f32 v[228:229], v[228:229], v[178:179], v[178:179] op_sel:[0,1,0] op_sel_hi:[1,1,0]
    v_pk_mul_f32 v[226:227], v[226:227], v[108:109]
    v_pk_mul_f32 v[228:229], v[228:229], v[110:111]
    v_exp_f32 v226, v226
    v_exp_f32 v227, v227
    v_exp_f32 v228, v228
    v_exp_f32 v229, v229
    v_pk_fma_f32 v[226:227], v[226:227], v[176:177], v[176:177] op_sel:[0,1,1] op_sel_hi:[1,1,1]
    v_pk_fma_f32 v[228:229], v[228:229], v[176:177], v[176:177] op_sel:[0,1,1] op_sel_hi:[1,1,1]
    v_rcp_f32 v226, v226
    v_rcp_f32 v227, v227
    v_rcp_f32 v228, v228
    v_rcp_f32 v229, v229
    v_pk_mul_f32 v[108:109], v[108:109], v[226:227]
    v_pk_mul_f32 v[110:111], v[110:111], v[228:229]
    v_pk_fma_f32 v[112:113], v[176:177], v[140:141], v[112:113] op_sel_hi:[0,1,1] neg_lo:[1,0,0] neg_hi:[1,0,0]
    v_pk_fma_f32 v[114:115], v[176:177], v[142:143], v[114:115] op_sel_hi:[0,1,1] neg_lo:[1,0,0] neg_hi:[1,0,0]
    v_pk_mul_f32 v[226:227], v[112:113], v[112:113]
    v_pk_mul_f32 v[228:229], v[114:115], v[114:115]
    v_pk_fma_f32 v[226:227], v[226:227], v[178:179], v[178:179] op_sel:[0,1,0] op_sel_hi:[1,1,0]
    v_pk_fma_f32 v[228:229], v[228:229], v[178:179], v[178:179] op_sel:[0,1,0] op_sel_hi:[1,1,0]
    v_pk_mul_f32 v[226:227], v[226:227], v[112:113]
    v_pk_mul_f32 v[228:229], v[228:229], v[114:115]
    v_exp_f32 v226, v226
    v_exp_f32 v227, v227
    v_exp_f32 v228, v228
    v_exp_f32 v229, v229
    v_pk_fma_f32 v[226:227], v[226:227], v[176:177], v[176:177] op_sel:[0,1,1] op_sel_hi:[1,1,1]
    v_pk_fma_f32 v[228:229], v[228:229], v[176:177], v[176:177] op_sel:[0,1,1] op_sel_hi:[1,1,1]
    v_rcp_f32 v226, v226
    v_rcp_f32 v227, v227
    v_rcp_f32 v228, v228
    v_rcp_f32 v229, v229
    v_pk_mul_f32 v[112:113], v[112:113], v[226:227]
    v_pk_mul_f32 v[114:115], v[114:115], v[228:229]
    v_cvt_pk_bf16_f32 v108, v108, v109
    v_cvt_pk_bf16_f32 v109, v110, v111
    v_cvt_pk_bf16_f32 v110, v112, v113
    v_cvt_pk_bf16_f32 v111, v114, v115
    ds_write_b128 v244, v[108:111] offset:6144
    s_add_u32 s36, s44, 688128
    buffer_store_dwordx4 v[108:111], v2, s[16:19], s36 offen sc1
    v_pk_fma_f32 v[32:33], v[164:165], v[144:145], v[32:33] op_sel_hi:[0,1,1] neg_lo:[1,0,0] neg_hi:[1,0,0]
    v_pk_fma_f32 v[34:35], v[164:165], v[146:147], v[34:35] op_sel_hi:[0,1,1] neg_lo:[1,0,0] neg_hi:[1,0,0]
    v_pk_mul_f32 v[226:227], v[32:33], v[32:33]
    v_pk_mul_f32 v[228:229], v[34:35], v[34:35]
    v_pk_fma_f32 v[226:227], v[226:227], v[166:167], v[166:167] op_sel:[0,1,0] op_sel_hi:[1,1,0]
    v_pk_fma_f32 v[228:229], v[228:229], v[166:167], v[166:167] op_sel:[0,1,0] op_sel_hi:[1,1,0]
    v_pk_mul_f32 v[226:227], v[226:227], v[32:33]
    v_pk_mul_f32 v[228:229], v[228:229], v[34:35]
    v_exp_f32 v226, v226
    v_exp_f32 v227, v227
    v_exp_f32 v228, v228
    v_exp_f32 v229, v229
    v_pk_fma_f32 v[226:227], v[226:227], v[164:165], v[164:165] op_sel:[0,1,1] op_sel_hi:[1,1,1]
    v_pk_fma_f32 v[228:229], v[228:229], v[164:165], v[164:165] op_sel:[0,1,1] op_sel_hi:[1,1,1]
    v_rcp_f32 v226, v226
    v_rcp_f32 v227, v227
    v_rcp_f32 v228, v228
    v_rcp_f32 v229, v229
    v_pk_mul_f32 v[32:33], v[32:33], v[226:227]
    v_pk_mul_f32 v[34:35], v[34:35], v[228:229]
    v_pk_fma_f32 v[36:37], v[164:165], v[148:149], v[36:37] op_sel_hi:[0,1,1] neg_lo:[1,0,0] neg_hi:[1,0,0]
    v_pk_fma_f32 v[38:39], v[164:165], v[150:151], v[38:39] op_sel_hi:[0,1,1] neg_lo:[1,0,0] neg_hi:[1,0,0]
    v_pk_mul_f32 v[226:227], v[36:37], v[36:37]
    v_pk_mul_f32 v[228:229], v[38:39], v[38:39]
    v_pk_fma_f32 v[226:227], v[226:227], v[166:167], v[166:167] op_sel:[0,1,0] op_sel_hi:[1,1,0]
    v_pk_fma_f32 v[228:229], v[228:229], v[166:167], v[166:167] op_sel:[0,1,0] op_sel_hi:[1,1,0]
    v_pk_mul_f32 v[226:227], v[226:227], v[36:37]
    v_pk_mul_f32 v[228:229], v[228:229], v[38:39]
    v_exp_f32 v226, v226
    v_exp_f32 v227, v227
    v_exp_f32 v228, v228
    v_exp_f32 v229, v229
    v_pk_fma_f32 v[226:227], v[226:227], v[164:165], v[164:165] op_sel:[0,1,1] op_sel_hi:[1,1,1]
    v_pk_fma_f32 v[228:229], v[228:229], v[164:165], v[164:165] op_sel:[0,1,1] op_sel_hi:[1,1,1]
    v_rcp_f32 v226, v226
    v_rcp_f32 v227, v227
    v_rcp_f32 v228, v228
    v_rcp_f32 v229, v229
    v_pk_mul_f32 v[36:37], v[36:37], v[226:227]
    v_pk_mul_f32 v[38:39], v[38:39], v[228:229]
    v_cvt_pk_bf16_f32 v32, v32, v33
    v_cvt_pk_bf16_f32 v33, v34, v35
    v_cvt_pk_bf16_f32 v34, v36, v37
    v_cvt_pk_bf16_f32 v35, v38, v39
    v_or_b32 v32, 1, v32
    ds_write_b128 v244, v[32:35] offset:16384
    v_pk_fma_f32 v[60:61], v[168:169], v[144:145], v[60:61] op_sel_hi:[0,1,1] neg_lo:[1,0,0] neg_hi:[1,0,0]
    v_pk_fma_f32 v[62:63], v[168:169], v[146:147], v[62:63] op_sel_hi:[0,1,1] neg_lo:[1,0,0] neg_hi:[1,0,0]
    v_pk_mul_f32 v[226:227], v[60:61], v[60:61]
    v_pk_mul_f32 v[228:229], v[62:63], v[62:63]
    v_pk_fma_f32 v[226:227], v[226:227], v[170:171], v[170:171] op_sel:[0,1,0] op_sel_hi:[1,1,0]
    v_pk_fma_f32 v[228:229], v[228:229], v[170:171], v[170:171] op_sel:[0,1,0] op_sel_hi:[1,1,0]
    v_pk_mul_f32 v[226:227], v[226:227], v[60:61]
    v_pk_mul_f32 v[228:229], v[228:229], v[62:63]
    v_exp_f32 v226, v226
    v_exp_f32 v227, v227
    v_exp_f32 v228, v228
    v_exp_f32 v229, v229
    v_pk_fma_f32 v[226:227], v[226:227], v[168:169], v[168:169] op_sel:[0,1,1] op_sel_hi:[1,1,1]
    v_pk_fma_f32 v[228:229], v[228:229], v[168:169], v[168:169] op_sel:[0,1,1] op_sel_hi:[1,1,1]
    v_rcp_f32 v226, v226
    v_rcp_f32 v227, v227
    v_rcp_f32 v228, v228
    v_rcp_f32 v229, v229
    v_pk_mul_f32 v[60:61], v[60:61], v[226:227]
    v_pk_mul_f32 v[62:63], v[62:63], v[228:229]
    v_pk_fma_f32 v[64:65], v[168:169], v[148:149], v[64:65] op_sel_hi:[0,1,1] neg_lo:[1,0,0] neg_hi:[1,0,0]
    v_pk_fma_f32 v[66:67], v[168:169], v[150:151], v[66:67] op_sel_hi:[0,1,1] neg_lo:[1,0,0] neg_hi:[1,0,0]
    v_pk_mul_f32 v[226:227], v[64:65], v[64:65]
    v_pk_mul_f32 v[228:229], v[66:67], v[66:67]
    v_pk_fma_f32 v[226:227], v[226:227], v[170:171], v[170:171] op_sel:[0,1,0] op_sel_hi:[1,1,0]
    v_pk_fma_f32 v[228:229], v[228:229], v[170:171], v[170:171] op_sel:[0,1,0] op_sel_hi:[1,1,0]
    v_pk_mul_f32 v[226:227], v[226:227], v[64:65]
    v_pk_mul_f32 v[228:229], v[228:229], v[66:67]
    v_exp_f32 v226, v226
    v_exp_f32 v227, v227
    v_exp_f32 v228, v228
    v_exp_f32 v229, v229
    v_pk_fma_f32 v[226:227], v[226:227], v[168:169], v[168:169] op_sel:[0,1,1] op_sel_hi:[1,1,1]
    v_pk_fma_f32 v[228:229], v[228:229], v[168:169], v[168:169] op_sel:[0,1,1] op_sel_hi:[1,1,1]
    v_rcp_f32 v226, v226
    v_rcp_f32 v227, v227
    v_rcp_f32 v228, v228
    v_rcp_f32 v229, v229
    v_pk_mul_f32 v[64:65], v[64:65], v[226:227]
    v_pk_mul_f32 v[66:67], v[66:67], v[228:229]
    v_cvt_pk_bf16_f32 v60, v60, v61
    v_cvt_pk_bf16_f32 v61, v62, v63
    v_cvt_pk_bf16_f32 v62, v64, v65
    v_cvt_pk_bf16_f32 v63, v66, v67
    v_or_b32 v60, 1, v60
    ds_write_b128 v244, v[60:63] offset:18432
    s_waitcnt vmcnt(0)
    s_mov_b64 exec, 1
    ds_add_u32 v246, v245
    s_mov_b64 exec, -1
    v_pk_fma_f32 v[88:89], v[172:173], v[144:145], v[88:89] op_sel_hi:[0,1,1] neg_lo:[1,0,0] neg_hi:[1,0,0]
    v_pk_fma_f32 v[90:91], v[172:173], v[146:147], v[90:91] op_sel_hi:[0,1,1] neg_lo:[1,0,0] neg_hi:[1,0,0]
    v_pk_mul_f32 v[226:227], v[88:89], v[88:89]
    v_pk_mul_f32 v[228:229], v[90:91], v[90:91]
    v_pk_fma_f32 v[226:227], v[226:227], v[174:175], v[174:175] op_sel:[0,1,0] op_sel_hi:[1,1,0]
    v_pk_fma_f32 v[228:229], v[228:229], v[174:175], v[174:175] op_sel:[0,1,0] op_sel_hi:[1,1,0]
    v_pk_mul_f32 v[226:227], v[226:227], v[88:89]
    v_pk_mul_f32 v[228:229], v[228:229], v[90:91]
    v_exp_f32 v226, v226
    v_exp_f32 v227, v227
    v_exp_f32 v228, v228
    v_exp_f32 v229, v229
    v_pk_fma_f32 v[226:227], v[226:227], v[172:173], v[172:173] op_sel:[0,1,1] op_sel_hi:[1,1,1]
    v_pk_fma_f32 v[228:229], v[228:229], v[172:173], v[172:173] op_sel:[0,1,1] op_sel_hi:[1,1,1]
    v_rcp_f32 v226, v226
    v_rcp_f32 v227, v227
    v_rcp_f32 v228, v228
    v_rcp_f32 v229, v229
    v_pk_mul_f32 v[88:89], v[88:89], v[226:227]
    v_pk_mul_f32 v[90:91], v[90:91], v[228:229]
    v_pk_fma_f32 v[92:93], v[172:173], v[148:149], v[92:93] op_sel_hi:[0,1,1] neg_lo:[1,0,0] neg_hi:[1,0,0]
    v_pk_fma_f32 v[94:95], v[172:173], v[150:151], v[94:95] op_sel_hi:[0,1,1] neg_lo:[1,0,0] neg_hi:[1,0,0]
    v_pk_mul_f32 v[226:227], v[92:93], v[92:93]
    v_pk_mul_f32 v[228:229], v[94:95], v[94:95]
    v_pk_fma_f32 v[226:227], v[226:227], v[174:175], v[174:175] op_sel:[0,1,0] op_sel_hi:[1,1,0]
    v_pk_fma_f32 v[228:229], v[228:229], v[174:175], v[174:175] op_sel:[0,1,0] op_sel_hi:[1,1,0]
    v_pk_mul_f32 v[226:227], v[226:227], v[92:93]
    v_pk_mul_f32 v[228:229], v[228:229], v[94:95]
    v_exp_f32 v226, v226
    v_exp_f32 v227, v227
    v_exp_f32 v228, v228
    v_exp_f32 v229, v229
    v_pk_fma_f32 v[226:227], v[226:227], v[172:173], v[172:173] op_sel:[0,1,1] op_sel_hi:[1,1,1]
    v_pk_fma_f32 v[228:229], v[228:229], v[172:173], v[172:173] op_sel:[0,1,1] op_sel_hi:[1,1,1]
    v_rcp_f32 v226, v226
    v_rcp_f32 v227, v227
    v_rcp_f32 v228, v228
    v_rcp_f32 v229, v229
    v_pk_mul_f32 v[92:93], v[92:93], v[226:227]
    v_pk_mul_f32 v[94:95], v[94:95], v[228:229]
    v_cvt_pk_bf16_f32 v88, v88, v89
    v_cvt_pk_bf16_f32 v89, v90, v91
    v_cvt_pk_bf16_f32 v90, v92, v93
    v_cvt_pk_bf16_f32 v91, v94, v95
    v_or_b32 v88, 1, v88
    ds_write_b128 v244, v[88:91] offset:20480
    s_cmp_eq_u32 s60, 1
    s_cbranch_scc1 G4_p10
    buffer_load_dwordx4 v[180:183], v196, s[84:87], 0 offen offset:0 sc1
    buffer_load_dwordx4 v[188:191], v196, s[88:91], 0 offen offset:0 sc1
    buffer_load_dwordx4 v[184:187], v196, s[84:87], 0 offen offset:2048 sc1
    buffer_load_dwordx4 v[192:195], v196, s[88:91], 0 offen offset:2048 sc1
    s_branch G4_p20
G4_p10:
    s_add_u32 s36, s40, 0
    buffer_load_dwordx4 v[180:183], v2, s[84:87], s36 offen offset:0 sc1
    buffer_load_dwordx4 v[184:187], v2, s[88:91], s36 offen offset:0 sc1
    buffer_load_dwordx4 v[188:191], v2, s[84:87], s36 offen offset:1024 sc1
    buffer_load_dwordx4 v[192:195], v2, s[88:91], s36 offen offset:1024 sc1
    s_add_u32 s36, s40, 65536
    buffer_load_dwordx4 v[196:199], v2, s[84:87], s36 offen offset:0 sc1
    buffer_load_dwordx4 v[230:233], v2, s[88:91], s36 offen offset:0 sc1
    buffer_load_dwordx4 v[234:237], v2, s[84:87], s36 offen offset:1024 sc1
    buffer_load_dwordx4 v[248:251], v2, s[88:91], s36 offen offset:1024 sc1
G4_p20:
    v_pk_fma_f32 v[116:117], v[176:177], v[144:145], v[116:117] op_sel_hi:[0,1,1] neg_lo:[1,0,0] neg_hi:[1,0,0]
    v_pk_fma_f32 v[118:119], v[176:177], v[146:147], v[118:119] op_sel_hi:[0,1,1] neg_lo:[1,0,0] neg_hi:[1,0,0]
    v_pk_mul_f32 v[226:227], v[116:117], v[116:117]
    v_pk_mul_f32 v[228:229], v[118:119], v[118:119]
    v_pk_fma_f32 v[226:227], v[226:227], v[178:179], v[178:179] op_sel:[0,1,0] op_sel_hi:[1,1,0]
    v_pk_fma_f32 v[228:229], v[228:229], v[178:179], v[178:179] op_sel:[0,1,0] op_sel_hi:[1,1,0]
    v_pk_mul_f32 v[226:227], v[226:227], v[116:117]
    v_pk_mul_f32 v[228:229], v[228:229], v[118:119]
    v_exp_f32 v226, v226
    v_exp_f32 v227, v227
    v_exp_f32 v228, v228
    v_exp_f32 v229, v229
    v_pk_fma_f32 v[226:227], v[226:227], v[176:177], v[176:177] op_sel:[0,1,1] op_sel_hi:[1,1,1]
    v_pk_fma_f32 v[228:229], v[228:229], v[176:177], v[176:177] op_sel:[0,1,1] op_sel_hi:[1,1,1]
    v_rcp_f32 v226, v226
    v_rcp_f32 v227, v227
    v_rcp_f32 v228, v228
    v_rcp_f32 v229, v229
    v_pk_mul_f32 v[116:117], v[116:117], v[226:227]
    v_pk_mul_f32 v[118:119], v[118:119], v[228:229]
    v_pk_fma_f32 v[120:121], v[176:177], v[148:149], v[120:121] op_sel_hi:[0,1,1] neg_lo:[1,0,0] neg_hi:[1,0,0]
    v_pk_fma_f32 v[122:123], v[176:177], v[150:151], v[122:123] op_sel_hi:[0,1,1] neg_lo:[1,0,0] neg_hi:[1,0,0]
    v_pk_mul_f32 v[226:227], v[120:121], v[120:121]
    v_pk_mul_f32 v[228:229], v[122:123], v[122:123]
    v_pk_fma_f32 v[226:227], v[226:227], v[178:179], v[178:179] op_sel:[0,1,0] op_sel_hi:[1,1,0]
    v_pk_fma_f32 v[228:229], v[228:229], v[178:179], v[178:179] op_sel:[0,1,0] op_sel_hi:[1,1,0]
    v_pk_mul_f32 v[226:227], v[226:227], v[120:121]
    v_pk_mul_f32 v[228:229], v[228:229], v[122:123]
    v_exp_f32 v226, v226
    v_exp_f32 v227, v227
    v_exp_f32 v228, v228
    v_exp_f32 v229, v229
    v_pk_fma_f32 v[226:227], v[226:227], v[176:177], v[176:177] op_sel:[0,1,1] op_sel_hi:[1,1,1]
    v_pk_fma_f32 v[228:229], v[228:229], v[176:177], v[176:177] op_sel:[0,1,1] op_sel_hi:[1,1,1]
    v_rcp_f32 v226, v226
    v_rcp_f32 v227, v227
    v_rcp_f32 v228, v228
    v_rcp_f32 v229, v229
    v_pk_mul_f32 v[120:121], v[120:121], v[226:227]
    v_pk_mul_f32 v[122:123], v[122:123], v[228:229]
    v_cvt_pk_bf16_f32 v116, v116, v117
    v_cvt_pk_bf16_f32 v117, v118, v119
    v_cvt_pk_bf16_f32 v118, v120, v121
    v_cvt_pk_bf16_f32 v119, v122, v123
    ds_write_b128 v244, v[116:119] offset:22528
    v_pk_fma_f32 v[40:41], v[164:165], v[152:153], v[40:41] op_sel_hi:[0,1,1] neg_lo:[1,0,0] neg_hi:[1,0,0]
    v_pk_fma_f32 v[42:43], v[164:165], v[154:155], v[42:43] op_sel_hi:[0,1,1] neg_lo:[1,0,0] neg_hi:[1,0,0]
    v_pk_mul_f32 v[226:227], v[40:41], v[40:41]
    v_pk_mul_f32 v[228:229], v[42:43], v[42:43]
    v_pk_fma_f32 v[226:227], v[226:227], v[166:167], v[166:167] op_sel:[0,1,0] op_sel_hi:[1,1,0]
    v_pk_fma_f32 v[228:229], v[228:229], v[166:167], v[166:167] op_sel:[0,1,0] op_sel_hi:[1,1,0]
    v_pk_mul_f32 v[226:227], v[226:227], v[40:41]
    v_pk_mul_f32 v[228:229], v[228:229], v[42:43]
    v_exp_f32 v226, v226
    v_exp_f32 v227, v227
    v_exp_f32 v228, v228
    v_exp_f32 v229, v229
    v_pk_fma_f32 v[226:227], v[226:227], v[164:165], v[164:165] op_sel:[0,1,1] op_sel_hi:[1,1,1]
    v_pk_fma_f32 v[228:229], v[228:229], v[164:165], v[164:165] op_sel:[0,1,1] op_sel_hi:[1,1,1]
    v_rcp_f32 v226, v226
    v_rcp_f32 v227, v227
    v_rcp_f32 v228, v228
    v_rcp_f32 v229, v229
    v_pk_mul_f32 v[40:41], v[40:41], v[226:227]
    v_pk_mul_f32 v[42:43], v[42:43], v[228:229]
    v_pk_fma_f32 v[44:45], v[164:165], v[156:157], v[44:45] op_sel_hi:[0,1,1] neg_lo:[1,0,0] neg_hi:[1,0,0]
    v_pk_fma_f32 v[46:47], v[164:165], v[158:159], v[46:47] op_sel_hi:[0,1,1] neg_lo:[1,0,0] neg_hi:[1,0,0]
    v_pk_mul_f32 v[226:227], v[44:45], v[44:45]
    v_pk_mul_f32 v[228:229], v[46:47], v[46:47]
    v_pk_fma_f32 v[226:227], v[226:227], v[166:167], v[166:167] op_sel:[0,1,0] op_sel_hi:[1,1,0]
    v_pk_fma_f32 v[228:229], v[228:229], v[166:167], v[166:167] op_sel:[0,1,0] op_sel_hi:[1,1,0]
    v_pk_mul_f32 v[226:227], v[226:227], v[44:45]
    v_pk_mul_f32 v[228:229], v[228:229], v[46:47]
    v_exp_f32 v226, v226
    v_exp_f32 v227, v227
    v_exp_f32 v228, v228
    v_exp_f32 v229, v229
    v_pk_fma_f32 v[226:227], v[226:227], v[164:165], v[164:165] op_sel:[0,1,1] op_sel_hi:[1,1,1]
    v_pk_fma_f32 v[228:229], v[228:229], v[164:165], v[164:165] op_sel:[0,1,1] op_sel_hi:[1,1,1]
    v_rcp_f32 v226, v226
    v_rcp_f32 v227, v227
    v_rcp_f32 v228, v228
    v_rcp_f32 v229, v229
    v_pk_mul_f32 v[44:45], v[44:45], v[226:227]
    v_pk_mul_f32 v[46:47], v[46:47], v[228:229]
    v_cvt_pk_bf16_f32 v200, v40, v41
    v_cvt_pk_bf16_f32 v201, v42, v43
    v_cvt_pk_bf16_f32 v202, v44, v45
    v_cvt_pk_bf16_f32 v203, v46, v47
    v_or_b32 v200, 1, v200
    ds_write_b128 v244, v[200:203] offset:32768
    v_pk_fma_f32 v[68:69], v[168:169], v[152:153], v[68:69] op_sel_hi:[0,1,1] neg_lo:[1,0,0] neg_hi:[1,0,0]
    v_pk_fma_f32 v[70:71], v[168:169], v[154:155], v[70:71] op_sel_hi:[0,1,1] neg_lo:[1,0,0] neg_hi:[1,0,0]
    v_pk_mul_f32 v[226:227], v[68:69], v[68:69]
    v_pk_mul_f32 v[228:229], v[70:71], v[70:71]
    v_pk_fma_f32 v[226:227], v[226:227], v[170:171], v[170:171] op_sel:[0,1,0] op_sel_hi:[1,1,0]
    v_pk_fma_f32 v[228:229], v[228:229], v[170:171], v[170:171] op_sel:[0,1,0] op_sel_hi:[1,1,0]
    v_pk_mul_f32 v[226:227], v[226:227], v[68:69]
    v_pk_mul_f32 v[228:229], v[228:229], v[70:71]
    v_exp_f32 v226, v226
    v_exp_f32 v227, v227
    v_exp_f32 v228, v228
    v_exp_f32 v229, v229
    v_pk_fma_f32 v[226:227], v[226:227], v[168:169], v[168:169] op_sel:[0,1,1] op_sel_hi:[1,1,1]
    v_pk_fma_f32 v[228:229], v[228:229], v[168:169], v[168:169] op_sel:[0,1,1] op_sel_hi:[1,1,1]
    v_rcp_f32 v226, v226
    v_rcp_f32 v227, v227
    v_rcp_f32 v228, v228
    v_rcp_f32 v229, v229
    v_pk_mul_f32 v[68:69], v[68:69], v[226:227]
    v_pk_mul_f32 v[70:71], v[70:71], v[228:229]
    v_pk_fma_f32 v[72:73], v[168:169], v[156:157], v[72:73] op_sel_hi:[0,1,1] neg_lo:[1,0,0] neg_hi:[1,0,0]
    v_pk_fma_f32 v[74:75], v[168:169], v[158:159], v[74:75] op_sel_hi:[0,1,1] neg_lo:[1,0,0] neg_hi:[1,0,0]
    v_pk_mul_f32 v[226:227], v[72:73], v[72:73]
    v_pk_mul_f32 v[228:229], v[74:75], v[74:75]
    v_pk_fma_f32 v[226:227], v[226:227], v[170:171], v[170:171] op_sel:[0,1,0] op_sel_hi:[1,1,0]
    v_pk_fma_f32 v[228:229], v[228:229], v[170:171], v[170:171] op_sel:[0,1,0] op_sel_hi:[1,1,0]
    v_pk_mul_f32 v[226:227], v[226:227], v[72:73]
    v_pk_mul_f32 v[228:229], v[228:229], v[74:75]
    v_exp_f32 v226, v226
    v_exp_f32 v227, v227
    v_exp_f32 v228, v228
    v_exp_f32 v229, v229
    v_pk_fma_f32 v[226:227], v[226:227], v[168:169], v[168:169] op_sel:[0,1,1] op_sel_hi:[1,1,1]
    v_pk_fma_f32 v[228:229], v[228:229], v[168:169], v[168:169] op_sel:[0,1,1] op_sel_hi:[1,1,1]
    v_rcp_f32 v226, v226
    v_rcp_f32 v227, v227
    v_rcp_f32 v228, v228
    v_rcp_f32 v229, v229
    v_pk_mul_f32 v[72:73], v[72:73], v[226:227]
    v_pk_mul_f32 v[74:75], v[74:75], v[228:229]
    v_cvt_pk_bf16_f32 v204, v68, v69
    v_cvt_pk_bf16_f32 v205, v70, v71
    v_cvt_pk_bf16_f32 v206, v72, v73
    v_cvt_pk_bf16_f32 v207, v74, v75
    v_or_b32 v204, 1, v204
    ds_write_b128 v244, v[204:207] offset:34816
    v_pk_fma_f32 v[96:97], v[172:173], v[152:153], v[96:97] op_sel_hi:[0,1,1] neg_lo:[1,0,0] neg_hi:[1,0,0]
    v_pk_fma_f32 v[98:99], v[172:173], v[154:155], v[98:99] op_sel_hi:[0,1,1] neg_lo:[1,0,0] neg_hi:[1,0,0]
    v_pk_mul_f32 v[226:227], v[96:97], v[96:97]
    v_pk_mul_f32 v[228:229], v[98:99], v[98:99]
    v_pk_fma_f32 v[226:227], v[226:227], v[174:175], v[174:175] op_sel:[0,1,0] op_sel_hi:[1,1,0]
    v_pk_fma_f32 v[228:229], v[228:229], v[174:175], v[174:175] op_sel:[0,1,0] op_sel_hi:[1,1,0]
    v_pk_mul_f32 v[226:227], v[226:227], v[96:97]
    v_pk_mul_f32 v[228:229], v[228:229], v[98:99]
    v_exp_f32 v226, v226
    v_exp_f32 v227, v227
    v_exp_f32 v228, v228
    v_exp_f32 v229, v229
    v_pk_fma_f32 v[226:227], v[226:227], v[172:173], v[172:173] op_sel:[0,1,1] op_sel_hi:[1,1,1]
    v_pk_fma_f32 v[228:229], v[228:229], v[172:173], v[172:173] op_sel:[0,1,1] op_sel_hi:[1,1,1]
    v_rcp_f32 v226, v226
    v_rcp_f32 v227, v227
    v_rcp_f32 v228, v228
    v_rcp_f32 v229, v229
    v_pk_mul_f32 v[96:97], v[96:97], v[226:227]
    v_pk_mul_f32 v[98:99], v[98:99], v[228:229]
    v_pk_fma_f32 v[100:101], v[172:173], v[156:157], v[100:101] op_sel_hi:[0,1,1] neg_lo:[1,0,0] neg_hi:[1,0,0]
    v_pk_fma_f32 v[102:103], v[172:173], v[158:159], v[102:103] op_sel_hi:[0,1,1] neg_lo:[1,0,0] neg_hi:[1,0,0]
    v_pk_mul_f32 v[226:227], v[100:101], v[100:101]
    v_pk_mul_f32 v[228:229], v[102:103], v[102:103]
    v_pk_fma_f32 v[226:227], v[226:227], v[174:175], v[174:175] op_sel:[0,1,0] op_sel_hi:[1,1,0]
    v_pk_fma_f32 v[228:229], v[228:229], v[174:175], v[174:175] op_sel:[0,1,0] op_sel_hi:[1,1,0]
    v_pk_mul_f32 v[226:227], v[226:227], v[100:101]
    v_pk_mul_f32 v[228:229], v[228:229], v[102:103]
    v_exp_f32 v226, v226
    v_exp_f32 v227, v227
    v_exp_f32 v228, v228
    v_exp_f32 v229, v229
    v_pk_fma_f32 v[226:227], v[226:227], v[172:173], v[172:173] op_sel:[0,1,1] op_sel_hi:[1,1,1]
    v_pk_fma_f32 v[228:229], v[228:229], v[172:173], v[172:173] op_sel:[0,1,1] op_sel_hi:[1,1,1]
    v_rcp_f32 v226, v226
    v_rcp_f32 v227, v227
    v_rcp_f32 v228, v228
    v_rcp_f32 v229, v229
    v_pk_mul_f32 v[100:101], v[100:101], v[226:227]
    v_pk_mul_f32 v[102:103], v[102:103], v[228:229]
    v_cvt_pk_bf16_f32 v208, v96, v97
    v_cvt_pk_bf16_f32 v209, v98, v99
    v_cvt_pk_bf16_f32 v210, v100, v101
    v_cvt_pk_bf16_f32 v211, v102, v103
    v_or_b32 v208, 1, v208
    ds_write_b128 v244, v[208:211] offset:36864
    v_pk_fma_f32 v[124:125], v[176:177], v[152:153], v[124:125] op_sel_hi:[0,1,1] neg_lo:[1,0,0] neg_hi:[1,0,0]
    v_pk_fma_f32 v[126:127], v[176:177], v[154:155], v[126:127] op_sel_hi:[0,1,1] neg_lo:[1,0,0] neg_hi:[1,0,0]
    v_pk_mul_f32 v[226:227], v[124:125], v[124:125]
    v_pk_mul_f32 v[228:229], v[126:127], v[126:127]
    v_pk_fma_f32 v[226:227], v[226:227], v[178:179], v[178:179] op_sel:[0,1,0] op_sel_hi:[1,1,0]
    v_pk_fma_f32 v[228:229], v[228:229], v[178:179], v[178:179] op_sel:[0,1,0] op_sel_hi:[1,1,0]
    v_pk_mul_f32 v[226:227], v[226:227], v[124:125]
    v_pk_mul_f32 v[228:229], v[228:229], v[126:127]
    v_exp_f32 v226, v226
    v_exp_f32 v227, v227
    v_exp_f32 v228, v228
    v_exp_f32 v229, v229
    v_pk_fma_f32 v[226:227], v[226:227], v[176:177], v[176:177] op_sel:[0,1,1] op_sel_hi:[1,1,1]
    v_pk_fma_f32 v[228:229], v[228:229], v[176:177], v[176:177] op_sel:[0,1,1] op_sel_hi:[1,1,1]
    v_rcp_f32 v226, v226
    v_rcp_f32 v227, v227
    v_rcp_f32 v228, v228
    v_rcp_f32 v229, v229
    v_pk_mul_f32 v[124:125], v[124:125], v[226:227]
    v_pk_mul_f32 v[126:127], v[126:127], v[228:229]
    v_pk_fma_f32 v[128:129], v[176:177], v[156:157], v[128:129] op_sel_hi:[0,1,1] neg_lo:[1,0,0] neg_hi:[1,0,0]
    v_pk_fma_f32 v[130:131], v[176:177], v[158:159], v[130:131] op_sel_hi:[0,1,1] neg_lo:[1,0,0] neg_hi:[1,0,0]
    v_pk_mul_f32 v[226:227], v[128:129], v[128:129]
    v_pk_mul_f32 v[228:229], v[130:131], v[130:131]
    v_pk_fma_f32 v[226:227], v[226:227], v[178:179], v[178:179] op_sel:[0,1,0] op_sel_hi:[1,1,0]
    v_pk_fma_f32 v[228:229], v[228:229], v[178:179], v[178:179] op_sel:[0,1,0] op_sel_hi:[1,1,0]
    v_pk_mul_f32 v[226:227], v[226:227], v[128:129]
    v_pk_mul_f32 v[228:229], v[228:229], v[130:131]
    v_exp_f32 v226, v226
    v_exp_f32 v227, v227
    v_exp_f32 v228, v228
    v_exp_f32 v229, v229
    v_pk_fma_f32 v[226:227], v[226:227], v[176:177], v[176:177] op_sel:[0,1,1] op_sel_hi:[1,1,1]
    v_pk_fma_f32 v[228:229], v[228:229], v[176:177], v[176:177] op_sel:[0,1,1] op_sel_hi:[1,1,1]
    v_rcp_f32 v226, v226
    v_rcp_f32 v227, v227
    v_rcp_f32 v228, v228
    v_rcp_f32 v229, v229
    v_pk_mul_f32 v[128:129], v[128:129], v[226:227]
    v_pk_mul_f32 v[130:131], v[130:131], v[228:229]
    v_cvt_pk_bf16_f32 v212, v124, v125
    v_cvt_pk_bf16_f32 v213, v126, v127
    v_cvt_pk_bf16_f32 v214, v128, v129
    v_cvt_pk_bf16_f32 v215, v130, v131
    ds_write_b128 v244, v[212:215] offset:38912
    v_pk_fma_f32 v[48:49], v[164:165], v[160:161], v[48:49] op_sel_hi:[0,1,1] neg_lo:[1,0,0] neg_hi:[1,0,0]
    v_pk_fma_f32 v[50:51], v[164:165], v[162:163], v[50:51] op_sel_hi:[0,1,1] neg_lo:[1,0,0] neg_hi:[1,0,0]
    v_pk_mul_f32 v[226:227], v[48:49], v[48:49]
    v_pk_mul_f32 v[228:229], v[50:51], v[50:51]
    v_pk_fma_f32 v[226:227], v[226:227], v[166:167], v[166:167] op_sel:[0,1,0] op_sel_hi:[1,1,0]
    v_pk_fma_f32 v[228:229], v[228:229], v[166:167], v[166:167] op_sel:[0,1,0] op_sel_hi:[1,1,0]
    v_pk_mul_f32 v[226:227], v[226:227], v[48:49]
    v_pk_mul_f32 v[228:229], v[228:229], v[50:51]
    v_exp_f32 v226, v226
    v_exp_f32 v227, v227
    v_exp_f32 v228, v228
    v_exp_f32 v229, v229
    v_pk_fma_f32 v[226:227], v[226:227], v[164:165], v[164:165] op_sel:[0,1,1] op_sel_hi:[1,1,1]
    v_pk_fma_f32 v[228:229], v[228:229], v[164:165], v[164:165] op_sel:[0,1,1] op_sel_hi:[1,1,1]
    v_rcp_f32 v226, v226
    v_rcp_f32 v227, v227
    v_rcp_f32 v228, v228
    v_rcp_f32 v229, v229
    v_pk_mul_f32 v[48:49], v[48:49], v[226:227]
    v_pk_mul_f32 v[50:51], v[50:51], v[228:229]
    v_cvt_pk_bf16_f32 v216, v48, v49
    v_cvt_pk_bf16_f32 v217, v50, v51
    v_or_b32 v216, 1, v216
    s_add_u32 s36, s45, 0
    buffer_store_dwordx4 v[32:35], v2, s[16:19], s36 offen sc1
    v_pk_fma_f32 v[76:77], v[168:169], v[160:161], v[76:77] op_sel_hi:[0,1,1] neg_lo:[1,0,0] neg_hi:[1,0,0]
    v_pk_fma_f32 v[78:79], v[168:169], v[162:163], v[78:79] op_sel_hi:[0,1,1] neg_lo:[1,0,0] neg_hi:[1,0,0]
    v_pk_mul_f32 v[226:227], v[76:77], v[76:77]
    v_pk_mul_f32 v[228:229], v[78:79], v[78:79]
    v_pk_fma_f32 v[226:227], v[226:227], v[170:171], v[170:171] op_sel:[0,1,0] op_sel_hi:[1,1,0]
    v_pk_fma_f32 v[228:229], v[228:229], v[170:171], v[170:171] op_sel:[0,1,0] op_sel_hi:[1,1,0]
    v_pk_mul_f32 v[226:227], v[226:227], v[76:77]
    v_pk_mul_f32 v[228:229], v[228:229], v[78:79]
    v_exp_f32 v226, v226
    v_exp_f32 v227, v227
    v_exp_f32 v228, v228
    v_exp_f32 v229, v229
    v_pk_fma_f32 v[226:227], v[226:227], v[168:169], v[168:169] op_sel:[0,1,1] op_sel_hi:[1,1,1]
    v_pk_fma_f32 v[228:229], v[228:229], v[168:169], v[168:169] op_sel:[0,1,1] op_sel_hi:[1,1,1]
    v_rcp_f32 v226, v226
    v_rcp_f32 v227, v227
    v_rcp_f32 v228, v228
    v_rcp_f32 v229, v229
    v_pk_mul_f32 v[76:77], v[76:77], v[226:227]
    v_pk_mul_f32 v[78:79], v[78:79], v[228:229]
    v_cvt_pk_bf16_f32 v218, v76, v77
    v_cvt_pk_bf16_f32 v219, v78, v79
    v_or_b32 v218, 1, v218
    s_add_u32 s36, s45, 229376
    buffer_store_dwordx4 v[60:63], v2, s[16:19], s36 offen sc1
    v_pk_fma_f32 v[104:105], v[172:173], v[160:161], v[104:105] op_sel_hi:[0,1,1] neg_lo:[1,0,0] neg_hi:[1,0,0]
    v_pk_fma_f32 v[106:107], v[172:173], v[162:163], v[106:107] op_sel_hi:[0,1,1] neg_lo:[1,0,0] neg_hi:[1,0,0]
    v_pk_mul_f32 v[226:227], v[104:105], v[104:105]
    v_pk_mul_f32 v[228:229], v[106:107], v[106:107]
    v_pk_fma_f32 v[226:227], v[226:227], v[174:175], v[174:175] op_sel:[0,1,0] op_sel_hi:[1,1,0]
    v_pk_fma_f32 v[228:229], v[228:229], v[174:175], v[174:175] op_sel:[0,1,0] op_sel_hi:[1,1,0]
    v_pk_mul_f32 v[226:227], v[226:227], v[104:105]
    v_pk_mul_f32 v[228:229], v[228:229], v[106:107]
    v_exp_f32 v226, v226
    v_exp_f32 v227, v227
    v_exp_f32 v228, v228
    v_exp_f32 v229, v229
    v_pk_fma_f32 v[226:227], v[226:227], v[172:173], v[172:173] op_sel:[0,1,1] op_sel_hi:[1,1,1]
    v_pk_fma_f32 v[228:229], v[228:229], v[172:173], v[172:173] op_sel:[0,1,1] op_sel_hi:[1,1,1]
    v_rcp_f32 v226, v226
    v_rcp_f32 v227, v227
    v_rcp_f32 v228, v228
    v_rcp_f32 v229, v229
    v_pk_mul_f32 v[104:105], v[104:105], v[226:227]
    v_pk_mul_f32 v[106:107], v[106:107], v[228:229]
    v_cvt_pk_bf16_f32 v220, v104, v105
    v_cvt_pk_bf16_f32 v221, v106, v107
    v_or_b32 v220, 1, v220
    s_add_u32 s36, s45, 458752
    buffer_store_dwordx4 v[88:91], v2, s[16:19], s36 offen sc1
    v_pk_fma_f32 v[132:133], v[176:177], v[160:161], v[132:133] op_sel_hi:[0,1,1] neg_lo:[1,0,0] neg_hi:[1,0,0]
    v_pk_fma_f32 v[134:135], v[176:177], v[162:163], v[134:135] op_sel_hi:[0,1,1] neg_lo:[1,0,0] neg_hi:[1,0,0]
    v_pk_mul_f32 v[226:227], v[132:133], v[132:133]
    v_pk_mul_f32 v[228:229], v[134:135], v[134:135]
    v_pk_fma_f32 v[226:227], v[226:227], v[178:179], v[178:179] op_sel:[0,1,0] op_sel_hi:[1,1,0]
    v_pk_fma_f32 v[228:229], v[228:229], v[178:179], v[178:179] op_sel:[0,1,0] op_sel_hi:[1,1,0]
    v_pk_mul_f32 v[226:227], v[226:227], v[132:133]
    v_pk_mul_f32 v[228:229], v[228:229], v[134:135]
    v_exp_f32 v226, v226
    v_exp_f32 v227, v227
    v_exp_f32 v228, v228
    v_exp_f32 v229, v229
    v_pk_fma_f32 v[226:227], v[226:227], v[176:177], v[176:177] op_sel:[0,1,1] op_sel_hi:[1,1,1]
    v_pk_fma_f32 v[228:229], v[228:229], v[176:177], v[176:177] op_sel:[0,1,1] op_sel_hi:[1,1,1]
    v_rcp_f32 v226, v226
    v_rcp_f32 v227, v227
    v_rcp_f32 v228, v228
    v_rcp_f32 v229, v229
    v_pk_mul_f32 v[132:133], v[132:133], v[226:227]
    v_pk_mul_f32 v[134:135], v[134:135], v[228:229]
    v_cvt_pk_bf16_f32 v222, v132, v133
    v_cvt_pk_bf16_f32 v223, v134, v135
    s_add_u32 s36, s45, 688128
    buffer_store_dwordx4 v[116:119], v2, s[16:19], s36 offen sc1
    s_waitcnt lgkmcnt(0)
    s_mov_b32 s44, s46
    s_mov_b32 s45, s47
    s_branch G3_e2
G3_e1:
    v_pk_fma_f32 v[28:29], v[164:165], v[140:141], v[28:29] op_sel_hi:[0,1,1] neg_lo:[1,0,0] neg_hi:[1,0,0]
    v_pk_fma_f32 v[30:31], v[164:165], v[142:143], v[30:31] op_sel_hi:[0,1,1] neg_lo:[1,0,0] neg_hi:[1,0,0]
    v_pk_mul_f32 v[226:227], v[28:29], v[28:29]
    v_pk_mul_f32 v[228:229], v[30:31], v[30:31]
    v_pk_fma_f32 v[226:227], v[226:227], v[166:167], v[166:167] op_sel:[0,1,0] op_sel_hi:[1,1,0]
    v_pk_fma_f32 v[228:229], v[228:229], v[166:167], v[166:167] op_sel:[0,1,0] op_sel_hi:[1,1,0]
    v_pk_mul_f32 v[226:227], v[226:227], v[28:29]
    v_pk_mul_f32 v[228:229], v[228:229], v[30:31]
    v_exp_f32 v226, v226
    v_exp_f32 v227, v227
    v_exp_f32 v228, v228
    v_exp_f32 v229, v229
    v_pk_fma_f32 v[226:227], v[226:227], v[164:165], v[164:165] op_sel:[0,1,1] op_sel_hi:[1,1,1]
    v_pk_fma_f32 v[228:229], v[228:229], v[164:165], v[164:165] op_sel:[0,1,1] op_sel_hi:[1,1,1]
    v_rcp_f32 v226, v226
    v_rcp_f32 v227, v227
    v_rcp_f32 v228, v228
    v_rcp_f32 v229, v229
    v_pk_mul_f32 v[28:29], v[28:29], v[226:227]
    v_pk_mul_f32 v[30:31], v[30:31], v[228:229]
    v_pk_fma_f32 v[32:33], v[164:165], v[144:145], v[32:33] op_sel_hi:[0,1,1] neg_lo:[1,0,0] neg_hi:[1,0,0]
    v_pk_fma_f32 v[34:35], v[164:165], v[146:147], v[34:35] op_sel_hi:[0,1,1] neg_lo:[1,0,0] neg_hi:[1,0,0]
    v_pk_mul_f32 v[226:227], v[32:33], v[32:33]
    v_pk_mul_f32 v[228:229], v[34:35], v[34:35]
    v_pk_fma_f32 v[226:227], v[226:227], v[166:167], v[166:167] op_sel:[0,1,0] op_sel_hi:[1,1,0]
    v_pk_fma_f32 v[228:229], v[228:229], v[166:167], v[166:167] op_sel:[0,1,0] op_sel_hi:[1,1,0]
    v_pk_mul_f32 v[226:227], v[226:227], v[32:33]
    v_pk_mul_f32 v[228:229], v[228:229], v[34:35]
    v_exp_f32 v226, v226
    v_exp_f32 v227, v227
    v_exp_f32 v228, v228
    v_exp_f32 v229, v229
    v_pk_fma_f32 v[226:227], v[226:227], v[164:165], v[164:165] op_sel:[0,1,1] op_sel_hi:[1,1,1]
    v_pk_fma_f32 v[228:229], v[228:229], v[164:165], v[164:165] op_sel:[0,1,1] op_sel_hi:[1,1,1]
    v_rcp_f32 v226, v226
    v_rcp_f32 v227, v227
    v_rcp_f32 v228, v228
    v_rcp_f32 v229, v229
    v_pk_mul_f32 v[32:33], v[32:33], v[226:227]
    v_pk_mul_f32 v[34:35], v[34:35], v[228:229]
    v_cvt_pk_bf16_f32 v28, v28, v29
    v_cvt_pk_bf16_f32 v29, v30, v31
    v_cvt_pk_bf16_f32 v30, v32, v33
    v_cvt_pk_bf16_f32 v31, v34, v35
    v_or_b32 v28, 1, v28
    ds_write_b128 v244, v[28:31] offset:0
    s_add_u32 s36, s45, 0
    buffer_store_dwordx4 v[28:31], v2, s[16:19], s36 offen sc1
    v_pk_fma_f32 v[56:57], v[168:169], v[140:141], v[56:57] op_sel_hi:[0,1,1] neg_lo:[1,0,0] neg_hi:[1,0,0]
    v_pk_fma_f32 v[58:59], v[168:169], v[142:143], v[58:59] op_sel_hi:[0,1,1] neg_lo:[1,0,0] neg_hi:[1,0,0]
    v_pk_mul_f32 v[226:227], v[56:57], v[56:57]
    v_pk_mul_f32 v[228:229], v[58:59], v[58:59]
    v_pk_fma_f32 v[226:227], v[226:227], v[170:171], v[170:171] op_sel:[0,1,0] op_sel_hi:[1,1,0]
    v_pk_fma_f32 v[228:229], v[228:229], v[170:171], v[170:171] op_sel:[0,1,0] op_sel_hi:[1,1,0]
    v_pk_mul_f32 v[226:227], v[226:227], v[56:57]
    v_pk_mul_f32 v[228:229], v[228:229], v[58:59]
    v_exp_f32 v226, v226
    v_exp_f32 v227, v227
    v_exp_f32 v228, v228
    v_exp_f32 v229, v229
    v_pk_fma_f32 v[226:227], v[226:227], v[168:169], v[168:169] op_sel:[0,1,1] op_sel_hi:[1,1,1]
    v_pk_fma_f32 v[228:229], v[228:229], v[168:169], v[168:169] op_sel:[0,1,1] op_sel_hi:[1,1,1]
    v_rcp_f32 v226, v226
    v_rcp_f32 v227, v227
    v_rcp_f32 v228, v228
    v_rcp_f32 v229, v229
    v_pk_mul_f32 v[56:57], v[56:57], v[226:227]
    v_pk_mul_f32 v[58:59], v[58:59], v[228:229]
    v_pk_fma_f32 v[60:61], v[168:169], v[144:145], v[60:61] op_sel_hi:[0,1,1] neg_lo:[1,0,0] neg_hi:[1,0,0]
    v_pk_fma_f32 v[62:63], v[168:169], v[146:147], v[62:63] op_sel_hi:[0,1,1] neg_lo:[1,0,0] neg_hi:[1,0,0]
    v_pk_mul_f32 v[226:227], v[60:61], v[60:61]
    v_pk_mul_f32 v[228:229], v[62:63], v[62:63]
    v_pk_fma_f32 v[226:227], v[226:227], v[170:171], v[170:171] op_sel:[0,1,0] op_sel_hi:[1,1,0]
    v_pk_fma_f32 v[228:229], v[228:229], v[170:171], v[170:171] op_sel:[0,1,0] op_sel_hi:[1,1,0]
    v_pk_mul_f32 v[226:227], v[226:227], v[60:61]
    v_pk_mul_f32 v[228:229], v[228:229], v[62:63]
    v_exp_f32 v226, v226
    v_exp_f32 v227, v227
    v_exp_f32 v228, v228
    v_exp_f32 v229, v229
    v_pk_fma_f32 v[226:227], v[226:227], v[168:169], v[168:169] op_sel:[0,1,1] op_sel_hi:[1,1,1]
    v_pk_fma_f32 v[228:229], v[228:229], v[168:169], v[168:169] op_sel:[0,1,1] op_sel_hi:[1,1,1]
    v_rcp_f32 v226, v226
    v_rcp_f32 v227, v227
    v_rcp_f32 v228, v228
    v_rcp_f32 v229, v229
    v_pk_mul_f32 v[60:61], v[60:61], v[226:227]
    v_pk_mul_f32 v[62:63], v[62:63], v[228:229]
    v_cvt_pk_bf16_f32 v56, v56, v57
    v_cvt_pk_bf16_f32 v57, v58, v59
    v_cvt_pk_bf16_f32 v58, v60, v61
    v_cvt_pk_bf16_f32 v59, v62, v63
    v_or_b32 v56, 1, v56
    ds_write_b128 v244, v[56:59] offset:2048
    s_add_u32 s36, s45, 229376
    buffer_store_dwordx4 v[56:59], v2, s[16:19], s36 offen sc1
    v_pk_fma_f32 v[84:85], v[172:173], v[140:141], v[84:85] op_sel_hi:[0,1,1] neg_lo:[1,0,0] neg_hi:[1,0,0]
    v_pk_fma_f32 v[86:87], v[172:173], v[142:143], v[86:87] op_sel_hi:[0,1,1] neg_lo:[1,0,0] neg_hi:[1,0,0]
    v_pk_mul_f32 v[226:227], v[84:85], v[84:85]
    v_pk_mul_f32 v[228:229], v[86:87], v[86:87]
    v_pk_fma_f32 v[226:227], v[226:227], v[174:175], v[174:175] op_sel:[0,1,0] op_sel_hi:[1,1,0]
    v_pk_fma_f32 v[228:229], v[228:229], v[174:175], v[174:175] op_sel:[0,1,0] op_sel_hi:[1,1,0]
    v_pk_mul_f32 v[226:227], v[226:227], v[84:85]
    v_pk_mul_f32 v[228:229], v[228:229], v[86:87]
    v_exp_f32 v226, v226
    v_exp_f32 v227, v227
    v_exp_f32 v228, v228
    v_exp_f32 v229, v229
    v_pk_fma_f32 v[226:227], v[226:227], v[172:173], v[172:173] op_sel:[0,1,1] op_sel_hi:[1,1,1]
    v_pk_fma_f32 v[228:229], v[228:229], v[172:173], v[172:173] op_sel:[0,1,1] op_sel_hi:[1,1,1]
    v_rcp_f32 v226, v226
    v_rcp_f32 v227, v227
    v_rcp_f32 v228, v228
    v_rcp_f32 v229, v229
    v_pk_mul_f32 v[84:85], v[84:85], v[226:227]
    v_pk_mul_f32 v[86:87], v[86:87], v[228:229]
    v_pk_fma_f32 v[88:89], v[172:173], v[144:145], v[88:89] op_sel_hi:[0,1,1] neg_lo:[1,0,0] neg_hi:[1,0,0]
    v_pk_fma_f32 v[90:91], v[172:173], v[146:147], v[90:91] op_sel_hi:[0,1,1] neg_lo:[1,0,0] neg_hi:[1,0,0]
    v_pk_mul_f32 v[226:227], v[88:89], v[88:89]
    v_pk_mul_f32 v[228:229], v[90:91], v[90:91]
    v_pk_fma_f32 v[226:227], v[226:227], v[174:175], v[174:175] op_sel:[0,1,0] op_sel_hi:[1,1,0]
    v_pk_fma_f32 v[228:229], v[228:229], v[174:175], v[174:175] op_sel:[0,1,0] op_sel_hi:[1,1,0]
    v_pk_mul_f32 v[226:227], v[226:227], v[88:89]
    v_pk_mul_f32 v[228:229], v[228:229], v[90:91]
    v_exp_f32 v226, v226
    v_exp_f32 v227, v227
    v_exp_f32 v228, v228
    v_exp_f32 v229, v229
    v_pk_fma_f32 v[226:227], v[226:227], v[172:173], v[172:173] op_sel:[0,1,1] op_sel_hi:[1,1,1]
    v_pk_fma_f32 v[228:229], v[228:229], v[172:173], v[172:173] op_sel:[0,1,1] op_sel_hi:[1,1,1]
    v_rcp_f32 v226, v226
    v_rcp_f32 v227, v227
    v_rcp_f32 v228, v228
    v_rcp_f32 v229, v229
    v_pk_mul_f32 v[88:89], v[88:89], v[226:227]
    v_pk_mul_f32 v[90:91], v[90:91], v[228:229]
    v_cvt_pk_bf16_f32 v84, v84, v85
    v_cvt_pk_bf16_f32 v85, v86, v87
    v_cvt_pk_bf16_f32 v86, v88, v89
    v_cvt_pk_bf16_f32 v87, v90, v91
    v_or_b32 v84, 1, v84
    ds_write_b128 v244, v[84:87] offset:4096
    s_add_u32 s36, s45, 458752
    buffer_store_dwordx4 v[84:87], v2, s[16:19], s36 offen sc1
    v_pk_fma_f32 v[112:113], v[176:177], v[140:141], v[112:113] op_sel_hi:[0,1,1] neg_lo:[1,0,0] neg_hi:[1,0,0]
    v_pk_fma_f32 v[114:115], v[176:177], v[142:143], v[114:115] op_sel_hi:[0,1,1] neg_lo:[1,0,0] neg_hi:[1,0,0]
    v_pk_mul_f32 v[226:227], v[112:113], v[112:113]
    v_pk_mul_f32 v[228:229], v[114:115], v[114:115]
    v_pk_fma_f32 v[226:227], v[226:227], v[178:179], v[178:179] op_sel:[0,1,0] op_sel_hi:[1,1,0]
    v_pk_fma_f32 v[228:229], v[228:229], v[178:179], v[178:179] op_sel:[0,1,0] op_sel_hi:[1,1,0]
    v_pk_mul_f32 v[226:227], v[226:227], v[112:113]
    v_pk_mul_f32 v[228:229], v[228:229], v[114:115]
    v_exp_f32 v226, v226
    v_exp_f32 v227, v227
    v_exp_f32 v228, v228
    v_exp_f32 v229, v229
    v_pk_fma_f32 v[226:227], v[226:227], v[176:177], v[176:177] op_sel:[0,1,1] op_sel_hi:[1,1,1]
    v_pk_fma_f32 v[228:229], v[228:229], v[176:177], v[176:177] op_sel:[0,1,1] op_sel_hi:[1,1,1]
    v_rcp_f32 v226, v226
    v_rcp_f32 v227, v227
    v_rcp_f32 v228, v228
    v_rcp_f32 v229, v229
    v_pk_mul_f32 v[112:113], v[112:113], v[226:227]
    v_pk_mul_f32 v[114:115], v[114:115], v[228:229]
    v_pk_fma_f32 v[116:117], v[176:177], v[144:145], v[116:117] op_sel_hi:[0,1,1] neg_lo:[1,0,0] neg_hi:[1,0,0]
    v_pk_fma_f32 v[118:119], v[176:177], v[146:147], v[118:119] op_sel_hi:[0,1,1] neg_lo:[1,0,0] neg_hi:[1,0,0]
    v_pk_mul_f32 v[226:227], v[116:117], v[116:117]
    v_pk_mul_f32 v[228:229], v[118:119], v[118:119]
    v_pk_fma_f32 v[226:227], v[226:227], v[178:179], v[178:179] op_sel:[0,1,0] op_sel_hi:[1,1,0]
    v_pk_fma_f32 v[228:229], v[228:229], v[178:179], v[178:179] op_sel:[0,1,0] op_sel_hi:[1,1,0]
    v_pk_mul_f32 v[226:227], v[226:227], v[116:117]
    v_pk_mul_f32 v[228:229], v[228:229], v[118:119]
    v_exp_f32 v226, v226
    v_exp_f32 v227, v227
    v_exp_f32 v228, v228
    v_exp_f32 v229, v229
    v_pk_fma_f32 v[226:227], v[226:227], v[176:177], v[176:177] op_sel:[0,1,1] op_sel_hi:[1,1,1]
    v_pk_fma_f32 v[228:229], v[228:229], v[176:177], v[176:177] op_sel:[0,1,1] op_sel_hi:[1,1,1]
    v_rcp_f32 v226, v226
    v_rcp_f32 v227, v227
    v_rcp_f32 v228, v228
    v_rcp_f32 v229, v229
    v_pk_mul_f32 v[116:117], v[116:117], v[226:227]
    v_pk_mul_f32 v[118:119], v[118:119], v[228:229]
    v_cvt_pk_bf16_f32 v112, v112, v113
    v_cvt_pk_bf16_f32 v113, v114, v115
    v_cvt_pk_bf16_f32 v114, v116, v117
    v_cvt_pk_bf16_f32 v115, v118, v119
    ds_write_b128 v244, v[112:115] offset:6144
    s_add_u32 s36, s45, 688128
    buffer_store_dwordx4 v[112:115], v2, s[16:19], s36 offen sc1
    v_pk_fma_f32 v[36:37], v[164:165], v[148:149], v[36:37] op_sel_hi:[0,1,1] neg_lo:[1,0,0] neg_hi:[1,0,0]
    v_pk_fma_f32 v[38:39], v[164:165], v[150:151], v[38:39] op_sel_hi:[0,1,1] neg_lo:[1,0,0] neg_hi:[1,0,0]
    v_pk_mul_f32 v[226:227], v[36:37], v[36:37]
    v_pk_mul_f32 v[228:229], v[38:39], v[38:39]
    v_pk_fma_f32 v[226:227], v[226:227], v[166:167], v[166:167] op_sel:[0,1,0] op_sel_hi:[1,1,0]
    v_pk_fma_f32 v[228:229], v[228:229], v[166:167], v[166:167] op_sel:[0,1,0] op_sel_hi:[1,1,0]
    v_pk_mul_f32 v[226:227], v[226:227], v[36:37]
    v_pk_mul_f32 v[228:229], v[228:229], v[38:39]
    v_exp_f32 v226, v226
    v_exp_f32 v227, v227
    v_exp_f32 v228, v228
    v_exp_f32 v229, v229
    v_pk_fma_f32 v[226:227], v[226:227], v[164:165], v[164:165] op_sel:[0,1,1] op_sel_hi:[1,1,1]
    v_pk_fma_f32 v[228:229], v[228:229], v[164:165], v[164:165] op_sel:[0,1,1] op_sel_hi:[1,1,1]
    v_rcp_f32 v226, v226
    v_rcp_f32 v227, v227
    v_rcp_f32 v228, v228
    v_rcp_f32 v229, v229
    v_pk_mul_f32 v[36:37], v[36:37], v[226:227]
    v_pk_mul_f32 v[38:39], v[38:39], v[228:229]
    v_pk_fma_f32 v[40:41], v[164:165], v[152:153], v[40:41] op_sel_hi:[0,1,1] neg_lo:[1,0,0] neg_hi:[1,0,0]
    v_pk_fma_f32 v[42:43], v[164:165], v[154:155], v[42:43] op_sel_hi:[0,1,1] neg_lo:[1,0,0] neg_hi:[1,0,0]
    v_pk_mul_f32 v[226:227], v[40:41], v[40:41]
    v_pk_mul_f32 v[228:229], v[42:43], v[42:43]
    v_pk_fma_f32 v[226:227], v[226:227], v[166:167], v[166:167] op_sel:[0,1,0] op_sel_hi:[1,1,0]
    v_pk_fma_f32 v[228:229], v[228:229], v[166:167], v[166:167] op_sel:[0,1,0] op_sel_hi:[1,1,0]
    v_pk_mul_f32 v[226:227], v[226:227], v[40:41]
    v_pk_mul_f32 v[228:229], v[228:229], v[42:43]
    v_exp_f32 v226, v226
    v_exp_f32 v227, v227
    v_exp_f32 v228, v228
    v_exp_f32 v229, v229
    v_pk_fma_f32 v[226:227], v[226:227], v[164:165], v[164:165] op_sel:[0,1,1] op_sel_hi:[1,1,1]
    v_pk_fma_f32 v[228:229], v[228:229], v[164:165], v[164:165] op_sel:[0,1,1] op_sel_hi:[1,1,1]
    v_rcp_f32 v226, v226
    v_rcp_f32 v227, v227
    v_rcp_f32 v228, v228
    v_rcp_f32 v229, v229
    v_pk_mul_f32 v[40:41], v[40:41], v[226:227]
    v_pk_mul_f32 v[42:43], v[42:43], v[228:229]
    v_cvt_pk_bf16_f32 v36, v36, v37
    v_cvt_pk_bf16_f32 v37, v38, v39
    v_cvt_pk_bf16_f32 v38, v40, v41
    v_cvt_pk_bf16_f32 v39, v42, v43
    v_or_b32 v36, 1, v36
    ds_write_b128 v244, v[36:39] offset:16384
    v_pk_fma_f32 v[64:65], v[168:169], v[148:149], v[64:65] op_sel_hi:[0,1,1] neg_lo:[1,0,0] neg_hi:[1,0,0]
    v_pk_fma_f32 v[66:67], v[168:169], v[150:151], v[66:67] op_sel_hi:[0,1,1] neg_lo:[1,0,0] neg_hi:[1,0,0]
    v_pk_mul_f32 v[226:227], v[64:65], v[64:65]
    v_pk_mul_f32 v[228:229], v[66:67], v[66:67]
    v_pk_fma_f32 v[226:227], v[226:227], v[170:171], v[170:171] op_sel:[0,1,0] op_sel_hi:[1,1,0]
    v_pk_fma_f32 v[228:229], v[228:229], v[170:171], v[170:171] op_sel:[0,1,0] op_sel_hi:[1,1,0]
    v_pk_mul_f32 v[226:227], v[226:227], v[64:65]
    v_pk_mul_f32 v[228:229], v[228:229], v[66:67]
    v_exp_f32 v226, v226
    v_exp_f32 v227, v227
    v_exp_f32 v228, v228
    v_exp_f32 v229, v229
    v_pk_fma_f32 v[226:227], v[226:227], v[168:169], v[168:169] op_sel:[0,1,1] op_sel_hi:[1,1,1]
    v_pk_fma_f32 v[228:229], v[228:229], v[168:169], v[168:169] op_sel:[0,1,1] op_sel_hi:[1,1,1]
    v_rcp_f32 v226, v226
    v_rcp_f32 v227, v227
    v_rcp_f32 v228, v228
    v_rcp_f32 v229, v229
    v_pk_mul_f32 v[64:65], v[64:65], v[226:227]
    v_pk_mul_f32 v[66:67], v[66:67], v[228:229]
    v_pk_fma_f32 v[68:69], v[168:169], v[152:153], v[68:69] op_sel_hi:[0,1,1] neg_lo:[1,0,0] neg_hi:[1,0,0]
    v_pk_fma_f32 v[70:71], v[168:169], v[154:155], v[70:71] op_sel_hi:[0,1,1] neg_lo:[1,0,0] neg_hi:[1,0,0]
    v_pk_mul_f32 v[226:227], v[68:69], v[68:69]
    v_pk_mul_f32 v[228:229], v[70:71], v[70:71]
    v_pk_fma_f32 v[226:227], v[226:227], v[170:171], v[170:171] op_sel:[0,1,0] op_sel_hi:[1,1,0]
    v_pk_fma_f32 v[228:229], v[228:229], v[170:171], v[170:171] op_sel:[0,1,0] op_sel_hi:[1,1,0]
    v_pk_mul_f32 v[226:227], v[226:227], v[68:69]
    v_pk_mul_f32 v[228:229], v[228:229], v[70:71]
    v_exp_f32 v226, v226
    v_exp_f32 v227, v227
    v_exp_f32 v228, v228
    v_exp_f32 v229, v229
    v_pk_fma_f32 v[226:227], v[226:227], v[168:169], v[168:169] op_sel:[0,1,1] op_sel_hi:[1,1,1]
    v_pk_fma_f32 v[228:229], v[228:229], v[168:169], v[168:169] op_sel:[0,1,1] op_sel_hi:[1,1,1]
    v_rcp_f32 v226, v226
    v_rcp_f32 v227, v227
    v_rcp_f32 v228, v228
    v_rcp_f32 v229, v229
    v_pk_mul_f32 v[68:69], v[68:69], v[226:227]
    v_pk_mul_f32 v[70:71], v[70:71], v[228:229]
    v_cvt_pk_bf16_f32 v64, v64, v65
    v_cvt_pk_bf16_f32 v65, v66, v67
    v_cvt_pk_bf16_f32 v66, v68, v69
    v_cvt_pk_bf16_f32 v67, v70, v71
    v_or_b32 v64, 1, v64
    ds_write_b128 v244, v[64:67] offset:18432
    s_waitcnt vmcnt(0)
    s_mov_b64 exec, 1
    ds_add_u32 v246, v245
    s_mov_b64 exec, -1
    v_pk_fma_f32 v[92:93], v[172:173], v[148:149], v[92:93] op_sel_hi:[0,1,1] neg_lo:[1,0,0] neg_hi:[1,0,0]
    v_pk_fma_f32 v[94:95], v[172:173], v[150:151], v[94:95] op_sel_hi:[0,1,1] neg_lo:[1,0,0] neg_hi:[1,0,0]
    v_pk_mul_f32 v[226:227], v[92:93], v[92:93]
    v_pk_mul_f32 v[228:229], v[94:95], v[94:95]
    v_pk_fma_f32 v[226:227], v[226:227], v[174:175], v[174:175] op_sel:[0,1,0] op_sel_hi:[1,1,0]
    v_pk_fma_f32 v[228:229], v[228:229], v[174:175], v[174:175] op_sel:[0,1,0] op_sel_hi:[1,1,0]
    v_pk_mul_f32 v[226:227], v[226:227], v[92:93]
    v_pk_mul_f32 v[228:229], v[228:229], v[94:95]
    v_exp_f32 v226, v226
    v_exp_f32 v227, v227
    v_exp_f32 v228, v228
    v_exp_f32 v229, v229
    v_pk_fma_f32 v[226:227], v[226:227], v[172:173], v[172:173] op_sel:[0,1,1] op_sel_hi:[1,1,1]
    v_pk_fma_f32 v[228:229], v[228:229], v[172:173], v[172:173] op_sel:[0,1,1] op_sel_hi:[1,1,1]
    v_rcp_f32 v226, v226
    v_rcp_f32 v227, v227
    v_rcp_f32 v228, v228
    v_rcp_f32 v229, v229
    v_pk_mul_f32 v[92:93], v[92:93], v[226:227]
    v_pk_mul_f32 v[94:95], v[94:95], v[228:229]
    v_pk_fma_f32 v[96:97], v[172:173], v[152:153], v[96:97] op_sel_hi:[0,1,1] neg_lo:[1,0,0] neg_hi:[1,0,0]
    v_pk_fma_f32 v[98:99], v[172:173], v[154:155], v[98:99] op_sel_hi:[0,1,1] neg_lo:[1,0,0] neg_hi:[1,0,0]
    v_pk_mul_f32 v[226:227], v[96:97], v[96:97]
    v_pk_mul_f32 v[228:229], v[98:99], v[98:99]
    v_pk_fma_f32 v[226:227], v[226:227], v[174:175], v[174:175] op_sel:[0,1,0] op_sel_hi:[1,1,0]
    v_pk_fma_f32 v[228:229], v[228:229], v[174:175], v[174:175] op_sel:[0,1,0] op_sel_hi:[1,1,0]
    v_pk_mul_f32 v[226:227], v[226:227], v[96:97]
    v_pk_mul_f32 v[228:229], v[228:229], v[98:99]
    v_exp_f32 v226, v226
    v_exp_f32 v227, v227
    v_exp_f32 v228, v228
    v_exp_f32 v229, v229
    v_pk_fma_f32 v[226:227], v[226:227], v[172:173], v[172:173] op_sel:[0,1,1] op_sel_hi:[1,1,1]
    v_pk_fma_f32 v[228:229], v[228:229], v[172:173], v[172:173] op_sel:[0,1,1] op_sel_hi:[1,1,1]
    v_rcp_f32 v226, v226
    v_rcp_f32 v227, v227
    v_rcp_f32 v228, v228
    v_rcp_f32 v229, v229
    v_pk_mul_f32 v[96:97], v[96:97], v[226:227]
    v_pk_mul_f32 v[98:99], v[98:99], v[228:229]
    v_cvt_pk_bf16_f32 v92, v92, v93
    v_cvt_pk_bf16_f32 v93, v94, v95
    v_cvt_pk_bf16_f32 v94, v96, v97
    v_cvt_pk_bf16_f32 v95, v98, v99
    v_or_b32 v92, 1, v92
    ds_write_b128 v244, v[92:95] offset:20480
    s_cmp_eq_u32 s60, 1
    s_cbranch_scc1 G4_p11
    buffer_load_dwordx4 v[180:183], v196, s[84:87], 0 offen offset:0 sc1
    buffer_load_dwordx4 v[188:191], v196, s[88:91], 0 offen offset:0 sc1
    buffer_load_dwordx4 v[184:187], v196, s[84:87], 0 offen offset:2048 sc1
    buffer_load_dwordx4 v[192:195], v196, s[88:91], 0 offen offset:2048 sc1
    s_branch G4_p21
G4_p11:
    s_add_u32 s36, s40, 0
    buffer_load_dwordx4 v[180:183], v2, s[84:87], s36 offen offset:0 sc1
    buffer_load_dwordx4 v[184:187], v2, s[88:91], s36 offen offset:0 sc1
    buffer_load_dwordx4 v[188:191], v2, s[84:87], s36 offen offset:1024 sc1
    buffer_load_dwordx4 v[192:195], v2, s[88:91], s36 offen offset:1024 sc1
    s_add_u32 s36, s40, 65536
    buffer_load_dwordx4 v[196:199], v2, s[84:87], s36 offen offset:0 sc1
    buffer_load_dwordx4 v[230:233], v2, s[88:91], s36 offen offset:0 sc1
    buffer_load_dwordx4 v[234:237], v2, s[84:87], s36 offen offset:1024 sc1
    buffer_load_dwordx4 v[248:251], v2, s[88:91], s36 offen offset:1024 sc1
G4_p21:
    v_pk_fma_f32 v[120:121], v[176:177], v[148:149], v[120:121] op_sel_hi:[0,1,1] neg_lo:[1,0,0] neg_hi:[1,0,0]
    v_pk_fma_f32 v[122:123], v[176:177], v[150:151], v[122:123] op_sel_hi:[0,1,1] neg_lo:[1,0,0] neg_hi:[1,0,0]
    v_pk_mul_f32 v[226:227], v[120:121], v[120:121]
    v_pk_mul_f32 v[228:229], v[122:123], v[122:123]
    v_pk_fma_f32 v[226:227], v[226:227], v[178:179], v[178:179] op_sel:[0,1,0] op_sel_hi:[1,1,0]
    v_pk_fma_f32 v[228:229], v[228:229], v[178:179], v[178:179] op_sel:[0,1,0] op_sel_hi:[1,1,0]
    v_pk_mul_f32 v[226:227], v[226:227], v[120:121]
    v_pk_mul_f32 v[228:229], v[228:229], v[122:123]
    v_exp_f32 v226, v226
    v_exp_f32 v227, v227
    v_exp_f32 v228, v228
    v_exp_f32 v229, v229
    v_pk_fma_f32 v[226:227], v[226:227], v[176:177], v[176:177] op_sel:[0,1,1] op_sel_hi:[1,1,1]
    v_pk_fma_f32 v[228:229], v[228:229], v[176:177], v[176:177] op_sel:[0,1,1] op_sel_hi:[1,1,1]
    v_rcp_f32 v226, v226
    v_rcp_f32 v227, v227
    v_rcp_f32 v228, v228
    v_rcp_f32 v229, v229
    v_pk_mul_f32 v[120:121], v[120:121], v[226:227]
    v_pk_mul_f32 v[122:123], v[122:123], v[228:229]
    v_pk_fma_f32 v[124:125], v[176:177], v[152:153], v[124:125] op_sel_hi:[0,1,1] neg_lo:[1,0,0] neg_hi:[1,0,0]
    v_pk_fma_f32 v[126:127], v[176:177], v[154:155], v[126:127] op_sel_hi:[0,1,1] neg_lo:[1,0,0] neg_hi:[1,0,0]
    v_pk_mul_f32 v[226:227], v[124:125], v[124:125]
    v_pk_mul_f32 v[228:229], v[126:127], v[126:127]
    v_pk_fma_f32 v[226:227], v[226:227], v[178:179], v[178:179] op_sel:[0,1,0] op_sel_hi:[1,1,0]
    v_pk_fma_f32 v[228:229], v[228:229], v[178:179], v[178:179] op_sel:[0,1,0] op_sel_hi:[1,1,0]
    v_pk_mul_f32 v[226:227], v[226:227], v[124:125]
    v_pk_mul_f32 v[228:229], v[228:229], v[126:127]
    v_exp_f32 v226, v226
    v_exp_f32 v227, v227
    v_exp_f32 v228, v228
    v_exp_f32 v229, v229
    v_pk_fma_f32 v[226:227], v[226:227], v[176:177], v[176:177] op_sel:[0,1,1] op_sel_hi:[1,1,1]
    v_pk_fma_f32 v[228:229], v[228:229], v[176:177], v[176:177] op_sel:[0,1,1] op_sel_hi:[1,1,1]
    v_rcp_f32 v226, v226
    v_rcp_f32 v227, v227
    v_rcp_f32 v228, v228
    v_rcp_f32 v229, v229
    v_pk_mul_f32 v[124:125], v[124:125], v[226:227]
    v_pk_mul_f32 v[126:127], v[126:127], v[228:229]
    v_cvt_pk_bf16_f32 v120, v120, v121
    v_cvt_pk_bf16_f32 v121, v122, v123
    v_cvt_pk_bf16_f32 v122, v124, v125
    v_cvt_pk_bf16_f32 v123, v126, v127
    ds_write_b128 v244, v[120:123] offset:22528
    v_pk_fma_f32 v[44:45], v[164:165], v[156:157], v[44:45] op_sel_hi:[0,1,1] neg_lo:[1,0,0] neg_hi:[1,0,0]
    v_pk_fma_f32 v[46:47], v[164:165], v[158:159], v[46:47] op_sel_hi:[0,1,1] neg_lo:[1,0,0] neg_hi:[1,0,0]
    v_pk_mul_f32 v[226:227], v[44:45], v[44:45]
    v_pk_mul_f32 v[228:229], v[46:47], v[46:47]
    v_pk_fma_f32 v[226:227], v[226:227], v[166:167], v[166:167] op_sel:[0,1,0] op_sel_hi:[1,1,0]
    v_pk_fma_f32 v[228:229], v[228:229], v[166:167], v[166:167] op_sel:[0,1,0] op_sel_hi:[1,1,0]
    v_pk_mul_f32 v[226:227], v[226:227], v[44:45]
    v_pk_mul_f32 v[228:229], v[228:229], v[46:47]
    v_exp_f32 v226, v226
    v_exp_f32 v227, v227
    v_exp_f32 v228, v228
    v_exp_f32 v229, v229
    v_pk_fma_f32 v[226:227], v[226:227], v[164:165], v[164:165] op_sel:[0,1,1] op_sel_hi:[1,1,1]
    v_pk_fma_f32 v[228:229], v[228:229], v[164:165], v[164:165] op_sel:[0,1,1] op_sel_hi:[1,1,1]
    v_rcp_f32 v226, v226
    v_rcp_f32 v227, v227
    v_rcp_f32 v228, v228
    v_rcp_f32 v229, v229
    v_pk_mul_f32 v[44:45], v[44:45], v[226:227]
    v_pk_mul_f32 v[46:47], v[46:47], v[228:229]
    v_pk_fma_f32 v[48:49], v[164:165], v[160:161], v[48:49] op_sel_hi:[0,1,1] neg_lo:[1,0,0] neg_hi:[1,0,0]
    v_pk_fma_f32 v[50:51], v[164:165], v[162:163], v[50:51] op_sel_hi:[0,1,1] neg_lo:[1,0,0] neg_hi:[1,0,0]
    v_pk_mul_f32 v[226:227], v[48:49], v[48:49]
    v_pk_mul_f32 v[228:229], v[50:51], v[50:51]
    v_pk_fma_f32 v[226:227], v[226:227], v[166:167], v[166:167] op_sel:[0,1,0] op_sel_hi:[1,1,0]
    v_pk_fma_f32 v[228:229], v[228:229], v[166:167], v[166:167] op_sel:[0,1,0] op_sel_hi:[1,1,0]
    v_pk_mul_f32 v[226:227], v[226:227], v[48:49]
    v_pk_mul_f32 v[228:229], v[228:229], v[50:51]
    v_exp_f32 v226, v226
    v_exp_f32 v227, v227
    v_exp_f32 v228, v228
    v_exp_f32 v229, v229
    v_pk_fma_f32 v[226:227], v[226:227], v[164:165], v[164:165] op_sel:[0,1,1] op_sel_hi:[1,1,1]
    v_pk_fma_f32 v[228:229], v[228:229], v[164:165], v[164:165] op_sel:[0,1,1] op_sel_hi:[1,1,1]
    v_rcp_f32 v226, v226
    v_rcp_f32 v227, v227
    v_rcp_f32 v228, v228
    v_rcp_f32 v229, v229
    v_pk_mul_f32 v[48:49], v[48:49], v[226:227]
    v_pk_mul_f32 v[50:51], v[50:51], v[228:229]
    v_cvt_pk_bf16_f32 v200, v44, v45
    v_cvt_pk_bf16_f32 v201, v46, v47
    v_cvt_pk_bf16_f32 v202, v48, v49
    v_cvt_pk_bf16_f32 v203, v50, v51
    v_or_b32 v200, 1, v200
    ds_write_b128 v244, v[200:203] offset:32768
    v_pk_fma_f32 v[72:73], v[168:169], v[156:157], v[72:73] op_sel_hi:[0,1,1] neg_lo:[1,0,0] neg_hi:[1,0,0]
    v_pk_fma_f32 v[74:75], v[168:169], v[158:159], v[74:75] op_sel_hi:[0,1,1] neg_lo:[1,0,0] neg_hi:[1,0,0]
    v_pk_mul_f32 v[226:227], v[72:73], v[72:73]
    v_pk_mul_f32 v[228:229], v[74:75], v[74:75]
    v_pk_fma_f32 v[226:227], v[226:227], v[170:171], v[170:171] op_sel:[0,1,0] op_sel_hi:[1,1,0]
    v_pk_fma_f32 v[228:229], v[228:229], v[170:171], v[170:171] op_sel:[0,1,0] op_sel_hi:[1,1,0]
    v_pk_mul_f32 v[226:227], v[226:227], v[72:73]
    v_pk_mul_f32 v[228:229], v[228:229], v[74:75]
    v_exp_f32 v226, v226
    v_exp_f32 v227, v227
    v_exp_f32 v228, v228
    v_exp_f32 v229, v229
    v_pk_fma_f32 v[226:227], v[226:227], v[168:169], v[168:169] op_sel:[0,1,1] op_sel_hi:[1,1,1]
    v_pk_fma_f32 v[228:229], v[228:229], v[168:169], v[168:169] op_sel:[0,1,1] op_sel_hi:[1,1,1]
    v_rcp_f32 v226, v226
    v_rcp_f32 v227, v227
    v_rcp_f32 v228, v228
    v_rcp_f32 v229, v229
    v_pk_mul_f32 v[72:73], v[72:73], v[226:227]
    v_pk_mul_f32 v[74:75], v[74:75], v[228:229]
    v_pk_fma_f32 v[76:77], v[168:169], v[160:161], v[76:77] op_sel_hi:[0,1,1] neg_lo:[1,0,0] neg_hi:[1,0,0]
    v_pk_fma_f32 v[78:79], v[168:169], v[162:163], v[78:79] op_sel_hi:[0,1,1] neg_lo:[1,0,0] neg_hi:[1,0,0]
    v_pk_mul_f32 v[226:227], v[76:77], v[76:77]
    v_pk_mul_f32 v[228:229], v[78:79], v[78:79]
    v_pk_fma_f32 v[226:227], v[226:227], v[170:171], v[170:171] op_sel:[0,1,0] op_sel_hi:[1,1,0]
    v_pk_fma_f32 v[228:229], v[228:229], v[170:171], v[170:171] op_sel:[0,1,0] op_sel_hi:[1,1,0]
    v_pk_mul_f32 v[226:227], v[226:227], v[76:77]
    v_pk_mul_f32 v[228:229], v[228:229], v[78:79]
    v_exp_f32 v226, v226
    v_exp_f32 v227, v227
    v_exp_f32 v228, v228
    v_exp_f32 v229, v229
    v_pk_fma_f32 v[226:227], v[226:227], v[168:169], v[168:169] op_sel:[0,1,1] op_sel_hi:[1,1,1]
    v_pk_fma_f32 v[228:229], v[228:229], v[168:169], v[168:169] op_sel:[0,1,1] op_sel_hi:[1,1,1]
    v_rcp_f32 v226, v226
    v_rcp_f32 v227, v227
    v_rcp_f32 v228, v228
    v_rcp_f32 v229, v229
    v_pk_mul_f32 v[76:77], v[76:77], v[226:227]
    v_pk_mul_f32 v[78:79], v[78:79], v[228:229]
    v_cvt_pk_bf16_f32 v204, v72, v73
    v_cvt_pk_bf16_f32 v205, v74, v75
    v_cvt_pk_bf16_f32 v206, v76, v77
    v_cvt_pk_bf16_f32 v207, v78, v79
    v_or_b32 v204, 1, v204
    ds_write_b128 v244, v[204:207] offset:34816
    v_pk_fma_f32 v[100:101], v[172:173], v[156:157], v[100:101] op_sel_hi:[0,1,1] neg_lo:[1,0,0] neg_hi:[1,0,0]
    v_pk_fma_f32 v[102:103], v[172:173], v[158:159], v[102:103] op_sel_hi:[0,1,1] neg_lo:[1,0,0] neg_hi:[1,0,0]
    v_pk_mul_f32 v[226:227], v[100:101], v[100:101]
    v_pk_mul_f32 v[228:229], v[102:103], v[102:103]
    v_pk_fma_f32 v[226:227], v[226:227], v[174:175], v[174:175] op_sel:[0,1,0] op_sel_hi:[1,1,0]
    v_pk_fma_f32 v[228:229], v[228:229], v[174:175], v[174:175] op_sel:[0,1,0] op_sel_hi:[1,1,0]
    v_pk_mul_f32 v[226:227], v[226:227], v[100:101]
    v_pk_mul_f32 v[228:229], v[228:229], v[102:103]
    v_exp_f32 v226, v226
    v_exp_f32 v227, v227
    v_exp_f32 v228, v228
    v_exp_f32 v229, v229
    v_pk_fma_f32 v[226:227], v[226:227], v[172:173], v[172:173] op_sel:[0,1,1] op_sel_hi:[1,1,1]
    v_pk_fma_f32 v[228:229], v[228:229], v[172:173], v[172:173] op_sel:[0,1,1] op_sel_hi:[1,1,1]
    v_rcp_f32 v226, v226
    v_rcp_f32 v227, v227
    v_rcp_f32 v228, v228
    v_rcp_f32 v229, v229
    v_pk_mul_f32 v[100:101], v[100:101], v[226:227]
    v_pk_mul_f32 v[102:103], v[102:103], v[228:229]
    v_pk_fma_f32 v[104:105], v[172:173], v[160:161], v[104:105] op_sel_hi:[0,1,1] neg_lo:[1,0,0] neg_hi:[1,0,0]
    v_pk_fma_f32 v[106:107], v[172:173], v[162:163], v[106:107] op_sel_hi:[0,1,1] neg_lo:[1,0,0] neg_hi:[1,0,0]
    v_pk_mul_f32 v[226:227], v[104:105], v[104:105]
    v_pk_mul_f32 v[228:229], v[106:107], v[106:107]
    v_pk_fma_f32 v[226:227], v[226:227], v[174:175], v[174:175] op_sel:[0,1,0] op_sel_hi:[1,1,0]
    v_pk_fma_f32 v[228:229], v[228:229], v[174:175], v[174:175] op_sel:[0,1,0] op_sel_hi:[1,1,0]
    v_pk_mul_f32 v[226:227], v[226:227], v[104:105]
    v_pk_mul_f32 v[228:229], v[228:229], v[106:107]
    v_exp_f32 v226, v226
    v_exp_f32 v227, v227
    v_exp_f32 v228, v228
    v_exp_f32 v229, v229
    v_pk_fma_f32 v[226:227], v[226:227], v[172:173], v[172:173] op_sel:[0,1,1] op_sel_hi:[1,1,1]
    v_pk_fma_f32 v[228:229], v[228:229], v[172:173], v[172:173] op_sel:[0,1,1] op_sel_hi:[1,1,1]
    v_rcp_f32 v226, v226
    v_rcp_f32 v227, v227
    v_rcp_f32 v228, v228
    v_rcp_f32 v229, v229
    v_pk_mul_f32 v[104:105], v[104:105], v[226:227]
    v_pk_mul_f32 v[106:107], v[106:107], v[228:229]
    v_cvt_pk_bf16_f32 v208, v100, v101
    v_cvt_pk_bf16_f32 v209, v102, v103
    v_cvt_pk_bf16_f32 v210, v104, v105
    v_cvt_pk_bf16_f32 v211, v106, v107
    v_or_b32 v208, 1, v208
    ds_write_b128 v244, v[208:211] offset:36864
    v_pk_fma_f32 v[128:129], v[176:177], v[156:157], v[128:129] op_sel_hi:[0,1,1] neg_lo:[1,0,0] neg_hi:[1,0,0]
    v_pk_fma_f32 v[130:131], v[176:177], v[158:159], v[130:131] op_sel_hi:[0,1,1] neg_lo:[1,0,0] neg_hi:[1,0,0]
    v_pk_mul_f32 v[226:227], v[128:129], v[128:129]
    v_pk_mul_f32 v[228:229], v[130:131], v[130:131]
    v_pk_fma_f32 v[226:227], v[226:227], v[178:179], v[178:179] op_sel:[0,1,0] op_sel_hi:[1,1,0]
    v_pk_fma_f32 v[228:229], v[228:229], v[178:179], v[178:179] op_sel:[0,1,0] op_sel_hi:[1,1,0]
    v_pk_mul_f32 v[226:227], v[226:227], v[128:129]
    v_pk_mul_f32 v[228:229], v[228:229], v[130:131]
    v_exp_f32 v226, v226
    v_exp_f32 v227, v227
    v_exp_f32 v228, v228
    v_exp_f32 v229, v229
    v_pk_fma_f32 v[226:227], v[226:227], v[176:177], v[176:177] op_sel:[0,1,1] op_sel_hi:[1,1,1]
    v_pk_fma_f32 v[228:229], v[228:229], v[176:177], v[176:177] op_sel:[0,1,1] op_sel_hi:[1,1,1]
    v_rcp_f32 v226, v226
    v_rcp_f32 v227, v227
    v_rcp_f32 v228, v228
    v_rcp_f32 v229, v229
    v_pk_mul_f32 v[128:129], v[128:129], v[226:227]
    v_pk_mul_f32 v[130:131], v[130:131], v[228:229]
    v_pk_fma_f32 v[132:133], v[176:177], v[160:161], v[132:133] op_sel_hi:[0,1,1] neg_lo:[1,0,0] neg_hi:[1,0,0]
    v_pk_fma_f32 v[134:135], v[176:177], v[162:163], v[134:135] op_sel_hi:[0,1,1] neg_lo:[1,0,0] neg_hi:[1,0,0]
    v_pk_mul_f32 v[226:227], v[132:133], v[132:133]
    v_pk_mul_f32 v[228:229], v[134:135], v[134:135]
    v_pk_fma_f32 v[226:227], v[226:227], v[178:179], v[178:179] op_sel:[0,1,0] op_sel_hi:[1,1,0]
    v_pk_fma_f32 v[228:229], v[228:229], v[178:179], v[178:179] op_sel:[0,1,0] op_sel_hi:[1,1,0]
    v_pk_mul_f32 v[226:227], v[226:227], v[132:133]
    v_pk_mul_f32 v[228:229], v[228:229], v[134:135]
    v_exp_f32 v226, v226
    v_exp_f32 v227, v227
    v_exp_f32 v228, v228
    v_exp_f32 v229, v229
    v_pk_fma_f32 v[226:227], v[226:227], v[176:177], v[176:177] op_sel:[0,1,1] op_sel_hi:[1,1,1]
    v_pk_fma_f32 v[228:229], v[228:229], v[176:177], v[176:177] op_sel:[0,1,1] op_sel_hi:[1,1,1]
    v_rcp_f32 v226, v226
    v_rcp_f32 v227, v227
    v_rcp_f32 v228, v228
    v_rcp_f32 v229, v229
    v_pk_mul_f32 v[132:133], v[132:133], v[226:227]
    v_pk_mul_f32 v[134:135], v[134:135], v[228:229]
    v_cvt_pk_bf16_f32 v212, v128, v129
    v_cvt_pk_bf16_f32 v213, v130, v131
    v_cvt_pk_bf16_f32 v214, v132, v133
    v_cvt_pk_bf16_f32 v215, v134, v135
    ds_write_b128 v244, v[212:215] offset:38912
    v_pk_fma_f32 v[24:25], v[164:165], v[136:137], v[24:25] op_sel_hi:[0,1,1] neg_lo:[1,0,0] neg_hi:[1,0,0]
    v_pk_fma_f32 v[26:27], v[164:165], v[138:139], v[26:27] op_sel_hi:[0,1,1] neg_lo:[1,0,0] neg_hi:[1,0,0]
    v_pk_mul_f32 v[226:227], v[24:25], v[24:25]
    v_pk_mul_f32 v[228:229], v[26:27], v[26:27]
    v_pk_fma_f32 v[226:227], v[226:227], v[166:167], v[166:167] op_sel:[0,1,0] op_sel_hi:[1,1,0]
    v_pk_fma_f32 v[228:229], v[228:229], v[166:167], v[166:167] op_sel:[0,1,0] op_sel_hi:[1,1,0]
    v_pk_mul_f32 v[226:227], v[226:227], v[24:25]
    v_pk_mul_f32 v[228:229], v[228:229], v[26:27]
    v_exp_f32 v226, v226
    v_exp_f32 v227, v227
    v_exp_f32 v228, v228
    v_exp_f32 v229, v229
    v_pk_fma_f32 v[226:227], v[226:227], v[164:165], v[164:165] op_sel:[0,1,1] op_sel_hi:[1,1,1]
    v_pk_fma_f32 v[228:229], v[228:229], v[164:165], v[164:165] op_sel:[0,1,1] op_sel_hi:[1,1,1]
    v_rcp_f32 v226, v226
    v_rcp_f32 v227, v227
    v_rcp_f32 v228, v228
    v_rcp_f32 v229, v229
    v_pk_mul_f32 v[24:25], v[24:25], v[226:227]
    v_pk_mul_f32 v[26:27], v[26:27], v[228:229]
    v_cvt_pk_bf16_f32 v216, v24, v25
    v_cvt_pk_bf16_f32 v217, v26, v27
    v_or_b32 v216, 1, v216
    s_add_u32 s36, s46, 0
    buffer_store_dwordx4 v[36:39], v2, s[16:19], s36 offen sc1
    v_pk_fma_f32 v[52:53], v[168:169], v[136:137], v[52:53] op_sel_hi:[0,1,1] neg_lo:[1,0,0] neg_hi:[1,0,0]
    v_pk_fma_f32 v[54:55], v[168:169], v[138:139], v[54:55] op_sel_hi:[0,1,1] neg_lo:[1,0,0] neg_hi:[1,0,0]
    v_pk_mul_f32 v[226:227], v[52:53], v[52:53]
    v_pk_mul_f32 v[228:229], v[54:55], v[54:55]
    v_pk_fma_f32 v[226:227], v[226:227], v[170:171], v[170:171] op_sel:[0,1,0] op_sel_hi:[1,1,0]
    v_pk_fma_f32 v[228:229], v[228:229], v[170:171], v[170:171] op_sel:[0,1,0] op_sel_hi:[1,1,0]
    v_pk_mul_f32 v[226:227], v[226:227], v[52:53]
    v_pk_mul_f32 v[228:229], v[228:229], v[54:55]
    v_exp_f32 v226, v226
    v_exp_f32 v227, v227
    v_exp_f32 v228, v228
    v_exp_f32 v229, v229
    v_pk_fma_f32 v[226:227], v[226:227], v[168:169], v[168:169] op_sel:[0,1,1] op_sel_hi:[1,1,1]
    v_pk_fma_f32 v[228:229], v[228:229], v[168:169], v[168:169] op_sel:[0,1,1] op_sel_hi:[1,1,1]
    v_rcp_f32 v226, v226
    v_rcp_f32 v227, v227
    v_rcp_f32 v228, v228
    v_rcp_f32 v229, v229
    v_pk_mul_f32 v[52:53], v[52:53], v[226:227]
    v_pk_mul_f32 v[54:55], v[54:55], v[228:229]
    v_cvt_pk_bf16_f32 v218, v52, v53
    v_cvt_pk_bf16_f32 v219, v54, v55
    v_or_b32 v218, 1, v218
    s_add_u32 s36, s46, 229376
    buffer_store_dwordx4 v[64:67], v2, s[16:19], s36 offen sc1
    v_pk_fma_f32 v[80:81], v[172:173], v[136:137], v[80:81] op_sel_hi:[0,1,1] neg_lo:[1,0,0] neg_hi:[1,0,0]
    v_pk_fma_f32 v[82:83], v[172:173], v[138:139], v[82:83] op_sel_hi:[0,1,1] neg_lo:[1,0,0] neg_hi:[1,0,0]
    v_pk_mul_f32 v[226:227], v[80:81], v[80:81]
    v_pk_mul_f32 v[228:229], v[82:83], v[82:83]
    v_pk_fma_f32 v[226:227], v[226:227], v[174:175], v[174:175] op_sel:[0,1,0] op_sel_hi:[1,1,0]
    v_pk_fma_f32 v[228:229], v[228:229], v[174:175], v[174:175] op_sel:[0,1,0] op_sel_hi:[1,1,0]
    v_pk_mul_f32 v[226:227], v[226:227], v[80:81]
    v_pk_mul_f32 v[228:229], v[228:229], v[82:83]
    v_exp_f32 v226, v226
    v_exp_f32 v227, v227
    v_exp_f32 v228, v228
    v_exp_f32 v229, v229
    v_pk_fma_f32 v[226:227], v[226:227], v[172:173], v[172:173] op_sel:[0,1,1] op_sel_hi:[1,1,1]
    v_pk_fma_f32 v[228:229], v[228:229], v[172:173], v[172:173] op_sel:[0,1,1] op_sel_hi:[1,1,1]
    v_rcp_f32 v226, v226
    v_rcp_f32 v227, v227
    v_rcp_f32 v228, v228
    v_rcp_f32 v229, v229
    v_pk_mul_f32 v[80:81], v[80:81], v[226:227]
    v_pk_mul_f32 v[82:83], v[82:83], v[228:229]
    v_cvt_pk_bf16_f32 v220, v80, v81
    v_cvt_pk_bf16_f32 v221, v82, v83
    v_or_b32 v220, 1, v220
    s_add_u32 s36, s46, 458752
    buffer_store_dwordx4 v[92:95], v2, s[16:19], s36 offen sc1
    v_pk_fma_f32 v[108:109], v[176:177], v[136:137], v[108:109] op_sel_hi:[0,1,1] neg_lo:[1,0,0] neg_hi:[1,0,0]
    v_pk_fma_f32 v[110:111], v[176:177], v[138:139], v[110:111] op_sel_hi:[0,1,1] neg_lo:[1,0,0] neg_hi:[1,0,0]
    v_pk_mul_f32 v[226:227], v[108:109], v[108:109]
    v_pk_mul_f32 v[228:229], v[110:111], v[110:111]
    v_pk_fma_f32 v[226:227], v[226:227], v[178:179], v[178:179] op_sel:[0,1,0] op_sel_hi:[1,1,0]
    v_pk_fma_f32 v[228:229], v[228:229], v[178:179], v[178:179] op_sel:[0,1,0] op_sel_hi:[1,1,0]
    v_pk_mul_f32 v[226:227], v[226:227], v[108:109]
    v_pk_mul_f32 v[228:229], v[228:229], v[110:111]
    v_exp_f32 v226, v226
    v_exp_f32 v227, v227
    v_exp_f32 v228, v228
    v_exp_f32 v229, v229
    v_pk_fma_f32 v[226:227], v[226:227], v[176:177], v[176:177] op_sel:[0,1,1] op_sel_hi:[1,1,1]
    v_pk_fma_f32 v[228:229], v[228:229], v[176:177], v[176:177] op_sel:[0,1,1] op_sel_hi:[1,1,1]
    v_rcp_f32 v226, v226
    v_rcp_f32 v227, v227
    v_rcp_f32 v228, v228
    v_rcp_f32 v229, v229
    v_pk_mul_f32 v[108:109], v[108:109], v[226:227]
    v_pk_mul_f32 v[110:111], v[110:111], v[228:229]
    v_cvt_pk_bf16_f32 v222, v108, v109
    v_cvt_pk_bf16_f32 v223, v110, v111
    s_add_u32 s36, s46, 688128
    buffer_store_dwordx4 v[120:123], v2, s[16:19], s36 offen sc1
    s_waitcnt lgkmcnt(0)
    s_add_u32 s45, s44, 512
    s_mov_b32 s44, s47
G3_e2:
    s_waitcnt lgkmcnt(0)
    s_barrier
    ds_read_b128 v[88:91], v17 offset:0
    ds_read_b128 v[92:95], v17 offset:2048
    ds_read_b128 v[96:99], v17 offset:4096
    ds_read_b128 v[100:103], v17 offset:6144
    ds_read_b64_tr_b16 v[104:105], v18 offset:0
    ds_read_b64_tr_b16 v[106:107], v18 offset:4096
    ds_read_b64_tr_b16 v[108:109], v19 offset:0
    ds_read_b64_tr_b16 v[110:111], v19 offset:4096
    ds_read_b64_tr_b16 v[112:113], v20 offset:0
    ds_read_b64_tr_b16 v[114:115], v20 offset:4096
    ds_read_b64_tr_b16 v[116:117], v21 offset:0
    ds_read_b64_tr_b16 v[118:119], v21 offset:4096
    s_waitcnt lgkmcnt(6)
    v_mfma_f32_16x16x32_bf16 v[24:27], v[104:107], v[88:91], 0
    ds_read_b128 v[120:123], v17 offset:1024
    s_add_u32 s42, s42, 16384
    v_mfma_f32_16x16x32_bf16 v[40:43], v[104:107], v[92:95], 0
    ds_read_b128 v[124:127], v17 offset:3072
    s_cmp_eq_u32 s42, 49152
    v_mfma_f32_16x16x32_bf16 v[56:59], v[104:107], v[96:99], 0
    ds_read_b128 v[128:131], v17 offset:5120
    s_cselect_b32 s42, 0, s42
    v_mfma_f32_16x16x32_bf16 v[72:75], v[104:107], v[100:103], 0
    ds_read_b128 v[132:135], v17 offset:7168
    s_waitcnt lgkmcnt(8)
    v_mfma_f32_16x16x32_bf16 v[76:79], v[108:111], v[100:103], 0
    ds_read_b64_tr_b16 v[136:137], v18 offset:8192
    s_add_u32 s48, s48, 16384
    v_mfma_f32_16x16x32_bf16 v[60:63], v[108:111], v[96:99], 0
    ds_read_b64_tr_b16 v[138:139], v18 offset:12288
    s_cmp_eq_u32 s48, 98304
    v_mfma_f32_16x16x32_bf16 v[44:47], v[108:111], v[92:95], 0
    ds_read_b64_tr_b16 v[140:141], v19 offset:8192
    s_cselect_b32 s48, 0, s48
    v_mfma_f32_16x16x32_bf16 v[28:31], v[108:111], v[88:91], 0
    ds_read_b64_tr_b16 v[142:143], v19 offset:12288
    s_waitcnt lgkmcnt(8)
    v_mfma_f32_16x16x32_bf16 v[32:35], v[112:115], v[88:91], 0
    ds_read_b64_tr_b16 v[144:145], v20 offset:8192
    v_add_u32 v17, s42, v12
    v_mfma_f32_16x16x32_bf16 v[48:51], v[112:115], v[92:95], 0
    ds_read_b64_tr_b16 v[146:147], v20 offset:12288
    s_add_u32 s36, s44, 0
    v_mfma_f32_16x16x32_bf16 v[64:67], v[112:115], v[96:99], 0
    ds_read_b64_tr_b16 v[148:149], v21 offset:8192
    buffer_store_dwordx4 v[200:203], v2, s[16:19], s36 offen sc1
    v_mfma_f32_16x16x32_bf16 v[80:83], v[112:115], v[100:103], 0
    ds_read_b64_tr_b16 v[150:151], v21 offset:12288
    s_add_u32 s36, s45, 0
    v_mfma_f32_16x16x32_bf16 v[84:87], v[116:119], v[100:103], 0
    buffer_store_dwordx2 v[216:217], v238, s[16:19], s36 offen sc1
    v_add_u32 v18, s48, v13
    v_mfma_f32_16x16x32_bf16 v[68:71], v[116:119], v[96:99], 0
    v_add_u32 v19, s48, v14
    v_mfma_f32_16x16x32_bf16 v[52:55], v[116:119], v[92:95], 0
    v_add_u32 v20, s48, v15
    v_mfma_f32_16x16x32_bf16 v[36:39], v[116:119], v[88:91], 0
    v_add_u32 v21, s48, v16
    s_waitcnt lgkmcnt(6)
    v_mfma_f32_16x16x32_bf16 v[24:27], v[136:139], v[120:123], v[24:27]
    v_mfma_f32_16x16x32_bf16 v[40:43], v[136:139], v[124:127], v[40:43]
    v_mfma_f32_16x16x32_bf16 v[56:59], v[136:139], v[128:131], v[56:59]
    s_waitcnt lgkmcnt(0)
    s_barrier
    v_mfma_f32_16x16x32_bf16 v[72:75], v[136:139], v[132:135], v[72:75]
    ds_read_b128 v[88:91], v17 offset:0
    s_add_u32 s36, s44, 229376
    v_mfma_f32_16x16x32_bf16 v[76:79], v[140:143], v[132:135], v[76:79]
    ds_read_b128 v[92:95], v17 offset:2048
    buffer_store_dwordx4 v[204:207], v2, s[16:19], s36 offen sc1
    v_mfma_f32_16x16x32_bf16 v[60:63], v[140:143], v[128:131], v[60:63]
    ds_read_b128 v[96:99], v17 offset:4096
    s_add_u32 s36, s45, 229376
    v_mfma_f32_16x16x32_bf16 v[44:47], v[140:143], v[124:127], v[44:47]
    ds_read_b128 v[100:103], v17 offset:6144
    buffer_store_dwordx2 v[218:219], v238, s[16:19], s36 offen sc1
    v_mfma_f32_16x16x32_bf16 v[28:31], v[140:143], v[120:123], v[28:31]
    ds_read_b64_tr_b16 v[104:105], v18 offset:0
    s_add_u32 s43, s43, 1
    v_mfma_f32_16x16x32_bf16 v[32:35], v[144:147], v[120:123], v[32:35]
    ds_read_b64_tr_b16 v[106:107], v18 offset:4096
    s_cmp_lt_u32 s43, 27
    v_mfma_f32_16x16x32_bf16 v[48:51], v[144:147], v[124:127], v[48:51]
    ds_read_b64_tr_b16 v[108:109], v19 offset:0
    v_mfma_f32_16x16x32_bf16 v[64:67], v[144:147], v[128:131], v[64:67]
    ds_read_b64_tr_b16 v[110:111], v19 offset:4096
    v_mfma_f32_16x16x32_bf16 v[80:83], v[144:147], v[132:135], v[80:83]
    ds_read_b64_tr_b16 v[112:113], v20 offset:0
    v_mfma_f32_16x16x32_bf16 v[84:87], v[148:151], v[132:135], v[84:87]
    ds_read_b64_tr_b16 v[114:115], v20 offset:4096
    v_mfma_f32_16x16x32_bf16 v[68:71], v[148:151], v[128:131], v[68:71]
    ds_read_b64_tr_b16 v[116:117], v21 offset:0
    v_mfma_f32_16x16x32_bf16 v[52:55], v[148:151], v[124:127], v[52:55]
    ds_read_b64_tr_b16 v[118:119], v21 offset:4096
    v_mfma_f32_16x16x32_bf16 v[36:39], v[148:151], v[120:123], v[36:39]
    s_waitcnt lgkmcnt(6)
    v_mfma_f32_16x16x32_bf16 v[24:27], v[104:107], v[88:91], v[24:27]
    ds_read_b128 v[120:123], v17 offset:1024
    s_add_u32 s42, s42, 16384
    v_mfma_f32_16x16x32_bf16 v[40:43], v[104:107], v[92:95], v[40:43]
    ds_read_b128 v[124:127], v17 offset:3072
    s_cmp_eq_u32 s42, 49152
    v_mfma_f32_16x16x32_bf16 v[56:59], v[104:107], v[96:99], v[56:59]
    ds_read_b128 v[128:131], v17 offset:5120
    s_cselect_b32 s42, 0, s42
    v_mfma_f32_16x16x32_bf16 v[72:75], v[104:107], v[100:103], v[72:75]
    ds_read_b128 v[132:135], v17 offset:7168
    s_waitcnt lgkmcnt(8)
    v_mfma_f32_16x16x32_bf16 v[76:79], v[108:111], v[100:103], v[76:79]
    ds_read_b64_tr_b16 v[136:137], v18 offset:8192
    s_add_u32 s48, s48, 16384
    v_mfma_f32_16x16x32_bf16 v[60:63], v[108:111], v[96:99], v[60:63]
    ds_read_b64_tr_b16 v[138:139], v18 offset:12288
    s_cmp_eq_u32 s48, 98304
    v_mfma_f32_16x16x32_bf16 v[44:47], v[108:111], v[92:95], v[44:47]
    ds_read_b64_tr_b16 v[140:141], v19 offset:8192
    s_cselect_b32 s48, 0, s48
    v_mfma_f32_16x16x32_bf16 v[28:31], v[108:111], v[88:91], v[28:31]
    ds_read_b64_tr_b16 v[142:143], v19 offset:12288
    s_waitcnt lgkmcnt(8)
    v_mfma_f32_16x16x32_bf16 v[32:35], v[112:115], v[88:91], v[32:35]
    ds_read_b64_tr_b16 v[144:145], v20 offset:8192
    v_add_u32 v17, s42, v12
    v_mfma_f32_16x16x32_bf16 v[48:51], v[112:115], v[92:95], v[48:51]
    ds_read_b64_tr_b16 v[146:147], v20 offset:12288
    s_add_u32 s36, s44, 458752
    v_mfma_f32_16x16x32_bf16 v[64:67], v[112:115], v[96:99], v[64:67]
    ds_read_b64_tr_b16 v[148:149], v21 offset:8192
    buffer_store_dwordx4 v[208:211], v2, s[16:19], s36 offen sc1
    v_mfma_f32_16x16x32_bf16 v[80:83], v[112:115], v[100:103], v[80:83]
    ds_read_b64_tr_b16 v[150:151], v21 offset:12288
    s_add_u32 s36, s45, 458752
    v_mfma_f32_16x16x32_bf16 v[84:87], v[116:119], v[100:103], v[84:87]
    buffer_store_dwordx2 v[220:221], v238, s[16:19], s36 offen sc1
    v_add_u32 v18, s48, v13
    v_mfma_f32_16x16x32_bf16 v[68:71], v[116:119], v[96:99], v[68:71]
    v_add_u32 v19, s48, v14
    v_mfma_f32_16x16x32_bf16 v[52:55], v[116:119], v[92:95], v[52:55]
    v_add_u32 v20, s48, v15
    v_mfma_f32_16x16x32_bf16 v[36:39], v[116:119], v[88:91], v[36:39]
    v_add_u32 v21, s48, v16
    s_waitcnt lgkmcnt(6)
    v_mfma_f32_16x16x32_bf16 v[24:27], v[136:139], v[120:123], v[24:27]
    v_mfma_f32_16x16x32_bf16 v[40:43], v[136:139], v[124:127], v[40:43]
    s_waitcnt vmcnt(6)
    v_mfma_f32_16x16x32_bf16 v[56:59], v[136:139], v[128:131], v[56:59]
    s_waitcnt lgkmcnt(0)
    s_barrier
    v_mfma_f32_16x16x32_bf16 v[72:75], v[136:139], v[132:135], v[72:75]
    ds_read_b128 v[88:91], v17 offset:0
    s_add_u32 s36, s44, 688128
    v_mfma_f32_16x16x32_bf16 v[76:79], v[140:143], v[132:135], v[76:79]
    ds_read_b128 v[92:95], v17 offset:2048
    buffer_store_dwordx4 v[212:215], v2, s[16:19], s36 offen sc1
    v_mfma_f32_16x16x32_bf16 v[60:63], v[140:143], v[128:131], v[60:63]
    ds_read_b128 v[96:99], v17 offset:4096
    s_add_u32 s36, s45, 688128
    v_mfma_f32_16x16x32_bf16 v[44:47], v[140:143], v[124:127], v[44:47]
    ds_read_b128 v[100:103], v17 offset:6144
    buffer_store_dwordx2 v[222:223], v238, s[16:19], s36 offen sc1
    v_mfma_f32_16x16x32_bf16 v[28:31], v[140:143], v[120:123], v[28:31]
    ds_read_b64_tr_b16 v[104:105], v18 offset:0
    s_add_u32 s43, s43, 1
    v_mfma_f32_16x16x32_bf16 v[32:35], v[144:147], v[120:123], v[32:35]
    ds_read_b64_tr_b16 v[106:107], v18 offset:4096
    s_cmp_lt_u32 s43, 27
    v_mfma_f32_16x16x32_bf16 v[48:51], v[144:147], v[124:127], v[48:51]
    ds_read_b64_tr_b16 v[108:109], v19 offset:0
    v_mfma_f32_16x16x32_bf16 v[64:67], v[144:147], v[128:131], v[64:67]
    ds_read_b64_tr_b16 v[110:111], v19 offset:4096
    v_mfma_f32_16x16x32_bf16 v[80:83], v[144:147], v[132:135], v[80:83]
    ds_read_b64_tr_b16 v[112:113], v20 offset:0
    v_mfma_f32_16x16x32_bf16 v[84:87], v[148:151], v[132:135], v[84:87]
    ds_read_b64_tr_b16 v[114:115], v20 offset:4096
    v_mfma_f32_16x16x32_bf16 v[68:71], v[148:151], v[128:131], v[68:71]
    ds_read_b64_tr_b16 v[116:117], v21 offset:0
    v_mfma_f32_16x16x32_bf16 v[52:55], v[148:151], v[124:127], v[52:55]
    ds_read_b64_tr_b16 v[118:119], v21 offset:4096
    v_mfma_f32_16x16x32_bf16 v[36:39], v[148:151], v[120:123], v[36:39]
    s_waitcnt lgkmcnt(6)
mm_27:
    v_mfma_f32_16x16x32_bf16 v[24:27], v[104:107], v[88:91], v[24:27]
    ds_read_b128 v[120:123], v17 offset:1024
    s_add_u32 s42, s42, 16384
    v_mfma_f32_16x16x32_bf16 v[40:43], v[104:107], v[92:95], v[40:43]
    ds_read_b128 v[124:127], v17 offset:3072
    s_cmp_eq_u32 s42, 49152
    v_mfma_f32_16x16x32_bf16 v[56:59], v[104:107], v[96:99], v[56:59]
    ds_read_b128 v[128:131], v17 offset:5120
    s_cselect_b32 s42, 0, s42
    v_mfma_f32_16x16x32_bf16 v[72:75], v[104:107], v[100:103], v[72:75]
    ds_read_b128 v[132:135], v17 offset:7168
    s_waitcnt lgkmcnt(8)
    v_mfma_f32_16x16x32_bf16 v[76:79], v[108:111], v[100:103], v[76:79]
    ds_read_b64_tr_b16 v[136:137], v18 offset:8192
    s_add_u32 s48, s48, 16384
    v_mfma_f32_16x16x32_bf16 v[60:63], v[108:111], v[96:99], v[60:63]
    ds_read_b64_tr_b16 v[138:139], v18 offset:12288
    s_cmp_eq_u32 s48, 98304
    v_mfma_f32_16x16x32_bf16 v[44:47], v[108:111], v[92:95], v[44:47]
    ds_read_b64_tr_b16 v[140:141], v19 offset:8192
    s_cselect_b32 s48, 0, s48
    v_mfma_f32_16x16x32_bf16 v[28:31], v[108:111], v[88:91], v[28:31]
    ds_read_b64_tr_b16 v[142:143], v19 offset:12288
    s_waitcnt lgkmcnt(8)
    v_mfma_f32_16x16x32_bf16 v[32:35], v[112:115], v[88:91], v[32:35]
    ds_read_b64_tr_b16 v[144:145], v20 offset:8192
    v_add_u32 v17, s42, v12
    v_mfma_f32_16x16x32_bf16 v[48:51], v[112:115], v[92:95], v[48:51]
    ds_read_b64_tr_b16 v[146:147], v20 offset:12288
    v_add_u32 v18, s48, v13
    v_mfma_f32_16x16x32_bf16 v[64:67], v[112:115], v[96:99], v[64:67]
    ds_read_b64_tr_b16 v[148:149], v21 offset:8192
    v_add_u32 v19, s48, v14
    v_mfma_f32_16x16x32_bf16 v[80:83], v[112:115], v[100:103], v[80:83]
    ds_read_b64_tr_b16 v[150:151], v21 offset:12288
    v_add_u32 v20, s48, v15
    v_mfma_f32_16x16x32_bf16 v[84:87], v[116:119], v[100:103], v[84:87]
    v_add_u32 v21, s48, v16
    v_mfma_f32_16x16x32_bf16 v[68:71], v[116:119], v[96:99], v[68:71]
    v_mfma_f32_16x16x32_bf16 v[52:55], v[116:119], v[92:95], v[52:55]
    v_mfma_f32_16x16x32_bf16 v[36:39], v[116:119], v[88:91], v[36:39]
    s_waitcnt lgkmcnt(6)
    v_mfma_f32_16x16x32_bf16 v[24:27], v[136:139], v[120:123], v[24:27]
    s_add_u32 s43, s43, 1
    s_cmp_lt_u32 s43, 4
    v_mfma_f32_16x16x32_bf16 v[40:43], v[136:139], v[124:127], v[40:43]
    v_mfma_f32_16x16x32_bf16 v[56:59], v[136:139], v[128:131], v[56:59]
    s_waitcnt lgkmcnt(0)
    s_barrier
    v_mfma_f32_16x16x32_bf16 v[72:75], v[136:139], v[132:135], v[72:75]
    ds_read_b128 v[88:91], v17 offset:0
    v_mfma_f32_16x16x32_bf16 v[76:79], v[140:143], v[132:135], v[76:79]
    ds_read_b128 v[92:95], v17 offset:2048
    v_mfma_f32_16x16x32_bf16 v[60:63], v[140:143], v[128:131], v[60:63]
    ds_read_b128 v[96:99], v17 offset:4096
    v_mfma_f32_16x16x32_bf16 v[44:47], v[140:143], v[124:127], v[44:47]
    ds_read_b128 v[100:103], v17 offset:6144
    v_mfma_f32_16x16x32_bf16 v[28:31], v[140:143], v[120:123], v[28:31]
    ds_read_b64_tr_b16 v[104:105], v18 offset:0
    v_mfma_f32_16x16x32_bf16 v[32:35], v[144:147], v[120:123], v[32:35]
    ds_read_b64_tr_b16 v[106:107], v18 offset:4096
    v_mfma_f32_16x16x32_bf16 v[48:51], v[144:147], v[124:127], v[48:51]
    ds_read_b64_tr_b16 v[108:109], v19 offset:0
    v_mfma_f32_16x16x32_bf16 v[64:67], v[144:147], v[128:131], v[64:67]
    ds_read_b64_tr_b16 v[110:111], v19 offset:4096
    v_mfma_f32_16x16x32_bf16 v[80:83], v[144:147], v[132:135], v[80:83]
    ds_read_b64_tr_b16 v[112:113], v20 offset:0
    v_mfma_f32_16x16x32_bf16 v[84:87], v[148:151], v[132:135], v[84:87]
    ds_read_b64_tr_b16 v[114:115], v20 offset:4096
    v_mfma_f32_16x16x32_bf16 v[68:71], v[148:151], v[128:131], v[68:71]
    ds_read_b64_tr_b16 v[116:117], v21 offset:0
    v_mfma_f32_16x16x32_bf16 v[52:55], v[148:151], v[124:127], v[52:55]
    ds_read_b64_tr_b16 v[118:119], v21 offset:4096
    v_mfma_f32_16x16x32_bf16 v[36:39], v[148:151], v[120:123], v[36:39]
    s_waitcnt lgkmcnt(6)
    s_cbranch_scc1 mm_27
mm_28:
    v_mfma_f32_16x16x32_bf16 v[24:27], v[104:107], v[88:91], v[24:27]
    ds_read_b128 v[120:123], v17 offset:1024
    s_add_u32 s42, s42, 16384
    v_mfma_f32_16x16x32_bf16 v[40:43], v[104:107], v[92:95], v[40:43]
    ds_read_b128 v[124:127], v17 offset:3072
    s_cmp_eq_u32 s42, 49152
    v_mfma_f32_16x16x32_bf16 v[56:59], v[104:107], v[96:99], v[56:59]
    ds_read_b128 v[128:131], v17 offset:5120
    s_cselect_b32 s42, 0, s42
    v_mfma_f32_16x16x32_bf16 v[72:75], v[104:107], v[100:103], v[72:75]
    ds_read_b128 v[132:135], v17 offset:7168
    s_waitcnt lgkmcnt(8)
    v_mfma_f32_16x16x32_bf16 v[76:79], v[108:111], v[100:103], v[76:79]
    ds_read_b64_tr_b16 v[136:137], v18 offset:8192
    s_add_u32 s48, s48, 16384
    v_mfma_f32_16x16x32_bf16 v[60:63], v[108:111], v[96:99], v[60:63]
    ds_read_b64_tr_b16 v[138:139], v18 offset:12288
    s_cmp_eq_u32 s48, 98304
    v_mfma_f32_16x16x32_bf16 v[44:47], v[108:111], v[92:95], v[44:47]
    ds_read_b64_tr_b16 v[140:141], v19 offset:8192
    s_cselect_b32 s48, 0, s48
    v_mfma_f32_16x16x32_bf16 v[28:31], v[108:111], v[88:91], v[28:31]
    ds_read_b64_tr_b16 v[142:143], v19 offset:12288
    s_waitcnt lgkmcnt(8)
    v_mfma_f32_16x16x32_bf16 v[32:35], v[112:115], v[88:91], v[32:35]
    ds_read_b64_tr_b16 v[144:145], v20 offset:8192
    v_add_u32 v17, s42, v12
    v_mfma_f32_16x16x32_bf16 v[48:51], v[112:115], v[92:95], v[48:51]
    ds_read_b64_tr_b16 v[146:147], v20 offset:12288
    v_add_u32 v18, s48, v13
    v_mfma_f32_16x16x32_bf16 v[64:67], v[112:115], v[96:99], v[64:67]
    ds_read_b64_tr_b16 v[148:149], v21 offset:8192
    v_add_u32 v19, s48, v14
    v_mfma_f32_16x16x32_bf16 v[80:83], v[112:115], v[100:103], v[80:83]
    ds_read_b64_tr_b16 v[150:151], v21 offset:12288
    v_add_u32 v20, s48, v15
    v_mfma_f32_16x16x32_bf16 v[84:87], v[116:119], v[100:103], v[84:87]
    v_add_u32 v21, s48, v16
    v_mfma_f32_16x16x32_bf16 v[68:71], v[116:119], v[96:99], v[68:71]
    v_mfma_f32_16x16x32_bf16 v[52:55], v[116:119], v[92:95], v[52:55]
    v_mfma_f32_16x16x32_bf16 v[36:39], v[116:119], v[88:91], v[36:39]
    s_waitcnt lgkmcnt(6)
    v_mfma_f32_16x16x32_bf16 v[24:27], v[136:139], v[120:123], v[24:27]
    s_add_u32 s43, s43, 1
    s_cmp_lt_u32 s43, 27
    v_mfma_f32_16x16x32_bf16 v[40:43], v[136:139], v[124:127], v[40:43]
    s_waitcnt vmcnt(0)
    v_mfma_f32_16x16x32_bf16 v[56:59], v[136:139], v[128:131], v[56:59]
    s_waitcnt lgkmcnt(0)
    s_barrier
    v_mfma_f32_16x16x32_bf16 v[72:75], v[136:139], v[132:135], v[72:75]
    ds_read_b128 v[88:91], v17 offset:0
    v_mfma_f32_16x16x32_bf16 v[76:79], v[140:143], v[132:135], v[76:79]
    ds_read_b128 v[92:95], v17 offset:2048
    v_mfma_f32_16x16x32_bf16 v[60:63], v[140:143], v[128:131], v[60:63]
    ds_read_b128 v[96:99], v17 offset:4096
    v_mfma_f32_16x16x32_bf16 v[44:47], v[140:143], v[124:127], v[44:47]
    ds_read_b128 v[100:103], v17 offset:6144
    v_mfma_f32_16x16x32_bf16 v[28:31], v[140:143], v[120:123], v[28:31]
    ds_read_b64_tr_b16 v[104:105], v18 offset:0
    v_mfma_f32_16x16x32_bf16 v[32:35], v[144:147], v[120:123], v[32:35]
    ds_read_b64_tr_b16 v[106:107], v18 offset:4096
    v_mfma_f32_16x16x32_bf16 v[48:51], v[144:147], v[124:127], v[48:51]
    ds_read_b64_tr_b16 v[108:109], v19 offset:0
    v_mfma_f32_16x16x32_bf16 v[64:67], v[144:147], v[128:131], v[64:67]
    ds_read_b64_tr_b16 v[110:111], v19 offset:4096
    v_mfma_f32_16x16x32_bf16 v[80:83], v[144:147], v[132:135], v[80:83]
    ds_read_b64_tr_b16 v[112:113], v20 offset:0
    v_mfma_f32_16x16x32_bf16 v[84:87], v[148:151], v[132:135], v[84:87]
    ds_read_b64_tr_b16 v[114:115], v20 offset:4096
    v_mfma_f32_16x16x32_bf16 v[68:71], v[148:151], v[128:131], v[68:71]
    ds_read_b64_tr_b16 v[116:117], v21 offset:0
    v_mfma_f32_16x16x32_bf16 v[52:55], v[148:151], v[124:127], v[52:55]
    ds_read_b64_tr_b16 v[118:119], v21 offset:4096
    v_mfma_f32_16x16x32_bf16 v[36:39], v[148:151], v[120:123], v[36:39]
    s_waitcnt lgkmcnt(6)
    s_cbranch_scc1 mm_28
    s_cmp_eq_u32 s60, 1
    s_cbranch_scc1 G4_last
    v_mfma_f32_16x16x32_bf16 v[24:27], v[104:107], v[88:91], v[24:27]
    ds_read_b128 v[120:123], v17 offset:1024
    v_mfma_f32_16x16x32_bf16 v[40:43], v[104:107], v[92:95], v[40:43]
    ds_read_b128 v[124:127], v17 offset:3072
    v_mfma_f32_16x16x32_bf16 v[56:59], v[104:107], v[96:99], v[56:59]
    ds_read_b128 v[128:131], v17 offset:5120
    v_mfma_f32_16x16x32_bf16 v[72:75], v[104:107], v[100:103], v[72:75]
    ds_read_b128 v[132:135], v17 offset:7168
    s_waitcnt lgkmcnt(8)
    v_mfma_f32_16x16x32_bf16 v[76:79], v[108:111], v[100:103], v[76:79]
    ds_read_b64_tr_b16 v[136:137], v18 offset:8192
    v_mfma_f32_16x16x32_bf16 v[60:63], v[108:111], v[96:99], v[60:63]
    ds_read_b64_tr_b16 v[138:139], v18 offset:12288
    v_mfma_f32_16x16x32_bf16 v[44:47], v[108:111], v[92:95], v[44:47]
    ds_read_b64_tr_b16 v[140:141], v19 offset:8192
    v_mfma_f32_16x16x32_bf16 v[28:31], v[108:111], v[88:91], v[28:31]
    ds_read_b64_tr_b16 v[142:143], v19 offset:12288
    s_waitcnt lgkmcnt(8)
    v_mfma_f32_16x16x32_bf16 v[32:35], v[112:115], v[88:91], v[32:35]
    ds_read_b64_tr_b16 v[144:145], v20 offset:8192
    v_mfma_f32_16x16x32_bf16 v[48:51], v[112:115], v[92:95], v[48:51]
    ds_read_b64_tr_b16 v[146:147], v20 offset:12288
    v_mfma_f32_16x16x32_bf16 v[64:67], v[112:115], v[96:99], v[64:67]
    ds_read_b64_tr_b16 v[148:149], v21 offset:8192
    v_mfma_f32_16x16x32_bf16 v[80:83], v[112:115], v[100:103], v[80:83]
    ds_read_b64_tr_b16 v[150:151], v21 offset:12288
    v_mfma_f32_16x16x32_bf16 v[84:87], v[116:119], v[100:103], v[84:87]
    v_mfma_f32_16x16x32_bf16 v[68:71], v[116:119], v[96:99], v[68:71]
    v_mfma_f32_16x16x32_bf16 v[52:55], v[116:119], v[92:95], v[52:55]
    v_mfma_f32_16x16x32_bf16 v[36:39], v[116:119], v[88:91], v[36:39]
    s_waitcnt lgkmcnt(0)
    v_mfma_f32_16x16x32_bf16 v[24:27], v[136:139], v[120:123], v[24:27]
    s_mul_i32 s36, s31, 524288
    s_add_u32 s36, s36, 0
    s_add_u32 s16, s62, s36
    v_mfma_f32_16x16x32_bf16 v[40:43], v[136:139], v[124:127], v[40:43]
    s_addc_u32 s17, s63, 0
    s_mov_b32 s18, 516096
    s_mov_b32 s19, 0x20000
    v_mfma_f32_16x16x32_bf16 v[56:59], v[136:139], v[128:131], v[56:59]
    v_mfma_f32_16x16x32_bf16 v[72:75], v[136:139], v[132:135], v[72:75]
    v_mfma_f32_16x16x32_bf16 v[76:79], v[140:143], v[132:135], v[76:79]
    v_mfma_f32_16x16x32_bf16 v[60:63], v[140:143], v[128:131], v[60:63]
    v_mfma_f32_16x16x32_bf16 v[44:47], v[140:143], v[124:127], v[44:47]
    v_mfma_f32_16x16x32_bf16 v[28:31], v[140:143], v[120:123], v[28:31]
    v_mfma_f32_16x16x32_bf16 v[32:35], v[144:147], v[120:123], v[32:35]
    v_mfma_f32_16x16x32_bf16 v[48:51], v[144:147], v[124:127], v[48:51]
    v_mfma_f32_16x16x32_bf16 v[64:67], v[144:147], v[128:131], v[64:67]
    v_mfma_f32_16x16x32_bf16 v[80:83], v[144:147], v[132:135], v[80:83]
    v_mfma_f32_16x16x32_bf16 v[84:87], v[148:151], v[132:135], v[84:87]
    v_mfma_f32_16x16x32_bf16 v[68:71], v[148:151], v[128:131], v[68:71]
    v_mfma_f32_16x16x32_bf16 v[52:55], v[148:151], v[124:127], v[52:55]
    v_mfma_f32_16x16x32_bf16 v[36:39], v[148:151], v[120:123], v[36:39]
    s_add_u32 s36, s39, 0
    v_cvt_pk_bf16_f32 v24, v24, v25
    v_cvt_pk_bf16_f32 v25, v26, v27
    v_cvt_pk_bf16_f32 v26, v28, v29
    v_cvt_pk_bf16_f32 v27, v30, v31
    v_or_b32 v24, 1, v24
    buffer_store_dwordx4 v[24:27], v2, s[16:19], s36 offen offset:0 sc1
    v_cvt_pk_bf16_f32 v32, v32, v33
    v_cvt_pk_bf16_f32 v33, v34, v35
    v_cvt_pk_bf16_f32 v34, v36, v37
    v_cvt_pk_bf16_f32 v35, v38, v39
    v_or_b32 v32, 1, v32
    buffer_store_dwordx4 v[32:35], v2, s[16:19], s36 offen offset:1024 sc1
    s_add_u32 s36, s39, 65536
    v_cvt_pk_bf16_f32 v40, v40, v41
    v_cvt_pk_bf16_f32 v41, v42, v43
    v_cvt_pk_bf16_f32 v42, v44, v45
    v_cvt_pk_bf16_f32 v43, v46, v47
    v_or_b32 v40, 1, v40
    buffer_store_dwordx4 v[40:43], v2, s[16:19], s36 offen offset:0 sc1
    v_cvt_pk_bf16_f32 v48, v48, v49
    v_cvt_pk_bf16_f32 v49, v50, v51
    v_cvt_pk_bf16_f32 v50, v52, v53
    v_cvt_pk_bf16_f32 v51, v54, v55
    v_or_b32 v48, 1, v48
    buffer_store_dwordx4 v[48:51], v2, s[16:19], s36 offen offset:1024 sc1
    s_add_u32 s36, s39, 131072
    v_cvt_pk_bf16_f32 v56, v56, v57
    v_cvt_pk_bf16_f32 v57, v58, v59
    v_cvt_pk_bf16_f32 v58, v60, v61
    v_cvt_pk_bf16_f32 v59, v62, v63
    v_or_b32 v56, 1, v56
    buffer_store_dwordx4 v[56:59], v2, s[16:19], s36 offen offset:0 sc1
    v_cvt_pk_bf16_f32 v64, v64, v65
    v_cvt_pk_bf16_f32 v65, v66, v67
    v_cvt_pk_bf16_f32 v66, v68, v69
    v_cvt_pk_bf16_f32 v67, v70, v71
    v_or_b32 v64, 1, v64
    buffer_store_dwordx4 v[64:67], v2, s[16:19], s36 offen offset:1024 sc1
    s_add_u32 s36, s39, 196608
    v_cvt_pk_bf16_f32 v72, v72, v73
    v_cvt_pk_bf16_f32 v73, v74, v75
    v_cvt_pk_bf16_f32 v74, v76, v77
    v_cvt_pk_bf16_f32 v75, v78, v79
    v_or_b32 v72, 1, v72
    buffer_store_dwordx4 v[72:75], v2, s[16:19], s36 offen offset:0 sc1
    v_cvt_pk_bf16_f32 v80, v80, v81
    v_cvt_pk_bf16_f32 v81, v82, v83
    v_cvt_pk_bf16_f32 v82, v84, v85
    v_cvt_pk_bf16_f32 v83, v86, v87
    v_or_b32 v80, 1, v80
    buffer_store_dwordx4 v[80:83], v2, s[16:19], s36 offen offset:1024 sc1
    s_barrier
    s_branch NEXT
G4_last:
    v_mfma_f32_16x16x32_bf16 v[24:27], v[104:107], v[88:91], v[24:27]
    ds_read_b128 v[120:123], v17 offset:1024
    v_mfma_f32_16x16x32_bf16 v[40:43], v[104:107], v[92:95], v[40:43]
    ds_read_b128 v[124:127], v17 offset:3072
    v_mfma_f32_16x16x32_bf16 v[56:59], v[104:107], v[96:99], v[56:59]
    ds_read_b128 v[128:131], v17 offset:5120
    v_mfma_f32_16x16x32_bf16 v[72:75], v[104:107], v[100:103], v[72:75]
    ds_read_b128 v[132:135], v17 offset:7168
    s_waitcnt lgkmcnt(8)
    v_mfma_f32_16x16x32_bf16 v[76:79], v[108:111], v[100:103], v[76:79]
    ds_read_b64_tr_b16 v[136:137], v18 offset:8192
    v_mfma_f32_16x16x32_bf16 v[60:63], v[108:111], v[96:99], v[60:63]
    ds_read_b64_tr_b16 v[138:139], v18 offset:12288
    v_mfma_f32_16x16x32_bf16 v[44:47], v[108:111], v[92:95], v[44:47]
    ds_read_b64_tr_b16 v[140:141], v19 offset:8192
    v_mfma_f32_16x16x32_bf16 v[28:31], v[108:111], v[88:91], v[28:31]
    ds_read_b64_tr_b16 v[142:143], v19 offset:12288
    s_waitcnt lgkmcnt(8)
    v_mfma_f32_16x16x32_bf16 v[32:35], v[112:115], v[88:91], v[32:35]
    ds_read_b64_tr_b16 v[144:145], v20 offset:8192
    v_mfma_f32_16x16x32_bf16 v[48:51], v[112:115], v[92:95], v[48:51]
    ds_read_b64_tr_b16 v[146:147], v20 offset:12288
    s_load_dwordx2 s[6:7], s[0:1], 88
    v_mfma_f32_16x16x32_bf16 v[64:67], v[112:115], v[96:99], v[64:67]
    ds_read_b64_tr_b16 v[148:149], v21 offset:8192
    v_mfma_f32_16x16x32_bf16 v[80:83], v[112:115], v[100:103], v[80:83]
    ds_read_b64_tr_b16 v[150:151], v21 offset:12288
    v_mfma_f32_16x16x32_bf16 v[84:87], v[116:119], v[100:103], v[84:87]
    v_mfma_f32_16x16x32_bf16 v[68:71], v[116:119], v[96:99], v[68:71]
    v_mfma_f32_16x16x32_bf16 v[52:55], v[116:119], v[92:95], v[52:55]
    v_mfma_f32_16x16x32_bf16 v[36:39], v[116:119], v[88:91], v[36:39]
    s_waitcnt lgkmcnt(0)
    v_mfma_f32_16x16x32_bf16 v[24:27], v[136:139], v[120:123], v[24:27]
    s_add_u32 s16, s62, 0x80000
    s_addc_u32 s17, s63, 0
    s_mov_b32 s18, 0x7e000
    v_mfma_f32_16x16x32_bf16 v[40:43], v[136:139], v[124:127], v[40:43]
    s_mov_b32 s19, 0x20000
    s_mov_b32 s20, s6
    s_mov_b32 s21, s7
    v_mfma_f32_16x16x32_bf16 v[56:59], v[136:139], v[128:131], v[56:59]
    s_mov_b32 s22, 0x400000
    s_mov_b32 s23, 0x20000
    s_add_u32 s44, s40, 65536
    v_mfma_f32_16x16x32_bf16 v[72:75], v[136:139], v[132:135], v[72:75]
    s_lshl_b32 s46, s28, 3
    s_add_u32 s46, s46, s37
    s_lshl_b32 s47, s31, 1
    v_mfma_f32_16x16x32_bf16 v[76:79], v[140:143], v[132:135], v[76:79]
    s_add_u32 s46, s46, s47
    s_lshl_b32 s46, s46, 15
    s_lshl_b32 s47, s38, 5
    v_mfma_f32_16x16x32_bf16 v[60:63], v[140:143], v[128:131], v[60:63]
    s_add_u32 s46, s46, s47
    s_add_u32 s47, s46, 32768
    v_and_b32 v225, 1, v23
    v_mfma_f32_16x16x32_bf16 v[44:47], v[140:143], v[124:127], v[44:47]
    v_lshlrev_b32 v224, 11, v22
    v_lshl_add_u32 v224, v225, 5, v224
    v_mfma_f32_16x16x32_bf16 v[28:31], v[140:143], v[120:123], v[28:31]
    v_lshrrev_b32 v225, 1, v23
    v_lshl_add_u32 v224, v225, 4, v224
    v_mfma_f32_16x16x32_bf16 v[32:35], v[144:147], v[120:123], v[32:35]
    v_lshrrev_b32 v225, 3, v22
    v_mul_u32_u24 v225, 16320, v225
    v_mfma_f32_16x16x32_bf16 v[48:51], v[144:147], v[124:127], v[48:51]
    v_sub_u32 v224, v224, v225
    v_add_u32 v225, 16384, v224
    v_mfma_f32_16x16x32_bf16 v[64:67], v[144:147], v[128:131], v[64:67]
    v_mfma_f32_16x16x32_bf16 v[80:83], v[144:147], v[132:135], v[80:83]
    v_mfma_f32_16x16x32_bf16 v[84:87], v[148:151], v[132:135], v[84:87]
    v_mfma_f32_16x16x32_bf16 v[68:71], v[148:151], v[128:131], v[68:71]
    v_mfma_f32_16x16x32_bf16 v[52:55], v[148:151], v[124:127], v[52:55]
    v_mfma_f32_16x16x32_bf16 v[36:39], v[148:151], v[120:123], v[36:39]
    s_cmp_eq_u32 s31, 0
    s_cbranch_scc1 G4_k0
    s_add_u32 s36, s41, 0
    v_cvt_pk_bf16_f32 v24, v24, v25
    v_cvt_pk_bf16_f32 v25, v26, v27
    v_cvt_pk_bf16_f32 v26, v28, v29
    v_cvt_pk_bf16_f32 v27, v30, v31
    v_or_b32 v24, 1, v24
    buffer_store_dwordx4 v[24:27], v2, s[16:19], s36 offen offset:0 sc1
    v_cvt_pk_bf16_f32 v32, v32, v33
    v_cvt_pk_bf16_f32 v33, v34, v35
    v_cvt_pk_bf16_f32 v34, v36, v37
    v_cvt_pk_bf16_f32 v35, v38, v39
    v_or_b32 v32, 1, v32
    buffer_store_dwordx4 v[32:35], v2, s[16:19], s36 offen offset:1024 sc1
    s_add_u32 s36, s41, 65536
    v_cvt_pk_bf16_f32 v40, v40, v41
    v_cvt_pk_bf16_f32 v41, v42, v43
    v_cvt_pk_bf16_f32 v42, v44, v45
    v_cvt_pk_bf16_f32 v43, v46, v47
    v_or_b32 v40, 1, v40
    buffer_store_dwordx4 v[40:43], v2, s[16:19], s36 offen offset:0 sc1
    v_cvt_pk_bf16_f32 v48, v48, v49
    v_cvt_pk_bf16_f32 v49, v50, v51
    v_cvt_pk_bf16_f32 v50, v52, v53
    v_cvt_pk_bf16_f32 v51, v54, v55
    v_or_b32 v48, 1, v48
    buffer_store_dwordx4 v[48:51], v2, s[16:19], s36 offen offset:1024 sc1
    v_pk_mov_b32 v[24:25], v[56:57], v[56:57] op_sel:[0,1]
    v_pk_mov_b32 v[26:27], v[58:59], v[58:59] op_sel:[0,1]
    v_pk_mov_b32 v[28:29], v[60:61], v[60:61] op_sel:[0,1]
    v_pk_mov_b32 v[30:31], v[62:63], v[62:63] op_sel:[0,1]
    v_pk_mov_b32 v[32:33], v[64:65], v[64:65] op_sel:[0,1]
    v_pk_mov_b32 v[34:35], v[66:67], v[66:67] op_sel:[0,1]
    v_pk_mov_b32 v[36:37], v[68:69], v[68:69] op_sel:[0,1]
    v_pk_mov_b32 v[38:39], v[70:71], v[70:71] op_sel:[0,1]
    v_pk_mov_b32 v[40:41], v[72:73], v[72:73] op_sel:[0,1]
    v_pk_mov_b32 v[42:43], v[74:75], v[74:75] op_sel:[0,1]
    v_pk_mov_b32 v[44:45], v[76:77], v[76:77] op_sel:[0,1]
    v_pk_mov_b32 v[46:47], v[78:79], v[78:79] op_sel:[0,1]
    v_pk_mov_b32 v[48:49], v[80:81], v[80:81] op_sel:[0,1]
    v_pk_mov_b32 v[50:51], v[82:83], v[82:83] op_sel:[0,1]
    v_pk_mov_b32 v[52:53], v[84:85], v[84:85] op_sel:[0,1]
    v_pk_mov_b32 v[54:55], v[86:87], v[86:87] op_sel:[0,1]
    s_branch G4_k1
G4_k0:
    s_add_u32 s36, s41, 0
    v_cvt_pk_bf16_f32 v56, v56, v57
    v_cvt_pk_bf16_f32 v57, v58, v59
    v_cvt_pk_bf16_f32 v58, v60, v61
    v_cvt_pk_bf16_f32 v59, v62, v63
    v_or_b32 v56, 1, v56
    buffer_store_dwordx4 v[56:59], v2, s[16:19], s36 offen offset:0 sc1
    v_cvt_pk_bf16_f32 v64, v64, v65
    v_cvt_pk_bf16_f32 v65, v66, v67
    v_cvt_pk_bf16_f32 v66, v68, v69
    v_cvt_pk_bf16_f32 v67, v70, v71
    v_or_b32 v64, 1, v64
    buffer_store_dwordx4 v[64:67], v2, s[16:19], s36 offen offset:1024 sc1
    s_add_u32 s36, s41, 65536
    v_cvt_pk_bf16_f32 v72, v72, v73
    v_cvt_pk_bf16_f32 v73, v74, v75
    v_cvt_pk_bf16_f32 v74, v76, v77
    v_cvt_pk_bf16_f32 v75, v78, v79
    v_or_b32 v72, 1, v72
    buffer_store_dwordx4 v[72:75], v2, s[16:19], s36 offen offset:0 sc1
    v_cvt_pk_bf16_f32 v80, v80, v81
    v_cvt_pk_bf16_f32 v81, v82, v83
    v_cvt_pk_bf16_f32 v82, v84, v85
    v_cvt_pk_bf16_f32 v83, v86, v87
    v_or_b32 v80, 1, v80
    buffer_store_dwordx4 v[80:83], v2, s[16:19], s36 offen offset:1024 sc1
G4_k1:
    s_mov_b32 s78, 0x3f80
    s_mov_b32 s79, 0x3f800000
    v_dot2_f32_bf16 v24, v180, s78, v24
    v_dot2_f32_bf16 v25, v180, s79, v25
    v_dot2_f32_bf16 v26, v181, s78, v26
    v_dot2_f32_bf16 v27, v181, s79, v27
    v_dot2_f32_bf16 v28, v182, s78, v28
    v_dot2_f32_bf16 v29, v182, s79, v29
    v_dot2_f32_bf16 v30, v183, s78, v30
    v_dot2_f32_bf16 v31, v183, s79, v31
    v_dot2_f32_bf16 v32, v188, s78, v32
    v_dot2_f32_bf16 v33, v188, s79, v33
    v_dot2_f32_bf16 v34, v189, s78, v34
    v_dot2_f32_bf16 v35, v189, s79, v35
    v_dot2_f32_bf16 v36, v190, s78, v36
    v_dot2_f32_bf16 v37, v190, s79, v37
    v_dot2_f32_bf16 v38, v191, s78, v38
    v_dot2_f32_bf16 v39, v191, s79, v39
    v_dot2_f32_bf16 v40, v196, s78, v40
    v_dot2_f32_bf16 v41, v196, s79, v41
    v_dot2_f32_bf16 v42, v197, s78, v42
    v_dot2_f32_bf16 v43, v197, s79, v43
    v_dot2_f32_bf16 v44, v198, s78, v44
    v_dot2_f32_bf16 v45, v198, s79, v45
    v_dot2_f32_bf16 v46, v199, s78, v46
    v_dot2_f32_bf16 v47, v199, s79, v47
    v_dot2_f32_bf16 v48, v234, s78, v48
    v_dot2_f32_bf16 v49, v234, s79, v49
    v_dot2_f32_bf16 v50, v235, s78, v50
    v_dot2_f32_bf16 v51, v235, s79, v51
    v_dot2_f32_bf16 v52, v236, s78, v52
    v_dot2_f32_bf16 v53, v236, s79, v53
    v_dot2_f32_bf16 v54, v237, s78, v54
    v_dot2_f32_bf16 v55, v237, s79, v55
    v_dot2_f32_bf16 v24, v184, s78, v24
    v_dot2_f32_bf16 v25, v184, s79, v25
    v_dot2_f32_bf16 v26, v185, s78, v26
    v_dot2_f32_bf16 v27, v185, s79, v27
    v_dot2_f32_bf16 v28, v186, s78, v28
    v_dot2_f32_bf16 v29, v186, s79, v29
    v_dot2_f32_bf16 v30, v187, s78, v30
    v_dot2_f32_bf16 v31, v187, s79, v31
    v_dot2_f32_bf16 v32, v192, s78, v32
    v_dot2_f32_bf16 v33, v192, s79, v33
    v_dot2_f32_bf16 v34, v193, s78, v34
    v_dot2_f32_bf16 v35, v193, s79, v35
    v_dot2_f32_bf16 v36, v194, s78, v36
    v_dot2_f32_bf16 v37, v194, s79, v37
    v_dot2_f32_bf16 v38, v195, s78, v38
    v_dot2_f32_bf16 v39, v195, s79, v39
    v_dot2_f32_bf16 v40, v230, s78, v40
    v_dot2_f32_bf16 v41, v230, s79, v41
    v_dot2_f32_bf16 v42, v231, s78, v42
    v_dot2_f32_bf16 v43, v231, s79, v43
    v_dot2_f32_bf16 v44, v232, s78, v44
    v_dot2_f32_bf16 v45, v232, s79, v45
    v_dot2_f32_bf16 v46, v233, s78, v46
    v_dot2_f32_bf16 v47, v233, s79, v47
    v_dot2_f32_bf16 v48, v248, s78, v48
    v_dot2_f32_bf16 v49, v248, s79, v49
    v_dot2_f32_bf16 v50, v249, s78, v50
    v_dot2_f32_bf16 v51, v249, s79, v51
    v_dot2_f32_bf16 v52, v250, s78, v52
    v_dot2_f32_bf16 v53, v250, s79, v53
    v_dot2_f32_bf16 v54, v251, s78, v54
    v_dot2_f32_bf16 v55, v251, s79, v55
    s_mov_b32 s53, 0
dp_29:
    buffer_load_dwordx4 v[208:211], v2, s[16:19], s40 offen offset:0 sc1
    buffer_load_dwordx4 v[212:215], v2, s[16:19], s40 offen offset:1024 sc1
    buffer_load_dwordx4 v[216:219], v2, s[16:19], s44 offen offset:0 sc1
    buffer_load_dwordx4 v[220:223], v2, s[16:19], s44 offen offset:1024 sc1
    s_waitcnt vmcnt(0)
    v_bitop3_b32 v6, v208, v212, v216 bitop3:0x80
    v_bitop3_b32 v6, v6, v220, 1 bitop3:0x80
    v_cmp_eq_u32 vcc, 0, v6
    s_cbranch_vccz dq_30
    s_sleep 2
    s_add_u32 s53, s53, 1
    s_cmp_lt_u32 s53, s61
    s_cbranch_scc1 dp_29
    s_mov_b32 s61, 0
dq_30:
    v_dot2_f32_bf16 v24, v208, s78, v24
    v_dot2_f32_bf16 v25, v208, s79, v25
    v_dot2_f32_bf16 v26, v209, s78, v26
    v_dot2_f32_bf16 v27, v209, s79, v27
    v_dot2_f32_bf16 v28, v210, s78, v28
    v_dot2_f32_bf16 v29, v210, s79, v29
    v_dot2_f32_bf16 v30, v211, s78, v30
    v_dot2_f32_bf16 v31, v211, s79, v31
    v_cvt_pk_bf16_f32 v24, v24, v25
    v_cvt_pk_bf16_f32 v25, v26, v27
    v_cvt_pk_bf16_f32 v26, v28, v29
    v_cvt_pk_bf16_f32 v27, v30, v31
    s_nop 0
    v_permlane16_swap_b32 v24, v26
    v_permlane16_swap_b32 v25, v27
    v_dot2_f32_bf16 v32, v212, s78, v32
    v_dot2_f32_bf16 v33, v212, s79, v33
    v_dot2_f32_bf16 v34, v213, s78, v34
    v_dot2_f32_bf16 v35, v213, s79, v35
    v_dot2_f32_bf16 v36, v214, s78, v36
    v_dot2_f32_bf16 v37, v214, s79, v37
    v_dot2_f32_bf16 v38, v215, s78, v38
    v_dot2_f32_bf16 v39, v215, s79, v39
    v_cvt_pk_bf16_f32 v32, v32, v33
    v_cvt_pk_bf16_f32 v33, v34, v35
    v_cvt_pk_bf16_f32 v34, v36, v37
    v_cvt_pk_bf16_f32 v35, v38, v39
    s_nop 0
    v_permlane16_swap_b32 v32, v34
    v_permlane16_swap_b32 v33, v35
    v_mov_b32 v36, v24
    v_mov_b32 v37, v25
    v_mov_b32 v38, v26
    v_mov_b32 v39, v27
    v_mov_b32_dpp v24, v32 row_ror:8 row_mask:0xf bank_mask:0xc
    v_mov_b32_dpp v25, v33 row_ror:8 row_mask:0xf bank_mask:0xc
    v_mov_b32_dpp v26, v34 row_ror:8 row_mask:0xf bank_mask:0xc
    v_mov_b32_dpp v27, v35 row_ror:8 row_mask:0xf bank_mask:0xc
    v_mov_b32_dpp v32, v36 row_ror:8 row_mask:0xf bank_mask:0x3
    v_mov_b32_dpp v33, v37 row_ror:8 row_mask:0xf bank_mask:0x3
    v_mov_b32_dpp v34, v38 row_ror:8 row_mask:0xf bank_mask:0x3
    v_mov_b32_dpp v35, v39 row_ror:8 row_mask:0xf bank_mask:0x3
    buffer_store_dwordx4 v[24:27], v224, s[20:23], s46 offen sc1
    buffer_store_dwordx4 v[32:35], v225, s[20:23], s46 offen sc1
    v_dot2_f32_bf16 v40, v216, s78, v40
    v_dot2_f32_bf16 v41, v216, s79, v41
    v_dot2_f32_bf16 v42, v217, s78, v42
    v_dot2_f32_bf16 v43, v217, s79, v43
    v_dot2_f32_bf16 v44, v218, s78, v44
    v_dot2_f32_bf16 v45, v218, s79, v45
    v_dot2_f32_bf16 v46, v219, s78, v46
    v_dot2_f32_bf16 v47, v219, s79, v47
    v_cvt_pk_bf16_f32 v40, v40, v41
    v_cvt_pk_bf16_f32 v41, v42, v43
    v_cvt_pk_bf16_f32 v42, v44, v45
    v_cvt_pk_bf16_f32 v43, v46, v47
    s_nop 0
    v_permlane16_swap_b32 v40, v42
    v_permlane16_swap_b32 v41, v43
    v_dot2_f32_bf16 v48, v220, s78, v48
    v_dot2_f32_bf16 v49, v220, s79, v49
    v_dot2_f32_bf16 v50, v221, s78, v50
    v_dot2_f32_bf16 v51, v221, s79, v51
    v_dot2_f32_bf16 v52, v222, s78, v52
    v_dot2_f32_bf16 v53, v222, s79, v53
    v_dot2_f32_bf16 v54, v223, s78, v54
    v_dot2_f32_bf16 v55, v223, s79, v55
    v_cvt_pk_bf16_f32 v48, v48, v49
    v_cvt_pk_bf16_f32 v49, v50, v51
    v_cvt_pk_bf16_f32 v50, v52, v53
    v_cvt_pk_bf16_f32 v51, v54, v55
    s_nop 0
    v_permlane16_swap_b32 v48, v50
    v_permlane16_swap_b32 v49, v51
    v_mov_b32 v52, v40
    v_mov_b32 v53, v41
    v_mov_b32 v54, v42
    v_mov_b32 v55, v43
    v_mov_b32_dpp v40, v48 row_ror:8 row_mask:0xf bank_mask:0xc
    v_mov_b32_dpp v41, v49 row_ror:8 row_mask:0xf bank_mask:0xc
    v_mov_b32_dpp v42, v50 row_ror:8 row_mask:0xf bank_mask:0xc
    v_mov_b32_dpp v43, v51 row_ror:8 row_mask:0xf bank_mask:0xc
    v_mov_b32_dpp v48, v52 row_ror:8 row_mask:0xf bank_mask:0x3
    v_mov_b32_dpp v49, v53 row_ror:8 row_mask:0xf bank_mask:0x3
    v_mov_b32_dpp v50, v54 row_ror:8 row_mask:0xf bank_mask:0x3
    v_mov_b32_dpp v51, v55 row_ror:8 row_mask:0xf bank_mask:0x3
    buffer_store_dwordx4 v[40:43], v224, s[20:23], s47 offen sc1
    buffer_store_dwordx4 v[48:51], v225, s[20:23], s47 offen sc1
    s_branch K_fin
LOADERS:
    s_cmp_lg_u32 s60, 0
    s_cbranch_scc1 pr_31
    s_and_b32 s36, s29, 6
    s_cmp_eq_u32 s36, 2
    s_cbranch_scc0 pr_31
    s_call_b64 s[76:77], SUB_park2
pr_31:
    s_cmp_ge_u32 s30, 6
    s_cbranch_scc1 WLOAD
    s_add_u32 s54, s55, 0x500
    v_mov_b32 v222, s54
    s_lshl_b32 s53, s29, 7
    s_add_u32 s53, s53, 23121920
    v_mov_b32 v226, s53
    s_sleep 30
    s_mov_b64 exec, 1
    buffer_load_dword v227, v226, s[56:59], 0 offen sc1
    s_mov_b64 exec, -1
    s_waitcnt vmcnt(0)
    v_readfirstlane_b32 s53, v227
    s_add_u32 s54, s52, 16
    s_cmp_eq_u32 s53, s54
    s_cbranch_scc1 fok_32
    s_mov_b32 s53, 0
    s_add_u32 s54, s52, 16
    s_bfm_b64 exec, 1, 0
poll_33:
    buffer_load_dword v227, v226, s[56:59], 0 offen sc1
    s_waitcnt vmcnt(0)
    v_xor_b32 v227, s54, v227
    v_cmp_eq_u32 vcc, 0, v227
    s_nop 0
    s_cmp_eq_u64 vcc, exec
    s_cbranch_scc1 pok_34
    s_sleep 5
    s_add_u32 s53, s53, 1
    s_cmp_lt_u32 s53, s61
    s_cbranch_scc1 poll_33
    s_mov_b32 s61, 0
pok_34:
    s_mov_b64 exec, -1
fok_32:
    s_add_u32 s24, s4, 0x1400000
    s_addc_u32 s25, s5, 0
    s_mov_b32 s26, 0x20000
    s_mov_b32 s27, 0x20000
    s_cmp_eq_u32 s60, 0
    s_cselect_b32 s26, s26, 0
    s_and_b32 s36, s30, 1
    s_mul_i32 s36, s36, 128
    s_mul_i32 s37, s29, 256
    s_add_u32 s37, s36, s37
    v_lshrrev_b32 v224, 3, v1
    v_mul_u32_u24 v224, 4096, v224
    v_and_b32 v23, 112, v2
    v_add_u32 v224, v224, v23
    s_cmp_eq_u32 s60, 0
    s_cselect_b64 exec, -1, 0
    buffer_load_dwordx4 v[24:27], v224, s[24:27], s37 offen sc1
    s_add_u32 s37, s37, 32768
    buffer_load_dwordx4 v[28:31], v224, s[24:27], s37 offen sc1
    s_add_u32 s37, s37, 32768
    buffer_load_dwordx4 v[32:35], v224, s[24:27], s37 offen sc1
    s_add_u32 s37, s37, 32768
    buffer_load_dwordx4 v[36:39], v224, s[24:27], s37 offen sc1
    s_add_u32 s37, s37, 32768
    s_mov_b64 exec, -1
    s_mov_b64 exec, 1
    buffer_load_dword v223, v222, s[56:59], 0 offen sc1
    s_mov_b64 exec, -1
    s_waitcnt vmcnt(0)
    v_readfirstlane_b32 s53, v223
    s_add_u32 s54, s52, 16
    s_cmp_eq_u32 s53, s54
    s_cbranch_scc1 fok_35
    s_mov_b32 s53, 0
    s_add_u32 s54, s52, 16
    s_bfm_b64 exec, 1, 0
poll_36:
    buffer_load_dword v223, v222, s[56:59], 0 offen sc1
    s_waitcnt vmcnt(0)
    v_xor_b32 v223, s54, v223
    v_cmp_eq_u32 vcc, 0, v223
    s_nop 0
    s_cmp_eq_u64 vcc, exec
    s_cbranch_scc1 pok_37
    s_sleep 5
    s_add_u32 s53, s53, 1
    s_cmp_lt_u32 s53, s61
    s_cbranch_scc1 poll_36
    s_mov_b32 s61, 0
pok_37:
    s_mov_b64 exec, -1
fok_35:
    s_add_u32 s20, s62, 0x5d0000
    s_addc_u32 s21, s63, 0
    s_mov_b32 s22, 0x800
    s_mov_b32 s23, 0x20000
    s_and_b32 s35, s30, 1
    s_lshl_b32 s35, s35, 10
    buffer_load_dwordx4 v[16:19], v2, s[20:23], s35 offen sc1
    s_cmp_lg_u32 s60, 0
    s_cbranch_scc1 pc_38
    v_add_f32 v24, v24, v28
    v_add_f32 v25, v25, v29
    v_add_f32 v26, v26, v30
    v_add_f32 v27, v27, v31
    v_add_f32 v24, v24, v32
    v_add_f32 v25, v25, v33
    v_add_f32 v26, v26, v34
    v_add_f32 v27, v27, v35
    v_add_f32 v24, v24, v36
    v_add_f32 v25, v25, v37
    v_add_f32 v26, v26, v38
    v_add_f32 v27, v27, v39
    v_add_f32_dpp v24, v24, v24 row_ror:8 row_mask:0xf bank_mask:0xf
    v_add_f32_dpp v25, v25, v25 row_ror:8 row_mask:0xf bank_mask:0xf
    v_add_f32_dpp v26, v26, v26 row_ror:8 row_mask:0xf bank_mask:0xf
    v_add_f32_dpp v27, v27, v27 row_ror:8 row_mask:0xf bank_mask:0xf
    v_mov_b32 v28, v24
    v_mov_b32 v29, v25
    v_mov_b32 v30, v26
    v_mov_b32 v31, v27
    v_permlane16_swap_b32 v24, v28
    v_permlane16_swap_b32 v25, v29
    v_permlane16_swap_b32 v26, v30
    v_permlane16_swap_b32 v27, v31
    v_add_f32 v24, v24, v28
    v_add_f32 v25, v25, v29
    v_add_f32 v26, v26, v30
    v_add_f32 v27, v27, v31
    v_mov_b32 v28, v24
    v_mov_b32 v29, v25
    v_mov_b32 v30, v26
    v_mov_b32 v31, v27
    v_permlane32_swap_b32 v24, v28
    v_permlane32_swap_b32 v25, v29
    v_permlane32_swap_b32 v26, v30
    v_permlane32_swap_b32 v27, v31
    v_add_f32 v24, v24, v28
    v_add_f32 v25, v25, v29
    v_add_f32 v26, v26, v30
    v_add_f32 v27, v27, v31
pc_38:
    s_cmp_lg_u32 s60, 0
    s_cbranch_scc1 pc_39
    s_and_b32 s36, s30, 1
    s_mul_i32 s36, s36, 128
    s_add_u32 s36, s36, 163328
    v_add_u32 v23, s36, v2
    s_bfm_b64 exec, 8, 0
    ds_write_b128 v23, v[24:27]
    s_mov_b64 exec, -1
    s_waitcnt lgkmcnt(0)
pc_39:
    s_waitcnt vmcnt(0)
    s_and_b32 s36, s30, 1
    s_lshl_b32 s36, s36, 10
    s_add_u32 s36, s36, 160768
    v_add_u32 v221, s36, v2
    ds_write_b128 v221, v[16:19]
    s_waitcnt lgkmcnt(0)
    s_cmp_lg_u32 s30, 4
    s_cbranch_scc1 AL_nw
    s_cmp_eq_u32 s60, 0
    s_cbranch_scc1 AL_nw
    s_add_u32 s54, s55, 0xffc00300
    s_add_u32 s53, s54, s92
    v_mov_b32 v9, s53
    s_add_u32 s53, s53, 128
    v_writelane_b32 v9, s53, 1
    s_add_u32 s53, s54, s93
    v_writelane_b32 v9, s53, 2
    s_add_u32 s53, s53, 128
    v_writelane_b32 v9, s53, 3
    s_mov_b32 s53, 0
    s_add_u32 s54, s52, 8
    s_bfm_b64 exec, 4, 0
poll_41:
    buffer_load_dword v8, v9, s[56:59], 0 offen sc1
    s_waitcnt vmcnt(0)
    v_xor_b32 v8, s54, v8
    v_cmp_eq_u32 vcc, 0, v8
    s_nop 0
    s_cmp_eq_u64 vcc, exec
    s_cbranch_scc1 pok_42
    s_sleep 5
    s_add_u32 s53, s53, 1
    s_cmp_lt_u32 s53, s61
    s_cbranch_scc1 poll_41
    s_mov_b32 s61, 0
pok_42:
    s_mov_b64 exec, -1
AL_nw:
    s_barrier
    s_call_b64 s[76:77], SUB_after_g1
    s_barrier
    s_waitcnt vmcnt(0)
    s_barrier
    s_call_b64 s[76:77], SUB_after_g2
    s_and_b32 s35, s30, 1
    s_add_u32 s12, s62, 0x80000
    s_addc_u32 s13, s63, 0
    s_mov_b32 s14, 0x7e000
    s_mov_b32 s15, 0x20000
    s_mul_i32 s38, s35, 262144
    s_lshl_b32 s41, s35, 13
    s_mov_b32 s42, 0
    s_mov_b32 s44, 0
    s_add_u32 s54, s55, 0x200
    v_mov_b32 v9, s54
    s_mov_b32 s44, 1
    s_mov_b32 s42, 16384
    s_add_u32 s54, s55, 0x580
    v_mov_b32 v222, s54
    v_lshlrev_b32 v221, 3, v1
    s_add_u32 s19, s41, s42
    v_readlane_b32 s16, v248, s44
    s_nop 0
    s_add_u32 s16, s16, s38
    s_add_u32 s44, s44, 1
    s_and_b32 s44, s44, 15
    s_add_u32 s42, s42, 16384
    s_cmp_eq_u32 s42, 49152
    s_cselect_b32 s42, 0, s42
    s_mov_b32 m0, s19
    s_mov_b32 s39, s16
    s_waitcnt vmcnt(63)
    s_barrier
    s_sleep 6
    s_mov_b32 s53, 0
    s_add_u32 s54, s52, 16
    s_bfm_b64 exec, 1, 0
poll_43:
    buffer_load_dword v8, v9, s[56:59], 0 offen sc1
    s_waitcnt vmcnt(0)
    v_xor_b32 v8, s54, v8
    v_cmp_eq_u32 vcc, 0, v8
    s_nop 0
    s_cmp_eq_u64 vcc, exec
    s_cbranch_scc1 pok_44
    s_sleep 5
    s_add_u32 s53, s53, 1
    s_cmp_lt_u32 s53, s61
    s_cbranch_scc1 poll_43
    s_mov_b32 s61, 0
pok_44:
    s_mov_b64 exec, -1
    buffer_load_dwordx4 v2, s[12:15], s39 offen sc1 lds
    buffer_load_dwordx4 v2, s[12:15], s39 offen offset:1024 sc1 lds
    s_add_u32 s19, s41, s42
    v_readlane_b32 s16, v248, s44
    s_nop 0
    s_add_u32 s16, s16, s38
    s_add_u32 s44, s44, 1
    s_and_b32 s44, s44, 15
    s_add_u32 s42, s42, 16384
    s_cmp_eq_u32 s42, 49152
    s_cselect_b32 s42, 0, s42
    s_add_u32 m0, m0, 2048
    s_add_u32 s39, s39, 65536
    buffer_load_dwordx4 v2, s[12:15], s39 offen sc1 lds
    buffer_load_dwordx4 v2, s[12:15], s39 offen offset:1024 sc1 lds
    s_add_u32 m0, m0, 2048
    s_add_u32 s39, s39, 65536
    buffer_load_dwordx4 v2, s[12:15], s39 offen sc1 lds
    buffer_load_dwordx4 v2, s[12:15], s39 offen offset:1024 sc1 lds
    s_add_u32 m0, m0, 2048
    s_add_u32 s39, s39, 65536
    buffer_load_dwordx4 v2, s[12:15], s39 offen sc1 lds
    buffer_load_dwordx4 v2, s[12:15], s39 offen offset:1024 sc1 lds
    s_mov_b32 m0, s19
    s_mov_b32 s39, s16
    buffer_load_dwordx4 v2, s[12:15], s39 offen sc1 lds
    buffer_load_dwordx4 v2, s[12:15], s39 offen offset:1024 sc1 lds
    s_add_u32 s19, s41, s42
    v_readlane_b32 s16, v248, s44
    s_nop 0
    s_add_u32 s16, s16, s38
    s_add_u32 s44, s44, 1
    s_and_b32 s44, s44, 15
    s_add_u32 s42, s42, 16384
    s_cmp_eq_u32 s42, 49152
    s_cselect_b32 s42, 0, s42
    s_add_u32 m0, m0, 2048
    s_add_u32 s39, s39, 65536
    buffer_load_dwordx4 v2, s[12:15], s39 offen sc1 lds
    buffer_load_dwordx4 v2, s[12:15], s39 offen offset:1024 sc1 lds
    s_add_u32 m0, m0, 2048
    s_add_u32 s39, s39, 65536
    buffer_load_dwordx4 v2, s[12:15], s39 offen sc1 lds
    buffer_load_dwordx4 v2, s[12:15], s39 offen offset:1024 sc1 lds
    s_add_u32 m0, m0, 2048
    s_add_u32 s39, s39, 65536
    buffer_load_dwordx4 v2, s[12:15], s39 offen sc1 lds
    buffer_load_dwordx4 v2, s[12:15], s39 offen offset:1024 sc1 lds
    s_mov_b32 m0, s19
    s_mov_b32 s39, s16
    s_waitcnt vmcnt(8)
    s_barrier
    buffer_load_dwordx4 v2, s[12:15], s39 offen sc1 lds
    buffer_load_dwordx4 v2, s[12:15], s39 offen offset:1024 sc1 lds
    s_add_u32 s19, s41, s42
    v_readlane_b32 s16, v248, s44
    s_nop 0
    s_add_u32 s16, s16, s38
    s_add_u32 s44, s44, 1
    s_and_b32 s44, s44, 15
    s_add_u32 s42, s42, 16384
    s_cmp_eq_u32 s42, 49152
    s_cselect_b32 s42, 0, s42
    s_add_u32 m0, m0, 2048
    s_add_u32 s39, s39, 65536
    buffer_load_dwordx4 v2, s[12:15], s39 offen sc1 lds
    buffer_load_dwordx4 v2, s[12:15], s39 offen offset:1024 sc1 lds
    s_add_u32 m0, m0, 2048
    s_add_u32 s39, s39, 65536
    buffer_load_dwordx4 v2, s[12:15], s39 offen sc1 lds
    buffer_load_dwordx4 v2, s[12:15], s39 offen offset:1024 sc1 lds
    s_add_u32 m0, m0, 2048
    s_add_u32 s39, s39, 65536
    buffer_load_dwordx4 v2, s[12:15], s39 offen sc1 lds
    buffer_load_dwordx4 v2, s[12:15], s39 offen offset:1024 sc1 lds
    s_mov_b32 m0, s19
    s_mov_b32 s39, s16
    s_add_u32 s24, s4, 0x1420000
    s_addc_u32 s25, s5, 0
    s_mov_b32 s26, 0x70000
    s_mov_b32 s27, 0x20000
    s_cmp_eq_u32 s60, 0
    s_cselect_b32 s26, s26, 0
    s_and_b32 s36, s30, 1
    s_mul_i32 s36, s36, 448
    s_mul_i32 s37, s29, 896
    s_add_u32 s37, s36, s37
    v_lshrrev_b32 v224, 5, v1
    v_mul_u32_u24 v224, 14336, v224
    v_and_b32 v179, 496, v2
    v_add_u32 v224, v224, v179
    s_cmp_eq_u32 s60, 0
    s_cselect_b64 exec, -1, 0
    buffer_load_dwordx4 v[180:183], v224, s[24:27], s37 offen sc1
    s_add_u32 s37, s37, 28672
    buffer_load_dwordx4 v[184:187], v224, s[24:27], s37 offen sc1
    s_add_u32 s37, s37, 28672
    buffer_load_dwordx4 v[188:191], v224, s[24:27], s37 offen sc1
    s_add_u32 s37, s37, 28672
    s_mov_b64 exec, -1
    s_waitcnt vmcnt(11)
    s_barrier
    buffer_load_dwordx4 v2, s[12:15], s39 offen sc1 lds
    buffer_load_dwordx4 v2, s[12:15], s39 offen offset:1024 sc1 lds
    s_add_u32 s19, s41, s42
    v_readlane_b32 s16, v248, s44
    s_nop 0
    s_add_u32 s16, s16, s38
    s_add_u32 s44, s44, 1
    s_and_b32 s44, s44, 15
    s_add_u32 s42, s42, 16384
    s_cmp_eq_u32 s42, 49152
    s_cselect_b32 s42, 0, s42
    s_add_u32 m0, m0, 2048
    s_add_u32 s39, s39, 65536
    buffer_load_dwordx4 v2, s[12:15], s39 offen sc1 lds
    buffer_load_dwordx4 v2, s[12:15], s39 offen offset:1024 sc1 lds
    s_add_u32 m0, m0, 2048
    s_add_u32 s39, s39, 65536
    buffer_load_dwordx4 v2, s[12:15], s39 offen sc1 lds
    buffer_load_dwordx4 v2, s[12:15], s39 offen offset:1024 sc1 lds
    s_add_u32 m0, m0, 2048
    s_add_u32 s39, s39, 65536
    buffer_load_dwordx4 v2, s[12:15], s39 offen sc1 lds
    buffer_load_dwordx4 v2, s[12:15], s39 offen offset:1024 sc1 lds
    s_mov_b32 m0, s19
    s_mov_b32 s39, s16
    s_cmp_eq_u32 s60, 0
    s_cselect_b64 exec, -1, 0
    buffer_load_dwordx4 v[192:195], v224, s[24:27], s37 offen sc1
    s_add_u32 s37, s37, 28672
    buffer_load_dwordx4 v[196:199], v224, s[24:27], s37 offen sc1
    s_add_u32 s37, s37, 28672
    buffer_load_dwordx4 v[200:203], v224, s[24:27], s37 offen sc1
    s_add_u32 s37, s37, 28672
    s_mov_b64 exec, -1
    s_waitcnt vmcnt(14)
    s_barrier
    buffer_load_dwordx4 v2, s[12:15], s39 offen sc1 lds
    buffer_load_dwordx4 v2, s[12:15], s39 offen offset:1024 sc1 lds
    s_add_u32 s19, s41, s42
    v_readlane_b32 s16, v248, s44
    s_nop 0
    s_add_u32 s16, s16, s38
    s_add_u32 s44, s44, 1
    s_and_b32 s44, s44, 15
    s_add_u32 s42, s42, 16384
    s_cmp_eq_u32 s42, 49152
    s_cselect_b32 s42, 0, s42
    s_add_u32 m0, m0, 2048
    s_add_u32 s39, s39, 65536
    buffer_load_dwordx4 v2, s[12:15], s39 offen sc1 lds
    buffer_load_dwordx4 v2, s[12:15], s39 offen offset:1024 sc1 lds
    s_add_u32 m0, m0, 2048
    s_add_u32 s39, s39, 65536
    buffer_load_dwordx4 v2, s[12:15], s39 offen sc1 lds
    buffer_load_dwordx4 v2, s[12:15], s39 offen offset:1024 sc1 lds
    s_add_u32 m0, m0, 2048
    s_add_u32 s39, s39, 65536
    buffer_load_dwordx4 v2, s[12:15], s39 offen sc1 lds
    buffer_load_dwordx4 v2, s[12:15], s39 offen offset:1024 sc1 lds
    s_mov_b32 m0, s19
    s_mov_b32 s39, s16
    s_cmp_eq_u32 s60, 0
    s_cselect_b64 exec, -1, 0
    buffer_load_dwordx4 v[204:207], v224, s[24:27], s37 offen sc1
    s_add_u32 s37, s37, 28672
    buffer_load_dwordx4 v[208:211], v224, s[24:27], s37 offen sc1
    s_add_u32 s37, s37, 28672
    buffer_load_dwordx4 v[212:215], v224, s[24:27], s37 offen sc1
    s_add_u32 s37, s37, 28672
    s_mov_b64 exec, -1
    s_mov_b64 exec, 1
    buffer_load_dword v223, v222, s[56:59], 0 offen sc1
    s_mov_b64 exec, -1
    s_waitcnt vmcnt(15)
    s_barrier
    buffer_load_dwordx4 v2, s[12:15], s39 offen sc1 lds
    buffer_load_dwordx4 v2, s[12:15], s39 offen offset:1024 sc1 lds
    s_add_u32 s19, s41, s42
    v_readlane_b32 s16, v248, s44
    s_nop 0
    s_add_u32 s16, s16, s38
    s_add_u32 s44, s44, 1
    s_and_b32 s44, s44, 15
    s_add_u32 s42, s42, 16384
    s_cmp_eq_u32 s42, 49152
    s_cselect_b32 s42, 0, s42
    s_add_u32 m0, m0, 2048
    s_add_u32 s39, s39, 65536
    buffer_load_dwordx4 v2, s[12:15], s39 offen sc1 lds
    buffer_load_dwordx4 v2, s[12:15], s39 offen offset:1024 sc1 lds
    s_add_u32 m0, m0, 2048
    s_add_u32 s39, s39, 65536
    buffer_load_dwordx4 v2, s[12:15], s39 offen sc1 lds
    buffer_load_dwordx4 v2, s[12:15], s39 offen offset:1024 sc1 lds
    s_add_u32 m0, m0, 2048
    s_add_u32 s39, s39, 65536
    buffer_load_dwordx4 v2, s[12:15], s39 offen sc1 lds
    buffer_load_dwordx4 v2, s[12:15], s39 offen offset:1024 sc1 lds
    s_mov_b32 m0, s19
    s_mov_b32 s39, s16
    s_waitcnt vmcnt(12)
    s_barrier
    buffer_load_dwordx4 v2, s[12:15], s39 offen sc1 lds
    buffer_load_dwordx4 v2, s[12:15], s39 offen offset:1024 sc1 lds
    s_add_u32 s19, s41, s42
    v_readlane_b32 s16, v248, s44
    s_nop 0
    s_add_u32 s16, s16, s38
    s_add_u32 s44, s44, 1
    s_and_b32 s44, s44, 15
    s_add_u32 s42, s42, 16384
    s_cmp_eq_u32 s42, 49152
    s_cselect_b32 s42, 0, s42
    s_add_u32 m0, m0, 2048
    s_add_u32 s39, s39, 65536
    buffer_load_dwordx4 v2, s[12:15], s39 offen sc1 lds
    buffer_load_dwordx4 v2, s[12:15], s39 offen offset:1024 sc1 lds
    s_add_u32 m0, m0, 2048
    s_add_u32 s39, s39, 65536
    buffer_load_dwordx4 v2, s[12:15], s39 offen sc1 lds
    buffer_load_dwordx4 v2, s[12:15], s39 offen offset:1024 sc1 lds
    s_add_u32 m0, m0, 2048
    s_add_u32 s39, s39, 65536
    buffer_load_dwordx4 v2, s[12:15], s39 offen sc1 lds
    buffer_load_dwordx4 v2, s[12:15], s39 offen offset:1024 sc1 lds
    s_mov_b32 m0, s19
    s_mov_b32 s39, s16
    s_waitcnt vmcnt(16)
    v_readfirstlane_b32 s53, v223
    s_add_u32 s54, s52, 16
    s_cmp_eq_u32 s53, s54
    s_cbranch_scc1 fok_45
    s_mov_b32 s53, 0
    s_add_u32 s54, s52, 16
    s_bfm_b64 exec, 1, 0
poll_46:
    buffer_load_dword v223, v222, s[56:59], 0 offen sc1
    s_waitcnt vmcnt(0)
    v_xor_b32 v223, s54, v223
    v_cmp_eq_u32 vcc, 0, v223
    s_nop 0
    s_cmp_eq_u64 vcc, exec
    s_cbranch_scc1 pok_47
    s_sleep 5
    s_add_u32 s53, s53, 1
    s_cmp_lt_u32 s53, s61
    s_cbranch_scc1 poll_46
    s_mov_b32 s61, 0
pok_47:
    s_mov_b64 exec, -1
fok_45:
    s_add_u32 s20, s62, 0x5c8000
    s_addc_u32 s21, s63, 0
    s_mov_b32 s22, 0x6000
    s_mov_b32 s23, 0x20000
    s_and_b32 s35, s30, 1
    s_lshl_b32 s35, s35, 9
    s_add_u32 s36, s35, 0
    buffer_load_dwordx2 v[16:17], v221, s[20:23], s36 offen offset:0 sc1
    buffer_load_dwordx2 v[18:19], v221, s[20:23], s36 offen offset:1024 sc1
    buffer_load_dwordx2 v[20:21], v221, s[20:23], s36 offen offset:2048 sc1
    buffer_load_dwordx2 v[22:23], v221, s[20:23], s36 offen offset:3072 sc1
    s_cmp_lg_u32 s60, 0
    s_cbranch_scc1 pc_48
    v_add_f32 v180, v180, v184
    v_add_f32 v181, v181, v185
    v_add_f32 v182, v182, v186
    v_add_f32 v183, v183, v187
    v_add_f32 v180, v180, v188
    v_add_f32 v181, v181, v189
    v_add_f32 v182, v182, v190
    v_add_f32 v183, v183, v191
    v_add_f32 v180, v180, v192
    v_add_f32 v181, v181, v193
    v_add_f32 v182, v182, v194
    v_add_f32 v183, v183, v195
    v_add_f32 v180, v180, v196
    v_add_f32 v181, v181, v197
    v_add_f32 v182, v182, v198
    v_add_f32 v183, v183, v199
pc_48:
    s_waitcnt vmcnt(12)
    s_barrier
    buffer_load_dwordx4 v2, s[12:15], s39 offen sc1 lds
    buffer_load_dwordx4 v2, s[12:15], s39 offen offset:1024 sc1 lds
    s_add_u32 s19, s41, s42
    v_readlane_b32 s16, v248, s44
    s_nop 0
    s_add_u32 s16, s16, s38
    s_add_u32 s44, s44, 1
    s_and_b32 s44, s44, 15
    s_add_u32 s42, s42, 16384
    s_cmp_eq_u32 s42, 49152
    s_cselect_b32 s42, 0, s42
    s_add_u32 m0, m0, 2048
    s_add_u32 s39, s39, 65536
    buffer_load_dwordx4 v2, s[12:15], s39 offen sc1 lds
    buffer_load_dwordx4 v2, s[12:15], s39 offen offset:1024 sc1 lds
    s_add_u32 m0, m0, 2048
    s_add_u32 s39, s39, 65536
    buffer_load_dwordx4 v2, s[12:15], s39 offen sc1 lds
    buffer_load_dwordx4 v2, s[12:15], s39 offen offset:1024 sc1 lds
    s_add_u32 m0, m0, 2048
    s_add_u32 s39, s39, 65536
    buffer_load_dwordx4 v2, s[12:15], s39 offen sc1 lds
    buffer_load_dwordx4 v2, s[12:15], s39 offen offset:1024 sc1 lds
    s_mov_b32 m0, s19
    s_mov_b32 s39, s16
    s_add_u32 s36, s35, 4096
    buffer_load_dwordx2 v[24:25], v221, s[20:23], s36 offen offset:0 sc1
    buffer_load_dwordx2 v[26:27], v221, s[20:23], s36 offen offset:1024 sc1
    buffer_load_dwordx2 v[28:29], v221, s[20:23], s36 offen offset:2048 sc1
    buffer_load_dwordx2 v[30:31], v221, s[20:23], s36 offen offset:3072 sc1
    s_cmp_lg_u32 s60, 0
    s_cbranch_scc1 pc_49
    v_add_f32 v180, v180, v200
    v_add_f32 v181, v181, v201
    v_add_f32 v182, v182, v202
    v_add_f32 v183, v183, v203
    v_add_f32 v180, v180, v204
    v_add_f32 v181, v181, v205
    v_add_f32 v182, v182, v206
    v_add_f32 v183, v183, v207
    v_add_f32 v180, v180, v208
    v_add_f32 v181, v181, v209
    v_add_f32 v182, v182, v210
    v_add_f32 v183, v183, v211
    v_add_f32 v180, v180, v212
    v_add_f32 v181, v181, v213
    v_add_f32 v182, v182, v214
    v_add_f32 v183, v183, v215
pc_49:
    s_cmp_eq_u32 s60, 0
    s_cselect_b64 exec, -1, 0
    buffer_load_dwordx4 v[184:187], v224, s[24:27], s37 offen sc1
    s_add_u32 s37, s37, 28672
    buffer_load_dwordx4 v[188:191], v224, s[24:27], s37 offen sc1
    s_add_u32 s37, s37, 28672
    buffer_load_dwordx4 v[192:195], v224, s[24:27], s37 offen sc1
    s_add_u32 s37, s37, 28672
    s_mov_b64 exec, -1
    s_waitcnt vmcnt(19)
    s_barrier
    buffer_load_dwordx4 v2, s[12:15], s39 offen sc1 lds
    buffer_load_dwordx4 v2, s[12:15], s39 offen offset:1024 sc1 lds
    s_add_u32 s19, s41, s42
    v_readlane_b32 s16, v248, s44
    s_nop 0
    s_add_u32 s16, s16, s38
    s_add_u32 s44, s44, 1
    s_and_b32 s44, s44, 15
    s_add_u32 s42, s42, 16384
    s_cmp_eq_u32 s42, 49152
    s_cselect_b32 s42, 0, s42
    s_add_u32 m0, m0, 2048
    s_add_u32 s39, s39, 65536
    buffer_load_dwordx4 v2, s[12:15], s39 offen sc1 lds
    buffer_load_dwordx4 v2, s[12:15], s39 offen offset:1024 sc1 lds
    s_add_u32 m0, m0, 2048
    s_add_u32 s39, s39, 65536
    buffer_load_dwordx4 v2, s[12:15], s39 offen sc1 lds
    buffer_load_dwordx4 v2, s[12:15], s39 offen offset:1024 sc1 lds
    s_add_u32 m0, m0, 2048
    s_add_u32 s39, s39, 65536
    buffer_load_dwordx4 v2, s[12:15], s39 offen sc1 lds
    buffer_load_dwordx4 v2, s[12:15], s39 offen offset:1024 sc1 lds
    s_mov_b32 m0, s19
    s_mov_b32 s39, s16
    s_add_u32 s36, s35, 16384
    buffer_load_dwordx2 v[32:33], v221, s[20:23], s36 offen offset:0 sc1
    buffer_load_dwordx2 v[34:35], v221, s[20:23], s36 offen offset:1024 sc1
    buffer_load_dwordx2 v[36:37], v221, s[20:23], s36 offen offset:2048 sc1
    buffer_load_dwordx2 v[38:39], v221, s[20:23], s36 offen offset:3072 sc1
    s_cmp_eq_u32 s60, 0
    s_cselect_b64 exec, -1, 0
    buffer_load_dwordx4 v[196:199], v224, s[24:27], s37 offen sc1
    s_add_u32 s37, s37, 28672
    buffer_load_dwordx4 v[200:203], v224, s[24:27], s37 offen sc1
    s_add_u32 s37, s37, 28672
    s_mov_b64 exec, -1
    s_waitcnt vmcnt(21)
    s_barrier
    buffer_load_dwordx4 v2, s[12:15], s39 offen sc1 lds
    buffer_load_dwordx4 v2, s[12:15], s39 offen offset:1024 sc1 lds
    s_add_u32 s19, s41, s42
    v_readlane_b32 s16, v248, s44
    s_nop 0
    s_add_u32 s16, s16, s38
    s_add_u32 s44, s44, 1
    s_and_b32 s44, s44, 15
    s_add_u32 s42, s42, 16384
    s_cmp_eq_u32 s42, 49152
    s_cselect_b32 s42, 0, s42
    s_add_u32 m0, m0, 2048
    s_add_u32 s39, s39, 65536
    buffer_load_dwordx4 v2, s[12:15], s39 offen sc1 lds
    buffer_load_dwordx4 v2, s[12:15], s39 offen offset:1024 sc1 lds
    s_add_u32 m0, m0, 2048
    s_add_u32 s39, s39, 65536
    buffer_load_dwordx4 v2, s[12:15], s39 offen sc1 lds
    buffer_load_dwordx4 v2, s[12:15], s39 offen offset:1024 sc1 lds
    s_add_u32 m0, m0, 2048
    s_add_u32 s39, s39, 65536
    buffer_load_dwordx4 v2, s[12:15], s39 offen sc1 lds
    buffer_load_dwordx4 v2, s[12:15], s39 offen offset:1024 sc1 lds
    s_mov_b32 m0, s19
    s_mov_b32 s39, s16
    s_add_u32 s36, s35, 20480
    buffer_load_dwordx2 v[40:41], v221, s[20:23], s36 offen offset:0 sc1
    buffer_load_dwordx2 v[42:43], v221, s[20:23], s36 offen offset:1024 sc1
    buffer_load_dwordx2 v[44:45], v221, s[20:23], s36 offen offset:2048 sc1
    buffer_load_dwordx2 v[46:47], v221, s[20:23], s36 offen offset:3072 sc1
    s_cmp_eq_u32 s60, 0
    s_cselect_b64 exec, -1, 0
    buffer_load_dwordx4 v[204:207], v224, s[24:27], s37 offen sc1
    s_add_u32 s37, s37, 28672
    buffer_load_dwordx4 v[208:211], v224, s[24:27], s37 offen sc1
    s_add_u32 s37, s37, 28672
    s_mov_b64 exec, -1
    s_waitcnt vmcnt(20)
    s_barrier
    buffer_load_dwordx4 v2, s[12:15], s39 offen sc1 lds
    buffer_load_dwordx4 v2, s[12:15], s39 offen offset:1024 sc1 lds
    s_add_u32 s19, s41, s42
    v_readlane_b32 s16, v248, s44
    s_nop 0
    s_add_u32 s16, s16, s38
    s_add_u32 s44, s44, 1
    s_and_b32 s44, s44, 15
    s_add_u32 s42, s42, 16384
    s_cmp_eq_u32 s42, 49152
    s_cselect_b32 s42, 0, s42
    s_add_u32 m0, m0, 2048
    s_add_u32 s39, s39, 65536
    buffer_load_dwordx4 v2, s[12:15], s39 offen sc1 lds
    buffer_load_dwordx4 v2, s[12:15], s39 offen offset:1024 sc1 lds
    s_add_u32 m0, m0, 2048
    s_add_u32 s39, s39, 65536
    buffer_load_dwordx4 v2, s[12:15], s39 offen sc1 lds
    buffer_load_dwordx4 v2, s[12:15], s39 offen offset:1024 sc1 lds
    s_add_u32 m0, m0, 2048
    s_add_u32 s39, s39, 65536
    buffer_load_dwordx4 v2, s[12:15], s39 offen sc1 lds
    buffer_load_dwordx4 v2, s[12:15], s39 offen offset:1024 sc1 lds
    s_mov_b32 m0, s19
    s_mov_b32 s39, s16
    s_waitcnt vmcnt(14)
    s_barrier
    buffer_load_dwordx4 v2, s[12:15], s39 offen sc1 lds
    buffer_load_dwordx4 v2, s[12:15], s39 offen offset:1024 sc1 lds
    s_add_u32 s19, s41, s42
    v_readlane_b32 s16, v248, s44
    s_nop 0
    s_add_u32 s16, s16, s38
    s_add_u32 s44, s44, 1
    s_and_b32 s44, s44, 15
    s_add_u32 s42, s42, 16384
    s_cmp_eq_u32 s42, 49152
    s_cselect_b32 s42, 0, s42
    s_add_u32 m0, m0, 2048
    s_add_u32 s39, s39, 65536
    buffer_load_dwordx4 v2, s[12:15], s39 offen sc1 lds
    buffer_load_dwordx4 v2, s[12:15], s39 offen offset:1024 sc1 lds
    s_add_u32 m0, m0, 2048
    s_add_u32 s39, s39, 65536
    buffer_load_dwordx4 v2, s[12:15], s39 offen sc1 lds
    buffer_load_dwordx4 v2, s[12:15], s39 offen offset:1024 sc1 lds
    s_add_u32 m0, m0, 2048
    s_add_u32 s39, s39, 65536
    buffer_load_dwordx4 v2, s[12:15], s39 offen sc1 lds
    buffer_load_dwordx4 v2, s[12:15], s39 offen offset:1024 sc1 lds
    s_mov_b32 m0, s19
    s_mov_b32 s39, s16
    s_waitcnt vmcnt(16)
    v_add_f32 v16, v16, v32
    v_add_f32 v17, v17, v33
    v_add_f32 v18, v18, v34
    v_add_f32 v19, v19, v35
    v_add_f32 v20, v20, v36
    v_add_f32 v21, v21, v37
    v_add_f32 v22, v22, v38
    v_add_f32 v23, v23, v39
    v_add_f32 v24, v24, v40
    v_add_f32 v25, v25, v41
    v_add_f32 v26, v26, v42
    v_add_f32 v27, v27, v43
    v_add_f32 v28, v28, v44
    v_add_f32 v29, v29, v45
    v_add_f32 v30, v30, v46
    v_add_f32 v31, v31, v47
    s_waitcnt vmcnt(8)
    s_barrier
    buffer_load_dwordx4 v2, s[12:15], s39 offen sc1 lds
    buffer_load_dwordx4 v2, s[12:15], s39 offen offset:1024 sc1 lds
    s_add_u32 s19, s41, s42
    v_readlane_b32 s16, v248, s44
    s_nop 0
    s_add_u32 s16, s16, s38
    s_add_u32 s44, s44, 1
    s_and_b32 s44, s44, 15
    s_add_u32 s42, s42, 16384
    s_cmp_eq_u32 s42, 49152
    s_cselect_b32 s42, 0, s42
    s_add_u32 m0, m0, 2048
    s_add_u32 s39, s39, 65536
    buffer_load_dwordx4 v2, s[12:15], s39 offen sc1 lds
    buffer_load_dwordx4 v2, s[12:15], s39 offen offset:1024 sc1 lds
    s_add_u32 m0, m0, 2048
    s_add_u32 s39, s39, 65536
    buffer_load_dwordx4 v2, s[12:15], s39 offen sc1 lds
    buffer_load_dwordx4 v2, s[12:15], s39 offen offset:1024 sc1 lds
    s_add_u32 m0, m0, 2048
    s_add_u32 s39, s39, 65536
    buffer_load_dwordx4 v2, s[12:15], s39 offen sc1 lds
    buffer_load_dwordx4 v2, s[12:15], s39 offen offset:1024 sc1 lds
    s_mov_b32 m0, s19
    s_mov_b32 s39, s16
    v_add_f32 v16, v16, v24
    v_add_f32 v17, v17, v25
    v_add_f32 v18, v18, v26
    v_add_f32 v19, v19, v27
    v_add_f32 v20, v20, v28
    v_add_f32 v21, v21, v29
    v_add_f32 v22, v22, v30
    v_add_f32 v23, v23, v31
    v_add_f32 v16, v16, v20
    v_add_f32 v17, v17, v21
    v_add_f32 v18, v18, v22
    v_add_f32 v19, v19, v23
    v_add_f32 v16, v16, v18
    v_add_f32 v17, v17, v19
    v_mul_f32 v20, 0x3a800000, v16
    v_mul_f32 v217, 0x3a800000, v17
    s_cmp_lg_u32 s60, 0
    s_cbranch_scc1 pc_52
    v_add_f32 v180, v180, v184
    v_add_f32 v181, v181, v185
    v_add_f32 v182, v182, v186
    v_add_f32 v183, v183, v187
    v_add_f32 v180, v180, v188
    v_add_f32 v181, v181, v189
    v_add_f32 v182, v182, v190
    v_add_f32 v183, v183, v191
    v_add_f32 v180, v180, v192
    v_add_f32 v181, v181, v193
    v_add_f32 v182, v182, v194
    v_add_f32 v183, v183, v195
pc_52:
    s_waitcnt vmcnt(8)
    s_barrier
    buffer_load_dwordx4 v2, s[12:15], s39 offen sc1 lds
    buffer_load_dwordx4 v2, s[12:15], s39 offen offset:1024 sc1 lds
    s_add_u32 s19, s41, s42
    v_readlane_b32 s16, v248, s44
    s_nop 0
    s_add_u32 s16, s16, s38
    s_add_u32 s44, s44, 1
    s_and_b32 s44, s44, 15
    s_add_u32 s42, s42, 16384
    s_cmp_eq_u32 s42, 49152
    s_cselect_b32 s42, 0, s42
    s_add_u32 m0, m0, 2048
    s_add_u32 s39, s39, 65536
    buffer_load_dwordx4 v2, s[12:15], s39 offen sc1 lds
    buffer_load_dwordx4 v2, s[12:15], s39 offen offset:1024 sc1 lds
    s_add_u32 m0, m0, 2048
    s_add_u32 s39, s39, 65536
    buffer_load_dwordx4 v2, s[12:15], s39 offen sc1 lds
    buffer_load_dwordx4 v2, s[12:15], s39 offen offset:1024 sc1 lds
    s_add_u32 m0, m0, 2048
    s_add_u32 s39, s39, 65536
    buffer_load_dwordx4 v2, s[12:15], s39 offen sc1 lds
    buffer_load_dwordx4 v2, s[12:15], s39 offen offset:1024 sc1 lds
    s_mov_b32 m0, s19
    s_mov_b32 s39, s16
    v_fma_f32 v217, -v20, v20, v217
    v_max_f32 v217, 0, v217
    v_add_f32 v217, 0x3727c5ac, v217
    v_sqrt_f32 v217, v217
    s_nop 0
    v_mov_b32 v21, v217
    v_rcp_f32 v219, v217
    s_nop 0
    v_mul_f32 v22, 0xc0135761, v219
    v_mul_f32 v23, v219, v219
    v_mul_f32 v23, v23, v22
    v_mul_f32 v23, 0x3d372713, v23
    s_lshl_b32 s35, s35, 1
    s_add_u32 s35, s35, 160768
    v_add_u32 v220, s35, v2
    ds_write_b128 v220, v[20:23]
    s_waitcnt lgkmcnt(0)
    s_waitcnt vmcnt(8)
    s_barrier
    buffer_load_dwordx4 v2, s[12:15], s39 offen sc1 lds
    buffer_load_dwordx4 v2, s[12:15], s39 offen offset:1024 sc1 lds
    s_add_u32 m0, m0, 2048
    s_add_u32 s39, s39, 65536
    buffer_load_dwordx4 v2, s[12:15], s39 offen sc1 lds
    buffer_load_dwordx4 v2, s[12:15], s39 offen offset:1024 sc1 lds
    s_add_u32 m0, m0, 2048
    s_add_u32 s39, s39, 65536
    buffer_load_dwordx4 v2, s[12:15], s39 offen sc1 lds
    buffer_load_dwordx4 v2, s[12:15], s39 offen offset:1024 sc1 lds
    s_add_u32 m0, m0, 2048
    s_add_u32 s39, s39, 65536
    buffer_load_dwordx4 v2, s[12:15], s39 offen sc1 lds
    buffer_load_dwordx4 v2, s[12:15], s39 offen offset:1024 sc1 lds
    s_cmp_lg_u32 s60, 0
    s_cbranch_scc1 pc_54
    v_add_f32 v180, v180, v196
    v_add_f32 v181, v181, v197
    v_add_f32 v182, v182, v198
    v_add_f32 v183, v183, v199
    v_add_f32 v180, v180, v200
    v_add_f32 v181, v181, v201
    v_add_f32 v182, v182, v202
    v_add_f32 v183, v183, v203
    v_add_f32 v180, v180, v204
    v_add_f32 v181, v181, v205
    v_add_f32 v182, v182, v206
    v_add_f32 v183, v183, v207
    v_add_f32 v180, v180, v208
    v_add_f32 v181, v181, v209
    v_add_f32 v182, v182, v210
    v_add_f32 v183, v183, v211
pc_54:
    s_waitcnt vmcnt(8)
    s_barrier
    s_cmp_lg_u32 s60, 0
    s_cbranch_scc1 pc_55
    v_mov_b32 v184, v180
    v_mov_b32 v185, v181
    v_mov_b32 v186, v182
    v_mov_b32 v187, v183
    v_permlane32_swap_b32 v180, v184
    v_permlane32_swap_b32 v181, v185
    v_permlane32_swap_b32 v182, v186
    v_permlane32_swap_b32 v183, v187
    v_add_f32 v180, v180, v184
    v_add_f32 v181, v181, v185
    v_add_f32 v182, v182, v186
    v_add_f32 v183, v183, v187
    s_and_b32 s36, s30, 1
    s_mul_i32 s36, s36, 448
    s_add_u32 s36, s36, 159744
    v_add_u32 v179, s36, v2
    s_bfm_b64 exec, 28, 0
    ds_write_b128 v179, v[180:183]
    s_mov_b64 exec, -1
    s_waitcnt lgkmcnt(0)
pc_55:
    s_waitcnt vmcnt(0)
    s_barrier
    s_cmp_lg_u32 s60, 0
    s_cbranch_scc1 tw4_56
    s_load_dwordx2 s[48:49], s[0:1], 80
    s_lshl_b32 s45, s2, 1
    s_and_b32 s50, s30, 1
    s_add_u32 s45, s45, s50
    s_mul_i32 s45, s45, 14336
    s_mov_b32 s50, 7340032
    s_mov_b32 s51, 0x20000
    s_waitcnt lgkmcnt(0)
    buffer_load_dwordx4 v[20:23], v2, s[48:51], s45 offen offset:0
    buffer_load_dwordx4 v[20:23], v2, s[48:51], s45 offen offset:1024
    buffer_load_dwordx4 v[20:23], v2, s[48:51], s45 offen offset:2048
    buffer_load_dwordx4 v[20:23], v2, s[48:51], s45 offen offset:3072
    s_add_u32 s45, s45, 4096
    buffer_load_dwordx4 v[20:23], v2, s[48:51], s45 offen offset:0
    buffer_load_dwordx4 v[20:23], v2, s[48:51], s45 offen offset:1024
    buffer_load_dwordx4 v[20:23], v2, s[48:51], s45 offen offset:2048
    buffer_load_dwordx4 v[20:23], v2, s[48:51], s45 offen offset:3072
    s_add_u32 s45, s45, 4096
    buffer_load_dwordx4 v[20:23], v2, s[48:51], s45 offen offset:0
    buffer_load_dwordx4 v[20:23], v2, s[48:51], s45 offen offset:1024
    buffer_load_dwordx4 v[20:23], v2, s[48:51], s45 offen offset:2048
    buffer_load_dwordx4 v[20:23], v2, s[48:51], s45 offen offset:3072
    s_add_u32 s45, s45, 4096
    buffer_load_dwordx4 v[20:23], v2, s[48:51], s45 offen offset:0
    buffer_load_dwordx4 v[20:23], v2, s[48:51], s45 offen offset:1024
tw4_56:
    s_barrier
    s_cmp_lg_u32 s60, 0
    s_cbranch_scc1 rp_57
    s_call_b64 s[76:77], SUB_r_pre
rp_57:
    s_and_b32 s35, s30, 1
    s_add_u32 s12, s62, 0x400000
    s_addc_u32 s13, s63, 0
    s_mov_b32 s14, 0x1be000
    s_mov_b32 s15, 0x20000
    s_mul_i32 s38, s35, 917504
    s_mul_i32 s36, s31, 114688
    s_add_u32 s38, s38, s36
    s_lshl_b32 s41, s35, 13
    s_mov_b32 s42, 0
    s_mov_b32 s44, 0
    s_add_u32 s54, s55, 0x700
    s_lshl_b32 s53, s31, 7
    s_add_u32 s54, s54, s53
    v_mov_b32 v9, s54
    s_add_u32 s54, s55, 0x600
    s_lshl_b32 s53, s31, 7
    s_add_u32 s54, s54, s53
    v_mov_b32 v10, s54
    s_add_u32 s54, s55, 0x300
    s_lshl_b32 s53, s31, 7
    s_add_u32 s54, s54, s53
    v_mov_b32 v12, s54
    v_mov_b32 v13, 1
    s_and_b32 s51, s30, 1
    s_lshl_b32 s51, s51, 30
    s_lshl_b32 s54, s60, 2
    s_add_u32 s54, s54, 4
    v_mov_b32 v14, 162880
spin_58:
    s_sleep 2
    ds_read_b32 v15, v14
    s_waitcnt lgkmcnt(0)
    v_readfirstlane_b32 s53, v15
    s_nop 0
    s_cmp_ge_u32 s53, s54
    s_cbranch_scc0 spin_58
    s_mov_b64 exec, 1
    buffer_atomic_add v13, v9, s[56:59], s51 offen sc1
    s_mov_b64 exec, -1
    v_xor_b32 v15, 128, v12
    s_mov_b32 s44, 3
    s_call_b64 s[76:77], PREP_a_issue_4
    s_mov_b32 m0, s19
    s_mov_b32 s39, s16
    s_mov_b32 s40, s17
    s_waitcnt vmcnt(16)
    s_barrier
    s_mov_b64 exec, 1
    buffer_load_dword v8, v9, s[56:59], 0 offen sc1
    s_mov_b64 exec, -1
    s_waitcnt vmcnt(9)
    s_barrier
    s_waitcnt vmcnt(0)
    v_readfirstlane_b32 s53, v8
    s_add_u32 s54, s52, 8
    s_cmp_eq_u32 s53, s54
    s_cbranch_scc1 fok_59
    s_mov_b32 s53, 0
    s_add_u32 s54, s52, 8
    s_bfm_b64 exec, 1, 0
poll_60:
    buffer_load_dword v8, v9, s[56:59], 0 offen sc1
    s_waitcnt vmcnt(0)
    v_xor_b32 v8, s54, v8
    v_cmp_eq_u32 vcc, 0, v8
    s_nop 0
    s_cmp_eq_u64 vcc, exec
    s_cbranch_scc1 pok_61
    s_sleep 5
    s_add_u32 s53, s53, 1
    s_cmp_lt_u32 s53, s61
    s_cbranch_scc1 poll_60
    s_mov_b32 s61, 0
pok_61:
    s_mov_b64 exec, -1
fok_59:
    buffer_load_dwordx4 v2, s[12:15], s39 offen sc1 lds
    s_add_u32 m0, m0, 1024
    s_nop 0
    buffer_load_dwordx4 v2, s[12:15], s40 offen sc1 lds
    s_call_b64 s[76:77], PREP_a_issue_4
    s_add_u32 m0, m0, 1024
    s_add_u32 s39, s39, 229376
    buffer_load_dwordx4 v2, s[12:15], s39 offen sc1 lds
    s_add_u32 m0, m0, 1024
    s_add_u32 s40, s40, 229376
    buffer_load_dwordx4 v2, s[12:15], s40 offen sc1 lds
    s_add_u32 m0, m0, 1024
    s_add_u32 s39, s39, 229376
    buffer_load_dwordx4 v2, s[12:15], s39 offen sc1 lds
    s_add_u32 m0, m0, 1024
    s_add_u32 s40, s40, 229376
    buffer_load_dwordx4 v2, s[12:15], s40 offen sc1 lds
    s_add_u32 m0, m0, 1024
    s_add_u32 s39, s39, 229376
    buffer_load_dwordx4 v2, s[12:15], s39 offen sc1 lds
    s_add_u32 m0, m0, 1024
    s_add_u32 s40, s40, 229376
    buffer_load_dwordx4 v2, s[12:15], s40 offen sc1 lds
    s_mov_b32 m0, s19
    s_mov_b32 s39, s16
    s_mov_b32 s40, s17
    s_waitcnt vmcnt(9)
    s_barrier
    s_mov_b64 exec, 1
    buffer_atomic_add v13, v10, s[56:59], s51 offen sc1
    s_mov_b64 exec, -1
    buffer_load_dwordx4 v2, s[12:15], s39 offen sc1 lds
    s_add_u32 m0, m0, 1024
    s_nop 0
    buffer_load_dwordx4 v2, s[12:15], s40 offen sc1 lds
    s_call_b64 s[76:77], PREP_a_issue_4
    s_add_u32 m0, m0, 1024
    s_add_u32 s39, s39, 229376
    buffer_load_dwordx4 v2, s[12:15], s39 offen sc1 lds
    s_add_u32 m0, m0, 1024
    s_add_u32 s40, s40, 229376
    buffer_load_dwordx4 v2, s[12:15], s40 offen sc1 lds
    s_add_u32 m0, m0, 1024
    s_add_u32 s39, s39, 229376
    buffer_load_dwordx4 v2, s[12:15], s39 offen sc1 lds
    s_add_u32 m0, m0, 1024
    s_add_u32 s40, s40, 229376
    buffer_load_dwordx4 v2, s[12:15], s40 offen sc1 lds
    s_add_u32 m0, m0, 1024
    s_add_u32 s39, s39, 229376
    buffer_load_dwordx4 v2, s[12:15], s39 offen sc1 lds
    s_add_u32 m0, m0, 1024
    s_add_u32 s40, s40, 229376
    buffer_load_dwordx4 v2, s[12:15], s40 offen sc1 lds
    s_mov_b32 m0, s19
    s_mov_b32 s39, s16
    s_mov_b32 s40, s17
    s_waitcnt vmcnt(9)
    s_barrier
    buffer_load_dwordx4 v2, s[12:15], s39 offen sc1 lds
    s_add_u32 m0, m0, 1024
    s_nop 0
    buffer_load_dwordx4 v2, s[12:15], s40 offen sc1 lds
    s_call_b64 s[76:77], PREP_a_issue_4
    s_add_u32 m0, m0, 1024
    s_add_u32 s39, s39, 229376
    buffer_load_dwordx4 v2, s[12:15], s39 offen sc1 lds
    s_add_u32 m0, m0, 1024
    s_add_u32 s40, s40, 229376
    buffer_load_dwordx4 v2, s[12:15], s40 offen sc1 lds
    s_add_u32 m0, m0, 1024
    s_add_u32 s39, s39, 229376
    buffer_load_dwordx4 v2, s[12:15], s39 offen sc1 lds
    s_add_u32 m0, m0, 1024
    s_add_u32 s40, s40, 229376
    buffer_load_dwordx4 v2, s[12:15], s40 offen sc1 lds
    s_add_u32 m0, m0, 1024
    s_add_u32 s39, s39, 229376
    buffer_load_dwordx4 v2, s[12:15], s39 offen sc1 lds
    s_add_u32 m0, m0, 1024
    s_add_u32 s40, s40, 229376
    buffer_load_dwordx4 v2, s[12:15], s40 offen sc1 lds
    s_mov_b32 m0, s19
    s_mov_b32 s39, s16
    s_mov_b32 s40, s17
    s_waitcnt vmcnt(8)
    s_barrier
    buffer_load_dwordx4 v2, s[12:15], s39 offen sc1 lds
    s_add_u32 m0, m0, 1024
    s_nop 0
    buffer_load_dwordx4 v2, s[12:15], s40 offen sc1 lds
    s_mov_b64 exec, 1
    buffer_load_dword v11, v10, s[56:59], 0 offen sc1
    s_mov_b64 exec, -1
    s_call_b64 s[76:77], PREP_a_issue_4
    s_add_u32 m0, m0, 1024
    s_add_u32 s39, s39, 229376
    buffer_load_dwordx4 v2, s[12:15], s39 offen sc1 lds
    s_add_u32 m0, m0, 1024
    s_add_u32 s40, s40, 229376
    buffer_load_dwordx4 v2, s[12:15], s40 offen sc1 lds
    s_add_u32 m0, m0, 1024
    s_add_u32 s39, s39, 229376
    buffer_load_dwordx4 v2, s[12:15], s39 offen sc1 lds
    s_add_u32 m0, m0, 1024
    s_add_u32 s40, s40, 229376
    buffer_load_dwordx4 v2, s[12:15], s40 offen sc1 lds
    s_add_u32 m0, m0, 1024
    s_add_u32 s39, s39, 229376
    buffer_load_dwordx4 v2, s[12:15], s39 offen sc1 lds
    s_add_u32 m0, m0, 1024
    s_add_u32 s40, s40, 229376
    buffer_load_dwordx4 v2, s[12:15], s40 offen sc1 lds
    s_mov_b32 m0, s19
    s_mov_b32 s39, s16
    s_mov_b32 s40, s17
    s_waitcnt vmcnt(9)
    s_barrier
    s_mov_b64 exec, 1
    buffer_atomic_add v13, v12, s[56:59], s51 offen sc1
    s_mov_b64 exec, -1
    buffer_load_dwordx4 v2, s[12:15], s39 offen sc1 lds
    s_add_u32 m0, m0, 1024
    s_nop 0
    buffer_load_dwordx4 v2, s[12:15], s40 offen sc1 lds
    s_call_b64 s[76:77], PREP_a_issue_4
    s_add_u32 m0, m0, 1024
    s_add_u32 s39, s39, 229376
    buffer_load_dwordx4 v2, s[12:15], s39 offen sc1 lds
    s_add_u32 m0, m0, 1024
    s_add_u32 s40, s40, 229376
    buffer_load_dwordx4 v2, s[12:15], s40 offen sc1 lds
    s_add_u32 m0, m0, 1024
    s_add_u32 s39, s39, 229376
    buffer_load_dwordx4 v2, s[12:15], s39 offen sc1 lds
    s_add_u32 m0, m0, 1024
    s_add_u32 s40, s40, 229376
    buffer_load_dwordx4 v2, s[12:15], s40 offen sc1 lds
    s_add_u32 m0, m0, 1024
    s_add_u32 s39, s39, 229376
    buffer_load_dwordx4 v2, s[12:15], s39 offen sc1 lds
    s_add_u32 m0, m0, 1024
    s_add_u32 s40, s40, 229376
    buffer_load_dwordx4 v2, s[12:15], s40 offen sc1 lds
    s_mov_b32 m0, s19
    s_mov_b32 s39, s16
    s_mov_b32 s40, s17
    s_waitcnt vmcnt(9)
    s_barrier
    buffer_load_dwordx4 v2, s[12:15], s39 offen sc1 lds
    s_add_u32 m0, m0, 1024
    s_nop 0
    buffer_load_dwordx4 v2, s[12:15], s40 offen sc1 lds
    s_waitcnt vmcnt(17)
    v_readfirstlane_b32 s53, v11
    s_add_u32 s54, s52, 8
    s_cmp_eq_u32 s53, s54
    s_cbranch_scc1 fok_62
    s_mov_b32 s53, 0
    s_add_u32 s54, s52, 8
    s_bfm_b64 exec, 1, 0
poll_63:
    buffer_load_dword v11, v10, s[56:59], 0 offen sc1
    s_waitcnt vmcnt(0)
    v_xor_b32 v11, s54, v11
    v_cmp_eq_u32 vcc, 0, v11
    s_nop 0
    s_cmp_eq_u64 vcc, exec
    s_cbranch_scc1 pok_64
    s_sleep 5
    s_add_u32 s53, s53, 1
    s_cmp_lt_u32 s53, s61
    s_cbranch_scc1 poll_63
    s_mov_b32 s61, 0
pok_64:
    s_mov_b64 exec, -1
fok_62:
    s_call_b64 s[76:77], PREP_a_issue_4
    s_add_u32 m0, m0, 1024
    s_add_u32 s39, s39, 229376
    buffer_load_dwordx4 v2, s[12:15], s39 offen sc1 lds
    s_add_u32 m0, m0, 1024
    s_add_u32 s40, s40, 229376
    buffer_load_dwordx4 v2, s[12:15], s40 offen sc1 lds
    s_add_u32 m0, m0, 1024
    s_add_u32 s39, s39, 229376
    buffer_load_dwordx4 v2, s[12:15], s39 offen sc1 lds
    s_add_u32 m0, m0, 1024
    s_add_u32 s40, s40, 229376
    buffer_load_dwordx4 v2, s[12:15], s40 offen sc1 lds
    s_add_u32 m0, m0, 1024
    s_add_u32 s39, s39, 229376
    buffer_load_dwordx4 v2, s[12:15], s39 offen sc1 lds
    s_add_u32 m0, m0, 1024
    s_add_u32 s40, s40, 229376
    buffer_load_dwordx4 v2, s[12:15], s40 offen sc1 lds
    s_mov_b32 m0, s19
    s_mov_b32 s39, s16
    s_mov_b32 s40, s17
    s_waitcnt vmcnt(8)
    s_barrier
    buffer_load_dwordx4 v2, s[12:15], s39 offen sc1 lds
    s_add_u32 m0, m0, 1024
    s_nop 0
    buffer_load_dwordx4 v2, s[12:15], s40 offen sc1 lds
    s_mov_b32 s43, 1
ld_65:
    s_add_u32 s19, s41, s42
    v_readlane_b32 s16, v249, s44
    v_readlane_b32 s17, v250, s44
    s_add_u32 s16, s16, s38
    s_add_u32 s17, s17, s38
    s_add_u32 s44, s44, 1
    s_add_u32 s42, s42, 16384
    s_cmp_eq_u32 s42, 49152
    s_cselect_b32 s42, 0, s42
    s_add_u32 m0, m0, 1024
    s_add_u32 s39, s39, 229376
    buffer_load_dwordx4 v2, s[12:15], s39 offen sc1 lds
    s_add_u32 m0, m0, 1024
    s_add_u32 s40, s40, 229376
    buffer_load_dwordx4 v2, s[12:15], s40 offen sc1 lds
    s_add_u32 m0, m0, 1024
    s_add_u32 s39, s39, 229376
    buffer_load_dwordx4 v2, s[12:15], s39 offen sc1 lds
    s_add_u32 m0, m0, 1024
    s_add_u32 s40, s40, 229376
    buffer_load_dwordx4 v2, s[12:15], s40 offen sc1 lds
    s_add_u32 m0, m0, 1024
    s_add_u32 s39, s39, 229376
    buffer_load_dwordx4 v2, s[12:15], s39 offen sc1 lds
    s_add_u32 m0, m0, 1024
    s_add_u32 s40, s40, 229376
    buffer_load_dwordx4 v2, s[12:15], s40 offen sc1 lds
    s_mov_b32 m0, s19
    s_mov_b32 s39, s16
    s_mov_b32 s40, s17
    s_waitcnt vmcnt(8)
    s_barrier
    buffer_load_dwordx4 v2, s[12:15], s39 offen sc1 lds
    s_add_u32 m0, m0, 1024
    s_nop 0
    buffer_load_dwordx4 v2, s[12:15], s40 offen sc1 lds
    s_add_u32 s43, s43, 1
    s_cmp_lt_u32 s43, 4
    s_cbranch_scc1 ld_65
    s_call_b64 s[76:77], PREP_a_issue_4
    s_add_u32 m0, m0, 1024
    s_add_u32 s39, s39, 229376
    buffer_load_dwordx4 v2, s[12:15], s39 offen sc1 lds
    s_add_u32 m0, m0, 1024
    s_add_u32 s40, s40, 229376
    buffer_load_dwordx4 v2, s[12:15], s40 offen sc1 lds
    s_add_u32 m0, m0, 1024
    s_add_u32 s39, s39, 229376
    buffer_load_dwordx4 v2, s[12:15], s39 offen sc1 lds
    s_add_u32 m0, m0, 1024
    s_add_u32 s40, s40, 229376
    buffer_load_dwordx4 v2, s[12:15], s40 offen sc1 lds
    s_add_u32 m0, m0, 1024
    s_add_u32 s39, s39, 229376
    buffer_load_dwordx4 v2, s[12:15], s39 offen sc1 lds
    s_add_u32 m0, m0, 1024
    s_add_u32 s40, s40, 229376
    buffer_load_dwordx4 v2, s[12:15], s40 offen sc1 lds
    s_mov_b32 m0, s19
    s_mov_b32 s39, s16
    s_mov_b32 s40, s17
    s_waitcnt vmcnt(8)
    s_barrier
    buffer_load_dwordx4 v2, s[12:15], s39 offen sc1 lds
    s_add_u32 m0, m0, 1024
    s_nop 0
    buffer_load_dwordx4 v2, s[12:15], s40 offen sc1 lds
    s_mov_b64 exec, 1
    buffer_load_dword v11, v12, s[56:59], 0 offen sc1
    s_mov_b64 exec, -1
    s_call_b64 s[76:77], PREP_a_issue_4
    s_add_u32 m0, m0, 1024
    s_add_u32 s39, s39, 229376
    buffer_load_dwordx4 v2, s[12:15], s39 offen sc1 lds
    s_add_u32 m0, m0, 1024
    s_add_u32 s40, s40, 229376
    buffer_load_dwordx4 v2, s[12:15], s40 offen sc1 lds
    s_add_u32 m0, m0, 1024
    s_add_u32 s39, s39, 229376
    buffer_load_dwordx4 v2, s[12:15], s39 offen sc1 lds
    s_add_u32 m0, m0, 1024
    s_add_u32 s40, s40, 229376
    buffer_load_dwordx4 v2, s[12:15], s40 offen sc1 lds
    s_add_u32 m0, m0, 1024
    s_add_u32 s39, s39, 229376
    buffer_load_dwordx4 v2, s[12:15], s39 offen sc1 lds
    s_add_u32 m0, m0, 1024
    s_add_u32 s40, s40, 229376
    buffer_load_dwordx4 v2, s[12:15], s40 offen sc1 lds
    s_mov_b32 m0, s19
    s_mov_b32 s39, s16
    s_mov_b32 s40, s17
    s_waitcnt vmcnt(9)
    s_barrier
    buffer_load_dwordx4 v2, s[12:15], s39 offen sc1 lds
    s_add_u32 m0, m0, 1024
    s_nop 0
    buffer_load_dwordx4 v2, s[12:15], s40 offen sc1 lds
    s_call_b64 s[76:77], PREP_a_issue_4
    s_add_u32 m0, m0, 1024
    s_add_u32 s39, s39, 229376
    buffer_load_dwordx4 v2, s[12:15], s39 offen sc1 lds
    s_add_u32 m0, m0, 1024
    s_add_u32 s40, s40, 229376
    buffer_load_dwordx4 v2, s[12:15], s40 offen sc1 lds
    s_add_u32 m0, m0, 1024
    s_add_u32 s39, s39, 229376
    buffer_load_dwordx4 v2, s[12:15], s39 offen sc1 lds
    s_add_u32 m0, m0, 1024
    s_add_u32 s40, s40, 229376
    buffer_load_dwordx4 v2, s[12:15], s40 offen sc1 lds
    s_add_u32 m0, m0, 1024
    s_add_u32 s39, s39, 229376
    buffer_load_dwordx4 v2, s[12:15], s39 offen sc1 lds
    s_add_u32 m0, m0, 1024
    s_add_u32 s40, s40, 229376
    buffer_load_dwordx4 v2, s[12:15], s40 offen sc1 lds
    s_mov_b32 m0, s19
    s_mov_b32 s39, s16
    s_mov_b32 s40, s17
    s_waitcnt vmcnt(8)
    s_barrier
    buffer_load_dwordx4 v2, s[12:15], s39 offen sc1 lds
    s_add_u32 m0, m0, 1024
    s_nop 0
    buffer_load_dwordx4 v2, s[12:15], s40 offen sc1 lds
    s_waitcnt vmcnt(16)
    v_readfirstlane_b32 s53, v11
    s_add_u32 s54, s52, 8
    s_cmp_eq_u32 s53, s54
    s_cbranch_scc1 fok_66
    s_mov_b32 s53, 0
    s_add_u32 s54, s52, 8
    s_bfm_b64 exec, 1, 0
poll_67:
    buffer_load_dword v11, v12, s[56:59], 0 offen sc1
    s_waitcnt vmcnt(0)
    v_xor_b32 v11, s54, v11
    v_cmp_eq_u32 vcc, 0, v11
    s_nop 0
    s_cmp_eq_u64 vcc, exec
    s_cbranch_scc1 pok_68
    s_sleep 5
    s_add_u32 s53, s53, 1
    s_cmp_lt_u32 s53, s61
    s_cbranch_scc1 poll_67
    s_mov_b32 s61, 0
pok_68:
    s_mov_b64 exec, -1
fok_66:
    s_call_b64 s[76:77], PREP_a_issue_4
    s_add_u32 m0, m0, 1024
    s_add_u32 s39, s39, 229376
    buffer_load_dwordx4 v2, s[12:15], s39 offen sc1 lds
    s_add_u32 m0, m0, 1024
    s_add_u32 s40, s40, 229376
    buffer_load_dwordx4 v2, s[12:15], s40 offen sc1 lds
    s_add_u32 m0, m0, 1024
    s_add_u32 s39, s39, 229376
    buffer_load_dwordx4 v2, s[12:15], s39 offen sc1 lds
    s_add_u32 m0, m0, 1024
    s_add_u32 s40, s40, 229376
    buffer_load_dwordx4 v2, s[12:15], s40 offen sc1 lds
    s_add_u32 m0, m0, 1024
    s_add_u32 s39, s39, 229376
    buffer_load_dwordx4 v2, s[12:15], s39 offen sc1 lds
    s_add_u32 m0, m0, 1024
    s_add_u32 s40, s40, 229376
    buffer_load_dwordx4 v2, s[12:15], s40 offen sc1 lds
    s_mov_b32 m0, s19
    s_mov_b32 s39, s16
    s_mov_b32 s40, s17
    s_waitcnt vmcnt(8)
    s_barrier
    buffer_load_dwordx4 v2, s[12:15], s39 offen sc1 lds
    s_add_u32 m0, m0, 1024
    s_nop 0
    buffer_load_dwordx4 v2, s[12:15], s40 offen sc1 lds
    s_mov_b32 s43, 1
ld_69:
    s_add_u32 s19, s41, s42
    v_readlane_b32 s16, v249, s44
    v_readlane_b32 s17, v250, s44
    s_add_u32 s16, s16, s38
    s_add_u32 s17, s17, s38
    s_add_u32 s44, s44, 1
    s_add_u32 s42, s42, 16384
    s_cmp_eq_u32 s42, 49152
    s_cselect_b32 s42, 0, s42
    s_add_u32 m0, m0, 1024
    s_add_u32 s39, s39, 229376
    buffer_load_dwordx4 v2, s[12:15], s39 offen sc1 lds
    s_add_u32 m0, m0, 1024
    s_add_u32 s40, s40, 229376
    buffer_load_dwordx4 v2, s[12:15], s40 offen sc1 lds
    s_add_u32 m0, m0, 1024
    s_add_u32 s39, s39, 229376
    buffer_load_dwordx4 v2, s[12:15], s39 offen sc1 lds
    s_add_u32 m0, m0, 1024
    s_add_u32 s40, s40, 229376
    buffer_load_dwordx4 v2, s[12:15], s40 offen sc1 lds
    s_add_u32 m0, m0, 1024
    s_add_u32 s39, s39, 229376
    buffer_load_dwordx4 v2, s[12:15], s39 offen sc1 lds
    s_add_u32 m0, m0, 1024
    s_add_u32 s40, s40, 229376
    buffer_load_dwordx4 v2, s[12:15], s40 offen sc1 lds
    s_mov_b32 m0, s19
    s_mov_b32 s39, s16
    s_mov_b32 s40, s17
    s_waitcnt vmcnt(8)
    s_barrier
    buffer_load_dwordx4 v2, s[12:15], s39 offen sc1 lds
    s_add_u32 m0, m0, 1024
    s_nop 0
    buffer_load_dwordx4 v2, s[12:15], s40 offen sc1 lds
    s_add_u32 s43, s43, 1
    s_cmp_lt_u32 s43, 5
    s_cbranch_scc1 ld_69
    s_call_b64 s[76:77], PREP_a_issue_4
    s_add_u32 m0, m0, 1024
    s_add_u32 s39, s39, 229376
    buffer_load_dwordx4 v2, s[12:15], s39 offen sc1 lds
    s_add_u32 m0, m0, 1024
    s_add_u32 s40, s40, 229376
    buffer_load_dwordx4 v2, s[12:15], s40 offen sc1 lds
    s_add_u32 m0, m0, 1024
    s_add_u32 s39, s39, 229376
    buffer_load_dwordx4 v2, s[12:15], s39 offen sc1 lds
    s_add_u32 m0, m0, 1024
    s_add_u32 s40, s40, 229376
    buffer_load_dwordx4 v2, s[12:15], s40 offen sc1 lds
    s_add_u32 m0, m0, 1024
    s_add_u32 s39, s39, 229376
    buffer_load_dwordx4 v2, s[12:15], s39 offen sc1 lds
    s_add_u32 m0, m0, 1024
    s_add_u32 s40, s40, 229376
    buffer_load_dwordx4 v2, s[12:15], s40 offen sc1 lds
    s_mov_b32 m0, s19
    s_mov_b32 s39, s16
    s_mov_b32 s40, s17
    s_waitcnt vmcnt(8)
    s_barrier
    buffer_load_dwordx4 v2, s[12:15], s39 offen sc1 lds
    s_add_u32 m0, m0, 1024
    s_nop 0
    buffer_load_dwordx4 v2, s[12:15], s40 offen sc1 lds
    s_mov_b64 exec, 1
    buffer_load_dword v11, v15, s[56:59], 0 offen sc1
    s_mov_b64 exec, -1
    s_call_b64 s[76:77], PREP_a_issue_4
    s_add_u32 m0, m0, 1024
    s_add_u32 s39, s39, 229376
    buffer_load_dwordx4 v2, s[12:15], s39 offen sc1 lds
    s_add_u32 m0, m0, 1024
    s_add_u32 s40, s40, 229376
    buffer_load_dwordx4 v2, s[12:15], s40 offen sc1 lds
    s_add_u32 m0, m0, 1024
    s_add_u32 s39, s39, 229376
    buffer_load_dwordx4 v2, s[12:15], s39 offen sc1 lds
    s_add_u32 m0, m0, 1024
    s_add_u32 s40, s40, 229376
    buffer_load_dwordx4 v2, s[12:15], s40 offen sc1 lds
    s_add_u32 m0, m0, 1024
    s_add_u32 s39, s39, 229376
    buffer_load_dwordx4 v2, s[12:15], s39 offen sc1 lds
    s_add_u32 m0, m0, 1024
    s_add_u32 s40, s40, 229376
    buffer_load_dwordx4 v2, s[12:15], s40 offen sc1 lds
    s_mov_b32 m0, s19
    s_mov_b32 s39, s16
    s_mov_b32 s40, s17
    s_waitcnt vmcnt(9)
    s_barrier
    buffer_load_dwordx4 v2, s[12:15], s39 offen sc1 lds
    s_add_u32 m0, m0, 1024
    s_nop 0
    buffer_load_dwordx4 v2, s[12:15], s40 offen sc1 lds
    s_call_b64 s[76:77], PREP_a_issue_4
    s_add_u32 m0, m0, 1024
    s_add_u32 s39, s39, 229376
    buffer_load_dwordx4 v2, s[12:15], s39 offen sc1 lds
    s_add_u32 m0, m0, 1024
    s_add_u32 s40, s40, 229376
    buffer_load_dwordx4 v2, s[12:15], s40 offen sc1 lds
    s_add_u32 m0, m0, 1024
    s_add_u32 s39, s39, 229376
    buffer_load_dwordx4 v2, s[12:15], s39 offen sc1 lds
    s_add_u32 m0, m0, 1024
    s_add_u32 s40, s40, 229376
    buffer_load_dwordx4 v2, s[12:15], s40 offen sc1 lds
    s_add_u32 m0, m0, 1024
    s_add_u32 s39, s39, 229376
    buffer_load_dwordx4 v2, s[12:15], s39 offen sc1 lds
    s_add_u32 m0, m0, 1024
    s_add_u32 s40, s40, 229376
    buffer_load_dwordx4 v2, s[12:15], s40 offen sc1 lds
    s_mov_b32 m0, s19
    s_mov_b32 s39, s16
    s_mov_b32 s40, s17
    s_waitcnt vmcnt(8)
    s_barrier
    buffer_load_dwordx4 v2, s[12:15], s39 offen sc1 lds
    s_add_u32 m0, m0, 1024
    s_nop 0
    buffer_load_dwordx4 v2, s[12:15], s40 offen sc1 lds
    s_waitcnt vmcnt(16)
    v_readfirstlane_b32 s53, v11
    s_add_u32 s54, s52, 8
    s_cmp_eq_u32 s53, s54
    s_cbranch_scc1 fok_70
    s_mov_b32 s53, 0
    s_add_u32 s54, s52, 8
    s_bfm_b64 exec, 1, 0
poll_71:
    buffer_load_dword v11, v15, s[56:59], 0 offen sc1
    s_waitcnt vmcnt(0)
    v_xor_b32 v11, s54, v11
    v_cmp_eq_u32 vcc, 0, v11
    s_nop 0
    s_cmp_eq_u64 vcc, exec
    s_cbranch_scc1 pok_72
    s_sleep 5
    s_add_u32 s53, s53, 1
    s_cmp_lt_u32 s53, s61
    s_cbranch_scc1 poll_71
    s_mov_b32 s61, 0
pok_72:
    s_mov_b64 exec, -1
fok_70:
    s_call_b64 s[76:77], PREP_a_issue_4
    s_add_u32 m0, m0, 1024
    s_add_u32 s39, s39, 229376
    buffer_load_dwordx4 v2, s[12:15], s39 offen sc1 lds
    s_add_u32 m0, m0, 1024
    s_add_u32 s40, s40, 229376
    buffer_load_dwordx4 v2, s[12:15], s40 offen sc1 lds
    s_add_u32 m0, m0, 1024
    s_add_u32 s39, s39, 229376
    buffer_load_dwordx4 v2, s[12:15], s39 offen sc1 lds
    s_add_u32 m0, m0, 1024
    s_add_u32 s40, s40, 229376
    buffer_load_dwordx4 v2, s[12:15], s40 offen sc1 lds
    s_add_u32 m0, m0, 1024
    s_add_u32 s39, s39, 229376
    buffer_load_dwordx4 v2, s[12:15], s39 offen sc1 lds
    s_add_u32 m0, m0, 1024
    s_add_u32 s40, s40, 229376
    buffer_load_dwordx4 v2, s[12:15], s40 offen sc1 lds
    s_mov_b32 m0, s19
    s_mov_b32 s39, s16
    s_mov_b32 s40, s17
    s_waitcnt vmcnt(8)
    s_barrier
    buffer_load_dwordx4 v2, s[12:15], s39 offen sc1 lds
    s_add_u32 m0, m0, 1024
    s_nop 0
    buffer_load_dwordx4 v2, s[12:15], s40 offen sc1 lds
    s_mov_b32 s43, 1
ld_73:
    s_add_u32 s19, s41, s42
    v_readlane_b32 s16, v249, s44
    v_readlane_b32 s17, v250, s44
    s_add_u32 s16, s16, s38
    s_add_u32 s17, s17, s38
    s_add_u32 s44, s44, 1
    s_add_u32 s42, s42, 16384
    s_cmp_eq_u32 s42, 49152
    s_cselect_b32 s42, 0, s42
    s_add_u32 m0, m0, 1024
    s_add_u32 s39, s39, 229376
    buffer_load_dwordx4 v2, s[12:15], s39 offen sc1 lds
    s_add_u32 m0, m0, 1024
    s_add_u32 s40, s40, 229376
    buffer_load_dwordx4 v2, s[12:15], s40 offen sc1 lds
    s_add_u32 m0, m0, 1024
    s_add_u32 s39, s39, 229376
    buffer_load_dwordx4 v2, s[12:15], s39 offen sc1 lds
    s_add_u32 m0, m0, 1024
    s_add_u32 s40, s40, 229376
    buffer_load_dwordx4 v2, s[12:15], s40 offen sc1 lds
    s_add_u32 m0, m0, 1024
    s_add_u32 s39, s39, 229376
    buffer_load_dwordx4 v2, s[12:15], s39 offen sc1 lds
    s_add_u32 m0, m0, 1024
    s_add_u32 s40, s40, 229376
    buffer_load_dwordx4 v2, s[12:15], s40 offen sc1 lds
    s_mov_b32 m0, s19
    s_mov_b32 s39, s16
    s_mov_b32 s40, s17
    s_waitcnt vmcnt(8)
    s_barrier
    buffer_load_dwordx4 v2, s[12:15], s39 offen sc1 lds
    s_add_u32 m0, m0, 1024
    s_nop 0
    buffer_load_dwordx4 v2, s[12:15], s40 offen sc1 lds
    s_add_u32 s43, s43, 1
    s_cmp_lt_u32 s43, 3
    s_cbranch_scc1 ld_73
    s_call_b64 s[76:77], PREP_a_issue_4
    s_add_u32 m0, m0, 1024
    s_add_u32 s39, s39, 229376
    buffer_load_dwordx4 v2, s[12:15], s39 offen sc1 lds
    s_add_u32 m0, m0, 1024
    s_add_u32 s40, s40, 229376
    buffer_load_dwordx4 v2, s[12:15], s40 offen sc1 lds
    s_add_u32 m0, m0, 1024
    s_add_u32 s39, s39, 229376
    buffer_load_dwordx4 v2, s[12:15], s39 offen sc1 lds
    s_add_u32 m0, m0, 1024
    s_add_u32 s40, s40, 229376
    buffer_load_dwordx4 v2, s[12:15], s40 offen sc1 lds
    s_add_u32 m0, m0, 1024
    s_add_u32 s39, s39, 229376
    buffer_load_dwordx4 v2, s[12:15], s39 offen sc1 lds
    s_add_u32 m0, m0, 1024
    s_add_u32 s40, s40, 229376
    buffer_load_dwordx4 v2, s[12:15], s40 offen sc1 lds
    s_mov_b32 m0, s19
    s_mov_b32 s39, s16
    s_mov_b32 s40, s17
    s_waitcnt vmcnt(8)
    s_barrier
    buffer_load_dwordx4 v2, s[12:15], s39 offen sc1 lds
    s_add_u32 m0, m0, 1024
    s_nop 0
    buffer_load_dwordx4 v2, s[12:15], s40 offen sc1 lds
    s_add_u32 m0, m0, 1024
    s_add_u32 s39, s39, 229376
    buffer_load_dwordx4 v2, s[12:15], s39 offen sc1 lds
    s_add_u32 m0, m0, 1024
    s_add_u32 s40, s40, 229376
    buffer_load_dwordx4 v2, s[12:15], s40 offen sc1 lds
    s_add_u32 m0, m0, 1024
    s_add_u32 s39, s39, 229376
    buffer_load_dwordx4 v2, s[12:15], s39 offen sc1 lds
    s_add_u32 m0, m0, 1024
    s_add_u32 s40, s40, 229376
    buffer_load_dwordx4 v2, s[12:15], s40 offen sc1 lds
    s_add_u32 m0, m0, 1024
    s_add_u32 s39, s39, 229376
    buffer_load_dwordx4 v2, s[12:15], s39 offen sc1 lds
    s_add_u32 m0, m0, 1024
    s_add_u32 s40, s40, 229376
    buffer_load_dwordx4 v2, s[12:15], s40 offen sc1 lds
    s_waitcnt vmcnt(8)
    s_barrier
    s_waitcnt vmcnt(0)
    s_barrier
    s_cmp_eq_u32 s60, 1
    s_cbranch_scc1 K_fin
    s_barrier
    s_branch NEXT
WLOAD:
    s_cmp_eq_u32 s60, 1
    s_cbranch_scc1 WL_1
    s_mov_b64 s[12:13], s[68:69]
    s_mov_b32 s14, 2097152
    s_mov_b32 s15, 0x20000
    s_and_b32 s35, s30, 1
    s_mul_i32 s38, s99, 128
    s_mul_i32 s41, s35, 65536
    s_add_u32 s38, s38, s41
    s_mul_i32 s41, s35, 4096
    s_add_u32 s41, s41, 24576
    s_mov_b32 s42, 0
    s_mov_b32 s44, s67
    s_branch WL_2
WL_1:
    s_mov_b64 s[12:13], s[68:69]
    s_mov_b32 s14, 2097152
    s_mov_b32 s15, 0x20000
    s_and_b32 s35, s30, 1
    s_mul_i32 s38, s99, 128
    s_mul_i32 s41, s35, 65536
    s_add_u32 s38, s38, s41
    s_mul_i32 s41, s35, 4096
    s_add_u32 s41, s41, 24576
    s_mov_b32 s42, 0
    s_mov_b32 s44, s67
WL_2:
    s_waitcnt vmcnt(0)
    s_barrier
    s_call_b64 s[76:77], SUB_after_g1
    s_barrier
    s_waitcnt vmcnt(0)
    s_barrier
    s_call_b64 s[76:77], SUB_after_g2
    s_mov_b64 s[12:13], s[72:73]
    s_mov_b32 s14, 7340032
    s_mov_b32 s15, 0x20000
    s_and_b32 s35, s30, 1
    s_mul_i32 s38, s29, 448
    s_mul_i32 s41, s35, 229376
    s_add_u32 s38, s38, s41
    s_mul_i32 s41, s35, 14336
    s_add_u32 s41, s41, 73728
    s_mov_b32 s42, 0
    s_mov_b32 s44, 0
    s_mov_b32 s42, 28672
    s_mov_b32 s44, 2
    s_add_u32 s19, s41, s42
    v_readlane_b32 s16, v248, s44
    s_nop 0
    s_add_u32 s16, s16, s38
    s_add_u32 s44, s44, 1
    s_and_b32 s44, s44, 15
    s_add_u32 s42, s42, 28672
    s_cmp_eq_u32 s42, 86016
    s_cselect_b32 s42, 0, s42
    s_mov_b32 m0, s19
    s_mov_b32 s39, s16
    s_waitcnt vmcnt(63)
    s_barrier
    buffer_load_dwordx4 v241, s[12:15], s39 offen lds
    s_add_u32 m0, m0, 1024
    s_nop 0
    buffer_load_dwordx4 v242, s[12:15], s39 offen lds
    s_add_u32 m0, m0, 1024
    s_nop 0
    buffer_load_dwordx4 v243, s[12:15], s39 offen lds
    s_mov_b32 s43, 1
ld_74:
    s_add_u32 s19, s41, s42
    v_readlane_b32 s16, v248, s44
    s_nop 0
    s_add_u32 s16, s16, s38
    s_add_u32 s44, s44, 1
    s_and_b32 s44, s44, 15
    s_add_u32 s42, s42, 28672
    s_cmp_eq_u32 s42, 86016
    s_cselect_b32 s42, 0, s42
    s_add_u32 m0, m0, 1024
    s_nop 0
    buffer_load_dwordx4 v244, s[12:15], s39 offen lds
    s_add_u32 m0, m0, 1024
    s_nop 0
    buffer_load_dwordx4 v245, s[12:15], s39 offen lds
    s_add_u32 m0, m0, 1024
    s_nop 0
    buffer_load_dwordx4 v246, s[12:15], s39 offen lds
    s_add_u32 m0, m0, 1024
    s_nop 0
    buffer_load_dwordx4 v247, s[12:15], s39 offen lds
    s_add_u32 m0, m0, 1024
    s_add_u32 s39, s39, 114688
    buffer_load_dwordx4 v241, s[12:15], s39 offen lds
    s_add_u32 m0, m0, 1024
    s_nop 0
    buffer_load_dwordx4 v242, s[12:15], s39 offen lds
    s_add_u32 m0, m0, 1024
    s_nop 0
    buffer_load_dwordx4 v243, s[12:15], s39 offen lds
    s_add_u32 m0, m0, 1024
    s_nop 0
    buffer_load_dwordx4 v244, s[12:15], s39 offen lds
    s_add_u32 m0, m0, 1024
    s_nop 0
    buffer_load_dwordx4 v245, s[12:15], s39 offen lds
    s_add_u32 m0, m0, 1024
    s_nop 0
    buffer_load_dwordx4 v246, s[12:15], s39 offen lds
    s_add_u32 m0, m0, 1024
    s_nop 0
    buffer_load_dwordx4 v247, s[12:15], s39 offen lds
    s_mov_b32 m0, s19
    s_mov_b32 s39, s16
    s_waitcnt vmcnt(14)
    s_barrier
    buffer_load_dwordx4 v241, s[12:15], s39 offen lds
    s_add_u32 m0, m0, 1024
    s_nop 0
    buffer_load_dwordx4 v242, s[12:15], s39 offen lds
    s_add_u32 m0, m0, 1024
    s_nop 0
    buffer_load_dwordx4 v243, s[12:15], s39 offen lds
    s_add_u32 s43, s43, 1
    s_cmp_lt_u32 s43, 13
    s_cbranch_scc1 ld_74
    s_add_u32 s19, s41, s42
    v_readlane_b32 s16, v248, s44
    s_nop 0
    s_add_u32 s16, s16, s38
    s_add_u32 s44, s44, 1
    s_and_b32 s44, s44, 15
    s_add_u32 s42, s42, 28672
    s_cmp_eq_u32 s42, 86016
    s_cselect_b32 s42, 0, s42
    s_add_u32 m0, m0, 1024
    s_nop 0
    buffer_load_dwordx4 v244, s[12:15], s39 offen lds
    s_add_u32 m0, m0, 1024
    s_nop 0
    buffer_load_dwordx4 v245, s[12:15], s39 offen lds
    s_add_u32 m0, m0, 1024
    s_nop 0
    buffer_load_dwordx4 v246, s[12:15], s39 offen lds
    s_add_u32 m0, m0, 1024
    s_nop 0
    buffer_load_dwordx4 v247, s[12:15], s39 offen lds
    s_add_u32 m0, m0, 1024
    s_add_u32 s39, s39, 114688
    buffer_load_dwordx4 v241, s[12:15], s39 offen lds
    s_add_u32 m0, m0, 1024
    s_nop 0
    buffer_load_dwordx4 v242, s[12:15], s39 offen lds
    s_add_u32 m0, m0, 1024
    s_nop 0
    buffer_load_dwordx4 v243, s[12:15], s39 offen lds
    s_add_u32 m0, m0, 1024
    s_nop 0
    buffer_load_dwordx4 v244, s[12:15], s39 offen lds
    s_add_u32 m0, m0, 1024
    s_nop 0
    buffer_load_dwordx4 v245, s[12:15], s39 offen lds
    s_add_u32 m0, m0, 1024
    s_nop 0
    buffer_load_dwordx4 v246, s[12:15], s39 offen lds
    s_add_u32 m0, m0, 1024
    s_nop 0
    buffer_load_dwordx4 v247, s[12:15], s39 offen lds
    s_mov_b32 m0, s19
    s_mov_b32 s39, s16
    s_waitcnt vmcnt(14)
    s_barrier
    buffer_load_dwordx4 v241, s[12:15], s39 offen lds
    s_add_u32 m0, m0, 1024
    s_nop 0
    buffer_load_dwordx4 v242, s[12:15], s39 offen lds
    s_add_u32 m0, m0, 1024
    s_nop 0
    buffer_load_dwordx4 v243, s[12:15], s39 offen lds
    s_add_u32 m0, m0, 1024
    s_nop 0
    buffer_load_dwordx4 v244, s[12:15], s39 offen lds
    s_add_u32 m0, m0, 1024
    s_nop 0
    buffer_load_dwordx4 v245, s[12:15], s39 offen lds
    s_add_u32 m0, m0, 1024
    s_nop 0
    buffer_load_dwordx4 v246, s[12:15], s39 offen lds
    s_add_u32 m0, m0, 1024
    s_nop 0
    buffer_load_dwordx4 v247, s[12:15], s39 offen lds
    s_add_u32 m0, m0, 1024
    s_add_u32 s39, s39, 114688
    buffer_load_dwordx4 v241, s[12:15], s39 offen lds
    s_add_u32 m0, m0, 1024
    s_nop 0
    buffer_load_dwordx4 v242, s[12:15], s39 offen lds
    s_add_u32 m0, m0, 1024
    s_nop 0
    buffer_load_dwordx4 v243, s[12:15], s39 offen lds
    s_add_u32 m0, m0, 1024
    s_nop 0
    buffer_load_dwordx4 v244, s[12:15], s39 offen lds
    s_add_u32 m0, m0, 1024
    s_nop 0
    buffer_load_dwordx4 v245, s[12:15], s39 offen lds
    s_add_u32 m0, m0, 1024
    s_nop 0
    buffer_load_dwordx4 v246, s[12:15], s39 offen lds
    s_add_u32 m0, m0, 1024
    s_nop 0
    buffer_load_dwordx4 v247, s[12:15], s39 offen lds
    s_waitcnt vmcnt(14)
    s_barrier
    s_call_b64 s[76:77], SUB_r_pre0
    s_waitcnt vmcnt(4)
    s_barrier
    s_barrier
    s_mov_b64 s[12:13], s[74:75]
    s_mov_b32 s14, 7340032
    s_mov_b32 s15, 0x20000
    s_and_b32 s35, s30, 1
    s_mul_i32 s38, s33, 256
    s_mul_i32 s41, s31, 3670016
    s_add_u32 s38, s38, s41
    s_mul_i32 s41, s35, 8192
    s_add_u32 s41, s41, 49152
    s_mov_b32 s42, 0
    s_mov_b32 s44, 0
    s_mov_b32 s49, s44
    s_and_b32 s43, s28, 3
    s_mul_i32 s43, s43, 6
    s_lshr_b32 s43, s43, 2
    s_mov_b32 s50, 0
wpre_75:
    s_mul_i32 s42, s43, 16384
    s_add_u32 s44, s49, s43
    s_mov_b32 s45, 8192
    s_add_u32 s19, s41, s42
    v_readlane_b32 s16, v249, s44
    s_nop 0
    s_bitcmp1_b32 s16, 0
    s_cselect_b32 s17, 16384, s45
    s_cselect_b32 s18, -40960, s45
    s_andn2_b32 s16, s16, 1
    s_add_u32 s16, s16, s38
    s_add_u32 s44, s44, 1
    s_add_u32 s42, s42, 16384
    s_cmp_eq_u32 s42, 98304
    s_cselect_b32 s42, 0, s42
    s_mov_b32 m0, s19
    s_mov_b32 s39, s16
    s_mov_b32 s32, s17
    s_mov_b32 s3, s18
    buffer_load_dwordx4 v239, s[12:15], s39 offen lds
    s_add_u32 m0, m0, 1024
    s_add_u32 s39, s39, s32
    buffer_load_dwordx4 v240, s[12:15], s39 offen lds
    s_add_u32 m0, m0, 1024
    s_add_u32 s39, s39, s32
    buffer_load_dwordx4 v239, s[12:15], s39 offen lds
    s_add_u32 m0, m0, 1024
    s_add_u32 s39, s39, s32
    buffer_load_dwordx4 v240, s[12:15], s39 offen lds
    s_waitcnt vmcnt(6)
    s_add_u32 m0, m0, 1024
    s_add_u32 s39, s39, s3
    buffer_load_dwordx4 v239, s[12:15], s39 offen lds
    s_add_u32 m0, m0, 1024
    s_add_u32 s39, s39, s32
    buffer_load_dwordx4 v240, s[12:15], s39 offen lds
    s_add_u32 m0, m0, 1024
    s_add_u32 s39, s39, s32
    buffer_load_dwordx4 v239, s[12:15], s39 offen lds
    s_add_u32 m0, m0, 1024
    s_add_u32 s39, s39, s32
    buffer_load_dwordx4 v240, s[12:15], s39 offen lds
    s_waitcnt vmcnt(6)
    s_add_u32 s43, s43, 1
    s_cmp_eq_u32 s43, 6
    s_cselect_b32 s43, 0, s43
    s_add_u32 s50, s50, 1
    s_cmp_lt_u32 s50, 6
    s_cbranch_scc1 wpre_75
    s_mov_b32 s42, 0
    s_add_u32 s44, s49, 6
    s_cmp_eq_u32 s60, 1
    s_cbranch_scc1 WL_t1
    s_call_b64 s[76:77], PREP_w_issue_4
    s_mov_b32 m0, s19
    s_mov_b32 s39, s16
    s_mov_b32 s32, s17
    s_mov_b32 s3, s18
    s_waitcnt vmcnt(0)
    s_barrier
    s_waitcnt vmcnt(0)
    s_barrier
    buffer_load_dwordx4 v239, s[12:15], s39 offen lds
    s_add_u32 m0, m0, 1024
    s_add_u32 s39, s39, s32
    buffer_load_dwordx4 v240, s[12:15], s39 offen lds
    s_call_b64 s[76:77], PREP_w_issue_4
    s_add_u32 m0, m0, 1024
    s_add_u32 s39, s39, s32
    buffer_load_dwordx4 v239, s[12:15], s39 offen lds
    s_add_u32 m0, m0, 1024
    s_add_u32 s39, s39, s32
    buffer_load_dwordx4 v240, s[12:15], s39 offen lds
    s_add_u32 m0, m0, 1024
    s_add_u32 s39, s39, s3
    buffer_load_dwordx4 v239, s[12:15], s39 offen lds
    s_add_u32 m0, m0, 1024
    s_add_u32 s39, s39, s32
    buffer_load_dwordx4 v240, s[12:15], s39 offen lds
    s_add_u32 m0, m0, 1024
    s_add_u32 s39, s39, s32
    buffer_load_dwordx4 v239, s[12:15], s39 offen lds
    s_add_u32 m0, m0, 1024
    s_add_u32 s39, s39, s32
    buffer_load_dwordx4 v240, s[12:15], s39 offen lds
    s_mov_b32 m0, s19
    s_mov_b32 s39, s16
    s_mov_b32 s32, s17
    s_mov_b32 s3, s18
    s_waitcnt vmcnt(8)
    s_barrier
    buffer_load_dwordx4 v239, s[12:15], s39 offen lds
    s_add_u32 m0, m0, 1024
    s_add_u32 s39, s39, s32
    buffer_load_dwordx4 v240, s[12:15], s39 offen lds
    s_call_b64 s[76:77], PREP_w_issue_4
    s_add_u32 m0, m0, 1024
    s_add_u32 s39, s39, s32
    buffer_load_dwordx4 v239, s[12:15], s39 offen lds
    s_add_u32 m0, m0, 1024
    s_add_u32 s39, s39, s32
    buffer_load_dwordx4 v240, s[12:15], s39 offen lds
    s_add_u32 m0, m0, 1024
    s_add_u32 s39, s39, s3
    buffer_load_dwordx4 v239, s[12:15], s39 offen lds
    s_add_u32 m0, m0, 1024
    s_add_u32 s39, s39, s32
    buffer_load_dwordx4 v240, s[12:15], s39 offen lds
    s_add_u32 m0, m0, 1024
    s_add_u32 s39, s39, s32
    buffer_load_dwordx4 v239, s[12:15], s39 offen lds
    s_add_u32 m0, m0, 1024
    s_add_u32 s39, s39, s32
    buffer_load_dwordx4 v240, s[12:15], s39 offen lds
    s_mov_b32 m0, s19
    s_mov_b32 s39, s16
    s_mov_b32 s32, s17
    s_mov_b32 s3, s18
    s_waitcnt vmcnt(16)
    s_barrier
    buffer_load_dwordx4 v239, s[12:15], s39 offen lds
    s_add_u32 m0, m0, 1024
    s_add_u32 s39, s39, s32
    buffer_load_dwordx4 v240, s[12:15], s39 offen lds
    s_call_b64 s[76:77], PREP_w_issue_4
    s_add_u32 m0, m0, 1024
    s_add_u32 s39, s39, s32
    buffer_load_dwordx4 v239, s[12:15], s39 offen lds
    s_add_u32 m0, m0, 1024
    s_add_u32 s39, s39, s32
    buffer_load_dwordx4 v240, s[12:15], s39 offen lds
    s_add_u32 m0, m0, 1024
    s_add_u32 s39, s39, s3
    buffer_load_dwordx4 v239, s[12:15], s39 offen lds
    s_add_u32 m0, m0, 1024
    s_add_u32 s39, s39, s32
    buffer_load_dwordx4 v240, s[12:15], s39 offen lds
    s_add_u32 m0, m0, 1024
    s_add_u32 s39, s39, s32
    buffer_load_dwordx4 v239, s[12:15], s39 offen lds
    s_add_u32 m0, m0, 1024
    s_add_u32 s39, s39, s32
    buffer_load_dwordx4 v240, s[12:15], s39 offen lds
    s_mov_b32 m0, s19
    s_mov_b32 s39, s16
    s_mov_b32 s32, s17
    s_mov_b32 s3, s18
    s_waitcnt vmcnt(24)
    s_barrier
    buffer_load_dwordx4 v239, s[12:15], s39 offen lds
    s_add_u32 m0, m0, 1024
    s_add_u32 s39, s39, s32
    buffer_load_dwordx4 v240, s[12:15], s39 offen lds
    s_mov_b32 s43, 1
ld_76:
    s_mov_b32 s45, 8192
    s_add_u32 s19, s41, s42
    v_readlane_b32 s16, v249, s44
    s_nop 0
    s_bitcmp1_b32 s16, 0
    s_cselect_b32 s17, 16384, s45
    s_cselect_b32 s18, -40960, s45
    s_andn2_b32 s16, s16, 1
    s_add_u32 s16, s16, s38
    s_add_u32 s44, s44, 1
    s_add_u32 s42, s42, 16384
    s_cmp_eq_u32 s42, 98304
    s_cselect_b32 s42, 0, s42
    s_add_u32 m0, m0, 1024
    s_add_u32 s39, s39, s32
    buffer_load_dwordx4 v239, s[12:15], s39 offen lds
    s_add_u32 m0, m0, 1024
    s_add_u32 s39, s39, s32
    buffer_load_dwordx4 v240, s[12:15], s39 offen lds
    s_add_u32 m0, m0, 1024
    s_add_u32 s39, s39, s3
    buffer_load_dwordx4 v239, s[12:15], s39 offen lds
    s_add_u32 m0, m0, 1024
    s_add_u32 s39, s39, s32
    buffer_load_dwordx4 v240, s[12:15], s39 offen lds
    s_add_u32 m0, m0, 1024
    s_add_u32 s39, s39, s32
    buffer_load_dwordx4 v239, s[12:15], s39 offen lds
    s_add_u32 m0, m0, 1024
    s_add_u32 s39, s39, s32
    buffer_load_dwordx4 v240, s[12:15], s39 offen lds
    s_mov_b32 m0, s19
    s_mov_b32 s39, s16
    s_mov_b32 s32, s17
    s_mov_b32 s3, s18
    s_waitcnt vmcnt(32)
    s_barrier
    buffer_load_dwordx4 v239, s[12:15], s39 offen lds
    s_add_u32 m0, m0, 1024
    s_add_u32 s39, s39, s32
    buffer_load_dwordx4 v240, s[12:15], s39 offen lds
    s_add_u32 s43, s43, 1
    s_cmp_lt_u32 s43, 18
    s_cbranch_scc1 ld_76
    s_call_b64 s[76:77], PREP_w_issue_4
    s_add_u32 m0, m0, 1024
    s_add_u32 s39, s39, s32
    buffer_load_dwordx4 v239, s[12:15], s39 offen lds
    s_add_u32 m0, m0, 1024
    s_add_u32 s39, s39, s32
    buffer_load_dwordx4 v240, s[12:15], s39 offen lds
    s_add_u32 m0, m0, 1024
    s_add_u32 s39, s39, s3
    buffer_load_dwordx4 v239, s[12:15], s39 offen lds
    s_add_u32 m0, m0, 1024
    s_add_u32 s39, s39, s32
    buffer_load_dwordx4 v240, s[12:15], s39 offen lds
    s_add_u32 m0, m0, 1024
    s_add_u32 s39, s39, s32
    buffer_load_dwordx4 v239, s[12:15], s39 offen lds
    s_add_u32 m0, m0, 1024
    s_add_u32 s39, s39, s32
    buffer_load_dwordx4 v240, s[12:15], s39 offen lds
    s_mov_b32 m0, s19
    s_mov_b32 s39, s16
    s_mov_b32 s32, s17
    s_mov_b32 s3, s18
    s_waitcnt vmcnt(32)
    s_barrier
    buffer_load_dwordx4 v239, s[12:15], s39 offen lds
    s_add_u32 m0, m0, 1024
    s_add_u32 s39, s39, s32
    buffer_load_dwordx4 v240, s[12:15], s39 offen lds
    s_add_u32 m0, m0, 1024
    s_add_u32 s39, s39, s32
    buffer_load_dwordx4 v239, s[12:15], s39 offen lds
    s_add_u32 m0, m0, 1024
    s_add_u32 s39, s39, s32
    buffer_load_dwordx4 v240, s[12:15], s39 offen lds
    s_add_u32 m0, m0, 1024
    s_add_u32 s39, s39, s3
    buffer_load_dwordx4 v239, s[12:15], s39 offen lds
    s_add_u32 m0, m0, 1024
    s_add_u32 s39, s39, s32
    buffer_load_dwordx4 v240, s[12:15], s39 offen lds
    s_add_u32 m0, m0, 1024
    s_add_u32 s39, s39, s32
    buffer_load_dwordx4 v239, s[12:15], s39 offen lds
    s_add_u32 m0, m0, 1024
    s_add_u32 s39, s39, s32
    buffer_load_dwordx4 v240, s[12:15], s39 offen lds
    s_waitcnt vmcnt(32)
    s_barrier
    s_mov_b64 s[12:13], s[68:69]
    s_mov_b32 s14, 2097152
    s_mov_b32 s15, 0x20000
    s_and_b32 s35, s30, 1
    s_mul_i32 s38, s99, 128
    s_mul_i32 s41, s35, 65536
    s_add_u32 s38, s38, s41
    s_mul_i32 s41, s35, 4096
    s_add_u32 s41, s41, 24576
    s_mov_b32 s42, 0
    s_mov_b32 s44, s67
    s_and_b32 s36, s99, 7
    s_cmp_eq_u32 s36, 3
    s_cselect_b64 s[50:51], 0, -1
    s_mov_b32 s42, 90112
    s_mov_b32 s44, s67
    s_add_u32 s44, s44, 11
    s_and_b32 s44, s44, 15
    s_call_b64 s[76:77], SUB_w_issue_1
    s_mov_b32 s42, 98304
    s_mov_b32 s44, s67
    s_add_u32 s44, s44, 12
    s_and_b32 s44, s44, 15
    s_call_b64 s[76:77], SUB_w_issue_1
    s_mov_b32 s42, 122880
    s_mov_b32 s44, s67
    s_add_u32 s44, s44, 15
    s_and_b32 s44, s44, 15
    s_call_b64 s[76:77], SUB_w_issue_1
    s_add_u32 s39, s38, 1179648
    buffer_load_dwordx4 v[16:19], v238, s[12:15], s39 offen
    s_add_u32 s39, s39, 16384
    buffer_load_dwordx4 v[20:23], v238, s[12:15], s39 offen
    s_add_u32 s39, s39, 16384
    buffer_load_dwordx4 v[24:27], v238, s[12:15], s39 offen
    s_add_u32 s39, s39, 16384
    buffer_load_dwordx4 v[28:31], v238, s[12:15], s39 offen
    s_add_u32 s39, s39, 16384
    s_waitcnt vmcnt(40)
    s_barrier
    s_mov_b32 s42, 106496
    s_mov_b32 s44, s67
    s_add_u32 s44, s44, 13
    s_and_b32 s44, s44, 15
    s_call_b64 s[76:77], SUB_w_issue_1
    s_mov_b32 s42, 114688
    s_mov_b32 s44, s67
    s_add_u32 s44, s44, 14
    s_and_b32 s44, s44, 15
    s_call_b64 s[76:77], SUB_w_issue_1
    s_add_u32 s39, s38, 1310720
    buffer_load_dwordx4 v[32:35], v238, s[12:15], s39 offen
    s_add_u32 s39, s39, 16384
    buffer_load_dwordx4 v[36:39], v238, s[12:15], s39 offen
    s_add_u32 s39, s39, 16384
    buffer_load_dwordx4 v[40:43], v238, s[12:15], s39 offen
    s_add_u32 s39, s39, 16384
    buffer_load_dwordx4 v[44:47], v238, s[12:15], s39 offen
    s_add_u32 s39, s39, 16384
    s_waitcnt vmcnt(44)
    s_barrier
    s_mov_b32 s42, 24576
    s_mov_b32 s44, s67
    s_add_u32 s44, s44, 3
    s_and_b32 s44, s44, 15
    s_call_b64 s[76:77], SUB_w_issue_1
    s_mov_b32 s42, 32768
    s_mov_b32 s44, s67
    s_add_u32 s44, s44, 4
    s_and_b32 s44, s44, 15
    s_call_b64 s[76:77], SUB_w_issue_1
    s_waitcnt vmcnt(44)
    s_barrier
    s_mov_b32 s42, 40960
    s_mov_b32 s44, s67
    s_add_u32 s44, s44, 5
    s_and_b32 s44, s44, 15
    s_call_b64 s[76:77], SUB_w_issue_1
    s_mov_b32 s42, 49152
    s_mov_b32 s44, s67
    s_add_u32 s44, s44, 6
    s_and_b32 s44, s44, 15
    s_call_b64 s[76:77], SUB_w_issue_1
    s_mov_b32 s42, 0
    s_mov_b32 s44, s67
    s_add_u32 s44, s44, 0
    s_and_b32 s44, s44, 15
    s_call_b64 s[76:77], SUB_w_issue_1
    s_waitcnt vmcnt(48)
    s_barrier
    s_mov_b32 s42, 57344
    s_mov_b32 s44, s67
    s_add_u32 s44, s44, 7
    s_and_b32 s44, s44, 15
    s_call_b64 s[76:77], SUB_w_issue_1
    s_mov_b32 s42, 65536
    s_mov_b32 s44, s67
    s_add_u32 s44, s44, 8
    s_and_b32 s44, s44, 15
    s_call_b64 s[76:77], SUB_w_issue_1
    s_mov_b32 s42, 8192
    s_mov_b32 s44, s67
    s_add_u32 s44, s44, 1
    s_and_b32 s44, s44, 15
    s_call_b64 s[76:77], SUB_w_issue_1
    s_mov_b32 s42, 16384
    s_mov_b32 s44, s67
    s_add_u32 s44, s44, 2
    s_and_b32 s44, s44, 15
    s_call_b64 s[76:77], SUB_w_issue_1
    s_barrier
    s_add_u32 s36, s41, 73728
    v_add_u32 v6, s36, v2
    s_waitcnt vmcnt(36)
    ds_write_b128 v6, v[16:19] offset:0
    ds_write_b128 v6, v[20:23] offset:1024
    ds_write_b128 v6, v[24:27] offset:2048
    ds_write_b128 v6, v[28:31] offset:3072
    ds_write_b128 v6, v[32:35] offset:8192
    ds_write_b128 v6, v[36:39] offset:9216
    ds_write_b128 v6, v[40:43] offset:10240
    ds_write_b128 v6, v[44:47] offset:11264
    s_waitcnt lgkmcnt(0)
    s_branch NEXT
WL_t1:
    s_call_b64 s[76:77], PREP_w_issue_4
    s_mov_b32 m0, s19
    s_mov_b32 s39, s16
    s_mov_b32 s32, s17
    s_mov_b32 s3, s18
    s_waitcnt vmcnt(0)
    s_barrier
    s_waitcnt vmcnt(0)
    s_barrier
    s_waitcnt vmcnt(0)
    s_barrier
    s_waitcnt vmcnt(0)
    s_barrier
    s_waitcnt vmcnt(0)
    s_barrier
    buffer_load_dwordx4 v239, s[12:15], s39 offen lds
    s_add_u32 m0, m0, 1024
    s_add_u32 s39, s39, s32
    buffer_load_dwordx4 v240, s[12:15], s39 offen lds
    s_mov_b32 s43, 1
ld_77:
    s_mov_b32 s45, 8192
    s_add_u32 s19, s41, s42
    v_readlane_b32 s16, v249, s44
    s_nop 0
    s_bitcmp1_b32 s16, 0
    s_cselect_b32 s17, 16384, s45
    s_cselect_b32 s18, -40960, s45
    s_andn2_b32 s16, s16, 1
    s_add_u32 s16, s16, s38
    s_add_u32 s44, s44, 1
    s_add_u32 s42, s42, 16384
    s_cmp_eq_u32 s42, 98304
    s_cselect_b32 s42, 0, s42
    s_add_u32 m0, m0, 1024
    s_add_u32 s39, s39, s32
    buffer_load_dwordx4 v239, s[12:15], s39 offen lds
    s_add_u32 m0, m0, 1024
    s_add_u32 s39, s39, s32
    buffer_load_dwordx4 v240, s[12:15], s39 offen lds
    s_add_u32 m0, m0, 1024
    s_add_u32 s39, s39, s3
    buffer_load_dwordx4 v239, s[12:15], s39 offen lds
    s_add_u32 m0, m0, 1024
    s_add_u32 s39, s39, s32
    buffer_load_dwordx4 v240, s[12:15], s39 offen lds
    s_add_u32 m0, m0, 1024
    s_add_u32 s39, s39, s32
    buffer_load_dwordx4 v239, s[12:15], s39 offen lds
    s_add_u32 m0, m0, 1024
    s_add_u32 s39, s39, s32
    buffer_load_dwordx4 v240, s[12:15], s39 offen lds
    s_mov_b32 m0, s19
    s_mov_b32 s39, s16
    s_mov_b32 s32, s17
    s_mov_b32 s3, s18
    s_waitcnt vmcnt(8)
    s_barrier
    buffer_load_dwordx4 v239, s[12:15], s39 offen lds
    s_add_u32 m0, m0, 1024
    s_add_u32 s39, s39, s32
    buffer_load_dwordx4 v240, s[12:15], s39 offen lds
    s_add_u32 s43, s43, 1
    s_cmp_lt_u32 s43, 21
    s_cbranch_scc1 ld_77
    s_call_b64 s[76:77], PREP_w_issue_4
    s_add_u32 m0, m0, 1024
    s_add_u32 s39, s39, s32
    buffer_load_dwordx4 v239, s[12:15], s39 offen lds
    s_add_u32 m0, m0, 1024
    s_add_u32 s39, s39, s32
    buffer_load_dwordx4 v240, s[12:15], s39 offen lds
    s_add_u32 m0, m0, 1024
    s_add_u32 s39, s39, s3
    buffer_load_dwordx4 v239, s[12:15], s39 offen lds
    s_add_u32 m0, m0, 1024
    s_add_u32 s39, s39, s32
    buffer_load_dwordx4 v240, s[12:15], s39 offen lds
    s_add_u32 m0, m0, 1024
    s_add_u32 s39, s39, s32
    buffer_load_dwordx4 v239, s[12:15], s39 offen lds
    s_add_u32 m0, m0, 1024
    s_add_u32 s39, s39, s32
    buffer_load_dwordx4 v240, s[12:15], s39 offen lds
    s_mov_b32 m0, s19
    s_mov_b32 s39, s16
    s_mov_b32 s32, s17
    s_mov_b32 s3, s18
    s_waitcnt vmcnt(8)
    s_barrier
    buffer_load_dwordx4 v239, s[12:15], s39 offen lds
    s_add_u32 m0, m0, 1024
    s_add_u32 s39, s39, s32
    buffer_load_dwordx4 v240, s[12:15], s39 offen lds
    s_add_u32 m0, m0, 1024
    s_add_u32 s39, s39, s32
    buffer_load_dwordx4 v239, s[12:15], s39 offen lds
    s_add_u32 m0, m0, 1024
    s_add_u32 s39, s39, s32
    buffer_load_dwordx4 v240, s[12:15], s39 offen lds
    s_add_u32 m0, m0, 1024
    s_add_u32 s39, s39, s3
    buffer_load_dwordx4 v239, s[12:15], s39 offen lds
    s_add_u32 m0, m0, 1024
    s_add_u32 s39, s39, s32
    buffer_load_dwordx4 v240, s[12:15], s39 offen lds
    s_add_u32 m0, m0, 1024
    s_add_u32 s39, s39, s32
    buffer_load_dwordx4 v239, s[12:15], s39 offen lds
    s_add_u32 m0, m0, 1024
    s_add_u32 s39, s39, s32
    buffer_load_dwordx4 v240, s[12:15], s39 offen lds
    s_waitcnt vmcnt(8)
    s_barrier
    s_waitcnt vmcnt(0)
    s_barrier
    s_branch K_fin
NEXT:
    s_setprio 0
    s_add_u32 s60, s60, 1
    s_add_u32 s55, s55, 4194304
    s_add_u32 s62, s62, 4194304
    s_addc_u32 s63, s63, 0
    s_branch LAYER
K_fin:
    s_endpgm
SUB_w1_regs:
    s_mov_b64 s[12:13], s[68:69]
    s_mov_b32 s14, 2097152
    s_mov_b32 s15, 0x20000
    s_and_b32 s35, s30, 3
    s_mul_i32 s35, s35, 294912
    s_lshl_b32 s39, s99, 7
    s_add_u32 s39, s39, s35
    buffer_load_dwordx4 v[176:179], v238, s[12:15], s39 offen
    s_add_u32 s39, s39, 16384
    buffer_load_dwordx4 v[188:191], v238, s[12:15], s39 offen
    s_add_u32 s39, s39, 16384
    buffer_load_dwordx4 v[192:195], v238, s[12:15], s39 offen
    s_add_u32 s39, s39, 16384
    buffer_load_dwordx4 v[200:203], v238, s[12:15], s39 offen
    s_add_u32 s39, s39, 16384
    s_waitcnt vmcnt(8)
    buffer_load_dwordx4 v[204:207], v238, s[12:15], s39 offen
    s_add_u32 s39, s39, 16384
    buffer_load_dwordx4 v[208:211], v238, s[12:15], s39 offen
    s_add_u32 s39, s39, 16384
    buffer_load_dwordx4 v[212:215], v238, s[12:15], s39 offen
    s_add_u32 s39, s39, 16384
    buffer_load_dwordx4 v[216:219], v238, s[12:15], s39 offen
    s_add_u32 s39, s39, 16384
    s_waitcnt vmcnt(8)
    buffer_load_dwordx4 v[220:223], v238, s[12:15], s39 offen
    s_add_u32 s39, s39, 16384
    buffer_load_dwordx4 v[224:227], v238, s[12:15], s39 offen
    s_add_u32 s39, s39, 16384
    buffer_load_dwordx4 v[16:19], v238, s[12:15], s39 offen
    s_add_u32 s39, s39, 16384
    buffer_load_dwordx4 v[20:23], v238, s[12:15], s39 offen
    s_add_u32 s39, s39, 16384
    s_waitcnt vmcnt(8)
    buffer_load_dwordx4 v[24:27], v238, s[12:15], s39 offen
    s_add_u32 s39, s39, 16384
    buffer_load_dwordx4 v[28:31], v238, s[12:15], s39 offen
    s_add_u32 s39, s39, 16384
    buffer_load_dwordx4 v[32:35], v238, s[12:15], s39 offen
    s_add_u32 s39, s39, 16384
    buffer_load_dwordx4 v[36:39], v238, s[12:15], s39 offen
    s_add_u32 s39, s39, 16384
    s_waitcnt vmcnt(8)
    buffer_load_dwordx4 v[40:43], v238, s[12:15], s39 offen
    s_add_u32 s39, s39, 16384
    buffer_load_dwordx4 v[44:47], v238, s[12:15], s39 offen
    s_add_u32 s39, s39, 16384
    s_setpc_b64 s[76:77]
SUB_park:
    s_mov_b64 s[12:13], s[70:71]
    s_mov_b32 s14, 2097152
    s_mov_b32 s15, 0x20000
    s_and_b32 s35, s30, 3
    s_lshl_b32 s35, s35, 19
    s_lshl_b32 s39, s29, 7
    s_add_u32 s39, s39, s35
    buffer_load_dwordx4 v[48:51], v238, s[12:15], s39 offen
    s_add_u32 s39, s39, 16384
    buffer_load_dwordx4 v[52:55], v238, s[12:15], s39 offen
    s_add_u32 s39, s39, 16384
    buffer_load_dwordx4 v[56:59], v238, s[12:15], s39 offen
    s_add_u32 s39, s39, 16384
    buffer_load_dwordx4 v[60:63], v238, s[12:15], s39 offen
    s_add_u32 s39, s39, 16384
    s_waitcnt vmcnt(8)
    buffer_load_dwordx4 v[64:67], v238, s[12:15], s39 offen
    s_add_u32 s39, s39, 16384
    buffer_load_dwordx4 v[68:71], v238, s[12:15], s39 offen
    s_add_u32 s39, s39, 16384
    buffer_load_dwordx4 v[72:75], v238, s[12:15], s39 offen
    s_add_u32 s39, s39, 16384
    buffer_load_dwordx4 v[76:79], v238, s[12:15], s39 offen
    s_add_u32 s39, s39, 16384
    s_waitcnt vmcnt(8)
    buffer_load_dwordx4 v[80:83], v238, s[12:15], s39 offen
    s_add_u32 s39, s39, 16384
    buffer_load_dwordx4 v[84:87], v238, s[12:15], s39 offen
    s_add_u32 s39, s39, 16384
    buffer_load_dwordx4 v[88:91], v238, s[12:15], s39 offen
    s_add_u32 s39, s39, 16384
    buffer_load_dwordx4 v[92:95], v238, s[12:15], s39 offen
    s_add_u32 s39, s39, 16384
    s_waitcnt vmcnt(8)
    buffer_load_dwordx4 v[96:99], v238, s[12:15], s39 offen
    s_add_u32 s39, s39, 16384
    buffer_load_dwordx4 v[100:103], v238, s[12:15], s39 offen
    s_add_u32 s39, s39, 16384
    buffer_load_dwordx4 v[104:107], v238, s[12:15], s39 offen
    s_add_u32 s39, s39, 16384
    buffer_load_dwordx4 v[108:111], v238, s[12:15], s39 offen
    s_add_u32 s39, s39, 16384
    s_waitcnt vmcnt(8)
    buffer_load_dwordx4 v[112:115], v238, s[12:15], s39 offen
    s_add_u32 s39, s39, 16384
    buffer_load_dwordx4 v[116:119], v238, s[12:15], s39 offen
    s_add_u32 s39, s39, 16384
    buffer_load_dwordx4 v[120:123], v238, s[12:15], s39 offen
    s_add_u32 s39, s39, 16384
    buffer_load_dwordx4 v[124:127], v238, s[12:15], s39 offen
    s_add_u32 s39, s39, 16384
    s_waitcnt vmcnt(8)
    buffer_load_dwordx4 v[128:131], v238, s[12:15], s39 offen
    s_add_u32 s39, s39, 16384
    buffer_load_dwordx4 v[132:135], v238, s[12:15], s39 offen
    s_add_u32 s39, s39, 16384
    buffer_load_dwordx4 v[136:139], v238, s[12:15], s39 offen
    s_add_u32 s39, s39, 16384
    buffer_load_dwordx4 v[140:143], v238, s[12:15], s39 offen
    s_add_u32 s39, s39, 16384
    s_waitcnt vmcnt(8)
    s_setpc_b64 s[76:77]
SUB_park2:
    s_mov_b64 s[12:13], s[70:71]
    s_mov_b32 s14, 2097152
    s_mov_b32 s15, 0x20000
    s_and_b32 s35, s30, 3
    s_lshl_b32 s35, s35, 19
    s_lshl_b32 s39, s29, 7
    s_add_u32 s39, s39, s35
    s_add_u32 s39, s39, 393216
    buffer_load_dwordx4 v[144:147], v238, s[12:15], s39 offen
    s_add_u32 s39, s39, 16384
    buffer_load_dwordx4 v[148:151], v238, s[12:15], s39 offen
    s_add_u32 s39, s39, 16384
    buffer_load_dwordx4 v[152:155], v238, s[12:15], s39 offen
    s_add_u32 s39, s39, 16384
    buffer_load_dwordx4 v[156:159], v238, s[12:15], s39 offen
    s_add_u32 s39, s39, 16384
    s_waitcnt vmcnt(8)
    buffer_load_dwordx4 v[160:163], v238, s[12:15], s39 offen
    s_add_u32 s39, s39, 16384
    buffer_load_dwordx4 v[164:167], v238, s[12:15], s39 offen
    s_add_u32 s39, s39, 16384
    buffer_load_dwordx4 v[168:171], v238, s[12:15], s39 offen
    s_add_u32 s39, s39, 16384
    buffer_load_dwordx4 v[172:175], v238, s[12:15], s39 offen
    s_add_u32 s39, s39, 16384
    s_waitcnt vmcnt(8)
    s_setpc_b64 s[76:77]
SUB_w1_put:
    s_and_b32 s35, s30, 3
    s_mul_i32 s35, s35, 18432
    v_add_u32 v8, s35, v2
    v_mov_b32 v6, 162836
spin_78:
    s_sleep 2
    ds_read_b32 v7, v6
    s_waitcnt lgkmcnt(0)
    v_readfirstlane_b32 s53, v7
    s_nop 0
    s_cmp_ge_u32 s53, 8
    s_cbranch_scc0 spin_78
    s_waitcnt vmcnt(24)
    ds_write_b128 v8, v[176:179] offset:24576
    ds_write_b128 v8, v[188:191] offset:25600
    ds_write_b128 v8, v[192:195] offset:26624
    ds_write_b128 v8, v[200:203] offset:27648
    ds_write_b128 v8, v[204:207] offset:28672
    ds_write_b128 v8, v[208:211] offset:29696
    ds_write_b128 v8, v[212:215] offset:30720
    ds_write_b128 v8, v[216:219] offset:31744
    ds_write_b128 v8, v[220:223] offset:32768
    ds_write_b128 v8, v[224:227] offset:33792
    ds_write_b128 v8, v[16:19] offset:34816
    ds_write_b128 v8, v[20:23] offset:35840
    ds_write_b128 v8, v[24:27] offset:36864
    ds_write_b128 v8, v[28:31] offset:37888
    ds_write_b128 v8, v[32:35] offset:38912
    ds_write_b128 v8, v[36:39] offset:39936
    ds_write_b128 v8, v[40:43] offset:40960
    ds_write_b128 v8, v[44:47] offset:41984
    s_waitcnt lgkmcnt(0)
    s_setpc_b64 s[76:77]
SUB_after_g1:
    s_mov_b64 s[12:13], s[72:73]
    s_mov_b32 s14, 7340032
    s_mov_b32 s15, 0x20000
    v_readlane_b32 s36, v251, 0
    v_readlane_b32 s37, v251, 1
    v_readlane_b32 s34, v251, 2
    s_and_b32 s35, s30, 3
    s_mul_i32 s38, s35, 114688
    s_mul_i32 s39, s29, 448
    s_add_u32 s38, s38, s39
    s_and_b32 s36, s36, 15
    s_mul_i32 s36, s36, 458752
    s_add_u32 s36, s36, s38
    s_and_b32 s37, s37, 15
    s_mul_i32 s37, s37, 458752
    s_add_u32 s37, s37, s38
    s_and_b32 s34, s34, 15
    s_mul_i32 s34, s34, 458752
    s_add_u32 s34, s34, s38
    s_mul_i32 s39, s35, 7168
    s_add_u32 m0, s39, 131072
    s_nop 0
    buffer_load_dwordx4 v241, s[12:15], s36 offen lds
    s_add_u32 m0, m0, 1024
    s_nop 0
    buffer_load_dwordx4 v242, s[12:15], s36 offen lds
    s_add_u32 m0, m0, 1024
    s_nop 0
    buffer_load_dwordx4 v243, s[12:15], s36 offen lds
    s_add_u32 m0, m0, 1024
    s_nop 0
    buffer_load_dwordx4 v244, s[12:15], s36 offen lds
    s_add_u32 m0, m0, 1024
    s_nop 0
    buffer_load_dwordx4 v245, s[12:15], s36 offen lds
    s_add_u32 m0, m0, 1024
    s_nop 0
    buffer_load_dwordx4 v246, s[12:15], s36 offen lds
    s_add_u32 m0, m0, 1024
    s_nop 0
    buffer_load_dwordx4 v247, s[12:15], s36 offen lds
    buffer_load_dwordx4 v[176:179], v241, s[12:15], s37 offen
    buffer_load_dwordx4 v[180:183], v242, s[12:15], s37 offen
    buffer_load_dwordx4 v[184:187], v243, s[12:15], s37 offen
    buffer_load_dwordx4 v[188:191], v244, s[12:15], s37 offen
    buffer_load_dwordx4 v[192:195], v245, s[12:15], s37 offen
    buffer_load_dwordx4 v[196:199], v246, s[12:15], s37 offen
    buffer_load_dwordx4 v[200:203], v247, s[12:15], s37 offen
    s_lshr_b32 s36, s67, 2
    s_sub_u32 s36, s35, s36
    s_and_b32 s36, s36, 3
    s_lshl_b32 s36, s36, 15
    v_add_u32 v6, s36, v2
    s_waitcnt vmcnt(14)
    ds_write_b128 v6, v[48:51] offset:0
    ds_write_b128 v6, v[52:55] offset:1024
    ds_write_b128 v6, v[56:59] offset:2048
    ds_write_b128 v6, v[60:63] offset:3072
    ds_write_b128 v6, v[64:67] offset:4096
    ds_write_b128 v6, v[68:71] offset:5120
    ds_write_b128 v6, v[72:75] offset:6144
    ds_write_b128 v6, v[76:79] offset:7168
    ds_write_b128 v6, v[80:83] offset:8192
    ds_write_b128 v6, v[84:87] offset:9216
    ds_write_b128 v6, v[88:91] offset:10240
    ds_write_b128 v6, v[92:95] offset:11264
    ds_write_b128 v6, v[96:99] offset:12288
    ds_write_b128 v6, v[100:103] offset:13312
    ds_write_b128 v6, v[104:107] offset:14336
    ds_write_b128 v6, v[108:111] offset:15360
    ds_write_b128 v6, v[112:115] offset:16384
    ds_write_b128 v6, v[116:119] offset:17408
    ds_write_b128 v6, v[120:123] offset:18432
    ds_write_b128 v6, v[124:127] offset:19456
    ds_write_b128 v6, v[128:131] offset:20480
    ds_write_b128 v6, v[132:135] offset:21504
    ds_write_b128 v6, v[136:139] offset:22528
    ds_write_b128 v6, v[140:143] offset:23552
    ds_write_b128 v6, v[144:147] offset:24576
    ds_write_b128 v6, v[148:151] offset:25600
    ds_write_b128 v6, v[152:155] offset:26624
    ds_write_b128 v6, v[156:159] offset:27648
    ds_write_b128 v6, v[160:163] offset:28672
    ds_write_b128 v6, v[164:167] offset:29696
    ds_write_b128 v6, v[168:171] offset:30720
    ds_write_b128 v6, v[172:175] offset:31744
    s_waitcnt lgkmcnt(0)
    s_setpc_b64 s[76:77]
SUB_after_g2:
    s_and_b32 s35, s30, 3
    s_mul_i32 s39, s35, 7168
    s_add_u32 s39, s39, 73728
    v_add_u32 v7, s39, v2
    ds_write_b128 v7, v[176:179] offset:0
    ds_write_b128 v7, v[180:183] offset:1024
    ds_write_b128 v7, v[184:187] offset:2048
    ds_write_b128 v7, v[188:191] offset:3072
    ds_write_b128 v7, v[192:195] offset:4096
    ds_write_b128 v7, v[196:199] offset:5120
    ds_write_b128 v7, v[200:203] offset:6144
    s_waitcnt lgkmcnt(0)
    s_setpc_b64 s[76:77]
SUB_r_pre:
    v_and_b32 v199, 7, v0
    v_lshrrev_b32 v228, 6, v0
    v_lshlrev_b32 v228, 4, v228
    v_bfe_u32 v229, v0, 3, 3
    v_add_u32 v228, v228, v229
    s_lshr_b32 s78, s29, 1
    s_lshl_b32 s78, s78, 16
    s_and_b32 s79, s29, 1
    s_lshl_b32 s79, s79, 7
    s_add_u32 s78, s78, s79
    s_lshr_b32 s79, s30, 1
    s_lshl_b32 s79, s79, 13
    s_add_u32 s78, s78, s79
    v_lshlrev_b32 v196, 8, v228
    v_lshl_add_u32 v196, v199, 4, v196
    v_add_u32 v196, s78, v196
    s_mov_b32 s84, s62
    s_mov_b32 s85, s63
    s_mov_b32 s86, 0x7e000
    s_mov_b32 s87, 0x20000
    s_add_u32 s88, s62, 0x80000
    s_addc_u32 s89, s63, 0
    s_mov_b32 s90, 0x7e000
    s_mov_b32 s91, 0x20000
    buffer_load_dwordx4 v[180:183], v196, s[84:87], 0 offen offset:0 sc1
    buffer_load_dwordx4 v[188:191], v196, s[88:91], 0 offen offset:0 sc1
    buffer_load_dwordx4 v[184:187], v196, s[84:87], 0 offen offset:2048 sc1
    buffer_load_dwordx4 v[192:195], v196, s[88:91], 0 offen offset:2048 sc1
    s_setpc_b64 s[76:77]
SUB_r_pre0:
    v_and_b32 v199, 7, v0
    v_lshrrev_b32 v228, 6, v0
    v_lshlrev_b32 v228, 4, v228
    v_bfe_u32 v229, v0, 3, 3
    v_add_u32 v228, v228, v229
    s_lshr_b32 s78, s29, 1
    s_lshl_b32 s78, s78, 16
    s_and_b32 s79, s29, 1
    s_lshl_b32 s79, s79, 7
    s_add_u32 s78, s78, s79
    s_lshr_b32 s79, s30, 1
    s_lshl_b32 s79, s79, 13
    s_add_u32 s78, s78, s79
    v_lshlrev_b32 v196, 8, v228
    v_lshl_add_u32 v196, v199, 4, v196
    v_add_u32 v196, s78, v196
    s_mov_b32 s84, s62
    s_mov_b32 s85, s63
    s_mov_b32 s86, 0x7e000
    s_mov_b32 s87, 0x20000
    s_add_u32 s88, s62, 0x80000
    s_addc_u32 s89, s63, 0
    s_mov_b32 s90, 0x7e000
    s_mov_b32 s91, 0x20000
    s_cmp_eq_u32 s60, 0
    s_cselect_b64 exec, -1, 0
    buffer_load_dwordx4 v[180:183], v196, s[84:87], 0 offen offset:0 sc1
    buffer_load_dwordx4 v[188:191], v196, s[88:91], 0 offen offset:0 sc1
    buffer_load_dwordx4 v[184:187], v196, s[84:87], 0 offen offset:2048 sc1
    buffer_load_dwordx4 v[192:195], v196, s[88:91], 0 offen offset:2048 sc1
    s_mov_b64 exec, -1
    s_setpc_b64 s[76:77]
SUB_w_issue_1:
    s_add_u32 s19, s41, s42
    s_mul_i32 s16, s44, 131072
    s_add_u32 s16, s16, s38
    s_add_u32 s44, s44, 1
    s_and_b32 s44, s44, 15
    s_add_u32 s42, s42, 8192
    s_cmp_eq_u32 s42, 131072
    s_cselect_b32 s42, 0, s42
    s_mov_b32 m0, s19
    s_mov_b32 s39, s16
    buffer_load_dwordx4 v238, s[12:15], s39 offen lds
    s_add_u32 m0, m0, 1024
    s_add_u32 s39, s39, 16384
    buffer_load_dwordx4 v238, s[12:15], s39 offen lds
    s_add_u32 m0, m0, 1024
    s_add_u32 s39, s39, 16384
    buffer_load_dwordx4 v238, s[12:15], s39 offen lds
    s_add_u32 m0, m0, 1024
    s_add_u32 s39, s39, 16384
    buffer_load_dwordx4 v238, s[12:15], s39 offen lds
    s_setpc_b64 s[76:77]
PREP_a_issue_4:
    s_add_u32 s19, s41, s42
    v_readlane_b32 s16, v249, s44
    v_readlane_b32 s17, v250, s44
    s_add_u32 s16, s16, s38
    s_add_u32 s17, s17, s38
    s_add_u32 s44, s44, 1
    s_add_u32 s42, s42, 16384
    s_cmp_eq_u32 s42, 49152
    s_cselect_b32 s42, 0, s42
    s_setpc_b64 s[76:77]
PREP_w_issue_4:
    s_mov_b32 s45, 8192
    s_add_u32 s19, s41, s42
    v_readlane_b32 s16, v249, s44
    s_nop 0
    s_bitcmp1_b32 s16, 0
    s_cselect_b32 s17, 16384, s45
    s_cselect_b32 s18, -40960, s45
    s_andn2_b32 s16, s16, 1
    s_add_u32 s16, s16, s38
    s_add_u32 s44, s44, 1
    s_add_u32 s42, s42, 16384
    s_cmp_eq_u32 s42, 98304
    s_cselect_b32 s42, 0, s42
    s_setpc_b64 s[76:77]
K_end:
    s_endpgm
.p2align 6
K_tab:
.short 4096,5137,6178,11379,18660,25941,40502,33223,47784,55065,19706,12427,26988,34269,48830,41551,56096,9264,20736,10448,23824,25008,38384,35296,39568,49856,54128,52944,0,0,0,0
.short 4096,5137,6178,18659,11380,25941,33222,47783,40504,55065,12426,26987,19708,34269,41550,56111,48816,9264,10448,23824,20736,25008,35296,39568,38384,49856,52944,54128,0,0,0,0
.short 4096,5137,6178,11379,25940,18661,33222,40503,55064,47785,12426,19707,34268,26989,41550,48831,9264,56096,10448,20736,25008,23824,35296,38384,49856,39568,52944,54128,0,0,0,0
.short 4096,5137,6178,11379,18660,33221,25942,40503,47784,12425,55066,19707,26988,41549,34270,48831,56096,10448,9264,20736,23824,35296,25008,38384,39568,52944,49856,54128,0,0,0,0
.short 11377,12418,13459,18660,4101,25942,33223,47784,40505,55066,5147,26988,19709,34270,41551,56096,48816,6176,10288,23824,20736,25008,35296,39568,38384,49856,52944,54128,0,0,0,0
.short 11377,12418,13459,4100,25941,18662,33223,40504,55065,47786,5147,19708,34269,26990,41551,48816,6176,56096,10288,20736,25008,23824,35296,38384,49856,39568,52944,54128,0,0,0,0
.short 11377,12418,13459,4100,18661,33222,25943,40504,47785,5146,55067,19708,26989,41550,34271,48816,56096,10288,6176,20736,23824,35296,25008,38384,39568,52944,49856,54128,0,0,0,0
.short 11377,12418,13459,4100,18661,25942,40503,33224,47785,55066,19707,5148,26989,34270,48831,41536,56096,6176,20736,10288,23824,25008,38384,35296,39568,49856,54128,52944,0,0,0,0
.short 18658,19699,20740,4101,25942,11383,33224,40505,55066,47787,5148,12429,34270,26991,41536,48817,6176,56096,9264,10448,25008,23824,35296,38384,49856,39568,52944,54128,0,0,0,0
.short 18658,19699,20740,4101,11382,33223,25944,40505,47786,5147,55068,12429,26990,41551,34256,48817,56096,9264,6176,10448,23824,35296,25008,38384,39568,52944,49856,54128,0,0,0,0
.short 18658,19699,20740,4101,11382,25943,40504,33225,47786,55067,12428,5149,26990,34271,48816,41537,56096,6176,10448,9264,23824,25008,38384,35296,39568,49856,54128,52944,0,0,0,0
.short 18658,19699,20740,11381,4102,25943,33224,47785,40506,55067,5148,26989,12430,34271,41536,56097,48816,6176,9264,23824,10448,25008,35296,39568,38384,49856,52944,54128,0,0,0,0
.short 25939,26980,28021,4102,11383,33224,18665,40506,47787,5148,55069,12430,19711,41536,34257,48818,56096,9264,6176,10448,20736,35296,24848,38384,39568,52944,49856,54128,0,0,0,0
.short 25939,26980,28021,4102,11383,18664,40505,33226,47787,55068,12429,5150,19711,34256,48817,41538,56096,6176,10448,9264,20736,24848,38384,35296,39568,49856,54128,52944,0,0,0,0
.short 25939,26980,28021,11382,4103,18664,33225,47786,40507,55068,5149,19710,12431,34256,41537,56098,48816,6176,9264,20736,10448,24848,35296,39568,38384,49856,52944,54128,0,0,0,0
.short 25939,26980,28021,4102,18663,11384,33225,40506,55067,47788,5149,12430,34271,19696,41537,48818,6176,56096,9264,10448,24848,20736,35296,38384,49856,39568,52944,54128,0,0,0,0
.short 33220,34261,35302,4103,11384,18665,40506,25947,47788,55069,12430,5151,19696,26977,48818,41539,56096,6176,10448,9264,20736,23824,38384,25008,39568,49856,54128,52944,0,0,0,0
.short 33220,34261,35302,11383,4104,18665,25946,47787,40508,55069,5150,19711,12416,26977,41538,56099,48816,6176,9264,20736,10448,23824,25008,39568,38384,49856,52944,54128,0,0,0,0
.short 33220,34261,35302,4103,18664,11385,25946,40507,55068,47789,5150,12431,26976,19697,41538,48819,6176,56096,9264,10448,23824,20736,25008,38384,49856,39568,52944,54128,0,0,0,0
.short 33220,34261,35302,4103,11384,25945,18666,40507,47788,5149,55070,12431,19696,41537,26978,48819,56096,9264,6176,10448,20736,25008,23824,38384,39568,52944,49856,54128,0,0,0,0
.short 40501,41542,42583,11384,4105,18666,25947,47788,33229,55070,5151,19696,12417,26978,34259,56100,48816,6176,9264,20736,10448,23824,25008,39408,35296,49856,52944,54128,0,0,0,0
.short 40501,41542,42583,4104,18665,11386,25947,33228,55069,47790,5151,12416,26977,19698,34259,48820,6176,56096,9264,10448,23824,20736,25008,35296,49856,39408,52944,54128,0,0,0,0
.short 40501,41542,42583,4104,11385,25946,18667,33228,47789,5150,55071,12416,19697,34258,26979,48820,56096,9264,6176,10448,20736,25008,23824,35296,39408,52944,49856,54128,0,0,0,0
.short 40501,41542,42583,4104,11385,18666,33227,25948,47789,55070,12431,5136,19697,26978,48819,34260,56096,6176,10448,9264,20736,23824,35296,25008,39408,49856,54128,52944,0,0,0,0
.short 47782,48823,49864,4105,18666,11387,25948,33229,55070,40511,5136,12417,26978,19699,34260,41541,6176,56096,9264,10448,23824,20736,25008,35296,39568,38384,52944,54128,0,0,0,0
.short 47782,48823,49864,4105,11386,25947,18668,33229,40510,5151,55056,12417,19698,34259,26980,41541,56096,9264,6176,10448,20736,25008,23824,35296,38384,52944,39568,54128,0,0,0,0
.short 47782,48823,49864,4105,11386,18667,33228,25949,40510,55071,12416,5137,19698,26979,41540,34261,56096,6176,10448,9264,20736,23824,35296,25008,38384,39568,54128,52944,0,0,0,0
.short 47782,48823,49864,11385,4106,18667,25948,40509,33230,55071,5136,19697,12418,26979,34260,56101,41536,6176,9264,20736,10448,23824,25008,38384,35296,39568,52944,54128,0,0,0,0
.short 55063,56104,57145,4106,11387,25948,18669,33230,40511,5136,47777,12418,19699,34260,26981,41542,48816,9264,6176,10448,20736,25008,23824,35296,38384,49856,39568,53968,0,0,0,0
.short 55063,56104,57145,4106,11387,18668,33229,25950,40511,47776,12417,5138,19699,26980,41541,34262,48816,6176,10448,9264,20736,23824,35296,25008,38384,39568,53968,49856,0,0,0,0
.short 55063,56104,57145,11386,4107,18668,25949,40510,33231,47776,5137,19698,12419,26980,34261,48822,41536,6176,9264,20736,10448,23824,25008,38384,35296,39568,49856,53968,0,0,0,0
.short 55063,56104,57145,4106,18667,11388,25949,33230,47791,40496,5137,12418,26979,19700,34261,41542,6176,48816,9264,10448,23824,20736,25008,35296,39568,38384,49856,53968,0,0,0,0
.short 4104,5145,6186,11387,18668,25949,40510,33231,47776,55057,19698,12419,26980,34261,48822,41543,56096,9264,20736,10448,23824,25008,38384,35296,39568,49856,54128,52944,0,0,0,0
.short 4104,5145,6186,18667,11388,25949,33230,47791,40496,55057,12418,26979,19700,34261,41542,56103,48816,9264,10448,23824,20736,25008,35296,39568,38384,49856,52944,54128,0,0,0,0
.short 4104,5145,6186,11387,25948,18669,33230,40511,55056,47777,12418,19699,34260,26981,41542,48823,9264,56096,10448,20736,25008,23824,35296,38384,49856,39568,52944,54128,0,0,0,0
.short 4104,5145,6186,11387,18668,33229,25950,40511,47776,12417,55058,19699,26980,41541,34262,48823,56096,10448,9264,20736,23824,35296,25008,38384,39568,52944,49856,54128,0,0,0,0
.short 11385,12426,13467,18668,4109,25950,33231,47776,40497,55058,5139,26980,19701,34262,41543,56104,48816,6176,10288,23824,20736,25008,35296,39568,38384,49856,52944,54128,0,0,0,0
.short 11385,12426,13467,4108,25949,18670,33231,40496,55057,47778,5139,19700,34261,26982,41543,48824,6176,56096,10288,20736,25008,23824,35296,38384,49856,39568,52944,54128,0,0,0,0
.short 11385,12426,13467,4108,18669,33230,25951,40496,47777,5138,55059,19700,26981,41542,34263,48824,56096,10288,6176,20736,23824,35296,25008,38384,39568,52944,49856,54128,0,0,0,0
.short 11385,12426,13467,4108,18669,25950,40511,33216,47777,55058,19699,5140,26981,34262,48823,41544,56096,6176,20736,10288,23824,25008,38384,35296,39568,49856,54128,52944,0,0,0,0
.short 18666,19707,20748,4109,25950,11391,33216,40497,55058,47779,5140,12421,34262,26983,41544,48825,6176,56096,9264,10448,25008,23824,35296,38384,49856,39568,52944,54128,0,0,0,0
.short 18666,19707,20748,4109,11390,33231,25936,40497,47778,5139,55060,12421,26982,41543,34264,48825,56096,9264,6176,10448,23824,35296,25008,38384,39568,52944,49856,54128,0,0,0,0
.short 18666,19707,20748,4109,11390,25951,40496,33217,47778,55059,12420,5141,26982,34263,48824,41545,56096,6176,10448,9264,23824,25008,38384,35296,39568,49856,54128,52944,0,0,0,0
.short 18666,19707,20748,11389,4110,25951,33216,47777,40498,55059,5140,26981,12422,34263,41544,56105,48816,6176,9264,23824,10448,25008,35296,39568,38384,49856,52944,54128,0,0,0,0
.short 25947,26988,28029,4110,11391,33216,18657,40498,47779,5140,55061,12422,19703,41544,34265,48826,56096,9264,6176,10448,20736,35296,24848,38384,39568,52944,49856,54128,0,0,0,0
.short 25947,26988,28029,4110,11391,18656,40497,33218,47779,55060,12421,5142,19703,34264,48825,41546,56096,6176,10448,9264,20736,24848,38384,35296,39568,49856,54128,52944,0,0,0,0
.short 25947,26988,28029,11390,4111,18656,33217,47778,40499,55060,5141,19702,12423,34264,41545,56106,48816,6176,9264,20736,10448,24848,35296,39568,38384,49856,52944,54128,0,0,0,0
.short 25947,26988,28029,4110,18671,11376,33217,40498,55059,47780,5141,12422,34263,19704,41545,48826,6176,56096,9264,10448,24848,20736,35296,38384,49856,39568,52944,54128,0,0,0,0
.short 33228,34269,35310,4111,11376,18657,40498,25939,47780,55061,12422,5143,19704,26985,48826,41547,56096,6176,10448,9264,20736,23824,38384,25008,39568,49856,54128,52944,0,0,0,0
.short 33228,34269,35310,11391,4096,18657,25938,47779,40500,55061,5142,19703,12424,26985,41546,56107,48816,6176,9264,20736,10448,23824,25008,39568,38384,49856,52944,54128,0,0,0,0
.short 33228,34269,35310,4111,18656,11377,25938,40499,55060,47781,5142,12423,26984,19705,41546,48827,6176,56096,9264,10448,23824,20736,25008,38384,49856,39568,52944,54128,0,0,0,0
.short 33228,34269,35310,4111,11376,25937,18658,40499,47780,5141,55062,12423,19704,41545,26986,48827,56096,9264,6176,10448,20736,25008,23824,38384,39568,52944,49856,54128,0,0,0,0
.short 40509,41550,42591,11376,4097,18658,25939,47780,33221,55062,5143,19704,12425,26986,34267,56108,48816,6176,9264,20736,10448,23824,25008,39408,35296,49856,52944,54128,0,0,0,0
.short 40509,41550,42591,4096,18657,11378,25939,33220,55061,47782,5143,12424,26985,19706,34267,48828,6176,56096,9264,10448,23824,20736,25008,35296,49856,39408,52944,54128,0,0,0,0
.short 40509,41550,42591,4096,11377,25938,18659,33220,47781,5142,55063,12424,19705,34266,26987,48828,56096,9264,6176,10448,20736,25008,23824,35296,39408,52944,49856,54128,0,0,0,0
.short 40509,41550,42591,4096,11377,18658,33219,25940,47781,55062,12423,5144,19705,26986,48827,34268,56096,6176,10448,9264,20736,23824,35296,25008,39408,49856,54128,52944,0,0,0,0
.short 47790,48831,49856,4097,18658,11379,25940,33221,55062,40503,5144,12425,26986,19707,34268,41549,6176,56096,9264,10448,23824,20736,25008,35296,39568,38384,52944,54128,0,0,0,0
.short 47790,48831,49856,4097,11378,25939,18660,33221,40502,5143,55064,12425,19706,34267,26988,41549,56096,9264,6176,10448,20736,25008,23824,35296,38384,52944,39568,54128,0,0,0,0
.short 47790,48831,49856,4097,11378,18659,33220,25941,40502,55063,12424,5145,19706,26987,41548,34269,56096,6176,10448,9264,20736,23824,35296,25008,38384,39568,54128,52944,0,0,0,0
.short 47790,48831,49856,11377,4098,18659,25940,40501,33222,55063,5144,19705,12426,26987,34268,56109,41536,6176,9264,20736,10448,23824,25008,38384,35296,39568,52944,54128,0,0,0,0
.short 55071,56096,57137,4098,11379,25940,18661,33222,40503,5144,47785,12426,19707,34268,26989,41550,48816,9264,6176,10448,20736,25008,23824,35296,38384,49856,39568,53968,0,0,0,0
.short 55071,56096,57137,4098,11379,18660,33221,25942,40503,47784,12425,5146,19707,26988,41549,34270,48816,6176,10448,9264,20736,23824,35296,25008,38384,39568,53968,49856,0,0,0,0
.short 55071,56096,57137,11378,4099,18660,25941,40502,33223,47784,5145,19706,12427,26988,34269,48830,41536,6176,9264,20736,10448,23824,25008,38384,35296,39568,49856,53968,0,0,0,0
.short 55071,56096,57137,4098,18659,11380,25941,33222,47783,40504,5145,12426,26987,19708,34269,41550,6176,48816,9264,10448,23824,20736,25008,35296,39568,38384,49856,53968,0,0,0,0
.section .rodata,"a"
.p2align 6
.amdhsa_kernel interleave_layers__ssm_conv_h3__mixer_s_mlp__prompt_kernel
  .amdhsa_next_free_vgpr 256
  .amdhsa_next_free_sgpr 102
  .amdhsa_accum_offset 256
  .amdhsa_group_segment_fixed_size 0
  .amdhsa_kernarg_size 112
  .amdhsa_user_sgpr_count 2
  .amdhsa_user_sgpr_kernarg_segment_ptr 1
  .amdhsa_system_sgpr_workgroup_id_x 1
  .amdhsa_float_denorm_mode_32 3
.end_amdhsa_kernel
```

```asm
; @launch grid=(256,1,1) block=(512,1,1) lds=163840
.amdgcn_target "amdgcn-amd-amdhsa--gfx950"
.text
.globl interleave_layers__ssm_conv_h3__mixer_s_mlp__prompt_kernel
.p2align 8
.type interleave_layers__ssm_conv_h3__mixer_s_mlp__prompt_kernel,@function
interleave_layers__ssm_conv_h3__mixer_s_mlp__prompt_kernel:
    s_cmp_ge_u32 s2, 256
    s_cbranch_scc1 K_end
    s_load_dwordx8 s[8:15], s[0:1], 8
    s_load_dwordx2 s[6:7], s[0:1], 0
    s_load_dwordx8 s[68:75], s[0:1], 56
    s_load_dwordx2 s[4:5], s[0:1], 104
    s_load_dwordx2 s[84:85], s[0:1], 96
    s_memrealtime s[46:47]
    s_load_dwordx2 s[96:97], s[0:1], 40
    v_lshrrev_b32 v1, 6, v0
    s_nop 0
    v_readfirstlane_b32 s30, v1
    s_getpc_b64 s[48:49]
K_pc:
    s_lshr_b32 s36, s2, 3
    s_lshl_b32 s36, s36, 11
    v_lshlrev_b32 v4, 2, v0
    v_add_u32 v4, s36, v4
    v_cmp_gt_u32 vcc, K_end-K_pc-8, v4
    s_nop 0
    s_and_saveexec_b64 s[36:37], vcc
    s_cbranch_execz K_3
    v_mov_b32 v5, s49
    v_add_co_u32 v4, vcc, s48, v4
    s_nop 1
    v_addc_co_u32 v5, vcc, 0, v5, vcc
    global_load_dword v250, v[4:5], off
K_3:
    s_mov_b64 exec, -1
    v_and_b32 v6, 31, v0
    v_lshrrev_b32 v7, 5, v0
    s_and_b32 s34, s2, 7
    s_lshr_b32 s35, s2, 3
    s_lshl_b32 s36, s35, 17
    s_lshl_b32 s37, s34, 8
    s_add_u32 s36, s36, s37
    v_lshlrev_b32 v8, 13, v7
    v_lshl_add_u32 v8, v6, 3, v8
    v_add_u32 v12, s36, v8
    v_add_u32 v14, 4096, v12
    s_mov_b32 s18, 4194304
    s_mov_b32 s19, 0x20000
    s_mov_b32 s22, s18
    s_mov_b32 s23, s19
    s_waitcnt lgkmcnt(0)
    s_mov_b32 s86, 256
    s_mov_b32 s87, 0x20000
    v_mov_b32 v78, 0
    s_lshl_b32 s45, s2, 3
    s_add_u32 s45, s45, s30
    s_cmp_lg_u32 s45, 4
    s_cbranch_scc1 KV_t0
    s_getreg_b32 s45, hwreg(HW_REG_XCC_ID, 0, 3)
    s_lshl_b32 s45, s45, 1
    s_lshl_b32 s44, s46, 6
    s_or_b32 s44, s44, s45
    s_or_b32 s44, s44, 1
    v_mov_b32 v76, s44
    v_mov_b32 v77, 0
    s_mov_b64 exec, 1
    buffer_store_dwordx2 v[76:77], v78, s[84:87], 0 offen sc1
    s_mov_b64 exec, -1
KV_t0:
    s_mov_b64 s[16:17], s[8:9]
    s_mov_b64 s[20:21], s[10:11]
    buffer_load_dwordx2 v[28:29], v12, s[16:19], 0 offen offset:0 nt
    buffer_load_dwordx2 v[30:31], v12, s[16:19], 0 offen offset:2048 nt
    buffer_load_dwordx2 v[32:33], v14, s[16:19], 0 offen offset:0 nt
    buffer_load_dwordx2 v[34:35], v14, s[16:19], 0 offen offset:2048 nt
    buffer_load_dwordx2 v[36:37], v12, s[20:23], 0 offen offset:0 nt
    buffer_load_dwordx2 v[38:39], v12, s[20:23], 0 offen offset:2048 nt
    buffer_load_dwordx2 v[40:41], v14, s[20:23], 0 offen offset:0 nt
    buffer_load_dwordx2 v[42:43], v14, s[20:23], 0 offen offset:2048 nt
    v_subrev_u32 v9, 6144, v12
    v_subrev_u32 v10, 4096, v12
    v_subrev_u32 v11, 2048, v12
    s_lshl_b32 s37, s34, 10
    v_lshlrev_b32 v16, 5, v6
    v_add_u32 v16, s37, v16
    s_mov_b32 s24, s12
    s_mov_b32 s25, s13
    s_mov_b32 s26, 0x2000
    s_mov_b32 s27, 0x20000
    v_and_b32 v8, 1, v7
    v_lshl_add_u32 v16, v8, 4, v16
    buffer_load_dwordx4 v[44:47], v16, s[24:27], 0 offen
    s_cmp_lg_u32 s30, 4
    s_cbranch_scc1 KV_t2
    buffer_load_dword v76, v78, s[84:87], 0 offen sc1
KV_t2:
    s_bfm_b64 exec, 32, 0
    buffer_load_dwordx2 v[22:23], v9, s[16:19], 0 offen nt
    buffer_load_dwordx2 v[24:25], v10, s[16:19], 0 offen nt
    buffer_load_dwordx2 v[26:27], v11, s[16:19], 0 offen nt
    s_mov_b64 exec, -1
    v_and_b32 v1, 63, v0
    v_lshlrev_b32 v2, 4, v1
    v_lshlrev_b32 v3, 2, v1
    s_mov_b32 s67, 0
    s_mov_b32 s60, 0
    s_mov_b32 s61, 40000
    s_mov_b32 s52, 0
    s_mov_b32 s55, 0
    s_mov_b32 s92, 0
    s_mov_b32 s93, 0
    s_mov_b32 s94, 0
    s_mov_b32 s56, s4
    s_mov_b32 s57, s5
    s_mov_b32 s58, 0xa000000
    s_mov_b32 s59, 0x20000
    s_add_u32 s62, s4, 33554432
    s_addc_u32 s63, s5, 0
    s_and_b32 s41, s30, 3
    s_and_b32 s38, s2, 7
    s_lshl_b32 s38, s38, 5
    s_lshr_b32 s39, s2, 3
    s_add_u32 s38, s38, s39
    s_lshl_b32 s39, s38, 2
    s_add_u32 s39, s39, s41
    s_mul_i32 s40, s41, 24576
    s_lshr_b32 s36, s39, 1
    s_lshl_b32 s36, s36, 2
    s_load_dword s98, s[96:97], s36
    s_lshl_b32 s36, s39, 12
    s_add_u32 s12, s14, s36
    s_addc_u32 s13, s15, 0
    s_mov_b32 s14, 4096
    s_mov_b32 s15, 0x20000
    s_lshr_b32 s45, s30, 2
    s_lshl_b32 s45, s45, 11
    s_add_u32 s36, s45, 0xffffffc0
    v_add_u32 v70, s36, v2
    v_add_u32 v71, 16, v70
    s_add_u32 s36, s45, 0x3c0
    v_add_u32 v72, s36, v2
    v_add_u32 v73, 16, v72
    s_mov_b32 s36, 4032
    v_add_u32 v74, s36, v2
    v_add_u32 v75, 16, v74
    s_and_b32 s34, s2, 7
    s_lshr_b32 s35, s2, 3
    v_mov_b32 v80, 0
    v_mov_b32 v81, 0
    v_mov_b32 v82, 0
    v_mov_b32 v83, 0
    v_add_u32 v86, s40, v2
    ds_write_b128 v86, v[80:83] offset:22784
    s_bfm_b64 exec, 26, 0
    ds_write_b128 v86, v[80:83] offset:23808
    s_mov_b64 exec, -1
    v_lshlrev_b32 v8, 2, v7
    v_sub_u32 v8, 60, v8
    v_lshrrev_b32 v85, 3, v8
    v_bfe_u32 v84, v6, 1, 3
    v_xor_b32 v85, v85, v84
    v_lshlrev_b32 v85, 4, v85
    v_and_b32 v8, 7, v8
    v_lshl_add_u32 v85, v8, 1, v85
    v_lshl_add_u32 v84, v6, 9, v85
    v_add_u32 v84, 98304, v84
    s_waitcnt vmcnt(0)
    s_cmp_lg_u32 s30, 4
    s_cbranch_scc1 KV_t1
KV_t1:
    buffer_load_dwordx4 v[52:55], v70, s[12:15], 0 offen nt
    buffer_load_dwordx2 v[56:57], v71, s[12:15], 0 offen nt
    buffer_load_dwordx4 v[58:61], v72, s[12:15], 0 offen nt
    buffer_load_dwordx2 v[62:63], v73, s[12:15], 0 offen nt
    buffer_load_dwordx4 v[64:67], v74, s[12:15], 0 offen nt
    buffer_load_dwordx2 v[68:69], v75, s[12:15], 0 offen nt
    v_mov_b32 v48, v44
    v_mov_b32 v49, v45
    v_mov_b32 v50, v46
    v_mov_b32 v51, v47
    v_mov_b32 v126, v30
    v_mov_b32 v127, v31
    v_mov_b32 v128, v32
    v_mov_b32 v129, v33
    v_mov_b32 v130, v34
    v_mov_b32 v131, v35
    v_permlane32_swap_b32 v44, v48
    v_permlane32_swap_b32 v45, v49
    v_permlane32_swap_b32 v46, v50
    v_permlane32_swap_b32 v47, v51
    v_permlane32_swap_b32 v22, v126
    v_permlane32_swap_b32 v23, v127
    v_permlane32_swap_b32 v24, v128
    v_permlane32_swap_b32 v25, v129
    v_permlane32_swap_b32 v26, v130
    v_permlane32_swap_b32 v27, v131
    v_lshlrev_b32 v88, 16, v44
    v_and_b32 v90, 0xffff0000, v44
    v_lshlrev_b32 v92, 16, v45
    v_and_b32 v94, 0xffff0000, v45
    v_lshlrev_b32 v89, 16, v46
    v_and_b32 v91, 0xffff0000, v46
    v_lshlrev_b32 v93, 16, v47
    v_and_b32 v95, 0xffff0000, v47
    v_lshlrev_b32 v96, 16, v22
    v_and_b32 v97, 0xffff0000, v22
    v_lshlrev_b32 v98, 16, v24
    v_and_b32 v99, 0xffff0000, v24
    v_lshlrev_b32 v100, 16, v26
    v_and_b32 v101, 0xffff0000, v26
    v_lshlrev_b32 v102, 16, v28
    v_and_b32 v103, 0xffff0000, v28
    v_lshlrev_b32 v104, 16, v30
    v_and_b32 v105, 0xffff0000, v30
    v_lshlrev_b32 v106, 16, v32
    v_and_b32 v107, 0xffff0000, v32
    v_lshlrev_b32 v108, 16, v34
    v_and_b32 v109, 0xffff0000, v34
    v_lshlrev_b32 v110, 16, v36
    v_and_b32 v111, 0xffff0000, v36
    v_lshlrev_b32 v112, 16, v38
    v_and_b32 v113, 0xffff0000, v38
    v_lshlrev_b32 v114, 16, v40
    v_and_b32 v115, 0xffff0000, v40
    v_lshlrev_b32 v116, 16, v42
    v_and_b32 v117, 0xffff0000, v42
    v_pk_mul_f32 v[118:119], v[96:97], v[94:95]
    v_pk_mul_f32 v[120:121], v[98:99], v[94:95]
    v_pk_mul_f32 v[122:123], v[100:101], v[94:95]
    v_pk_mul_f32 v[124:125], v[102:103], v[94:95]
    v_pk_fma_f32 v[118:119], v[98:99], v[92:93], v[118:119]
    v_pk_fma_f32 v[120:121], v[100:101], v[92:93], v[120:121]
    v_pk_fma_f32 v[122:123], v[102:103], v[92:93], v[122:123]
    v_pk_fma_f32 v[124:125], v[104:105], v[92:93], v[124:125]
    v_pk_fma_f32 v[118:119], v[100:101], v[90:91], v[118:119]
    v_pk_fma_f32 v[120:121], v[102:103], v[90:91], v[120:121]
    v_pk_fma_f32 v[122:123], v[104:105], v[90:91], v[122:123]
    v_pk_fma_f32 v[124:125], v[106:107], v[90:91], v[124:125]
    v_pk_fma_f32 v[118:119], v[102:103], v[88:89], v[118:119]
    v_pk_fma_f32 v[120:121], v[104:105], v[88:89], v[120:121]
    v_pk_fma_f32 v[122:123], v[106:107], v[88:89], v[122:123]
    v_pk_fma_f32 v[124:125], v[108:109], v[88:89], v[124:125]
    v_pk_mul_f32 v[118:119], v[118:119], v[110:111]
    v_pk_mul_f32 v[120:121], v[120:121], v[112:113]
    v_pk_mul_f32 v[122:123], v[122:123], v[114:115]
    v_pk_mul_f32 v[124:125], v[124:125], v[116:117]
    v_cvt_pk_bf16_f32 v136, v124, v122
    v_cvt_pk_bf16_f32 v137, v120, v118
    ds_write_b64 v84, v[136:137] offset:0
    v_cvt_pk_bf16_f32 v138, v125, v123
    v_cvt_pk_bf16_f32 v139, v121, v119
    ds_write_b64 v84, v[138:139] offset:128
    v_lshlrev_b32 v88, 16, v48
    v_and_b32 v90, 0xffff0000, v48
    v_lshlrev_b32 v92, 16, v49
    v_and_b32 v94, 0xffff0000, v49
    v_lshlrev_b32 v89, 16, v50
    v_and_b32 v91, 0xffff0000, v50
    v_lshlrev_b32 v93, 16, v51
    v_and_b32 v95, 0xffff0000, v51
    v_lshlrev_b32 v96, 16, v23
    v_and_b32 v97, 0xffff0000, v23
    v_lshlrev_b32 v98, 16, v25
    v_and_b32 v99, 0xffff0000, v25
    v_lshlrev_b32 v100, 16, v27
    v_and_b32 v101, 0xffff0000, v27
    v_lshlrev_b32 v102, 16, v29
    v_and_b32 v103, 0xffff0000, v29
    v_lshlrev_b32 v104, 16, v31
    v_and_b32 v105, 0xffff0000, v31
    v_lshlrev_b32 v106, 16, v33
    v_and_b32 v107, 0xffff0000, v33
    v_lshlrev_b32 v108, 16, v35
    v_and_b32 v109, 0xffff0000, v35
    v_lshlrev_b32 v110, 16, v37
    v_and_b32 v111, 0xffff0000, v37
    v_lshlrev_b32 v112, 16, v39
    v_and_b32 v113, 0xffff0000, v39
    v_lshlrev_b32 v114, 16, v41
    v_and_b32 v115, 0xffff0000, v41
    v_lshlrev_b32 v116, 16, v43
    v_and_b32 v117, 0xffff0000, v43
    v_pk_mul_f32 v[118:119], v[96:97], v[94:95]
    v_pk_mul_f32 v[120:121], v[98:99], v[94:95]
    v_pk_mul_f32 v[122:123], v[100:101], v[94:95]
    v_pk_mul_f32 v[124:125], v[102:103], v[94:95]
    v_pk_fma_f32 v[118:119], v[98:99], v[92:93], v[118:119]
    v_pk_fma_f32 v[120:121], v[100:101], v[92:93], v[120:121]
    v_pk_fma_f32 v[122:123], v[102:103], v[92:93], v[122:123]
    v_pk_fma_f32 v[124:125], v[104:105], v[92:93], v[124:125]
    v_pk_fma_f32 v[118:119], v[100:101], v[90:91], v[118:119]
    v_pk_fma_f32 v[120:121], v[102:103], v[90:91], v[120:121]
    v_pk_fma_f32 v[122:123], v[104:105], v[90:91], v[122:123]
    v_pk_fma_f32 v[124:125], v[106:107], v[90:91], v[124:125]
    v_pk_fma_f32 v[118:119], v[102:103], v[88:89], v[118:119]
    v_pk_fma_f32 v[120:121], v[104:105], v[88:89], v[120:121]
    v_pk_fma_f32 v[122:123], v[106:107], v[88:89], v[122:123]
    v_pk_fma_f32 v[124:125], v[108:109], v[88:89], v[124:125]
    v_pk_mul_f32 v[118:119], v[118:119], v[110:111]
    v_pk_mul_f32 v[120:121], v[120:121], v[112:113]
    v_pk_mul_f32 v[122:123], v[122:123], v[114:115]
    v_pk_mul_f32 v[124:125], v[124:125], v[116:117]
    v_cvt_pk_bf16_f32 v140, v124, v122
    v_cvt_pk_bf16_f32 v141, v120, v118
    ds_write_b64 v84, v[140:141] offset:256
    v_cvt_pk_bf16_f32 v142, v125, v123
    v_cvt_pk_bf16_f32 v143, v121, v119
    ds_write_b64 v84, v[142:143] offset:384
    s_cmp_lg_u32 s30, 4
    s_cbranch_scc1 HB_2
    v_add_u32 v18, 162816, v3
    ds_write_b32 v18, v78
    s_mov_b32 s53, 0
    s_waitcnt vmcnt(6)
HB_p:
    v_readfirstlane_b32 s52, v76
    s_nop 0
    s_cmp_eq_u32 s52, 0
    s_cbranch_scc1 HB_r
    s_cmp_ge_u32 s53, 60
    s_cbranch_scc1 HB_q
    s_add_u32 s54, s46, 8192
    s_lshl_b32 s54, s54, 6
    s_sub_u32 s54, s54, s52
    s_cmp_lt_u32 s54, 786432
    s_cbranch_scc1 HB_q
HB_r:
    buffer_load_dword v76, v78, s[84:87], 0 offen sc1
    s_waitcnt vmcnt(0)
    s_add_u32 s53, s53, 1
    s_cmp_lt_u32 s53, s61
    s_cbranch_scc1 HB_p
    s_mov_b32 s52, 1
    s_mov_b32 s61, 0
HB_q:
    v_mov_b32 v18, 162828
    v_mov_b32 v19, s52
    s_waitcnt lgkmcnt(0)
    ds_write_b32 v18, v19
HB_2:
    s_add_u32 s16, s4, 0x2000000
    s_addc_u32 s17, s5, 0
    s_mov_b32 s18, 0x8000000
    s_mov_b32 s19, 0x20000
    v_lshrrev_b32 v8, 3, v0
    v_and_b32 v85, 7, v0
    v_lshlrev_b32 v149, 12, v8
    v_lshl_add_u32 v149, v85, 4, v149
    s_lshl_b32 s36, s34, 24
    s_sub_u32 s37, 31, s35
    s_lshl_b32 s37, s37, 7
    s_add_u32 s36, s36, s37
    s_add_u32 s37, s36, 262144
    v_lshrrev_b32 v148, 3, v8
    v_xor_b32 v148, v148, v85
    v_lshlrev_b32 v148, 4, v148
    v_lshl_add_u32 v148, v8, 7, v148
    v_add_u32 v148, 98304, v148
    v_mov_b32 v18, 162828
    s_waitcnt lgkmcnt(0)
    s_barrier
    ds_read_b128 v[152:155], v148 offset:0
    ds_read_b128 v[156:159], v148 offset:8192
    ds_read_b32 v19, v18
    s_waitcnt lgkmcnt(2)
    v_or_b32 v152, 1, v152
    buffer_store_dwordx4 v[152:155], v149, s[16:19], s36 offen sc1
    s_waitcnt lgkmcnt(1)
    v_or_b32 v156, 1, v156
    buffer_store_dwordx4 v[156:159], v149, s[16:19], s37 offen sc1
    s_waitcnt lgkmcnt(0)
    v_readfirstlane_b32 s52, v19
    s_cmp_lg_u32 s30, 0
    s_cbranch_scc1 KV_ni
    s_cmp_ge_u32 s35, 16
    s_cbranch_scc1 KV_ni
    v_mov_b32 v8, s52
    s_lshl_b32 s37, s34, 7
    s_lshl_b32 s53, s35, 10
    s_add_u32 s37, s37, s53
    s_add_u32 s37, s37, 23101440
    s_mov_b64 exec, 1
    buffer_store_dword v8, v78, s[56:59], s37 offen sc1
    s_mov_b64 exec, -1
KV_ni:
    s_cmp_ge_u32 s2, 32
    s_cbranch_scc1 KV_n3
    s_cmp_lg_u32 s30, 5
    s_cbranch_scc1 KV_n3
    s_and_b32 s42, s2, 7
    s_lshl_b32 s42, s42, 10
    s_lshr_b32 s43, s2, 3
    s_lshl_b32 s43, s43, 14
    s_add_u32 s42, s42, s43
    s_add_u32 s42, s42, 39714816
    v_lshrrev_b32 v8, 5, v1
    v_mul_u32_u24 v8, 7680, v8
    v_add_u32 v8, v8, v2
    buffer_store_dwordx4 v[80:83], v8, s[56:59], s42 offen sc1
KV_n3:
    s_bfe_u32 s32, s52, 0x30001
    s_add_u32 s32, s32, s2
    s_and_b32 s32, s32, 7
    s_lshr_b32 s33, s2, 3
    s_and_b32 s28, s32, 2
    s_lshr_b32 s53, s32, 2
    s_or_b32 s28, s28, s53
    s_lshl_b32 s28, s28, 2
    s_and_b32 s53, s33, 3
    s_add_u32 s28, s28, s53
    s_and_b32 s31, s32, 1
    s_lshr_b32 s33, s33, 2
    s_lshl_b32 s29, s31, 3
    s_add_u32 s29, s29, s33
    s_xor_b32 s99, s29, 1
    v_and_b32 v199, 7, v0
    v_lshrrev_b32 v228, 6, v0
    v_lshlrev_b32 v228, 4, v228
    v_bfe_u32 v229, v0, 3, 3
    v_add_u32 v228, v228, v229
    s_lshr_b32 s78, s29, 1
    s_lshl_b32 s78, s78, 16
    s_and_b32 s79, s29, 1
    s_lshl_b32 s79, s79, 7
    s_add_u32 s78, s78, s79
    s_lshr_b32 s79, s30, 1
    s_lshl_b32 s79, s79, 13
    s_add_u32 s78, s78, s79
    v_lshlrev_b32 v196, 8, v228
    v_lshl_add_u32 v196, v199, 4, v196
    v_add_u32 v196, s78, v196
    s_lshl_b32 s78, s28, 7
    s_lshl_b32 s79, s29, 3
    s_add_u32 s78, s78, s79
    v_add_u32 v197, s78, v199
    v_lshlrev_b32 v198, 11, v197
    v_lshrrev_b32 v229, 2, v228
    v_lshlrev_b32 v229, 3, v229
    v_and_b32 v228, 3, v228
    v_add_u32 v228, v228, v229
    v_lshl_add_u32 v198, v228, 3, v198
    v_and_b32 v197, 15, v197
    v_lshlrev_b32 v197, 4, v197
    v_and_b32 v229, 15, v228
    v_lshl_add_u32 v197, v229, 9, v197
    v_lshrrev_b32 v229, 4, v228
    v_lshl_add_u32 v197, v229, 14, v197
    s_lshr_b32 s78, s28, 3
    s_lshl_b32 s78, s78, 2
    s_and_b32 s79, s28, 3
    s_add_u32 s78, s78, s79
    s_lshl_b32 s78, s78, 24
    s_and_b32 s79, s28, 4
    s_lshl_b32 s79, s79, 11
    s_add_u32 s78, s78, s79
    s_and_b32 s79, s29, 4
    s_lshl_b32 s79, s79, 6
    s_add_u32 s78, s78, s79
    s_and_b32 s79, s29, 2
    s_lshl_b32 s79, s79, 2
    s_add_u32 s78, s78, s79
    s_lshl_b32 s79, s31, 18
    s_add_u32 s78, s78, s79
    v_add_u32 v197, s78, v197
    s_lshl_b32 s36, s34, 5
    s_add_u32 s36, s36, s35
    s_lshl_b32 s36, s36, 7
    s_add_u32 s36, s36, 23068672
    v_mov_b32 v18, 1
    v_mov_b32 v19, 162820
    v_mov_b32 v21, 0
    s_mov_b64 exec, 1
    s_waitcnt vmcnt(0)
    ds_add_rtn_u32 v20, v19, v18
    v_mov_b32 v19, s52
    s_waitcnt lgkmcnt(0)
    v_readfirstlane_b32 s54, v20
    s_nop 0
    s_and_b32 s54, s54, 7
    s_cmp_lg_u32 s54, 7
    s_cbranch_scc1 pub_1
    buffer_store_dword v19, v21, s[56:59], s36 offen sc1
pub_1:
    s_mov_b64 exec, -1
    s_mov_b32 s8, s6
    s_mov_b32 s9, s7
    s_mov_b32 s10, 0x400000
    s_mov_b32 s11, 0x20000
    buffer_load_dwordx2 v[180:181], v198, s[8:11], 0 offen offset:0 nt
    buffer_load_dwordx2 v[182:183], v198, s[8:11], 0 offen offset:32 nt
    buffer_load_dwordx2 v[184:185], v198, s[8:11], 0 offen offset:128 nt
    buffer_load_dwordx2 v[186:187], v198, s[8:11], 0 offen offset:160 nt
    v_add_u32 v160, s45, v86
    v_alignbit_b32 v88, v53, v52, 16
    v_mov_b32 v92, v53
    v_alignbit_b32 v96, v54, v53, 16
    v_alignbit_b32 v89, v54, v53, 16
    v_mov_b32 v93, v54
    v_alignbit_b32 v97, v55, v54, 16
    v_alignbit_b32 v90, v55, v54, 16
    v_mov_b32 v94, v55
    v_alignbit_b32 v98, v56, v55, 16
    v_alignbit_b32 v91, v56, v55, 16
    v_mov_b32 v95, v56
    v_alignbit_b32 v99, v57, v56, 16
    ds_write_b128 v160, v[88:91] offset:0
    ds_write_b128 v160, v[92:95] offset:4160
    ds_write_b128 v160, v[96:99] offset:8320
    ds_write_b128 v160, v[54:57] offset:12480
    v_alignbit_b32 v100, v59, v58, 16
    v_mov_b32 v104, v59
    v_alignbit_b32 v108, v60, v59, 16
    v_alignbit_b32 v101, v60, v59, 16
    v_mov_b32 v105, v60
    v_alignbit_b32 v109, v61, v60, 16
    v_alignbit_b32 v102, v61, v60, 16
    v_mov_b32 v106, v61
    v_alignbit_b32 v110, v62, v61, 16
    v_alignbit_b32 v103, v62, v61, 16
    v_mov_b32 v107, v62
    v_alignbit_b32 v111, v63, v62, 16
    ds_write_b128 v160, v[100:103] offset:1024
    ds_write_b128 v160, v[104:107] offset:5184
    ds_write_b128 v160, v[108:111] offset:9344
    ds_write_b128 v160, v[60:63] offset:13504
    v_alignbit_b32 v112, v65, v64, 16
    v_mov_b32 v116, v65
    v_alignbit_b32 v120, v66, v65, 16
    v_alignbit_b32 v113, v66, v65, 16
    v_mov_b32 v117, v66
    v_alignbit_b32 v121, v67, v66, 16
    v_alignbit_b32 v114, v67, v66, 16
    v_mov_b32 v118, v67
    v_alignbit_b32 v122, v68, v67, 16
    v_alignbit_b32 v115, v68, v67, 16
    v_mov_b32 v119, v68
    v_alignbit_b32 v123, v69, v68, 16
    s_mov_b64 exec, 0xf
    ds_write_b128 v86, v[112:115] offset:4096
    ds_write_b128 v86, v[116:119] offset:8256
    ds_write_b128 v86, v[120:123] offset:12416
    ds_write_b128 v86, v[66:69] offset:16576
    s_mov_b64 exec, -1
    s_waitcnt lgkmcnt(0)
    s_barrier
    v_mov_b32 v238, 0
    v_mov_b32 v239, 0
    v_mov_b32 v240, 0
    v_mov_b32 v241, 0
    v_mov_b32 v242, 0
    v_mov_b32 v243, 0
    v_mov_b32 v244, 0
    v_mov_b32 v245, 0
    v_mov_b32 v246, 0
    v_mov_b32 v247, 0
    s_cmp_ge_u32 s30, 4
    s_cbranch_scc1 FR_b
    s_and_b32 s38, s2, 7
    s_lshl_b32 s38, s38, 5
    s_lshr_b32 s39, s2, 3
    s_add_u32 s38, s38, s39
    s_lshl_b32 s39, s38, 2
    s_add_u32 s39, s39, s30
    s_mul_i32 s40, s30, 24576
    s_and_b32 s36, s39, 127
    s_lshl_b32 s36, s36, 12
    s_lshr_b32 s37, s39, 7
    s_lshl_b32 s37, s37, 24
    s_add_u32 s36, s36, s37
    s_add_u32 s36, s36, 33554432
    s_add_u32 s16, s4, s36
    s_addc_u32 s17, s5, 0
    s_mov_b32 s18, 4096
    s_mov_b32 s19, 0x20000
    v_lshrrev_b32 v6, 2, v1
    v_mul_u32_u24 v12, 96, v6
    v_and_b32 v6, 3, v1
    v_lshl_add_u32 v12, v6, 4, v12
    v_add_u32 v12, s40, v12
    v_and_b32 v35, 15, v1
    v_lshrrev_b32 v36, 4, v1
    v_and_b32 v6, 3, v35
    v_mul_u32_u24 v32, 4160, v6
    v_lshl_add_u32 v32, v36, 4, v32
    v_lshrrev_b32 v6, 2, v35
    v_lshl_add_u32 v32, v6, 3, v32
    v_add_u32 v32, s40, v32
    v_sub_u32 v6, 15, v35
    v_mul_u32_u24 v34, 96, v6
    v_add_u32 v34, s40, v34
    v_lshl_add_u32 v33, v36, 4, v34
    ds_read_b64 v[72:73], v32 offset:0
    ds_read_b64 v[74:75], v32 offset:8
    ds_read_b64 v[76:77], v32 offset:32
    ds_read_b64 v[78:79], v32 offset:40
    ds_read_b64 v[80:81], v32 offset:1024
    ds_read_b64 v[82:83], v32 offset:1032
    ds_read_b64 v[84:85], v32 offset:1056
    ds_read_b64 v[86:87], v32 offset:1064
    ds_read_b64 v[88:89], v32 offset:2048
    ds_read_b64 v[90:91], v32 offset:2056
    ds_read_b64 v[92:93], v32 offset:2080
    ds_read_b64 v[94:95], v32 offset:2088
    ds_read_b64 v[96:97], v32 offset:3072
    ds_read_b64 v[98:99], v32 offset:3080
    ds_read_b64 v[100:101], v32 offset:3104
    ds_read_b64 v[102:103], v32 offset:3112
    s_bitcmp1_b32 s39, 0
    s_cselect_b32 s36, 0, 16
    s_lshl_b32 s41, s98, s36
    s_and_b32 s41, s41, 0xffff0000
    s_lshr_b32 s36, s41, 16
    v_lshl_add_u32 v6, v36, 3, v35
    v_sub_u32 v6, 31, v6
    v_mov_b32 v10, s36
    v_mov_b32 v11, s41
    v_and_b32 v8, 1, v6
    v_cmp_eq_u32 vcc, 1, v8
    s_nop 1
    v_cndmask_b32 v10, v10, v11, vcc
    v_ashrrev_i32 v6, 1, v6
    v_cmp_eq_u32 vcc, 0, v6
    s_nop 1
    v_cndmask_b32 v152, 0, v10, vcc
    v_cmp_eq_u32 vcc, 1, v6
    s_nop 1
    v_cndmask_b32 v153, 0, v10, vcc
    v_cmp_eq_u32 vcc, 2, v6
    s_nop 1
    v_cndmask_b32 v154, 0, v10, vcc
    v_cmp_eq_u32 vcc, 3, v6
    s_nop 1
    v_cndmask_b32 v155, 0, v10, vcc
    v_cmp_eq_u32 vcc, 8, v6
    s_nop 1
    v_cndmask_b32 v156, 0, v10, vcc
    v_cmp_eq_u32 vcc, 9, v6
    s_nop 1
    v_cndmask_b32 v157, 0, v10, vcc
    v_cmp_eq_u32 vcc, 10, v6
    s_nop 1
    v_cndmask_b32 v158, 0, v10, vcc
    v_cmp_eq_u32 vcc, 11, v6
    s_nop 1
    v_cndmask_b32 v159, 0, v10, vcc
    s_add_u32 s12, s4, 0x2100000
    s_addc_u32 s13, s5, 0
    s_mov_b32 s14, 0x7f00000
    s_mov_b32 s15, 0x20000
    v_bfe_u32 v6, v1, 2, 2
    v_mul_u32_u24 v168, 24640, v6
    v_mul_u32_u24 v6, 72, v36
    v_add_u32 v168, v168, v6
    v_and_b32 v6, 3, v1
    v_lshl_add_u32 v168, v6, 3, v168
    s_mul_i32 s36, s30, 1152
    v_add_u32 v168, s36, v168
    v_lshrrev_b32 v6, 5, v1
    v_mul_u32_u24 v169, 261632, v6
    v_add_u32 v169, v169, v2
    s_lshr_b32 s44, s38, 4
    s_lshl_b32 s44, s44, 14
    s_and_b32 s37, s38, 15
    s_lshl_b32 s37, s37, 9
    s_add_u32 s44, s44, s37
    s_and_b32 s37, s30, 1
    s_lshl_b32 s37, s37, 13
    s_add_u32 s44, s44, s37
    s_lshr_b32 s37, s30, 1
    s_lshl_b32 s37, s37, 26
    s_add_u32 s44, s44, s37
    s_and_b32 s47, s44, 0x2000
    s_xor_b32 s47, s47, 8192
    s_lshr_b32 s37, s30, 1
    s_lshl_b32 s37, s37, 12
    s_add_u32 s47, s47, s37
    s_and_b32 s37, s2, 7
    s_lshl_b32 s37, s37, 7
    s_add_u32 s47, s47, s37
    v_mov_b32 v34, 162824
    v_mov_b32 v7, 1
    s_mul_i32 s36, s30, 24640
    v_mul_u32_u24 v170, 72, v35
    v_lshl_add_u32 v170, v36, 3, v170
    v_add_u32 v170, s36, v170
    v_lshlrev_b32 v6, 10, v1
    v_mov_b32 v35, 0
    s_and_b32 s45, s2, 31
    s_lshl_b32 s45, s45, 7
    s_add_u32 s45, s45, 23117824
    s_cmp_lg_u32 s30, 0
    s_cbranch_scc1 CV_w
    s_and_b32 s36, s2, 7
    s_lshl_b32 s36, s36, 12
    s_add_u32 s36, s36, 23068672
    v_lshlrev_b32 v9, 7, v1
    v_add_u32 v9, s36, v9
    s_mov_b32 s53, 0
    s_add_u32 s54, s52, 0
    s_bfm_b64 exec, 32, 0
poll_2:
    buffer_load_dword v8, v9, s[56:59], 0 offen sc1
    s_waitcnt vmcnt(0)
    v_xor_b32 v8, s54, v8
    v_cmp_eq_u32 vcc, 0, v8
    s_nop 0
    s_cmp_eq_u64 vcc, exec
    s_cbranch_scc1 pok_3
    s_sleep 5
    s_add_u32 s53, s53, 1
    s_cmp_lt_u32 s53, s61
    s_cbranch_scc1 poll_2
    s_mov_b32 s61, 0
pok_3:
    s_mov_b64 exec, -1
    v_mov_b32 v8, 162832
    v_mov_b32 v9, 1
    s_waitcnt lgkmcnt(0)
    ds_write_b32 v8, v9
CV_w:
    v_mov_b32 v8, 162832
spin_4:
    ds_read_b32 v9, v8
    s_waitcnt lgkmcnt(0)
    v_readfirstlane_b32 s53, v9
    s_nop 0
    s_cmp_ge_u32 s53, 1
    s_cbranch_scc0 spin_4
    buffer_load_dwordx4 v[16:19], v2, s[16:19], 0 offen offset:0 sc1 nt
    buffer_load_dwordx4 v[20:23], v2, s[16:19], 0 offen offset:1024 sc1 nt
    buffer_load_dwordx4 v[24:27], v2, s[16:19], 0 offen offset:2048 sc1 nt
    buffer_load_dwordx4 v[28:31], v2, s[16:19], 0 offen offset:3072 sc1 nt
    s_waitcnt vmcnt(3)
    ds_write_b128 v12, v[16:19] offset:16640
    s_waitcnt vmcnt(2)
    ds_write_b128 v12, v[20:23] offset:18176
    s_waitcnt vmcnt(1)
    ds_write_b128 v12, v[24:27] offset:19712
    s_waitcnt vmcnt(0)
    ds_write_b128 v12, v[28:31] offset:21248
    v_mov_b32 v8, 162836
    v_mov_b32 v9, 1
    s_mov_b64 exec, 1
    ds_add_u32 v8, v9
    s_mov_b64 exec, -1
    s_waitcnt lgkmcnt(0)
    ds_read_b128 v[136:139], v33 offset:21248
    ds_read_b128 v[140:143], v33 offset:19712
    ds_read_b128 v[144:147], v33 offset:18176
    ds_read_b128 v[148:151], v33 offset:16640
    s_waitcnt lgkmcnt(3)
    v_mfma_f32_16x16x32_bf16 v[40:43], v[152:155], v[136:139], 0
    v_mfma_f32_16x16x32_bf16 v[44:47], v[156:159], v[136:139], 0
    s_waitcnt lgkmcnt(2)
    v_mfma_f32_16x16x32_bf16 v[48:51], v[152:155], v[140:143], 0
    v_mfma_f32_16x16x32_bf16 v[52:55], v[156:159], v[140:143], 0
    s_waitcnt lgkmcnt(1)
    v_mfma_f32_16x16x32_bf16 v[56:59], v[152:155], v[144:147], 0
    v_mfma_f32_16x16x32_bf16 v[60:63], v[156:159], v[144:147], 0
    s_waitcnt lgkmcnt(0)
    v_mfma_f32_16x16x32_bf16 v[64:67], v[152:155], v[148:151], 0
    v_mfma_f32_16x16x32_bf16 v[68:71], v[156:159], v[148:151], 0
    s_mov_b32 s43, 0
CV_r:
    s_waitcnt lgkmcnt(0)
    v_mfma_f32_16x16x32_bf16 v[40:43], v[72:75], v[136:139], v[40:43]
    v_mfma_f32_16x16x32_bf16 v[48:51], v[72:75], v[140:143], v[48:51]
    v_mfma_f32_16x16x32_bf16 v[56:59], v[72:75], v[144:147], v[56:59]
    v_mfma_f32_16x16x32_bf16 v[64:67], v[72:75], v[148:151], v[64:67]
    v_mfma_f32_16x16x32_bf16 v[44:47], v[76:79], v[136:139], v[44:47]
    v_mfma_f32_16x16x32_bf16 v[52:55], v[76:79], v[140:143], v[52:55]
    v_mfma_f32_16x16x32_bf16 v[60:63], v[76:79], v[144:147], v[60:63]
    v_mfma_f32_16x16x32_bf16 v[68:71], v[76:79], v[148:151], v[68:71]
    v_mfma_f32_16x16x32_bf16 v[48:51], v[80:83], v[136:139], v[48:51]
    v_mfma_f32_16x16x32_bf16 v[56:59], v[80:83], v[140:143], v[56:59]
    v_mfma_f32_16x16x32_bf16 v[64:67], v[80:83], v[144:147], v[64:67]
    v_mfma_f32_16x16x32_bf16 v[52:55], v[84:87], v[136:139], v[52:55]
    v_mfma_f32_16x16x32_bf16 v[60:63], v[84:87], v[140:143], v[60:63]
    v_mfma_f32_16x16x32_bf16 v[68:71], v[84:87], v[144:147], v[68:71]
    v_mfma_f32_16x16x32_bf16 v[56:59], v[88:91], v[136:139], v[56:59]
    v_mfma_f32_16x16x32_bf16 v[64:67], v[88:91], v[140:143], v[64:67]
    v_mfma_f32_16x16x32_bf16 v[60:63], v[92:95], v[136:139], v[60:63]
    v_mfma_f32_16x16x32_bf16 v[68:71], v[92:95], v[140:143], v[68:71]
    v_mfma_f32_16x16x32_bf16 v[64:67], v[96:99], v[136:139], v[64:67]
    v_mfma_f32_16x16x32_bf16 v[68:71], v[100:103], v[136:139], v[68:71]
    ds_read_b128 v[152:155], v33 offset:21344
    ds_read_b128 v[156:159], v33 offset:19808
    ds_read_b128 v[160:163], v33 offset:18272
    ds_read_b128 v[164:167], v33 offset:16736
    ds_read_b64 v[104:105], v32 offset:64
    ds_read_b64 v[106:107], v32 offset:72
    ds_read_b64 v[108:109], v32 offset:96
    ds_read_b64 v[110:111], v32 offset:104
    ds_read_b64 v[112:113], v32 offset:1088
    ds_read_b64 v[114:115], v32 offset:1096
    ds_read_b64 v[116:117], v32 offset:1120
    ds_read_b64 v[118:119], v32 offset:1128
    ds_read_b64 v[120:121], v32 offset:2112
    ds_read_b64 v[122:123], v32 offset:2120
    ds_read_b64 v[124:125], v32 offset:2144
    ds_read_b64 v[126:127], v32 offset:2152
    ds_read_b64 v[128:129], v32 offset:3136
    ds_read_b64 v[130:131], v32 offset:3144
    ds_read_b64 v[132:133], v32 offset:3168
    ds_read_b64 v[134:135], v32 offset:3176
    s_waitcnt lgkmcnt(0)
    v_mfma_f32_16x16x32_bf16 v[40:43], v[104:107], v[152:155], v[40:43]
    v_mfma_f32_16x16x32_bf16 v[48:51], v[104:107], v[156:159], v[48:51]
    v_mfma_f32_16x16x32_bf16 v[56:59], v[104:107], v[160:163], v[56:59]
    v_mfma_f32_16x16x32_bf16 v[64:67], v[104:107], v[164:167], v[64:67]
    v_mfma_f32_16x16x32_bf16 v[44:47], v[108:111], v[152:155], v[44:47]
    v_mfma_f32_16x16x32_bf16 v[52:55], v[108:111], v[156:159], v[52:55]
    v_mfma_f32_16x16x32_bf16 v[60:63], v[108:111], v[160:163], v[60:63]
    v_mfma_f32_16x16x32_bf16 v[68:71], v[108:111], v[164:167], v[68:71]
    v_mfma_f32_16x16x32_bf16 v[48:51], v[112:115], v[152:155], v[48:51]
    v_mfma_f32_16x16x32_bf16 v[56:59], v[112:115], v[156:159], v[56:59]
    v_mfma_f32_16x16x32_bf16 v[64:67], v[112:115], v[160:163], v[64:67]
    v_mfma_f32_16x16x32_bf16 v[52:55], v[116:119], v[152:155], v[52:55]
    v_mfma_f32_16x16x32_bf16 v[60:63], v[116:119], v[156:159], v[60:63]
    v_mfma_f32_16x16x32_bf16 v[68:71], v[116:119], v[160:163], v[68:71]
    v_mfma_f32_16x16x32_bf16 v[56:59], v[120:123], v[152:155], v[56:59]
    v_mfma_f32_16x16x32_bf16 v[64:67], v[120:123], v[156:159], v[64:67]
    v_mfma_f32_16x16x32_bf16 v[60:63], v[124:127], v[152:155], v[60:63]
    v_mfma_f32_16x16x32_bf16 v[68:71], v[124:127], v[156:159], v[68:71]
    v_mfma_f32_16x16x32_bf16 v[64:67], v[128:131], v[152:155], v[64:67]
    v_mfma_f32_16x16x32_bf16 v[68:71], v[132:135], v[152:155], v[68:71]
    ds_read_b128 v[136:139], v33 offset:21440
    ds_read_b128 v[140:143], v33 offset:19904
    ds_read_b128 v[144:147], v33 offset:18368
    ds_read_b128 v[148:151], v33 offset:16832
    ds_read_b64 v[72:73], v32 offset:128
    ds_read_b64 v[74:75], v32 offset:136
    ds_read_b64 v[76:77], v32 offset:160
    ds_read_b64 v[78:79], v32 offset:168
    ds_read_b64 v[80:81], v32 offset:1152
    ds_read_b64 v[82:83], v32 offset:1160
    ds_read_b64 v[84:85], v32 offset:1184
    ds_read_b64 v[86:87], v32 offset:1192
    ds_read_b64 v[88:89], v32 offset:2176
    ds_read_b64 v[90:91], v32 offset:2184
    ds_read_b64 v[92:93], v32 offset:2208
    ds_read_b64 v[94:95], v32 offset:2216
    ds_read_b64 v[96:97], v32 offset:3200
    ds_read_b64 v[98:99], v32 offset:3208
    ds_read_b64 v[100:101], v32 offset:3232
    ds_read_b64 v[102:103], v32 offset:3240
    v_add_u32 v32, 128, v32
    v_add_u32 v33, 192, v33
    s_add_u32 s43, s43, 1
    s_cmp_lt_u32 s43, 4
    s_cbranch_scc1 CV_r
CV_l:
    s_waitcnt lgkmcnt(10)
    v_mfma_f32_16x16x32_bf16 v[40:43], v[72:75], v[136:139], v[40:43]
    ds_read_b128 v[152:155], v33 offset:21344
    v_mfma_f32_16x16x32_bf16 v[48:51], v[72:75], v[140:143], v[48:51]
    ds_read_b128 v[156:159], v33 offset:19808
    s_cmp_eq_u32 s43, 5
    v_mfma_f32_16x16x32_bf16 v[56:59], v[72:75], v[144:147], v[56:59]
    ds_read_b128 v[160:163], v33 offset:18272
    s_cselect_b64 exec, 1, 0
    buffer_load_dword v12, v35, s[56:59], s45 offen sc1
    s_mov_b64 exec, -1
    v_mfma_f32_16x16x32_bf16 v[64:67], v[72:75], v[148:151], v[64:67]
    ds_read_b128 v[164:167], v33 offset:16736
    v_mfma_f32_16x16x32_bf16 v[44:47], v[76:79], v[136:139], v[44:47]
    ds_read_b64 v[104:105], v32 offset:64
    v_mfma_f32_16x16x32_bf16 v[52:55], v[76:79], v[140:143], v[52:55]
    ds_read_b64 v[106:107], v32 offset:72
    v_mfma_f32_16x16x32_bf16 v[60:63], v[76:79], v[144:147], v[60:63]
    ds_read_b64 v[108:109], v32 offset:96
    v_mfma_f32_16x16x32_bf16 v[68:71], v[76:79], v[148:151], v[68:71]
    ds_read_b64 v[110:111], v32 offset:104
    v_mfma_f32_16x16x32_bf16 v[48:51], v[80:83], v[136:139], v[48:51]
    ds_read_b64 v[112:113], v32 offset:1088
    v_mfma_f32_16x16x32_bf16 v[56:59], v[80:83], v[140:143], v[56:59]
    ds_read_b64 v[114:115], v32 offset:1096
    s_waitcnt lgkmcnt(10)
    v_mfma_f32_16x16x32_bf16 v[64:67], v[80:83], v[144:147], v[64:67]
    ds_read_b64 v[116:117], v32 offset:1120
    v_mfma_f32_16x16x32_bf16 v[52:55], v[84:87], v[136:139], v[52:55]
    ds_read_b64 v[118:119], v32 offset:1128
    v_mfma_f32_16x16x32_bf16 v[60:63], v[84:87], v[140:143], v[60:63]
    ds_read_b64 v[120:121], v32 offset:2112
    v_mfma_f32_16x16x32_bf16 v[68:71], v[84:87], v[144:147], v[68:71]
    ds_read_b64 v[122:123], v32 offset:2120
    v_mfma_f32_16x16x32_bf16 v[56:59], v[88:91], v[136:139], v[56:59]
    ds_read_b64 v[124:125], v32 offset:2144
    v_mfma_f32_16x16x32_bf16 v[64:67], v[88:91], v[140:143], v[64:67]
    ds_read_b64 v[126:127], v32 offset:2152
    v_mfma_f32_16x16x32_bf16 v[60:63], v[92:95], v[136:139], v[60:63]
    ds_read_b64 v[128:129], v32 offset:3136
    v_mfma_f32_16x16x32_bf16 v[68:71], v[92:95], v[140:143], v[68:71]
    ds_read_b64 v[130:131], v32 offset:3144
    v_mfma_f32_16x16x32_bf16 v[64:67], v[96:99], v[136:139], v[64:67]
    ds_read_b64 v[132:133], v32 offset:3168
    v_mfma_f32_16x16x32_bf16 v[68:71], v[100:103], v[136:139], v[68:71]
    ds_read_b64 v[134:135], v32 offset:3176
    s_waitcnt lgkmcnt(10)
    v_mfma_f32_16x16x32_bf16 v[40:43], v[104:107], v[152:155], v[40:43]
    ds_read_b128 v[136:139], v33 offset:21440
    v_mfma_f32_16x16x32_bf16 v[48:51], v[104:107], v[156:159], v[48:51]
    ds_read_b128 v[140:143], v33 offset:19904
    v_mfma_f32_16x16x32_bf16 v[56:59], v[104:107], v[160:163], v[56:59]
    ds_read_b128 v[144:147], v33 offset:18368
    v_mfma_f32_16x16x32_bf16 v[64:67], v[104:107], v[164:167], v[64:67]
    ds_read_b128 v[148:151], v33 offset:16832
    v_mfma_f32_16x16x32_bf16 v[44:47], v[108:111], v[152:155], v[44:47]
    ds_read_b64 v[72:73], v32 offset:128
    v_mfma_f32_16x16x32_bf16 v[52:55], v[108:111], v[156:159], v[52:55]
    ds_read_b64 v[74:75], v32 offset:136
    v_add_u32 v33, 192, v33
    v_mfma_f32_16x16x32_bf16 v[60:63], v[108:111], v[160:163], v[60:63]
    ds_read_b64 v[76:77], v32 offset:160
    s_add_u32 s43, s43, 1
    v_mfma_f32_16x16x32_bf16 v[68:71], v[108:111], v[164:167], v[68:71]
    ds_read_b64 v[78:79], v32 offset:168
    s_cmp_lt_u32 s43, 8
    v_mfma_f32_16x16x32_bf16 v[48:51], v[112:115], v[152:155], v[48:51]
    ds_read_b64 v[80:81], v32 offset:1152
    v_mfma_f32_16x16x32_bf16 v[56:59], v[112:115], v[156:159], v[56:59]
    ds_read_b64 v[82:83], v32 offset:1160
    s_waitcnt lgkmcnt(10)
    v_mfma_f32_16x16x32_bf16 v[64:67], v[112:115], v[160:163], v[64:67]
    ds_read_b64 v[84:85], v32 offset:1184
    v_mfma_f32_16x16x32_bf16 v[52:55], v[116:119], v[152:155], v[52:55]
    ds_read_b64 v[86:87], v32 offset:1192
    v_mfma_f32_16x16x32_bf16 v[60:63], v[116:119], v[156:159], v[60:63]
    ds_read_b64 v[88:89], v32 offset:2176
    v_mfma_f32_16x16x32_bf16 v[68:71], v[116:119], v[160:163], v[68:71]
    ds_read_b64 v[90:91], v32 offset:2184
    v_mfma_f32_16x16x32_bf16 v[56:59], v[120:123], v[152:155], v[56:59]
    ds_read_b64 v[92:93], v32 offset:2208
    v_mfma_f32_16x16x32_bf16 v[64:67], v[120:123], v[156:159], v[64:67]
    ds_read_b64 v[94:95], v32 offset:2216
    v_mfma_f32_16x16x32_bf16 v[60:63], v[124:127], v[152:155], v[60:63]
    ds_read_b64 v[96:97], v32 offset:3200
    v_mfma_f32_16x16x32_bf16 v[68:71], v[124:127], v[156:159], v[68:71]
    ds_read_b64 v[98:99], v32 offset:3208
    v_mfma_f32_16x16x32_bf16 v[64:67], v[128:131], v[152:155], v[64:67]
    ds_read_b64 v[100:101], v32 offset:3232
    v_mfma_f32_16x16x32_bf16 v[68:71], v[132:135], v[152:155], v[68:71]
    ds_read_b64 v[102:103], v32 offset:3240
    v_add_u32 v32, 128, v32
    s_cbranch_scc1 CV_l
    v_cvt_pk_bf16_f32 v16, v40, v41
    v_cvt_pk_bf16_f32 v17, v42, v43
    ds_write_b64 v170, v[16:17] offset:0
    v_cvt_pk_bf16_f32 v18, v44, v45
    v_cvt_pk_bf16_f32 v19, v46, v47
    ds_write_b64 v170, v[18:19] offset:32
    v_cvt_pk_bf16_f32 v20, v48, v49
    v_cvt_pk_bf16_f32 v21, v50, v51
    ds_write_b64 v170, v[20:21] offset:1152
    v_cvt_pk_bf16_f32 v22, v52, v53
    v_cvt_pk_bf16_f32 v23, v54, v55
    ds_write_b64 v170, v[22:23] offset:1184
    v_cvt_pk_bf16_f32 v24, v56, v57
    v_cvt_pk_bf16_f32 v25, v58, v59
    ds_write_b64 v170, v[24:25] offset:2304
    v_cvt_pk_bf16_f32 v26, v60, v61
    v_cvt_pk_bf16_f32 v27, v62, v63
    ds_write_b64 v170, v[26:27] offset:2336
    v_cvt_pk_bf16_f32 v28, v64, v65
    v_cvt_pk_bf16_f32 v29, v66, v67
    ds_write_b64 v170, v[28:29] offset:3456
    v_cvt_pk_bf16_f32 v30, v68, v69
    v_cvt_pk_bf16_f32 v31, v70, v71
    ds_write_b64 v170, v[30:31] offset:3488
    s_mov_b64 exec, 1
    ds_add_u32 v34, v7
    s_mov_b64 exec, -1
    s_mov_b32 s53, 0
    s_waitcnt vmcnt(0)
CV_v:
    v_readfirstlane_b32 s94, v12
    s_nop 0
    s_sub_u32 s94, s94, s52
    s_and_b32 s37, s94, 0xfffffe01
    s_cbranch_scc0 CV_k
    buffer_load_dword v12, v35, s[56:59], s45 offen sc1
    s_waitcnt vmcnt(0)
    s_add_u32 s53, s53, 1
    s_cmp_lt_u32 s53, s61
    s_cbranch_scc1 CV_v
    s_mov_b32 s61, 0
    s_mov_b32 s94, 0
CV_k:
    s_lshr_b32 s94, s94, 1
    s_add_u32 s37, s94, 65536
    v_mov_b32 v8, 162844
    v_mov_b32 v9, s37
    ds_write_b32 v8, v9
    s_cmp_gt_u32 s94, 10
    s_cselect_b32 s37, 0x2000, 0
    s_xor_b32 s44, s44, s37
    s_xor_b32 s45, s47, s37
    s_add_u32 s45, s45, 23101440
    v_mov_b32 v8, 162824
spin_5:
    ds_read_b32 v9, v8
    s_waitcnt lgkmcnt(0)
    v_readfirstlane_b32 s53, v9
    s_nop 0
    s_cmp_ge_u32 s53, 6
    s_cbranch_scc0 spin_5
    ds_read_b64_tr_b16 v[104:105], v168 offset:0
    ds_read_b64_tr_b16 v[106:107], v168 offset:32
    ds_read_b64_tr_b16 v[108:109], v168 offset:288
    ds_read_b64_tr_b16 v[110:111], v168 offset:320
    ds_read_b64_tr_b16 v[112:113], v168 offset:576
    ds_read_b64_tr_b16 v[114:115], v168 offset:608
    ds_read_b64_tr_b16 v[116:117], v168 offset:864
    ds_read_b64_tr_b16 v[118:119], v168 offset:896
    s_waitcnt lgkmcnt(6)
    v_or_b32 v104, 1, v104
    buffer_store_dwordx4 v[104:107], v169, s[12:15], s44 offen sc1
    s_add_u32 s44, s44, 16777216
    s_waitcnt lgkmcnt(4)
    v_or_b32 v108, 1, v108
    buffer_store_dwordx4 v[108:111], v169, s[12:15], s44 offen sc1
    s_add_u32 s44, s44, 16777216
    s_waitcnt lgkmcnt(2)
    v_or_b32 v112, 1, v112
    buffer_store_dwordx4 v[112:115], v169, s[12:15], s44 offen sc1
    s_add_u32 s44, s44, 16777216
    s_waitcnt lgkmcnt(0)
    v_or_b32 v116, 1, v116
    buffer_store_dwordx4 v[116:119], v169, s[12:15], s44 offen sc1
    s_add_u32 s44, s44, 16777216
    v_mov_b32 v8, 162836
    v_mov_b32 v9, 1
    s_mov_b64 exec, 1
    ds_add_u32 v8, v9
    s_mov_b64 exec, -1
    s_mov_b64 exec, 0xf
    s_waitcnt vmcnt(0)
    buffer_atomic_add v7, v6, s[56:59], s45 offen sc1
    s_mov_b64 exec, -1
    s_branch FR_end
FR_b:
    s_cmp_ge_u32 s2, 32
    s_cbranch_scc1 FB_np
    s_cmp_lg_u32 s30, 5
    s_cbranch_scc1 FB_np
    s_and_b32 s42, s2, 7
    s_lshl_b32 s42, s42, 10
    s_lshr_b32 s43, s2, 3
    s_lshl_b32 s43, s43, 14
    s_add_u32 s42, s42, s43
    s_add_u32 s42, s42, 39714816
    v_mov_b32 v14, 0
    s_mov_b64 exec, 1
    s_mov_b32 s46, -1
    s_mov_b32 s47, -1
    s_add_u32 s48, s4, s42
    s_addc_u32 s49, s5, 0
    s_load_dword s101, s[48:49], 384
    s_waitcnt lgkmcnt(0)
    s_memtime s[34:35]
    s_waitcnt lgkmcnt(0)
    s_load_dword s101, s[48:49], 0
    s_waitcnt lgkmcnt(0)
    s_memtime s[36:37]
    s_waitcnt lgkmcnt(0)
    s_sub_u32 s43, s36, s34
    s_min_u32 s46, s46, s43
    s_load_dword s101, s[48:49], 8192
    s_waitcnt lgkmcnt(0)
    s_memtime s[34:35]
    s_waitcnt lgkmcnt(0)
    s_sub_u32 s43, s34, s36
    s_min_u32 s47, s47, s43
    s_load_dword s101, s[48:49], 128
    s_waitcnt lgkmcnt(0)
    s_memtime s[36:37]
    s_waitcnt lgkmcnt(0)
    s_sub_u32 s43, s36, s34
    s_min_u32 s46, s46, s43
    s_load_dword s101, s[48:49], 8320
    s_waitcnt lgkmcnt(0)
    s_memtime s[34:35]
    s_waitcnt lgkmcnt(0)
    s_sub_u32 s43, s34, s36
    s_min_u32 s47, s47, s43
    s_cmp_lt_u32 s47, s46
    s_cselect_b32 s45, 1, 0
    s_lshr_b32 s46, s28, 2
    s_xor_b32 s45, s45, s46
    s_and_b32 s45, s45, 1
    s_lshl_b32 s45, s45, 8
    s_or_b32 s43, s45, 1
    v_mov_b32 v12, s43
    buffer_atomic_add v12, v14, s[84:87], 0 offen offset:4 sc0 sc1
    s_waitcnt vmcnt(0)
    v_readfirstlane_b32 s36, v12
    s_nop 0
    s_add_u32 s36, s36, s43
    s_and_b32 s37, s36, 255
    s_cmp_lg_u32 s37, 21
    s_cbranch_scc1 FB_np
    s_lshr_b32 s36, s36, 8
    s_lshl_b32 s36, s36, 1
    s_add_u32 s36, s36, s52
    s_bfm_b64 exec, 32, 0
    v_mov_b32 v12, s36
    v_lshlrev_b32 v13, 7, v1
    s_mov_b32 s36, 23117824
    buffer_store_dword v12, v13, s[56:59], s36 offen sc1
FB_np:
    s_mov_b64 exec, -1
    s_getpc_b64 s[34:35]
K_tpc:
    s_lshl_b32 s36, s29, 2
    s_and_b32 s37, s28, 3
    s_add_u32 s36, s36, s37
    s_lshl_b32 s36, s36, 6
    s_add_u32 s36, s36, K_tab-K_tpc
    s_add_u32 s34, s34, s36
    s_addc_u32 s35, s35, 0
    v_and_b32 v248, 31, v1
    v_lshlrev_b32 v248, 1, v248
    global_load_ushort v251, v248, s[34:35]
    v_lshrrev_b32 v253, 3, v1
    v_lshlrev_b32 v238, 11, v253
    v_and_b32 v253, 6, v253
    v_and_b32 v254, 7, v1
    v_xor_b32 v253, v253, v254
    v_lshl_add_u32 v238, v253, 4, v238
    v_lshrrev_b32 v253, 4, v1
    v_lshlrev_b32 v239, 11, v253
    v_add_u32 v253, 0, v253
    v_lshlrev_b32 v253, 1, v253
    v_and_b32 v254, 15, v1
    v_xor_b32 v253, v253, v254
    v_lshl_add_u32 v239, v253, 4, v239
    v_lshrrev_b32 v253, 4, v1
    v_lshlrev_b32 v240, 11, v253
    v_add_u32 v253, 4, v253
    v_lshlrev_b32 v253, 1, v253
    v_and_b32 v254, 15, v1
    v_xor_b32 v253, v253, v254
    v_lshl_add_u32 v240, v253, 4, v240
    v_add_u32 v254, 0, v1
    v_mul_u32_u24 v253, 2341, v254
    v_lshrrev_b32 v253, 16, v253
    v_mul_u32_u24 v241, 28, v253
    v_sub_u32 v254, v254, v241
    v_mul_u32_u24 v241, 7168, v253
    v_lshrrev_b32 v253, 1, v253
    v_and_b32 v253, 2, v253
    v_xor_b32 v254, v254, v253
    v_lshl_add_u32 v241, v254, 4, v241
    v_add_u32 v254, 64, v1
    v_mul_u32_u24 v253, 2341, v254
    v_lshrrev_b32 v253, 16, v253
    v_mul_u32_u24 v242, 28, v253
    v_sub_u32 v254, v254, v242
    v_mul_u32_u24 v242, 7168, v253
    v_lshrrev_b32 v253, 1, v253
    v_and_b32 v253, 2, v253
    v_xor_b32 v254, v254, v253
    v_lshl_add_u32 v242, v254, 4, v242
    v_add_u32 v254, 128, v1
    v_mul_u32_u24 v253, 2341, v254
    v_lshrrev_b32 v253, 16, v253
    v_mul_u32_u24 v243, 28, v253
    v_sub_u32 v254, v254, v243
    v_mul_u32_u24 v243, 7168, v253
    v_lshrrev_b32 v253, 1, v253
    v_and_b32 v253, 2, v253
    v_xor_b32 v254, v254, v253
    v_lshl_add_u32 v243, v254, 4, v243
    v_add_u32 v254, 192, v1
    v_mul_u32_u24 v253, 2341, v254
    v_lshrrev_b32 v253, 16, v253
    v_mul_u32_u24 v244, 28, v253
    v_sub_u32 v254, v254, v244
    v_mul_u32_u24 v244, 7168, v253
    v_lshrrev_b32 v253, 1, v253
    v_and_b32 v253, 2, v253
    v_xor_b32 v254, v254, v253
    v_lshl_add_u32 v244, v254, 4, v244
    v_add_u32 v254, 256, v1
    v_mul_u32_u24 v253, 2341, v254
    v_lshrrev_b32 v253, 16, v253
    v_mul_u32_u24 v245, 28, v253
    v_sub_u32 v254, v254, v245
    v_mul_u32_u24 v245, 7168, v253
    v_lshrrev_b32 v253, 1, v253
    v_and_b32 v253, 2, v253
    v_xor_b32 v254, v254, v253
    v_lshl_add_u32 v245, v254, 4, v245
    v_add_u32 v254, 320, v1
    v_mul_u32_u24 v253, 2341, v254
    v_lshrrev_b32 v253, 16, v253
    v_mul_u32_u24 v246, 28, v253
    v_sub_u32 v254, v254, v246
    v_mul_u32_u24 v246, 7168, v253
    v_lshrrev_b32 v253, 1, v253
    v_and_b32 v253, 2, v253
    v_xor_b32 v254, v254, v253
    v_lshl_add_u32 v246, v254, 4, v246
    v_add_u32 v254, 384, v1
    v_mul_u32_u24 v253, 2341, v254
    v_lshrrev_b32 v253, 16, v253
    v_mul_u32_u24 v247, 28, v253
    v_sub_u32 v254, v254, v247
    v_mul_u32_u24 v247, 7168, v253
    v_lshrrev_b32 v253, 1, v253
    v_and_b32 v253, 2, v253
    v_xor_b32 v254, v254, v253
    v_lshl_add_u32 v247, v254, 4, v247
    s_cmp_ge_u32 s30, 6
    s_cbranch_scc1 FB_cs
    s_cmp_lg_u32 s30, 4
    s_cbranch_scc1 FB_ni
    v_mov_b32 v12, s52
    s_lshr_b32 s53, s28, 3
    s_lshl_b32 s53, s53, 2
    s_and_b32 s54, s28, 3
    s_add_u32 s53, s53, s54
    s_lshl_b32 s53, s53, 24
    s_lshr_b32 s54, s28, 2
    s_xor_b32 s54, s54, s94
    s_and_b32 s54, s54, 1
    s_lshl_b32 s54, s54, 13
    s_add_u32 s37, s53, s54
    s_add_u32 s37, s37, 33554432
    s_andn2_b32 s37, s37, 0x2000
    s_lshl_b32 s53, s29, 7
    s_add_u32 s37, s37, s53
    s_add_u32 s37, s37, 6029312
    v_and_b32 v13, 1, v1
    v_lshlrev_b32 v13, 13, v13
    v_lshrrev_b32 v14, 1, v1
    v_lshl_add_u32 v13, v14, 22, v13
    s_mov_b64 exec, 0xf
    buffer_store_dword v12, v13, s[56:59], s37 offen sc1
    s_cmp_lg_u32 s28, 0
    s_cbranch_scc1 FB_n2
    s_add_u32 s37, s53, 23121920
    s_mov_b64 exec, 1
    buffer_store_dword v12, v13, s[56:59], s37 offen sc1
FB_n2:
    s_mov_b64 exec, -1
FB_ni:
    s_waitcnt vmcnt(0)
    v_bfe_u32 v252, v251, 2, 2
    v_lshlrev_b32 v248, 14, v252
    v_and_b32 v252, 3, v251
    v_lshl_add_u32 v248, v252, 11, v248
    v_bfe_u32 v252, v251, 7, 3
    v_lshlrev_b32 v249, 14, v252
    v_bfe_u32 v252, v251, 4, 3
    v_lshl_add_u32 v249, v252, 10, v249
    v_bfe_u32 v252, v251, 13, 3
    v_lshlrev_b32 v250, 14, v252
    v_bfe_u32 v252, v251, 10, 3
    v_lshl_add_u32 v250, v252, 10, v250
    v_mov_b32 v6, 162836
spin_7:
    s_sleep 2
    ds_read_b32 v7, v6
    s_waitcnt lgkmcnt(0)
    v_readfirstlane_b32 s53, v7
    s_nop 0
    s_cmp_ge_u32 s53, 4
    s_cbranch_scc0 spin_7
    s_load_dwordx2 s[48:49], s[0:1], 64
    s_lshl_b32 s45, s2, 1
    s_and_b32 s50, s30, 1
    s_add_u32 s45, s45, s50
    s_mul_i32 s45, s45, 4096
    s_mov_b32 s50, 2097152
    s_mov_b32 s51, 0x20000
    s_waitcnt lgkmcnt(0)
    buffer_load_dwordx4 v[20:23], v2, s[48:51], s45 offen offset:0
    buffer_load_dwordx4 v[20:23], v2, s[48:51], s45 offen offset:1024
    buffer_load_dwordx4 v[20:23], v2, s[48:51], s45 offen offset:2048
    buffer_load_dwordx4 v[20:23], v2, s[48:51], s45 offen offset:3072
    v_mov_b32 v6, 1
    v_mov_b32 v7, 162824
    s_mov_b64 exec, 1
    s_waitcnt vmcnt(0)
    ds_add_u32 v7, v6
    s_mov_b64 exec, -1
    v_mov_b32 v6, 162840
spin_9:
    s_sleep 4
    ds_read_b32 v7, v6
    s_waitcnt lgkmcnt(0)
    v_readfirstlane_b32 s53, v7
    s_nop 0
    s_cmp_ge_u32 s53, 2
    s_cbranch_scc0 spin_9
    s_call_b64 s[76:77], SUB_w1_regs
    s_call_b64 s[76:77], SUB_park
    v_mov_b32 v6, 162840
spin_10:
    s_sleep 3
    ds_read_b32 v7, v6
    s_waitcnt lgkmcnt(0)
    v_readfirstlane_b32 s53, v7
    s_nop 0
    s_cmp_ge_u32 s53, 4
    s_cbranch_scc0 spin_10
    s_mov_b64 s[12:13], s[68:69]
    s_mov_b32 s14, 2097152
    s_mov_b32 s15, 0x20000
    s_and_b32 s35, s30, 1
    s_mul_i32 s38, s99, 128
    s_mul_i32 s41, s35, 65536
    s_add_u32 s38, s38, s41
    s_mul_i32 s41, s35, 4096
    s_add_u32 s41, s41, 24576
    s_mov_b32 s42, 0
    s_mov_b32 s44, s67
    s_mov_b32 s42, 73728
    s_mov_b32 s44, s67
    s_add_u32 s44, s44, 9
    s_and_b32 s44, s44, 15
    s_call_b64 s[76:77], SUB_w_issue_1
    s_waitcnt vmcnt(8)
    s_mov_b32 s42, 81920
    s_mov_b32 s44, s67
    s_add_u32 s44, s44, 10
    s_and_b32 s44, s44, 15
    s_call_b64 s[76:77], SUB_w_issue_1
    s_waitcnt vmcnt(8)
    s_mov_b32 s42, 90112
    s_mov_b32 s44, s67
    s_add_u32 s44, s44, 11
    s_and_b32 s44, s44, 15
    s_call_b64 s[76:77], SUB_w_issue_1
    s_waitcnt vmcnt(8)
    s_and_b32 s36, s29, 6
    s_cmp_eq_u32 s36, 2
    s_cbranch_scc1 pr_11
    s_call_b64 s[76:77], SUB_park2
pr_11:
    s_call_b64 s[76:77], SUB_w1_put
    s_branch FR_end
FB_cs:
    v_and_b32 v164, 15, v1
    v_mov_b32 v165, 0x3f803f80
    v_cmp_eq_u32 vcc, 0, v164
    s_nop 1
    v_cndmask_b32 v16, 0, v165, vcc
    v_cndmask_b32 v17, 0, v165, vcc
    v_cndmask_b32 v18, 0, v165, vcc
    v_cndmask_b32 v19, 0, v165, vcc
    v_cmp_eq_u32 vcc, 1, v164
    s_nop 1
    v_cndmask_b32 v20, 0, v165, vcc
    v_cndmask_b32 v21, 0, v165, vcc
    v_cndmask_b32 v22, 0, v165, vcc
    v_cndmask_b32 v23, 0, v165, vcc
    v_cmp_eq_u32 vcc, 2, v164
    s_nop 1
    v_cndmask_b32 v24, 0, v165, vcc
    v_cndmask_b32 v25, 0, v165, vcc
    v_cndmask_b32 v26, 0, v165, vcc
    v_cndmask_b32 v27, 0, v165, vcc
    v_cmp_eq_u32 vcc, 3, v164
    s_nop 1
    v_cndmask_b32 v28, 0, v165, vcc
    v_cndmask_b32 v29, 0, v165, vcc
    v_cndmask_b32 v30, 0, v165, vcc
    v_cndmask_b32 v31, 0, v165, vcc
    v_cmp_eq_u32 vcc, 4, v164
    s_nop 1
    v_cndmask_b32 v32, 0, v165, vcc
    v_cndmask_b32 v33, 0, v165, vcc
    v_cndmask_b32 v34, 0, v165, vcc
    v_cndmask_b32 v35, 0, v165, vcc
    v_cmp_eq_u32 vcc, 5, v164
    s_nop 1
    v_cndmask_b32 v36, 0, v165, vcc
    v_cndmask_b32 v37, 0, v165, vcc
    v_cndmask_b32 v38, 0, v165, vcc
    v_cndmask_b32 v39, 0, v165, vcc
    v_cmp_eq_u32 vcc, 6, v164
    s_nop 1
    v_cndmask_b32 v40, 0, v165, vcc
    v_cndmask_b32 v41, 0, v165, vcc
    v_cndmask_b32 v42, 0, v165, vcc
    v_cndmask_b32 v43, 0, v165, vcc
    v_cmp_eq_u32 vcc, 7, v164
    s_nop 1
    v_cndmask_b32 v44, 0, v165, vcc
    v_cndmask_b32 v45, 0, v165, vcc
    v_cndmask_b32 v46, 0, v165, vcc
    v_cndmask_b32 v47, 0, v165, vcc
    v_cmp_eq_u32 vcc, 8, v164
    s_nop 1
    v_cndmask_b32 v48, 0, v165, vcc
    v_cndmask_b32 v49, 0, v165, vcc
    v_cndmask_b32 v50, 0, v165, vcc
    v_cndmask_b32 v51, 0, v165, vcc
    v_cmp_eq_u32 vcc, 9, v164
    s_nop 1
    v_cndmask_b32 v52, 0, v165, vcc
    v_cndmask_b32 v53, 0, v165, vcc
    v_cndmask_b32 v54, 0, v165, vcc
    v_cndmask_b32 v55, 0, v165, vcc
    v_cmp_eq_u32 vcc, 10, v164
    s_nop 1
    v_cndmask_b32 v56, 0, v165, vcc
    v_cndmask_b32 v57, 0, v165, vcc
    v_cndmask_b32 v58, 0, v165, vcc
    v_cndmask_b32 v59, 0, v165, vcc
    v_cmp_eq_u32 vcc, 11, v164
    s_nop 1
    v_cndmask_b32 v60, 0, v165, vcc
    v_cndmask_b32 v61, 0, v165, vcc
    v_cndmask_b32 v62, 0, v165, vcc
    v_cndmask_b32 v63, 0, v165, vcc
    v_cmp_eq_u32 vcc, 12, v164
    s_nop 1
    v_cndmask_b32 v64, 0, v165, vcc
    v_cndmask_b32 v65, 0, v165, vcc
    v_cndmask_b32 v66, 0, v165, vcc
    v_cndmask_b32 v67, 0, v165, vcc
    v_cmp_eq_u32 vcc, 13, v164
    s_nop 1
    v_cndmask_b32 v68, 0, v165, vcc
    v_cndmask_b32 v69, 0, v165, vcc
    v_cndmask_b32 v70, 0, v165, vcc
    v_cndmask_b32 v71, 0, v165, vcc
    s_mov_b32 s35, 0
    v_lshrrev_b32 v253, 2, v1
    v_mul_u32_u24 v144, 128, v253
    v_and_b32 v254, 3, v1
    v_lshl_add_u32 v144, v254, 3, v144
    v_add_u32 v144, 24576, v144
    v_bfe_u32 v253, v253, 1, 2
    s_mul_i32 s36, s35, 4
    s_add_u32 s36, s36, 3
    v_xor_b32 v254, s36, v253
    v_lshl_add_u32 v147, v254, 5, v144
    s_mul_i32 s36, s35, 4
    s_add_u32 s36, s36, 2
    v_xor_b32 v254, s36, v253
    v_lshl_add_u32 v146, v254, 5, v144
    s_mul_i32 s36, s35, 4
    s_add_u32 s36, s36, 1
    v_xor_b32 v254, s36, v253
    v_lshl_add_u32 v145, v254, 5, v144
    s_mul_i32 s36, s35, 4
    s_add_u32 s36, s36, 0
    v_xor_b32 v254, s36, v253
    v_lshl_add_u32 v144, v254, 5, v144
    s_and_b32 s35, s30, 1
    s_mul_i32 s35, s35, 4096
    s_add_u32 s35, s35, 73728
    v_add_u32 v144, s35, v144
    v_add_u32 v145, s35, v145
    v_add_u32 v146, s35, v146
    v_add_u32 v147, s35, v147
    s_mov_b32 s35, 0
    v_lshrrev_b32 v253, 2, v1
    v_mul_u32_u24 v148, 448, v253
    v_and_b32 v254, 3, v1
    v_lshl_add_u32 v148, v254, 3, v148
    v_add_u32 v148, 73728, v148
    s_mul_i32 s36, s35, 224
    v_add_u32 v148, s36, v148
    v_bfe_u32 v253, v1, 4, 1
    v_lshlrev_b32 v253, 5, v253
    s_cmp_eq_u32 s35, 0
    s_cselect_b32 s36, 1, -1
    v_mul_lo_u32 v253, v253, s36
    v_sub_u32 v149, v148, v253
    v_add_u32 v148, v148, v253
    s_and_b32 s35, s30, 1
    s_mul_i32 s35, s35, 14336
    s_add_u32 s35, s35, 32768
    v_add_u32 v148, s35, v148
    v_add_u32 v149, s35, v149
    s_mov_b32 s35, 1
    v_lshrrev_b32 v253, 2, v1
    v_mul_u32_u24 v150, 448, v253
    v_and_b32 v254, 3, v1
    v_lshl_add_u32 v150, v254, 3, v150
    v_add_u32 v150, 73728, v150
    s_mul_i32 s36, s35, 224
    v_add_u32 v150, s36, v150
    v_bfe_u32 v253, v1, 4, 1
    v_lshlrev_b32 v253, 5, v253
    s_cmp_eq_u32 s35, 0
    s_cselect_b32 s36, 1, -1
    v_mul_lo_u32 v253, v253, s36
    v_sub_u32 v151, v150, v253
    v_add_u32 v150, v150, v253
    s_and_b32 s35, s30, 1
    s_mul_i32 s35, s35, 14336
    s_add_u32 s35, s35, 32768
    v_add_u32 v150, s35, v150
    v_add_u32 v151, s35, v151
    v_mov_b32 v156, 0
    v_mov_b32 v157, 0
    v_mov_b32 v158, 0
    v_mov_b32 v159, 0
    v_mov_b32 v160, 0
    v_mov_b32 v161, 0
    v_mov_b32 v162, 0
    v_mov_b32 v163, 0
    v_lshrrev_b32 v166, 4, v1
    v_lshlrev_b32 v166, 4, v166
    v_lshl_add_u32 v166, v164, 6, v166
    v_mov_b32 v165, 0x7f000000
    v_cmp_gt_u32 vcc, 4, v164
    s_nop 1
    v_cndmask_b32 v167, v165, v166, vcc
    v_cmp_gt_u32 vcc, 14, v164
    s_nop 1
    v_cndmask_b32 v168, v165, v166, vcc
    s_waitcnt vmcnt(0)
    v_and_b32 v252, 15, v251
    v_mul_u32_u24 v248, 458752, v252
    s_and_b32 s36, s30, 1
    s_mul_i32 s36, s36, 6
    s_add_u32 s36, s36, 4
    v_bfe_u32 v252, v251, s36, 6
    v_mul_u32_u24 v250, 37, v252
    v_lshrrev_b32 v250, 8, v250
    v_mul_u32_u24 v250, 7, v250
    v_sub_u32 v250, v252, v250
    v_cmp_eq_u32 vcc, 3, v250
    s_nop 1
    v_cndmask_b32 v250, 0, 1, vcc
    v_lshl_add_u32 v249, v252, 16, v250
    v_mov_b32 v6, 162836
spin_12:
    s_sleep 2
    ds_read_b32 v7, v6
    s_waitcnt lgkmcnt(0)
    v_readfirstlane_b32 s53, v7
    s_nop 0
    s_cmp_ge_u32 s53, 4
    s_cbranch_scc0 spin_12
    s_mov_b64 s[12:13], s[68:69]
    s_mov_b32 s14, 2097152
    s_mov_b32 s15, 0x20000
    s_and_b32 s35, s30, 1
    s_mul_i32 s38, s99, 128
    s_mul_i32 s41, s35, 65536
    s_add_u32 s38, s38, s41
    s_mul_i32 s41, s35, 4096
    s_add_u32 s41, s41, 24576
    s_mov_b32 s42, 0
    s_mov_b32 s44, s67
    s_mov_b32 s42, 73728
    s_mov_b32 s44, s28
    s_add_u32 s19, s41, s42
    s_mul_i32 s16, s44, 131072
    s_add_u32 s16, s16, s38
    s_add_u32 s44, s44, 1
    s_and_b32 s44, s44, 15
    s_add_u32 s42, s42, 8192
    s_cmp_eq_u32 s42, 131072
    s_cselect_b32 s42, 0, s42
    s_mov_b32 m0, s19
    s_mov_b32 s39, s16
    buffer_load_dwordx4 v238, s[12:15], s39 offen lds
    s_add_u32 m0, m0, 1024
    s_add_u32 s39, s39, 16384
    buffer_load_dwordx4 v238, s[12:15], s39 offen lds
    s_add_u32 m0, m0, 1024
    s_add_u32 s39, s39, 16384
    buffer_load_dwordx4 v238, s[12:15], s39 offen lds
    s_add_u32 m0, m0, 1024
    s_add_u32 s39, s39, 16384
    buffer_load_dwordx4 v238, s[12:15], s39 offen lds
    s_mov_b64 s[12:13], s[72:73]
    s_mov_b32 s14, 7340032
    s_mov_b32 s15, 0x20000
    s_and_b32 s35, s30, 1
    s_mul_i32 s38, s29, 448
    s_mul_i32 s41, s35, 229376
    s_add_u32 s38, s38, s41
    s_mul_i32 s41, s35, 14336
    s_add_u32 s41, s41, 73728
    s_mov_b32 s42, 0
    s_mov_b32 s44, 0
    s_mov_b32 s42, 32768
    s_mov_b32 s44, s28
    s_add_u32 s19, s41, s42
    s_mul_i32 s16, s44, 458752
    s_add_u32 s16, s16, s38
    s_add_u32 s44, s44, 1
    s_and_b32 s44, s44, 15
    s_add_u32 s42, s42, 28672
    s_cmp_eq_u32 s42, 86016
    s_cselect_b32 s42, 0, s42
    s_mov_b32 m0, s19
    s_mov_b32 s39, s16
    buffer_load_dwordx4 v241, s[12:15], s39 offen lds
    s_add_u32 m0, m0, 1024
    s_nop 0
    buffer_load_dwordx4 v242, s[12:15], s39 offen lds
    s_add_u32 m0, m0, 1024
    s_nop 0
    buffer_load_dwordx4 v243, s[12:15], s39 offen lds
    s_add_u32 m0, m0, 1024
    s_nop 0
    buffer_load_dwordx4 v244, s[12:15], s39 offen lds
    s_add_u32 m0, m0, 1024
    s_nop 0
    buffer_load_dwordx4 v245, s[12:15], s39 offen lds
    s_add_u32 m0, m0, 1024
    s_nop 0
    buffer_load_dwordx4 v246, s[12:15], s39 offen lds
    s_add_u32 m0, m0, 1024
    s_nop 0
    buffer_load_dwordx4 v247, s[12:15], s39 offen lds
    s_add_u32 m0, m0, 1024
    s_add_u32 s39, s39, 114688
    buffer_load_dwordx4 v241, s[12:15], s39 offen lds
    s_add_u32 m0, m0, 1024
    s_nop 0
    buffer_load_dwordx4 v242, s[12:15], s39 offen lds
    s_add_u32 m0, m0, 1024
    s_nop 0
    buffer_load_dwordx4 v243, s[12:15], s39 offen lds
    s_add_u32 m0, m0, 1024
    s_nop 0
    buffer_load_dwordx4 v244, s[12:15], s39 offen lds
    s_add_u32 m0, m0, 1024
    s_nop 0
    buffer_load_dwordx4 v245, s[12:15], s39 offen lds
    s_add_u32 m0, m0, 1024
    s_nop 0
    buffer_load_dwordx4 v246, s[12:15], s39 offen lds
    s_add_u32 m0, m0, 1024
    s_nop 0
    buffer_load_dwordx4 v247, s[12:15], s39 offen lds
    s_waitcnt vmcnt(14)
    s_setprio 1
    ds_read_b64_tr_b16 v[128:129], v144 offset:0
    ds_read_b64_tr_b16 v[130:131], v144 offset:2048
    ds_read_b64_tr_b16 v[132:133], v145 offset:0
    ds_read_b64_tr_b16 v[134:135], v145 offset:2048
    ds_read_b64_tr_b16 v[136:137], v146 offset:0
    ds_read_b64_tr_b16 v[138:139], v146 offset:2048
    ds_read_b64_tr_b16 v[140:141], v147 offset:0
    ds_read_b64_tr_b16 v[142:143], v147 offset:2048
    s_add_u32 s20, s4, 0x1400000
    s_addc_u32 s21, s5, 0
    s_mov_b32 s22, 0x20000
    s_mov_b32 s23, 0x20000
    s_lshl_b32 s35, s28, 1
    s_and_b32 s36, s30, 1
    s_add_u32 s35, s35, s36
    s_mul_i32 s35, s35, 4096
    s_mul_i32 s36, s29, 256
    s_add_u32 s35, s35, s36
    s_waitcnt lgkmcnt(0)
    v_mfma_f32_16x16x32_bf16 v[160:163], v[128:131], v[16:19], v[160:163]
    v_mfma_f32_16x16x32_bf16 v[160:163], v[132:135], v[20:23], v[160:163]
    v_mfma_f32_16x16x32_bf16 v[160:163], v[136:139], v[24:27], v[160:163]
    v_mfma_f32_16x16x32_bf16 v[160:163], v[140:143], v[28:31], v[160:163]
    s_nop 7
    buffer_store_dwordx4 v[160:163], v167, s[20:23], s35 offen sc1
    s_waitcnt vmcnt(1)
    v_mov_b32 v6, 162840
    v_mov_b32 v7, 1
    s_mov_b64 exec, 1
    ds_add_u32 v6, v7
    s_mov_b64 exec, -1
    ds_read_b64_tr_b16 v[72:73], v148 offset:0
    ds_read_b64_tr_b16 v[74:75], v148 offset:7168
    ds_read_b64_tr_b16 v[76:77], v149 offset:32
    ds_read_b64_tr_b16 v[78:79], v149 offset:7200
    ds_read_b64_tr_b16 v[80:81], v148 offset:64
    ds_read_b64_tr_b16 v[82:83], v148 offset:7232
    ds_read_b64_tr_b16 v[84:85], v149 offset:96
    ds_read_b64_tr_b16 v[86:87], v149 offset:7264
    ds_read_b64_tr_b16 v[88:89], v148 offset:128
    ds_read_b64_tr_b16 v[90:91], v148 offset:7296
    ds_read_b64_tr_b16 v[92:93], v149 offset:160
    ds_read_b64_tr_b16 v[94:95], v149 offset:7328
    ds_read_b64_tr_b16 v[96:97], v148 offset:192
    ds_read_b64_tr_b16 v[98:99], v148 offset:7360
    ds_read_b64_tr_b16 v[100:101], v150 offset:0
    ds_read_b64_tr_b16 v[102:103], v150 offset:7168
    ds_read_b64_tr_b16 v[104:105], v151 offset:32
    ds_read_b64_tr_b16 v[106:107], v151 offset:7200
    ds_read_b64_tr_b16 v[108:109], v150 offset:64
    ds_read_b64_tr_b16 v[110:111], v150 offset:7232
    ds_read_b64_tr_b16 v[112:113], v151 offset:96
    ds_read_b64_tr_b16 v[114:115], v151 offset:7264
    ds_read_b64_tr_b16 v[116:117], v150 offset:128
    ds_read_b64_tr_b16 v[118:119], v150 offset:7296
    ds_read_b64_tr_b16 v[120:121], v151 offset:160
    ds_read_b64_tr_b16 v[122:123], v151 offset:7328
    ds_read_b64_tr_b16 v[124:125], v150 offset:192
    ds_read_b64_tr_b16 v[126:127], v150 offset:7360
    s_add_u32 s20, s4, 0x1420000
    s_addc_u32 s21, s5, 0
    s_mov_b32 s22, 0x70000
    s_mov_b32 s23, 0x20000
    s_lshl_b32 s35, s28, 1
    s_and_b32 s36, s30, 1
    s_add_u32 s35, s35, s36
    s_mul_i32 s35, s35, 14336
    s_mul_i32 s36, s29, 896
    s_add_u32 s35, s35, s36
    s_waitcnt lgkmcnt(0)
    v_mfma_f32_16x16x32_bf16 v[156:159], v[72:75], v[16:19], v[156:159]
    v_mfma_f32_16x16x32_bf16 v[156:159], v[76:79], v[20:23], v[156:159]
    v_mfma_f32_16x16x32_bf16 v[156:159], v[80:83], v[24:27], v[156:159]
    v_mfma_f32_16x16x32_bf16 v[156:159], v[84:87], v[28:31], v[156:159]
    v_mfma_f32_16x16x32_bf16 v[156:159], v[88:91], v[32:35], v[156:159]
    v_mfma_f32_16x16x32_bf16 v[156:159], v[92:95], v[36:39], v[156:159]
    v_mfma_f32_16x16x32_bf16 v[156:159], v[96:99], v[40:43], v[156:159]
    v_mfma_f32_16x16x32_bf16 v[156:159], v[100:103], v[44:47], v[156:159]
    v_mfma_f32_16x16x32_bf16 v[156:159], v[104:107], v[48:51], v[156:159]
    v_mfma_f32_16x16x32_bf16 v[156:159], v[108:111], v[52:55], v[156:159]
    v_mfma_f32_16x16x32_bf16 v[156:159], v[112:115], v[56:59], v[156:159]
    v_mfma_f32_16x16x32_bf16 v[156:159], v[116:119], v[60:63], v[156:159]
    v_mfma_f32_16x16x32_bf16 v[156:159], v[120:123], v[64:67], v[156:159]
    v_mfma_f32_16x16x32_bf16 v[156:159], v[124:127], v[68:71], v[156:159]
    s_nop 7
    buffer_store_dwordx4 v[156:159], v168, s[20:23], s35 offen sc1
    v_mov_b32 v6, 162840
    v_mov_b32 v7, 1
    s_mov_b64 exec, 1
    ds_add_u32 v6, v7
    s_mov_b64 exec, -1
    s_setprio 0
    s_call_b64 s[76:77], SUB_w1_regs
    s_call_b64 s[76:77], SUB_park
    v_mov_b32 v6, 162840
spin_14:
    s_sleep 3
    ds_read_b32 v7, v6
    s_waitcnt lgkmcnt(0)
    v_readfirstlane_b32 s53, v7
    s_nop 0
    s_cmp_ge_u32 s53, 4
    s_cbranch_scc0 spin_14
    s_mov_b64 s[12:13], s[68:69]
    s_mov_b32 s14, 2097152
    s_mov_b32 s15, 0x20000
    s_and_b32 s35, s30, 1
    s_mul_i32 s38, s99, 128
    s_mul_i32 s41, s35, 65536
    s_add_u32 s38, s38, s41
    s_mul_i32 s41, s35, 4096
    s_add_u32 s41, s41, 24576
    s_mov_b32 s42, 0
    s_mov_b32 s44, s67
    s_mov_b32 s42, 98304
    s_mov_b32 s44, s67
    s_add_u32 s44, s44, 12
    s_and_b32 s44, s44, 15
    s_call_b64 s[76:77], SUB_w_issue_1
    s_waitcnt vmcnt(8)
    s_mov_b32 s42, 106496
    s_mov_b32 s44, s67
    s_add_u32 s44, s44, 13
    s_and_b32 s44, s44, 15
    s_call_b64 s[76:77], SUB_w_issue_1
    s_waitcnt vmcnt(8)
    s_mov_b32 s42, 114688
    s_mov_b32 s44, s67
    s_add_u32 s44, s44, 14
    s_and_b32 s44, s44, 15
    s_call_b64 s[76:77], SUB_w_issue_1
    s_waitcnt vmcnt(8)
    s_mov_b32 s42, 122880
    s_mov_b32 s44, s67
    s_add_u32 s44, s44, 15
    s_and_b32 s44, s44, 15
    s_call_b64 s[76:77], SUB_w_issue_1
    s_waitcnt vmcnt(8)
    s_and_b32 s36, s29, 6
    s_cmp_eq_u32 s36, 2
    s_cbranch_scc1 pr_15
    s_call_b64 s[76:77], SUB_park2
pr_15:
    s_call_b64 s[76:77], SUB_w1_put
FR_end:
LAYER:
    v_lshlrev_b32 v40, 6, v199
    v_add_u32 v40, 161792, v40
    s_lshl_b32 s35, s30, 3
    v_add_u32 v39, s35, v40
    s_cmp_eq_u32 s60, 0
    s_cbranch_scc1 R_l0
    s_sub_u32 s8, s62, 0x400000
    s_subb_u32 s9, s63, 0
    s_mov_b32 s10, 0x7e000
    s_mov_b32 s11, 0x20000
    s_sub_u32 s12, s62, 0x380000
    s_subb_u32 s13, s63, 0
    s_mov_b32 s14, 0x7e000
    s_mov_b32 s15, 0x20000
    s_mov_b32 s20, s62
    s_mov_b32 s21, s63
    s_mov_b32 s22, 0x7e000
    s_mov_b32 s23, 0x20000
    s_mov_b32 s78, 0x3f80
    s_mov_b32 s79, 0x3f800000
    v_lshlrev_b32 v222, 16, v230
    v_and_b32 v223, 0xffff0000, v230
    v_lshlrev_b32 v206, 16, v180
    v_and_b32 v207, 0xffff0000, v180
    v_lshlrev_b32 v12, 16, v188
    v_and_b32 v13, 0xffff0000, v188
    v_pk_add_f32 v[206:207], v[206:207], v[12:13]
    v_lshlrev_b32 v224, 16, v231
    v_and_b32 v225, 0xffff0000, v231
    v_lshlrev_b32 v208, 16, v181
    v_and_b32 v209, 0xffff0000, v181
    v_lshlrev_b32 v14, 16, v189
    v_and_b32 v15, 0xffff0000, v189
    v_pk_add_f32 v[208:209], v[208:209], v[14:15]
    v_lshlrev_b32 v226, 16, v232
    v_and_b32 v227, 0xffff0000, v232
    v_lshlrev_b32 v210, 16, v182
    v_and_b32 v211, 0xffff0000, v182
    v_lshlrev_b32 v16, 16, v190
    v_and_b32 v17, 0xffff0000, v190
    v_pk_add_f32 v[210:211], v[210:211], v[16:17]
    v_lshlrev_b32 v228, 16, v233
    v_and_b32 v229, 0xffff0000, v233
    v_lshlrev_b32 v212, 16, v183
    v_and_b32 v213, 0xffff0000, v183
    v_lshlrev_b32 v18, 16, v191
    v_and_b32 v19, 0xffff0000, v191
    v_pk_add_f32 v[212:213], v[212:213], v[18:19]
    v_lshlrev_b32 v230, 16, v234
    v_and_b32 v231, 0xffff0000, v234
    v_lshlrev_b32 v214, 16, v184
    v_and_b32 v215, 0xffff0000, v184
    v_lshlrev_b32 v20, 16, v192
    v_and_b32 v21, 0xffff0000, v192
    v_pk_add_f32 v[214:215], v[214:215], v[20:21]
    v_lshlrev_b32 v232, 16, v235
    v_and_b32 v233, 0xffff0000, v235
    v_lshlrev_b32 v216, 16, v185
    v_and_b32 v217, 0xffff0000, v185
    v_lshlrev_b32 v22, 16, v193
    v_and_b32 v23, 0xffff0000, v193
    v_pk_add_f32 v[216:217], v[216:217], v[22:23]
    v_lshlrev_b32 v234, 16, v236
    v_and_b32 v235, 0xffff0000, v236
    v_lshlrev_b32 v218, 16, v186
    v_and_b32 v219, 0xffff0000, v186
    v_lshlrev_b32 v24, 16, v194
    v_and_b32 v25, 0xffff0000, v194
    v_pk_add_f32 v[218:219], v[218:219], v[24:25]
    v_lshlrev_b32 v236, 16, v237
    v_and_b32 v237, 0xffff0000, v237
    v_lshlrev_b32 v220, 16, v187
    v_and_b32 v221, 0xffff0000, v187
    v_lshlrev_b32 v26, 16, v195
    v_and_b32 v27, 0xffff0000, v195
    v_pk_add_f32 v[220:221], v[220:221], v[26:27]
    s_mov_b32 s53, 0
    s_sleep 10
    s_cmp_ge_u32 s30, 6
    s_cbranch_scc1 dp_16
    s_sleep 14
dp_16:
    buffer_load_dwordx4 v[180:183], v196, s[8:11], 0 offen offset:0 sc1
    buffer_load_dwordx4 v[188:191], v196, s[12:15], 0 offen offset:0 sc1
    buffer_load_dwordx4 v[184:187], v196, s[8:11], 0 offen offset:2048 sc1
    buffer_load_dwordx4 v[192:195], v196, s[12:15], 0 offen offset:2048 sc1
    s_waitcnt vmcnt(0)
    v_bitop3_b32 v6, v180, v184, v188 bitop3:0x80
    v_bitop3_b32 v6, v6, v192, 1 bitop3:0x80
    v_cmp_eq_u32 vcc, 0, v6
    s_cbranch_vccz dq_17
    s_sleep 4
    s_add_u32 s53, s53, 1
    s_cmp_lt_u32 s53, s61
    s_cbranch_scc1 dp_16
    s_mov_b32 s61, 0
dq_17:
    v_dot2_f32_bf16 v206, v180, s78, v206
    v_dot2_f32_bf16 v207, v180, s79, v207
    v_dot2_f32_bf16 v208, v181, s78, v208
    v_dot2_f32_bf16 v209, v181, s79, v209
    v_dot2_f32_bf16 v210, v182, s78, v210
    v_dot2_f32_bf16 v211, v182, s79, v211
    v_dot2_f32_bf16 v212, v183, s78, v212
    v_dot2_f32_bf16 v213, v183, s79, v213
    v_dot2_f32_bf16 v214, v184, s78, v214
    v_dot2_f32_bf16 v215, v184, s79, v215
    v_dot2_f32_bf16 v216, v185, s78, v216
    v_dot2_f32_bf16 v217, v185, s79, v217
    v_dot2_f32_bf16 v218, v186, s78, v218
    v_dot2_f32_bf16 v219, v186, s79, v219
    v_dot2_f32_bf16 v220, v187, s78, v220
    v_dot2_f32_bf16 v221, v187, s79, v221
    v_dot2_f32_bf16 v206, v188, s78, v206
    v_dot2_f32_bf16 v207, v188, s79, v207
    v_dot2_f32_bf16 v208, v189, s78, v208
    v_dot2_f32_bf16 v209, v189, s79, v209
    v_dot2_f32_bf16 v210, v190, s78, v210
    v_dot2_f32_bf16 v211, v190, s79, v211
    v_dot2_f32_bf16 v212, v191, s78, v212
    v_dot2_f32_bf16 v213, v191, s79, v213
    v_dot2_f32_bf16 v214, v192, s78, v214
    v_dot2_f32_bf16 v215, v192, s79, v215
    v_dot2_f32_bf16 v216, v193, s78, v216
    v_dot2_f32_bf16 v217, v193, s79, v217
    v_dot2_f32_bf16 v218, v194, s78, v218
    v_dot2_f32_bf16 v219, v194, s79, v219
    v_dot2_f32_bf16 v220, v195, s78, v220
    v_dot2_f32_bf16 v221, v195, s79, v221
    s_nop 2
    v_pk_add_f32 v[32:33], v[206:207], v[208:209]
    v_pk_mul_f32 v[34:35], v[206:207], v[206:207]
    v_pk_fma_f32 v[34:35], v[208:209], v[208:209], v[34:35]
    v_pk_add_f32 v[32:33], v[32:33], v[210:211]
    v_pk_fma_f32 v[34:35], v[210:211], v[210:211], v[34:35]
    v_pk_add_f32 v[32:33], v[32:33], v[212:213]
    v_pk_fma_f32 v[34:35], v[212:213], v[212:213], v[34:35]
    v_pk_add_f32 v[32:33], v[32:33], v[214:215]
    v_pk_fma_f32 v[34:35], v[214:215], v[214:215], v[34:35]
    v_pk_add_f32 v[32:33], v[32:33], v[216:217]
    v_pk_fma_f32 v[34:35], v[216:217], v[216:217], v[34:35]
    v_pk_add_f32 v[32:33], v[32:33], v[218:219]
    v_pk_fma_f32 v[34:35], v[218:219], v[218:219], v[34:35]
    v_pk_add_f32 v[32:33], v[32:33], v[220:221]
    v_pk_fma_f32 v[34:35], v[220:221], v[220:221], v[34:35]
    v_add_f32 v30, v32, v33
    v_add_f32 v31, v34, v35
    s_nop 0
    v_add_f32_dpp v30, v30, v30 row_ror:8 row_mask:0xf bank_mask:0xf
    v_add_f32_dpp v31, v31, v31 row_ror:8 row_mask:0xf bank_mask:0xf
    v_mov_b32 v32, v30
    v_mov_b32 v33, v31
    s_nop 0
    v_permlane16_swap_b32 v30, v32
    v_permlane16_swap_b32 v31, v33
    v_pk_add_f32 v[30:31], v[30:31], v[32:33]
    v_mov_b32 v32, v30
    v_mov_b32 v33, v31
    s_nop 0
    v_permlane32_swap_b32 v30, v32
    v_permlane32_swap_b32 v31, v33
    v_pk_add_f32 v[30:31], v[30:31], v[32:33]
    ds_write_b64 v39, v[30:31] offset:0
    s_waitcnt lgkmcnt(0)
    s_barrier
    ds_read_b128 v[12:15], v40 offset:0
    ds_read_b128 v[16:19], v40 offset:16
    ds_read_b128 v[20:23], v40 offset:32
    ds_read_b128 v[24:27], v40 offset:48
    s_waitcnt lgkmcnt(0)
    v_pk_add_f32 v[12:13], v[12:13], v[14:15]
    v_pk_add_f32 v[16:17], v[16:17], v[18:19]
    v_pk_add_f32 v[20:21], v[20:21], v[22:23]
    v_pk_add_f32 v[24:25], v[24:25], v[26:27]
    v_pk_add_f32 v[12:13], v[12:13], v[16:17]
    v_pk_add_f32 v[20:21], v[20:21], v[24:25]
    v_pk_add_f32 v[12:13], v[12:13], v[20:21]
    v_mul_f32 v36, 0x3a800000, v12
    v_mul_f32 v38, 0x3a800000, v13
    v_fma_f32 v38, -v36, v36, v38
    v_max_f32 v38, 0, v38
    v_add_f32 v38, 0x3727c5ac, v38
    v_rsq_f32 v37, v38
    s_nop 0
    v_mul_f32 v36, v36, v37
    v_pk_fma_f32 v[12:13], v[206:207], v[36:37], v[36:37] op_sel:[0,1,0] op_sel_hi:[1,1,0] neg_lo:[0,0,1] neg_hi:[0,0,1]
    v_pk_fma_f32 v[14:15], v[208:209], v[36:37], v[36:37] op_sel:[0,1,0] op_sel_hi:[1,1,0] neg_lo:[0,0,1] neg_hi:[0,0,1]
    v_pk_fma_f32 v[16:17], v[210:211], v[36:37], v[36:37] op_sel:[0,1,0] op_sel_hi:[1,1,0] neg_lo:[0,0,1] neg_hi:[0,0,1]
    v_pk_fma_f32 v[18:19], v[212:213], v[36:37], v[36:37] op_sel:[0,1,0] op_sel_hi:[1,1,0] neg_lo:[0,0,1] neg_hi:[0,0,1]
    v_pk_fma_f32 v[20:21], v[214:215], v[36:37], v[36:37] op_sel:[0,1,0] op_sel_hi:[1,1,0] neg_lo:[0,0,1] neg_hi:[0,0,1]
    v_pk_fma_f32 v[22:23], v[216:217], v[36:37], v[36:37] op_sel:[0,1,0] op_sel_hi:[1,1,0] neg_lo:[0,0,1] neg_hi:[0,0,1]
    v_pk_fma_f32 v[24:25], v[218:219], v[36:37], v[36:37] op_sel:[0,1,0] op_sel_hi:[1,1,0] neg_lo:[0,0,1] neg_hi:[0,0,1]
    v_pk_fma_f32 v[26:27], v[220:221], v[36:37], v[36:37] op_sel:[0,1,0] op_sel_hi:[1,1,0] neg_lo:[0,0,1] neg_hi:[0,0,1]
    v_pk_fma_f32 v[206:207], v[12:13], v[222:223], v[206:207]
    v_cvt_pk_bf16_f32 v180, v206, v207
    v_pk_fma_f32 v[208:209], v[14:15], v[224:225], v[208:209]
    v_cvt_pk_bf16_f32 v181, v208, v209
    v_and_b32 v180, -2, v180
    v_pk_fma_f32 v[210:211], v[16:17], v[226:227], v[210:211]
    v_cvt_pk_bf16_f32 v182, v210, v211
    v_pk_fma_f32 v[212:213], v[18:19], v[228:229], v[212:213]
    v_cvt_pk_bf16_f32 v183, v212, v213
    buffer_store_dwordx4 v[180:183], v196, s[20:23], 0 offen offset:0 sc1
    v_pk_fma_f32 v[214:215], v[20:21], v[230:231], v[214:215]
    v_cvt_pk_bf16_f32 v184, v214, v215
    v_pk_fma_f32 v[216:217], v[22:23], v[232:233], v[216:217]
    v_cvt_pk_bf16_f32 v185, v216, v217
    v_and_b32 v184, -2, v184
    v_pk_fma_f32 v[218:219], v[24:25], v[234:235], v[218:219]
    v_cvt_pk_bf16_f32 v186, v218, v219
    v_pk_fma_f32 v[220:221], v[26:27], v[236:237], v[220:221]
    v_cvt_pk_bf16_f32 v187, v220, v221
    buffer_store_dwordx4 v[184:187], v196, s[20:23], 0 offen offset:2048 sc1
    s_branch R_s2
R_l0:
    v_lshlrev_b32 v206, 16, v180
    v_and_b32 v207, 0xffff0000, v180
    v_lshlrev_b32 v208, 16, v181
    v_and_b32 v209, 0xffff0000, v181
    v_lshlrev_b32 v210, 16, v182
    v_and_b32 v211, 0xffff0000, v182
    v_lshlrev_b32 v212, 16, v183
    v_and_b32 v213, 0xffff0000, v183
    v_lshlrev_b32 v214, 16, v184
    v_and_b32 v215, 0xffff0000, v184
    v_lshlrev_b32 v216, 16, v185
    v_and_b32 v217, 0xffff0000, v185
    v_lshlrev_b32 v218, 16, v186
    v_and_b32 v219, 0xffff0000, v186
    v_lshlrev_b32 v220, 16, v187
    v_and_b32 v221, 0xffff0000, v187
    v_pk_add_f32 v[32:33], v[206:207], v[208:209]
    v_pk_mul_f32 v[34:35], v[206:207], v[206:207]
    v_pk_fma_f32 v[34:35], v[208:209], v[208:209], v[34:35]
    v_pk_add_f32 v[32:33], v[32:33], v[210:211]
    v_pk_fma_f32 v[34:35], v[210:211], v[210:211], v[34:35]
    v_pk_add_f32 v[32:33], v[32:33], v[212:213]
    v_pk_fma_f32 v[34:35], v[212:213], v[212:213], v[34:35]
    v_pk_add_f32 v[32:33], v[32:33], v[214:215]
    v_pk_fma_f32 v[34:35], v[214:215], v[214:215], v[34:35]
    v_pk_add_f32 v[32:33], v[32:33], v[216:217]
    v_pk_fma_f32 v[34:35], v[216:217], v[216:217], v[34:35]
    v_pk_add_f32 v[32:33], v[32:33], v[218:219]
    v_pk_fma_f32 v[34:35], v[218:219], v[218:219], v[34:35]
    v_pk_add_f32 v[32:33], v[32:33], v[220:221]
    v_pk_fma_f32 v[34:35], v[220:221], v[220:221], v[34:35]
    v_add_f32 v30, v32, v33
    v_add_f32 v31, v34, v35
    s_nop 0
    v_add_f32_dpp v30, v30, v30 row_ror:8 row_mask:0xf bank_mask:0xf
    v_add_f32_dpp v31, v31, v31 row_ror:8 row_mask:0xf bank_mask:0xf
    v_mov_b32 v32, v30
    v_mov_b32 v33, v31
    s_nop 0
    v_permlane16_swap_b32 v30, v32
    v_permlane16_swap_b32 v31, v33
    v_pk_add_f32 v[30:31], v[30:31], v[32:33]
    v_mov_b32 v32, v30
    v_mov_b32 v33, v31
    s_nop 0
    v_permlane32_swap_b32 v30, v32
    v_permlane32_swap_b32 v31, v33
    v_pk_add_f32 v[30:31], v[30:31], v[32:33]
    ds_write_b64 v39, v[30:31] offset:0
    s_waitcnt lgkmcnt(0)
    v_mov_b32 v222, 162844
spin_18:
    ds_read_b32 v223, v222
    s_waitcnt lgkmcnt(0)
    v_readfirstlane_b32 s94, v223
    s_nop 0
    s_cmp_ge_u32 s94, 65536
    s_cbranch_scc0 spin_18
    s_cmp_gt_u32 s94, 65546
    s_cselect_b32 s94, 1, 0
    s_lshl_b32 s53, s94, 13
    v_xor_b32 v197, s53, v197
    s_lshr_b32 s53, s28, 3
    s_lshl_b32 s53, s53, 2
    s_and_b32 s54, s28, 3
    s_add_u32 s53, s53, s54
    s_lshl_b32 s53, s53, 24
    s_lshr_b32 s54, s28, 2
    s_xor_b32 s54, s54, s94
    s_and_b32 s54, s54, 1
    s_lshl_b32 s54, s54, 13
    s_add_u32 s36, s53, s54
    s_add_u32 s36, s36, 33554432
    s_lshr_b32 s53, s53, 14
    s_add_u32 s36, s53, s54
    s_xor_b32 s36, s36, 8192
    s_add_u32 s36, s36, 23101440
    s_lshl_b32 s53, s30, 7
    s_add_u32 s36, s36, s53
    v_mov_b32 v226, s36
    s_waitcnt vmcnt(0)
    s_barrier
    s_mov_b32 s53, 0
    s_add_u32 s54, s52, 32
    s_bfm_b64 exec, 1, 0
poll_19:
    buffer_load_dword v222, v226, s[56:59], 0 offen sc1
    s_waitcnt vmcnt(0)
    v_xor_b32 v222, s54, v222
    v_cmp_eq_u32 vcc, 0, v222
    s_nop 0
    s_cmp_eq_u64 vcc, exec
    s_cbranch_scc1 pok_20
    s_sleep 6
    s_add_u32 s53, s53, 1
    s_cmp_lt_u32 s53, s61
    s_cbranch_scc1 poll_19
    s_mov_b32 s61, 0
pok_20:
    s_mov_b64 exec, -1
    s_add_u32 s80, s4, 0x2100000
    s_addc_u32 s81, s5, 0
    s_mov_b32 s82, 0x7f00000
    s_mov_b32 s83, 0x20000
    s_mov_b32 s78, 0
    buffer_load_dwordx2 v[230:231], v197, s[80:83], s78 offen sc1
    s_mov_b32 s78, 2048
    buffer_load_dwordx2 v[232:233], v197, s[80:83], s78 offen sc1
    s_mov_b32 s78, 16384
    buffer_load_dwordx2 v[234:235], v197, s[80:83], s78 offen sc1
    s_mov_b32 s78, 18432
    buffer_load_dwordx2 v[236:237], v197, s[80:83], s78 offen sc1
    s_lshr_b32 s53, s28, 3
    s_lshl_b32 s53, s53, 2
    s_and_b32 s54, s28, 3
    s_add_u32 s53, s53, s54
    s_lshl_b32 s53, s53, 24
    s_lshr_b32 s54, s28, 2
    s_xor_b32 s54, s54, s94
    s_and_b32 s54, s54, 1
    s_lshl_b32 s54, s54, 13
    s_add_u32 s55, s53, s54
    s_add_u32 s55, s55, 33554432
    s_add_u32 s62, s4, s55
    s_addc_u32 s63, s5, 0
    s_sub_u32 s36, s28, 1
    s_max_i32 s36, s36, 0
    s_lshr_b32 s53, s36, 3
    s_lshl_b32 s53, s53, 2
    s_and_b32 s54, s36, 3
    s_add_u32 s53, s53, s54
    s_lshl_b32 s53, s53, 24
    s_lshr_b32 s54, s36, 2
    s_xor_b32 s54, s54, s94
    s_and_b32 s54, s54, 1
    s_lshl_b32 s54, s54, 13
    s_add_u32 s92, s53, s54
    s_add_u32 s92, s92, 33554432
    s_sub_u32 s92, s92, s55
    s_add_u32 s36, s28, 1
    s_min_u32 s36, s36, 15
    s_lshr_b32 s53, s36, 3
    s_lshl_b32 s53, s53, 2
    s_and_b32 s54, s36, 3
    s_add_u32 s53, s53, s54
    s_lshl_b32 s53, s53, 24
    s_lshr_b32 s54, s36, 2
    s_xor_b32 s54, s54, s94
    s_and_b32 s54, s54, 1
    s_lshl_b32 s54, s54, 13
    s_add_u32 s93, s53, s54
    s_add_u32 s93, s93, 33554432
    s_sub_u32 s93, s93, s55
    s_add_u32 s55, s55, 6029312
    s_mov_b32 s20, s62
    s_mov_b32 s21, s63
    s_mov_b32 s22, 0x7e000
    s_mov_b32 s23, 0x20000
    ds_read_b128 v[12:15], v40 offset:0
    ds_read_b128 v[16:19], v40 offset:16
    ds_read_b128 v[20:23], v40 offset:32
    ds_read_b128 v[24:27], v40 offset:48
    s_waitcnt lgkmcnt(0)
    v_pk_add_f32 v[12:13], v[12:13], v[14:15]
    v_pk_add_f32 v[16:17], v[16:17], v[18:19]
    v_pk_add_f32 v[20:21], v[20:21], v[22:23]
    v_pk_add_f32 v[24:25], v[24:25], v[26:27]
    v_pk_add_f32 v[12:13], v[12:13], v[16:17]
    v_pk_add_f32 v[20:21], v[20:21], v[24:25]
    v_pk_add_f32 v[12:13], v[12:13], v[20:21]
    v_mul_f32 v36, 0x3a800000, v12
    v_mul_f32 v38, 0x3a800000, v13
    v_fma_f32 v38, -v36, v36, v38
    v_max_f32 v38, 0, v38
    v_add_f32 v38, 0x3727c5ac, v38
    v_rsq_f32 v37, v38
    s_nop 0
    v_pk_add_f32 v[12:13], v[206:207], v[36:37] op_sel_hi:[1,0] neg_lo:[0,1] neg_hi:[0,1]
    v_pk_mul_f32 v[12:13], v[12:13], v[36:37] op_sel:[0,1] op_sel_hi:[1,1]
    v_pk_add_f32 v[14:15], v[208:209], v[36:37] op_sel_hi:[1,0] neg_lo:[0,1] neg_hi:[0,1]
    v_pk_mul_f32 v[14:15], v[14:15], v[36:37] op_sel:[0,1] op_sel_hi:[1,1]
    v_pk_add_f32 v[16:17], v[210:211], v[36:37] op_sel_hi:[1,0] neg_lo:[0,1] neg_hi:[0,1]
    v_pk_mul_f32 v[16:17], v[16:17], v[36:37] op_sel:[0,1] op_sel_hi:[1,1]
    v_pk_add_f32 v[18:19], v[212:213], v[36:37] op_sel_hi:[1,0] neg_lo:[0,1] neg_hi:[0,1]
    v_pk_mul_f32 v[18:19], v[18:19], v[36:37] op_sel:[0,1] op_sel_hi:[1,1]
    v_pk_add_f32 v[20:21], v[214:215], v[36:37] op_sel_hi:[1,0] neg_lo:[0,1] neg_hi:[0,1]
    v_pk_mul_f32 v[20:21], v[20:21], v[36:37] op_sel:[0,1] op_sel_hi:[1,1]
    v_pk_add_f32 v[22:23], v[216:217], v[36:37] op_sel_hi:[1,0] neg_lo:[0,1] neg_hi:[0,1]
    v_pk_mul_f32 v[22:23], v[22:23], v[36:37] op_sel:[0,1] op_sel_hi:[1,1]
    v_pk_add_f32 v[24:25], v[218:219], v[36:37] op_sel_hi:[1,0] neg_lo:[0,1] neg_hi:[0,1]
    v_pk_mul_f32 v[24:25], v[24:25], v[36:37] op_sel:[0,1] op_sel_hi:[1,1]
    v_pk_add_f32 v[26:27], v[220:221], v[36:37] op_sel_hi:[1,0] neg_lo:[0,1] neg_hi:[0,1]
    v_pk_mul_f32 v[26:27], v[26:27], v[36:37] op_sel:[0,1] op_sel_hi:[1,1]
    s_barrier
    s_waitcnt vmcnt(0)
    v_lshlrev_b32 v222, 16, v230
    v_and_b32 v223, 0xffff0000, v230
    v_pk_fma_f32 v[206:207], v[12:13], v[222:223], v[206:207]
    v_cvt_pk_bf16_f32 v180, v206, v207
    v_lshlrev_b32 v222, 16, v231
    v_and_b32 v223, 0xffff0000, v231
    v_pk_fma_f32 v[208:209], v[14:15], v[222:223], v[208:209]
    v_cvt_pk_bf16_f32 v181, v208, v209
    v_and_b32 v180, -2, v180
    v_lshlrev_b32 v222, 16, v232
    v_and_b32 v223, 0xffff0000, v232
    v_pk_fma_f32 v[210:211], v[16:17], v[222:223], v[210:211]
    v_cvt_pk_bf16_f32 v182, v210, v211
    v_lshlrev_b32 v222, 16, v233
    v_and_b32 v223, 0xffff0000, v233
    v_pk_fma_f32 v[212:213], v[18:19], v[222:223], v[212:213]
    v_cvt_pk_bf16_f32 v183, v212, v213
    buffer_store_dwordx4 v[180:183], v196, s[20:23], 0 offen offset:0 sc1
    v_lshlrev_b32 v222, 16, v234
    v_and_b32 v223, 0xffff0000, v234
    v_pk_fma_f32 v[214:215], v[20:21], v[222:223], v[214:215]
    v_cvt_pk_bf16_f32 v184, v214, v215
    v_lshlrev_b32 v222, 16, v235
    v_and_b32 v223, 0xffff0000, v235
    v_pk_fma_f32 v[216:217], v[22:23], v[222:223], v[216:217]
    v_cvt_pk_bf16_f32 v185, v216, v217
    v_and_b32 v184, -2, v184
    v_lshlrev_b32 v222, 16, v236
    v_and_b32 v223, 0xffff0000, v236
    v_pk_fma_f32 v[218:219], v[24:25], v[222:223], v[218:219]
    v_cvt_pk_bf16_f32 v186, v218, v219
    v_lshlrev_b32 v222, 16, v237
    v_and_b32 v223, 0xffff0000, v237
    v_pk_fma_f32 v[220:221], v[26:27], v[222:223], v[220:221]
    v_cvt_pk_bf16_f32 v187, v220, v221
    buffer_store_dwordx4 v[184:187], v196, s[20:23], 0 offen offset:2048 sc1
R_s2:
    v_lshlrev_b32 v206, 16, v180
    v_and_b32 v207, 0xffff0000, v180
    v_lshlrev_b32 v208, 16, v181
    v_and_b32 v209, 0xffff0000, v181
    v_lshlrev_b32 v210, 16, v182
    v_and_b32 v211, 0xffff0000, v182
    v_lshlrev_b32 v212, 16, v183
    v_and_b32 v213, 0xffff0000, v183
    v_lshlrev_b32 v214, 16, v184
    v_and_b32 v215, 0xffff0000, v184
    v_lshlrev_b32 v216, 16, v185
    v_and_b32 v217, 0xffff0000, v185
    v_lshlrev_b32 v218, 16, v186
    v_and_b32 v219, 0xffff0000, v186
    v_lshlrev_b32 v220, 16, v187
    v_and_b32 v221, 0xffff0000, v187
    v_pk_add_f32 v[32:33], v[206:207], v[208:209]
    v_pk_mul_f32 v[34:35], v[206:207], v[206:207]
    v_pk_fma_f32 v[34:35], v[208:209], v[208:209], v[34:35]
    v_pk_add_f32 v[32:33], v[32:33], v[210:211]
    v_pk_fma_f32 v[34:35], v[210:211], v[210:211], v[34:35]
    v_pk_add_f32 v[32:33], v[32:33], v[212:213]
    v_pk_fma_f32 v[34:35], v[212:213], v[212:213], v[34:35]
    v_pk_add_f32 v[32:33], v[32:33], v[214:215]
    v_pk_fma_f32 v[34:35], v[214:215], v[214:215], v[34:35]
    v_pk_add_f32 v[32:33], v[32:33], v[216:217]
    v_pk_fma_f32 v[34:35], v[216:217], v[216:217], v[34:35]
    v_pk_add_f32 v[32:33], v[32:33], v[218:219]
    v_pk_fma_f32 v[34:35], v[218:219], v[218:219], v[34:35]
    v_pk_add_f32 v[32:33], v[32:33], v[220:221]
    v_pk_fma_f32 v[34:35], v[220:221], v[220:221], v[34:35]
    v_add_f32 v30, v32, v33
    v_add_f32 v31, v34, v35
    s_nop 0
    v_add_f32_dpp v30, v30, v30 row_ror:8 row_mask:0xf bank_mask:0xf
    v_add_f32_dpp v31, v31, v31 row_ror:8 row_mask:0xf bank_mask:0xf
    v_mov_b32 v32, v30
    v_mov_b32 v33, v31
    s_nop 0
    v_permlane16_swap_b32 v30, v32
    v_permlane16_swap_b32 v31, v33
    v_pk_add_f32 v[30:31], v[30:31], v[32:33]
    v_mov_b32 v32, v30
    v_mov_b32 v33, v31
    s_nop 0
    v_permlane32_swap_b32 v30, v32
    v_permlane32_swap_b32 v31, v33
    v_pk_add_f32 v[30:31], v[30:31], v[32:33]
    ds_write_b64 v39, v[30:31] offset:512
    s_waitcnt lgkmcnt(0)
    s_barrier
    s_cmp_lg_u32 s30, 6
    s_cbranch_scc1 R_n6
    s_cmp_lg_u32 s60, 0
    s_cbranch_scc1 R_n6
    s_lshl_b32 s53, s29, 7
    s_add_u32 s53, s53, 23121920
    v_mov_b32 v8, 1
    v_mov_b32 v9, 0
    s_mov_b64 exec, 1
    buffer_atomic_add v8, v9, s[56:59], s53 offen sc1
    s_mov_b64 exec, -1
R_n6:
    s_cmp_lg_u32 s30, 7
    s_cbranch_scc1 R_nl
    ds_read_b128 v[12:15], v40 offset:512
    ds_read_b128 v[16:19], v40 offset:528
    ds_read_b128 v[20:23], v40 offset:544
    ds_read_b128 v[24:27], v40 offset:560
    s_waitcnt lgkmcnt(0)
    v_pk_add_f32 v[12:13], v[12:13], v[14:15]
    v_pk_add_f32 v[16:17], v[16:17], v[18:19]
    v_pk_add_f32 v[20:21], v[20:21], v[22:23]
    v_pk_add_f32 v[24:25], v[24:25], v[26:27]
    v_pk_add_f32 v[12:13], v[12:13], v[16:17]
    v_pk_add_f32 v[20:21], v[20:21], v[24:25]
    v_pk_add_f32 v[12:13], v[12:13], v[20:21]
    v_mul_f32 v36, 0x3a800000, v12
    v_mul_f32 v38, 0x3a800000, v13
    v_fma_f32 v38, -v36, v36, v38
    v_max_f32 v38, 0, v38
    v_mov_b32 v42, v36
    v_mov_b32 v43, v38
    v_add_f32 v38, 0x3727c5ac, v38
    v_sqrt_f32 v38, v38
    s_nop 0
    v_mov_b32 v41, v38
    v_rcp_f32 v37, v38
    v_sub_f32 v42, v42, v36
    v_mul_f32 v42, v42, v37
    v_mul_f32 v43, v43, v37
    v_mul_f32 v43, v43, v37
    v_add_f32 v43, 0x3727c5ac, v43
    v_rsq_f32 v44, v43
    v_mov_b32 v224, v36
    v_mov_b32 v225, v37
    v_fma_f32 v226, v42, v41, v36
    v_mul_f32 v227, v37, v44
    s_add_u32 s24, s62, 0x5d0000
    s_addc_u32 s25, s63, 0
    s_mov_b32 s26, 0x800
    s_mov_b32 s27, 0x20000
    s_lshl_b32 s36, s29, 3
    v_add_u32 v6, s36, v199
    v_lshlrev_b32 v6, 4, v6
    s_mov_b64 exec, 0xff
    buffer_store_dwordx4 v[224:227], v6, s[24:27], 0 offen sc1
    s_mov_b64 exec, -1
    s_add_u32 s53, s55, 1280
    v_mov_b32 v8, 1
    v_mov_b32 v9, 162816
    v_mov_b32 v11, 0
    s_mov_b64 exec, 1
    s_waitcnt vmcnt(0)
    buffer_atomic_add v8, v11, s[56:59], s53 offen sc1
pub_21:
    s_mov_b64 exec, -1
R_nl:
    s_cmp_ge_u32 s30, 4
    s_cbranch_scc1 LOADERS
    s_mov_b32 s8, s62
    s_mov_b32 s9, s63
    s_mov_b32 s10, 0x7e000
    s_mov_b32 s11, 0x20000
    v_add_u32 v126, 0, v2
    v_add_u32 v127, 65536, v2
    s_lshl_b32 s44, s30, 17
    s_mov_b32 s34, s30
    s_mov_b32 s35, 0
    v_and_b32 v22, 15, v1
    v_lshrrev_b32 v23, 4, v1
    s_mul_i32 s37, s34, 2
    s_mul_i32 s38, s99, 4
    s_mul_i32 s36, s35, 4
    s_add_u32 s38, s38, s36
    v_add_u32 v128, 4096, v2
    v_add_u32 v129, 69632, v2
    s_add_u32 s45, s44, 16384
    s_add_u32 s46, s44, 32768
    s_add_u32 s47, s44, 49152
    v_lshrrev_b32 v6, 2, v1
    v_mul_u32_u24 v13, 128, v6
    v_and_b32 v7, 3, v1
    v_lshl_add_u32 v13, v7, 3, v13
    v_add_u32 v13, 24576, v13
    v_bfe_u32 v6, v6, 1, 2
    s_mul_i32 s36, s35, 4
    s_add_u32 s36, s36, 3
    v_xor_b32 v7, s36, v6
    v_lshl_add_u32 v16, v7, 5, v13
    s_mul_i32 s36, s35, 4
    s_add_u32 s36, s36, 2
    v_xor_b32 v7, s36, v6
    v_lshl_add_u32 v15, v7, 5, v13
    s_mul_i32 s36, s35, 4
    s_add_u32 s36, s36, 1
    v_xor_b32 v7, s36, v6
    v_lshl_add_u32 v14, v7, 5, v13
    s_mul_i32 s36, s35, 4
    s_add_u32 s36, s36, 0
    v_xor_b32 v7, s36, v6
    v_lshl_add_u32 v13, v7, 5, v13
    v_pk_mov_b32 v[24:25], 0, 0
    v_pk_mov_b32 v[26:27], 0, 0
    v_pk_mov_b32 v[28:29], 0, 0
    v_pk_mov_b32 v[30:31], 0, 0
    v_pk_mov_b32 v[32:33], 0, 0
    v_pk_mov_b32 v[34:35], 0, 0
    v_pk_mov_b32 v[36:37], 0, 0
    v_pk_mov_b32 v[38:39], 0, 0
    v_pk_mov_b32 v[40:41], 0, 0
    v_pk_mov_b32 v[42:43], 0, 0
    v_pk_mov_b32 v[44:45], 0, 0
    v_pk_mov_b32 v[46:47], 0, 0
    v_pk_mov_b32 v[48:49], 0, 0
    v_pk_mov_b32 v[50:51], 0, 0
    v_pk_mov_b32 v[52:53], 0, 0
    v_pk_mov_b32 v[54:55], 0, 0
    s_mov_b32 s43, 0
    s_mul_i32 s36, s35, 256
    s_add_u32 s36, s36, 163328
    v_lshlrev_b32 v6, 4, v23
    v_add_u32 v6, s36, v6
    s_lshl_b32 s36, s37, 8
    s_add_u32 s36, s36, 160776
    v_lshlrev_b32 v7, 4, v22
    v_add_u32 v7, s36, v7
    s_add_u32 s16, s62, 0x100000
    s_addc_u32 s17, s63, 0
    s_mov_b32 s18, 0x7e000
    s_mov_b32 s19, 0x20000
    v_lshlrev_b32 v12, 11, v23
    v_lshl_add_u32 v12, v22, 4, v12
    s_lshl_b32 s39, s38, 13
    s_lshl_b32 s36, s37, 8
    s_add_u32 s39, s39, s36
    s_add_u32 s40, s39, 16384
    s_lshl_b32 s36, s29, 1
    s_lshr_b32 s53, s36, 3
    s_lshl_b32 s53, s53, 14
    s_and_b32 s41, s36, 7
    s_lshl_b32 s41, s41, 10
    s_add_u32 s41, s41, s53
    s_lshl_b32 s36, s37, 16
    s_add_u32 s41, s41, s36
    s_mov_b32 s53, 0
    s_mov_b32 s49, s44
    ds_read_b64_tr_b16 v[56:57], v13 offset:0
    ds_read_b64_tr_b16 v[58:59], v13 offset:2048
    ds_read_b64_tr_b16 v[60:61], v14 offset:0
    ds_read_b64_tr_b16 v[62:63], v14 offset:2048
    ds_read_b64_tr_b16 v[64:65], v15 offset:0
    ds_read_b64_tr_b16 v[66:67], v15 offset:2048
    ds_read_b64_tr_b16 v[68:69], v16 offset:0
    ds_read_b64_tr_b16 v[70:71], v16 offset:2048
    ds_read_b64_tr_b16 v[72:73], v13 offset:4096
    ds_read_b64_tr_b16 v[74:75], v13 offset:6144
    ds_read_b64_tr_b16 v[76:77], v14 offset:4096
    ds_read_b64_tr_b16 v[78:79], v14 offset:6144
    ds_read_b64_tr_b16 v[80:81], v15 offset:4096
    ds_read_b64_tr_b16 v[82:83], v15 offset:6144
    ds_read_b64_tr_b16 v[84:85], v16 offset:4096
    ds_read_b64_tr_b16 v[86:87], v16 offset:6144
dm_22p:
    buffer_load_dwordx4 v[164:167], v126, s[8:11], s44 offen offset:0 sc1
    buffer_load_dwordx4 v[168:171], v127, s[8:11], s44 offen offset:0 sc1
    buffer_load_dwordx4 v[172:175], v126, s[8:11], s44 offen offset:1024 sc1
    buffer_load_dwordx4 v[176:179], v127, s[8:11], s44 offen offset:1024 sc1
    buffer_load_dwordx4 v[180:183], v126, s[8:11], s44 offen offset:2048 sc1
    buffer_load_dwordx4 v[184:187], v127, s[8:11], s44 offen offset:2048 sc1
    buffer_load_dwordx4 v[188:191], v126, s[8:11], s44 offen offset:3072 sc1
    buffer_load_dwordx4 v[192:195], v127, s[8:11], s44 offen offset:3072 sc1
dm_22w:
    s_waitcnt vmcnt(4)
    v_or3_b32 v17, v164, v168, v172
    v_bitop3_b32 v17, v17, v176, 1 bitop3:0xa8
    v_cmp_ne_u32 vcc, 0, v17
    s_cbranch_vccz dm_22q
dm_22r:
    s_sleep 2
    buffer_load_dwordx4 v[164:167], v126, s[8:11], s44 offen offset:0 sc1
    buffer_load_dwordx4 v[168:171], v127, s[8:11], s44 offen offset:0 sc1
    buffer_load_dwordx4 v[172:175], v126, s[8:11], s44 offen offset:1024 sc1
    buffer_load_dwordx4 v[176:179], v127, s[8:11], s44 offen offset:1024 sc1
    buffer_load_dwordx4 v[180:183], v126, s[8:11], s44 offen offset:2048 sc1
    buffer_load_dwordx4 v[184:187], v127, s[8:11], s44 offen offset:2048 sc1
    buffer_load_dwordx4 v[188:191], v126, s[8:11], s44 offen offset:3072 sc1
    buffer_load_dwordx4 v[192:195], v127, s[8:11], s44 offen offset:3072 sc1
    s_waitcnt vmcnt(4)
    v_or3_b32 v17, v164, v168, v172
    v_bitop3_b32 v17, v17, v176, 1 bitop3:0xa8
    v_cmp_ne_u32 vcc, 0, v17
    s_cbranch_vccz dm_22t
    s_add_u32 s53, s53, 1
    s_cmp_lt_u32 s53, s61
    s_cbranch_scc1 dm_22r
    s_mov_b32 s61, 0
    s_branch dm_22t
dm_22q:
dm_22t:
    buffer_load_dwordx4 v[196:199], v128, s[8:11], s44 offen offset:0 sc1
    buffer_load_dwordx4 v[200:203], v129, s[8:11], s44 offen offset:0 sc1
    buffer_load_dwordx4 v[204:207], v128, s[8:11], s44 offen offset:1024 sc1
    buffer_load_dwordx4 v[208:211], v129, s[8:11], s44 offen offset:1024 sc1
    buffer_load_dwordx4 v[212:215], v128, s[8:11], s44 offen offset:2048 sc1
    buffer_load_dwordx4 v[216:219], v129, s[8:11], s44 offen offset:2048 sc1
    s_waitcnt lgkmcnt(0)
dm_22:
    v_mfma_f32_16x16x32_bf16 v[24:27], v[56:59], v[164:167], v[24:27]
    ds_read_b64_tr_b16 v[88:89], v13 offset:8192
    buffer_load_dwordx4 v[220:223], v128, s[8:11], s44 offen offset:3072 sc1
    v_mfma_f32_16x16x32_bf16 v[40:43], v[56:59], v[168:171], v[40:43]
    ds_read_b64_tr_b16 v[90:91], v13 offset:10240
    buffer_load_dwordx4 v[224:227], v129, s[8:11], s44 offen offset:3072 sc1
    v_mfma_f32_16x16x32_bf16 v[44:47], v[60:63], v[168:171], v[44:47]
    ds_read_b64_tr_b16 v[92:93], v14 offset:8192
    s_mov_b32 s44, s45
    v_mfma_f32_16x16x32_bf16 v[28:31], v[60:63], v[164:167], v[28:31]
    ds_read_b64_tr_b16 v[94:95], v14 offset:10240
    s_mov_b32 s45, s46
    v_mfma_f32_16x16x32_bf16 v[32:35], v[64:67], v[164:167], v[32:35]
    ds_read_b64_tr_b16 v[96:97], v15 offset:8192
    s_mov_b32 s46, s47
    v_mfma_f32_16x16x32_bf16 v[48:51], v[64:67], v[168:171], v[48:51]
    ds_read_b64_tr_b16 v[98:99], v15 offset:10240
    s_mov_b32 s47, 1048576
    v_mfma_f32_16x16x32_bf16 v[52:55], v[68:71], v[168:171], v[52:55]
    ds_read_b64_tr_b16 v[100:101], v16 offset:8192
    v_mfma_f32_16x16x32_bf16 v[36:39], v[68:71], v[164:167], v[36:39]
    ds_read_b64_tr_b16 v[102:103], v16 offset:10240
    s_waitcnt lgkmcnt(8)
    v_mfma_f32_16x16x32_bf16 v[24:27], v[72:75], v[172:175], v[24:27]
    ds_read_b64_tr_b16 v[104:105], v13 offset:12288
    buffer_load_dwordx4 v[164:167], v126, s[8:11], s44 offen offset:0 sc1
    v_mfma_f32_16x16x32_bf16 v[40:43], v[72:75], v[176:179], v[40:43]
    ds_read_b64_tr_b16 v[106:107], v13 offset:14336
    buffer_load_dwordx4 v[168:171], v127, s[8:11], s44 offen offset:0 sc1
    v_mfma_f32_16x16x32_bf16 v[44:47], v[76:79], v[176:179], v[44:47]
    ds_read_b64_tr_b16 v[108:109], v14 offset:12288
    s_waitcnt vmcnt(10)
    v_mfma_f32_16x16x32_bf16 v[28:31], v[76:79], v[172:175], v[28:31]
    ds_read_b64_tr_b16 v[110:111], v14 offset:14336
    v_or3_b32 v17, v180, v184, v188
    v_mfma_f32_16x16x32_bf16 v[32:35], v[80:83], v[172:175], v[32:35]
    ds_read_b64_tr_b16 v[112:113], v15 offset:12288
    v_bitop3_b32 v17, v17, v192, 1 bitop3:0xa8
    v_mfma_f32_16x16x32_bf16 v[48:51], v[80:83], v[176:179], v[48:51]
    ds_read_b64_tr_b16 v[114:115], v15 offset:14336
    v_cmp_ne_u32 vcc, 0, v17
    v_mfma_f32_16x16x32_bf16 v[52:55], v[84:87], v[176:179], v[52:55]
    ds_read_b64_tr_b16 v[116:117], v16 offset:12288
    ds_read_b64_tr_b16 v[118:119], v16 offset:14336
    v_mfma_f32_16x16x32_bf16 v[36:39], v[84:87], v[172:175], v[36:39]
    s_waitcnt lgkmcnt(8)
    s_cbranch_vccnz dm_22f0
dm_22g0:
    v_mfma_f32_16x16x32_bf16 v[24:27], v[88:91], v[180:183], v[24:27]
    ds_read_b64_tr_b16 v[56:57], v13 offset:16384
    buffer_load_dwordx4 v[172:175], v126, s[8:11], s44 offen offset:1024 sc1
    v_mfma_f32_16x16x32_bf16 v[40:43], v[88:91], v[184:187], v[40:43]
    ds_read_b64_tr_b16 v[58:59], v13 offset:18432
    buffer_load_dwordx4 v[176:179], v127, s[8:11], s44 offen offset:1024 sc1
    v_mfma_f32_16x16x32_bf16 v[44:47], v[92:95], v[184:187], v[44:47]
    ds_read_b64_tr_b16 v[60:61], v14 offset:16384
    v_mfma_f32_16x16x32_bf16 v[28:31], v[92:95], v[180:183], v[28:31]
    ds_read_b64_tr_b16 v[62:63], v14 offset:18432
    v_mfma_f32_16x16x32_bf16 v[32:35], v[96:99], v[180:183], v[32:35]
    ds_read_b64_tr_b16 v[64:65], v15 offset:16384
    v_mfma_f32_16x16x32_bf16 v[48:51], v[96:99], v[184:187], v[48:51]
    ds_read_b64_tr_b16 v[66:67], v15 offset:18432
    v_mfma_f32_16x16x32_bf16 v[52:55], v[100:103], v[184:187], v[52:55]
    ds_read_b64_tr_b16 v[68:69], v16 offset:16384
    v_mfma_f32_16x16x32_bf16 v[36:39], v[100:103], v[180:183], v[36:39]
    ds_read_b64_tr_b16 v[70:71], v16 offset:18432
    s_waitcnt lgkmcnt(8)
    v_mfma_f32_16x16x32_bf16 v[24:27], v[104:107], v[188:191], v[24:27]
    ds_read_b64_tr_b16 v[72:73], v13 offset:20480
    buffer_load_dwordx4 v[180:183], v126, s[8:11], s44 offen offset:2048 sc1
    v_mfma_f32_16x16x32_bf16 v[40:43], v[104:107], v[192:195], v[40:43]
    ds_read_b64_tr_b16 v[74:75], v13 offset:22528
    buffer_load_dwordx4 v[184:187], v127, s[8:11], s44 offen offset:2048 sc1
    v_mfma_f32_16x16x32_bf16 v[44:47], v[108:111], v[192:195], v[44:47]
    ds_read_b64_tr_b16 v[76:77], v14 offset:20480
    s_waitcnt vmcnt(10)
    v_mfma_f32_16x16x32_bf16 v[28:31], v[108:111], v[188:191], v[28:31]
    ds_read_b64_tr_b16 v[78:79], v14 offset:22528
    v_or3_b32 v17, v196, v200, v204
    v_mfma_f32_16x16x32_bf16 v[32:35], v[112:115], v[188:191], v[32:35]
    ds_read_b64_tr_b16 v[80:81], v15 offset:20480
    v_bitop3_b32 v17, v17, v208, 1 bitop3:0xa8
    v_mfma_f32_16x16x32_bf16 v[48:51], v[112:115], v[192:195], v[48:51]
    ds_read_b64_tr_b16 v[82:83], v15 offset:22528
    v_cmp_ne_u32 vcc, 0, v17
    v_mfma_f32_16x16x32_bf16 v[52:55], v[116:119], v[192:195], v[52:55]
    ds_read_b64_tr_b16 v[84:85], v16 offset:20480
    ds_read_b64_tr_b16 v[86:87], v16 offset:22528
    v_mfma_f32_16x16x32_bf16 v[36:39], v[116:119], v[188:191], v[36:39]
    s_waitcnt lgkmcnt(8)
    s_cbranch_vccnz dm_22f1
dm_22g1:
    v_mfma_f32_16x16x32_bf16 v[24:27], v[56:59], v[196:199], v[24:27]
    ds_read_b64_tr_b16 v[88:89], v13 offset:24576
    buffer_load_dwordx4 v[188:191], v126, s[8:11], s44 offen offset:3072 sc1
    v_mfma_f32_16x16x32_bf16 v[40:43], v[56:59], v[200:203], v[40:43]
    ds_read_b64_tr_b16 v[90:91], v13 offset:26624
    buffer_load_dwordx4 v[192:195], v127, s[8:11], s44 offen offset:3072 sc1
    v_mfma_f32_16x16x32_bf16 v[44:47], v[60:63], v[200:203], v[44:47]
    ds_read_b64_tr_b16 v[92:93], v14 offset:24576
    v_mfma_f32_16x16x32_bf16 v[28:31], v[60:63], v[196:199], v[28:31]
    ds_read_b64_tr_b16 v[94:95], v14 offset:26624
    v_mfma_f32_16x16x32_bf16 v[32:35], v[64:67], v[196:199], v[32:35]
    ds_read_b64_tr_b16 v[96:97], v15 offset:24576
    s_add_u32 s43, s43, 1
    v_mfma_f32_16x16x32_bf16 v[48:51], v[64:67], v[200:203], v[48:51]
    ds_read_b64_tr_b16 v[98:99], v15 offset:26624
    v_mfma_f32_16x16x32_bf16 v[52:55], v[68:71], v[200:203], v[52:55]
    ds_read_b64_tr_b16 v[100:101], v16 offset:24576
    v_mfma_f32_16x16x32_bf16 v[36:39], v[68:71], v[196:199], v[36:39]
    ds_read_b64_tr_b16 v[102:103], v16 offset:26624
    s_waitcnt lgkmcnt(8)
    v_mfma_f32_16x16x32_bf16 v[24:27], v[72:75], v[204:207], v[24:27]
    ds_read_b64_tr_b16 v[104:105], v13 offset:28672
    buffer_load_dwordx4 v[196:199], v128, s[8:11], s44 offen offset:0 sc1
    v_mfma_f32_16x16x32_bf16 v[40:43], v[72:75], v[208:211], v[40:43]
    ds_read_b64_tr_b16 v[106:107], v13 offset:30720
    buffer_load_dwordx4 v[200:203], v129, s[8:11], s44 offen offset:0 sc1
    v_mfma_f32_16x16x32_bf16 v[44:47], v[76:79], v[208:211], v[44:47]
    ds_read_b64_tr_b16 v[108:109], v14 offset:28672
    s_waitcnt vmcnt(10)
    v_mfma_f32_16x16x32_bf16 v[28:31], v[76:79], v[204:207], v[28:31]
    ds_read_b64_tr_b16 v[110:111], v14 offset:30720
    v_add_u32 v13, 32768, v13
    v_or3_b32 v17, v212, v216, v220
    v_mfma_f32_16x16x32_bf16 v[32:35], v[80:83], v[204:207], v[32:35]
    ds_read_b64_tr_b16 v[112:113], v15 offset:28672
    v_add_u32 v14, 32768, v14
    v_bitop3_b32 v17, v17, v224, 1 bitop3:0xa8
    v_mfma_f32_16x16x32_bf16 v[48:51], v[80:83], v[208:211], v[48:51]
    ds_read_b64_tr_b16 v[114:115], v15 offset:30720
    v_add_u32 v15, 32768, v15
    v_cmp_ne_u32 vcc, 0, v17
    v_mfma_f32_16x16x32_bf16 v[52:55], v[84:87], v[208:211], v[52:55]
    ds_read_b64_tr_b16 v[116:117], v16 offset:28672
    ds_read_b64_tr_b16 v[118:119], v16 offset:30720
    s_cmp_eq_u32 s43, 4
    v_mfma_f32_16x16x32_bf16 v[36:39], v[84:87], v[204:207], v[36:39]
    v_add_u32 v16, 32768, v16
    s_waitcnt lgkmcnt(8)
    s_cbranch_vccnz dm_22f2
dm_22g2:
    s_cbranch_scc1 dm_22x
    v_mfma_f32_16x16x32_bf16 v[24:27], v[88:91], v[212:215], v[24:27]
    ds_read_b64_tr_b16 v[56:57], v13 offset:0
    buffer_load_dwordx4 v[204:207], v128, s[8:11], s44 offen offset:1024 sc1
    v_mfma_f32_16x16x32_bf16 v[40:43], v[88:91], v[216:219], v[40:43]
    ds_read_b64_tr_b16 v[58:59], v13 offset:2048
    buffer_load_dwordx4 v[208:211], v129, s[8:11], s44 offen offset:1024 sc1
    v_mfma_f32_16x16x32_bf16 v[44:47], v[92:95], v[216:219], v[44:47]
    ds_read_b64_tr_b16 v[60:61], v14 offset:0
    s_mov_b32 s49, s44
    v_mfma_f32_16x16x32_bf16 v[28:31], v[92:95], v[212:215], v[28:31]
    ds_read_b64_tr_b16 v[62:63], v14 offset:2048
    v_mfma_f32_16x16x32_bf16 v[32:35], v[96:99], v[212:215], v[32:35]
    ds_read_b64_tr_b16 v[64:65], v15 offset:0
    v_mfma_f32_16x16x32_bf16 v[48:51], v[96:99], v[216:219], v[48:51]
    ds_read_b64_tr_b16 v[66:67], v15 offset:2048
    v_mfma_f32_16x16x32_bf16 v[52:55], v[100:103], v[216:219], v[52:55]
    ds_read_b64_tr_b16 v[68:69], v16 offset:0
    v_mfma_f32_16x16x32_bf16 v[36:39], v[100:103], v[212:215], v[36:39]
    ds_read_b64_tr_b16 v[70:71], v16 offset:2048
    s_waitcnt lgkmcnt(8)
    v_mfma_f32_16x16x32_bf16 v[24:27], v[104:107], v[220:223], v[24:27]
    ds_read_b64_tr_b16 v[72:73], v13 offset:4096
    buffer_load_dwordx4 v[212:215], v128, s[8:11], s44 offen offset:2048 sc1
    v_mfma_f32_16x16x32_bf16 v[40:43], v[104:107], v[224:227], v[40:43]
    ds_read_b64_tr_b16 v[74:75], v13 offset:6144
    buffer_load_dwordx4 v[216:219], v129, s[8:11], s44 offen offset:2048 sc1
    v_mfma_f32_16x16x32_bf16 v[44:47], v[108:111], v[224:227], v[44:47]
    ds_read_b64_tr_b16 v[76:77], v14 offset:4096
    s_waitcnt vmcnt(10)
    v_mfma_f32_16x16x32_bf16 v[28:31], v[108:111], v[220:223], v[28:31]
    ds_read_b64_tr_b16 v[78:79], v14 offset:6144
    v_or3_b32 v17, v164, v168, v172
    v_mfma_f32_16x16x32_bf16 v[32:35], v[112:115], v[220:223], v[32:35]
    ds_read_b64_tr_b16 v[80:81], v15 offset:4096
    v_bitop3_b32 v17, v17, v176, 1 bitop3:0xa8
    v_mfma_f32_16x16x32_bf16 v[48:51], v[112:115], v[224:227], v[48:51]
    ds_read_b64_tr_b16 v[82:83], v15 offset:6144
    v_cmp_ne_u32 vcc, 0, v17
    v_mfma_f32_16x16x32_bf16 v[52:55], v[116:119], v[224:227], v[52:55]
    ds_read_b64_tr_b16 v[84:85], v16 offset:4096
    ds_read_b64_tr_b16 v[86:87], v16 offset:6144
    v_mfma_f32_16x16x32_bf16 v[36:39], v[116:119], v[220:223], v[36:39]
    s_waitcnt lgkmcnt(8)
    s_cbranch_vccnz dm_22f3
dm_22g3:
    s_branch dm_22
dm_22f0:
    s_cselect_b32 s50, 1, 0
dm_22h0:
    s_sleep 2
    buffer_load_dwordx4 v[180:183], v126, s[8:11], s49 offen offset:2048 sc1
    buffer_load_dwordx4 v[184:187], v127, s[8:11], s49 offen offset:2048 sc1
    buffer_load_dwordx4 v[188:191], v126, s[8:11], s49 offen offset:3072 sc1
    buffer_load_dwordx4 v[192:195], v127, s[8:11], s49 offen offset:3072 sc1
    buffer_load_dwordx4 v[196:199], v128, s[8:11], s49 offen offset:0 sc1
    buffer_load_dwordx4 v[200:203], v129, s[8:11], s49 offen offset:0 sc1
    buffer_load_dwordx4 v[204:207], v128, s[8:11], s49 offen offset:1024 sc1
    buffer_load_dwordx4 v[208:211], v129, s[8:11], s49 offen offset:1024 sc1
    buffer_load_dwordx4 v[212:215], v128, s[8:11], s49 offen offset:2048 sc1
    buffer_load_dwordx4 v[216:219], v129, s[8:11], s49 offen offset:2048 sc1
    buffer_load_dwordx4 v[220:223], v128, s[8:11], s49 offen offset:3072 sc1
    buffer_load_dwordx4 v[224:227], v129, s[8:11], s49 offen offset:3072 sc1
    buffer_load_dwordx4 v[164:167], v126, s[8:11], s44 offen offset:0 sc1
    buffer_load_dwordx4 v[168:171], v127, s[8:11], s44 offen offset:0 sc1
    s_waitcnt vmcnt(10)
    v_or3_b32 v17, v180, v184, v188
    v_bitop3_b32 v17, v17, v192, 1 bitop3:0xa8
    v_cmp_ne_u32 vcc, 0, v17
    s_add_u32 s53, s53, 1
    s_cmp_ge_u32 s53, s61
    s_cselect_b32 s61, 0, s61
    s_cbranch_scc1 dm_22k0
    s_cbranch_vccnz dm_22h0
dm_22k0:
    s_cmp_eq_u32 s50, 1
    s_branch dm_22g0
dm_22f1:
    s_cselect_b32 s50, 1, 0
dm_22h1:
    s_sleep 2
    buffer_load_dwordx4 v[196:199], v128, s[8:11], s49 offen offset:0 sc1
    buffer_load_dwordx4 v[200:203], v129, s[8:11], s49 offen offset:0 sc1
    buffer_load_dwordx4 v[204:207], v128, s[8:11], s49 offen offset:1024 sc1
    buffer_load_dwordx4 v[208:211], v129, s[8:11], s49 offen offset:1024 sc1
    buffer_load_dwordx4 v[212:215], v128, s[8:11], s49 offen offset:2048 sc1
    buffer_load_dwordx4 v[216:219], v129, s[8:11], s49 offen offset:2048 sc1
    buffer_load_dwordx4 v[220:223], v128, s[8:11], s49 offen offset:3072 sc1
    buffer_load_dwordx4 v[224:227], v129, s[8:11], s49 offen offset:3072 sc1
    buffer_load_dwordx4 v[164:167], v126, s[8:11], s44 offen offset:0 sc1
    buffer_load_dwordx4 v[168:171], v127, s[8:11], s44 offen offset:0 sc1
    buffer_load_dwordx4 v[172:175], v126, s[8:11], s44 offen offset:1024 sc1
    buffer_load_dwordx4 v[176:179], v127, s[8:11], s44 offen offset:1024 sc1
    buffer_load_dwordx4 v[180:183], v126, s[8:11], s44 offen offset:2048 sc1
    buffer_load_dwordx4 v[184:187], v127, s[8:11], s44 offen offset:2048 sc1
    s_waitcnt vmcnt(10)
    v_or3_b32 v17, v196, v200, v204
    v_bitop3_b32 v17, v17, v208, 1 bitop3:0xa8
    v_cmp_ne_u32 vcc, 0, v17
    s_add_u32 s53, s53, 1
    s_cmp_ge_u32 s53, s61
    s_cselect_b32 s61, 0, s61
    s_cbranch_scc1 dm_22k1
    s_cbranch_vccnz dm_22h1
dm_22k1:
    s_cmp_eq_u32 s50, 1
    s_branch dm_22g1
dm_22f2:
    s_cselect_b32 s50, 1, 0
dm_22h2:
    s_sleep 2
    buffer_load_dwordx4 v[212:215], v128, s[8:11], s49 offen offset:2048 sc1
    buffer_load_dwordx4 v[216:219], v129, s[8:11], s49 offen offset:2048 sc1
    buffer_load_dwordx4 v[220:223], v128, s[8:11], s49 offen offset:3072 sc1
    buffer_load_dwordx4 v[224:227], v129, s[8:11], s49 offen offset:3072 sc1
    buffer_load_dwordx4 v[164:167], v126, s[8:11], s44 offen offset:0 sc1
    buffer_load_dwordx4 v[168:171], v127, s[8:11], s44 offen offset:0 sc1
    buffer_load_dwordx4 v[172:175], v126, s[8:11], s44 offen offset:1024 sc1
    buffer_load_dwordx4 v[176:179], v127, s[8:11], s44 offen offset:1024 sc1
    buffer_load_dwordx4 v[180:183], v126, s[8:11], s44 offen offset:2048 sc1
    buffer_load_dwordx4 v[184:187], v127, s[8:11], s44 offen offset:2048 sc1
    buffer_load_dwordx4 v[188:191], v126, s[8:11], s44 offen offset:3072 sc1
    buffer_load_dwordx4 v[192:195], v127, s[8:11], s44 offen offset:3072 sc1
    buffer_load_dwordx4 v[196:199], v128, s[8:11], s44 offen offset:0 sc1
    buffer_load_dwordx4 v[200:203], v129, s[8:11], s44 offen offset:0 sc1
    s_waitcnt vmcnt(10)
    v_or3_b32 v17, v212, v216, v220
    v_bitop3_b32 v17, v17, v224, 1 bitop3:0xa8
    v_cmp_ne_u32 vcc, 0, v17
    s_add_u32 s53, s53, 1
    s_cmp_ge_u32 s53, s61
    s_cselect_b32 s61, 0, s61
    s_cbranch_scc1 dm_22k2
    s_cbranch_vccnz dm_22h2
dm_22k2:
    s_cmp_eq_u32 s50, 1
    s_branch dm_22g2
dm_22f3:
    s_cselect_b32 s50, 1, 0
dm_22h3:
    s_sleep 2
    buffer_load_dwordx4 v[164:167], v126, s[8:11], s49 offen offset:0 sc1
    buffer_load_dwordx4 v[168:171], v127, s[8:11], s49 offen offset:0 sc1
    buffer_load_dwordx4 v[172:175], v126, s[8:11], s49 offen offset:1024 sc1
    buffer_load_dwordx4 v[176:179], v127, s[8:11], s49 offen offset:1024 sc1
    buffer_load_dwordx4 v[180:183], v126, s[8:11], s49 offen offset:2048 sc1
    buffer_load_dwordx4 v[184:187], v127, s[8:11], s49 offen offset:2048 sc1
    buffer_load_dwordx4 v[188:191], v126, s[8:11], s49 offen offset:3072 sc1
    buffer_load_dwordx4 v[192:195], v127, s[8:11], s49 offen offset:3072 sc1
    buffer_load_dwordx4 v[196:199], v128, s[8:11], s49 offen offset:0 sc1
    buffer_load_dwordx4 v[200:203], v129, s[8:11], s49 offen offset:0 sc1
    buffer_load_dwordx4 v[204:207], v128, s[8:11], s49 offen offset:1024 sc1
    buffer_load_dwordx4 v[208:211], v129, s[8:11], s49 offen offset:1024 sc1
    buffer_load_dwordx4 v[212:215], v128, s[8:11], s49 offen offset:2048 sc1
    buffer_load_dwordx4 v[216:219], v129, s[8:11], s49 offen offset:2048 sc1
    s_waitcnt vmcnt(10)
    v_or3_b32 v17, v164, v168, v172
    v_bitop3_b32 v17, v17, v176, 1 bitop3:0xa8
    v_cmp_ne_u32 vcc, 0, v17
    s_add_u32 s53, s53, 1
    s_cmp_ge_u32 s53, s61
    s_cselect_b32 s61, 0, s61
    s_cbranch_scc1 dm_22k3
    s_cbranch_vccnz dm_22h3
dm_22k3:
    s_cmp_eq_u32 s50, 1
    s_branch dm_22g3
dm_22x:
    v_mfma_f32_16x16x32_bf16 v[24:27], v[88:91], v[212:215], v[24:27]
    buffer_load_dwordx4 v[148:151], v126, s[8:11], s41 offen offset:0 sc1
    v_mfma_f32_16x16x32_bf16 v[40:43], v[88:91], v[216:219], v[40:43]
    v_mfma_f32_16x16x32_bf16 v[44:47], v[92:95], v[216:219], v[44:47]
    buffer_load_dwordx4 v[152:155], v126, s[8:11], s41 offen offset:1024 sc1
    v_mfma_f32_16x16x32_bf16 v[28:31], v[92:95], v[212:215], v[28:31]
    v_mfma_f32_16x16x32_bf16 v[32:35], v[96:99], v[212:215], v[32:35]
    buffer_load_dwordx4 v[156:159], v127, s[8:11], s41 offen offset:0 sc1
    v_mfma_f32_16x16x32_bf16 v[48:51], v[96:99], v[216:219], v[48:51]
    v_mfma_f32_16x16x32_bf16 v[52:55], v[100:103], v[216:219], v[52:55]
    buffer_load_dwordx4 v[160:163], v127, s[8:11], s41 offen offset:1024 sc1
    v_mfma_f32_16x16x32_bf16 v[36:39], v[100:103], v[212:215], v[36:39]
    s_waitcnt lgkmcnt(0)
    s_barrier
    v_mfma_f32_16x16x32_bf16 v[24:27], v[104:107], v[220:223], v[24:27]
    ds_read_b128 v[56:59], v6 offset:0
    v_mfma_f32_16x16x32_bf16 v[40:43], v[104:107], v[224:227], v[40:43]
    ds_read_b128 v[60:63], v6 offset:64
    v_mfma_f32_16x16x32_bf16 v[44:47], v[108:111], v[224:227], v[44:47]
    ds_read_b128 v[64:67], v6 offset:128
    v_mfma_f32_16x16x32_bf16 v[28:31], v[108:111], v[220:223], v[28:31]
    ds_read_b128 v[68:71], v6 offset:192
    v_mfma_f32_16x16x32_bf16 v[32:35], v[112:115], v[220:223], v[32:35]
    ds_read_b64 v[72:73], v7 offset:0
    v_mfma_f32_16x16x32_bf16 v[48:51], v[112:115], v[224:227], v[48:51]
    ds_read_b64 v[74:75], v7 offset:256
    v_mfma_f32_16x16x32_bf16 v[52:55], v[116:119], v[224:227], v[52:55]
    v_mfma_f32_16x16x32_bf16 v[36:39], v[116:119], v[220:223], v[36:39]
    s_waitcnt lgkmcnt(0)
    v_mul_f32 v134, 0xc0135761, v73
    v_mul_f32 v135, v73, v73
    v_mul_f32 v135, v135, v134
    v_mul_f32 v135, 0x3d372713, v135
    v_rcp_f32 v73, v73
    v_mul_f32 v136, 0xc0135761, v75
    v_mul_f32 v137, v75, v75
    v_mul_f32 v137, v137, v136
    v_mul_f32 v137, 0x3d372713, v137
    v_rcp_f32 v75, v75
    v_pk_fma_f32 v[24:25], v[72:73], v[56:57], v[24:25] op_sel_hi:[0,1,1] neg_lo:[1,0,0] neg_hi:[1,0,0]
    v_pk_fma_f32 v[26:27], v[72:73], v[58:59], v[26:27] op_sel_hi:[0,1,1] neg_lo:[1,0,0] neg_hi:[1,0,0]
    v_pk_mul_f32 v[122:123], v[24:25], v[24:25]
    v_pk_mul_f32 v[124:125], v[26:27], v[26:27]
    v_pk_fma_f32 v[122:123], v[122:123], v[134:135], v[134:135] op_sel:[0,1,0] op_sel_hi:[1,1,0]
    v_pk_fma_f32 v[124:125], v[124:125], v[134:135], v[134:135] op_sel:[0,1,0] op_sel_hi:[1,1,0]
    v_pk_mul_f32 v[122:123], v[122:123], v[24:25]
    v_pk_mul_f32 v[124:125], v[124:125], v[26:27]
    v_exp_f32 v122, v122
    v_exp_f32 v123, v123
    v_exp_f32 v124, v124
    v_exp_f32 v125, v125
    v_pk_fma_f32 v[122:123], v[122:123], v[72:73], v[72:73] op_sel:[0,1,1] op_sel_hi:[1,1,1]
    v_pk_fma_f32 v[124:125], v[124:125], v[72:73], v[72:73] op_sel:[0,1,1] op_sel_hi:[1,1,1]
    v_rcp_f32 v122, v122
    v_rcp_f32 v123, v123
    v_rcp_f32 v124, v124
    v_rcp_f32 v125, v125
    v_pk_mul_f32 v[24:25], v[24:25], v[122:123]
    v_pk_mul_f32 v[26:27], v[26:27], v[124:125]
    v_pk_fma_f32 v[28:29], v[72:73], v[60:61], v[28:29] op_sel_hi:[0,1,1] neg_lo:[1,0,0] neg_hi:[1,0,0]
    v_pk_fma_f32 v[30:31], v[72:73], v[62:63], v[30:31] op_sel_hi:[0,1,1] neg_lo:[1,0,0] neg_hi:[1,0,0]
    v_pk_mul_f32 v[122:123], v[28:29], v[28:29]
    v_pk_mul_f32 v[124:125], v[30:31], v[30:31]
    v_pk_fma_f32 v[122:123], v[122:123], v[134:135], v[134:135] op_sel:[0,1,0] op_sel_hi:[1,1,0]
    v_pk_fma_f32 v[124:125], v[124:125], v[134:135], v[134:135] op_sel:[0,1,0] op_sel_hi:[1,1,0]
    v_pk_mul_f32 v[122:123], v[122:123], v[28:29]
    v_pk_mul_f32 v[124:125], v[124:125], v[30:31]
    v_exp_f32 v122, v122
    v_exp_f32 v123, v123
    v_exp_f32 v124, v124
    v_exp_f32 v125, v125
    v_pk_fma_f32 v[122:123], v[122:123], v[72:73], v[72:73] op_sel:[0,1,1] op_sel_hi:[1,1,1]
    v_pk_fma_f32 v[124:125], v[124:125], v[72:73], v[72:73] op_sel:[0,1,1] op_sel_hi:[1,1,1]
    v_rcp_f32 v122, v122
    v_rcp_f32 v123, v123
    v_rcp_f32 v124, v124
    v_rcp_f32 v125, v125
    v_pk_mul_f32 v[28:29], v[28:29], v[122:123]
    v_pk_mul_f32 v[30:31], v[30:31], v[124:125]
    v_cvt_pk_bf16_f32 v24, v24, v25
    v_cvt_pk_bf16_f32 v25, v26, v27
    v_cvt_pk_bf16_f32 v26, v28, v29
    v_cvt_pk_bf16_f32 v27, v30, v31
    v_and_b32 v24, -2, v24
    buffer_store_dwordx4 v[24:27], v12, s[16:19], s39 offen offset:0 sc1
    v_pk_fma_f32 v[40:41], v[74:75], v[56:57], v[40:41] op_sel_hi:[0,1,1] neg_lo:[1,0,0] neg_hi:[1,0,0]
    v_pk_fma_f32 v[42:43], v[74:75], v[58:59], v[42:43] op_sel_hi:[0,1,1] neg_lo:[1,0,0] neg_hi:[1,0,0]
    v_pk_mul_f32 v[122:123], v[40:41], v[40:41]
    v_pk_mul_f32 v[124:125], v[42:43], v[42:43]
    v_pk_fma_f32 v[122:123], v[122:123], v[136:137], v[136:137] op_sel:[0,1,0] op_sel_hi:[1,1,0]
    v_pk_fma_f32 v[124:125], v[124:125], v[136:137], v[136:137] op_sel:[0,1,0] op_sel_hi:[1,1,0]
    v_pk_mul_f32 v[122:123], v[122:123], v[40:41]
    v_pk_mul_f32 v[124:125], v[124:125], v[42:43]
    v_exp_f32 v122, v122
    v_exp_f32 v123, v123
    v_exp_f32 v124, v124
    v_exp_f32 v125, v125
    v_pk_fma_f32 v[122:123], v[122:123], v[74:75], v[74:75] op_sel:[0,1,1] op_sel_hi:[1,1,1]
    v_pk_fma_f32 v[124:125], v[124:125], v[74:75], v[74:75] op_sel:[0,1,1] op_sel_hi:[1,1,1]
    v_rcp_f32 v122, v122
    v_rcp_f32 v123, v123
    v_rcp_f32 v124, v124
    v_rcp_f32 v125, v125
    v_pk_mul_f32 v[40:41], v[40:41], v[122:123]
    v_pk_mul_f32 v[42:43], v[42:43], v[124:125]
    v_pk_fma_f32 v[44:45], v[74:75], v[60:61], v[44:45] op_sel_hi:[0,1,1] neg_lo:[1,0,0] neg_hi:[1,0,0]
    v_pk_fma_f32 v[46:47], v[74:75], v[62:63], v[46:47] op_sel_hi:[0,1,1] neg_lo:[1,0,0] neg_hi:[1,0,0]
    v_pk_mul_f32 v[122:123], v[44:45], v[44:45]
    v_pk_mul_f32 v[124:125], v[46:47], v[46:47]
    v_pk_fma_f32 v[122:123], v[122:123], v[136:137], v[136:137] op_sel:[0,1,0] op_sel_hi:[1,1,0]
    v_pk_fma_f32 v[124:125], v[124:125], v[136:137], v[136:137] op_sel:[0,1,0] op_sel_hi:[1,1,0]
    v_pk_mul_f32 v[122:123], v[122:123], v[44:45]
    v_pk_mul_f32 v[124:125], v[124:125], v[46:47]
    v_exp_f32 v122, v122
    v_exp_f32 v123, v123
    v_exp_f32 v124, v124
    v_exp_f32 v125, v125
    v_pk_fma_f32 v[122:123], v[122:123], v[74:75], v[74:75] op_sel:[0,1,1] op_sel_hi:[1,1,1]
    v_pk_fma_f32 v[124:125], v[124:125], v[74:75], v[74:75] op_sel:[0,1,1] op_sel_hi:[1,1,1]
    v_rcp_f32 v122, v122
    v_rcp_f32 v123, v123
    v_rcp_f32 v124, v124
    v_rcp_f32 v125, v125
    v_pk_mul_f32 v[44:45], v[44:45], v[122:123]
    v_pk_mul_f32 v[46:47], v[46:47], v[124:125]
    v_cvt_pk_bf16_f32 v40, v40, v41
    v_cvt_pk_bf16_f32 v41, v42, v43
    v_cvt_pk_bf16_f32 v42, v44, v45
    v_cvt_pk_bf16_f32 v43, v46, v47
    v_and_b32 v40, -2, v40
    buffer_store_dwordx4 v[40:43], v12, s[16:19], s39 offen offset:256 sc1
    v_pk_fma_f32 v[32:33], v[72:73], v[64:65], v[32:33] op_sel_hi:[0,1,1] neg_lo:[1,0,0] neg_hi:[1,0,0]
    v_pk_fma_f32 v[34:35], v[72:73], v[66:67], v[34:35] op_sel_hi:[0,1,1] neg_lo:[1,0,0] neg_hi:[1,0,0]
    v_pk_mul_f32 v[122:123], v[32:33], v[32:33]
    v_pk_mul_f32 v[124:125], v[34:35], v[34:35]
    v_pk_fma_f32 v[122:123], v[122:123], v[134:135], v[134:135] op_sel:[0,1,0] op_sel_hi:[1,1,0]
    v_pk_fma_f32 v[124:125], v[124:125], v[134:135], v[134:135] op_sel:[0,1,0] op_sel_hi:[1,1,0]
    v_pk_mul_f32 v[122:123], v[122:123], v[32:33]
    v_pk_mul_f32 v[124:125], v[124:125], v[34:35]
    v_exp_f32 v122, v122
    v_exp_f32 v123, v123
    v_exp_f32 v124, v124
    v_exp_f32 v125, v125
    v_pk_fma_f32 v[122:123], v[122:123], v[72:73], v[72:73] op_sel:[0,1,1] op_sel_hi:[1,1,1]
    v_pk_fma_f32 v[124:125], v[124:125], v[72:73], v[72:73] op_sel:[0,1,1] op_sel_hi:[1,1,1]
    v_rcp_f32 v122, v122
    v_rcp_f32 v123, v123
    v_rcp_f32 v124, v124
    v_rcp_f32 v125, v125
    v_pk_mul_f32 v[32:33], v[32:33], v[122:123]
    v_pk_mul_f32 v[34:35], v[34:35], v[124:125]
    v_pk_fma_f32 v[36:37], v[72:73], v[68:69], v[36:37] op_sel_hi:[0,1,1] neg_lo:[1,0,0] neg_hi:[1,0,0]
    v_pk_fma_f32 v[38:39], v[72:73], v[70:71], v[38:39] op_sel_hi:[0,1,1] neg_lo:[1,0,0] neg_hi:[1,0,0]
    v_pk_mul_f32 v[122:123], v[36:37], v[36:37]
    v_pk_mul_f32 v[124:125], v[38:39], v[38:39]
    v_pk_fma_f32 v[122:123], v[122:123], v[134:135], v[134:135] op_sel:[0,1,0] op_sel_hi:[1,1,0]
    v_pk_fma_f32 v[124:125], v[124:125], v[134:135], v[134:135] op_sel:[0,1,0] op_sel_hi:[1,1,0]
    v_pk_mul_f32 v[122:123], v[122:123], v[36:37]
    v_pk_mul_f32 v[124:125], v[124:125], v[38:39]
    v_exp_f32 v122, v122
    v_exp_f32 v123, v123
    v_exp_f32 v124, v124
    v_exp_f32 v125, v125
    v_pk_fma_f32 v[122:123], v[122:123], v[72:73], v[72:73] op_sel:[0,1,1] op_sel_hi:[1,1,1]
    v_pk_fma_f32 v[124:125], v[124:125], v[72:73], v[72:73] op_sel:[0,1,1] op_sel_hi:[1,1,1]
    v_rcp_f32 v122, v122
    v_rcp_f32 v123, v123
    v_rcp_f32 v124, v124
    v_rcp_f32 v125, v125
    v_pk_mul_f32 v[36:37], v[36:37], v[122:123]
    v_pk_mul_f32 v[38:39], v[38:39], v[124:125]
    v_cvt_pk_bf16_f32 v32, v32, v33
    v_cvt_pk_bf16_f32 v33, v34, v35
    v_cvt_pk_bf16_f32 v34, v36, v37
    v_cvt_pk_bf16_f32 v35, v38, v39
    v_and_b32 v32, -2, v32
    buffer_store_dwordx4 v[32:35], v12, s[16:19], s40 offen offset:0 sc1
    v_pk_fma_f32 v[48:49], v[74:75], v[64:65], v[48:49] op_sel_hi:[0,1,1] neg_lo:[1,0,0] neg_hi:[1,0,0]
    v_pk_fma_f32 v[50:51], v[74:75], v[66:67], v[50:51] op_sel_hi:[0,1,1] neg_lo:[1,0,0] neg_hi:[1,0,0]
    v_pk_mul_f32 v[122:123], v[48:49], v[48:49]
    v_pk_mul_f32 v[124:125], v[50:51], v[50:51]
    v_pk_fma_f32 v[122:123], v[122:123], v[136:137], v[136:137] op_sel:[0,1,0] op_sel_hi:[1,1,0]
    v_pk_fma_f32 v[124:125], v[124:125], v[136:137], v[136:137] op_sel:[0,1,0] op_sel_hi:[1,1,0]
    v_pk_mul_f32 v[122:123], v[122:123], v[48:49]
    v_pk_mul_f32 v[124:125], v[124:125], v[50:51]
    v_exp_f32 v122, v122
    v_exp_f32 v123, v123
    v_exp_f32 v124, v124
    v_exp_f32 v125, v125
    v_pk_fma_f32 v[122:123], v[122:123], v[74:75], v[74:75] op_sel:[0,1,1] op_sel_hi:[1,1,1]
    v_pk_fma_f32 v[124:125], v[124:125], v[74:75], v[74:75] op_sel:[0,1,1] op_sel_hi:[1,1,1]
    v_rcp_f32 v122, v122
    v_rcp_f32 v123, v123
    v_rcp_f32 v124, v124
    v_rcp_f32 v125, v125
    v_pk_mul_f32 v[48:49], v[48:49], v[122:123]
    v_pk_mul_f32 v[50:51], v[50:51], v[124:125]
    v_pk_fma_f32 v[52:53], v[74:75], v[68:69], v[52:53] op_sel_hi:[0,1,1] neg_lo:[1,0,0] neg_hi:[1,0,0]
    v_pk_fma_f32 v[54:55], v[74:75], v[70:71], v[54:55] op_sel_hi:[0,1,1] neg_lo:[1,0,0] neg_hi:[1,0,0]
    v_pk_mul_f32 v[122:123], v[52:53], v[52:53]
    v_pk_mul_f32 v[124:125], v[54:55], v[54:55]
    v_pk_fma_f32 v[122:123], v[122:123], v[136:137], v[136:137] op_sel:[0,1,0] op_sel_hi:[1,1,0]
    v_pk_fma_f32 v[124:125], v[124:125], v[136:137], v[136:137] op_sel:[0,1,0] op_sel_hi:[1,1,0]
    v_pk_mul_f32 v[122:123], v[122:123], v[52:53]
    v_pk_mul_f32 v[124:125], v[124:125], v[54:55]
    v_exp_f32 v122, v122
    v_exp_f32 v123, v123
    v_exp_f32 v124, v124
    v_exp_f32 v125, v125
    v_pk_fma_f32 v[122:123], v[122:123], v[74:75], v[74:75] op_sel:[0,1,1] op_sel_hi:[1,1,1]
    v_pk_fma_f32 v[124:125], v[124:125], v[74:75], v[74:75] op_sel:[0,1,1] op_sel_hi:[1,1,1]
    v_rcp_f32 v122, v122
    v_rcp_f32 v123, v123
    v_rcp_f32 v124, v124
    v_rcp_f32 v125, v125
    v_pk_mul_f32 v[52:53], v[52:53], v[122:123]
    v_pk_mul_f32 v[54:55], v[54:55], v[124:125]
    v_cvt_pk_bf16_f32 v48, v48, v49
    v_cvt_pk_bf16_f32 v49, v50, v51
    v_cvt_pk_bf16_f32 v50, v52, v53
    v_cvt_pk_bf16_f32 v51, v54, v55
    v_and_b32 v48, -2, v48
    buffer_store_dwordx4 v[48:51], v12, s[16:19], s40 offen offset:256 sc1
    s_add_u32 s8, s4, 0x2100000
    s_addc_u32 s9, s5, 0
    s_mov_b32 s10, 0x8400000
    s_mov_b32 s11, 0x20000
    s_sub_u32 s47, s55, 39583744
    s_lshl_b32 s46, s30, 9
    s_add_u32 s47, s47, s46
    s_add_u32 s45, s92, 2048
    s_cmp_eq_u32 s28, 0
    s_cselect_b32 s45, 1073741824, s45
    s_cmp_eq_u32 s30, 0
    s_cselect_b32 s45, s45, 0
    s_add_u32 s53, s47, 0xfffffff0
    v_add_u32 v126, s53, v12
    v_add_u32 v127, 256, v126
    v_add_u32 v134, s45, v126
    v_cmp_gt_u32 vcc, 1, v22
    s_nop 1
    v_cndmask_b32 v126, v126, v134, vcc
    s_mov_b32 s34, s30
    s_mov_b32 s35, 0
    v_and_b32 v22, 15, v1
    v_lshrrev_b32 v23, 4, v1
    s_mul_i32 s37, s34, 2
    s_mul_i32 s38, s29, 4
    s_mul_i32 s36, s35, 4
    s_add_u32 s38, s38, s36
    s_lshr_b32 s36, s38, 1
    s_lshr_b32 s53, s36, 3
    s_lshl_b32 s53, s53, 14
    s_and_b32 s39, s36, 7
    s_lshl_b32 s39, s39, 10
    s_add_u32 s39, s39, s53
    s_lshl_b32 s36, s37, 16
    s_add_u32 s39, s39, s36
    s_sub_u32 s46, s93, 2048
    s_cmp_eq_u32 s28, 15
    s_cselect_b32 s46, 1073741824, s46
    s_cmp_eq_u32 s30, 3
    s_cselect_b32 s46, s46, 0
    s_add_u32 s53, s47, 0x10
    v_add_u32 v128, s53, v12
    v_add_u32 v129, 256, v128
    v_add_u32 v134, s46, v129
    v_cmp_le_u32 vcc, 15, v22
    s_nop 1
    v_cndmask_b32 v129, v129, v134, vcc
    s_add_u32 s53, s47, 0xffffffe0
    v_add_u32 v130, s53, v12
    v_add_u32 v131, 256, v130
    v_add_u32 v134, s45, v130
    v_cmp_gt_u32 vcc, 2, v22
    s_nop 1
    v_cndmask_b32 v130, v130, v134, vcc
    s_add_u32 s53, s47, 0x20
    v_add_u32 v132, s53, v12
    v_add_u32 v133, 256, v132
    v_add_u32 v134, s46, v133
    v_cmp_le_u32 vcc, 14, v22
    s_nop 1
    v_cndmask_b32 v133, v133, v134, vcc
    v_mov_b32 v134, v126
    v_mov_b32 v135, v127
    v_lshrrev_b32 v6, 2, v1
    v_mul_u32_u24 v13, 128, v6
    v_and_b32 v7, 3, v1
    v_lshl_add_u32 v13, v7, 3, v13
    v_add_u32 v13, 0, v13
    v_bfe_u32 v6, v6, 1, 2
    s_mul_i32 s36, s35, 4
    s_add_u32 s36, s36, 3
    v_xor_b32 v7, s36, v6
    v_lshl_add_u32 v16, v7, 5, v13
    s_mul_i32 s36, s35, 4
    s_add_u32 s36, s36, 2
    v_xor_b32 v7, s36, v6
    v_lshl_add_u32 v15, v7, 5, v13
    s_mul_i32 s36, s35, 4
    s_add_u32 s36, s36, 1
    v_xor_b32 v7, s36, v6
    v_lshl_add_u32 v14, v7, 5, v13
    s_mul_i32 s36, s35, 4
    s_add_u32 s36, s36, 0
    v_xor_b32 v7, s36, v6
    v_lshl_add_u32 v13, v7, 5, v13
    s_lshl_b32 s36, s37, 8
    s_add_u32 s36, s36, 160768
    v_lshlrev_b32 v7, 4, v22
    v_add_u32 v7, s36, v7
    ds_read_b64 v[56:57], v7 offset:0
    ds_read_b64 v[58:59], v7 offset:256
    s_waitcnt vmcnt(4) lgkmcnt(0)
    s_sleep 6
    s_cmp_lg_u32 s60, 0
    s_cbranch_scc1 G2_nd
    s_sleep 2
G2_nd:
    s_mov_b32 s44, 0
    buffer_load_dwordx4 v[164:167], v126, s[8:11], s44 offen sc1
    buffer_load_dwordx4 v[168:171], v127, s[8:11], s44 offen sc1
    s_add_u32 s44, s44, 16384
    buffer_load_dwordx4 v[172:175], v126, s[8:11], s44 offen sc1
    buffer_load_dwordx4 v[176:179], v127, s[8:11], s44 offen sc1
    s_add_u32 s44, s44, 16384
    buffer_load_dwordx4 v[180:183], v126, s[8:11], s44 offen
    buffer_load_dwordx4 v[184:187], v127, s[8:11], s44 offen
    s_add_u32 s44, s44, 16384
    buffer_load_dwordx4 v[188:191], v126, s[8:11], s44 offen
    buffer_load_dwordx4 v[192:195], v127, s[8:11], s44 offen
    s_add_u32 s44, s44, 16384
    v_lshlrev_b32 v24, 16, v148
    v_and_b32 v25, 0xffff0000, v148
    v_pk_add_f32 v[24:25], v[24:25], v[56:57] op_sel_hi:[1,0] neg_lo:[0,1] neg_hi:[0,1]
    v_pk_mul_f32 v[24:25], v[24:25], v[56:57] op_sel:[0,1] op_sel_hi:[1,1]
    v_lshlrev_b32 v26, 16, v149
    v_and_b32 v27, 0xffff0000, v149
    v_pk_add_f32 v[26:27], v[26:27], v[56:57] op_sel_hi:[1,0] neg_lo:[0,1] neg_hi:[0,1]
    v_pk_mul_f32 v[26:27], v[26:27], v[56:57] op_sel:[0,1] op_sel_hi:[1,1]
    v_lshlrev_b32 v28, 16, v150
    v_and_b32 v29, 0xffff0000, v150
    v_pk_add_f32 v[28:29], v[28:29], v[56:57] op_sel_hi:[1,0] neg_lo:[0,1] neg_hi:[0,1]
    v_pk_mul_f32 v[28:29], v[28:29], v[56:57] op_sel:[0,1] op_sel_hi:[1,1]
    v_lshlrev_b32 v30, 16, v151
    v_and_b32 v31, 0xffff0000, v151
    v_pk_add_f32 v[30:31], v[30:31], v[56:57] op_sel_hi:[1,0] neg_lo:[0,1] neg_hi:[0,1]
    v_pk_mul_f32 v[30:31], v[30:31], v[56:57] op_sel:[0,1] op_sel_hi:[1,1]
    v_lshlrev_b32 v32, 16, v152
    v_and_b32 v33, 0xffff0000, v152
    v_pk_add_f32 v[32:33], v[32:33], v[56:57] op_sel_hi:[1,0] neg_lo:[0,1] neg_hi:[0,1]
    v_pk_mul_f32 v[32:33], v[32:33], v[56:57] op_sel:[0,1] op_sel_hi:[1,1]
    v_lshlrev_b32 v34, 16, v153
    v_and_b32 v35, 0xffff0000, v153
    v_pk_add_f32 v[34:35], v[34:35], v[56:57] op_sel_hi:[1,0] neg_lo:[0,1] neg_hi:[0,1]
    v_pk_mul_f32 v[34:35], v[34:35], v[56:57] op_sel:[0,1] op_sel_hi:[1,1]
    v_lshlrev_b32 v36, 16, v154
    v_and_b32 v37, 0xffff0000, v154
    v_pk_add_f32 v[36:37], v[36:37], v[56:57] op_sel_hi:[1,0] neg_lo:[0,1] neg_hi:[0,1]
    v_pk_mul_f32 v[36:37], v[36:37], v[56:57] op_sel:[0,1] op_sel_hi:[1,1]
    v_lshlrev_b32 v38, 16, v155
    v_and_b32 v39, 0xffff0000, v155
    v_pk_add_f32 v[38:39], v[38:39], v[56:57] op_sel_hi:[1,0] neg_lo:[0,1] neg_hi:[0,1]
    v_pk_mul_f32 v[38:39], v[38:39], v[56:57] op_sel:[0,1] op_sel_hi:[1,1]
    v_lshlrev_b32 v40, 16, v156
    v_and_b32 v41, 0xffff0000, v156
    v_pk_add_f32 v[40:41], v[40:41], v[58:59] op_sel_hi:[1,0] neg_lo:[0,1] neg_hi:[0,1]
    v_pk_mul_f32 v[40:41], v[40:41], v[58:59] op_sel:[0,1] op_sel_hi:[1,1]
    v_lshlrev_b32 v42, 16, v157
    v_and_b32 v43, 0xffff0000, v157
    v_pk_add_f32 v[42:43], v[42:43], v[58:59] op_sel_hi:[1,0] neg_lo:[0,1] neg_hi:[0,1]
    v_pk_mul_f32 v[42:43], v[42:43], v[58:59] op_sel:[0,1] op_sel_hi:[1,1]
    v_lshlrev_b32 v44, 16, v158
    v_and_b32 v45, 0xffff0000, v158
    v_pk_add_f32 v[44:45], v[44:45], v[58:59] op_sel_hi:[1,0] neg_lo:[0,1] neg_hi:[0,1]
    v_pk_mul_f32 v[44:45], v[44:45], v[58:59] op_sel:[0,1] op_sel_hi:[1,1]
    v_lshlrev_b32 v46, 16, v159
    v_and_b32 v47, 0xffff0000, v159
    v_pk_add_f32 v[46:47], v[46:47], v[58:59] op_sel_hi:[1,0] neg_lo:[0,1] neg_hi:[0,1]
    v_pk_mul_f32 v[46:47], v[46:47], v[58:59] op_sel:[0,1] op_sel_hi:[1,1]
    v_lshlrev_b32 v48, 16, v160
    v_and_b32 v49, 0xffff0000, v160
    v_pk_add_f32 v[48:49], v[48:49], v[58:59] op_sel_hi:[1,0] neg_lo:[0,1] neg_hi:[0,1]
    v_pk_mul_f32 v[48:49], v[48:49], v[58:59] op_sel:[0,1] op_sel_hi:[1,1]
    v_lshlrev_b32 v50, 16, v161
    v_and_b32 v51, 0xffff0000, v161
    v_pk_add_f32 v[50:51], v[50:51], v[58:59] op_sel_hi:[1,0] neg_lo:[0,1] neg_hi:[0,1]
    v_pk_mul_f32 v[50:51], v[50:51], v[58:59] op_sel:[0,1] op_sel_hi:[1,1]
    v_lshlrev_b32 v52, 16, v162
    v_and_b32 v53, 0xffff0000, v162
    v_pk_add_f32 v[52:53], v[52:53], v[58:59] op_sel_hi:[1,0] neg_lo:[0,1] neg_hi:[0,1]
    v_pk_mul_f32 v[52:53], v[52:53], v[58:59] op_sel:[0,1] op_sel_hi:[1,1]
    v_lshlrev_b32 v54, 16, v163
    v_and_b32 v55, 0xffff0000, v163
    v_pk_add_f32 v[54:55], v[54:55], v[58:59] op_sel_hi:[1,0] neg_lo:[0,1] neg_hi:[0,1]
    v_pk_mul_f32 v[54:55], v[54:55], v[58:59] op_sel:[0,1] op_sel_hi:[1,1]
    s_mov_b32 s43, 0
    s_add_u32 s16, s62, 0x80000
    s_addc_u32 s17, s63, 0
    s_mov_b32 s18, 0x7e000
    s_mov_b32 s19, 0x20000
    s_mov_b32 s53, 0
    s_mov_b32 s49, s44
    s_barrier
    ds_read_b64_tr_b16 v[56:57], v13 offset:0
    ds_read_b64_tr_b16 v[58:59], v13 offset:2048
    ds_read_b64_tr_b16 v[60:61], v14 offset:0
    ds_read_b64_tr_b16 v[62:63], v14 offset:2048
    ds_read_b64_tr_b16 v[64:65], v15 offset:0
    ds_read_b64_tr_b16 v[66:67], v15 offset:2048
    ds_read_b64_tr_b16 v[68:69], v16 offset:0
    ds_read_b64_tr_b16 v[70:71], v16 offset:2048
    ds_read_b64_tr_b16 v[72:73], v13 offset:4096
    ds_read_b64_tr_b16 v[74:75], v13 offset:6144
    ds_read_b64_tr_b16 v[76:77], v14 offset:4096
    ds_read_b64_tr_b16 v[78:79], v14 offset:6144
    ds_read_b64_tr_b16 v[80:81], v15 offset:4096
    ds_read_b64_tr_b16 v[82:83], v15 offset:6144
    ds_read_b64_tr_b16 v[84:85], v16 offset:4096
    ds_read_b64_tr_b16 v[86:87], v16 offset:6144
    s_branch dm_23w
dm_23p:
    s_mov_b32 s44, 0
    buffer_load_dwordx4 v[164:167], v126, s[8:11], s44 offen sc1
    buffer_load_dwordx4 v[168:171], v127, s[8:11], s44 offen sc1
    s_add_u32 s44, s44, 16384
    buffer_load_dwordx4 v[172:175], v126, s[8:11], s44 offen sc1
    buffer_load_dwordx4 v[176:179], v127, s[8:11], s44 offen sc1
    s_add_u32 s44, s44, 16384
    buffer_load_dwordx4 v[180:183], v126, s[8:11], s44 offen
    buffer_load_dwordx4 v[184:187], v127, s[8:11], s44 offen
    s_add_u32 s44, s44, 16384
    buffer_load_dwordx4 v[188:191], v126, s[8:11], s44 offen
    buffer_load_dwordx4 v[192:195], v127, s[8:11], s44 offen
    s_add_u32 s44, s44, 16384
dm_23w:
    s_waitcnt vmcnt(4)
    v_or3_b32 v17, v164, v168, v172
    v_bitop3_b32 v17, v17, v176, 1 bitop3:0xa8
    v_cmp_ne_u32 vcc, 0, v17
    s_cbranch_vccz dm_23q
dm_23r:
    s_sleep 2
    s_mov_b32 s44, 0
    buffer_load_dwordx4 v[164:167], v126, s[8:11], s44 offen sc1
    buffer_load_dwordx4 v[168:171], v127, s[8:11], s44 offen sc1
    s_add_u32 s44, s44, 16384
    buffer_load_dwordx4 v[172:175], v126, s[8:11], s44 offen sc1
    buffer_load_dwordx4 v[176:179], v127, s[8:11], s44 offen sc1
    s_add_u32 s44, s44, 16384
    buffer_load_dwordx4 v[180:183], v126, s[8:11], s44 offen sc1
    buffer_load_dwordx4 v[184:187], v127, s[8:11], s44 offen sc1
    s_add_u32 s44, s44, 16384
    buffer_load_dwordx4 v[188:191], v126, s[8:11], s44 offen sc1
    buffer_load_dwordx4 v[192:195], v127, s[8:11], s44 offen sc1
    s_add_u32 s44, s44, 16384
    s_waitcnt vmcnt(4)
    v_or3_b32 v17, v164, v168, v172
    v_bitop3_b32 v17, v17, v176, 1 bitop3:0xa8
    v_cmp_ne_u32 vcc, 0, v17
    s_cbranch_vccz dm_23t
    s_add_u32 s53, s53, 1
    s_cmp_lt_u32 s53, s61
    s_cbranch_scc1 dm_23r
    s_mov_b32 s61, 0
    s_branch dm_23t
dm_23q:
dm_23t:
    buffer_load_dwordx4 v[196:199], v126, s[8:11], s44 offen
    buffer_load_dwordx4 v[200:203], v127, s[8:11], s44 offen
    s_add_u32 s44, s44, 16384
    buffer_load_dwordx4 v[204:207], v126, s[8:11], s44 offen
    buffer_load_dwordx4 v[208:211], v127, s[8:11], s44 offen
    s_add_u32 s44, s44, 16384
    buffer_load_dwordx4 v[212:215], v126, s[8:11], s44 offen
    buffer_load_dwordx4 v[216:219], v127, s[8:11], s44 offen
    s_add_u32 s44, s44, 16384
    s_waitcnt lgkmcnt(0)
dm_23:
    v_mfma_f32_16x16x32_bf16 v[24:27], v[56:59], v[164:167], v[24:27]
    ds_read_b64_tr_b16 v[88:89], v13 offset:8192
    buffer_load_dwordx4 v[220:223], v126, s[8:11], s44 offen
    v_mfma_f32_16x16x32_bf16 v[40:43], v[56:59], v[168:171], v[40:43]
    ds_read_b64_tr_b16 v[90:91], v13 offset:10240
    buffer_load_dwordx4 v[224:227], v127, s[8:11], s44 offen
    v_mfma_f32_16x16x32_bf16 v[44:47], v[60:63], v[168:171], v[44:47]
    ds_read_b64_tr_b16 v[92:93], v14 offset:8192
    s_add_u32 s44, s44, 16384
    v_mfma_f32_16x16x32_bf16 v[28:31], v[60:63], v[164:167], v[28:31]
    ds_read_b64_tr_b16 v[94:95], v14 offset:10240
    v_mov_b32 v126, v128
    v_mfma_f32_16x16x32_bf16 v[32:35], v[64:67], v[164:167], v[32:35]
    ds_read_b64_tr_b16 v[96:97], v15 offset:8192
    v_mov_b32 v127, v129
    v_mfma_f32_16x16x32_bf16 v[48:51], v[64:67], v[168:171], v[48:51]
    ds_read_b64_tr_b16 v[98:99], v15 offset:10240
    v_mov_b32 v128, v130
    v_mfma_f32_16x16x32_bf16 v[52:55], v[68:71], v[168:171], v[52:55]
    ds_read_b64_tr_b16 v[100:101], v16 offset:8192
    v_mov_b32 v129, v131
    v_mfma_f32_16x16x32_bf16 v[36:39], v[68:71], v[164:167], v[36:39]
    ds_read_b64_tr_b16 v[102:103], v16 offset:10240
    s_waitcnt lgkmcnt(8)
    v_mfma_f32_16x16x32_bf16 v[24:27], v[72:75], v[172:175], v[24:27]
    ds_read_b64_tr_b16 v[104:105], v13 offset:12288
    buffer_load_dwordx4 v[164:167], v126, s[8:11], s44 offen
    v_mfma_f32_16x16x32_bf16 v[40:43], v[72:75], v[176:179], v[40:43]
    ds_read_b64_tr_b16 v[106:107], v13 offset:14336
    buffer_load_dwordx4 v[168:171], v127, s[8:11], s44 offen
    v_mfma_f32_16x16x32_bf16 v[44:47], v[76:79], v[176:179], v[44:47]
    ds_read_b64_tr_b16 v[108:109], v14 offset:12288
    s_add_u32 s44, s44, 16384
    s_waitcnt vmcnt(10)
    v_mfma_f32_16x16x32_bf16 v[28:31], v[76:79], v[172:175], v[28:31]
    ds_read_b64_tr_b16 v[110:111], v14 offset:14336
    v_or3_b32 v17, v180, v184, v188
    v_mfma_f32_16x16x32_bf16 v[32:35], v[80:83], v[172:175], v[32:35]
    ds_read_b64_tr_b16 v[112:113], v15 offset:12288
    v_bitop3_b32 v17, v17, v192, 1 bitop3:0xa8
    v_mfma_f32_16x16x32_bf16 v[48:51], v[80:83], v[176:179], v[48:51]
    ds_read_b64_tr_b16 v[114:115], v15 offset:14336
    v_cmp_ne_u32 vcc, 0, v17
    v_mfma_f32_16x16x32_bf16 v[52:55], v[84:87], v[176:179], v[52:55]
    ds_read_b64_tr_b16 v[116:117], v16 offset:12288
    ds_read_b64_tr_b16 v[118:119], v16 offset:14336
    v_mfma_f32_16x16x32_bf16 v[36:39], v[84:87], v[172:175], v[36:39]
    s_waitcnt lgkmcnt(8)
    s_cbranch_vccnz dm_23f0
dm_23g0:
    v_mfma_f32_16x16x32_bf16 v[24:27], v[88:91], v[180:183], v[24:27]
    ds_read_b64_tr_b16 v[56:57], v13 offset:16384
    buffer_load_dwordx4 v[172:175], v126, s[8:11], s44 offen
    v_mfma_f32_16x16x32_bf16 v[40:43], v[88:91], v[184:187], v[40:43]
    ds_read_b64_tr_b16 v[58:59], v13 offset:18432
    buffer_load_dwordx4 v[176:179], v127, s[8:11], s44 offen
    v_mfma_f32_16x16x32_bf16 v[44:47], v[92:95], v[184:187], v[44:47]
    ds_read_b64_tr_b16 v[60:61], v14 offset:16384
    s_add_u32 s44, s44, 16384
    v_mfma_f32_16x16x32_bf16 v[28:31], v[92:95], v[180:183], v[28:31]
    ds_read_b64_tr_b16 v[62:63], v14 offset:18432
    v_mov_b32 v130, v132
    v_mfma_f32_16x16x32_bf16 v[32:35], v[96:99], v[180:183], v[32:35]
    ds_read_b64_tr_b16 v[64:65], v15 offset:16384
    v_mov_b32 v131, v133
    v_mfma_f32_16x16x32_bf16 v[48:51], v[96:99], v[184:187], v[48:51]
    ds_read_b64_tr_b16 v[66:67], v15 offset:18432
    v_mov_b32 v132, 1073741824
    v_mfma_f32_16x16x32_bf16 v[52:55], v[100:103], v[184:187], v[52:55]
    ds_read_b64_tr_b16 v[68:69], v16 offset:16384
    v_mov_b32 v133, 1073741824
    v_mfma_f32_16x16x32_bf16 v[36:39], v[100:103], v[180:183], v[36:39]
    ds_read_b64_tr_b16 v[70:71], v16 offset:18432
    s_waitcnt lgkmcnt(8)
    v_mfma_f32_16x16x32_bf16 v[24:27], v[104:107], v[188:191], v[24:27]
    ds_read_b64_tr_b16 v[72:73], v13 offset:20480
    buffer_load_dwordx4 v[180:183], v126, s[8:11], s44 offen
    v_mfma_f32_16x16x32_bf16 v[40:43], v[104:107], v[192:195], v[40:43]
    ds_read_b64_tr_b16 v[74:75], v13 offset:22528
    buffer_load_dwordx4 v[184:187], v127, s[8:11], s44 offen
    v_mfma_f32_16x16x32_bf16 v[44:47], v[108:111], v[192:195], v[44:47]
    ds_read_b64_tr_b16 v[76:77], v14 offset:20480
    s_add_u32 s44, s44, 16384
    s_waitcnt vmcnt(10)
    v_mfma_f32_16x16x32_bf16 v[28:31], v[108:111], v[188:191], v[28:31]
    ds_read_b64_tr_b16 v[78:79], v14 offset:22528
    v_or3_b32 v17, v196, v200, v204
    v_mfma_f32_16x16x32_bf16 v[32:35], v[112:115], v[188:191], v[32:35]
    ds_read_b64_tr_b16 v[80:81], v15 offset:20480
    v_bitop3_b32 v17, v17, v208, 1 bitop3:0xa8
    v_mfma_f32_16x16x32_bf16 v[48:51], v[112:115], v[192:195], v[48:51]
    ds_read_b64_tr_b16 v[82:83], v15 offset:22528
    v_cmp_ne_u32 vcc, 0, v17
    v_mfma_f32_16x16x32_bf16 v[52:55], v[116:119], v[192:195], v[52:55]
    ds_read_b64_tr_b16 v[84:85], v16 offset:20480
    ds_read_b64_tr_b16 v[86:87], v16 offset:22528
    v_mfma_f32_16x16x32_bf16 v[36:39], v[116:119], v[188:191], v[36:39]
    s_waitcnt lgkmcnt(8)
    s_cbranch_vccnz dm_23f1
dm_23g1:
    v_mfma_f32_16x16x32_bf16 v[24:27], v[56:59], v[196:199], v[24:27]
    ds_read_b64_tr_b16 v[88:89], v13 offset:24576
    buffer_load_dwordx4 v[188:191], v126, s[8:11], s44 offen
    v_mfma_f32_16x16x32_bf16 v[40:43], v[56:59], v[200:203], v[40:43]
    ds_read_b64_tr_b16 v[90:91], v13 offset:26624
    buffer_load_dwordx4 v[192:195], v127, s[8:11], s44 offen
    v_mfma_f32_16x16x32_bf16 v[44:47], v[60:63], v[200:203], v[44:47]
    ds_read_b64_tr_b16 v[92:93], v14 offset:24576
    s_add_u32 s44, s44, 16384
    v_mfma_f32_16x16x32_bf16 v[28:31], v[60:63], v[196:199], v[28:31]
    ds_read_b64_tr_b16 v[94:95], v14 offset:26624
    v_mfma_f32_16x16x32_bf16 v[32:35], v[64:67], v[196:199], v[32:35]
    ds_read_b64_tr_b16 v[96:97], v15 offset:24576
    s_add_u32 s43, s43, 1
    v_mfma_f32_16x16x32_bf16 v[48:51], v[64:67], v[200:203], v[48:51]
    ds_read_b64_tr_b16 v[98:99], v15 offset:26624
    v_mfma_f32_16x16x32_bf16 v[52:55], v[68:71], v[200:203], v[52:55]
    ds_read_b64_tr_b16 v[100:101], v16 offset:24576
    v_mfma_f32_16x16x32_bf16 v[36:39], v[68:71], v[196:199], v[36:39]
    ds_read_b64_tr_b16 v[102:103], v16 offset:26624
    s_waitcnt lgkmcnt(8)
    v_mfma_f32_16x16x32_bf16 v[24:27], v[72:75], v[204:207], v[24:27]
    ds_read_b64_tr_b16 v[104:105], v13 offset:28672
    buffer_load_dwordx4 v[196:199], v126, s[8:11], s44 offen
    v_mfma_f32_16x16x32_bf16 v[40:43], v[72:75], v[208:211], v[40:43]
    ds_read_b64_tr_b16 v[106:107], v13 offset:30720
    buffer_load_dwordx4 v[200:203], v127, s[8:11], s44 offen
    v_mfma_f32_16x16x32_bf16 v[44:47], v[76:79], v[208:211], v[44:47]
    ds_read_b64_tr_b16 v[108:109], v14 offset:28672
    s_add_u32 s44, s44, 16384
    s_waitcnt vmcnt(10)
    v_mfma_f32_16x16x32_bf16 v[28:31], v[76:79], v[204:207], v[28:31]
    ds_read_b64_tr_b16 v[110:111], v14 offset:30720
    v_add_u32 v13, 32768, v13
    v_or3_b32 v17, v212, v216, v220
    v_mfma_f32_16x16x32_bf16 v[32:35], v[80:83], v[204:207], v[32:35]
    ds_read_b64_tr_b16 v[112:113], v15 offset:28672
    v_add_u32 v14, 32768, v14
    v_bitop3_b32 v17, v17, v224, 1 bitop3:0xa8
    v_mfma_f32_16x16x32_bf16 v[48:51], v[80:83], v[208:211], v[48:51]
    ds_read_b64_tr_b16 v[114:115], v15 offset:30720
    v_add_u32 v15, 32768, v15
    v_cmp_ne_u32 vcc, 0, v17
    v_mfma_f32_16x16x32_bf16 v[52:55], v[84:87], v[208:211], v[52:55]
    ds_read_b64_tr_b16 v[116:117], v16 offset:28672
    ds_read_b64_tr_b16 v[118:119], v16 offset:30720
    s_cmp_eq_u32 s43, 4
    v_mfma_f32_16x16x32_bf16 v[36:39], v[84:87], v[204:207], v[36:39]
    v_add_u32 v16, 32768, v16
    s_waitcnt lgkmcnt(8)
    s_cbranch_vccnz dm_23f2
dm_23g2:
    s_cbranch_scc1 dm_23x
    v_mfma_f32_16x16x32_bf16 v[24:27], v[88:91], v[212:215], v[24:27]
    ds_read_b64_tr_b16 v[56:57], v13 offset:0
    buffer_load_dwordx4 v[204:207], v126, s[8:11], s44 offen
    v_mfma_f32_16x16x32_bf16 v[40:43], v[88:91], v[216:219], v[40:43]
    ds_read_b64_tr_b16 v[58:59], v13 offset:2048
    buffer_load_dwordx4 v[208:211], v127, s[8:11], s44 offen
    v_mfma_f32_16x16x32_bf16 v[44:47], v[92:95], v[216:219], v[44:47]
    ds_read_b64_tr_b16 v[60:61], v14 offset:0
    s_add_u32 s44, s44, 16384
    v_mfma_f32_16x16x32_bf16 v[28:31], v[92:95], v[212:215], v[28:31]
    ds_read_b64_tr_b16 v[62:63], v14 offset:2048
    v_mov_b32 v134, v126
    v_mfma_f32_16x16x32_bf16 v[32:35], v[96:99], v[212:215], v[32:35]
    ds_read_b64_tr_b16 v[64:65], v15 offset:0
    v_mov_b32 v135, v127
    v_mfma_f32_16x16x32_bf16 v[48:51], v[96:99], v[216:219], v[48:51]
    ds_read_b64_tr_b16 v[66:67], v15 offset:2048
    v_mfma_f32_16x16x32_bf16 v[52:55], v[100:103], v[216:219], v[52:55]
    ds_read_b64_tr_b16 v[68:69], v16 offset:0
    v_mfma_f32_16x16x32_bf16 v[36:39], v[100:103], v[212:215], v[36:39]
    ds_read_b64_tr_b16 v[70:71], v16 offset:2048
    s_waitcnt lgkmcnt(8)
    v_mfma_f32_16x16x32_bf16 v[24:27], v[104:107], v[220:223], v[24:27]
    ds_read_b64_tr_b16 v[72:73], v13 offset:4096
    buffer_load_dwordx4 v[212:215], v126, s[8:11], s44 offen
    v_mfma_f32_16x16x32_bf16 v[40:43], v[104:107], v[224:227], v[40:43]
    ds_read_b64_tr_b16 v[74:75], v13 offset:6144
    buffer_load_dwordx4 v[216:219], v127, s[8:11], s44 offen
    v_mfma_f32_16x16x32_bf16 v[44:47], v[108:111], v[224:227], v[44:47]
    ds_read_b64_tr_b16 v[76:77], v14 offset:4096
    s_add_u32 s44, s44, 16384
    s_waitcnt vmcnt(10)
    v_mfma_f32_16x16x32_bf16 v[28:31], v[108:111], v[220:223], v[28:31]
    ds_read_b64_tr_b16 v[78:79], v14 offset:6144
    v_or3_b32 v17, v164, v168, v172
    v_mfma_f32_16x16x32_bf16 v[32:35], v[112:115], v[220:223], v[32:35]
    ds_read_b64_tr_b16 v[80:81], v15 offset:4096
    v_bitop3_b32 v17, v17, v176, 1 bitop3:0xa8
    v_mfma_f32_16x16x32_bf16 v[48:51], v[112:115], v[224:227], v[48:51]
    ds_read_b64_tr_b16 v[82:83], v15 offset:6144
    v_cmp_ne_u32 vcc, 0, v17
    v_mfma_f32_16x16x32_bf16 v[52:55], v[116:119], v[224:227], v[52:55]
    ds_read_b64_tr_b16 v[84:85], v16 offset:4096
    ds_read_b64_tr_b16 v[86:87], v16 offset:6144
    v_mfma_f32_16x16x32_bf16 v[36:39], v[116:119], v[220:223], v[36:39]
    s_waitcnt lgkmcnt(8)
    s_cbranch_vccnz dm_23f3
dm_23g3:
    s_branch dm_23
dm_23f0:
    s_cselect_b32 s50, 1, 0
dm_23h0:
    s_sleep 2
    s_sub_u32 s44, s44, 114688
    buffer_load_dwordx4 v[180:183], v134, s[8:11], s44 offen sc1
    buffer_load_dwordx4 v[184:187], v135, s[8:11], s44 offen sc1
    s_add_u32 s44, s44, 16384
    buffer_load_dwordx4 v[188:191], v134, s[8:11], s44 offen sc1
    buffer_load_dwordx4 v[192:195], v135, s[8:11], s44 offen sc1
    s_add_u32 s44, s44, 16384
    buffer_load_dwordx4 v[196:199], v134, s[8:11], s44 offen sc1
    buffer_load_dwordx4 v[200:203], v135, s[8:11], s44 offen sc1
    s_add_u32 s44, s44, 16384
    buffer_load_dwordx4 v[204:207], v134, s[8:11], s44 offen sc1
    buffer_load_dwordx4 v[208:211], v135, s[8:11], s44 offen sc1
    s_add_u32 s44, s44, 16384
    buffer_load_dwordx4 v[212:215], v134, s[8:11], s44 offen sc1
    buffer_load_dwordx4 v[216:219], v135, s[8:11], s44 offen sc1
    s_add_u32 s44, s44, 16384
    buffer_load_dwordx4 v[220:223], v134, s[8:11], s44 offen sc1
    buffer_load_dwordx4 v[224:227], v135, s[8:11], s44 offen sc1
    s_add_u32 s44, s44, 16384
    buffer_load_dwordx4 v[164:167], v126, s[8:11], s44 offen sc1
    buffer_load_dwordx4 v[168:171], v127, s[8:11], s44 offen sc1
    s_add_u32 s44, s44, 16384
    s_waitcnt vmcnt(10)
    v_or3_b32 v17, v180, v184, v188
    v_bitop3_b32 v17, v17, v192, 1 bitop3:0xa8
    v_cmp_ne_u32 vcc, 0, v17
    s_add_u32 s53, s53, 1
    s_cmp_ge_u32 s53, s61
    s_cselect_b32 s61, 0, s61
    s_cbranch_scc1 dm_23k0
    s_cbranch_vccnz dm_23h0
dm_23k0:
    s_cmp_eq_u32 s50, 1
    s_branch dm_23g0
dm_23f1:
    s_cselect_b32 s50, 1, 0
dm_23h1:
    s_sleep 2
    s_sub_u32 s44, s44, 114688
    buffer_load_dwordx4 v[196:199], v134, s[8:11], s44 offen sc1
    buffer_load_dwordx4 v[200:203], v135, s[8:11], s44 offen sc1
    s_add_u32 s44, s44, 16384
    buffer_load_dwordx4 v[204:207], v134, s[8:11], s44 offen sc1
    buffer_load_dwordx4 v[208:211], v135, s[8:11], s44 offen sc1
    s_add_u32 s44, s44, 16384
    buffer_load_dwordx4 v[212:215], v134, s[8:11], s44 offen sc1
    buffer_load_dwordx4 v[216:219], v135, s[8:11], s44 offen sc1
    s_add_u32 s44, s44, 16384
    buffer_load_dwordx4 v[220:223], v134, s[8:11], s44 offen sc1
    buffer_load_dwordx4 v[224:227], v135, s[8:11], s44 offen sc1
    s_add_u32 s44, s44, 16384
    buffer_load_dwordx4 v[164:167], v126, s[8:11], s44 offen sc1
    buffer_load_dwordx4 v[168:171], v127, s[8:11], s44 offen sc1
    s_add_u32 s44, s44, 16384
    buffer_load_dwordx4 v[172:175], v126, s[8:11], s44 offen sc1
    buffer_load_dwordx4 v[176:179], v127, s[8:11], s44 offen sc1
    s_add_u32 s44, s44, 16384
    buffer_load_dwordx4 v[180:183], v126, s[8:11], s44 offen sc1
    buffer_load_dwordx4 v[184:187], v127, s[8:11], s44 offen sc1
    s_add_u32 s44, s44, 16384
    s_waitcnt vmcnt(10)
    v_or3_b32 v17, v196, v200, v204
    v_bitop3_b32 v17, v17, v208, 1 bitop3:0xa8
    v_cmp_ne_u32 vcc, 0, v17
    s_add_u32 s53, s53, 1
    s_cmp_ge_u32 s53, s61
    s_cselect_b32 s61, 0, s61
    s_cbranch_scc1 dm_23k1
    s_cbranch_vccnz dm_23h1
dm_23k1:
    s_cmp_eq_u32 s50, 1
    s_branch dm_23g1
dm_23f2:
    s_cselect_b32 s50, 1, 0
dm_23h2:
    s_sleep 2
    s_sub_u32 s44, s44, 114688
    buffer_load_dwordx4 v[212:215], v134, s[8:11], s44 offen sc1
    buffer_load_dwordx4 v[216:219], v135, s[8:11], s44 offen sc1
    s_add_u32 s44, s44, 16384
    buffer_load_dwordx4 v[220:223], v134, s[8:11], s44 offen sc1
    buffer_load_dwordx4 v[224:227], v135, s[8:11], s44 offen sc1
    s_add_u32 s44, s44, 16384
    buffer_load_dwordx4 v[164:167], v126, s[8:11], s44 offen sc1
    buffer_load_dwordx4 v[168:171], v127, s[8:11], s44 offen sc1
    s_add_u32 s44, s44, 16384
    buffer_load_dwordx4 v[172:175], v126, s[8:11], s44 offen sc1
    buffer_load_dwordx4 v[176:179], v127, s[8:11], s44 offen sc1
    s_add_u32 s44, s44, 16384
    buffer_load_dwordx4 v[180:183], v126, s[8:11], s44 offen sc1
    buffer_load_dwordx4 v[184:187], v127, s[8:11], s44 offen sc1
    s_add_u32 s44, s44, 16384
    buffer_load_dwordx4 v[188:191], v126, s[8:11], s44 offen sc1
    buffer_load_dwordx4 v[192:195], v127, s[8:11], s44 offen sc1
    s_add_u32 s44, s44, 16384
    buffer_load_dwordx4 v[196:199], v126, s[8:11], s44 offen sc1
    buffer_load_dwordx4 v[200:203], v127, s[8:11], s44 offen sc1
    s_add_u32 s44, s44, 16384
    s_waitcnt vmcnt(10)
    v_or3_b32 v17, v212, v216, v220
    v_bitop3_b32 v17, v17, v224, 1 bitop3:0xa8
    v_cmp_ne_u32 vcc, 0, v17
    s_add_u32 s53, s53, 1
    s_cmp_ge_u32 s53, s61
    s_cselect_b32 s61, 0, s61
    s_cbranch_scc1 dm_23k2
    s_cbranch_vccnz dm_23h2
dm_23k2:
    s_cmp_eq_u32 s50, 1
    s_branch dm_23g2
dm_23f3:
    s_cselect_b32 s50, 1, 0
dm_23h3:
    s_sleep 2
    s_sub_u32 s44, s44, 114688
    buffer_load_dwordx4 v[164:167], v134, s[8:11], s44 offen sc1
    buffer_load_dwordx4 v[168:171], v135, s[8:11], s44 offen sc1
    s_add_u32 s44, s44, 16384
    buffer_load_dwordx4 v[172:175], v134, s[8:11], s44 offen sc1
    buffer_load_dwordx4 v[176:179], v135, s[8:11], s44 offen sc1
    s_add_u32 s44, s44, 16384
    buffer_load_dwordx4 v[180:183], v134, s[8:11], s44 offen sc1
    buffer_load_dwordx4 v[184:187], v135, s[8:11], s44 offen sc1
    s_add_u32 s44, s44, 16384
    buffer_load_dwordx4 v[188:191], v134, s[8:11], s44 offen sc1
    buffer_load_dwordx4 v[192:195], v135, s[8:11], s44 offen sc1
    s_add_u32 s44, s44, 16384
    buffer_load_dwordx4 v[196:199], v134, s[8:11], s44 offen sc1
    buffer_load_dwordx4 v[200:203], v135, s[8:11], s44 offen sc1
    s_add_u32 s44, s44, 16384
    buffer_load_dwordx4 v[204:207], v134, s[8:11], s44 offen sc1
    buffer_load_dwordx4 v[208:211], v135, s[8:11], s44 offen sc1
    s_add_u32 s44, s44, 16384
    buffer_load_dwordx4 v[212:215], v134, s[8:11], s44 offen sc1
    buffer_load_dwordx4 v[216:219], v135, s[8:11], s44 offen sc1
    s_add_u32 s44, s44, 16384
    s_waitcnt vmcnt(10)
    v_or3_b32 v17, v164, v168, v172
    v_bitop3_b32 v17, v17, v176, 1 bitop3:0xa8
    v_cmp_ne_u32 vcc, 0, v17
    s_add_u32 s53, s53, 1
    s_cmp_ge_u32 s53, s61
    s_cselect_b32 s61, 0, s61
    s_cbranch_scc1 dm_23k3
    s_cbranch_vccnz dm_23h3
dm_23k3:
    s_cmp_eq_u32 s50, 1
    s_branch dm_23g3
dm_23x:
    v_mfma_f32_16x16x32_bf16 v[24:27], v[88:91], v[212:215], v[24:27]
    v_mfma_f32_16x16x32_bf16 v[40:43], v[88:91], v[216:219], v[40:43]
    v_mfma_f32_16x16x32_bf16 v[44:47], v[92:95], v[216:219], v[44:47]
    v_mfma_f32_16x16x32_bf16 v[28:31], v[92:95], v[212:215], v[28:31]
    v_mfma_f32_16x16x32_bf16 v[32:35], v[96:99], v[212:215], v[32:35]
    v_mfma_f32_16x16x32_bf16 v[48:51], v[96:99], v[216:219], v[48:51]
    v_mfma_f32_16x16x32_bf16 v[52:55], v[100:103], v[216:219], v[52:55]
    v_mfma_f32_16x16x32_bf16 v[36:39], v[100:103], v[212:215], v[36:39]
    s_waitcnt lgkmcnt(0)
    v_mfma_f32_16x16x32_bf16 v[24:27], v[104:107], v[220:223], v[24:27]
    s_add_u32 s44, s62, 0x5c8000
    v_mfma_f32_16x16x32_bf16 v[40:43], v[104:107], v[224:227], v[40:43]
    s_addc_u32 s45, s63, 0
    v_mfma_f32_16x16x32_bf16 v[44:47], v[108:111], v[224:227], v[44:47]
    v_mfma_f32_16x16x32_bf16 v[28:31], v[108:111], v[220:223], v[28:31]
    s_mov_b32 s46, 0x6000
    v_mfma_f32_16x16x32_bf16 v[32:35], v[112:115], v[220:223], v[32:35]
    v_mfma_f32_16x16x32_bf16 v[48:51], v[112:115], v[224:227], v[48:51]
    s_mov_b32 s47, 0x20000
    v_mfma_f32_16x16x32_bf16 v[52:55], v[116:119], v[224:227], v[52:55]
    v_mfma_f32_16x16x32_bf16 v[36:39], v[116:119], v[220:223], v[36:39]
    s_add_u32 s36, s39, 0
    v_cvt_pk_bf16_f32 v148, v24, v25
    v_cvt_pk_bf16_f32 v149, v26, v27
    v_cvt_pk_bf16_f32 v150, v28, v29
    v_cvt_pk_bf16_f32 v151, v30, v31
    v_and_b32 v148, -2, v148
    buffer_store_dwordx4 v[148:151], v2, s[16:19], s36 offen offset:0 sc1
    v_cvt_pk_bf16_f32 v152, v32, v33
    v_cvt_pk_bf16_f32 v153, v34, v35
    v_cvt_pk_bf16_f32 v154, v36, v37
    v_cvt_pk_bf16_f32 v155, v38, v39
    v_and_b32 v152, -2, v152
    buffer_store_dwordx4 v[152:155], v2, s[16:19], s36 offen offset:1024 sc1
    s_add_u32 s36, s39, 65536
    v_cvt_pk_bf16_f32 v156, v40, v41
    v_cvt_pk_bf16_f32 v157, v42, v43
    v_cvt_pk_bf16_f32 v158, v44, v45
    v_cvt_pk_bf16_f32 v159, v46, v47
    v_and_b32 v156, -2, v156
    buffer_store_dwordx4 v[156:159], v2, s[16:19], s36 offen offset:0 sc1
    v_cvt_pk_bf16_f32 v160, v48, v49
    v_cvt_pk_bf16_f32 v161, v50, v51
    v_cvt_pk_bf16_f32 v162, v52, v53
    v_cvt_pk_bf16_f32 v163, v54, v55
    v_and_b32 v160, -2, v160
    buffer_store_dwordx4 v[160:163], v2, s[16:19], s36 offen offset:1024 sc1
    s_barrier
    s_lshl_b32 s36, s37, 11
    v_add_u32 v7, s36, v2
    ds_write_b128 v7, v[148:151] offset:0
    ds_write_b128 v7, v[152:155] offset:1024
    ds_write_b128 v7, v[156:159] offset:2048
    ds_write_b128 v7, v[160:163] offset:3072
    v_lshlrev_b32 v24, 16, v148
    v_and_b32 v25, 0xffff0000, v148
    v_lshlrev_b32 v26, 16, v149
    v_and_b32 v27, 0xffff0000, v149
    v_lshlrev_b32 v28, 16, v150
    v_and_b32 v29, 0xffff0000, v150
    v_lshlrev_b32 v30, 16, v151
    v_and_b32 v31, 0xffff0000, v151
    v_lshlrev_b32 v32, 16, v152
    v_and_b32 v33, 0xffff0000, v152
    v_lshlrev_b32 v34, 16, v153
    v_and_b32 v35, 0xffff0000, v153
    v_lshlrev_b32 v36, 16, v154
    v_and_b32 v37, 0xffff0000, v154
    v_lshlrev_b32 v38, 16, v155
    v_and_b32 v39, 0xffff0000, v155
    v_lshlrev_b32 v40, 16, v156
    v_and_b32 v41, 0xffff0000, v156
    v_lshlrev_b32 v42, 16, v157
    v_and_b32 v43, 0xffff0000, v157
    v_lshlrev_b32 v44, 16, v158
    v_and_b32 v45, 0xffff0000, v158
    v_lshlrev_b32 v46, 16, v159
    v_and_b32 v47, 0xffff0000, v159
    v_lshlrev_b32 v48, 16, v160
    v_and_b32 v49, 0xffff0000, v160
    v_lshlrev_b32 v50, 16, v161
    v_and_b32 v51, 0xffff0000, v161
    v_lshlrev_b32 v52, 16, v162
    v_and_b32 v53, 0xffff0000, v162
    v_lshlrev_b32 v54, 16, v163
    v_and_b32 v55, 0xffff0000, v163
    s_add_u32 s53, s55, 512
    v_mov_b32 v8, 1
    v_mov_b32 v9, 162816
    v_mov_b32 v11, 0
    s_mov_b64 exec, 1
    s_waitcnt vmcnt(0)
    ds_add_rtn_u32 v10, v9, v8
    s_waitcnt lgkmcnt(0)
    v_readfirstlane_b32 s54, v10
    s_nop 0
    s_and_b32 s54, s54, 3
    s_cmp_lg_u32 s54, 3
    s_cbranch_scc1 pub_24
    buffer_atomic_add v8, v11, s[56:59], s53 offen sc1
    v_mov_b32 v9, 162872
    ds_add_u32 v9, v8
pub_24:
    s_mov_b64 exec, -1
    s_waitcnt lgkmcnt(0)
    s_barrier
    v_pk_add_f32 v[142:143], v[24:25], v[26:27]
    v_pk_mul_f32 v[136:137], v[24:25], v[24:25]
    v_pk_fma_f32 v[136:137], v[26:27], v[26:27], v[136:137]
    v_pk_add_f32 v[142:143], v[142:143], v[28:29]
    v_pk_fma_f32 v[136:137], v[28:29], v[28:29], v[136:137]
    v_pk_add_f32 v[142:143], v[142:143], v[30:31]
    v_pk_fma_f32 v[136:137], v[30:31], v[30:31], v[136:137]
    v_pk_add_f32 v[142:143], v[142:143], v[32:33]
    v_pk_fma_f32 v[136:137], v[32:33], v[32:33], v[136:137]
    v_pk_add_f32 v[142:143], v[142:143], v[34:35]
    v_pk_fma_f32 v[136:137], v[34:35], v[34:35], v[136:137]
    v_pk_add_f32 v[142:143], v[142:143], v[36:37]
    v_pk_fma_f32 v[136:137], v[36:37], v[36:37], v[136:137]
    v_pk_add_f32 v[142:143], v[142:143], v[38:39]
    v_pk_fma_f32 v[136:137], v[38:39], v[38:39], v[136:137]
    v_add_f32 v138, v142, v143
    v_add_f32 v139, v136, v137
    v_mov_b32 v142, v138
    v_mov_b32 v143, v139
    s_nop 0
    v_permlane16_swap_b32 v138, v142
    v_permlane16_swap_b32 v139, v143
    v_pk_add_f32 v[138:139], v[138:139], v[142:143]
    v_mov_b32 v142, v138
    v_mov_b32 v143, v139
    s_nop 0
    v_permlane32_swap_b32 v138, v142
    v_permlane32_swap_b32 v139, v143
    v_pk_add_f32 v[138:139], v[138:139], v[142:143]
    v_pk_add_f32 v[142:143], v[40:41], v[42:43]
    v_pk_mul_f32 v[136:137], v[40:41], v[40:41]
    v_pk_fma_f32 v[136:137], v[42:43], v[42:43], v[136:137]
    v_pk_add_f32 v[142:143], v[142:143], v[44:45]
    v_pk_fma_f32 v[136:137], v[44:45], v[44:45], v[136:137]
    v_pk_add_f32 v[142:143], v[142:143], v[46:47]
    v_pk_fma_f32 v[136:137], v[46:47], v[46:47], v[136:137]
    v_pk_add_f32 v[142:143], v[142:143], v[48:49]
    v_pk_fma_f32 v[136:137], v[48:49], v[48:49], v[136:137]
    v_pk_add_f32 v[142:143], v[142:143], v[50:51]
    v_pk_fma_f32 v[136:137], v[50:51], v[50:51], v[136:137]
    v_pk_add_f32 v[142:143], v[142:143], v[52:53]
    v_pk_fma_f32 v[136:137], v[52:53], v[52:53], v[136:137]
    v_pk_add_f32 v[142:143], v[142:143], v[54:55]
    v_pk_fma_f32 v[136:137], v[54:55], v[54:55], v[136:137]
    v_add_f32 v140, v142, v143
    v_add_f32 v141, v136, v137
    v_mov_b32 v142, v140
    v_mov_b32 v143, v141
    s_nop 0
    v_permlane16_swap_b32 v140, v142
    v_permlane16_swap_b32 v141, v143
    v_pk_add_f32 v[140:141], v[140:141], v[142:143]
    v_mov_b32 v142, v140
    v_mov_b32 v143, v141
    s_nop 0
    v_permlane32_swap_b32 v140, v142
    v_permlane32_swap_b32 v141, v143
    v_pk_add_f32 v[140:141], v[140:141], v[142:143]
    v_cmp_eq_u32 vcc, 0, v23
    s_nop 1
    v_cndmask_b32 v138, v140, v138, vcc
    v_cndmask_b32 v139, v141, v139, vcc
    s_lshr_b32 s53, s29, 3
    s_lshl_b32 s53, s53, 14
    s_and_b32 s40, s29, 7
    s_lshl_b32 s40, s40, 10
    s_add_u32 s40, s40, s53
    s_lshl_b32 s36, s34, 8
    s_add_u32 s40, s40, s36
    v_lshlrev_b32 v7, 3, v1
    s_bfm_b64 exec, 32, 0
    buffer_store_dwordx2 v[138:139], v7, s[44:47], s40 offen sc1
    s_mov_b64 exec, -1
    s_lshr_b32 s34, s30, 1
    s_and_b32 s35, s30, 1
    v_and_b32 v22, 15, v1
    v_lshrrev_b32 v23, 4, v1
    s_mul_i32 s37, s34, 4
    s_mul_i32 s38, s29, 14
    s_mul_i32 s36, s35, 7
    s_add_u32 s38, s38, s36
    s_mul_i32 s36, s34, 8192
    v_add_u32 v12, s36, v2
    v_lshrrev_b32 v6, 2, v1
    v_mul_u32_u24 v13, 448, v6
    v_and_b32 v7, 3, v1
    v_lshl_add_u32 v13, v7, 3, v13
    v_add_u32 v13, 73728, v13
    s_mul_i32 s36, s35, 224
    v_add_u32 v13, s36, v13
    v_bfe_u32 v6, v1, 4, 1
    v_lshlrev_b32 v6, 5, v6
    s_cmp_eq_u32 s35, 0
    s_cselect_b32 s36, 1, -1
    v_mul_lo_u32 v6, v6, s36
    v_sub_u32 v14, v13, v6
    v_add_u32 v13, v13, v6
    v_mov_b32 v17, v12
    s_mov_b32 s42, 0
    s_mov_b32 s43, 0
    s_mov_b32 s48, 57344
    v_add_u32 v18, 57344, v13
    v_add_u32 v19, 57344, v14
    ds_read_b128 v[136:139], v17 offset:0
    ds_read_b128 v[140:143], v17 offset:2048
    ds_read_b128 v[144:147], v17 offset:4096
    ds_read_b128 v[148:151], v17 offset:6144
    ds_read_b64_tr_b16 v[152:153], v18 offset:0
    ds_read_b64_tr_b16 v[154:155], v18 offset:7168
    ds_read_b64_tr_b16 v[156:157], v19 offset:32
    ds_read_b64_tr_b16 v[158:159], v19 offset:7200
    ds_read_b64_tr_b16 v[160:161], v18 offset:64
    ds_read_b64_tr_b16 v[162:163], v18 offset:7232
    ds_read_b64_tr_b16 v[164:165], v19 offset:96
    ds_read_b64_tr_b16 v[166:167], v19 offset:7264
    ds_read_b64_tr_b16 v[168:169], v18 offset:128
    ds_read_b64_tr_b16 v[170:171], v18 offset:7296
    ds_read_b64_tr_b16 v[172:173], v19 offset:160
    ds_read_b64_tr_b16 v[174:175], v19 offset:7328
    ds_read_b64_tr_b16 v[176:177], v18 offset:192
    ds_read_b64_tr_b16 v[178:179], v18 offset:7360
    s_waitcnt lgkmcnt(12)
    v_mfma_f32_16x16x32_bf16 v[24:27], v[152:155], v[136:139], 0
    ds_read_b128 v[180:183], v17 offset:1024
    s_add_u32 s42, s42, 16384
    v_mfma_f32_16x16x32_bf16 v[52:55], v[152:155], v[140:143], 0
    ds_read_b128 v[184:187], v17 offset:3072
    s_cmp_eq_u32 s42, 49152
    v_mfma_f32_16x16x32_bf16 v[80:83], v[152:155], v[144:147], 0
    ds_read_b128 v[188:191], v17 offset:5120
    s_cselect_b32 s42, 0, s42
    v_mfma_f32_16x16x32_bf16 v[108:111], v[152:155], v[148:151], 0
    ds_read_b128 v[192:195], v17 offset:7168
    s_waitcnt lgkmcnt(14)
    v_mfma_f32_16x16x32_bf16 v[112:115], v[156:159], v[148:151], 0
    ds_read_b64_tr_b16 v[196:197], v18 offset:14336
    s_add_u32 s48, s48, 28672
    v_mfma_f32_16x16x32_bf16 v[84:87], v[156:159], v[144:147], 0
    ds_read_b64_tr_b16 v[198:199], v18 offset:21504
    s_cmp_eq_u32 s48, 86016
    v_mfma_f32_16x16x32_bf16 v[56:59], v[156:159], v[140:143], 0
    ds_read_b64_tr_b16 v[200:201], v19 offset:14368
    s_cselect_b32 s48, 0, s48
    v_mfma_f32_16x16x32_bf16 v[28:31], v[156:159], v[136:139], 0
    ds_read_b64_tr_b16 v[202:203], v19 offset:21536
    s_waitcnt lgkmcnt(8)
    v_mfma_f32_16x16x32_bf16 v[32:35], v[160:163], v[136:139], 0
    ds_read_b64_tr_b16 v[204:205], v18 offset:14400
    v_add_u32 v17, s42, v12
    v_mfma_f32_16x16x32_bf16 v[60:63], v[160:163], v[140:143], 0
    ds_read_b64_tr_b16 v[206:207], v18 offset:21568
    v_mfma_f32_16x16x32_bf16 v[88:91], v[160:163], v[144:147], 0
    ds_read_b64_tr_b16 v[208:209], v19 offset:14432
    v_mfma_f32_16x16x32_bf16 v[116:119], v[160:163], v[148:151], 0
    ds_read_b64_tr_b16 v[210:211], v19 offset:21600
    v_mfma_f32_16x16x32_bf16 v[120:123], v[164:167], v[148:151], 0
    ds_read_b64_tr_b16 v[212:213], v18 offset:14464
    v_mfma_f32_16x16x32_bf16 v[92:95], v[164:167], v[144:147], 0
    ds_read_b64_tr_b16 v[214:215], v18 offset:21632
    v_mfma_f32_16x16x32_bf16 v[64:67], v[164:167], v[140:143], 0
    ds_read_b64_tr_b16 v[216:217], v19 offset:14496
    v_mfma_f32_16x16x32_bf16 v[36:39], v[164:167], v[136:139], 0
    ds_read_b64_tr_b16 v[218:219], v19 offset:21664
    v_add_u32 v19, s48, v14
    v_mfma_f32_16x16x32_bf16 v[40:43], v[168:171], v[136:139], 0
    ds_read_b64_tr_b16 v[220:221], v18 offset:14528
    v_mfma_f32_16x16x32_bf16 v[68:71], v[168:171], v[140:143], 0
    ds_read_b64_tr_b16 v[222:223], v18 offset:21696
    v_add_u32 v18, s48, v13
    v_mfma_f32_16x16x32_bf16 v[96:99], v[168:171], v[144:147], 0
    v_mfma_f32_16x16x32_bf16 v[124:127], v[168:171], v[148:151], 0
    v_mfma_f32_16x16x32_bf16 v[128:131], v[172:175], v[148:151], 0
    v_mfma_f32_16x16x32_bf16 v[100:103], v[172:175], v[144:147], 0
    v_mfma_f32_16x16x32_bf16 v[72:75], v[172:175], v[140:143], 0
    v_mfma_f32_16x16x32_bf16 v[44:47], v[172:175], v[136:139], 0
    v_mfma_f32_16x16x32_bf16 v[48:51], v[176:179], v[136:139], 0
    v_mfma_f32_16x16x32_bf16 v[76:79], v[176:179], v[140:143], 0
    v_mfma_f32_16x16x32_bf16 v[104:107], v[176:179], v[144:147], 0
    v_mfma_f32_16x16x32_bf16 v[132:135], v[176:179], v[148:151], 0
    s_waitcnt lgkmcnt(12)
    v_mfma_f32_16x16x32_bf16 v[24:27], v[196:199], v[180:183], v[24:27]
    s_add_u32 s43, s43, 1
    s_mul_i32 s36, s35, 448
    s_add_u32 s36, s36, 159744
    v_lshlrev_b32 v6, 4, v23
    v_mfma_f32_16x16x32_bf16 v[52:55], v[196:199], v[184:187], v[52:55]
    v_add_u32 v6, s36, v6
    s_lshl_b32 s36, s37, 8
    s_add_u32 s36, s36, 160768
    v_lshlrev_b32 v7, 4, v22
    v_mfma_f32_16x16x32_bf16 v[80:83], v[196:199], v[188:191], v[80:83]
    v_add_u32 v7, s36, v7
    s_add_u32 s16, s62, 0x400000
    s_addc_u32 s17, s63, 0
    s_mov_b32 s18, 0x1be000
    v_mfma_f32_16x16x32_bf16 v[108:111], v[196:199], v[192:195], v[108:111]
    s_mov_b32 s19, 0x20000
    s_mul_i32 s39, s37, 229376
    s_lshr_b32 s36, s38, 1
    s_waitcnt lgkmcnt(0)
    v_mfma_f32_16x16x32_bf16 v[112:115], v[200:203], v[192:195], v[112:115]
    s_add_u32 s36, s36, 0
    s_lshr_b32 s53, s36, 3
    s_lshl_b32 s53, s53, 14
    s_and_b32 s44, s36, 7
    v_mfma_f32_16x16x32_bf16 v[84:87], v[200:203], v[188:191], v[84:87]
    s_lshl_b32 s44, s44, 10
    s_add_u32 s44, s44, s53
    s_add_u32 s44, s44, s39
    s_lshr_b32 s36, s38, 1
    v_mfma_f32_16x16x32_bf16 v[56:59], v[200:203], v[184:187], v[56:59]
    s_add_u32 s36, s36, 1
    s_lshr_b32 s53, s36, 3
    s_lshl_b32 s53, s53, 14
    s_and_b32 s45, s36, 7
    v_mfma_f32_16x16x32_bf16 v[28:31], v[200:203], v[180:183], v[28:31]
    s_lshl_b32 s45, s45, 10
    s_add_u32 s45, s45, s53
    s_add_u32 s45, s45, s39
    s_lshr_b32 s36, s38, 1
    v_mfma_f32_16x16x32_bf16 v[32:35], v[204:207], v[180:183], v[32:35]
    s_add_u32 s36, s36, 2
    s_lshr_b32 s53, s36, 3
    s_lshl_b32 s53, s53, 14
    s_and_b32 s46, s36, 7
    v_mfma_f32_16x16x32_bf16 v[60:63], v[204:207], v[184:187], v[60:63]
    s_lshl_b32 s46, s46, 10
    s_add_u32 s46, s46, s53
    s_add_u32 s46, s46, s39
    s_lshr_b32 s36, s38, 1
    v_mfma_f32_16x16x32_bf16 v[88:91], v[204:207], v[188:191], v[88:91]
    s_add_u32 s36, s36, 3
    s_lshr_b32 s53, s36, 3
    s_lshl_b32 s53, s53, 14
    s_and_b32 s47, s36, 7
    v_mfma_f32_16x16x32_bf16 v[116:119], v[204:207], v[192:195], v[116:119]
    s_lshl_b32 s47, s47, 10
    s_add_u32 s47, s47, s53
    s_add_u32 s47, s47, s39
    v_lshrrev_b32 v226, 2, v1
    v_mfma_f32_16x16x32_bf16 v[120:123], v[208:211], v[192:195], v[120:123]
    v_mul_u32_u24 v240, 256, v226
    v_and_b32 v227, 3, v1
    v_lshl_add_u32 v240, v227, 3, v240
    v_add_u32 v240, 49152, v240
    v_mfma_f32_16x16x32_bf16 v[92:95], v[208:211], v[188:191], v[92:95]
    v_and_b32 v226, 7, v226
    s_mul_i32 s36, s35, 4
    s_add_u32 s36, s36, 3
    v_xor_b32 v227, s36, v226
    v_mfma_f32_16x16x32_bf16 v[64:67], v[208:211], v[184:187], v[64:67]
    v_lshl_add_u32 v243, v227, 5, v240
    s_mul_i32 s36, s35, 4
    s_add_u32 s36, s36, 2
    v_xor_b32 v227, s36, v226
    v_mfma_f32_16x16x32_bf16 v[36:39], v[208:211], v[180:183], v[36:39]
    v_lshl_add_u32 v242, v227, 5, v240
    s_mul_i32 s36, s35, 4
    s_add_u32 s36, s36, 1
    v_xor_b32 v227, s36, v226
    v_mfma_f32_16x16x32_bf16 v[40:43], v[212:215], v[180:183], v[40:43]
    v_lshl_add_u32 v241, v227, 5, v240
    s_mul_i32 s36, s35, 4
    s_add_u32 s36, s36, 0
    v_xor_b32 v227, s36, v226
    v_mfma_f32_16x16x32_bf16 v[68:71], v[212:215], v[184:187], v[68:71]
    v_lshl_add_u32 v240, v227, 5, v240
    s_lshl_b32 s38, s33, 3
    s_lshl_b32 s36, s35, 2
    s_add_u32 s38, s38, s36
    v_mfma_f32_16x16x32_bf16 v[96:99], v[212:215], v[188:191], v[96:99]
    s_lshr_b32 s36, s38, 1
    s_lshr_b32 s53, s36, 3
    s_lshl_b32 s53, s53, 14
    s_and_b32 s39, s36, 7
    v_mfma_f32_16x16x32_bf16 v[124:127], v[212:215], v[192:195], v[124:127]
    s_lshl_b32 s39, s39, 10
    s_add_u32 s39, s39, s53
    s_lshl_b32 s36, s37, 16
    s_add_u32 s39, s39, s36
    v_mfma_f32_16x16x32_bf16 v[128:131], v[216:219], v[192:195], v[128:131]
    s_lshl_b32 s40, s31, 17
    s_add_u32 s40, s40, s39
    s_xor_b32 s41, s31, 1
    s_lshl_b32 s41, s41, 17
    v_mfma_f32_16x16x32_bf16 v[100:103], v[216:219], v[188:191], v[100:103]
    s_add_u32 s41, s41, s39
    s_mov_b32 s84, s62
    s_mov_b32 s85, s63
    s_mov_b32 s86, 0x7e000
    v_mfma_f32_16x16x32_bf16 v[72:75], v[216:219], v[184:187], v[72:75]
    s_mov_b32 s87, 0x20000
    s_add_u32 s88, s62, 0x80000
    s_addc_u32 s89, s63, 0
    s_mov_b32 s90, 0x7e000
    v_mfma_f32_16x16x32_bf16 v[44:47], v[216:219], v[180:183], v[44:47]
    s_mov_b32 s91, 0x20000
    s_lshl_b32 s36, s37, 1
    s_add_u32 s36, s36, s35
    s_lshl_b32 s36, s36, 10
    v_mfma_f32_16x16x32_bf16 v[48:51], v[220:223], v[180:183], v[48:51]
    v_add_u32 v244, s36, v2
    v_mov_b32 v245, 1
    v_mov_b32 v246, 162880
    v_lshrrev_b32 v238, 1, v23
    v_mfma_f32_16x16x32_bf16 v[76:79], v[220:223], v[184:187], v[76:79]
    v_lshlrev_b32 v238, 8, v238
    v_lshl_add_u32 v238, v22, 4, v238
    v_and_b32 v224, 1, v23
    v_lshl_add_u32 v238, v224, 3, v238
    v_mfma_f32_16x16x32_bf16 v[104:107], v[220:223], v[188:191], v[104:107]
    v_mfma_f32_16x16x32_bf16 v[132:135], v[220:223], v[192:195], v[132:135]
    s_add_u32 s53, s55, 1408
    v_mov_b32 v8, 1
    v_mov_b32 v9, 162864
    v_mov_b32 v11, 0
    s_mov_b64 exec, 1
    s_waitcnt vmcnt(0)
    ds_add_rtn_u32 v10, v9, v8
    s_waitcnt lgkmcnt(0)
    v_readfirstlane_b32 s54, v10
    s_nop 0
    s_and_b32 s54, s54, 3
    s_cmp_lg_u32 s54, 3
    s_cbranch_scc1 pub_25
    buffer_atomic_add v8, v11, s[56:59], s53 offen sc1
pub_25:
    s_mov_b64 exec, -1
    s_barrier
    ds_read_b128 v[136:139], v17 offset:0
    ds_read_b128 v[140:143], v17 offset:2048
    ds_read_b128 v[144:147], v17 offset:4096
    ds_read_b128 v[148:151], v17 offset:6144
    ds_read_b64_tr_b16 v[152:153], v18 offset:0
    ds_read_b64_tr_b16 v[154:155], v18 offset:7168
    ds_read_b64_tr_b16 v[156:157], v19 offset:32
    ds_read_b64_tr_b16 v[158:159], v19 offset:7200
    ds_read_b64_tr_b16 v[160:161], v18 offset:64
    ds_read_b64_tr_b16 v[162:163], v18 offset:7232
    ds_read_b64_tr_b16 v[164:165], v19 offset:96
    ds_read_b64_tr_b16 v[166:167], v19 offset:7264
    ds_read_b64_tr_b16 v[168:169], v18 offset:128
    ds_read_b64_tr_b16 v[170:171], v18 offset:7296
    ds_read_b64_tr_b16 v[172:173], v19 offset:160
    ds_read_b64_tr_b16 v[174:175], v19 offset:7328
    ds_read_b64_tr_b16 v[176:177], v18 offset:192
    ds_read_b64_tr_b16 v[178:179], v18 offset:7360
    s_waitcnt lgkmcnt(12)
mm_26:
    v_mfma_f32_16x16x32_bf16 v[24:27], v[152:155], v[136:139], v[24:27]
    ds_read_b128 v[180:183], v17 offset:1024
    s_add_u32 s42, s42, 16384
    v_mfma_f32_16x16x32_bf16 v[52:55], v[152:155], v[140:143], v[52:55]
    ds_read_b128 v[184:187], v17 offset:3072
    s_cmp_eq_u32 s42, 49152
    v_mfma_f32_16x16x32_bf16 v[80:83], v[152:155], v[144:147], v[80:83]
    ds_read_b128 v[188:191], v17 offset:5120
    s_cselect_b32 s42, 0, s42
    v_mfma_f32_16x16x32_bf16 v[108:111], v[152:155], v[148:151], v[108:111]
    ds_read_b128 v[192:195], v17 offset:7168
    s_waitcnt lgkmcnt(14)
    v_mfma_f32_16x16x32_bf16 v[112:115], v[156:159], v[148:151], v[112:115]
    ds_read_b64_tr_b16 v[196:197], v18 offset:14336
    s_add_u32 s48, s48, 28672
    v_mfma_f32_16x16x32_bf16 v[84:87], v[156:159], v[144:147], v[84:87]
    ds_read_b64_tr_b16 v[198:199], v18 offset:21504
    s_cmp_eq_u32 s48, 86016
    v_mfma_f32_16x16x32_bf16 v[56:59], v[156:159], v[140:143], v[56:59]
    ds_read_b64_tr_b16 v[200:201], v19 offset:14368
    s_cselect_b32 s48, 0, s48
    v_mfma_f32_16x16x32_bf16 v[28:31], v[156:159], v[136:139], v[28:31]
    ds_read_b64_tr_b16 v[202:203], v19 offset:21536
    s_waitcnt lgkmcnt(8)
    v_mfma_f32_16x16x32_bf16 v[32:35], v[160:163], v[136:139], v[32:35]
    ds_read_b64_tr_b16 v[204:205], v18 offset:14400
    v_add_u32 v17, s42, v12
    v_mfma_f32_16x16x32_bf16 v[60:63], v[160:163], v[140:143], v[60:63]
    ds_read_b64_tr_b16 v[206:207], v18 offset:21568
    v_mfma_f32_16x16x32_bf16 v[88:91], v[160:163], v[144:147], v[88:91]
    ds_read_b64_tr_b16 v[208:209], v19 offset:14432
    v_mfma_f32_16x16x32_bf16 v[116:119], v[160:163], v[148:151], v[116:119]
    ds_read_b64_tr_b16 v[210:211], v19 offset:21600
    v_mfma_f32_16x16x32_bf16 v[120:123], v[164:167], v[148:151], v[120:123]
    ds_read_b64_tr_b16 v[212:213], v18 offset:14464
    v_mfma_f32_16x16x32_bf16 v[92:95], v[164:167], v[144:147], v[92:95]
    ds_read_b64_tr_b16 v[214:215], v18 offset:21632
    v_mfma_f32_16x16x32_bf16 v[64:67], v[164:167], v[140:143], v[64:67]
    ds_read_b64_tr_b16 v[216:217], v19 offset:14496
    v_mfma_f32_16x16x32_bf16 v[36:39], v[164:167], v[136:139], v[36:39]
    ds_read_b64_tr_b16 v[218:219], v19 offset:21664
    v_add_u32 v19, s48, v14
    v_mfma_f32_16x16x32_bf16 v[40:43], v[168:171], v[136:139], v[40:43]
    ds_read_b64_tr_b16 v[220:221], v18 offset:14528
    v_mfma_f32_16x16x32_bf16 v[68:71], v[168:171], v[140:143], v[68:71]
    ds_read_b64_tr_b16 v[222:223], v18 offset:21696
    v_add_u32 v18, s48, v13
    v_mfma_f32_16x16x32_bf16 v[96:99], v[168:171], v[144:147], v[96:99]
    v_mfma_f32_16x16x32_bf16 v[124:127], v[168:171], v[148:151], v[124:127]
    v_mfma_f32_16x16x32_bf16 v[128:131], v[172:175], v[148:151], v[128:131]
    v_mfma_f32_16x16x32_bf16 v[100:103], v[172:175], v[144:147], v[100:103]
    v_mfma_f32_16x16x32_bf16 v[72:75], v[172:175], v[140:143], v[72:75]
    v_mfma_f32_16x16x32_bf16 v[44:47], v[172:175], v[136:139], v[44:47]
    v_mfma_f32_16x16x32_bf16 v[48:51], v[176:179], v[136:139], v[48:51]
    v_mfma_f32_16x16x32_bf16 v[76:79], v[176:179], v[140:143], v[76:79]
    v_mfma_f32_16x16x32_bf16 v[104:107], v[176:179], v[144:147], v[104:107]
    v_mfma_f32_16x16x32_bf16 v[132:135], v[176:179], v[148:151], v[132:135]
    s_waitcnt lgkmcnt(12)
    v_mfma_f32_16x16x32_bf16 v[24:27], v[196:199], v[180:183], v[24:27]
    s_add_u32 s43, s43, 1
    s_cmp_lt_u32 s43, 15
    v_mfma_f32_16x16x32_bf16 v[52:55], v[196:199], v[184:187], v[52:55]
    v_mfma_f32_16x16x32_bf16 v[80:83], v[196:199], v[188:191], v[80:83]
    v_mfma_f32_16x16x32_bf16 v[108:111], v[196:199], v[192:195], v[108:111]
    s_waitcnt lgkmcnt(0)
    s_barrier
    v_mfma_f32_16x16x32_bf16 v[112:115], v[200:203], v[192:195], v[112:115]
    ds_read_b128 v[136:139], v17 offset:0
    v_mfma_f32_16x16x32_bf16 v[84:87], v[200:203], v[188:191], v[84:87]
    ds_read_b128 v[140:143], v17 offset:2048
    v_mfma_f32_16x16x32_bf16 v[56:59], v[200:203], v[184:187], v[56:59]
    ds_read_b128 v[144:147], v17 offset:4096
    v_mfma_f32_16x16x32_bf16 v[28:31], v[200:203], v[180:183], v[28:31]
    ds_read_b128 v[148:151], v17 offset:6144
    v_mfma_f32_16x16x32_bf16 v[32:35], v[204:207], v[180:183], v[32:35]
    ds_read_b64_tr_b16 v[152:153], v18 offset:0
    v_mfma_f32_16x16x32_bf16 v[60:63], v[204:207], v[184:187], v[60:63]
    ds_read_b64_tr_b16 v[154:155], v18 offset:7168
    v_mfma_f32_16x16x32_bf16 v[88:91], v[204:207], v[188:191], v[88:91]
    ds_read_b64_tr_b16 v[156:157], v19 offset:32
    v_mfma_f32_16x16x32_bf16 v[116:119], v[204:207], v[192:195], v[116:119]
    ds_read_b64_tr_b16 v[158:159], v19 offset:7200
    v_mfma_f32_16x16x32_bf16 v[120:123], v[208:211], v[192:195], v[120:123]
    ds_read_b64_tr_b16 v[160:161], v18 offset:64
    v_mfma_f32_16x16x32_bf16 v[92:95], v[208:211], v[188:191], v[92:95]
    ds_read_b64_tr_b16 v[162:163], v18 offset:7232
    v_mfma_f32_16x16x32_bf16 v[64:67], v[208:211], v[184:187], v[64:67]
    ds_read_b64_tr_b16 v[164:165], v19 offset:96
    v_mfma_f32_16x16x32_bf16 v[36:39], v[208:211], v[180:183], v[36:39]
    ds_read_b64_tr_b16 v[166:167], v19 offset:7264
    v_mfma_f32_16x16x32_bf16 v[40:43], v[212:215], v[180:183], v[40:43]
    ds_read_b64_tr_b16 v[168:169], v18 offset:128
    v_mfma_f32_16x16x32_bf16 v[68:71], v[212:215], v[184:187], v[68:71]
    ds_read_b64_tr_b16 v[170:171], v18 offset:7296
    v_mfma_f32_16x16x32_bf16 v[96:99], v[212:215], v[188:191], v[96:99]
    ds_read_b64_tr_b16 v[172:173], v19 offset:160
    v_mfma_f32_16x16x32_bf16 v[124:127], v[212:215], v[192:195], v[124:127]
    ds_read_b64_tr_b16 v[174:175], v19 offset:7328
    v_mfma_f32_16x16x32_bf16 v[128:131], v[216:219], v[192:195], v[128:131]
    ds_read_b64_tr_b16 v[176:177], v18 offset:192
    v_mfma_f32_16x16x32_bf16 v[100:103], v[216:219], v[188:191], v[100:103]
    ds_read_b64_tr_b16 v[178:179], v18 offset:7360
    v_mfma_f32_16x16x32_bf16 v[72:75], v[216:219], v[184:187], v[72:75]
    v_mfma_f32_16x16x32_bf16 v[44:47], v[216:219], v[180:183], v[44:47]
    v_mfma_f32_16x16x32_bf16 v[48:51], v[220:223], v[180:183], v[48:51]
    v_mfma_f32_16x16x32_bf16 v[76:79], v[220:223], v[184:187], v[76:79]
    v_mfma_f32_16x16x32_bf16 v[104:107], v[220:223], v[188:191], v[104:107]
    v_mfma_f32_16x16x32_bf16 v[132:135], v[220:223], v[192:195], v[132:135]
    s_waitcnt lgkmcnt(12)
    s_cbranch_scc1 mm_26
    v_mfma_f32_16x16x32_bf16 v[24:27], v[152:155], v[136:139], v[24:27]
    ds_read_b128 v[180:183], v17 offset:1024
    v_mfma_f32_16x16x32_bf16 v[52:55], v[152:155], v[140:143], v[52:55]
    ds_read_b128 v[184:187], v17 offset:3072
    v_mfma_f32_16x16x32_bf16 v[80:83], v[152:155], v[144:147], v[80:83]
    ds_read_b128 v[188:191], v17 offset:5120
    v_mfma_f32_16x16x32_bf16 v[108:111], v[152:155], v[148:151], v[108:111]
    ds_read_b128 v[192:195], v17 offset:7168
    s_waitcnt lgkmcnt(14)
    v_mfma_f32_16x16x32_bf16 v[112:115], v[156:159], v[148:151], v[112:115]
    ds_read_b64_tr_b16 v[196:197], v18 offset:14336
    v_mfma_f32_16x16x32_bf16 v[84:87], v[156:159], v[144:147], v[84:87]
    ds_read_b64_tr_b16 v[198:199], v18 offset:21504
    v_mfma_f32_16x16x32_bf16 v[56:59], v[156:159], v[140:143], v[56:59]
    ds_read_b64_tr_b16 v[200:201], v19 offset:14368
    v_mfma_f32_16x16x32_bf16 v[28:31], v[156:159], v[136:139], v[28:31]
    ds_read_b64_tr_b16 v[202:203], v19 offset:21536
    s_waitcnt lgkmcnt(8)
    v_mfma_f32_16x16x32_bf16 v[32:35], v[160:163], v[136:139], v[32:35]
    ds_read_b64_tr_b16 v[204:205], v18 offset:14400
    v_mfma_f32_16x16x32_bf16 v[60:63], v[160:163], v[140:143], v[60:63]
    ds_read_b64_tr_b16 v[206:207], v18 offset:21568
    v_mfma_f32_16x16x32_bf16 v[88:91], v[160:163], v[144:147], v[88:91]
    ds_read_b64_tr_b16 v[208:209], v19 offset:14432
    v_mfma_f32_16x16x32_bf16 v[116:119], v[160:163], v[148:151], v[116:119]
    ds_read_b64_tr_b16 v[210:211], v19 offset:21600
    v_mfma_f32_16x16x32_bf16 v[120:123], v[164:167], v[148:151], v[120:123]
    ds_read_b64_tr_b16 v[212:213], v18 offset:14464
    v_mfma_f32_16x16x32_bf16 v[92:95], v[164:167], v[144:147], v[92:95]
    ds_read_b64_tr_b16 v[214:215], v18 offset:21632
    v_mfma_f32_16x16x32_bf16 v[64:67], v[164:167], v[140:143], v[64:67]
    ds_read_b64_tr_b16 v[216:217], v19 offset:14496
    v_mfma_f32_16x16x32_bf16 v[36:39], v[164:167], v[136:139], v[36:39]
    ds_read_b64_tr_b16 v[218:219], v19 offset:21664
    v_mfma_f32_16x16x32_bf16 v[40:43], v[168:171], v[136:139], v[40:43]
    ds_read_b64_tr_b16 v[220:221], v18 offset:14528
    v_mfma_f32_16x16x32_bf16 v[68:71], v[168:171], v[140:143], v[68:71]
    ds_read_b64_tr_b16 v[222:223], v18 offset:21696
    v_mfma_f32_16x16x32_bf16 v[96:99], v[168:171], v[144:147], v[96:99]
    v_mfma_f32_16x16x32_bf16 v[124:127], v[168:171], v[148:151], v[124:127]
    v_mfma_f32_16x16x32_bf16 v[128:131], v[172:175], v[148:151], v[128:131]
    v_mfma_f32_16x16x32_bf16 v[100:103], v[172:175], v[144:147], v[100:103]
    v_mfma_f32_16x16x32_bf16 v[72:75], v[172:175], v[140:143], v[72:75]
    v_mfma_f32_16x16x32_bf16 v[44:47], v[172:175], v[136:139], v[44:47]
    v_mfma_f32_16x16x32_bf16 v[48:51], v[176:179], v[136:139], v[48:51]
    v_mfma_f32_16x16x32_bf16 v[76:79], v[176:179], v[140:143], v[76:79]
    v_mfma_f32_16x16x32_bf16 v[104:107], v[176:179], v[144:147], v[104:107]
    v_mfma_f32_16x16x32_bf16 v[132:135], v[176:179], v[148:151], v[132:135]
    s_waitcnt lgkmcnt(0)
    s_barrier
    v_mfma_f32_16x16x32_bf16 v[24:27], v[196:199], v[180:183], v[24:27]
    ds_read_b128 v[136:139], v6 offset:0
    v_mfma_f32_16x16x32_bf16 v[52:55], v[196:199], v[184:187], v[52:55]
    ds_read_b128 v[140:143], v6 offset:64
    v_mfma_f32_16x16x32_bf16 v[80:83], v[196:199], v[188:191], v[80:83]
    ds_read_b128 v[144:147], v6 offset:128
    v_mfma_f32_16x16x32_bf16 v[108:111], v[196:199], v[192:195], v[108:111]
    ds_read_b128 v[148:151], v6 offset:192
    v_mfma_f32_16x16x32_bf16 v[112:115], v[200:203], v[192:195], v[112:115]
    ds_read_b128 v[152:155], v6 offset:256
    v_mfma_f32_16x16x32_bf16 v[84:87], v[200:203], v[188:191], v[84:87]
    ds_read_b128 v[156:159], v6 offset:320
    v_mfma_f32_16x16x32_bf16 v[56:59], v[200:203], v[184:187], v[56:59]
    ds_read_b128 v[160:163], v6 offset:384
    v_mfma_f32_16x16x32_bf16 v[28:31], v[200:203], v[180:183], v[28:31]
    ds_read_b128 v[164:167], v7 offset:0
    v_mfma_f32_16x16x32_bf16 v[32:35], v[204:207], v[180:183], v[32:35]
    ds_read_b128 v[168:171], v7 offset:256
    v_mfma_f32_16x16x32_bf16 v[60:63], v[204:207], v[184:187], v[60:63]
    ds_read_b128 v[172:175], v7 offset:512
    v_mfma_f32_16x16x32_bf16 v[88:91], v[204:207], v[188:191], v[88:91]
    ds_read_b128 v[176:179], v7 offset:768
    v_mov_b32 v13, v240
    v_mfma_f32_16x16x32_bf16 v[116:119], v[204:207], v[192:195], v[116:119]
    v_add_u32 v18, 0, v240
    v_mov_b32 v14, v241
    v_mfma_f32_16x16x32_bf16 v[120:123], v[208:211], v[192:195], v[120:123]
    v_add_u32 v19, 0, v241
    v_mov_b32 v15, v242
    v_mfma_f32_16x16x32_bf16 v[92:95], v[208:211], v[188:191], v[92:95]
    v_add_u32 v20, 0, v242
    v_mov_b32 v16, v243
    v_mfma_f32_16x16x32_bf16 v[64:67], v[208:211], v[184:187], v[64:67]
    v_add_u32 v21, 0, v243
    s_mov_b32 s42, 0
    s_mov_b32 s43, 0
    v_mfma_f32_16x16x32_bf16 v[36:39], v[208:211], v[180:183], v[36:39]
    s_mov_b32 s48, 0
    v_mov_b32 v17, v12
    v_and_b32 v199, 7, v0
    v_mfma_f32_16x16x32_bf16 v[40:43], v[212:215], v[180:183], v[40:43]
    v_lshrrev_b32 v228, 6, v0
    v_lshlrev_b32 v228, 4, v228
    v_mfma_f32_16x16x32_bf16 v[68:71], v[212:215], v[184:187], v[68:71]
    v_bfe_u32 v229, v0, 3, 3
    v_add_u32 v228, v228, v229
    s_lshr_b32 s78, s29, 1
    v_mfma_f32_16x16x32_bf16 v[96:99], v[212:215], v[188:191], v[96:99]
    s_lshl_b32 s78, s78, 16
    s_and_b32 s79, s29, 1
    s_lshl_b32 s79, s79, 7
    v_mfma_f32_16x16x32_bf16 v[124:127], v[212:215], v[192:195], v[124:127]
    s_add_u32 s78, s78, s79
    s_lshr_b32 s79, s30, 1
    s_lshl_b32 s79, s79, 13
    v_mfma_f32_16x16x32_bf16 v[128:131], v[216:219], v[192:195], v[128:131]
    s_add_u32 s78, s78, s79
    v_lshlrev_b32 v196, 8, v228
    v_lshl_add_u32 v196, v199, 4, v196
    v_mfma_f32_16x16x32_bf16 v[100:103], v[216:219], v[188:191], v[100:103]
    v_add_u32 v196, s78, v196
    v_mfma_f32_16x16x32_bf16 v[72:75], v[216:219], v[184:187], v[72:75]
    v_mfma_f32_16x16x32_bf16 v[44:47], v[216:219], v[180:183], v[44:47]
    v_mfma_f32_16x16x32_bf16 v[48:51], v[220:223], v[180:183], v[48:51]
    v_mfma_f32_16x16x32_bf16 v[76:79], v[220:223], v[184:187], v[76:79]
    v_mfma_f32_16x16x32_bf16 v[104:107], v[220:223], v[188:191], v[104:107]
    v_mfma_f32_16x16x32_bf16 v[132:135], v[220:223], v[192:195], v[132:135]
    s_waitcnt lgkmcnt(0)
    s_cmp_eq_u32 s35, 1
    s_cbranch_scc1 G3_e1
    v_pk_fma_f32 v[24:25], v[164:165], v[136:137], v[24:25] op_sel_hi:[0,1,1] neg_lo:[1,0,0] neg_hi:[1,0,0]
    v_pk_fma_f32 v[26:27], v[164:165], v[138:139], v[26:27] op_sel_hi:[0,1,1] neg_lo:[1,0,0] neg_hi:[1,0,0]
    v_pk_mul_f32 v[226:227], v[24:25], v[24:25]
    v_pk_mul_f32 v[228:229], v[26:27], v[26:27]
    v_pk_fma_f32 v[226:227], v[226:227], v[166:167], v[166:167] op_sel:[0,1,0] op_sel_hi:[1,1,0]
    v_pk_fma_f32 v[228:229], v[228:229], v[166:167], v[166:167] op_sel:[0,1,0] op_sel_hi:[1,1,0]
    v_pk_mul_f32 v[226:227], v[226:227], v[24:25]
    v_pk_mul_f32 v[228:229], v[228:229], v[26:27]
    v_exp_f32 v226, v226
    v_exp_f32 v227, v227
    v_exp_f32 v228, v228
    v_exp_f32 v229, v229
    v_pk_fma_f32 v[226:227], v[226:227], v[164:165], v[164:165] op_sel:[0,1,1] op_sel_hi:[1,1,1]
    v_pk_fma_f32 v[228:229], v[228:229], v[164:165], v[164:165] op_sel:[0,1,1] op_sel_hi:[1,1,1]
    v_rcp_f32 v226, v226
    v_rcp_f32 v227, v227
    v_rcp_f32 v228, v228
    v_rcp_f32 v229, v229
    v_pk_mul_f32 v[24:25], v[24:25], v[226:227]
    v_pk_mul_f32 v[26:27], v[26:27], v[228:229]
    v_pk_fma_f32 v[28:29], v[164:165], v[140:141], v[28:29] op_sel_hi:[0,1,1] neg_lo:[1,0,0] neg_hi:[1,0,0]
    v_pk_fma_f32 v[30:31], v[164:165], v[142:143], v[30:31] op_sel_hi:[0,1,1] neg_lo:[1,0,0] neg_hi:[1,0,0]
    v_pk_mul_f32 v[226:227], v[28:29], v[28:29]
    v_pk_mul_f32 v[228:229], v[30:31], v[30:31]
    v_pk_fma_f32 v[226:227], v[226:227], v[166:167], v[166:167] op_sel:[0,1,0] op_sel_hi:[1,1,0]
    v_pk_fma_f32 v[228:229], v[228:229], v[166:167], v[166:167] op_sel:[0,1,0] op_sel_hi:[1,1,0]
    v_pk_mul_f32 v[226:227], v[226:227], v[28:29]
    v_pk_mul_f32 v[228:229], v[228:229], v[30:31]
    v_exp_f32 v226, v226
    v_exp_f32 v227, v227
    v_exp_f32 v228, v228
    v_exp_f32 v229, v229
    v_pk_fma_f32 v[226:227], v[226:227], v[164:165], v[164:165] op_sel:[0,1,1] op_sel_hi:[1,1,1]
    v_pk_fma_f32 v[228:229], v[228:229], v[164:165], v[164:165] op_sel:[0,1,1] op_sel_hi:[1,1,1]
    v_rcp_f32 v226, v226
    v_rcp_f32 v227, v227
    v_rcp_f32 v228, v228
    v_rcp_f32 v229, v229
    v_pk_mul_f32 v[28:29], v[28:29], v[226:227]
    v_pk_mul_f32 v[30:31], v[30:31], v[228:229]
    v_cvt_pk_bf16_f32 v24, v24, v25
    v_cvt_pk_bf16_f32 v25, v26, v27
    v_cvt_pk_bf16_f32 v26, v28, v29
    v_cvt_pk_bf16_f32 v27, v30, v31
    v_or_b32 v24, 1, v24
    ds_write_b128 v244, v[24:27] offset:0
    s_add_u32 s36, s44, 0
    buffer_store_dwordx4 v[24:27], v2, s[16:19], s36 offen sc1
    v_pk_fma_f32 v[52:53], v[168:169], v[136:137], v[52:53] op_sel_hi:[0,1,1] neg_lo:[1,0,0] neg_hi:[1,0,0]
    v_pk_fma_f32 v[54:55], v[168:169], v[138:139], v[54:55] op_sel_hi:[0,1,1] neg_lo:[1,0,0] neg_hi:[1,0,0]
    v_pk_mul_f32 v[226:227], v[52:53], v[52:53]
    v_pk_mul_f32 v[228:229], v[54:55], v[54:55]
    v_pk_fma_f32 v[226:227], v[226:227], v[170:171], v[170:171] op_sel:[0,1,0] op_sel_hi:[1,1,0]
    v_pk_fma_f32 v[228:229], v[228:229], v[170:171], v[170:171] op_sel:[0,1,0] op_sel_hi:[1,1,0]
    v_pk_mul_f32 v[226:227], v[226:227], v[52:53]
    v_pk_mul_f32 v[228:229], v[228:229], v[54:55]
    v_exp_f32 v226, v226
    v_exp_f32 v227, v227
    v_exp_f32 v228, v228
    v_exp_f32 v229, v229
    v_pk_fma_f32 v[226:227], v[226:227], v[168:169], v[168:169] op_sel:[0,1,1] op_sel_hi:[1,1,1]
    v_pk_fma_f32 v[228:229], v[228:229], v[168:169], v[168:169] op_sel:[0,1,1] op_sel_hi:[1,1,1]
    v_rcp_f32 v226, v226
    v_rcp_f32 v227, v227
    v_rcp_f32 v228, v228
    v_rcp_f32 v229, v229
    v_pk_mul_f32 v[52:53], v[52:53], v[226:227]
    v_pk_mul_f32 v[54:55], v[54:55], v[228:229]
    v_pk_fma_f32 v[56:57], v[168:169], v[140:141], v[56:57] op_sel_hi:[0,1,1] neg_lo:[1,0,0] neg_hi:[1,0,0]
    v_pk_fma_f32 v[58:59], v[168:169], v[142:143], v[58:59] op_sel_hi:[0,1,1] neg_lo:[1,0,0] neg_hi:[1,0,0]
    v_pk_mul_f32 v[226:227], v[56:57], v[56:57]
    v_pk_mul_f32 v[228:229], v[58:59], v[58:59]
    v_pk_fma_f32 v[226:227], v[226:227], v[170:171], v[170:171] op_sel:[0,1,0] op_sel_hi:[1,1,0]
    v_pk_fma_f32 v[228:229], v[228:229], v[170:171], v[170:171] op_sel:[0,1,0] op_sel_hi:[1,1,0]
    v_pk_mul_f32 v[226:227], v[226:227], v[56:57]
    v_pk_mul_f32 v[228:229], v[228:229], v[58:59]
    v_exp_f32 v226, v226
    v_exp_f32 v227, v227
    v_exp_f32 v228, v228
    v_exp_f32 v229, v229
    v_pk_fma_f32 v[226:227], v[226:227], v[168:169], v[168:169] op_sel:[0,1,1] op_sel_hi:[1,1,1]
    v_pk_fma_f32 v[228:229], v[228:229], v[168:169], v[168:169] op_sel:[0,1,1] op_sel_hi:[1,1,1]
    v_rcp_f32 v226, v226
    v_rcp_f32 v227, v227
    v_rcp_f32 v228, v228
    v_rcp_f32 v229, v229
    v_pk_mul_f32 v[56:57], v[56:57], v[226:227]
    v_pk_mul_f32 v[58:59], v[58:59], v[228:229]
    v_cvt_pk_bf16_f32 v52, v52, v53
    v_cvt_pk_bf16_f32 v53, v54, v55
    v_cvt_pk_bf16_f32 v54, v56, v57
    v_cvt_pk_bf16_f32 v55, v58, v59
    v_or_b32 v52, 1, v52
    ds_write_b128 v244, v[52:55] offset:2048
    s_add_u32 s36, s44, 229376
    buffer_store_dwordx4 v[52:55], v2, s[16:19], s36 offen sc1
    v_pk_fma_f32 v[80:81], v[172:173], v[136:137], v[80:81] op_sel_hi:[0,1,1] neg_lo:[1,0,0] neg_hi:[1,0,0]
    v_pk_fma_f32 v[82:83], v[172:173], v[138:139], v[82:83] op_sel_hi:[0,1,1] neg_lo:[1,0,0] neg_hi:[1,0,0]
    v_pk_mul_f32 v[226:227], v[80:81], v[80:81]
    v_pk_mul_f32 v[228:229], v[82:83], v[82:83]
    v_pk_fma_f32 v[226:227], v[226:227], v[174:175], v[174:175] op_sel:[0,1,0] op_sel_hi:[1,1,0]
    v_pk_fma_f32 v[228:229], v[228:229], v[174:175], v[174:175] op_sel:[0,1,0] op_sel_hi:[1,1,0]
    v_pk_mul_f32 v[226:227], v[226:227], v[80:81]
    v_pk_mul_f32 v[228:229], v[228:229], v[82:83]
    v_exp_f32 v226, v226
    v_exp_f32 v227, v227
    v_exp_f32 v228, v228
    v_exp_f32 v229, v229
    v_pk_fma_f32 v[226:227], v[226:227], v[172:173], v[172:173] op_sel:[0,1,1] op_sel_hi:[1,1,1]
    v_pk_fma_f32 v[228:229], v[228:229], v[172:173], v[172:173] op_sel:[0,1,1] op_sel_hi:[1,1,1]
    v_rcp_f32 v226, v226
    v_rcp_f32 v227, v227
    v_rcp_f32 v228, v228
    v_rcp_f32 v229, v229
    v_pk_mul_f32 v[80:81], v[80:81], v[226:227]
    v_pk_mul_f32 v[82:83], v[82:83], v[228:229]
    v_pk_fma_f32 v[84:85], v[172:173], v[140:141], v[84:85] op_sel_hi:[0,1,1] neg_lo:[1,0,0] neg_hi:[1,0,0]
    v_pk_fma_f32 v[86:87], v[172:173], v[142:143], v[86:87] op_sel_hi:[0,1,1] neg_lo:[1,0,0] neg_hi:[1,0,0]
    v_pk_mul_f32 v[226:227], v[84:85], v[84:85]
    v_pk_mul_f32 v[228:229], v[86:87], v[86:87]
    v_pk_fma_f32 v[226:227], v[226:227], v[174:175], v[174:175] op_sel:[0,1,0] op_sel_hi:[1,1,0]
    v_pk_fma_f32 v[228:229], v[228:229], v[174:175], v[174:175] op_sel:[0,1,0] op_sel_hi:[1,1,0]
    v_pk_mul_f32 v[226:227], v[226:227], v[84:85]
    v_pk_mul_f32 v[228:229], v[228:229], v[86:87]
    v_exp_f32 v226, v226
    v_exp_f32 v227, v227
    v_exp_f32 v228, v228
    v_exp_f32 v229, v229
    v_pk_fma_f32 v[226:227], v[226:227], v[172:173], v[172:173] op_sel:[0,1,1] op_sel_hi:[1,1,1]
    v_pk_fma_f32 v[228:229], v[228:229], v[172:173], v[172:173] op_sel:[0,1,1] op_sel_hi:[1,1,1]
    v_rcp_f32 v226, v226
    v_rcp_f32 v227, v227
    v_rcp_f32 v228, v228
    v_rcp_f32 v229, v229
    v_pk_mul_f32 v[84:85], v[84:85], v[226:227]
    v_pk_mul_f32 v[86:87], v[86:87], v[228:229]
    v_cvt_pk_bf16_f32 v80, v80, v81
    v_cvt_pk_bf16_f32 v81, v82, v83
    v_cvt_pk_bf16_f32 v82, v84, v85
    v_cvt_pk_bf16_f32 v83, v86, v87
    v_or_b32 v80, 1, v80
    ds_write_b128 v244, v[80:83] offset:4096
    s_add_u32 s36, s44, 458752
    buffer_store_dwordx4 v[80:83], v2, s[16:19], s36 offen sc1
    v_pk_fma_f32 v[108:109], v[176:177], v[136:137], v[108:109] op_sel_hi:[0,1,1] neg_lo:[1,0,0] neg_hi:[1,0,0]
    v_pk_fma_f32 v[110:111], v[176:177], v[138:139], v[110:111] op_sel_hi:[0,1,1] neg_lo:[1,0,0] neg_hi:[1,0,0]
    v_pk_mul_f32 v[226:227], v[108:109], v[108:109]
    v_pk_mul_f32 v[228:229], v[110:111], v[110:111]
    v_pk_fma_f32 v[226:227], v[226:227], v[178:179], v[178:179] op_sel:[0,1,0] op_sel_hi:[1,1,0]
    v_pk_fma_f32 v[228:229], v[228:229], v[178:179], v[178:179] op_sel:[0,1,0] op_sel_hi:[1,1,0]
    v_pk_mul_f32 v[226:227], v[226:227], v[108:109]
    v_pk_mul_f32 v[228:229], v[228:229], v[110:111]
    v_exp_f32 v226, v226
    v_exp_f32 v227, v227
    v_exp_f32 v228, v228
    v_exp_f32 v229, v229
    v_pk_fma_f32 v[226:227], v[226:227], v[176:177], v[176:177] op_sel:[0,1,1] op_sel_hi:[1,1,1]
    v_pk_fma_f32 v[228:229], v[228:229], v[176:177], v[176:177] op_sel:[0,1,1] op_sel_hi:[1,1,1]
    v_rcp_f32 v226, v226
    v_rcp_f32 v227, v227
    v_rcp_f32 v228, v228
    v_rcp_f32 v229, v229
    v_pk_mul_f32 v[108:109], v[108:109], v[226:227]
    v_pk_mul_f32 v[110:111], v[110:111], v[228:229]
    v_pk_fma_f32 v[112:113], v[176:177], v[140:141], v[112:113] op_sel_hi:[0,1,1] neg_lo:[1,0,0] neg_hi:[1,0,0]
    v_pk_fma_f32 v[114:115], v[176:177], v[142:143], v[114:115] op_sel_hi:[0,1,1] neg_lo:[1,0,0] neg_hi:[1,0,0]
    v_pk_mul_f32 v[226:227], v[112:113], v[112:113]
    v_pk_mul_f32 v[228:229], v[114:115], v[114:115]
    v_pk_fma_f32 v[226:227], v[226:227], v[178:179], v[178:179] op_sel:[0,1,0] op_sel_hi:[1,1,0]
    v_pk_fma_f32 v[228:229], v[228:229], v[178:179], v[178:179] op_sel:[0,1,0] op_sel_hi:[1,1,0]
    v_pk_mul_f32 v[226:227], v[226:227], v[112:113]
    v_pk_mul_f32 v[228:229], v[228:229], v[114:115]
    v_exp_f32 v226, v226
    v_exp_f32 v227, v227
    v_exp_f32 v228, v228
    v_exp_f32 v229, v229
    v_pk_fma_f32 v[226:227], v[226:227], v[176:177], v[176:177] op_sel:[0,1,1] op_sel_hi:[1,1,1]
    v_pk_fma_f32 v[228:229], v[228:229], v[176:177], v[176:177] op_sel:[0,1,1] op_sel_hi:[1,1,1]
    v_rcp_f32 v226, v226
    v_rcp_f32 v227, v227
    v_rcp_f32 v228, v228
    v_rcp_f32 v229, v229
    v_pk_mul_f32 v[112:113], v[112:113], v[226:227]
    v_pk_mul_f32 v[114:115], v[114:115], v[228:229]
    v_cvt_pk_bf16_f32 v108, v108, v109
    v_cvt_pk_bf16_f32 v109, v110, v111
    v_cvt_pk_bf16_f32 v110, v112, v113
    v_cvt_pk_bf16_f32 v111, v114, v115
    ds_write_b128 v244, v[108:111] offset:6144
    s_add_u32 s36, s44, 688128
    buffer_store_dwordx4 v[108:111], v2, s[16:19], s36 offen sc1
    v_pk_fma_f32 v[32:33], v[164:165], v[144:145], v[32:33] op_sel_hi:[0,1,1] neg_lo:[1,0,0] neg_hi:[1,0,0]
    v_pk_fma_f32 v[34:35], v[164:165], v[146:147], v[34:35] op_sel_hi:[0,1,1] neg_lo:[1,0,0] neg_hi:[1,0,0]
    v_pk_mul_f32 v[226:227], v[32:33], v[32:33]
    v_pk_mul_f32 v[228:229], v[34:35], v[34:35]
    v_pk_fma_f32 v[226:227], v[226:227], v[166:167], v[166:167] op_sel:[0,1,0] op_sel_hi:[1,1,0]
    v_pk_fma_f32 v[228:229], v[228:229], v[166:167], v[166:167] op_sel:[0,1,0] op_sel_hi:[1,1,0]
    v_pk_mul_f32 v[226:227], v[226:227], v[32:33]
    v_pk_mul_f32 v[228:229], v[228:229], v[34:35]
    v_exp_f32 v226, v226
    v_exp_f32 v227, v227
    v_exp_f32 v228, v228
    v_exp_f32 v229, v229
    v_pk_fma_f32 v[226:227], v[226:227], v[164:165], v[164:165] op_sel:[0,1,1] op_sel_hi:[1,1,1]
    v_pk_fma_f32 v[228:229], v[228:229], v[164:165], v[164:165] op_sel:[0,1,1] op_sel_hi:[1,1,1]
    v_rcp_f32 v226, v226
    v_rcp_f32 v227, v227
    v_rcp_f32 v228, v228
    v_rcp_f32 v229, v229
    v_pk_mul_f32 v[32:33], v[32:33], v[226:227]
    v_pk_mul_f32 v[34:35], v[34:35], v[228:229]
    v_pk_fma_f32 v[36:37], v[164:165], v[148:149], v[36:37] op_sel_hi:[0,1,1] neg_lo:[1,0,0] neg_hi:[1,0,0]
    v_pk_fma_f32 v[38:39], v[164:165], v[150:151], v[38:39] op_sel_hi:[0,1,1] neg_lo:[1,0,0] neg_hi:[1,0,0]
    v_pk_mul_f32 v[226:227], v[36:37], v[36:37]
    v_pk_mul_f32 v[228:229], v[38:39], v[38:39]
    v_pk_fma_f32 v[226:227], v[226:227], v[166:167], v[166:167] op_sel:[0,1,0] op_sel_hi:[1,1,0]
    v_pk_fma_f32 v[228:229], v[228:229], v[166:167], v[166:167] op_sel:[0,1,0] op_sel_hi:[1,1,0]
    v_pk_mul_f32 v[226:227], v[226:227], v[36:37]
    v_pk_mul_f32 v[228:229], v[228:229], v[38:39]
    v_exp_f32 v226, v226
    v_exp_f32 v227, v227
    v_exp_f32 v228, v228
    v_exp_f32 v229, v229
    v_pk_fma_f32 v[226:227], v[226:227], v[164:165], v[164:165] op_sel:[0,1,1] op_sel_hi:[1,1,1]
    v_pk_fma_f32 v[228:229], v[228:229], v[164:165], v[164:165] op_sel:[0,1,1] op_sel_hi:[1,1,1]
    v_rcp_f32 v226, v226
    v_rcp_f32 v227, v227
    v_rcp_f32 v228, v228
    v_rcp_f32 v229, v229
    v_pk_mul_f32 v[36:37], v[36:37], v[226:227]
    v_pk_mul_f32 v[38:39], v[38:39], v[228:229]
    v_cvt_pk_bf16_f32 v32, v32, v33
    v_cvt_pk_bf16_f32 v33, v34, v35
    v_cvt_pk_bf16_f32 v34, v36, v37
    v_cvt_pk_bf16_f32 v35, v38, v39
    v_or_b32 v32, 1, v32
    ds_write_b128 v244, v[32:35] offset:16384
    v_pk_fma_f32 v[60:61], v[168:169], v[144:145], v[60:61] op_sel_hi:[0,1,1] neg_lo:[1,0,0] neg_hi:[1,0,0]
    v_pk_fma_f32 v[62:63], v[168:169], v[146:147], v[62:63] op_sel_hi:[0,1,1] neg_lo:[1,0,0] neg_hi:[1,0,0]
    v_pk_mul_f32 v[226:227], v[60:61], v[60:61]
    v_pk_mul_f32 v[228:229], v[62:63], v[62:63]
    v_pk_fma_f32 v[226:227], v[226:227], v[170:171], v[170:171] op_sel:[0,1,0] op_sel_hi:[1,1,0]
    v_pk_fma_f32 v[228:229], v[228:229], v[170:171], v[170:171] op_sel:[0,1,0] op_sel_hi:[1,1,0]
    v_pk_mul_f32 v[226:227], v[226:227], v[60:61]
    v_pk_mul_f32 v[228:229], v[228:229], v[62:63]
    v_exp_f32 v226, v226
    v_exp_f32 v227, v227
    v_exp_f32 v228, v228
    v_exp_f32 v229, v229
    v_pk_fma_f32 v[226:227], v[226:227], v[168:169], v[168:169] op_sel:[0,1,1] op_sel_hi:[1,1,1]
    v_pk_fma_f32 v[228:229], v[228:229], v[168:169], v[168:169] op_sel:[0,1,1] op_sel_hi:[1,1,1]
    v_rcp_f32 v226, v226
    v_rcp_f32 v227, v227
    v_rcp_f32 v228, v228
    v_rcp_f32 v229, v229
    v_pk_mul_f32 v[60:61], v[60:61], v[226:227]
    v_pk_mul_f32 v[62:63], v[62:63], v[228:229]
    v_pk_fma_f32 v[64:65], v[168:169], v[148:149], v[64:65] op_sel_hi:[0,1,1] neg_lo:[1,0,0] neg_hi:[1,0,0]
    v_pk_fma_f32 v[66:67], v[168:169], v[150:151], v[66:67] op_sel_hi:[0,1,1] neg_lo:[1,0,0] neg_hi:[1,0,0]
    v_pk_mul_f32 v[226:227], v[64:65], v[64:65]
    v_pk_mul_f32 v[228:229], v[66:67], v[66:67]
    v_pk_fma_f32 v[226:227], v[226:227], v[170:171], v[170:171] op_sel:[0,1,0] op_sel_hi:[1,1,0]
    v_pk_fma_f32 v[228:229], v[228:229], v[170:171], v[170:171] op_sel:[0,1,0] op_sel_hi:[1,1,0]
    v_pk_mul_f32 v[226:227], v[226:227], v[64:65]
    v_pk_mul_f32 v[228:229], v[228:229], v[66:67]
    v_exp_f32 v226, v226
    v_exp_f32 v227, v227
    v_exp_f32 v228, v228
    v_exp_f32 v229, v229
    v_pk_fma_f32 v[226:227], v[226:227], v[168:169], v[168:169] op_sel:[0,1,1] op_sel_hi:[1,1,1]
    v_pk_fma_f32 v[228:229], v[228:229], v[168:169], v[168:169] op_sel:[0,1,1] op_sel_hi:[1,1,1]
    v_rcp_f32 v226, v226
    v_rcp_f32 v227, v227
    v_rcp_f32 v228, v228
    v_rcp_f32 v229, v229
    v_pk_mul_f32 v[64:65], v[64:65], v[226:227]
    v_pk_mul_f32 v[66:67], v[66:67], v[228:229]
    v_cvt_pk_bf16_f32 v60, v60, v61
    v_cvt_pk_bf16_f32 v61, v62, v63
    v_cvt_pk_bf16_f32 v62, v64, v65
    v_cvt_pk_bf16_f32 v63, v66, v67
    v_or_b32 v60, 1, v60
    ds_write_b128 v244, v[60:63] offset:18432
    s_waitcnt vmcnt(0)
    s_mov_b64 exec, 1
    ds_add_u32 v246, v245
    s_mov_b64 exec, -1
    v_pk_fma_f32 v[88:89], v[172:173], v[144:145], v[88:89] op_sel_hi:[0,1,1] neg_lo:[1,0,0] neg_hi:[1,0,0]
    v_pk_fma_f32 v[90:91], v[172:173], v[146:147], v[90:91] op_sel_hi:[0,1,1] neg_lo:[1,0,0] neg_hi:[1,0,0]
    v_pk_mul_f32 v[226:227], v[88:89], v[88:89]
    v_pk_mul_f32 v[228:229], v[90:91], v[90:91]
    v_pk_fma_f32 v[226:227], v[226:227], v[174:175], v[174:175] op_sel:[0,1,0] op_sel_hi:[1,1,0]
    v_pk_fma_f32 v[228:229], v[228:229], v[174:175], v[174:175] op_sel:[0,1,0] op_sel_hi:[1,1,0]
    v_pk_mul_f32 v[226:227], v[226:227], v[88:89]
    v_pk_mul_f32 v[228:229], v[228:229], v[90:91]
    v_exp_f32 v226, v226
    v_exp_f32 v227, v227
    v_exp_f32 v228, v228
    v_exp_f32 v229, v229
    v_pk_fma_f32 v[226:227], v[226:227], v[172:173], v[172:173] op_sel:[0,1,1] op_sel_hi:[1,1,1]
    v_pk_fma_f32 v[228:229], v[228:229], v[172:173], v[172:173] op_sel:[0,1,1] op_sel_hi:[1,1,1]
    v_rcp_f32 v226, v226
    v_rcp_f32 v227, v227
    v_rcp_f32 v228, v228
    v_rcp_f32 v229, v229
    v_pk_mul_f32 v[88:89], v[88:89], v[226:227]
    v_pk_mul_f32 v[90:91], v[90:91], v[228:229]
    v_pk_fma_f32 v[92:93], v[172:173], v[148:149], v[92:93] op_sel_hi:[0,1,1] neg_lo:[1,0,0] neg_hi:[1,0,0]
    v_pk_fma_f32 v[94:95], v[172:173], v[150:151], v[94:95] op_sel_hi:[0,1,1] neg_lo:[1,0,0] neg_hi:[1,0,0]
    v_pk_mul_f32 v[226:227], v[92:93], v[92:93]
    v_pk_mul_f32 v[228:229], v[94:95], v[94:95]
    v_pk_fma_f32 v[226:227], v[226:227], v[174:175], v[174:175] op_sel:[0,1,0] op_sel_hi:[1,1,0]
    v_pk_fma_f32 v[228:229], v[228:229], v[174:175], v[174:175] op_sel:[0,1,0] op_sel_hi:[1,1,0]
    v_pk_mul_f32 v[226:227], v[226:227], v[92:93]
    v_pk_mul_f32 v[228:229], v[228:229], v[94:95]
    v_exp_f32 v226, v226
    v_exp_f32 v227, v227
    v_exp_f32 v228, v228
    v_exp_f32 v229, v229
    v_pk_fma_f32 v[226:227], v[226:227], v[172:173], v[172:173] op_sel:[0,1,1] op_sel_hi:[1,1,1]
    v_pk_fma_f32 v[228:229], v[228:229], v[172:173], v[172:173] op_sel:[0,1,1] op_sel_hi:[1,1,1]
    v_rcp_f32 v226, v226
    v_rcp_f32 v227, v227
    v_rcp_f32 v228, v228
    v_rcp_f32 v229, v229
    v_pk_mul_f32 v[92:93], v[92:93], v[226:227]
    v_pk_mul_f32 v[94:95], v[94:95], v[228:229]
    v_cvt_pk_bf16_f32 v88, v88, v89
    v_cvt_pk_bf16_f32 v89, v90, v91
    v_cvt_pk_bf16_f32 v90, v92, v93
    v_cvt_pk_bf16_f32 v91, v94, v95
    v_or_b32 v88, 1, v88
    ds_write_b128 v244, v[88:91] offset:20480
    s_cmp_eq_u32 s60, 1
    s_cbranch_scc1 G4_p10
    buffer_load_dwordx4 v[180:183], v196, s[84:87], 0 offen offset:0 sc1
    buffer_load_dwordx4 v[188:191], v196, s[88:91], 0 offen offset:0 sc1
    buffer_load_dwordx4 v[184:187], v196, s[84:87], 0 offen offset:2048 sc1
    buffer_load_dwordx4 v[192:195], v196, s[88:91], 0 offen offset:2048 sc1
    s_branch G4_p20
G4_p10:
    s_add_u32 s36, s40, 0
    buffer_load_dwordx4 v[180:183], v2, s[84:87], s36 offen offset:0 sc1
    buffer_load_dwordx4 v[184:187], v2, s[88:91], s36 offen offset:0 sc1
    buffer_load_dwordx4 v[188:191], v2, s[84:87], s36 offen offset:1024 sc1
    buffer_load_dwordx4 v[192:195], v2, s[88:91], s36 offen offset:1024 sc1
    s_add_u32 s36, s40, 65536
    buffer_load_dwordx4 v[196:199], v2, s[84:87], s36 offen offset:0 sc1
    buffer_load_dwordx4 v[230:233], v2, s[88:91], s36 offen offset:0 sc1
    buffer_load_dwordx4 v[234:237], v2, s[84:87], s36 offen offset:1024 sc1
    buffer_load_dwordx4 v[248:251], v2, s[88:91], s36 offen offset:1024 sc1
G4_p20:
    v_pk_fma_f32 v[116:117], v[176:177], v[144:145], v[116:117] op_sel_hi:[0,1,1] neg_lo:[1,0,0] neg_hi:[1,0,0]
    v_pk_fma_f32 v[118:119], v[176:177], v[146:147], v[118:119] op_sel_hi:[0,1,1] neg_lo:[1,0,0] neg_hi:[1,0,0]
    v_pk_mul_f32 v[226:227], v[116:117], v[116:117]
    v_pk_mul_f32 v[228:229], v[118:119], v[118:119]
    v_pk_fma_f32 v[226:227], v[226:227], v[178:179], v[178:179] op_sel:[0,1,0] op_sel_hi:[1,1,0]
    v_pk_fma_f32 v[228:229], v[228:229], v[178:179], v[178:179] op_sel:[0,1,0] op_sel_hi:[1,1,0]
    v_pk_mul_f32 v[226:227], v[226:227], v[116:117]
    v_pk_mul_f32 v[228:229], v[228:229], v[118:119]
    v_exp_f32 v226, v226
    v_exp_f32 v227, v227
    v_exp_f32 v228, v228
    v_exp_f32 v229, v229
    v_pk_fma_f32 v[226:227], v[226:227], v[176:177], v[176:177] op_sel:[0,1,1] op_sel_hi:[1,1,1]
    v_pk_fma_f32 v[228:229], v[228:229], v[176:177], v[176:177] op_sel:[0,1,1] op_sel_hi:[1,1,1]
    v_rcp_f32 v226, v226
    v_rcp_f32 v227, v227
    v_rcp_f32 v228, v228
    v_rcp_f32 v229, v229
    v_pk_mul_f32 v[116:117], v[116:117], v[226:227]
    v_pk_mul_f32 v[118:119], v[118:119], v[228:229]
    v_pk_fma_f32 v[120:121], v[176:177], v[148:149], v[120:121] op_sel_hi:[0,1,1] neg_lo:[1,0,0] neg_hi:[1,0,0]
    v_pk_fma_f32 v[122:123], v[176:177], v[150:151], v[122:123] op_sel_hi:[0,1,1] neg_lo:[1,0,0] neg_hi:[1,0,0]
    v_pk_mul_f32 v[226:227], v[120:121], v[120:121]
    v_pk_mul_f32 v[228:229], v[122:123], v[122:123]
    v_pk_fma_f32 v[226:227], v[226:227], v[178:179], v[178:179] op_sel:[0,1,0] op_sel_hi:[1,1,0]
    v_pk_fma_f32 v[228:229], v[228:229], v[178:179], v[178:179] op_sel:[0,1,0] op_sel_hi:[1,1,0]
    v_pk_mul_f32 v[226:227], v[226:227], v[120:121]
    v_pk_mul_f32 v[228:229], v[228:229], v[122:123]
    v_exp_f32 v226, v226
    v_exp_f32 v227, v227
    v_exp_f32 v228, v228
    v_exp_f32 v229, v229
    v_pk_fma_f32 v[226:227], v[226:227], v[176:177], v[176:177] op_sel:[0,1,1] op_sel_hi:[1,1,1]
    v_pk_fma_f32 v[228:229], v[228:229], v[176:177], v[176:177] op_sel:[0,1,1] op_sel_hi:[1,1,1]
    v_rcp_f32 v226, v226
    v_rcp_f32 v227, v227
    v_rcp_f32 v228, v228
    v_rcp_f32 v229, v229
    v_pk_mul_f32 v[120:121], v[120:121], v[226:227]
    v_pk_mul_f32 v[122:123], v[122:123], v[228:229]
    v_cvt_pk_bf16_f32 v116, v116, v117
    v_cvt_pk_bf16_f32 v117, v118, v119
    v_cvt_pk_bf16_f32 v118, v120, v121
    v_cvt_pk_bf16_f32 v119, v122, v123
    ds_write_b128 v244, v[116:119] offset:22528
    v_pk_fma_f32 v[40:41], v[164:165], v[152:153], v[40:41] op_sel_hi:[0,1,1] neg_lo:[1,0,0] neg_hi:[1,0,0]
    v_pk_fma_f32 v[42:43], v[164:165], v[154:155], v[42:43] op_sel_hi:[0,1,1] neg_lo:[1,0,0] neg_hi:[1,0,0]
    v_pk_mul_f32 v[226:227], v[40:41], v[40:41]
    v_pk_mul_f32 v[228:229], v[42:43], v[42:43]
    v_pk_fma_f32 v[226:227], v[226:227], v[166:167], v[166:167] op_sel:[0,1,0] op_sel_hi:[1,1,0]
    v_pk_fma_f32 v[228:229], v[228:229], v[166:167], v[166:167] op_sel:[0,1,0] op_sel_hi:[1,1,0]
    v_pk_mul_f32 v[226:227], v[226:227], v[40:41]
    v_pk_mul_f32 v[228:229], v[228:229], v[42:43]
    v_exp_f32 v226, v226
    v_exp_f32 v227, v227
    v_exp_f32 v228, v228
    v_exp_f32 v229, v229
    v_pk_fma_f32 v[226:227], v[226:227], v[164:165], v[164:165] op_sel:[0,1,1] op_sel_hi:[1,1,1]
    v_pk_fma_f32 v[228:229], v[228:229], v[164:165], v[164:165] op_sel:[0,1,1] op_sel_hi:[1,1,1]
    v_rcp_f32 v226, v226
    v_rcp_f32 v227, v227
    v_rcp_f32 v228, v228
    v_rcp_f32 v229, v229
    v_pk_mul_f32 v[40:41], v[40:41], v[226:227]
    v_pk_mul_f32 v[42:43], v[42:43], v[228:229]
    v_pk_fma_f32 v[44:45], v[164:165], v[156:157], v[44:45] op_sel_hi:[0,1,1] neg_lo:[1,0,0] neg_hi:[1,0,0]
    v_pk_fma_f32 v[46:47], v[164:165], v[158:159], v[46:47] op_sel_hi:[0,1,1] neg_lo:[1,0,0] neg_hi:[1,0,0]
    v_pk_mul_f32 v[226:227], v[44:45], v[44:45]
    v_pk_mul_f32 v[228:229], v[46:47], v[46:47]
    v_pk_fma_f32 v[226:227], v[226:227], v[166:167], v[166:167] op_sel:[0,1,0] op_sel_hi:[1,1,0]
    v_pk_fma_f32 v[228:229], v[228:229], v[166:167], v[166:167] op_sel:[0,1,0] op_sel_hi:[1,1,0]
    v_pk_mul_f32 v[226:227], v[226:227], v[44:45]
    v_pk_mul_f32 v[228:229], v[228:229], v[46:47]
    v_exp_f32 v226, v226
    v_exp_f32 v227, v227
    v_exp_f32 v228, v228
    v_exp_f32 v229, v229
    v_pk_fma_f32 v[226:227], v[226:227], v[164:165], v[164:165] op_sel:[0,1,1] op_sel_hi:[1,1,1]
    v_pk_fma_f32 v[228:229], v[228:229], v[164:165], v[164:165] op_sel:[0,1,1] op_sel_hi:[1,1,1]
    v_rcp_f32 v226, v226
    v_rcp_f32 v227, v227
    v_rcp_f32 v228, v228
    v_rcp_f32 v229, v229
    v_pk_mul_f32 v[44:45], v[44:45], v[226:227]
    v_pk_mul_f32 v[46:47], v[46:47], v[228:229]
    v_cvt_pk_bf16_f32 v200, v40, v41
    v_cvt_pk_bf16_f32 v201, v42, v43
    v_cvt_pk_bf16_f32 v202, v44, v45
    v_cvt_pk_bf16_f32 v203, v46, v47
    v_or_b32 v200, 1, v200
    ds_write_b128 v244, v[200:203] offset:32768
    v_pk_fma_f32 v[68:69], v[168:169], v[152:153], v[68:69] op_sel_hi:[0,1,1] neg_lo:[1,0,0] neg_hi:[1,0,0]
    v_pk_fma_f32 v[70:71], v[168:169], v[154:155], v[70:71] op_sel_hi:[0,1,1] neg_lo:[1,0,0] neg_hi:[1,0,0]
    v_pk_mul_f32 v[226:227], v[68:69], v[68:69]
    v_pk_mul_f32 v[228:229], v[70:71], v[70:71]
    v_pk_fma_f32 v[226:227], v[226:227], v[170:171], v[170:171] op_sel:[0,1,0] op_sel_hi:[1,1,0]
    v_pk_fma_f32 v[228:229], v[228:229], v[170:171], v[170:171] op_sel:[0,1,0] op_sel_hi:[1,1,0]
    v_pk_mul_f32 v[226:227], v[226:227], v[68:69]
    v_pk_mul_f32 v[228:229], v[228:229], v[70:71]
    v_exp_f32 v226, v226
    v_exp_f32 v227, v227
    v_exp_f32 v228, v228
    v_exp_f32 v229, v229
    v_pk_fma_f32 v[226:227], v[226:227], v[168:169], v[168:169] op_sel:[0,1,1] op_sel_hi:[1,1,1]
    v_pk_fma_f32 v[228:229], v[228:229], v[168:169], v[168:169] op_sel:[0,1,1] op_sel_hi:[1,1,1]
    v_rcp_f32 v226, v226
    v_rcp_f32 v227, v227
    v_rcp_f32 v228, v228
    v_rcp_f32 v229, v229
    v_pk_mul_f32 v[68:69], v[68:69], v[226:227]
    v_pk_mul_f32 v[70:71], v[70:71], v[228:229]
    v_pk_fma_f32 v[72:73], v[168:169], v[156:157], v[72:73] op_sel_hi:[0,1,1] neg_lo:[1,0,0] neg_hi:[1,0,0]
    v_pk_fma_f32 v[74:75], v[168:169], v[158:159], v[74:75] op_sel_hi:[0,1,1] neg_lo:[1,0,0] neg_hi:[1,0,0]
    v_pk_mul_f32 v[226:227], v[72:73], v[72:73]
    v_pk_mul_f32 v[228:229], v[74:75], v[74:75]
    v_pk_fma_f32 v[226:227], v[226:227], v[170:171], v[170:171] op_sel:[0,1,0] op_sel_hi:[1,1,0]
    v_pk_fma_f32 v[228:229], v[228:229], v[170:171], v[170:171] op_sel:[0,1,0] op_sel_hi:[1,1,0]
    v_pk_mul_f32 v[226:227], v[226:227], v[72:73]
    v_pk_mul_f32 v[228:229], v[228:229], v[74:75]
    v_exp_f32 v226, v226
    v_exp_f32 v227, v227
    v_exp_f32 v228, v228
    v_exp_f32 v229, v229
    v_pk_fma_f32 v[226:227], v[226:227], v[168:169], v[168:169] op_sel:[0,1,1] op_sel_hi:[1,1,1]
    v_pk_fma_f32 v[228:229], v[228:229], v[168:169], v[168:169] op_sel:[0,1,1] op_sel_hi:[1,1,1]
    v_rcp_f32 v226, v226
    v_rcp_f32 v227, v227
    v_rcp_f32 v228, v228
    v_rcp_f32 v229, v229
    v_pk_mul_f32 v[72:73], v[72:73], v[226:227]
    v_pk_mul_f32 v[74:75], v[74:75], v[228:229]
    v_cvt_pk_bf16_f32 v204, v68, v69
    v_cvt_pk_bf16_f32 v205, v70, v71
    v_cvt_pk_bf16_f32 v206, v72, v73
    v_cvt_pk_bf16_f32 v207, v74, v75
    v_or_b32 v204, 1, v204
    ds_write_b128 v244, v[204:207] offset:34816
    v_pk_fma_f32 v[96:97], v[172:173], v[152:153], v[96:97] op_sel_hi:[0,1,1] neg_lo:[1,0,0] neg_hi:[1,0,0]
    v_pk_fma_f32 v[98:99], v[172:173], v[154:155], v[98:99] op_sel_hi:[0,1,1] neg_lo:[1,0,0] neg_hi:[1,0,0]
    v_pk_mul_f32 v[226:227], v[96:97], v[96:97]
    v_pk_mul_f32 v[228:229], v[98:99], v[98:99]
    v_pk_fma_f32 v[226:227], v[226:227], v[174:175], v[174:175] op_sel:[0,1,0] op_sel_hi:[1,1,0]
    v_pk_fma_f32 v[228:229], v[228:229], v[174:175], v[174:175] op_sel:[0,1,0] op_sel_hi:[1,1,0]
    v_pk_mul_f32 v[226:227], v[226:227], v[96:97]
    v_pk_mul_f32 v[228:229], v[228:229], v[98:99]
    v_exp_f32 v226, v226
    v_exp_f32 v227, v227
    v_exp_f32 v228, v228
    v_exp_f32 v229, v229
    v_pk_fma_f32 v[226:227], v[226:227], v[172:173], v[172:173] op_sel:[0,1,1] op_sel_hi:[1,1,1]
    v_pk_fma_f32 v[228:229], v[228:229], v[172:173], v[172:173] op_sel:[0,1,1] op_sel_hi:[1,1,1]
    v_rcp_f32 v226, v226
    v_rcp_f32 v227, v227
    v_rcp_f32 v228, v228
    v_rcp_f32 v229, v229
    v_pk_mul_f32 v[96:97], v[96:97], v[226:227]
    v_pk_mul_f32 v[98:99], v[98:99], v[228:229]
    v_pk_fma_f32 v[100:101], v[172:173], v[156:157], v[100:101] op_sel_hi:[0,1,1] neg_lo:[1,0,0] neg_hi:[1,0,0]
    v_pk_fma_f32 v[102:103], v[172:173], v[158:159], v[102:103] op_sel_hi:[0,1,1] neg_lo:[1,0,0] neg_hi:[1,0,0]
    v_pk_mul_f32 v[226:227], v[100:101], v[100:101]
    v_pk_mul_f32 v[228:229], v[102:103], v[102:103]
    v_pk_fma_f32 v[226:227], v[226:227], v[174:175], v[174:175] op_sel:[0,1,0] op_sel_hi:[1,1,0]
    v_pk_fma_f32 v[228:229], v[228:229], v[174:175], v[174:175] op_sel:[0,1,0] op_sel_hi:[1,1,0]
    v_pk_mul_f32 v[226:227], v[226:227], v[100:101]
    v_pk_mul_f32 v[228:229], v[228:229], v[102:103]
    v_exp_f32 v226, v226
    v_exp_f32 v227, v227
    v_exp_f32 v228, v228
    v_exp_f32 v229, v229
    v_pk_fma_f32 v[226:227], v[226:227], v[172:173], v[172:173] op_sel:[0,1,1] op_sel_hi:[1,1,1]
    v_pk_fma_f32 v[228:229], v[228:229], v[172:173], v[172:173] op_sel:[0,1,1] op_sel_hi:[1,1,1]
    v_rcp_f32 v226, v226
    v_rcp_f32 v227, v227
    v_rcp_f32 v228, v228
    v_rcp_f32 v229, v229
    v_pk_mul_f32 v[100:101], v[100:101], v[226:227]
    v_pk_mul_f32 v[102:103], v[102:103], v[228:229]
    v_cvt_pk_bf16_f32 v208, v96, v97
    v_cvt_pk_bf16_f32 v209, v98, v99
    v_cvt_pk_bf16_f32 v210, v100, v101
    v_cvt_pk_bf16_f32 v211, v102, v103
    v_or_b32 v208, 1, v208
    ds_write_b128 v244, v[208:211] offset:36864
    v_pk_fma_f32 v[124:125], v[176:177], v[152:153], v[124:125] op_sel_hi:[0,1,1] neg_lo:[1,0,0] neg_hi:[1,0,0]
    v_pk_fma_f32 v[126:127], v[176:177], v[154:155], v[126:127] op_sel_hi:[0,1,1] neg_lo:[1,0,0] neg_hi:[1,0,0]
    v_pk_mul_f32 v[226:227], v[124:125], v[124:125]
    v_pk_mul_f32 v[228:229], v[126:127], v[126:127]
    v_pk_fma_f32 v[226:227], v[226:227], v[178:179], v[178:179] op_sel:[0,1,0] op_sel_hi:[1,1,0]
    v_pk_fma_f32 v[228:229], v[228:229], v[178:179], v[178:179] op_sel:[0,1,0] op_sel_hi:[1,1,0]
    v_pk_mul_f32 v[226:227], v[226:227], v[124:125]
    v_pk_mul_f32 v[228:229], v[228:229], v[126:127]
    v_exp_f32 v226, v226
    v_exp_f32 v227, v227
    v_exp_f32 v228, v228
    v_exp_f32 v229, v229
    v_pk_fma_f32 v[226:227], v[226:227], v[176:177], v[176:177] op_sel:[0,1,1] op_sel_hi:[1,1,1]
    v_pk_fma_f32 v[228:229], v[228:229], v[176:177], v[176:177] op_sel:[0,1,1] op_sel_hi:[1,1,1]
    v_rcp_f32 v226, v226
    v_rcp_f32 v227, v227
    v_rcp_f32 v228, v228
    v_rcp_f32 v229, v229
    v_pk_mul_f32 v[124:125], v[124:125], v[226:227]
    v_pk_mul_f32 v[126:127], v[126:127], v[228:229]
    v_pk_fma_f32 v[128:129], v[176:177], v[156:157], v[128:129] op_sel_hi:[0,1,1] neg_lo:[1,0,0] neg_hi:[1,0,0]
    v_pk_fma_f32 v[130:131], v[176:177], v[158:159], v[130:131] op_sel_hi:[0,1,1] neg_lo:[1,0,0] neg_hi:[1,0,0]
    v_pk_mul_f32 v[226:227], v[128:129], v[128:129]
    v_pk_mul_f32 v[228:229], v[130:131], v[130:131]
    v_pk_fma_f32 v[226:227], v[226:227], v[178:179], v[178:179] op_sel:[0,1,0] op_sel_hi:[1,1,0]
    v_pk_fma_f32 v[228:229], v[228:229], v[178:179], v[178:179] op_sel:[0,1,0] op_sel_hi:[1,1,0]
    v_pk_mul_f32 v[226:227], v[226:227], v[128:129]
    v_pk_mul_f32 v[228:229], v[228:229], v[130:131]
    v_exp_f32 v226, v226
    v_exp_f32 v227, v227
    v_exp_f32 v228, v228
    v_exp_f32 v229, v229
    v_pk_fma_f32 v[226:227], v[226:227], v[176:177], v[176:177] op_sel:[0,1,1] op_sel_hi:[1,1,1]
    v_pk_fma_f32 v[228:229], v[228:229], v[176:177], v[176:177] op_sel:[0,1,1] op_sel_hi:[1,1,1]
    v_rcp_f32 v226, v226
    v_rcp_f32 v227, v227
    v_rcp_f32 v228, v228
    v_rcp_f32 v229, v229
    v_pk_mul_f32 v[128:129], v[128:129], v[226:227]
    v_pk_mul_f32 v[130:131], v[130:131], v[228:229]
    v_cvt_pk_bf16_f32 v212, v124, v125
    v_cvt_pk_bf16_f32 v213, v126, v127
    v_cvt_pk_bf16_f32 v214, v128, v129
    v_cvt_pk_bf16_f32 v215, v130, v131
    ds_write_b128 v244, v[212:215] offset:38912
    v_pk_fma_f32 v[48:49], v[164:165], v[160:161], v[48:49] op_sel_hi:[0,1,1] neg_lo:[1,0,0] neg_hi:[1,0,0]
    v_pk_fma_f32 v[50:51], v[164:165], v[162:163], v[50:51] op_sel_hi:[0,1,1] neg_lo:[1,0,0] neg_hi:[1,0,0]
    v_pk_mul_f32 v[226:227], v[48:49], v[48:49]
    v_pk_mul_f32 v[228:229], v[50:51], v[50:51]
    v_pk_fma_f32 v[226:227], v[226:227], v[166:167], v[166:167] op_sel:[0,1,0] op_sel_hi:[1,1,0]
    v_pk_fma_f32 v[228:229], v[228:229], v[166:167], v[166:167] op_sel:[0,1,0] op_sel_hi:[1,1,0]
    v_pk_mul_f32 v[226:227], v[226:227], v[48:49]
    v_pk_mul_f32 v[228:229], v[228:229], v[50:51]
    v_exp_f32 v226, v226
    v_exp_f32 v227, v227
    v_exp_f32 v228, v228
    v_exp_f32 v229, v229
    v_pk_fma_f32 v[226:227], v[226:227], v[164:165], v[164:165] op_sel:[0,1,1] op_sel_hi:[1,1,1]
    v_pk_fma_f32 v[228:229], v[228:229], v[164:165], v[164:165] op_sel:[0,1,1] op_sel_hi:[1,1,1]
    v_rcp_f32 v226, v226
    v_rcp_f32 v227, v227
    v_rcp_f32 v228, v228
    v_rcp_f32 v229, v229
    v_pk_mul_f32 v[48:49], v[48:49], v[226:227]
    v_pk_mul_f32 v[50:51], v[50:51], v[228:229]
    v_cvt_pk_bf16_f32 v216, v48, v49
    v_cvt_pk_bf16_f32 v217, v50, v51
    v_or_b32 v216, 1, v216
    s_add_u32 s36, s45, 0
    buffer_store_dwordx4 v[32:35], v2, s[16:19], s36 offen sc1
    v_pk_fma_f32 v[76:77], v[168:169], v[160:161], v[76:77] op_sel_hi:[0,1,1] neg_lo:[1,0,0] neg_hi:[1,0,0]
    v_pk_fma_f32 v[78:79], v[168:169], v[162:163], v[78:79] op_sel_hi:[0,1,1] neg_lo:[1,0,0] neg_hi:[1,0,0]
    v_pk_mul_f32 v[226:227], v[76:77], v[76:77]
    v_pk_mul_f32 v[228:229], v[78:79], v[78:79]
    v_pk_fma_f32 v[226:227], v[226:227], v[170:171], v[170:171] op_sel:[0,1,0] op_sel_hi:[1,1,0]
    v_pk_fma_f32 v[228:229], v[228:229], v[170:171], v[170:171] op_sel:[0,1,0] op_sel_hi:[1,1,0]
    v_pk_mul_f32 v[226:227], v[226:227], v[76:77]
    v_pk_mul_f32 v[228:229], v[228:229], v[78:79]
    v_exp_f32 v226, v226
    v_exp_f32 v227, v227
    v_exp_f32 v228, v228
    v_exp_f32 v229, v229
    v_pk_fma_f32 v[226:227], v[226:227], v[168:169], v[168:169] op_sel:[0,1,1] op_sel_hi:[1,1,1]
    v_pk_fma_f32 v[228:229], v[228:229], v[168:169], v[168:169] op_sel:[0,1,1] op_sel_hi:[1,1,1]
    v_rcp_f32 v226, v226
    v_rcp_f32 v227, v227
    v_rcp_f32 v228, v228
    v_rcp_f32 v229, v229
    v_pk_mul_f32 v[76:77], v[76:77], v[226:227]
    v_pk_mul_f32 v[78:79], v[78:79], v[228:229]
    v_cvt_pk_bf16_f32 v218, v76, v77
    v_cvt_pk_bf16_f32 v219, v78, v79
    v_or_b32 v218, 1, v218
    s_add_u32 s36, s45, 229376
    buffer_store_dwordx4 v[60:63], v2, s[16:19], s36 offen sc1
    v_pk_fma_f32 v[104:105], v[172:173], v[160:161], v[104:105] op_sel_hi:[0,1,1] neg_lo:[1,0,0] neg_hi:[1,0,0]
    v_pk_fma_f32 v[106:107], v[172:173], v[162:163], v[106:107] op_sel_hi:[0,1,1] neg_lo:[1,0,0] neg_hi:[1,0,0]
    v_pk_mul_f32 v[226:227], v[104:105], v[104:105]
    v_pk_mul_f32 v[228:229], v[106:107], v[106:107]
    v_pk_fma_f32 v[226:227], v[226:227], v[174:175], v[174:175] op_sel:[0,1,0] op_sel_hi:[1,1,0]
    v_pk_fma_f32 v[228:229], v[228:229], v[174:175], v[174:175] op_sel:[0,1,0] op_sel_hi:[1,1,0]
    v_pk_mul_f32 v[226:227], v[226:227], v[104:105]
    v_pk_mul_f32 v[228:229], v[228:229], v[106:107]
    v_exp_f32 v226, v226
    v_exp_f32 v227, v227
    v_exp_f32 v228, v228
    v_exp_f32 v229, v229
    v_pk_fma_f32 v[226:227], v[226:227], v[172:173], v[172:173] op_sel:[0,1,1] op_sel_hi:[1,1,1]
    v_pk_fma_f32 v[228:229], v[228:229], v[172:173], v[172:173] op_sel:[0,1,1] op_sel_hi:[1,1,1]
    v_rcp_f32 v226, v226
    v_rcp_f32 v227, v227
    v_rcp_f32 v228, v228
    v_rcp_f32 v229, v229
    v_pk_mul_f32 v[104:105], v[104:105], v[226:227]
    v_pk_mul_f32 v[106:107], v[106:107], v[228:229]
    v_cvt_pk_bf16_f32 v220, v104, v105
    v_cvt_pk_bf16_f32 v221, v106, v107
    v_or_b32 v220, 1, v220
    s_add_u32 s36, s45, 458752
    buffer_store_dwordx4 v[88:91], v2, s[16:19], s36 offen sc1
    v_pk_fma_f32 v[132:133], v[176:177], v[160:161], v[132:133] op_sel_hi:[0,1,1] neg_lo:[1,0,0] neg_hi:[1,0,0]
    v_pk_fma_f32 v[134:135], v[176:177], v[162:163], v[134:135] op_sel_hi:[0,1,1] neg_lo:[1,0,0] neg_hi:[1,0,0]
    v_pk_mul_f32 v[226:227], v[132:133], v[132:133]
    v_pk_mul_f32 v[228:229], v[134:135], v[134:135]
    v_pk_fma_f32 v[226:227], v[226:227], v[178:179], v[178:179] op_sel:[0,1,0] op_sel_hi:[1,1,0]
    v_pk_fma_f32 v[228:229], v[228:229], v[178:179], v[178:179] op_sel:[0,1,0] op_sel_hi:[1,1,0]
    v_pk_mul_f32 v[226:227], v[226:227], v[132:133]
    v_pk_mul_f32 v[228:229], v[228:229], v[134:135]
    v_exp_f32 v226, v226
    v_exp_f32 v227, v227
    v_exp_f32 v228, v228
    v_exp_f32 v229, v229
    v_pk_fma_f32 v[226:227], v[226:227], v[176:177], v[176:177] op_sel:[0,1,1] op_sel_hi:[1,1,1]
    v_pk_fma_f32 v[228:229], v[228:229], v[176:177], v[176:177] op_sel:[0,1,1] op_sel_hi:[1,1,1]
    v_rcp_f32 v226, v226
    v_rcp_f32 v227, v227
    v_rcp_f32 v228, v228
    v_rcp_f32 v229, v229
    v_pk_mul_f32 v[132:133], v[132:133], v[226:227]
    v_pk_mul_f32 v[134:135], v[134:135], v[228:229]
    v_cvt_pk_bf16_f32 v222, v132, v133
    v_cvt_pk_bf16_f32 v223, v134, v135
    s_add_u32 s36, s45, 688128
    buffer_store_dwordx4 v[116:119], v2, s[16:19], s36 offen sc1
    s_waitcnt lgkmcnt(0)
    s_mov_b32 s44, s46
    s_mov_b32 s45, s47
    s_branch G3_e2
G3_e1:
    v_pk_fma_f32 v[28:29], v[164:165], v[140:141], v[28:29] op_sel_hi:[0,1,1] neg_lo:[1,0,0] neg_hi:[1,0,0]
    v_pk_fma_f32 v[30:31], v[164:165], v[142:143], v[30:31] op_sel_hi:[0,1,1] neg_lo:[1,0,0] neg_hi:[1,0,0]
    v_pk_mul_f32 v[226:227], v[28:29], v[28:29]
    v_pk_mul_f32 v[228:229], v[30:31], v[30:31]
    v_pk_fma_f32 v[226:227], v[226:227], v[166:167], v[166:167] op_sel:[0,1,0] op_sel_hi:[1,1,0]
    v_pk_fma_f32 v[228:229], v[228:229], v[166:167], v[166:167] op_sel:[0,1,0] op_sel_hi:[1,1,0]
    v_pk_mul_f32 v[226:227], v[226:227], v[28:29]
    v_pk_mul_f32 v[228:229], v[228:229], v[30:31]
    v_exp_f32 v226, v226
    v_exp_f32 v227, v227
    v_exp_f32 v228, v228
    v_exp_f32 v229, v229
    v_pk_fma_f32 v[226:227], v[226:227], v[164:165], v[164:165] op_sel:[0,1,1] op_sel_hi:[1,1,1]
    v_pk_fma_f32 v[228:229], v[228:229], v[164:165], v[164:165] op_sel:[0,1,1] op_sel_hi:[1,1,1]
    v_rcp_f32 v226, v226
    v_rcp_f32 v227, v227
    v_rcp_f32 v228, v228
    v_rcp_f32 v229, v229
    v_pk_mul_f32 v[28:29], v[28:29], v[226:227]
    v_pk_mul_f32 v[30:31], v[30:31], v[228:229]
    v_pk_fma_f32 v[32:33], v[164:165], v[144:145], v[32:33] op_sel_hi:[0,1,1] neg_lo:[1,0,0] neg_hi:[1,0,0]
    v_pk_fma_f32 v[34:35], v[164:165], v[146:147], v[34:35] op_sel_hi:[0,1,1] neg_lo:[1,0,0] neg_hi:[1,0,0]
    v_pk_mul_f32 v[226:227], v[32:33], v[32:33]
    v_pk_mul_f32 v[228:229], v[34:35], v[34:35]
    v_pk_fma_f32 v[226:227], v[226:227], v[166:167], v[166:167] op_sel:[0,1,0] op_sel_hi:[1,1,0]
    v_pk_fma_f32 v[228:229], v[228:229], v[166:167], v[166:167] op_sel:[0,1,0] op_sel_hi:[1,1,0]
    v_pk_mul_f32 v[226:227], v[226:227], v[32:33]
    v_pk_mul_f32 v[228:229], v[228:229], v[34:35]
    v_exp_f32 v226, v226
    v_exp_f32 v227, v227
    v_exp_f32 v228, v228
    v_exp_f32 v229, v229
    v_pk_fma_f32 v[226:227], v[226:227], v[164:165], v[164:165] op_sel:[0,1,1] op_sel_hi:[1,1,1]
    v_pk_fma_f32 v[228:229], v[228:229], v[164:165], v[164:165] op_sel:[0,1,1] op_sel_hi:[1,1,1]
    v_rcp_f32 v226, v226
    v_rcp_f32 v227, v227
    v_rcp_f32 v228, v228
    v_rcp_f32 v229, v229
    v_pk_mul_f32 v[32:33], v[32:33], v[226:227]
    v_pk_mul_f32 v[34:35], v[34:35], v[228:229]
    v_cvt_pk_bf16_f32 v28, v28, v29
    v_cvt_pk_bf16_f32 v29, v30, v31
    v_cvt_pk_bf16_f32 v30, v32, v33
    v_cvt_pk_bf16_f32 v31, v34, v35
    v_or_b32 v28, 1, v28
    ds_write_b128 v244, v[28:31] offset:0
    s_add_u32 s36, s45, 0
    buffer_store_dwordx4 v[28:31], v2, s[16:19], s36 offen sc1
    v_pk_fma_f32 v[56:57], v[168:169], v[140:141], v[56:57] op_sel_hi:[0,1,1] neg_lo:[1,0,0] neg_hi:[1,0,0]
    v_pk_fma_f32 v[58:59], v[168:169], v[142:143], v[58:59] op_sel_hi:[0,1,1] neg_lo:[1,0,0] neg_hi:[1,0,0]
    v_pk_mul_f32 v[226:227], v[56:57], v[56:57]
    v_pk_mul_f32 v[228:229], v[58:59], v[58:59]
    v_pk_fma_f32 v[226:227], v[226:227], v[170:171], v[170:171] op_sel:[0,1,0] op_sel_hi:[1,1,0]
    v_pk_fma_f32 v[228:229], v[228:229], v[170:171], v[170:171] op_sel:[0,1,0] op_sel_hi:[1,1,0]
    v_pk_mul_f32 v[226:227], v[226:227], v[56:57]
    v_pk_mul_f32 v[228:229], v[228:229], v[58:59]
    v_exp_f32 v226, v226
    v_exp_f32 v227, v227
    v_exp_f32 v228, v228
    v_exp_f32 v229, v229
    v_pk_fma_f32 v[226:227], v[226:227], v[168:169], v[168:169] op_sel:[0,1,1] op_sel_hi:[1,1,1]
    v_pk_fma_f32 v[228:229], v[228:229], v[168:169], v[168:169] op_sel:[0,1,1] op_sel_hi:[1,1,1]
    v_rcp_f32 v226, v226
    v_rcp_f32 v227, v227
    v_rcp_f32 v228, v228
    v_rcp_f32 v229, v229
    v_pk_mul_f32 v[56:57], v[56:57], v[226:227]
    v_pk_mul_f32 v[58:59], v[58:59], v[228:229]
    v_pk_fma_f32 v[60:61], v[168:169], v[144:145], v[60:61] op_sel_hi:[0,1,1] neg_lo:[1,0,0] neg_hi:[1,0,0]
    v_pk_fma_f32 v[62:63], v[168:169], v[146:147], v[62:63] op_sel_hi:[0,1,1] neg_lo:[1,0,0] neg_hi:[1,0,0]
    v_pk_mul_f32 v[226:227], v[60:61], v[60:61]
    v_pk_mul_f32 v[228:229], v[62:63], v[62:63]
    v_pk_fma_f32 v[226:227], v[226:227], v[170:171], v[170:171] op_sel:[0,1,0] op_sel_hi:[1,1,0]
    v_pk_fma_f32 v[228:229], v[228:229], v[170:171], v[170:171] op_sel:[0,1,0] op_sel_hi:[1,1,0]
    v_pk_mul_f32 v[226:227], v[226:227], v[60:61]
    v_pk_mul_f32 v[228:229], v[228:229], v[62:63]
    v_exp_f32 v226, v226
    v_exp_f32 v227, v227
    v_exp_f32 v228, v228
    v_exp_f32 v229, v229
    v_pk_fma_f32 v[226:227], v[226:227], v[168:169], v[168:169] op_sel:[0,1,1] op_sel_hi:[1,1,1]
    v_pk_fma_f32 v[228:229], v[228:229], v[168:169], v[168:169] op_sel:[0,1,1] op_sel_hi:[1,1,1]
    v_rcp_f32 v226, v226
    v_rcp_f32 v227, v227
    v_rcp_f32 v228, v228
    v_rcp_f32 v229, v229
    v_pk_mul_f32 v[60:61], v[60:61], v[226:227]
    v_pk_mul_f32 v[62:63], v[62:63], v[228:229]
    v_cvt_pk_bf16_f32 v56, v56, v57
    v_cvt_pk_bf16_f32 v57, v58, v59
    v_cvt_pk_bf16_f32 v58, v60, v61
    v_cvt_pk_bf16_f32 v59, v62, v63
    v_or_b32 v56, 1, v56
    ds_write_b128 v244, v[56:59] offset:2048
    s_add_u32 s36, s45, 229376
    buffer_store_dwordx4 v[56:59], v2, s[16:19], s36 offen sc1
    v_pk_fma_f32 v[84:85], v[172:173], v[140:141], v[84:85] op_sel_hi:[0,1,1] neg_lo:[1,0,0] neg_hi:[1,0,0]
    v_pk_fma_f32 v[86:87], v[172:173], v[142:143], v[86:87] op_sel_hi:[0,1,1] neg_lo:[1,0,0] neg_hi:[1,0,0]
    v_pk_mul_f32 v[226:227], v[84:85], v[84:85]
    v_pk_mul_f32 v[228:229], v[86:87], v[86:87]
    v_pk_fma_f32 v[226:227], v[226:227], v[174:175], v[174:175] op_sel:[0,1,0] op_sel_hi:[1,1,0]
    v_pk_fma_f32 v[228:229], v[228:229], v[174:175], v[174:175] op_sel:[0,1,0] op_sel_hi:[1,1,0]
    v_pk_mul_f32 v[226:227], v[226:227], v[84:85]
    v_pk_mul_f32 v[228:229], v[228:229], v[86:87]
    v_exp_f32 v226, v226
    v_exp_f32 v227, v227
    v_exp_f32 v228, v228
    v_exp_f32 v229, v229
    v_pk_fma_f32 v[226:227], v[226:227], v[172:173], v[172:173] op_sel:[0,1,1] op_sel_hi:[1,1,1]
    v_pk_fma_f32 v[228:229], v[228:229], v[172:173], v[172:173] op_sel:[0,1,1] op_sel_hi:[1,1,1]
    v_rcp_f32 v226, v226
    v_rcp_f32 v227, v227
    v_rcp_f32 v228, v228
    v_rcp_f32 v229, v229
    v_pk_mul_f32 v[84:85], v[84:85], v[226:227]
    v_pk_mul_f32 v[86:87], v[86:87], v[228:229]
    v_pk_fma_f32 v[88:89], v[172:173], v[144:145], v[88:89] op_sel_hi:[0,1,1] neg_lo:[1,0,0] neg_hi:[1,0,0]
    v_pk_fma_f32 v[90:91], v[172:173], v[146:147], v[90:91] op_sel_hi:[0,1,1] neg_lo:[1,0,0] neg_hi:[1,0,0]
    v_pk_mul_f32 v[226:227], v[88:89], v[88:89]
    v_pk_mul_f32 v[228:229], v[90:91], v[90:91]
    v_pk_fma_f32 v[226:227], v[226:227], v[174:175], v[174:175] op_sel:[0,1,0] op_sel_hi:[1,1,0]
    v_pk_fma_f32 v[228:229], v[228:229], v[174:175], v[174:175] op_sel:[0,1,0] op_sel_hi:[1,1,0]
    v_pk_mul_f32 v[226:227], v[226:227], v[88:89]
    v_pk_mul_f32 v[228:229], v[228:229], v[90:91]
    v_exp_f32 v226, v226
    v_exp_f32 v227, v227
    v_exp_f32 v228, v228
    v_exp_f32 v229, v229
    v_pk_fma_f32 v[226:227], v[226:227], v[172:173], v[172:173] op_sel:[0,1,1] op_sel_hi:[1,1,1]
    v_pk_fma_f32 v[228:229], v[228:229], v[172:173], v[172:173] op_sel:[0,1,1] op_sel_hi:[1,1,1]
    v_rcp_f32 v226, v226
    v_rcp_f32 v227, v227
    v_rcp_f32 v228, v228
    v_rcp_f32 v229, v229
    v_pk_mul_f32 v[88:89], v[88:89], v[226:227]
    v_pk_mul_f32 v[90:91], v[90:91], v[228:229]
    v_cvt_pk_bf16_f32 v84, v84, v85
    v_cvt_pk_bf16_f32 v85, v86, v87
    v_cvt_pk_bf16_f32 v86, v88, v89
    v_cvt_pk_bf16_f32 v87, v90, v91
    v_or_b32 v84, 1, v84
    ds_write_b128 v244, v[84:87] offset:4096
    s_add_u32 s36, s45, 458752
    buffer_store_dwordx4 v[84:87], v2, s[16:19], s36 offen sc1
    v_pk_fma_f32 v[112:113], v[176:177], v[140:141], v[112:113] op_sel_hi:[0,1,1] neg_lo:[1,0,0] neg_hi:[1,0,0]
    v_pk_fma_f32 v[114:115], v[176:177], v[142:143], v[114:115] op_sel_hi:[0,1,1] neg_lo:[1,0,0] neg_hi:[1,0,0]
    v_pk_mul_f32 v[226:227], v[112:113], v[112:113]
    v_pk_mul_f32 v[228:229], v[114:115], v[114:115]
    v_pk_fma_f32 v[226:227], v[226:227], v[178:179], v[178:179] op_sel:[0,1,0] op_sel_hi:[1,1,0]
    v_pk_fma_f32 v[228:229], v[228:229], v[178:179], v[178:179] op_sel:[0,1,0] op_sel_hi:[1,1,0]
    v_pk_mul_f32 v[226:227], v[226:227], v[112:113]
    v_pk_mul_f32 v[228:229], v[228:229], v[114:115]
    v_exp_f32 v226, v226
    v_exp_f32 v227, v227
    v_exp_f32 v228, v228
    v_exp_f32 v229, v229
    v_pk_fma_f32 v[226:227], v[226:227], v[176:177], v[176:177] op_sel:[0,1,1] op_sel_hi:[1,1,1]
    v_pk_fma_f32 v[228:229], v[228:229], v[176:177], v[176:177] op_sel:[0,1,1] op_sel_hi:[1,1,1]
    v_rcp_f32 v226, v226
    v_rcp_f32 v227, v227
    v_rcp_f32 v228, v228
    v_rcp_f32 v229, v229
    v_pk_mul_f32 v[112:113], v[112:113], v[226:227]
    v_pk_mul_f32 v[114:115], v[114:115], v[228:229]
    v_pk_fma_f32 v[116:117], v[176:177], v[144:145], v[116:117] op_sel_hi:[0,1,1] neg_lo:[1,0,0] neg_hi:[1,0,0]
    v_pk_fma_f32 v[118:119], v[176:177], v[146:147], v[118:119] op_sel_hi:[0,1,1] neg_lo:[1,0,0] neg_hi:[1,0,0]
    v_pk_mul_f32 v[226:227], v[116:117], v[116:117]
    v_pk_mul_f32 v[228:229], v[118:119], v[118:119]
    v_pk_fma_f32 v[226:227], v[226:227], v[178:179], v[178:179] op_sel:[0,1,0] op_sel_hi:[1,1,0]
    v_pk_fma_f32 v[228:229], v[228:229], v[178:179], v[178:179] op_sel:[0,1,0] op_sel_hi:[1,1,0]
    v_pk_mul_f32 v[226:227], v[226:227], v[116:117]
    v_pk_mul_f32 v[228:229], v[228:229], v[118:119]
    v_exp_f32 v226, v226
    v_exp_f32 v227, v227
    v_exp_f32 v228, v228
    v_exp_f32 v229, v229
    v_pk_fma_f32 v[226:227], v[226:227], v[176:177], v[176:177] op_sel:[0,1,1] op_sel_hi:[1,1,1]
    v_pk_fma_f32 v[228:229], v[228:229], v[176:177], v[176:177] op_sel:[0,1,1] op_sel_hi:[1,1,1]
    v_rcp_f32 v226, v226
    v_rcp_f32 v227, v227
    v_rcp_f32 v228, v228
    v_rcp_f32 v229, v229
    v_pk_mul_f32 v[116:117], v[116:117], v[226:227]
    v_pk_mul_f32 v[118:119], v[118:119], v[228:229]
    v_cvt_pk_bf16_f32 v112, v112, v113
    v_cvt_pk_bf16_f32 v113, v114, v115
    v_cvt_pk_bf16_f32 v114, v116, v117
    v_cvt_pk_bf16_f32 v115, v118, v119
    ds_write_b128 v244, v[112:115] offset:6144
    s_add_u32 s36, s45, 688128
    buffer_store_dwordx4 v[112:115], v2, s[16:19], s36 offen sc1
    v_pk_fma_f32 v[36:37], v[164:165], v[148:149], v[36:37] op_sel_hi:[0,1,1] neg_lo:[1,0,0] neg_hi:[1,0,0]
    v_pk_fma_f32 v[38:39], v[164:165], v[150:151], v[38:39] op_sel_hi:[0,1,1] neg_lo:[1,0,0] neg_hi:[1,0,0]
    v_pk_mul_f32 v[226:227], v[36:37], v[36:37]
    v_pk_mul_f32 v[228:229], v[38:39], v[38:39]
    v_pk_fma_f32 v[226:227], v[226:227], v[166:167], v[166:167] op_sel:[0,1,0] op_sel_hi:[1,1,0]
    v_pk_fma_f32 v[228:229], v[228:229], v[166:167], v[166:167] op_sel:[0,1,0] op_sel_hi:[1,1,0]
    v_pk_mul_f32 v[226:227], v[226:227], v[36:37]
    v_pk_mul_f32 v[228:229], v[228:229], v[38:39]
    v_exp_f32 v226, v226
    v_exp_f32 v227, v227
    v_exp_f32 v228, v228
    v_exp_f32 v229, v229
    v_pk_fma_f32 v[226:227], v[226:227], v[164:165], v[164:165] op_sel:[0,1,1] op_sel_hi:[1,1,1]
    v_pk_fma_f32 v[228:229], v[228:229], v[164:165], v[164:165] op_sel:[0,1,1] op_sel_hi:[1,1,1]
    v_rcp_f32 v226, v226
    v_rcp_f32 v227, v227
    v_rcp_f32 v228, v228
    v_rcp_f32 v229, v229
    v_pk_mul_f32 v[36:37], v[36:37], v[226:227]
    v_pk_mul_f32 v[38:39], v[38:39], v[228:229]
    v_pk_fma_f32 v[40:41], v[164:165], v[152:153], v[40:41] op_sel_hi:[0,1,1] neg_lo:[1,0,0] neg_hi:[1,0,0]
    v_pk_fma_f32 v[42:43], v[164:165], v[154:155], v[42:43] op_sel_hi:[0,1,1] neg_lo:[1,0,0] neg_hi:[1,0,0]
    v_pk_mul_f32 v[226:227], v[40:41], v[40:41]
    v_pk_mul_f32 v[228:229], v[42:43], v[42:43]
    v_pk_fma_f32 v[226:227], v[226:227], v[166:167], v[166:167] op_sel:[0,1,0] op_sel_hi:[1,1,0]
    v_pk_fma_f32 v[228:229], v[228:229], v[166:167], v[166:167] op_sel:[0,1,0] op_sel_hi:[1,1,0]
    v_pk_mul_f32 v[226:227], v[226:227], v[40:41]
    v_pk_mul_f32 v[228:229], v[228:229], v[42:43]
    v_exp_f32 v226, v226
    v_exp_f32 v227, v227
    v_exp_f32 v228, v228
    v_exp_f32 v229, v229
    v_pk_fma_f32 v[226:227], v[226:227], v[164:165], v[164:165] op_sel:[0,1,1] op_sel_hi:[1,1,1]
    v_pk_fma_f32 v[228:229], v[228:229], v[164:165], v[164:165] op_sel:[0,1,1] op_sel_hi:[1,1,1]
    v_rcp_f32 v226, v226
    v_rcp_f32 v227, v227
    v_rcp_f32 v228, v228
    v_rcp_f32 v229, v229
    v_pk_mul_f32 v[40:41], v[40:41], v[226:227]
    v_pk_mul_f32 v[42:43], v[42:43], v[228:229]
    v_cvt_pk_bf16_f32 v36, v36, v37
    v_cvt_pk_bf16_f32 v37, v38, v39
    v_cvt_pk_bf16_f32 v38, v40, v41
    v_cvt_pk_bf16_f32 v39, v42, v43
    v_or_b32 v36, 1, v36
    ds_write_b128 v244, v[36:39] offset:16384
    v_pk_fma_f32 v[64:65], v[168:169], v[148:149], v[64:65] op_sel_hi:[0,1,1] neg_lo:[1,0,0] neg_hi:[1,0,0]
    v_pk_fma_f32 v[66:67], v[168:169], v[150:151], v[66:67] op_sel_hi:[0,1,1] neg_lo:[1,0,0] neg_hi:[1,0,0]
    v_pk_mul_f32 v[226:227], v[64:65], v[64:65]
    v_pk_mul_f32 v[228:229], v[66:67], v[66:67]
    v_pk_fma_f32 v[226:227], v[226:227], v[170:171], v[170:171] op_sel:[0,1,0] op_sel_hi:[1,1,0]
    v_pk_fma_f32 v[228:229], v[228:229], v[170:171], v[170:171] op_sel:[0,1,0] op_sel_hi:[1,1,0]
    v_pk_mul_f32 v[226:227], v[226:227], v[64:65]
    v_pk_mul_f32 v[228:229], v[228:229], v[66:67]
    v_exp_f32 v226, v226
    v_exp_f32 v227, v227
    v_exp_f32 v228, v228
    v_exp_f32 v229, v229
    v_pk_fma_f32 v[226:227], v[226:227], v[168:169], v[168:169] op_sel:[0,1,1] op_sel_hi:[1,1,1]
    v_pk_fma_f32 v[228:229], v[228:229], v[168:169], v[168:169] op_sel:[0,1,1] op_sel_hi:[1,1,1]
    v_rcp_f32 v226, v226
    v_rcp_f32 v227, v227
    v_rcp_f32 v228, v228
    v_rcp_f32 v229, v229
    v_pk_mul_f32 v[64:65], v[64:65], v[226:227]
    v_pk_mul_f32 v[66:67], v[66:67], v[228:229]
    v_pk_fma_f32 v[68:69], v[168:169], v[152:153], v[68:69] op_sel_hi:[0,1,1] neg_lo:[1,0,0] neg_hi:[1,0,0]
    v_pk_fma_f32 v[70:71], v[168:169], v[154:155], v[70:71] op_sel_hi:[0,1,1] neg_lo:[1,0,0] neg_hi:[1,0,0]
    v_pk_mul_f32 v[226:227], v[68:69], v[68:69]
    v_pk_mul_f32 v[228:229], v[70:71], v[70:71]
    v_pk_fma_f32 v[226:227], v[226:227], v[170:171], v[170:171] op_sel:[0,1,0] op_sel_hi:[1,1,0]
    v_pk_fma_f32 v[228:229], v[228:229], v[170:171], v[170:171] op_sel:[0,1,0] op_sel_hi:[1,1,0]
    v_pk_mul_f32 v[226:227], v[226:227], v[68:69]
    v_pk_mul_f32 v[228:229], v[228:229], v[70:71]
    v_exp_f32 v226, v226
    v_exp_f32 v227, v227
    v_exp_f32 v228, v228
    v_exp_f32 v229, v229
    v_pk_fma_f32 v[226:227], v[226:227], v[168:169], v[168:169] op_sel:[0,1,1] op_sel_hi:[1,1,1]
    v_pk_fma_f32 v[228:229], v[228:229], v[168:169], v[168:169] op_sel:[0,1,1] op_sel_hi:[1,1,1]
    v_rcp_f32 v226, v226
    v_rcp_f32 v227, v227
    v_rcp_f32 v228, v228
    v_rcp_f32 v229, v229
    v_pk_mul_f32 v[68:69], v[68:69], v[226:227]
    v_pk_mul_f32 v[70:71], v[70:71], v[228:229]
    v_cvt_pk_bf16_f32 v64, v64, v65
    v_cvt_pk_bf16_f32 v65, v66, v67
    v_cvt_pk_bf16_f32 v66, v68, v69
    v_cvt_pk_bf16_f32 v67, v70, v71
    v_or_b32 v64, 1, v64
    ds_write_b128 v244, v[64:67] offset:18432
    s_waitcnt vmcnt(0)
    s_mov_b64 exec, 1
    ds_add_u32 v246, v245
    s_mov_b64 exec, -1
    v_pk_fma_f32 v[92:93], v[172:173], v[148:149], v[92:93] op_sel_hi:[0,1,1] neg_lo:[1,0,0] neg_hi:[1,0,0]
    v_pk_fma_f32 v[94:95], v[172:173], v[150:151], v[94:95] op_sel_hi:[0,1,1] neg_lo:[1,0,0] neg_hi:[1,0,0]
    v_pk_mul_f32 v[226:227], v[92:93], v[92:93]
    v_pk_mul_f32 v[228:229], v[94:95], v[94:95]
    v_pk_fma_f32 v[226:227], v[226:227], v[174:175], v[174:175] op_sel:[0,1,0] op_sel_hi:[1,1,0]
    v_pk_fma_f32 v[228:229], v[228:229], v[174:175], v[174:175] op_sel:[0,1,0] op_sel_hi:[1,1,0]
    v_pk_mul_f32 v[226:227], v[226:227], v[92:93]
    v_pk_mul_f32 v[228:229], v[228:229], v[94:95]
    v_exp_f32 v226, v226
    v_exp_f32 v227, v227
    v_exp_f32 v228, v228
    v_exp_f32 v229, v229
    v_pk_fma_f32 v[226:227], v[226:227], v[172:173], v[172:173] op_sel:[0,1,1] op_sel_hi:[1,1,1]
    v_pk_fma_f32 v[228:229], v[228:229], v[172:173], v[172:173] op_sel:[0,1,1] op_sel_hi:[1,1,1]
    v_rcp_f32 v226, v226
    v_rcp_f32 v227, v227
    v_rcp_f32 v228, v228
    v_rcp_f32 v229, v229
    v_pk_mul_f32 v[92:93], v[92:93], v[226:227]
    v_pk_mul_f32 v[94:95], v[94:95], v[228:229]
    v_pk_fma_f32 v[96:97], v[172:173], v[152:153], v[96:97] op_sel_hi:[0,1,1] neg_lo:[1,0,0] neg_hi:[1,0,0]
    v_pk_fma_f32 v[98:99], v[172:173], v[154:155], v[98:99] op_sel_hi:[0,1,1] neg_lo:[1,0,0] neg_hi:[1,0,0]
    v_pk_mul_f32 v[226:227], v[96:97], v[96:97]
    v_pk_mul_f32 v[228:229], v[98:99], v[98:99]
    v_pk_fma_f32 v[226:227], v[226:227], v[174:175], v[174:175] op_sel:[0,1,0] op_sel_hi:[1,1,0]
    v_pk_fma_f32 v[228:229], v[228:229], v[174:175], v[174:175] op_sel:[0,1,0] op_sel_hi:[1,1,0]
    v_pk_mul_f32 v[226:227], v[226:227], v[96:97]
    v_pk_mul_f32 v[228:229], v[228:229], v[98:99]
    v_exp_f32 v226, v226
    v_exp_f32 v227, v227
    v_exp_f32 v228, v228
    v_exp_f32 v229, v229
    v_pk_fma_f32 v[226:227], v[226:227], v[172:173], v[172:173] op_sel:[0,1,1] op_sel_hi:[1,1,1]
    v_pk_fma_f32 v[228:229], v[228:229], v[172:173], v[172:173] op_sel:[0,1,1] op_sel_hi:[1,1,1]
    v_rcp_f32 v226, v226
    v_rcp_f32 v227, v227
    v_rcp_f32 v228, v228
    v_rcp_f32 v229, v229
    v_pk_mul_f32 v[96:97], v[96:97], v[226:227]
    v_pk_mul_f32 v[98:99], v[98:99], v[228:229]
    v_cvt_pk_bf16_f32 v92, v92, v93
    v_cvt_pk_bf16_f32 v93, v94, v95
    v_cvt_pk_bf16_f32 v94, v96, v97
    v_cvt_pk_bf16_f32 v95, v98, v99
    v_or_b32 v92, 1, v92
    ds_write_b128 v244, v[92:95] offset:20480
    s_cmp_eq_u32 s60, 1
    s_cbranch_scc1 G4_p11
    buffer_load_dwordx4 v[180:183], v196, s[84:87], 0 offen offset:0 sc1
    buffer_load_dwordx4 v[188:191], v196, s[88:91], 0 offen offset:0 sc1
    buffer_load_dwordx4 v[184:187], v196, s[84:87], 0 offen offset:2048 sc1
    buffer_load_dwordx4 v[192:195], v196, s[88:91], 0 offen offset:2048 sc1
    s_branch G4_p21
G4_p11:
    s_add_u32 s36, s40, 0
    buffer_load_dwordx4 v[180:183], v2, s[84:87], s36 offen offset:0 sc1
    buffer_load_dwordx4 v[184:187], v2, s[88:91], s36 offen offset:0 sc1
    buffer_load_dwordx4 v[188:191], v2, s[84:87], s36 offen offset:1024 sc1
    buffer_load_dwordx4 v[192:195], v2, s[88:91], s36 offen offset:1024 sc1
    s_add_u32 s36, s40, 65536
    buffer_load_dwordx4 v[196:199], v2, s[84:87], s36 offen offset:0 sc1
    buffer_load_dwordx4 v[230:233], v2, s[88:91], s36 offen offset:0 sc1
    buffer_load_dwordx4 v[234:237], v2, s[84:87], s36 offen offset:1024 sc1
    buffer_load_dwordx4 v[248:251], v2, s[88:91], s36 offen offset:1024 sc1
G4_p21:
    v_pk_fma_f32 v[120:121], v[176:177], v[148:149], v[120:121] op_sel_hi:[0,1,1] neg_lo:[1,0,0] neg_hi:[1,0,0]
    v_pk_fma_f32 v[122:123], v[176:177], v[150:151], v[122:123] op_sel_hi:[0,1,1] neg_lo:[1,0,0] neg_hi:[1,0,0]
    v_pk_mul_f32 v[226:227], v[120:121], v[120:121]
    v_pk_mul_f32 v[228:229], v[122:123], v[122:123]
    v_pk_fma_f32 v[226:227], v[226:227], v[178:179], v[178:179] op_sel:[0,1,0] op_sel_hi:[1,1,0]
    v_pk_fma_f32 v[228:229], v[228:229], v[178:179], v[178:179] op_sel:[0,1,0] op_sel_hi:[1,1,0]
    v_pk_mul_f32 v[226:227], v[226:227], v[120:121]
    v_pk_mul_f32 v[228:229], v[228:229], v[122:123]
    v_exp_f32 v226, v226
    v_exp_f32 v227, v227
    v_exp_f32 v228, v228
    v_exp_f32 v229, v229
    v_pk_fma_f32 v[226:227], v[226:227], v[176:177], v[176:177] op_sel:[0,1,1] op_sel_hi:[1,1,1]
    v_pk_fma_f32 v[228:229], v[228:229], v[176:177], v[176:177] op_sel:[0,1,1] op_sel_hi:[1,1,1]
    v_rcp_f32 v226, v226
    v_rcp_f32 v227, v227
    v_rcp_f32 v228, v228
    v_rcp_f32 v229, v229
    v_pk_mul_f32 v[120:121], v[120:121], v[226:227]
    v_pk_mul_f32 v[122:123], v[122:123], v[228:229]
    v_pk_fma_f32 v[124:125], v[176:177], v[152:153], v[124:125] op_sel_hi:[0,1,1] neg_lo:[1,0,0] neg_hi:[1,0,0]
    v_pk_fma_f32 v[126:127], v[176:177], v[154:155], v[126:127] op_sel_hi:[0,1,1] neg_lo:[1,0,0] neg_hi:[1,0,0]
    v_pk_mul_f32 v[226:227], v[124:125], v[124:125]
    v_pk_mul_f32 v[228:229], v[126:127], v[126:127]
    v_pk_fma_f32 v[226:227], v[226:227], v[178:179], v[178:179] op_sel:[0,1,0] op_sel_hi:[1,1,0]
    v_pk_fma_f32 v[228:229], v[228:229], v[178:179], v[178:179] op_sel:[0,1,0] op_sel_hi:[1,1,0]
    v_pk_mul_f32 v[226:227], v[226:227], v[124:125]
    v_pk_mul_f32 v[228:229], v[228:229], v[126:127]
    v_exp_f32 v226, v226
    v_exp_f32 v227, v227
    v_exp_f32 v228, v228
    v_exp_f32 v229, v229
    v_pk_fma_f32 v[226:227], v[226:227], v[176:177], v[176:177] op_sel:[0,1,1] op_sel_hi:[1,1,1]
    v_pk_fma_f32 v[228:229], v[228:229], v[176:177], v[176:177] op_sel:[0,1,1] op_sel_hi:[1,1,1]
    v_rcp_f32 v226, v226
    v_rcp_f32 v227, v227
    v_rcp_f32 v228, v228
    v_rcp_f32 v229, v229
    v_pk_mul_f32 v[124:125], v[124:125], v[226:227]
    v_pk_mul_f32 v[126:127], v[126:127], v[228:229]
    v_cvt_pk_bf16_f32 v120, v120, v121
    v_cvt_pk_bf16_f32 v121, v122, v123
    v_cvt_pk_bf16_f32 v122, v124, v125
    v_cvt_pk_bf16_f32 v123, v126, v127
    ds_write_b128 v244, v[120:123] offset:22528
    v_pk_fma_f32 v[44:45], v[164:165], v[156:157], v[44:45] op_sel_hi:[0,1,1] neg_lo:[1,0,0] neg_hi:[1,0,0]
    v_pk_fma_f32 v[46:47], v[164:165], v[158:159], v[46:47] op_sel_hi:[0,1,1] neg_lo:[1,0,0] neg_hi:[1,0,0]
    v_pk_mul_f32 v[226:227], v[44:45], v[44:45]
    v_pk_mul_f32 v[228:229], v[46:47], v[46:47]
    v_pk_fma_f32 v[226:227], v[226:227], v[166:167], v[166:167] op_sel:[0,1,0] op_sel_hi:[1,1,0]
    v_pk_fma_f32 v[228:229], v[228:229], v[166:167], v[166:167] op_sel:[0,1,0] op_sel_hi:[1,1,0]
    v_pk_mul_f32 v[226:227], v[226:227], v[44:45]
    v_pk_mul_f32 v[228:229], v[228:229], v[46:47]
    v_exp_f32 v226, v226
    v_exp_f32 v227, v227
    v_exp_f32 v228, v228
    v_exp_f32 v229, v229
    v_pk_fma_f32 v[226:227], v[226:227], v[164:165], v[164:165] op_sel:[0,1,1] op_sel_hi:[1,1,1]
    v_pk_fma_f32 v[228:229], v[228:229], v[164:165], v[164:165] op_sel:[0,1,1] op_sel_hi:[1,1,1]
    v_rcp_f32 v226, v226
    v_rcp_f32 v227, v227
    v_rcp_f32 v228, v228
    v_rcp_f32 v229, v229
    v_pk_mul_f32 v[44:45], v[44:45], v[226:227]
    v_pk_mul_f32 v[46:47], v[46:47], v[228:229]
    v_pk_fma_f32 v[48:49], v[164:165], v[160:161], v[48:49] op_sel_hi:[0,1,1] neg_lo:[1,0,0] neg_hi:[1,0,0]
    v_pk_fma_f32 v[50:51], v[164:165], v[162:163], v[50:51] op_sel_hi:[0,1,1] neg_lo:[1,0,0] neg_hi:[1,0,0]
    v_pk_mul_f32 v[226:227], v[48:49], v[48:49]
    v_pk_mul_f32 v[228:229], v[50:51], v[50:51]
    v_pk_fma_f32 v[226:227], v[226:227], v[166:167], v[166:167] op_sel:[0,1,0] op_sel_hi:[1,1,0]
    v_pk_fma_f32 v[228:229], v[228:229], v[166:167], v[166:167] op_sel:[0,1,0] op_sel_hi:[1,1,0]
    v_pk_mul_f32 v[226:227], v[226:227], v[48:49]
    v_pk_mul_f32 v[228:229], v[228:229], v[50:51]
    v_exp_f32 v226, v226
    v_exp_f32 v227, v227
    v_exp_f32 v228, v228
    v_exp_f32 v229, v229
    v_pk_fma_f32 v[226:227], v[226:227], v[164:165], v[164:165] op_sel:[0,1,1] op_sel_hi:[1,1,1]
    v_pk_fma_f32 v[228:229], v[228:229], v[164:165], v[164:165] op_sel:[0,1,1] op_sel_hi:[1,1,1]
    v_rcp_f32 v226, v226
    v_rcp_f32 v227, v227
    v_rcp_f32 v228, v228
    v_rcp_f32 v229, v229
    v_pk_mul_f32 v[48:49], v[48:49], v[226:227]
    v_pk_mul_f32 v[50:51], v[50:51], v[228:229]
    v_cvt_pk_bf16_f32 v200, v44, v45
    v_cvt_pk_bf16_f32 v201, v46, v47
    v_cvt_pk_bf16_f32 v202, v48, v49
    v_cvt_pk_bf16_f32 v203, v50, v51
    v_or_b32 v200, 1, v200
    ds_write_b128 v244, v[200:203] offset:32768
    v_pk_fma_f32 v[72:73], v[168:169], v[156:157], v[72:73] op_sel_hi:[0,1,1] neg_lo:[1,0,0] neg_hi:[1,0,0]
    v_pk_fma_f32 v[74:75], v[168:169], v[158:159], v[74:75] op_sel_hi:[0,1,1] neg_lo:[1,0,0] neg_hi:[1,0,0]
    v_pk_mul_f32 v[226:227], v[72:73], v[72:73]
    v_pk_mul_f32 v[228:229], v[74:75], v[74:75]
    v_pk_fma_f32 v[226:227], v[226:227], v[170:171], v[170:171] op_sel:[0,1,0] op_sel_hi:[1,1,0]
    v_pk_fma_f32 v[228:229], v[228:229], v[170:171], v[170:171] op_sel:[0,1,0] op_sel_hi:[1,1,0]
    v_pk_mul_f32 v[226:227], v[226:227], v[72:73]
    v_pk_mul_f32 v[228:229], v[228:229], v[74:75]
    v_exp_f32 v226, v226
    v_exp_f32 v227, v227
    v_exp_f32 v228, v228
    v_exp_f32 v229, v229
    v_pk_fma_f32 v[226:227], v[226:227], v[168:169], v[168:169] op_sel:[0,1,1] op_sel_hi:[1,1,1]
    v_pk_fma_f32 v[228:229], v[228:229], v[168:169], v[168:169] op_sel:[0,1,1] op_sel_hi:[1,1,1]
    v_rcp_f32 v226, v226
    v_rcp_f32 v227, v227
    v_rcp_f32 v228, v228
    v_rcp_f32 v229, v229
    v_pk_mul_f32 v[72:73], v[72:73], v[226:227]
    v_pk_mul_f32 v[74:75], v[74:75], v[228:229]
    v_pk_fma_f32 v[76:77], v[168:169], v[160:161], v[76:77] op_sel_hi:[0,1,1] neg_lo:[1,0,0] neg_hi:[1,0,0]
    v_pk_fma_f32 v[78:79], v[168:169], v[162:163], v[78:79] op_sel_hi:[0,1,1] neg_lo:[1,0,0] neg_hi:[1,0,0]
    v_pk_mul_f32 v[226:227], v[76:77], v[76:77]
    v_pk_mul_f32 v[228:229], v[78:79], v[78:79]
    v_pk_fma_f32 v[226:227], v[226:227], v[170:171], v[170:171] op_sel:[0,1,0] op_sel_hi:[1,1,0]
    v_pk_fma_f32 v[228:229], v[228:229], v[170:171], v[170:171] op_sel:[0,1,0] op_sel_hi:[1,1,0]
    v_pk_mul_f32 v[226:227], v[226:227], v[76:77]
    v_pk_mul_f32 v[228:229], v[228:229], v[78:79]
    v_exp_f32 v226, v226
    v_exp_f32 v227, v227
    v_exp_f32 v228, v228
    v_exp_f32 v229, v229
    v_pk_fma_f32 v[226:227], v[226:227], v[168:169], v[168:169] op_sel:[0,1,1] op_sel_hi:[1,1,1]
    v_pk_fma_f32 v[228:229], v[228:229], v[168:169], v[168:169] op_sel:[0,1,1] op_sel_hi:[1,1,1]
    v_rcp_f32 v226, v226
    v_rcp_f32 v227, v227
    v_rcp_f32 v228, v228
    v_rcp_f32 v229, v229
    v_pk_mul_f32 v[76:77], v[76:77], v[226:227]
    v_pk_mul_f32 v[78:79], v[78:79], v[228:229]
    v_cvt_pk_bf16_f32 v204, v72, v73
    v_cvt_pk_bf16_f32 v205, v74, v75
    v_cvt_pk_bf16_f32 v206, v76, v77
    v_cvt_pk_bf16_f32 v207, v78, v79
    v_or_b32 v204, 1, v204
    ds_write_b128 v244, v[204:207] offset:34816
    v_pk_fma_f32 v[100:101], v[172:173], v[156:157], v[100:101] op_sel_hi:[0,1,1] neg_lo:[1,0,0] neg_hi:[1,0,0]
    v_pk_fma_f32 v[102:103], v[172:173], v[158:159], v[102:103] op_sel_hi:[0,1,1] neg_lo:[1,0,0] neg_hi:[1,0,0]
    v_pk_mul_f32 v[226:227], v[100:101], v[100:101]
    v_pk_mul_f32 v[228:229], v[102:103], v[102:103]
    v_pk_fma_f32 v[226:227], v[226:227], v[174:175], v[174:175] op_sel:[0,1,0] op_sel_hi:[1,1,0]
    v_pk_fma_f32 v[228:229], v[228:229], v[174:175], v[174:175] op_sel:[0,1,0] op_sel_hi:[1,1,0]
    v_pk_mul_f32 v[226:227], v[226:227], v[100:101]
    v_pk_mul_f32 v[228:229], v[228:229], v[102:103]
    v_exp_f32 v226, v226
    v_exp_f32 v227, v227
    v_exp_f32 v228, v228
    v_exp_f32 v229, v229
    v_pk_fma_f32 v[226:227], v[226:227], v[172:173], v[172:173] op_sel:[0,1,1] op_sel_hi:[1,1,1]
    v_pk_fma_f32 v[228:229], v[228:229], v[172:173], v[172:173] op_sel:[0,1,1] op_sel_hi:[1,1,1]
    v_rcp_f32 v226, v226
    v_rcp_f32 v227, v227
    v_rcp_f32 v228, v228
    v_rcp_f32 v229, v229
    v_pk_mul_f32 v[100:101], v[100:101], v[226:227]
    v_pk_mul_f32 v[102:103], v[102:103], v[228:229]
    v_pk_fma_f32 v[104:105], v[172:173], v[160:161], v[104:105] op_sel_hi:[0,1,1] neg_lo:[1,0,0] neg_hi:[1,0,0]
    v_pk_fma_f32 v[106:107], v[172:173], v[162:163], v[106:107] op_sel_hi:[0,1,1] neg_lo:[1,0,0] neg_hi:[1,0,0]
    v_pk_mul_f32 v[226:227], v[104:105], v[104:105]
    v_pk_mul_f32 v[228:229], v[106:107], v[106:107]
    v_pk_fma_f32 v[226:227], v[226:227], v[174:175], v[174:175] op_sel:[0,1,0] op_sel_hi:[1,1,0]
    v_pk_fma_f32 v[228:229], v[228:229], v[174:175], v[174:175] op_sel:[0,1,0] op_sel_hi:[1,1,0]
    v_pk_mul_f32 v[226:227], v[226:227], v[104:105]
    v_pk_mul_f32 v[228:229], v[228:229], v[106:107]
    v_exp_f32 v226, v226
    v_exp_f32 v227, v227
    v_exp_f32 v228, v228
    v_exp_f32 v229, v229
    v_pk_fma_f32 v[226:227], v[226:227], v[172:173], v[172:173] op_sel:[0,1,1] op_sel_hi:[1,1,1]
    v_pk_fma_f32 v[228:229], v[228:229], v[172:173], v[172:173] op_sel:[0,1,1] op_sel_hi:[1,1,1]
    v_rcp_f32 v226, v226
    v_rcp_f32 v227, v227
    v_rcp_f32 v228, v228
    v_rcp_f32 v229, v229
    v_pk_mul_f32 v[104:105], v[104:105], v[226:227]
    v_pk_mul_f32 v[106:107], v[106:107], v[228:229]
    v_cvt_pk_bf16_f32 v208, v100, v101
    v_cvt_pk_bf16_f32 v209, v102, v103
    v_cvt_pk_bf16_f32 v210, v104, v105
    v_cvt_pk_bf16_f32 v211, v106, v107
    v_or_b32 v208, 1, v208
    ds_write_b128 v244, v[208:211] offset:36864
    v_pk_fma_f32 v[128:129], v[176:177], v[156:157], v[128:129] op_sel_hi:[0,1,1] neg_lo:[1,0,0] neg_hi:[1,0,0]
    v_pk_fma_f32 v[130:131], v[176:177], v[158:159], v[130:131] op_sel_hi:[0,1,1] neg_lo:[1,0,0] neg_hi:[1,0,0]
    v_pk_mul_f32 v[226:227], v[128:129], v[128:129]
    v_pk_mul_f32 v[228:229], v[130:131], v[130:131]
    v_pk_fma_f32 v[226:227], v[226:227], v[178:179], v[178:179] op_sel:[0,1,0] op_sel_hi:[1,1,0]
    v_pk_fma_f32 v[228:229], v[228:229], v[178:179], v[178:179] op_sel:[0,1,0] op_sel_hi:[1,1,0]
    v_pk_mul_f32 v[226:227], v[226:227], v[128:129]
    v_pk_mul_f32 v[228:229], v[228:229], v[130:131]
    v_exp_f32 v226, v226
    v_exp_f32 v227, v227
    v_exp_f32 v228, v228
    v_exp_f32 v229, v229
    v_pk_fma_f32 v[226:227], v[226:227], v[176:177], v[176:177] op_sel:[0,1,1] op_sel_hi:[1,1,1]
    v_pk_fma_f32 v[228:229], v[228:229], v[176:177], v[176:177] op_sel:[0,1,1] op_sel_hi:[1,1,1]
    v_rcp_f32 v226, v226
    v_rcp_f32 v227, v227
    v_rcp_f32 v228, v228
    v_rcp_f32 v229, v229
    v_pk_mul_f32 v[128:129], v[128:129], v[226:227]
    v_pk_mul_f32 v[130:131], v[130:131], v[228:229]
    v_pk_fma_f32 v[132:133], v[176:177], v[160:161], v[132:133] op_sel_hi:[0,1,1] neg_lo:[1,0,0] neg_hi:[1,0,0]
    v_pk_fma_f32 v[134:135], v[176:177], v[162:163], v[134:135] op_sel_hi:[0,1,1] neg_lo:[1,0,0] neg_hi:[1,0,0]
    v_pk_mul_f32 v[226:227], v[132:133], v[132:133]
    v_pk_mul_f32 v[228:229], v[134:135], v[134:135]
    v_pk_fma_f32 v[226:227], v[226:227], v[178:179], v[178:179] op_sel:[0,1,0] op_sel_hi:[1,1,0]
    v_pk_fma_f32 v[228:229], v[228:229], v[178:179], v[178:179] op_sel:[0,1,0] op_sel_hi:[1,1,0]
    v_pk_mul_f32 v[226:227], v[226:227], v[132:133]
    v_pk_mul_f32 v[228:229], v[228:229], v[134:135]
    v_exp_f32 v226, v226
    v_exp_f32 v227, v227
    v_exp_f32 v228, v228
    v_exp_f32 v229, v229
    v_pk_fma_f32 v[226:227], v[226:227], v[176:177], v[176:177] op_sel:[0,1,1] op_sel_hi:[1,1,1]
    v_pk_fma_f32 v[228:229], v[228:229], v[176:177], v[176:177] op_sel:[0,1,1] op_sel_hi:[1,1,1]
    v_rcp_f32 v226, v226
    v_rcp_f32 v227, v227
    v_rcp_f32 v228, v228
    v_rcp_f32 v229, v229
    v_pk_mul_f32 v[132:133], v[132:133], v[226:227]
    v_pk_mul_f32 v[134:135], v[134:135], v[228:229]
    v_cvt_pk_bf16_f32 v212, v128, v129
    v_cvt_pk_bf16_f32 v213, v130, v131
    v_cvt_pk_bf16_f32 v214, v132, v133
    v_cvt_pk_bf16_f32 v215, v134, v135
    ds_write_b128 v244, v[212:215] offset:38912
    v_pk_fma_f32 v[24:25], v[164:165], v[136:137], v[24:25] op_sel_hi:[0,1,1] neg_lo:[1,0,0] neg_hi:[1,0,0]
    v_pk_fma_f32 v[26:27], v[164:165], v[138:139], v[26:27] op_sel_hi:[0,1,1] neg_lo:[1,0,0] neg_hi:[1,0,0]
    v_pk_mul_f32 v[226:227], v[24:25], v[24:25]
    v_pk_mul_f32 v[228:229], v[26:27], v[26:27]
    v_pk_fma_f32 v[226:227], v[226:227], v[166:167], v[166:167] op_sel:[0,1,0] op_sel_hi:[1,1,0]
    v_pk_fma_f32 v[228:229], v[228:229], v[166:167], v[166:167] op_sel:[0,1,0] op_sel_hi:[1,1,0]
    v_pk_mul_f32 v[226:227], v[226:227], v[24:25]
    v_pk_mul_f32 v[228:229], v[228:229], v[26:27]
    v_exp_f32 v226, v226
    v_exp_f32 v227, v227
    v_exp_f32 v228, v228
    v_exp_f32 v229, v229
    v_pk_fma_f32 v[226:227], v[226:227], v[164:165], v[164:165] op_sel:[0,1,1] op_sel_hi:[1,1,1]
    v_pk_fma_f32 v[228:229], v[228:229], v[164:165], v[164:165] op_sel:[0,1,1] op_sel_hi:[1,1,1]
    v_rcp_f32 v226, v226
    v_rcp_f32 v227, v227
    v_rcp_f32 v228, v228
    v_rcp_f32 v229, v229
    v_pk_mul_f32 v[24:25], v[24:25], v[226:227]
    v_pk_mul_f32 v[26:27], v[26:27], v[228:229]
    v_cvt_pk_bf16_f32 v216, v24, v25
    v_cvt_pk_bf16_f32 v217, v26, v27
    v_or_b32 v216, 1, v216
    s_add_u32 s36, s46, 0
    buffer_store_dwordx4 v[36:39], v2, s[16:19], s36 offen sc1
    v_pk_fma_f32 v[52:53], v[168:169], v[136:137], v[52:53] op_sel_hi:[0,1,1] neg_lo:[1,0,0] neg_hi:[1,0,0]
    v_pk_fma_f32 v[54:55], v[168:169], v[138:139], v[54:55] op_sel_hi:[0,1,1] neg_lo:[1,0,0] neg_hi:[1,0,0]
    v_pk_mul_f32 v[226:227], v[52:53], v[52:53]
    v_pk_mul_f32 v[228:229], v[54:55], v[54:55]
    v_pk_fma_f32 v[226:227], v[226:227], v[170:171], v[170:171] op_sel:[0,1,0] op_sel_hi:[1,1,0]
    v_pk_fma_f32 v[228:229], v[228:229], v[170:171], v[170:171] op_sel:[0,1,0] op_sel_hi:[1,1,0]
    v_pk_mul_f32 v[226:227], v[226:227], v[52:53]
    v_pk_mul_f32 v[228:229], v[228:229], v[54:55]
    v_exp_f32 v226, v226
    v_exp_f32 v227, v227
    v_exp_f32 v228, v228
    v_exp_f32 v229, v229
    v_pk_fma_f32 v[226:227], v[226:227], v[168:169], v[168:169] op_sel:[0,1,1] op_sel_hi:[1,1,1]
    v_pk_fma_f32 v[228:229], v[228:229], v[168:169], v[168:169] op_sel:[0,1,1] op_sel_hi:[1,1,1]
    v_rcp_f32 v226, v226
    v_rcp_f32 v227, v227
    v_rcp_f32 v228, v228
    v_rcp_f32 v229, v229
    v_pk_mul_f32 v[52:53], v[52:53], v[226:227]
    v_pk_mul_f32 v[54:55], v[54:55], v[228:229]
    v_cvt_pk_bf16_f32 v218, v52, v53
    v_cvt_pk_bf16_f32 v219, v54, v55
    v_or_b32 v218, 1, v218
    s_add_u32 s36, s46, 229376
    buffer_store_dwordx4 v[64:67], v2, s[16:19], s36 offen sc1
    v_pk_fma_f32 v[80:81], v[172:173], v[136:137], v[80:81] op_sel_hi:[0,1,1] neg_lo:[1,0,0] neg_hi:[1,0,0]
    v_pk_fma_f32 v[82:83], v[172:173], v[138:139], v[82:83] op_sel_hi:[0,1,1] neg_lo:[1,0,0] neg_hi:[1,0,0]
    v_pk_mul_f32 v[226:227], v[80:81], v[80:81]
    v_pk_mul_f32 v[228:229], v[82:83], v[82:83]
    v_pk_fma_f32 v[226:227], v[226:227], v[174:175], v[174:175] op_sel:[0,1,0] op_sel_hi:[1,1,0]
    v_pk_fma_f32 v[228:229], v[228:229], v[174:175], v[174:175] op_sel:[0,1,0] op_sel_hi:[1,1,0]
    v_pk_mul_f32 v[226:227], v[226:227], v[80:81]
    v_pk_mul_f32 v[228:229], v[228:229], v[82:83]
    v_exp_f32 v226, v226
    v_exp_f32 v227, v227
    v_exp_f32 v228, v228
    v_exp_f32 v229, v229
    v_pk_fma_f32 v[226:227], v[226:227], v[172:173], v[172:173] op_sel:[0,1,1] op_sel_hi:[1,1,1]
    v_pk_fma_f32 v[228:229], v[228:229], v[172:173], v[172:173] op_sel:[0,1,1] op_sel_hi:[1,1,1]
    v_rcp_f32 v226, v226
    v_rcp_f32 v227, v227
    v_rcp_f32 v228, v228
    v_rcp_f32 v229, v229
    v_pk_mul_f32 v[80:81], v[80:81], v[226:227]
    v_pk_mul_f32 v[82:83], v[82:83], v[228:229]
    v_cvt_pk_bf16_f32 v220, v80, v81
    v_cvt_pk_bf16_f32 v221, v82, v83
    v_or_b32 v220, 1, v220
    s_add_u32 s36, s46, 458752
    buffer_store_dwordx4 v[92:95], v2, s[16:19], s36 offen sc1
    v_pk_fma_f32 v[108:109], v[176:177], v[136:137], v[108:109] op_sel_hi:[0,1,1] neg_lo:[1,0,0] neg_hi:[1,0,0]
    v_pk_fma_f32 v[110:111], v[176:177], v[138:139], v[110:111] op_sel_hi:[0,1,1] neg_lo:[1,0,0] neg_hi:[1,0,0]
    v_pk_mul_f32 v[226:227], v[108:109], v[108:109]
    v_pk_mul_f32 v[228:229], v[110:111], v[110:111]
    v_pk_fma_f32 v[226:227], v[226:227], v[178:179], v[178:179] op_sel:[0,1,0] op_sel_hi:[1,1,0]
    v_pk_fma_f32 v[228:229], v[228:229], v[178:179], v[178:179] op_sel:[0,1,0] op_sel_hi:[1,1,0]
    v_pk_mul_f32 v[226:227], v[226:227], v[108:109]
    v_pk_mul_f32 v[228:229], v[228:229], v[110:111]
    v_exp_f32 v226, v226
    v_exp_f32 v227, v227
    v_exp_f32 v228, v228
    v_exp_f32 v229, v229
    v_pk_fma_f32 v[226:227], v[226:227], v[176:177], v[176:177] op_sel:[0,1,1] op_sel_hi:[1,1,1]
    v_pk_fma_f32 v[228:229], v[228:229], v[176:177], v[176:177] op_sel:[0,1,1] op_sel_hi:[1,1,1]
    v_rcp_f32 v226, v226
    v_rcp_f32 v227, v227
    v_rcp_f32 v228, v228
    v_rcp_f32 v229, v229
    v_pk_mul_f32 v[108:109], v[108:109], v[226:227]
    v_pk_mul_f32 v[110:111], v[110:111], v[228:229]
    v_cvt_pk_bf16_f32 v222, v108, v109
    v_cvt_pk_bf16_f32 v223, v110, v111
    s_add_u32 s36, s46, 688128
    buffer_store_dwordx4 v[120:123], v2, s[16:19], s36 offen sc1
    s_waitcnt lgkmcnt(0)
    s_add_u32 s45, s44, 512
    s_mov_b32 s44, s47
G3_e2:
    s_waitcnt lgkmcnt(0)
    s_barrier
    ds_read_b128 v[88:91], v17 offset:0
    ds_read_b128 v[92:95], v17 offset:2048
    ds_read_b128 v[96:99], v17 offset:4096
    ds_read_b128 v[100:103], v17 offset:6144
    ds_read_b64_tr_b16 v[104:105], v18 offset:0
    ds_read_b64_tr_b16 v[106:107], v18 offset:4096
    ds_read_b64_tr_b16 v[108:109], v19 offset:0
    ds_read_b64_tr_b16 v[110:111], v19 offset:4096
    ds_read_b64_tr_b16 v[112:113], v20 offset:0
    ds_read_b64_tr_b16 v[114:115], v20 offset:4096
    ds_read_b64_tr_b16 v[116:117], v21 offset:0
    ds_read_b64_tr_b16 v[118:119], v21 offset:4096
    s_waitcnt lgkmcnt(6)
    v_mfma_f32_16x16x32_bf16 v[24:27], v[104:107], v[88:91], 0
    ds_read_b128 v[120:123], v17 offset:1024
    s_add_u32 s42, s42, 16384
    v_mfma_f32_16x16x32_bf16 v[40:43], v[104:107], v[92:95], 0
    ds_read_b128 v[124:127], v17 offset:3072
    s_cmp_eq_u32 s42, 49152
    v_mfma_f32_16x16x32_bf16 v[56:59], v[104:107], v[96:99], 0
    ds_read_b128 v[128:131], v17 offset:5120
    s_cselect_b32 s42, 0, s42
    v_mfma_f32_16x16x32_bf16 v[72:75], v[104:107], v[100:103], 0
    ds_read_b128 v[132:135], v17 offset:7168
    s_waitcnt lgkmcnt(8)
    v_mfma_f32_16x16x32_bf16 v[76:79], v[108:111], v[100:103], 0
    ds_read_b64_tr_b16 v[136:137], v18 offset:8192
    s_add_u32 s48, s48, 16384
    v_mfma_f32_16x16x32_bf16 v[60:63], v[108:111], v[96:99], 0
    ds_read_b64_tr_b16 v[138:139], v18 offset:12288
    s_cmp_eq_u32 s48, 98304
    v_mfma_f32_16x16x32_bf16 v[44:47], v[108:111], v[92:95], 0
    ds_read_b64_tr_b16 v[140:141], v19 offset:8192
    s_cselect_b32 s48, 0, s48
    v_mfma_f32_16x16x32_bf16 v[28:31], v[108:111], v[88:91], 0
    ds_read_b64_tr_b16 v[142:143], v19 offset:12288
    s_waitcnt lgkmcnt(8)
    v_mfma_f32_16x16x32_bf16 v[32:35], v[112:115], v[88:91], 0
    ds_read_b64_tr_b16 v[144:145], v20 offset:8192
    v_add_u32 v17, s42, v12
    v_mfma_f32_16x16x32_bf16 v[48:51], v[112:115], v[92:95], 0
    ds_read_b64_tr_b16 v[146:147], v20 offset:12288
    s_add_u32 s36, s44, 0
    v_mfma_f32_16x16x32_bf16 v[64:67], v[112:115], v[96:99], 0
    ds_read_b64_tr_b16 v[148:149], v21 offset:8192
    buffer_store_dwordx4 v[200:203], v2, s[16:19], s36 offen sc1
    v_mfma_f32_16x16x32_bf16 v[80:83], v[112:115], v[100:103], 0
    ds_read_b64_tr_b16 v[150:151], v21 offset:12288
    s_add_u32 s36, s45, 0
    v_mfma_f32_16x16x32_bf16 v[84:87], v[116:119], v[100:103], 0
    buffer_store_dwordx2 v[216:217], v238, s[16:19], s36 offen sc1
    v_add_u32 v18, s48, v13
    v_mfma_f32_16x16x32_bf16 v[68:71], v[116:119], v[96:99], 0
    v_add_u32 v19, s48, v14
    v_mfma_f32_16x16x32_bf16 v[52:55], v[116:119], v[92:95], 0
    v_add_u32 v20, s48, v15
    v_mfma_f32_16x16x32_bf16 v[36:39], v[116:119], v[88:91], 0
    v_add_u32 v21, s48, v16
    s_waitcnt lgkmcnt(6)
    v_mfma_f32_16x16x32_bf16 v[24:27], v[136:139], v[120:123], v[24:27]
    v_mfma_f32_16x16x32_bf16 v[40:43], v[136:139], v[124:127], v[40:43]
    v_mfma_f32_16x16x32_bf16 v[56:59], v[136:139], v[128:131], v[56:59]
    s_waitcnt lgkmcnt(0)
    s_barrier
    v_mfma_f32_16x16x32_bf16 v[72:75], v[136:139], v[132:135], v[72:75]
    ds_read_b128 v[88:91], v17 offset:0
    s_add_u32 s36, s44, 229376
    v_mfma_f32_16x16x32_bf16 v[76:79], v[140:143], v[132:135], v[76:79]
    ds_read_b128 v[92:95], v17 offset:2048
    buffer_store_dwordx4 v[204:207], v2, s[16:19], s36 offen sc1
    v_mfma_f32_16x16x32_bf16 v[60:63], v[140:143], v[128:131], v[60:63]
    ds_read_b128 v[96:99], v17 offset:4096
    s_add_u32 s36, s45, 229376
    v_mfma_f32_16x16x32_bf16 v[44:47], v[140:143], v[124:127], v[44:47]
    ds_read_b128 v[100:103], v17 offset:6144
    buffer_store_dwordx2 v[218:219], v238, s[16:19], s36 offen sc1
    v_mfma_f32_16x16x32_bf16 v[28:31], v[140:143], v[120:123], v[28:31]
    ds_read_b64_tr_b16 v[104:105], v18 offset:0
    s_add_u32 s43, s43, 1
    v_mfma_f32_16x16x32_bf16 v[32:35], v[144:147], v[120:123], v[32:35]
    ds_read_b64_tr_b16 v[106:107], v18 offset:4096
    s_cmp_lt_u32 s43, 27
    v_mfma_f32_16x16x32_bf16 v[48:51], v[144:147], v[124:127], v[48:51]
    ds_read_b64_tr_b16 v[108:109], v19 offset:0
    v_mfma_f32_16x16x32_bf16 v[64:67], v[144:147], v[128:131], v[64:67]
    ds_read_b64_tr_b16 v[110:111], v19 offset:4096
    v_mfma_f32_16x16x32_bf16 v[80:83], v[144:147], v[132:135], v[80:83]
    ds_read_b64_tr_b16 v[112:113], v20 offset:0
    v_mfma_f32_16x16x32_bf16 v[84:87], v[148:151], v[132:135], v[84:87]
    ds_read_b64_tr_b16 v[114:115], v20 offset:4096
    v_mfma_f32_16x16x32_bf16 v[68:71], v[148:151], v[128:131], v[68:71]
    ds_read_b64_tr_b16 v[116:117], v21 offset:0
    v_mfma_f32_16x16x32_bf16 v[52:55], v[148:151], v[124:127], v[52:55]
    ds_read_b64_tr_b16 v[118:119], v21 offset:4096
    v_mfma_f32_16x16x32_bf16 v[36:39], v[148:151], v[120:123], v[36:39]
    s_waitcnt lgkmcnt(6)
    v_mfma_f32_16x16x32_bf16 v[24:27], v[104:107], v[88:91], v[24:27]
    ds_read_b128 v[120:123], v17 offset:1024
    s_add_u32 s42, s42, 16384
    v_mfma_f32_16x16x32_bf16 v[40:43], v[104:107], v[92:95], v[40:43]
    ds_read_b128 v[124:127], v17 offset:3072
    s_cmp_eq_u32 s42, 49152
    v_mfma_f32_16x16x32_bf16 v[56:59], v[104:107], v[96:99], v[56:59]
    ds_read_b128 v[128:131], v17 offset:5120
    s_cselect_b32 s42, 0, s42
    v_mfma_f32_16x16x32_bf16 v[72:75], v[104:107], v[100:103], v[72:75]
    ds_read_b128 v[132:135], v17 offset:7168
    s_waitcnt lgkmcnt(8)
    v_mfma_f32_16x16x32_bf16 v[76:79], v[108:111], v[100:103], v[76:79]
    ds_read_b64_tr_b16 v[136:137], v18 offset:8192
    s_add_u32 s48, s48, 16384
    v_mfma_f32_16x16x32_bf16 v[60:63], v[108:111], v[96:99], v[60:63]
    ds_read_b64_tr_b16 v[138:139], v18 offset:12288
    s_cmp_eq_u32 s48, 98304
    v_mfma_f32_16x16x32_bf16 v[44:47], v[108:111], v[92:95], v[44:47]
    ds_read_b64_tr_b16 v[140:141], v19 offset:8192
    s_cselect_b32 s48, 0, s48
    v_mfma_f32_16x16x32_bf16 v[28:31], v[108:111], v[88:91], v[28:31]
    ds_read_b64_tr_b16 v[142:143], v19 offset:12288
    s_waitcnt lgkmcnt(8)
    v_mfma_f32_16x16x32_bf16 v[32:35], v[112:115], v[88:91], v[32:35]
    ds_read_b64_tr_b16 v[144:145], v20 offset:8192
    v_add_u32 v17, s42, v12
    v_mfma_f32_16x16x32_bf16 v[48:51], v[112:115], v[92:95], v[48:51]
    ds_read_b64_tr_b16 v[146:147], v20 offset:12288
    s_add_u32 s36, s44, 458752
    v_mfma_f32_16x16x32_bf16 v[64:67], v[112:115], v[96:99], v[64:67]
    ds_read_b64_tr_b16 v[148:149], v21 offset:8192
    buffer_store_dwordx4 v[208:211], v2, s[16:19], s36 offen sc1
    v_mfma_f32_16x16x32_bf16 v[80:83], v[112:115], v[100:103], v[80:83]
    ds_read_b64_tr_b16 v[150:151], v21 offset:12288
    s_add_u32 s36, s45, 458752
    v_mfma_f32_16x16x32_bf16 v[84:87], v[116:119], v[100:103], v[84:87]
    buffer_store_dwordx2 v[220:221], v238, s[16:19], s36 offen sc1
    v_add_u32 v18, s48, v13
    v_mfma_f32_16x16x32_bf16 v[68:71], v[116:119], v[96:99], v[68:71]
    v_add_u32 v19, s48, v14
    v_mfma_f32_16x16x32_bf16 v[52:55], v[116:119], v[92:95], v[52:55]
    v_add_u32 v20, s48, v15
    v_mfma_f32_16x16x32_bf16 v[36:39], v[116:119], v[88:91], v[36:39]
    v_add_u32 v21, s48, v16
    s_waitcnt lgkmcnt(6)
    v_mfma_f32_16x16x32_bf16 v[24:27], v[136:139], v[120:123], v[24:27]
    v_mfma_f32_16x16x32_bf16 v[40:43], v[136:139], v[124:127], v[40:43]
    s_waitcnt vmcnt(6)
    v_mfma_f32_16x16x32_bf16 v[56:59], v[136:139], v[128:131], v[56:59]
    s_waitcnt lgkmcnt(0)
    s_barrier
    v_mfma_f32_16x16x32_bf16 v[72:75], v[136:139], v[132:135], v[72:75]
    ds_read_b128 v[88:91], v17 offset:0
    s_add_u32 s36, s44, 688128
    v_mfma_f32_16x16x32_bf16 v[76:79], v[140:143], v[132:135], v[76:79]
    ds_read_b128 v[92:95], v17 offset:2048
    buffer_store_dwordx4 v[212:215], v2, s[16:19], s36 offen sc1
    v_mfma_f32_16x16x32_bf16 v[60:63], v[140:143], v[128:131], v[60:63]
    ds_read_b128 v[96:99], v17 offset:4096
    s_add_u32 s36, s45, 688128
    v_mfma_f32_16x16x32_bf16 v[44:47], v[140:143], v[124:127], v[44:47]
    ds_read_b128 v[100:103], v17 offset:6144
    buffer_store_dwordx2 v[222:223], v238, s[16:19], s36 offen sc1
    v_mfma_f32_16x16x32_bf16 v[28:31], v[140:143], v[120:123], v[28:31]
    ds_read_b64_tr_b16 v[104:105], v18 offset:0
    s_add_u32 s43, s43, 1
    v_mfma_f32_16x16x32_bf16 v[32:35], v[144:147], v[120:123], v[32:35]
    ds_read_b64_tr_b16 v[106:107], v18 offset:4096
    s_cmp_lt_u32 s43, 27
    v_mfma_f32_16x16x32_bf16 v[48:51], v[144:147], v[124:127], v[48:51]
    ds_read_b64_tr_b16 v[108:109], v19 offset:0
    v_mfma_f32_16x16x32_bf16 v[64:67], v[144:147], v[128:131], v[64:67]
    ds_read_b64_tr_b16 v[110:111], v19 offset:4096
    v_mfma_f32_16x16x32_bf16 v[80:83], v[144:147], v[132:135], v[80:83]
    ds_read_b64_tr_b16 v[112:113], v20 offset:0
    v_mfma_f32_16x16x32_bf16 v[84:87], v[148:151], v[132:135], v[84:87]
    ds_read_b64_tr_b16 v[114:115], v20 offset:4096
    v_mfma_f32_16x16x32_bf16 v[68:71], v[148:151], v[128:131], v[68:71]
    ds_read_b64_tr_b16 v[116:117], v21 offset:0
    v_mfma_f32_16x16x32_bf16 v[52:55], v[148:151], v[124:127], v[52:55]
    ds_read_b64_tr_b16 v[118:119], v21 offset:4096
    v_mfma_f32_16x16x32_bf16 v[36:39], v[148:151], v[120:123], v[36:39]
    s_waitcnt lgkmcnt(6)
mm_27:
    v_mfma_f32_16x16x32_bf16 v[24:27], v[104:107], v[88:91], v[24:27]
    ds_read_b128 v[120:123], v17 offset:1024
    s_add_u32 s42, s42, 16384
    v_mfma_f32_16x16x32_bf16 v[40:43], v[104:107], v[92:95], v[40:43]
    ds_read_b128 v[124:127], v17 offset:3072
    s_cmp_eq_u32 s42, 49152
    v_mfma_f32_16x16x32_bf16 v[56:59], v[104:107], v[96:99], v[56:59]
    ds_read_b128 v[128:131], v17 offset:5120
    s_cselect_b32 s42, 0, s42
    v_mfma_f32_16x16x32_bf16 v[72:75], v[104:107], v[100:103], v[72:75]
    ds_read_b128 v[132:135], v17 offset:7168
    s_waitcnt lgkmcnt(8)
    v_mfma_f32_16x16x32_bf16 v[76:79], v[108:111], v[100:103], v[76:79]
    ds_read_b64_tr_b16 v[136:137], v18 offset:8192
    s_add_u32 s48, s48, 16384
    v_mfma_f32_16x16x32_bf16 v[60:63], v[108:111], v[96:99], v[60:63]
    ds_read_b64_tr_b16 v[138:139], v18 offset:12288
    s_cmp_eq_u32 s48, 98304
    v_mfma_f32_16x16x32_bf16 v[44:47], v[108:111], v[92:95], v[44:47]
    ds_read_b64_tr_b16 v[140:141], v19 offset:8192
    s_cselect_b32 s48, 0, s48
    v_mfma_f32_16x16x32_bf16 v[28:31], v[108:111], v[88:91], v[28:31]
    ds_read_b64_tr_b16 v[142:143], v19 offset:12288
    s_waitcnt lgkmcnt(8)
    v_mfma_f32_16x16x32_bf16 v[32:35], v[112:115], v[88:91], v[32:35]
    ds_read_b64_tr_b16 v[144:145], v20 offset:8192
    v_add_u32 v17, s42, v12
    v_mfma_f32_16x16x32_bf16 v[48:51], v[112:115], v[92:95], v[48:51]
    ds_read_b64_tr_b16 v[146:147], v20 offset:12288
    v_add_u32 v18, s48, v13
    v_mfma_f32_16x16x32_bf16 v[64:67], v[112:115], v[96:99], v[64:67]
    ds_read_b64_tr_b16 v[148:149], v21 offset:8192
    v_add_u32 v19, s48, v14
    v_mfma_f32_16x16x32_bf16 v[80:83], v[112:115], v[100:103], v[80:83]
    ds_read_b64_tr_b16 v[150:151], v21 offset:12288
    v_add_u32 v20, s48, v15
    v_mfma_f32_16x16x32_bf16 v[84:87], v[116:119], v[100:103], v[84:87]
    v_add_u32 v21, s48, v16
    v_mfma_f32_16x16x32_bf16 v[68:71], v[116:119], v[96:99], v[68:71]
    v_mfma_f32_16x16x32_bf16 v[52:55], v[116:119], v[92:95], v[52:55]
    v_mfma_f32_16x16x32_bf16 v[36:39], v[116:119], v[88:91], v[36:39]
    s_waitcnt lgkmcnt(6)
    v_mfma_f32_16x16x32_bf16 v[24:27], v[136:139], v[120:123], v[24:27]
    s_add_u32 s43, s43, 1
    s_cmp_lt_u32 s43, 4
    v_mfma_f32_16x16x32_bf16 v[40:43], v[136:139], v[124:127], v[40:43]
    v_mfma_f32_16x16x32_bf16 v[56:59], v[136:139], v[128:131], v[56:59]
    s_waitcnt lgkmcnt(0)
    s_barrier
    v_mfma_f32_16x16x32_bf16 v[72:75], v[136:139], v[132:135], v[72:75]
    ds_read_b128 v[88:91], v17 offset:0
    v_mfma_f32_16x16x32_bf16 v[76:79], v[140:143], v[132:135], v[76:79]
    ds_read_b128 v[92:95], v17 offset:2048
    v_mfma_f32_16x16x32_bf16 v[60:63], v[140:143], v[128:131], v[60:63]
    ds_read_b128 v[96:99], v17 offset:4096
    v_mfma_f32_16x16x32_bf16 v[44:47], v[140:143], v[124:127], v[44:47]
    ds_read_b128 v[100:103], v17 offset:6144
    v_mfma_f32_16x16x32_bf16 v[28:31], v[140:143], v[120:123], v[28:31]
    ds_read_b64_tr_b16 v[104:105], v18 offset:0
    v_mfma_f32_16x16x32_bf16 v[32:35], v[144:147], v[120:123], v[32:35]
    ds_read_b64_tr_b16 v[106:107], v18 offset:4096
    v_mfma_f32_16x16x32_bf16 v[48:51], v[144:147], v[124:127], v[48:51]
    ds_read_b64_tr_b16 v[108:109], v19 offset:0
    v_mfma_f32_16x16x32_bf16 v[64:67], v[144:147], v[128:131], v[64:67]
    ds_read_b64_tr_b16 v[110:111], v19 offset:4096
    v_mfma_f32_16x16x32_bf16 v[80:83], v[144:147], v[132:135], v[80:83]
    ds_read_b64_tr_b16 v[112:113], v20 offset:0
    v_mfma_f32_16x16x32_bf16 v[84:87], v[148:151], v[132:135], v[84:87]
    ds_read_b64_tr_b16 v[114:115], v20 offset:4096
    v_mfma_f32_16x16x32_bf16 v[68:71], v[148:151], v[128:131], v[68:71]
    ds_read_b64_tr_b16 v[116:117], v21 offset:0
    v_mfma_f32_16x16x32_bf16 v[52:55], v[148:151], v[124:127], v[52:55]
    ds_read_b64_tr_b16 v[118:119], v21 offset:4096
    v_mfma_f32_16x16x32_bf16 v[36:39], v[148:151], v[120:123], v[36:39]
    s_waitcnt lgkmcnt(6)
    s_cbranch_scc1 mm_27
mm_28:
    v_mfma_f32_16x16x32_bf16 v[24:27], v[104:107], v[88:91], v[24:27]
    ds_read_b128 v[120:123], v17 offset:1024
    s_add_u32 s42, s42, 16384
    v_mfma_f32_16x16x32_bf16 v[40:43], v[104:107], v[92:95], v[40:43]
    ds_read_b128 v[124:127], v17 offset:3072
    s_cmp_eq_u32 s42, 49152
    v_mfma_f32_16x16x32_bf16 v[56:59], v[104:107], v[96:99], v[56:59]
    ds_read_b128 v[128:131], v17 offset:5120
    s_cselect_b32 s42, 0, s42
    v_mfma_f32_16x16x32_bf16 v[72:75], v[104:107], v[100:103], v[72:75]
    ds_read_b128 v[132:135], v17 offset:7168
    s_waitcnt lgkmcnt(8)
    v_mfma_f32_16x16x32_bf16 v[76:79], v[108:111], v[100:103], v[76:79]
    ds_read_b64_tr_b16 v[136:137], v18 offset:8192
    s_add_u32 s48, s48, 16384
    v_mfma_f32_16x16x32_bf16 v[60:63], v[108:111], v[96:99], v[60:63]
    ds_read_b64_tr_b16 v[138:139], v18 offset:12288
    s_cmp_eq_u32 s48, 98304
    v_mfma_f32_16x16x32_bf16 v[44:47], v[108:111], v[92:95], v[44:47]
    ds_read_b64_tr_b16 v[140:141], v19 offset:8192
    s_cselect_b32 s48, 0, s48
    v_mfma_f32_16x16x32_bf16 v[28:31], v[108:111], v[88:91], v[28:31]
    ds_read_b64_tr_b16 v[142:143], v19 offset:12288
    s_waitcnt lgkmcnt(8)
    v_mfma_f32_16x16x32_bf16 v[32:35], v[112:115], v[88:91], v[32:35]
    ds_read_b64_tr_b16 v[144:145], v20 offset:8192
    v_add_u32 v17, s42, v12
    v_mfma_f32_16x16x32_bf16 v[48:51], v[112:115], v[92:95], v[48:51]
    ds_read_b64_tr_b16 v[146:147], v20 offset:12288
    v_add_u32 v18, s48, v13
    v_mfma_f32_16x16x32_bf16 v[64:67], v[112:115], v[96:99], v[64:67]
    ds_read_b64_tr_b16 v[148:149], v21 offset:8192
    v_add_u32 v19, s48, v14
    v_mfma_f32_16x16x32_bf16 v[80:83], v[112:115], v[100:103], v[80:83]
    ds_read_b64_tr_b16 v[150:151], v21 offset:12288
    v_add_u32 v20, s48, v15
    v_mfma_f32_16x16x32_bf16 v[84:87], v[116:119], v[100:103], v[84:87]
    v_add_u32 v21, s48, v16
    v_mfma_f32_16x16x32_bf16 v[68:71], v[116:119], v[96:99], v[68:71]
    v_mfma_f32_16x16x32_bf16 v[52:55], v[116:119], v[92:95], v[52:55]
    v_mfma_f32_16x16x32_bf16 v[36:39], v[116:119], v[88:91], v[36:39]
    s_waitcnt lgkmcnt(6)
    v_mfma_f32_16x16x32_bf16 v[24:27], v[136:139], v[120:123], v[24:27]
    s_add_u32 s43, s43, 1
    s_cmp_lt_u32 s43, 27
    v_mfma_f32_16x16x32_bf16 v[40:43], v[136:139], v[124:127], v[40:43]
    s_waitcnt vmcnt(0)
    v_mfma_f32_16x16x32_bf16 v[56:59], v[136:139], v[128:131], v[56:59]
    s_waitcnt lgkmcnt(0)
    s_barrier
    v_mfma_f32_16x16x32_bf16 v[72:75], v[136:139], v[132:135], v[72:75]
    ds_read_b128 v[88:91], v17 offset:0
    v_mfma_f32_16x16x32_bf16 v[76:79], v[140:143], v[132:135], v[76:79]
    ds_read_b128 v[92:95], v17 offset:2048
    v_mfma_f32_16x16x32_bf16 v[60:63], v[140:143], v[128:131], v[60:63]
    ds_read_b128 v[96:99], v17 offset:4096
    v_mfma_f32_16x16x32_bf16 v[44:47], v[140:143], v[124:127], v[44:47]
    ds_read_b128 v[100:103], v17 offset:6144
    v_mfma_f32_16x16x32_bf16 v[28:31], v[140:143], v[120:123], v[28:31]
    ds_read_b64_tr_b16 v[104:105], v18 offset:0
    v_mfma_f32_16x16x32_bf16 v[32:35], v[144:147], v[120:123], v[32:35]
    ds_read_b64_tr_b16 v[106:107], v18 offset:4096
    v_mfma_f32_16x16x32_bf16 v[48:51], v[144:147], v[124:127], v[48:51]
    ds_read_b64_tr_b16 v[108:109], v19 offset:0
    v_mfma_f32_16x16x32_bf16 v[64:67], v[144:147], v[128:131], v[64:67]
    ds_read_b64_tr_b16 v[110:111], v19 offset:4096
    v_mfma_f32_16x16x32_bf16 v[80:83], v[144:147], v[132:135], v[80:83]
    ds_read_b64_tr_b16 v[112:113], v20 offset:0
    v_mfma_f32_16x16x32_bf16 v[84:87], v[148:151], v[132:135], v[84:87]
    ds_read_b64_tr_b16 v[114:115], v20 offset:4096
    v_mfma_f32_16x16x32_bf16 v[68:71], v[148:151], v[128:131], v[68:71]
    ds_read_b64_tr_b16 v[116:117], v21 offset:0
    v_mfma_f32_16x16x32_bf16 v[52:55], v[148:151], v[124:127], v[52:55]
    ds_read_b64_tr_b16 v[118:119], v21 offset:4096
    v_mfma_f32_16x16x32_bf16 v[36:39], v[148:151], v[120:123], v[36:39]
    s_waitcnt lgkmcnt(6)
    s_cbranch_scc1 mm_28
    s_cmp_eq_u32 s60, 1
    s_cbranch_scc1 G4_last
    v_mfma_f32_16x16x32_bf16 v[24:27], v[104:107], v[88:91], v[24:27]
    ds_read_b128 v[120:123], v17 offset:1024
    v_mfma_f32_16x16x32_bf16 v[40:43], v[104:107], v[92:95], v[40:43]
    ds_read_b128 v[124:127], v17 offset:3072
    v_mfma_f32_16x16x32_bf16 v[56:59], v[104:107], v[96:99], v[56:59]
    ds_read_b128 v[128:131], v17 offset:5120
    v_mfma_f32_16x16x32_bf16 v[72:75], v[104:107], v[100:103], v[72:75]
    ds_read_b128 v[132:135], v17 offset:7168
    s_waitcnt lgkmcnt(8)
    v_mfma_f32_16x16x32_bf16 v[76:79], v[108:111], v[100:103], v[76:79]
    ds_read_b64_tr_b16 v[136:137], v18 offset:8192
    v_mfma_f32_16x16x32_bf16 v[60:63], v[108:111], v[96:99], v[60:63]
    ds_read_b64_tr_b16 v[138:139], v18 offset:12288
    v_mfma_f32_16x16x32_bf16 v[44:47], v[108:111], v[92:95], v[44:47]
    ds_read_b64_tr_b16 v[140:141], v19 offset:8192
    v_mfma_f32_16x16x32_bf16 v[28:31], v[108:111], v[88:91], v[28:31]
    ds_read_b64_tr_b16 v[142:143], v19 offset:12288
    s_waitcnt lgkmcnt(8)
    v_mfma_f32_16x16x32_bf16 v[32:35], v[112:115], v[88:91], v[32:35]
    ds_read_b64_tr_b16 v[144:145], v20 offset:8192
    v_mfma_f32_16x16x32_bf16 v[48:51], v[112:115], v[92:95], v[48:51]
    ds_read_b64_tr_b16 v[146:147], v20 offset:12288
    v_mfma_f32_16x16x32_bf16 v[64:67], v[112:115], v[96:99], v[64:67]
    ds_read_b64_tr_b16 v[148:149], v21 offset:8192
    v_mfma_f32_16x16x32_bf16 v[80:83], v[112:115], v[100:103], v[80:83]
    ds_read_b64_tr_b16 v[150:151], v21 offset:12288
    v_mfma_f32_16x16x32_bf16 v[84:87], v[116:119], v[100:103], v[84:87]
    v_mfma_f32_16x16x32_bf16 v[68:71], v[116:119], v[96:99], v[68:71]
    v_mfma_f32_16x16x32_bf16 v[52:55], v[116:119], v[92:95], v[52:55]
    v_mfma_f32_16x16x32_bf16 v[36:39], v[116:119], v[88:91], v[36:39]
    s_waitcnt lgkmcnt(0)
    v_mfma_f32_16x16x32_bf16 v[24:27], v[136:139], v[120:123], v[24:27]
    s_mul_i32 s36, s31, 524288
    s_add_u32 s36, s36, 0
    s_add_u32 s16, s62, s36
    v_mfma_f32_16x16x32_bf16 v[40:43], v[136:139], v[124:127], v[40:43]
    s_addc_u32 s17, s63, 0
    s_mov_b32 s18, 516096
    s_mov_b32 s19, 0x20000
    v_mfma_f32_16x16x32_bf16 v[56:59], v[136:139], v[128:131], v[56:59]
    v_mfma_f32_16x16x32_bf16 v[72:75], v[136:139], v[132:135], v[72:75]
    v_mfma_f32_16x16x32_bf16 v[76:79], v[140:143], v[132:135], v[76:79]
    v_mfma_f32_16x16x32_bf16 v[60:63], v[140:143], v[128:131], v[60:63]
    v_mfma_f32_16x16x32_bf16 v[44:47], v[140:143], v[124:127], v[44:47]
    v_mfma_f32_16x16x32_bf16 v[28:31], v[140:143], v[120:123], v[28:31]
    v_mfma_f32_16x16x32_bf16 v[32:35], v[144:147], v[120:123], v[32:35]
    v_mfma_f32_16x16x32_bf16 v[48:51], v[144:147], v[124:127], v[48:51]
    v_mfma_f32_16x16x32_bf16 v[64:67], v[144:147], v[128:131], v[64:67]
    v_mfma_f32_16x16x32_bf16 v[80:83], v[144:147], v[132:135], v[80:83]
    v_mfma_f32_16x16x32_bf16 v[84:87], v[148:151], v[132:135], v[84:87]
    v_mfma_f32_16x16x32_bf16 v[68:71], v[148:151], v[128:131], v[68:71]
    v_mfma_f32_16x16x32_bf16 v[52:55], v[148:151], v[124:127], v[52:55]
    v_mfma_f32_16x16x32_bf16 v[36:39], v[148:151], v[120:123], v[36:39]
    s_add_u32 s36, s39, 0
    v_cvt_pk_bf16_f32 v24, v24, v25
    v_cvt_pk_bf16_f32 v25, v26, v27
    v_cvt_pk_bf16_f32 v26, v28, v29
    v_cvt_pk_bf16_f32 v27, v30, v31
    v_or_b32 v24, 1, v24
    buffer_store_dwordx4 v[24:27], v2, s[16:19], s36 offen offset:0 sc1
    v_cvt_pk_bf16_f32 v32, v32, v33
    v_cvt_pk_bf16_f32 v33, v34, v35
    v_cvt_pk_bf16_f32 v34, v36, v37
    v_cvt_pk_bf16_f32 v35, v38, v39
    v_or_b32 v32, 1, v32
    buffer_store_dwordx4 v[32:35], v2, s[16:19], s36 offen offset:1024 sc1
    s_add_u32 s36, s39, 65536
    v_cvt_pk_bf16_f32 v40, v40, v41
    v_cvt_pk_bf16_f32 v41, v42, v43
    v_cvt_pk_bf16_f32 v42, v44, v45
    v_cvt_pk_bf16_f32 v43, v46, v47
    v_or_b32 v40, 1, v40
    buffer_store_dwordx4 v[40:43], v2, s[16:19], s36 offen offset:0 sc1
    v_cvt_pk_bf16_f32 v48, v48, v49
    v_cvt_pk_bf16_f32 v49, v50, v51
    v_cvt_pk_bf16_f32 v50, v52, v53
    v_cvt_pk_bf16_f32 v51, v54, v55
    v_or_b32 v48, 1, v48
    buffer_store_dwordx4 v[48:51], v2, s[16:19], s36 offen offset:1024 sc1
    s_add_u32 s36, s39, 131072
    v_cvt_pk_bf16_f32 v56, v56, v57
    v_cvt_pk_bf16_f32 v57, v58, v59
    v_cvt_pk_bf16_f32 v58, v60, v61
    v_cvt_pk_bf16_f32 v59, v62, v63
    v_or_b32 v56, 1, v56
    buffer_store_dwordx4 v[56:59], v2, s[16:19], s36 offen offset:0 sc1
    v_cvt_pk_bf16_f32 v64, v64, v65
    v_cvt_pk_bf16_f32 v65, v66, v67
    v_cvt_pk_bf16_f32 v66, v68, v69
    v_cvt_pk_bf16_f32 v67, v70, v71
    v_or_b32 v64, 1, v64
    buffer_store_dwordx4 v[64:67], v2, s[16:19], s36 offen offset:1024 sc1
    s_add_u32 s36, s39, 196608
    v_cvt_pk_bf16_f32 v72, v72, v73
    v_cvt_pk_bf16_f32 v73, v74, v75
    v_cvt_pk_bf16_f32 v74, v76, v77
    v_cvt_pk_bf16_f32 v75, v78, v79
    v_or_b32 v72, 1, v72
    buffer_store_dwordx4 v[72:75], v2, s[16:19], s36 offen offset:0 sc1
    v_cvt_pk_bf16_f32 v80, v80, v81
    v_cvt_pk_bf16_f32 v81, v82, v83
    v_cvt_pk_bf16_f32 v82, v84, v85
    v_cvt_pk_bf16_f32 v83, v86, v87
    v_or_b32 v80, 1, v80
    buffer_store_dwordx4 v[80:83], v2, s[16:19], s36 offen offset:1024 sc1
    s_barrier
    s_branch NEXT
G4_last:
    v_mfma_f32_16x16x32_bf16 v[24:27], v[104:107], v[88:91], v[24:27]
    ds_read_b128 v[120:123], v17 offset:1024
    v_mfma_f32_16x16x32_bf16 v[40:43], v[104:107], v[92:95], v[40:43]
    ds_read_b128 v[124:127], v17 offset:3072
    v_mfma_f32_16x16x32_bf16 v[56:59], v[104:107], v[96:99], v[56:59]
    ds_read_b128 v[128:131], v17 offset:5120
    v_mfma_f32_16x16x32_bf16 v[72:75], v[104:107], v[100:103], v[72:75]
    ds_read_b128 v[132:135], v17 offset:7168
    s_waitcnt lgkmcnt(8)
    v_mfma_f32_16x16x32_bf16 v[76:79], v[108:111], v[100:103], v[76:79]
    ds_read_b64_tr_b16 v[136:137], v18 offset:8192
    v_mfma_f32_16x16x32_bf16 v[60:63], v[108:111], v[96:99], v[60:63]
    ds_read_b64_tr_b16 v[138:139], v18 offset:12288
    v_mfma_f32_16x16x32_bf16 v[44:47], v[108:111], v[92:95], v[44:47]
    ds_read_b64_tr_b16 v[140:141], v19 offset:8192
    v_mfma_f32_16x16x32_bf16 v[28:31], v[108:111], v[88:91], v[28:31]
    ds_read_b64_tr_b16 v[142:143], v19 offset:12288
    s_waitcnt lgkmcnt(8)
    v_mfma_f32_16x16x32_bf16 v[32:35], v[112:115], v[88:91], v[32:35]
    ds_read_b64_tr_b16 v[144:145], v20 offset:8192
    v_mfma_f32_16x16x32_bf16 v[48:51], v[112:115], v[92:95], v[48:51]
    ds_read_b64_tr_b16 v[146:147], v20 offset:12288
    s_load_dwordx2 s[6:7], s[0:1], 88
    v_mfma_f32_16x16x32_bf16 v[64:67], v[112:115], v[96:99], v[64:67]
    ds_read_b64_tr_b16 v[148:149], v21 offset:8192
    v_mfma_f32_16x16x32_bf16 v[80:83], v[112:115], v[100:103], v[80:83]
    ds_read_b64_tr_b16 v[150:151], v21 offset:12288
    v_mfma_f32_16x16x32_bf16 v[84:87], v[116:119], v[100:103], v[84:87]
    v_mfma_f32_16x16x32_bf16 v[68:71], v[116:119], v[96:99], v[68:71]
    v_mfma_f32_16x16x32_bf16 v[52:55], v[116:119], v[92:95], v[52:55]
    v_mfma_f32_16x16x32_bf16 v[36:39], v[116:119], v[88:91], v[36:39]
    s_waitcnt lgkmcnt(0)
    v_mfma_f32_16x16x32_bf16 v[24:27], v[136:139], v[120:123], v[24:27]
    s_add_u32 s16, s62, 0x80000
    s_addc_u32 s17, s63, 0
    s_mov_b32 s18, 0x7e000
    v_mfma_f32_16x16x32_bf16 v[40:43], v[136:139], v[124:127], v[40:43]
    s_mov_b32 s19, 0x20000
    s_mov_b32 s20, s6
    s_mov_b32 s21, s7
    v_mfma_f32_16x16x32_bf16 v[56:59], v[136:139], v[128:131], v[56:59]
    s_mov_b32 s22, 0x400000
    s_mov_b32 s23, 0x20000
    s_add_u32 s44, s40, 65536
    v_mfma_f32_16x16x32_bf16 v[72:75], v[136:139], v[132:135], v[72:75]
    s_lshl_b32 s46, s28, 3
    s_add_u32 s46, s46, s37
    s_lshl_b32 s47, s31, 1
    v_mfma_f32_16x16x32_bf16 v[76:79], v[140:143], v[132:135], v[76:79]
    s_add_u32 s46, s46, s47
    s_lshl_b32 s46, s46, 15
    s_lshl_b32 s47, s38, 5
    v_mfma_f32_16x16x32_bf16 v[60:63], v[140:143], v[128:131], v[60:63]
    s_add_u32 s46, s46, s47
    s_add_u32 s47, s46, 32768
    v_and_b32 v225, 1, v23
    v_mfma_f32_16x16x32_bf16 v[44:47], v[140:143], v[124:127], v[44:47]
    v_lshlrev_b32 v224, 11, v22
    v_lshl_add_u32 v224, v225, 5, v224
    v_mfma_f32_16x16x32_bf16 v[28:31], v[140:143], v[120:123], v[28:31]
    v_lshrrev_b32 v225, 1, v23
    v_lshl_add_u32 v224, v225, 4, v224
    v_mfma_f32_16x16x32_bf16 v[32:35], v[144:147], v[120:123], v[32:35]
    v_lshrrev_b32 v225, 3, v22
    v_mul_u32_u24 v225, 16320, v225
    v_mfma_f32_16x16x32_bf16 v[48:51], v[144:147], v[124:127], v[48:51]
    v_sub_u32 v224, v224, v225
    v_add_u32 v225, 16384, v224
    v_mfma_f32_16x16x32_bf16 v[64:67], v[144:147], v[128:131], v[64:67]
    v_mfma_f32_16x16x32_bf16 v[80:83], v[144:147], v[132:135], v[80:83]
    v_mfma_f32_16x16x32_bf16 v[84:87], v[148:151], v[132:135], v[84:87]
    v_mfma_f32_16x16x32_bf16 v[68:71], v[148:151], v[128:131], v[68:71]
    v_mfma_f32_16x16x32_bf16 v[52:55], v[148:151], v[124:127], v[52:55]
    v_mfma_f32_16x16x32_bf16 v[36:39], v[148:151], v[120:123], v[36:39]
    s_cmp_eq_u32 s31, 0
    s_cbranch_scc1 G4_k0
    s_add_u32 s36, s41, 0
    v_cvt_pk_bf16_f32 v24, v24, v25
    v_cvt_pk_bf16_f32 v25, v26, v27
    v_cvt_pk_bf16_f32 v26, v28, v29
    v_cvt_pk_bf16_f32 v27, v30, v31
    v_or_b32 v24, 1, v24
    buffer_store_dwordx4 v[24:27], v2, s[16:19], s36 offen offset:0 sc1
    v_cvt_pk_bf16_f32 v32, v32, v33
    v_cvt_pk_bf16_f32 v33, v34, v35
    v_cvt_pk_bf16_f32 v34, v36, v37
    v_cvt_pk_bf16_f32 v35, v38, v39
    v_or_b32 v32, 1, v32
    buffer_store_dwordx4 v[32:35], v2, s[16:19], s36 offen offset:1024 sc1
    s_add_u32 s36, s41, 65536
    v_cvt_pk_bf16_f32 v40, v40, v41
    v_cvt_pk_bf16_f32 v41, v42, v43
    v_cvt_pk_bf16_f32 v42, v44, v45
    v_cvt_pk_bf16_f32 v43, v46, v47
    v_or_b32 v40, 1, v40
    buffer_store_dwordx4 v[40:43], v2, s[16:19], s36 offen offset:0 sc1
    v_cvt_pk_bf16_f32 v48, v48, v49
    v_cvt_pk_bf16_f32 v49, v50, v51
    v_cvt_pk_bf16_f32 v50, v52, v53
    v_cvt_pk_bf16_f32 v51, v54, v55
    v_or_b32 v48, 1, v48
    buffer_store_dwordx4 v[48:51], v2, s[16:19], s36 offen offset:1024 sc1
    v_pk_mov_b32 v[24:25], v[56:57], v[56:57] op_sel:[0,1]
    v_pk_mov_b32 v[26:27], v[58:59], v[58:59] op_sel:[0,1]
    v_pk_mov_b32 v[28:29], v[60:61], v[60:61] op_sel:[0,1]
    v_pk_mov_b32 v[30:31], v[62:63], v[62:63] op_sel:[0,1]
    v_pk_mov_b32 v[32:33], v[64:65], v[64:65] op_sel:[0,1]
    v_pk_mov_b32 v[34:35], v[66:67], v[66:67] op_sel:[0,1]
    v_pk_mov_b32 v[36:37], v[68:69], v[68:69] op_sel:[0,1]
    v_pk_mov_b32 v[38:39], v[70:71], v[70:71] op_sel:[0,1]
    v_pk_mov_b32 v[40:41], v[72:73], v[72:73] op_sel:[0,1]
    v_pk_mov_b32 v[42:43], v[74:75], v[74:75] op_sel:[0,1]
    v_pk_mov_b32 v[44:45], v[76:77], v[76:77] op_sel:[0,1]
    v_pk_mov_b32 v[46:47], v[78:79], v[78:79] op_sel:[0,1]
    v_pk_mov_b32 v[48:49], v[80:81], v[80:81] op_sel:[0,1]
    v_pk_mov_b32 v[50:51], v[82:83], v[82:83] op_sel:[0,1]
    v_pk_mov_b32 v[52:53], v[84:85], v[84:85] op_sel:[0,1]
    v_pk_mov_b32 v[54:55], v[86:87], v[86:87] op_sel:[0,1]
    s_branch G4_k1
G4_k0:
    s_add_u32 s36, s41, 0
    v_cvt_pk_bf16_f32 v56, v56, v57
    v_cvt_pk_bf16_f32 v57, v58, v59
    v_cvt_pk_bf16_f32 v58, v60, v61
    v_cvt_pk_bf16_f32 v59, v62, v63
    v_or_b32 v56, 1, v56
    buffer_store_dwordx4 v[56:59], v2, s[16:19], s36 offen offset:0 sc1
    v_cvt_pk_bf16_f32 v64, v64, v65
    v_cvt_pk_bf16_f32 v65, v66, v67
    v_cvt_pk_bf16_f32 v66, v68, v69
    v_cvt_pk_bf16_f32 v67, v70, v71
    v_or_b32 v64, 1, v64
    buffer_store_dwordx4 v[64:67], v2, s[16:19], s36 offen offset:1024 sc1
    s_add_u32 s36, s41, 65536
    v_cvt_pk_bf16_f32 v72, v72, v73
    v_cvt_pk_bf16_f32 v73, v74, v75
    v_cvt_pk_bf16_f32 v74, v76, v77
    v_cvt_pk_bf16_f32 v75, v78, v79
    v_or_b32 v72, 1, v72
    buffer_store_dwordx4 v[72:75], v2, s[16:19], s36 offen offset:0 sc1
    v_cvt_pk_bf16_f32 v80, v80, v81
    v_cvt_pk_bf16_f32 v81, v82, v83
    v_cvt_pk_bf16_f32 v82, v84, v85
    v_cvt_pk_bf16_f32 v83, v86, v87
    v_or_b32 v80, 1, v80
    buffer_store_dwordx4 v[80:83], v2, s[16:19], s36 offen offset:1024 sc1
G4_k1:
    s_mov_b32 s78, 0x3f80
    s_mov_b32 s79, 0x3f800000
    v_dot2_f32_bf16 v24, v180, s78, v24
    v_dot2_f32_bf16 v25, v180, s79, v25
    v_dot2_f32_bf16 v26, v181, s78, v26
    v_dot2_f32_bf16 v27, v181, s79, v27
    v_dot2_f32_bf16 v28, v182, s78, v28
    v_dot2_f32_bf16 v29, v182, s79, v29
    v_dot2_f32_bf16 v30, v183, s78, v30
    v_dot2_f32_bf16 v31, v183, s79, v31
    v_dot2_f32_bf16 v32, v188, s78, v32
    v_dot2_f32_bf16 v33, v188, s79, v33
    v_dot2_f32_bf16 v34, v189, s78, v34
    v_dot2_f32_bf16 v35, v189, s79, v35
    v_dot2_f32_bf16 v36, v190, s78, v36
    v_dot2_f32_bf16 v37, v190, s79, v37
    v_dot2_f32_bf16 v38, v191, s78, v38
    v_dot2_f32_bf16 v39, v191, s79, v39
    v_dot2_f32_bf16 v40, v196, s78, v40
    v_dot2_f32_bf16 v41, v196, s79, v41
    v_dot2_f32_bf16 v42, v197, s78, v42
    v_dot2_f32_bf16 v43, v197, s79, v43
    v_dot2_f32_bf16 v44, v198, s78, v44
    v_dot2_f32_bf16 v45, v198, s79, v45
    v_dot2_f32_bf16 v46, v199, s78, v46
    v_dot2_f32_bf16 v47, v199, s79, v47
    v_dot2_f32_bf16 v48, v234, s78, v48
    v_dot2_f32_bf16 v49, v234, s79, v49
    v_dot2_f32_bf16 v50, v235, s78, v50
    v_dot2_f32_bf16 v51, v235, s79, v51
    v_dot2_f32_bf16 v52, v236, s78, v52
    v_dot2_f32_bf16 v53, v236, s79, v53
    v_dot2_f32_bf16 v54, v237, s78, v54
    v_dot2_f32_bf16 v55, v237, s79, v55
    v_dot2_f32_bf16 v24, v184, s78, v24
    v_dot2_f32_bf16 v25, v184, s79, v25
    v_dot2_f32_bf16 v26, v185, s78, v26
    v_dot2_f32_bf16 v27, v185, s79, v27
    v_dot2_f32_bf16 v28, v186, s78, v28
    v_dot2_f32_bf16 v29, v186, s79, v29
    v_dot2_f32_bf16 v30, v187, s78, v30
    v_dot2_f32_bf16 v31, v187, s79, v31
    v_dot2_f32_bf16 v32, v192, s78, v32
    v_dot2_f32_bf16 v33, v192, s79, v33
    v_dot2_f32_bf16 v34, v193, s78, v34
    v_dot2_f32_bf16 v35, v193, s79, v35
    v_dot2_f32_bf16 v36, v194, s78, v36
    v_dot2_f32_bf16 v37, v194, s79, v37
    v_dot2_f32_bf16 v38, v195, s78, v38
    v_dot2_f32_bf16 v39, v195, s79, v39
    v_dot2_f32_bf16 v40, v230, s78, v40
    v_dot2_f32_bf16 v41, v230, s79, v41
    v_dot2_f32_bf16 v42, v231, s78, v42
    v_dot2_f32_bf16 v43, v231, s79, v43
    v_dot2_f32_bf16 v44, v232, s78, v44
    v_dot2_f32_bf16 v45, v232, s79, v45
    v_dot2_f32_bf16 v46, v233, s78, v46
    v_dot2_f32_bf16 v47, v233, s79, v47
    v_dot2_f32_bf16 v48, v248, s78, v48
    v_dot2_f32_bf16 v49, v248, s79, v49
    v_dot2_f32_bf16 v50, v249, s78, v50
    v_dot2_f32_bf16 v51, v249, s79, v51
    v_dot2_f32_bf16 v52, v250, s78, v52
    v_dot2_f32_bf16 v53, v250, s79, v53
    v_dot2_f32_bf16 v54, v251, s78, v54
    v_dot2_f32_bf16 v55, v251, s79, v55
    s_mov_b32 s53, 0
dp_29:
    buffer_load_dwordx4 v[208:211], v2, s[16:19], s40 offen offset:0 sc1
    buffer_load_dwordx4 v[212:215], v2, s[16:19], s40 offen offset:1024 sc1
    buffer_load_dwordx4 v[216:219], v2, s[16:19], s44 offen offset:0 sc1
    buffer_load_dwordx4 v[220:223], v2, s[16:19], s44 offen offset:1024 sc1
    s_waitcnt vmcnt(0)
    v_bitop3_b32 v6, v208, v212, v216 bitop3:0x80
    v_bitop3_b32 v6, v6, v220, 1 bitop3:0x80
    v_cmp_eq_u32 vcc, 0, v6
    s_cbranch_vccz dq_30
    s_sleep 2
    s_add_u32 s53, s53, 1
    s_cmp_lt_u32 s53, s61
    s_cbranch_scc1 dp_29
    s_mov_b32 s61, 0
dq_30:
    v_dot2_f32_bf16 v24, v208, s78, v24
    v_dot2_f32_bf16 v25, v208, s79, v25
    v_dot2_f32_bf16 v26, v209, s78, v26
    v_dot2_f32_bf16 v27, v209, s79, v27
    v_dot2_f32_bf16 v28, v210, s78, v28
    v_dot2_f32_bf16 v29, v210, s79, v29
    v_dot2_f32_bf16 v30, v211, s78, v30
    v_dot2_f32_bf16 v31, v211, s79, v31
    v_cvt_pk_bf16_f32 v24, v24, v25
    v_cvt_pk_bf16_f32 v25, v26, v27
    v_cvt_pk_bf16_f32 v26, v28, v29
    v_cvt_pk_bf16_f32 v27, v30, v31
    s_nop 0
    v_permlane16_swap_b32 v24, v26
    v_permlane16_swap_b32 v25, v27
    v_dot2_f32_bf16 v32, v212, s78, v32
    v_dot2_f32_bf16 v33, v212, s79, v33
    v_dot2_f32_bf16 v34, v213, s78, v34
    v_dot2_f32_bf16 v35, v213, s79, v35
    v_dot2_f32_bf16 v36, v214, s78, v36
    v_dot2_f32_bf16 v37, v214, s79, v37
    v_dot2_f32_bf16 v38, v215, s78, v38
    v_dot2_f32_bf16 v39, v215, s79, v39
    v_cvt_pk_bf16_f32 v32, v32, v33
    v_cvt_pk_bf16_f32 v33, v34, v35
    v_cvt_pk_bf16_f32 v34, v36, v37
    v_cvt_pk_bf16_f32 v35, v38, v39
    s_nop 0
    v_permlane16_swap_b32 v32, v34
    v_permlane16_swap_b32 v33, v35
    v_mov_b32 v36, v24
    v_mov_b32 v37, v25
    v_mov_b32 v38, v26
    v_mov_b32 v39, v27
    v_mov_b32_dpp v24, v32 row_ror:8 row_mask:0xf bank_mask:0xc
    v_mov_b32_dpp v25, v33 row_ror:8 row_mask:0xf bank_mask:0xc
    v_mov_b32_dpp v26, v34 row_ror:8 row_mask:0xf bank_mask:0xc
    v_mov_b32_dpp v27, v35 row_ror:8 row_mask:0xf bank_mask:0xc
    v_mov_b32_dpp v32, v36 row_ror:8 row_mask:0xf bank_mask:0x3
    v_mov_b32_dpp v33, v37 row_ror:8 row_mask:0xf bank_mask:0x3
    v_mov_b32_dpp v34, v38 row_ror:8 row_mask:0xf bank_mask:0x3
    v_mov_b32_dpp v35, v39 row_ror:8 row_mask:0xf bank_mask:0x3
    buffer_store_dwordx4 v[24:27], v224, s[20:23], s46 offen sc1
    buffer_store_dwordx4 v[32:35], v225, s[20:23], s46 offen sc1
    v_dot2_f32_bf16 v40, v216, s78, v40
    v_dot2_f32_bf16 v41, v216, s79, v41
    v_dot2_f32_bf16 v42, v217, s78, v42
    v_dot2_f32_bf16 v43, v217, s79, v43
    v_dot2_f32_bf16 v44, v218, s78, v44
    v_dot2_f32_bf16 v45, v218, s79, v45
    v_dot2_f32_bf16 v46, v219, s78, v46
    v_dot2_f32_bf16 v47, v219, s79, v47
    v_cvt_pk_bf16_f32 v40, v40, v41
    v_cvt_pk_bf16_f32 v41, v42, v43
    v_cvt_pk_bf16_f32 v42, v44, v45
    v_cvt_pk_bf16_f32 v43, v46, v47
    s_nop 0
    v_permlane16_swap_b32 v40, v42
    v_permlane16_swap_b32 v41, v43
    v_dot2_f32_bf16 v48, v220, s78, v48
    v_dot2_f32_bf16 v49, v220, s79, v49
    v_dot2_f32_bf16 v50, v221, s78, v50
    v_dot2_f32_bf16 v51, v221, s79, v51
    v_dot2_f32_bf16 v52, v222, s78, v52
    v_dot2_f32_bf16 v53, v222, s79, v53
    v_dot2_f32_bf16 v54, v223, s78, v54
    v_dot2_f32_bf16 v55, v223, s79, v55
    v_cvt_pk_bf16_f32 v48, v48, v49
    v_cvt_pk_bf16_f32 v49, v50, v51
    v_cvt_pk_bf16_f32 v50, v52, v53
    v_cvt_pk_bf16_f32 v51, v54, v55
    s_nop 0
    v_permlane16_swap_b32 v48, v50
    v_permlane16_swap_b32 v49, v51
    v_mov_b32 v52, v40
    v_mov_b32 v53, v41
    v_mov_b32 v54, v42
    v_mov_b32 v55, v43
    v_mov_b32_dpp v40, v48 row_ror:8 row_mask:0xf bank_mask:0xc
    v_mov_b32_dpp v41, v49 row_ror:8 row_mask:0xf bank_mask:0xc
    v_mov_b32_dpp v42, v50 row_ror:8 row_mask:0xf bank_mask:0xc
    v_mov_b32_dpp v43, v51 row_ror:8 row_mask:0xf bank_mask:0xc
    v_mov_b32_dpp v48, v52 row_ror:8 row_mask:0xf bank_mask:0x3
    v_mov_b32_dpp v49, v53 row_ror:8 row_mask:0xf bank_mask:0x3
    v_mov_b32_dpp v50, v54 row_ror:8 row_mask:0xf bank_mask:0x3
    v_mov_b32_dpp v51, v55 row_ror:8 row_mask:0xf bank_mask:0x3
    buffer_store_dwordx4 v[40:43], v224, s[20:23], s47 offen sc1
    buffer_store_dwordx4 v[48:51], v225, s[20:23], s47 offen sc1
    s_branch K_fin
LOADERS:
    s_cmp_lg_u32 s60, 0
    s_cbranch_scc1 pr_31
    s_and_b32 s36, s29, 6
    s_cmp_eq_u32 s36, 2
    s_cbranch_scc0 pr_31
    s_call_b64 s[76:77], SUB_park2
pr_31:
    s_cmp_ge_u32 s30, 6
    s_cbranch_scc1 WLOAD
    s_add_u32 s54, s55, 0x500
    v_mov_b32 v222, s54
    s_lshl_b32 s53, s29, 7
    s_add_u32 s53, s53, 23121920
    v_mov_b32 v226, s53
    s_sleep 30
    s_mov_b64 exec, 1
    buffer_load_dword v227, v226, s[56:59], 0 offen sc1
    s_mov_b64 exec, -1
    s_waitcnt vmcnt(0)
    v_readfirstlane_b32 s53, v227
    s_add_u32 s54, s52, 16
    s_cmp_eq_u32 s53, s54
    s_cbranch_scc1 fok_32
    s_mov_b32 s53, 0
    s_add_u32 s54, s52, 16
    s_bfm_b64 exec, 1, 0
poll_33:
    buffer_load_dword v227, v226, s[56:59], 0 offen sc1
    s_waitcnt vmcnt(0)
    v_xor_b32 v227, s54, v227
    v_cmp_eq_u32 vcc, 0, v227
    s_nop 0
    s_cmp_eq_u64 vcc, exec
    s_cbranch_scc1 pok_34
    s_sleep 5
    s_add_u32 s53, s53, 1
    s_cmp_lt_u32 s53, s61
    s_cbranch_scc1 poll_33
    s_mov_b32 s61, 0
pok_34:
    s_mov_b64 exec, -1
fok_32:
    s_add_u32 s24, s4, 0x1400000
    s_addc_u32 s25, s5, 0
    s_mov_b32 s26, 0x20000
    s_mov_b32 s27, 0x20000
    s_cmp_eq_u32 s60, 0
    s_cselect_b32 s26, s26, 0
    s_and_b32 s36, s30, 1
    s_mul_i32 s36, s36, 128
    s_mul_i32 s37, s29, 256
    s_add_u32 s37, s36, s37
    v_lshrrev_b32 v224, 3, v1
    v_mul_u32_u24 v224, 4096, v224
    v_and_b32 v23, 112, v2
    v_add_u32 v224, v224, v23
    s_cmp_eq_u32 s60, 0
    s_cselect_b64 exec, -1, 0
    buffer_load_dwordx4 v[24:27], v224, s[24:27], s37 offen sc1
    s_add_u32 s37, s37, 32768
    buffer_load_dwordx4 v[28:31], v224, s[24:27], s37 offen sc1
    s_add_u32 s37, s37, 32768
    buffer_load_dwordx4 v[32:35], v224, s[24:27], s37 offen sc1
    s_add_u32 s37, s37, 32768
    buffer_load_dwordx4 v[36:39], v224, s[24:27], s37 offen sc1
    s_add_u32 s37, s37, 32768
    s_mov_b64 exec, -1
    s_mov_b64 exec, 1
    buffer_load_dword v223, v222, s[56:59], 0 offen sc1
    s_mov_b64 exec, -1
    s_waitcnt vmcnt(0)
    v_readfirstlane_b32 s53, v223
    s_add_u32 s54, s52, 16
    s_cmp_eq_u32 s53, s54
    s_cbranch_scc1 fok_35
    s_mov_b32 s53, 0
    s_add_u32 s54, s52, 16
    s_bfm_b64 exec, 1, 0
poll_36:
    buffer_load_dword v223, v222, s[56:59], 0 offen sc1
    s_waitcnt vmcnt(0)
    v_xor_b32 v223, s54, v223
    v_cmp_eq_u32 vcc, 0, v223
    s_nop 0
    s_cmp_eq_u64 vcc, exec
    s_cbranch_scc1 pok_37
    s_sleep 5
    s_add_u32 s53, s53, 1
    s_cmp_lt_u32 s53, s61
    s_cbranch_scc1 poll_36
    s_mov_b32 s61, 0
pok_37:
    s_mov_b64 exec, -1
fok_35:
    s_add_u32 s20, s62, 0x5d0000
    s_addc_u32 s21, s63, 0
    s_mov_b32 s22, 0x800
    s_mov_b32 s23, 0x20000
    s_and_b32 s35, s30, 1
    s_lshl_b32 s35, s35, 10
    buffer_load_dwordx4 v[16:19], v2, s[20:23], s35 offen sc1
    s_cmp_lg_u32 s60, 0
    s_cbranch_scc1 pc_38
    v_add_f32 v24, v24, v28
    v_add_f32 v25, v25, v29
    v_add_f32 v26, v26, v30
    v_add_f32 v27, v27, v31
    v_add_f32 v24, v24, v32
    v_add_f32 v25, v25, v33
    v_add_f32 v26, v26, v34
    v_add_f32 v27, v27, v35
    v_add_f32 v24, v24, v36
    v_add_f32 v25, v25, v37
    v_add_f32 v26, v26, v38
    v_add_f32 v27, v27, v39
    v_add_f32_dpp v24, v24, v24 row_ror:8 row_mask:0xf bank_mask:0xf
    v_add_f32_dpp v25, v25, v25 row_ror:8 row_mask:0xf bank_mask:0xf
    v_add_f32_dpp v26, v26, v26 row_ror:8 row_mask:0xf bank_mask:0xf
    v_add_f32_dpp v27, v27, v27 row_ror:8 row_mask:0xf bank_mask:0xf
    v_mov_b32 v28, v24
    v_mov_b32 v29, v25
    v_mov_b32 v30, v26
    v_mov_b32 v31, v27
    v_permlane16_swap_b32 v24, v28
    v_permlane16_swap_b32 v25, v29
    v_permlane16_swap_b32 v26, v30
    v_permlane16_swap_b32 v27, v31
    v_add_f32 v24, v24, v28
    v_add_f32 v25, v25, v29
    v_add_f32 v26, v26, v30
    v_add_f32 v27, v27, v31
    v_mov_b32 v28, v24
    v_mov_b32 v29, v25
    v_mov_b32 v30, v26
    v_mov_b32 v31, v27
    v_permlane32_swap_b32 v24, v28
    v_permlane32_swap_b32 v25, v29
    v_permlane32_swap_b32 v26, v30
    v_permlane32_swap_b32 v27, v31
    v_add_f32 v24, v24, v28
    v_add_f32 v25, v25, v29
    v_add_f32 v26, v26, v30
    v_add_f32 v27, v27, v31
pc_38:
    s_cmp_lg_u32 s60, 0
    s_cbranch_scc1 pc_39
    s_and_b32 s36, s30, 1
    s_mul_i32 s36, s36, 128
    s_add_u32 s36, s36, 163328
    v_add_u32 v23, s36, v2
    s_bfm_b64 exec, 8, 0
    ds_write_b128 v23, v[24:27]
    s_mov_b64 exec, -1
    s_waitcnt lgkmcnt(0)
pc_39:
    s_waitcnt vmcnt(0)
    s_and_b32 s36, s30, 1
    s_lshl_b32 s36, s36, 10
    s_add_u32 s36, s36, 160768
    v_add_u32 v221, s36, v2
    ds_write_b128 v221, v[16:19]
    s_waitcnt lgkmcnt(0)
    s_cmp_lg_u32 s30, 4
    s_cbranch_scc1 AL_nw
    s_cmp_eq_u32 s60, 0
    s_cbranch_scc1 AL_nw
    s_add_u32 s54, s55, 0xffc00300
    s_add_u32 s53, s54, s92
    v_mov_b32 v9, s53
    s_add_u32 s53, s53, 128
    v_writelane_b32 v9, s53, 1
    s_add_u32 s53, s54, s93
    v_writelane_b32 v9, s53, 2
    s_add_u32 s53, s53, 128
    v_writelane_b32 v9, s53, 3
    s_mov_b32 s53, 0
    s_add_u32 s54, s52, 8
    s_bfm_b64 exec, 4, 0
poll_41:
    buffer_load_dword v8, v9, s[56:59], 0 offen sc1
    s_waitcnt vmcnt(0)
    v_xor_b32 v8, s54, v8
    v_cmp_eq_u32 vcc, 0, v8
    s_nop 0
    s_cmp_eq_u64 vcc, exec
    s_cbranch_scc1 pok_42
    s_sleep 5
    s_add_u32 s53, s53, 1
    s_cmp_lt_u32 s53, s61
    s_cbranch_scc1 poll_41
    s_mov_b32 s61, 0
pok_42:
    s_mov_b64 exec, -1
AL_nw:
    s_barrier
    s_call_b64 s[76:77], SUB_after_g1
    s_barrier
    s_waitcnt vmcnt(0)
    s_barrier
    s_call_b64 s[76:77], SUB_after_g2
    s_and_b32 s35, s30, 1
    s_add_u32 s12, s62, 0x80000
    s_addc_u32 s13, s63, 0
    s_mov_b32 s14, 0x7e000
    s_mov_b32 s15, 0x20000
    s_mul_i32 s38, s35, 262144
    s_lshl_b32 s41, s35, 13
    s_mov_b32 s42, 0
    s_mov_b32 s44, 0
    s_add_u32 s54, s55, 0x200
    v_mov_b32 v9, s54
    s_mov_b32 s44, 1
    s_mov_b32 s42, 16384
    s_add_u32 s54, s55, 0x580
    v_mov_b32 v222, s54
    v_lshlrev_b32 v221, 3, v1
    s_add_u32 s19, s41, s42
    v_readlane_b32 s16, v248, s44
    s_nop 0
    s_add_u32 s16, s16, s38
    s_add_u32 s44, s44, 1
    s_and_b32 s44, s44, 15
    s_add_u32 s42, s42, 16384
    s_cmp_eq_u32 s42, 49152
    s_cselect_b32 s42, 0, s42
    s_mov_b32 m0, s19
    s_mov_b32 s39, s16
    s_waitcnt vmcnt(63)
    s_barrier
    s_sleep 6
    s_mov_b32 s53, 0
    s_add_u32 s54, s52, 16
    s_bfm_b64 exec, 1, 0
poll_43:
    buffer_load_dword v8, v9, s[56:59], 0 offen sc1
    s_waitcnt vmcnt(0)
    v_xor_b32 v8, s54, v8
    v_cmp_eq_u32 vcc, 0, v8
    s_nop 0
    s_cmp_eq_u64 vcc, exec
    s_cbranch_scc1 pok_44
    s_sleep 5
    s_add_u32 s53, s53, 1
    s_cmp_lt_u32 s53, s61
    s_cbranch_scc1 poll_43
    s_mov_b32 s61, 0
pok_44:
    s_mov_b64 exec, -1
    buffer_load_dwordx4 v2, s[12:15], s39 offen sc1 lds
    buffer_load_dwordx4 v2, s[12:15], s39 offen offset:1024 sc1 lds
    s_add_u32 s19, s41, s42
    v_readlane_b32 s16, v248, s44
    s_nop 0
    s_add_u32 s16, s16, s38
    s_add_u32 s44, s44, 1
    s_and_b32 s44, s44, 15
    s_add_u32 s42, s42, 16384
    s_cmp_eq_u32 s42, 49152
    s_cselect_b32 s42, 0, s42
    s_add_u32 m0, m0, 2048
    s_add_u32 s39, s39, 65536
    buffer_load_dwordx4 v2, s[12:15], s39 offen sc1 lds
    buffer_load_dwordx4 v2, s[12:15], s39 offen offset:1024 sc1 lds
    s_add_u32 m0, m0, 2048
    s_add_u32 s39, s39, 65536
    buffer_load_dwordx4 v2, s[12:15], s39 offen sc1 lds
    buffer_load_dwordx4 v2, s[12:15], s39 offen offset:1024 sc1 lds
    s_add_u32 m0, m0, 2048
    s_add_u32 s39, s39, 65536
    buffer_load_dwordx4 v2, s[12:15], s39 offen sc1 lds
    buffer_load_dwordx4 v2, s[12:15], s39 offen offset:1024 sc1 lds
    s_mov_b32 m0, s19
    s_mov_b32 s39, s16
    buffer_load_dwordx4 v2, s[12:15], s39 offen sc1 lds
    buffer_load_dwordx4 v2, s[12:15], s39 offen offset:1024 sc1 lds
    s_add_u32 s19, s41, s42
    v_readlane_b32 s16, v248, s44
    s_nop 0
    s_add_u32 s16, s16, s38
    s_add_u32 s44, s44, 1
    s_and_b32 s44, s44, 15
    s_add_u32 s42, s42, 16384
    s_cmp_eq_u32 s42, 49152
    s_cselect_b32 s42, 0, s42
    s_add_u32 m0, m0, 2048
    s_add_u32 s39, s39, 65536
    buffer_load_dwordx4 v2, s[12:15], s39 offen sc1 lds
    buffer_load_dwordx4 v2, s[12:15], s39 offen offset:1024 sc1 lds
    s_add_u32 m0, m0, 2048
    s_add_u32 s39, s39, 65536
    buffer_load_dwordx4 v2, s[12:15], s39 offen sc1 lds
    buffer_load_dwordx4 v2, s[12:15], s39 offen offset:1024 sc1 lds
    s_add_u32 m0, m0, 2048
    s_add_u32 s39, s39, 65536
    buffer_load_dwordx4 v2, s[12:15], s39 offen sc1 lds
    buffer_load_dwordx4 v2, s[12:15], s39 offen offset:1024 sc1 lds
    s_mov_b32 m0, s19
    s_mov_b32 s39, s16
    s_waitcnt vmcnt(8)
    s_barrier
    buffer_load_dwordx4 v2, s[12:15], s39 offen sc1 lds
    buffer_load_dwordx4 v2, s[12:15], s39 offen offset:1024 sc1 lds
    s_add_u32 s19, s41, s42
    v_readlane_b32 s16, v248, s44
    s_nop 0
    s_add_u32 s16, s16, s38
    s_add_u32 s44, s44, 1
    s_and_b32 s44, s44, 15
    s_add_u32 s42, s42, 16384
    s_cmp_eq_u32 s42, 49152
    s_cselect_b32 s42, 0, s42
    s_add_u32 m0, m0, 2048
    s_add_u32 s39, s39, 65536
    buffer_load_dwordx4 v2, s[12:15], s39 offen sc1 lds
    buffer_load_dwordx4 v2, s[12:15], s39 offen offset:1024 sc1 lds
    s_add_u32 m0, m0, 2048
    s_add_u32 s39, s39, 65536
    buffer_load_dwordx4 v2, s[12:15], s39 offen sc1 lds
    buffer_load_dwordx4 v2, s[12:15], s39 offen offset:1024 sc1 lds
    s_add_u32 m0, m0, 2048
    s_add_u32 s39, s39, 65536
    buffer_load_dwordx4 v2, s[12:15], s39 offen sc1 lds
    buffer_load_dwordx4 v2, s[12:15], s39 offen offset:1024 sc1 lds
    s_mov_b32 m0, s19
    s_mov_b32 s39, s16
    s_add_u32 s24, s4, 0x1420000
    s_addc_u32 s25, s5, 0
    s_mov_b32 s26, 0x70000
    s_mov_b32 s27, 0x20000
    s_cmp_eq_u32 s60, 0
    s_cselect_b32 s26, s26, 0
    s_and_b32 s36, s30, 1
    s_mul_i32 s36, s36, 448
    s_mul_i32 s37, s29, 896
    s_add_u32 s37, s36, s37
    v_lshrrev_b32 v224, 5, v1
    v_mul_u32_u24 v224, 14336, v224
    v_and_b32 v179, 496, v2
    v_add_u32 v224, v224, v179
    s_cmp_eq_u32 s60, 0
    s_cselect_b64 exec, -1, 0
    buffer_load_dwordx4 v[180:183], v224, s[24:27], s37 offen sc1
    s_add_u32 s37, s37, 28672
    buffer_load_dwordx4 v[184:187], v224, s[24:27], s37 offen sc1
    s_add_u32 s37, s37, 28672
    buffer_load_dwordx4 v[188:191], v224, s[24:27], s37 offen sc1
    s_add_u32 s37, s37, 28672
    s_mov_b64 exec, -1
    s_waitcnt vmcnt(11)
    s_barrier
    buffer_load_dwordx4 v2, s[12:15], s39 offen sc1 lds
    buffer_load_dwordx4 v2, s[12:15], s39 offen offset:1024 sc1 lds
    s_add_u32 s19, s41, s42
    v_readlane_b32 s16, v248, s44
    s_nop 0
    s_add_u32 s16, s16, s38
    s_add_u32 s44, s44, 1
    s_and_b32 s44, s44, 15
    s_add_u32 s42, s42, 16384
    s_cmp_eq_u32 s42, 49152
    s_cselect_b32 s42, 0, s42
    s_add_u32 m0, m0, 2048
    s_add_u32 s39, s39, 65536
    buffer_load_dwordx4 v2, s[12:15], s39 offen sc1 lds
    buffer_load_dwordx4 v2, s[12:15], s39 offen offset:1024 sc1 lds
    s_add_u32 m0, m0, 2048
    s_add_u32 s39, s39, 65536
    buffer_load_dwordx4 v2, s[12:15], s39 offen sc1 lds
    buffer_load_dwordx4 v2, s[12:15], s39 offen offset:1024 sc1 lds
    s_add_u32 m0, m0, 2048
    s_add_u32 s39, s39, 65536
    buffer_load_dwordx4 v2, s[12:15], s39 offen sc1 lds
    buffer_load_dwordx4 v2, s[12:15], s39 offen offset:1024 sc1 lds
    s_mov_b32 m0, s19
    s_mov_b32 s39, s16
    s_cmp_eq_u32 s60, 0
    s_cselect_b64 exec, -1, 0
    buffer_load_dwordx4 v[192:195], v224, s[24:27], s37 offen sc1
    s_add_u32 s37, s37, 28672
    buffer_load_dwordx4 v[196:199], v224, s[24:27], s37 offen sc1
    s_add_u32 s37, s37, 28672
    buffer_load_dwordx4 v[200:203], v224, s[24:27], s37 offen sc1
    s_add_u32 s37, s37, 28672
    s_mov_b64 exec, -1
    s_waitcnt vmcnt(14)
    s_barrier
    buffer_load_dwordx4 v2, s[12:15], s39 offen sc1 lds
    buffer_load_dwordx4 v2, s[12:15], s39 offen offset:1024 sc1 lds
    s_add_u32 s19, s41, s42
    v_readlane_b32 s16, v248, s44
    s_nop 0
    s_add_u32 s16, s16, s38
    s_add_u32 s44, s44, 1
    s_and_b32 s44, s44, 15
    s_add_u32 s42, s42, 16384
    s_cmp_eq_u32 s42, 49152
    s_cselect_b32 s42, 0, s42
    s_add_u32 m0, m0, 2048
    s_add_u32 s39, s39, 65536
    buffer_load_dwordx4 v2, s[12:15], s39 offen sc1 lds
    buffer_load_dwordx4 v2, s[12:15], s39 offen offset:1024 sc1 lds
    s_add_u32 m0, m0, 2048
    s_add_u32 s39, s39, 65536
    buffer_load_dwordx4 v2, s[12:15], s39 offen sc1 lds
    buffer_load_dwordx4 v2, s[12:15], s39 offen offset:1024 sc1 lds
    s_add_u32 m0, m0, 2048
    s_add_u32 s39, s39, 65536
    buffer_load_dwordx4 v2, s[12:15], s39 offen sc1 lds
    buffer_load_dwordx4 v2, s[12:15], s39 offen offset:1024 sc1 lds
    s_mov_b32 m0, s19
    s_mov_b32 s39, s16
    s_cmp_eq_u32 s60, 0
    s_cselect_b64 exec, -1, 0
    buffer_load_dwordx4 v[204:207], v224, s[24:27], s37 offen sc1
    s_add_u32 s37, s37, 28672
    buffer_load_dwordx4 v[208:211], v224, s[24:27], s37 offen sc1
    s_add_u32 s37, s37, 28672
    buffer_load_dwordx4 v[212:215], v224, s[24:27], s37 offen sc1
    s_add_u32 s37, s37, 28672
    s_mov_b64 exec, -1
    s_mov_b64 exec, 1
    buffer_load_dword v223, v222, s[56:59], 0 offen sc1
    s_mov_b64 exec, -1
    s_waitcnt vmcnt(15)
    s_barrier
    buffer_load_dwordx4 v2, s[12:15], s39 offen sc1 lds
    buffer_load_dwordx4 v2, s[12:15], s39 offen offset:1024 sc1 lds
    s_add_u32 s19, s41, s42
    v_readlane_b32 s16, v248, s44
    s_nop 0
    s_add_u32 s16, s16, s38
    s_add_u32 s44, s44, 1
    s_and_b32 s44, s44, 15
    s_add_u32 s42, s42, 16384
    s_cmp_eq_u32 s42, 49152
    s_cselect_b32 s42, 0, s42
    s_add_u32 m0, m0, 2048
    s_add_u32 s39, s39, 65536
    buffer_load_dwordx4 v2, s[12:15], s39 offen sc1 lds
    buffer_load_dwordx4 v2, s[12:15], s39 offen offset:1024 sc1 lds
    s_add_u32 m0, m0, 2048
    s_add_u32 s39, s39, 65536
    buffer_load_dwordx4 v2, s[12:15], s39 offen sc1 lds
    buffer_load_dwordx4 v2, s[12:15], s39 offen offset:1024 sc1 lds
    s_add_u32 m0, m0, 2048
    s_add_u32 s39, s39, 65536
    buffer_load_dwordx4 v2, s[12:15], s39 offen sc1 lds
    buffer_load_dwordx4 v2, s[12:15], s39 offen offset:1024 sc1 lds
    s_mov_b32 m0, s19
    s_mov_b32 s39, s16
    s_waitcnt vmcnt(12)
    s_barrier
    buffer_load_dwordx4 v2, s[12:15], s39 offen sc1 lds
    buffer_load_dwordx4 v2, s[12:15], s39 offen offset:1024 sc1 lds
    s_add_u32 s19, s41, s42
    v_readlane_b32 s16, v248, s44
    s_nop 0
    s_add_u32 s16, s16, s38
    s_add_u32 s44, s44, 1
    s_and_b32 s44, s44, 15
    s_add_u32 s42, s42, 16384
    s_cmp_eq_u32 s42, 49152
    s_cselect_b32 s42, 0, s42
    s_add_u32 m0, m0, 2048
    s_add_u32 s39, s39, 65536
    buffer_load_dwordx4 v2, s[12:15], s39 offen sc1 lds
    buffer_load_dwordx4 v2, s[12:15], s39 offen offset:1024 sc1 lds
    s_add_u32 m0, m0, 2048
    s_add_u32 s39, s39, 65536
    buffer_load_dwordx4 v2, s[12:15], s39 offen sc1 lds
    buffer_load_dwordx4 v2, s[12:15], s39 offen offset:1024 sc1 lds
    s_add_u32 m0, m0, 2048
    s_add_u32 s39, s39, 65536
    buffer_load_dwordx4 v2, s[12:15], s39 offen sc1 lds
    buffer_load_dwordx4 v2, s[12:15], s39 offen offset:1024 sc1 lds
    s_mov_b32 m0, s19
    s_mov_b32 s39, s16
    s_waitcnt vmcnt(16)
    v_readfirstlane_b32 s53, v223
    s_add_u32 s54, s52, 16
    s_cmp_eq_u32 s53, s54
    s_cbranch_scc1 fok_45
    s_mov_b32 s53, 0
    s_add_u32 s54, s52, 16
    s_bfm_b64 exec, 1, 0
poll_46:
    buffer_load_dword v223, v222, s[56:59], 0 offen sc1
    s_waitcnt vmcnt(0)
    v_xor_b32 v223, s54, v223
    v_cmp_eq_u32 vcc, 0, v223
    s_nop 0
    s_cmp_eq_u64 vcc, exec
    s_cbranch_scc1 pok_47
    s_sleep 5
    s_add_u32 s53, s53, 1
    s_cmp_lt_u32 s53, s61
    s_cbranch_scc1 poll_46
    s_mov_b32 s61, 0
pok_47:
    s_mov_b64 exec, -1
fok_45:
    s_add_u32 s20, s62, 0x5c8000
    s_addc_u32 s21, s63, 0
    s_mov_b32 s22, 0x6000
    s_mov_b32 s23, 0x20000
    s_and_b32 s35, s30, 1
    s_lshl_b32 s35, s35, 9
    s_add_u32 s36, s35, 0
    buffer_load_dwordx2 v[16:17], v221, s[20:23], s36 offen offset:0 sc1
    buffer_load_dwordx2 v[18:19], v221, s[20:23], s36 offen offset:1024 sc1
    buffer_load_dwordx2 v[20:21], v221, s[20:23], s36 offen offset:2048 sc1
    buffer_load_dwordx2 v[22:23], v221, s[20:23], s36 offen offset:3072 sc1
    s_cmp_lg_u32 s60, 0
    s_cbranch_scc1 pc_48
    v_add_f32 v180, v180, v184
    v_add_f32 v181, v181, v185
    v_add_f32 v182, v182, v186
    v_add_f32 v183, v183, v187
    v_add_f32 v180, v180, v188
    v_add_f32 v181, v181, v189
    v_add_f32 v182, v182, v190
    v_add_f32 v183, v183, v191
    v_add_f32 v180, v180, v192
    v_add_f32 v181, v181, v193
    v_add_f32 v182, v182, v194
    v_add_f32 v183, v183, v195
    v_add_f32 v180, v180, v196
    v_add_f32 v181, v181, v197
    v_add_f32 v182, v182, v198
    v_add_f32 v183, v183, v199
pc_48:
    s_waitcnt vmcnt(12)
    s_barrier
    buffer_load_dwordx4 v2, s[12:15], s39 offen sc1 lds
    buffer_load_dwordx4 v2, s[12:15], s39 offen offset:1024 sc1 lds
    s_add_u32 s19, s41, s42
    v_readlane_b32 s16, v248, s44
    s_nop 0
    s_add_u32 s16, s16, s38
    s_add_u32 s44, s44, 1
    s_and_b32 s44, s44, 15
    s_add_u32 s42, s42, 16384
    s_cmp_eq_u32 s42, 49152
    s_cselect_b32 s42, 0, s42
    s_add_u32 m0, m0, 2048
    s_add_u32 s39, s39, 65536
    buffer_load_dwordx4 v2, s[12:15], s39 offen sc1 lds
    buffer_load_dwordx4 v2, s[12:15], s39 offen offset:1024 sc1 lds
    s_add_u32 m0, m0, 2048
    s_add_u32 s39, s39, 65536
    buffer_load_dwordx4 v2, s[12:15], s39 offen sc1 lds
    buffer_load_dwordx4 v2, s[12:15], s39 offen offset:1024 sc1 lds
    s_add_u32 m0, m0, 2048
    s_add_u32 s39, s39, 65536
    buffer_load_dwordx4 v2, s[12:15], s39 offen sc1 lds
    buffer_load_dwordx4 v2, s[12:15], s39 offen offset:1024 sc1 lds
    s_mov_b32 m0, s19
    s_mov_b32 s39, s16
    s_add_u32 s36, s35, 4096
    buffer_load_dwordx2 v[24:25], v221, s[20:23], s36 offen offset:0 sc1
    buffer_load_dwordx2 v[26:27], v221, s[20:23], s36 offen offset:1024 sc1
    buffer_load_dwordx2 v[28:29], v221, s[20:23], s36 offen offset:2048 sc1
    buffer_load_dwordx2 v[30:31], v221, s[20:23], s36 offen offset:3072 sc1
    s_cmp_lg_u32 s60, 0
    s_cbranch_scc1 pc_49
    v_add_f32 v180, v180, v200
    v_add_f32 v181, v181, v201
    v_add_f32 v182, v182, v202
    v_add_f32 v183, v183, v203
    v_add_f32 v180, v180, v204
    v_add_f32 v181, v181, v205
    v_add_f32 v182, v182, v206
    v_add_f32 v183, v183, v207
    v_add_f32 v180, v180, v208
    v_add_f32 v181, v181, v209
    v_add_f32 v182, v182, v210
    v_add_f32 v183, v183, v211
    v_add_f32 v180, v180, v212
    v_add_f32 v181, v181, v213
    v_add_f32 v182, v182, v214
    v_add_f32 v183, v183, v215
pc_49:
    s_cmp_eq_u32 s60, 0
    s_cselect_b64 exec, -1, 0
    buffer_load_dwordx4 v[184:187], v224, s[24:27], s37 offen sc1
    s_add_u32 s37, s37, 28672
    buffer_load_dwordx4 v[188:191], v224, s[24:27], s37 offen sc1
    s_add_u32 s37, s37, 28672
    buffer_load_dwordx4 v[192:195], v224, s[24:27], s37 offen sc1
    s_add_u32 s37, s37, 28672
    s_mov_b64 exec, -1
    s_waitcnt vmcnt(19)
    s_barrier
    buffer_load_dwordx4 v2, s[12:15], s39 offen sc1 lds
    buffer_load_dwordx4 v2, s[12:15], s39 offen offset:1024 sc1 lds
    s_add_u32 s19, s41, s42
    v_readlane_b32 s16, v248, s44
    s_nop 0
    s_add_u32 s16, s16, s38
    s_add_u32 s44, s44, 1
    s_and_b32 s44, s44, 15
    s_add_u32 s42, s42, 16384
    s_cmp_eq_u32 s42, 49152
    s_cselect_b32 s42, 0, s42
    s_add_u32 m0, m0, 2048
    s_add_u32 s39, s39, 65536
    buffer_load_dwordx4 v2, s[12:15], s39 offen sc1 lds
    buffer_load_dwordx4 v2, s[12:15], s39 offen offset:1024 sc1 lds
    s_add_u32 m0, m0, 2048
    s_add_u32 s39, s39, 65536
    buffer_load_dwordx4 v2, s[12:15], s39 offen sc1 lds
    buffer_load_dwordx4 v2, s[12:15], s39 offen offset:1024 sc1 lds
    s_add_u32 m0, m0, 2048
    s_add_u32 s39, s39, 65536
    buffer_load_dwordx4 v2, s[12:15], s39 offen sc1 lds
    buffer_load_dwordx4 v2, s[12:15], s39 offen offset:1024 sc1 lds
    s_mov_b32 m0, s19
    s_mov_b32 s39, s16
    s_add_u32 s36, s35, 16384
    buffer_load_dwordx2 v[32:33], v221, s[20:23], s36 offen offset:0 sc1
    buffer_load_dwordx2 v[34:35], v221, s[20:23], s36 offen offset:1024 sc1
    buffer_load_dwordx2 v[36:37], v221, s[20:23], s36 offen offset:2048 sc1
    buffer_load_dwordx2 v[38:39], v221, s[20:23], s36 offen offset:3072 sc1
    s_cmp_eq_u32 s60, 0
    s_cselect_b64 exec, -1, 0
    buffer_load_dwordx4 v[196:199], v224, s[24:27], s37 offen sc1
    s_add_u32 s37, s37, 28672
    buffer_load_dwordx4 v[200:203], v224, s[24:27], s37 offen sc1
    s_add_u32 s37, s37, 28672
    s_mov_b64 exec, -1
    s_waitcnt vmcnt(21)
    s_barrier
    buffer_load_dwordx4 v2, s[12:15], s39 offen sc1 lds
    buffer_load_dwordx4 v2, s[12:15], s39 offen offset:1024 sc1 lds
    s_add_u32 s19, s41, s42
    v_readlane_b32 s16, v248, s44
    s_nop 0
    s_add_u32 s16, s16, s38
    s_add_u32 s44, s44, 1
    s_and_b32 s44, s44, 15
    s_add_u32 s42, s42, 16384
    s_cmp_eq_u32 s42, 49152
    s_cselect_b32 s42, 0, s42
    s_add_u32 m0, m0, 2048
    s_add_u32 s39, s39, 65536
    buffer_load_dwordx4 v2, s[12:15], s39 offen sc1 lds
    buffer_load_dwordx4 v2, s[12:15], s39 offen offset:1024 sc1 lds
    s_add_u32 m0, m0, 2048
    s_add_u32 s39, s39, 65536
    buffer_load_dwordx4 v2, s[12:15], s39 offen sc1 lds
    buffer_load_dwordx4 v2, s[12:15], s39 offen offset:1024 sc1 lds
    s_add_u32 m0, m0, 2048
    s_add_u32 s39, s39, 65536
    buffer_load_dwordx4 v2, s[12:15], s39 offen sc1 lds
    buffer_load_dwordx4 v2, s[12:15], s39 offen offset:1024 sc1 lds
    s_mov_b32 m0, s19
    s_mov_b32 s39, s16
    s_add_u32 s36, s35, 20480
    buffer_load_dwordx2 v[40:41], v221, s[20:23], s36 offen offset:0 sc1
    buffer_load_dwordx2 v[42:43], v221, s[20:23], s36 offen offset:1024 sc1
    buffer_load_dwordx2 v[44:45], v221, s[20:23], s36 offen offset:2048 sc1
    buffer_load_dwordx2 v[46:47], v221, s[20:23], s36 offen offset:3072 sc1
    s_cmp_eq_u32 s60, 0
    s_cselect_b64 exec, -1, 0
    buffer_load_dwordx4 v[204:207], v224, s[24:27], s37 offen sc1
    s_add_u32 s37, s37, 28672
    buffer_load_dwordx4 v[208:211], v224, s[24:27], s37 offen sc1
    s_add_u32 s37, s37, 28672
    s_mov_b64 exec, -1
    s_waitcnt vmcnt(20)
    s_barrier
    buffer_load_dwordx4 v2, s[12:15], s39 offen sc1 lds
    buffer_load_dwordx4 v2, s[12:15], s39 offen offset:1024 sc1 lds
    s_add_u32 s19, s41, s42
    v_readlane_b32 s16, v248, s44
    s_nop 0
    s_add_u32 s16, s16, s38
    s_add_u32 s44, s44, 1
    s_and_b32 s44, s44, 15
    s_add_u32 s42, s42, 16384
    s_cmp_eq_u32 s42, 49152
    s_cselect_b32 s42, 0, s42
    s_add_u32 m0, m0, 2048
    s_add_u32 s39, s39, 65536
    buffer_load_dwordx4 v2, s[12:15], s39 offen sc1 lds
    buffer_load_dwordx4 v2, s[12:15], s39 offen offset:1024 sc1 lds
    s_add_u32 m0, m0, 2048
    s_add_u32 s39, s39, 65536
    buffer_load_dwordx4 v2, s[12:15], s39 offen sc1 lds
    buffer_load_dwordx4 v2, s[12:15], s39 offen offset:1024 sc1 lds
    s_add_u32 m0, m0, 2048
    s_add_u32 s39, s39, 65536
    buffer_load_dwordx4 v2, s[12:15], s39 offen sc1 lds
    buffer_load_dwordx4 v2, s[12:15], s39 offen offset:1024 sc1 lds
    s_mov_b32 m0, s19
    s_mov_b32 s39, s16
    s_waitcnt vmcnt(14)
    s_barrier
    buffer_load_dwordx4 v2, s[12:15], s39 offen sc1 lds
    buffer_load_dwordx4 v2, s[12:15], s39 offen offset:1024 sc1 lds
    s_add_u32 s19, s41, s42
    v_readlane_b32 s16, v248, s44
    s_nop 0
    s_add_u32 s16, s16, s38
    s_add_u32 s44, s44, 1
    s_and_b32 s44, s44, 15
    s_add_u32 s42, s42, 16384
    s_cmp_eq_u32 s42, 49152
    s_cselect_b32 s42, 0, s42
    s_add_u32 m0, m0, 2048
    s_add_u32 s39, s39, 65536
    buffer_load_dwordx4 v2, s[12:15], s39 offen sc1 lds
    buffer_load_dwordx4 v2, s[12:15], s39 offen offset:1024 sc1 lds
    s_add_u32 m0, m0, 2048
    s_add_u32 s39, s39, 65536
    buffer_load_dwordx4 v2, s[12:15], s39 offen sc1 lds
    buffer_load_dwordx4 v2, s[12:15], s39 offen offset:1024 sc1 lds
    s_add_u32 m0, m0, 2048
    s_add_u32 s39, s39, 65536
    buffer_load_dwordx4 v2, s[12:15], s39 offen sc1 lds
    buffer_load_dwordx4 v2, s[12:15], s39 offen offset:1024 sc1 lds
    s_mov_b32 m0, s19
    s_mov_b32 s39, s16
    s_waitcnt vmcnt(16)
    v_add_f32 v16, v16, v32
    v_add_f32 v17, v17, v33
    v_add_f32 v18, v18, v34
    v_add_f32 v19, v19, v35
    v_add_f32 v20, v20, v36
    v_add_f32 v21, v21, v37
    v_add_f32 v22, v22, v38
    v_add_f32 v23, v23, v39
    v_add_f32 v24, v24, v40
    v_add_f32 v25, v25, v41
    v_add_f32 v26, v26, v42
    v_add_f32 v27, v27, v43
    v_add_f32 v28, v28, v44
    v_add_f32 v29, v29, v45
    v_add_f32 v30, v30, v46
    v_add_f32 v31, v31, v47
    s_waitcnt vmcnt(8)
    s_barrier
    buffer_load_dwordx4 v2, s[12:15], s39 offen sc1 lds
    buffer_load_dwordx4 v2, s[12:15], s39 offen offset:1024 sc1 lds
    s_add_u32 s19, s41, s42
    v_readlane_b32 s16, v248, s44
    s_nop 0
    s_add_u32 s16, s16, s38
    s_add_u32 s44, s44, 1
    s_and_b32 s44, s44, 15
    s_add_u32 s42, s42, 16384
    s_cmp_eq_u32 s42, 49152
    s_cselect_b32 s42, 0, s42
    s_add_u32 m0, m0, 2048
    s_add_u32 s39, s39, 65536
    buffer_load_dwordx4 v2, s[12:15], s39 offen sc1 lds
    buffer_load_dwordx4 v2, s[12:15], s39 offen offset:1024 sc1 lds
    s_add_u32 m0, m0, 2048
    s_add_u32 s39, s39, 65536
    buffer_load_dwordx4 v2, s[12:15], s39 offen sc1 lds
    buffer_load_dwordx4 v2, s[12:15], s39 offen offset:1024 sc1 lds
    s_add_u32 m0, m0, 2048
    s_add_u32 s39, s39, 65536
    buffer_load_dwordx4 v2, s[12:15], s39 offen sc1 lds
    buffer_load_dwordx4 v2, s[12:15], s39 offen offset:1024 sc1 lds
    s_mov_b32 m0, s19
    s_mov_b32 s39, s16
    v_add_f32 v16, v16, v24
    v_add_f32 v17, v17, v25
    v_add_f32 v18, v18, v26
    v_add_f32 v19, v19, v27
    v_add_f32 v20, v20, v28
    v_add_f32 v21, v21, v29
    v_add_f32 v22, v22, v30
    v_add_f32 v23, v23, v31
    v_add_f32 v16, v16, v20
    v_add_f32 v17, v17, v21
    v_add_f32 v18, v18, v22
    v_add_f32 v19, v19, v23
    v_add_f32 v16, v16, v18
    v_add_f32 v17, v17, v19
    v_mul_f32 v20, 0x3a800000, v16
    v_mul_f32 v217, 0x3a800000, v17
    s_cmp_lg_u32 s60, 0
    s_cbranch_scc1 pc_52
    v_add_f32 v180, v180, v184
    v_add_f32 v181, v181, v185
    v_add_f32 v182, v182, v186
    v_add_f32 v183, v183, v187
    v_add_f32 v180, v180, v188
    v_add_f32 v181, v181, v189
    v_add_f32 v182, v182, v190
    v_add_f32 v183, v183, v191
    v_add_f32 v180, v180, v192
    v_add_f32 v181, v181, v193
    v_add_f32 v182, v182, v194
    v_add_f32 v183, v183, v195
pc_52:
    s_waitcnt vmcnt(8)
    s_barrier
    buffer_load_dwordx4 v2, s[12:15], s39 offen sc1 lds
    buffer_load_dwordx4 v2, s[12:15], s39 offen offset:1024 sc1 lds
    s_add_u32 s19, s41, s42
    v_readlane_b32 s16, v248, s44
    s_nop 0
    s_add_u32 s16, s16, s38
    s_add_u32 s44, s44, 1
    s_and_b32 s44, s44, 15
    s_add_u32 s42, s42, 16384
    s_cmp_eq_u32 s42, 49152
    s_cselect_b32 s42, 0, s42
    s_add_u32 m0, m0, 2048
    s_add_u32 s39, s39, 65536
    buffer_load_dwordx4 v2, s[12:15], s39 offen sc1 lds
    buffer_load_dwordx4 v2, s[12:15], s39 offen offset:1024 sc1 lds
    s_add_u32 m0, m0, 2048
    s_add_u32 s39, s39, 65536
    buffer_load_dwordx4 v2, s[12:15], s39 offen sc1 lds
    buffer_load_dwordx4 v2, s[12:15], s39 offen offset:1024 sc1 lds
    s_add_u32 m0, m0, 2048
    s_add_u32 s39, s39, 65536
    buffer_load_dwordx4 v2, s[12:15], s39 offen sc1 lds
    buffer_load_dwordx4 v2, s[12:15], s39 offen offset:1024 sc1 lds
    s_mov_b32 m0, s19
    s_mov_b32 s39, s16
    v_fma_f32 v217, -v20, v20, v217
    v_max_f32 v217, 0, v217
    v_add_f32 v217, 0x3727c5ac, v217
    v_sqrt_f32 v217, v217
    s_nop 0
    v_mov_b32 v21, v217
    v_rcp_f32 v219, v217
    s_nop 0
    v_mul_f32 v22, 0xc0135761, v219
    v_mul_f32 v23, v219, v219
    v_mul_f32 v23, v23, v22
    v_mul_f32 v23, 0x3d372713, v23
    s_lshl_b32 s35, s35, 1
    s_add_u32 s35, s35, 160768
    v_add_u32 v220, s35, v2
    ds_write_b128 v220, v[20:23]
    s_waitcnt lgkmcnt(0)
    s_waitcnt vmcnt(8)
    s_barrier
    buffer_load_dwordx4 v2, s[12:15], s39 offen sc1 lds
    buffer_load_dwordx4 v2, s[12:15], s39 offen offset:1024 sc1 lds
    s_add_u32 m0, m0, 2048
    s_add_u32 s39, s39, 65536
    buffer_load_dwordx4 v2, s[12:15], s39 offen sc1 lds
    buffer_load_dwordx4 v2, s[12:15], s39 offen offset:1024 sc1 lds
    s_add_u32 m0, m0, 2048
    s_add_u32 s39, s39, 65536
    buffer_load_dwordx4 v2, s[12:15], s39 offen sc1 lds
    buffer_load_dwordx4 v2, s[12:15], s39 offen offset:1024 sc1 lds
    s_add_u32 m0, m0, 2048
    s_add_u32 s39, s39, 65536
    buffer_load_dwordx4 v2, s[12:15], s39 offen sc1 lds
    buffer_load_dwordx4 v2, s[12:15], s39 offen offset:1024 sc1 lds
    s_cmp_lg_u32 s60, 0
    s_cbranch_scc1 pc_54
    v_add_f32 v180, v180, v196
    v_add_f32 v181, v181, v197
    v_add_f32 v182, v182, v198
    v_add_f32 v183, v183, v199
    v_add_f32 v180, v180, v200
    v_add_f32 v181, v181, v201
    v_add_f32 v182, v182, v202
    v_add_f32 v183, v183, v203
    v_add_f32 v180, v180, v204
    v_add_f32 v181, v181, v205
    v_add_f32 v182, v182, v206
    v_add_f32 v183, v183, v207
    v_add_f32 v180, v180, v208
    v_add_f32 v181, v181, v209
    v_add_f32 v182, v182, v210
    v_add_f32 v183, v183, v211
pc_54:
    s_waitcnt vmcnt(8)
    s_barrier
    s_cmp_lg_u32 s60, 0
    s_cbranch_scc1 pc_55
    v_mov_b32 v184, v180
    v_mov_b32 v185, v181
    v_mov_b32 v186, v182
    v_mov_b32 v187, v183
    v_permlane32_swap_b32 v180, v184
    v_permlane32_swap_b32 v181, v185
    v_permlane32_swap_b32 v182, v186
    v_permlane32_swap_b32 v183, v187
    v_add_f32 v180, v180, v184
    v_add_f32 v181, v181, v185
    v_add_f32 v182, v182, v186
    v_add_f32 v183, v183, v187
    s_and_b32 s36, s30, 1
    s_mul_i32 s36, s36, 448
    s_add_u32 s36, s36, 159744
    v_add_u32 v179, s36, v2
    s_bfm_b64 exec, 28, 0
    ds_write_b128 v179, v[180:183]
    s_mov_b64 exec, -1
    s_waitcnt lgkmcnt(0)
pc_55:
    s_waitcnt vmcnt(0)
    s_barrier
    s_cmp_lg_u32 s60, 0
    s_cbranch_scc1 tw4_56
    s_load_dwordx2 s[48:49], s[0:1], 80
    s_lshl_b32 s45, s2, 1
    s_and_b32 s50, s30, 1
    s_add_u32 s45, s45, s50
    s_mul_i32 s45, s45, 14336
    s_mov_b32 s50, 7340032
    s_mov_b32 s51, 0x20000
    s_waitcnt lgkmcnt(0)
    buffer_load_dwordx4 v[20:23], v2, s[48:51], s45 offen offset:0
    buffer_load_dwordx4 v[20:23], v2, s[48:51], s45 offen offset:1024
    buffer_load_dwordx4 v[20:23], v2, s[48:51], s45 offen offset:2048
    buffer_load_dwordx4 v[20:23], v2, s[48:51], s45 offen offset:3072
    s_add_u32 s45, s45, 4096
    buffer_load_dwordx4 v[20:23], v2, s[48:51], s45 offen offset:0
    buffer_load_dwordx4 v[20:23], v2, s[48:51], s45 offen offset:1024
    buffer_load_dwordx4 v[20:23], v2, s[48:51], s45 offen offset:2048
    buffer_load_dwordx4 v[20:23], v2, s[48:51], s45 offen offset:3072
    s_add_u32 s45, s45, 4096
    buffer_load_dwordx4 v[20:23], v2, s[48:51], s45 offen offset:0
    buffer_load_dwordx4 v[20:23], v2, s[48:51], s45 offen offset:1024
    buffer_load_dwordx4 v[20:23], v2, s[48:51], s45 offen offset:2048
    buffer_load_dwordx4 v[20:23], v2, s[48:51], s45 offen offset:3072
    s_add_u32 s45, s45, 4096
    buffer_load_dwordx4 v[20:23], v2, s[48:51], s45 offen offset:0
    buffer_load_dwordx4 v[20:23], v2, s[48:51], s45 offen offset:1024
tw4_56:
    s_barrier
    s_cmp_lg_u32 s60, 0
    s_cbranch_scc1 rp_57
    s_call_b64 s[76:77], SUB_r_pre
rp_57:
    s_and_b32 s35, s30, 1
    s_add_u32 s12, s62, 0x400000
    s_addc_u32 s13, s63, 0
    s_mov_b32 s14, 0x1be000
    s_mov_b32 s15, 0x20000
    s_mul_i32 s38, s35, 917504
    s_mul_i32 s36, s31, 114688
    s_add_u32 s38, s38, s36
    s_lshl_b32 s41, s35, 13
    s_mov_b32 s42, 0
    s_mov_b32 s44, 0
    s_add_u32 s54, s55, 0x700
    s_lshl_b32 s53, s31, 7
    s_add_u32 s54, s54, s53
    v_mov_b32 v9, s54
    s_add_u32 s54, s55, 0x600
    s_lshl_b32 s53, s31, 7
    s_add_u32 s54, s54, s53
    v_mov_b32 v10, s54
    s_add_u32 s54, s55, 0x300
    s_lshl_b32 s53, s31, 7
    s_add_u32 s54, s54, s53
    v_mov_b32 v12, s54
    v_mov_b32 v13, 1
    s_and_b32 s51, s30, 1
    s_lshl_b32 s51, s51, 30
    s_lshl_b32 s54, s60, 2
    s_add_u32 s54, s54, 4
    v_mov_b32 v14, 162880
spin_58:
    s_sleep 2
    ds_read_b32 v15, v14
    s_waitcnt lgkmcnt(0)
    v_readfirstlane_b32 s53, v15
    s_nop 0
    s_cmp_ge_u32 s53, s54
    s_cbranch_scc0 spin_58
    s_mov_b64 exec, 1
    buffer_atomic_add v13, v9, s[56:59], s51 offen sc1
    s_mov_b64 exec, -1
    v_xor_b32 v15, 128, v12
    s_mov_b32 s44, 3
    s_call_b64 s[76:77], PREP_a_issue_4
    s_mov_b32 m0, s19
    s_mov_b32 s39, s16
    s_mov_b32 s40, s17
    s_waitcnt vmcnt(16)
    s_barrier
    s_mov_b64 exec, 1
    buffer_load_dword v8, v9, s[56:59], 0 offen sc1
    s_mov_b64 exec, -1
    s_waitcnt vmcnt(9)
    s_barrier
    s_waitcnt vmcnt(0)
    v_readfirstlane_b32 s53, v8
    s_add_u32 s54, s52, 8
    s_cmp_eq_u32 s53, s54
    s_cbranch_scc1 fok_59
    s_mov_b32 s53, 0
    s_add_u32 s54, s52, 8
    s_bfm_b64 exec, 1, 0
poll_60:
    buffer_load_dword v8, v9, s[56:59], 0 offen sc1
    s_waitcnt vmcnt(0)
    v_xor_b32 v8, s54, v8
    v_cmp_eq_u32 vcc, 0, v8
    s_nop 0
    s_cmp_eq_u64 vcc, exec
    s_cbranch_scc1 pok_61
    s_sleep 5
    s_add_u32 s53, s53, 1
    s_cmp_lt_u32 s53, s61
    s_cbranch_scc1 poll_60
    s_mov_b32 s61, 0
pok_61:
    s_mov_b64 exec, -1
fok_59:
    buffer_load_dwordx4 v2, s[12:15], s39 offen sc1 lds
    s_add_u32 m0, m0, 1024
    s_nop 0
    buffer_load_dwordx4 v2, s[12:15], s40 offen sc1 lds
    s_call_b64 s[76:77], PREP_a_issue_4
    s_add_u32 m0, m0, 1024
    s_add_u32 s39, s39, 229376
    buffer_load_dwordx4 v2, s[12:15], s39 offen sc1 lds
    s_add_u32 m0, m0, 1024
    s_add_u32 s40, s40, 229376
    buffer_load_dwordx4 v2, s[12:15], s40 offen sc1 lds
    s_add_u32 m0, m0, 1024
    s_add_u32 s39, s39, 229376
    buffer_load_dwordx4 v2, s[12:15], s39 offen sc1 lds
    s_add_u32 m0, m0, 1024
    s_add_u32 s40, s40, 229376
    buffer_load_dwordx4 v2, s[12:15], s40 offen sc1 lds
    s_add_u32 m0, m0, 1024
    s_add_u32 s39, s39, 229376
    buffer_load_dwordx4 v2, s[12:15], s39 offen sc1 lds
    s_add_u32 m0, m0, 1024
    s_add_u32 s40, s40, 229376
    buffer_load_dwordx4 v2, s[12:15], s40 offen sc1 lds
    s_mov_b32 m0, s19
    s_mov_b32 s39, s16
    s_mov_b32 s40, s17
    s_waitcnt vmcnt(9)
    s_barrier
    s_mov_b64 exec, 1
    buffer_atomic_add v13, v10, s[56:59], s51 offen sc1
    s_mov_b64 exec, -1
    buffer_load_dwordx4 v2, s[12:15], s39 offen sc1 lds
    s_add_u32 m0, m0, 1024
    s_nop 0
    buffer_load_dwordx4 v2, s[12:15], s40 offen sc1 lds
    s_call_b64 s[76:77], PREP_a_issue_4
    s_add_u32 m0, m0, 1024
    s_add_u32 s39, s39, 229376
    buffer_load_dwordx4 v2, s[12:15], s39 offen sc1 lds
    s_add_u32 m0, m0, 1024
    s_add_u32 s40, s40, 229376
    buffer_load_dwordx4 v2, s[12:15], s40 offen sc1 lds
    s_add_u32 m0, m0, 1024
    s_add_u32 s39, s39, 229376
    buffer_load_dwordx4 v2, s[12:15], s39 offen sc1 lds
    s_add_u32 m0, m0, 1024
    s_add_u32 s40, s40, 229376
    buffer_load_dwordx4 v2, s[12:15], s40 offen sc1 lds
    s_add_u32 m0, m0, 1024
    s_add_u32 s39, s39, 229376
    buffer_load_dwordx4 v2, s[12:15], s39 offen sc1 lds
    s_add_u32 m0, m0, 1024
    s_add_u32 s40, s40, 229376
    buffer_load_dwordx4 v2, s[12:15], s40 offen sc1 lds
    s_mov_b32 m0, s19
    s_mov_b32 s39, s16
    s_mov_b32 s40, s17
    s_waitcnt vmcnt(9)
    s_barrier
    buffer_load_dwordx4 v2, s[12:15], s39 offen sc1 lds
    s_add_u32 m0, m0, 1024
    s_nop 0
    buffer_load_dwordx4 v2, s[12:15], s40 offen sc1 lds
    s_call_b64 s[76:77], PREP_a_issue_4
    s_add_u32 m0, m0, 1024
    s_add_u32 s39, s39, 229376
    buffer_load_dwordx4 v2, s[12:15], s39 offen sc1 lds
    s_add_u32 m0, m0, 1024
    s_add_u32 s40, s40, 229376
    buffer_load_dwordx4 v2, s[12:15], s40 offen sc1 lds
    s_add_u32 m0, m0, 1024
    s_add_u32 s39, s39, 229376
    buffer_load_dwordx4 v2, s[12:15], s39 offen sc1 lds
    s_add_u32 m0, m0, 1024
    s_add_u32 s40, s40, 229376
    buffer_load_dwordx4 v2, s[12:15], s40 offen sc1 lds
    s_add_u32 m0, m0, 1024
    s_add_u32 s39, s39, 229376
    buffer_load_dwordx4 v2, s[12:15], s39 offen sc1 lds
    s_add_u32 m0, m0, 1024
    s_add_u32 s40, s40, 229376
    buffer_load_dwordx4 v2, s[12:15], s40 offen sc1 lds
    s_mov_b32 m0, s19
    s_mov_b32 s39, s16
    s_mov_b32 s40, s17
    s_waitcnt vmcnt(8)
    s_barrier
    buffer_load_dwordx4 v2, s[12:15], s39 offen sc1 lds
    s_add_u32 m0, m0, 1024
    s_nop 0
    buffer_load_dwordx4 v2, s[12:15], s40 offen sc1 lds
    s_mov_b64 exec, 1
    buffer_load_dword v11, v10, s[56:59], 0 offen sc1
    s_mov_b64 exec, -1
    s_call_b64 s[76:77], PREP_a_issue_4
    s_add_u32 m0, m0, 1024
    s_add_u32 s39, s39, 229376
    buffer_load_dwordx4 v2, s[12:15], s39 offen sc1 lds
    s_add_u32 m0, m0, 1024
    s_add_u32 s40, s40, 229376
    buffer_load_dwordx4 v2, s[12:15], s40 offen sc1 lds
    s_add_u32 m0, m0, 1024
    s_add_u32 s39, s39, 229376
    buffer_load_dwordx4 v2, s[12:15], s39 offen sc1 lds
    s_add_u32 m0, m0, 1024
    s_add_u32 s40, s40, 229376
    buffer_load_dwordx4 v2, s[12:15], s40 offen sc1 lds
    s_add_u32 m0, m0, 1024
    s_add_u32 s39, s39, 229376
    buffer_load_dwordx4 v2, s[12:15], s39 offen sc1 lds
    s_add_u32 m0, m0, 1024
    s_add_u32 s40, s40, 229376
    buffer_load_dwordx4 v2, s[12:15], s40 offen sc1 lds
    s_mov_b32 m0, s19
    s_mov_b32 s39, s16
    s_mov_b32 s40, s17
    s_waitcnt vmcnt(9)
    s_barrier
    s_mov_b64 exec, 1
    buffer_atomic_add v13, v12, s[56:59], s51 offen sc1
    s_mov_b64 exec, -1
    buffer_load_dwordx4 v2, s[12:15], s39 offen sc1 lds
    s_add_u32 m0, m0, 1024
    s_nop 0
    buffer_load_dwordx4 v2, s[12:15], s40 offen sc1 lds
    s_call_b64 s[76:77], PREP_a_issue_4
    s_add_u32 m0, m0, 1024
    s_add_u32 s39, s39, 229376
    buffer_load_dwordx4 v2, s[12:15], s39 offen sc1 lds
    s_add_u32 m0, m0, 1024
    s_add_u32 s40, s40, 229376
    buffer_load_dwordx4 v2, s[12:15], s40 offen sc1 lds
    s_add_u32 m0, m0, 1024
    s_add_u32 s39, s39, 229376
    buffer_load_dwordx4 v2, s[12:15], s39 offen sc1 lds
    s_add_u32 m0, m0, 1024
    s_add_u32 s40, s40, 229376
    buffer_load_dwordx4 v2, s[12:15], s40 offen sc1 lds
    s_add_u32 m0, m0, 1024
    s_add_u32 s39, s39, 229376
    buffer_load_dwordx4 v2, s[12:15], s39 offen sc1 lds
    s_add_u32 m0, m0, 1024
    s_add_u32 s40, s40, 229376
    buffer_load_dwordx4 v2, s[12:15], s40 offen sc1 lds
    s_mov_b32 m0, s19
    s_mov_b32 s39, s16
    s_mov_b32 s40, s17
    s_waitcnt vmcnt(9)
    s_barrier
    buffer_load_dwordx4 v2, s[12:15], s39 offen sc1 lds
    s_add_u32 m0, m0, 1024
    s_nop 0
    buffer_load_dwordx4 v2, s[12:15], s40 offen sc1 lds
    s_waitcnt vmcnt(17)
    v_readfirstlane_b32 s53, v11
    s_add_u32 s54, s52, 8
    s_cmp_eq_u32 s53, s54
    s_cbranch_scc1 fok_62
    s_mov_b32 s53, 0
    s_add_u32 s54, s52, 8
    s_bfm_b64 exec, 1, 0
poll_63:
    buffer_load_dword v11, v10, s[56:59], 0 offen sc1
    s_waitcnt vmcnt(0)
    v_xor_b32 v11, s54, v11
    v_cmp_eq_u32 vcc, 0, v11
    s_nop 0
    s_cmp_eq_u64 vcc, exec
    s_cbranch_scc1 pok_64
    s_sleep 5
    s_add_u32 s53, s53, 1
    s_cmp_lt_u32 s53, s61
    s_cbranch_scc1 poll_63
    s_mov_b32 s61, 0
pok_64:
    s_mov_b64 exec, -1
fok_62:
    s_call_b64 s[76:77], PREP_a_issue_4
    s_add_u32 m0, m0, 1024
    s_add_u32 s39, s39, 229376
    buffer_load_dwordx4 v2, s[12:15], s39 offen sc1 lds
    s_add_u32 m0, m0, 1024
    s_add_u32 s40, s40, 229376
    buffer_load_dwordx4 v2, s[12:15], s40 offen sc1 lds
    s_add_u32 m0, m0, 1024
    s_add_u32 s39, s39, 229376
    buffer_load_dwordx4 v2, s[12:15], s39 offen sc1 lds
    s_add_u32 m0, m0, 1024
    s_add_u32 s40, s40, 229376
    buffer_load_dwordx4 v2, s[12:15], s40 offen sc1 lds
    s_add_u32 m0, m0, 1024
    s_add_u32 s39, s39, 229376
    buffer_load_dwordx4 v2, s[12:15], s39 offen sc1 lds
    s_add_u32 m0, m0, 1024
    s_add_u32 s40, s40, 229376
    buffer_load_dwordx4 v2, s[12:15], s40 offen sc1 lds
    s_mov_b32 m0, s19
    s_mov_b32 s39, s16
    s_mov_b32 s40, s17
    s_waitcnt vmcnt(8)
    s_barrier
    buffer_load_dwordx4 v2, s[12:15], s39 offen sc1 lds
    s_add_u32 m0, m0, 1024
    s_nop 0
    buffer_load_dwordx4 v2, s[12:15], s40 offen sc1 lds
    s_mov_b32 s43, 1
ld_65:
    s_add_u32 s19, s41, s42
    v_readlane_b32 s16, v249, s44
    v_readlane_b32 s17, v250, s44
    s_add_u32 s16, s16, s38
    s_add_u32 s17, s17, s38
    s_add_u32 s44, s44, 1
    s_add_u32 s42, s42, 16384
    s_cmp_eq_u32 s42, 49152
    s_cselect_b32 s42, 0, s42
    s_add_u32 m0, m0, 1024
    s_add_u32 s39, s39, 229376
    buffer_load_dwordx4 v2, s[12:15], s39 offen sc1 lds
    s_add_u32 m0, m0, 1024
    s_add_u32 s40, s40, 229376
    buffer_load_dwordx4 v2, s[12:15], s40 offen sc1 lds
    s_add_u32 m0, m0, 1024
    s_add_u32 s39, s39, 229376
    buffer_load_dwordx4 v2, s[12:15], s39 offen sc1 lds
    s_add_u32 m0, m0, 1024
    s_add_u32 s40, s40, 229376
    buffer_load_dwordx4 v2, s[12:15], s40 offen sc1 lds
    s_add_u32 m0, m0, 1024
    s_add_u32 s39, s39, 229376
    buffer_load_dwordx4 v2, s[12:15], s39 offen sc1 lds
    s_add_u32 m0, m0, 1024
    s_add_u32 s40, s40, 229376
    buffer_load_dwordx4 v2, s[12:15], s40 offen sc1 lds
    s_mov_b32 m0, s19
    s_mov_b32 s39, s16
    s_mov_b32 s40, s17
    s_waitcnt vmcnt(8)
    s_barrier
    buffer_load_dwordx4 v2, s[12:15], s39 offen sc1 lds
    s_add_u32 m0, m0, 1024
    s_nop 0
    buffer_load_dwordx4 v2, s[12:15], s40 offen sc1 lds
    s_add_u32 s43, s43, 1
    s_cmp_lt_u32 s43, 4
    s_cbranch_scc1 ld_65
    s_call_b64 s[76:77], PREP_a_issue_4
    s_add_u32 m0, m0, 1024
    s_add_u32 s39, s39, 229376
    buffer_load_dwordx4 v2, s[12:15], s39 offen sc1 lds
    s_add_u32 m0, m0, 1024
    s_add_u32 s40, s40, 229376
    buffer_load_dwordx4 v2, s[12:15], s40 offen sc1 lds
    s_add_u32 m0, m0, 1024
    s_add_u32 s39, s39, 229376
    buffer_load_dwordx4 v2, s[12:15], s39 offen sc1 lds
    s_add_u32 m0, m0, 1024
    s_add_u32 s40, s40, 229376
    buffer_load_dwordx4 v2, s[12:15], s40 offen sc1 lds
    s_add_u32 m0, m0, 1024
    s_add_u32 s39, s39, 229376
    buffer_load_dwordx4 v2, s[12:15], s39 offen sc1 lds
    s_add_u32 m0, m0, 1024
    s_add_u32 s40, s40, 229376
    buffer_load_dwordx4 v2, s[12:15], s40 offen sc1 lds
    s_mov_b32 m0, s19
    s_mov_b32 s39, s16
    s_mov_b32 s40, s17
    s_waitcnt vmcnt(8)
    s_barrier
    buffer_load_dwordx4 v2, s[12:15], s39 offen sc1 lds
    s_add_u32 m0, m0, 1024
    s_nop 0
    buffer_load_dwordx4 v2, s[12:15], s40 offen sc1 lds
    s_mov_b64 exec, 1
    buffer_load_dword v11, v12, s[56:59], 0 offen sc1
    s_mov_b64 exec, -1
    s_call_b64 s[76:77], PREP_a_issue_4
    s_add_u32 m0, m0, 1024
    s_add_u32 s39, s39, 229376
    buffer_load_dwordx4 v2, s[12:15], s39 offen sc1 lds
    s_add_u32 m0, m0, 1024
    s_add_u32 s40, s40, 229376
    buffer_load_dwordx4 v2, s[12:15], s40 offen sc1 lds
    s_add_u32 m0, m0, 1024
    s_add_u32 s39, s39, 229376
    buffer_load_dwordx4 v2, s[12:15], s39 offen sc1 lds
    s_add_u32 m0, m0, 1024
    s_add_u32 s40, s40, 229376
    buffer_load_dwordx4 v2, s[12:15], s40 offen sc1 lds
    s_add_u32 m0, m0, 1024
    s_add_u32 s39, s39, 229376
    buffer_load_dwordx4 v2, s[12:15], s39 offen sc1 lds
    s_add_u32 m0, m0, 1024
    s_add_u32 s40, s40, 229376
    buffer_load_dwordx4 v2, s[12:15], s40 offen sc1 lds
    s_mov_b32 m0, s19
    s_mov_b32 s39, s16
    s_mov_b32 s40, s17
    s_waitcnt vmcnt(9)
    s_barrier
    buffer_load_dwordx4 v2, s[12:15], s39 offen sc1 lds
    s_add_u32 m0, m0, 1024
    s_nop 0
    buffer_load_dwordx4 v2, s[12:15], s40 offen sc1 lds
    s_call_b64 s[76:77], PREP_a_issue_4
    s_add_u32 m0, m0, 1024
    s_add_u32 s39, s39, 229376
    buffer_load_dwordx4 v2, s[12:15], s39 offen sc1 lds
    s_add_u32 m0, m0, 1024
    s_add_u32 s40, s40, 229376
    buffer_load_dwordx4 v2, s[12:15], s40 offen sc1 lds
    s_add_u32 m0, m0, 1024
    s_add_u32 s39, s39, 229376
    buffer_load_dwordx4 v2, s[12:15], s39 offen sc1 lds
    s_add_u32 m0, m0, 1024
    s_add_u32 s40, s40, 229376
    buffer_load_dwordx4 v2, s[12:15], s40 offen sc1 lds
    s_add_u32 m0, m0, 1024
    s_add_u32 s39, s39, 229376
    buffer_load_dwordx4 v2, s[12:15], s39 offen sc1 lds
    s_add_u32 m0, m0, 1024
    s_add_u32 s40, s40, 229376
    buffer_load_dwordx4 v2, s[12:15], s40 offen sc1 lds
    s_mov_b32 m0, s19
    s_mov_b32 s39, s16
    s_mov_b32 s40, s17
    s_waitcnt vmcnt(8)
    s_barrier
    buffer_load_dwordx4 v2, s[12:15], s39 offen sc1 lds
    s_add_u32 m0, m0, 1024
    s_nop 0
    buffer_load_dwordx4 v2, s[12:15], s40 offen sc1 lds
    s_waitcnt vmcnt(16)
    v_readfirstlane_b32 s53, v11
    s_add_u32 s54, s52, 8
    s_cmp_eq_u32 s53, s54
    s_cbranch_scc1 fok_66
    s_mov_b32 s53, 0
    s_add_u32 s54, s52, 8
    s_bfm_b64 exec, 1, 0
poll_67:
    buffer_load_dword v11, v12, s[56:59], 0 offen sc1
    s_waitcnt vmcnt(0)
    v_xor_b32 v11, s54, v11
    v_cmp_eq_u32 vcc, 0, v11
    s_nop 0
    s_cmp_eq_u64 vcc, exec
    s_cbranch_scc1 pok_68
    s_sleep 5
    s_add_u32 s53, s53, 1
    s_cmp_lt_u32 s53, s61
    s_cbranch_scc1 poll_67
    s_mov_b32 s61, 0
pok_68:
    s_mov_b64 exec, -1
fok_66:
    s_call_b64 s[76:77], PREP_a_issue_4
    s_add_u32 m0, m0, 1024
    s_add_u32 s39, s39, 229376
    buffer_load_dwordx4 v2, s[12:15], s39 offen sc1 lds
    s_add_u32 m0, m0, 1024
    s_add_u32 s40, s40, 229376
    buffer_load_dwordx4 v2, s[12:15], s40 offen sc1 lds
    s_add_u32 m0, m0, 1024
    s_add_u32 s39, s39, 229376
    buffer_load_dwordx4 v2, s[12:15], s39 offen sc1 lds
    s_add_u32 m0, m0, 1024
    s_add_u32 s40, s40, 229376
    buffer_load_dwordx4 v2, s[12:15], s40 offen sc1 lds
    s_add_u32 m0, m0, 1024
    s_add_u32 s39, s39, 229376
    buffer_load_dwordx4 v2, s[12:15], s39 offen sc1 lds
    s_add_u32 m0, m0, 1024
    s_add_u32 s40, s40, 229376
    buffer_load_dwordx4 v2, s[12:15], s40 offen sc1 lds
    s_mov_b32 m0, s19
    s_mov_b32 s39, s16
    s_mov_b32 s40, s17
    s_waitcnt vmcnt(8)
    s_barrier
    buffer_load_dwordx4 v2, s[12:15], s39 offen sc1 lds
    s_add_u32 m0, m0, 1024
    s_nop 0
    buffer_load_dwordx4 v2, s[12:15], s40 offen sc1 lds
    s_mov_b32 s43, 1
ld_69:
    s_add_u32 s19, s41, s42
    v_readlane_b32 s16, v249, s44
    v_readlane_b32 s17, v250, s44
    s_add_u32 s16, s16, s38
    s_add_u32 s17, s17, s38
    s_add_u32 s44, s44, 1
    s_add_u32 s42, s42, 16384
    s_cmp_eq_u32 s42, 49152
    s_cselect_b32 s42, 0, s42
    s_add_u32 m0, m0, 1024
    s_add_u32 s39, s39, 229376
    buffer_load_dwordx4 v2, s[12:15], s39 offen sc1 lds
    s_add_u32 m0, m0, 1024
    s_add_u32 s40, s40, 229376
    buffer_load_dwordx4 v2, s[12:15], s40 offen sc1 lds
    s_add_u32 m0, m0, 1024
    s_add_u32 s39, s39, 229376
    buffer_load_dwordx4 v2, s[12:15], s39 offen sc1 lds
    s_add_u32 m0, m0, 1024
    s_add_u32 s40, s40, 229376
    buffer_load_dwordx4 v2, s[12:15], s40 offen sc1 lds
    s_add_u32 m0, m0, 1024
    s_add_u32 s39, s39, 229376
    buffer_load_dwordx4 v2, s[12:15], s39 offen sc1 lds
    s_add_u32 m0, m0, 1024
    s_add_u32 s40, s40, 229376
    buffer_load_dwordx4 v2, s[12:15], s40 offen sc1 lds
    s_mov_b32 m0, s19
    s_mov_b32 s39, s16
    s_mov_b32 s40, s17
    s_waitcnt vmcnt(8)
    s_barrier
    buffer_load_dwordx4 v2, s[12:15], s39 offen sc1 lds
    s_add_u32 m0, m0, 1024
    s_nop 0
    buffer_load_dwordx4 v2, s[12:15], s40 offen sc1 lds
    s_add_u32 s43, s43, 1
    s_cmp_lt_u32 s43, 5
    s_cbranch_scc1 ld_69
    s_call_b64 s[76:77], PREP_a_issue_4
    s_add_u32 m0, m0, 1024
    s_add_u32 s39, s39, 229376
    buffer_load_dwordx4 v2, s[12:15], s39 offen sc1 lds
    s_add_u32 m0, m0, 1024
    s_add_u32 s40, s40, 229376
    buffer_load_dwordx4 v2, s[12:15], s40 offen sc1 lds
    s_add_u32 m0, m0, 1024
    s_add_u32 s39, s39, 229376
    buffer_load_dwordx4 v2, s[12:15], s39 offen sc1 lds
    s_add_u32 m0, m0, 1024
    s_add_u32 s40, s40, 229376
    buffer_load_dwordx4 v2, s[12:15], s40 offen sc1 lds
    s_add_u32 m0, m0, 1024
    s_add_u32 s39, s39, 229376
    buffer_load_dwordx4 v2, s[12:15], s39 offen sc1 lds
    s_add_u32 m0, m0, 1024
    s_add_u32 s40, s40, 229376
    buffer_load_dwordx4 v2, s[12:15], s40 offen sc1 lds
    s_mov_b32 m0, s19
    s_mov_b32 s39, s16
    s_mov_b32 s40, s17
    s_waitcnt vmcnt(8)
    s_barrier
    buffer_load_dwordx4 v2, s[12:15], s39 offen sc1 lds
    s_add_u32 m0, m0, 1024
    s_nop 0
    buffer_load_dwordx4 v2, s[12:15], s40 offen sc1 lds
    s_mov_b64 exec, 1
    buffer_load_dword v11, v15, s[56:59], 0 offen sc1
    s_mov_b64 exec, -1
    s_call_b64 s[76:77], PREP_a_issue_4
    s_add_u32 m0, m0, 1024
    s_add_u32 s39, s39, 229376
    buffer_load_dwordx4 v2, s[12:15], s39 offen sc1 lds
    s_add_u32 m0, m0, 1024
    s_add_u32 s40, s40, 229376
    buffer_load_dwordx4 v2, s[12:15], s40 offen sc1 lds
    s_add_u32 m0, m0, 1024
    s_add_u32 s39, s39, 229376
    buffer_load_dwordx4 v2, s[12:15], s39 offen sc1 lds
    s_add_u32 m0, m0, 1024
    s_add_u32 s40, s40, 229376
    buffer_load_dwordx4 v2, s[12:15], s40 offen sc1 lds
    s_add_u32 m0, m0, 1024
    s_add_u32 s39, s39, 229376
    buffer_load_dwordx4 v2, s[12:15], s39 offen sc1 lds
    s_add_u32 m0, m0, 1024
    s_add_u32 s40, s40, 229376
    buffer_load_dwordx4 v2, s[12:15], s40 offen sc1 lds
    s_mov_b32 m0, s19
    s_mov_b32 s39, s16
    s_mov_b32 s40, s17
    s_waitcnt vmcnt(9)
    s_barrier
    buffer_load_dwordx4 v2, s[12:15], s39 offen sc1 lds
    s_add_u32 m0, m0, 1024
    s_nop 0
    buffer_load_dwordx4 v2, s[12:15], s40 offen sc1 lds
    s_call_b64 s[76:77], PREP_a_issue_4
    s_add_u32 m0, m0, 1024
    s_add_u32 s39, s39, 229376
    buffer_load_dwordx4 v2, s[12:15], s39 offen sc1 lds
    s_add_u32 m0, m0, 1024
    s_add_u32 s40, s40, 229376
    buffer_load_dwordx4 v2, s[12:15], s40 offen sc1 lds
    s_add_u32 m0, m0, 1024
    s_add_u32 s39, s39, 229376
    buffer_load_dwordx4 v2, s[12:15], s39 offen sc1 lds
    s_add_u32 m0, m0, 1024
    s_add_u32 s40, s40, 229376
    buffer_load_dwordx4 v2, s[12:15], s40 offen sc1 lds
    s_add_u32 m0, m0, 1024
    s_add_u32 s39, s39, 229376
    buffer_load_dwordx4 v2, s[12:15], s39 offen sc1 lds
    s_add_u32 m0, m0, 1024
    s_add_u32 s40, s40, 229376
    buffer_load_dwordx4 v2, s[12:15], s40 offen sc1 lds
    s_mov_b32 m0, s19
    s_mov_b32 s39, s16
    s_mov_b32 s40, s17
    s_waitcnt vmcnt(8)
    s_barrier
    buffer_load_dwordx4 v2, s[12:15], s39 offen sc1 lds
    s_add_u32 m0, m0, 1024
    s_nop 0
    buffer_load_dwordx4 v2, s[12:15], s40 offen sc1 lds
    s_waitcnt vmcnt(16)
    v_readfirstlane_b32 s53, v11
    s_add_u32 s54, s52, 8
    s_cmp_eq_u32 s53, s54
    s_cbranch_scc1 fok_70
    s_mov_b32 s53, 0
    s_add_u32 s54, s52, 8
    s_bfm_b64 exec, 1, 0
poll_71:
    buffer_load_dword v11, v15, s[56:59], 0 offen sc1
    s_waitcnt vmcnt(0)
    v_xor_b32 v11, s54, v11
    v_cmp_eq_u32 vcc, 0, v11
    s_nop 0
    s_cmp_eq_u64 vcc, exec
    s_cbranch_scc1 pok_72
    s_sleep 5
    s_add_u32 s53, s53, 1
    s_cmp_lt_u32 s53, s61
    s_cbranch_scc1 poll_71
    s_mov_b32 s61, 0
pok_72:
    s_mov_b64 exec, -1
fok_70:
    s_call_b64 s[76:77], PREP_a_issue_4
    s_add_u32 m0, m0, 1024
    s_add_u32 s39, s39, 229376
    buffer_load_dwordx4 v2, s[12:15], s39 offen sc1 lds
    s_add_u32 m0, m0, 1024
    s_add_u32 s40, s40, 229376
    buffer_load_dwordx4 v2, s[12:15], s40 offen sc1 lds
    s_add_u32 m0, m0, 1024
    s_add_u32 s39, s39, 229376
    buffer_load_dwordx4 v2, s[12:15], s39 offen sc1 lds
    s_add_u32 m0, m0, 1024
    s_add_u32 s40, s40, 229376
    buffer_load_dwordx4 v2, s[12:15], s40 offen sc1 lds
    s_add_u32 m0, m0, 1024
    s_add_u32 s39, s39, 229376
    buffer_load_dwordx4 v2, s[12:15], s39 offen sc1 lds
    s_add_u32 m0, m0, 1024
    s_add_u32 s40, s40, 229376
    buffer_load_dwordx4 v2, s[12:15], s40 offen sc1 lds
    s_mov_b32 m0, s19
    s_mov_b32 s39, s16
    s_mov_b32 s40, s17
    s_waitcnt vmcnt(8)
    s_barrier
    buffer_load_dwordx4 v2, s[12:15], s39 offen sc1 lds
    s_add_u32 m0, m0, 1024
    s_nop 0
    buffer_load_dwordx4 v2, s[12:15], s40 offen sc1 lds
    s_mov_b32 s43, 1
ld_73:
    s_add_u32 s19, s41, s42
    v_readlane_b32 s16, v249, s44
    v_readlane_b32 s17, v250, s44
    s_add_u32 s16, s16, s38
    s_add_u32 s17, s17, s38
    s_add_u32 s44, s44, 1
    s_add_u32 s42, s42, 16384
    s_cmp_eq_u32 s42, 49152
    s_cselect_b32 s42, 0, s42
    s_add_u32 m0, m0, 1024
    s_add_u32 s39, s39, 229376
    buffer_load_dwordx4 v2, s[12:15], s39 offen sc1 lds
    s_add_u32 m0, m0, 1024
    s_add_u32 s40, s40, 229376
    buffer_load_dwordx4 v2, s[12:15], s40 offen sc1 lds
    s_add_u32 m0, m0, 1024
    s_add_u32 s39, s39, 229376
    buffer_load_dwordx4 v2, s[12:15], s39 offen sc1 lds
    s_add_u32 m0, m0, 1024
    s_add_u32 s40, s40, 229376
    buffer_load_dwordx4 v2, s[12:15], s40 offen sc1 lds
    s_add_u32 m0, m0, 1024
    s_add_u32 s39, s39, 229376
    buffer_load_dwordx4 v2, s[12:15], s39 offen sc1 lds
    s_add_u32 m0, m0, 1024
    s_add_u32 s40, s40, 229376
    buffer_load_dwordx4 v2, s[12:15], s40 offen sc1 lds
    s_mov_b32 m0, s19
    s_mov_b32 s39, s16
    s_mov_b32 s40, s17
    s_waitcnt vmcnt(8)
    s_barrier
    buffer_load_dwordx4 v2, s[12:15], s39 offen sc1 lds
    s_add_u32 m0, m0, 1024
    s_nop 0
    buffer_load_dwordx4 v2, s[12:15], s40 offen sc1 lds
    s_add_u32 s43, s43, 1
    s_cmp_lt_u32 s43, 3
    s_cbranch_scc1 ld_73
    s_call_b64 s[76:77], PREP_a_issue_4
    s_add_u32 m0, m0, 1024
    s_add_u32 s39, s39, 229376
    buffer_load_dwordx4 v2, s[12:15], s39 offen sc1 lds
    s_add_u32 m0, m0, 1024
    s_add_u32 s40, s40, 229376
    buffer_load_dwordx4 v2, s[12:15], s40 offen sc1 lds
    s_add_u32 m0, m0, 1024
    s_add_u32 s39, s39, 229376
    buffer_load_dwordx4 v2, s[12:15], s39 offen sc1 lds
    s_add_u32 m0, m0, 1024
    s_add_u32 s40, s40, 229376
    buffer_load_dwordx4 v2, s[12:15], s40 offen sc1 lds
    s_add_u32 m0, m0, 1024
    s_add_u32 s39, s39, 229376
    buffer_load_dwordx4 v2, s[12:15], s39 offen sc1 lds
    s_add_u32 m0, m0, 1024
    s_add_u32 s40, s40, 229376
    buffer_load_dwordx4 v2, s[12:15], s40 offen sc1 lds
    s_mov_b32 m0, s19
    s_mov_b32 s39, s16
    s_mov_b32 s40, s17
    s_waitcnt vmcnt(8)
    s_barrier
    buffer_load_dwordx4 v2, s[12:15], s39 offen sc1 lds
    s_add_u32 m0, m0, 1024
    s_nop 0
    buffer_load_dwordx4 v2, s[12:15], s40 offen sc1 lds
    s_add_u32 m0, m0, 1024
    s_add_u32 s39, s39, 229376
    buffer_load_dwordx4 v2, s[12:15], s39 offen sc1 lds
    s_add_u32 m0, m0, 1024
    s_add_u32 s40, s40, 229376
    buffer_load_dwordx4 v2, s[12:15], s40 offen sc1 lds
    s_add_u32 m0, m0, 1024
    s_add_u32 s39, s39, 229376
    buffer_load_dwordx4 v2, s[12:15], s39 offen sc1 lds
    s_add_u32 m0, m0, 1024
    s_add_u32 s40, s40, 229376
    buffer_load_dwordx4 v2, s[12:15], s40 offen sc1 lds
    s_add_u32 m0, m0, 1024
    s_add_u32 s39, s39, 229376
    buffer_load_dwordx4 v2, s[12:15], s39 offen sc1 lds
    s_add_u32 m0, m0, 1024
    s_add_u32 s40, s40, 229376
    buffer_load_dwordx4 v2, s[12:15], s40 offen sc1 lds
    s_waitcnt vmcnt(8)
    s_barrier
    s_waitcnt vmcnt(0)
    s_barrier
    s_cmp_eq_u32 s60, 1
    s_cbranch_scc1 K_fin
    s_barrier
    s_branch NEXT
WLOAD:
    s_cmp_eq_u32 s60, 1
    s_cbranch_scc1 WL_1
    s_mov_b64 s[12:13], s[68:69]
    s_mov_b32 s14, 2097152
    s_mov_b32 s15, 0x20000
    s_and_b32 s35, s30, 1
    s_mul_i32 s38, s99, 128
    s_mul_i32 s41, s35, 65536
    s_add_u32 s38, s38, s41
    s_mul_i32 s41, s35, 4096
    s_add_u32 s41, s41, 24576
    s_mov_b32 s42, 0
    s_mov_b32 s44, s67
    s_branch WL_2
WL_1:
    s_mov_b64 s[12:13], s[68:69]
    s_mov_b32 s14, 2097152
    s_mov_b32 s15, 0x20000
    s_and_b32 s35, s30, 1
    s_mul_i32 s38, s99, 128
    s_mul_i32 s41, s35, 65536
    s_add_u32 s38, s38, s41
    s_mul_i32 s41, s35, 4096
    s_add_u32 s41, s41, 24576
    s_mov_b32 s42, 0
    s_mov_b32 s44, s67
WL_2:
    s_waitcnt vmcnt(0)
    s_and_b32 s36, s30, 1
    s_lshl_b32 s36, s36, 12
    s_add_u32 s36, s36, 81920
    v_add_u32 v6, s36, v2
    ds_read_b128 v[16:19], v6 offset:16384
    ds_read_b128 v[20:23], v6 offset:17408
    ds_read_b128 v[24:27], v6 offset:18432
    ds_read_b128 v[28:31], v6 offset:19456
    ds_read_b128 v[32:35], v6 offset:24576
    ds_read_b128 v[36:39], v6 offset:25600
    ds_read_b128 v[40:43], v6 offset:26624
    ds_read_b128 v[44:47], v6 offset:27648
    ds_read_b128 v[204:207], v6 offset:0
    ds_read_b128 v[208:211], v6 offset:1024
    ds_read_b128 v[212:215], v6 offset:2048
    ds_read_b128 v[216:219], v6 offset:3072
    s_waitcnt lgkmcnt(0)
    s_barrier
    s_call_b64 s[76:77], SUB_after_g1
    s_barrier
    s_waitcnt vmcnt(0)
    s_barrier
    s_call_b64 s[76:77], SUB_after_g2
    s_mov_b64 s[12:13], s[72:73]
    s_mov_b32 s14, 7340032
    s_mov_b32 s15, 0x20000
    s_and_b32 s35, s30, 1
    s_mul_i32 s38, s29, 448
    s_mul_i32 s41, s35, 229376
    s_add_u32 s38, s38, s41
    s_mul_i32 s41, s35, 14336
    s_add_u32 s41, s41, 73728
    s_mov_b32 s42, 0
    s_mov_b32 s44, 0
    s_mov_b32 s42, 28672
    s_mov_b32 s44, 2
    s_add_u32 s19, s41, s42
    v_readlane_b32 s16, v248, s44
    s_nop 0
    s_add_u32 s16, s16, s38
    s_add_u32 s44, s44, 1
    s_and_b32 s44, s44, 15
    s_add_u32 s42, s42, 28672
    s_cmp_eq_u32 s42, 86016
    s_cselect_b32 s42, 0, s42
    s_mov_b32 m0, s19
    s_mov_b32 s39, s16
    s_waitcnt vmcnt(63)
    s_barrier
    buffer_load_dwordx4 v241, s[12:15], s39 offen lds
    s_add_u32 m0, m0, 1024
    s_nop 0
    buffer_load_dwordx4 v242, s[12:15], s39 offen lds
    s_add_u32 m0, m0, 1024
    s_nop 0
    buffer_load_dwordx4 v243, s[12:15], s39 offen lds
    s_mov_b32 s43, 1
ld_74:
    s_add_u32 s19, s41, s42
    v_readlane_b32 s16, v248, s44
    s_nop 0
    s_add_u32 s16, s16, s38
    s_add_u32 s44, s44, 1
    s_and_b32 s44, s44, 15
    s_add_u32 s42, s42, 28672
    s_cmp_eq_u32 s42, 86016
    s_cselect_b32 s42, 0, s42
    s_add_u32 m0, m0, 1024
    s_nop 0
    buffer_load_dwordx4 v244, s[12:15], s39 offen lds
    s_add_u32 m0, m0, 1024
    s_nop 0
    buffer_load_dwordx4 v245, s[12:15], s39 offen lds
    s_add_u32 m0, m0, 1024
    s_nop 0
    buffer_load_dwordx4 v246, s[12:15], s39 offen lds
    s_add_u32 m0, m0, 1024
    s_nop 0
    buffer_load_dwordx4 v247, s[12:15], s39 offen lds
    s_add_u32 m0, m0, 1024
    s_add_u32 s39, s39, 114688
    buffer_load_dwordx4 v241, s[12:15], s39 offen lds
    s_add_u32 m0, m0, 1024
    s_nop 0
    buffer_load_dwordx4 v242, s[12:15], s39 offen lds
    s_add_u32 m0, m0, 1024
    s_nop 0
    buffer_load_dwordx4 v243, s[12:15], s39 offen lds
    s_add_u32 m0, m0, 1024
    s_nop 0
    buffer_load_dwordx4 v244, s[12:15], s39 offen lds
    s_add_u32 m0, m0, 1024
    s_nop 0
    buffer_load_dwordx4 v245, s[12:15], s39 offen lds
    s_add_u32 m0, m0, 1024
    s_nop 0
    buffer_load_dwordx4 v246, s[12:15], s39 offen lds
    s_add_u32 m0, m0, 1024
    s_nop 0
    buffer_load_dwordx4 v247, s[12:15], s39 offen lds
    s_mov_b32 m0, s19
    s_mov_b32 s39, s16
    s_waitcnt vmcnt(14)
    s_barrier
    buffer_load_dwordx4 v241, s[12:15], s39 offen lds
    s_add_u32 m0, m0, 1024
    s_nop 0
    buffer_load_dwordx4 v242, s[12:15], s39 offen lds
    s_add_u32 m0, m0, 1024
    s_nop 0
    buffer_load_dwordx4 v243, s[12:15], s39 offen lds
    s_add_u32 s43, s43, 1
    s_cmp_lt_u32 s43, 13
    s_cbranch_scc1 ld_74
    s_add_u32 s19, s41, s42
    v_readlane_b32 s16, v248, s44
    s_nop 0
    s_add_u32 s16, s16, s38
    s_add_u32 s44, s44, 1
    s_and_b32 s44, s44, 15
    s_add_u32 s42, s42, 28672
    s_cmp_eq_u32 s42, 86016
    s_cselect_b32 s42, 0, s42
    s_add_u32 m0, m0, 1024
    s_nop 0
    buffer_load_dwordx4 v244, s[12:15], s39 offen lds
    s_add_u32 m0, m0, 1024
    s_nop 0
    buffer_load_dwordx4 v245, s[12:15], s39 offen lds
    s_add_u32 m0, m0, 1024
    s_nop 0
    buffer_load_dwordx4 v246, s[12:15], s39 offen lds
    s_add_u32 m0, m0, 1024
    s_nop 0
    buffer_load_dwordx4 v247, s[12:15], s39 offen lds
    s_add_u32 m0, m0, 1024
    s_add_u32 s39, s39, 114688
    buffer_load_dwordx4 v241, s[12:15], s39 offen lds
    s_add_u32 m0, m0, 1024
    s_nop 0
    buffer_load_dwordx4 v242, s[12:15], s39 offen lds
    s_add_u32 m0, m0, 1024
    s_nop 0
    buffer_load_dwordx4 v243, s[12:15], s39 offen lds
    s_add_u32 m0, m0, 1024
    s_nop 0
    buffer_load_dwordx4 v244, s[12:15], s39 offen lds
    s_add_u32 m0, m0, 1024
    s_nop 0
    buffer_load_dwordx4 v245, s[12:15], s39 offen lds
    s_add_u32 m0, m0, 1024
    s_nop 0
    buffer_load_dwordx4 v246, s[12:15], s39 offen lds
    s_add_u32 m0, m0, 1024
    s_nop 0
    buffer_load_dwordx4 v247, s[12:15], s39 offen lds
    s_mov_b32 m0, s19
    s_mov_b32 s39, s16
    s_waitcnt vmcnt(14)
    s_barrier
    buffer_load_dwordx4 v241, s[12:15], s39 offen lds
    s_add_u32 m0, m0, 1024
    s_nop 0
    buffer_load_dwordx4 v242, s[12:15], s39 offen lds
    s_add_u32 m0, m0, 1024
    s_nop 0
    buffer_load_dwordx4 v243, s[12:15], s39 offen lds
    s_add_u32 m0, m0, 1024
    s_nop 0
    buffer_load_dwordx4 v244, s[12:15], s39 offen lds
    s_add_u32 m0, m0, 1024
    s_nop 0
    buffer_load_dwordx4 v245, s[12:15], s39 offen lds
    s_add_u32 m0, m0, 1024
    s_nop 0
    buffer_load_dwordx4 v246, s[12:15], s39 offen lds
    s_add_u32 m0, m0, 1024
    s_nop 0
    buffer_load_dwordx4 v247, s[12:15], s39 offen lds
    s_add_u32 m0, m0, 1024
    s_add_u32 s39, s39, 114688
    buffer_load_dwordx4 v241, s[12:15], s39 offen lds
    s_add_u32 m0, m0, 1024
    s_nop 0
    buffer_load_dwordx4 v242, s[12:15], s39 offen lds
    s_add_u32 m0, m0, 1024
    s_nop 0
    buffer_load_dwordx4 v243, s[12:15], s39 offen lds
    s_add_u32 m0, m0, 1024
    s_nop 0
    buffer_load_dwordx4 v244, s[12:15], s39 offen lds
    s_add_u32 m0, m0, 1024
    s_nop 0
    buffer_load_dwordx4 v245, s[12:15], s39 offen lds
    s_add_u32 m0, m0, 1024
    s_nop 0
    buffer_load_dwordx4 v246, s[12:15], s39 offen lds
    s_add_u32 m0, m0, 1024
    s_nop 0
    buffer_load_dwordx4 v247, s[12:15], s39 offen lds
    s_waitcnt vmcnt(14)
    s_barrier
    s_call_b64 s[76:77], SUB_r_pre0
    s_waitcnt vmcnt(4)
    s_barrier
    s_barrier
    s_mov_b64 s[12:13], s[74:75]
    s_mov_b32 s14, 7340032
    s_mov_b32 s15, 0x20000
    s_and_b32 s35, s30, 1
    s_mul_i32 s38, s33, 256
    s_mul_i32 s41, s31, 3670016
    s_add_u32 s38, s38, s41
    s_mul_i32 s41, s35, 8192
    s_add_u32 s41, s41, 49152
    s_mov_b32 s42, 0
    s_mov_b32 s44, 0
    s_mov_b32 s49, s44
    s_and_b32 s43, s28, 3
    s_mul_i32 s43, s43, 6
    s_lshr_b32 s43, s43, 2
    s_mov_b32 s50, 0
wpre_75:
    s_mul_i32 s42, s43, 16384
    s_add_u32 s44, s49, s43
    s_mov_b32 s45, 8192
    s_add_u32 s19, s41, s42
    v_readlane_b32 s16, v249, s44
    s_nop 0
    s_bitcmp1_b32 s16, 0
    s_cselect_b32 s17, 16384, s45
    s_cselect_b32 s18, -40960, s45
    s_andn2_b32 s16, s16, 1
    s_add_u32 s16, s16, s38
    s_add_u32 s44, s44, 1
    s_add_u32 s42, s42, 16384
    s_cmp_eq_u32 s42, 98304
    s_cselect_b32 s42, 0, s42
    s_mov_b32 m0, s19
    s_mov_b32 s39, s16
    s_mov_b32 s32, s17
    s_mov_b32 s3, s18
    buffer_load_dwordx4 v239, s[12:15], s39 offen lds
    s_add_u32 m0, m0, 1024
    s_add_u32 s39, s39, s32
    buffer_load_dwordx4 v240, s[12:15], s39 offen lds
    s_add_u32 m0, m0, 1024
    s_add_u32 s39, s39, s32
    buffer_load_dwordx4 v239, s[12:15], s39 offen lds
    s_add_u32 m0, m0, 1024
    s_add_u32 s39, s39, s32
    buffer_load_dwordx4 v240, s[12:15], s39 offen lds
    s_waitcnt vmcnt(6)
    s_add_u32 m0, m0, 1024
    s_add_u32 s39, s39, s3
    buffer_load_dwordx4 v239, s[12:15], s39 offen lds
    s_add_u32 m0, m0, 1024
    s_add_u32 s39, s39, s32
    buffer_load_dwordx4 v240, s[12:15], s39 offen lds
    s_add_u32 m0, m0, 1024
    s_add_u32 s39, s39, s32
    buffer_load_dwordx4 v239, s[12:15], s39 offen lds
    s_add_u32 m0, m0, 1024
    s_add_u32 s39, s39, s32
    buffer_load_dwordx4 v240, s[12:15], s39 offen lds
    s_waitcnt vmcnt(6)
    s_add_u32 s43, s43, 1
    s_cmp_eq_u32 s43, 6
    s_cselect_b32 s43, 0, s43
    s_add_u32 s50, s50, 1
    s_cmp_lt_u32 s50, 6
    s_cbranch_scc1 wpre_75
    s_mov_b32 s42, 0
    s_add_u32 s44, s49, 6
    s_cmp_eq_u32 s60, 1
    s_cbranch_scc1 WL_t1
    s_call_b64 s[76:77], PREP_w_issue_4
    s_mov_b32 m0, s19
    s_mov_b32 s39, s16
    s_mov_b32 s32, s17
    s_mov_b32 s3, s18
    s_waitcnt vmcnt(0)
    s_barrier
    s_waitcnt vmcnt(0)
    s_barrier
    buffer_load_dwordx4 v239, s[12:15], s39 offen lds
    s_add_u32 m0, m0, 1024
    s_add_u32 s39, s39, s32
    buffer_load_dwordx4 v240, s[12:15], s39 offen lds
    s_call_b64 s[76:77], PREP_w_issue_4
    s_add_u32 m0, m0, 1024
    s_add_u32 s39, s39, s32
    buffer_load_dwordx4 v239, s[12:15], s39 offen lds
    s_add_u32 m0, m0, 1024
    s_add_u32 s39, s39, s32
    buffer_load_dwordx4 v240, s[12:15], s39 offen lds
    s_add_u32 m0, m0, 1024
    s_add_u32 s39, s39, s3
    buffer_load_dwordx4 v239, s[12:15], s39 offen lds
    s_add_u32 m0, m0, 1024
    s_add_u32 s39, s39, s32
    buffer_load_dwordx4 v240, s[12:15], s39 offen lds
    s_add_u32 m0, m0, 1024
    s_add_u32 s39, s39, s32
    buffer_load_dwordx4 v239, s[12:15], s39 offen lds
    s_add_u32 m0, m0, 1024
    s_add_u32 s39, s39, s32
    buffer_load_dwordx4 v240, s[12:15], s39 offen lds
    s_mov_b32 m0, s19
    s_mov_b32 s39, s16
    s_mov_b32 s32, s17
    s_mov_b32 s3, s18
    s_waitcnt vmcnt(8)
    s_barrier
    buffer_load_dwordx4 v239, s[12:15], s39 offen lds
    s_add_u32 m0, m0, 1024
    s_add_u32 s39, s39, s32
    buffer_load_dwordx4 v240, s[12:15], s39 offen lds
    s_call_b64 s[76:77], PREP_w_issue_4
    s_add_u32 m0, m0, 1024
    s_add_u32 s39, s39, s32
    buffer_load_dwordx4 v239, s[12:15], s39 offen lds
    s_add_u32 m0, m0, 1024
    s_add_u32 s39, s39, s32
    buffer_load_dwordx4 v240, s[12:15], s39 offen lds
    s_add_u32 m0, m0, 1024
    s_add_u32 s39, s39, s3
    buffer_load_dwordx4 v239, s[12:15], s39 offen lds
    s_add_u32 m0, m0, 1024
    s_add_u32 s39, s39, s32
    buffer_load_dwordx4 v240, s[12:15], s39 offen lds
    s_add_u32 m0, m0, 1024
    s_add_u32 s39, s39, s32
    buffer_load_dwordx4 v239, s[12:15], s39 offen lds
    s_add_u32 m0, m0, 1024
    s_add_u32 s39, s39, s32
    buffer_load_dwordx4 v240, s[12:15], s39 offen lds
    s_mov_b32 m0, s19
    s_mov_b32 s39, s16
    s_mov_b32 s32, s17
    s_mov_b32 s3, s18
    s_waitcnt vmcnt(16)
    s_barrier
    buffer_load_dwordx4 v239, s[12:15], s39 offen lds
    s_add_u32 m0, m0, 1024
    s_add_u32 s39, s39, s32
    buffer_load_dwordx4 v240, s[12:15], s39 offen lds
    s_call_b64 s[76:77], PREP_w_issue_4
    s_add_u32 m0, m0, 1024
    s_add_u32 s39, s39, s32
    buffer_load_dwordx4 v239, s[12:15], s39 offen lds
    s_add_u32 m0, m0, 1024
    s_add_u32 s39, s39, s32
    buffer_load_dwordx4 v240, s[12:15], s39 offen lds
    s_add_u32 m0, m0, 1024
    s_add_u32 s39, s39, s3
    buffer_load_dwordx4 v239, s[12:15], s39 offen lds
    s_add_u32 m0, m0, 1024
    s_add_u32 s39, s39, s32
    buffer_load_dwordx4 v240, s[12:15], s39 offen lds
    s_add_u32 m0, m0, 1024
    s_add_u32 s39, s39, s32
    buffer_load_dwordx4 v239, s[12:15], s39 offen lds
    s_add_u32 m0, m0, 1024
    s_add_u32 s39, s39, s32
    buffer_load_dwordx4 v240, s[12:15], s39 offen lds
    s_mov_b32 m0, s19
    s_mov_b32 s39, s16
    s_mov_b32 s32, s17
    s_mov_b32 s3, s18
    s_waitcnt vmcnt(24)
    s_barrier
    buffer_load_dwordx4 v239, s[12:15], s39 offen lds
    s_add_u32 m0, m0, 1024
    s_add_u32 s39, s39, s32
    buffer_load_dwordx4 v240, s[12:15], s39 offen lds
    s_mov_b32 s43, 1
ld_76:
    s_mov_b32 s45, 8192
    s_add_u32 s19, s41, s42
    v_readlane_b32 s16, v249, s44
    s_nop 0
    s_bitcmp1_b32 s16, 0
    s_cselect_b32 s17, 16384, s45
    s_cselect_b32 s18, -40960, s45
    s_andn2_b32 s16, s16, 1
    s_add_u32 s16, s16, s38
    s_add_u32 s44, s44, 1
    s_add_u32 s42, s42, 16384
    s_cmp_eq_u32 s42, 98304
    s_cselect_b32 s42, 0, s42
    s_add_u32 m0, m0, 1024
    s_add_u32 s39, s39, s32
    buffer_load_dwordx4 v239, s[12:15], s39 offen lds
    s_add_u32 m0, m0, 1024
    s_add_u32 s39, s39, s32
    buffer_load_dwordx4 v240, s[12:15], s39 offen lds
    s_add_u32 m0, m0, 1024
    s_add_u32 s39, s39, s3
    buffer_load_dwordx4 v239, s[12:15], s39 offen lds
    s_add_u32 m0, m0, 1024
    s_add_u32 s39, s39, s32
    buffer_load_dwordx4 v240, s[12:15], s39 offen lds
    s_add_u32 m0, m0, 1024
    s_add_u32 s39, s39, s32
    buffer_load_dwordx4 v239, s[12:15], s39 offen lds
    s_add_u32 m0, m0, 1024
    s_add_u32 s39, s39, s32
    buffer_load_dwordx4 v240, s[12:15], s39 offen lds
    s_mov_b32 m0, s19
    s_mov_b32 s39, s16
    s_mov_b32 s32, s17
    s_mov_b32 s3, s18
    s_waitcnt vmcnt(32)
    s_barrier
    buffer_load_dwordx4 v239, s[12:15], s39 offen lds
    s_add_u32 m0, m0, 1024
    s_add_u32 s39, s39, s32
    buffer_load_dwordx4 v240, s[12:15], s39 offen lds
    s_add_u32 s43, s43, 1
    s_cmp_lt_u32 s43, 18
    s_cbranch_scc1 ld_76
    s_call_b64 s[76:77], PREP_w_issue_4
    s_add_u32 m0, m0, 1024
    s_add_u32 s39, s39, s32
    buffer_load_dwordx4 v239, s[12:15], s39 offen lds
    s_add_u32 m0, m0, 1024
    s_add_u32 s39, s39, s32
    buffer_load_dwordx4 v240, s[12:15], s39 offen lds
    s_add_u32 m0, m0, 1024
    s_add_u32 s39, s39, s3
    buffer_load_dwordx4 v239, s[12:15], s39 offen lds
    s_add_u32 m0, m0, 1024
    s_add_u32 s39, s39, s32
    buffer_load_dwordx4 v240, s[12:15], s39 offen lds
    s_add_u32 m0, m0, 1024
    s_add_u32 s39, s39, s32
    buffer_load_dwordx4 v239, s[12:15], s39 offen lds
    s_add_u32 m0, m0, 1024
    s_add_u32 s39, s39, s32
    buffer_load_dwordx4 v240, s[12:15], s39 offen lds
    s_mov_b32 m0, s19
    s_mov_b32 s39, s16
    s_mov_b32 s32, s17
    s_mov_b32 s3, s18
    s_waitcnt vmcnt(32)
    s_barrier
    buffer_load_dwordx4 v239, s[12:15], s39 offen lds
    s_add_u32 m0, m0, 1024
    s_add_u32 s39, s39, s32
    buffer_load_dwordx4 v240, s[12:15], s39 offen lds
    s_add_u32 m0, m0, 1024
    s_add_u32 s39, s39, s32
    buffer_load_dwordx4 v239, s[12:15], s39 offen lds
    s_add_u32 m0, m0, 1024
    s_add_u32 s39, s39, s32
    buffer_load_dwordx4 v240, s[12:15], s39 offen lds
    s_add_u32 m0, m0, 1024
    s_add_u32 s39, s39, s3
    buffer_load_dwordx4 v239, s[12:15], s39 offen lds
    s_add_u32 m0, m0, 1024
    s_add_u32 s39, s39, s32
    buffer_load_dwordx4 v240, s[12:15], s39 offen lds
    s_add_u32 m0, m0, 1024
    s_add_u32 s39, s39, s32
    buffer_load_dwordx4 v239, s[12:15], s39 offen lds
    s_add_u32 m0, m0, 1024
    s_add_u32 s39, s39, s32
    buffer_load_dwordx4 v240, s[12:15], s39 offen lds
    s_waitcnt vmcnt(32)
    s_barrier
    s_mov_b64 s[12:13], s[68:69]
    s_mov_b32 s14, 2097152
    s_mov_b32 s15, 0x20000
    s_and_b32 s35, s30, 1
    s_mul_i32 s38, s99, 128
    s_mul_i32 s41, s35, 65536
    s_add_u32 s38, s38, s41
    s_mul_i32 s41, s35, 4096
    s_add_u32 s41, s41, 24576
    s_mov_b32 s42, 0
    s_mov_b32 s44, s67
    s_and_b32 s36, s99, 7
    s_cmp_eq_u32 s36, 3
    s_cselect_b64 s[50:51], 0, -1
    s_mov_b32 s42, 90112
    s_mov_b32 s44, s67
    s_add_u32 s44, s44, 11
    s_and_b32 s44, s44, 15
    s_call_b64 s[76:77], SUB_w_issue_1
    s_mov_b32 s42, 98304
    s_mov_b32 s44, s67
    s_add_u32 s44, s44, 12
    s_and_b32 s44, s44, 15
    s_call_b64 s[76:77], SUB_w_issue_1
    s_mov_b32 s42, 122880
    s_mov_b32 s44, s67
    s_add_u32 s44, s44, 15
    s_and_b32 s44, s44, 15
    s_call_b64 s[76:77], SUB_w_issue_1
    s_waitcnt vmcnt(36)
    s_barrier
    s_mov_b32 s42, 106496
    s_mov_b32 s44, s67
    s_add_u32 s44, s44, 13
    s_and_b32 s44, s44, 15
    s_call_b64 s[76:77], SUB_w_issue_1
    s_mov_b32 s42, 114688
    s_mov_b32 s44, s67
    s_add_u32 s44, s44, 14
    s_and_b32 s44, s44, 15
    s_call_b64 s[76:77], SUB_w_issue_1
    s_waitcnt vmcnt(36)
    s_barrier
    s_mov_b32 s42, 24576
    s_mov_b32 s44, s67
    s_add_u32 s44, s44, 3
    s_and_b32 s44, s44, 15
    s_call_b64 s[76:77], SUB_w_issue_1
    s_mov_b32 s42, 32768
    s_mov_b32 s44, s67
    s_add_u32 s44, s44, 4
    s_and_b32 s44, s44, 15
    s_call_b64 s[76:77], SUB_w_issue_1
    s_waitcnt vmcnt(36)
    s_barrier
    s_mov_b32 s42, 40960
    s_mov_b32 s44, s67
    s_add_u32 s44, s44, 5
    s_and_b32 s44, s44, 15
    s_call_b64 s[76:77], SUB_w_issue_1
    s_mov_b32 s42, 49152
    s_mov_b32 s44, s67
    s_add_u32 s44, s44, 6
    s_and_b32 s44, s44, 15
    s_call_b64 s[76:77], SUB_w_issue_1
    s_mov_b32 s42, 0
    s_mov_b32 s44, s67
    s_add_u32 s44, s44, 0
    s_and_b32 s44, s44, 15
    s_call_b64 s[76:77], SUB_w_issue_1
    s_waitcnt vmcnt(40)
    s_barrier
    s_mov_b32 s42, 65536
    s_mov_b32 s44, s67
    s_add_u32 s44, s44, 8
    s_and_b32 s44, s44, 15
    s_call_b64 s[76:77], SUB_w_issue_1
    s_mov_b32 s42, 8192
    s_mov_b32 s44, s67
    s_add_u32 s44, s44, 1
    s_and_b32 s44, s44, 15
    s_call_b64 s[76:77], SUB_w_issue_1
    s_mov_b32 s42, 16384
    s_mov_b32 s44, s67
    s_add_u32 s44, s44, 2
    s_and_b32 s44, s44, 15
    s_call_b64 s[76:77], SUB_w_issue_1
    s_add_u32 s36, s41, 57344
    v_add_u32 v6, s36, v2
    ds_write_b128 v6, v[204:207] offset:0
    ds_write_b128 v6, v[208:211] offset:1024
    ds_write_b128 v6, v[212:215] offset:2048
    ds_write_b128 v6, v[216:219] offset:3072
    s_barrier
    s_add_u32 s36, s41, 57344
    v_add_u32 v6, s36, v2
    ds_write_b128 v6, v[16:19] offset:16384
    ds_write_b128 v6, v[20:23] offset:17408
    ds_write_b128 v6, v[24:27] offset:18432
    ds_write_b128 v6, v[28:31] offset:19456
    ds_write_b128 v6, v[32:35] offset:24576
    ds_write_b128 v6, v[36:39] offset:25600
    ds_write_b128 v6, v[40:43] offset:26624
    ds_write_b128 v6, v[44:47] offset:27648
    s_waitcnt lgkmcnt(0)
    s_branch NEXT
WL_t1:
    s_call_b64 s[76:77], PREP_w_issue_4
    s_mov_b32 m0, s19
    s_mov_b32 s39, s16
    s_mov_b32 s32, s17
    s_mov_b32 s3, s18
    s_waitcnt vmcnt(0)
    s_barrier
    s_waitcnt vmcnt(0)
    s_barrier
    s_waitcnt vmcnt(0)
    s_barrier
    s_waitcnt vmcnt(0)
    s_barrier
    s_waitcnt vmcnt(0)
    s_barrier
    buffer_load_dwordx4 v239, s[12:15], s39 offen lds
    s_add_u32 m0, m0, 1024
    s_add_u32 s39, s39, s32
    buffer_load_dwordx4 v240, s[12:15], s39 offen lds
    s_mov_b32 s43, 1
ld_77:
    s_mov_b32 s45, 8192
    s_add_u32 s19, s41, s42
    v_readlane_b32 s16, v249, s44
    s_nop 0
    s_bitcmp1_b32 s16, 0
    s_cselect_b32 s17, 16384, s45
    s_cselect_b32 s18, -40960, s45
    s_andn2_b32 s16, s16, 1
    s_add_u32 s16, s16, s38
    s_add_u32 s44, s44, 1
    s_add_u32 s42, s42, 16384
    s_cmp_eq_u32 s42, 98304
    s_cselect_b32 s42, 0, s42
    s_add_u32 m0, m0, 1024
    s_add_u32 s39, s39, s32
    buffer_load_dwordx4 v239, s[12:15], s39 offen lds
    s_add_u32 m0, m0, 1024
    s_add_u32 s39, s39, s32
    buffer_load_dwordx4 v240, s[12:15], s39 offen lds
    s_add_u32 m0, m0, 1024
    s_add_u32 s39, s39, s3
    buffer_load_dwordx4 v239, s[12:15], s39 offen lds
    s_add_u32 m0, m0, 1024
    s_add_u32 s39, s39, s32
    buffer_load_dwordx4 v240, s[12:15], s39 offen lds
    s_add_u32 m0, m0, 1024
    s_add_u32 s39, s39, s32
    buffer_load_dwordx4 v239, s[12:15], s39 offen lds
    s_add_u32 m0, m0, 1024
    s_add_u32 s39, s39, s32
    buffer_load_dwordx4 v240, s[12:15], s39 offen lds
    s_mov_b32 m0, s19
    s_mov_b32 s39, s16
    s_mov_b32 s32, s17
    s_mov_b32 s3, s18
    s_waitcnt vmcnt(8)
    s_barrier
    buffer_load_dwordx4 v239, s[12:15], s39 offen lds
    s_add_u32 m0, m0, 1024
    s_add_u32 s39, s39, s32
    buffer_load_dwordx4 v240, s[12:15], s39 offen lds
    s_add_u32 s43, s43, 1
    s_cmp_lt_u32 s43, 21
    s_cbranch_scc1 ld_77
    s_call_b64 s[76:77], PREP_w_issue_4
    s_add_u32 m0, m0, 1024
    s_add_u32 s39, s39, s32
    buffer_load_dwordx4 v239, s[12:15], s39 offen lds
    s_add_u32 m0, m0, 1024
    s_add_u32 s39, s39, s32
    buffer_load_dwordx4 v240, s[12:15], s39 offen lds
    s_add_u32 m0, m0, 1024
    s_add_u32 s39, s39, s3
    buffer_load_dwordx4 v239, s[12:15], s39 offen lds
    s_add_u32 m0, m0, 1024
    s_add_u32 s39, s39, s32
    buffer_load_dwordx4 v240, s[12:15], s39 offen lds
    s_add_u32 m0, m0, 1024
    s_add_u32 s39, s39, s32
    buffer_load_dwordx4 v239, s[12:15], s39 offen lds
    s_add_u32 m0, m0, 1024
    s_add_u32 s39, s39, s32
    buffer_load_dwordx4 v240, s[12:15], s39 offen lds
    s_mov_b32 m0, s19
    s_mov_b32 s39, s16
    s_mov_b32 s32, s17
    s_mov_b32 s3, s18
    s_waitcnt vmcnt(8)
    s_barrier
    buffer_load_dwordx4 v239, s[12:15], s39 offen lds
    s_add_u32 m0, m0, 1024
    s_add_u32 s39, s39, s32
    buffer_load_dwordx4 v240, s[12:15], s39 offen lds
    s_add_u32 m0, m0, 1024
    s_add_u32 s39, s39, s32
    buffer_load_dwordx4 v239, s[12:15], s39 offen lds
    s_add_u32 m0, m0, 1024
    s_add_u32 s39, s39, s32
    buffer_load_dwordx4 v240, s[12:15], s39 offen lds
    s_add_u32 m0, m0, 1024
    s_add_u32 s39, s39, s3
    buffer_load_dwordx4 v239, s[12:15], s39 offen lds
    s_add_u32 m0, m0, 1024
    s_add_u32 s39, s39, s32
    buffer_load_dwordx4 v240, s[12:15], s39 offen lds
    s_add_u32 m0, m0, 1024
    s_add_u32 s39, s39, s32
    buffer_load_dwordx4 v239, s[12:15], s39 offen lds
    s_add_u32 m0, m0, 1024
    s_add_u32 s39, s39, s32
    buffer_load_dwordx4 v240, s[12:15], s39 offen lds
    s_waitcnt vmcnt(8)
    s_barrier
    s_waitcnt vmcnt(0)
    s_barrier
    s_branch K_fin
NEXT:
    s_setprio 0
    s_add_u32 s60, s60, 1
    s_add_u32 s55, s55, 4194304
    s_add_u32 s62, s62, 4194304
    s_addc_u32 s63, s63, 0
    s_branch LAYER
K_fin:
    s_endpgm
SUB_w1_regs:
    s_mov_b64 s[12:13], s[68:69]
    s_mov_b32 s14, 2097152
    s_mov_b32 s15, 0x20000
    s_and_b32 s35, s30, 3
    s_mul_i32 s35, s35, 294912
    s_lshl_b32 s39, s99, 7
    s_add_u32 s39, s39, s35
    buffer_load_dwordx4 v[176:179], v238, s[12:15], s39 offen
    s_add_u32 s39, s39, 16384
    buffer_load_dwordx4 v[188:191], v238, s[12:15], s39 offen
    s_add_u32 s39, s39, 16384
    buffer_load_dwordx4 v[192:195], v238, s[12:15], s39 offen
    s_add_u32 s39, s39, 16384
    buffer_load_dwordx4 v[200:203], v238, s[12:15], s39 offen
    s_add_u32 s39, s39, 16384
    s_waitcnt vmcnt(8)
    buffer_load_dwordx4 v[204:207], v238, s[12:15], s39 offen
    s_add_u32 s39, s39, 16384
    buffer_load_dwordx4 v[208:211], v238, s[12:15], s39 offen
    s_add_u32 s39, s39, 16384
    buffer_load_dwordx4 v[212:215], v238, s[12:15], s39 offen
    s_add_u32 s39, s39, 16384
    buffer_load_dwordx4 v[216:219], v238, s[12:15], s39 offen
    s_add_u32 s39, s39, 16384
    s_waitcnt vmcnt(8)
    buffer_load_dwordx4 v[220:223], v238, s[12:15], s39 offen
    s_add_u32 s39, s39, 16384
    buffer_load_dwordx4 v[224:227], v238, s[12:15], s39 offen
    s_add_u32 s39, s39, 16384
    buffer_load_dwordx4 v[16:19], v238, s[12:15], s39 offen
    s_add_u32 s39, s39, 16384
    buffer_load_dwordx4 v[20:23], v238, s[12:15], s39 offen
    s_add_u32 s39, s39, 16384
    s_waitcnt vmcnt(8)
    buffer_load_dwordx4 v[24:27], v238, s[12:15], s39 offen
    s_add_u32 s39, s39, 16384
    buffer_load_dwordx4 v[28:31], v238, s[12:15], s39 offen
    s_add_u32 s39, s39, 16384
    buffer_load_dwordx4 v[32:35], v238, s[12:15], s39 offen
    s_add_u32 s39, s39, 16384
    buffer_load_dwordx4 v[36:39], v238, s[12:15], s39 offen
    s_add_u32 s39, s39, 16384
    s_waitcnt vmcnt(8)
    buffer_load_dwordx4 v[40:43], v238, s[12:15], s39 offen
    s_add_u32 s39, s39, 16384
    buffer_load_dwordx4 v[44:47], v238, s[12:15], s39 offen
    s_add_u32 s39, s39, 16384
    s_setpc_b64 s[76:77]
SUB_park:
    s_mov_b64 s[12:13], s[70:71]
    s_mov_b32 s14, 2097152
    s_mov_b32 s15, 0x20000
    s_and_b32 s35, s30, 3
    s_lshl_b32 s35, s35, 19
    s_lshl_b32 s39, s29, 7
    s_add_u32 s39, s39, s35
    buffer_load_dwordx4 v[48:51], v238, s[12:15], s39 offen
    s_add_u32 s39, s39, 16384
    buffer_load_dwordx4 v[52:55], v238, s[12:15], s39 offen
    s_add_u32 s39, s39, 16384
    buffer_load_dwordx4 v[56:59], v238, s[12:15], s39 offen
    s_add_u32 s39, s39, 16384
    buffer_load_dwordx4 v[60:63], v238, s[12:15], s39 offen
    s_add_u32 s39, s39, 16384
    s_waitcnt vmcnt(8)
    buffer_load_dwordx4 v[64:67], v238, s[12:15], s39 offen
    s_add_u32 s39, s39, 16384
    buffer_load_dwordx4 v[68:71], v238, s[12:15], s39 offen
    s_add_u32 s39, s39, 16384
    buffer_load_dwordx4 v[72:75], v238, s[12:15], s39 offen
    s_add_u32 s39, s39, 16384
    buffer_load_dwordx4 v[76:79], v238, s[12:15], s39 offen
    s_add_u32 s39, s39, 16384
    s_waitcnt vmcnt(8)
    buffer_load_dwordx4 v[80:83], v238, s[12:15], s39 offen
    s_add_u32 s39, s39, 16384
    buffer_load_dwordx4 v[84:87], v238, s[12:15], s39 offen
    s_add_u32 s39, s39, 16384
    buffer_load_dwordx4 v[88:91], v238, s[12:15], s39 offen
    s_add_u32 s39, s39, 16384
    buffer_load_dwordx4 v[92:95], v238, s[12:15], s39 offen
    s_add_u32 s39, s39, 16384
    s_waitcnt vmcnt(8)
    buffer_load_dwordx4 v[96:99], v238, s[12:15], s39 offen
    s_add_u32 s39, s39, 16384
    buffer_load_dwordx4 v[100:103], v238, s[12:15], s39 offen
    s_add_u32 s39, s39, 16384
    buffer_load_dwordx4 v[104:107], v238, s[12:15], s39 offen
    s_add_u32 s39, s39, 16384
    buffer_load_dwordx4 v[108:111], v238, s[12:15], s39 offen
    s_add_u32 s39, s39, 16384
    s_waitcnt vmcnt(8)
    buffer_load_dwordx4 v[112:115], v238, s[12:15], s39 offen
    s_add_u32 s39, s39, 16384
    buffer_load_dwordx4 v[116:119], v238, s[12:15], s39 offen
    s_add_u32 s39, s39, 16384
    buffer_load_dwordx4 v[120:123], v238, s[12:15], s39 offen
    s_add_u32 s39, s39, 16384
    buffer_load_dwordx4 v[124:127], v238, s[12:15], s39 offen
    s_add_u32 s39, s39, 16384
    s_waitcnt vmcnt(8)
    buffer_load_dwordx4 v[128:131], v238, s[12:15], s39 offen
    s_add_u32 s39, s39, 16384
    buffer_load_dwordx4 v[132:135], v238, s[12:15], s39 offen
    s_add_u32 s39, s39, 16384
    buffer_load_dwordx4 v[136:139], v238, s[12:15], s39 offen
    s_add_u32 s39, s39, 16384
    buffer_load_dwordx4 v[140:143], v238, s[12:15], s39 offen
    s_add_u32 s39, s39, 16384
    s_waitcnt vmcnt(8)
    s_setpc_b64 s[76:77]
SUB_park2:
    s_mov_b64 s[12:13], s[70:71]
    s_mov_b32 s14, 2097152
    s_mov_b32 s15, 0x20000
    s_and_b32 s35, s30, 3
    s_lshl_b32 s35, s35, 19
    s_lshl_b32 s39, s29, 7
    s_add_u32 s39, s39, s35
    s_add_u32 s39, s39, 393216
    buffer_load_dwordx4 v[144:147], v238, s[12:15], s39 offen
    s_add_u32 s39, s39, 16384
    buffer_load_dwordx4 v[148:151], v238, s[12:15], s39 offen
    s_add_u32 s39, s39, 16384
    buffer_load_dwordx4 v[152:155], v238, s[12:15], s39 offen
    s_add_u32 s39, s39, 16384
    buffer_load_dwordx4 v[156:159], v238, s[12:15], s39 offen
    s_add_u32 s39, s39, 16384
    s_waitcnt vmcnt(8)
    buffer_load_dwordx4 v[160:163], v238, s[12:15], s39 offen
    s_add_u32 s39, s39, 16384
    buffer_load_dwordx4 v[164:167], v238, s[12:15], s39 offen
    s_add_u32 s39, s39, 16384
    buffer_load_dwordx4 v[168:171], v238, s[12:15], s39 offen
    s_add_u32 s39, s39, 16384
    buffer_load_dwordx4 v[172:175], v238, s[12:15], s39 offen
    s_add_u32 s39, s39, 16384
    s_waitcnt vmcnt(8)
    s_setpc_b64 s[76:77]
SUB_w1_put:
    s_and_b32 s35, s30, 3
    s_mul_i32 s35, s35, 18432
    v_add_u32 v8, s35, v2
    v_mov_b32 v6, 162836
spin_78:
    s_sleep 2
    ds_read_b32 v7, v6
    s_waitcnt lgkmcnt(0)
    v_readfirstlane_b32 s53, v7
    s_nop 0
    s_cmp_ge_u32 s53, 8
    s_cbranch_scc0 spin_78
    s_waitcnt vmcnt(24)
    ds_write_b128 v8, v[176:179] offset:24576
    ds_write_b128 v8, v[188:191] offset:25600
    ds_write_b128 v8, v[192:195] offset:26624
    ds_write_b128 v8, v[200:203] offset:27648
    ds_write_b128 v8, v[204:207] offset:28672
    ds_write_b128 v8, v[208:211] offset:29696
    ds_write_b128 v8, v[212:215] offset:30720
    ds_write_b128 v8, v[216:219] offset:31744
    ds_write_b128 v8, v[220:223] offset:32768
    ds_write_b128 v8, v[224:227] offset:33792
    ds_write_b128 v8, v[16:19] offset:34816
    ds_write_b128 v8, v[20:23] offset:35840
    ds_write_b128 v8, v[24:27] offset:36864
    ds_write_b128 v8, v[28:31] offset:37888
    ds_write_b128 v8, v[32:35] offset:38912
    ds_write_b128 v8, v[36:39] offset:39936
    ds_write_b128 v8, v[40:43] offset:40960
    ds_write_b128 v8, v[44:47] offset:41984
    s_waitcnt lgkmcnt(0)
    s_setpc_b64 s[76:77]
SUB_after_g1:
    s_mov_b64 s[12:13], s[72:73]
    s_mov_b32 s14, 7340032
    s_mov_b32 s15, 0x20000
    v_readlane_b32 s36, v251, 0
    v_readlane_b32 s37, v251, 1
    v_readlane_b32 s34, v251, 2
    s_and_b32 s35, s30, 3
    s_mul_i32 s38, s35, 114688
    s_mul_i32 s39, s29, 448
    s_add_u32 s38, s38, s39
    s_and_b32 s36, s36, 15
    s_mul_i32 s36, s36, 458752
    s_add_u32 s36, s36, s38
    s_and_b32 s37, s37, 15
    s_mul_i32 s37, s37, 458752
    s_add_u32 s37, s37, s38
    s_and_b32 s34, s34, 15
    s_mul_i32 s34, s34, 458752
    s_add_u32 s34, s34, s38
    s_mul_i32 s39, s35, 7168
    s_add_u32 m0, s39, 131072
    s_nop 0
    buffer_load_dwordx4 v241, s[12:15], s36 offen lds
    s_add_u32 m0, m0, 1024
    s_nop 0
    buffer_load_dwordx4 v242, s[12:15], s36 offen lds
    s_add_u32 m0, m0, 1024
    s_nop 0
    buffer_load_dwordx4 v243, s[12:15], s36 offen lds
    s_add_u32 m0, m0, 1024
    s_nop 0
    buffer_load_dwordx4 v244, s[12:15], s36 offen lds
    s_add_u32 m0, m0, 1024
    s_nop 0
    buffer_load_dwordx4 v245, s[12:15], s36 offen lds
    s_add_u32 m0, m0, 1024
    s_nop 0
    buffer_load_dwordx4 v246, s[12:15], s36 offen lds
    s_add_u32 m0, m0, 1024
    s_nop 0
    buffer_load_dwordx4 v247, s[12:15], s36 offen lds
    buffer_load_dwordx4 v[176:179], v241, s[12:15], s37 offen
    buffer_load_dwordx4 v[180:183], v242, s[12:15], s37 offen
    buffer_load_dwordx4 v[184:187], v243, s[12:15], s37 offen
    buffer_load_dwordx4 v[188:191], v244, s[12:15], s37 offen
    buffer_load_dwordx4 v[192:195], v245, s[12:15], s37 offen
    buffer_load_dwordx4 v[196:199], v246, s[12:15], s37 offen
    buffer_load_dwordx4 v[200:203], v247, s[12:15], s37 offen
    s_lshr_b32 s36, s67, 2
    s_sub_u32 s36, s35, s36
    s_and_b32 s36, s36, 3
    s_lshl_b32 s36, s36, 15
    v_add_u32 v6, s36, v2
    s_waitcnt vmcnt(14)
    ds_write_b128 v6, v[48:51] offset:0
    ds_write_b128 v6, v[52:55] offset:1024
    ds_write_b128 v6, v[56:59] offset:2048
    ds_write_b128 v6, v[60:63] offset:3072
    ds_write_b128 v6, v[64:67] offset:4096
    ds_write_b128 v6, v[68:71] offset:5120
    ds_write_b128 v6, v[72:75] offset:6144
    ds_write_b128 v6, v[76:79] offset:7168
    ds_write_b128 v6, v[80:83] offset:8192
    ds_write_b128 v6, v[84:87] offset:9216
    ds_write_b128 v6, v[88:91] offset:10240
    ds_write_b128 v6, v[92:95] offset:11264
    ds_write_b128 v6, v[96:99] offset:12288
    ds_write_b128 v6, v[100:103] offset:13312
    ds_write_b128 v6, v[104:107] offset:14336
    ds_write_b128 v6, v[108:111] offset:15360
    ds_write_b128 v6, v[112:115] offset:16384
    ds_write_b128 v6, v[116:119] offset:17408
    ds_write_b128 v6, v[120:123] offset:18432
    ds_write_b128 v6, v[124:127] offset:19456
    ds_write_b128 v6, v[128:131] offset:20480
    ds_write_b128 v6, v[132:135] offset:21504
    ds_write_b128 v6, v[136:139] offset:22528
    ds_write_b128 v6, v[140:143] offset:23552
    ds_write_b128 v6, v[144:147] offset:24576
    ds_write_b128 v6, v[148:151] offset:25600
    ds_write_b128 v6, v[152:155] offset:26624
    ds_write_b128 v6, v[156:159] offset:27648
    ds_write_b128 v6, v[160:163] offset:28672
    ds_write_b128 v6, v[164:167] offset:29696
    ds_write_b128 v6, v[168:171] offset:30720
    ds_write_b128 v6, v[172:175] offset:31744
    s_waitcnt lgkmcnt(0)
    s_setpc_b64 s[76:77]
SUB_after_g2:
    s_and_b32 s35, s30, 3
    s_mul_i32 s39, s35, 7168
    s_add_u32 s39, s39, 73728
    v_add_u32 v7, s39, v2
    ds_write_b128 v7, v[176:179] offset:0
    ds_write_b128 v7, v[180:183] offset:1024
    ds_write_b128 v7, v[184:187] offset:2048
    ds_write_b128 v7, v[188:191] offset:3072
    ds_write_b128 v7, v[192:195] offset:4096
    ds_write_b128 v7, v[196:199] offset:5120
    ds_write_b128 v7, v[200:203] offset:6144
    s_waitcnt lgkmcnt(0)
    s_setpc_b64 s[76:77]
SUB_r_pre:
    v_and_b32 v199, 7, v0
    v_lshrrev_b32 v228, 6, v0
    v_lshlrev_b32 v228, 4, v228
    v_bfe_u32 v229, v0, 3, 3
    v_add_u32 v228, v228, v229
    s_lshr_b32 s78, s29, 1
    s_lshl_b32 s78, s78, 16
    s_and_b32 s79, s29, 1
    s_lshl_b32 s79, s79, 7
    s_add_u32 s78, s78, s79
    s_lshr_b32 s79, s30, 1
    s_lshl_b32 s79, s79, 13
    s_add_u32 s78, s78, s79
    v_lshlrev_b32 v196, 8, v228
    v_lshl_add_u32 v196, v199, 4, v196
    v_add_u32 v196, s78, v196
    s_mov_b32 s84, s62
    s_mov_b32 s85, s63
    s_mov_b32 s86, 0x7e000
    s_mov_b32 s87, 0x20000
    s_add_u32 s88, s62, 0x80000
    s_addc_u32 s89, s63, 0
    s_mov_b32 s90, 0x7e000
    s_mov_b32 s91, 0x20000
    buffer_load_dwordx4 v[180:183], v196, s[84:87], 0 offen offset:0 sc1
    buffer_load_dwordx4 v[188:191], v196, s[88:91], 0 offen offset:0 sc1
    buffer_load_dwordx4 v[184:187], v196, s[84:87], 0 offen offset:2048 sc1
    buffer_load_dwordx4 v[192:195], v196, s[88:91], 0 offen offset:2048 sc1
    s_setpc_b64 s[76:77]
SUB_r_pre0:
    v_and_b32 v199, 7, v0
    v_lshrrev_b32 v228, 6, v0
    v_lshlrev_b32 v228, 4, v228
    v_bfe_u32 v229, v0, 3, 3
    v_add_u32 v228, v228, v229
    s_lshr_b32 s78, s29, 1
    s_lshl_b32 s78, s78, 16
    s_and_b32 s79, s29, 1
    s_lshl_b32 s79, s79, 7
    s_add_u32 s78, s78, s79
    s_lshr_b32 s79, s30, 1
    s_lshl_b32 s79, s79, 13
    s_add_u32 s78, s78, s79
    v_lshlrev_b32 v196, 8, v228
    v_lshl_add_u32 v196, v199, 4, v196
    v_add_u32 v196, s78, v196
    s_mov_b32 s84, s62
    s_mov_b32 s85, s63
    s_mov_b32 s86, 0x7e000
    s_mov_b32 s87, 0x20000
    s_add_u32 s88, s62, 0x80000
    s_addc_u32 s89, s63, 0
    s_mov_b32 s90, 0x7e000
    s_mov_b32 s91, 0x20000
    s_cmp_eq_u32 s60, 0
    s_cselect_b64 exec, -1, 0
    buffer_load_dwordx4 v[180:183], v196, s[84:87], 0 offen offset:0 sc1
    buffer_load_dwordx4 v[188:191], v196, s[88:91], 0 offen offset:0 sc1
    buffer_load_dwordx4 v[184:187], v196, s[84:87], 0 offen offset:2048 sc1
    buffer_load_dwordx4 v[192:195], v196, s[88:91], 0 offen offset:2048 sc1
    s_mov_b64 exec, -1
    s_setpc_b64 s[76:77]
SUB_w_issue_1:
    s_add_u32 s19, s41, s42
    s_mul_i32 s16, s44, 131072
    s_add_u32 s16, s16, s38
    s_add_u32 s44, s44, 1
    s_and_b32 s44, s44, 15
    s_add_u32 s42, s42, 8192
    s_cmp_eq_u32 s42, 131072
    s_cselect_b32 s42, 0, s42
    s_mov_b32 m0, s19
    s_mov_b32 s39, s16
    buffer_load_dwordx4 v238, s[12:15], s39 offen lds
    s_add_u32 m0, m0, 1024
    s_add_u32 s39, s39, 16384
    buffer_load_dwordx4 v238, s[12:15], s39 offen lds
    s_add_u32 m0, m0, 1024
    s_add_u32 s39, s39, 16384
    buffer_load_dwordx4 v238, s[12:15], s39 offen lds
    s_add_u32 m0, m0, 1024
    s_add_u32 s39, s39, 16384
    buffer_load_dwordx4 v238, s[12:15], s39 offen lds
    s_setpc_b64 s[76:77]
PREP_a_issue_4:
    s_add_u32 s19, s41, s42
    v_readlane_b32 s16, v249, s44
    v_readlane_b32 s17, v250, s44
    s_add_u32 s16, s16, s38
    s_add_u32 s17, s17, s38
    s_add_u32 s44, s44, 1
    s_add_u32 s42, s42, 16384
    s_cmp_eq_u32 s42, 49152
    s_cselect_b32 s42, 0, s42
    s_setpc_b64 s[76:77]
PREP_w_issue_4:
    s_mov_b32 s45, 8192
    s_add_u32 s19, s41, s42
    v_readlane_b32 s16, v249, s44
    s_nop 0
    s_bitcmp1_b32 s16, 0
    s_cselect_b32 s17, 16384, s45
    s_cselect_b32 s18, -40960, s45
    s_andn2_b32 s16, s16, 1
    s_add_u32 s16, s16, s38
    s_add_u32 s44, s44, 1
    s_add_u32 s42, s42, 16384
    s_cmp_eq_u32 s42, 98304
    s_cselect_b32 s42, 0, s42
    s_setpc_b64 s[76:77]
K_end:
    s_endpgm
.p2align 6
K_tab:
.short 4096,5137,6178,11379,18660,25941,40502,33223,47784,55065,19706,12427,26988,34269,48830,41551,56096,9264,20736,10448,23824,25008,38384,35296,39568,49856,54128,52944,0,0,0,0
.short 4096,5137,6178,18659,11380,25941,33222,47783,40504,55065,12426,26987,19708,34269,41550,56111,48816,9264,10448,23824,20736,25008,35296,39568,38384,49856,52944,54128,0,0,0,0
.short 4096,5137,6178,11379,25940,18661,33222,40503,55064,47785,12426,19707,34268,26989,41550,48831,9264,56096,10448,20736,25008,23824,35296,38384,49856,39568,52944,54128,0,0,0,0
.short 4096,5137,6178,11379,18660,33221,25942,40503,47784,12425,55066,19707,26988,41549,34270,48831,56096,10448,9264,20736,23824,35296,25008,38384,39568,52944,49856,54128,0,0,0,0
.short 11377,12418,13459,18660,4101,25942,33223,47784,40505,55066,5147,26988,19709,34270,41551,56096,48816,6176,10288,23824,20736,25008,35296,39568,38384,49856,52944,54128,0,0,0,0
.short 11377,12418,13459,4100,25941,18662,33223,40504,55065,47786,5147,19708,34269,26990,41551,48816,6176,56096,10288,20736,25008,23824,35296,38384,49856,39568,52944,54128,0,0,0,0
.short 11377,12418,13459,4100,18661,33222,25943,40504,47785,5146,55067,19708,26989,41550,34271,48816,56096,10288,6176,20736,23824,35296,25008,38384,39568,52944,49856,54128,0,0,0,0
.short 11377,12418,13459,4100,18661,25942,40503,33224,47785,55066,19707,5148,26989,34270,48831,41536,56096,6176,20736,10288,23824,25008,38384,35296,39568,49856,54128,52944,0,0,0,0
.short 18658,19699,20740,4101,25942,11383,33224,40505,55066,47787,5148,12429,34270,26991,41536,48817,6176,56096,9264,10448,25008,23824,35296,38384,49856,39568,52944,54128,0,0,0,0
.short 18658,19699,20740,4101,11382,33223,25944,40505,47786,5147,55068,12429,26990,41551,34256,48817,56096,9264,6176,10448,23824,35296,25008,38384,39568,52944,49856,54128,0,0,0,0
.short 18658,19699,20740,4101,11382,25943,40504,33225,47786,55067,12428,5149,26990,34271,48816,41537,56096,6176,10448,9264,23824,25008,38384,35296,39568,49856,54128,52944,0,0,0,0
.short 18658,19699,20740,11381,4102,25943,33224,47785,40506,55067,5148,26989,12430,34271,41536,56097,48816,6176,9264,23824,10448,25008,35296,39568,38384,49856,52944,54128,0,0,0,0
.short 25939,26980,28021,4102,11383,33224,18665,40506,47787,5148,55069,12430,19711,41536,34257,48818,56096,9264,6176,10448,20736,35296,24848,38384,39568,52944,49856,54128,0,0,0,0
.short 25939,26980,28021,4102,11383,18664,40505,33226,47787,55068,12429,5150,19711,34256,48817,41538,56096,6176,10448,9264,20736,24848,38384,35296,39568,49856,54128,52944,0,0,0,0
.short 25939,26980,28021,11382,4103,18664,33225,47786,40507,55068,5149,19710,12431,34256,41537,56098,48816,6176,9264,20736,10448,24848,35296,39568,38384,49856,52944,54128,0,0,0,0
.short 25939,26980,28021,4102,18663,11384,33225,40506,55067,47788,5149,12430,34271,19696,41537,48818,6176,56096,9264,10448,24848,20736,35296,38384,49856,39568,52944,54128,0,0,0,0
.short 33220,34261,35302,4103,11384,18665,40506,25947,47788,55069,12430,5151,19696,26977,48818,41539,56096,6176,10448,9264,20736,23824,38384,25008,39568,49856,54128,52944,0,0,0,0
.short 33220,34261,35302,11383,4104,18665,25946,47787,40508,55069,5150,19711,12416,26977,41538,56099,48816,6176,9264,20736,10448,23824,25008,39568,38384,49856,52944,54128,0,0,0,0
.short 33220,34261,35302,4103,18664,11385,25946,40507,55068,47789,5150,12431,26976,19697,41538,48819,6176,56096,9264,10448,23824,20736,25008,38384,49856,39568,52944,54128,0,0,0,0
.short 33220,34261,35302,4103,11384,25945,18666,40507,47788,5149,55070,12431,19696,41537,26978,48819,56096,9264,6176,10448,20736,25008,23824,38384,39568,52944,49856,54128,0,0,0,0
.short 40501,41542,42583,11384,4105,18666,25947,47788,33229,55070,5151,19696,12417,26978,34259,56100,48816,6176,9264,20736,10448,23824,25008,39408,35296,49856,52944,54128,0,0,0,0
.short 40501,41542,42583,4104,18665,11386,25947,33228,55069,47790,5151,12416,26977,19698,34259,48820,6176,56096,9264,10448,23824,20736,25008,35296,49856,39408,52944,54128,0,0,0,0
.short 40501,41542,42583,4104,11385,25946,18667,33228,47789,5150,55071,12416,19697,34258,26979,48820,56096,9264,6176,10448,20736,25008,23824,35296,39408,52944,49856,54128,0,0,0,0
.short 40501,41542,42583,4104,11385,18666,33227,25948,47789,55070,12431,5136,19697,26978,48819,34260,56096,6176,10448,9264,20736,23824,35296,25008,39408,49856,54128,52944,0,0,0,0
.short 47782,48823,49864,4105,18666,11387,25948,33229,55070,40511,5136,12417,26978,19699,34260,41541,6176,56096,9264,10448,23824,20736,25008,35296,39568,38384,52944,54128,0,0,0,0
.short 47782,48823,49864,4105,11386,25947,18668,33229,40510,5151,55056,12417,19698,34259,26980,41541,56096,9264,6176,10448,20736,25008,23824,35296,38384,52944,39568,54128,0,0,0,0
.short 47782,48823,49864,4105,11386,18667,33228,25949,40510,55071,12416,5137,19698,26979,41540,34261,56096,6176,10448,9264,20736,23824,35296,25008,38384,39568,54128,52944,0,0,0,0
.short 47782,48823,49864,11385,4106,18667,25948,40509,33230,55071,5136,19697,12418,26979,34260,56101,41536,6176,9264,20736,10448,23824,25008,38384,35296,39568,52944,54128,0,0,0,0
.short 55063,56104,57145,4106,11387,25948,18669,33230,40511,5136,47777,12418,19699,34260,26981,41542,48816,9264,6176,10448,20736,25008,23824,35296,38384,49856,39568,53968,0,0,0,0
.short 55063,56104,57145,4106,11387,18668,33229,25950,40511,47776,12417,5138,19699,26980,41541,34262,48816,6176,10448,9264,20736,23824,35296,25008,38384,39568,53968,49856,0,0,0,0
.short 55063,56104,57145,11386,4107,18668,25949,40510,33231,47776,5137,19698,12419,26980,34261,48822,41536,6176,9264,20736,10448,23824,25008,38384,35296,39568,49856,53968,0,0,0,0
.short 55063,56104,57145,4106,18667,11388,25949,33230,47791,40496,5137,12418,26979,19700,34261,41542,6176,48816,9264,10448,23824,20736,25008,35296,39568,38384,49856,53968,0,0,0,0
.short 4104,5145,6186,11387,18668,25949,40510,33231,47776,55057,19698,12419,26980,34261,48822,41543,56096,9264,20736,10448,23824,25008,38384,35296,39568,49856,54128,52944,0,0,0,0
.short 4104,5145,6186,18667,11388,25949,33230,47791,40496,55057,12418,26979,19700,34261,41542,56103,48816,9264,10448,23824,20736,25008,35296,39568,38384,49856,52944,54128,0,0,0,0
.short 4104,5145,6186,11387,25948,18669,33230,40511,55056,47777,12418,19699,34260,26981,41542,48823,9264,56096,10448,20736,25008,23824,35296,38384,49856,39568,52944,54128,0,0,0,0
.short 4104,5145,6186,11387,18668,33229,25950,40511,47776,12417,55058,19699,26980,41541,34262,48823,56096,10448,9264,20736,23824,35296,25008,38384,39568,52944,49856,54128,0,0,0,0
.short 11385,12426,13467,18668,4109,25950,33231,47776,40497,55058,5139,26980,19701,34262,41543,56104,48816,6176,10288,23824,20736,25008,35296,39568,38384,49856,52944,54128,0,0,0,0
.short 11385,12426,13467,4108,25949,18670,33231,40496,55057,47778,5139,19700,34261,26982,41543,48824,6176,56096,10288,20736,25008,23824,35296,38384,49856,39568,52944,54128,0,0,0,0
.short 11385,12426,13467,4108,18669,33230,25951,40496,47777,5138,55059,19700,26981,41542,34263,48824,56096,10288,6176,20736,23824,35296,25008,38384,39568,52944,49856,54128,0,0,0,0
.short 11385,12426,13467,4108,18669,25950,40511,33216,47777,55058,19699,5140,26981,34262,48823,41544,56096,6176,20736,10288,23824,25008,38384,35296,39568,49856,54128,52944,0,0,0,0
.short 18666,19707,20748,4109,25950,11391,33216,40497,55058,47779,5140,12421,34262,26983,41544,48825,6176,56096,9264,10448,25008,23824,35296,38384,49856,39568,52944,54128,0,0,0,0
.short 18666,19707,20748,4109,11390,33231,25936,40497,47778,5139,55060,12421,26982,41543,34264,48825,56096,9264,6176,10448,23824,35296,25008,38384,39568,52944,49856,54128,0,0,0,0
.short 18666,19707,20748,4109,11390,25951,40496,33217,47778,55059,12420,5141,26982,34263,48824,41545,56096,6176,10448,9264,23824,25008,38384,35296,39568,49856,54128,52944,0,0,0,0
.short 18666,19707,20748,11389,4110,25951,33216,47777,40498,55059,5140,26981,12422,34263,41544,56105,48816,6176,9264,23824,10448,25008,35296,39568,38384,49856,52944,54128,0,0,0,0
.short 25947,26988,28029,4110,11391,33216,18657,40498,47779,5140,55061,12422,19703,41544,34265,48826,56096,9264,6176,10448,20736,35296,24848,38384,39568,52944,49856,54128,0,0,0,0
.short 25947,26988,28029,4110,11391,18656,40497,33218,47779,55060,12421,5142,19703,34264,48825,41546,56096,6176,10448,9264,20736,24848,38384,35296,39568,49856,54128,52944,0,0,0,0
.short 25947,26988,28029,11390,4111,18656,33217,47778,40499,55060,5141,19702,12423,34264,41545,56106,48816,6176,9264,20736,10448,24848,35296,39568,38384,49856,52944,54128,0,0,0,0
.short 25947,26988,28029,4110,18671,11376,33217,40498,55059,47780,5141,12422,34263,19704,41545,48826,6176,56096,9264,10448,24848,20736,35296,38384,49856,39568,52944,54128,0,0,0,0
.short 33228,34269,35310,4111,11376,18657,40498,25939,47780,55061,12422,5143,19704,26985,48826,41547,56096,6176,10448,9264,20736,23824,38384,25008,39568,49856,54128,52944,0,0,0,0
.short 33228,34269,35310,11391,4096,18657,25938,47779,40500,55061,5142,19703,12424,26985,41546,56107,48816,6176,9264,20736,10448,23824,25008,39568,38384,49856,52944,54128,0,0,0,0
.short 33228,34269,35310,4111,18656,11377,25938,40499,55060,47781,5142,12423,26984,19705,41546,48827,6176,56096,9264,10448,23824,20736,25008,38384,49856,39568,52944,54128,0,0,0,0
.short 33228,34269,35310,4111,11376,25937,18658,40499,47780,5141,55062,12423,19704,41545,26986,48827,56096,9264,6176,10448,20736,25008,23824,38384,39568,52944,49856,54128,0,0,0,0
.short 40509,41550,42591,11376,4097,18658,25939,47780,33221,55062,5143,19704,12425,26986,34267,56108,48816,6176,9264,20736,10448,23824,25008,39408,35296,49856,52944,54128,0,0,0,0
.short 40509,41550,42591,4096,18657,11378,25939,33220,55061,47782,5143,12424,26985,19706,34267,48828,6176,56096,9264,10448,23824,20736,25008,35296,49856,39408,52944,54128,0,0,0,0
.short 40509,41550,42591,4096,11377,25938,18659,33220,47781,5142,55063,12424,19705,34266,26987,48828,56096,9264,6176,10448,20736,25008,23824,35296,39408,52944,49856,54128,0,0,0,0
.short 40509,41550,42591,4096,11377,18658,33219,25940,47781,55062,12423,5144,19705,26986,48827,34268,56096,6176,10448,9264,20736,23824,35296,25008,39408,49856,54128,52944,0,0,0,0
.short 47790,48831,49856,4097,18658,11379,25940,33221,55062,40503,5144,12425,26986,19707,34268,41549,6176,56096,9264,10448,23824,20736,25008,35296,39568,38384,52944,54128,0,0,0,0
.short 47790,48831,49856,4097,11378,25939,18660,33221,40502,5143,55064,12425,19706,34267,26988,41549,56096,9264,6176,10448,20736,25008,23824,35296,38384,52944,39568,54128,0,0,0,0
.short 47790,48831,49856,4097,11378,18659,33220,25941,40502,55063,12424,5145,19706,26987,41548,34269,56096,6176,10448,9264,20736,23824,35296,25008,38384,39568,54128,52944,0,0,0,0
.short 47790,48831,49856,11377,4098,18659,25940,40501,33222,55063,5144,19705,12426,26987,34268,56109,41536,6176,9264,20736,10448,23824,25008,38384,35296,39568,52944,54128,0,0,0,0
.short 55071,56096,57137,4098,11379,25940,18661,33222,40503,5144,47785,12426,19707,34268,26989,41550,48816,9264,6176,10448,20736,25008,23824,35296,38384,49856,39568,53968,0,0,0,0
.short 55071,56096,57137,4098,11379,18660,33221,25942,40503,47784,12425,5146,19707,26988,41549,34270,48816,6176,10448,9264,20736,23824,35296,25008,38384,39568,53968,49856,0,0,0,0
.short 55071,56096,57137,11378,4099,18660,25941,40502,33223,47784,5145,19706,12427,26988,34269,48830,41536,6176,9264,20736,10448,23824,25008,38384,35296,39568,49856,53968,0,0,0,0
.short 55071,56096,57137,4098,18659,11380,25941,33222,47783,40504,5145,12426,26987,19708,34269,41550,6176,48816,9264,10448,23824,20736,25008,35296,39568,38384,49856,53968,0,0,0,0
.section .rodata,"a"
.p2align 6
.amdhsa_kernel interleave_layers__ssm_conv_h3__mixer_s_mlp__prompt_kernel
  .amdhsa_next_free_vgpr 256
  .amdhsa_next_free_sgpr 102
  .amdhsa_accum_offset 256
  .amdhsa_group_segment_fixed_size 0
  .amdhsa_kernarg_size 112
  .amdhsa_user_sgpr_count 2
  .amdhsa_user_sgpr_kernarg_segment_ptr 1
  .amdhsa_system_sgpr_workgroup_id_x 1
  .amdhsa_float_denorm_mode_32 3
.end_amdhsa_kernel
```

```asm
; @launch grid=(256,1,1) block=(512,1,1) lds=163840
.amdgcn_target "amdgcn-amd-amdhsa--gfx950"
.text
.globl interleave_layers__ssm_conv_h3__mixer_s_mlp__prompt_kernel
.p2align 8
.type interleave_layers__ssm_conv_h3__mixer_s_mlp__prompt_kernel,@function
interleave_layers__ssm_conv_h3__mixer_s_mlp__prompt_kernel:
    s_cmp_ge_u32 s2, 256
    s_cbranch_scc1 K_end
    s_load_dwordx8 s[8:15], s[0:1], 8
    s_load_dwordx2 s[6:7], s[0:1], 0
    s_load_dwordx8 s[68:75], s[0:1], 56
    s_load_dwordx2 s[4:5], s[0:1], 104
    s_load_dwordx2 s[84:85], s[0:1], 96
    s_memrealtime s[46:47]
    s_load_dwordx2 s[96:97], s[0:1], 40
    v_lshrrev_b32 v1, 6, v0
    s_nop 0
    v_readfirstlane_b32 s30, v1
    s_getpc_b64 s[48:49]
K_pc:
    s_lshr_b32 s36, s2, 3
    s_lshl_b32 s36, s36, 11
    v_lshlrev_b32 v4, 2, v0
    v_add_u32 v4, s36, v4
    v_cmp_gt_u32 vcc, K_end-K_pc-8, v4
    s_nop 0
    s_and_saveexec_b64 s[36:37], vcc
    s_cbranch_execz K_3
    v_mov_b32 v5, s49
    v_add_co_u32 v4, vcc, s48, v4
    s_nop 1
    v_addc_co_u32 v5, vcc, 0, v5, vcc
    global_load_dword v250, v[4:5], off
K_3:
    s_mov_b64 exec, -1
    v_and_b32 v6, 31, v0
    v_lshrrev_b32 v7, 5, v0
    s_and_b32 s34, s2, 7
    s_lshr_b32 s35, s2, 3
    s_lshl_b32 s36, s35, 17
    s_lshl_b32 s37, s34, 8
    s_add_u32 s36, s36, s37
    v_lshlrev_b32 v8, 13, v7
    v_lshl_add_u32 v8, v6, 3, v8
    v_add_u32 v12, s36, v8
    v_add_u32 v14, 4096, v12
    s_mov_b32 s18, 4194304
    s_mov_b32 s19, 0x20000
    s_mov_b32 s22, s18
    s_mov_b32 s23, s19
    s_waitcnt lgkmcnt(0)
    s_mov_b32 s86, 256
    s_mov_b32 s87, 0x20000
    v_mov_b32 v78, 0
    s_lshl_b32 s45, s2, 3
    s_add_u32 s45, s45, s30
    s_cmp_lg_u32 s45, 4
    s_cbranch_scc1 KV_t0
    s_getreg_b32 s45, hwreg(HW_REG_XCC_ID, 0, 3)
    s_lshl_b32 s45, s45, 1
    s_lshl_b32 s44, s46, 6
    s_or_b32 s44, s44, s45
    s_or_b32 s44, s44, 1
    v_mov_b32 v76, s44
    v_mov_b32 v77, 0
    s_mov_b64 exec, 1
    buffer_store_dwordx2 v[76:77], v78, s[84:87], 0 offen sc1
    s_mov_b64 exec, -1
KV_t0:
    s_mov_b64 s[16:17], s[8:9]
    s_mov_b64 s[20:21], s[10:11]
    buffer_load_dwordx2 v[28:29], v12, s[16:19], 0 offen offset:0 nt
    buffer_load_dwordx2 v[30:31], v12, s[16:19], 0 offen offset:2048 nt
    buffer_load_dwordx2 v[32:33], v14, s[16:19], 0 offen offset:0 nt
    buffer_load_dwordx2 v[34:35], v14, s[16:19], 0 offen offset:2048 nt
    buffer_load_dwordx2 v[36:37], v12, s[20:23], 0 offen offset:0 nt
    buffer_load_dwordx2 v[38:39], v12, s[20:23], 0 offen offset:2048 nt
    buffer_load_dwordx2 v[40:41], v14, s[20:23], 0 offen offset:0 nt
    buffer_load_dwordx2 v[42:43], v14, s[20:23], 0 offen offset:2048 nt
    v_subrev_u32 v9, 6144, v12
    v_subrev_u32 v10, 4096, v12
    v_subrev_u32 v11, 2048, v12
    s_lshl_b32 s37, s34, 10
    v_lshlrev_b32 v16, 5, v6
    v_add_u32 v16, s37, v16
    s_mov_b32 s24, s12
    s_mov_b32 s25, s13
    s_mov_b32 s26, 0x2000
    s_mov_b32 s27, 0x20000
    v_and_b32 v8, 1, v7
    v_lshl_add_u32 v16, v8, 4, v16
    buffer_load_dwordx4 v[44:47], v16, s[24:27], 0 offen
    s_cmp_lg_u32 s30, 4
    s_cbranch_scc1 KV_t2
    buffer_load_dword v76, v78, s[84:87], 0 offen sc1
KV_t2:
    s_bfm_b64 exec, 32, 0
    buffer_load_dwordx2 v[22:23], v9, s[16:19], 0 offen nt
    buffer_load_dwordx2 v[24:25], v10, s[16:19], 0 offen nt
    buffer_load_dwordx2 v[26:27], v11, s[16:19], 0 offen nt
    s_mov_b64 exec, -1
    v_and_b32 v1, 63, v0
    v_lshlrev_b32 v2, 4, v1
    v_lshlrev_b32 v3, 2, v1
    s_mov_b32 s67, 0
    s_mov_b32 s60, 0
    s_mov_b32 s61, 40000
    s_mov_b32 s52, 0
    s_mov_b32 s55, 0
    s_mov_b32 s92, 0
    s_mov_b32 s93, 0
    s_mov_b32 s94, 0
    s_mov_b32 s56, s4
    s_mov_b32 s57, s5
    s_mov_b32 s58, 0xa000000
    s_mov_b32 s59, 0x20000
    s_add_u32 s62, s4, 33554432
    s_addc_u32 s63, s5, 0
    s_and_b32 s41, s30, 3
    s_and_b32 s38, s2, 7
    s_lshl_b32 s38, s38, 5
    s_lshr_b32 s39, s2, 3
    s_add_u32 s38, s38, s39
    s_lshl_b32 s39, s38, 2
    s_add_u32 s39, s39, s41
    s_mul_i32 s40, s41, 24576
    s_lshr_b32 s36, s39, 1
    s_lshl_b32 s36, s36, 2
    s_load_dword s98, s[96:97], s36
    s_lshl_b32 s36, s39, 12
    s_add_u32 s12, s14, s36
    s_addc_u32 s13, s15, 0
    s_mov_b32 s14, 4096
    s_mov_b32 s15, 0x20000
    s_lshr_b32 s45, s30, 2
    s_lshl_b32 s45, s45, 11
    s_add_u32 s36, s45, 0xffffffc0
    v_add_u32 v70, s36, v2
    v_add_u32 v71, 16, v70
    s_add_u32 s36, s45, 0x3c0
    v_add_u32 v72, s36, v2
    v_add_u32 v73, 16, v72
    s_mov_b32 s36, 4032
    v_add_u32 v74, s36, v2
    v_add_u32 v75, 16, v74
    s_and_b32 s34, s2, 7
    s_lshr_b32 s35, s2, 3
    v_mov_b32 v80, 0
    v_mov_b32 v81, 0
    v_mov_b32 v82, 0
    v_mov_b32 v83, 0
    v_add_u32 v86, s40, v2
    ds_write_b128 v86, v[80:83] offset:22784
    s_bfm_b64 exec, 26, 0
    ds_write_b128 v86, v[80:83] offset:23808
    s_mov_b64 exec, -1
    v_lshlrev_b32 v8, 2, v7
    v_sub_u32 v8, 60, v8
    v_lshrrev_b32 v85, 3, v8
    v_bfe_u32 v84, v6, 1, 3
    v_xor_b32 v85, v85, v84
    v_lshlrev_b32 v85, 4, v85
    v_and_b32 v8, 7, v8
    v_lshl_add_u32 v85, v8, 1, v85
    v_lshl_add_u32 v84, v6, 9, v85
    v_add_u32 v84, 98304, v84
    s_waitcnt vmcnt(0)
    s_cmp_lg_u32 s30, 4
    s_cbranch_scc1 KV_t1
KV_t1:
    buffer_load_dwordx4 v[52:55], v70, s[12:15], 0 offen nt
    buffer_load_dwordx2 v[56:57], v71, s[12:15], 0 offen nt
    buffer_load_dwordx4 v[58:61], v72, s[12:15], 0 offen nt
    buffer_load_dwordx2 v[62:63], v73, s[12:15], 0 offen nt
    buffer_load_dwordx4 v[64:67], v74, s[12:15], 0 offen nt
    buffer_load_dwordx2 v[68:69], v75, s[12:15], 0 offen nt
    v_mov_b32 v48, v44
    v_mov_b32 v49, v45
    v_mov_b32 v50, v46
    v_mov_b32 v51, v47
    v_mov_b32 v126, v30
    v_mov_b32 v127, v31
    v_mov_b32 v128, v32
    v_mov_b32 v129, v33
    v_mov_b32 v130, v34
    v_mov_b32 v131, v35
    v_permlane32_swap_b32 v44, v48
    v_permlane32_swap_b32 v45, v49
    v_permlane32_swap_b32 v46, v50
    v_permlane32_swap_b32 v47, v51
    v_permlane32_swap_b32 v22, v126
    v_permlane32_swap_b32 v23, v127
    v_permlane32_swap_b32 v24, v128
    v_permlane32_swap_b32 v25, v129
    v_permlane32_swap_b32 v26, v130
    v_permlane32_swap_b32 v27, v131
    v_lshlrev_b32 v88, 16, v44
    v_and_b32 v90, 0xffff0000, v44
    v_lshlrev_b32 v92, 16, v45
    v_and_b32 v94, 0xffff0000, v45
    v_lshlrev_b32 v89, 16, v46
    v_and_b32 v91, 0xffff0000, v46
    v_lshlrev_b32 v93, 16, v47
    v_and_b32 v95, 0xffff0000, v47
    v_lshlrev_b32 v96, 16, v22
    v_and_b32 v97, 0xffff0000, v22
    v_lshlrev_b32 v98, 16, v24
    v_and_b32 v99, 0xffff0000, v24
    v_lshlrev_b32 v100, 16, v26
    v_and_b32 v101, 0xffff0000, v26
    v_lshlrev_b32 v102, 16, v28
    v_and_b32 v103, 0xffff0000, v28
    v_lshlrev_b32 v104, 16, v30
    v_and_b32 v105, 0xffff0000, v30
    v_lshlrev_b32 v106, 16, v32
    v_and_b32 v107, 0xffff0000, v32
    v_lshlrev_b32 v108, 16, v34
    v_and_b32 v109, 0xffff0000, v34
    v_lshlrev_b32 v110, 16, v36
    v_and_b32 v111, 0xffff0000, v36
    v_lshlrev_b32 v112, 16, v38
    v_and_b32 v113, 0xffff0000, v38
    v_lshlrev_b32 v114, 16, v40
    v_and_b32 v115, 0xffff0000, v40
    v_lshlrev_b32 v116, 16, v42
    v_and_b32 v117, 0xffff0000, v42
    v_pk_mul_f32 v[118:119], v[96:97], v[94:95]
    v_pk_mul_f32 v[120:121], v[98:99], v[94:95]
    v_pk_mul_f32 v[122:123], v[100:101], v[94:95]
    v_pk_mul_f32 v[124:125], v[102:103], v[94:95]
    v_pk_fma_f32 v[118:119], v[98:99], v[92:93], v[118:119]
    v_pk_fma_f32 v[120:121], v[100:101], v[92:93], v[120:121]
    v_pk_fma_f32 v[122:123], v[102:103], v[92:93], v[122:123]
    v_pk_fma_f32 v[124:125], v[104:105], v[92:93], v[124:125]
    v_pk_fma_f32 v[118:119], v[100:101], v[90:91], v[118:119]
    v_pk_fma_f32 v[120:121], v[102:103], v[90:91], v[120:121]
    v_pk_fma_f32 v[122:123], v[104:105], v[90:91], v[122:123]
    v_pk_fma_f32 v[124:125], v[106:107], v[90:91], v[124:125]
    v_pk_fma_f32 v[118:119], v[102:103], v[88:89], v[118:119]
    v_pk_fma_f32 v[120:121], v[104:105], v[88:89], v[120:121]
    v_pk_fma_f32 v[122:123], v[106:107], v[88:89], v[122:123]
    v_pk_fma_f32 v[124:125], v[108:109], v[88:89], v[124:125]
    v_pk_mul_f32 v[118:119], v[118:119], v[110:111]
    v_pk_mul_f32 v[120:121], v[120:121], v[112:113]
    v_pk_mul_f32 v[122:123], v[122:123], v[114:115]
    v_pk_mul_f32 v[124:125], v[124:125], v[116:117]
    v_cvt_pk_bf16_f32 v136, v124, v122
    v_cvt_pk_bf16_f32 v137, v120, v118
    ds_write_b64 v84, v[136:137] offset:0
    v_cvt_pk_bf16_f32 v138, v125, v123
    v_cvt_pk_bf16_f32 v139, v121, v119
    ds_write_b64 v84, v[138:139] offset:128
    v_lshlrev_b32 v88, 16, v48
    v_and_b32 v90, 0xffff0000, v48
    v_lshlrev_b32 v92, 16, v49
    v_and_b32 v94, 0xffff0000, v49
    v_lshlrev_b32 v89, 16, v50
    v_and_b32 v91, 0xffff0000, v50
    v_lshlrev_b32 v93, 16, v51
    v_and_b32 v95, 0xffff0000, v51
    v_lshlrev_b32 v96, 16, v23
    v_and_b32 v97, 0xffff0000, v23
    v_lshlrev_b32 v98, 16, v25
    v_and_b32 v99, 0xffff0000, v25
    v_lshlrev_b32 v100, 16, v27
    v_and_b32 v101, 0xffff0000, v27
    v_lshlrev_b32 v102, 16, v29
    v_and_b32 v103, 0xffff0000, v29
    v_lshlrev_b32 v104, 16, v31
    v_and_b32 v105, 0xffff0000, v31
    v_lshlrev_b32 v106, 16, v33
    v_and_b32 v107, 0xffff0000, v33
    v_lshlrev_b32 v108, 16, v35
    v_and_b32 v109, 0xffff0000, v35
    v_lshlrev_b32 v110, 16, v37
    v_and_b32 v111, 0xffff0000, v37
    v_lshlrev_b32 v112, 16, v39
    v_and_b32 v113, 0xffff0000, v39
    v_lshlrev_b32 v114, 16, v41
    v_and_b32 v115, 0xffff0000, v41
    v_lshlrev_b32 v116, 16, v43
    v_and_b32 v117, 0xffff0000, v43
    v_pk_mul_f32 v[118:119], v[96:97], v[94:95]
    v_pk_mul_f32 v[120:121], v[98:99], v[94:95]
    v_pk_mul_f32 v[122:123], v[100:101], v[94:95]
    v_pk_mul_f32 v[124:125], v[102:103], v[94:95]
    v_pk_fma_f32 v[118:119], v[98:99], v[92:93], v[118:119]
    v_pk_fma_f32 v[120:121], v[100:101], v[92:93], v[120:121]
    v_pk_fma_f32 v[122:123], v[102:103], v[92:93], v[122:123]
    v_pk_fma_f32 v[124:125], v[104:105], v[92:93], v[124:125]
    v_pk_fma_f32 v[118:119], v[100:101], v[90:91], v[118:119]
    v_pk_fma_f32 v[120:121], v[102:103], v[90:91], v[120:121]
    v_pk_fma_f32 v[122:123], v[104:105], v[90:91], v[122:123]
    v_pk_fma_f32 v[124:125], v[106:107], v[90:91], v[124:125]
    v_pk_fma_f32 v[118:119], v[102:103], v[88:89], v[118:119]
    v_pk_fma_f32 v[120:121], v[104:105], v[88:89], v[120:121]
    v_pk_fma_f32 v[122:123], v[106:107], v[88:89], v[122:123]
    v_pk_fma_f32 v[124:125], v[108:109], v[88:89], v[124:125]
    v_pk_mul_f32 v[118:119], v[118:119], v[110:111]
    v_pk_mul_f32 v[120:121], v[120:121], v[112:113]
    v_pk_mul_f32 v[122:123], v[122:123], v[114:115]
    v_pk_mul_f32 v[124:125], v[124:125], v[116:117]
    v_cvt_pk_bf16_f32 v140, v124, v122
    v_cvt_pk_bf16_f32 v141, v120, v118
    ds_write_b64 v84, v[140:141] offset:256
    v_cvt_pk_bf16_f32 v142, v125, v123
    v_cvt_pk_bf16_f32 v143, v121, v119
    ds_write_b64 v84, v[142:143] offset:384
    s_cmp_lg_u32 s30, 4
    s_cbranch_scc1 HB_2
    v_add_u32 v18, 162816, v3
    ds_write_b32 v18, v78
    s_mov_b32 s53, 0
    s_waitcnt vmcnt(6)
HB_p:
    v_readfirstlane_b32 s52, v76
    s_nop 0
    s_cmp_eq_u32 s52, 0
    s_cbranch_scc1 HB_r
    s_cmp_ge_u32 s53, 60
    s_cbranch_scc1 HB_q
    s_add_u32 s54, s46, 8192
    s_lshl_b32 s54, s54, 6
    s_sub_u32 s54, s54, s52
    s_cmp_lt_u32 s54, 786432
    s_cbranch_scc1 HB_q
HB_r:
    buffer_load_dword v76, v78, s[84:87], 0 offen sc1
    s_waitcnt vmcnt(0)
    s_add_u32 s53, s53, 1
    s_cmp_lt_u32 s53, s61
    s_cbranch_scc1 HB_p
    s_mov_b32 s52, 1
    s_mov_b32 s61, 0
HB_q:
    v_mov_b32 v18, 162828
    v_mov_b32 v19, s52
    s_waitcnt lgkmcnt(0)
    ds_write_b32 v18, v19
HB_2:
    s_add_u32 s16, s4, 0x2000000
    s_addc_u32 s17, s5, 0
    s_mov_b32 s18, 0x8000000
    s_mov_b32 s19, 0x20000
    v_lshrrev_b32 v8, 3, v0
    v_and_b32 v85, 7, v0
    v_lshlrev_b32 v149, 12, v8
    v_lshl_add_u32 v149, v85, 4, v149
    s_lshl_b32 s36, s34, 24
    s_sub_u32 s37, 31, s35
    s_lshl_b32 s37, s37, 7
    s_add_u32 s36, s36, s37
    s_add_u32 s37, s36, 262144
    v_lshrrev_b32 v148, 3, v8
    v_xor_b32 v148, v148, v85
    v_lshlrev_b32 v148, 4, v148
    v_lshl_add_u32 v148, v8, 7, v148
    v_add_u32 v148, 98304, v148
    v_mov_b32 v18, 162828
    s_waitcnt lgkmcnt(0)
    s_barrier
    ds_read_b128 v[152:155], v148 offset:0
    ds_read_b128 v[156:159], v148 offset:8192
    ds_read_b32 v19, v18
    s_waitcnt lgkmcnt(2)
    v_or_b32 v152, 1, v152
    buffer_store_dwordx4 v[152:155], v149, s[16:19], s36 offen sc1
    s_waitcnt lgkmcnt(1)
    v_or_b32 v156, 1, v156
    buffer_store_dwordx4 v[156:159], v149, s[16:19], s37 offen sc1
    s_waitcnt lgkmcnt(0)
    v_readfirstlane_b32 s52, v19
    s_cmp_lg_u32 s30, 0
    s_cbranch_scc1 KV_ni
    s_cmp_ge_u32 s35, 16
    s_cbranch_scc1 KV_ni
    v_mov_b32 v8, s52
    s_lshl_b32 s37, s34, 7
    s_lshl_b32 s53, s35, 10
    s_add_u32 s37, s37, s53
    s_add_u32 s37, s37, 23101440
    s_mov_b64 exec, 1
    buffer_store_dword v8, v78, s[56:59], s37 offen sc1
    s_mov_b64 exec, -1
KV_ni:
    s_cmp_ge_u32 s2, 32
    s_cbranch_scc1 KV_n3
    s_cmp_lg_u32 s30, 5
    s_cbranch_scc1 KV_n3
    s_and_b32 s42, s2, 7
    s_lshl_b32 s42, s42, 10
    s_lshr_b32 s43, s2, 3
    s_lshl_b32 s43, s43, 14
    s_add_u32 s42, s42, s43
    s_add_u32 s42, s42, 39714816
    v_lshrrev_b32 v8, 5, v1
    v_mul_u32_u24 v8, 7680, v8
    v_add_u32 v8, v8, v2
    buffer_store_dwordx4 v[80:83], v8, s[56:59], s42 offen sc1
KV_n3:
    s_bfe_u32 s32, s52, 0x30001
    s_add_u32 s32, s32, s2
    s_and_b32 s32, s32, 7
    s_lshr_b32 s33, s2, 3
    s_and_b32 s28, s32, 2
    s_lshr_b32 s53, s32, 2
    s_or_b32 s28, s28, s53
    s_lshl_b32 s28, s28, 2
    s_and_b32 s53, s33, 3
    s_add_u32 s28, s28, s53
    s_and_b32 s31, s32, 1
    s_lshr_b32 s33, s33, 2
    s_lshl_b32 s29, s31, 3
    s_add_u32 s29, s29, s33
    s_xor_b32 s99, s29, 1
    v_and_b32 v199, 7, v0
    v_lshrrev_b32 v228, 6, v0
    v_lshlrev_b32 v228, 4, v228
    v_bfe_u32 v229, v0, 3, 3
    v_add_u32 v228, v228, v229
    s_lshr_b32 s78, s29, 1
    s_lshl_b32 s78, s78, 16
    s_and_b32 s79, s29, 1
    s_lshl_b32 s79, s79, 7
    s_add_u32 s78, s78, s79
    s_lshr_b32 s79, s30, 1
    s_lshl_b32 s79, s79, 13
    s_add_u32 s78, s78, s79
    v_lshlrev_b32 v196, 8, v228
    v_lshl_add_u32 v196, v199, 4, v196
    v_add_u32 v196, s78, v196
    s_lshl_b32 s78, s28, 7
    s_lshl_b32 s79, s29, 3
    s_add_u32 s78, s78, s79
    v_add_u32 v197, s78, v199
    v_lshlrev_b32 v198, 11, v197
    v_lshrrev_b32 v229, 2, v228
    v_lshlrev_b32 v229, 3, v229
    v_and_b32 v228, 3, v228
    v_add_u32 v228, v228, v229
    v_lshl_add_u32 v198, v228, 3, v198
    v_and_b32 v197, 15, v197
    v_lshlrev_b32 v197, 4, v197
    v_and_b32 v229, 15, v228
    v_lshl_add_u32 v197, v229, 9, v197
    v_lshrrev_b32 v229, 4, v228
    v_lshl_add_u32 v197, v229, 14, v197
    s_lshr_b32 s78, s28, 3
    s_lshl_b32 s78, s78, 2
    s_and_b32 s79, s28, 3
    s_add_u32 s78, s78, s79
    s_lshl_b32 s78, s78, 24
    s_and_b32 s79, s28, 4
    s_lshl_b32 s79, s79, 11
    s_add_u32 s78, s78, s79
    s_and_b32 s79, s29, 4
    s_lshl_b32 s79, s79, 6
    s_add_u32 s78, s78, s79
    s_and_b32 s79, s29, 2
    s_lshl_b32 s79, s79, 2
    s_add_u32 s78, s78, s79
    s_lshl_b32 s79, s31, 18
    s_add_u32 s78, s78, s79
    v_add_u32 v197, s78, v197
    s_lshl_b32 s36, s34, 5
    s_add_u32 s36, s36, s35
    s_lshl_b32 s36, s36, 7
    s_add_u32 s36, s36, 23068672
    v_mov_b32 v18, 1
    v_mov_b32 v19, 162820
    v_mov_b32 v21, 0
    s_mov_b64 exec, 1
    s_waitcnt vmcnt(0)
    ds_add_rtn_u32 v20, v19, v18
    v_mov_b32 v19, s52
    s_waitcnt lgkmcnt(0)
    v_readfirstlane_b32 s54, v20
    s_nop 0
    s_and_b32 s54, s54, 7
    s_cmp_lg_u32 s54, 7
    s_cbranch_scc1 pub_1
    buffer_store_dword v19, v21, s[56:59], s36 offen sc1
pub_1:
    s_mov_b64 exec, -1
    s_mov_b32 s8, s6
    s_mov_b32 s9, s7
    s_mov_b32 s10, 0x400000
    s_mov_b32 s11, 0x20000
    buffer_load_dwordx2 v[180:181], v198, s[8:11], 0 offen offset:0 nt
    buffer_load_dwordx2 v[182:183], v198, s[8:11], 0 offen offset:32 nt
    buffer_load_dwordx2 v[184:185], v198, s[8:11], 0 offen offset:128 nt
    buffer_load_dwordx2 v[186:187], v198, s[8:11], 0 offen offset:160 nt
    v_add_u32 v160, s45, v86
    v_alignbit_b32 v88, v53, v52, 16
    v_mov_b32 v92, v53
    v_alignbit_b32 v96, v54, v53, 16
    v_alignbit_b32 v89, v54, v53, 16
    v_mov_b32 v93, v54
    v_alignbit_b32 v97, v55, v54, 16
    v_alignbit_b32 v90, v55, v54, 16
    v_mov_b32 v94, v55
    v_alignbit_b32 v98, v56, v55, 16
    v_alignbit_b32 v91, v56, v55, 16
    v_mov_b32 v95, v56
    v_alignbit_b32 v99, v57, v56, 16
    ds_write_b128 v160, v[88:91] offset:0
    ds_write_b128 v160, v[92:95] offset:4160
    ds_write_b128 v160, v[96:99] offset:8320
    ds_write_b128 v160, v[54:57] offset:12480
    v_alignbit_b32 v100, v59, v58, 16
    v_mov_b32 v104, v59
    v_alignbit_b32 v108, v60, v59, 16
    v_alignbit_b32 v101, v60, v59, 16
    v_mov_b32 v105, v60
    v_alignbit_b32 v109, v61, v60, 16
    v_alignbit_b32 v102, v61, v60, 16
    v_mov_b32 v106, v61
    v_alignbit_b32 v110, v62, v61, 16
    v_alignbit_b32 v103, v62, v61, 16
    v_mov_b32 v107, v62
    v_alignbit_b32 v111, v63, v62, 16
    ds_write_b128 v160, v[100:103] offset:1024
    ds_write_b128 v160, v[104:107] offset:5184
    ds_write_b128 v160, v[108:111] offset:9344
    ds_write_b128 v160, v[60:63] offset:13504
    v_alignbit_b32 v112, v65, v64, 16
    v_mov_b32 v116, v65
    v_alignbit_b32 v120, v66, v65, 16
    v_alignbit_b32 v113, v66, v65, 16
    v_mov_b32 v117, v66
    v_alignbit_b32 v121, v67, v66, 16
    v_alignbit_b32 v114, v67, v66, 16
    v_mov_b32 v118, v67
    v_alignbit_b32 v122, v68, v67, 16
    v_alignbit_b32 v115, v68, v67, 16
    v_mov_b32 v119, v68
    v_alignbit_b32 v123, v69, v68, 16
    s_mov_b64 exec, 0xf
    ds_write_b128 v86, v[112:115] offset:4096
    ds_write_b128 v86, v[116:119] offset:8256
    ds_write_b128 v86, v[120:123] offset:12416
    ds_write_b128 v86, v[66:69] offset:16576
    s_mov_b64 exec, -1
    s_waitcnt lgkmcnt(0)
    s_barrier
    v_mov_b32 v238, 0
    v_mov_b32 v239, 0
    v_mov_b32 v240, 0
    v_mov_b32 v241, 0
    v_mov_b32 v242, 0
    v_mov_b32 v243, 0
    v_mov_b32 v244, 0
    v_mov_b32 v245, 0
    v_mov_b32 v246, 0
    v_mov_b32 v247, 0
    s_cmp_ge_u32 s30, 4
    s_cbranch_scc1 FR_b
    s_and_b32 s38, s2, 7
    s_lshl_b32 s38, s38, 5
    s_lshr_b32 s39, s2, 3
    s_add_u32 s38, s38, s39
    s_lshl_b32 s39, s38, 2
    s_add_u32 s39, s39, s30
    s_mul_i32 s40, s30, 24576
    s_and_b32 s36, s39, 127
    s_lshl_b32 s36, s36, 12
    s_lshr_b32 s37, s39, 7
    s_lshl_b32 s37, s37, 24
    s_add_u32 s36, s36, s37
    s_add_u32 s36, s36, 33554432
    s_add_u32 s16, s4, s36
    s_addc_u32 s17, s5, 0
    s_mov_b32 s18, 4096
    s_mov_b32 s19, 0x20000
    v_lshrrev_b32 v6, 2, v1
    v_mul_u32_u24 v12, 96, v6
    v_and_b32 v6, 3, v1
    v_lshl_add_u32 v12, v6, 4, v12
    v_add_u32 v12, s40, v12
    v_and_b32 v35, 15, v1
    v_lshrrev_b32 v36, 4, v1
    v_and_b32 v6, 3, v35
    v_mul_u32_u24 v32, 4160, v6
    v_lshl_add_u32 v32, v36, 4, v32
    v_lshrrev_b32 v6, 2, v35
    v_lshl_add_u32 v32, v6, 3, v32
    v_add_u32 v32, s40, v32
    v_sub_u32 v6, 15, v35
    v_mul_u32_u24 v34, 96, v6
    v_add_u32 v34, s40, v34
    v_lshl_add_u32 v33, v36, 4, v34
    ds_read_b64 v[72:73], v32 offset:0
    ds_read_b64 v[74:75], v32 offset:8
    ds_read_b64 v[76:77], v32 offset:32
    ds_read_b64 v[78:79], v32 offset:40
    ds_read_b64 v[80:81], v32 offset:1024
    ds_read_b64 v[82:83], v32 offset:1032
    ds_read_b64 v[84:85], v32 offset:1056
    ds_read_b64 v[86:87], v32 offset:1064
    ds_read_b64 v[88:89], v32 offset:2048
    ds_read_b64 v[90:91], v32 offset:2056
    ds_read_b64 v[92:93], v32 offset:2080
    ds_read_b64 v[94:95], v32 offset:2088
    ds_read_b64 v[96:97], v32 offset:3072
    ds_read_b64 v[98:99], v32 offset:3080
    ds_read_b64 v[100:101], v32 offset:3104
    ds_read_b64 v[102:103], v32 offset:3112
    s_bitcmp1_b32 s39, 0
    s_cselect_b32 s36, 0, 16
    s_lshl_b32 s41, s98, s36
    s_and_b32 s41, s41, 0xffff0000
    s_lshr_b32 s36, s41, 16
    v_lshl_add_u32 v6, v36, 3, v35
    v_sub_u32 v6, 31, v6
    v_mov_b32 v10, s36
    v_mov_b32 v11, s41
    v_and_b32 v8, 1, v6
    v_cmp_eq_u32 vcc, 1, v8
    s_nop 1
    v_cndmask_b32 v10, v10, v11, vcc
    v_ashrrev_i32 v6, 1, v6
    v_cmp_eq_u32 vcc, 0, v6
    s_nop 1
    v_cndmask_b32 v152, 0, v10, vcc
    v_cmp_eq_u32 vcc, 1, v6
    s_nop 1
    v_cndmask_b32 v153, 0, v10, vcc
    v_cmp_eq_u32 vcc, 2, v6
    s_nop 1
    v_cndmask_b32 v154, 0, v10, vcc
    v_cmp_eq_u32 vcc, 3, v6
    s_nop 1
    v_cndmask_b32 v155, 0, v10, vcc
    v_cmp_eq_u32 vcc, 8, v6
    s_nop 1
    v_cndmask_b32 v156, 0, v10, vcc
    v_cmp_eq_u32 vcc, 9, v6
    s_nop 1
    v_cndmask_b32 v157, 0, v10, vcc
    v_cmp_eq_u32 vcc, 10, v6
    s_nop 1
    v_cndmask_b32 v158, 0, v10, vcc
    v_cmp_eq_u32 vcc, 11, v6
    s_nop 1
    v_cndmask_b32 v159, 0, v10, vcc
    s_add_u32 s12, s4, 0x2100000
    s_addc_u32 s13, s5, 0
    s_mov_b32 s14, 0x7f00000
    s_mov_b32 s15, 0x20000
    v_bfe_u32 v6, v1, 2, 2
    v_mul_u32_u24 v168, 24640, v6
    v_mul_u32_u24 v6, 72, v36
    v_add_u32 v168, v168, v6
    v_and_b32 v6, 3, v1
    v_lshl_add_u32 v168, v6, 3, v168
    s_mul_i32 s36, s30, 1152
    v_add_u32 v168, s36, v168
    v_lshrrev_b32 v6, 5, v1
    v_mul_u32_u24 v169, 261632, v6
    v_add_u32 v169, v169, v2
    s_lshr_b32 s44, s38, 4
    s_lshl_b32 s44, s44, 14
    s_and_b32 s37, s38, 15
    s_lshl_b32 s37, s37, 9
    s_add_u32 s44, s44, s37
    s_and_b32 s37, s30, 1
    s_lshl_b32 s37, s37, 13
    s_add_u32 s44, s44, s37
    s_lshr_b32 s37, s30, 1
    s_lshl_b32 s37, s37, 26
    s_add_u32 s44, s44, s37
    s_and_b32 s47, s44, 0x2000
    s_xor_b32 s47, s47, 8192
    s_lshr_b32 s37, s30, 1
    s_lshl_b32 s37, s37, 12
    s_add_u32 s47, s47, s37
    s_and_b32 s37, s2, 7
    s_lshl_b32 s37, s37, 7
    s_add_u32 s47, s47, s37
    v_mov_b32 v34, 162824
    v_mov_b32 v7, 1
    s_mul_i32 s36, s30, 24640
    v_mul_u32_u24 v170, 72, v35
    v_lshl_add_u32 v170, v36, 3, v170
    v_add_u32 v170, s36, v170
    v_lshlrev_b32 v6, 10, v1
    v_mov_b32 v35, 0
    s_and_b32 s45, s2, 31
    s_lshl_b32 s45, s45, 7
    s_add_u32 s45, s45, 23117824
    s_cmp_lg_u32 s30, 0
    s_cbranch_scc1 CV_w
    s_and_b32 s36, s2, 7
    s_lshl_b32 s36, s36, 12
    s_add_u32 s36, s36, 23068672
    v_lshlrev_b32 v9, 7, v1
    v_add_u32 v9, s36, v9
    s_mov_b32 s53, 0
    s_add_u32 s54, s52, 0
    s_bfm_b64 exec, 32, 0
poll_2:
    buffer_load_dword v8, v9, s[56:59], 0 offen sc1
    s_waitcnt vmcnt(0)
    v_xor_b32 v8, s54, v8
    v_cmp_eq_u32 vcc, 0, v8
    s_nop 0
    s_cmp_eq_u64 vcc, exec
    s_cbranch_scc1 pok_3
    s_sleep 5
    s_add_u32 s53, s53, 1
    s_cmp_lt_u32 s53, s61
    s_cbranch_scc1 poll_2
    s_mov_b32 s61, 0
pok_3:
    s_mov_b64 exec, -1
    v_mov_b32 v8, 162832
    v_mov_b32 v9, 1
    s_waitcnt lgkmcnt(0)
    ds_write_b32 v8, v9
CV_w:
    v_mov_b32 v8, 162832
spin_4:
    ds_read_b32 v9, v8
    s_waitcnt lgkmcnt(0)
    v_readfirstlane_b32 s53, v9
    s_nop 0
    s_cmp_ge_u32 s53, 1
    s_cbranch_scc0 spin_4
    buffer_load_dwordx4 v[16:19], v2, s[16:19], 0 offen offset:0 sc1 nt
    buffer_load_dwordx4 v[20:23], v2, s[16:19], 0 offen offset:1024 sc1 nt
    buffer_load_dwordx4 v[24:27], v2, s[16:19], 0 offen offset:2048 sc1 nt
    buffer_load_dwordx4 v[28:31], v2, s[16:19], 0 offen offset:3072 sc1 nt
    s_waitcnt vmcnt(3)
    ds_write_b128 v12, v[16:19] offset:16640
    s_waitcnt vmcnt(2)
    ds_write_b128 v12, v[20:23] offset:18176
    s_waitcnt vmcnt(1)
    ds_write_b128 v12, v[24:27] offset:19712
    s_waitcnt vmcnt(0)
    ds_write_b128 v12, v[28:31] offset:21248
    v_mov_b32 v8, 162836
    v_mov_b32 v9, 1
    s_mov_b64 exec, 1
    ds_add_u32 v8, v9
    s_mov_b64 exec, -1
    s_waitcnt lgkmcnt(0)
    ds_read_b128 v[136:139], v33 offset:21248
    ds_read_b128 v[140:143], v33 offset:19712
    ds_read_b128 v[144:147], v33 offset:18176
    ds_read_b128 v[148:151], v33 offset:16640
    s_waitcnt lgkmcnt(3)
    v_mfma_f32_16x16x32_bf16 v[40:43], v[152:155], v[136:139], 0
    v_mfma_f32_16x16x32_bf16 v[44:47], v[156:159], v[136:139], 0
    s_waitcnt lgkmcnt(2)
    v_mfma_f32_16x16x32_bf16 v[48:51], v[152:155], v[140:143], 0
    v_mfma_f32_16x16x32_bf16 v[52:55], v[156:159], v[140:143], 0
    s_waitcnt lgkmcnt(1)
    v_mfma_f32_16x16x32_bf16 v[56:59], v[152:155], v[144:147], 0
    v_mfma_f32_16x16x32_bf16 v[60:63], v[156:159], v[144:147], 0
    s_waitcnt lgkmcnt(0)
    v_mfma_f32_16x16x32_bf16 v[64:67], v[152:155], v[148:151], 0
    v_mfma_f32_16x16x32_bf16 v[68:71], v[156:159], v[148:151], 0
    s_mov_b32 s43, 0
CV_r:
    s_waitcnt lgkmcnt(0)
    v_mfma_f32_16x16x32_bf16 v[40:43], v[72:75], v[136:139], v[40:43]
    v_mfma_f32_16x16x32_bf16 v[48:51], v[72:75], v[140:143], v[48:51]
    v_mfma_f32_16x16x32_bf16 v[56:59], v[72:75], v[144:147], v[56:59]
    v_mfma_f32_16x16x32_bf16 v[64:67], v[72:75], v[148:151], v[64:67]
    v_mfma_f32_16x16x32_bf16 v[44:47], v[76:79], v[136:139], v[44:47]
    v_mfma_f32_16x16x32_bf16 v[52:55], v[76:79], v[140:143], v[52:55]
    v_mfma_f32_16x16x32_bf16 v[60:63], v[76:79], v[144:147], v[60:63]
    v_mfma_f32_16x16x32_bf16 v[68:71], v[76:79], v[148:151], v[68:71]
    v_mfma_f32_16x16x32_bf16 v[48:51], v[80:83], v[136:139], v[48:51]
    v_mfma_f32_16x16x32_bf16 v[56:59], v[80:83], v[140:143], v[56:59]
    v_mfma_f32_16x16x32_bf16 v[64:67], v[80:83], v[144:147], v[64:67]
    v_mfma_f32_16x16x32_bf16 v[52:55], v[84:87], v[136:139], v[52:55]
    v_mfma_f32_16x16x32_bf16 v[60:63], v[84:87], v[140:143], v[60:63]
    v_mfma_f32_16x16x32_bf16 v[68:71], v[84:87], v[144:147], v[68:71]
    v_mfma_f32_16x16x32_bf16 v[56:59], v[88:91], v[136:139], v[56:59]
    v_mfma_f32_16x16x32_bf16 v[64:67], v[88:91], v[140:143], v[64:67]
    v_mfma_f32_16x16x32_bf16 v[60:63], v[92:95], v[136:139], v[60:63]
    v_mfma_f32_16x16x32_bf16 v[68:71], v[92:95], v[140:143], v[68:71]
    v_mfma_f32_16x16x32_bf16 v[64:67], v[96:99], v[136:139], v[64:67]
    v_mfma_f32_16x16x32_bf16 v[68:71], v[100:103], v[136:139], v[68:71]
    ds_read_b128 v[152:155], v33 offset:21344
    ds_read_b128 v[156:159], v33 offset:19808
    ds_read_b128 v[160:163], v33 offset:18272
    ds_read_b128 v[164:167], v33 offset:16736
    ds_read_b64 v[104:105], v32 offset:64
    ds_read_b64 v[106:107], v32 offset:72
    ds_read_b64 v[108:109], v32 offset:96
    ds_read_b64 v[110:111], v32 offset:104
    ds_read_b64 v[112:113], v32 offset:1088
    ds_read_b64 v[114:115], v32 offset:1096
    ds_read_b64 v[116:117], v32 offset:1120
    ds_read_b64 v[118:119], v32 offset:1128
    ds_read_b64 v[120:121], v32 offset:2112
    ds_read_b64 v[122:123], v32 offset:2120
    ds_read_b64 v[124:125], v32 offset:2144
    ds_read_b64 v[126:127], v32 offset:2152
    ds_read_b64 v[128:129], v32 offset:3136
    ds_read_b64 v[130:131], v32 offset:3144
    ds_read_b64 v[132:133], v32 offset:3168
    ds_read_b64 v[134:135], v32 offset:3176
    s_waitcnt lgkmcnt(0)
    v_mfma_f32_16x16x32_bf16 v[40:43], v[104:107], v[152:155], v[40:43]
    v_mfma_f32_16x16x32_bf16 v[48:51], v[104:107], v[156:159], v[48:51]
    v_mfma_f32_16x16x32_bf16 v[56:59], v[104:107], v[160:163], v[56:59]
    v_mfma_f32_16x16x32_bf16 v[64:67], v[104:107], v[164:167], v[64:67]
    v_mfma_f32_16x16x32_bf16 v[44:47], v[108:111], v[152:155], v[44:47]
    v_mfma_f32_16x16x32_bf16 v[52:55], v[108:111], v[156:159], v[52:55]
    v_mfma_f32_16x16x32_bf16 v[60:63], v[108:111], v[160:163], v[60:63]
    v_mfma_f32_16x16x32_bf16 v[68:71], v[108:111], v[164:167], v[68:71]
    v_mfma_f32_16x16x32_bf16 v[48:51], v[112:115], v[152:155], v[48:51]
    v_mfma_f32_16x16x32_bf16 v[56:59], v[112:115], v[156:159], v[56:59]
    v_mfma_f32_16x16x32_bf16 v[64:67], v[112:115], v[160:163], v[64:67]
    v_mfma_f32_16x16x32_bf16 v[52:55], v[116:119], v[152:155], v[52:55]
    v_mfma_f32_16x16x32_bf16 v[60:63], v[116:119], v[156:159], v[60:63]
    v_mfma_f32_16x16x32_bf16 v[68:71], v[116:119], v[160:163], v[68:71]
    v_mfma_f32_16x16x32_bf16 v[56:59], v[120:123], v[152:155], v[56:59]
    v_mfma_f32_16x16x32_bf16 v[64:67], v[120:123], v[156:159], v[64:67]
    v_mfma_f32_16x16x32_bf16 v[60:63], v[124:127], v[152:155], v[60:63]
    v_mfma_f32_16x16x32_bf16 v[68:71], v[124:127], v[156:159], v[68:71]
    v_mfma_f32_16x16x32_bf16 v[64:67], v[128:131], v[152:155], v[64:67]
    v_mfma_f32_16x16x32_bf16 v[68:71], v[132:135], v[152:155], v[68:71]
    ds_read_b128 v[136:139], v33 offset:21440
    ds_read_b128 v[140:143], v33 offset:19904
    ds_read_b128 v[144:147], v33 offset:18368
    ds_read_b128 v[148:151], v33 offset:16832
    ds_read_b64 v[72:73], v32 offset:128
    ds_read_b64 v[74:75], v32 offset:136
    ds_read_b64 v[76:77], v32 offset:160
    ds_read_b64 v[78:79], v32 offset:168
    ds_read_b64 v[80:81], v32 offset:1152
    ds_read_b64 v[82:83], v32 offset:1160
    ds_read_b64 v[84:85], v32 offset:1184
    ds_read_b64 v[86:87], v32 offset:1192
    ds_read_b64 v[88:89], v32 offset:2176
    ds_read_b64 v[90:91], v32 offset:2184
    ds_read_b64 v[92:93], v32 offset:2208
    ds_read_b64 v[94:95], v32 offset:2216
    ds_read_b64 v[96:97], v32 offset:3200
    ds_read_b64 v[98:99], v32 offset:3208
    ds_read_b64 v[100:101], v32 offset:3232
    ds_read_b64 v[102:103], v32 offset:3240
    v_add_u32 v32, 128, v32
    v_add_u32 v33, 192, v33
    s_add_u32 s43, s43, 1
    s_cmp_lt_u32 s43, 4
    s_cbranch_scc1 CV_r
CV_l:
    s_waitcnt lgkmcnt(10)
    v_mfma_f32_16x16x32_bf16 v[40:43], v[72:75], v[136:139], v[40:43]
    ds_read_b128 v[152:155], v33 offset:21344
    v_mfma_f32_16x16x32_bf16 v[48:51], v[72:75], v[140:143], v[48:51]
    ds_read_b128 v[156:159], v33 offset:19808
    s_cmp_eq_u32 s43, 5
    v_mfma_f32_16x16x32_bf16 v[56:59], v[72:75], v[144:147], v[56:59]
    ds_read_b128 v[160:163], v33 offset:18272
    s_cselect_b64 exec, 1, 0
    buffer_load_dword v12, v35, s[56:59], s45 offen sc1
    s_mov_b64 exec, -1
    v_mfma_f32_16x16x32_bf16 v[64:67], v[72:75], v[148:151], v[64:67]
    ds_read_b128 v[164:167], v33 offset:16736
    v_mfma_f32_16x16x32_bf16 v[44:47], v[76:79], v[136:139], v[44:47]
    ds_read_b64 v[104:105], v32 offset:64
    v_mfma_f32_16x16x32_bf16 v[52:55], v[76:79], v[140:143], v[52:55]
    ds_read_b64 v[106:107], v32 offset:72
    v_mfma_f32_16x16x32_bf16 v[60:63], v[76:79], v[144:147], v[60:63]
    ds_read_b64 v[108:109], v32 offset:96
    v_mfma_f32_16x16x32_bf16 v[68:71], v[76:79], v[148:151], v[68:71]
    ds_read_b64 v[110:111], v32 offset:104
    v_mfma_f32_16x16x32_bf16 v[48:51], v[80:83], v[136:139], v[48:51]
    ds_read_b64 v[112:113], v32 offset:1088
    v_mfma_f32_16x16x32_bf16 v[56:59], v[80:83], v[140:143], v[56:59]
    ds_read_b64 v[114:115], v32 offset:1096
    s_waitcnt lgkmcnt(10)
    v_mfma_f32_16x16x32_bf16 v[64:67], v[80:83], v[144:147], v[64:67]
    ds_read_b64 v[116:117], v32 offset:1120
    v_mfma_f32_16x16x32_bf16 v[52:55], v[84:87], v[136:139], v[52:55]
    ds_read_b64 v[118:119], v32 offset:1128
    v_mfma_f32_16x16x32_bf16 v[60:63], v[84:87], v[140:143], v[60:63]
    ds_read_b64 v[120:121], v32 offset:2112
    v_mfma_f32_16x16x32_bf16 v[68:71], v[84:87], v[144:147], v[68:71]
    ds_read_b64 v[122:123], v32 offset:2120
    v_mfma_f32_16x16x32_bf16 v[56:59], v[88:91], v[136:139], v[56:59]
    ds_read_b64 v[124:125], v32 offset:2144
    v_mfma_f32_16x16x32_bf16 v[64:67], v[88:91], v[140:143], v[64:67]
    ds_read_b64 v[126:127], v32 offset:2152
    v_mfma_f32_16x16x32_bf16 v[60:63], v[92:95], v[136:139], v[60:63]
    ds_read_b64 v[128:129], v32 offset:3136
    v_mfma_f32_16x16x32_bf16 v[68:71], v[92:95], v[140:143], v[68:71]
    ds_read_b64 v[130:131], v32 offset:3144
    v_mfma_f32_16x16x32_bf16 v[64:67], v[96:99], v[136:139], v[64:67]
    ds_read_b64 v[132:133], v32 offset:3168
    v_mfma_f32_16x16x32_bf16 v[68:71], v[100:103], v[136:139], v[68:71]
    ds_read_b64 v[134:135], v32 offset:3176
    s_waitcnt lgkmcnt(10)
    v_mfma_f32_16x16x32_bf16 v[40:43], v[104:107], v[152:155], v[40:43]
    ds_read_b128 v[136:139], v33 offset:21440
    v_mfma_f32_16x16x32_bf16 v[48:51], v[104:107], v[156:159], v[48:51]
    ds_read_b128 v[140:143], v33 offset:19904
    v_mfma_f32_16x16x32_bf16 v[56:59], v[104:107], v[160:163], v[56:59]
    ds_read_b128 v[144:147], v33 offset:18368
    v_mfma_f32_16x16x32_bf16 v[64:67], v[104:107], v[164:167], v[64:67]
    ds_read_b128 v[148:151], v33 offset:16832
    v_mfma_f32_16x16x32_bf16 v[44:47], v[108:111], v[152:155], v[44:47]
    ds_read_b64 v[72:73], v32 offset:128
    v_mfma_f32_16x16x32_bf16 v[52:55], v[108:111], v[156:159], v[52:55]
    ds_read_b64 v[74:75], v32 offset:136
    v_add_u32 v33, 192, v33
    v_mfma_f32_16x16x32_bf16 v[60:63], v[108:111], v[160:163], v[60:63]
    ds_read_b64 v[76:77], v32 offset:160
    s_add_u32 s43, s43, 1
    v_mfma_f32_16x16x32_bf16 v[68:71], v[108:111], v[164:167], v[68:71]
    ds_read_b64 v[78:79], v32 offset:168
    s_cmp_lt_u32 s43, 8
    v_mfma_f32_16x16x32_bf16 v[48:51], v[112:115], v[152:155], v[48:51]
    ds_read_b64 v[80:81], v32 offset:1152
    v_mfma_f32_16x16x32_bf16 v[56:59], v[112:115], v[156:159], v[56:59]
    ds_read_b64 v[82:83], v32 offset:1160
    s_waitcnt lgkmcnt(10)
    v_mfma_f32_16x16x32_bf16 v[64:67], v[112:115], v[160:163], v[64:67]
    ds_read_b64 v[84:85], v32 offset:1184
    v_mfma_f32_16x16x32_bf16 v[52:55], v[116:119], v[152:155], v[52:55]
    ds_read_b64 v[86:87], v32 offset:1192
    v_mfma_f32_16x16x32_bf16 v[60:63], v[116:119], v[156:159], v[60:63]
    ds_read_b64 v[88:89], v32 offset:2176
    v_mfma_f32_16x16x32_bf16 v[68:71], v[116:119], v[160:163], v[68:71]
    ds_read_b64 v[90:91], v32 offset:2184
    v_mfma_f32_16x16x32_bf16 v[56:59], v[120:123], v[152:155], v[56:59]
    ds_read_b64 v[92:93], v32 offset:2208
    v_mfma_f32_16x16x32_bf16 v[64:67], v[120:123], v[156:159], v[64:67]
    ds_read_b64 v[94:95], v32 offset:2216
    v_mfma_f32_16x16x32_bf16 v[60:63], v[124:127], v[152:155], v[60:63]
    ds_read_b64 v[96:97], v32 offset:3200
    v_mfma_f32_16x16x32_bf16 v[68:71], v[124:127], v[156:159], v[68:71]
    ds_read_b64 v[98:99], v32 offset:3208
    v_mfma_f32_16x16x32_bf16 v[64:67], v[128:131], v[152:155], v[64:67]
    ds_read_b64 v[100:101], v32 offset:3232
    v_mfma_f32_16x16x32_bf16 v[68:71], v[132:135], v[152:155], v[68:71]
    ds_read_b64 v[102:103], v32 offset:3240
    v_add_u32 v32, 128, v32
    s_cbranch_scc1 CV_l
    v_cvt_pk_bf16_f32 v16, v40, v41
    v_cvt_pk_bf16_f32 v17, v42, v43
    ds_write_b64 v170, v[16:17] offset:0
    v_cvt_pk_bf16_f32 v18, v44, v45
    v_cvt_pk_bf16_f32 v19, v46, v47
    ds_write_b64 v170, v[18:19] offset:32
    v_cvt_pk_bf16_f32 v20, v48, v49
    v_cvt_pk_bf16_f32 v21, v50, v51
    ds_write_b64 v170, v[20:21] offset:1152
    v_cvt_pk_bf16_f32 v22, v52, v53
    v_cvt_pk_bf16_f32 v23, v54, v55
    ds_write_b64 v170, v[22:23] offset:1184
    v_cvt_pk_bf16_f32 v24, v56, v57
    v_cvt_pk_bf16_f32 v25, v58, v59
    ds_write_b64 v170, v[24:25] offset:2304
    v_cvt_pk_bf16_f32 v26, v60, v61
    v_cvt_pk_bf16_f32 v27, v62, v63
    ds_write_b64 v170, v[26:27] offset:2336
    v_cvt_pk_bf16_f32 v28, v64, v65
    v_cvt_pk_bf16_f32 v29, v66, v67
    ds_write_b64 v170, v[28:29] offset:3456
    v_cvt_pk_bf16_f32 v30, v68, v69
    v_cvt_pk_bf16_f32 v31, v70, v71
    ds_write_b64 v170, v[30:31] offset:3488
    s_mov_b64 exec, 1
    ds_add_u32 v34, v7
    s_mov_b64 exec, -1
    s_mov_b32 s53, 0
    s_waitcnt vmcnt(0)
CV_v:
    v_readfirstlane_b32 s94, v12
    s_nop 0
    s_sub_u32 s94, s94, s52
    s_and_b32 s37, s94, 0xfffffe01
    s_cbranch_scc0 CV_k
    buffer_load_dword v12, v35, s[56:59], s45 offen sc1
    s_waitcnt vmcnt(0)
    s_add_u32 s53, s53, 1
    s_cmp_lt_u32 s53, s61
    s_cbranch_scc1 CV_v
    s_mov_b32 s61, 0
    s_mov_b32 s94, 0
CV_k:
    s_lshr_b32 s94, s94, 1
    s_add_u32 s37, s94, 65536
    v_mov_b32 v8, 162844
    v_mov_b32 v9, s37
    ds_write_b32 v8, v9
    s_cmp_gt_u32 s94, 10
    s_cselect_b32 s37, 0x2000, 0
    s_xor_b32 s44, s44, s37
    s_xor_b32 s45, s47, s37
    s_add_u32 s45, s45, 23101440
    v_mov_b32 v8, 162824
spin_5:
    ds_read_b32 v9, v8
    s_waitcnt lgkmcnt(0)
    v_readfirstlane_b32 s53, v9
    s_nop 0
    s_cmp_ge_u32 s53, 6
    s_cbranch_scc0 spin_5
    ds_read_b64_tr_b16 v[104:105], v168 offset:0
    ds_read_b64_tr_b16 v[106:107], v168 offset:32
    ds_read_b64_tr_b16 v[108:109], v168 offset:288
    ds_read_b64_tr_b16 v[110:111], v168 offset:320
    ds_read_b64_tr_b16 v[112:113], v168 offset:576
    ds_read_b64_tr_b16 v[114:115], v168 offset:608
    ds_read_b64_tr_b16 v[116:117], v168 offset:864
    ds_read_b64_tr_b16 v[118:119], v168 offset:896
    s_waitcnt lgkmcnt(6)
    v_or_b32 v104, 1, v104
    buffer_store_dwordx4 v[104:107], v169, s[12:15], s44 offen sc1
    s_add_u32 s44, s44, 16777216
    s_waitcnt lgkmcnt(4)
    v_or_b32 v108, 1, v108
    buffer_store_dwordx4 v[108:111], v169, s[12:15], s44 offen sc1
    s_add_u32 s44, s44, 16777216
    s_waitcnt lgkmcnt(2)
    v_or_b32 v112, 1, v112
    buffer_store_dwordx4 v[112:115], v169, s[12:15], s44 offen sc1
    s_add_u32 s44, s44, 16777216
    s_waitcnt lgkmcnt(0)
    v_or_b32 v116, 1, v116
    buffer_store_dwordx4 v[116:119], v169, s[12:15], s44 offen sc1
    s_add_u32 s44, s44, 16777216
    v_mov_b32 v8, 162836
    v_mov_b32 v9, 1
    s_mov_b64 exec, 1
    ds_add_u32 v8, v9
    s_mov_b64 exec, -1
    s_mov_b64 exec, 0xf
    s_waitcnt vmcnt(0)
    buffer_atomic_add v7, v6, s[56:59], s45 offen sc1
    s_mov_b64 exec, -1
    s_branch FR_end
FR_b:
    s_cmp_ge_u32 s2, 32
    s_cbranch_scc1 FB_np
    s_cmp_lg_u32 s30, 5
    s_cbranch_scc1 FB_np
    s_and_b32 s42, s2, 7
    s_lshl_b32 s42, s42, 10
    s_lshr_b32 s43, s2, 3
    s_lshl_b32 s43, s43, 14
    s_add_u32 s42, s42, s43
    s_add_u32 s42, s42, 39714816
    v_mov_b32 v14, 0
    s_mov_b64 exec, 1
    s_mov_b32 s46, -1
    s_mov_b32 s47, -1
    s_add_u32 s48, s4, s42
    s_addc_u32 s49, s5, 0
    s_load_dword s101, s[48:49], 384
    s_waitcnt lgkmcnt(0)
    s_memtime s[34:35]
    s_waitcnt lgkmcnt(0)
    s_load_dword s101, s[48:49], 0
    s_waitcnt lgkmcnt(0)
    s_memtime s[36:37]
    s_waitcnt lgkmcnt(0)
    s_sub_u32 s43, s36, s34
    s_min_u32 s46, s46, s43
    s_load_dword s101, s[48:49], 8192
    s_waitcnt lgkmcnt(0)
    s_memtime s[34:35]
    s_waitcnt lgkmcnt(0)
    s_sub_u32 s43, s34, s36
    s_min_u32 s47, s47, s43
    s_load_dword s101, s[48:49], 128
    s_waitcnt lgkmcnt(0)
    s_memtime s[36:37]
    s_waitcnt lgkmcnt(0)
    s_sub_u32 s43, s36, s34
    s_min_u32 s46, s46, s43
    s_load_dword s101, s[48:49], 8320
    s_waitcnt lgkmcnt(0)
    s_memtime s[34:35]
    s_waitcnt lgkmcnt(0)
    s_sub_u32 s43, s34, s36
    s_min_u32 s47, s47, s43
    s_cmp_lt_u32 s47, s46
    s_cselect_b32 s45, 1, 0
    s_lshr_b32 s46, s28, 2
    s_xor_b32 s45, s45, s46
    s_and_b32 s45, s45, 1
    s_lshl_b32 s45, s45, 8
    s_or_b32 s43, s45, 1
    v_mov_b32 v12, s43
    buffer_atomic_add v12, v14, s[84:87], 0 offen offset:4 sc0 sc1
    s_waitcnt vmcnt(0)
    v_readfirstlane_b32 s36, v12
    s_nop 0
    s_add_u32 s36, s36, s43
    s_and_b32 s37, s36, 255
    s_cmp_lg_u32 s37, 21
    s_cbranch_scc1 FB_np
    s_lshr_b32 s36, s36, 8
    s_lshl_b32 s36, s36, 1
    s_add_u32 s36, s36, s52
    s_bfm_b64 exec, 32, 0
    v_mov_b32 v12, s36
    v_lshlrev_b32 v13, 7, v1
    s_mov_b32 s36, 23117824
    buffer_store_dword v12, v13, s[56:59], s36 offen sc1
FB_np:
    s_mov_b64 exec, -1
    s_getpc_b64 s[34:35]
K_tpc:
    s_lshl_b32 s36, s29, 2
    s_and_b32 s37, s28, 3
    s_add_u32 s36, s36, s37
    s_lshl_b32 s36, s36, 6
    s_add_u32 s36, s36, K_tab-K_tpc
    s_add_u32 s34, s34, s36
    s_addc_u32 s35, s35, 0
    v_and_b32 v248, 31, v1
    v_lshlrev_b32 v248, 1, v248
    global_load_ushort v251, v248, s[34:35]
    v_lshrrev_b32 v253, 3, v1
    v_lshlrev_b32 v238, 11, v253
    v_and_b32 v253, 6, v253
    v_and_b32 v254, 7, v1
    v_xor_b32 v253, v253, v254
    v_lshl_add_u32 v238, v253, 4, v238
    v_lshrrev_b32 v253, 4, v1
    v_lshlrev_b32 v239, 11, v253
    v_add_u32 v253, 0, v253
    v_lshlrev_b32 v253, 1, v253
    v_and_b32 v254, 15, v1
    v_xor_b32 v253, v253, v254
    v_lshl_add_u32 v239, v253, 4, v239
    v_lshrrev_b32 v253, 4, v1
    v_lshlrev_b32 v240, 11, v253
    v_add_u32 v253, 4, v253
    v_lshlrev_b32 v253, 1, v253
    v_and_b32 v254, 15, v1
    v_xor_b32 v253, v253, v254
    v_lshl_add_u32 v240, v253, 4, v240
    v_add_u32 v254, 0, v1
    v_mul_u32_u24 v253, 2341, v254
    v_lshrrev_b32 v253, 16, v253
    v_mul_u32_u24 v241, 28, v253
    v_sub_u32 v254, v254, v241
    v_mul_u32_u24 v241, 7168, v253
    v_lshrrev_b32 v253, 1, v253
    v_and_b32 v253, 2, v253
    v_xor_b32 v254, v254, v253
    v_lshl_add_u32 v241, v254, 4, v241
    v_add_u32 v254, 64, v1
    v_mul_u32_u24 v253, 2341, v254
    v_lshrrev_b32 v253, 16, v253
    v_mul_u32_u24 v242, 28, v253
    v_sub_u32 v254, v254, v242
    v_mul_u32_u24 v242, 7168, v253
    v_lshrrev_b32 v253, 1, v253
    v_and_b32 v253, 2, v253
    v_xor_b32 v254, v254, v253
    v_lshl_add_u32 v242, v254, 4, v242
    v_add_u32 v254, 128, v1
    v_mul_u32_u24 v253, 2341, v254
    v_lshrrev_b32 v253, 16, v253
    v_mul_u32_u24 v243, 28, v253
    v_sub_u32 v254, v254, v243
    v_mul_u32_u24 v243, 7168, v253
    v_lshrrev_b32 v253, 1, v253
    v_and_b32 v253, 2, v253
    v_xor_b32 v254, v254, v253
    v_lshl_add_u32 v243, v254, 4, v243
    v_add_u32 v254, 192, v1
    v_mul_u32_u24 v253, 2341, v254
    v_lshrrev_b32 v253, 16, v253
    v_mul_u32_u24 v244, 28, v253
    v_sub_u32 v254, v254, v244
    v_mul_u32_u24 v244, 7168, v253
    v_lshrrev_b32 v253, 1, v253
    v_and_b32 v253, 2, v253
    v_xor_b32 v254, v254, v253
    v_lshl_add_u32 v244, v254, 4, v244
    v_add_u32 v254, 256, v1
    v_mul_u32_u24 v253, 2341, v254
    v_lshrrev_b32 v253, 16, v253
    v_mul_u32_u24 v245, 28, v253
    v_sub_u32 v254, v254, v245
    v_mul_u32_u24 v245, 7168, v253
    v_lshrrev_b32 v253, 1, v253
    v_and_b32 v253, 2, v253
    v_xor_b32 v254, v254, v253
    v_lshl_add_u32 v245, v254, 4, v245
    v_add_u32 v254, 320, v1
    v_mul_u32_u24 v253, 2341, v254
    v_lshrrev_b32 v253, 16, v253
    v_mul_u32_u24 v246, 28, v253
    v_sub_u32 v254, v254, v246
    v_mul_u32_u24 v246, 7168, v253
    v_lshrrev_b32 v253, 1, v253
    v_and_b32 v253, 2, v253
    v_xor_b32 v254, v254, v253
    v_lshl_add_u32 v246, v254, 4, v246
    v_add_u32 v254, 384, v1
    v_mul_u32_u24 v253, 2341, v254
    v_lshrrev_b32 v253, 16, v253
    v_mul_u32_u24 v247, 28, v253
    v_sub_u32 v254, v254, v247
    v_mul_u32_u24 v247, 7168, v253
    v_lshrrev_b32 v253, 1, v253
    v_and_b32 v253, 2, v253
    v_xor_b32 v254, v254, v253
    v_lshl_add_u32 v247, v254, 4, v247
    s_cmp_ge_u32 s30, 6
    s_cbranch_scc1 FB_cs
    s_cmp_lg_u32 s30, 4
    s_cbranch_scc1 FB_ni
    v_mov_b32 v12, s52
    s_lshr_b32 s53, s28, 3
    s_lshl_b32 s53, s53, 2
    s_and_b32 s54, s28, 3
    s_add_u32 s53, s53, s54
    s_lshl_b32 s53, s53, 24
    s_lshr_b32 s54, s28, 2
    s_xor_b32 s54, s54, s94
    s_and_b32 s54, s54, 1
    s_lshl_b32 s54, s54, 13
    s_add_u32 s37, s53, s54
    s_add_u32 s37, s37, 33554432
    s_andn2_b32 s37, s37, 0x2000
    s_lshl_b32 s53, s29, 7
    s_add_u32 s37, s37, s53
    s_add_u32 s37, s37, 6029312
    v_and_b32 v13, 1, v1
    v_lshlrev_b32 v13, 13, v13
    v_lshrrev_b32 v14, 1, v1
    v_lshl_add_u32 v13, v14, 22, v13
    s_mov_b64 exec, 0xf
    buffer_store_dword v12, v13, s[56:59], s37 offen sc1
    s_cmp_lg_u32 s28, 0
    s_cbranch_scc1 FB_n2
    s_add_u32 s37, s53, 23121920
    s_mov_b64 exec, 1
    buffer_store_dword v12, v13, s[56:59], s37 offen sc1
FB_n2:
    s_mov_b64 exec, -1
FB_ni:
    s_waitcnt vmcnt(0)
    v_bfe_u32 v252, v251, 2, 2
    v_lshlrev_b32 v248, 14, v252
    v_and_b32 v252, 3, v251
    v_lshl_add_u32 v248, v252, 11, v248
    v_bfe_u32 v252, v251, 7, 3
    v_lshlrev_b32 v249, 14, v252
    v_bfe_u32 v252, v251, 4, 3
    v_lshl_add_u32 v249, v252, 10, v249
    v_bfe_u32 v252, v251, 13, 3
    v_lshlrev_b32 v250, 14, v252
    v_bfe_u32 v252, v251, 10, 3
    v_lshl_add_u32 v250, v252, 10, v250
    v_mov_b32 v6, 162836
spin_7:
    s_sleep 2
    ds_read_b32 v7, v6
    s_waitcnt lgkmcnt(0)
    v_readfirstlane_b32 s53, v7
    s_nop 0
    s_cmp_ge_u32 s53, 4
    s_cbranch_scc0 spin_7
    s_load_dwordx2 s[48:49], s[0:1], 64
    s_lshl_b32 s45, s2, 1
    s_and_b32 s50, s30, 1
    s_add_u32 s45, s45, s50
    s_mul_i32 s45, s45, 4096
    s_mov_b32 s50, 2097152
    s_mov_b32 s51, 0x20000
    s_waitcnt lgkmcnt(0)
    buffer_load_dwordx4 v[20:23], v2, s[48:51], s45 offen offset:0
    buffer_load_dwordx4 v[20:23], v2, s[48:51], s45 offen offset:1024
    buffer_load_dwordx4 v[20:23], v2, s[48:51], s45 offen offset:2048
    buffer_load_dwordx4 v[20:23], v2, s[48:51], s45 offen offset:3072
    v_mov_b32 v6, 1
    v_mov_b32 v7, 162824
    s_mov_b64 exec, 1
    s_waitcnt vmcnt(0)
    ds_add_u32 v7, v6
    s_mov_b64 exec, -1
    v_mov_b32 v6, 162840
spin_9:
    s_sleep 4
    ds_read_b32 v7, v6
    s_waitcnt lgkmcnt(0)
    v_readfirstlane_b32 s53, v7
    s_nop 0
    s_cmp_ge_u32 s53, 2
    s_cbranch_scc0 spin_9
    s_call_b64 s[76:77], SUB_w1_regs
    s_call_b64 s[76:77], SUB_park
    v_mov_b32 v6, 162840
spin_10:
    s_sleep 3
    ds_read_b32 v7, v6
    s_waitcnt lgkmcnt(0)
    v_readfirstlane_b32 s53, v7
    s_nop 0
    s_cmp_ge_u32 s53, 4
    s_cbranch_scc0 spin_10
    s_mov_b64 s[12:13], s[68:69]
    s_mov_b32 s14, 2097152
    s_mov_b32 s15, 0x20000
    s_and_b32 s35, s30, 1
    s_mul_i32 s38, s99, 128
    s_mul_i32 s41, s35, 65536
    s_add_u32 s38, s38, s41
    s_mul_i32 s41, s35, 4096
    s_add_u32 s41, s41, 24576
    s_mov_b32 s42, 0
    s_mov_b32 s44, s67
    s_mov_b32 s42, 73728
    s_mov_b32 s44, s67
    s_add_u32 s44, s44, 9
    s_and_b32 s44, s44, 15
    s_call_b64 s[76:77], SUB_w_issue_1
    s_waitcnt vmcnt(8)
    s_mov_b32 s42, 81920
    s_mov_b32 s44, s67
    s_add_u32 s44, s44, 10
    s_and_b32 s44, s44, 15
    s_call_b64 s[76:77], SUB_w_issue_1
    s_waitcnt vmcnt(8)
    s_mov_b32 s42, 90112
    s_mov_b32 s44, s67
    s_add_u32 s44, s44, 11
    s_and_b32 s44, s44, 15
    s_call_b64 s[76:77], SUB_w_issue_1
    s_waitcnt vmcnt(8)
    s_and_b32 s36, s29, 6
    s_cmp_eq_u32 s36, 2
    s_cbranch_scc1 pr_11
    s_call_b64 s[76:77], SUB_park2
pr_11:
    s_call_b64 s[76:77], SUB_w1_put
    s_branch FR_end
FB_cs:
    v_and_b32 v164, 15, v1
    v_mov_b32 v165, 0x3f803f80
    v_cmp_eq_u32 vcc, 0, v164
    s_nop 1
    v_cndmask_b32 v16, 0, v165, vcc
    v_cndmask_b32 v17, 0, v165, vcc
    v_cndmask_b32 v18, 0, v165, vcc
    v_cndmask_b32 v19, 0, v165, vcc
    v_cmp_eq_u32 vcc, 1, v164
    s_nop 1
    v_cndmask_b32 v20, 0, v165, vcc
    v_cndmask_b32 v21, 0, v165, vcc
    v_cndmask_b32 v22, 0, v165, vcc
    v_cndmask_b32 v23, 0, v165, vcc
    v_cmp_eq_u32 vcc, 2, v164
    s_nop 1
    v_cndmask_b32 v24, 0, v165, vcc
    v_cndmask_b32 v25, 0, v165, vcc
    v_cndmask_b32 v26, 0, v165, vcc
    v_cndmask_b32 v27, 0, v165, vcc
    v_cmp_eq_u32 vcc, 3, v164
    s_nop 1
    v_cndmask_b32 v28, 0, v165, vcc
    v_cndmask_b32 v29, 0, v165, vcc
    v_cndmask_b32 v30, 0, v165, vcc
    v_cndmask_b32 v31, 0, v165, vcc
    v_cmp_eq_u32 vcc, 4, v164
    s_nop 1
    v_cndmask_b32 v32, 0, v165, vcc
    v_cndmask_b32 v33, 0, v165, vcc
    v_cndmask_b32 v34, 0, v165, vcc
    v_cndmask_b32 v35, 0, v165, vcc
    v_cmp_eq_u32 vcc, 5, v164
    s_nop 1
    v_cndmask_b32 v36, 0, v165, vcc
    v_cndmask_b32 v37, 0, v165, vcc
    v_cndmask_b32 v38, 0, v165, vcc
    v_cndmask_b32 v39, 0, v165, vcc
    v_cmp_eq_u32 vcc, 6, v164
    s_nop 1
    v_cndmask_b32 v40, 0, v165, vcc
    v_cndmask_b32 v41, 0, v165, vcc
    v_cndmask_b32 v42, 0, v165, vcc
    v_cndmask_b32 v43, 0, v165, vcc
    v_cmp_eq_u32 vcc, 7, v164
    s_nop 1
    v_cndmask_b32 v44, 0, v165, vcc
    v_cndmask_b32 v45, 0, v165, vcc
    v_cndmask_b32 v46, 0, v165, vcc
    v_cndmask_b32 v47, 0, v165, vcc
    v_cmp_eq_u32 vcc, 8, v164
    s_nop 1
    v_cndmask_b32 v48, 0, v165, vcc
    v_cndmask_b32 v49, 0, v165, vcc
    v_cndmask_b32 v50, 0, v165, vcc
    v_cndmask_b32 v51, 0, v165, vcc
    v_cmp_eq_u32 vcc, 9, v164
    s_nop 1
    v_cndmask_b32 v52, 0, v165, vcc
    v_cndmask_b32 v53, 0, v165, vcc
    v_cndmask_b32 v54, 0, v165, vcc
    v_cndmask_b32 v55, 0, v165, vcc
    v_cmp_eq_u32 vcc, 10, v164
    s_nop 1
    v_cndmask_b32 v56, 0, v165, vcc
    v_cndmask_b32 v57, 0, v165, vcc
    v_cndmask_b32 v58, 0, v165, vcc
    v_cndmask_b32 v59, 0, v165, vcc
    v_cmp_eq_u32 vcc, 11, v164
    s_nop 1
    v_cndmask_b32 v60, 0, v165, vcc
    v_cndmask_b32 v61, 0, v165, vcc
    v_cndmask_b32 v62, 0, v165, vcc
    v_cndmask_b32 v63, 0, v165, vcc
    v_cmp_eq_u32 vcc, 12, v164
    s_nop 1
    v_cndmask_b32 v64, 0, v165, vcc
    v_cndmask_b32 v65, 0, v165, vcc
    v_cndmask_b32 v66, 0, v165, vcc
    v_cndmask_b32 v67, 0, v165, vcc
    v_cmp_eq_u32 vcc, 13, v164
    s_nop 1
    v_cndmask_b32 v68, 0, v165, vcc
    v_cndmask_b32 v69, 0, v165, vcc
    v_cndmask_b32 v70, 0, v165, vcc
    v_cndmask_b32 v71, 0, v165, vcc
    s_mov_b32 s35, 0
    v_lshrrev_b32 v253, 2, v1
    v_mul_u32_u24 v144, 128, v253
    v_and_b32 v254, 3, v1
    v_lshl_add_u32 v144, v254, 3, v144
    v_add_u32 v144, 24576, v144
    v_bfe_u32 v253, v253, 1, 2
    s_mul_i32 s36, s35, 4
    s_add_u32 s36, s36, 3
    v_xor_b32 v254, s36, v253
    v_lshl_add_u32 v147, v254, 5, v144
    s_mul_i32 s36, s35, 4
    s_add_u32 s36, s36, 2
    v_xor_b32 v254, s36, v253
    v_lshl_add_u32 v146, v254, 5, v144
    s_mul_i32 s36, s35, 4
    s_add_u32 s36, s36, 1
    v_xor_b32 v254, s36, v253
    v_lshl_add_u32 v145, v254, 5, v144
    s_mul_i32 s36, s35, 4
    s_add_u32 s36, s36, 0
    v_xor_b32 v254, s36, v253
    v_lshl_add_u32 v144, v254, 5, v144
    s_and_b32 s35, s30, 1
    s_mul_i32 s35, s35, 4096
    s_add_u32 s35, s35, 73728
    v_add_u32 v144, s35, v144
    v_add_u32 v145, s35, v145
    v_add_u32 v146, s35, v146
    v_add_u32 v147, s35, v147
    s_mov_b32 s35, 0
    v_lshrrev_b32 v253, 2, v1
    v_mul_u32_u24 v148, 448, v253
    v_and_b32 v254, 3, v1
    v_lshl_add_u32 v148, v254, 3, v148
    v_add_u32 v148, 73728, v148
    s_mul_i32 s36, s35, 224
    v_add_u32 v148, s36, v148
    v_bfe_u32 v253, v1, 4, 1
    v_lshlrev_b32 v253, 5, v253
    s_cmp_eq_u32 s35, 0
    s_cselect_b32 s36, 1, -1
    v_mul_lo_u32 v253, v253, s36
    v_sub_u32 v149, v148, v253
    v_add_u32 v148, v148, v253
    s_and_b32 s35, s30, 1
    s_mul_i32 s35, s35, 14336
    s_add_u32 s35, s35, 32768
    v_add_u32 v148, s35, v148
    v_add_u32 v149, s35, v149
    s_mov_b32 s35, 1
    v_lshrrev_b32 v253, 2, v1
    v_mul_u32_u24 v150, 448, v253
    v_and_b32 v254, 3, v1
    v_lshl_add_u32 v150, v254, 3, v150
    v_add_u32 v150, 73728, v150
    s_mul_i32 s36, s35, 224
    v_add_u32 v150, s36, v150
    v_bfe_u32 v253, v1, 4, 1
    v_lshlrev_b32 v253, 5, v253
    s_cmp_eq_u32 s35, 0
    s_cselect_b32 s36, 1, -1
    v_mul_lo_u32 v253, v253, s36
    v_sub_u32 v151, v150, v253
    v_add_u32 v150, v150, v253
    s_and_b32 s35, s30, 1
    s_mul_i32 s35, s35, 14336
    s_add_u32 s35, s35, 32768
    v_add_u32 v150, s35, v150
    v_add_u32 v151, s35, v151
    v_mov_b32 v156, 0
    v_mov_b32 v157, 0
    v_mov_b32 v158, 0
    v_mov_b32 v159, 0
    v_mov_b32 v160, 0
    v_mov_b32 v161, 0
    v_mov_b32 v162, 0
    v_mov_b32 v163, 0
    v_lshrrev_b32 v166, 4, v1
    v_lshlrev_b32 v166, 4, v166
    v_lshl_add_u32 v166, v164, 6, v166
    v_mov_b32 v165, 0x7f000000
    v_cmp_gt_u32 vcc, 4, v164
    s_nop 1
    v_cndmask_b32 v167, v165, v166, vcc
    v_cmp_gt_u32 vcc, 14, v164
    s_nop 1
    v_cndmask_b32 v168, v165, v166, vcc
    s_waitcnt vmcnt(0)
    v_and_b32 v252, 15, v251
    v_mul_u32_u24 v248, 458752, v252
    s_and_b32 s36, s30, 1
    s_mul_i32 s36, s36, 6
    s_add_u32 s36, s36, 4
    v_bfe_u32 v252, v251, s36, 6
    v_mul_u32_u24 v250, 37, v252
    v_lshrrev_b32 v250, 8, v250
    v_mul_u32_u24 v250, 7, v250
    v_sub_u32 v250, v252, v250
    v_cmp_eq_u32 vcc, 3, v250
    s_nop 1
    v_cndmask_b32 v250, 0, 1, vcc
    v_lshl_add_u32 v249, v252, 16, v250
    v_mov_b32 v6, 162836
spin_12:
    s_sleep 2
    ds_read_b32 v7, v6
    s_waitcnt lgkmcnt(0)
    v_readfirstlane_b32 s53, v7
    s_nop 0
    s_cmp_ge_u32 s53, 4
    s_cbranch_scc0 spin_12
    s_mov_b64 s[12:13], s[68:69]
    s_mov_b32 s14, 2097152
    s_mov_b32 s15, 0x20000
    s_and_b32 s35, s30, 1
    s_mul_i32 s38, s99, 128
    s_mul_i32 s41, s35, 65536
    s_add_u32 s38, s38, s41
    s_mul_i32 s41, s35, 4096
    s_add_u32 s41, s41, 24576
    s_mov_b32 s42, 0
    s_mov_b32 s44, s67
    s_mov_b32 s42, 73728
    s_mov_b32 s44, s28
    s_add_u32 s19, s41, s42
    s_mul_i32 s16, s44, 131072
    s_add_u32 s16, s16, s38
    s_add_u32 s44, s44, 1
    s_and_b32 s44, s44, 15
    s_add_u32 s42, s42, 8192
    s_cmp_eq_u32 s42, 131072
    s_cselect_b32 s42, 0, s42
    s_mov_b32 m0, s19
    s_mov_b32 s39, s16
    buffer_load_dwordx4 v238, s[12:15], s39 offen lds
    s_add_u32 m0, m0, 1024
    s_add_u32 s39, s39, 16384
    buffer_load_dwordx4 v238, s[12:15], s39 offen lds
    s_add_u32 m0, m0, 1024
    s_add_u32 s39, s39, 16384
    buffer_load_dwordx4 v238, s[12:15], s39 offen lds
    s_add_u32 m0, m0, 1024
    s_add_u32 s39, s39, 16384
    buffer_load_dwordx4 v238, s[12:15], s39 offen lds
    s_mov_b64 s[12:13], s[72:73]
    s_mov_b32 s14, 7340032
    s_mov_b32 s15, 0x20000
    s_and_b32 s35, s30, 1
    s_mul_i32 s38, s29, 448
    s_mul_i32 s41, s35, 229376
    s_add_u32 s38, s38, s41
    s_mul_i32 s41, s35, 14336
    s_add_u32 s41, s41, 73728
    s_mov_b32 s42, 0
    s_mov_b32 s44, 0
    s_mov_b32 s42, 32768
    s_mov_b32 s44, s28
    s_add_u32 s19, s41, s42
    s_mul_i32 s16, s44, 458752
    s_add_u32 s16, s16, s38
    s_add_u32 s44, s44, 1
    s_and_b32 s44, s44, 15
    s_add_u32 s42, s42, 28672
    s_cmp_eq_u32 s42, 86016
    s_cselect_b32 s42, 0, s42
    s_mov_b32 m0, s19
    s_mov_b32 s39, s16
    buffer_load_dwordx4 v241, s[12:15], s39 offen lds
    s_add_u32 m0, m0, 1024
    s_nop 0
    buffer_load_dwordx4 v242, s[12:15], s39 offen lds
    s_add_u32 m0, m0, 1024
    s_nop 0
    buffer_load_dwordx4 v243, s[12:15], s39 offen lds
    s_add_u32 m0, m0, 1024
    s_nop 0
    buffer_load_dwordx4 v244, s[12:15], s39 offen lds
    s_add_u32 m0, m0, 1024
    s_nop 0
    buffer_load_dwordx4 v245, s[12:15], s39 offen lds
    s_add_u32 m0, m0, 1024
    s_nop 0
    buffer_load_dwordx4 v246, s[12:15], s39 offen lds
    s_add_u32 m0, m0, 1024
    s_nop 0
    buffer_load_dwordx4 v247, s[12:15], s39 offen lds
    s_add_u32 m0, m0, 1024
    s_add_u32 s39, s39, 114688
    buffer_load_dwordx4 v241, s[12:15], s39 offen lds
    s_add_u32 m0, m0, 1024
    s_nop 0
    buffer_load_dwordx4 v242, s[12:15], s39 offen lds
    s_add_u32 m0, m0, 1024
    s_nop 0
    buffer_load_dwordx4 v243, s[12:15], s39 offen lds
    s_add_u32 m0, m0, 1024
    s_nop 0
    buffer_load_dwordx4 v244, s[12:15], s39 offen lds
    s_add_u32 m0, m0, 1024
    s_nop 0
    buffer_load_dwordx4 v245, s[12:15], s39 offen lds
    s_add_u32 m0, m0, 1024
    s_nop 0
    buffer_load_dwordx4 v246, s[12:15], s39 offen lds
    s_add_u32 m0, m0, 1024
    s_nop 0
    buffer_load_dwordx4 v247, s[12:15], s39 offen lds
    s_waitcnt vmcnt(14)
    s_setprio 1
    ds_read_b64_tr_b16 v[128:129], v144 offset:0
    ds_read_b64_tr_b16 v[130:131], v144 offset:2048
    ds_read_b64_tr_b16 v[132:133], v145 offset:0
    ds_read_b64_tr_b16 v[134:135], v145 offset:2048
    ds_read_b64_tr_b16 v[136:137], v146 offset:0
    ds_read_b64_tr_b16 v[138:139], v146 offset:2048
    ds_read_b64_tr_b16 v[140:141], v147 offset:0
    ds_read_b64_tr_b16 v[142:143], v147 offset:2048
    s_add_u32 s20, s4, 0x1400000
    s_addc_u32 s21, s5, 0
    s_mov_b32 s22, 0x20000
    s_mov_b32 s23, 0x20000
    s_lshl_b32 s35, s28, 1
    s_and_b32 s36, s30, 1
    s_add_u32 s35, s35, s36
    s_mul_i32 s35, s35, 4096
    s_mul_i32 s36, s29, 256
    s_add_u32 s35, s35, s36
    s_waitcnt lgkmcnt(0)
    v_mfma_f32_16x16x32_bf16 v[160:163], v[128:131], v[16:19], v[160:163]
    v_mfma_f32_16x16x32_bf16 v[160:163], v[132:135], v[20:23], v[160:163]
    v_mfma_f32_16x16x32_bf16 v[160:163], v[136:139], v[24:27], v[160:163]
    v_mfma_f32_16x16x32_bf16 v[160:163], v[140:143], v[28:31], v[160:163]
    s_nop 7
    buffer_store_dwordx4 v[160:163], v167, s[20:23], s35 offen sc1
    s_waitcnt vmcnt(1)
    v_mov_b32 v6, 162840
    v_mov_b32 v7, 1
    s_mov_b64 exec, 1
    ds_add_u32 v6, v7
    s_mov_b64 exec, -1
    ds_read_b64_tr_b16 v[72:73], v148 offset:0
    ds_read_b64_tr_b16 v[74:75], v148 offset:7168
    ds_read_b64_tr_b16 v[76:77], v149 offset:32
    ds_read_b64_tr_b16 v[78:79], v149 offset:7200
    ds_read_b64_tr_b16 v[80:81], v148 offset:64
    ds_read_b64_tr_b16 v[82:83], v148 offset:7232
    ds_read_b64_tr_b16 v[84:85], v149 offset:96
    ds_read_b64_tr_b16 v[86:87], v149 offset:7264
    ds_read_b64_tr_b16 v[88:89], v148 offset:128
    ds_read_b64_tr_b16 v[90:91], v148 offset:7296
    ds_read_b64_tr_b16 v[92:93], v149 offset:160
    ds_read_b64_tr_b16 v[94:95], v149 offset:7328
    ds_read_b64_tr_b16 v[96:97], v148 offset:192
    ds_read_b64_tr_b16 v[98:99], v148 offset:7360
    ds_read_b64_tr_b16 v[100:101], v150 offset:0
    ds_read_b64_tr_b16 v[102:103], v150 offset:7168
    ds_read_b64_tr_b16 v[104:105], v151 offset:32
    ds_read_b64_tr_b16 v[106:107], v151 offset:7200
    ds_read_b64_tr_b16 v[108:109], v150 offset:64
    ds_read_b64_tr_b16 v[110:111], v150 offset:7232
    ds_read_b64_tr_b16 v[112:113], v151 offset:96
    ds_read_b64_tr_b16 v[114:115], v151 offset:7264
    ds_read_b64_tr_b16 v[116:117], v150 offset:128
    ds_read_b64_tr_b16 v[118:119], v150 offset:7296
    ds_read_b64_tr_b16 v[120:121], v151 offset:160
    ds_read_b64_tr_b16 v[122:123], v151 offset:7328
    ds_read_b64_tr_b16 v[124:125], v150 offset:192
    ds_read_b64_tr_b16 v[126:127], v150 offset:7360
    s_add_u32 s20, s4, 0x1420000
    s_addc_u32 s21, s5, 0
    s_mov_b32 s22, 0x70000
    s_mov_b32 s23, 0x20000
    s_lshl_b32 s35, s28, 1
    s_and_b32 s36, s30, 1
    s_add_u32 s35, s35, s36
    s_mul_i32 s35, s35, 14336
    s_mul_i32 s36, s29, 896
    s_add_u32 s35, s35, s36
    s_waitcnt lgkmcnt(0)
    v_mfma_f32_16x16x32_bf16 v[156:159], v[72:75], v[16:19], v[156:159]
    v_mfma_f32_16x16x32_bf16 v[156:159], v[76:79], v[20:23], v[156:159]
    v_mfma_f32_16x16x32_bf16 v[156:159], v[80:83], v[24:27], v[156:159]
    v_mfma_f32_16x16x32_bf16 v[156:159], v[84:87], v[28:31], v[156:159]
    v_mfma_f32_16x16x32_bf16 v[156:159], v[88:91], v[32:35], v[156:159]
    v_mfma_f32_16x16x32_bf16 v[156:159], v[92:95], v[36:39], v[156:159]
    v_mfma_f32_16x16x32_bf16 v[156:159], v[96:99], v[40:43], v[156:159]
    v_mfma_f32_16x16x32_bf16 v[156:159], v[100:103], v[44:47], v[156:159]
    v_mfma_f32_16x16x32_bf16 v[156:159], v[104:107], v[48:51], v[156:159]
    v_mfma_f32_16x16x32_bf16 v[156:159], v[108:111], v[52:55], v[156:159]
    v_mfma_f32_16x16x32_bf16 v[156:159], v[112:115], v[56:59], v[156:159]
    v_mfma_f32_16x16x32_bf16 v[156:159], v[116:119], v[60:63], v[156:159]
    v_mfma_f32_16x16x32_bf16 v[156:159], v[120:123], v[64:67], v[156:159]
    v_mfma_f32_16x16x32_bf16 v[156:159], v[124:127], v[68:71], v[156:159]
    s_nop 7
    buffer_store_dwordx4 v[156:159], v168, s[20:23], s35 offen sc1
    v_mov_b32 v6, 162840
    v_mov_b32 v7, 1
    s_mov_b64 exec, 1
    ds_add_u32 v6, v7
    s_mov_b64 exec, -1
    s_setprio 0
    s_call_b64 s[76:77], SUB_w1_regs
    s_call_b64 s[76:77], SUB_park
    v_mov_b32 v6, 162840
spin_14:
    s_sleep 3
    ds_read_b32 v7, v6
    s_waitcnt lgkmcnt(0)
    v_readfirstlane_b32 s53, v7
    s_nop 0
    s_cmp_ge_u32 s53, 4
    s_cbranch_scc0 spin_14
    s_mov_b64 s[12:13], s[68:69]
    s_mov_b32 s14, 2097152
    s_mov_b32 s15, 0x20000
    s_and_b32 s35, s30, 1
    s_mul_i32 s38, s99, 128
    s_mul_i32 s41, s35, 65536
    s_add_u32 s38, s38, s41
    s_mul_i32 s41, s35, 4096
    s_add_u32 s41, s41, 24576
    s_mov_b32 s42, 0
    s_mov_b32 s44, s67
    s_mov_b32 s42, 98304
    s_mov_b32 s44, s67
    s_add_u32 s44, s44, 12
    s_and_b32 s44, s44, 15
    s_call_b64 s[76:77], SUB_w_issue_1
    s_waitcnt vmcnt(8)
    s_mov_b32 s42, 106496
    s_mov_b32 s44, s67
    s_add_u32 s44, s44, 13
    s_and_b32 s44, s44, 15
    s_call_b64 s[76:77], SUB_w_issue_1
    s_waitcnt vmcnt(8)
    s_mov_b32 s42, 114688
    s_mov_b32 s44, s67
    s_add_u32 s44, s44, 14
    s_and_b32 s44, s44, 15
    s_call_b64 s[76:77], SUB_w_issue_1
    s_waitcnt vmcnt(8)
    s_mov_b32 s42, 122880
    s_mov_b32 s44, s67
    s_add_u32 s44, s44, 15
    s_and_b32 s44, s44, 15
    s_call_b64 s[76:77], SUB_w_issue_1
    s_waitcnt vmcnt(8)
    s_and_b32 s36, s29, 6
    s_cmp_eq_u32 s36, 2
    s_cbranch_scc1 pr_15
    s_call_b64 s[76:77], SUB_park2
pr_15:
    s_call_b64 s[76:77], SUB_w1_put
FR_end:
LAYER:
    v_lshlrev_b32 v40, 6, v199
    v_add_u32 v40, 161792, v40
    s_lshl_b32 s35, s30, 3
    v_add_u32 v39, s35, v40
    s_cmp_eq_u32 s60, 0
    s_cbranch_scc1 R_l0
    s_sub_u32 s8, s62, 0x400000
    s_subb_u32 s9, s63, 0
    s_mov_b32 s10, 0x7e000
    s_mov_b32 s11, 0x20000
    s_sub_u32 s12, s62, 0x380000
    s_subb_u32 s13, s63, 0
    s_mov_b32 s14, 0x7e000
    s_mov_b32 s15, 0x20000
    s_mov_b32 s20, s62
    s_mov_b32 s21, s63
    s_mov_b32 s22, 0x7e000
    s_mov_b32 s23, 0x20000
    s_mov_b32 s78, 0x3f80
    s_mov_b32 s79, 0x3f800000
    v_lshlrev_b32 v222, 16, v230
    v_and_b32 v223, 0xffff0000, v230
    v_lshlrev_b32 v206, 16, v180
    v_and_b32 v207, 0xffff0000, v180
    v_lshlrev_b32 v12, 16, v188
    v_and_b32 v13, 0xffff0000, v188
    v_pk_add_f32 v[206:207], v[206:207], v[12:13]
    v_lshlrev_b32 v224, 16, v231
    v_and_b32 v225, 0xffff0000, v231
    v_lshlrev_b32 v208, 16, v181
    v_and_b32 v209, 0xffff0000, v181
    v_lshlrev_b32 v14, 16, v189
    v_and_b32 v15, 0xffff0000, v189
    v_pk_add_f32 v[208:209], v[208:209], v[14:15]
    v_lshlrev_b32 v226, 16, v232
    v_and_b32 v227, 0xffff0000, v232
    v_lshlrev_b32 v210, 16, v182
    v_and_b32 v211, 0xffff0000, v182
    v_lshlrev_b32 v16, 16, v190
    v_and_b32 v17, 0xffff0000, v190
    v_pk_add_f32 v[210:211], v[210:211], v[16:17]
    v_lshlrev_b32 v228, 16, v233
    v_and_b32 v229, 0xffff0000, v233
    v_lshlrev_b32 v212, 16, v183
    v_and_b32 v213, 0xffff0000, v183
    v_lshlrev_b32 v18, 16, v191
    v_and_b32 v19, 0xffff0000, v191
    v_pk_add_f32 v[212:213], v[212:213], v[18:19]
    v_lshlrev_b32 v230, 16, v234
    v_and_b32 v231, 0xffff0000, v234
    v_lshlrev_b32 v214, 16, v184
    v_and_b32 v215, 0xffff0000, v184
    v_lshlrev_b32 v20, 16, v192
    v_and_b32 v21, 0xffff0000, v192
    v_pk_add_f32 v[214:215], v[214:215], v[20:21]
    v_lshlrev_b32 v232, 16, v235
    v_and_b32 v233, 0xffff0000, v235
    v_lshlrev_b32 v216, 16, v185
    v_and_b32 v217, 0xffff0000, v185
    v_lshlrev_b32 v22, 16, v193
    v_and_b32 v23, 0xffff0000, v193
    v_pk_add_f32 v[216:217], v[216:217], v[22:23]
    v_lshlrev_b32 v234, 16, v236
    v_and_b32 v235, 0xffff0000, v236
    v_lshlrev_b32 v218, 16, v186
    v_and_b32 v219, 0xffff0000, v186
    v_lshlrev_b32 v24, 16, v194
    v_and_b32 v25, 0xffff0000, v194
    v_pk_add_f32 v[218:219], v[218:219], v[24:25]
    v_lshlrev_b32 v236, 16, v237
    v_and_b32 v237, 0xffff0000, v237
    v_lshlrev_b32 v220, 16, v187
    v_and_b32 v221, 0xffff0000, v187
    v_lshlrev_b32 v26, 16, v195
    v_and_b32 v27, 0xffff0000, v195
    v_pk_add_f32 v[220:221], v[220:221], v[26:27]
    s_mov_b32 s53, 0
    s_sleep 10
    s_cmp_ge_u32 s30, 6
    s_cbranch_scc1 dp_16
    s_sleep 14
dp_16:
    buffer_load_dwordx4 v[180:183], v196, s[8:11], 0 offen offset:0 sc1
    buffer_load_dwordx4 v[188:191], v196, s[12:15], 0 offen offset:0 sc1
    buffer_load_dwordx4 v[184:187], v196, s[8:11], 0 offen offset:2048 sc1
    buffer_load_dwordx4 v[192:195], v196, s[12:15], 0 offen offset:2048 sc1
    s_waitcnt vmcnt(0)
    v_bitop3_b32 v6, v180, v184, v188 bitop3:0x80
    v_bitop3_b32 v6, v6, v192, 1 bitop3:0x80
    v_cmp_eq_u32 vcc, 0, v6
    s_cbranch_vccz dq_17
    s_sleep 4
    s_add_u32 s53, s53, 1
    s_cmp_lt_u32 s53, s61
    s_cbranch_scc1 dp_16
    s_mov_b32 s61, 0
dq_17:
    v_dot2_f32_bf16 v206, v180, s78, v206
    v_dot2_f32_bf16 v207, v180, s79, v207
    v_dot2_f32_bf16 v208, v181, s78, v208
    v_dot2_f32_bf16 v209, v181, s79, v209
    v_dot2_f32_bf16 v210, v182, s78, v210
    v_dot2_f32_bf16 v211, v182, s79, v211
    v_dot2_f32_bf16 v212, v183, s78, v212
    v_dot2_f32_bf16 v213, v183, s79, v213
    v_dot2_f32_bf16 v214, v184, s78, v214
    v_dot2_f32_bf16 v215, v184, s79, v215
    v_dot2_f32_bf16 v216, v185, s78, v216
    v_dot2_f32_bf16 v217, v185, s79, v217
    v_dot2_f32_bf16 v218, v186, s78, v218
    v_dot2_f32_bf16 v219, v186, s79, v219
    v_dot2_f32_bf16 v220, v187, s78, v220
    v_dot2_f32_bf16 v221, v187, s79, v221
    v_dot2_f32_bf16 v206, v188, s78, v206
    v_dot2_f32_bf16 v207, v188, s79, v207
    v_dot2_f32_bf16 v208, v189, s78, v208
    v_dot2_f32_bf16 v209, v189, s79, v209
    v_dot2_f32_bf16 v210, v190, s78, v210
    v_dot2_f32_bf16 v211, v190, s79, v211
    v_dot2_f32_bf16 v212, v191, s78, v212
    v_dot2_f32_bf16 v213, v191, s79, v213
    v_dot2_f32_bf16 v214, v192, s78, v214
    v_dot2_f32_bf16 v215, v192, s79, v215
    v_dot2_f32_bf16 v216, v193, s78, v216
    v_dot2_f32_bf16 v217, v193, s79, v217
    v_dot2_f32_bf16 v218, v194, s78, v218
    v_dot2_f32_bf16 v219, v194, s79, v219
    v_dot2_f32_bf16 v220, v195, s78, v220
    v_dot2_f32_bf16 v221, v195, s79, v221
    s_nop 2
    v_pk_add_f32 v[32:33], v[206:207], v[208:209]
    v_pk_mul_f32 v[34:35], v[206:207], v[206:207]
    v_pk_fma_f32 v[34:35], v[208:209], v[208:209], v[34:35]
    v_pk_add_f32 v[32:33], v[32:33], v[210:211]
    v_pk_fma_f32 v[34:35], v[210:211], v[210:211], v[34:35]
    v_pk_add_f32 v[32:33], v[32:33], v[212:213]
    v_pk_fma_f32 v[34:35], v[212:213], v[212:213], v[34:35]
    v_pk_add_f32 v[32:33], v[32:33], v[214:215]
    v_pk_fma_f32 v[34:35], v[214:215], v[214:215], v[34:35]
    v_pk_add_f32 v[32:33], v[32:33], v[216:217]
    v_pk_fma_f32 v[34:35], v[216:217], v[216:217], v[34:35]
    v_pk_add_f32 v[32:33], v[32:33], v[218:219]
    v_pk_fma_f32 v[34:35], v[218:219], v[218:219], v[34:35]
    v_pk_add_f32 v[32:33], v[32:33], v[220:221]
    v_pk_fma_f32 v[34:35], v[220:221], v[220:221], v[34:35]
    v_add_f32 v30, v32, v33
    v_add_f32 v31, v34, v35
    s_nop 0
    v_add_f32_dpp v30, v30, v30 row_ror:8 row_mask:0xf bank_mask:0xf
    v_add_f32_dpp v31, v31, v31 row_ror:8 row_mask:0xf bank_mask:0xf
    v_mov_b32 v32, v30
    v_mov_b32 v33, v31
    s_nop 0
    v_permlane16_swap_b32 v30, v32
    v_permlane16_swap_b32 v31, v33
    v_pk_add_f32 v[30:31], v[30:31], v[32:33]
    v_mov_b32 v32, v30
    v_mov_b32 v33, v31
    s_nop 0
    v_permlane32_swap_b32 v30, v32
    v_permlane32_swap_b32 v31, v33
    v_pk_add_f32 v[30:31], v[30:31], v[32:33]
    ds_write_b64 v39, v[30:31] offset:0
    s_waitcnt lgkmcnt(0)
    s_barrier
    ds_read_b128 v[12:15], v40 offset:0
    ds_read_b128 v[16:19], v40 offset:16
    ds_read_b128 v[20:23], v40 offset:32
    ds_read_b128 v[24:27], v40 offset:48
    s_waitcnt lgkmcnt(0)
    v_pk_add_f32 v[12:13], v[12:13], v[14:15]
    v_pk_add_f32 v[16:17], v[16:17], v[18:19]
    v_pk_add_f32 v[20:21], v[20:21], v[22:23]
    v_pk_add_f32 v[24:25], v[24:25], v[26:27]
    v_pk_add_f32 v[12:13], v[12:13], v[16:17]
    v_pk_add_f32 v[20:21], v[20:21], v[24:25]
    v_pk_add_f32 v[12:13], v[12:13], v[20:21]
    v_mul_f32 v36, 0x3a800000, v12
    v_mul_f32 v38, 0x3a800000, v13
    v_fma_f32 v38, -v36, v36, v38
    v_max_f32 v38, 0, v38
    v_add_f32 v38, 0x3727c5ac, v38
    v_rsq_f32 v37, v38
    s_nop 0
    v_mul_f32 v36, v36, v37
    v_pk_fma_f32 v[12:13], v[206:207], v[36:37], v[36:37] op_sel:[0,1,0] op_sel_hi:[1,1,0] neg_lo:[0,0,1] neg_hi:[0,0,1]
    v_pk_fma_f32 v[14:15], v[208:209], v[36:37], v[36:37] op_sel:[0,1,0] op_sel_hi:[1,1,0] neg_lo:[0,0,1] neg_hi:[0,0,1]
    v_pk_fma_f32 v[16:17], v[210:211], v[36:37], v[36:37] op_sel:[0,1,0] op_sel_hi:[1,1,0] neg_lo:[0,0,1] neg_hi:[0,0,1]
    v_pk_fma_f32 v[18:19], v[212:213], v[36:37], v[36:37] op_sel:[0,1,0] op_sel_hi:[1,1,0] neg_lo:[0,0,1] neg_hi:[0,0,1]
    v_pk_fma_f32 v[20:21], v[214:215], v[36:37], v[36:37] op_sel:[0,1,0] op_sel_hi:[1,1,0] neg_lo:[0,0,1] neg_hi:[0,0,1]
    v_pk_fma_f32 v[22:23], v[216:217], v[36:37], v[36:37] op_sel:[0,1,0] op_sel_hi:[1,1,0] neg_lo:[0,0,1] neg_hi:[0,0,1]
    v_pk_fma_f32 v[24:25], v[218:219], v[36:37], v[36:37] op_sel:[0,1,0] op_sel_hi:[1,1,0] neg_lo:[0,0,1] neg_hi:[0,0,1]
    v_pk_fma_f32 v[26:27], v[220:221], v[36:37], v[36:37] op_sel:[0,1,0] op_sel_hi:[1,1,0] neg_lo:[0,0,1] neg_hi:[0,0,1]
    v_pk_fma_f32 v[206:207], v[12:13], v[222:223], v[206:207]
    v_cvt_pk_bf16_f32 v180, v206, v207
    v_pk_fma_f32 v[208:209], v[14:15], v[224:225], v[208:209]
    v_cvt_pk_bf16_f32 v181, v208, v209
    v_and_b32 v180, -2, v180
    v_pk_fma_f32 v[210:211], v[16:17], v[226:227], v[210:211]
    v_cvt_pk_bf16_f32 v182, v210, v211
    v_pk_fma_f32 v[212:213], v[18:19], v[228:229], v[212:213]
    v_cvt_pk_bf16_f32 v183, v212, v213
    buffer_store_dwordx4 v[180:183], v196, s[20:23], 0 offen offset:0 sc1
    v_pk_fma_f32 v[214:215], v[20:21], v[230:231], v[214:215]
    v_cvt_pk_bf16_f32 v184, v214, v215
    v_pk_fma_f32 v[216:217], v[22:23], v[232:233], v[216:217]
    v_cvt_pk_bf16_f32 v185, v216, v217
    v_and_b32 v184, -2, v184
    v_pk_fma_f32 v[218:219], v[24:25], v[234:235], v[218:219]
    v_cvt_pk_bf16_f32 v186, v218, v219
    v_pk_fma_f32 v[220:221], v[26:27], v[236:237], v[220:221]
    v_cvt_pk_bf16_f32 v187, v220, v221
    buffer_store_dwordx4 v[184:187], v196, s[20:23], 0 offen offset:2048 sc1
    s_branch R_s2
R_l0:
    v_lshlrev_b32 v206, 16, v180
    v_and_b32 v207, 0xffff0000, v180
    v_lshlrev_b32 v208, 16, v181
    v_and_b32 v209, 0xffff0000, v181
    v_lshlrev_b32 v210, 16, v182
    v_and_b32 v211, 0xffff0000, v182
    v_lshlrev_b32 v212, 16, v183
    v_and_b32 v213, 0xffff0000, v183
    v_lshlrev_b32 v214, 16, v184
    v_and_b32 v215, 0xffff0000, v184
    v_lshlrev_b32 v216, 16, v185
    v_and_b32 v217, 0xffff0000, v185
    v_lshlrev_b32 v218, 16, v186
    v_and_b32 v219, 0xffff0000, v186
    v_lshlrev_b32 v220, 16, v187
    v_and_b32 v221, 0xffff0000, v187
    v_pk_add_f32 v[32:33], v[206:207], v[208:209]
    v_pk_mul_f32 v[34:35], v[206:207], v[206:207]
    v_pk_fma_f32 v[34:35], v[208:209], v[208:209], v[34:35]
    v_pk_add_f32 v[32:33], v[32:33], v[210:211]
    v_pk_fma_f32 v[34:35], v[210:211], v[210:211], v[34:35]
    v_pk_add_f32 v[32:33], v[32:33], v[212:213]
    v_pk_fma_f32 v[34:35], v[212:213], v[212:213], v[34:35]
    v_pk_add_f32 v[32:33], v[32:33], v[214:215]
    v_pk_fma_f32 v[34:35], v[214:215], v[214:215], v[34:35]
    v_pk_add_f32 v[32:33], v[32:33], v[216:217]
    v_pk_fma_f32 v[34:35], v[216:217], v[216:217], v[34:35]
    v_pk_add_f32 v[32:33], v[32:33], v[218:219]
    v_pk_fma_f32 v[34:35], v[218:219], v[218:219], v[34:35]
    v_pk_add_f32 v[32:33], v[32:33], v[220:221]
    v_pk_fma_f32 v[34:35], v[220:221], v[220:221], v[34:35]
    v_add_f32 v30, v32, v33
    v_add_f32 v31, v34, v35
    s_nop 0
    v_add_f32_dpp v30, v30, v30 row_ror:8 row_mask:0xf bank_mask:0xf
    v_add_f32_dpp v31, v31, v31 row_ror:8 row_mask:0xf bank_mask:0xf
    v_mov_b32 v32, v30
    v_mov_b32 v33, v31
    s_nop 0
    v_permlane16_swap_b32 v30, v32
    v_permlane16_swap_b32 v31, v33
    v_pk_add_f32 v[30:31], v[30:31], v[32:33]
    v_mov_b32 v32, v30
    v_mov_b32 v33, v31
    s_nop 0
    v_permlane32_swap_b32 v30, v32
    v_permlane32_swap_b32 v31, v33
    v_pk_add_f32 v[30:31], v[30:31], v[32:33]
    ds_write_b64 v39, v[30:31] offset:0
    s_waitcnt lgkmcnt(0)
    v_mov_b32 v222, 162844
spin_18:
    ds_read_b32 v223, v222
    s_waitcnt lgkmcnt(0)
    v_readfirstlane_b32 s94, v223
    s_nop 0
    s_cmp_ge_u32 s94, 65536
    s_cbranch_scc0 spin_18
    s_cmp_gt_u32 s94, 65546
    s_cselect_b32 s94, 1, 0
    s_lshl_b32 s53, s94, 13
    v_xor_b32 v197, s53, v197
    s_lshr_b32 s53, s28, 3
    s_lshl_b32 s53, s53, 2
    s_and_b32 s54, s28, 3
    s_add_u32 s53, s53, s54
    s_lshl_b32 s53, s53, 24
    s_lshr_b32 s54, s28, 2
    s_xor_b32 s54, s54, s94
    s_and_b32 s54, s54, 1
    s_lshl_b32 s54, s54, 13
    s_add_u32 s36, s53, s54
    s_add_u32 s36, s36, 33554432
    s_lshr_b32 s53, s53, 14
    s_add_u32 s36, s53, s54
    s_xor_b32 s36, s36, 8192
    s_add_u32 s36, s36, 23101440
    s_lshl_b32 s53, s30, 7
    s_add_u32 s36, s36, s53
    v_mov_b32 v226, s36
    s_waitcnt vmcnt(0)
    s_barrier
    s_mov_b32 s53, 0
    s_add_u32 s54, s52, 32
    s_bfm_b64 exec, 1, 0
poll_19:
    buffer_load_dword v222, v226, s[56:59], 0 offen sc1
    s_waitcnt vmcnt(0)
    v_xor_b32 v222, s54, v222
    v_cmp_eq_u32 vcc, 0, v222
    s_nop 0
    s_cmp_eq_u64 vcc, exec
    s_cbranch_scc1 pok_20
    s_sleep 6
    s_add_u32 s53, s53, 1
    s_cmp_lt_u32 s53, s61
    s_cbranch_scc1 poll_19
    s_mov_b32 s61, 0
pok_20:
    s_mov_b64 exec, -1
    s_add_u32 s80, s4, 0x2100000
    s_addc_u32 s81, s5, 0
    s_mov_b32 s82, 0x7f00000
    s_mov_b32 s83, 0x20000
    s_mov_b32 s78, 0
    buffer_load_dwordx2 v[230:231], v197, s[80:83], s78 offen sc1
    s_mov_b32 s78, 2048
    buffer_load_dwordx2 v[232:233], v197, s[80:83], s78 offen sc1
    s_mov_b32 s78, 16384
    buffer_load_dwordx2 v[234:235], v197, s[80:83], s78 offen sc1
    s_mov_b32 s78, 18432
    buffer_load_dwordx2 v[236:237], v197, s[80:83], s78 offen sc1
    s_lshr_b32 s53, s28, 3
    s_lshl_b32 s53, s53, 2
    s_and_b32 s54, s28, 3
    s_add_u32 s53, s53, s54
    s_lshl_b32 s53, s53, 24
    s_lshr_b32 s54, s28, 2
    s_xor_b32 s54, s54, s94
    s_and_b32 s54, s54, 1
    s_lshl_b32 s54, s54, 13
    s_add_u32 s55, s53, s54
    s_add_u32 s55, s55, 33554432
    s_add_u32 s62, s4, s55
    s_addc_u32 s63, s5, 0
    s_sub_u32 s36, s28, 1
    s_max_i32 s36, s36, 0
    s_lshr_b32 s53, s36, 3
    s_lshl_b32 s53, s53, 2
    s_and_b32 s54, s36, 3
    s_add_u32 s53, s53, s54
    s_lshl_b32 s53, s53, 24
    s_lshr_b32 s54, s36, 2
    s_xor_b32 s54, s54, s94
    s_and_b32 s54, s54, 1
    s_lshl_b32 s54, s54, 13
    s_add_u32 s92, s53, s54
    s_add_u32 s92, s92, 33554432
    s_sub_u32 s92, s92, s55
    s_add_u32 s36, s28, 1
    s_min_u32 s36, s36, 15
    s_lshr_b32 s53, s36, 3
    s_lshl_b32 s53, s53, 2
    s_and_b32 s54, s36, 3
    s_add_u32 s53, s53, s54
    s_lshl_b32 s53, s53, 24
    s_lshr_b32 s54, s36, 2
    s_xor_b32 s54, s54, s94
    s_and_b32 s54, s54, 1
    s_lshl_b32 s54, s54, 13
    s_add_u32 s93, s53, s54
    s_add_u32 s93, s93, 33554432
    s_sub_u32 s93, s93, s55
    s_add_u32 s55, s55, 6029312
    s_mov_b32 s20, s62
    s_mov_b32 s21, s63
    s_mov_b32 s22, 0x7e000
    s_mov_b32 s23, 0x20000
    ds_read_b128 v[12:15], v40 offset:0
    ds_read_b128 v[16:19], v40 offset:16
    ds_read_b128 v[20:23], v40 offset:32
    ds_read_b128 v[24:27], v40 offset:48
    s_waitcnt lgkmcnt(0)
    v_pk_add_f32 v[12:13], v[12:13], v[14:15]
    v_pk_add_f32 v[16:17], v[16:17], v[18:19]
    v_pk_add_f32 v[20:21], v[20:21], v[22:23]
    v_pk_add_f32 v[24:25], v[24:25], v[26:27]
    v_pk_add_f32 v[12:13], v[12:13], v[16:17]
    v_pk_add_f32 v[20:21], v[20:21], v[24:25]
    v_pk_add_f32 v[12:13], v[12:13], v[20:21]
    v_mul_f32 v36, 0x3a800000, v12
    v_mul_f32 v38, 0x3a800000, v13
    v_fma_f32 v38, -v36, v36, v38
    v_max_f32 v38, 0, v38
    v_add_f32 v38, 0x3727c5ac, v38
    v_rsq_f32 v37, v38
    s_nop 0
    v_pk_add_f32 v[12:13], v[206:207], v[36:37] op_sel_hi:[1,0] neg_lo:[0,1] neg_hi:[0,1]
    v_pk_mul_f32 v[12:13], v[12:13], v[36:37] op_sel:[0,1] op_sel_hi:[1,1]
    v_pk_add_f32 v[14:15], v[208:209], v[36:37] op_sel_hi:[1,0] neg_lo:[0,1] neg_hi:[0,1]
    v_pk_mul_f32 v[14:15], v[14:15], v[36:37] op_sel:[0,1] op_sel_hi:[1,1]
    v_pk_add_f32 v[16:17], v[210:211], v[36:37] op_sel_hi:[1,0] neg_lo:[0,1] neg_hi:[0,1]
    v_pk_mul_f32 v[16:17], v[16:17], v[36:37] op_sel:[0,1] op_sel_hi:[1,1]
    v_pk_add_f32 v[18:19], v[212:213], v[36:37] op_sel_hi:[1,0] neg_lo:[0,1] neg_hi:[0,1]
    v_pk_mul_f32 v[18:19], v[18:19], v[36:37] op_sel:[0,1] op_sel_hi:[1,1]
    v_pk_add_f32 v[20:21], v[214:215], v[36:37] op_sel_hi:[1,0] neg_lo:[0,1] neg_hi:[0,1]
    v_pk_mul_f32 v[20:21], v[20:21], v[36:37] op_sel:[0,1] op_sel_hi:[1,1]
    v_pk_add_f32 v[22:23], v[216:217], v[36:37] op_sel_hi:[1,0] neg_lo:[0,1] neg_hi:[0,1]
    v_pk_mul_f32 v[22:23], v[22:23], v[36:37] op_sel:[0,1] op_sel_hi:[1,1]
    v_pk_add_f32 v[24:25], v[218:219], v[36:37] op_sel_hi:[1,0] neg_lo:[0,1] neg_hi:[0,1]
    v_pk_mul_f32 v[24:25], v[24:25], v[36:37] op_sel:[0,1] op_sel_hi:[1,1]
    v_pk_add_f32 v[26:27], v[220:221], v[36:37] op_sel_hi:[1,0] neg_lo:[0,1] neg_hi:[0,1]
    v_pk_mul_f32 v[26:27], v[26:27], v[36:37] op_sel:[0,1] op_sel_hi:[1,1]
    s_barrier
    s_waitcnt vmcnt(0)
    v_lshlrev_b32 v222, 16, v230
    v_and_b32 v223, 0xffff0000, v230
    v_pk_fma_f32 v[206:207], v[12:13], v[222:223], v[206:207]
    v_cvt_pk_bf16_f32 v180, v206, v207
    v_lshlrev_b32 v222, 16, v231
    v_and_b32 v223, 0xffff0000, v231
    v_pk_fma_f32 v[208:209], v[14:15], v[222:223], v[208:209]
    v_cvt_pk_bf16_f32 v181, v208, v209
    v_and_b32 v180, -2, v180
    v_lshlrev_b32 v222, 16, v232
    v_and_b32 v223, 0xffff0000, v232
    v_pk_fma_f32 v[210:211], v[16:17], v[222:223], v[210:211]
    v_cvt_pk_bf16_f32 v182, v210, v211
    v_lshlrev_b32 v222, 16, v233
    v_and_b32 v223, 0xffff0000, v233
    v_pk_fma_f32 v[212:213], v[18:19], v[222:223], v[212:213]
    v_cvt_pk_bf16_f32 v183, v212, v213
    buffer_store_dwordx4 v[180:183], v196, s[20:23], 0 offen offset:0 sc1
    v_lshlrev_b32 v222, 16, v234
    v_and_b32 v223, 0xffff0000, v234
    v_pk_fma_f32 v[214:215], v[20:21], v[222:223], v[214:215]
    v_cvt_pk_bf16_f32 v184, v214, v215
    v_lshlrev_b32 v222, 16, v235
    v_and_b32 v223, 0xffff0000, v235
    v_pk_fma_f32 v[216:217], v[22:23], v[222:223], v[216:217]
    v_cvt_pk_bf16_f32 v185, v216, v217
    v_and_b32 v184, -2, v184
    v_lshlrev_b32 v222, 16, v236
    v_and_b32 v223, 0xffff0000, v236
    v_pk_fma_f32 v[218:219], v[24:25], v[222:223], v[218:219]
    v_cvt_pk_bf16_f32 v186, v218, v219
    v_lshlrev_b32 v222, 16, v237
    v_and_b32 v223, 0xffff0000, v237
    v_pk_fma_f32 v[220:221], v[26:27], v[222:223], v[220:221]
    v_cvt_pk_bf16_f32 v187, v220, v221
    buffer_store_dwordx4 v[184:187], v196, s[20:23], 0 offen offset:2048 sc1
R_s2:
    v_lshlrev_b32 v206, 16, v180
    v_and_b32 v207, 0xffff0000, v180
    v_lshlrev_b32 v208, 16, v181
    v_and_b32 v209, 0xffff0000, v181
    v_lshlrev_b32 v210, 16, v182
    v_and_b32 v211, 0xffff0000, v182
    v_lshlrev_b32 v212, 16, v183
    v_and_b32 v213, 0xffff0000, v183
    v_lshlrev_b32 v214, 16, v184
    v_and_b32 v215, 0xffff0000, v184
    v_lshlrev_b32 v216, 16, v185
    v_and_b32 v217, 0xffff0000, v185
    v_lshlrev_b32 v218, 16, v186
    v_and_b32 v219, 0xffff0000, v186
    v_lshlrev_b32 v220, 16, v187
    v_and_b32 v221, 0xffff0000, v187
    v_pk_add_f32 v[32:33], v[206:207], v[208:209]
    v_pk_mul_f32 v[34:35], v[206:207], v[206:207]
    v_pk_fma_f32 v[34:35], v[208:209], v[208:209], v[34:35]
    v_pk_add_f32 v[32:33], v[32:33], v[210:211]
    v_pk_fma_f32 v[34:35], v[210:211], v[210:211], v[34:35]
    v_pk_add_f32 v[32:33], v[32:33], v[212:213]
    v_pk_fma_f32 v[34:35], v[212:213], v[212:213], v[34:35]
    v_pk_add_f32 v[32:33], v[32:33], v[214:215]
    v_pk_fma_f32 v[34:35], v[214:215], v[214:215], v[34:35]
    v_pk_add_f32 v[32:33], v[32:33], v[216:217]
    v_pk_fma_f32 v[34:35], v[216:217], v[216:217], v[34:35]
    v_pk_add_f32 v[32:33], v[32:33], v[218:219]
    v_pk_fma_f32 v[34:35], v[218:219], v[218:219], v[34:35]
    v_pk_add_f32 v[32:33], v[32:33], v[220:221]
    v_pk_fma_f32 v[34:35], v[220:221], v[220:221], v[34:35]
    v_add_f32 v30, v32, v33
    v_add_f32 v31, v34, v35
    s_nop 0
    v_add_f32_dpp v30, v30, v30 row_ror:8 row_mask:0xf bank_mask:0xf
    v_add_f32_dpp v31, v31, v31 row_ror:8 row_mask:0xf bank_mask:0xf
    v_mov_b32 v32, v30
    v_mov_b32 v33, v31
    s_nop 0
    v_permlane16_swap_b32 v30, v32
    v_permlane16_swap_b32 v31, v33
    v_pk_add_f32 v[30:31], v[30:31], v[32:33]
    v_mov_b32 v32, v30
    v_mov_b32 v33, v31
    s_nop 0
    v_permlane32_swap_b32 v30, v32
    v_permlane32_swap_b32 v31, v33
    v_pk_add_f32 v[30:31], v[30:31], v[32:33]
    ds_write_b64 v39, v[30:31] offset:512
    s_waitcnt lgkmcnt(0)
    s_barrier
    s_cmp_lg_u32 s30, 6
    s_cbranch_scc1 R_n6
    s_cmp_lg_u32 s60, 0
    s_cbranch_scc1 R_n6
    s_lshl_b32 s53, s29, 7
    s_add_u32 s53, s53, 23121920
    v_mov_b32 v8, 1
    v_mov_b32 v9, 0
    s_mov_b64 exec, 1
    buffer_atomic_add v8, v9, s[56:59], s53 offen sc1
    s_mov_b64 exec, -1
R_n6:
    s_cmp_lg_u32 s30, 7
    s_cbranch_scc1 R_nl
    ds_read_b128 v[12:15], v40 offset:512
    ds_read_b128 v[16:19], v40 offset:528
    ds_read_b128 v[20:23], v40 offset:544
    ds_read_b128 v[24:27], v40 offset:560
    s_waitcnt lgkmcnt(0)
    v_pk_add_f32 v[12:13], v[12:13], v[14:15]
    v_pk_add_f32 v[16:17], v[16:17], v[18:19]
    v_pk_add_f32 v[20:21], v[20:21], v[22:23]
    v_pk_add_f32 v[24:25], v[24:25], v[26:27]
    v_pk_add_f32 v[12:13], v[12:13], v[16:17]
    v_pk_add_f32 v[20:21], v[20:21], v[24:25]
    v_pk_add_f32 v[12:13], v[12:13], v[20:21]
    v_mul_f32 v36, 0x3a800000, v12
    v_mul_f32 v38, 0x3a800000, v13
    v_fma_f32 v38, -v36, v36, v38
    v_max_f32 v38, 0, v38
    v_mov_b32 v42, v36
    v_mov_b32 v43, v38
    v_add_f32 v38, 0x3727c5ac, v38
    v_sqrt_f32 v38, v38
    s_nop 0
    v_mov_b32 v41, v38
    v_rcp_f32 v37, v38
    v_sub_f32 v42, v42, v36
    v_mul_f32 v42, v42, v37
    v_mul_f32 v43, v43, v37
    v_mul_f32 v43, v43, v37
    v_add_f32 v43, 0x3727c5ac, v43
    v_rsq_f32 v44, v43
    v_mov_b32 v224, v36
    v_mov_b32 v225, v37
    v_fma_f32 v226, v42, v41, v36
    v_mul_f32 v227, v37, v44
    s_add_u32 s24, s62, 0x5d0000
    s_addc_u32 s25, s63, 0
    s_mov_b32 s26, 0x800
    s_mov_b32 s27, 0x20000
    s_lshl_b32 s36, s29, 3
    v_add_u32 v6, s36, v199
    v_lshlrev_b32 v6, 4, v6
    s_mov_b64 exec, 0xff
    buffer_store_dwordx4 v[224:227], v6, s[24:27], 0 offen sc1
    s_mov_b64 exec, -1
    s_add_u32 s53, s55, 1280
    v_mov_b32 v8, 1
    v_mov_b32 v9, 162816
    v_mov_b32 v11, 0
    s_mov_b64 exec, 1
    s_waitcnt vmcnt(0)
    buffer_atomic_add v8, v11, s[56:59], s53 offen sc1
pub_21:
    s_mov_b64 exec, -1
R_nl:
    s_cmp_ge_u32 s30, 4
    s_cbranch_scc1 LOADERS
    s_setprio 1
    s_mov_b32 s8, s62
    s_mov_b32 s9, s63
    s_mov_b32 s10, 0x7e000
    s_mov_b32 s11, 0x20000
    v_add_u32 v126, 0, v2
    v_add_u32 v127, 65536, v2
    s_lshl_b32 s44, s30, 17
    s_mov_b32 s34, s30
    s_mov_b32 s35, 0
    v_and_b32 v22, 15, v1
    v_lshrrev_b32 v23, 4, v1
    s_mul_i32 s37, s34, 2
    s_mul_i32 s38, s99, 4
    s_mul_i32 s36, s35, 4
    s_add_u32 s38, s38, s36
    v_add_u32 v128, 4096, v2
    v_add_u32 v129, 69632, v2
    s_add_u32 s45, s44, 16384
    s_add_u32 s46, s44, 32768
    s_add_u32 s47, s44, 49152
    v_lshrrev_b32 v6, 2, v1
    v_mul_u32_u24 v13, 128, v6
    v_and_b32 v7, 3, v1
    v_lshl_add_u32 v13, v7, 3, v13
    v_add_u32 v13, 24576, v13
    v_bfe_u32 v6, v6, 1, 2
    s_mul_i32 s36, s35, 4
    s_add_u32 s36, s36, 3
    v_xor_b32 v7, s36, v6
    v_lshl_add_u32 v16, v7, 5, v13
    s_mul_i32 s36, s35, 4
    s_add_u32 s36, s36, 2
    v_xor_b32 v7, s36, v6
    v_lshl_add_u32 v15, v7, 5, v13
    s_mul_i32 s36, s35, 4
    s_add_u32 s36, s36, 1
    v_xor_b32 v7, s36, v6
    v_lshl_add_u32 v14, v7, 5, v13
    s_mul_i32 s36, s35, 4
    s_add_u32 s36, s36, 0
    v_xor_b32 v7, s36, v6
    v_lshl_add_u32 v13, v7, 5, v13
    v_pk_mov_b32 v[24:25], 0, 0
    v_pk_mov_b32 v[26:27], 0, 0
    v_pk_mov_b32 v[28:29], 0, 0
    v_pk_mov_b32 v[30:31], 0, 0
    v_pk_mov_b32 v[32:33], 0, 0
    v_pk_mov_b32 v[34:35], 0, 0
    v_pk_mov_b32 v[36:37], 0, 0
    v_pk_mov_b32 v[38:39], 0, 0
    v_pk_mov_b32 v[40:41], 0, 0
    v_pk_mov_b32 v[42:43], 0, 0
    v_pk_mov_b32 v[44:45], 0, 0
    v_pk_mov_b32 v[46:47], 0, 0
    v_pk_mov_b32 v[48:49], 0, 0
    v_pk_mov_b32 v[50:51], 0, 0
    v_pk_mov_b32 v[52:53], 0, 0
    v_pk_mov_b32 v[54:55], 0, 0
    s_mov_b32 s43, 0
    s_mul_i32 s36, s35, 256
    s_add_u32 s36, s36, 163328
    v_lshlrev_b32 v6, 4, v23
    v_add_u32 v6, s36, v6
    s_lshl_b32 s36, s37, 8
    s_add_u32 s36, s36, 160776
    v_lshlrev_b32 v7, 4, v22
    v_add_u32 v7, s36, v7
    s_add_u32 s16, s62, 0x100000
    s_addc_u32 s17, s63, 0
    s_mov_b32 s18, 0x7e000
    s_mov_b32 s19, 0x20000
    v_lshlrev_b32 v12, 11, v23
    v_lshl_add_u32 v12, v22, 4, v12
    s_lshl_b32 s39, s38, 13
    s_lshl_b32 s36, s37, 8
    s_add_u32 s39, s39, s36
    s_add_u32 s40, s39, 16384
    s_lshl_b32 s36, s29, 1
    s_lshr_b32 s53, s36, 3
    s_lshl_b32 s53, s53, 14
    s_and_b32 s41, s36, 7
    s_lshl_b32 s41, s41, 10
    s_add_u32 s41, s41, s53
    s_lshl_b32 s36, s37, 16
    s_add_u32 s41, s41, s36
    s_mov_b32 s53, 0
    s_mov_b32 s49, s44
    ds_read_b64_tr_b16 v[56:57], v13 offset:0
    ds_read_b64_tr_b16 v[58:59], v13 offset:2048
    ds_read_b64_tr_b16 v[60:61], v14 offset:0
    ds_read_b64_tr_b16 v[62:63], v14 offset:2048
    ds_read_b64_tr_b16 v[64:65], v15 offset:0
    ds_read_b64_tr_b16 v[66:67], v15 offset:2048
    ds_read_b64_tr_b16 v[68:69], v16 offset:0
    ds_read_b64_tr_b16 v[70:71], v16 offset:2048
    ds_read_b64_tr_b16 v[72:73], v13 offset:4096
    ds_read_b64_tr_b16 v[74:75], v13 offset:6144
    ds_read_b64_tr_b16 v[76:77], v14 offset:4096
    ds_read_b64_tr_b16 v[78:79], v14 offset:6144
    ds_read_b64_tr_b16 v[80:81], v15 offset:4096
    ds_read_b64_tr_b16 v[82:83], v15 offset:6144
    ds_read_b64_tr_b16 v[84:85], v16 offset:4096
    ds_read_b64_tr_b16 v[86:87], v16 offset:6144
dm_22p:
    buffer_load_dwordx4 v[164:167], v126, s[8:11], s44 offen offset:0 sc1
    buffer_load_dwordx4 v[168:171], v127, s[8:11], s44 offen offset:0 sc1
    buffer_load_dwordx4 v[172:175], v126, s[8:11], s44 offen offset:1024 sc1
    buffer_load_dwordx4 v[176:179], v127, s[8:11], s44 offen offset:1024 sc1
    buffer_load_dwordx4 v[180:183], v126, s[8:11], s44 offen offset:2048 sc1
    buffer_load_dwordx4 v[184:187], v127, s[8:11], s44 offen offset:2048 sc1
    buffer_load_dwordx4 v[188:191], v126, s[8:11], s44 offen offset:3072 sc1
    buffer_load_dwordx4 v[192:195], v127, s[8:11], s44 offen offset:3072 sc1
dm_22w:
    s_waitcnt vmcnt(4)
    v_or3_b32 v17, v164, v168, v172
    v_bitop3_b32 v17, v17, v176, 1 bitop3:0xa8
    v_cmp_ne_u32 vcc, 0, v17
    s_cbranch_vccz dm_22q
dm_22r:
    s_sleep 2
    buffer_load_dwordx4 v[164:167], v126, s[8:11], s44 offen offset:0 sc1
    buffer_load_dwordx4 v[168:171], v127, s[8:11], s44 offen offset:0 sc1
    buffer_load_dwordx4 v[172:175], v126, s[8:11], s44 offen offset:1024 sc1
    buffer_load_dwordx4 v[176:179], v127, s[8:11], s44 offen offset:1024 sc1
    buffer_load_dwordx4 v[180:183], v126, s[8:11], s44 offen offset:2048 sc1
    buffer_load_dwordx4 v[184:187], v127, s[8:11], s44 offen offset:2048 sc1
    buffer_load_dwordx4 v[188:191], v126, s[8:11], s44 offen offset:3072 sc1
    buffer_load_dwordx4 v[192:195], v127, s[8:11], s44 offen offset:3072 sc1
    s_waitcnt vmcnt(4)
    v_or3_b32 v17, v164, v168, v172
    v_bitop3_b32 v17, v17, v176, 1 bitop3:0xa8
    v_cmp_ne_u32 vcc, 0, v17
    s_cbranch_vccz dm_22t
    s_add_u32 s53, s53, 1
    s_cmp_lt_u32 s53, s61
    s_cbranch_scc1 dm_22r
    s_mov_b32 s61, 0
    s_branch dm_22t
dm_22q:
dm_22t:
    buffer_load_dwordx4 v[196:199], v128, s[8:11], s44 offen offset:0 sc1
    buffer_load_dwordx4 v[200:203], v129, s[8:11], s44 offen offset:0 sc1
    buffer_load_dwordx4 v[204:207], v128, s[8:11], s44 offen offset:1024 sc1
    buffer_load_dwordx4 v[208:211], v129, s[8:11], s44 offen offset:1024 sc1
    buffer_load_dwordx4 v[212:215], v128, s[8:11], s44 offen offset:2048 sc1
    buffer_load_dwordx4 v[216:219], v129, s[8:11], s44 offen offset:2048 sc1
    s_waitcnt lgkmcnt(0)
dm_22:
    v_mfma_f32_16x16x32_bf16 v[24:27], v[56:59], v[164:167], v[24:27]
    ds_read_b64_tr_b16 v[88:89], v13 offset:8192
    buffer_load_dwordx4 v[220:223], v128, s[8:11], s44 offen offset:3072 sc1
    v_mfma_f32_16x16x32_bf16 v[40:43], v[56:59], v[168:171], v[40:43]
    ds_read_b64_tr_b16 v[90:91], v13 offset:10240
    buffer_load_dwordx4 v[224:227], v129, s[8:11], s44 offen offset:3072 sc1
    v_mfma_f32_16x16x32_bf16 v[44:47], v[60:63], v[168:171], v[44:47]
    ds_read_b64_tr_b16 v[92:93], v14 offset:8192
    s_mov_b32 s44, s45
    v_mfma_f32_16x16x32_bf16 v[28:31], v[60:63], v[164:167], v[28:31]
    ds_read_b64_tr_b16 v[94:95], v14 offset:10240
    s_mov_b32 s45, s46
    v_mfma_f32_16x16x32_bf16 v[32:35], v[64:67], v[164:167], v[32:35]
    ds_read_b64_tr_b16 v[96:97], v15 offset:8192
    s_mov_b32 s46, s47
    v_mfma_f32_16x16x32_bf16 v[48:51], v[64:67], v[168:171], v[48:51]
    ds_read_b64_tr_b16 v[98:99], v15 offset:10240
    s_mov_b32 s47, 1048576
    v_mfma_f32_16x16x32_bf16 v[52:55], v[68:71], v[168:171], v[52:55]
    ds_read_b64_tr_b16 v[100:101], v16 offset:8192
    v_mfma_f32_16x16x32_bf16 v[36:39], v[68:71], v[164:167], v[36:39]
    ds_read_b64_tr_b16 v[102:103], v16 offset:10240
    s_waitcnt lgkmcnt(8)
    v_mfma_f32_16x16x32_bf16 v[24:27], v[72:75], v[172:175], v[24:27]
    ds_read_b64_tr_b16 v[104:105], v13 offset:12288
    buffer_load_dwordx4 v[164:167], v126, s[8:11], s44 offen offset:0 sc1
    v_mfma_f32_16x16x32_bf16 v[40:43], v[72:75], v[176:179], v[40:43]
    ds_read_b64_tr_b16 v[106:107], v13 offset:14336
    buffer_load_dwordx4 v[168:171], v127, s[8:11], s44 offen offset:0 sc1
    v_mfma_f32_16x16x32_bf16 v[44:47], v[76:79], v[176:179], v[44:47]
    ds_read_b64_tr_b16 v[108:109], v14 offset:12288
    s_waitcnt vmcnt(10)
    v_mfma_f32_16x16x32_bf16 v[28:31], v[76:79], v[172:175], v[28:31]
    ds_read_b64_tr_b16 v[110:111], v14 offset:14336
    v_or3_b32 v17, v180, v184, v188
    v_mfma_f32_16x16x32_bf16 v[32:35], v[80:83], v[172:175], v[32:35]
    ds_read_b64_tr_b16 v[112:113], v15 offset:12288
    v_bitop3_b32 v17, v17, v192, 1 bitop3:0xa8
    v_mfma_f32_16x16x32_bf16 v[48:51], v[80:83], v[176:179], v[48:51]
    ds_read_b64_tr_b16 v[114:115], v15 offset:14336
    v_cmp_ne_u32 vcc, 0, v17
    v_mfma_f32_16x16x32_bf16 v[52:55], v[84:87], v[176:179], v[52:55]
    ds_read_b64_tr_b16 v[116:117], v16 offset:12288
    ds_read_b64_tr_b16 v[118:119], v16 offset:14336
    v_mfma_f32_16x16x32_bf16 v[36:39], v[84:87], v[172:175], v[36:39]
    s_waitcnt lgkmcnt(8)
    s_cbranch_vccnz dm_22f0
dm_22g0:
    v_mfma_f32_16x16x32_bf16 v[24:27], v[88:91], v[180:183], v[24:27]
    ds_read_b64_tr_b16 v[56:57], v13 offset:16384
    buffer_load_dwordx4 v[172:175], v126, s[8:11], s44 offen offset:1024 sc1
    v_mfma_f32_16x16x32_bf16 v[40:43], v[88:91], v[184:187], v[40:43]
    ds_read_b64_tr_b16 v[58:59], v13 offset:18432
    buffer_load_dwordx4 v[176:179], v127, s[8:11], s44 offen offset:1024 sc1
    v_mfma_f32_16x16x32_bf16 v[44:47], v[92:95], v[184:187], v[44:47]
    ds_read_b64_tr_b16 v[60:61], v14 offset:16384
    v_mfma_f32_16x16x32_bf16 v[28:31], v[92:95], v[180:183], v[28:31]
    ds_read_b64_tr_b16 v[62:63], v14 offset:18432
    v_mfma_f32_16x16x32_bf16 v[32:35], v[96:99], v[180:183], v[32:35]
    ds_read_b64_tr_b16 v[64:65], v15 offset:16384
    v_mfma_f32_16x16x32_bf16 v[48:51], v[96:99], v[184:187], v[48:51]
    ds_read_b64_tr_b16 v[66:67], v15 offset:18432
    v_mfma_f32_16x16x32_bf16 v[52:55], v[100:103], v[184:187], v[52:55]
    ds_read_b64_tr_b16 v[68:69], v16 offset:16384
    v_mfma_f32_16x16x32_bf16 v[36:39], v[100:103], v[180:183], v[36:39]
    ds_read_b64_tr_b16 v[70:71], v16 offset:18432
    s_waitcnt lgkmcnt(8)
    v_mfma_f32_16x16x32_bf16 v[24:27], v[104:107], v[188:191], v[24:27]
    ds_read_b64_tr_b16 v[72:73], v13 offset:20480
    buffer_load_dwordx4 v[180:183], v126, s[8:11], s44 offen offset:2048 sc1
    v_mfma_f32_16x16x32_bf16 v[40:43], v[104:107], v[192:195], v[40:43]
    ds_read_b64_tr_b16 v[74:75], v13 offset:22528
    buffer_load_dwordx4 v[184:187], v127, s[8:11], s44 offen offset:2048 sc1
    v_mfma_f32_16x16x32_bf16 v[44:47], v[108:111], v[192:195], v[44:47]
    ds_read_b64_tr_b16 v[76:77], v14 offset:20480
    s_waitcnt vmcnt(10)
    v_mfma_f32_16x16x32_bf16 v[28:31], v[108:111], v[188:191], v[28:31]
    ds_read_b64_tr_b16 v[78:79], v14 offset:22528
    v_or3_b32 v17, v196, v200, v204
    v_mfma_f32_16x16x32_bf16 v[32:35], v[112:115], v[188:191], v[32:35]
    ds_read_b64_tr_b16 v[80:81], v15 offset:20480
    v_bitop3_b32 v17, v17, v208, 1 bitop3:0xa8
    v_mfma_f32_16x16x32_bf16 v[48:51], v[112:115], v[192:195], v[48:51]
    ds_read_b64_tr_b16 v[82:83], v15 offset:22528
    v_cmp_ne_u32 vcc, 0, v17
    v_mfma_f32_16x16x32_bf16 v[52:55], v[116:119], v[192:195], v[52:55]
    ds_read_b64_tr_b16 v[84:85], v16 offset:20480
    ds_read_b64_tr_b16 v[86:87], v16 offset:22528
    v_mfma_f32_16x16x32_bf16 v[36:39], v[116:119], v[188:191], v[36:39]
    s_waitcnt lgkmcnt(8)
    s_cbranch_vccnz dm_22f1
dm_22g1:
    v_mfma_f32_16x16x32_bf16 v[24:27], v[56:59], v[196:199], v[24:27]
    ds_read_b64_tr_b16 v[88:89], v13 offset:24576
    buffer_load_dwordx4 v[188:191], v126, s[8:11], s44 offen offset:3072 sc1
    v_mfma_f32_16x16x32_bf16 v[40:43], v[56:59], v[200:203], v[40:43]
    ds_read_b64_tr_b16 v[90:91], v13 offset:26624
    buffer_load_dwordx4 v[192:195], v127, s[8:11], s44 offen offset:3072 sc1
    v_mfma_f32_16x16x32_bf16 v[44:47], v[60:63], v[200:203], v[44:47]
    ds_read_b64_tr_b16 v[92:93], v14 offset:24576
    v_mfma_f32_16x16x32_bf16 v[28:31], v[60:63], v[196:199], v[28:31]
    ds_read_b64_tr_b16 v[94:95], v14 offset:26624
    v_mfma_f32_16x16x32_bf16 v[32:35], v[64:67], v[196:199], v[32:35]
    ds_read_b64_tr_b16 v[96:97], v15 offset:24576
    s_add_u32 s43, s43, 1
    v_mfma_f32_16x16x32_bf16 v[48:51], v[64:67], v[200:203], v[48:51]
    ds_read_b64_tr_b16 v[98:99], v15 offset:26624
    v_mfma_f32_16x16x32_bf16 v[52:55], v[68:71], v[200:203], v[52:55]
    ds_read_b64_tr_b16 v[100:101], v16 offset:24576
    v_mfma_f32_16x16x32_bf16 v[36:39], v[68:71], v[196:199], v[36:39]
    ds_read_b64_tr_b16 v[102:103], v16 offset:26624
    s_waitcnt lgkmcnt(8)
    v_mfma_f32_16x16x32_bf16 v[24:27], v[72:75], v[204:207], v[24:27]
    ds_read_b64_tr_b16 v[104:105], v13 offset:28672
    buffer_load_dwordx4 v[196:199], v128, s[8:11], s44 offen offset:0 sc1
    v_mfma_f32_16x16x32_bf16 v[40:43], v[72:75], v[208:211], v[40:43]
    ds_read_b64_tr_b16 v[106:107], v13 offset:30720
    buffer_load_dwordx4 v[200:203], v129, s[8:11], s44 offen offset:0 sc1
    v_mfma_f32_16x16x32_bf16 v[44:47], v[76:79], v[208:211], v[44:47]
    ds_read_b64_tr_b16 v[108:109], v14 offset:28672
    s_waitcnt vmcnt(10)
    v_mfma_f32_16x16x32_bf16 v[28:31], v[76:79], v[204:207], v[28:31]
    ds_read_b64_tr_b16 v[110:111], v14 offset:30720
    v_add_u32 v13, 32768, v13
    v_or3_b32 v17, v212, v216, v220
    v_mfma_f32_16x16x32_bf16 v[32:35], v[80:83], v[204:207], v[32:35]
    ds_read_b64_tr_b16 v[112:113], v15 offset:28672
    v_add_u32 v14, 32768, v14
    v_bitop3_b32 v17, v17, v224, 1 bitop3:0xa8
    v_mfma_f32_16x16x32_bf16 v[48:51], v[80:83], v[208:211], v[48:51]
    ds_read_b64_tr_b16 v[114:115], v15 offset:30720
    v_add_u32 v15, 32768, v15
    v_cmp_ne_u32 vcc, 0, v17
    v_mfma_f32_16x16x32_bf16 v[52:55], v[84:87], v[208:211], v[52:55]
    ds_read_b64_tr_b16 v[116:117], v16 offset:28672
    ds_read_b64_tr_b16 v[118:119], v16 offset:30720
    s_cmp_eq_u32 s43, 4
    v_mfma_f32_16x16x32_bf16 v[36:39], v[84:87], v[204:207], v[36:39]
    v_add_u32 v16, 32768, v16
    s_waitcnt lgkmcnt(8)
    s_cbranch_vccnz dm_22f2
dm_22g2:
    s_cbranch_scc1 dm_22x
    v_mfma_f32_16x16x32_bf16 v[24:27], v[88:91], v[212:215], v[24:27]
    ds_read_b64_tr_b16 v[56:57], v13 offset:0
    buffer_load_dwordx4 v[204:207], v128, s[8:11], s44 offen offset:1024 sc1
    v_mfma_f32_16x16x32_bf16 v[40:43], v[88:91], v[216:219], v[40:43]
    ds_read_b64_tr_b16 v[58:59], v13 offset:2048
    buffer_load_dwordx4 v[208:211], v129, s[8:11], s44 offen offset:1024 sc1
    v_mfma_f32_16x16x32_bf16 v[44:47], v[92:95], v[216:219], v[44:47]
    ds_read_b64_tr_b16 v[60:61], v14 offset:0
    s_mov_b32 s49, s44
    v_mfma_f32_16x16x32_bf16 v[28:31], v[92:95], v[212:215], v[28:31]
    ds_read_b64_tr_b16 v[62:63], v14 offset:2048
    v_mfma_f32_16x16x32_bf16 v[32:35], v[96:99], v[212:215], v[32:35]
    ds_read_b64_tr_b16 v[64:65], v15 offset:0
    v_mfma_f32_16x16x32_bf16 v[48:51], v[96:99], v[216:219], v[48:51]
    ds_read_b64_tr_b16 v[66:67], v15 offset:2048
    v_mfma_f32_16x16x32_bf16 v[52:55], v[100:103], v[216:219], v[52:55]
    ds_read_b64_tr_b16 v[68:69], v16 offset:0
    v_mfma_f32_16x16x32_bf16 v[36:39], v[100:103], v[212:215], v[36:39]
    ds_read_b64_tr_b16 v[70:71], v16 offset:2048
    s_waitcnt lgkmcnt(8)
    v_mfma_f32_16x16x32_bf16 v[24:27], v[104:107], v[220:223], v[24:27]
    ds_read_b64_tr_b16 v[72:73], v13 offset:4096
    buffer_load_dwordx4 v[212:215], v128, s[8:11], s44 offen offset:2048 sc1
    v_mfma_f32_16x16x32_bf16 v[40:43], v[104:107], v[224:227], v[40:43]
    ds_read_b64_tr_b16 v[74:75], v13 offset:6144
    buffer_load_dwordx4 v[216:219], v129, s[8:11], s44 offen offset:2048 sc1
    v_mfma_f32_16x16x32_bf16 v[44:47], v[108:111], v[224:227], v[44:47]
    ds_read_b64_tr_b16 v[76:77], v14 offset:4096
    s_waitcnt vmcnt(10)
    v_mfma_f32_16x16x32_bf16 v[28:31], v[108:111], v[220:223], v[28:31]
    ds_read_b64_tr_b16 v[78:79], v14 offset:6144
    v_or3_b32 v17, v164, v168, v172
    v_mfma_f32_16x16x32_bf16 v[32:35], v[112:115], v[220:223], v[32:35]
    ds_read_b64_tr_b16 v[80:81], v15 offset:4096
    v_bitop3_b32 v17, v17, v176, 1 bitop3:0xa8
    v_mfma_f32_16x16x32_bf16 v[48:51], v[112:115], v[224:227], v[48:51]
    ds_read_b64_tr_b16 v[82:83], v15 offset:6144
    v_cmp_ne_u32 vcc, 0, v17
    v_mfma_f32_16x16x32_bf16 v[52:55], v[116:119], v[224:227], v[52:55]
    ds_read_b64_tr_b16 v[84:85], v16 offset:4096
    ds_read_b64_tr_b16 v[86:87], v16 offset:6144
    v_mfma_f32_16x16x32_bf16 v[36:39], v[116:119], v[220:223], v[36:39]
    s_waitcnt lgkmcnt(8)
    s_cbranch_vccnz dm_22f3
dm_22g3:
    s_branch dm_22
dm_22f0:
    s_cselect_b32 s50, 1, 0
dm_22h0:
    s_sleep 2
    buffer_load_dwordx4 v[180:183], v126, s[8:11], s49 offen offset:2048 sc1
    buffer_load_dwordx4 v[184:187], v127, s[8:11], s49 offen offset:2048 sc1
    buffer_load_dwordx4 v[188:191], v126, s[8:11], s49 offen offset:3072 sc1
    buffer_load_dwordx4 v[192:195], v127, s[8:11], s49 offen offset:3072 sc1
    buffer_load_dwordx4 v[196:199], v128, s[8:11], s49 offen offset:0 sc1
    buffer_load_dwordx4 v[200:203], v129, s[8:11], s49 offen offset:0 sc1
    buffer_load_dwordx4 v[204:207], v128, s[8:11], s49 offen offset:1024 sc1
    buffer_load_dwordx4 v[208:211], v129, s[8:11], s49 offen offset:1024 sc1
    buffer_load_dwordx4 v[212:215], v128, s[8:11], s49 offen offset:2048 sc1
    buffer_load_dwordx4 v[216:219], v129, s[8:11], s49 offen offset:2048 sc1
    buffer_load_dwordx4 v[220:223], v128, s[8:11], s49 offen offset:3072 sc1
    buffer_load_dwordx4 v[224:227], v129, s[8:11], s49 offen offset:3072 sc1
    buffer_load_dwordx4 v[164:167], v126, s[8:11], s44 offen offset:0 sc1
    buffer_load_dwordx4 v[168:171], v127, s[8:11], s44 offen offset:0 sc1
    s_waitcnt vmcnt(10)
    v_or3_b32 v17, v180, v184, v188
    v_bitop3_b32 v17, v17, v192, 1 bitop3:0xa8
    v_cmp_ne_u32 vcc, 0, v17
    s_add_u32 s53, s53, 1
    s_cmp_ge_u32 s53, s61
    s_cselect_b32 s61, 0, s61
    s_cbranch_scc1 dm_22k0
    s_cbranch_vccnz dm_22h0
dm_22k0:
    s_cmp_eq_u32 s50, 1
    s_branch dm_22g0
dm_22f1:
    s_cselect_b32 s50, 1, 0
dm_22h1:
    s_sleep 2
    buffer_load_dwordx4 v[196:199], v128, s[8:11], s49 offen offset:0 sc1
    buffer_load_dwordx4 v[200:203], v129, s[8:11], s49 offen offset:0 sc1
    buffer_load_dwordx4 v[204:207], v128, s[8:11], s49 offen offset:1024 sc1
    buffer_load_dwordx4 v[208:211], v129, s[8:11], s49 offen offset:1024 sc1
    buffer_load_dwordx4 v[212:215], v128, s[8:11], s49 offen offset:2048 sc1
    buffer_load_dwordx4 v[216:219], v129, s[8:11], s49 offen offset:2048 sc1
    buffer_load_dwordx4 v[220:223], v128, s[8:11], s49 offen offset:3072 sc1
    buffer_load_dwordx4 v[224:227], v129, s[8:11], s49 offen offset:3072 sc1
    buffer_load_dwordx4 v[164:167], v126, s[8:11], s44 offen offset:0 sc1
    buffer_load_dwordx4 v[168:171], v127, s[8:11], s44 offen offset:0 sc1
    buffer_load_dwordx4 v[172:175], v126, s[8:11], s44 offen offset:1024 sc1
    buffer_load_dwordx4 v[176:179], v127, s[8:11], s44 offen offset:1024 sc1
    buffer_load_dwordx4 v[180:183], v126, s[8:11], s44 offen offset:2048 sc1
    buffer_load_dwordx4 v[184:187], v127, s[8:11], s44 offen offset:2048 sc1
    s_waitcnt vmcnt(10)
    v_or3_b32 v17, v196, v200, v204
    v_bitop3_b32 v17, v17, v208, 1 bitop3:0xa8
    v_cmp_ne_u32 vcc, 0, v17
    s_add_u32 s53, s53, 1
    s_cmp_ge_u32 s53, s61
    s_cselect_b32 s61, 0, s61
    s_cbranch_scc1 dm_22k1
    s_cbranch_vccnz dm_22h1
dm_22k1:
    s_cmp_eq_u32 s50, 1
    s_branch dm_22g1
dm_22f2:
    s_cselect_b32 s50, 1, 0
dm_22h2:
    s_sleep 2
    buffer_load_dwordx4 v[212:215], v128, s[8:11], s49 offen offset:2048 sc1
    buffer_load_dwordx4 v[216:219], v129, s[8:11], s49 offen offset:2048 sc1
    buffer_load_dwordx4 v[220:223], v128, s[8:11], s49 offen offset:3072 sc1
    buffer_load_dwordx4 v[224:227], v129, s[8:11], s49 offen offset:3072 sc1
    buffer_load_dwordx4 v[164:167], v126, s[8:11], s44 offen offset:0 sc1
    buffer_load_dwordx4 v[168:171], v127, s[8:11], s44 offen offset:0 sc1
    buffer_load_dwordx4 v[172:175], v126, s[8:11], s44 offen offset:1024 sc1
    buffer_load_dwordx4 v[176:179], v127, s[8:11], s44 offen offset:1024 sc1
    buffer_load_dwordx4 v[180:183], v126, s[8:11], s44 offen offset:2048 sc1
    buffer_load_dwordx4 v[184:187], v127, s[8:11], s44 offen offset:2048 sc1
    buffer_load_dwordx4 v[188:191], v126, s[8:11], s44 offen offset:3072 sc1
    buffer_load_dwordx4 v[192:195], v127, s[8:11], s44 offen offset:3072 sc1
    buffer_load_dwordx4 v[196:199], v128, s[8:11], s44 offen offset:0 sc1
    buffer_load_dwordx4 v[200:203], v129, s[8:11], s44 offen offset:0 sc1
    s_waitcnt vmcnt(10)
    v_or3_b32 v17, v212, v216, v220
    v_bitop3_b32 v17, v17, v224, 1 bitop3:0xa8
    v_cmp_ne_u32 vcc, 0, v17
    s_add_u32 s53, s53, 1
    s_cmp_ge_u32 s53, s61
    s_cselect_b32 s61, 0, s61
    s_cbranch_scc1 dm_22k2
    s_cbranch_vccnz dm_22h2
dm_22k2:
    s_cmp_eq_u32 s50, 1
    s_branch dm_22g2
dm_22f3:
    s_cselect_b32 s50, 1, 0
dm_22h3:
    s_sleep 2
    buffer_load_dwordx4 v[164:167], v126, s[8:11], s49 offen offset:0 sc1
    buffer_load_dwordx4 v[168:171], v127, s[8:11], s49 offen offset:0 sc1
    buffer_load_dwordx4 v[172:175], v126, s[8:11], s49 offen offset:1024 sc1
    buffer_load_dwordx4 v[176:179], v127, s[8:11], s49 offen offset:1024 sc1
    buffer_load_dwordx4 v[180:183], v126, s[8:11], s49 offen offset:2048 sc1
    buffer_load_dwordx4 v[184:187], v127, s[8:11], s49 offen offset:2048 sc1
    buffer_load_dwordx4 v[188:191], v126, s[8:11], s49 offen offset:3072 sc1
    buffer_load_dwordx4 v[192:195], v127, s[8:11], s49 offen offset:3072 sc1
    buffer_load_dwordx4 v[196:199], v128, s[8:11], s49 offen offset:0 sc1
    buffer_load_dwordx4 v[200:203], v129, s[8:11], s49 offen offset:0 sc1
    buffer_load_dwordx4 v[204:207], v128, s[8:11], s49 offen offset:1024 sc1
    buffer_load_dwordx4 v[208:211], v129, s[8:11], s49 offen offset:1024 sc1
    buffer_load_dwordx4 v[212:215], v128, s[8:11], s49 offen offset:2048 sc1
    buffer_load_dwordx4 v[216:219], v129, s[8:11], s49 offen offset:2048 sc1
    s_waitcnt vmcnt(10)
    v_or3_b32 v17, v164, v168, v172
    v_bitop3_b32 v17, v17, v176, 1 bitop3:0xa8
    v_cmp_ne_u32 vcc, 0, v17
    s_add_u32 s53, s53, 1
    s_cmp_ge_u32 s53, s61
    s_cselect_b32 s61, 0, s61
    s_cbranch_scc1 dm_22k3
    s_cbranch_vccnz dm_22h3
dm_22k3:
    s_cmp_eq_u32 s50, 1
    s_branch dm_22g3
dm_22x:
    v_mfma_f32_16x16x32_bf16 v[24:27], v[88:91], v[212:215], v[24:27]
    buffer_load_dwordx4 v[148:151], v126, s[8:11], s41 offen offset:0 sc1
    v_mfma_f32_16x16x32_bf16 v[40:43], v[88:91], v[216:219], v[40:43]
    v_mfma_f32_16x16x32_bf16 v[44:47], v[92:95], v[216:219], v[44:47]
    buffer_load_dwordx4 v[152:155], v126, s[8:11], s41 offen offset:1024 sc1
    v_mfma_f32_16x16x32_bf16 v[28:31], v[92:95], v[212:215], v[28:31]
    v_mfma_f32_16x16x32_bf16 v[32:35], v[96:99], v[212:215], v[32:35]
    buffer_load_dwordx4 v[156:159], v127, s[8:11], s41 offen offset:0 sc1
    v_mfma_f32_16x16x32_bf16 v[48:51], v[96:99], v[216:219], v[48:51]
    v_mfma_f32_16x16x32_bf16 v[52:55], v[100:103], v[216:219], v[52:55]
    buffer_load_dwordx4 v[160:163], v127, s[8:11], s41 offen offset:1024 sc1
    v_mfma_f32_16x16x32_bf16 v[36:39], v[100:103], v[212:215], v[36:39]
    s_waitcnt lgkmcnt(0)
    s_barrier
    v_mfma_f32_16x16x32_bf16 v[24:27], v[104:107], v[220:223], v[24:27]
    ds_read_b128 v[56:59], v6 offset:0
    v_mfma_f32_16x16x32_bf16 v[40:43], v[104:107], v[224:227], v[40:43]
    ds_read_b128 v[60:63], v6 offset:64
    v_mfma_f32_16x16x32_bf16 v[44:47], v[108:111], v[224:227], v[44:47]
    ds_read_b128 v[64:67], v6 offset:128
    v_mfma_f32_16x16x32_bf16 v[28:31], v[108:111], v[220:223], v[28:31]
    ds_read_b128 v[68:71], v6 offset:192
    v_mfma_f32_16x16x32_bf16 v[32:35], v[112:115], v[220:223], v[32:35]
    ds_read_b64 v[72:73], v7 offset:0
    v_mfma_f32_16x16x32_bf16 v[48:51], v[112:115], v[224:227], v[48:51]
    ds_read_b64 v[74:75], v7 offset:256
    v_mfma_f32_16x16x32_bf16 v[52:55], v[116:119], v[224:227], v[52:55]
    v_mfma_f32_16x16x32_bf16 v[36:39], v[116:119], v[220:223], v[36:39]
    s_waitcnt lgkmcnt(0)
    v_mul_f32 v134, 0xc0135761, v73
    v_mul_f32 v135, v73, v73
    v_mul_f32 v135, v135, v134
    v_mul_f32 v135, 0x3d372713, v135
    v_rcp_f32 v73, v73
    v_mul_f32 v136, 0xc0135761, v75
    v_mul_f32 v137, v75, v75
    v_mul_f32 v137, v137, v136
    v_mul_f32 v137, 0x3d372713, v137
    v_rcp_f32 v75, v75
    v_pk_fma_f32 v[24:25], v[72:73], v[56:57], v[24:25] op_sel_hi:[0,1,1] neg_lo:[1,0,0] neg_hi:[1,0,0]
    v_pk_fma_f32 v[26:27], v[72:73], v[58:59], v[26:27] op_sel_hi:[0,1,1] neg_lo:[1,0,0] neg_hi:[1,0,0]
    v_pk_mul_f32 v[122:123], v[24:25], v[24:25]
    v_pk_mul_f32 v[124:125], v[26:27], v[26:27]
    v_pk_fma_f32 v[122:123], v[122:123], v[134:135], v[134:135] op_sel:[0,1,0] op_sel_hi:[1,1,0]
    v_pk_fma_f32 v[124:125], v[124:125], v[134:135], v[134:135] op_sel:[0,1,0] op_sel_hi:[1,1,0]
    v_pk_mul_f32 v[122:123], v[122:123], v[24:25]
    v_pk_mul_f32 v[124:125], v[124:125], v[26:27]
    v_exp_f32 v122, v122
    v_exp_f32 v123, v123
    v_exp_f32 v124, v124
    v_exp_f32 v125, v125
    v_pk_fma_f32 v[122:123], v[122:123], v[72:73], v[72:73] op_sel:[0,1,1] op_sel_hi:[1,1,1]
    v_pk_fma_f32 v[124:125], v[124:125], v[72:73], v[72:73] op_sel:[0,1,1] op_sel_hi:[1,1,1]
    v_rcp_f32 v122, v122
    v_rcp_f32 v123, v123
    v_rcp_f32 v124, v124
    v_rcp_f32 v125, v125
    v_pk_mul_f32 v[24:25], v[24:25], v[122:123]
    v_pk_mul_f32 v[26:27], v[26:27], v[124:125]
    v_pk_fma_f32 v[28:29], v[72:73], v[60:61], v[28:29] op_sel_hi:[0,1,1] neg_lo:[1,0,0] neg_hi:[1,0,0]
    v_pk_fma_f32 v[30:31], v[72:73], v[62:63], v[30:31] op_sel_hi:[0,1,1] neg_lo:[1,0,0] neg_hi:[1,0,0]
    v_pk_mul_f32 v[122:123], v[28:29], v[28:29]
    v_pk_mul_f32 v[124:125], v[30:31], v[30:31]
    v_pk_fma_f32 v[122:123], v[122:123], v[134:135], v[134:135] op_sel:[0,1,0] op_sel_hi:[1,1,0]
    v_pk_fma_f32 v[124:125], v[124:125], v[134:135], v[134:135] op_sel:[0,1,0] op_sel_hi:[1,1,0]
    v_pk_mul_f32 v[122:123], v[122:123], v[28:29]
    v_pk_mul_f32 v[124:125], v[124:125], v[30:31]
    v_exp_f32 v122, v122
    v_exp_f32 v123, v123
    v_exp_f32 v124, v124
    v_exp_f32 v125, v125
    v_pk_fma_f32 v[122:123], v[122:123], v[72:73], v[72:73] op_sel:[0,1,1] op_sel_hi:[1,1,1]
    v_pk_fma_f32 v[124:125], v[124:125], v[72:73], v[72:73] op_sel:[0,1,1] op_sel_hi:[1,1,1]
    v_rcp_f32 v122, v122
    v_rcp_f32 v123, v123
    v_rcp_f32 v124, v124
    v_rcp_f32 v125, v125
    v_pk_mul_f32 v[28:29], v[28:29], v[122:123]
    v_pk_mul_f32 v[30:31], v[30:31], v[124:125]
    v_cvt_pk_bf16_f32 v24, v24, v25
    v_cvt_pk_bf16_f32 v25, v26, v27
    v_cvt_pk_bf16_f32 v26, v28, v29
    v_cvt_pk_bf16_f32 v27, v30, v31
    v_and_b32 v24, -2, v24
    buffer_store_dwordx4 v[24:27], v12, s[16:19], s39 offen offset:0 sc1
    v_pk_fma_f32 v[40:41], v[74:75], v[56:57], v[40:41] op_sel_hi:[0,1,1] neg_lo:[1,0,0] neg_hi:[1,0,0]
    v_pk_fma_f32 v[42:43], v[74:75], v[58:59], v[42:43] op_sel_hi:[0,1,1] neg_lo:[1,0,0] neg_hi:[1,0,0]
    v_pk_mul_f32 v[122:123], v[40:41], v[40:41]
    v_pk_mul_f32 v[124:125], v[42:43], v[42:43]
    v_pk_fma_f32 v[122:123], v[122:123], v[136:137], v[136:137] op_sel:[0,1,0] op_sel_hi:[1,1,0]
    v_pk_fma_f32 v[124:125], v[124:125], v[136:137], v[136:137] op_sel:[0,1,0] op_sel_hi:[1,1,0]
    v_pk_mul_f32 v[122:123], v[122:123], v[40:41]
    v_pk_mul_f32 v[124:125], v[124:125], v[42:43]
    v_exp_f32 v122, v122
    v_exp_f32 v123, v123
    v_exp_f32 v124, v124
    v_exp_f32 v125, v125
    v_pk_fma_f32 v[122:123], v[122:123], v[74:75], v[74:75] op_sel:[0,1,1] op_sel_hi:[1,1,1]
    v_pk_fma_f32 v[124:125], v[124:125], v[74:75], v[74:75] op_sel:[0,1,1] op_sel_hi:[1,1,1]
    v_rcp_f32 v122, v122
    v_rcp_f32 v123, v123
    v_rcp_f32 v124, v124
    v_rcp_f32 v125, v125
    v_pk_mul_f32 v[40:41], v[40:41], v[122:123]
    v_pk_mul_f32 v[42:43], v[42:43], v[124:125]
    v_pk_fma_f32 v[44:45], v[74:75], v[60:61], v[44:45] op_sel_hi:[0,1,1] neg_lo:[1,0,0] neg_hi:[1,0,0]
    v_pk_fma_f32 v[46:47], v[74:75], v[62:63], v[46:47] op_sel_hi:[0,1,1] neg_lo:[1,0,0] neg_hi:[1,0,0]
    v_pk_mul_f32 v[122:123], v[44:45], v[44:45]
    v_pk_mul_f32 v[124:125], v[46:47], v[46:47]
    v_pk_fma_f32 v[122:123], v[122:123], v[136:137], v[136:137] op_sel:[0,1,0] op_sel_hi:[1,1,0]
    v_pk_fma_f32 v[124:125], v[124:125], v[136:137], v[136:137] op_sel:[0,1,0] op_sel_hi:[1,1,0]
    v_pk_mul_f32 v[122:123], v[122:123], v[44:45]
    v_pk_mul_f32 v[124:125], v[124:125], v[46:47]
    v_exp_f32 v122, v122
    v_exp_f32 v123, v123
    v_exp_f32 v124, v124
    v_exp_f32 v125, v125
    v_pk_fma_f32 v[122:123], v[122:123], v[74:75], v[74:75] op_sel:[0,1,1] op_sel_hi:[1,1,1]
    v_pk_fma_f32 v[124:125], v[124:125], v[74:75], v[74:75] op_sel:[0,1,1] op_sel_hi:[1,1,1]
    v_rcp_f32 v122, v122
    v_rcp_f32 v123, v123
    v_rcp_f32 v124, v124
    v_rcp_f32 v125, v125
    v_pk_mul_f32 v[44:45], v[44:45], v[122:123]
    v_pk_mul_f32 v[46:47], v[46:47], v[124:125]
    v_cvt_pk_bf16_f32 v40, v40, v41
    v_cvt_pk_bf16_f32 v41, v42, v43
    v_cvt_pk_bf16_f32 v42, v44, v45
    v_cvt_pk_bf16_f32 v43, v46, v47
    v_and_b32 v40, -2, v40
    buffer_store_dwordx4 v[40:43], v12, s[16:19], s39 offen offset:256 sc1
    v_pk_fma_f32 v[32:33], v[72:73], v[64:65], v[32:33] op_sel_hi:[0,1,1] neg_lo:[1,0,0] neg_hi:[1,0,0]
    v_pk_fma_f32 v[34:35], v[72:73], v[66:67], v[34:35] op_sel_hi:[0,1,1] neg_lo:[1,0,0] neg_hi:[1,0,0]
    v_pk_mul_f32 v[122:123], v[32:33], v[32:33]
    v_pk_mul_f32 v[124:125], v[34:35], v[34:35]
    v_pk_fma_f32 v[122:123], v[122:123], v[134:135], v[134:135] op_sel:[0,1,0] op_sel_hi:[1,1,0]
    v_pk_fma_f32 v[124:125], v[124:125], v[134:135], v[134:135] op_sel:[0,1,0] op_sel_hi:[1,1,0]
    v_pk_mul_f32 v[122:123], v[122:123], v[32:33]
    v_pk_mul_f32 v[124:125], v[124:125], v[34:35]
    v_exp_f32 v122, v122
    v_exp_f32 v123, v123
    v_exp_f32 v124, v124
    v_exp_f32 v125, v125
    v_pk_fma_f32 v[122:123], v[122:123], v[72:73], v[72:73] op_sel:[0,1,1] op_sel_hi:[1,1,1]
    v_pk_fma_f32 v[124:125], v[124:125], v[72:73], v[72:73] op_sel:[0,1,1] op_sel_hi:[1,1,1]
    v_rcp_f32 v122, v122
    v_rcp_f32 v123, v123
    v_rcp_f32 v124, v124
    v_rcp_f32 v125, v125
    v_pk_mul_f32 v[32:33], v[32:33], v[122:123]
    v_pk_mul_f32 v[34:35], v[34:35], v[124:125]
    v_pk_fma_f32 v[36:37], v[72:73], v[68:69], v[36:37] op_sel_hi:[0,1,1] neg_lo:[1,0,0] neg_hi:[1,0,0]
    v_pk_fma_f32 v[38:39], v[72:73], v[70:71], v[38:39] op_sel_hi:[0,1,1] neg_lo:[1,0,0] neg_hi:[1,0,0]
    v_pk_mul_f32 v[122:123], v[36:37], v[36:37]
    v_pk_mul_f32 v[124:125], v[38:39], v[38:39]
    v_pk_fma_f32 v[122:123], v[122:123], v[134:135], v[134:135] op_sel:[0,1,0] op_sel_hi:[1,1,0]
    v_pk_fma_f32 v[124:125], v[124:125], v[134:135], v[134:135] op_sel:[0,1,0] op_sel_hi:[1,1,0]
    v_pk_mul_f32 v[122:123], v[122:123], v[36:37]
    v_pk_mul_f32 v[124:125], v[124:125], v[38:39]
    v_exp_f32 v122, v122
    v_exp_f32 v123, v123
    v_exp_f32 v124, v124
    v_exp_f32 v125, v125
    v_pk_fma_f32 v[122:123], v[122:123], v[72:73], v[72:73] op_sel:[0,1,1] op_sel_hi:[1,1,1]
    v_pk_fma_f32 v[124:125], v[124:125], v[72:73], v[72:73] op_sel:[0,1,1] op_sel_hi:[1,1,1]
    v_rcp_f32 v122, v122
    v_rcp_f32 v123, v123
    v_rcp_f32 v124, v124
    v_rcp_f32 v125, v125
    v_pk_mul_f32 v[36:37], v[36:37], v[122:123]
    v_pk_mul_f32 v[38:39], v[38:39], v[124:125]
    v_cvt_pk_bf16_f32 v32, v32, v33
    v_cvt_pk_bf16_f32 v33, v34, v35
    v_cvt_pk_bf16_f32 v34, v36, v37
    v_cvt_pk_bf16_f32 v35, v38, v39
    v_and_b32 v32, -2, v32
    buffer_store_dwordx4 v[32:35], v12, s[16:19], s40 offen offset:0 sc1
    v_pk_fma_f32 v[48:49], v[74:75], v[64:65], v[48:49] op_sel_hi:[0,1,1] neg_lo:[1,0,0] neg_hi:[1,0,0]
    v_pk_fma_f32 v[50:51], v[74:75], v[66:67], v[50:51] op_sel_hi:[0,1,1] neg_lo:[1,0,0] neg_hi:[1,0,0]
    v_pk_mul_f32 v[122:123], v[48:49], v[48:49]
    v_pk_mul_f32 v[124:125], v[50:51], v[50:51]
    v_pk_fma_f32 v[122:123], v[122:123], v[136:137], v[136:137] op_sel:[0,1,0] op_sel_hi:[1,1,0]
    v_pk_fma_f32 v[124:125], v[124:125], v[136:137], v[136:137] op_sel:[0,1,0] op_sel_hi:[1,1,0]
    v_pk_mul_f32 v[122:123], v[122:123], v[48:49]
    v_pk_mul_f32 v[124:125], v[124:125], v[50:51]
    v_exp_f32 v122, v122
    v_exp_f32 v123, v123
    v_exp_f32 v124, v124
    v_exp_f32 v125, v125
    v_pk_fma_f32 v[122:123], v[122:123], v[74:75], v[74:75] op_sel:[0,1,1] op_sel_hi:[1,1,1]
    v_pk_fma_f32 v[124:125], v[124:125], v[74:75], v[74:75] op_sel:[0,1,1] op_sel_hi:[1,1,1]
    v_rcp_f32 v122, v122
    v_rcp_f32 v123, v123
    v_rcp_f32 v124, v124
    v_rcp_f32 v125, v125
    v_pk_mul_f32 v[48:49], v[48:49], v[122:123]
    v_pk_mul_f32 v[50:51], v[50:51], v[124:125]
    v_pk_fma_f32 v[52:53], v[74:75], v[68:69], v[52:53] op_sel_hi:[0,1,1] neg_lo:[1,0,0] neg_hi:[1,0,0]
    v_pk_fma_f32 v[54:55], v[74:75], v[70:71], v[54:55] op_sel_hi:[0,1,1] neg_lo:[1,0,0] neg_hi:[1,0,0]
    v_pk_mul_f32 v[122:123], v[52:53], v[52:53]
    v_pk_mul_f32 v[124:125], v[54:55], v[54:55]
    v_pk_fma_f32 v[122:123], v[122:123], v[136:137], v[136:137] op_sel:[0,1,0] op_sel_hi:[1,1,0]
    v_pk_fma_f32 v[124:125], v[124:125], v[136:137], v[136:137] op_sel:[0,1,0] op_sel_hi:[1,1,0]
    v_pk_mul_f32 v[122:123], v[122:123], v[52:53]
    v_pk_mul_f32 v[124:125], v[124:125], v[54:55]
    v_exp_f32 v122, v122
    v_exp_f32 v123, v123
    v_exp_f32 v124, v124
    v_exp_f32 v125, v125
    v_pk_fma_f32 v[122:123], v[122:123], v[74:75], v[74:75] op_sel:[0,1,1] op_sel_hi:[1,1,1]
    v_pk_fma_f32 v[124:125], v[124:125], v[74:75], v[74:75] op_sel:[0,1,1] op_sel_hi:[1,1,1]
    v_rcp_f32 v122, v122
    v_rcp_f32 v123, v123
    v_rcp_f32 v124, v124
    v_rcp_f32 v125, v125
    v_pk_mul_f32 v[52:53], v[52:53], v[122:123]
    v_pk_mul_f32 v[54:55], v[54:55], v[124:125]
    v_cvt_pk_bf16_f32 v48, v48, v49
    v_cvt_pk_bf16_f32 v49, v50, v51
    v_cvt_pk_bf16_f32 v50, v52, v53
    v_cvt_pk_bf16_f32 v51, v54, v55
    v_and_b32 v48, -2, v48
    buffer_store_dwordx4 v[48:51], v12, s[16:19], s40 offen offset:256 sc1
    s_add_u32 s8, s4, 0x2100000
    s_addc_u32 s9, s5, 0
    s_mov_b32 s10, 0x8400000
    s_mov_b32 s11, 0x20000
    s_sub_u32 s47, s55, 39583744
    s_lshl_b32 s46, s30, 9
    s_add_u32 s47, s47, s46
    s_add_u32 s45, s92, 2048
    s_cmp_eq_u32 s28, 0
    s_cselect_b32 s45, 1073741824, s45
    s_cmp_eq_u32 s30, 0
    s_cselect_b32 s45, s45, 0
    s_add_u32 s53, s47, 0xfffffff0
    v_add_u32 v126, s53, v12
    v_add_u32 v127, 256, v126
    v_add_u32 v134, s45, v126
    v_cmp_gt_u32 vcc, 1, v22
    s_nop 1
    v_cndmask_b32 v126, v126, v134, vcc
    s_mov_b32 s34, s30
    s_mov_b32 s35, 0
    v_and_b32 v22, 15, v1
    v_lshrrev_b32 v23, 4, v1
    s_mul_i32 s37, s34, 2
    s_mul_i32 s38, s29, 4
    s_mul_i32 s36, s35, 4
    s_add_u32 s38, s38, s36
    s_lshr_b32 s36, s38, 1
    s_lshr_b32 s53, s36, 3
    s_lshl_b32 s53, s53, 14
    s_and_b32 s39, s36, 7
    s_lshl_b32 s39, s39, 10
    s_add_u32 s39, s39, s53
    s_lshl_b32 s36, s37, 16
    s_add_u32 s39, s39, s36
    s_sub_u32 s46, s93, 2048
    s_cmp_eq_u32 s28, 15
    s_cselect_b32 s46, 1073741824, s46
    s_cmp_eq_u32 s30, 3
    s_cselect_b32 s46, s46, 0
    s_add_u32 s53, s47, 0x10
    v_add_u32 v128, s53, v12
    v_add_u32 v129, 256, v128
    v_add_u32 v134, s46, v129
    v_cmp_le_u32 vcc, 15, v22
    s_nop 1
    v_cndmask_b32 v129, v129, v134, vcc
    s_add_u32 s53, s47, 0xffffffe0
    v_add_u32 v130, s53, v12
    v_add_u32 v131, 256, v130
    v_add_u32 v134, s45, v130
    v_cmp_gt_u32 vcc, 2, v22
    s_nop 1
    v_cndmask_b32 v130, v130, v134, vcc
    s_add_u32 s53, s47, 0x20
    v_add_u32 v132, s53, v12
    v_add_u32 v133, 256, v132
    v_add_u32 v134, s46, v133
    v_cmp_le_u32 vcc, 14, v22
    s_nop 1
    v_cndmask_b32 v133, v133, v134, vcc
    v_mov_b32 v134, v126
    v_mov_b32 v135, v127
    v_lshrrev_b32 v6, 2, v1
    v_mul_u32_u24 v13, 128, v6
    v_and_b32 v7, 3, v1
    v_lshl_add_u32 v13, v7, 3, v13
    v_add_u32 v13, 0, v13
    v_bfe_u32 v6, v6, 1, 2
    s_mul_i32 s36, s35, 4
    s_add_u32 s36, s36, 3
    v_xor_b32 v7, s36, v6
    v_lshl_add_u32 v16, v7, 5, v13
    s_mul_i32 s36, s35, 4
    s_add_u32 s36, s36, 2
    v_xor_b32 v7, s36, v6
    v_lshl_add_u32 v15, v7, 5, v13
    s_mul_i32 s36, s35, 4
    s_add_u32 s36, s36, 1
    v_xor_b32 v7, s36, v6
    v_lshl_add_u32 v14, v7, 5, v13
    s_mul_i32 s36, s35, 4
    s_add_u32 s36, s36, 0
    v_xor_b32 v7, s36, v6
    v_lshl_add_u32 v13, v7, 5, v13
    s_lshl_b32 s36, s37, 8
    s_add_u32 s36, s36, 160768
    v_lshlrev_b32 v7, 4, v22
    v_add_u32 v7, s36, v7
    ds_read_b64 v[56:57], v7 offset:0
    ds_read_b64 v[58:59], v7 offset:256
    s_waitcnt vmcnt(4) lgkmcnt(0)
    s_sleep 6
    s_cmp_lg_u32 s60, 0
    s_cbranch_scc1 G2_nd
    s_sleep 2
G2_nd:
    s_mov_b32 s44, 0
    buffer_load_dwordx4 v[164:167], v126, s[8:11], s44 offen sc1
    buffer_load_dwordx4 v[168:171], v127, s[8:11], s44 offen sc1
    s_add_u32 s44, s44, 16384
    buffer_load_dwordx4 v[172:175], v126, s[8:11], s44 offen sc1
    buffer_load_dwordx4 v[176:179], v127, s[8:11], s44 offen sc1
    s_add_u32 s44, s44, 16384
    buffer_load_dwordx4 v[180:183], v126, s[8:11], s44 offen
    buffer_load_dwordx4 v[184:187], v127, s[8:11], s44 offen
    s_add_u32 s44, s44, 16384
    buffer_load_dwordx4 v[188:191], v126, s[8:11], s44 offen
    buffer_load_dwordx4 v[192:195], v127, s[8:11], s44 offen
    s_add_u32 s44, s44, 16384
    v_lshlrev_b32 v24, 16, v148
    v_and_b32 v25, 0xffff0000, v148
    v_pk_add_f32 v[24:25], v[24:25], v[56:57] op_sel_hi:[1,0] neg_lo:[0,1] neg_hi:[0,1]
    v_pk_mul_f32 v[24:25], v[24:25], v[56:57] op_sel:[0,1] op_sel_hi:[1,1]
    v_lshlrev_b32 v26, 16, v149
    v_and_b32 v27, 0xffff0000, v149
    v_pk_add_f32 v[26:27], v[26:27], v[56:57] op_sel_hi:[1,0] neg_lo:[0,1] neg_hi:[0,1]
    v_pk_mul_f32 v[26:27], v[26:27], v[56:57] op_sel:[0,1] op_sel_hi:[1,1]
    v_lshlrev_b32 v28, 16, v150
    v_and_b32 v29, 0xffff0000, v150
    v_pk_add_f32 v[28:29], v[28:29], v[56:57] op_sel_hi:[1,0] neg_lo:[0,1] neg_hi:[0,1]
    v_pk_mul_f32 v[28:29], v[28:29], v[56:57] op_sel:[0,1] op_sel_hi:[1,1]
    v_lshlrev_b32 v30, 16, v151
    v_and_b32 v31, 0xffff0000, v151
    v_pk_add_f32 v[30:31], v[30:31], v[56:57] op_sel_hi:[1,0] neg_lo:[0,1] neg_hi:[0,1]
    v_pk_mul_f32 v[30:31], v[30:31], v[56:57] op_sel:[0,1] op_sel_hi:[1,1]
    v_lshlrev_b32 v32, 16, v152
    v_and_b32 v33, 0xffff0000, v152
    v_pk_add_f32 v[32:33], v[32:33], v[56:57] op_sel_hi:[1,0] neg_lo:[0,1] neg_hi:[0,1]
    v_pk_mul_f32 v[32:33], v[32:33], v[56:57] op_sel:[0,1] op_sel_hi:[1,1]
    v_lshlrev_b32 v34, 16, v153
    v_and_b32 v35, 0xffff0000, v153
    v_pk_add_f32 v[34:35], v[34:35], v[56:57] op_sel_hi:[1,0] neg_lo:[0,1] neg_hi:[0,1]
    v_pk_mul_f32 v[34:35], v[34:35], v[56:57] op_sel:[0,1] op_sel_hi:[1,1]
    v_lshlrev_b32 v36, 16, v154
    v_and_b32 v37, 0xffff0000, v154
    v_pk_add_f32 v[36:37], v[36:37], v[56:57] op_sel_hi:[1,0] neg_lo:[0,1] neg_hi:[0,1]
    v_pk_mul_f32 v[36:37], v[36:37], v[56:57] op_sel:[0,1] op_sel_hi:[1,1]
    v_lshlrev_b32 v38, 16, v155
    v_and_b32 v39, 0xffff0000, v155
    v_pk_add_f32 v[38:39], v[38:39], v[56:57] op_sel_hi:[1,0] neg_lo:[0,1] neg_hi:[0,1]
    v_pk_mul_f32 v[38:39], v[38:39], v[56:57] op_sel:[0,1] op_sel_hi:[1,1]
    v_lshlrev_b32 v40, 16, v156
    v_and_b32 v41, 0xffff0000, v156
    v_pk_add_f32 v[40:41], v[40:41], v[58:59] op_sel_hi:[1,0] neg_lo:[0,1] neg_hi:[0,1]
    v_pk_mul_f32 v[40:41], v[40:41], v[58:59] op_sel:[0,1] op_sel_hi:[1,1]
    v_lshlrev_b32 v42, 16, v157
    v_and_b32 v43, 0xffff0000, v157
    v_pk_add_f32 v[42:43], v[42:43], v[58:59] op_sel_hi:[1,0] neg_lo:[0,1] neg_hi:[0,1]
    v_pk_mul_f32 v[42:43], v[42:43], v[58:59] op_sel:[0,1] op_sel_hi:[1,1]
    v_lshlrev_b32 v44, 16, v158
    v_and_b32 v45, 0xffff0000, v158
    v_pk_add_f32 v[44:45], v[44:45], v[58:59] op_sel_hi:[1,0] neg_lo:[0,1] neg_hi:[0,1]
    v_pk_mul_f32 v[44:45], v[44:45], v[58:59] op_sel:[0,1] op_sel_hi:[1,1]
    v_lshlrev_b32 v46, 16, v159
    v_and_b32 v47, 0xffff0000, v159
    v_pk_add_f32 v[46:47], v[46:47], v[58:59] op_sel_hi:[1,0] neg_lo:[0,1] neg_hi:[0,1]
    v_pk_mul_f32 v[46:47], v[46:47], v[58:59] op_sel:[0,1] op_sel_hi:[1,1]
    v_lshlrev_b32 v48, 16, v160
    v_and_b32 v49, 0xffff0000, v160
    v_pk_add_f32 v[48:49], v[48:49], v[58:59] op_sel_hi:[1,0] neg_lo:[0,1] neg_hi:[0,1]
    v_pk_mul_f32 v[48:49], v[48:49], v[58:59] op_sel:[0,1] op_sel_hi:[1,1]
    v_lshlrev_b32 v50, 16, v161
    v_and_b32 v51, 0xffff0000, v161
    v_pk_add_f32 v[50:51], v[50:51], v[58:59] op_sel_hi:[1,0] neg_lo:[0,1] neg_hi:[0,1]
    v_pk_mul_f32 v[50:51], v[50:51], v[58:59] op_sel:[0,1] op_sel_hi:[1,1]
    v_lshlrev_b32 v52, 16, v162
    v_and_b32 v53, 0xffff0000, v162
    v_pk_add_f32 v[52:53], v[52:53], v[58:59] op_sel_hi:[1,0] neg_lo:[0,1] neg_hi:[0,1]
    v_pk_mul_f32 v[52:53], v[52:53], v[58:59] op_sel:[0,1] op_sel_hi:[1,1]
    v_lshlrev_b32 v54, 16, v163
    v_and_b32 v55, 0xffff0000, v163
    v_pk_add_f32 v[54:55], v[54:55], v[58:59] op_sel_hi:[1,0] neg_lo:[0,1] neg_hi:[0,1]
    v_pk_mul_f32 v[54:55], v[54:55], v[58:59] op_sel:[0,1] op_sel_hi:[1,1]
    s_mov_b32 s43, 0
    s_add_u32 s16, s62, 0x80000
    s_addc_u32 s17, s63, 0
    s_mov_b32 s18, 0x7e000
    s_mov_b32 s19, 0x20000
    s_mov_b32 s53, 0
    s_mov_b32 s49, s44
    s_barrier
    ds_read_b64_tr_b16 v[56:57], v13 offset:0
    ds_read_b64_tr_b16 v[58:59], v13 offset:2048
    ds_read_b64_tr_b16 v[60:61], v14 offset:0
    ds_read_b64_tr_b16 v[62:63], v14 offset:2048
    ds_read_b64_tr_b16 v[64:65], v15 offset:0
    ds_read_b64_tr_b16 v[66:67], v15 offset:2048
    ds_read_b64_tr_b16 v[68:69], v16 offset:0
    ds_read_b64_tr_b16 v[70:71], v16 offset:2048
    ds_read_b64_tr_b16 v[72:73], v13 offset:4096
    ds_read_b64_tr_b16 v[74:75], v13 offset:6144
    ds_read_b64_tr_b16 v[76:77], v14 offset:4096
    ds_read_b64_tr_b16 v[78:79], v14 offset:6144
    ds_read_b64_tr_b16 v[80:81], v15 offset:4096
    ds_read_b64_tr_b16 v[82:83], v15 offset:6144
    ds_read_b64_tr_b16 v[84:85], v16 offset:4096
    ds_read_b64_tr_b16 v[86:87], v16 offset:6144
    s_branch dm_23w
dm_23p:
    s_mov_b32 s44, 0
    buffer_load_dwordx4 v[164:167], v126, s[8:11], s44 offen sc1
    buffer_load_dwordx4 v[168:171], v127, s[8:11], s44 offen sc1
    s_add_u32 s44, s44, 16384
    buffer_load_dwordx4 v[172:175], v126, s[8:11], s44 offen sc1
    buffer_load_dwordx4 v[176:179], v127, s[8:11], s44 offen sc1
    s_add_u32 s44, s44, 16384
    buffer_load_dwordx4 v[180:183], v126, s[8:11], s44 offen
    buffer_load_dwordx4 v[184:187], v127, s[8:11], s44 offen
    s_add_u32 s44, s44, 16384
    buffer_load_dwordx4 v[188:191], v126, s[8:11], s44 offen
    buffer_load_dwordx4 v[192:195], v127, s[8:11], s44 offen
    s_add_u32 s44, s44, 16384
dm_23w:
    s_waitcnt vmcnt(4)
    v_or3_b32 v17, v164, v168, v172
    v_bitop3_b32 v17, v17, v176, 1 bitop3:0xa8
    v_cmp_ne_u32 vcc, 0, v17
    s_cbranch_vccz dm_23q
dm_23r:
    s_sleep 2
    s_mov_b32 s44, 0
    buffer_load_dwordx4 v[164:167], v126, s[8:11], s44 offen sc1
    buffer_load_dwordx4 v[168:171], v127, s[8:11], s44 offen sc1
    s_add_u32 s44, s44, 16384
    buffer_load_dwordx4 v[172:175], v126, s[8:11], s44 offen sc1
    buffer_load_dwordx4 v[176:179], v127, s[8:11], s44 offen sc1
    s_add_u32 s44, s44, 16384
    buffer_load_dwordx4 v[180:183], v126, s[8:11], s44 offen sc1
    buffer_load_dwordx4 v[184:187], v127, s[8:11], s44 offen sc1
    s_add_u32 s44, s44, 16384
    buffer_load_dwordx4 v[188:191], v126, s[8:11], s44 offen sc1
    buffer_load_dwordx4 v[192:195], v127, s[8:11], s44 offen sc1
    s_add_u32 s44, s44, 16384
    s_waitcnt vmcnt(4)
    v_or3_b32 v17, v164, v168, v172
    v_bitop3_b32 v17, v17, v176, 1 bitop3:0xa8
    v_cmp_ne_u32 vcc, 0, v17
    s_cbranch_vccz dm_23t
    s_add_u32 s53, s53, 1
    s_cmp_lt_u32 s53, s61
    s_cbranch_scc1 dm_23r
    s_mov_b32 s61, 0
    s_branch dm_23t
dm_23q:
dm_23t:
    buffer_load_dwordx4 v[196:199], v126, s[8:11], s44 offen
    buffer_load_dwordx4 v[200:203], v127, s[8:11], s44 offen
    s_add_u32 s44, s44, 16384
    buffer_load_dwordx4 v[204:207], v126, s[8:11], s44 offen
    buffer_load_dwordx4 v[208:211], v127, s[8:11], s44 offen
    s_add_u32 s44, s44, 16384
    buffer_load_dwordx4 v[212:215], v126, s[8:11], s44 offen
    buffer_load_dwordx4 v[216:219], v127, s[8:11], s44 offen
    s_add_u32 s44, s44, 16384
    s_waitcnt lgkmcnt(0)
dm_23:
    v_mfma_f32_16x16x32_bf16 v[24:27], v[56:59], v[164:167], v[24:27]
    ds_read_b64_tr_b16 v[88:89], v13 offset:8192
    buffer_load_dwordx4 v[220:223], v126, s[8:11], s44 offen
    v_mfma_f32_16x16x32_bf16 v[40:43], v[56:59], v[168:171], v[40:43]
    ds_read_b64_tr_b16 v[90:91], v13 offset:10240
    buffer_load_dwordx4 v[224:227], v127, s[8:11], s44 offen
    v_mfma_f32_16x16x32_bf16 v[44:47], v[60:63], v[168:171], v[44:47]
    ds_read_b64_tr_b16 v[92:93], v14 offset:8192
    s_add_u32 s44, s44, 16384
    v_mfma_f32_16x16x32_bf16 v[28:31], v[60:63], v[164:167], v[28:31]
    ds_read_b64_tr_b16 v[94:95], v14 offset:10240
    v_mov_b32 v126, v128
    v_mfma_f32_16x16x32_bf16 v[32:35], v[64:67], v[164:167], v[32:35]
    ds_read_b64_tr_b16 v[96:97], v15 offset:8192
    v_mov_b32 v127, v129
    v_mfma_f32_16x16x32_bf16 v[48:51], v[64:67], v[168:171], v[48:51]
    ds_read_b64_tr_b16 v[98:99], v15 offset:10240
    v_mov_b32 v128, v130
    v_mfma_f32_16x16x32_bf16 v[52:55], v[68:71], v[168:171], v[52:55]
    ds_read_b64_tr_b16 v[100:101], v16 offset:8192
    v_mov_b32 v129, v131
    v_mfma_f32_16x16x32_bf16 v[36:39], v[68:71], v[164:167], v[36:39]
    ds_read_b64_tr_b16 v[102:103], v16 offset:10240
    s_waitcnt lgkmcnt(8)
    v_mfma_f32_16x16x32_bf16 v[24:27], v[72:75], v[172:175], v[24:27]
    ds_read_b64_tr_b16 v[104:105], v13 offset:12288
    buffer_load_dwordx4 v[164:167], v126, s[8:11], s44 offen
    v_mfma_f32_16x16x32_bf16 v[40:43], v[72:75], v[176:179], v[40:43]
    ds_read_b64_tr_b16 v[106:107], v13 offset:14336
    buffer_load_dwordx4 v[168:171], v127, s[8:11], s44 offen
    v_mfma_f32_16x16x32_bf16 v[44:47], v[76:79], v[176:179], v[44:47]
    ds_read_b64_tr_b16 v[108:109], v14 offset:12288
    s_add_u32 s44, s44, 16384
    s_waitcnt vmcnt(10)
    v_mfma_f32_16x16x32_bf16 v[28:31], v[76:79], v[172:175], v[28:31]
    ds_read_b64_tr_b16 v[110:111], v14 offset:14336
    v_or3_b32 v17, v180, v184, v188
    v_mfma_f32_16x16x32_bf16 v[32:35], v[80:83], v[172:175], v[32:35]
    ds_read_b64_tr_b16 v[112:113], v15 offset:12288
    v_bitop3_b32 v17, v17, v192, 1 bitop3:0xa8
    v_mfma_f32_16x16x32_bf16 v[48:51], v[80:83], v[176:179], v[48:51]
    ds_read_b64_tr_b16 v[114:115], v15 offset:14336
    v_cmp_ne_u32 vcc, 0, v17
    v_mfma_f32_16x16x32_bf16 v[52:55], v[84:87], v[176:179], v[52:55]
    ds_read_b64_tr_b16 v[116:117], v16 offset:12288
    ds_read_b64_tr_b16 v[118:119], v16 offset:14336
    v_mfma_f32_16x16x32_bf16 v[36:39], v[84:87], v[172:175], v[36:39]
    s_waitcnt lgkmcnt(8)
    s_cbranch_vccnz dm_23f0
dm_23g0:
    v_mfma_f32_16x16x32_bf16 v[24:27], v[88:91], v[180:183], v[24:27]
    ds_read_b64_tr_b16 v[56:57], v13 offset:16384
    buffer_load_dwordx4 v[172:175], v126, s[8:11], s44 offen
    v_mfma_f32_16x16x32_bf16 v[40:43], v[88:91], v[184:187], v[40:43]
    ds_read_b64_tr_b16 v[58:59], v13 offset:18432
    buffer_load_dwordx4 v[176:179], v127, s[8:11], s44 offen
    v_mfma_f32_16x16x32_bf16 v[44:47], v[92:95], v[184:187], v[44:47]
    ds_read_b64_tr_b16 v[60:61], v14 offset:16384
    s_add_u32 s44, s44, 16384
    v_mfma_f32_16x16x32_bf16 v[28:31], v[92:95], v[180:183], v[28:31]
    ds_read_b64_tr_b16 v[62:63], v14 offset:18432
    v_mov_b32 v130, v132
    v_mfma_f32_16x16x32_bf16 v[32:35], v[96:99], v[180:183], v[32:35]
    ds_read_b64_tr_b16 v[64:65], v15 offset:16384
    v_mov_b32 v131, v133
    v_mfma_f32_16x16x32_bf16 v[48:51], v[96:99], v[184:187], v[48:51]
    ds_read_b64_tr_b16 v[66:67], v15 offset:18432
    v_mov_b32 v132, 1073741824
    v_mfma_f32_16x16x32_bf16 v[52:55], v[100:103], v[184:187], v[52:55]
    ds_read_b64_tr_b16 v[68:69], v16 offset:16384
    v_mov_b32 v133, 1073741824
    v_mfma_f32_16x16x32_bf16 v[36:39], v[100:103], v[180:183], v[36:39]
    ds_read_b64_tr_b16 v[70:71], v16 offset:18432
    s_waitcnt lgkmcnt(8)
    v_mfma_f32_16x16x32_bf16 v[24:27], v[104:107], v[188:191], v[24:27]
    ds_read_b64_tr_b16 v[72:73], v13 offset:20480
    buffer_load_dwordx4 v[180:183], v126, s[8:11], s44 offen
    v_mfma_f32_16x16x32_bf16 v[40:43], v[104:107], v[192:195], v[40:43]
    ds_read_b64_tr_b16 v[74:75], v13 offset:22528
    buffer_load_dwordx4 v[184:187], v127, s[8:11], s44 offen
    v_mfma_f32_16x16x32_bf16 v[44:47], v[108:111], v[192:195], v[44:47]
    ds_read_b64_tr_b16 v[76:77], v14 offset:20480
    s_add_u32 s44, s44, 16384
    s_waitcnt vmcnt(10)
    v_mfma_f32_16x16x32_bf16 v[28:31], v[108:111], v[188:191], v[28:31]
    ds_read_b64_tr_b16 v[78:79], v14 offset:22528
    v_or3_b32 v17, v196, v200, v204
    v_mfma_f32_16x16x32_bf16 v[32:35], v[112:115], v[188:191], v[32:35]
    ds_read_b64_tr_b16 v[80:81], v15 offset:20480
    v_bitop3_b32 v17, v17, v208, 1 bitop3:0xa8
    v_mfma_f32_16x16x32_bf16 v[48:51], v[112:115], v[192:195], v[48:51]
    ds_read_b64_tr_b16 v[82:83], v15 offset:22528
    v_cmp_ne_u32 vcc, 0, v17
    v_mfma_f32_16x16x32_bf16 v[52:55], v[116:119], v[192:195], v[52:55]
    ds_read_b64_tr_b16 v[84:85], v16 offset:20480
    ds_read_b64_tr_b16 v[86:87], v16 offset:22528
    v_mfma_f32_16x16x32_bf16 v[36:39], v[116:119], v[188:191], v[36:39]
    s_waitcnt lgkmcnt(8)
    s_cbranch_vccnz dm_23f1
dm_23g1:
    v_mfma_f32_16x16x32_bf16 v[24:27], v[56:59], v[196:199], v[24:27]
    ds_read_b64_tr_b16 v[88:89], v13 offset:24576
    buffer_load_dwordx4 v[188:191], v126, s[8:11], s44 offen
    v_mfma_f32_16x16x32_bf16 v[40:43], v[56:59], v[200:203], v[40:43]
    ds_read_b64_tr_b16 v[90:91], v13 offset:26624
    buffer_load_dwordx4 v[192:195], v127, s[8:11], s44 offen
    v_mfma_f32_16x16x32_bf16 v[44:47], v[60:63], v[200:203], v[44:47]
    ds_read_b64_tr_b16 v[92:93], v14 offset:24576
    s_add_u32 s44, s44, 16384
    v_mfma_f32_16x16x32_bf16 v[28:31], v[60:63], v[196:199], v[28:31]
    ds_read_b64_tr_b16 v[94:95], v14 offset:26624
    v_mfma_f32_16x16x32_bf16 v[32:35], v[64:67], v[196:199], v[32:35]
    ds_read_b64_tr_b16 v[96:97], v15 offset:24576
    s_add_u32 s43, s43, 1
    v_mfma_f32_16x16x32_bf16 v[48:51], v[64:67], v[200:203], v[48:51]
    ds_read_b64_tr_b16 v[98:99], v15 offset:26624
    v_mfma_f32_16x16x32_bf16 v[52:55], v[68:71], v[200:203], v[52:55]
    ds_read_b64_tr_b16 v[100:101], v16 offset:24576
    v_mfma_f32_16x16x32_bf16 v[36:39], v[68:71], v[196:199], v[36:39]
    ds_read_b64_tr_b16 v[102:103], v16 offset:26624
    s_waitcnt lgkmcnt(8)
    v_mfma_f32_16x16x32_bf16 v[24:27], v[72:75], v[204:207], v[24:27]
    ds_read_b64_tr_b16 v[104:105], v13 offset:28672
    buffer_load_dwordx4 v[196:199], v126, s[8:11], s44 offen
    v_mfma_f32_16x16x32_bf16 v[40:43], v[72:75], v[208:211], v[40:43]
    ds_read_b64_tr_b16 v[106:107], v13 offset:30720
    buffer_load_dwordx4 v[200:203], v127, s[8:11], s44 offen
    v_mfma_f32_16x16x32_bf16 v[44:47], v[76:79], v[208:211], v[44:47]
    ds_read_b64_tr_b16 v[108:109], v14 offset:28672
    s_add_u32 s44, s44, 16384
    s_waitcnt vmcnt(10)
    v_mfma_f32_16x16x32_bf16 v[28:31], v[76:79], v[204:207], v[28:31]
    ds_read_b64_tr_b16 v[110:111], v14 offset:30720
    v_add_u32 v13, 32768, v13
    v_or3_b32 v17, v212, v216, v220
    v_mfma_f32_16x16x32_bf16 v[32:35], v[80:83], v[204:207], v[32:35]
    ds_read_b64_tr_b16 v[112:113], v15 offset:28672
    v_add_u32 v14, 32768, v14
    v_bitop3_b32 v17, v17, v224, 1 bitop3:0xa8
    v_mfma_f32_16x16x32_bf16 v[48:51], v[80:83], v[208:211], v[48:51]
    ds_read_b64_tr_b16 v[114:115], v15 offset:30720
    v_add_u32 v15, 32768, v15
    v_cmp_ne_u32 vcc, 0, v17
    v_mfma_f32_16x16x32_bf16 v[52:55], v[84:87], v[208:211], v[52:55]
    ds_read_b64_tr_b16 v[116:117], v16 offset:28672
    ds_read_b64_tr_b16 v[118:119], v16 offset:30720
    s_cmp_eq_u32 s43, 4
    v_mfma_f32_16x16x32_bf16 v[36:39], v[84:87], v[204:207], v[36:39]
    v_add_u32 v16, 32768, v16
    s_waitcnt lgkmcnt(8)
    s_cbranch_vccnz dm_23f2
dm_23g2:
    s_cbranch_scc1 dm_23x
    v_mfma_f32_16x16x32_bf16 v[24:27], v[88:91], v[212:215], v[24:27]
    ds_read_b64_tr_b16 v[56:57], v13 offset:0
    buffer_load_dwordx4 v[204:207], v126, s[8:11], s44 offen
    v_mfma_f32_16x16x32_bf16 v[40:43], v[88:91], v[216:219], v[40:43]
    ds_read_b64_tr_b16 v[58:59], v13 offset:2048
    buffer_load_dwordx4 v[208:211], v127, s[8:11], s44 offen
    v_mfma_f32_16x16x32_bf16 v[44:47], v[92:95], v[216:219], v[44:47]
    ds_read_b64_tr_b16 v[60:61], v14 offset:0
    s_add_u32 s44, s44, 16384
    v_mfma_f32_16x16x32_bf16 v[28:31], v[92:95], v[212:215], v[28:31]
    ds_read_b64_tr_b16 v[62:63], v14 offset:2048
    v_mov_b32 v134, v126
    v_mfma_f32_16x16x32_bf16 v[32:35], v[96:99], v[212:215], v[32:35]
    ds_read_b64_tr_b16 v[64:65], v15 offset:0
    v_mov_b32 v135, v127
    v_mfma_f32_16x16x32_bf16 v[48:51], v[96:99], v[216:219], v[48:51]
    ds_read_b64_tr_b16 v[66:67], v15 offset:2048
    v_mfma_f32_16x16x32_bf16 v[52:55], v[100:103], v[216:219], v[52:55]
    ds_read_b64_tr_b16 v[68:69], v16 offset:0
    v_mfma_f32_16x16x32_bf16 v[36:39], v[100:103], v[212:215], v[36:39]
    ds_read_b64_tr_b16 v[70:71], v16 offset:2048
    s_waitcnt lgkmcnt(8)
    v_mfma_f32_16x16x32_bf16 v[24:27], v[104:107], v[220:223], v[24:27]
    ds_read_b64_tr_b16 v[72:73], v13 offset:4096
    buffer_load_dwordx4 v[212:215], v126, s[8:11], s44 offen
    v_mfma_f32_16x16x32_bf16 v[40:43], v[104:107], v[224:227], v[40:43]
    ds_read_b64_tr_b16 v[74:75], v13 offset:6144
    buffer_load_dwordx4 v[216:219], v127, s[8:11], s44 offen
    v_mfma_f32_16x16x32_bf16 v[44:47], v[108:111], v[224:227], v[44:47]
    ds_read_b64_tr_b16 v[76:77], v14 offset:4096
    s_add_u32 s44, s44, 16384
    s_waitcnt vmcnt(10)
    v_mfma_f32_16x16x32_bf16 v[28:31], v[108:111], v[220:223], v[28:31]
    ds_read_b64_tr_b16 v[78:79], v14 offset:6144
    v_or3_b32 v17, v164, v168, v172
    v_mfma_f32_16x16x32_bf16 v[32:35], v[112:115], v[220:223], v[32:35]
    ds_read_b64_tr_b16 v[80:81], v15 offset:4096
    v_bitop3_b32 v17, v17, v176, 1 bitop3:0xa8
    v_mfma_f32_16x16x32_bf16 v[48:51], v[112:115], v[224:227], v[48:51]
    ds_read_b64_tr_b16 v[82:83], v15 offset:6144
    v_cmp_ne_u32 vcc, 0, v17
    v_mfma_f32_16x16x32_bf16 v[52:55], v[116:119], v[224:227], v[52:55]
    ds_read_b64_tr_b16 v[84:85], v16 offset:4096
    ds_read_b64_tr_b16 v[86:87], v16 offset:6144
    v_mfma_f32_16x16x32_bf16 v[36:39], v[116:119], v[220:223], v[36:39]
    s_waitcnt lgkmcnt(8)
    s_cbranch_vccnz dm_23f3
dm_23g3:
    s_branch dm_23
dm_23f0:
    s_cselect_b32 s50, 1, 0
dm_23h0:
    s_sleep 2
    s_sub_u32 s44, s44, 114688
    buffer_load_dwordx4 v[180:183], v134, s[8:11], s44 offen sc1
    buffer_load_dwordx4 v[184:187], v135, s[8:11], s44 offen sc1
    s_add_u32 s44, s44, 16384
    buffer_load_dwordx4 v[188:191], v134, s[8:11], s44 offen sc1
    buffer_load_dwordx4 v[192:195], v135, s[8:11], s44 offen sc1
    s_add_u32 s44, s44, 16384
    buffer_load_dwordx4 v[196:199], v134, s[8:11], s44 offen sc1
    buffer_load_dwordx4 v[200:203], v135, s[8:11], s44 offen sc1
    s_add_u32 s44, s44, 16384
    buffer_load_dwordx4 v[204:207], v134, s[8:11], s44 offen sc1
    buffer_load_dwordx4 v[208:211], v135, s[8:11], s44 offen sc1
    s_add_u32 s44, s44, 16384
    buffer_load_dwordx4 v[212:215], v134, s[8:11], s44 offen sc1
    buffer_load_dwordx4 v[216:219], v135, s[8:11], s44 offen sc1
    s_add_u32 s44, s44, 16384
    buffer_load_dwordx4 v[220:223], v134, s[8:11], s44 offen sc1
    buffer_load_dwordx4 v[224:227], v135, s[8:11], s44 offen sc1
    s_add_u32 s44, s44, 16384
    buffer_load_dwordx4 v[164:167], v126, s[8:11], s44 offen sc1
    buffer_load_dwordx4 v[168:171], v127, s[8:11], s44 offen sc1
    s_add_u32 s44, s44, 16384
    s_waitcnt vmcnt(10)
    v_or3_b32 v17, v180, v184, v188
    v_bitop3_b32 v17, v17, v192, 1 bitop3:0xa8
    v_cmp_ne_u32 vcc, 0, v17
    s_add_u32 s53, s53, 1
    s_cmp_ge_u32 s53, s61
    s_cselect_b32 s61, 0, s61
    s_cbranch_scc1 dm_23k0
    s_cbranch_vccnz dm_23h0
dm_23k0:
    s_cmp_eq_u32 s50, 1
    s_branch dm_23g0
dm_23f1:
    s_cselect_b32 s50, 1, 0
dm_23h1:
    s_sleep 2
    s_sub_u32 s44, s44, 114688
    buffer_load_dwordx4 v[196:199], v134, s[8:11], s44 offen sc1
    buffer_load_dwordx4 v[200:203], v135, s[8:11], s44 offen sc1
    s_add_u32 s44, s44, 16384
    buffer_load_dwordx4 v[204:207], v134, s[8:11], s44 offen sc1
    buffer_load_dwordx4 v[208:211], v135, s[8:11], s44 offen sc1
    s_add_u32 s44, s44, 16384
    buffer_load_dwordx4 v[212:215], v134, s[8:11], s44 offen sc1
    buffer_load_dwordx4 v[216:219], v135, s[8:11], s44 offen sc1
    s_add_u32 s44, s44, 16384
    buffer_load_dwordx4 v[220:223], v134, s[8:11], s44 offen sc1
    buffer_load_dwordx4 v[224:227], v135, s[8:11], s44 offen sc1
    s_add_u32 s44, s44, 16384
    buffer_load_dwordx4 v[164:167], v126, s[8:11], s44 offen sc1
    buffer_load_dwordx4 v[168:171], v127, s[8:11], s44 offen sc1
    s_add_u32 s44, s44, 16384
    buffer_load_dwordx4 v[172:175], v126, s[8:11], s44 offen sc1
    buffer_load_dwordx4 v[176:179], v127, s[8:11], s44 offen sc1
    s_add_u32 s44, s44, 16384
    buffer_load_dwordx4 v[180:183], v126, s[8:11], s44 offen sc1
    buffer_load_dwordx4 v[184:187], v127, s[8:11], s44 offen sc1
    s_add_u32 s44, s44, 16384
    s_waitcnt vmcnt(10)
    v_or3_b32 v17, v196, v200, v204
    v_bitop3_b32 v17, v17, v208, 1 bitop3:0xa8
    v_cmp_ne_u32 vcc, 0, v17
    s_add_u32 s53, s53, 1
    s_cmp_ge_u32 s53, s61
    s_cselect_b32 s61, 0, s61
    s_cbranch_scc1 dm_23k1
    s_cbranch_vccnz dm_23h1
dm_23k1:
    s_cmp_eq_u32 s50, 1
    s_branch dm_23g1
dm_23f2:
    s_cselect_b32 s50, 1, 0
dm_23h2:
    s_sleep 2
    s_sub_u32 s44, s44, 114688
    buffer_load_dwordx4 v[212:215], v134, s[8:11], s44 offen sc1
    buffer_load_dwordx4 v[216:219], v135, s[8:11], s44 offen sc1
    s_add_u32 s44, s44, 16384
    buffer_load_dwordx4 v[220:223], v134, s[8:11], s44 offen sc1
    buffer_load_dwordx4 v[224:227], v135, s[8:11], s44 offen sc1
    s_add_u32 s44, s44, 16384
    buffer_load_dwordx4 v[164:167], v126, s[8:11], s44 offen sc1
    buffer_load_dwordx4 v[168:171], v127, s[8:11], s44 offen sc1
    s_add_u32 s44, s44, 16384
    buffer_load_dwordx4 v[172:175], v126, s[8:11], s44 offen sc1
    buffer_load_dwordx4 v[176:179], v127, s[8:11], s44 offen sc1
    s_add_u32 s44, s44, 16384
    buffer_load_dwordx4 v[180:183], v126, s[8:11], s44 offen sc1
    buffer_load_dwordx4 v[184:187], v127, s[8:11], s44 offen sc1
    s_add_u32 s44, s44, 16384
    buffer_load_dwordx4 v[188:191], v126, s[8:11], s44 offen sc1
    buffer_load_dwordx4 v[192:195], v127, s[8:11], s44 offen sc1
    s_add_u32 s44, s44, 16384
    buffer_load_dwordx4 v[196:199], v126, s[8:11], s44 offen sc1
    buffer_load_dwordx4 v[200:203], v127, s[8:11], s44 offen sc1
    s_add_u32 s44, s44, 16384
    s_waitcnt vmcnt(10)
    v_or3_b32 v17, v212, v216, v220
    v_bitop3_b32 v17, v17, v224, 1 bitop3:0xa8
    v_cmp_ne_u32 vcc, 0, v17
    s_add_u32 s53, s53, 1
    s_cmp_ge_u32 s53, s61
    s_cselect_b32 s61, 0, s61
    s_cbranch_scc1 dm_23k2
    s_cbranch_vccnz dm_23h2
dm_23k2:
    s_cmp_eq_u32 s50, 1
    s_branch dm_23g2
dm_23f3:
    s_cselect_b32 s50, 1, 0
dm_23h3:
    s_sleep 2
    s_sub_u32 s44, s44, 114688
    buffer_load_dwordx4 v[164:167], v134, s[8:11], s44 offen sc1
    buffer_load_dwordx4 v[168:171], v135, s[8:11], s44 offen sc1
    s_add_u32 s44, s44, 16384
    buffer_load_dwordx4 v[172:175], v134, s[8:11], s44 offen sc1
    buffer_load_dwordx4 v[176:179], v135, s[8:11], s44 offen sc1
    s_add_u32 s44, s44, 16384
    buffer_load_dwordx4 v[180:183], v134, s[8:11], s44 offen sc1
    buffer_load_dwordx4 v[184:187], v135, s[8:11], s44 offen sc1
    s_add_u32 s44, s44, 16384
    buffer_load_dwordx4 v[188:191], v134, s[8:11], s44 offen sc1
    buffer_load_dwordx4 v[192:195], v135, s[8:11], s44 offen sc1
    s_add_u32 s44, s44, 16384
    buffer_load_dwordx4 v[196:199], v134, s[8:11], s44 offen sc1
    buffer_load_dwordx4 v[200:203], v135, s[8:11], s44 offen sc1
    s_add_u32 s44, s44, 16384
    buffer_load_dwordx4 v[204:207], v134, s[8:11], s44 offen sc1
    buffer_load_dwordx4 v[208:211], v135, s[8:11], s44 offen sc1
    s_add_u32 s44, s44, 16384
    buffer_load_dwordx4 v[212:215], v134, s[8:11], s44 offen sc1
    buffer_load_dwordx4 v[216:219], v135, s[8:11], s44 offen sc1
    s_add_u32 s44, s44, 16384
    s_waitcnt vmcnt(10)
    v_or3_b32 v17, v164, v168, v172
    v_bitop3_b32 v17, v17, v176, 1 bitop3:0xa8
    v_cmp_ne_u32 vcc, 0, v17
    s_add_u32 s53, s53, 1
    s_cmp_ge_u32 s53, s61
    s_cselect_b32 s61, 0, s61
    s_cbranch_scc1 dm_23k3
    s_cbranch_vccnz dm_23h3
dm_23k3:
    s_cmp_eq_u32 s50, 1
    s_branch dm_23g3
dm_23x:
    v_mfma_f32_16x16x32_bf16 v[24:27], v[88:91], v[212:215], v[24:27]
    v_mfma_f32_16x16x32_bf16 v[40:43], v[88:91], v[216:219], v[40:43]
    v_mfma_f32_16x16x32_bf16 v[44:47], v[92:95], v[216:219], v[44:47]
    v_mfma_f32_16x16x32_bf16 v[28:31], v[92:95], v[212:215], v[28:31]
    v_mfma_f32_16x16x32_bf16 v[32:35], v[96:99], v[212:215], v[32:35]
    v_mfma_f32_16x16x32_bf16 v[48:51], v[96:99], v[216:219], v[48:51]
    v_mfma_f32_16x16x32_bf16 v[52:55], v[100:103], v[216:219], v[52:55]
    v_mfma_f32_16x16x32_bf16 v[36:39], v[100:103], v[212:215], v[36:39]
    s_waitcnt lgkmcnt(0)
    v_mfma_f32_16x16x32_bf16 v[24:27], v[104:107], v[220:223], v[24:27]
    s_add_u32 s44, s62, 0x5c8000
    v_mfma_f32_16x16x32_bf16 v[40:43], v[104:107], v[224:227], v[40:43]
    s_addc_u32 s45, s63, 0
    v_mfma_f32_16x16x32_bf16 v[44:47], v[108:111], v[224:227], v[44:47]
    v_mfma_f32_16x16x32_bf16 v[28:31], v[108:111], v[220:223], v[28:31]
    s_mov_b32 s46, 0x6000
    v_mfma_f32_16x16x32_bf16 v[32:35], v[112:115], v[220:223], v[32:35]
    v_mfma_f32_16x16x32_bf16 v[48:51], v[112:115], v[224:227], v[48:51]
    s_mov_b32 s47, 0x20000
    v_mfma_f32_16x16x32_bf16 v[52:55], v[116:119], v[224:227], v[52:55]
    v_mfma_f32_16x16x32_bf16 v[36:39], v[116:119], v[220:223], v[36:39]
    s_add_u32 s36, s39, 0
    v_cvt_pk_bf16_f32 v148, v24, v25
    v_cvt_pk_bf16_f32 v149, v26, v27
    v_cvt_pk_bf16_f32 v150, v28, v29
    v_cvt_pk_bf16_f32 v151, v30, v31
    v_and_b32 v148, -2, v148
    buffer_store_dwordx4 v[148:151], v2, s[16:19], s36 offen offset:0 sc1
    v_cvt_pk_bf16_f32 v152, v32, v33
    v_cvt_pk_bf16_f32 v153, v34, v35
    v_cvt_pk_bf16_f32 v154, v36, v37
    v_cvt_pk_bf16_f32 v155, v38, v39
    v_and_b32 v152, -2, v152
    buffer_store_dwordx4 v[152:155], v2, s[16:19], s36 offen offset:1024 sc1
    s_add_u32 s36, s39, 65536
    v_cvt_pk_bf16_f32 v156, v40, v41
    v_cvt_pk_bf16_f32 v157, v42, v43
    v_cvt_pk_bf16_f32 v158, v44, v45
    v_cvt_pk_bf16_f32 v159, v46, v47
    v_and_b32 v156, -2, v156
    buffer_store_dwordx4 v[156:159], v2, s[16:19], s36 offen offset:0 sc1
    v_cvt_pk_bf16_f32 v160, v48, v49
    v_cvt_pk_bf16_f32 v161, v50, v51
    v_cvt_pk_bf16_f32 v162, v52, v53
    v_cvt_pk_bf16_f32 v163, v54, v55
    v_and_b32 v160, -2, v160
    buffer_store_dwordx4 v[160:163], v2, s[16:19], s36 offen offset:1024 sc1
    s_barrier
    s_lshl_b32 s36, s37, 11
    v_add_u32 v7, s36, v2
    ds_write_b128 v7, v[148:151] offset:0
    ds_write_b128 v7, v[152:155] offset:1024
    ds_write_b128 v7, v[156:159] offset:2048
    ds_write_b128 v7, v[160:163] offset:3072
    v_lshlrev_b32 v24, 16, v148
    v_and_b32 v25, 0xffff0000, v148
    v_lshlrev_b32 v26, 16, v149
    v_and_b32 v27, 0xffff0000, v149
    v_lshlrev_b32 v28, 16, v150
    v_and_b32 v29, 0xffff0000, v150
    v_lshlrev_b32 v30, 16, v151
    v_and_b32 v31, 0xffff0000, v151
    v_lshlrev_b32 v32, 16, v152
    v_and_b32 v33, 0xffff0000, v152
    v_lshlrev_b32 v34, 16, v153
    v_and_b32 v35, 0xffff0000, v153
    v_lshlrev_b32 v36, 16, v154
    v_and_b32 v37, 0xffff0000, v154
    v_lshlrev_b32 v38, 16, v155
    v_and_b32 v39, 0xffff0000, v155
    v_lshlrev_b32 v40, 16, v156
    v_and_b32 v41, 0xffff0000, v156
    v_lshlrev_b32 v42, 16, v157
    v_and_b32 v43, 0xffff0000, v157
    v_lshlrev_b32 v44, 16, v158
    v_and_b32 v45, 0xffff0000, v158
    v_lshlrev_b32 v46, 16, v159
    v_and_b32 v47, 0xffff0000, v159
    v_lshlrev_b32 v48, 16, v160
    v_and_b32 v49, 0xffff0000, v160
    v_lshlrev_b32 v50, 16, v161
    v_and_b32 v51, 0xffff0000, v161
    v_lshlrev_b32 v52, 16, v162
    v_and_b32 v53, 0xffff0000, v162
    v_lshlrev_b32 v54, 16, v163
    v_and_b32 v55, 0xffff0000, v163
    s_add_u32 s53, s55, 512
    v_mov_b32 v8, 1
    v_mov_b32 v9, 162816
    v_mov_b32 v11, 0
    s_mov_b64 exec, 1
    s_waitcnt vmcnt(0)
    ds_add_rtn_u32 v10, v9, v8
    s_waitcnt lgkmcnt(0)
    v_readfirstlane_b32 s54, v10
    s_nop 0
    s_and_b32 s54, s54, 3
    s_cmp_lg_u32 s54, 3
    s_cbranch_scc1 pub_24
    buffer_atomic_add v8, v11, s[56:59], s53 offen sc1
    v_mov_b32 v9, 162872
    ds_add_u32 v9, v8
pub_24:
    s_mov_b64 exec, -1
    s_waitcnt lgkmcnt(0)
    s_barrier
    v_pk_add_f32 v[142:143], v[24:25], v[26:27]
    v_pk_mul_f32 v[136:137], v[24:25], v[24:25]
    v_pk_fma_f32 v[136:137], v[26:27], v[26:27], v[136:137]
    v_pk_add_f32 v[142:143], v[142:143], v[28:29]
    v_pk_fma_f32 v[136:137], v[28:29], v[28:29], v[136:137]
    v_pk_add_f32 v[142:143], v[142:143], v[30:31]
    v_pk_fma_f32 v[136:137], v[30:31], v[30:31], v[136:137]
    v_pk_add_f32 v[142:143], v[142:143], v[32:33]
    v_pk_fma_f32 v[136:137], v[32:33], v[32:33], v[136:137]
    v_pk_add_f32 v[142:143], v[142:143], v[34:35]
    v_pk_fma_f32 v[136:137], v[34:35], v[34:35], v[136:137]
    v_pk_add_f32 v[142:143], v[142:143], v[36:37]
    v_pk_fma_f32 v[136:137], v[36:37], v[36:37], v[136:137]
    v_pk_add_f32 v[142:143], v[142:143], v[38:39]
    v_pk_fma_f32 v[136:137], v[38:39], v[38:39], v[136:137]
    v_add_f32 v138, v142, v143
    v_add_f32 v139, v136, v137
    v_mov_b32 v142, v138
    v_mov_b32 v143, v139
    s_nop 0
    v_permlane16_swap_b32 v138, v142
    v_permlane16_swap_b32 v139, v143
    v_pk_add_f32 v[138:139], v[138:139], v[142:143]
    v_mov_b32 v142, v138
    v_mov_b32 v143, v139
    s_nop 0
    v_permlane32_swap_b32 v138, v142
    v_permlane32_swap_b32 v139, v143
    v_pk_add_f32 v[138:139], v[138:139], v[142:143]
    v_pk_add_f32 v[142:143], v[40:41], v[42:43]
    v_pk_mul_f32 v[136:137], v[40:41], v[40:41]
    v_pk_fma_f32 v[136:137], v[42:43], v[42:43], v[136:137]
    v_pk_add_f32 v[142:143], v[142:143], v[44:45]
    v_pk_fma_f32 v[136:137], v[44:45], v[44:45], v[136:137]
    v_pk_add_f32 v[142:143], v[142:143], v[46:47]
    v_pk_fma_f32 v[136:137], v[46:47], v[46:47], v[136:137]
    v_pk_add_f32 v[142:143], v[142:143], v[48:49]
    v_pk_fma_f32 v[136:137], v[48:49], v[48:49], v[136:137]
    v_pk_add_f32 v[142:143], v[142:143], v[50:51]
    v_pk_fma_f32 v[136:137], v[50:51], v[50:51], v[136:137]
    v_pk_add_f32 v[142:143], v[142:143], v[52:53]
    v_pk_fma_f32 v[136:137], v[52:53], v[52:53], v[136:137]
    v_pk_add_f32 v[142:143], v[142:143], v[54:55]
    v_pk_fma_f32 v[136:137], v[54:55], v[54:55], v[136:137]
    v_add_f32 v140, v142, v143
    v_add_f32 v141, v136, v137
    v_mov_b32 v142, v140
    v_mov_b32 v143, v141
    s_nop 0
    v_permlane16_swap_b32 v140, v142
    v_permlane16_swap_b32 v141, v143
    v_pk_add_f32 v[140:141], v[140:141], v[142:143]
    v_mov_b32 v142, v140
    v_mov_b32 v143, v141
    s_nop 0
    v_permlane32_swap_b32 v140, v142
    v_permlane32_swap_b32 v141, v143
    v_pk_add_f32 v[140:141], v[140:141], v[142:143]
    v_cmp_eq_u32 vcc, 0, v23
    s_nop 1
    v_cndmask_b32 v138, v140, v138, vcc
    v_cndmask_b32 v139, v141, v139, vcc
    s_lshr_b32 s53, s29, 3
    s_lshl_b32 s53, s53, 14
    s_and_b32 s40, s29, 7
    s_lshl_b32 s40, s40, 10
    s_add_u32 s40, s40, s53
    s_lshl_b32 s36, s34, 8
    s_add_u32 s40, s40, s36
    v_lshlrev_b32 v7, 3, v1
    s_bfm_b64 exec, 32, 0
    buffer_store_dwordx2 v[138:139], v7, s[44:47], s40 offen sc1
    s_mov_b64 exec, -1
    s_lshr_b32 s34, s30, 1
    s_and_b32 s35, s30, 1
    v_and_b32 v22, 15, v1
    v_lshrrev_b32 v23, 4, v1
    s_mul_i32 s37, s34, 4
    s_mul_i32 s38, s29, 14
    s_mul_i32 s36, s35, 7
    s_add_u32 s38, s38, s36
    s_mul_i32 s36, s34, 8192
    v_add_u32 v12, s36, v2
    v_lshrrev_b32 v6, 2, v1
    v_mul_u32_u24 v13, 448, v6
    v_and_b32 v7, 3, v1
    v_lshl_add_u32 v13, v7, 3, v13
    v_add_u32 v13, 73728, v13
    s_mul_i32 s36, s35, 224
    v_add_u32 v13, s36, v13
    v_bfe_u32 v6, v1, 4, 1
    v_lshlrev_b32 v6, 5, v6
    s_cmp_eq_u32 s35, 0
    s_cselect_b32 s36, 1, -1
    v_mul_lo_u32 v6, v6, s36
    v_sub_u32 v14, v13, v6
    v_add_u32 v13, v13, v6
    v_mov_b32 v17, v12
    s_mov_b32 s42, 0
    s_mov_b32 s43, 0
    s_mov_b32 s48, 57344
    v_add_u32 v18, 57344, v13
    v_add_u32 v19, 57344, v14
    ds_read_b128 v[136:139], v17 offset:0
    ds_read_b128 v[140:143], v17 offset:2048
    ds_read_b128 v[144:147], v17 offset:4096
    ds_read_b128 v[148:151], v17 offset:6144
    ds_read_b64_tr_b16 v[152:153], v18 offset:0
    ds_read_b64_tr_b16 v[154:155], v18 offset:7168
    ds_read_b64_tr_b16 v[156:157], v19 offset:32
    ds_read_b64_tr_b16 v[158:159], v19 offset:7200
    ds_read_b64_tr_b16 v[160:161], v18 offset:64
    ds_read_b64_tr_b16 v[162:163], v18 offset:7232
    ds_read_b64_tr_b16 v[164:165], v19 offset:96
    ds_read_b64_tr_b16 v[166:167], v19 offset:7264
    ds_read_b64_tr_b16 v[168:169], v18 offset:128
    ds_read_b64_tr_b16 v[170:171], v18 offset:7296
    ds_read_b64_tr_b16 v[172:173], v19 offset:160
    ds_read_b64_tr_b16 v[174:175], v19 offset:7328
    ds_read_b64_tr_b16 v[176:177], v18 offset:192
    ds_read_b64_tr_b16 v[178:179], v18 offset:7360
    s_waitcnt lgkmcnt(12)
    v_mfma_f32_16x16x32_bf16 v[24:27], v[152:155], v[136:139], 0
    ds_read_b128 v[180:183], v17 offset:1024
    s_add_u32 s42, s42, 16384
    v_mfma_f32_16x16x32_bf16 v[52:55], v[152:155], v[140:143], 0
    ds_read_b128 v[184:187], v17 offset:3072
    s_cmp_eq_u32 s42, 49152
    v_mfma_f32_16x16x32_bf16 v[80:83], v[152:155], v[144:147], 0
    ds_read_b128 v[188:191], v17 offset:5120
    s_cselect_b32 s42, 0, s42
    v_mfma_f32_16x16x32_bf16 v[108:111], v[152:155], v[148:151], 0
    ds_read_b128 v[192:195], v17 offset:7168
    s_waitcnt lgkmcnt(14)
    v_mfma_f32_16x16x32_bf16 v[112:115], v[156:159], v[148:151], 0
    ds_read_b64_tr_b16 v[196:197], v18 offset:14336
    s_add_u32 s48, s48, 28672
    v_mfma_f32_16x16x32_bf16 v[84:87], v[156:159], v[144:147], 0
    ds_read_b64_tr_b16 v[198:199], v18 offset:21504
    s_cmp_eq_u32 s48, 86016
    v_mfma_f32_16x16x32_bf16 v[56:59], v[156:159], v[140:143], 0
    ds_read_b64_tr_b16 v[200:201], v19 offset:14368
    s_cselect_b32 s48, 0, s48
    v_mfma_f32_16x16x32_bf16 v[28:31], v[156:159], v[136:139], 0
    ds_read_b64_tr_b16 v[202:203], v19 offset:21536
    s_waitcnt lgkmcnt(8)
    v_mfma_f32_16x16x32_bf16 v[32:35], v[160:163], v[136:139], 0
    ds_read_b64_tr_b16 v[204:205], v18 offset:14400
    v_add_u32 v17, s42, v12
    v_mfma_f32_16x16x32_bf16 v[60:63], v[160:163], v[140:143], 0
    ds_read_b64_tr_b16 v[206:207], v18 offset:21568
    v_mfma_f32_16x16x32_bf16 v[88:91], v[160:163], v[144:147], 0
    ds_read_b64_tr_b16 v[208:209], v19 offset:14432
    v_mfma_f32_16x16x32_bf16 v[116:119], v[160:163], v[148:151], 0
    ds_read_b64_tr_b16 v[210:211], v19 offset:21600
    v_mfma_f32_16x16x32_bf16 v[120:123], v[164:167], v[148:151], 0
    ds_read_b64_tr_b16 v[212:213], v18 offset:14464
    v_mfma_f32_16x16x32_bf16 v[92:95], v[164:167], v[144:147], 0
    ds_read_b64_tr_b16 v[214:215], v18 offset:21632
    v_mfma_f32_16x16x32_bf16 v[64:67], v[164:167], v[140:143], 0
    ds_read_b64_tr_b16 v[216:217], v19 offset:14496
    v_mfma_f32_16x16x32_bf16 v[36:39], v[164:167], v[136:139], 0
    ds_read_b64_tr_b16 v[218:219], v19 offset:21664
    v_add_u32 v19, s48, v14
    v_mfma_f32_16x16x32_bf16 v[40:43], v[168:171], v[136:139], 0
    ds_read_b64_tr_b16 v[220:221], v18 offset:14528
    v_mfma_f32_16x16x32_bf16 v[68:71], v[168:171], v[140:143], 0
    ds_read_b64_tr_b16 v[222:223], v18 offset:21696
    v_add_u32 v18, s48, v13
    v_mfma_f32_16x16x32_bf16 v[96:99], v[168:171], v[144:147], 0
    v_mfma_f32_16x16x32_bf16 v[124:127], v[168:171], v[148:151], 0
    v_mfma_f32_16x16x32_bf16 v[128:131], v[172:175], v[148:151], 0
    v_mfma_f32_16x16x32_bf16 v[100:103], v[172:175], v[144:147], 0
    v_mfma_f32_16x16x32_bf16 v[72:75], v[172:175], v[140:143], 0
    v_mfma_f32_16x16x32_bf16 v[44:47], v[172:175], v[136:139], 0
    v_mfma_f32_16x16x32_bf16 v[48:51], v[176:179], v[136:139], 0
    v_mfma_f32_16x16x32_bf16 v[76:79], v[176:179], v[140:143], 0
    v_mfma_f32_16x16x32_bf16 v[104:107], v[176:179], v[144:147], 0
    v_mfma_f32_16x16x32_bf16 v[132:135], v[176:179], v[148:151], 0
    s_waitcnt lgkmcnt(12)
    v_mfma_f32_16x16x32_bf16 v[24:27], v[196:199], v[180:183], v[24:27]
    s_add_u32 s43, s43, 1
    s_mul_i32 s36, s35, 448
    s_add_u32 s36, s36, 159744
    v_lshlrev_b32 v6, 4, v23
    v_mfma_f32_16x16x32_bf16 v[52:55], v[196:199], v[184:187], v[52:55]
    v_add_u32 v6, s36, v6
    s_lshl_b32 s36, s37, 8
    s_add_u32 s36, s36, 160768
    v_lshlrev_b32 v7, 4, v22
    v_mfma_f32_16x16x32_bf16 v[80:83], v[196:199], v[188:191], v[80:83]
    v_add_u32 v7, s36, v7
    s_add_u32 s16, s62, 0x400000
    s_addc_u32 s17, s63, 0
    s_mov_b32 s18, 0x1be000
    v_mfma_f32_16x16x32_bf16 v[108:111], v[196:199], v[192:195], v[108:111]
    s_mov_b32 s19, 0x20000
    s_mul_i32 s39, s37, 229376
    s_lshr_b32 s36, s38, 1
    s_waitcnt lgkmcnt(0)
    v_mfma_f32_16x16x32_bf16 v[112:115], v[200:203], v[192:195], v[112:115]
    s_add_u32 s36, s36, 0
    s_lshr_b32 s53, s36, 3
    s_lshl_b32 s53, s53, 14
    s_and_b32 s44, s36, 7
    v_mfma_f32_16x16x32_bf16 v[84:87], v[200:203], v[188:191], v[84:87]
    s_lshl_b32 s44, s44, 10
    s_add_u32 s44, s44, s53
    s_add_u32 s44, s44, s39
    s_lshr_b32 s36, s38, 1
    v_mfma_f32_16x16x32_bf16 v[56:59], v[200:203], v[184:187], v[56:59]
    s_add_u32 s36, s36, 1
    s_lshr_b32 s53, s36, 3
    s_lshl_b32 s53, s53, 14
    s_and_b32 s45, s36, 7
    v_mfma_f32_16x16x32_bf16 v[28:31], v[200:203], v[180:183], v[28:31]
    s_lshl_b32 s45, s45, 10
    s_add_u32 s45, s45, s53
    s_add_u32 s45, s45, s39
    s_lshr_b32 s36, s38, 1
    v_mfma_f32_16x16x32_bf16 v[32:35], v[204:207], v[180:183], v[32:35]
    s_add_u32 s36, s36, 2
    s_lshr_b32 s53, s36, 3
    s_lshl_b32 s53, s53, 14
    s_and_b32 s46, s36, 7
    v_mfma_f32_16x16x32_bf16 v[60:63], v[204:207], v[184:187], v[60:63]
    s_lshl_b32 s46, s46, 10
    s_add_u32 s46, s46, s53
    s_add_u32 s46, s46, s39
    s_lshr_b32 s36, s38, 1
    v_mfma_f32_16x16x32_bf16 v[88:91], v[204:207], v[188:191], v[88:91]
    s_add_u32 s36, s36, 3
    s_lshr_b32 s53, s36, 3
    s_lshl_b32 s53, s53, 14
    s_and_b32 s47, s36, 7
    v_mfma_f32_16x16x32_bf16 v[116:119], v[204:207], v[192:195], v[116:119]
    s_lshl_b32 s47, s47, 10
    s_add_u32 s47, s47, s53
    s_add_u32 s47, s47, s39
    v_lshrrev_b32 v226, 2, v1
    v_mfma_f32_16x16x32_bf16 v[120:123], v[208:211], v[192:195], v[120:123]
    v_mul_u32_u24 v240, 256, v226
    v_and_b32 v227, 3, v1
    v_lshl_add_u32 v240, v227, 3, v240
    v_add_u32 v240, 49152, v240
    v_mfma_f32_16x16x32_bf16 v[92:95], v[208:211], v[188:191], v[92:95]
    v_and_b32 v226, 7, v226
    s_mul_i32 s36, s35, 4
    s_add_u32 s36, s36, 3
    v_xor_b32 v227, s36, v226
    v_mfma_f32_16x16x32_bf16 v[64:67], v[208:211], v[184:187], v[64:67]
    v_lshl_add_u32 v243, v227, 5, v240
    s_mul_i32 s36, s35, 4
    s_add_u32 s36, s36, 2
    v_xor_b32 v227, s36, v226
    v_mfma_f32_16x16x32_bf16 v[36:39], v[208:211], v[180:183], v[36:39]
    v_lshl_add_u32 v242, v227, 5, v240
    s_mul_i32 s36, s35, 4
    s_add_u32 s36, s36, 1
    v_xor_b32 v227, s36, v226
    v_mfma_f32_16x16x32_bf16 v[40:43], v[212:215], v[180:183], v[40:43]
    v_lshl_add_u32 v241, v227, 5, v240
    s_mul_i32 s36, s35, 4
    s_add_u32 s36, s36, 0
    v_xor_b32 v227, s36, v226
    v_mfma_f32_16x16x32_bf16 v[68:71], v[212:215], v[184:187], v[68:71]
    v_lshl_add_u32 v240, v227, 5, v240
    s_lshl_b32 s38, s33, 3
    s_lshl_b32 s36, s35, 2
    s_add_u32 s38, s38, s36
    v_mfma_f32_16x16x32_bf16 v[96:99], v[212:215], v[188:191], v[96:99]
    s_lshr_b32 s36, s38, 1
    s_lshr_b32 s53, s36, 3
    s_lshl_b32 s53, s53, 14
    s_and_b32 s39, s36, 7
    v_mfma_f32_16x16x32_bf16 v[124:127], v[212:215], v[192:195], v[124:127]
    s_lshl_b32 s39, s39, 10
    s_add_u32 s39, s39, s53
    s_lshl_b32 s36, s37, 16
    s_add_u32 s39, s39, s36
    v_mfma_f32_16x16x32_bf16 v[128:131], v[216:219], v[192:195], v[128:131]
    s_lshl_b32 s40, s31, 17
    s_add_u32 s40, s40, s39
    s_xor_b32 s41, s31, 1
    s_lshl_b32 s41, s41, 17
    v_mfma_f32_16x16x32_bf16 v[100:103], v[216:219], v[188:191], v[100:103]
    s_add_u32 s41, s41, s39
    s_mov_b32 s84, s62
    s_mov_b32 s85, s63
    s_mov_b32 s86, 0x7e000
    v_mfma_f32_16x16x32_bf16 v[72:75], v[216:219], v[184:187], v[72:75]
    s_mov_b32 s87, 0x20000
    s_add_u32 s88, s62, 0x80000
    s_addc_u32 s89, s63, 0
    s_mov_b32 s90, 0x7e000
    v_mfma_f32_16x16x32_bf16 v[44:47], v[216:219], v[180:183], v[44:47]
    s_mov_b32 s91, 0x20000
    s_lshl_b32 s36, s37, 1
    s_add_u32 s36, s36, s35
    s_lshl_b32 s36, s36, 10
    v_mfma_f32_16x16x32_bf16 v[48:51], v[220:223], v[180:183], v[48:51]
    v_add_u32 v244, s36, v2
    v_mov_b32 v245, 1
    v_mov_b32 v246, 162880
    v_lshrrev_b32 v238, 1, v23
    v_mfma_f32_16x16x32_bf16 v[76:79], v[220:223], v[184:187], v[76:79]
    v_lshlrev_b32 v238, 8, v238
    v_lshl_add_u32 v238, v22, 4, v238
    v_and_b32 v224, 1, v23
    v_lshl_add_u32 v238, v224, 3, v238
    v_mfma_f32_16x16x32_bf16 v[104:107], v[220:223], v[188:191], v[104:107]
    v_mfma_f32_16x16x32_bf16 v[132:135], v[220:223], v[192:195], v[132:135]
    s_add_u32 s53, s55, 1408
    v_mov_b32 v8, 1
    v_mov_b32 v9, 162864
    v_mov_b32 v11, 0
    s_mov_b64 exec, 1
    s_waitcnt vmcnt(0)
    ds_add_rtn_u32 v10, v9, v8
    s_waitcnt lgkmcnt(0)
    v_readfirstlane_b32 s54, v10
    s_nop 0
    s_and_b32 s54, s54, 3
    s_cmp_lg_u32 s54, 3
    s_cbranch_scc1 pub_25
    buffer_atomic_add v8, v11, s[56:59], s53 offen sc1
pub_25:
    s_mov_b64 exec, -1
    s_barrier
    ds_read_b128 v[136:139], v17 offset:0
    ds_read_b128 v[140:143], v17 offset:2048
    ds_read_b128 v[144:147], v17 offset:4096
    ds_read_b128 v[148:151], v17 offset:6144
    ds_read_b64_tr_b16 v[152:153], v18 offset:0
    ds_read_b64_tr_b16 v[154:155], v18 offset:7168
    ds_read_b64_tr_b16 v[156:157], v19 offset:32
    ds_read_b64_tr_b16 v[158:159], v19 offset:7200
    ds_read_b64_tr_b16 v[160:161], v18 offset:64
    ds_read_b64_tr_b16 v[162:163], v18 offset:7232
    ds_read_b64_tr_b16 v[164:165], v19 offset:96
    ds_read_b64_tr_b16 v[166:167], v19 offset:7264
    ds_read_b64_tr_b16 v[168:169], v18 offset:128
    ds_read_b64_tr_b16 v[170:171], v18 offset:7296
    ds_read_b64_tr_b16 v[172:173], v19 offset:160
    ds_read_b64_tr_b16 v[174:175], v19 offset:7328
    ds_read_b64_tr_b16 v[176:177], v18 offset:192
    ds_read_b64_tr_b16 v[178:179], v18 offset:7360
    s_waitcnt lgkmcnt(12)
mm_26:
    v_mfma_f32_16x16x32_bf16 v[24:27], v[152:155], v[136:139], v[24:27]
    ds_read_b128 v[180:183], v17 offset:1024
    s_add_u32 s42, s42, 16384
    v_mfma_f32_16x16x32_bf16 v[52:55], v[152:155], v[140:143], v[52:55]
    ds_read_b128 v[184:187], v17 offset:3072
    s_cmp_eq_u32 s42, 49152
    v_mfma_f32_16x16x32_bf16 v[80:83], v[152:155], v[144:147], v[80:83]
    ds_read_b128 v[188:191], v17 offset:5120
    s_cselect_b32 s42, 0, s42
    v_mfma_f32_16x16x32_bf16 v[108:111], v[152:155], v[148:151], v[108:111]
    ds_read_b128 v[192:195], v17 offset:7168
    s_waitcnt lgkmcnt(14)
    v_mfma_f32_16x16x32_bf16 v[112:115], v[156:159], v[148:151], v[112:115]
    ds_read_b64_tr_b16 v[196:197], v18 offset:14336
    s_add_u32 s48, s48, 28672
    v_mfma_f32_16x16x32_bf16 v[84:87], v[156:159], v[144:147], v[84:87]
    ds_read_b64_tr_b16 v[198:199], v18 offset:21504
    s_cmp_eq_u32 s48, 86016
    v_mfma_f32_16x16x32_bf16 v[56:59], v[156:159], v[140:143], v[56:59]
    ds_read_b64_tr_b16 v[200:201], v19 offset:14368
    s_cselect_b32 s48, 0, s48
    v_mfma_f32_16x16x32_bf16 v[28:31], v[156:159], v[136:139], v[28:31]
    ds_read_b64_tr_b16 v[202:203], v19 offset:21536
    s_waitcnt lgkmcnt(8)
    v_mfma_f32_16x16x32_bf16 v[32:35], v[160:163], v[136:139], v[32:35]
    ds_read_b64_tr_b16 v[204:205], v18 offset:14400
    v_add_u32 v17, s42, v12
    v_mfma_f32_16x16x32_bf16 v[60:63], v[160:163], v[140:143], v[60:63]
    ds_read_b64_tr_b16 v[206:207], v18 offset:21568
    v_mfma_f32_16x16x32_bf16 v[88:91], v[160:163], v[144:147], v[88:91]
    ds_read_b64_tr_b16 v[208:209], v19 offset:14432
    v_mfma_f32_16x16x32_bf16 v[116:119], v[160:163], v[148:151], v[116:119]
    ds_read_b64_tr_b16 v[210:211], v19 offset:21600
    v_mfma_f32_16x16x32_bf16 v[120:123], v[164:167], v[148:151], v[120:123]
    ds_read_b64_tr_b16 v[212:213], v18 offset:14464
    v_mfma_f32_16x16x32_bf16 v[92:95], v[164:167], v[144:147], v[92:95]
    ds_read_b64_tr_b16 v[214:215], v18 offset:21632
    v_mfma_f32_16x16x32_bf16 v[64:67], v[164:167], v[140:143], v[64:67]
    ds_read_b64_tr_b16 v[216:217], v19 offset:14496
    v_mfma_f32_16x16x32_bf16 v[36:39], v[164:167], v[136:139], v[36:39]
    ds_read_b64_tr_b16 v[218:219], v19 offset:21664
    v_add_u32 v19, s48, v14
    v_mfma_f32_16x16x32_bf16 v[40:43], v[168:171], v[136:139], v[40:43]
    ds_read_b64_tr_b16 v[220:221], v18 offset:14528
    v_mfma_f32_16x16x32_bf16 v[68:71], v[168:171], v[140:143], v[68:71]
    ds_read_b64_tr_b16 v[222:223], v18 offset:21696
    v_add_u32 v18, s48, v13
    v_mfma_f32_16x16x32_bf16 v[96:99], v[168:171], v[144:147], v[96:99]
    v_mfma_f32_16x16x32_bf16 v[124:127], v[168:171], v[148:151], v[124:127]
    v_mfma_f32_16x16x32_bf16 v[128:131], v[172:175], v[148:151], v[128:131]
    v_mfma_f32_16x16x32_bf16 v[100:103], v[172:175], v[144:147], v[100:103]
    v_mfma_f32_16x16x32_bf16 v[72:75], v[172:175], v[140:143], v[72:75]
    v_mfma_f32_16x16x32_bf16 v[44:47], v[172:175], v[136:139], v[44:47]
    v_mfma_f32_16x16x32_bf16 v[48:51], v[176:179], v[136:139], v[48:51]
    v_mfma_f32_16x16x32_bf16 v[76:79], v[176:179], v[140:143], v[76:79]
    v_mfma_f32_16x16x32_bf16 v[104:107], v[176:179], v[144:147], v[104:107]
    v_mfma_f32_16x16x32_bf16 v[132:135], v[176:179], v[148:151], v[132:135]
    s_waitcnt lgkmcnt(12)
    v_mfma_f32_16x16x32_bf16 v[24:27], v[196:199], v[180:183], v[24:27]
    s_add_u32 s43, s43, 1
    s_cmp_lt_u32 s43, 15
    v_mfma_f32_16x16x32_bf16 v[52:55], v[196:199], v[184:187], v[52:55]
    v_mfma_f32_16x16x32_bf16 v[80:83], v[196:199], v[188:191], v[80:83]
    v_mfma_f32_16x16x32_bf16 v[108:111], v[196:199], v[192:195], v[108:111]
    s_waitcnt lgkmcnt(0)
    s_barrier
    v_mfma_f32_16x16x32_bf16 v[112:115], v[200:203], v[192:195], v[112:115]
    ds_read_b128 v[136:139], v17 offset:0
    v_mfma_f32_16x16x32_bf16 v[84:87], v[200:203], v[188:191], v[84:87]
    ds_read_b128 v[140:143], v17 offset:2048
    v_mfma_f32_16x16x32_bf16 v[56:59], v[200:203], v[184:187], v[56:59]
    ds_read_b128 v[144:147], v17 offset:4096
    v_mfma_f32_16x16x32_bf16 v[28:31], v[200:203], v[180:183], v[28:31]
    ds_read_b128 v[148:151], v17 offset:6144
    v_mfma_f32_16x16x32_bf16 v[32:35], v[204:207], v[180:183], v[32:35]
    ds_read_b64_tr_b16 v[152:153], v18 offset:0
    v_mfma_f32_16x16x32_bf16 v[60:63], v[204:207], v[184:187], v[60:63]
    ds_read_b64_tr_b16 v[154:155], v18 offset:7168
    v_mfma_f32_16x16x32_bf16 v[88:91], v[204:207], v[188:191], v[88:91]
    ds_read_b64_tr_b16 v[156:157], v19 offset:32
    v_mfma_f32_16x16x32_bf16 v[116:119], v[204:207], v[192:195], v[116:119]
    ds_read_b64_tr_b16 v[158:159], v19 offset:7200
    v_mfma_f32_16x16x32_bf16 v[120:123], v[208:211], v[192:195], v[120:123]
    ds_read_b64_tr_b16 v[160:161], v18 offset:64
    v_mfma_f32_16x16x32_bf16 v[92:95], v[208:211], v[188:191], v[92:95]
    ds_read_b64_tr_b16 v[162:163], v18 offset:7232
    v_mfma_f32_16x16x32_bf16 v[64:67], v[208:211], v[184:187], v[64:67]
    ds_read_b64_tr_b16 v[164:165], v19 offset:96
    v_mfma_f32_16x16x32_bf16 v[36:39], v[208:211], v[180:183], v[36:39]
    ds_read_b64_tr_b16 v[166:167], v19 offset:7264
    v_mfma_f32_16x16x32_bf16 v[40:43], v[212:215], v[180:183], v[40:43]
    ds_read_b64_tr_b16 v[168:169], v18 offset:128
    v_mfma_f32_16x16x32_bf16 v[68:71], v[212:215], v[184:187], v[68:71]
    ds_read_b64_tr_b16 v[170:171], v18 offset:7296
    v_mfma_f32_16x16x32_bf16 v[96:99], v[212:215], v[188:191], v[96:99]
    ds_read_b64_tr_b16 v[172:173], v19 offset:160
    v_mfma_f32_16x16x32_bf16 v[124:127], v[212:215], v[192:195], v[124:127]
    ds_read_b64_tr_b16 v[174:175], v19 offset:7328
    v_mfma_f32_16x16x32_bf16 v[128:131], v[216:219], v[192:195], v[128:131]
    ds_read_b64_tr_b16 v[176:177], v18 offset:192
    v_mfma_f32_16x16x32_bf16 v[100:103], v[216:219], v[188:191], v[100:103]
    ds_read_b64_tr_b16 v[178:179], v18 offset:7360
    v_mfma_f32_16x16x32_bf16 v[72:75], v[216:219], v[184:187], v[72:75]
    v_mfma_f32_16x16x32_bf16 v[44:47], v[216:219], v[180:183], v[44:47]
    v_mfma_f32_16x16x32_bf16 v[48:51], v[220:223], v[180:183], v[48:51]
    v_mfma_f32_16x16x32_bf16 v[76:79], v[220:223], v[184:187], v[76:79]
    v_mfma_f32_16x16x32_bf16 v[104:107], v[220:223], v[188:191], v[104:107]
    v_mfma_f32_16x16x32_bf16 v[132:135], v[220:223], v[192:195], v[132:135]
    s_waitcnt lgkmcnt(12)
    s_cbranch_scc1 mm_26
    v_mfma_f32_16x16x32_bf16 v[24:27], v[152:155], v[136:139], v[24:27]
    ds_read_b128 v[180:183], v17 offset:1024
    v_mfma_f32_16x16x32_bf16 v[52:55], v[152:155], v[140:143], v[52:55]
    ds_read_b128 v[184:187], v17 offset:3072
    v_mfma_f32_16x16x32_bf16 v[80:83], v[152:155], v[144:147], v[80:83]
    ds_read_b128 v[188:191], v17 offset:5120
    v_mfma_f32_16x16x32_bf16 v[108:111], v[152:155], v[148:151], v[108:111]
    ds_read_b128 v[192:195], v17 offset:7168
    s_waitcnt lgkmcnt(14)
    v_mfma_f32_16x16x32_bf16 v[112:115], v[156:159], v[148:151], v[112:115]
    ds_read_b64_tr_b16 v[196:197], v18 offset:14336
    v_mfma_f32_16x16x32_bf16 v[84:87], v[156:159], v[144:147], v[84:87]
    ds_read_b64_tr_b16 v[198:199], v18 offset:21504
    v_mfma_f32_16x16x32_bf16 v[56:59], v[156:159], v[140:143], v[56:59]
    ds_read_b64_tr_b16 v[200:201], v19 offset:14368
    v_mfma_f32_16x16x32_bf16 v[28:31], v[156:159], v[136:139], v[28:31]
    ds_read_b64_tr_b16 v[202:203], v19 offset:21536
    s_waitcnt lgkmcnt(8)
    v_mfma_f32_16x16x32_bf16 v[32:35], v[160:163], v[136:139], v[32:35]
    ds_read_b64_tr_b16 v[204:205], v18 offset:14400
    v_mfma_f32_16x16x32_bf16 v[60:63], v[160:163], v[140:143], v[60:63]
    ds_read_b64_tr_b16 v[206:207], v18 offset:21568
    v_mfma_f32_16x16x32_bf16 v[88:91], v[160:163], v[144:147], v[88:91]
    ds_read_b64_tr_b16 v[208:209], v19 offset:14432
    v_mfma_f32_16x16x32_bf16 v[116:119], v[160:163], v[148:151], v[116:119]
    ds_read_b64_tr_b16 v[210:211], v19 offset:21600
    v_mfma_f32_16x16x32_bf16 v[120:123], v[164:167], v[148:151], v[120:123]
    ds_read_b64_tr_b16 v[212:213], v18 offset:14464
    v_mfma_f32_16x16x32_bf16 v[92:95], v[164:167], v[144:147], v[92:95]
    ds_read_b64_tr_b16 v[214:215], v18 offset:21632
    v_mfma_f32_16x16x32_bf16 v[64:67], v[164:167], v[140:143], v[64:67]
    ds_read_b64_tr_b16 v[216:217], v19 offset:14496
    v_mfma_f32_16x16x32_bf16 v[36:39], v[164:167], v[136:139], v[36:39]
    ds_read_b64_tr_b16 v[218:219], v19 offset:21664
    v_mfma_f32_16x16x32_bf16 v[40:43], v[168:171], v[136:139], v[40:43]
    ds_read_b64_tr_b16 v[220:221], v18 offset:14528
    v_mfma_f32_16x16x32_bf16 v[68:71], v[168:171], v[140:143], v[68:71]
    ds_read_b64_tr_b16 v[222:223], v18 offset:21696
    v_mfma_f32_16x16x32_bf16 v[96:99], v[168:171], v[144:147], v[96:99]
    v_mfma_f32_16x16x32_bf16 v[124:127], v[168:171], v[148:151], v[124:127]
    v_mfma_f32_16x16x32_bf16 v[128:131], v[172:175], v[148:151], v[128:131]
    v_mfma_f32_16x16x32_bf16 v[100:103], v[172:175], v[144:147], v[100:103]
    v_mfma_f32_16x16x32_bf16 v[72:75], v[172:175], v[140:143], v[72:75]
    v_mfma_f32_16x16x32_bf16 v[44:47], v[172:175], v[136:139], v[44:47]
    v_mfma_f32_16x16x32_bf16 v[48:51], v[176:179], v[136:139], v[48:51]
    v_mfma_f32_16x16x32_bf16 v[76:79], v[176:179], v[140:143], v[76:79]
    v_mfma_f32_16x16x32_bf16 v[104:107], v[176:179], v[144:147], v[104:107]
    v_mfma_f32_16x16x32_bf16 v[132:135], v[176:179], v[148:151], v[132:135]
    s_waitcnt lgkmcnt(0)
    s_barrier
    v_mfma_f32_16x16x32_bf16 v[24:27], v[196:199], v[180:183], v[24:27]
    ds_read_b128 v[136:139], v6 offset:0
    v_mfma_f32_16x16x32_bf16 v[52:55], v[196:199], v[184:187], v[52:55]
    ds_read_b128 v[140:143], v6 offset:64
    v_mfma_f32_16x16x32_bf16 v[80:83], v[196:199], v[188:191], v[80:83]
    ds_read_b128 v[144:147], v6 offset:128
    v_mfma_f32_16x16x32_bf16 v[108:111], v[196:199], v[192:195], v[108:111]
    ds_read_b128 v[148:151], v6 offset:192
    v_mfma_f32_16x16x32_bf16 v[112:115], v[200:203], v[192:195], v[112:115]
    ds_read_b128 v[152:155], v6 offset:256
    v_mfma_f32_16x16x32_bf16 v[84:87], v[200:203], v[188:191], v[84:87]
    ds_read_b128 v[156:159], v6 offset:320
    v_mfma_f32_16x16x32_bf16 v[56:59], v[200:203], v[184:187], v[56:59]
    ds_read_b128 v[160:163], v6 offset:384
    v_mfma_f32_16x16x32_bf16 v[28:31], v[200:203], v[180:183], v[28:31]
    ds_read_b128 v[164:167], v7 offset:0
    v_mfma_f32_16x16x32_bf16 v[32:35], v[204:207], v[180:183], v[32:35]
    ds_read_b128 v[168:171], v7 offset:256
    v_mfma_f32_16x16x32_bf16 v[60:63], v[204:207], v[184:187], v[60:63]
    ds_read_b128 v[172:175], v7 offset:512
    v_mfma_f32_16x16x32_bf16 v[88:91], v[204:207], v[188:191], v[88:91]
    ds_read_b128 v[176:179], v7 offset:768
    v_mov_b32 v13, v240
    v_mfma_f32_16x16x32_bf16 v[116:119], v[204:207], v[192:195], v[116:119]
    v_add_u32 v18, 0, v240
    v_mov_b32 v14, v241
    v_mfma_f32_16x16x32_bf16 v[120:123], v[208:211], v[192:195], v[120:123]
    v_add_u32 v19, 0, v241
    v_mov_b32 v15, v242
    v_mfma_f32_16x16x32_bf16 v[92:95], v[208:211], v[188:191], v[92:95]
    v_add_u32 v20, 0, v242
    v_mov_b32 v16, v243
    v_mfma_f32_16x16x32_bf16 v[64:67], v[208:211], v[184:187], v[64:67]
    v_add_u32 v21, 0, v243
    s_mov_b32 s42, 0
    s_mov_b32 s43, 0
    v_mfma_f32_16x16x32_bf16 v[36:39], v[208:211], v[180:183], v[36:39]
    s_mov_b32 s48, 0
    v_mov_b32 v17, v12
    v_and_b32 v199, 7, v0
    v_mfma_f32_16x16x32_bf16 v[40:43], v[212:215], v[180:183], v[40:43]
    v_lshrrev_b32 v228, 6, v0
    v_lshlrev_b32 v228, 4, v228
    v_mfma_f32_16x16x32_bf16 v[68:71], v[212:215], v[184:187], v[68:71]
    v_bfe_u32 v229, v0, 3, 3
    v_add_u32 v228, v228, v229
    s_lshr_b32 s78, s29, 1
    v_mfma_f32_16x16x32_bf16 v[96:99], v[212:215], v[188:191], v[96:99]
    s_lshl_b32 s78, s78, 16
    s_and_b32 s79, s29, 1
    s_lshl_b32 s79, s79, 7
    v_mfma_f32_16x16x32_bf16 v[124:127], v[212:215], v[192:195], v[124:127]
    s_add_u32 s78, s78, s79
    s_lshr_b32 s79, s30, 1
    s_lshl_b32 s79, s79, 13
    v_mfma_f32_16x16x32_bf16 v[128:131], v[216:219], v[192:195], v[128:131]
    s_add_u32 s78, s78, s79
    v_lshlrev_b32 v196, 8, v228
    v_lshl_add_u32 v196, v199, 4, v196
    v_mfma_f32_16x16x32_bf16 v[100:103], v[216:219], v[188:191], v[100:103]
    v_add_u32 v196, s78, v196
    v_mfma_f32_16x16x32_bf16 v[72:75], v[216:219], v[184:187], v[72:75]
    v_mfma_f32_16x16x32_bf16 v[44:47], v[216:219], v[180:183], v[44:47]
    v_mfma_f32_16x16x32_bf16 v[48:51], v[220:223], v[180:183], v[48:51]
    v_mfma_f32_16x16x32_bf16 v[76:79], v[220:223], v[184:187], v[76:79]
    v_mfma_f32_16x16x32_bf16 v[104:107], v[220:223], v[188:191], v[104:107]
    v_mfma_f32_16x16x32_bf16 v[132:135], v[220:223], v[192:195], v[132:135]
    s_waitcnt lgkmcnt(0)
    s_cmp_eq_u32 s35, 1
    s_cbranch_scc1 G3_e1
    v_pk_fma_f32 v[24:25], v[164:165], v[136:137], v[24:25] op_sel_hi:[0,1,1] neg_lo:[1,0,0] neg_hi:[1,0,0]
    v_pk_fma_f32 v[26:27], v[164:165], v[138:139], v[26:27] op_sel_hi:[0,1,1] neg_lo:[1,0,0] neg_hi:[1,0,0]
    v_pk_mul_f32 v[226:227], v[24:25], v[24:25]
    v_pk_mul_f32 v[228:229], v[26:27], v[26:27]
    v_pk_fma_f32 v[226:227], v[226:227], v[166:167], v[166:167] op_sel:[0,1,0] op_sel_hi:[1,1,0]
    v_pk_fma_f32 v[228:229], v[228:229], v[166:167], v[166:167] op_sel:[0,1,0] op_sel_hi:[1,1,0]
    v_pk_mul_f32 v[226:227], v[226:227], v[24:25]
    v_pk_mul_f32 v[228:229], v[228:229], v[26:27]
    v_exp_f32 v226, v226
    v_exp_f32 v227, v227
    v_exp_f32 v228, v228
    v_exp_f32 v229, v229
    v_pk_fma_f32 v[226:227], v[226:227], v[164:165], v[164:165] op_sel:[0,1,1] op_sel_hi:[1,1,1]
    v_pk_fma_f32 v[228:229], v[228:229], v[164:165], v[164:165] op_sel:[0,1,1] op_sel_hi:[1,1,1]
    v_rcp_f32 v226, v226
    v_rcp_f32 v227, v227
    v_rcp_f32 v228, v228
    v_rcp_f32 v229, v229
    v_pk_mul_f32 v[24:25], v[24:25], v[226:227]
    v_pk_mul_f32 v[26:27], v[26:27], v[228:229]
    v_pk_fma_f32 v[28:29], v[164:165], v[140:141], v[28:29] op_sel_hi:[0,1,1] neg_lo:[1,0,0] neg_hi:[1,0,0]
    v_pk_fma_f32 v[30:31], v[164:165], v[142:143], v[30:31] op_sel_hi:[0,1,1] neg_lo:[1,0,0] neg_hi:[1,0,0]
    v_pk_mul_f32 v[226:227], v[28:29], v[28:29]
    v_pk_mul_f32 v[228:229], v[30:31], v[30:31]
    v_pk_fma_f32 v[226:227], v[226:227], v[166:167], v[166:167] op_sel:[0,1,0] op_sel_hi:[1,1,0]
    v_pk_fma_f32 v[228:229], v[228:229], v[166:167], v[166:167] op_sel:[0,1,0] op_sel_hi:[1,1,0]
    v_pk_mul_f32 v[226:227], v[226:227], v[28:29]
    v_pk_mul_f32 v[228:229], v[228:229], v[30:31]
    v_exp_f32 v226, v226
    v_exp_f32 v227, v227
    v_exp_f32 v228, v228
    v_exp_f32 v229, v229
    v_pk_fma_f32 v[226:227], v[226:227], v[164:165], v[164:165] op_sel:[0,1,1] op_sel_hi:[1,1,1]
    v_pk_fma_f32 v[228:229], v[228:229], v[164:165], v[164:165] op_sel:[0,1,1] op_sel_hi:[1,1,1]
    v_rcp_f32 v226, v226
    v_rcp_f32 v227, v227
    v_rcp_f32 v228, v228
    v_rcp_f32 v229, v229
    v_pk_mul_f32 v[28:29], v[28:29], v[226:227]
    v_pk_mul_f32 v[30:31], v[30:31], v[228:229]
    v_cvt_pk_bf16_f32 v24, v24, v25
    v_cvt_pk_bf16_f32 v25, v26, v27
    v_cvt_pk_bf16_f32 v26, v28, v29
    v_cvt_pk_bf16_f32 v27, v30, v31
    v_or_b32 v24, 1, v24
    ds_write_b128 v244, v[24:27] offset:0
    s_add_u32 s36, s44, 0
    buffer_store_dwordx4 v[24:27], v2, s[16:19], s36 offen sc1
    v_pk_fma_f32 v[52:53], v[168:169], v[136:137], v[52:53] op_sel_hi:[0,1,1] neg_lo:[1,0,0] neg_hi:[1,0,0]
    v_pk_fma_f32 v[54:55], v[168:169], v[138:139], v[54:55] op_sel_hi:[0,1,1] neg_lo:[1,0,0] neg_hi:[1,0,0]
    v_pk_mul_f32 v[226:227], v[52:53], v[52:53]
    v_pk_mul_f32 v[228:229], v[54:55], v[54:55]
    v_pk_fma_f32 v[226:227], v[226:227], v[170:171], v[170:171] op_sel:[0,1,0] op_sel_hi:[1,1,0]
    v_pk_fma_f32 v[228:229], v[228:229], v[170:171], v[170:171] op_sel:[0,1,0] op_sel_hi:[1,1,0]
    v_pk_mul_f32 v[226:227], v[226:227], v[52:53]
    v_pk_mul_f32 v[228:229], v[228:229], v[54:55]
    v_exp_f32 v226, v226
    v_exp_f32 v227, v227
    v_exp_f32 v228, v228
    v_exp_f32 v229, v229
    v_pk_fma_f32 v[226:227], v[226:227], v[168:169], v[168:169] op_sel:[0,1,1] op_sel_hi:[1,1,1]
    v_pk_fma_f32 v[228:229], v[228:229], v[168:169], v[168:169] op_sel:[0,1,1] op_sel_hi:[1,1,1]
    v_rcp_f32 v226, v226
    v_rcp_f32 v227, v227
    v_rcp_f32 v228, v228
    v_rcp_f32 v229, v229
    v_pk_mul_f32 v[52:53], v[52:53], v[226:227]
    v_pk_mul_f32 v[54:55], v[54:55], v[228:229]
    v_pk_fma_f32 v[56:57], v[168:169], v[140:141], v[56:57] op_sel_hi:[0,1,1] neg_lo:[1,0,0] neg_hi:[1,0,0]
    v_pk_fma_f32 v[58:59], v[168:169], v[142:143], v[58:59] op_sel_hi:[0,1,1] neg_lo:[1,0,0] neg_hi:[1,0,0]
    v_pk_mul_f32 v[226:227], v[56:57], v[56:57]
    v_pk_mul_f32 v[228:229], v[58:59], v[58:59]
    v_pk_fma_f32 v[226:227], v[226:227], v[170:171], v[170:171] op_sel:[0,1,0] op_sel_hi:[1,1,0]
    v_pk_fma_f32 v[228:229], v[228:229], v[170:171], v[170:171] op_sel:[0,1,0] op_sel_hi:[1,1,0]
    v_pk_mul_f32 v[226:227], v[226:227], v[56:57]
    v_pk_mul_f32 v[228:229], v[228:229], v[58:59]
    v_exp_f32 v226, v226
    v_exp_f32 v227, v227
    v_exp_f32 v228, v228
    v_exp_f32 v229, v229
    v_pk_fma_f32 v[226:227], v[226:227], v[168:169], v[168:169] op_sel:[0,1,1] op_sel_hi:[1,1,1]
    v_pk_fma_f32 v[228:229], v[228:229], v[168:169], v[168:169] op_sel:[0,1,1] op_sel_hi:[1,1,1]
    v_rcp_f32 v226, v226
    v_rcp_f32 v227, v227
    v_rcp_f32 v228, v228
    v_rcp_f32 v229, v229
    v_pk_mul_f32 v[56:57], v[56:57], v[226:227]
    v_pk_mul_f32 v[58:59], v[58:59], v[228:229]
    v_cvt_pk_bf16_f32 v52, v52, v53
    v_cvt_pk_bf16_f32 v53, v54, v55
    v_cvt_pk_bf16_f32 v54, v56, v57
    v_cvt_pk_bf16_f32 v55, v58, v59
    v_or_b32 v52, 1, v52
    ds_write_b128 v244, v[52:55] offset:2048
    s_add_u32 s36, s44, 229376
    buffer_store_dwordx4 v[52:55], v2, s[16:19], s36 offen sc1
    v_pk_fma_f32 v[80:81], v[172:173], v[136:137], v[80:81] op_sel_hi:[0,1,1] neg_lo:[1,0,0] neg_hi:[1,0,0]
    v_pk_fma_f32 v[82:83], v[172:173], v[138:139], v[82:83] op_sel_hi:[0,1,1] neg_lo:[1,0,0] neg_hi:[1,0,0]
    v_pk_mul_f32 v[226:227], v[80:81], v[80:81]
    v_pk_mul_f32 v[228:229], v[82:83], v[82:83]
    v_pk_fma_f32 v[226:227], v[226:227], v[174:175], v[174:175] op_sel:[0,1,0] op_sel_hi:[1,1,0]
    v_pk_fma_f32 v[228:229], v[228:229], v[174:175], v[174:175] op_sel:[0,1,0] op_sel_hi:[1,1,0]
    v_pk_mul_f32 v[226:227], v[226:227], v[80:81]
    v_pk_mul_f32 v[228:229], v[228:229], v[82:83]
    v_exp_f32 v226, v226
    v_exp_f32 v227, v227
    v_exp_f32 v228, v228
    v_exp_f32 v229, v229
    v_pk_fma_f32 v[226:227], v[226:227], v[172:173], v[172:173] op_sel:[0,1,1] op_sel_hi:[1,1,1]
    v_pk_fma_f32 v[228:229], v[228:229], v[172:173], v[172:173] op_sel:[0,1,1] op_sel_hi:[1,1,1]
    v_rcp_f32 v226, v226
    v_rcp_f32 v227, v227
    v_rcp_f32 v228, v228
    v_rcp_f32 v229, v229
    v_pk_mul_f32 v[80:81], v[80:81], v[226:227]
    v_pk_mul_f32 v[82:83], v[82:83], v[228:229]
    v_pk_fma_f32 v[84:85], v[172:173], v[140:141], v[84:85] op_sel_hi:[0,1,1] neg_lo:[1,0,0] neg_hi:[1,0,0]
    v_pk_fma_f32 v[86:87], v[172:173], v[142:143], v[86:87] op_sel_hi:[0,1,1] neg_lo:[1,0,0] neg_hi:[1,0,0]
    v_pk_mul_f32 v[226:227], v[84:85], v[84:85]
    v_pk_mul_f32 v[228:229], v[86:87], v[86:87]
    v_pk_fma_f32 v[226:227], v[226:227], v[174:175], v[174:175] op_sel:[0,1,0] op_sel_hi:[1,1,0]
    v_pk_fma_f32 v[228:229], v[228:229], v[174:175], v[174:175] op_sel:[0,1,0] op_sel_hi:[1,1,0]
    v_pk_mul_f32 v[226:227], v[226:227], v[84:85]
    v_pk_mul_f32 v[228:229], v[228:229], v[86:87]
    v_exp_f32 v226, v226
    v_exp_f32 v227, v227
    v_exp_f32 v228, v228
    v_exp_f32 v229, v229
    v_pk_fma_f32 v[226:227], v[226:227], v[172:173], v[172:173] op_sel:[0,1,1] op_sel_hi:[1,1,1]
    v_pk_fma_f32 v[228:229], v[228:229], v[172:173], v[172:173] op_sel:[0,1,1] op_sel_hi:[1,1,1]
    v_rcp_f32 v226, v226
    v_rcp_f32 v227, v227
    v_rcp_f32 v228, v228
    v_rcp_f32 v229, v229
    v_pk_mul_f32 v[84:85], v[84:85], v[226:227]
    v_pk_mul_f32 v[86:87], v[86:87], v[228:229]
    v_cvt_pk_bf16_f32 v80, v80, v81
    v_cvt_pk_bf16_f32 v81, v82, v83
    v_cvt_pk_bf16_f32 v82, v84, v85
    v_cvt_pk_bf16_f32 v83, v86, v87
    v_or_b32 v80, 1, v80
    ds_write_b128 v244, v[80:83] offset:4096
    s_add_u32 s36, s44, 458752
    buffer_store_dwordx4 v[80:83], v2, s[16:19], s36 offen sc1
    v_pk_fma_f32 v[108:109], v[176:177], v[136:137], v[108:109] op_sel_hi:[0,1,1] neg_lo:[1,0,0] neg_hi:[1,0,0]
    v_pk_fma_f32 v[110:111], v[176:177], v[138:139], v[110:111] op_sel_hi:[0,1,1] neg_lo:[1,0,0] neg_hi:[1,0,0]
    v_pk_mul_f32 v[226:227], v[108:109], v[108:109]
    v_pk_mul_f32 v[228:229], v[110:111], v[110:111]
    v_pk_fma_f32 v[226:227], v[226:227], v[178:179], v[178:179] op_sel:[0,1,0] op_sel_hi:[1,1,0]
    v_pk_fma_f32 v[228:229], v[228:229], v[178:179], v[178:179] op_sel:[0,1,0] op_sel_hi:[1,1,0]
    v_pk_mul_f32 v[226:227], v[226:227], v[108:109]
    v_pk_mul_f32 v[228:229], v[228:229], v[110:111]
    v_exp_f32 v226, v226
    v_exp_f32 v227, v227
    v_exp_f32 v228, v228
    v_exp_f32 v229, v229
    v_pk_fma_f32 v[226:227], v[226:227], v[176:177], v[176:177] op_sel:[0,1,1] op_sel_hi:[1,1,1]
    v_pk_fma_f32 v[228:229], v[228:229], v[176:177], v[176:177] op_sel:[0,1,1] op_sel_hi:[1,1,1]
    v_rcp_f32 v226, v226
    v_rcp_f32 v227, v227
    v_rcp_f32 v228, v228
    v_rcp_f32 v229, v229
    v_pk_mul_f32 v[108:109], v[108:109], v[226:227]
    v_pk_mul_f32 v[110:111], v[110:111], v[228:229]
    v_pk_fma_f32 v[112:113], v[176:177], v[140:141], v[112:113] op_sel_hi:[0,1,1] neg_lo:[1,0,0] neg_hi:[1,0,0]
    v_pk_fma_f32 v[114:115], v[176:177], v[142:143], v[114:115] op_sel_hi:[0,1,1] neg_lo:[1,0,0] neg_hi:[1,0,0]
    v_pk_mul_f32 v[226:227], v[112:113], v[112:113]
    v_pk_mul_f32 v[228:229], v[114:115], v[114:115]
    v_pk_fma_f32 v[226:227], v[226:227], v[178:179], v[178:179] op_sel:[0,1,0] op_sel_hi:[1,1,0]
    v_pk_fma_f32 v[228:229], v[228:229], v[178:179], v[178:179] op_sel:[0,1,0] op_sel_hi:[1,1,0]
    v_pk_mul_f32 v[226:227], v[226:227], v[112:113]
    v_pk_mul_f32 v[228:229], v[228:229], v[114:115]
    v_exp_f32 v226, v226
    v_exp_f32 v227, v227
    v_exp_f32 v228, v228
    v_exp_f32 v229, v229
    v_pk_fma_f32 v[226:227], v[226:227], v[176:177], v[176:177] op_sel:[0,1,1] op_sel_hi:[1,1,1]
    v_pk_fma_f32 v[228:229], v[228:229], v[176:177], v[176:177] op_sel:[0,1,1] op_sel_hi:[1,1,1]
    v_rcp_f32 v226, v226
    v_rcp_f32 v227, v227
    v_rcp_f32 v228, v228
    v_rcp_f32 v229, v229
    v_pk_mul_f32 v[112:113], v[112:113], v[226:227]
    v_pk_mul_f32 v[114:115], v[114:115], v[228:229]
    v_cvt_pk_bf16_f32 v108, v108, v109
    v_cvt_pk_bf16_f32 v109, v110, v111
    v_cvt_pk_bf16_f32 v110, v112, v113
    v_cvt_pk_bf16_f32 v111, v114, v115
    ds_write_b128 v244, v[108:111] offset:6144
    s_add_u32 s36, s44, 688128
    buffer_store_dwordx4 v[108:111], v2, s[16:19], s36 offen sc1
    v_pk_fma_f32 v[32:33], v[164:165], v[144:145], v[32:33] op_sel_hi:[0,1,1] neg_lo:[1,0,0] neg_hi:[1,0,0]
    v_pk_fma_f32 v[34:35], v[164:165], v[146:147], v[34:35] op_sel_hi:[0,1,1] neg_lo:[1,0,0] neg_hi:[1,0,0]
    v_pk_mul_f32 v[226:227], v[32:33], v[32:33]
    v_pk_mul_f32 v[228:229], v[34:35], v[34:35]
    v_pk_fma_f32 v[226:227], v[226:227], v[166:167], v[166:167] op_sel:[0,1,0] op_sel_hi:[1,1,0]
    v_pk_fma_f32 v[228:229], v[228:229], v[166:167], v[166:167] op_sel:[0,1,0] op_sel_hi:[1,1,0]
    v_pk_mul_f32 v[226:227], v[226:227], v[32:33]
    v_pk_mul_f32 v[228:229], v[228:229], v[34:35]
    v_exp_f32 v226, v226
    v_exp_f32 v227, v227
    v_exp_f32 v228, v228
    v_exp_f32 v229, v229
    v_pk_fma_f32 v[226:227], v[226:227], v[164:165], v[164:165] op_sel:[0,1,1] op_sel_hi:[1,1,1]
    v_pk_fma_f32 v[228:229], v[228:229], v[164:165], v[164:165] op_sel:[0,1,1] op_sel_hi:[1,1,1]
    v_rcp_f32 v226, v226
    v_rcp_f32 v227, v227
    v_rcp_f32 v228, v228
    v_rcp_f32 v229, v229
    v_pk_mul_f32 v[32:33], v[32:33], v[226:227]
    v_pk_mul_f32 v[34:35], v[34:35], v[228:229]
    v_pk_fma_f32 v[36:37], v[164:165], v[148:149], v[36:37] op_sel_hi:[0,1,1] neg_lo:[1,0,0] neg_hi:[1,0,0]
    v_pk_fma_f32 v[38:39], v[164:165], v[150:151], v[38:39] op_sel_hi:[0,1,1] neg_lo:[1,0,0] neg_hi:[1,0,0]
    v_pk_mul_f32 v[226:227], v[36:37], v[36:37]
    v_pk_mul_f32 v[228:229], v[38:39], v[38:39]
    v_pk_fma_f32 v[226:227], v[226:227], v[166:167], v[166:167] op_sel:[0,1,0] op_sel_hi:[1,1,0]
    v_pk_fma_f32 v[228:229], v[228:229], v[166:167], v[166:167] op_sel:[0,1,0] op_sel_hi:[1,1,0]
    v_pk_mul_f32 v[226:227], v[226:227], v[36:37]
    v_pk_mul_f32 v[228:229], v[228:229], v[38:39]
    v_exp_f32 v226, v226
    v_exp_f32 v227, v227
    v_exp_f32 v228, v228
    v_exp_f32 v229, v229
    v_pk_fma_f32 v[226:227], v[226:227], v[164:165], v[164:165] op_sel:[0,1,1] op_sel_hi:[1,1,1]
    v_pk_fma_f32 v[228:229], v[228:229], v[164:165], v[164:165] op_sel:[0,1,1] op_sel_hi:[1,1,1]
    v_rcp_f32 v226, v226
    v_rcp_f32 v227, v227
    v_rcp_f32 v228, v228
    v_rcp_f32 v229, v229
    v_pk_mul_f32 v[36:37], v[36:37], v[226:227]
    v_pk_mul_f32 v[38:39], v[38:39], v[228:229]
    v_cvt_pk_bf16_f32 v32, v32, v33
    v_cvt_pk_bf16_f32 v33, v34, v35
    v_cvt_pk_bf16_f32 v34, v36, v37
    v_cvt_pk_bf16_f32 v35, v38, v39
    v_or_b32 v32, 1, v32
    ds_write_b128 v244, v[32:35] offset:16384
    v_pk_fma_f32 v[60:61], v[168:169], v[144:145], v[60:61] op_sel_hi:[0,1,1] neg_lo:[1,0,0] neg_hi:[1,0,0]
    v_pk_fma_f32 v[62:63], v[168:169], v[146:147], v[62:63] op_sel_hi:[0,1,1] neg_lo:[1,0,0] neg_hi:[1,0,0]
    v_pk_mul_f32 v[226:227], v[60:61], v[60:61]
    v_pk_mul_f32 v[228:229], v[62:63], v[62:63]
    v_pk_fma_f32 v[226:227], v[226:227], v[170:171], v[170:171] op_sel:[0,1,0] op_sel_hi:[1,1,0]
    v_pk_fma_f32 v[228:229], v[228:229], v[170:171], v[170:171] op_sel:[0,1,0] op_sel_hi:[1,1,0]
    v_pk_mul_f32 v[226:227], v[226:227], v[60:61]
    v_pk_mul_f32 v[228:229], v[228:229], v[62:63]
    v_exp_f32 v226, v226
    v_exp_f32 v227, v227
    v_exp_f32 v228, v228
    v_exp_f32 v229, v229
    v_pk_fma_f32 v[226:227], v[226:227], v[168:169], v[168:169] op_sel:[0,1,1] op_sel_hi:[1,1,1]
    v_pk_fma_f32 v[228:229], v[228:229], v[168:169], v[168:169] op_sel:[0,1,1] op_sel_hi:[1,1,1]
    v_rcp_f32 v226, v226
    v_rcp_f32 v227, v227
    v_rcp_f32 v228, v228
    v_rcp_f32 v229, v229
    v_pk_mul_f32 v[60:61], v[60:61], v[226:227]
    v_pk_mul_f32 v[62:63], v[62:63], v[228:229]
    v_pk_fma_f32 v[64:65], v[168:169], v[148:149], v[64:65] op_sel_hi:[0,1,1] neg_lo:[1,0,0] neg_hi:[1,0,0]
    v_pk_fma_f32 v[66:67], v[168:169], v[150:151], v[66:67] op_sel_hi:[0,1,1] neg_lo:[1,0,0] neg_hi:[1,0,0]
    v_pk_mul_f32 v[226:227], v[64:65], v[64:65]
    v_pk_mul_f32 v[228:229], v[66:67], v[66:67]
    v_pk_fma_f32 v[226:227], v[226:227], v[170:171], v[170:171] op_sel:[0,1,0] op_sel_hi:[1,1,0]
    v_pk_fma_f32 v[228:229], v[228:229], v[170:171], v[170:171] op_sel:[0,1,0] op_sel_hi:[1,1,0]
    v_pk_mul_f32 v[226:227], v[226:227], v[64:65]
    v_pk_mul_f32 v[228:229], v[228:229], v[66:67]
    v_exp_f32 v226, v226
    v_exp_f32 v227, v227
    v_exp_f32 v228, v228
    v_exp_f32 v229, v229
    v_pk_fma_f32 v[226:227], v[226:227], v[168:169], v[168:169] op_sel:[0,1,1] op_sel_hi:[1,1,1]
    v_pk_fma_f32 v[228:229], v[228:229], v[168:169], v[168:169] op_sel:[0,1,1] op_sel_hi:[1,1,1]
    v_rcp_f32 v226, v226
    v_rcp_f32 v227, v227
    v_rcp_f32 v228, v228
    v_rcp_f32 v229, v229
    v_pk_mul_f32 v[64:65], v[64:65], v[226:227]
    v_pk_mul_f32 v[66:67], v[66:67], v[228:229]
    v_cvt_pk_bf16_f32 v60, v60, v61
    v_cvt_pk_bf16_f32 v61, v62, v63
    v_cvt_pk_bf16_f32 v62, v64, v65
    v_cvt_pk_bf16_f32 v63, v66, v67
    v_or_b32 v60, 1, v60
    ds_write_b128 v244, v[60:63] offset:18432
    s_waitcnt vmcnt(0)
    s_mov_b64 exec, 1
    ds_add_u32 v246, v245
    s_mov_b64 exec, -1
    v_pk_fma_f32 v[88:89], v[172:173], v[144:145], v[88:89] op_sel_hi:[0,1,1] neg_lo:[1,0,0] neg_hi:[1,0,0]
    v_pk_fma_f32 v[90:91], v[172:173], v[146:147], v[90:91] op_sel_hi:[0,1,1] neg_lo:[1,0,0] neg_hi:[1,0,0]
    v_pk_mul_f32 v[226:227], v[88:89], v[88:89]
    v_pk_mul_f32 v[228:229], v[90:91], v[90:91]
    v_pk_fma_f32 v[226:227], v[226:227], v[174:175], v[174:175] op_sel:[0,1,0] op_sel_hi:[1,1,0]
    v_pk_fma_f32 v[228:229], v[228:229], v[174:175], v[174:175] op_sel:[0,1,0] op_sel_hi:[1,1,0]
    v_pk_mul_f32 v[226:227], v[226:227], v[88:89]
    v_pk_mul_f32 v[228:229], v[228:229], v[90:91]
    v_exp_f32 v226, v226
    v_exp_f32 v227, v227
    v_exp_f32 v228, v228
    v_exp_f32 v229, v229
    v_pk_fma_f32 v[226:227], v[226:227], v[172:173], v[172:173] op_sel:[0,1,1] op_sel_hi:[1,1,1]
    v_pk_fma_f32 v[228:229], v[228:229], v[172:173], v[172:173] op_sel:[0,1,1] op_sel_hi:[1,1,1]
    v_rcp_f32 v226, v226
    v_rcp_f32 v227, v227
    v_rcp_f32 v228, v228
    v_rcp_f32 v229, v229
    v_pk_mul_f32 v[88:89], v[88:89], v[226:227]
    v_pk_mul_f32 v[90:91], v[90:91], v[228:229]
    v_pk_fma_f32 v[92:93], v[172:173], v[148:149], v[92:93] op_sel_hi:[0,1,1] neg_lo:[1,0,0] neg_hi:[1,0,0]
    v_pk_fma_f32 v[94:95], v[172:173], v[150:151], v[94:95] op_sel_hi:[0,1,1] neg_lo:[1,0,0] neg_hi:[1,0,0]
    v_pk_mul_f32 v[226:227], v[92:93], v[92:93]
    v_pk_mul_f32 v[228:229], v[94:95], v[94:95]
    v_pk_fma_f32 v[226:227], v[226:227], v[174:175], v[174:175] op_sel:[0,1,0] op_sel_hi:[1,1,0]
    v_pk_fma_f32 v[228:229], v[228:229], v[174:175], v[174:175] op_sel:[0,1,0] op_sel_hi:[1,1,0]
    v_pk_mul_f32 v[226:227], v[226:227], v[92:93]
    v_pk_mul_f32 v[228:229], v[228:229], v[94:95]
    v_exp_f32 v226, v226
    v_exp_f32 v227, v227
    v_exp_f32 v228, v228
    v_exp_f32 v229, v229
    v_pk_fma_f32 v[226:227], v[226:227], v[172:173], v[172:173] op_sel:[0,1,1] op_sel_hi:[1,1,1]
    v_pk_fma_f32 v[228:229], v[228:229], v[172:173], v[172:173] op_sel:[0,1,1] op_sel_hi:[1,1,1]
    v_rcp_f32 v226, v226
    v_rcp_f32 v227, v227
    v_rcp_f32 v228, v228
    v_rcp_f32 v229, v229
    v_pk_mul_f32 v[92:93], v[92:93], v[226:227]
    v_pk_mul_f32 v[94:95], v[94:95], v[228:229]
    v_cvt_pk_bf16_f32 v88, v88, v89
    v_cvt_pk_bf16_f32 v89, v90, v91
    v_cvt_pk_bf16_f32 v90, v92, v93
    v_cvt_pk_bf16_f32 v91, v94, v95
    v_or_b32 v88, 1, v88
    ds_write_b128 v244, v[88:91] offset:20480
    s_cmp_eq_u32 s60, 1
    s_cbranch_scc1 G4_p10
    buffer_load_dwordx4 v[180:183], v196, s[84:87], 0 offen offset:0 sc1
    buffer_load_dwordx4 v[188:191], v196, s[88:91], 0 offen offset:0 sc1
    buffer_load_dwordx4 v[184:187], v196, s[84:87], 0 offen offset:2048 sc1
    buffer_load_dwordx4 v[192:195], v196, s[88:91], 0 offen offset:2048 sc1
    s_branch G4_p20
G4_p10:
    s_add_u32 s36, s40, 0
    buffer_load_dwordx4 v[180:183], v2, s[84:87], s36 offen offset:0 sc1
    buffer_load_dwordx4 v[184:187], v2, s[88:91], s36 offen offset:0 sc1
    buffer_load_dwordx4 v[188:191], v2, s[84:87], s36 offen offset:1024 sc1
    buffer_load_dwordx4 v[192:195], v2, s[88:91], s36 offen offset:1024 sc1
    s_add_u32 s36, s40, 65536
    buffer_load_dwordx4 v[196:199], v2, s[84:87], s36 offen offset:0 sc1
    buffer_load_dwordx4 v[230:233], v2, s[88:91], s36 offen offset:0 sc1
    buffer_load_dwordx4 v[234:237], v2, s[84:87], s36 offen offset:1024 sc1
    buffer_load_dwordx4 v[248:251], v2, s[88:91], s36 offen offset:1024 sc1
G4_p20:
    v_pk_fma_f32 v[116:117], v[176:177], v[144:145], v[116:117] op_sel_hi:[0,1,1] neg_lo:[1,0,0] neg_hi:[1,0,0]
    v_pk_fma_f32 v[118:119], v[176:177], v[146:147], v[118:119] op_sel_hi:[0,1,1] neg_lo:[1,0,0] neg_hi:[1,0,0]
    v_pk_mul_f32 v[226:227], v[116:117], v[116:117]
    v_pk_mul_f32 v[228:229], v[118:119], v[118:119]
    v_pk_fma_f32 v[226:227], v[226:227], v[178:179], v[178:179] op_sel:[0,1,0] op_sel_hi:[1,1,0]
    v_pk_fma_f32 v[228:229], v[228:229], v[178:179], v[178:179] op_sel:[0,1,0] op_sel_hi:[1,1,0]
    v_pk_mul_f32 v[226:227], v[226:227], v[116:117]
    v_pk_mul_f32 v[228:229], v[228:229], v[118:119]
    v_exp_f32 v226, v226
    v_exp_f32 v227, v227
    v_exp_f32 v228, v228
    v_exp_f32 v229, v229
    v_pk_fma_f32 v[226:227], v[226:227], v[176:177], v[176:177] op_sel:[0,1,1] op_sel_hi:[1,1,1]
    v_pk_fma_f32 v[228:229], v[228:229], v[176:177], v[176:177] op_sel:[0,1,1] op_sel_hi:[1,1,1]
    v_rcp_f32 v226, v226
    v_rcp_f32 v227, v227
    v_rcp_f32 v228, v228
    v_rcp_f32 v229, v229
    v_pk_mul_f32 v[116:117], v[116:117], v[226:227]
    v_pk_mul_f32 v[118:119], v[118:119], v[228:229]
    v_pk_fma_f32 v[120:121], v[176:177], v[148:149], v[120:121] op_sel_hi:[0,1,1] neg_lo:[1,0,0] neg_hi:[1,0,0]
    v_pk_fma_f32 v[122:123], v[176:177], v[150:151], v[122:123] op_sel_hi:[0,1,1] neg_lo:[1,0,0] neg_hi:[1,0,0]
    v_pk_mul_f32 v[226:227], v[120:121], v[120:121]
    v_pk_mul_f32 v[228:229], v[122:123], v[122:123]
    v_pk_fma_f32 v[226:227], v[226:227], v[178:179], v[178:179] op_sel:[0,1,0] op_sel_hi:[1,1,0]
    v_pk_fma_f32 v[228:229], v[228:229], v[178:179], v[178:179] op_sel:[0,1,0] op_sel_hi:[1,1,0]
    v_pk_mul_f32 v[226:227], v[226:227], v[120:121]
    v_pk_mul_f32 v[228:229], v[228:229], v[122:123]
    v_exp_f32 v226, v226
    v_exp_f32 v227, v227
    v_exp_f32 v228, v228
    v_exp_f32 v229, v229
    v_pk_fma_f32 v[226:227], v[226:227], v[176:177], v[176:177] op_sel:[0,1,1] op_sel_hi:[1,1,1]
    v_pk_fma_f32 v[228:229], v[228:229], v[176:177], v[176:177] op_sel:[0,1,1] op_sel_hi:[1,1,1]
    v_rcp_f32 v226, v226
    v_rcp_f32 v227, v227
    v_rcp_f32 v228, v228
    v_rcp_f32 v229, v229
    v_pk_mul_f32 v[120:121], v[120:121], v[226:227]
    v_pk_mul_f32 v[122:123], v[122:123], v[228:229]
    v_cvt_pk_bf16_f32 v116, v116, v117
    v_cvt_pk_bf16_f32 v117, v118, v119
    v_cvt_pk_bf16_f32 v118, v120, v121
    v_cvt_pk_bf16_f32 v119, v122, v123
    ds_write_b128 v244, v[116:119] offset:22528
    v_pk_fma_f32 v[40:41], v[164:165], v[152:153], v[40:41] op_sel_hi:[0,1,1] neg_lo:[1,0,0] neg_hi:[1,0,0]
    v_pk_fma_f32 v[42:43], v[164:165], v[154:155], v[42:43] op_sel_hi:[0,1,1] neg_lo:[1,0,0] neg_hi:[1,0,0]
    v_pk_mul_f32 v[226:227], v[40:41], v[40:41]
    v_pk_mul_f32 v[228:229], v[42:43], v[42:43]
    v_pk_fma_f32 v[226:227], v[226:227], v[166:167], v[166:167] op_sel:[0,1,0] op_sel_hi:[1,1,0]
    v_pk_fma_f32 v[228:229], v[228:229], v[166:167], v[166:167] op_sel:[0,1,0] op_sel_hi:[1,1,0]
    v_pk_mul_f32 v[226:227], v[226:227], v[40:41]
    v_pk_mul_f32 v[228:229], v[228:229], v[42:43]
    v_exp_f32 v226, v226
    v_exp_f32 v227, v227
    v_exp_f32 v228, v228
    v_exp_f32 v229, v229
    v_pk_fma_f32 v[226:227], v[226:227], v[164:165], v[164:165] op_sel:[0,1,1] op_sel_hi:[1,1,1]
    v_pk_fma_f32 v[228:229], v[228:229], v[164:165], v[164:165] op_sel:[0,1,1] op_sel_hi:[1,1,1]
    v_rcp_f32 v226, v226
    v_rcp_f32 v227, v227
    v_rcp_f32 v228, v228
    v_rcp_f32 v229, v229
    v_pk_mul_f32 v[40:41], v[40:41], v[226:227]
    v_pk_mul_f32 v[42:43], v[42:43], v[228:229]
    v_pk_fma_f32 v[44:45], v[164:165], v[156:157], v[44:45] op_sel_hi:[0,1,1] neg_lo:[1,0,0] neg_hi:[1,0,0]
    v_pk_fma_f32 v[46:47], v[164:165], v[158:159], v[46:47] op_sel_hi:[0,1,1] neg_lo:[1,0,0] neg_hi:[1,0,0]
    v_pk_mul_f32 v[226:227], v[44:45], v[44:45]
    v_pk_mul_f32 v[228:229], v[46:47], v[46:47]
    v_pk_fma_f32 v[226:227], v[226:227], v[166:167], v[166:167] op_sel:[0,1,0] op_sel_hi:[1,1,0]
    v_pk_fma_f32 v[228:229], v[228:229], v[166:167], v[166:167] op_sel:[0,1,0] op_sel_hi:[1,1,0]
    v_pk_mul_f32 v[226:227], v[226:227], v[44:45]
    v_pk_mul_f32 v[228:229], v[228:229], v[46:47]
    v_exp_f32 v226, v226
    v_exp_f32 v227, v227
    v_exp_f32 v228, v228
    v_exp_f32 v229, v229
    v_pk_fma_f32 v[226:227], v[226:227], v[164:165], v[164:165] op_sel:[0,1,1] op_sel_hi:[1,1,1]
    v_pk_fma_f32 v[228:229], v[228:229], v[164:165], v[164:165] op_sel:[0,1,1] op_sel_hi:[1,1,1]
    v_rcp_f32 v226, v226
    v_rcp_f32 v227, v227
    v_rcp_f32 v228, v228
    v_rcp_f32 v229, v229
    v_pk_mul_f32 v[44:45], v[44:45], v[226:227]
    v_pk_mul_f32 v[46:47], v[46:47], v[228:229]
    v_cvt_pk_bf16_f32 v200, v40, v41
    v_cvt_pk_bf16_f32 v201, v42, v43
    v_cvt_pk_bf16_f32 v202, v44, v45
    v_cvt_pk_bf16_f32 v203, v46, v47
    v_or_b32 v200, 1, v200
    ds_write_b128 v244, v[200:203] offset:32768
    v_pk_fma_f32 v[68:69], v[168:169], v[152:153], v[68:69] op_sel_hi:[0,1,1] neg_lo:[1,0,0] neg_hi:[1,0,0]
    v_pk_fma_f32 v[70:71], v[168:169], v[154:155], v[70:71] op_sel_hi:[0,1,1] neg_lo:[1,0,0] neg_hi:[1,0,0]
    v_pk_mul_f32 v[226:227], v[68:69], v[68:69]
    v_pk_mul_f32 v[228:229], v[70:71], v[70:71]
    v_pk_fma_f32 v[226:227], v[226:227], v[170:171], v[170:171] op_sel:[0,1,0] op_sel_hi:[1,1,0]
    v_pk_fma_f32 v[228:229], v[228:229], v[170:171], v[170:171] op_sel:[0,1,0] op_sel_hi:[1,1,0]
    v_pk_mul_f32 v[226:227], v[226:227], v[68:69]
    v_pk_mul_f32 v[228:229], v[228:229], v[70:71]
    v_exp_f32 v226, v226
    v_exp_f32 v227, v227
    v_exp_f32 v228, v228
    v_exp_f32 v229, v229
    v_pk_fma_f32 v[226:227], v[226:227], v[168:169], v[168:169] op_sel:[0,1,1] op_sel_hi:[1,1,1]
    v_pk_fma_f32 v[228:229], v[228:229], v[168:169], v[168:169] op_sel:[0,1,1] op_sel_hi:[1,1,1]
    v_rcp_f32 v226, v226
    v_rcp_f32 v227, v227
    v_rcp_f32 v228, v228
    v_rcp_f32 v229, v229
    v_pk_mul_f32 v[68:69], v[68:69], v[226:227]
    v_pk_mul_f32 v[70:71], v[70:71], v[228:229]
    v_pk_fma_f32 v[72:73], v[168:169], v[156:157], v[72:73] op_sel_hi:[0,1,1] neg_lo:[1,0,0] neg_hi:[1,0,0]
    v_pk_fma_f32 v[74:75], v[168:169], v[158:159], v[74:75] op_sel_hi:[0,1,1] neg_lo:[1,0,0] neg_hi:[1,0,0]
    v_pk_mul_f32 v[226:227], v[72:73], v[72:73]
    v_pk_mul_f32 v[228:229], v[74:75], v[74:75]
    v_pk_fma_f32 v[226:227], v[226:227], v[170:171], v[170:171] op_sel:[0,1,0] op_sel_hi:[1,1,0]
    v_pk_fma_f32 v[228:229], v[228:229], v[170:171], v[170:171] op_sel:[0,1,0] op_sel_hi:[1,1,0]
    v_pk_mul_f32 v[226:227], v[226:227], v[72:73]
    v_pk_mul_f32 v[228:229], v[228:229], v[74:75]
    v_exp_f32 v226, v226
    v_exp_f32 v227, v227
    v_exp_f32 v228, v228
    v_exp_f32 v229, v229
    v_pk_fma_f32 v[226:227], v[226:227], v[168:169], v[168:169] op_sel:[0,1,1] op_sel_hi:[1,1,1]
    v_pk_fma_f32 v[228:229], v[228:229], v[168:169], v[168:169] op_sel:[0,1,1] op_sel_hi:[1,1,1]
    v_rcp_f32 v226, v226
    v_rcp_f32 v227, v227
    v_rcp_f32 v228, v228
    v_rcp_f32 v229, v229
    v_pk_mul_f32 v[72:73], v[72:73], v[226:227]
    v_pk_mul_f32 v[74:75], v[74:75], v[228:229]
    v_cvt_pk_bf16_f32 v204, v68, v69
    v_cvt_pk_bf16_f32 v205, v70, v71
    v_cvt_pk_bf16_f32 v206, v72, v73
    v_cvt_pk_bf16_f32 v207, v74, v75
    v_or_b32 v204, 1, v204
    ds_write_b128 v244, v[204:207] offset:34816
    v_pk_fma_f32 v[96:97], v[172:173], v[152:153], v[96:97] op_sel_hi:[0,1,1] neg_lo:[1,0,0] neg_hi:[1,0,0]
    v_pk_fma_f32 v[98:99], v[172:173], v[154:155], v[98:99] op_sel_hi:[0,1,1] neg_lo:[1,0,0] neg_hi:[1,0,0]
    v_pk_mul_f32 v[226:227], v[96:97], v[96:97]
    v_pk_mul_f32 v[228:229], v[98:99], v[98:99]
    v_pk_fma_f32 v[226:227], v[226:227], v[174:175], v[174:175] op_sel:[0,1,0] op_sel_hi:[1,1,0]
    v_pk_fma_f32 v[228:229], v[228:229], v[174:175], v[174:175] op_sel:[0,1,0] op_sel_hi:[1,1,0]
    v_pk_mul_f32 v[226:227], v[226:227], v[96:97]
    v_pk_mul_f32 v[228:229], v[228:229], v[98:99]
    v_exp_f32 v226, v226
    v_exp_f32 v227, v227
    v_exp_f32 v228, v228
    v_exp_f32 v229, v229
    v_pk_fma_f32 v[226:227], v[226:227], v[172:173], v[172:173] op_sel:[0,1,1] op_sel_hi:[1,1,1]
    v_pk_fma_f32 v[228:229], v[228:229], v[172:173], v[172:173] op_sel:[0,1,1] op_sel_hi:[1,1,1]
    v_rcp_f32 v226, v226
    v_rcp_f32 v227, v227
    v_rcp_f32 v228, v228
    v_rcp_f32 v229, v229
    v_pk_mul_f32 v[96:97], v[96:97], v[226:227]
    v_pk_mul_f32 v[98:99], v[98:99], v[228:229]
    v_pk_fma_f32 v[100:101], v[172:173], v[156:157], v[100:101] op_sel_hi:[0,1,1] neg_lo:[1,0,0] neg_hi:[1,0,0]
    v_pk_fma_f32 v[102:103], v[172:173], v[158:159], v[102:103] op_sel_hi:[0,1,1] neg_lo:[1,0,0] neg_hi:[1,0,0]
    v_pk_mul_f32 v[226:227], v[100:101], v[100:101]
    v_pk_mul_f32 v[228:229], v[102:103], v[102:103]
    v_pk_fma_f32 v[226:227], v[226:227], v[174:175], v[174:175] op_sel:[0,1,0] op_sel_hi:[1,1,0]
    v_pk_fma_f32 v[228:229], v[228:229], v[174:175], v[174:175] op_sel:[0,1,0] op_sel_hi:[1,1,0]
    v_pk_mul_f32 v[226:227], v[226:227], v[100:101]
    v_pk_mul_f32 v[228:229], v[228:229], v[102:103]
    v_exp_f32 v226, v226
    v_exp_f32 v227, v227
    v_exp_f32 v228, v228
    v_exp_f32 v229, v229
    v_pk_fma_f32 v[226:227], v[226:227], v[172:173], v[172:173] op_sel:[0,1,1] op_sel_hi:[1,1,1]
    v_pk_fma_f32 v[228:229], v[228:229], v[172:173], v[172:173] op_sel:[0,1,1] op_sel_hi:[1,1,1]
    v_rcp_f32 v226, v226
    v_rcp_f32 v227, v227
    v_rcp_f32 v228, v228
    v_rcp_f32 v229, v229
    v_pk_mul_f32 v[100:101], v[100:101], v[226:227]
    v_pk_mul_f32 v[102:103], v[102:103], v[228:229]
    v_cvt_pk_bf16_f32 v208, v96, v97
    v_cvt_pk_bf16_f32 v209, v98, v99
    v_cvt_pk_bf16_f32 v210, v100, v101
    v_cvt_pk_bf16_f32 v211, v102, v103
    v_or_b32 v208, 1, v208
    ds_write_b128 v244, v[208:211] offset:36864
    v_pk_fma_f32 v[124:125], v[176:177], v[152:153], v[124:125] op_sel_hi:[0,1,1] neg_lo:[1,0,0] neg_hi:[1,0,0]
    v_pk_fma_f32 v[126:127], v[176:177], v[154:155], v[126:127] op_sel_hi:[0,1,1] neg_lo:[1,0,0] neg_hi:[1,0,0]
    v_pk_mul_f32 v[226:227], v[124:125], v[124:125]
    v_pk_mul_f32 v[228:229], v[126:127], v[126:127]
    v_pk_fma_f32 v[226:227], v[226:227], v[178:179], v[178:179] op_sel:[0,1,0] op_sel_hi:[1,1,0]
    v_pk_fma_f32 v[228:229], v[228:229], v[178:179], v[178:179] op_sel:[0,1,0] op_sel_hi:[1,1,0]
    v_pk_mul_f32 v[226:227], v[226:227], v[124:125]
    v_pk_mul_f32 v[228:229], v[228:229], v[126:127]
    v_exp_f32 v226, v226
    v_exp_f32 v227, v227
    v_exp_f32 v228, v228
    v_exp_f32 v229, v229
    v_pk_fma_f32 v[226:227], v[226:227], v[176:177], v[176:177] op_sel:[0,1,1] op_sel_hi:[1,1,1]
    v_pk_fma_f32 v[228:229], v[228:229], v[176:177], v[176:177] op_sel:[0,1,1] op_sel_hi:[1,1,1]
    v_rcp_f32 v226, v226
    v_rcp_f32 v227, v227
    v_rcp_f32 v228, v228
    v_rcp_f32 v229, v229
    v_pk_mul_f32 v[124:125], v[124:125], v[226:227]
    v_pk_mul_f32 v[126:127], v[126:127], v[228:229]
    v_pk_fma_f32 v[128:129], v[176:177], v[156:157], v[128:129] op_sel_hi:[0,1,1] neg_lo:[1,0,0] neg_hi:[1,0,0]
    v_pk_fma_f32 v[130:131], v[176:177], v[158:159], v[130:131] op_sel_hi:[0,1,1] neg_lo:[1,0,0] neg_hi:[1,0,0]
    v_pk_mul_f32 v[226:227], v[128:129], v[128:129]
    v_pk_mul_f32 v[228:229], v[130:131], v[130:131]
    v_pk_fma_f32 v[226:227], v[226:227], v[178:179], v[178:179] op_sel:[0,1,0] op_sel_hi:[1,1,0]
    v_pk_fma_f32 v[228:229], v[228:229], v[178:179], v[178:179] op_sel:[0,1,0] op_sel_hi:[1,1,0]
    v_pk_mul_f32 v[226:227], v[226:227], v[128:129]
    v_pk_mul_f32 v[228:229], v[228:229], v[130:131]
    v_exp_f32 v226, v226
    v_exp_f32 v227, v227
    v_exp_f32 v228, v228
    v_exp_f32 v229, v229
    v_pk_fma_f32 v[226:227], v[226:227], v[176:177], v[176:177] op_sel:[0,1,1] op_sel_hi:[1,1,1]
    v_pk_fma_f32 v[228:229], v[228:229], v[176:177], v[176:177] op_sel:[0,1,1] op_sel_hi:[1,1,1]
    v_rcp_f32 v226, v226
    v_rcp_f32 v227, v227
    v_rcp_f32 v228, v228
    v_rcp_f32 v229, v229
    v_pk_mul_f32 v[128:129], v[128:129], v[226:227]
    v_pk_mul_f32 v[130:131], v[130:131], v[228:229]
    v_cvt_pk_bf16_f32 v212, v124, v125
    v_cvt_pk_bf16_f32 v213, v126, v127
    v_cvt_pk_bf16_f32 v214, v128, v129
    v_cvt_pk_bf16_f32 v215, v130, v131
    ds_write_b128 v244, v[212:215] offset:38912
    v_pk_fma_f32 v[48:49], v[164:165], v[160:161], v[48:49] op_sel_hi:[0,1,1] neg_lo:[1,0,0] neg_hi:[1,0,0]
    v_pk_fma_f32 v[50:51], v[164:165], v[162:163], v[50:51] op_sel_hi:[0,1,1] neg_lo:[1,0,0] neg_hi:[1,0,0]
    v_pk_mul_f32 v[226:227], v[48:49], v[48:49]
    v_pk_mul_f32 v[228:229], v[50:51], v[50:51]
    v_pk_fma_f32 v[226:227], v[226:227], v[166:167], v[166:167] op_sel:[0,1,0] op_sel_hi:[1,1,0]
    v_pk_fma_f32 v[228:229], v[228:229], v[166:167], v[166:167] op_sel:[0,1,0] op_sel_hi:[1,1,0]
    v_pk_mul_f32 v[226:227], v[226:227], v[48:49]
    v_pk_mul_f32 v[228:229], v[228:229], v[50:51]
    v_exp_f32 v226, v226
    v_exp_f32 v227, v227
    v_exp_f32 v228, v228
    v_exp_f32 v229, v229
    v_pk_fma_f32 v[226:227], v[226:227], v[164:165], v[164:165] op_sel:[0,1,1] op_sel_hi:[1,1,1]
    v_pk_fma_f32 v[228:229], v[228:229], v[164:165], v[164:165] op_sel:[0,1,1] op_sel_hi:[1,1,1]
    v_rcp_f32 v226, v226
    v_rcp_f32 v227, v227
    v_rcp_f32 v228, v228
    v_rcp_f32 v229, v229
    v_pk_mul_f32 v[48:49], v[48:49], v[226:227]
    v_pk_mul_f32 v[50:51], v[50:51], v[228:229]
    v_cvt_pk_bf16_f32 v216, v48, v49
    v_cvt_pk_bf16_f32 v217, v50, v51
    v_or_b32 v216, 1, v216
    s_add_u32 s36, s45, 0
    buffer_store_dwordx4 v[32:35], v2, s[16:19], s36 offen sc1
    v_pk_fma_f32 v[76:77], v[168:169], v[160:161], v[76:77] op_sel_hi:[0,1,1] neg_lo:[1,0,0] neg_hi:[1,0,0]
    v_pk_fma_f32 v[78:79], v[168:169], v[162:163], v[78:79] op_sel_hi:[0,1,1] neg_lo:[1,0,0] neg_hi:[1,0,0]
    v_pk_mul_f32 v[226:227], v[76:77], v[76:77]
    v_pk_mul_f32 v[228:229], v[78:79], v[78:79]
    v_pk_fma_f32 v[226:227], v[226:227], v[170:171], v[170:171] op_sel:[0,1,0] op_sel_hi:[1,1,0]
    v_pk_fma_f32 v[228:229], v[228:229], v[170:171], v[170:171] op_sel:[0,1,0] op_sel_hi:[1,1,0]
    v_pk_mul_f32 v[226:227], v[226:227], v[76:77]
    v_pk_mul_f32 v[228:229], v[228:229], v[78:79]
    v_exp_f32 v226, v226
    v_exp_f32 v227, v227
    v_exp_f32 v228, v228
    v_exp_f32 v229, v229
    v_pk_fma_f32 v[226:227], v[226:227], v[168:169], v[168:169] op_sel:[0,1,1] op_sel_hi:[1,1,1]
    v_pk_fma_f32 v[228:229], v[228:229], v[168:169], v[168:169] op_sel:[0,1,1] op_sel_hi:[1,1,1]
    v_rcp_f32 v226, v226
    v_rcp_f32 v227, v227
    v_rcp_f32 v228, v228
    v_rcp_f32 v229, v229
    v_pk_mul_f32 v[76:77], v[76:77], v[226:227]
    v_pk_mul_f32 v[78:79], v[78:79], v[228:229]
    v_cvt_pk_bf16_f32 v218, v76, v77
    v_cvt_pk_bf16_f32 v219, v78, v79
    v_or_b32 v218, 1, v218
    s_add_u32 s36, s45, 229376
    buffer_store_dwordx4 v[60:63], v2, s[16:19], s36 offen sc1
    v_pk_fma_f32 v[104:105], v[172:173], v[160:161], v[104:105] op_sel_hi:[0,1,1] neg_lo:[1,0,0] neg_hi:[1,0,0]
    v_pk_fma_f32 v[106:107], v[172:173], v[162:163], v[106:107] op_sel_hi:[0,1,1] neg_lo:[1,0,0] neg_hi:[1,0,0]
    v_pk_mul_f32 v[226:227], v[104:105], v[104:105]
    v_pk_mul_f32 v[228:229], v[106:107], v[106:107]
    v_pk_fma_f32 v[226:227], v[226:227], v[174:175], v[174:175] op_sel:[0,1,0] op_sel_hi:[1,1,0]
    v_pk_fma_f32 v[228:229], v[228:229], v[174:175], v[174:175] op_sel:[0,1,0] op_sel_hi:[1,1,0]
    v_pk_mul_f32 v[226:227], v[226:227], v[104:105]
    v_pk_mul_f32 v[228:229], v[228:229], v[106:107]
    v_exp_f32 v226, v226
    v_exp_f32 v227, v227
    v_exp_f32 v228, v228
    v_exp_f32 v229, v229
    v_pk_fma_f32 v[226:227], v[226:227], v[172:173], v[172:173] op_sel:[0,1,1] op_sel_hi:[1,1,1]
    v_pk_fma_f32 v[228:229], v[228:229], v[172:173], v[172:173] op_sel:[0,1,1] op_sel_hi:[1,1,1]
    v_rcp_f32 v226, v226
    v_rcp_f32 v227, v227
    v_rcp_f32 v228, v228
    v_rcp_f32 v229, v229
    v_pk_mul_f32 v[104:105], v[104:105], v[226:227]
    v_pk_mul_f32 v[106:107], v[106:107], v[228:229]
    v_cvt_pk_bf16_f32 v220, v104, v105
    v_cvt_pk_bf16_f32 v221, v106, v107
    v_or_b32 v220, 1, v220
    s_add_u32 s36, s45, 458752
    buffer_store_dwordx4 v[88:91], v2, s[16:19], s36 offen sc1
    v_pk_fma_f32 v[132:133], v[176:177], v[160:161], v[132:133] op_sel_hi:[0,1,1] neg_lo:[1,0,0] neg_hi:[1,0,0]
    v_pk_fma_f32 v[134:135], v[176:177], v[162:163], v[134:135] op_sel_hi:[0,1,1] neg_lo:[1,0,0] neg_hi:[1,0,0]
    v_pk_mul_f32 v[226:227], v[132:133], v[132:133]
    v_pk_mul_f32 v[228:229], v[134:135], v[134:135]
    v_pk_fma_f32 v[226:227], v[226:227], v[178:179], v[178:179] op_sel:[0,1,0] op_sel_hi:[1,1,0]
    v_pk_fma_f32 v[228:229], v[228:229], v[178:179], v[178:179] op_sel:[0,1,0] op_sel_hi:[1,1,0]
    v_pk_mul_f32 v[226:227], v[226:227], v[132:133]
    v_pk_mul_f32 v[228:229], v[228:229], v[134:135]
    v_exp_f32 v226, v226
    v_exp_f32 v227, v227
    v_exp_f32 v228, v228
    v_exp_f32 v229, v229
    v_pk_fma_f32 v[226:227], v[226:227], v[176:177], v[176:177] op_sel:[0,1,1] op_sel_hi:[1,1,1]
    v_pk_fma_f32 v[228:229], v[228:229], v[176:177], v[176:177] op_sel:[0,1,1] op_sel_hi:[1,1,1]
    v_rcp_f32 v226, v226
    v_rcp_f32 v227, v227
    v_rcp_f32 v228, v228
    v_rcp_f32 v229, v229
    v_pk_mul_f32 v[132:133], v[132:133], v[226:227]
    v_pk_mul_f32 v[134:135], v[134:135], v[228:229]
    v_cvt_pk_bf16_f32 v222, v132, v133
    v_cvt_pk_bf16_f32 v223, v134, v135
    s_add_u32 s36, s45, 688128
    buffer_store_dwordx4 v[116:119], v2, s[16:19], s36 offen sc1
    s_waitcnt lgkmcnt(0)
    s_mov_b32 s44, s46
    s_mov_b32 s45, s47
    s_branch G3_e2
G3_e1:
    v_pk_fma_f32 v[28:29], v[164:165], v[140:141], v[28:29] op_sel_hi:[0,1,1] neg_lo:[1,0,0] neg_hi:[1,0,0]
    v_pk_fma_f32 v[30:31], v[164:165], v[142:143], v[30:31] op_sel_hi:[0,1,1] neg_lo:[1,0,0] neg_hi:[1,0,0]
    v_pk_mul_f32 v[226:227], v[28:29], v[28:29]
    v_pk_mul_f32 v[228:229], v[30:31], v[30:31]
    v_pk_fma_f32 v[226:227], v[226:227], v[166:167], v[166:167] op_sel:[0,1,0] op_sel_hi:[1,1,0]
    v_pk_fma_f32 v[228:229], v[228:229], v[166:167], v[166:167] op_sel:[0,1,0] op_sel_hi:[1,1,0]
    v_pk_mul_f32 v[226:227], v[226:227], v[28:29]
    v_pk_mul_f32 v[228:229], v[228:229], v[30:31]
    v_exp_f32 v226, v226
    v_exp_f32 v227, v227
    v_exp_f32 v228, v228
    v_exp_f32 v229, v229
    v_pk_fma_f32 v[226:227], v[226:227], v[164:165], v[164:165] op_sel:[0,1,1] op_sel_hi:[1,1,1]
    v_pk_fma_f32 v[228:229], v[228:229], v[164:165], v[164:165] op_sel:[0,1,1] op_sel_hi:[1,1,1]
    v_rcp_f32 v226, v226
    v_rcp_f32 v227, v227
    v_rcp_f32 v228, v228
    v_rcp_f32 v229, v229
    v_pk_mul_f32 v[28:29], v[28:29], v[226:227]
    v_pk_mul_f32 v[30:31], v[30:31], v[228:229]
    v_pk_fma_f32 v[32:33], v[164:165], v[144:145], v[32:33] op_sel_hi:[0,1,1] neg_lo:[1,0,0] neg_hi:[1,0,0]
    v_pk_fma_f32 v[34:35], v[164:165], v[146:147], v[34:35] op_sel_hi:[0,1,1] neg_lo:[1,0,0] neg_hi:[1,0,0]
    v_pk_mul_f32 v[226:227], v[32:33], v[32:33]
    v_pk_mul_f32 v[228:229], v[34:35], v[34:35]
    v_pk_fma_f32 v[226:227], v[226:227], v[166:167], v[166:167] op_sel:[0,1,0] op_sel_hi:[1,1,0]
    v_pk_fma_f32 v[228:229], v[228:229], v[166:167], v[166:167] op_sel:[0,1,0] op_sel_hi:[1,1,0]
    v_pk_mul_f32 v[226:227], v[226:227], v[32:33]
    v_pk_mul_f32 v[228:229], v[228:229], v[34:35]
    v_exp_f32 v226, v226
    v_exp_f32 v227, v227
    v_exp_f32 v228, v228
    v_exp_f32 v229, v229
    v_pk_fma_f32 v[226:227], v[226:227], v[164:165], v[164:165] op_sel:[0,1,1] op_sel_hi:[1,1,1]
    v_pk_fma_f32 v[228:229], v[228:229], v[164:165], v[164:165] op_sel:[0,1,1] op_sel_hi:[1,1,1]
    v_rcp_f32 v226, v226
    v_rcp_f32 v227, v227
    v_rcp_f32 v228, v228
    v_rcp_f32 v229, v229
    v_pk_mul_f32 v[32:33], v[32:33], v[226:227]
    v_pk_mul_f32 v[34:35], v[34:35], v[228:229]
    v_cvt_pk_bf16_f32 v28, v28, v29
    v_cvt_pk_bf16_f32 v29, v30, v31
    v_cvt_pk_bf16_f32 v30, v32, v33
    v_cvt_pk_bf16_f32 v31, v34, v35
    v_or_b32 v28, 1, v28
    ds_write_b128 v244, v[28:31] offset:0
    s_add_u32 s36, s45, 0
    buffer_store_dwordx4 v[28:31], v2, s[16:19], s36 offen sc1
    v_pk_fma_f32 v[56:57], v[168:169], v[140:141], v[56:57] op_sel_hi:[0,1,1] neg_lo:[1,0,0] neg_hi:[1,0,0]
    v_pk_fma_f32 v[58:59], v[168:169], v[142:143], v[58:59] op_sel_hi:[0,1,1] neg_lo:[1,0,0] neg_hi:[1,0,0]
    v_pk_mul_f32 v[226:227], v[56:57], v[56:57]
    v_pk_mul_f32 v[228:229], v[58:59], v[58:59]
    v_pk_fma_f32 v[226:227], v[226:227], v[170:171], v[170:171] op_sel:[0,1,0] op_sel_hi:[1,1,0]
    v_pk_fma_f32 v[228:229], v[228:229], v[170:171], v[170:171] op_sel:[0,1,0] op_sel_hi:[1,1,0]
    v_pk_mul_f32 v[226:227], v[226:227], v[56:57]
    v_pk_mul_f32 v[228:229], v[228:229], v[58:59]
    v_exp_f32 v226, v226
    v_exp_f32 v227, v227
    v_exp_f32 v228, v228
    v_exp_f32 v229, v229
    v_pk_fma_f32 v[226:227], v[226:227], v[168:169], v[168:169] op_sel:[0,1,1] op_sel_hi:[1,1,1]
    v_pk_fma_f32 v[228:229], v[228:229], v[168:169], v[168:169] op_sel:[0,1,1] op_sel_hi:[1,1,1]
    v_rcp_f32 v226, v226
    v_rcp_f32 v227, v227
    v_rcp_f32 v228, v228
    v_rcp_f32 v229, v229
    v_pk_mul_f32 v[56:57], v[56:57], v[226:227]
    v_pk_mul_f32 v[58:59], v[58:59], v[228:229]
    v_pk_fma_f32 v[60:61], v[168:169], v[144:145], v[60:61] op_sel_hi:[0,1,1] neg_lo:[1,0,0] neg_hi:[1,0,0]
    v_pk_fma_f32 v[62:63], v[168:169], v[146:147], v[62:63] op_sel_hi:[0,1,1] neg_lo:[1,0,0] neg_hi:[1,0,0]
    v_pk_mul_f32 v[226:227], v[60:61], v[60:61]
    v_pk_mul_f32 v[228:229], v[62:63], v[62:63]
    v_pk_fma_f32 v[226:227], v[226:227], v[170:171], v[170:171] op_sel:[0,1,0] op_sel_hi:[1,1,0]
    v_pk_fma_f32 v[228:229], v[228:229], v[170:171], v[170:171] op_sel:[0,1,0] op_sel_hi:[1,1,0]
    v_pk_mul_f32 v[226:227], v[226:227], v[60:61]
    v_pk_mul_f32 v[228:229], v[228:229], v[62:63]
    v_exp_f32 v226, v226
    v_exp_f32 v227, v227
    v_exp_f32 v228, v228
    v_exp_f32 v229, v229
    v_pk_fma_f32 v[226:227], v[226:227], v[168:169], v[168:169] op_sel:[0,1,1] op_sel_hi:[1,1,1]
    v_pk_fma_f32 v[228:229], v[228:229], v[168:169], v[168:169] op_sel:[0,1,1] op_sel_hi:[1,1,1]
    v_rcp_f32 v226, v226
    v_rcp_f32 v227, v227
    v_rcp_f32 v228, v228
    v_rcp_f32 v229, v229
    v_pk_mul_f32 v[60:61], v[60:61], v[226:227]
    v_pk_mul_f32 v[62:63], v[62:63], v[228:229]
    v_cvt_pk_bf16_f32 v56, v56, v57
    v_cvt_pk_bf16_f32 v57, v58, v59
    v_cvt_pk_bf16_f32 v58, v60, v61
    v_cvt_pk_bf16_f32 v59, v62, v63
    v_or_b32 v56, 1, v56
    ds_write_b128 v244, v[56:59] offset:2048
    s_add_u32 s36, s45, 229376
    buffer_store_dwordx4 v[56:59], v2, s[16:19], s36 offen sc1
    v_pk_fma_f32 v[84:85], v[172:173], v[140:141], v[84:85] op_sel_hi:[0,1,1] neg_lo:[1,0,0] neg_hi:[1,0,0]
    v_pk_fma_f32 v[86:87], v[172:173], v[142:143], v[86:87] op_sel_hi:[0,1,1] neg_lo:[1,0,0] neg_hi:[1,0,0]
    v_pk_mul_f32 v[226:227], v[84:85], v[84:85]
    v_pk_mul_f32 v[228:229], v[86:87], v[86:87]
    v_pk_fma_f32 v[226:227], v[226:227], v[174:175], v[174:175] op_sel:[0,1,0] op_sel_hi:[1,1,0]
    v_pk_fma_f32 v[228:229], v[228:229], v[174:175], v[174:175] op_sel:[0,1,0] op_sel_hi:[1,1,0]
    v_pk_mul_f32 v[226:227], v[226:227], v[84:85]
    v_pk_mul_f32 v[228:229], v[228:229], v[86:87]
    v_exp_f32 v226, v226
    v_exp_f32 v227, v227
    v_exp_f32 v228, v228
    v_exp_f32 v229, v229
    v_pk_fma_f32 v[226:227], v[226:227], v[172:173], v[172:173] op_sel:[0,1,1] op_sel_hi:[1,1,1]
    v_pk_fma_f32 v[228:229], v[228:229], v[172:173], v[172:173] op_sel:[0,1,1] op_sel_hi:[1,1,1]
    v_rcp_f32 v226, v226
    v_rcp_f32 v227, v227
    v_rcp_f32 v228, v228
    v_rcp_f32 v229, v229
    v_pk_mul_f32 v[84:85], v[84:85], v[226:227]
    v_pk_mul_f32 v[86:87], v[86:87], v[228:229]
    v_pk_fma_f32 v[88:89], v[172:173], v[144:145], v[88:89] op_sel_hi:[0,1,1] neg_lo:[1,0,0] neg_hi:[1,0,0]
    v_pk_fma_f32 v[90:91], v[172:173], v[146:147], v[90:91] op_sel_hi:[0,1,1] neg_lo:[1,0,0] neg_hi:[1,0,0]
    v_pk_mul_f32 v[226:227], v[88:89], v[88:89]
    v_pk_mul_f32 v[228:229], v[90:91], v[90:91]
    v_pk_fma_f32 v[226:227], v[226:227], v[174:175], v[174:175] op_sel:[0,1,0] op_sel_hi:[1,1,0]
    v_pk_fma_f32 v[228:229], v[228:229], v[174:175], v[174:175] op_sel:[0,1,0] op_sel_hi:[1,1,0]
    v_pk_mul_f32 v[226:227], v[226:227], v[88:89]
    v_pk_mul_f32 v[228:229], v[228:229], v[90:91]
    v_exp_f32 v226, v226
    v_exp_f32 v227, v227
    v_exp_f32 v228, v228
    v_exp_f32 v229, v229
    v_pk_fma_f32 v[226:227], v[226:227], v[172:173], v[172:173] op_sel:[0,1,1] op_sel_hi:[1,1,1]
    v_pk_fma_f32 v[228:229], v[228:229], v[172:173], v[172:173] op_sel:[0,1,1] op_sel_hi:[1,1,1]
    v_rcp_f32 v226, v226
    v_rcp_f32 v227, v227
    v_rcp_f32 v228, v228
    v_rcp_f32 v229, v229
    v_pk_mul_f32 v[88:89], v[88:89], v[226:227]
    v_pk_mul_f32 v[90:91], v[90:91], v[228:229]
    v_cvt_pk_bf16_f32 v84, v84, v85
    v_cvt_pk_bf16_f32 v85, v86, v87
    v_cvt_pk_bf16_f32 v86, v88, v89
    v_cvt_pk_bf16_f32 v87, v90, v91
    v_or_b32 v84, 1, v84
    ds_write_b128 v244, v[84:87] offset:4096
    s_add_u32 s36, s45, 458752
    buffer_store_dwordx4 v[84:87], v2, s[16:19], s36 offen sc1
    v_pk_fma_f32 v[112:113], v[176:177], v[140:141], v[112:113] op_sel_hi:[0,1,1] neg_lo:[1,0,0] neg_hi:[1,0,0]
    v_pk_fma_f32 v[114:115], v[176:177], v[142:143], v[114:115] op_sel_hi:[0,1,1] neg_lo:[1,0,0] neg_hi:[1,0,0]
    v_pk_mul_f32 v[226:227], v[112:113], v[112:113]
    v_pk_mul_f32 v[228:229], v[114:115], v[114:115]
    v_pk_fma_f32 v[226:227], v[226:227], v[178:179], v[178:179] op_sel:[0,1,0] op_sel_hi:[1,1,0]
    v_pk_fma_f32 v[228:229], v[228:229], v[178:179], v[178:179] op_sel:[0,1,0] op_sel_hi:[1,1,0]
    v_pk_mul_f32 v[226:227], v[226:227], v[112:113]
    v_pk_mul_f32 v[228:229], v[228:229], v[114:115]
    v_exp_f32 v226, v226
    v_exp_f32 v227, v227
    v_exp_f32 v228, v228
    v_exp_f32 v229, v229
    v_pk_fma_f32 v[226:227], v[226:227], v[176:177], v[176:177] op_sel:[0,1,1] op_sel_hi:[1,1,1]
    v_pk_fma_f32 v[228:229], v[228:229], v[176:177], v[176:177] op_sel:[0,1,1] op_sel_hi:[1,1,1]
    v_rcp_f32 v226, v226
    v_rcp_f32 v227, v227
    v_rcp_f32 v228, v228
    v_rcp_f32 v229, v229
    v_pk_mul_f32 v[112:113], v[112:113], v[226:227]
    v_pk_mul_f32 v[114:115], v[114:115], v[228:229]
    v_pk_fma_f32 v[116:117], v[176:177], v[144:145], v[116:117] op_sel_hi:[0,1,1] neg_lo:[1,0,0] neg_hi:[1,0,0]
    v_pk_fma_f32 v[118:119], v[176:177], v[146:147], v[118:119] op_sel_hi:[0,1,1] neg_lo:[1,0,0] neg_hi:[1,0,0]
    v_pk_mul_f32 v[226:227], v[116:117], v[116:117]
    v_pk_mul_f32 v[228:229], v[118:119], v[118:119]
    v_pk_fma_f32 v[226:227], v[226:227], v[178:179], v[178:179] op_sel:[0,1,0] op_sel_hi:[1,1,0]
    v_pk_fma_f32 v[228:229], v[228:229], v[178:179], v[178:179] op_sel:[0,1,0] op_sel_hi:[1,1,0]
    v_pk_mul_f32 v[226:227], v[226:227], v[116:117]
    v_pk_mul_f32 v[228:229], v[228:229], v[118:119]
    v_exp_f32 v226, v226
    v_exp_f32 v227, v227
    v_exp_f32 v228, v228
    v_exp_f32 v229, v229
    v_pk_fma_f32 v[226:227], v[226:227], v[176:177], v[176:177] op_sel:[0,1,1] op_sel_hi:[1,1,1]
    v_pk_fma_f32 v[228:229], v[228:229], v[176:177], v[176:177] op_sel:[0,1,1] op_sel_hi:[1,1,1]
    v_rcp_f32 v226, v226
    v_rcp_f32 v227, v227
    v_rcp_f32 v228, v228
    v_rcp_f32 v229, v229
    v_pk_mul_f32 v[116:117], v[116:117], v[226:227]
    v_pk_mul_f32 v[118:119], v[118:119], v[228:229]
    v_cvt_pk_bf16_f32 v112, v112, v113
    v_cvt_pk_bf16_f32 v113, v114, v115
    v_cvt_pk_bf16_f32 v114, v116, v117
    v_cvt_pk_bf16_f32 v115, v118, v119
    ds_write_b128 v244, v[112:115] offset:6144
    s_add_u32 s36, s45, 688128
    buffer_store_dwordx4 v[112:115], v2, s[16:19], s36 offen sc1
    v_pk_fma_f32 v[36:37], v[164:165], v[148:149], v[36:37] op_sel_hi:[0,1,1] neg_lo:[1,0,0] neg_hi:[1,0,0]
    v_pk_fma_f32 v[38:39], v[164:165], v[150:151], v[38:39] op_sel_hi:[0,1,1] neg_lo:[1,0,0] neg_hi:[1,0,0]
    v_pk_mul_f32 v[226:227], v[36:37], v[36:37]
    v_pk_mul_f32 v[228:229], v[38:39], v[38:39]
    v_pk_fma_f32 v[226:227], v[226:227], v[166:167], v[166:167] op_sel:[0,1,0] op_sel_hi:[1,1,0]
    v_pk_fma_f32 v[228:229], v[228:229], v[166:167], v[166:167] op_sel:[0,1,0] op_sel_hi:[1,1,0]
    v_pk_mul_f32 v[226:227], v[226:227], v[36:37]
    v_pk_mul_f32 v[228:229], v[228:229], v[38:39]
    v_exp_f32 v226, v226
    v_exp_f32 v227, v227
    v_exp_f32 v228, v228
    v_exp_f32 v229, v229
    v_pk_fma_f32 v[226:227], v[226:227], v[164:165], v[164:165] op_sel:[0,1,1] op_sel_hi:[1,1,1]
    v_pk_fma_f32 v[228:229], v[228:229], v[164:165], v[164:165] op_sel:[0,1,1] op_sel_hi:[1,1,1]
    v_rcp_f32 v226, v226
    v_rcp_f32 v227, v227
    v_rcp_f32 v228, v228
    v_rcp_f32 v229, v229
    v_pk_mul_f32 v[36:37], v[36:37], v[226:227]
    v_pk_mul_f32 v[38:39], v[38:39], v[228:229]
    v_pk_fma_f32 v[40:41], v[164:165], v[152:153], v[40:41] op_sel_hi:[0,1,1] neg_lo:[1,0,0] neg_hi:[1,0,0]
    v_pk_fma_f32 v[42:43], v[164:165], v[154:155], v[42:43] op_sel_hi:[0,1,1] neg_lo:[1,0,0] neg_hi:[1,0,0]
    v_pk_mul_f32 v[226:227], v[40:41], v[40:41]
    v_pk_mul_f32 v[228:229], v[42:43], v[42:43]
    v_pk_fma_f32 v[226:227], v[226:227], v[166:167], v[166:167] op_sel:[0,1,0] op_sel_hi:[1,1,0]
    v_pk_fma_f32 v[228:229], v[228:229], v[166:167], v[166:167] op_sel:[0,1,0] op_sel_hi:[1,1,0]
    v_pk_mul_f32 v[226:227], v[226:227], v[40:41]
    v_pk_mul_f32 v[228:229], v[228:229], v[42:43]
    v_exp_f32 v226, v226
    v_exp_f32 v227, v227
    v_exp_f32 v228, v228
    v_exp_f32 v229, v229
    v_pk_fma_f32 v[226:227], v[226:227], v[164:165], v[164:165] op_sel:[0,1,1] op_sel_hi:[1,1,1]
    v_pk_fma_f32 v[228:229], v[228:229], v[164:165], v[164:165] op_sel:[0,1,1] op_sel_hi:[1,1,1]
    v_rcp_f32 v226, v226
    v_rcp_f32 v227, v227
    v_rcp_f32 v228, v228
    v_rcp_f32 v229, v229
    v_pk_mul_f32 v[40:41], v[40:41], v[226:227]
    v_pk_mul_f32 v[42:43], v[42:43], v[228:229]
    v_cvt_pk_bf16_f32 v36, v36, v37
    v_cvt_pk_bf16_f32 v37, v38, v39
    v_cvt_pk_bf16_f32 v38, v40, v41
    v_cvt_pk_bf16_f32 v39, v42, v43
    v_or_b32 v36, 1, v36
    ds_write_b128 v244, v[36:39] offset:16384
    v_pk_fma_f32 v[64:65], v[168:169], v[148:149], v[64:65] op_sel_hi:[0,1,1] neg_lo:[1,0,0] neg_hi:[1,0,0]
    v_pk_fma_f32 v[66:67], v[168:169], v[150:151], v[66:67] op_sel_hi:[0,1,1] neg_lo:[1,0,0] neg_hi:[1,0,0]
    v_pk_mul_f32 v[226:227], v[64:65], v[64:65]
    v_pk_mul_f32 v[228:229], v[66:67], v[66:67]
    v_pk_fma_f32 v[226:227], v[226:227], v[170:171], v[170:171] op_sel:[0,1,0] op_sel_hi:[1,1,0]
    v_pk_fma_f32 v[228:229], v[228:229], v[170:171], v[170:171] op_sel:[0,1,0] op_sel_hi:[1,1,0]
    v_pk_mul_f32 v[226:227], v[226:227], v[64:65]
    v_pk_mul_f32 v[228:229], v[228:229], v[66:67]
    v_exp_f32 v226, v226
    v_exp_f32 v227, v227
    v_exp_f32 v228, v228
    v_exp_f32 v229, v229
    v_pk_fma_f32 v[226:227], v[226:227], v[168:169], v[168:169] op_sel:[0,1,1] op_sel_hi:[1,1,1]
    v_pk_fma_f32 v[228:229], v[228:229], v[168:169], v[168:169] op_sel:[0,1,1] op_sel_hi:[1,1,1]
    v_rcp_f32 v226, v226
    v_rcp_f32 v227, v227
    v_rcp_f32 v228, v228
    v_rcp_f32 v229, v229
    v_pk_mul_f32 v[64:65], v[64:65], v[226:227]
    v_pk_mul_f32 v[66:67], v[66:67], v[228:229]
    v_pk_fma_f32 v[68:69], v[168:169], v[152:153], v[68:69] op_sel_hi:[0,1,1] neg_lo:[1,0,0] neg_hi:[1,0,0]
    v_pk_fma_f32 v[70:71], v[168:169], v[154:155], v[70:71] op_sel_hi:[0,1,1] neg_lo:[1,0,0] neg_hi:[1,0,0]
    v_pk_mul_f32 v[226:227], v[68:69], v[68:69]
    v_pk_mul_f32 v[228:229], v[70:71], v[70:71]
    v_pk_fma_f32 v[226:227], v[226:227], v[170:171], v[170:171] op_sel:[0,1,0] op_sel_hi:[1,1,0]
    v_pk_fma_f32 v[228:229], v[228:229], v[170:171], v[170:171] op_sel:[0,1,0] op_sel_hi:[1,1,0]
    v_pk_mul_f32 v[226:227], v[226:227], v[68:69]
    v_pk_mul_f32 v[228:229], v[228:229], v[70:71]
    v_exp_f32 v226, v226
    v_exp_f32 v227, v227
    v_exp_f32 v228, v228
    v_exp_f32 v229, v229
    v_pk_fma_f32 v[226:227], v[226:227], v[168:169], v[168:169] op_sel:[0,1,1] op_sel_hi:[1,1,1]
    v_pk_fma_f32 v[228:229], v[228:229], v[168:169], v[168:169] op_sel:[0,1,1] op_sel_hi:[1,1,1]
    v_rcp_f32 v226, v226
    v_rcp_f32 v227, v227
    v_rcp_f32 v228, v228
    v_rcp_f32 v229, v229
    v_pk_mul_f32 v[68:69], v[68:69], v[226:227]
    v_pk_mul_f32 v[70:71], v[70:71], v[228:229]
    v_cvt_pk_bf16_f32 v64, v64, v65
    v_cvt_pk_bf16_f32 v65, v66, v67
    v_cvt_pk_bf16_f32 v66, v68, v69
    v_cvt_pk_bf16_f32 v67, v70, v71
    v_or_b32 v64, 1, v64
    ds_write_b128 v244, v[64:67] offset:18432
    s_waitcnt vmcnt(0)
    s_mov_b64 exec, 1
    ds_add_u32 v246, v245
    s_mov_b64 exec, -1
    v_pk_fma_f32 v[92:93], v[172:173], v[148:149], v[92:93] op_sel_hi:[0,1,1] neg_lo:[1,0,0] neg_hi:[1,0,0]
    v_pk_fma_f32 v[94:95], v[172:173], v[150:151], v[94:95] op_sel_hi:[0,1,1] neg_lo:[1,0,0] neg_hi:[1,0,0]
    v_pk_mul_f32 v[226:227], v[92:93], v[92:93]
    v_pk_mul_f32 v[228:229], v[94:95], v[94:95]
    v_pk_fma_f32 v[226:227], v[226:227], v[174:175], v[174:175] op_sel:[0,1,0] op_sel_hi:[1,1,0]
    v_pk_fma_f32 v[228:229], v[228:229], v[174:175], v[174:175] op_sel:[0,1,0] op_sel_hi:[1,1,0]
    v_pk_mul_f32 v[226:227], v[226:227], v[92:93]
    v_pk_mul_f32 v[228:229], v[228:229], v[94:95]
    v_exp_f32 v226, v226
    v_exp_f32 v227, v227
    v_exp_f32 v228, v228
    v_exp_f32 v229, v229
    v_pk_fma_f32 v[226:227], v[226:227], v[172:173], v[172:173] op_sel:[0,1,1] op_sel_hi:[1,1,1]
    v_pk_fma_f32 v[228:229], v[228:229], v[172:173], v[172:173] op_sel:[0,1,1] op_sel_hi:[1,1,1]
    v_rcp_f32 v226, v226
    v_rcp_f32 v227, v227
    v_rcp_f32 v228, v228
    v_rcp_f32 v229, v229
    v_pk_mul_f32 v[92:93], v[92:93], v[226:227]
    v_pk_mul_f32 v[94:95], v[94:95], v[228:229]
    v_pk_fma_f32 v[96:97], v[172:173], v[152:153], v[96:97] op_sel_hi:[0,1,1] neg_lo:[1,0,0] neg_hi:[1,0,0]
    v_pk_fma_f32 v[98:99], v[172:173], v[154:155], v[98:99] op_sel_hi:[0,1,1] neg_lo:[1,0,0] neg_hi:[1,0,0]
    v_pk_mul_f32 v[226:227], v[96:97], v[96:97]
    v_pk_mul_f32 v[228:229], v[98:99], v[98:99]
    v_pk_fma_f32 v[226:227], v[226:227], v[174:175], v[174:175] op_sel:[0,1,0] op_sel_hi:[1,1,0]
    v_pk_fma_f32 v[228:229], v[228:229], v[174:175], v[174:175] op_sel:[0,1,0] op_sel_hi:[1,1,0]
    v_pk_mul_f32 v[226:227], v[226:227], v[96:97]
    v_pk_mul_f32 v[228:229], v[228:229], v[98:99]
    v_exp_f32 v226, v226
    v_exp_f32 v227, v227
    v_exp_f32 v228, v228
    v_exp_f32 v229, v229
    v_pk_fma_f32 v[226:227], v[226:227], v[172:173], v[172:173] op_sel:[0,1,1] op_sel_hi:[1,1,1]
    v_pk_fma_f32 v[228:229], v[228:229], v[172:173], v[172:173] op_sel:[0,1,1] op_sel_hi:[1,1,1]
    v_rcp_f32 v226, v226
    v_rcp_f32 v227, v227
    v_rcp_f32 v228, v228
    v_rcp_f32 v229, v229
    v_pk_mul_f32 v[96:97], v[96:97], v[226:227]
    v_pk_mul_f32 v[98:99], v[98:99], v[228:229]
    v_cvt_pk_bf16_f32 v92, v92, v93
    v_cvt_pk_bf16_f32 v93, v94, v95
    v_cvt_pk_bf16_f32 v94, v96, v97
    v_cvt_pk_bf16_f32 v95, v98, v99
    v_or_b32 v92, 1, v92
    ds_write_b128 v244, v[92:95] offset:20480
    s_cmp_eq_u32 s60, 1
    s_cbranch_scc1 G4_p11
    buffer_load_dwordx4 v[180:183], v196, s[84:87], 0 offen offset:0 sc1
    buffer_load_dwordx4 v[188:191], v196, s[88:91], 0 offen offset:0 sc1
    buffer_load_dwordx4 v[184:187], v196, s[84:87], 0 offen offset:2048 sc1
    buffer_load_dwordx4 v[192:195], v196, s[88:91], 0 offen offset:2048 sc1
    s_branch G4_p21
G4_p11:
    s_add_u32 s36, s40, 0
    buffer_load_dwordx4 v[180:183], v2, s[84:87], s36 offen offset:0 sc1
    buffer_load_dwordx4 v[184:187], v2, s[88:91], s36 offen offset:0 sc1
    buffer_load_dwordx4 v[188:191], v2, s[84:87], s36 offen offset:1024 sc1
    buffer_load_dwordx4 v[192:195], v2, s[88:91], s36 offen offset:1024 sc1
    s_add_u32 s36, s40, 65536
    buffer_load_dwordx4 v[196:199], v2, s[84:87], s36 offen offset:0 sc1
    buffer_load_dwordx4 v[230:233], v2, s[88:91], s36 offen offset:0 sc1
    buffer_load_dwordx4 v[234:237], v2, s[84:87], s36 offen offset:1024 sc1
    buffer_load_dwordx4 v[248:251], v2, s[88:91], s36 offen offset:1024 sc1
G4_p21:
    v_pk_fma_f32 v[120:121], v[176:177], v[148:149], v[120:121] op_sel_hi:[0,1,1] neg_lo:[1,0,0] neg_hi:[1,0,0]
    v_pk_fma_f32 v[122:123], v[176:177], v[150:151], v[122:123] op_sel_hi:[0,1,1] neg_lo:[1,0,0] neg_hi:[1,0,0]
    v_pk_mul_f32 v[226:227], v[120:121], v[120:121]
    v_pk_mul_f32 v[228:229], v[122:123], v[122:123]
    v_pk_fma_f32 v[226:227], v[226:227], v[178:179], v[178:179] op_sel:[0,1,0] op_sel_hi:[1,1,0]
    v_pk_fma_f32 v[228:229], v[228:229], v[178:179], v[178:179] op_sel:[0,1,0] op_sel_hi:[1,1,0]
    v_pk_mul_f32 v[226:227], v[226:227], v[120:121]
    v_pk_mul_f32 v[228:229], v[228:229], v[122:123]
    v_exp_f32 v226, v226
    v_exp_f32 v227, v227
    v_exp_f32 v228, v228
    v_exp_f32 v229, v229
    v_pk_fma_f32 v[226:227], v[226:227], v[176:177], v[176:177] op_sel:[0,1,1] op_sel_hi:[1,1,1]
    v_pk_fma_f32 v[228:229], v[228:229], v[176:177], v[176:177] op_sel:[0,1,1] op_sel_hi:[1,1,1]
    v_rcp_f32 v226, v226
    v_rcp_f32 v227, v227
    v_rcp_f32 v228, v228
    v_rcp_f32 v229, v229
    v_pk_mul_f32 v[120:121], v[120:121], v[226:227]
    v_pk_mul_f32 v[122:123], v[122:123], v[228:229]
    v_pk_fma_f32 v[124:125], v[176:177], v[152:153], v[124:125] op_sel_hi:[0,1,1] neg_lo:[1,0,0] neg_hi:[1,0,0]
    v_pk_fma_f32 v[126:127], v[176:177], v[154:155], v[126:127] op_sel_hi:[0,1,1] neg_lo:[1,0,0] neg_hi:[1,0,0]
    v_pk_mul_f32 v[226:227], v[124:125], v[124:125]
    v_pk_mul_f32 v[228:229], v[126:127], v[126:127]
    v_pk_fma_f32 v[226:227], v[226:227], v[178:179], v[178:179] op_sel:[0,1,0] op_sel_hi:[1,1,0]
    v_pk_fma_f32 v[228:229], v[228:229], v[178:179], v[178:179] op_sel:[0,1,0] op_sel_hi:[1,1,0]
    v_pk_mul_f32 v[226:227], v[226:227], v[124:125]
    v_pk_mul_f32 v[228:229], v[228:229], v[126:127]
    v_exp_f32 v226, v226
    v_exp_f32 v227, v227
    v_exp_f32 v228, v228
    v_exp_f32 v229, v229
    v_pk_fma_f32 v[226:227], v[226:227], v[176:177], v[176:177] op_sel:[0,1,1] op_sel_hi:[1,1,1]
    v_pk_fma_f32 v[228:229], v[228:229], v[176:177], v[176:177] op_sel:[0,1,1] op_sel_hi:[1,1,1]
    v_rcp_f32 v226, v226
    v_rcp_f32 v227, v227
    v_rcp_f32 v228, v228
    v_rcp_f32 v229, v229
    v_pk_mul_f32 v[124:125], v[124:125], v[226:227]
    v_pk_mul_f32 v[126:127], v[126:127], v[228:229]
    v_cvt_pk_bf16_f32 v120, v120, v121
    v_cvt_pk_bf16_f32 v121, v122, v123
    v_cvt_pk_bf16_f32 v122, v124, v125
    v_cvt_pk_bf16_f32 v123, v126, v127
    ds_write_b128 v244, v[120:123] offset:22528
    v_pk_fma_f32 v[44:45], v[164:165], v[156:157], v[44:45] op_sel_hi:[0,1,1] neg_lo:[1,0,0] neg_hi:[1,0,0]
    v_pk_fma_f32 v[46:47], v[164:165], v[158:159], v[46:47] op_sel_hi:[0,1,1] neg_lo:[1,0,0] neg_hi:[1,0,0]
    v_pk_mul_f32 v[226:227], v[44:45], v[44:45]
    v_pk_mul_f32 v[228:229], v[46:47], v[46:47]
    v_pk_fma_f32 v[226:227], v[226:227], v[166:167], v[166:167] op_sel:[0,1,0] op_sel_hi:[1,1,0]
    v_pk_fma_f32 v[228:229], v[228:229], v[166:167], v[166:167] op_sel:[0,1,0] op_sel_hi:[1,1,0]
    v_pk_mul_f32 v[226:227], v[226:227], v[44:45]
    v_pk_mul_f32 v[228:229], v[228:229], v[46:47]
    v_exp_f32 v226, v226
    v_exp_f32 v227, v227
    v_exp_f32 v228, v228
    v_exp_f32 v229, v229
    v_pk_fma_f32 v[226:227], v[226:227], v[164:165], v[164:165] op_sel:[0,1,1] op_sel_hi:[1,1,1]
    v_pk_fma_f32 v[228:229], v[228:229], v[164:165], v[164:165] op_sel:[0,1,1] op_sel_hi:[1,1,1]
    v_rcp_f32 v226, v226
    v_rcp_f32 v227, v227
    v_rcp_f32 v228, v228
    v_rcp_f32 v229, v229
    v_pk_mul_f32 v[44:45], v[44:45], v[226:227]
    v_pk_mul_f32 v[46:47], v[46:47], v[228:229]
    v_pk_fma_f32 v[48:49], v[164:165], v[160:161], v[48:49] op_sel_hi:[0,1,1] neg_lo:[1,0,0] neg_hi:[1,0,0]
    v_pk_fma_f32 v[50:51], v[164:165], v[162:163], v[50:51] op_sel_hi:[0,1,1] neg_lo:[1,0,0] neg_hi:[1,0,0]
    v_pk_mul_f32 v[226:227], v[48:49], v[48:49]
    v_pk_mul_f32 v[228:229], v[50:51], v[50:51]
    v_pk_fma_f32 v[226:227], v[226:227], v[166:167], v[166:167] op_sel:[0,1,0] op_sel_hi:[1,1,0]
    v_pk_fma_f32 v[228:229], v[228:229], v[166:167], v[166:167] op_sel:[0,1,0] op_sel_hi:[1,1,0]
    v_pk_mul_f32 v[226:227], v[226:227], v[48:49]
    v_pk_mul_f32 v[228:229], v[228:229], v[50:51]
    v_exp_f32 v226, v226
    v_exp_f32 v227, v227
    v_exp_f32 v228, v228
    v_exp_f32 v229, v229
    v_pk_fma_f32 v[226:227], v[226:227], v[164:165], v[164:165] op_sel:[0,1,1] op_sel_hi:[1,1,1]
    v_pk_fma_f32 v[228:229], v[228:229], v[164:165], v[164:165] op_sel:[0,1,1] op_sel_hi:[1,1,1]
    v_rcp_f32 v226, v226
    v_rcp_f32 v227, v227
    v_rcp_f32 v228, v228
    v_rcp_f32 v229, v229
    v_pk_mul_f32 v[48:49], v[48:49], v[226:227]
    v_pk_mul_f32 v[50:51], v[50:51], v[228:229]
    v_cvt_pk_bf16_f32 v200, v44, v45
    v_cvt_pk_bf16_f32 v201, v46, v47
    v_cvt_pk_bf16_f32 v202, v48, v49
    v_cvt_pk_bf16_f32 v203, v50, v51
    v_or_b32 v200, 1, v200
    ds_write_b128 v244, v[200:203] offset:32768
    v_pk_fma_f32 v[72:73], v[168:169], v[156:157], v[72:73] op_sel_hi:[0,1,1] neg_lo:[1,0,0] neg_hi:[1,0,0]
    v_pk_fma_f32 v[74:75], v[168:169], v[158:159], v[74:75] op_sel_hi:[0,1,1] neg_lo:[1,0,0] neg_hi:[1,0,0]
    v_pk_mul_f32 v[226:227], v[72:73], v[72:73]
    v_pk_mul_f32 v[228:229], v[74:75], v[74:75]
    v_pk_fma_f32 v[226:227], v[226:227], v[170:171], v[170:171] op_sel:[0,1,0] op_sel_hi:[1,1,0]
    v_pk_fma_f32 v[228:229], v[228:229], v[170:171], v[170:171] op_sel:[0,1,0] op_sel_hi:[1,1,0]
    v_pk_mul_f32 v[226:227], v[226:227], v[72:73]
    v_pk_mul_f32 v[228:229], v[228:229], v[74:75]
    v_exp_f32 v226, v226
    v_exp_f32 v227, v227
    v_exp_f32 v228, v228
    v_exp_f32 v229, v229
    v_pk_fma_f32 v[226:227], v[226:227], v[168:169], v[168:169] op_sel:[0,1,1] op_sel_hi:[1,1,1]
    v_pk_fma_f32 v[228:229], v[228:229], v[168:169], v[168:169] op_sel:[0,1,1] op_sel_hi:[1,1,1]
    v_rcp_f32 v226, v226
    v_rcp_f32 v227, v227
    v_rcp_f32 v228, v228
    v_rcp_f32 v229, v229
    v_pk_mul_f32 v[72:73], v[72:73], v[226:227]
    v_pk_mul_f32 v[74:75], v[74:75], v[228:229]
    v_pk_fma_f32 v[76:77], v[168:169], v[160:161], v[76:77] op_sel_hi:[0,1,1] neg_lo:[1,0,0] neg_hi:[1,0,0]
    v_pk_fma_f32 v[78:79], v[168:169], v[162:163], v[78:79] op_sel_hi:[0,1,1] neg_lo:[1,0,0] neg_hi:[1,0,0]
    v_pk_mul_f32 v[226:227], v[76:77], v[76:77]
    v_pk_mul_f32 v[228:229], v[78:79], v[78:79]
    v_pk_fma_f32 v[226:227], v[226:227], v[170:171], v[170:171] op_sel:[0,1,0] op_sel_hi:[1,1,0]
    v_pk_fma_f32 v[228:229], v[228:229], v[170:171], v[170:171] op_sel:[0,1,0] op_sel_hi:[1,1,0]
    v_pk_mul_f32 v[226:227], v[226:227], v[76:77]
    v_pk_mul_f32 v[228:229], v[228:229], v[78:79]
    v_exp_f32 v226, v226
    v_exp_f32 v227, v227
    v_exp_f32 v228, v228
    v_exp_f32 v229, v229
    v_pk_fma_f32 v[226:227], v[226:227], v[168:169], v[168:169] op_sel:[0,1,1] op_sel_hi:[1,1,1]
    v_pk_fma_f32 v[228:229], v[228:229], v[168:169], v[168:169] op_sel:[0,1,1] op_sel_hi:[1,1,1]
    v_rcp_f32 v226, v226
    v_rcp_f32 v227, v227
    v_rcp_f32 v228, v228
    v_rcp_f32 v229, v229
    v_pk_mul_f32 v[76:77], v[76:77], v[226:227]
    v_pk_mul_f32 v[78:79], v[78:79], v[228:229]
    v_cvt_pk_bf16_f32 v204, v72, v73
    v_cvt_pk_bf16_f32 v205, v74, v75
    v_cvt_pk_bf16_f32 v206, v76, v77
    v_cvt_pk_bf16_f32 v207, v78, v79
    v_or_b32 v204, 1, v204
    ds_write_b128 v244, v[204:207] offset:34816
    v_pk_fma_f32 v[100:101], v[172:173], v[156:157], v[100:101] op_sel_hi:[0,1,1] neg_lo:[1,0,0] neg_hi:[1,0,0]
    v_pk_fma_f32 v[102:103], v[172:173], v[158:159], v[102:103] op_sel_hi:[0,1,1] neg_lo:[1,0,0] neg_hi:[1,0,0]
    v_pk_mul_f32 v[226:227], v[100:101], v[100:101]
    v_pk_mul_f32 v[228:229], v[102:103], v[102:103]
    v_pk_fma_f32 v[226:227], v[226:227], v[174:175], v[174:175] op_sel:[0,1,0] op_sel_hi:[1,1,0]
    v_pk_fma_f32 v[228:229], v[228:229], v[174:175], v[174:175] op_sel:[0,1,0] op_sel_hi:[1,1,0]
    v_pk_mul_f32 v[226:227], v[226:227], v[100:101]
    v_pk_mul_f32 v[228:229], v[228:229], v[102:103]
    v_exp_f32 v226, v226
    v_exp_f32 v227, v227
    v_exp_f32 v228, v228
    v_exp_f32 v229, v229
    v_pk_fma_f32 v[226:227], v[226:227], v[172:173], v[172:173] op_sel:[0,1,1] op_sel_hi:[1,1,1]
    v_pk_fma_f32 v[228:229], v[228:229], v[172:173], v[172:173] op_sel:[0,1,1] op_sel_hi:[1,1,1]
    v_rcp_f32 v226, v226
    v_rcp_f32 v227, v227
    v_rcp_f32 v228, v228
    v_rcp_f32 v229, v229
    v_pk_mul_f32 v[100:101], v[100:101], v[226:227]
    v_pk_mul_f32 v[102:103], v[102:103], v[228:229]
    v_pk_fma_f32 v[104:105], v[172:173], v[160:161], v[104:105] op_sel_hi:[0,1,1] neg_lo:[1,0,0] neg_hi:[1,0,0]
    v_pk_fma_f32 v[106:107], v[172:173], v[162:163], v[106:107] op_sel_hi:[0,1,1] neg_lo:[1,0,0] neg_hi:[1,0,0]
    v_pk_mul_f32 v[226:227], v[104:105], v[104:105]
    v_pk_mul_f32 v[228:229], v[106:107], v[106:107]
    v_pk_fma_f32 v[226:227], v[226:227], v[174:175], v[174:175] op_sel:[0,1,0] op_sel_hi:[1,1,0]
    v_pk_fma_f32 v[228:229], v[228:229], v[174:175], v[174:175] op_sel:[0,1,0] op_sel_hi:[1,1,0]
    v_pk_mul_f32 v[226:227], v[226:227], v[104:105]
    v_pk_mul_f32 v[228:229], v[228:229], v[106:107]
    v_exp_f32 v226, v226
    v_exp_f32 v227, v227
    v_exp_f32 v228, v228
    v_exp_f32 v229, v229
    v_pk_fma_f32 v[226:227], v[226:227], v[172:173], v[172:173] op_sel:[0,1,1] op_sel_hi:[1,1,1]
    v_pk_fma_f32 v[228:229], v[228:229], v[172:173], v[172:173] op_sel:[0,1,1] op_sel_hi:[1,1,1]
    v_rcp_f32 v226, v226
    v_rcp_f32 v227, v227
    v_rcp_f32 v228, v228
    v_rcp_f32 v229, v229
    v_pk_mul_f32 v[104:105], v[104:105], v[226:227]
    v_pk_mul_f32 v[106:107], v[106:107], v[228:229]
    v_cvt_pk_bf16_f32 v208, v100, v101
    v_cvt_pk_bf16_f32 v209, v102, v103
    v_cvt_pk_bf16_f32 v210, v104, v105
    v_cvt_pk_bf16_f32 v211, v106, v107
    v_or_b32 v208, 1, v208
    ds_write_b128 v244, v[208:211] offset:36864
    v_pk_fma_f32 v[128:129], v[176:177], v[156:157], v[128:129] op_sel_hi:[0,1,1] neg_lo:[1,0,0] neg_hi:[1,0,0]
    v_pk_fma_f32 v[130:131], v[176:177], v[158:159], v[130:131] op_sel_hi:[0,1,1] neg_lo:[1,0,0] neg_hi:[1,0,0]
    v_pk_mul_f32 v[226:227], v[128:129], v[128:129]
    v_pk_mul_f32 v[228:229], v[130:131], v[130:131]
    v_pk_fma_f32 v[226:227], v[226:227], v[178:179], v[178:179] op_sel:[0,1,0] op_sel_hi:[1,1,0]
    v_pk_fma_f32 v[228:229], v[228:229], v[178:179], v[178:179] op_sel:[0,1,0] op_sel_hi:[1,1,0]
    v_pk_mul_f32 v[226:227], v[226:227], v[128:129]
    v_pk_mul_f32 v[228:229], v[228:229], v[130:131]
    v_exp_f32 v226, v226
    v_exp_f32 v227, v227
    v_exp_f32 v228, v228
    v_exp_f32 v229, v229
    v_pk_fma_f32 v[226:227], v[226:227], v[176:177], v[176:177] op_sel:[0,1,1] op_sel_hi:[1,1,1]
    v_pk_fma_f32 v[228:229], v[228:229], v[176:177], v[176:177] op_sel:[0,1,1] op_sel_hi:[1,1,1]
    v_rcp_f32 v226, v226
    v_rcp_f32 v227, v227
    v_rcp_f32 v228, v228
    v_rcp_f32 v229, v229
    v_pk_mul_f32 v[128:129], v[128:129], v[226:227]
    v_pk_mul_f32 v[130:131], v[130:131], v[228:229]
    v_pk_fma_f32 v[132:133], v[176:177], v[160:161], v[132:133] op_sel_hi:[0,1,1] neg_lo:[1,0,0] neg_hi:[1,0,0]
    v_pk_fma_f32 v[134:135], v[176:177], v[162:163], v[134:135] op_sel_hi:[0,1,1] neg_lo:[1,0,0] neg_hi:[1,0,0]
    v_pk_mul_f32 v[226:227], v[132:133], v[132:133]
    v_pk_mul_f32 v[228:229], v[134:135], v[134:135]
    v_pk_fma_f32 v[226:227], v[226:227], v[178:179], v[178:179] op_sel:[0,1,0] op_sel_hi:[1,1,0]
    v_pk_fma_f32 v[228:229], v[228:229], v[178:179], v[178:179] op_sel:[0,1,0] op_sel_hi:[1,1,0]
    v_pk_mul_f32 v[226:227], v[226:227], v[132:133]
    v_pk_mul_f32 v[228:229], v[228:229], v[134:135]
    v_exp_f32 v226, v226
    v_exp_f32 v227, v227
    v_exp_f32 v228, v228
    v_exp_f32 v229, v229
    v_pk_fma_f32 v[226:227], v[226:227], v[176:177], v[176:177] op_sel:[0,1,1] op_sel_hi:[1,1,1]
    v_pk_fma_f32 v[228:229], v[228:229], v[176:177], v[176:177] op_sel:[0,1,1] op_sel_hi:[1,1,1]
    v_rcp_f32 v226, v226
    v_rcp_f32 v227, v227
    v_rcp_f32 v228, v228
    v_rcp_f32 v229, v229
    v_pk_mul_f32 v[132:133], v[132:133], v[226:227]
    v_pk_mul_f32 v[134:135], v[134:135], v[228:229]
    v_cvt_pk_bf16_f32 v212, v128, v129
    v_cvt_pk_bf16_f32 v213, v130, v131
    v_cvt_pk_bf16_f32 v214, v132, v133
    v_cvt_pk_bf16_f32 v215, v134, v135
    ds_write_b128 v244, v[212:215] offset:38912
    v_pk_fma_f32 v[24:25], v[164:165], v[136:137], v[24:25] op_sel_hi:[0,1,1] neg_lo:[1,0,0] neg_hi:[1,0,0]
    v_pk_fma_f32 v[26:27], v[164:165], v[138:139], v[26:27] op_sel_hi:[0,1,1] neg_lo:[1,0,0] neg_hi:[1,0,0]
    v_pk_mul_f32 v[226:227], v[24:25], v[24:25]
    v_pk_mul_f32 v[228:229], v[26:27], v[26:27]
    v_pk_fma_f32 v[226:227], v[226:227], v[166:167], v[166:167] op_sel:[0,1,0] op_sel_hi:[1,1,0]
    v_pk_fma_f32 v[228:229], v[228:229], v[166:167], v[166:167] op_sel:[0,1,0] op_sel_hi:[1,1,0]
    v_pk_mul_f32 v[226:227], v[226:227], v[24:25]
    v_pk_mul_f32 v[228:229], v[228:229], v[26:27]
    v_exp_f32 v226, v226
    v_exp_f32 v227, v227
    v_exp_f32 v228, v228
    v_exp_f32 v229, v229
    v_pk_fma_f32 v[226:227], v[226:227], v[164:165], v[164:165] op_sel:[0,1,1] op_sel_hi:[1,1,1]
    v_pk_fma_f32 v[228:229], v[228:229], v[164:165], v[164:165] op_sel:[0,1,1] op_sel_hi:[1,1,1]
    v_rcp_f32 v226, v226
    v_rcp_f32 v227, v227
    v_rcp_f32 v228, v228
    v_rcp_f32 v229, v229
    v_pk_mul_f32 v[24:25], v[24:25], v[226:227]
    v_pk_mul_f32 v[26:27], v[26:27], v[228:229]
    v_cvt_pk_bf16_f32 v216, v24, v25
    v_cvt_pk_bf16_f32 v217, v26, v27
    v_or_b32 v216, 1, v216
    s_add_u32 s36, s46, 0
    buffer_store_dwordx4 v[36:39], v2, s[16:19], s36 offen sc1
    v_pk_fma_f32 v[52:53], v[168:169], v[136:137], v[52:53] op_sel_hi:[0,1,1] neg_lo:[1,0,0] neg_hi:[1,0,0]
    v_pk_fma_f32 v[54:55], v[168:169], v[138:139], v[54:55] op_sel_hi:[0,1,1] neg_lo:[1,0,0] neg_hi:[1,0,0]
    v_pk_mul_f32 v[226:227], v[52:53], v[52:53]
    v_pk_mul_f32 v[228:229], v[54:55], v[54:55]
    v_pk_fma_f32 v[226:227], v[226:227], v[170:171], v[170:171] op_sel:[0,1,0] op_sel_hi:[1,1,0]
    v_pk_fma_f32 v[228:229], v[228:229], v[170:171], v[170:171] op_sel:[0,1,0] op_sel_hi:[1,1,0]
    v_pk_mul_f32 v[226:227], v[226:227], v[52:53]
    v_pk_mul_f32 v[228:229], v[228:229], v[54:55]
    v_exp_f32 v226, v226
    v_exp_f32 v227, v227
    v_exp_f32 v228, v228
    v_exp_f32 v229, v229
    v_pk_fma_f32 v[226:227], v[226:227], v[168:169], v[168:169] op_sel:[0,1,1] op_sel_hi:[1,1,1]
    v_pk_fma_f32 v[228:229], v[228:229], v[168:169], v[168:169] op_sel:[0,1,1] op_sel_hi:[1,1,1]
    v_rcp_f32 v226, v226
    v_rcp_f32 v227, v227
    v_rcp_f32 v228, v228
    v_rcp_f32 v229, v229
    v_pk_mul_f32 v[52:53], v[52:53], v[226:227]
    v_pk_mul_f32 v[54:55], v[54:55], v[228:229]
    v_cvt_pk_bf16_f32 v218, v52, v53
    v_cvt_pk_bf16_f32 v219, v54, v55
    v_or_b32 v218, 1, v218
    s_add_u32 s36, s46, 229376
    buffer_store_dwordx4 v[64:67], v2, s[16:19], s36 offen sc1
    v_pk_fma_f32 v[80:81], v[172:173], v[136:137], v[80:81] op_sel_hi:[0,1,1] neg_lo:[1,0,0] neg_hi:[1,0,0]
    v_pk_fma_f32 v[82:83], v[172:173], v[138:139], v[82:83] op_sel_hi:[0,1,1] neg_lo:[1,0,0] neg_hi:[1,0,0]
    v_pk_mul_f32 v[226:227], v[80:81], v[80:81]
    v_pk_mul_f32 v[228:229], v[82:83], v[82:83]
    v_pk_fma_f32 v[226:227], v[226:227], v[174:175], v[174:175] op_sel:[0,1,0] op_sel_hi:[1,1,0]
    v_pk_fma_f32 v[228:229], v[228:229], v[174:175], v[174:175] op_sel:[0,1,0] op_sel_hi:[1,1,0]
    v_pk_mul_f32 v[226:227], v[226:227], v[80:81]
    v_pk_mul_f32 v[228:229], v[228:229], v[82:83]
    v_exp_f32 v226, v226
    v_exp_f32 v227, v227
    v_exp_f32 v228, v228
    v_exp_f32 v229, v229
    v_pk_fma_f32 v[226:227], v[226:227], v[172:173], v[172:173] op_sel:[0,1,1] op_sel_hi:[1,1,1]
    v_pk_fma_f32 v[228:229], v[228:229], v[172:173], v[172:173] op_sel:[0,1,1] op_sel_hi:[1,1,1]
    v_rcp_f32 v226, v226
    v_rcp_f32 v227, v227
    v_rcp_f32 v228, v228
    v_rcp_f32 v229, v229
    v_pk_mul_f32 v[80:81], v[80:81], v[226:227]
    v_pk_mul_f32 v[82:83], v[82:83], v[228:229]
    v_cvt_pk_bf16_f32 v220, v80, v81
    v_cvt_pk_bf16_f32 v221, v82, v83
    v_or_b32 v220, 1, v220
    s_add_u32 s36, s46, 458752
    buffer_store_dwordx4 v[92:95], v2, s[16:19], s36 offen sc1
    v_pk_fma_f32 v[108:109], v[176:177], v[136:137], v[108:109] op_sel_hi:[0,1,1] neg_lo:[1,0,0] neg_hi:[1,0,0]
    v_pk_fma_f32 v[110:111], v[176:177], v[138:139], v[110:111] op_sel_hi:[0,1,1] neg_lo:[1,0,0] neg_hi:[1,0,0]
    v_pk_mul_f32 v[226:227], v[108:109], v[108:109]
    v_pk_mul_f32 v[228:229], v[110:111], v[110:111]
    v_pk_fma_f32 v[226:227], v[226:227], v[178:179], v[178:179] op_sel:[0,1,0] op_sel_hi:[1,1,0]
    v_pk_fma_f32 v[228:229], v[228:229], v[178:179], v[178:179] op_sel:[0,1,0] op_sel_hi:[1,1,0]
    v_pk_mul_f32 v[226:227], v[226:227], v[108:109]
    v_pk_mul_f32 v[228:229], v[228:229], v[110:111]
    v_exp_f32 v226, v226
    v_exp_f32 v227, v227
    v_exp_f32 v228, v228
    v_exp_f32 v229, v229
    v_pk_fma_f32 v[226:227], v[226:227], v[176:177], v[176:177] op_sel:[0,1,1] op_sel_hi:[1,1,1]
    v_pk_fma_f32 v[228:229], v[228:229], v[176:177], v[176:177] op_sel:[0,1,1] op_sel_hi:[1,1,1]
    v_rcp_f32 v226, v226
    v_rcp_f32 v227, v227
    v_rcp_f32 v228, v228
    v_rcp_f32 v229, v229
    v_pk_mul_f32 v[108:109], v[108:109], v[226:227]
    v_pk_mul_f32 v[110:111], v[110:111], v[228:229]
    v_cvt_pk_bf16_f32 v222, v108, v109
    v_cvt_pk_bf16_f32 v223, v110, v111
    s_add_u32 s36, s46, 688128
    buffer_store_dwordx4 v[120:123], v2, s[16:19], s36 offen sc1
    s_waitcnt lgkmcnt(0)
    s_add_u32 s45, s44, 512
    s_mov_b32 s44, s47
G3_e2:
    s_waitcnt lgkmcnt(0)
    s_barrier
    ds_read_b128 v[88:91], v17 offset:0
    ds_read_b128 v[92:95], v17 offset:2048
    ds_read_b128 v[96:99], v17 offset:4096
    ds_read_b128 v[100:103], v17 offset:6144
    ds_read_b64_tr_b16 v[104:105], v18 offset:0
    ds_read_b64_tr_b16 v[106:107], v18 offset:4096
    ds_read_b64_tr_b16 v[108:109], v19 offset:0
    ds_read_b64_tr_b16 v[110:111], v19 offset:4096
    ds_read_b64_tr_b16 v[112:113], v20 offset:0
    ds_read_b64_tr_b16 v[114:115], v20 offset:4096
    ds_read_b64_tr_b16 v[116:117], v21 offset:0
    ds_read_b64_tr_b16 v[118:119], v21 offset:4096
    s_waitcnt lgkmcnt(6)
    v_mfma_f32_16x16x32_bf16 v[24:27], v[104:107], v[88:91], 0
    ds_read_b128 v[120:123], v17 offset:1024
    s_add_u32 s42, s42, 16384
    v_mfma_f32_16x16x32_bf16 v[40:43], v[104:107], v[92:95], 0
    ds_read_b128 v[124:127], v17 offset:3072
    s_cmp_eq_u32 s42, 49152
    v_mfma_f32_16x16x32_bf16 v[56:59], v[104:107], v[96:99], 0
    ds_read_b128 v[128:131], v17 offset:5120
    s_cselect_b32 s42, 0, s42
    v_mfma_f32_16x16x32_bf16 v[72:75], v[104:107], v[100:103], 0
    ds_read_b128 v[132:135], v17 offset:7168
    s_waitcnt lgkmcnt(8)
    v_mfma_f32_16x16x32_bf16 v[76:79], v[108:111], v[100:103], 0
    ds_read_b64_tr_b16 v[136:137], v18 offset:8192
    s_add_u32 s48, s48, 16384
    v_mfma_f32_16x16x32_bf16 v[60:63], v[108:111], v[96:99], 0
    ds_read_b64_tr_b16 v[138:139], v18 offset:12288
    s_cmp_eq_u32 s48, 98304
    v_mfma_f32_16x16x32_bf16 v[44:47], v[108:111], v[92:95], 0
    ds_read_b64_tr_b16 v[140:141], v19 offset:8192
    s_cselect_b32 s48, 0, s48
    v_mfma_f32_16x16x32_bf16 v[28:31], v[108:111], v[88:91], 0
    ds_read_b64_tr_b16 v[142:143], v19 offset:12288
    s_waitcnt lgkmcnt(8)
    v_mfma_f32_16x16x32_bf16 v[32:35], v[112:115], v[88:91], 0
    ds_read_b64_tr_b16 v[144:145], v20 offset:8192
    v_add_u32 v17, s42, v12
    v_mfma_f32_16x16x32_bf16 v[48:51], v[112:115], v[92:95], 0
    ds_read_b64_tr_b16 v[146:147], v20 offset:12288
    s_add_u32 s36, s44, 0
    v_mfma_f32_16x16x32_bf16 v[64:67], v[112:115], v[96:99], 0
    ds_read_b64_tr_b16 v[148:149], v21 offset:8192
    buffer_store_dwordx4 v[200:203], v2, s[16:19], s36 offen sc1
    v_mfma_f32_16x16x32_bf16 v[80:83], v[112:115], v[100:103], 0
    ds_read_b64_tr_b16 v[150:151], v21 offset:12288
    s_add_u32 s36, s45, 0
    v_mfma_f32_16x16x32_bf16 v[84:87], v[116:119], v[100:103], 0
    buffer_store_dwordx2 v[216:217], v238, s[16:19], s36 offen sc1
    v_add_u32 v18, s48, v13
    v_mfma_f32_16x16x32_bf16 v[68:71], v[116:119], v[96:99], 0
    v_add_u32 v19, s48, v14
    v_mfma_f32_16x16x32_bf16 v[52:55], v[116:119], v[92:95], 0
    v_add_u32 v20, s48, v15
    v_mfma_f32_16x16x32_bf16 v[36:39], v[116:119], v[88:91], 0
    v_add_u32 v21, s48, v16
    s_waitcnt lgkmcnt(6)
    v_mfma_f32_16x16x32_bf16 v[24:27], v[136:139], v[120:123], v[24:27]
    v_mfma_f32_16x16x32_bf16 v[40:43], v[136:139], v[124:127], v[40:43]
    v_mfma_f32_16x16x32_bf16 v[56:59], v[136:139], v[128:131], v[56:59]
    s_waitcnt lgkmcnt(0)
    s_barrier
    v_mfma_f32_16x16x32_bf16 v[72:75], v[136:139], v[132:135], v[72:75]
    ds_read_b128 v[88:91], v17 offset:0
    s_add_u32 s36, s44, 229376
    v_mfma_f32_16x16x32_bf16 v[76:79], v[140:143], v[132:135], v[76:79]
    ds_read_b128 v[92:95], v17 offset:2048
    buffer_store_dwordx4 v[204:207], v2, s[16:19], s36 offen sc1
    v_mfma_f32_16x16x32_bf16 v[60:63], v[140:143], v[128:131], v[60:63]
    ds_read_b128 v[96:99], v17 offset:4096
    s_add_u32 s36, s45, 229376
    v_mfma_f32_16x16x32_bf16 v[44:47], v[140:143], v[124:127], v[44:47]
    ds_read_b128 v[100:103], v17 offset:6144
    buffer_store_dwordx2 v[218:219], v238, s[16:19], s36 offen sc1
    v_mfma_f32_16x16x32_bf16 v[28:31], v[140:143], v[120:123], v[28:31]
    ds_read_b64_tr_b16 v[104:105], v18 offset:0
    s_add_u32 s43, s43, 1
    v_mfma_f32_16x16x32_bf16 v[32:35], v[144:147], v[120:123], v[32:35]
    ds_read_b64_tr_b16 v[106:107], v18 offset:4096
    s_cmp_lt_u32 s43, 27
    v_mfma_f32_16x16x32_bf16 v[48:51], v[144:147], v[124:127], v[48:51]
    ds_read_b64_tr_b16 v[108:109], v19 offset:0
    v_mfma_f32_16x16x32_bf16 v[64:67], v[144:147], v[128:131], v[64:67]
    ds_read_b64_tr_b16 v[110:111], v19 offset:4096
    v_mfma_f32_16x16x32_bf16 v[80:83], v[144:147], v[132:135], v[80:83]
    ds_read_b64_tr_b16 v[112:113], v20 offset:0
    v_mfma_f32_16x16x32_bf16 v[84:87], v[148:151], v[132:135], v[84:87]
    ds_read_b64_tr_b16 v[114:115], v20 offset:4096
    v_mfma_f32_16x16x32_bf16 v[68:71], v[148:151], v[128:131], v[68:71]
    ds_read_b64_tr_b16 v[116:117], v21 offset:0
    v_mfma_f32_16x16x32_bf16 v[52:55], v[148:151], v[124:127], v[52:55]
    ds_read_b64_tr_b16 v[118:119], v21 offset:4096
    v_mfma_f32_16x16x32_bf16 v[36:39], v[148:151], v[120:123], v[36:39]
    s_waitcnt lgkmcnt(6)
    v_mfma_f32_16x16x32_bf16 v[24:27], v[104:107], v[88:91], v[24:27]
    ds_read_b128 v[120:123], v17 offset:1024
    s_add_u32 s42, s42, 16384
    v_mfma_f32_16x16x32_bf16 v[40:43], v[104:107], v[92:95], v[40:43]
    ds_read_b128 v[124:127], v17 offset:3072
    s_cmp_eq_u32 s42, 49152
    v_mfma_f32_16x16x32_bf16 v[56:59], v[104:107], v[96:99], v[56:59]
    ds_read_b128 v[128:131], v17 offset:5120
    s_cselect_b32 s42, 0, s42
    v_mfma_f32_16x16x32_bf16 v[72:75], v[104:107], v[100:103], v[72:75]
    ds_read_b128 v[132:135], v17 offset:7168
    s_waitcnt lgkmcnt(8)
    v_mfma_f32_16x16x32_bf16 v[76:79], v[108:111], v[100:103], v[76:79]
    ds_read_b64_tr_b16 v[136:137], v18 offset:8192
    s_add_u32 s48, s48, 16384
    v_mfma_f32_16x16x32_bf16 v[60:63], v[108:111], v[96:99], v[60:63]
    ds_read_b64_tr_b16 v[138:139], v18 offset:12288
    s_cmp_eq_u32 s48, 98304
    v_mfma_f32_16x16x32_bf16 v[44:47], v[108:111], v[92:95], v[44:47]
    ds_read_b64_tr_b16 v[140:141], v19 offset:8192
    s_cselect_b32 s48, 0, s48
    v_mfma_f32_16x16x32_bf16 v[28:31], v[108:111], v[88:91], v[28:31]
    ds_read_b64_tr_b16 v[142:143], v19 offset:12288
    s_waitcnt lgkmcnt(8)
    v_mfma_f32_16x16x32_bf16 v[32:35], v[112:115], v[88:91], v[32:35]
    ds_read_b64_tr_b16 v[144:145], v20 offset:8192
    v_add_u32 v17, s42, v12
    v_mfma_f32_16x16x32_bf16 v[48:51], v[112:115], v[92:95], v[48:51]
    ds_read_b64_tr_b16 v[146:147], v20 offset:12288
    s_add_u32 s36, s44, 458752
    v_mfma_f32_16x16x32_bf16 v[64:67], v[112:115], v[96:99], v[64:67]
    ds_read_b64_tr_b16 v[148:149], v21 offset:8192
    buffer_store_dwordx4 v[208:211], v2, s[16:19], s36 offen sc1
    v_mfma_f32_16x16x32_bf16 v[80:83], v[112:115], v[100:103], v[80:83]
    ds_read_b64_tr_b16 v[150:151], v21 offset:12288
    s_add_u32 s36, s45, 458752
    v_mfma_f32_16x16x32_bf16 v[84:87], v[116:119], v[100:103], v[84:87]
    buffer_store_dwordx2 v[220:221], v238, s[16:19], s36 offen sc1
    v_add_u32 v18, s48, v13
    v_mfma_f32_16x16x32_bf16 v[68:71], v[116:119], v[96:99], v[68:71]
    v_add_u32 v19, s48, v14
    v_mfma_f32_16x16x32_bf16 v[52:55], v[116:119], v[92:95], v[52:55]
    v_add_u32 v20, s48, v15
    v_mfma_f32_16x16x32_bf16 v[36:39], v[116:119], v[88:91], v[36:39]
    v_add_u32 v21, s48, v16
    s_waitcnt lgkmcnt(6)
    v_mfma_f32_16x16x32_bf16 v[24:27], v[136:139], v[120:123], v[24:27]
    v_mfma_f32_16x16x32_bf16 v[40:43], v[136:139], v[124:127], v[40:43]
    s_waitcnt vmcnt(6)
    v_mfma_f32_16x16x32_bf16 v[56:59], v[136:139], v[128:131], v[56:59]
    s_waitcnt lgkmcnt(0)
    s_barrier
    v_mfma_f32_16x16x32_bf16 v[72:75], v[136:139], v[132:135], v[72:75]
    ds_read_b128 v[88:91], v17 offset:0
    s_add_u32 s36, s44, 688128
    v_mfma_f32_16x16x32_bf16 v[76:79], v[140:143], v[132:135], v[76:79]
    ds_read_b128 v[92:95], v17 offset:2048
    buffer_store_dwordx4 v[212:215], v2, s[16:19], s36 offen sc1
    v_mfma_f32_16x16x32_bf16 v[60:63], v[140:143], v[128:131], v[60:63]
    ds_read_b128 v[96:99], v17 offset:4096
    s_add_u32 s36, s45, 688128
    v_mfma_f32_16x16x32_bf16 v[44:47], v[140:143], v[124:127], v[44:47]
    ds_read_b128 v[100:103], v17 offset:6144
    buffer_store_dwordx2 v[222:223], v238, s[16:19], s36 offen sc1
    v_mfma_f32_16x16x32_bf16 v[28:31], v[140:143], v[120:123], v[28:31]
    ds_read_b64_tr_b16 v[104:105], v18 offset:0
    s_add_u32 s43, s43, 1
    v_mfma_f32_16x16x32_bf16 v[32:35], v[144:147], v[120:123], v[32:35]
    ds_read_b64_tr_b16 v[106:107], v18 offset:4096
    s_cmp_lt_u32 s43, 27
    v_mfma_f32_16x16x32_bf16 v[48:51], v[144:147], v[124:127], v[48:51]
    ds_read_b64_tr_b16 v[108:109], v19 offset:0
    v_mfma_f32_16x16x32_bf16 v[64:67], v[144:147], v[128:131], v[64:67]
    ds_read_b64_tr_b16 v[110:111], v19 offset:4096
    v_mfma_f32_16x16x32_bf16 v[80:83], v[144:147], v[132:135], v[80:83]
    ds_read_b64_tr_b16 v[112:113], v20 offset:0
    v_mfma_f32_16x16x32_bf16 v[84:87], v[148:151], v[132:135], v[84:87]
    ds_read_b64_tr_b16 v[114:115], v20 offset:4096
    v_mfma_f32_16x16x32_bf16 v[68:71], v[148:151], v[128:131], v[68:71]
    ds_read_b64_tr_b16 v[116:117], v21 offset:0
    v_mfma_f32_16x16x32_bf16 v[52:55], v[148:151], v[124:127], v[52:55]
    ds_read_b64_tr_b16 v[118:119], v21 offset:4096
    v_mfma_f32_16x16x32_bf16 v[36:39], v[148:151], v[120:123], v[36:39]
    s_waitcnt lgkmcnt(6)
mm_27:
    v_mfma_f32_16x16x32_bf16 v[24:27], v[104:107], v[88:91], v[24:27]
    ds_read_b128 v[120:123], v17 offset:1024
    s_add_u32 s42, s42, 16384
    v_mfma_f32_16x16x32_bf16 v[40:43], v[104:107], v[92:95], v[40:43]
    ds_read_b128 v[124:127], v17 offset:3072
    s_cmp_eq_u32 s42, 49152
    v_mfma_f32_16x16x32_bf16 v[56:59], v[104:107], v[96:99], v[56:59]
    ds_read_b128 v[128:131], v17 offset:5120
    s_cselect_b32 s42, 0, s42
    v_mfma_f32_16x16x32_bf16 v[72:75], v[104:107], v[100:103], v[72:75]
    ds_read_b128 v[132:135], v17 offset:7168
    s_waitcnt lgkmcnt(8)
    v_mfma_f32_16x16x32_bf16 v[76:79], v[108:111], v[100:103], v[76:79]
    ds_read_b64_tr_b16 v[136:137], v18 offset:8192
    s_add_u32 s48, s48, 16384
    v_mfma_f32_16x16x32_bf16 v[60:63], v[108:111], v[96:99], v[60:63]
    ds_read_b64_tr_b16 v[138:139], v18 offset:12288
    s_cmp_eq_u32 s48, 98304
    v_mfma_f32_16x16x32_bf16 v[44:47], v[108:111], v[92:95], v[44:47]
    ds_read_b64_tr_b16 v[140:141], v19 offset:8192
    s_cselect_b32 s48, 0, s48
    v_mfma_f32_16x16x32_bf16 v[28:31], v[108:111], v[88:91], v[28:31]
    ds_read_b64_tr_b16 v[142:143], v19 offset:12288
    s_waitcnt lgkmcnt(8)
    v_mfma_f32_16x16x32_bf16 v[32:35], v[112:115], v[88:91], v[32:35]
    ds_read_b64_tr_b16 v[144:145], v20 offset:8192
    v_add_u32 v17, s42, v12
    v_mfma_f32_16x16x32_bf16 v[48:51], v[112:115], v[92:95], v[48:51]
    ds_read_b64_tr_b16 v[146:147], v20 offset:12288
    v_add_u32 v18, s48, v13
    v_mfma_f32_16x16x32_bf16 v[64:67], v[112:115], v[96:99], v[64:67]
    ds_read_b64_tr_b16 v[148:149], v21 offset:8192
    v_add_u32 v19, s48, v14
    v_mfma_f32_16x16x32_bf16 v[80:83], v[112:115], v[100:103], v[80:83]
    ds_read_b64_tr_b16 v[150:151], v21 offset:12288
    v_add_u32 v20, s48, v15
    v_mfma_f32_16x16x32_bf16 v[84:87], v[116:119], v[100:103], v[84:87]
    v_add_u32 v21, s48, v16
    v_mfma_f32_16x16x32_bf16 v[68:71], v[116:119], v[96:99], v[68:71]
    v_mfma_f32_16x16x32_bf16 v[52:55], v[116:119], v[92:95], v[52:55]
    v_mfma_f32_16x16x32_bf16 v[36:39], v[116:119], v[88:91], v[36:39]
    s_waitcnt lgkmcnt(6)
    v_mfma_f32_16x16x32_bf16 v[24:27], v[136:139], v[120:123], v[24:27]
    s_add_u32 s43, s43, 1
    s_cmp_lt_u32 s43, 4
    v_mfma_f32_16x16x32_bf16 v[40:43], v[136:139], v[124:127], v[40:43]
    v_mfma_f32_16x16x32_bf16 v[56:59], v[136:139], v[128:131], v[56:59]
    s_waitcnt lgkmcnt(0)
    s_barrier
    v_mfma_f32_16x16x32_bf16 v[72:75], v[136:139], v[132:135], v[72:75]
    ds_read_b128 v[88:91], v17 offset:0
    v_mfma_f32_16x16x32_bf16 v[76:79], v[140:143], v[132:135], v[76:79]
    ds_read_b128 v[92:95], v17 offset:2048
    v_mfma_f32_16x16x32_bf16 v[60:63], v[140:143], v[128:131], v[60:63]
    ds_read_b128 v[96:99], v17 offset:4096
    v_mfma_f32_16x16x32_bf16 v[44:47], v[140:143], v[124:127], v[44:47]
    ds_read_b128 v[100:103], v17 offset:6144
    v_mfma_f32_16x16x32_bf16 v[28:31], v[140:143], v[120:123], v[28:31]
    ds_read_b64_tr_b16 v[104:105], v18 offset:0
    v_mfma_f32_16x16x32_bf16 v[32:35], v[144:147], v[120:123], v[32:35]
    ds_read_b64_tr_b16 v[106:107], v18 offset:4096
    v_mfma_f32_16x16x32_bf16 v[48:51], v[144:147], v[124:127], v[48:51]
    ds_read_b64_tr_b16 v[108:109], v19 offset:0
    v_mfma_f32_16x16x32_bf16 v[64:67], v[144:147], v[128:131], v[64:67]
    ds_read_b64_tr_b16 v[110:111], v19 offset:4096
    v_mfma_f32_16x16x32_bf16 v[80:83], v[144:147], v[132:135], v[80:83]
    ds_read_b64_tr_b16 v[112:113], v20 offset:0
    v_mfma_f32_16x16x32_bf16 v[84:87], v[148:151], v[132:135], v[84:87]
    ds_read_b64_tr_b16 v[114:115], v20 offset:4096
    v_mfma_f32_16x16x32_bf16 v[68:71], v[148:151], v[128:131], v[68:71]
    ds_read_b64_tr_b16 v[116:117], v21 offset:0
    v_mfma_f32_16x16x32_bf16 v[52:55], v[148:151], v[124:127], v[52:55]
    ds_read_b64_tr_b16 v[118:119], v21 offset:4096
    v_mfma_f32_16x16x32_bf16 v[36:39], v[148:151], v[120:123], v[36:39]
    s_waitcnt lgkmcnt(6)
    s_cbranch_scc1 mm_27
mm_28:
    v_mfma_f32_16x16x32_bf16 v[24:27], v[104:107], v[88:91], v[24:27]
    ds_read_b128 v[120:123], v17 offset:1024
    s_add_u32 s42, s42, 16384
    v_mfma_f32_16x16x32_bf16 v[40:43], v[104:107], v[92:95], v[40:43]
    ds_read_b128 v[124:127], v17 offset:3072
    s_cmp_eq_u32 s42, 49152
    v_mfma_f32_16x16x32_bf16 v[56:59], v[104:107], v[96:99], v[56:59]
    ds_read_b128 v[128:131], v17 offset:5120
    s_cselect_b32 s42, 0, s42
    v_mfma_f32_16x16x32_bf16 v[72:75], v[104:107], v[100:103], v[72:75]
    ds_read_b128 v[132:135], v17 offset:7168
    s_waitcnt lgkmcnt(8)
    v_mfma_f32_16x16x32_bf16 v[76:79], v[108:111], v[100:103], v[76:79]
    ds_read_b64_tr_b16 v[136:137], v18 offset:8192
    s_add_u32 s48, s48, 16384
    v_mfma_f32_16x16x32_bf16 v[60:63], v[108:111], v[96:99], v[60:63]
    ds_read_b64_tr_b16 v[138:139], v18 offset:12288
    s_cmp_eq_u32 s48, 98304
    v_mfma_f32_16x16x32_bf16 v[44:47], v[108:111], v[92:95], v[44:47]
    ds_read_b64_tr_b16 v[140:141], v19 offset:8192
    s_cselect_b32 s48, 0, s48
    v_mfma_f32_16x16x32_bf16 v[28:31], v[108:111], v[88:91], v[28:31]
    ds_read_b64_tr_b16 v[142:143], v19 offset:12288
    s_waitcnt lgkmcnt(8)
    v_mfma_f32_16x16x32_bf16 v[32:35], v[112:115], v[88:91], v[32:35]
    ds_read_b64_tr_b16 v[144:145], v20 offset:8192
    v_add_u32 v17, s42, v12
    v_mfma_f32_16x16x32_bf16 v[48:51], v[112:115], v[92:95], v[48:51]
    ds_read_b64_tr_b16 v[146:147], v20 offset:12288
    v_add_u32 v18, s48, v13
    v_mfma_f32_16x16x32_bf16 v[64:67], v[112:115], v[96:99], v[64:67]
    ds_read_b64_tr_b16 v[148:149], v21 offset:8192
    v_add_u32 v19, s48, v14
    v_mfma_f32_16x16x32_bf16 v[80:83], v[112:115], v[100:103], v[80:83]
    ds_read_b64_tr_b16 v[150:151], v21 offset:12288
    v_add_u32 v20, s48, v15
    v_mfma_f32_16x16x32_bf16 v[84:87], v[116:119], v[100:103], v[84:87]
    v_add_u32 v21, s48, v16
    v_mfma_f32_16x16x32_bf16 v[68:71], v[116:119], v[96:99], v[68:71]
    v_mfma_f32_16x16x32_bf16 v[52:55], v[116:119], v[92:95], v[52:55]
    v_mfma_f32_16x16x32_bf16 v[36:39], v[116:119], v[88:91], v[36:39]
    s_waitcnt lgkmcnt(6)
    v_mfma_f32_16x16x32_bf16 v[24:27], v[136:139], v[120:123], v[24:27]
    s_add_u32 s43, s43, 1
    s_cmp_lt_u32 s43, 27
    v_mfma_f32_16x16x32_bf16 v[40:43], v[136:139], v[124:127], v[40:43]
    s_waitcnt vmcnt(0)
    v_mfma_f32_16x16x32_bf16 v[56:59], v[136:139], v[128:131], v[56:59]
    s_waitcnt lgkmcnt(0)
    s_barrier
    v_mfma_f32_16x16x32_bf16 v[72:75], v[136:139], v[132:135], v[72:75]
    ds_read_b128 v[88:91], v17 offset:0
    v_mfma_f32_16x16x32_bf16 v[76:79], v[140:143], v[132:135], v[76:79]
    ds_read_b128 v[92:95], v17 offset:2048
    v_mfma_f32_16x16x32_bf16 v[60:63], v[140:143], v[128:131], v[60:63]
    ds_read_b128 v[96:99], v17 offset:4096
    v_mfma_f32_16x16x32_bf16 v[44:47], v[140:143], v[124:127], v[44:47]
    ds_read_b128 v[100:103], v17 offset:6144
    v_mfma_f32_16x16x32_bf16 v[28:31], v[140:143], v[120:123], v[28:31]
    ds_read_b64_tr_b16 v[104:105], v18 offset:0
    v_mfma_f32_16x16x32_bf16 v[32:35], v[144:147], v[120:123], v[32:35]
    ds_read_b64_tr_b16 v[106:107], v18 offset:4096
    v_mfma_f32_16x16x32_bf16 v[48:51], v[144:147], v[124:127], v[48:51]
    ds_read_b64_tr_b16 v[108:109], v19 offset:0
    v_mfma_f32_16x16x32_bf16 v[64:67], v[144:147], v[128:131], v[64:67]
    ds_read_b64_tr_b16 v[110:111], v19 offset:4096
    v_mfma_f32_16x16x32_bf16 v[80:83], v[144:147], v[132:135], v[80:83]
    ds_read_b64_tr_b16 v[112:113], v20 offset:0
    v_mfma_f32_16x16x32_bf16 v[84:87], v[148:151], v[132:135], v[84:87]
    ds_read_b64_tr_b16 v[114:115], v20 offset:4096
    v_mfma_f32_16x16x32_bf16 v[68:71], v[148:151], v[128:131], v[68:71]
    ds_read_b64_tr_b16 v[116:117], v21 offset:0
    v_mfma_f32_16x16x32_bf16 v[52:55], v[148:151], v[124:127], v[52:55]
    ds_read_b64_tr_b16 v[118:119], v21 offset:4096
    v_mfma_f32_16x16x32_bf16 v[36:39], v[148:151], v[120:123], v[36:39]
    s_waitcnt lgkmcnt(6)
    s_cbranch_scc1 mm_28
    s_cmp_eq_u32 s60, 1
    s_cbranch_scc1 G4_last
    v_mfma_f32_16x16x32_bf16 v[24:27], v[104:107], v[88:91], v[24:27]
    ds_read_b128 v[120:123], v17 offset:1024
    v_mfma_f32_16x16x32_bf16 v[40:43], v[104:107], v[92:95], v[40:43]
    ds_read_b128 v[124:127], v17 offset:3072
    v_mfma_f32_16x16x32_bf16 v[56:59], v[104:107], v[96:99], v[56:59]
    ds_read_b128 v[128:131], v17 offset:5120
    v_mfma_f32_16x16x32_bf16 v[72:75], v[104:107], v[100:103], v[72:75]
    ds_read_b128 v[132:135], v17 offset:7168
    s_waitcnt lgkmcnt(8)
    v_mfma_f32_16x16x32_bf16 v[76:79], v[108:111], v[100:103], v[76:79]
    ds_read_b64_tr_b16 v[136:137], v18 offset:8192
    v_mfma_f32_16x16x32_bf16 v[60:63], v[108:111], v[96:99], v[60:63]
    ds_read_b64_tr_b16 v[138:139], v18 offset:12288
    v_mfma_f32_16x16x32_bf16 v[44:47], v[108:111], v[92:95], v[44:47]
    ds_read_b64_tr_b16 v[140:141], v19 offset:8192
    v_mfma_f32_16x16x32_bf16 v[28:31], v[108:111], v[88:91], v[28:31]
    ds_read_b64_tr_b16 v[142:143], v19 offset:12288
    s_waitcnt lgkmcnt(8)
    v_mfma_f32_16x16x32_bf16 v[32:35], v[112:115], v[88:91], v[32:35]
    ds_read_b64_tr_b16 v[144:145], v20 offset:8192
    v_mfma_f32_16x16x32_bf16 v[48:51], v[112:115], v[92:95], v[48:51]
    ds_read_b64_tr_b16 v[146:147], v20 offset:12288
    v_mfma_f32_16x16x32_bf16 v[64:67], v[112:115], v[96:99], v[64:67]
    ds_read_b64_tr_b16 v[148:149], v21 offset:8192
    v_mfma_f32_16x16x32_bf16 v[80:83], v[112:115], v[100:103], v[80:83]
    ds_read_b64_tr_b16 v[150:151], v21 offset:12288
    v_mfma_f32_16x16x32_bf16 v[84:87], v[116:119], v[100:103], v[84:87]
    v_mfma_f32_16x16x32_bf16 v[68:71], v[116:119], v[96:99], v[68:71]
    v_mfma_f32_16x16x32_bf16 v[52:55], v[116:119], v[92:95], v[52:55]
    v_mfma_f32_16x16x32_bf16 v[36:39], v[116:119], v[88:91], v[36:39]
    s_waitcnt lgkmcnt(0)
    v_mfma_f32_16x16x32_bf16 v[24:27], v[136:139], v[120:123], v[24:27]
    s_mul_i32 s36, s31, 524288
    s_add_u32 s36, s36, 0
    s_add_u32 s16, s62, s36
    v_mfma_f32_16x16x32_bf16 v[40:43], v[136:139], v[124:127], v[40:43]
    s_addc_u32 s17, s63, 0
    s_mov_b32 s18, 516096
    s_mov_b32 s19, 0x20000
    v_mfma_f32_16x16x32_bf16 v[56:59], v[136:139], v[128:131], v[56:59]
    v_mfma_f32_16x16x32_bf16 v[72:75], v[136:139], v[132:135], v[72:75]
    v_mfma_f32_16x16x32_bf16 v[76:79], v[140:143], v[132:135], v[76:79]
    v_mfma_f32_16x16x32_bf16 v[60:63], v[140:143], v[128:131], v[60:63]
    v_mfma_f32_16x16x32_bf16 v[44:47], v[140:143], v[124:127], v[44:47]
    v_mfma_f32_16x16x32_bf16 v[28:31], v[140:143], v[120:123], v[28:31]
    v_mfma_f32_16x16x32_bf16 v[32:35], v[144:147], v[120:123], v[32:35]
    v_mfma_f32_16x16x32_bf16 v[48:51], v[144:147], v[124:127], v[48:51]
    v_mfma_f32_16x16x32_bf16 v[64:67], v[144:147], v[128:131], v[64:67]
    v_mfma_f32_16x16x32_bf16 v[80:83], v[144:147], v[132:135], v[80:83]
    v_mfma_f32_16x16x32_bf16 v[84:87], v[148:151], v[132:135], v[84:87]
    v_mfma_f32_16x16x32_bf16 v[68:71], v[148:151], v[128:131], v[68:71]
    v_mfma_f32_16x16x32_bf16 v[52:55], v[148:151], v[124:127], v[52:55]
    v_mfma_f32_16x16x32_bf16 v[36:39], v[148:151], v[120:123], v[36:39]
    s_add_u32 s36, s39, 0
    v_cvt_pk_bf16_f32 v24, v24, v25
    v_cvt_pk_bf16_f32 v25, v26, v27
    v_cvt_pk_bf16_f32 v26, v28, v29
    v_cvt_pk_bf16_f32 v27, v30, v31
    v_or_b32 v24, 1, v24
    buffer_store_dwordx4 v[24:27], v2, s[16:19], s36 offen offset:0 sc1
    v_cvt_pk_bf16_f32 v32, v32, v33
    v_cvt_pk_bf16_f32 v33, v34, v35
    v_cvt_pk_bf16_f32 v34, v36, v37
    v_cvt_pk_bf16_f32 v35, v38, v39
    v_or_b32 v32, 1, v32
    buffer_store_dwordx4 v[32:35], v2, s[16:19], s36 offen offset:1024 sc1
    s_add_u32 s36, s39, 65536
    v_cvt_pk_bf16_f32 v40, v40, v41
    v_cvt_pk_bf16_f32 v41, v42, v43
    v_cvt_pk_bf16_f32 v42, v44, v45
    v_cvt_pk_bf16_f32 v43, v46, v47
    v_or_b32 v40, 1, v40
    buffer_store_dwordx4 v[40:43], v2, s[16:19], s36 offen offset:0 sc1
    v_cvt_pk_bf16_f32 v48, v48, v49
    v_cvt_pk_bf16_f32 v49, v50, v51
    v_cvt_pk_bf16_f32 v50, v52, v53
    v_cvt_pk_bf16_f32 v51, v54, v55
    v_or_b32 v48, 1, v48
    buffer_store_dwordx4 v[48:51], v2, s[16:19], s36 offen offset:1024 sc1
    s_add_u32 s36, s39, 131072
    v_cvt_pk_bf16_f32 v56, v56, v57
    v_cvt_pk_bf16_f32 v57, v58, v59
    v_cvt_pk_bf16_f32 v58, v60, v61
    v_cvt_pk_bf16_f32 v59, v62, v63
    v_or_b32 v56, 1, v56
    buffer_store_dwordx4 v[56:59], v2, s[16:19], s36 offen offset:0 sc1
    v_cvt_pk_bf16_f32 v64, v64, v65
    v_cvt_pk_bf16_f32 v65, v66, v67
    v_cvt_pk_bf16_f32 v66, v68, v69
    v_cvt_pk_bf16_f32 v67, v70, v71
    v_or_b32 v64, 1, v64
    buffer_store_dwordx4 v[64:67], v2, s[16:19], s36 offen offset:1024 sc1
    s_add_u32 s36, s39, 196608
    v_cvt_pk_bf16_f32 v72, v72, v73
    v_cvt_pk_bf16_f32 v73, v74, v75
    v_cvt_pk_bf16_f32 v74, v76, v77
    v_cvt_pk_bf16_f32 v75, v78, v79
    v_or_b32 v72, 1, v72
    buffer_store_dwordx4 v[72:75], v2, s[16:19], s36 offen offset:0 sc1
    v_cvt_pk_bf16_f32 v80, v80, v81
    v_cvt_pk_bf16_f32 v81, v82, v83
    v_cvt_pk_bf16_f32 v82, v84, v85
    v_cvt_pk_bf16_f32 v83, v86, v87
    v_or_b32 v80, 1, v80
    buffer_store_dwordx4 v[80:83], v2, s[16:19], s36 offen offset:1024 sc1
    s_barrier
    s_branch NEXT
G4_last:
    v_mfma_f32_16x16x32_bf16 v[24:27], v[104:107], v[88:91], v[24:27]
    ds_read_b128 v[120:123], v17 offset:1024
    v_mfma_f32_16x16x32_bf16 v[40:43], v[104:107], v[92:95], v[40:43]
    ds_read_b128 v[124:127], v17 offset:3072
    v_mfma_f32_16x16x32_bf16 v[56:59], v[104:107], v[96:99], v[56:59]
    ds_read_b128 v[128:131], v17 offset:5120
    v_mfma_f32_16x16x32_bf16 v[72:75], v[104:107], v[100:103], v[72:75]
    ds_read_b128 v[132:135], v17 offset:7168
    s_waitcnt lgkmcnt(8)
    v_mfma_f32_16x16x32_bf16 v[76:79], v[108:111], v[100:103], v[76:79]
    ds_read_b64_tr_b16 v[136:137], v18 offset:8192
    v_mfma_f32_16x16x32_bf16 v[60:63], v[108:111], v[96:99], v[60:63]
    ds_read_b64_tr_b16 v[138:139], v18 offset:12288
    v_mfma_f32_16x16x32_bf16 v[44:47], v[108:111], v[92:95], v[44:47]
    ds_read_b64_tr_b16 v[140:141], v19 offset:8192
    v_mfma_f32_16x16x32_bf16 v[28:31], v[108:111], v[88:91], v[28:31]
    ds_read_b64_tr_b16 v[142:143], v19 offset:12288
    s_waitcnt lgkmcnt(8)
    v_mfma_f32_16x16x32_bf16 v[32:35], v[112:115], v[88:91], v[32:35]
    ds_read_b64_tr_b16 v[144:145], v20 offset:8192
    v_mfma_f32_16x16x32_bf16 v[48:51], v[112:115], v[92:95], v[48:51]
    ds_read_b64_tr_b16 v[146:147], v20 offset:12288
    s_load_dwordx2 s[6:7], s[0:1], 88
    v_mfma_f32_16x16x32_bf16 v[64:67], v[112:115], v[96:99], v[64:67]
    ds_read_b64_tr_b16 v[148:149], v21 offset:8192
    v_mfma_f32_16x16x32_bf16 v[80:83], v[112:115], v[100:103], v[80:83]
    ds_read_b64_tr_b16 v[150:151], v21 offset:12288
    v_mfma_f32_16x16x32_bf16 v[84:87], v[116:119], v[100:103], v[84:87]
    v_mfma_f32_16x16x32_bf16 v[68:71], v[116:119], v[96:99], v[68:71]
    v_mfma_f32_16x16x32_bf16 v[52:55], v[116:119], v[92:95], v[52:55]
    v_mfma_f32_16x16x32_bf16 v[36:39], v[116:119], v[88:91], v[36:39]
    s_waitcnt lgkmcnt(0)
    v_mfma_f32_16x16x32_bf16 v[24:27], v[136:139], v[120:123], v[24:27]
    s_add_u32 s16, s62, 0x80000
    s_addc_u32 s17, s63, 0
    s_mov_b32 s18, 0x7e000
    v_mfma_f32_16x16x32_bf16 v[40:43], v[136:139], v[124:127], v[40:43]
    s_mov_b32 s19, 0x20000
    s_mov_b32 s20, s6
    s_mov_b32 s21, s7
    v_mfma_f32_16x16x32_bf16 v[56:59], v[136:139], v[128:131], v[56:59]
    s_mov_b32 s22, 0x400000
    s_mov_b32 s23, 0x20000
    s_add_u32 s44, s40, 65536
    v_mfma_f32_16x16x32_bf16 v[72:75], v[136:139], v[132:135], v[72:75]
    s_lshl_b32 s46, s28, 3
    s_add_u32 s46, s46, s37
    s_lshl_b32 s47, s31, 1
    v_mfma_f32_16x16x32_bf16 v[76:79], v[140:143], v[132:135], v[76:79]
    s_add_u32 s46, s46, s47
    s_lshl_b32 s46, s46, 15
    s_lshl_b32 s47, s38, 5
    v_mfma_f32_16x16x32_bf16 v[60:63], v[140:143], v[128:131], v[60:63]
    s_add_u32 s46, s46, s47
    s_add_u32 s47, s46, 32768
    v_and_b32 v225, 1, v23
    v_mfma_f32_16x16x32_bf16 v[44:47], v[140:143], v[124:127], v[44:47]
    v_lshlrev_b32 v224, 11, v22
    v_lshl_add_u32 v224, v225, 5, v224
    v_mfma_f32_16x16x32_bf16 v[28:31], v[140:143], v[120:123], v[28:31]
    v_lshrrev_b32 v225, 1, v23
    v_lshl_add_u32 v224, v225, 4, v224
    v_mfma_f32_16x16x32_bf16 v[32:35], v[144:147], v[120:123], v[32:35]
    v_lshrrev_b32 v225, 3, v22
    v_mul_u32_u24 v225, 16320, v225
    v_mfma_f32_16x16x32_bf16 v[48:51], v[144:147], v[124:127], v[48:51]
    v_sub_u32 v224, v224, v225
    v_add_u32 v225, 16384, v224
    v_mfma_f32_16x16x32_bf16 v[64:67], v[144:147], v[128:131], v[64:67]
    v_mfma_f32_16x16x32_bf16 v[80:83], v[144:147], v[132:135], v[80:83]
    v_mfma_f32_16x16x32_bf16 v[84:87], v[148:151], v[132:135], v[84:87]
    v_mfma_f32_16x16x32_bf16 v[68:71], v[148:151], v[128:131], v[68:71]
    v_mfma_f32_16x16x32_bf16 v[52:55], v[148:151], v[124:127], v[52:55]
    v_mfma_f32_16x16x32_bf16 v[36:39], v[148:151], v[120:123], v[36:39]
    s_cmp_eq_u32 s31, 0
    s_cbranch_scc1 G4_k0
    s_add_u32 s36, s41, 0
    v_cvt_pk_bf16_f32 v24, v24, v25
    v_cvt_pk_bf16_f32 v25, v26, v27
    v_cvt_pk_bf16_f32 v26, v28, v29
    v_cvt_pk_bf16_f32 v27, v30, v31
    v_or_b32 v24, 1, v24
    buffer_store_dwordx4 v[24:27], v2, s[16:19], s36 offen offset:0 sc1
    v_cvt_pk_bf16_f32 v32, v32, v33
    v_cvt_pk_bf16_f32 v33, v34, v35
    v_cvt_pk_bf16_f32 v34, v36, v37
    v_cvt_pk_bf16_f32 v35, v38, v39
    v_or_b32 v32, 1, v32
    buffer_store_dwordx4 v[32:35], v2, s[16:19], s36 offen offset:1024 sc1
    s_add_u32 s36, s41, 65536
    v_cvt_pk_bf16_f32 v40, v40, v41
    v_cvt_pk_bf16_f32 v41, v42, v43
    v_cvt_pk_bf16_f32 v42, v44, v45
    v_cvt_pk_bf16_f32 v43, v46, v47
    v_or_b32 v40, 1, v40
    buffer_store_dwordx4 v[40:43], v2, s[16:19], s36 offen offset:0 sc1
    v_cvt_pk_bf16_f32 v48, v48, v49
    v_cvt_pk_bf16_f32 v49, v50, v51
    v_cvt_pk_bf16_f32 v50, v52, v53
    v_cvt_pk_bf16_f32 v51, v54, v55
    v_or_b32 v48, 1, v48
    buffer_store_dwordx4 v[48:51], v2, s[16:19], s36 offen offset:1024 sc1
    v_pk_mov_b32 v[24:25], v[56:57], v[56:57] op_sel:[0,1]
    v_pk_mov_b32 v[26:27], v[58:59], v[58:59] op_sel:[0,1]
    v_pk_mov_b32 v[28:29], v[60:61], v[60:61] op_sel:[0,1]
    v_pk_mov_b32 v[30:31], v[62:63], v[62:63] op_sel:[0,1]
    v_pk_mov_b32 v[32:33], v[64:65], v[64:65] op_sel:[0,1]
    v_pk_mov_b32 v[34:35], v[66:67], v[66:67] op_sel:[0,1]
    v_pk_mov_b32 v[36:37], v[68:69], v[68:69] op_sel:[0,1]
    v_pk_mov_b32 v[38:39], v[70:71], v[70:71] op_sel:[0,1]
    v_pk_mov_b32 v[40:41], v[72:73], v[72:73] op_sel:[0,1]
    v_pk_mov_b32 v[42:43], v[74:75], v[74:75] op_sel:[0,1]
    v_pk_mov_b32 v[44:45], v[76:77], v[76:77] op_sel:[0,1]
    v_pk_mov_b32 v[46:47], v[78:79], v[78:79] op_sel:[0,1]
    v_pk_mov_b32 v[48:49], v[80:81], v[80:81] op_sel:[0,1]
    v_pk_mov_b32 v[50:51], v[82:83], v[82:83] op_sel:[0,1]
    v_pk_mov_b32 v[52:53], v[84:85], v[84:85] op_sel:[0,1]
    v_pk_mov_b32 v[54:55], v[86:87], v[86:87] op_sel:[0,1]
    s_branch G4_k1
G4_k0:
    s_add_u32 s36, s41, 0
    v_cvt_pk_bf16_f32 v56, v56, v57
    v_cvt_pk_bf16_f32 v57, v58, v59
    v_cvt_pk_bf16_f32 v58, v60, v61
    v_cvt_pk_bf16_f32 v59, v62, v63
    v_or_b32 v56, 1, v56
    buffer_store_dwordx4 v[56:59], v2, s[16:19], s36 offen offset:0 sc1
    v_cvt_pk_bf16_f32 v64, v64, v65
    v_cvt_pk_bf16_f32 v65, v66, v67
    v_cvt_pk_bf16_f32 v66, v68, v69
    v_cvt_pk_bf16_f32 v67, v70, v71
    v_or_b32 v64, 1, v64
    buffer_store_dwordx4 v[64:67], v2, s[16:19], s36 offen offset:1024 sc1
    s_add_u32 s36, s41, 65536
    v_cvt_pk_bf16_f32 v72, v72, v73
    v_cvt_pk_bf16_f32 v73, v74, v75
    v_cvt_pk_bf16_f32 v74, v76, v77
    v_cvt_pk_bf16_f32 v75, v78, v79
    v_or_b32 v72, 1, v72
    buffer_store_dwordx4 v[72:75], v2, s[16:19], s36 offen offset:0 sc1
    v_cvt_pk_bf16_f32 v80, v80, v81
    v_cvt_pk_bf16_f32 v81, v82, v83
    v_cvt_pk_bf16_f32 v82, v84, v85
    v_cvt_pk_bf16_f32 v83, v86, v87
    v_or_b32 v80, 1, v80
    buffer_store_dwordx4 v[80:83], v2, s[16:19], s36 offen offset:1024 sc1
G4_k1:
    s_mov_b32 s78, 0x3f80
    s_mov_b32 s79, 0x3f800000
    v_dot2_f32_bf16 v24, v180, s78, v24
    v_dot2_f32_bf16 v25, v180, s79, v25
    v_dot2_f32_bf16 v26, v181, s78, v26
    v_dot2_f32_bf16 v27, v181, s79, v27
    v_dot2_f32_bf16 v28, v182, s78, v28
    v_dot2_f32_bf16 v29, v182, s79, v29
    v_dot2_f32_bf16 v30, v183, s78, v30
    v_dot2_f32_bf16 v31, v183, s79, v31
    v_dot2_f32_bf16 v32, v188, s78, v32
    v_dot2_f32_bf16 v33, v188, s79, v33
    v_dot2_f32_bf16 v34, v189, s78, v34
    v_dot2_f32_bf16 v35, v189, s79, v35
    v_dot2_f32_bf16 v36, v190, s78, v36
    v_dot2_f32_bf16 v37, v190, s79, v37
    v_dot2_f32_bf16 v38, v191, s78, v38
    v_dot2_f32_bf16 v39, v191, s79, v39
    v_dot2_f32_bf16 v40, v196, s78, v40
    v_dot2_f32_bf16 v41, v196, s79, v41
    v_dot2_f32_bf16 v42, v197, s78, v42
    v_dot2_f32_bf16 v43, v197, s79, v43
    v_dot2_f32_bf16 v44, v198, s78, v44
    v_dot2_f32_bf16 v45, v198, s79, v45
    v_dot2_f32_bf16 v46, v199, s78, v46
    v_dot2_f32_bf16 v47, v199, s79, v47
    v_dot2_f32_bf16 v48, v234, s78, v48
    v_dot2_f32_bf16 v49, v234, s79, v49
    v_dot2_f32_bf16 v50, v235, s78, v50
    v_dot2_f32_bf16 v51, v235, s79, v51
    v_dot2_f32_bf16 v52, v236, s78, v52
    v_dot2_f32_bf16 v53, v236, s79, v53
    v_dot2_f32_bf16 v54, v237, s78, v54
    v_dot2_f32_bf16 v55, v237, s79, v55
    v_dot2_f32_bf16 v24, v184, s78, v24
    v_dot2_f32_bf16 v25, v184, s79, v25
    v_dot2_f32_bf16 v26, v185, s78, v26
    v_dot2_f32_bf16 v27, v185, s79, v27
    v_dot2_f32_bf16 v28, v186, s78, v28
    v_dot2_f32_bf16 v29, v186, s79, v29
    v_dot2_f32_bf16 v30, v187, s78, v30
    v_dot2_f32_bf16 v31, v187, s79, v31
    v_dot2_f32_bf16 v32, v192, s78, v32
    v_dot2_f32_bf16 v33, v192, s79, v33
    v_dot2_f32_bf16 v34, v193, s78, v34
    v_dot2_f32_bf16 v35, v193, s79, v35
    v_dot2_f32_bf16 v36, v194, s78, v36
    v_dot2_f32_bf16 v37, v194, s79, v37
    v_dot2_f32_bf16 v38, v195, s78, v38
    v_dot2_f32_bf16 v39, v195, s79, v39
    v_dot2_f32_bf16 v40, v230, s78, v40
    v_dot2_f32_bf16 v41, v230, s79, v41
    v_dot2_f32_bf16 v42, v231, s78, v42
    v_dot2_f32_bf16 v43, v231, s79, v43
    v_dot2_f32_bf16 v44, v232, s78, v44
    v_dot2_f32_bf16 v45, v232, s79, v45
    v_dot2_f32_bf16 v46, v233, s78, v46
    v_dot2_f32_bf16 v47, v233, s79, v47
    v_dot2_f32_bf16 v48, v248, s78, v48
    v_dot2_f32_bf16 v49, v248, s79, v49
    v_dot2_f32_bf16 v50, v249, s78, v50
    v_dot2_f32_bf16 v51, v249, s79, v51
    v_dot2_f32_bf16 v52, v250, s78, v52
    v_dot2_f32_bf16 v53, v250, s79, v53
    v_dot2_f32_bf16 v54, v251, s78, v54
    v_dot2_f32_bf16 v55, v251, s79, v55
    s_mov_b32 s53, 0
dp_29:
    buffer_load_dwordx4 v[208:211], v2, s[16:19], s40 offen offset:0 sc1
    buffer_load_dwordx4 v[212:215], v2, s[16:19], s40 offen offset:1024 sc1
    buffer_load_dwordx4 v[216:219], v2, s[16:19], s44 offen offset:0 sc1
    buffer_load_dwordx4 v[220:223], v2, s[16:19], s44 offen offset:1024 sc1
    s_waitcnt vmcnt(0)
    v_bitop3_b32 v6, v208, v212, v216 bitop3:0x80
    v_bitop3_b32 v6, v6, v220, 1 bitop3:0x80
    v_cmp_eq_u32 vcc, 0, v6
    s_cbranch_vccz dq_30
    s_sleep 2
    s_add_u32 s53, s53, 1
    s_cmp_lt_u32 s53, s61
    s_cbranch_scc1 dp_29
    s_mov_b32 s61, 0
dq_30:
    v_dot2_f32_bf16 v24, v208, s78, v24
    v_dot2_f32_bf16 v25, v208, s79, v25
    v_dot2_f32_bf16 v26, v209, s78, v26
    v_dot2_f32_bf16 v27, v209, s79, v27
    v_dot2_f32_bf16 v28, v210, s78, v28
    v_dot2_f32_bf16 v29, v210, s79, v29
    v_dot2_f32_bf16 v30, v211, s78, v30
    v_dot2_f32_bf16 v31, v211, s79, v31
    v_cvt_pk_bf16_f32 v24, v24, v25
    v_cvt_pk_bf16_f32 v25, v26, v27
    v_cvt_pk_bf16_f32 v26, v28, v29
    v_cvt_pk_bf16_f32 v27, v30, v31
    s_nop 0
    v_permlane16_swap_b32 v24, v26
    v_permlane16_swap_b32 v25, v27
    v_dot2_f32_bf16 v32, v212, s78, v32
    v_dot2_f32_bf16 v33, v212, s79, v33
    v_dot2_f32_bf16 v34, v213, s78, v34
    v_dot2_f32_bf16 v35, v213, s79, v35
    v_dot2_f32_bf16 v36, v214, s78, v36
    v_dot2_f32_bf16 v37, v214, s79, v37
    v_dot2_f32_bf16 v38, v215, s78, v38
    v_dot2_f32_bf16 v39, v215, s79, v39
    v_cvt_pk_bf16_f32 v32, v32, v33
    v_cvt_pk_bf16_f32 v33, v34, v35
    v_cvt_pk_bf16_f32 v34, v36, v37
    v_cvt_pk_bf16_f32 v35, v38, v39
    s_nop 0
    v_permlane16_swap_b32 v32, v34
    v_permlane16_swap_b32 v33, v35
    v_mov_b32 v36, v24
    v_mov_b32 v37, v25
    v_mov_b32 v38, v26
    v_mov_b32 v39, v27
    v_mov_b32_dpp v24, v32 row_ror:8 row_mask:0xf bank_mask:0xc
    v_mov_b32_dpp v25, v33 row_ror:8 row_mask:0xf bank_mask:0xc
    v_mov_b32_dpp v26, v34 row_ror:8 row_mask:0xf bank_mask:0xc
    v_mov_b32_dpp v27, v35 row_ror:8 row_mask:0xf bank_mask:0xc
    v_mov_b32_dpp v32, v36 row_ror:8 row_mask:0xf bank_mask:0x3
    v_mov_b32_dpp v33, v37 row_ror:8 row_mask:0xf bank_mask:0x3
    v_mov_b32_dpp v34, v38 row_ror:8 row_mask:0xf bank_mask:0x3
    v_mov_b32_dpp v35, v39 row_ror:8 row_mask:0xf bank_mask:0x3
    buffer_store_dwordx4 v[24:27], v224, s[20:23], s46 offen sc1
    buffer_store_dwordx4 v[32:35], v225, s[20:23], s46 offen sc1
    v_dot2_f32_bf16 v40, v216, s78, v40
    v_dot2_f32_bf16 v41, v216, s79, v41
    v_dot2_f32_bf16 v42, v217, s78, v42
    v_dot2_f32_bf16 v43, v217, s79, v43
    v_dot2_f32_bf16 v44, v218, s78, v44
    v_dot2_f32_bf16 v45, v218, s79, v45
    v_dot2_f32_bf16 v46, v219, s78, v46
    v_dot2_f32_bf16 v47, v219, s79, v47
    v_cvt_pk_bf16_f32 v40, v40, v41
    v_cvt_pk_bf16_f32 v41, v42, v43
    v_cvt_pk_bf16_f32 v42, v44, v45
    v_cvt_pk_bf16_f32 v43, v46, v47
    s_nop 0
    v_permlane16_swap_b32 v40, v42
    v_permlane16_swap_b32 v41, v43
    v_dot2_f32_bf16 v48, v220, s78, v48
    v_dot2_f32_bf16 v49, v220, s79, v49
    v_dot2_f32_bf16 v50, v221, s78, v50
    v_dot2_f32_bf16 v51, v221, s79, v51
    v_dot2_f32_bf16 v52, v222, s78, v52
    v_dot2_f32_bf16 v53, v222, s79, v53
    v_dot2_f32_bf16 v54, v223, s78, v54
    v_dot2_f32_bf16 v55, v223, s79, v55
    v_cvt_pk_bf16_f32 v48, v48, v49
    v_cvt_pk_bf16_f32 v49, v50, v51
    v_cvt_pk_bf16_f32 v50, v52, v53
    v_cvt_pk_bf16_f32 v51, v54, v55
    s_nop 0
    v_permlane16_swap_b32 v48, v50
    v_permlane16_swap_b32 v49, v51
    v_mov_b32 v52, v40
    v_mov_b32 v53, v41
    v_mov_b32 v54, v42
    v_mov_b32 v55, v43
    v_mov_b32_dpp v40, v48 row_ror:8 row_mask:0xf bank_mask:0xc
    v_mov_b32_dpp v41, v49 row_ror:8 row_mask:0xf bank_mask:0xc
    v_mov_b32_dpp v42, v50 row_ror:8 row_mask:0xf bank_mask:0xc
    v_mov_b32_dpp v43, v51 row_ror:8 row_mask:0xf bank_mask:0xc
    v_mov_b32_dpp v48, v52 row_ror:8 row_mask:0xf bank_mask:0x3
    v_mov_b32_dpp v49, v53 row_ror:8 row_mask:0xf bank_mask:0x3
    v_mov_b32_dpp v50, v54 row_ror:8 row_mask:0xf bank_mask:0x3
    v_mov_b32_dpp v51, v55 row_ror:8 row_mask:0xf bank_mask:0x3
    buffer_store_dwordx4 v[40:43], v224, s[20:23], s47 offen sc1
    buffer_store_dwordx4 v[48:51], v225, s[20:23], s47 offen sc1
    s_branch K_fin
LOADERS:
    s_cmp_lg_u32 s60, 0
    s_cbranch_scc1 pr_31
    s_and_b32 s36, s29, 6
    s_cmp_eq_u32 s36, 2
    s_cbranch_scc0 pr_31
    s_call_b64 s[76:77], SUB_park2
pr_31:
    s_cmp_ge_u32 s30, 6
    s_cbranch_scc1 WLOAD
    s_add_u32 s54, s55, 0x500
    v_mov_b32 v222, s54
    s_lshl_b32 s53, s29, 7
    s_add_u32 s53, s53, 23121920
    v_mov_b32 v226, s53
    s_sleep 30
    s_mov_b64 exec, 1
    buffer_load_dword v227, v226, s[56:59], 0 offen sc1
    s_mov_b64 exec, -1
    s_waitcnt vmcnt(0)
    v_readfirstlane_b32 s53, v227
    s_add_u32 s54, s52, 16
    s_cmp_eq_u32 s53, s54
    s_cbranch_scc1 fok_32
    s_mov_b32 s53, 0
    s_add_u32 s54, s52, 16
    s_bfm_b64 exec, 1, 0
poll_33:
    buffer_load_dword v227, v226, s[56:59], 0 offen sc1
    s_waitcnt vmcnt(0)
    v_xor_b32 v227, s54, v227
    v_cmp_eq_u32 vcc, 0, v227
    s_nop 0
    s_cmp_eq_u64 vcc, exec
    s_cbranch_scc1 pok_34
    s_sleep 5
    s_add_u32 s53, s53, 1
    s_cmp_lt_u32 s53, s61
    s_cbranch_scc1 poll_33
    s_mov_b32 s61, 0
pok_34:
    s_mov_b64 exec, -1
fok_32:
    s_add_u32 s24, s4, 0x1400000
    s_addc_u32 s25, s5, 0
    s_mov_b32 s26, 0x20000
    s_mov_b32 s27, 0x20000
    s_cmp_eq_u32 s60, 0
    s_cselect_b32 s26, s26, 0
    s_and_b32 s36, s30, 1
    s_mul_i32 s36, s36, 128
    s_mul_i32 s37, s29, 256
    s_add_u32 s37, s36, s37
    v_lshrrev_b32 v224, 3, v1
    v_mul_u32_u24 v224, 4096, v224
    v_and_b32 v23, 112, v2
    v_add_u32 v224, v224, v23
    s_cmp_eq_u32 s60, 0
    s_cselect_b64 exec, -1, 0
    buffer_load_dwordx4 v[24:27], v224, s[24:27], s37 offen sc1
    s_add_u32 s37, s37, 32768
    buffer_load_dwordx4 v[28:31], v224, s[24:27], s37 offen sc1
    s_add_u32 s37, s37, 32768
    buffer_load_dwordx4 v[32:35], v224, s[24:27], s37 offen sc1
    s_add_u32 s37, s37, 32768
    buffer_load_dwordx4 v[36:39], v224, s[24:27], s37 offen sc1
    s_add_u32 s37, s37, 32768
    s_mov_b64 exec, -1
    s_mov_b64 exec, 1
    buffer_load_dword v223, v222, s[56:59], 0 offen sc1
    s_mov_b64 exec, -1
    s_waitcnt vmcnt(0)
    v_readfirstlane_b32 s53, v223
    s_add_u32 s54, s52, 16
    s_cmp_eq_u32 s53, s54
    s_cbranch_scc1 fok_35
    s_mov_b32 s53, 0
    s_add_u32 s54, s52, 16
    s_bfm_b64 exec, 1, 0
poll_36:
    buffer_load_dword v223, v222, s[56:59], 0 offen sc1
    s_waitcnt vmcnt(0)
    v_xor_b32 v223, s54, v223
    v_cmp_eq_u32 vcc, 0, v223
    s_nop 0
    s_cmp_eq_u64 vcc, exec
    s_cbranch_scc1 pok_37
    s_sleep 5
    s_add_u32 s53, s53, 1
    s_cmp_lt_u32 s53, s61
    s_cbranch_scc1 poll_36
    s_mov_b32 s61, 0
pok_37:
    s_mov_b64 exec, -1
fok_35:
    s_add_u32 s20, s62, 0x5d0000
    s_addc_u32 s21, s63, 0
    s_mov_b32 s22, 0x800
    s_mov_b32 s23, 0x20000
    s_and_b32 s35, s30, 1
    s_lshl_b32 s35, s35, 10
    buffer_load_dwordx4 v[16:19], v2, s[20:23], s35 offen sc1
    s_cmp_lg_u32 s60, 0
    s_cbranch_scc1 pc_38
    v_add_f32 v24, v24, v28
    v_add_f32 v25, v25, v29
    v_add_f32 v26, v26, v30
    v_add_f32 v27, v27, v31
    v_add_f32 v24, v24, v32
    v_add_f32 v25, v25, v33
    v_add_f32 v26, v26, v34
    v_add_f32 v27, v27, v35
    v_add_f32 v24, v24, v36
    v_add_f32 v25, v25, v37
    v_add_f32 v26, v26, v38
    v_add_f32 v27, v27, v39
    v_add_f32_dpp v24, v24, v24 row_ror:8 row_mask:0xf bank_mask:0xf
    v_add_f32_dpp v25, v25, v25 row_ror:8 row_mask:0xf bank_mask:0xf
    v_add_f32_dpp v26, v26, v26 row_ror:8 row_mask:0xf bank_mask:0xf
    v_add_f32_dpp v27, v27, v27 row_ror:8 row_mask:0xf bank_mask:0xf
    v_mov_b32 v28, v24
    v_mov_b32 v29, v25
    v_mov_b32 v30, v26
    v_mov_b32 v31, v27
    v_permlane16_swap_b32 v24, v28
    v_permlane16_swap_b32 v25, v29
    v_permlane16_swap_b32 v26, v30
    v_permlane16_swap_b32 v27, v31
    v_add_f32 v24, v24, v28
    v_add_f32 v25, v25, v29
    v_add_f32 v26, v26, v30
    v_add_f32 v27, v27, v31
    v_mov_b32 v28, v24
    v_mov_b32 v29, v25
    v_mov_b32 v30, v26
    v_mov_b32 v31, v27
    v_permlane32_swap_b32 v24, v28
    v_permlane32_swap_b32 v25, v29
    v_permlane32_swap_b32 v26, v30
    v_permlane32_swap_b32 v27, v31
    v_add_f32 v24, v24, v28
    v_add_f32 v25, v25, v29
    v_add_f32 v26, v26, v30
    v_add_f32 v27, v27, v31
pc_38:
    s_cmp_lg_u32 s60, 0
    s_cbranch_scc1 pc_39
    s_and_b32 s36, s30, 1
    s_mul_i32 s36, s36, 128
    s_add_u32 s36, s36, 163328
    v_add_u32 v23, s36, v2
    s_bfm_b64 exec, 8, 0
    ds_write_b128 v23, v[24:27]
    s_mov_b64 exec, -1
    s_waitcnt lgkmcnt(0)
pc_39:
    s_waitcnt vmcnt(0)
    s_and_b32 s36, s30, 1
    s_lshl_b32 s36, s36, 10
    s_add_u32 s36, s36, 160768
    v_add_u32 v221, s36, v2
    ds_write_b128 v221, v[16:19]
    s_waitcnt lgkmcnt(0)
    s_cmp_lg_u32 s30, 4
    s_cbranch_scc1 AL_nw
    s_cmp_eq_u32 s60, 0
    s_cbranch_scc1 AL_nw
    s_add_u32 s54, s55, 0xffc00300
    s_add_u32 s53, s54, s92
    v_mov_b32 v9, s53
    s_add_u32 s53, s53, 128
    v_writelane_b32 v9, s53, 1
    s_add_u32 s53, s54, s93
    v_writelane_b32 v9, s53, 2
    s_add_u32 s53, s53, 128
    v_writelane_b32 v9, s53, 3
    s_mov_b32 s53, 0
    s_add_u32 s54, s52, 8
    s_bfm_b64 exec, 4, 0
poll_41:
    buffer_load_dword v8, v9, s[56:59], 0 offen sc1
    s_waitcnt vmcnt(0)
    v_xor_b32 v8, s54, v8
    v_cmp_eq_u32 vcc, 0, v8
    s_nop 0
    s_cmp_eq_u64 vcc, exec
    s_cbranch_scc1 pok_42
    s_sleep 5
    s_add_u32 s53, s53, 1
    s_cmp_lt_u32 s53, s61
    s_cbranch_scc1 poll_41
    s_mov_b32 s61, 0
pok_42:
    s_mov_b64 exec, -1
AL_nw:
    s_barrier
    s_call_b64 s[76:77], SUB_after_g1
    s_barrier
    s_waitcnt vmcnt(0)
    s_barrier
    s_call_b64 s[76:77], SUB_after_g2
    s_and_b32 s35, s30, 1
    s_add_u32 s12, s62, 0x80000
    s_addc_u32 s13, s63, 0
    s_mov_b32 s14, 0x7e000
    s_mov_b32 s15, 0x20000
    s_mul_i32 s38, s35, 262144
    s_lshl_b32 s41, s35, 13
    s_mov_b32 s42, 0
    s_mov_b32 s44, 0
    s_add_u32 s54, s55, 0x200
    v_mov_b32 v9, s54
    s_mov_b32 s44, 1
    s_mov_b32 s42, 16384
    s_add_u32 s54, s55, 0x580
    v_mov_b32 v222, s54
    v_lshlrev_b32 v221, 3, v1
    s_add_u32 s19, s41, s42
    v_readlane_b32 s16, v248, s44
    s_nop 0
    s_add_u32 s16, s16, s38
    s_add_u32 s44, s44, 1
    s_and_b32 s44, s44, 15
    s_add_u32 s42, s42, 16384
    s_cmp_eq_u32 s42, 49152
    s_cselect_b32 s42, 0, s42
    s_mov_b32 m0, s19
    s_mov_b32 s39, s16
    s_waitcnt vmcnt(63)
    s_barrier
    s_sleep 6
    s_mov_b32 s53, 0
    s_add_u32 s54, s52, 16
    s_bfm_b64 exec, 1, 0
poll_43:
    buffer_load_dword v8, v9, s[56:59], 0 offen sc1
    s_waitcnt vmcnt(0)
    v_xor_b32 v8, s54, v8
    v_cmp_eq_u32 vcc, 0, v8
    s_nop 0
    s_cmp_eq_u64 vcc, exec
    s_cbranch_scc1 pok_44
    s_sleep 5
    s_add_u32 s53, s53, 1
    s_cmp_lt_u32 s53, s61
    s_cbranch_scc1 poll_43
    s_mov_b32 s61, 0
pok_44:
    s_mov_b64 exec, -1
    buffer_load_dwordx4 v2, s[12:15], s39 offen sc1 lds
    buffer_load_dwordx4 v2, s[12:15], s39 offen offset:1024 sc1 lds
    s_add_u32 m0, m0, 2048
    s_add_u32 s39, s39, 65536
    buffer_load_dwordx4 v2, s[12:15], s39 offen sc1 lds
    buffer_load_dwordx4 v2, s[12:15], s39 offen offset:1024 sc1 lds
    s_add_u32 s19, s41, s42
    v_readlane_b32 s16, v248, s44
    s_nop 0
    s_add_u32 s16, s16, s38
    s_add_u32 s44, s44, 1
    s_and_b32 s44, s44, 15
    s_add_u32 s42, s42, 16384
    s_cmp_eq_u32 s42, 49152
    s_cselect_b32 s42, 0, s42
    s_add_u32 m0, m0, 2048
    s_add_u32 s39, s39, 65536
    buffer_load_dwordx4 v2, s[12:15], s39 offen sc1 lds
    buffer_load_dwordx4 v2, s[12:15], s39 offen offset:1024 sc1 lds
    s_add_u32 m0, m0, 2048
    s_add_u32 s39, s39, 65536
    buffer_load_dwordx4 v2, s[12:15], s39 offen sc1 lds
    buffer_load_dwordx4 v2, s[12:15], s39 offen offset:1024 sc1 lds
    s_mov_b32 m0, s19
    s_mov_b32 s39, s16
    buffer_load_dwordx4 v2, s[12:15], s39 offen sc1 lds
    buffer_load_dwordx4 v2, s[12:15], s39 offen offset:1024 sc1 lds
    s_add_u32 m0, m0, 2048
    s_add_u32 s39, s39, 65536
    buffer_load_dwordx4 v2, s[12:15], s39 offen sc1 lds
    buffer_load_dwordx4 v2, s[12:15], s39 offen offset:1024 sc1 lds
    s_add_u32 s19, s41, s42
    v_readlane_b32 s16, v248, s44
    s_nop 0
    s_add_u32 s16, s16, s38
    s_add_u32 s44, s44, 1
    s_and_b32 s44, s44, 15
    s_add_u32 s42, s42, 16384
    s_cmp_eq_u32 s42, 49152
    s_cselect_b32 s42, 0, s42
    s_add_u32 m0, m0, 2048
    s_add_u32 s39, s39, 65536
    buffer_load_dwordx4 v2, s[12:15], s39 offen sc1 lds
    buffer_load_dwordx4 v2, s[12:15], s39 offen offset:1024 sc1 lds
    s_add_u32 m0, m0, 2048
    s_add_u32 s39, s39, 65536
    buffer_load_dwordx4 v2, s[12:15], s39 offen sc1 lds
    buffer_load_dwordx4 v2, s[12:15], s39 offen offset:1024 sc1 lds
    s_mov_b32 m0, s19
    s_mov_b32 s39, s16
    s_waitcnt vmcnt(8)
    s_barrier
    buffer_load_dwordx4 v2, s[12:15], s39 offen sc1 lds
    buffer_load_dwordx4 v2, s[12:15], s39 offen offset:1024 sc1 lds
    s_add_u32 m0, m0, 2048
    s_add_u32 s39, s39, 65536
    buffer_load_dwordx4 v2, s[12:15], s39 offen sc1 lds
    buffer_load_dwordx4 v2, s[12:15], s39 offen offset:1024 sc1 lds
    s_add_u32 s19, s41, s42
    v_readlane_b32 s16, v248, s44
    s_nop 0
    s_add_u32 s16, s16, s38
    s_add_u32 s44, s44, 1
    s_and_b32 s44, s44, 15
    s_add_u32 s42, s42, 16384
    s_cmp_eq_u32 s42, 49152
    s_cselect_b32 s42, 0, s42
    s_add_u32 m0, m0, 2048
    s_add_u32 s39, s39, 65536
    buffer_load_dwordx4 v2, s[12:15], s39 offen sc1 lds
    buffer_load_dwordx4 v2, s[12:15], s39 offen offset:1024 sc1 lds
    s_add_u32 m0, m0, 2048
    s_add_u32 s39, s39, 65536
    buffer_load_dwordx4 v2, s[12:15], s39 offen sc1 lds
    buffer_load_dwordx4 v2, s[12:15], s39 offen offset:1024 sc1 lds
    s_mov_b32 m0, s19
    s_mov_b32 s39, s16
    s_add_u32 s24, s4, 0x1420000
    s_addc_u32 s25, s5, 0
    s_mov_b32 s26, 0x70000
    s_mov_b32 s27, 0x20000
    s_cmp_eq_u32 s60, 0
    s_cselect_b32 s26, s26, 0
    s_and_b32 s36, s30, 1
    s_mul_i32 s36, s36, 448
    s_mul_i32 s37, s29, 896
    s_add_u32 s37, s36, s37
    v_lshrrev_b32 v224, 5, v1
    v_mul_u32_u24 v224, 14336, v224
    v_and_b32 v179, 496, v2
    v_add_u32 v224, v224, v179
    s_cmp_eq_u32 s60, 0
    s_cselect_b64 exec, -1, 0
    buffer_load_dwordx4 v[180:183], v224, s[24:27], s37 offen sc1
    s_add_u32 s37, s37, 28672
    buffer_load_dwordx4 v[184:187], v224, s[24:27], s37 offen sc1
    s_add_u32 s37, s37, 28672
    buffer_load_dwordx4 v[188:191], v224, s[24:27], s37 offen sc1
    s_add_u32 s37, s37, 28672
    s_mov_b64 exec, -1
    s_waitcnt vmcnt(11)
    s_barrier
    buffer_load_dwordx4 v2, s[12:15], s39 offen sc1 lds
    buffer_load_dwordx4 v2, s[12:15], s39 offen offset:1024 sc1 lds
    s_add_u32 m0, m0, 2048
    s_add_u32 s39, s39, 65536
    buffer_load_dwordx4 v2, s[12:15], s39 offen sc1 lds
    buffer_load_dwordx4 v2, s[12:15], s39 offen offset:1024 sc1 lds
    s_add_u32 s19, s41, s42
    v_readlane_b32 s16, v248, s44
    s_nop 0
    s_add_u32 s16, s16, s38
    s_add_u32 s44, s44, 1
    s_and_b32 s44, s44, 15
    s_add_u32 s42, s42, 16384
    s_cmp_eq_u32 s42, 49152
    s_cselect_b32 s42, 0, s42
    s_add_u32 m0, m0, 2048
    s_add_u32 s39, s39, 65536
    buffer_load_dwordx4 v2, s[12:15], s39 offen sc1 lds
    buffer_load_dwordx4 v2, s[12:15], s39 offen offset:1024 sc1 lds
    s_add_u32 m0, m0, 2048
    s_add_u32 s39, s39, 65536
    buffer_load_dwordx4 v2, s[12:15], s39 offen sc1 lds
    buffer_load_dwordx4 v2, s[12:15], s39 offen offset:1024 sc1 lds
    s_mov_b32 m0, s19
    s_mov_b32 s39, s16
    s_cmp_eq_u32 s60, 0
    s_cselect_b64 exec, -1, 0
    buffer_load_dwordx4 v[192:195], v224, s[24:27], s37 offen sc1
    s_add_u32 s37, s37, 28672
    buffer_load_dwordx4 v[196:199], v224, s[24:27], s37 offen sc1
    s_add_u32 s37, s37, 28672
    buffer_load_dwordx4 v[200:203], v224, s[24:27], s37 offen sc1
    s_add_u32 s37, s37, 28672
    s_mov_b64 exec, -1
    s_waitcnt vmcnt(14)
    s_barrier
    buffer_load_dwordx4 v2, s[12:15], s39 offen sc1 lds
    buffer_load_dwordx4 v2, s[12:15], s39 offen offset:1024 sc1 lds
    s_add_u32 m0, m0, 2048
    s_add_u32 s39, s39, 65536
    buffer_load_dwordx4 v2, s[12:15], s39 offen sc1 lds
    buffer_load_dwordx4 v2, s[12:15], s39 offen offset:1024 sc1 lds
    s_add_u32 s19, s41, s42
    v_readlane_b32 s16, v248, s44
    s_nop 0
    s_add_u32 s16, s16, s38
    s_add_u32 s44, s44, 1
    s_and_b32 s44, s44, 15
    s_add_u32 s42, s42, 16384
    s_cmp_eq_u32 s42, 49152
    s_cselect_b32 s42, 0, s42
    s_add_u32 m0, m0, 2048
    s_add_u32 s39, s39, 65536
    buffer_load_dwordx4 v2, s[12:15], s39 offen sc1 lds
    buffer_load_dwordx4 v2, s[12:15], s39 offen offset:1024 sc1 lds
    s_add_u32 m0, m0, 2048
    s_add_u32 s39, s39, 65536
    buffer_load_dwordx4 v2, s[12:15], s39 offen sc1 lds
    buffer_load_dwordx4 v2, s[12:15], s39 offen offset:1024 sc1 lds
    s_mov_b32 m0, s19
    s_mov_b32 s39, s16
    s_cmp_eq_u32 s60, 0
    s_cselect_b64 exec, -1, 0
    buffer_load_dwordx4 v[204:207], v224, s[24:27], s37 offen sc1
    s_add_u32 s37, s37, 28672
    buffer_load_dwordx4 v[208:211], v224, s[24:27], s37 offen sc1
    s_add_u32 s37, s37, 28672
    buffer_load_dwordx4 v[212:215], v224, s[24:27], s37 offen sc1
    s_add_u32 s37, s37, 28672
    s_mov_b64 exec, -1
    s_mov_b64 exec, 1
    buffer_load_dword v223, v222, s[56:59], 0 offen sc1
    s_mov_b64 exec, -1
    s_waitcnt vmcnt(15)
    s_barrier
    buffer_load_dwordx4 v2, s[12:15], s39 offen sc1 lds
    buffer_load_dwordx4 v2, s[12:15], s39 offen offset:1024 sc1 lds
    s_add_u32 m0, m0, 2048
    s_add_u32 s39, s39, 65536
    buffer_load_dwordx4 v2, s[12:15], s39 offen sc1 lds
    buffer_load_dwordx4 v2, s[12:15], s39 offen offset:1024 sc1 lds
    s_add_u32 s19, s41, s42
    v_readlane_b32 s16, v248, s44
    s_nop 0
    s_add_u32 s16, s16, s38
    s_add_u32 s44, s44, 1
    s_and_b32 s44, s44, 15
    s_add_u32 s42, s42, 16384
    s_cmp_eq_u32 s42, 49152
    s_cselect_b32 s42, 0, s42
    s_add_u32 m0, m0, 2048
    s_add_u32 s39, s39, 65536
    buffer_load_dwordx4 v2, s[12:15], s39 offen sc1 lds
    buffer_load_dwordx4 v2, s[12:15], s39 offen offset:1024 sc1 lds
    s_add_u32 m0, m0, 2048
    s_add_u32 s39, s39, 65536
    buffer_load_dwordx4 v2, s[12:15], s39 offen sc1 lds
    buffer_load_dwordx4 v2, s[12:15], s39 offen offset:1024 sc1 lds
    s_mov_b32 m0, s19
    s_mov_b32 s39, s16
    s_waitcnt vmcnt(12)
    s_barrier
    buffer_load_dwordx4 v2, s[12:15], s39 offen sc1 lds
    buffer_load_dwordx4 v2, s[12:15], s39 offen offset:1024 sc1 lds
    s_add_u32 m0, m0, 2048
    s_add_u32 s39, s39, 65536
    buffer_load_dwordx4 v2, s[12:15], s39 offen sc1 lds
    buffer_load_dwordx4 v2, s[12:15], s39 offen offset:1024 sc1 lds
    s_add_u32 s19, s41, s42
    v_readlane_b32 s16, v248, s44
    s_nop 0
    s_add_u32 s16, s16, s38
    s_add_u32 s44, s44, 1
    s_and_b32 s44, s44, 15
    s_add_u32 s42, s42, 16384
    s_cmp_eq_u32 s42, 49152
    s_cselect_b32 s42, 0, s42
    s_add_u32 m0, m0, 2048
    s_add_u32 s39, s39, 65536
    buffer_load_dwordx4 v2, s[12:15], s39 offen sc1 lds
    buffer_load_dwordx4 v2, s[12:15], s39 offen offset:1024 sc1 lds
    s_add_u32 m0, m0, 2048
    s_add_u32 s39, s39, 65536
    buffer_load_dwordx4 v2, s[12:15], s39 offen sc1 lds
    buffer_load_dwordx4 v2, s[12:15], s39 offen offset:1024 sc1 lds
    s_mov_b32 m0, s19
    s_mov_b32 s39, s16
    s_waitcnt vmcnt(16)
    v_readfirstlane_b32 s53, v223
    s_add_u32 s54, s52, 16
    s_cmp_eq_u32 s53, s54
    s_cbranch_scc1 fok_45
    s_mov_b32 s53, 0
    s_add_u32 s54, s52, 16
    s_bfm_b64 exec, 1, 0
poll_46:
    buffer_load_dword v223, v222, s[56:59], 0 offen sc1
    s_waitcnt vmcnt(0)
    v_xor_b32 v223, s54, v223
    v_cmp_eq_u32 vcc, 0, v223
    s_nop 0
    s_cmp_eq_u64 vcc, exec
    s_cbranch_scc1 pok_47
    s_sleep 5
    s_add_u32 s53, s53, 1
    s_cmp_lt_u32 s53, s61
    s_cbranch_scc1 poll_46
    s_mov_b32 s61, 0
pok_47:
    s_mov_b64 exec, -1
fok_45:
    s_add_u32 s20, s62, 0x5c8000
    s_addc_u32 s21, s63, 0
    s_mov_b32 s22, 0x6000
    s_mov_b32 s23, 0x20000
    s_and_b32 s35, s30, 1
    s_lshl_b32 s35, s35, 9
    s_add_u32 s36, s35, 0
    buffer_load_dwordx2 v[16:17], v221, s[20:23], s36 offen offset:0 sc1
    buffer_load_dwordx2 v[18:19], v221, s[20:23], s36 offen offset:1024 sc1
    buffer_load_dwordx2 v[20:21], v221, s[20:23], s36 offen offset:2048 sc1
    buffer_load_dwordx2 v[22:23], v221, s[20:23], s36 offen offset:3072 sc1
    s_cmp_lg_u32 s60, 0
    s_cbranch_scc1 pc_48
    v_add_f32 v180, v180, v184
    v_add_f32 v181, v181, v185
    v_add_f32 v182, v182, v186
    v_add_f32 v183, v183, v187
    v_add_f32 v180, v180, v188
    v_add_f32 v181, v181, v189
    v_add_f32 v182, v182, v190
    v_add_f32 v183, v183, v191
    v_add_f32 v180, v180, v192
    v_add_f32 v181, v181, v193
    v_add_f32 v182, v182, v194
    v_add_f32 v183, v183, v195
    v_add_f32 v180, v180, v196
    v_add_f32 v181, v181, v197
    v_add_f32 v182, v182, v198
    v_add_f32 v183, v183, v199
pc_48:
    s_waitcnt vmcnt(12)
    s_barrier
    buffer_load_dwordx4 v2, s[12:15], s39 offen sc1 lds
    buffer_load_dwordx4 v2, s[12:15], s39 offen offset:1024 sc1 lds
    s_add_u32 m0, m0, 2048
    s_add_u32 s39, s39, 65536
    buffer_load_dwordx4 v2, s[12:15], s39 offen sc1 lds
    buffer_load_dwordx4 v2, s[12:15], s39 offen offset:1024 sc1 lds
    s_add_u32 s19, s41, s42
    v_readlane_b32 s16, v248, s44
    s_nop 0
    s_add_u32 s16, s16, s38
    s_add_u32 s44, s44, 1
    s_and_b32 s44, s44, 15
    s_add_u32 s42, s42, 16384
    s_cmp_eq_u32 s42, 49152
    s_cselect_b32 s42, 0, s42
    s_add_u32 m0, m0, 2048
    s_add_u32 s39, s39, 65536
    buffer_load_dwordx4 v2, s[12:15], s39 offen sc1 lds
    buffer_load_dwordx4 v2, s[12:15], s39 offen offset:1024 sc1 lds
    s_add_u32 m0, m0, 2048
    s_add_u32 s39, s39, 65536
    buffer_load_dwordx4 v2, s[12:15], s39 offen sc1 lds
    buffer_load_dwordx4 v2, s[12:15], s39 offen offset:1024 sc1 lds
    s_mov_b32 m0, s19
    s_mov_b32 s39, s16
    s_add_u32 s36, s35, 4096
    buffer_load_dwordx2 v[24:25], v221, s[20:23], s36 offen offset:0 sc1
    buffer_load_dwordx2 v[26:27], v221, s[20:23], s36 offen offset:1024 sc1
    buffer_load_dwordx2 v[28:29], v221, s[20:23], s36 offen offset:2048 sc1
    buffer_load_dwordx2 v[30:31], v221, s[20:23], s36 offen offset:3072 sc1
    s_cmp_lg_u32 s60, 0
    s_cbranch_scc1 pc_49
    v_add_f32 v180, v180, v200
    v_add_f32 v181, v181, v201
    v_add_f32 v182, v182, v202
    v_add_f32 v183, v183, v203
    v_add_f32 v180, v180, v204
    v_add_f32 v181, v181, v205
    v_add_f32 v182, v182, v206
    v_add_f32 v183, v183, v207
    v_add_f32 v180, v180, v208
    v_add_f32 v181, v181, v209
    v_add_f32 v182, v182, v210
    v_add_f32 v183, v183, v211
    v_add_f32 v180, v180, v212
    v_add_f32 v181, v181, v213
    v_add_f32 v182, v182, v214
    v_add_f32 v183, v183, v215
pc_49:
    s_cmp_eq_u32 s60, 0
    s_cselect_b64 exec, -1, 0
    buffer_load_dwordx4 v[184:187], v224, s[24:27], s37 offen sc1
    s_add_u32 s37, s37, 28672
    buffer_load_dwordx4 v[188:191], v224, s[24:27], s37 offen sc1
    s_add_u32 s37, s37, 28672
    buffer_load_dwordx4 v[192:195], v224, s[24:27], s37 offen sc1
    s_add_u32 s37, s37, 28672
    s_mov_b64 exec, -1
    s_waitcnt vmcnt(19)
    s_barrier
    buffer_load_dwordx4 v2, s[12:15], s39 offen sc1 lds
    buffer_load_dwordx4 v2, s[12:15], s39 offen offset:1024 sc1 lds
    s_add_u32 m0, m0, 2048
    s_add_u32 s39, s39, 65536
    buffer_load_dwordx4 v2, s[12:15], s39 offen sc1 lds
    buffer_load_dwordx4 v2, s[12:15], s39 offen offset:1024 sc1 lds
    s_add_u32 s19, s41, s42
    v_readlane_b32 s16, v248, s44
    s_nop 0
    s_add_u32 s16, s16, s38
    s_add_u32 s44, s44, 1
    s_and_b32 s44, s44, 15
    s_add_u32 s42, s42, 16384
    s_cmp_eq_u32 s42, 49152
    s_cselect_b32 s42, 0, s42
    s_add_u32 m0, m0, 2048
    s_add_u32 s39, s39, 65536
    buffer_load_dwordx4 v2, s[12:15], s39 offen sc1 lds
    buffer_load_dwordx4 v2, s[12:15], s39 offen offset:1024 sc1 lds
    s_add_u32 m0, m0, 2048
    s_add_u32 s39, s39, 65536
    buffer_load_dwordx4 v2, s[12:15], s39 offen sc1 lds
    buffer_load_dwordx4 v2, s[12:15], s39 offen offset:1024 sc1 lds
    s_mov_b32 m0, s19
    s_mov_b32 s39, s16
    s_add_u32 s36, s35, 16384
    buffer_load_dwordx2 v[32:33], v221, s[20:23], s36 offen offset:0 sc1
    buffer_load_dwordx2 v[34:35], v221, s[20:23], s36 offen offset:1024 sc1
    buffer_load_dwordx2 v[36:37], v221, s[20:23], s36 offen offset:2048 sc1
    buffer_load_dwordx2 v[38:39], v221, s[20:23], s36 offen offset:3072 sc1
    s_cmp_eq_u32 s60, 0
    s_cselect_b64 exec, -1, 0
    buffer_load_dwordx4 v[196:199], v224, s[24:27], s37 offen sc1
    s_add_u32 s37, s37, 28672
    buffer_load_dwordx4 v[200:203], v224, s[24:27], s37 offen sc1
    s_add_u32 s37, s37, 28672
    s_mov_b64 exec, -1
    s_waitcnt vmcnt(21)
    s_barrier
    buffer_load_dwordx4 v2, s[12:15], s39 offen sc1 lds
    buffer_load_dwordx4 v2, s[12:15], s39 offen offset:1024 sc1 lds
    s_add_u32 m0, m0, 2048
    s_add_u32 s39, s39, 65536
    buffer_load_dwordx4 v2, s[12:15], s39 offen sc1 lds
    buffer_load_dwordx4 v2, s[12:15], s39 offen offset:1024 sc1 lds
    s_add_u32 s19, s41, s42
    v_readlane_b32 s16, v248, s44
    s_nop 0
    s_add_u32 s16, s16, s38
    s_add_u32 s44, s44, 1
    s_and_b32 s44, s44, 15
    s_add_u32 s42, s42, 16384
    s_cmp_eq_u32 s42, 49152
    s_cselect_b32 s42, 0, s42
    s_add_u32 m0, m0, 2048
    s_add_u32 s39, s39, 65536
    buffer_load_dwordx4 v2, s[12:15], s39 offen sc1 lds
    buffer_load_dwordx4 v2, s[12:15], s39 offen offset:1024 sc1 lds
    s_add_u32 m0, m0, 2048
    s_add_u32 s39, s39, 65536
    buffer_load_dwordx4 v2, s[12:15], s39 offen sc1 lds
    buffer_load_dwordx4 v2, s[12:15], s39 offen offset:1024 sc1 lds
    s_mov_b32 m0, s19
    s_mov_b32 s39, s16
    s_add_u32 s36, s35, 20480
    buffer_load_dwordx2 v[40:41], v221, s[20:23], s36 offen offset:0 sc1
    buffer_load_dwordx2 v[42:43], v221, s[20:23], s36 offen offset:1024 sc1
    buffer_load_dwordx2 v[44:45], v221, s[20:23], s36 offen offset:2048 sc1
    buffer_load_dwordx2 v[46:47], v221, s[20:23], s36 offen offset:3072 sc1
    s_cmp_eq_u32 s60, 0
    s_cselect_b64 exec, -1, 0
    buffer_load_dwordx4 v[204:207], v224, s[24:27], s37 offen sc1
    s_add_u32 s37, s37, 28672
    buffer_load_dwordx4 v[208:211], v224, s[24:27], s37 offen sc1
    s_add_u32 s37, s37, 28672
    s_mov_b64 exec, -1
    s_waitcnt vmcnt(20)
    s_barrier
    buffer_load_dwordx4 v2, s[12:15], s39 offen sc1 lds
    buffer_load_dwordx4 v2, s[12:15], s39 offen offset:1024 sc1 lds
    s_add_u32 m0, m0, 2048
    s_add_u32 s39, s39, 65536
    buffer_load_dwordx4 v2, s[12:15], s39 offen sc1 lds
    buffer_load_dwordx4 v2, s[12:15], s39 offen offset:1024 sc1 lds
    s_add_u32 s19, s41, s42
    v_readlane_b32 s16, v248, s44
    s_nop 0
    s_add_u32 s16, s16, s38
    s_add_u32 s44, s44, 1
    s_and_b32 s44, s44, 15
    s_add_u32 s42, s42, 16384
    s_cmp_eq_u32 s42, 49152
    s_cselect_b32 s42, 0, s42
    s_add_u32 m0, m0, 2048
    s_add_u32 s39, s39, 65536
    buffer_load_dwordx4 v2, s[12:15], s39 offen sc1 lds
    buffer_load_dwordx4 v2, s[12:15], s39 offen offset:1024 sc1 lds
    s_add_u32 m0, m0, 2048
    s_add_u32 s39, s39, 65536
    buffer_load_dwordx4 v2, s[12:15], s39 offen sc1 lds
    buffer_load_dwordx4 v2, s[12:15], s39 offen offset:1024 sc1 lds
    s_mov_b32 m0, s19
    s_mov_b32 s39, s16
    s_waitcnt vmcnt(14)
    s_barrier
    buffer_load_dwordx4 v2, s[12:15], s39 offen sc1 lds
    buffer_load_dwordx4 v2, s[12:15], s39 offen offset:1024 sc1 lds
    s_add_u32 m0, m0, 2048
    s_add_u32 s39, s39, 65536
    buffer_load_dwordx4 v2, s[12:15], s39 offen sc1 lds
    buffer_load_dwordx4 v2, s[12:15], s39 offen offset:1024 sc1 lds
    s_add_u32 s19, s41, s42
    v_readlane_b32 s16, v248, s44
    s_nop 0
    s_add_u32 s16, s16, s38
    s_add_u32 s44, s44, 1
    s_and_b32 s44, s44, 15
    s_add_u32 s42, s42, 16384
    s_cmp_eq_u32 s42, 49152
    s_cselect_b32 s42, 0, s42
    s_add_u32 m0, m0, 2048
    s_add_u32 s39, s39, 65536
    buffer_load_dwordx4 v2, s[12:15], s39 offen sc1 lds
    buffer_load_dwordx4 v2, s[12:15], s39 offen offset:1024 sc1 lds
    s_add_u32 m0, m0, 2048
    s_add_u32 s39, s39, 65536
    buffer_load_dwordx4 v2, s[12:15], s39 offen sc1 lds
    buffer_load_dwordx4 v2, s[12:15], s39 offen offset:1024 sc1 lds
    s_mov_b32 m0, s19
    s_mov_b32 s39, s16
    s_waitcnt vmcnt(16)
    v_add_f32 v16, v16, v32
    v_add_f32 v17, v17, v33
    v_add_f32 v18, v18, v34
    v_add_f32 v19, v19, v35
    v_add_f32 v20, v20, v36
    v_add_f32 v21, v21, v37
    v_add_f32 v22, v22, v38
    v_add_f32 v23, v23, v39
    v_add_f32 v24, v24, v40
    v_add_f32 v25, v25, v41
    v_add_f32 v26, v26, v42
    v_add_f32 v27, v27, v43
    v_add_f32 v28, v28, v44
    v_add_f32 v29, v29, v45
    v_add_f32 v30, v30, v46
    v_add_f32 v31, v31, v47
    s_waitcnt vmcnt(8)
    s_barrier
    buffer_load_dwordx4 v2, s[12:15], s39 offen sc1 lds
    buffer_load_dwordx4 v2, s[12:15], s39 offen offset:1024 sc1 lds
    s_add_u32 m0, m0, 2048
    s_add_u32 s39, s39, 65536
    buffer_load_dwordx4 v2, s[12:15], s39 offen sc1 lds
    buffer_load_dwordx4 v2, s[12:15], s39 offen offset:1024 sc1 lds
    s_add_u32 s19, s41, s42
    v_readlane_b32 s16, v248, s44
    s_nop 0
    s_add_u32 s16, s16, s38
    s_add_u32 s44, s44, 1
    s_and_b32 s44, s44, 15
    s_add_u32 s42, s42, 16384
    s_cmp_eq_u32 s42, 49152
    s_cselect_b32 s42, 0, s42
    s_add_u32 m0, m0, 2048
    s_add_u32 s39, s39, 65536
    buffer_load_dwordx4 v2, s[12:15], s39 offen sc1 lds
    buffer_load_dwordx4 v2, s[12:15], s39 offen offset:1024 sc1 lds
    s_add_u32 m0, m0, 2048
    s_add_u32 s39, s39, 65536
    buffer_load_dwordx4 v2, s[12:15], s39 offen sc1 lds
    buffer_load_dwordx4 v2, s[12:15], s39 offen offset:1024 sc1 lds
    s_mov_b32 m0, s19
    s_mov_b32 s39, s16
    v_add_f32 v16, v16, v24
    v_add_f32 v17, v17, v25
    v_add_f32 v18, v18, v26
    v_add_f32 v19, v19, v27
    v_add_f32 v20, v20, v28
    v_add_f32 v21, v21, v29
    v_add_f32 v22, v22, v30
    v_add_f32 v23, v23, v31
    v_add_f32 v16, v16, v20
    v_add_f32 v17, v17, v21
    v_add_f32 v18, v18, v22
    v_add_f32 v19, v19, v23
    v_add_f32 v16, v16, v18
    v_add_f32 v17, v17, v19
    v_mul_f32 v20, 0x3a800000, v16
    v_mul_f32 v217, 0x3a800000, v17
    s_cmp_lg_u32 s60, 0
    s_cbranch_scc1 pc_52
    v_add_f32 v180, v180, v184
    v_add_f32 v181, v181, v185
    v_add_f32 v182, v182, v186
    v_add_f32 v183, v183, v187
    v_add_f32 v180, v180, v188
    v_add_f32 v181, v181, v189
    v_add_f32 v182, v182, v190
    v_add_f32 v183, v183, v191
    v_add_f32 v180, v180, v192
    v_add_f32 v181, v181, v193
    v_add_f32 v182, v182, v194
    v_add_f32 v183, v183, v195
pc_52:
    s_waitcnt vmcnt(8)
    s_barrier
    buffer_load_dwordx4 v2, s[12:15], s39 offen sc1 lds
    buffer_load_dwordx4 v2, s[12:15], s39 offen offset:1024 sc1 lds
    s_add_u32 m0, m0, 2048
    s_add_u32 s39, s39, 65536
    buffer_load_dwordx4 v2, s[12:15], s39 offen sc1 lds
    buffer_load_dwordx4 v2, s[12:15], s39 offen offset:1024 sc1 lds
    s_add_u32 s19, s41, s42
    v_readlane_b32 s16, v248, s44
    s_nop 0
    s_add_u32 s16, s16, s38
    s_add_u32 s44, s44, 1
    s_and_b32 s44, s44, 15
    s_add_u32 s42, s42, 16384
    s_cmp_eq_u32 s42, 49152
    s_cselect_b32 s42, 0, s42
    s_add_u32 m0, m0, 2048
    s_add_u32 s39, s39, 65536
    buffer_load_dwordx4 v2, s[12:15], s39 offen sc1 lds
    buffer_load_dwordx4 v2, s[12:15], s39 offen offset:1024 sc1 lds
    s_add_u32 m0, m0, 2048
    s_add_u32 s39, s39, 65536
    buffer_load_dwordx4 v2, s[12:15], s39 offen sc1 lds
    buffer_load_dwordx4 v2, s[12:15], s39 offen offset:1024 sc1 lds
    s_mov_b32 m0, s19
    s_mov_b32 s39, s16
    v_fma_f32 v217, -v20, v20, v217
    v_max_f32 v217, 0, v217
    v_add_f32 v217, 0x3727c5ac, v217
    v_sqrt_f32 v217, v217
    s_nop 0
    v_mov_b32 v21, v217
    v_rcp_f32 v219, v217
    s_nop 0
    v_mul_f32 v22, 0xc0135761, v219
    v_mul_f32 v23, v219, v219
    v_mul_f32 v23, v23, v22
    v_mul_f32 v23, 0x3d372713, v23
    s_lshl_b32 s35, s35, 1
    s_add_u32 s35, s35, 160768
    v_add_u32 v220, s35, v2
    ds_write_b128 v220, v[20:23]
    s_waitcnt lgkmcnt(0)
    s_waitcnt vmcnt(8)
    s_barrier
    buffer_load_dwordx4 v2, s[12:15], s39 offen sc1 lds
    buffer_load_dwordx4 v2, s[12:15], s39 offen offset:1024 sc1 lds
    s_add_u32 m0, m0, 2048
    s_add_u32 s39, s39, 65536
    buffer_load_dwordx4 v2, s[12:15], s39 offen sc1 lds
    buffer_load_dwordx4 v2, s[12:15], s39 offen offset:1024 sc1 lds
    s_add_u32 m0, m0, 2048
    s_add_u32 s39, s39, 65536
    buffer_load_dwordx4 v2, s[12:15], s39 offen sc1 lds
    buffer_load_dwordx4 v2, s[12:15], s39 offen offset:1024 sc1 lds
    s_add_u32 m0, m0, 2048
    s_add_u32 s39, s39, 65536
    buffer_load_dwordx4 v2, s[12:15], s39 offen sc1 lds
    buffer_load_dwordx4 v2, s[12:15], s39 offen offset:1024 sc1 lds
    s_cmp_lg_u32 s60, 0
    s_cbranch_scc1 pc_54
    v_add_f32 v180, v180, v196
    v_add_f32 v181, v181, v197
    v_add_f32 v182, v182, v198
    v_add_f32 v183, v183, v199
    v_add_f32 v180, v180, v200
    v_add_f32 v181, v181, v201
    v_add_f32 v182, v182, v202
    v_add_f32 v183, v183, v203
    v_add_f32 v180, v180, v204
    v_add_f32 v181, v181, v205
    v_add_f32 v182, v182, v206
    v_add_f32 v183, v183, v207
    v_add_f32 v180, v180, v208
    v_add_f32 v181, v181, v209
    v_add_f32 v182, v182, v210
    v_add_f32 v183, v183, v211
pc_54:
    s_waitcnt vmcnt(8)
    s_barrier
    s_cmp_lg_u32 s60, 0
    s_cbranch_scc1 pc_55
    v_mov_b32 v184, v180
    v_mov_b32 v185, v181
    v_mov_b32 v186, v182
    v_mov_b32 v187, v183
    v_permlane32_swap_b32 v180, v184
    v_permlane32_swap_b32 v181, v185
    v_permlane32_swap_b32 v182, v186
    v_permlane32_swap_b32 v183, v187
    v_add_f32 v180, v180, v184
    v_add_f32 v181, v181, v185
    v_add_f32 v182, v182, v186
    v_add_f32 v183, v183, v187
    s_and_b32 s36, s30, 1
    s_mul_i32 s36, s36, 448
    s_add_u32 s36, s36, 159744
    v_add_u32 v179, s36, v2
    s_bfm_b64 exec, 28, 0
    ds_write_b128 v179, v[180:183]
    s_mov_b64 exec, -1
    s_waitcnt lgkmcnt(0)
pc_55:
    s_waitcnt vmcnt(0)
    s_barrier
    s_cmp_lg_u32 s60, 0
    s_cbranch_scc1 tw4_56
    s_load_dwordx2 s[48:49], s[0:1], 80
    s_lshl_b32 s45, s2, 1
    s_and_b32 s50, s30, 1
    s_add_u32 s45, s45, s50
    s_mul_i32 s45, s45, 14336
    s_mov_b32 s50, 7340032
    s_mov_b32 s51, 0x20000
    s_waitcnt lgkmcnt(0)
    buffer_load_dwordx4 v[20:23], v2, s[48:51], s45 offen offset:0
    buffer_load_dwordx4 v[20:23], v2, s[48:51], s45 offen offset:1024
    buffer_load_dwordx4 v[20:23], v2, s[48:51], s45 offen offset:2048
    buffer_load_dwordx4 v[20:23], v2, s[48:51], s45 offen offset:3072
    s_add_u32 s45, s45, 4096
    buffer_load_dwordx4 v[20:23], v2, s[48:51], s45 offen offset:0
    buffer_load_dwordx4 v[20:23], v2, s[48:51], s45 offen offset:1024
    buffer_load_dwordx4 v[20:23], v2, s[48:51], s45 offen offset:2048
    buffer_load_dwordx4 v[20:23], v2, s[48:51], s45 offen offset:3072
    s_add_u32 s45, s45, 4096
    buffer_load_dwordx4 v[20:23], v2, s[48:51], s45 offen offset:0
    buffer_load_dwordx4 v[20:23], v2, s[48:51], s45 offen offset:1024
    buffer_load_dwordx4 v[20:23], v2, s[48:51], s45 offen offset:2048
    buffer_load_dwordx4 v[20:23], v2, s[48:51], s45 offen offset:3072
    s_add_u32 s45, s45, 4096
    buffer_load_dwordx4 v[20:23], v2, s[48:51], s45 offen offset:0
    buffer_load_dwordx4 v[20:23], v2, s[48:51], s45 offen offset:1024
tw4_56:
    s_barrier
    s_cmp_lg_u32 s60, 0
    s_cbranch_scc1 rp_57
    s_call_b64 s[76:77], SUB_r_pre
rp_57:
    s_and_b32 s35, s30, 1
    s_add_u32 s12, s62, 0x400000
    s_addc_u32 s13, s63, 0
    s_mov_b32 s14, 0x1be000
    s_mov_b32 s15, 0x20000
    s_mul_i32 s38, s35, 917504
    s_mul_i32 s36, s31, 114688
    s_add_u32 s38, s38, s36
    s_lshl_b32 s41, s35, 13
    s_mov_b32 s42, 0
    s_mov_b32 s44, 0
    s_add_u32 s54, s55, 0x700
    s_lshl_b32 s53, s31, 7
    s_add_u32 s54, s54, s53
    v_mov_b32 v9, s54
    s_add_u32 s54, s55, 0x600
    s_lshl_b32 s53, s31, 7
    s_add_u32 s54, s54, s53
    v_mov_b32 v10, s54
    s_add_u32 s54, s55, 0x300
    s_lshl_b32 s53, s31, 7
    s_add_u32 s54, s54, s53
    v_mov_b32 v12, s54
    v_mov_b32 v13, 1
    s_and_b32 s51, s30, 1
    s_lshl_b32 s51, s51, 30
    s_lshl_b32 s54, s60, 2
    s_add_u32 s54, s54, 4
    v_mov_b32 v14, 162880
spin_58:
    s_sleep 2
    ds_read_b32 v15, v14
    s_waitcnt lgkmcnt(0)
    v_readfirstlane_b32 s53, v15
    s_nop 0
    s_cmp_ge_u32 s53, s54
    s_cbranch_scc0 spin_58
    s_mov_b64 exec, 1
    buffer_atomic_add v13, v9, s[56:59], s51 offen sc1
    s_mov_b64 exec, -1
    v_xor_b32 v15, 128, v12
    s_mov_b32 s44, 3
    s_call_b64 s[76:77], PREP_a_issue_4
    s_mov_b32 m0, s19
    s_mov_b32 s39, s16
    s_mov_b32 s40, s17
    s_waitcnt vmcnt(16)
    s_barrier
    s_mov_b64 exec, 1
    buffer_load_dword v8, v9, s[56:59], 0 offen sc1
    s_mov_b64 exec, -1
    s_waitcnt vmcnt(9)
    s_barrier
    s_waitcnt vmcnt(0)
    v_readfirstlane_b32 s53, v8
    s_add_u32 s54, s52, 8
    s_cmp_eq_u32 s53, s54
    s_cbranch_scc1 fok_59
    s_mov_b32 s53, 0
    s_add_u32 s54, s52, 8
    s_bfm_b64 exec, 1, 0
poll_60:
    buffer_load_dword v8, v9, s[56:59], 0 offen sc1
    s_waitcnt vmcnt(0)
    v_xor_b32 v8, s54, v8
    v_cmp_eq_u32 vcc, 0, v8
    s_nop 0
    s_cmp_eq_u64 vcc, exec
    s_cbranch_scc1 pok_61
    s_sleep 5
    s_add_u32 s53, s53, 1
    s_cmp_lt_u32 s53, s61
    s_cbranch_scc1 poll_60
    s_mov_b32 s61, 0
pok_61:
    s_mov_b64 exec, -1
fok_59:
    buffer_load_dwordx4 v2, s[12:15], s39 offen sc1 lds
    s_add_u32 m0, m0, 1024
    s_nop 0
    buffer_load_dwordx4 v2, s[12:15], s40 offen sc1 lds
    s_add_u32 m0, m0, 1024
    s_add_u32 s39, s39, 229376
    buffer_load_dwordx4 v2, s[12:15], s39 offen sc1 lds
    s_add_u32 m0, m0, 1024
    s_add_u32 s40, s40, 229376
    buffer_load_dwordx4 v2, s[12:15], s40 offen sc1 lds
    s_call_b64 s[76:77], PREP_a_issue_4
    s_add_u32 m0, m0, 1024
    s_add_u32 s39, s39, 229376
    buffer_load_dwordx4 v2, s[12:15], s39 offen sc1 lds
    s_add_u32 m0, m0, 1024
    s_add_u32 s40, s40, 229376
    buffer_load_dwordx4 v2, s[12:15], s40 offen sc1 lds
    s_add_u32 m0, m0, 1024
    s_add_u32 s39, s39, 229376
    buffer_load_dwordx4 v2, s[12:15], s39 offen sc1 lds
    s_add_u32 m0, m0, 1024
    s_add_u32 s40, s40, 229376
    buffer_load_dwordx4 v2, s[12:15], s40 offen sc1 lds
    s_mov_b32 m0, s19
    s_mov_b32 s39, s16
    s_mov_b32 s40, s17
    s_waitcnt vmcnt(9)
    s_barrier
    s_mov_b64 exec, 1
    buffer_atomic_add v13, v10, s[56:59], s51 offen sc1
    s_mov_b64 exec, -1
    buffer_load_dwordx4 v2, s[12:15], s39 offen sc1 lds
    s_add_u32 m0, m0, 1024
    s_nop 0
    buffer_load_dwordx4 v2, s[12:15], s40 offen sc1 lds
    s_add_u32 m0, m0, 1024
    s_add_u32 s39, s39, 229376
    buffer_load_dwordx4 v2, s[12:15], s39 offen sc1 lds
    s_add_u32 m0, m0, 1024
    s_add_u32 s40, s40, 229376
    buffer_load_dwordx4 v2, s[12:15], s40 offen sc1 lds
    s_call_b64 s[76:77], PREP_a_issue_4
    s_add_u32 m0, m0, 1024
    s_add_u32 s39, s39, 229376
    buffer_load_dwordx4 v2, s[12:15], s39 offen sc1 lds
    s_add_u32 m0, m0, 1024
    s_add_u32 s40, s40, 229376
    buffer_load_dwordx4 v2, s[12:15], s40 offen sc1 lds
    s_add_u32 m0, m0, 1024
    s_add_u32 s39, s39, 229376
    buffer_load_dwordx4 v2, s[12:15], s39 offen sc1 lds
    s_add_u32 m0, m0, 1024
    s_add_u32 s40, s40, 229376
    buffer_load_dwordx4 v2, s[12:15], s40 offen sc1 lds
    s_mov_b32 m0, s19
    s_mov_b32 s39, s16
    s_mov_b32 s40, s17
    s_waitcnt vmcnt(9)
    s_barrier
    buffer_load_dwordx4 v2, s[12:15], s39 offen sc1 lds
    s_add_u32 m0, m0, 1024
    s_nop 0
    buffer_load_dwordx4 v2, s[12:15], s40 offen sc1 lds
    s_add_u32 m0, m0, 1024
    s_add_u32 s39, s39, 229376
    buffer_load_dwordx4 v2, s[12:15], s39 offen sc1 lds
    s_add_u32 m0, m0, 1024
    s_add_u32 s40, s40, 229376
    buffer_load_dwordx4 v2, s[12:15], s40 offen sc1 lds
    s_call_b64 s[76:77], PREP_a_issue_4
    s_add_u32 m0, m0, 1024
    s_add_u32 s39, s39, 229376
    buffer_load_dwordx4 v2, s[12:15], s39 offen sc1 lds
    s_add_u32 m0, m0, 1024
    s_add_u32 s40, s40, 229376
    buffer_load_dwordx4 v2, s[12:15], s40 offen sc1 lds
    s_add_u32 m0, m0, 1024
    s_add_u32 s39, s39, 229376
    buffer_load_dwordx4 v2, s[12:15], s39 offen sc1 lds
    s_add_u32 m0, m0, 1024
    s_add_u32 s40, s40, 229376
    buffer_load_dwordx4 v2, s[12:15], s40 offen sc1 lds
    s_mov_b32 m0, s19
    s_mov_b32 s39, s16
    s_mov_b32 s40, s17
    s_waitcnt vmcnt(8)
    s_barrier
    buffer_load_dwordx4 v2, s[12:15], s39 offen sc1 lds
    s_add_u32 m0, m0, 1024
    s_nop 0
    buffer_load_dwordx4 v2, s[12:15], s40 offen sc1 lds
    s_add_u32 m0, m0, 1024
    s_add_u32 s39, s39, 229376
    buffer_load_dwordx4 v2, s[12:15], s39 offen sc1 lds
    s_add_u32 m0, m0, 1024
    s_add_u32 s40, s40, 229376
    buffer_load_dwordx4 v2, s[12:15], s40 offen sc1 lds
    s_mov_b64 exec, 1
    buffer_load_dword v11, v10, s[56:59], 0 offen sc1
    s_mov_b64 exec, -1
    s_call_b64 s[76:77], PREP_a_issue_4
    s_add_u32 m0, m0, 1024
    s_add_u32 s39, s39, 229376
    buffer_load_dwordx4 v2, s[12:15], s39 offen sc1 lds
    s_add_u32 m0, m0, 1024
    s_add_u32 s40, s40, 229376
    buffer_load_dwordx4 v2, s[12:15], s40 offen sc1 lds
    s_add_u32 m0, m0, 1024
    s_add_u32 s39, s39, 229376
    buffer_load_dwordx4 v2, s[12:15], s39 offen sc1 lds
    s_add_u32 m0, m0, 1024
    s_add_u32 s40, s40, 229376
    buffer_load_dwordx4 v2, s[12:15], s40 offen sc1 lds
    s_mov_b32 m0, s19
    s_mov_b32 s39, s16
    s_mov_b32 s40, s17
    s_waitcnt vmcnt(9)
    s_barrier
    s_mov_b64 exec, 1
    buffer_atomic_add v13, v12, s[56:59], s51 offen sc1
    s_mov_b64 exec, -1
    buffer_load_dwordx4 v2, s[12:15], s39 offen sc1 lds
    s_add_u32 m0, m0, 1024
    s_nop 0
    buffer_load_dwordx4 v2, s[12:15], s40 offen sc1 lds
    s_add_u32 m0, m0, 1024
    s_add_u32 s39, s39, 229376
    buffer_load_dwordx4 v2, s[12:15], s39 offen sc1 lds
    s_add_u32 m0, m0, 1024
    s_add_u32 s40, s40, 229376
    buffer_load_dwordx4 v2, s[12:15], s40 offen sc1 lds
    s_call_b64 s[76:77], PREP_a_issue_4
    s_add_u32 m0, m0, 1024
    s_add_u32 s39, s39, 229376
    buffer_load_dwordx4 v2, s[12:15], s39 offen sc1 lds
    s_add_u32 m0, m0, 1024
    s_add_u32 s40, s40, 229376
    buffer_load_dwordx4 v2, s[12:15], s40 offen sc1 lds
    s_add_u32 m0, m0, 1024
    s_add_u32 s39, s39, 229376
    buffer_load_dwordx4 v2, s[12:15], s39 offen sc1 lds
    s_add_u32 m0, m0, 1024
    s_add_u32 s40, s40, 229376
    buffer_load_dwordx4 v2, s[12:15], s40 offen sc1 lds
    s_mov_b32 m0, s19
    s_mov_b32 s39, s16
    s_mov_b32 s40, s17
    s_waitcnt vmcnt(9)
    s_barrier
    buffer_load_dwordx4 v2, s[12:15], s39 offen sc1 lds
    s_add_u32 m0, m0, 1024
    s_nop 0
    buffer_load_dwordx4 v2, s[12:15], s40 offen sc1 lds
    s_add_u32 m0, m0, 1024
    s_add_u32 s39, s39, 229376
    buffer_load_dwordx4 v2, s[12:15], s39 offen sc1 lds
    s_add_u32 m0, m0, 1024
    s_add_u32 s40, s40, 229376
    buffer_load_dwordx4 v2, s[12:15], s40 offen sc1 lds
    s_waitcnt vmcnt(17)
    v_readfirstlane_b32 s53, v11
    s_add_u32 s54, s52, 8
    s_cmp_eq_u32 s53, s54
    s_cbranch_scc1 fok_62
    s_mov_b32 s53, 0
    s_add_u32 s54, s52, 8
    s_bfm_b64 exec, 1, 0
poll_63:
    buffer_load_dword v11, v10, s[56:59], 0 offen sc1
    s_waitcnt vmcnt(0)
    v_xor_b32 v11, s54, v11
    v_cmp_eq_u32 vcc, 0, v11
    s_nop 0
    s_cmp_eq_u64 vcc, exec
    s_cbranch_scc1 pok_64
    s_sleep 5
    s_add_u32 s53, s53, 1
    s_cmp_lt_u32 s53, s61
    s_cbranch_scc1 poll_63
    s_mov_b32 s61, 0
pok_64:
    s_mov_b64 exec, -1
fok_62:
    s_call_b64 s[76:77], PREP_a_issue_4
    s_add_u32 m0, m0, 1024
    s_add_u32 s39, s39, 229376
    buffer_load_dwordx4 v2, s[12:15], s39 offen sc1 lds
    s_add_u32 m0, m0, 1024
    s_add_u32 s40, s40, 229376
    buffer_load_dwordx4 v2, s[12:15], s40 offen sc1 lds
    s_add_u32 m0, m0, 1024
    s_add_u32 s39, s39, 229376
    buffer_load_dwordx4 v2, s[12:15], s39 offen sc1 lds
    s_add_u32 m0, m0, 1024
    s_add_u32 s40, s40, 229376
    buffer_load_dwordx4 v2, s[12:15], s40 offen sc1 lds
    s_mov_b32 m0, s19
    s_mov_b32 s39, s16
    s_mov_b32 s40, s17
    s_waitcnt vmcnt(8)
    s_barrier
    buffer_load_dwordx4 v2, s[12:15], s39 offen sc1 lds
    s_add_u32 m0, m0, 1024
    s_nop 0
    buffer_load_dwordx4 v2, s[12:15], s40 offen sc1 lds
    s_add_u32 m0, m0, 1024
    s_add_u32 s39, s39, 229376
    buffer_load_dwordx4 v2, s[12:15], s39 offen sc1 lds
    s_add_u32 m0, m0, 1024
    s_add_u32 s40, s40, 229376
    buffer_load_dwordx4 v2, s[12:15], s40 offen sc1 lds
    s_mov_b32 s43, 1
ld_65:
    s_add_u32 s19, s41, s42
    v_readlane_b32 s16, v249, s44
    v_readlane_b32 s17, v250, s44
    s_add_u32 s16, s16, s38
    s_add_u32 s17, s17, s38
    s_add_u32 s44, s44, 1
    s_add_u32 s42, s42, 16384
    s_cmp_eq_u32 s42, 49152
    s_cselect_b32 s42, 0, s42
    s_add_u32 m0, m0, 1024
    s_add_u32 s39, s39, 229376
    buffer_load_dwordx4 v2, s[12:15], s39 offen sc1 lds
    s_add_u32 m0, m0, 1024
    s_add_u32 s40, s40, 229376
    buffer_load_dwordx4 v2, s[12:15], s40 offen sc1 lds
    s_add_u32 m0, m0, 1024
    s_add_u32 s39, s39, 229376
    buffer_load_dwordx4 v2, s[12:15], s39 offen sc1 lds
    s_add_u32 m0, m0, 1024
    s_add_u32 s40, s40, 229376
    buffer_load_dwordx4 v2, s[12:15], s40 offen sc1 lds
    s_mov_b32 m0, s19
    s_mov_b32 s39, s16
    s_mov_b32 s40, s17
    s_waitcnt vmcnt(8)
    s_barrier
    buffer_load_dwordx4 v2, s[12:15], s39 offen sc1 lds
    s_add_u32 m0, m0, 1024
    s_nop 0
    buffer_load_dwordx4 v2, s[12:15], s40 offen sc1 lds
    s_add_u32 m0, m0, 1024
    s_add_u32 s39, s39, 229376
    buffer_load_dwordx4 v2, s[12:15], s39 offen sc1 lds
    s_add_u32 m0, m0, 1024
    s_add_u32 s40, s40, 229376
    buffer_load_dwordx4 v2, s[12:15], s40 offen sc1 lds
    s_add_u32 s43, s43, 1
    s_cmp_lt_u32 s43, 4
    s_cbranch_scc1 ld_65
    s_call_b64 s[76:77], PREP_a_issue_4
    s_add_u32 m0, m0, 1024
    s_add_u32 s39, s39, 229376
    buffer_load_dwordx4 v2, s[12:15], s39 offen sc1 lds
    s_add_u32 m0, m0, 1024
    s_add_u32 s40, s40, 229376
    buffer_load_dwordx4 v2, s[12:15], s40 offen sc1 lds
    s_add_u32 m0, m0, 1024
    s_add_u32 s39, s39, 229376
    buffer_load_dwordx4 v2, s[12:15], s39 offen sc1 lds
    s_add_u32 m0, m0, 1024
    s_add_u32 s40, s40, 229376
    buffer_load_dwordx4 v2, s[12:15], s40 offen sc1 lds
    s_mov_b32 m0, s19
    s_mov_b32 s39, s16
    s_mov_b32 s40, s17
    s_waitcnt vmcnt(8)
    s_barrier
    buffer_load_dwordx4 v2, s[12:15], s39 offen sc1 lds
    s_add_u32 m0, m0, 1024
    s_nop 0
    buffer_load_dwordx4 v2, s[12:15], s40 offen sc1 lds
    s_add_u32 m0, m0, 1024
    s_add_u32 s39, s39, 229376
    buffer_load_dwordx4 v2, s[12:15], s39 offen sc1 lds
    s_add_u32 m0, m0, 1024
    s_add_u32 s40, s40, 229376
    buffer_load_dwordx4 v2, s[12:15], s40 offen sc1 lds
    s_mov_b64 exec, 1
    buffer_load_dword v11, v12, s[56:59], 0 offen sc1
    s_mov_b64 exec, -1
    s_call_b64 s[76:77], PREP_a_issue_4
    s_add_u32 m0, m0, 1024
    s_add_u32 s39, s39, 229376
    buffer_load_dwordx4 v2, s[12:15], s39 offen sc1 lds
    s_add_u32 m0, m0, 1024
    s_add_u32 s40, s40, 229376
    buffer_load_dwordx4 v2, s[12:15], s40 offen sc1 lds
    s_add_u32 m0, m0, 1024
    s_add_u32 s39, s39, 229376
    buffer_load_dwordx4 v2, s[12:15], s39 offen sc1 lds
    s_add_u32 m0, m0, 1024
    s_add_u32 s40, s40, 229376
    buffer_load_dwordx4 v2, s[12:15], s40 offen sc1 lds
    s_mov_b32 m0, s19
    s_mov_b32 s39, s16
    s_mov_b32 s40, s17
    s_waitcnt vmcnt(9)
    s_barrier
    buffer_load_dwordx4 v2, s[12:15], s39 offen sc1 lds
    s_add_u32 m0, m0, 1024
    s_nop 0
    buffer_load_dwordx4 v2, s[12:15], s40 offen sc1 lds
    s_add_u32 m0, m0, 1024
    s_add_u32 s39, s39, 229376
    buffer_load_dwordx4 v2, s[12:15], s39 offen sc1 lds
    s_add_u32 m0, m0, 1024
    s_add_u32 s40, s40, 229376
    buffer_load_dwordx4 v2, s[12:15], s40 offen sc1 lds
    s_call_b64 s[76:77], PREP_a_issue_4
    s_add_u32 m0, m0, 1024
    s_add_u32 s39, s39, 229376
    buffer_load_dwordx4 v2, s[12:15], s39 offen sc1 lds
    s_add_u32 m0, m0, 1024
    s_add_u32 s40, s40, 229376
    buffer_load_dwordx4 v2, s[12:15], s40 offen sc1 lds
    s_add_u32 m0, m0, 1024
    s_add_u32 s39, s39, 229376
    buffer_load_dwordx4 v2, s[12:15], s39 offen sc1 lds
    s_add_u32 m0, m0, 1024
    s_add_u32 s40, s40, 229376
    buffer_load_dwordx4 v2, s[12:15], s40 offen sc1 lds
    s_mov_b32 m0, s19
    s_mov_b32 s39, s16
    s_mov_b32 s40, s17
    s_waitcnt vmcnt(8)
    s_barrier
    buffer_load_dwordx4 v2, s[12:15], s39 offen sc1 lds
    s_add_u32 m0, m0, 1024
    s_nop 0
    buffer_load_dwordx4 v2, s[12:15], s40 offen sc1 lds
    s_add_u32 m0, m0, 1024
    s_add_u32 s39, s39, 229376
    buffer_load_dwordx4 v2, s[12:15], s39 offen sc1 lds
    s_add_u32 m0, m0, 1024
    s_add_u32 s40, s40, 229376
    buffer_load_dwordx4 v2, s[12:15], s40 offen sc1 lds
    s_waitcnt vmcnt(16)
    v_readfirstlane_b32 s53, v11
    s_add_u32 s54, s52, 8
    s_cmp_eq_u32 s53, s54
    s_cbranch_scc1 fok_66
    s_mov_b32 s53, 0
    s_add_u32 s54, s52, 8
    s_bfm_b64 exec, 1, 0
poll_67:
    buffer_load_dword v11, v12, s[56:59], 0 offen sc1
    s_waitcnt vmcnt(0)
    v_xor_b32 v11, s54, v11
    v_cmp_eq_u32 vcc, 0, v11
    s_nop 0
    s_cmp_eq_u64 vcc, exec
    s_cbranch_scc1 pok_68
    s_sleep 5
    s_add_u32 s53, s53, 1
    s_cmp_lt_u32 s53, s61
    s_cbranch_scc1 poll_67
    s_mov_b32 s61, 0
pok_68:
    s_mov_b64 exec, -1
fok_66:
    s_call_b64 s[76:77], PREP_a_issue_4
    s_add_u32 m0, m0, 1024
    s_add_u32 s39, s39, 229376
    buffer_load_dwordx4 v2, s[12:15], s39 offen sc1 lds
    s_add_u32 m0, m0, 1024
    s_add_u32 s40, s40, 229376
    buffer_load_dwordx4 v2, s[12:15], s40 offen sc1 lds
    s_add_u32 m0, m0, 1024
    s_add_u32 s39, s39, 229376
    buffer_load_dwordx4 v2, s[12:15], s39 offen sc1 lds
    s_add_u32 m0, m0, 1024
    s_add_u32 s40, s40, 229376
    buffer_load_dwordx4 v2, s[12:15], s40 offen sc1 lds
    s_mov_b32 m0, s19
    s_mov_b32 s39, s16
    s_mov_b32 s40, s17
    s_waitcnt vmcnt(8)
    s_barrier
    buffer_load_dwordx4 v2, s[12:15], s39 offen sc1 lds
    s_add_u32 m0, m0, 1024
    s_nop 0
    buffer_load_dwordx4 v2, s[12:15], s40 offen sc1 lds
    s_add_u32 m0, m0, 1024
    s_add_u32 s39, s39, 229376
    buffer_load_dwordx4 v2, s[12:15], s39 offen sc1 lds
    s_add_u32 m0, m0, 1024
    s_add_u32 s40, s40, 229376
    buffer_load_dwordx4 v2, s[12:15], s40 offen sc1 lds
    s_mov_b32 s43, 1
ld_69:
    s_add_u32 s19, s41, s42
    v_readlane_b32 s16, v249, s44
    v_readlane_b32 s17, v250, s44
    s_add_u32 s16, s16, s38
    s_add_u32 s17, s17, s38
    s_add_u32 s44, s44, 1
    s_add_u32 s42, s42, 16384
    s_cmp_eq_u32 s42, 49152
    s_cselect_b32 s42, 0, s42
    s_add_u32 m0, m0, 1024
    s_add_u32 s39, s39, 229376
    buffer_load_dwordx4 v2, s[12:15], s39 offen sc1 lds
    s_add_u32 m0, m0, 1024
    s_add_u32 s40, s40, 229376
    buffer_load_dwordx4 v2, s[12:15], s40 offen sc1 lds
    s_add_u32 m0, m0, 1024
    s_add_u32 s39, s39, 229376
    buffer_load_dwordx4 v2, s[12:15], s39 offen sc1 lds
    s_add_u32 m0, m0, 1024
    s_add_u32 s40, s40, 229376
    buffer_load_dwordx4 v2, s[12:15], s40 offen sc1 lds
    s_mov_b32 m0, s19
    s_mov_b32 s39, s16
    s_mov_b32 s40, s17
    s_waitcnt vmcnt(8)
    s_barrier
    buffer_load_dwordx4 v2, s[12:15], s39 offen sc1 lds
    s_add_u32 m0, m0, 1024
    s_nop 0
    buffer_load_dwordx4 v2, s[12:15], s40 offen sc1 lds
    s_add_u32 m0, m0, 1024
    s_add_u32 s39, s39, 229376
    buffer_load_dwordx4 v2, s[12:15], s39 offen sc1 lds
    s_add_u32 m0, m0, 1024
    s_add_u32 s40, s40, 229376
    buffer_load_dwordx4 v2, s[12:15], s40 offen sc1 lds
    s_add_u32 s43, s43, 1
    s_cmp_lt_u32 s43, 5
    s_cbranch_scc1 ld_69
    s_call_b64 s[76:77], PREP_a_issue_4
    s_add_u32 m0, m0, 1024
    s_add_u32 s39, s39, 229376
    buffer_load_dwordx4 v2, s[12:15], s39 offen sc1 lds
    s_add_u32 m0, m0, 1024
    s_add_u32 s40, s40, 229376
    buffer_load_dwordx4 v2, s[12:15], s40 offen sc1 lds
    s_add_u32 m0, m0, 1024
    s_add_u32 s39, s39, 229376
    buffer_load_dwordx4 v2, s[12:15], s39 offen sc1 lds
    s_add_u32 m0, m0, 1024
    s_add_u32 s40, s40, 229376
    buffer_load_dwordx4 v2, s[12:15], s40 offen sc1 lds
    s_mov_b32 m0, s19
    s_mov_b32 s39, s16
    s_mov_b32 s40, s17
    s_waitcnt vmcnt(8)
    s_barrier
    buffer_load_dwordx4 v2, s[12:15], s39 offen sc1 lds
    s_add_u32 m0, m0, 1024
    s_nop 0
    buffer_load_dwordx4 v2, s[12:15], s40 offen sc1 lds
    s_add_u32 m0, m0, 1024
    s_add_u32 s39, s39, 229376
    buffer_load_dwordx4 v2, s[12:15], s39 offen sc1 lds
    s_add_u32 m0, m0, 1024
    s_add_u32 s40, s40, 229376
    buffer_load_dwordx4 v2, s[12:15], s40 offen sc1 lds
    s_mov_b64 exec, 1
    buffer_load_dword v11, v15, s[56:59], 0 offen sc1
    s_mov_b64 exec, -1
    s_call_b64 s[76:77], PREP_a_issue_4
    s_add_u32 m0, m0, 1024
    s_add_u32 s39, s39, 229376
    buffer_load_dwordx4 v2, s[12:15], s39 offen sc1 lds
    s_add_u32 m0, m0, 1024
    s_add_u32 s40, s40, 229376
    buffer_load_dwordx4 v2, s[12:15], s40 offen sc1 lds
    s_add_u32 m0, m0, 1024
    s_add_u32 s39, s39, 229376
    buffer_load_dwordx4 v2, s[12:15], s39 offen sc1 lds
    s_add_u32 m0, m0, 1024
    s_add_u32 s40, s40, 229376
    buffer_load_dwordx4 v2, s[12:15], s40 offen sc1 lds
    s_mov_b32 m0, s19
    s_mov_b32 s39, s16
    s_mov_b32 s40, s17
    s_waitcnt vmcnt(9)
    s_barrier
    buffer_load_dwordx4 v2, s[12:15], s39 offen sc1 lds
    s_add_u32 m0, m0, 1024
    s_nop 0
    buffer_load_dwordx4 v2, s[12:15], s40 offen sc1 lds
    s_add_u32 m0, m0, 1024
    s_add_u32 s39, s39, 229376
    buffer_load_dwordx4 v2, s[12:15], s39 offen sc1 lds
    s_add_u32 m0, m0, 1024
    s_add_u32 s40, s40, 229376
    buffer_load_dwordx4 v2, s[12:15], s40 offen sc1 lds
    s_call_b64 s[76:77], PREP_a_issue_4
    s_add_u32 m0, m0, 1024
    s_add_u32 s39, s39, 229376
    buffer_load_dwordx4 v2, s[12:15], s39 offen sc1 lds
    s_add_u32 m0, m0, 1024
    s_add_u32 s40, s40, 229376
    buffer_load_dwordx4 v2, s[12:15], s40 offen sc1 lds
    s_add_u32 m0, m0, 1024
    s_add_u32 s39, s39, 229376
    buffer_load_dwordx4 v2, s[12:15], s39 offen sc1 lds
    s_add_u32 m0, m0, 1024
    s_add_u32 s40, s40, 229376
    buffer_load_dwordx4 v2, s[12:15], s40 offen sc1 lds
    s_mov_b32 m0, s19
    s_mov_b32 s39, s16
    s_mov_b32 s40, s17
    s_waitcnt vmcnt(8)
    s_barrier
    buffer_load_dwordx4 v2, s[12:15], s39 offen sc1 lds
    s_add_u32 m0, m0, 1024
    s_nop 0
    buffer_load_dwordx4 v2, s[12:15], s40 offen sc1 lds
    s_add_u32 m0, m0, 1024
    s_add_u32 s39, s39, 229376
    buffer_load_dwordx4 v2, s[12:15], s39 offen sc1 lds
    s_add_u32 m0, m0, 1024
    s_add_u32 s40, s40, 229376
    buffer_load_dwordx4 v2, s[12:15], s40 offen sc1 lds
    s_waitcnt vmcnt(16)
    v_readfirstlane_b32 s53, v11
    s_add_u32 s54, s52, 8
    s_cmp_eq_u32 s53, s54
    s_cbranch_scc1 fok_70
    s_mov_b32 s53, 0
    s_add_u32 s54, s52, 8
    s_bfm_b64 exec, 1, 0
poll_71:
    buffer_load_dword v11, v15, s[56:59], 0 offen sc1
    s_waitcnt vmcnt(0)
    v_xor_b32 v11, s54, v11
    v_cmp_eq_u32 vcc, 0, v11
    s_nop 0
    s_cmp_eq_u64 vcc, exec
    s_cbranch_scc1 pok_72
    s_sleep 5
    s_add_u32 s53, s53, 1
    s_cmp_lt_u32 s53, s61
    s_cbranch_scc1 poll_71
    s_mov_b32 s61, 0
pok_72:
    s_mov_b64 exec, -1
fok_70:
    s_call_b64 s[76:77], PREP_a_issue_4
    s_add_u32 m0, m0, 1024
    s_add_u32 s39, s39, 229376
    buffer_load_dwordx4 v2, s[12:15], s39 offen sc1 lds
    s_add_u32 m0, m0, 1024
    s_add_u32 s40, s40, 229376
    buffer_load_dwordx4 v2, s[12:15], s40 offen sc1 lds
    s_add_u32 m0, m0, 1024
    s_add_u32 s39, s39, 229376
    buffer_load_dwordx4 v2, s[12:15], s39 offen sc1 lds
    s_add_u32 m0, m0, 1024
    s_add_u32 s40, s40, 229376
    buffer_load_dwordx4 v2, s[12:15], s40 offen sc1 lds
    s_mov_b32 m0, s19
    s_mov_b32 s39, s16
    s_mov_b32 s40, s17
    s_waitcnt vmcnt(8)
    s_barrier
    buffer_load_dwordx4 v2, s[12:15], s39 offen sc1 lds
    s_add_u32 m0, m0, 1024
    s_nop 0
    buffer_load_dwordx4 v2, s[12:15], s40 offen sc1 lds
    s_add_u32 m0, m0, 1024
    s_add_u32 s39, s39, 229376
    buffer_load_dwordx4 v2, s[12:15], s39 offen sc1 lds
    s_add_u32 m0, m0, 1024
    s_add_u32 s40, s40, 229376
    buffer_load_dwordx4 v2, s[12:15], s40 offen sc1 lds
    s_mov_b32 s43, 1
ld_73:
    s_add_u32 s19, s41, s42
    v_readlane_b32 s16, v249, s44
    v_readlane_b32 s17, v250, s44
    s_add_u32 s16, s16, s38
    s_add_u32 s17, s17, s38
    s_add_u32 s44, s44, 1
    s_add_u32 s42, s42, 16384
    s_cmp_eq_u32 s42, 49152
    s_cselect_b32 s42, 0, s42
    s_add_u32 m0, m0, 1024
    s_add_u32 s39, s39, 229376
    buffer_load_dwordx4 v2, s[12:15], s39 offen sc1 lds
    s_add_u32 m0, m0, 1024
    s_add_u32 s40, s40, 229376
    buffer_load_dwordx4 v2, s[12:15], s40 offen sc1 lds
    s_add_u32 m0, m0, 1024
    s_add_u32 s39, s39, 229376
    buffer_load_dwordx4 v2, s[12:15], s39 offen sc1 lds
    s_add_u32 m0, m0, 1024
    s_add_u32 s40, s40, 229376
    buffer_load_dwordx4 v2, s[12:15], s40 offen sc1 lds
    s_mov_b32 m0, s19
    s_mov_b32 s39, s16
    s_mov_b32 s40, s17
    s_waitcnt vmcnt(8)
    s_barrier
    buffer_load_dwordx4 v2, s[12:15], s39 offen sc1 lds
    s_add_u32 m0, m0, 1024
    s_nop 0
    buffer_load_dwordx4 v2, s[12:15], s40 offen sc1 lds
    s_add_u32 m0, m0, 1024
    s_add_u32 s39, s39, 229376
    buffer_load_dwordx4 v2, s[12:15], s39 offen sc1 lds
    s_add_u32 m0, m0, 1024
    s_add_u32 s40, s40, 229376
    buffer_load_dwordx4 v2, s[12:15], s40 offen sc1 lds
    s_add_u32 s43, s43, 1
    s_cmp_lt_u32 s43, 3
    s_cbranch_scc1 ld_73
    s_call_b64 s[76:77], PREP_a_issue_4
    s_add_u32 m0, m0, 1024
    s_add_u32 s39, s39, 229376
    buffer_load_dwordx4 v2, s[12:15], s39 offen sc1 lds
    s_add_u32 m0, m0, 1024
    s_add_u32 s40, s40, 229376
    buffer_load_dwordx4 v2, s[12:15], s40 offen sc1 lds
    s_add_u32 m0, m0, 1024
    s_add_u32 s39, s39, 229376
    buffer_load_dwordx4 v2, s[12:15], s39 offen sc1 lds
    s_add_u32 m0, m0, 1024
    s_add_u32 s40, s40, 229376
    buffer_load_dwordx4 v2, s[12:15], s40 offen sc1 lds
    s_mov_b32 m0, s19
    s_mov_b32 s39, s16
    s_mov_b32 s40, s17
    s_waitcnt vmcnt(8)
    s_barrier
    buffer_load_dwordx4 v2, s[12:15], s39 offen sc1 lds
    s_add_u32 m0, m0, 1024
    s_nop 0
    buffer_load_dwordx4 v2, s[12:15], s40 offen sc1 lds
    s_add_u32 m0, m0, 1024
    s_add_u32 s39, s39, 229376
    buffer_load_dwordx4 v2, s[12:15], s39 offen sc1 lds
    s_add_u32 m0, m0, 1024
    s_add_u32 s40, s40, 229376
    buffer_load_dwordx4 v2, s[12:15], s40 offen sc1 lds
    s_add_u32 m0, m0, 1024
    s_add_u32 s39, s39, 229376
    buffer_load_dwordx4 v2, s[12:15], s39 offen sc1 lds
    s_add_u32 m0, m0, 1024
    s_add_u32 s40, s40, 229376
    buffer_load_dwordx4 v2, s[12:15], s40 offen sc1 lds
    s_add_u32 m0, m0, 1024
    s_add_u32 s39, s39, 229376
    buffer_load_dwordx4 v2, s[12:15], s39 offen sc1 lds
    s_add_u32 m0, m0, 1024
    s_add_u32 s40, s40, 229376
    buffer_load_dwordx4 v2, s[12:15], s40 offen sc1 lds
    s_waitcnt vmcnt(8)
    s_barrier
    s_waitcnt vmcnt(0)
    s_barrier
    s_cmp_eq_u32 s60, 1
    s_cbranch_scc1 K_fin
    s_barrier
    s_branch NEXT
WLOAD:
    s_cmp_eq_u32 s60, 1
    s_cbranch_scc1 WL_1
    s_mov_b64 s[12:13], s[68:69]
    s_mov_b32 s14, 2097152
    s_mov_b32 s15, 0x20000
    s_and_b32 s35, s30, 1
    s_mul_i32 s38, s99, 128
    s_mul_i32 s41, s35, 65536
    s_add_u32 s38, s38, s41
    s_mul_i32 s41, s35, 4096
    s_add_u32 s41, s41, 24576
    s_mov_b32 s42, 0
    s_mov_b32 s44, s67
    s_branch WL_2
WL_1:
    s_mov_b64 s[12:13], s[68:69]
    s_mov_b32 s14, 2097152
    s_mov_b32 s15, 0x20000
    s_and_b32 s35, s30, 1
    s_mul_i32 s38, s99, 128
    s_mul_i32 s41, s35, 65536
    s_add_u32 s38, s38, s41
    s_mul_i32 s41, s35, 4096
    s_add_u32 s41, s41, 24576
    s_mov_b32 s42, 0
    s_mov_b32 s44, s67
WL_2:
    s_waitcnt vmcnt(0)
    s_and_b32 s36, s30, 1
    s_lshl_b32 s36, s36, 12
    s_add_u32 s36, s36, 81920
    v_add_u32 v6, s36, v2
    ds_read_b128 v[16:19], v6 offset:16384
    ds_read_b128 v[20:23], v6 offset:17408
    ds_read_b128 v[24:27], v6 offset:18432
    ds_read_b128 v[28:31], v6 offset:19456
    ds_read_b128 v[32:35], v6 offset:24576
    ds_read_b128 v[36:39], v6 offset:25600
    ds_read_b128 v[40:43], v6 offset:26624
    ds_read_b128 v[44:47], v6 offset:27648
    ds_read_b128 v[204:207], v6 offset:0
    ds_read_b128 v[208:211], v6 offset:1024
    ds_read_b128 v[212:215], v6 offset:2048
    ds_read_b128 v[216:219], v6 offset:3072
    s_waitcnt lgkmcnt(0)
    s_barrier
    s_call_b64 s[76:77], SUB_after_g1
    s_barrier
    s_waitcnt vmcnt(0)
    s_barrier
    s_call_b64 s[76:77], SUB_after_g2
    s_mov_b64 s[12:13], s[72:73]
    s_mov_b32 s14, 7340032
    s_mov_b32 s15, 0x20000
    s_and_b32 s35, s30, 1
    s_mul_i32 s38, s29, 448
    s_mul_i32 s41, s35, 229376
    s_add_u32 s38, s38, s41
    s_mul_i32 s41, s35, 14336
    s_add_u32 s41, s41, 73728
    s_mov_b32 s42, 0
    s_mov_b32 s44, 0
    s_mov_b32 s42, 28672
    s_mov_b32 s44, 2
    s_add_u32 s19, s41, s42
    v_readlane_b32 s16, v248, s44
    s_nop 0
    s_add_u32 s16, s16, s38
    s_add_u32 s44, s44, 1
    s_and_b32 s44, s44, 15
    s_add_u32 s42, s42, 28672
    s_cmp_eq_u32 s42, 86016
    s_cselect_b32 s42, 0, s42
    s_mov_b32 m0, s19
    s_mov_b32 s39, s16
    s_waitcnt vmcnt(63)
    s_barrier
    buffer_load_dwordx4 v241, s[12:15], s39 offen lds
    s_add_u32 m0, m0, 1024
    s_nop 0
    buffer_load_dwordx4 v242, s[12:15], s39 offen lds
    s_add_u32 m0, m0, 1024
    s_nop 0
    buffer_load_dwordx4 v243, s[12:15], s39 offen lds
    s_add_u32 m0, m0, 1024
    s_nop 0
    buffer_load_dwordx4 v244, s[12:15], s39 offen lds
    s_add_u32 m0, m0, 1024
    s_nop 0
    buffer_load_dwordx4 v245, s[12:15], s39 offen lds
    s_add_u32 m0, m0, 1024
    s_nop 0
    buffer_load_dwordx4 v246, s[12:15], s39 offen lds
    s_add_u32 m0, m0, 1024
    s_nop 0
    buffer_load_dwordx4 v247, s[12:15], s39 offen lds
    s_mov_b32 s43, 1
ld_74:
    s_add_u32 s19, s41, s42
    v_readlane_b32 s16, v248, s44
    s_nop 0
    s_add_u32 s16, s16, s38
    s_add_u32 s44, s44, 1
    s_and_b32 s44, s44, 15
    s_add_u32 s42, s42, 28672
    s_cmp_eq_u32 s42, 86016
    s_cselect_b32 s42, 0, s42
    s_add_u32 m0, m0, 1024
    s_add_u32 s39, s39, 114688
    buffer_load_dwordx4 v241, s[12:15], s39 offen lds
    s_add_u32 m0, m0, 1024
    s_nop 0
    buffer_load_dwordx4 v242, s[12:15], s39 offen lds
    s_add_u32 m0, m0, 1024
    s_nop 0
    buffer_load_dwordx4 v243, s[12:15], s39 offen lds
    s_add_u32 m0, m0, 1024
    s_nop 0
    buffer_load_dwordx4 v244, s[12:15], s39 offen lds
    s_add_u32 m0, m0, 1024
    s_nop 0
    buffer_load_dwordx4 v245, s[12:15], s39 offen lds
    s_add_u32 m0, m0, 1024
    s_nop 0
    buffer_load_dwordx4 v246, s[12:15], s39 offen lds
    s_add_u32 m0, m0, 1024
    s_nop 0
    buffer_load_dwordx4 v247, s[12:15], s39 offen lds
    s_mov_b32 m0, s19
    s_mov_b32 s39, s16
    s_waitcnt vmcnt(14)
    s_barrier
    buffer_load_dwordx4 v241, s[12:15], s39 offen lds
    s_add_u32 m0, m0, 1024
    s_nop 0
    buffer_load_dwordx4 v242, s[12:15], s39 offen lds
    s_add_u32 m0, m0, 1024
    s_nop 0
    buffer_load_dwordx4 v243, s[12:15], s39 offen lds
    s_add_u32 m0, m0, 1024
    s_nop 0
    buffer_load_dwordx4 v244, s[12:15], s39 offen lds
    s_add_u32 m0, m0, 1024
    s_nop 0
    buffer_load_dwordx4 v245, s[12:15], s39 offen lds
    s_add_u32 m0, m0, 1024
    s_nop 0
    buffer_load_dwordx4 v246, s[12:15], s39 offen lds
    s_add_u32 m0, m0, 1024
    s_nop 0
    buffer_load_dwordx4 v247, s[12:15], s39 offen lds
    s_add_u32 s43, s43, 1
    s_cmp_lt_u32 s43, 13
    s_cbranch_scc1 ld_74
    s_add_u32 s19, s41, s42
    v_readlane_b32 s16, v248, s44
    s_nop 0
    s_add_u32 s16, s16, s38
    s_add_u32 s44, s44, 1
    s_and_b32 s44, s44, 15
    s_add_u32 s42, s42, 28672
    s_cmp_eq_u32 s42, 86016
    s_cselect_b32 s42, 0, s42
    s_add_u32 m0, m0, 1024
    s_add_u32 s39, s39, 114688
    buffer_load_dwordx4 v241, s[12:15], s39 offen lds
    s_add_u32 m0, m0, 1024
    s_nop 0
    buffer_load_dwordx4 v242, s[12:15], s39 offen lds
    s_add_u32 m0, m0, 1024
    s_nop 0
    buffer_load_dwordx4 v243, s[12:15], s39 offen lds
    s_add_u32 m0, m0, 1024
    s_nop 0
    buffer_load_dwordx4 v244, s[12:15], s39 offen lds
    s_add_u32 m0, m0, 1024
    s_nop 0
    buffer_load_dwordx4 v245, s[12:15], s39 offen lds
    s_add_u32 m0, m0, 1024
    s_nop 0
    buffer_load_dwordx4 v246, s[12:15], s39 offen lds
    s_add_u32 m0, m0, 1024
    s_nop 0
    buffer_load_dwordx4 v247, s[12:15], s39 offen lds
    s_mov_b32 m0, s19
    s_mov_b32 s39, s16
    s_waitcnt vmcnt(14)
    s_barrier
    buffer_load_dwordx4 v241, s[12:15], s39 offen lds
    s_add_u32 m0, m0, 1024
    s_nop 0
    buffer_load_dwordx4 v242, s[12:15], s39 offen lds
    s_add_u32 m0, m0, 1024
    s_nop 0
    buffer_load_dwordx4 v243, s[12:15], s39 offen lds
    s_add_u32 m0, m0, 1024
    s_nop 0
    buffer_load_dwordx4 v244, s[12:15], s39 offen lds
    s_add_u32 m0, m0, 1024
    s_nop 0
    buffer_load_dwordx4 v245, s[12:15], s39 offen lds
    s_add_u32 m0, m0, 1024
    s_nop 0
    buffer_load_dwordx4 v246, s[12:15], s39 offen lds
    s_add_u32 m0, m0, 1024
    s_nop 0
    buffer_load_dwordx4 v247, s[12:15], s39 offen lds
    s_add_u32 m0, m0, 1024
    s_add_u32 s39, s39, 114688
    buffer_load_dwordx4 v241, s[12:15], s39 offen lds
    s_add_u32 m0, m0, 1024
    s_nop 0
    buffer_load_dwordx4 v242, s[12:15], s39 offen lds
    s_add_u32 m0, m0, 1024
    s_nop 0
    buffer_load_dwordx4 v243, s[12:15], s39 offen lds
    s_add_u32 m0, m0, 1024
    s_nop 0
    buffer_load_dwordx4 v244, s[12:15], s39 offen lds
    s_add_u32 m0, m0, 1024
    s_nop 0
    buffer_load_dwordx4 v245, s[12:15], s39 offen lds
    s_add_u32 m0, m0, 1024
    s_nop 0
    buffer_load_dwordx4 v246, s[12:15], s39 offen lds
    s_add_u32 m0, m0, 1024
    s_nop 0
    buffer_load_dwordx4 v247, s[12:15], s39 offen lds
    s_waitcnt vmcnt(14)
    s_barrier
    s_call_b64 s[76:77], SUB_r_pre0
    s_waitcnt vmcnt(4)
    s_barrier
    s_barrier
    s_mov_b64 s[12:13], s[74:75]
    s_mov_b32 s14, 7340032
    s_mov_b32 s15, 0x20000
    s_and_b32 s35, s30, 1
    s_mul_i32 s38, s33, 256
    s_mul_i32 s41, s31, 3670016
    s_add_u32 s38, s38, s41
    s_mul_i32 s41, s35, 8192
    s_add_u32 s41, s41, 49152
    s_mov_b32 s42, 0
    s_mov_b32 s44, 0
    s_mov_b32 s49, s44
    s_and_b32 s43, s28, 3
    s_mul_i32 s43, s43, 6
    s_lshr_b32 s43, s43, 2
    s_mov_b32 s50, 0
wpre_75:
    s_mul_i32 s42, s43, 16384
    s_add_u32 s44, s49, s43
    s_mov_b32 s45, 8192
    s_add_u32 s19, s41, s42
    v_readlane_b32 s16, v249, s44
    s_nop 0
    s_bitcmp1_b32 s16, 0
    s_cselect_b32 s17, 16384, s45
    s_cselect_b32 s18, -40960, s45
    s_andn2_b32 s16, s16, 1
    s_add_u32 s16, s16, s38
    s_add_u32 s44, s44, 1
    s_add_u32 s42, s42, 16384
    s_cmp_eq_u32 s42, 98304
    s_cselect_b32 s42, 0, s42
    s_mov_b32 m0, s19
    s_mov_b32 s39, s16
    s_mov_b32 s32, s17
    s_mov_b32 s3, s18
    buffer_load_dwordx4 v239, s[12:15], s39 offen lds
    s_add_u32 m0, m0, 1024
    s_add_u32 s39, s39, s32
    buffer_load_dwordx4 v240, s[12:15], s39 offen lds
    s_add_u32 m0, m0, 1024
    s_add_u32 s39, s39, s32
    buffer_load_dwordx4 v239, s[12:15], s39 offen lds
    s_add_u32 m0, m0, 1024
    s_add_u32 s39, s39, s32
    buffer_load_dwordx4 v240, s[12:15], s39 offen lds
    s_waitcnt vmcnt(8)
    s_add_u32 m0, m0, 1024
    s_add_u32 s39, s39, s3
    buffer_load_dwordx4 v239, s[12:15], s39 offen lds
    s_add_u32 m0, m0, 1024
    s_add_u32 s39, s39, s32
    buffer_load_dwordx4 v240, s[12:15], s39 offen lds
    s_add_u32 m0, m0, 1024
    s_add_u32 s39, s39, s32
    buffer_load_dwordx4 v239, s[12:15], s39 offen lds
    s_add_u32 m0, m0, 1024
    s_add_u32 s39, s39, s32
    buffer_load_dwordx4 v240, s[12:15], s39 offen lds
    s_waitcnt vmcnt(8)
    s_add_u32 s43, s43, 1
    s_cmp_eq_u32 s43, 6
    s_cselect_b32 s43, 0, s43
    s_add_u32 s50, s50, 1
    s_cmp_lt_u32 s50, 6
    s_cbranch_scc1 wpre_75
    s_mov_b32 s42, 0
    s_add_u32 s44, s49, 6
    s_cmp_eq_u32 s60, 1
    s_cbranch_scc1 WL_t1
    s_call_b64 s[76:77], PREP_w_issue_4
    s_mov_b32 m0, s19
    s_mov_b32 s39, s16
    s_mov_b32 s32, s17
    s_mov_b32 s3, s18
    s_waitcnt vmcnt(0)
    s_barrier
    s_waitcnt vmcnt(0)
    s_barrier
    buffer_load_dwordx4 v239, s[12:15], s39 offen lds
    s_add_u32 m0, m0, 1024
    s_add_u32 s39, s39, s32
    buffer_load_dwordx4 v240, s[12:15], s39 offen lds
    s_add_u32 m0, m0, 1024
    s_add_u32 s39, s39, s32
    buffer_load_dwordx4 v239, s[12:15], s39 offen lds
    s_add_u32 m0, m0, 1024
    s_add_u32 s39, s39, s32
    buffer_load_dwordx4 v240, s[12:15], s39 offen lds
    s_call_b64 s[76:77], PREP_w_issue_4
    s_add_u32 m0, m0, 1024
    s_add_u32 s39, s39, s3
    buffer_load_dwordx4 v239, s[12:15], s39 offen lds
    s_add_u32 m0, m0, 1024
    s_add_u32 s39, s39, s32
    buffer_load_dwordx4 v240, s[12:15], s39 offen lds
    s_add_u32 m0, m0, 1024
    s_add_u32 s39, s39, s32
    buffer_load_dwordx4 v239, s[12:15], s39 offen lds
    s_add_u32 m0, m0, 1024
    s_add_u32 s39, s39, s32
    buffer_load_dwordx4 v240, s[12:15], s39 offen lds
    s_mov_b32 m0, s19
    s_mov_b32 s39, s16
    s_mov_b32 s32, s17
    s_mov_b32 s3, s18
    s_waitcnt vmcnt(8)
    s_barrier
    buffer_load_dwordx4 v239, s[12:15], s39 offen lds
    s_add_u32 m0, m0, 1024
    s_add_u32 s39, s39, s32
    buffer_load_dwordx4 v240, s[12:15], s39 offen lds
    s_add_u32 m0, m0, 1024
    s_add_u32 s39, s39, s32
    buffer_load_dwordx4 v239, s[12:15], s39 offen lds
    s_add_u32 m0, m0, 1024
    s_add_u32 s39, s39, s32
    buffer_load_dwordx4 v240, s[12:15], s39 offen lds
    s_call_b64 s[76:77], PREP_w_issue_4
    s_add_u32 m0, m0, 1024
    s_add_u32 s39, s39, s3
    buffer_load_dwordx4 v239, s[12:15], s39 offen lds
    s_add_u32 m0, m0, 1024
    s_add_u32 s39, s39, s32
    buffer_load_dwordx4 v240, s[12:15], s39 offen lds
    s_add_u32 m0, m0, 1024
    s_add_u32 s39, s39, s32
    buffer_load_dwordx4 v239, s[12:15], s39 offen lds
    s_add_u32 m0, m0, 1024
    s_add_u32 s39, s39, s32
    buffer_load_dwordx4 v240, s[12:15], s39 offen lds
    s_mov_b32 m0, s19
    s_mov_b32 s39, s16
    s_mov_b32 s32, s17
    s_mov_b32 s3, s18
    s_waitcnt vmcnt(16)
    s_barrier
    buffer_load_dwordx4 v239, s[12:15], s39 offen lds
    s_add_u32 m0, m0, 1024
    s_add_u32 s39, s39, s32
    buffer_load_dwordx4 v240, s[12:15], s39 offen lds
    s_add_u32 m0, m0, 1024
    s_add_u32 s39, s39, s32
    buffer_load_dwordx4 v239, s[12:15], s39 offen lds
    s_add_u32 m0, m0, 1024
    s_add_u32 s39, s39, s32
    buffer_load_dwordx4 v240, s[12:15], s39 offen lds
    s_call_b64 s[76:77], PREP_w_issue_4
    s_add_u32 m0, m0, 1024
    s_add_u32 s39, s39, s3
    buffer_load_dwordx4 v239, s[12:15], s39 offen lds
    s_add_u32 m0, m0, 1024
    s_add_u32 s39, s39, s32
    buffer_load_dwordx4 v240, s[12:15], s39 offen lds
    s_add_u32 m0, m0, 1024
    s_add_u32 s39, s39, s32
    buffer_load_dwordx4 v239, s[12:15], s39 offen lds
    s_add_u32 m0, m0, 1024
    s_add_u32 s39, s39, s32
    buffer_load_dwordx4 v240, s[12:15], s39 offen lds
    s_mov_b32 m0, s19
    s_mov_b32 s39, s16
    s_mov_b32 s32, s17
    s_mov_b32 s3, s18
    s_waitcnt vmcnt(24)
    s_barrier
    buffer_load_dwordx4 v239, s[12:15], s39 offen lds
    s_add_u32 m0, m0, 1024
    s_add_u32 s39, s39, s32
    buffer_load_dwordx4 v240, s[12:15], s39 offen lds
    s_add_u32 m0, m0, 1024
    s_add_u32 s39, s39, s32
    buffer_load_dwordx4 v239, s[12:15], s39 offen lds
    s_add_u32 m0, m0, 1024
    s_add_u32 s39, s39, s32
    buffer_load_dwordx4 v240, s[12:15], s39 offen lds
    s_mov_b32 s43, 1
ld_76:
    s_mov_b32 s45, 8192
    s_add_u32 s19, s41, s42
    v_readlane_b32 s16, v249, s44
    s_nop 0
    s_bitcmp1_b32 s16, 0
    s_cselect_b32 s17, 16384, s45
    s_cselect_b32 s18, -40960, s45
    s_andn2_b32 s16, s16, 1
    s_add_u32 s16, s16, s38
    s_add_u32 s44, s44, 1
    s_add_u32 s42, s42, 16384
    s_cmp_eq_u32 s42, 98304
    s_cselect_b32 s42, 0, s42
    s_add_u32 m0, m0, 1024
    s_add_u32 s39, s39, s3
    buffer_load_dwordx4 v239, s[12:15], s39 offen lds
    s_add_u32 m0, m0, 1024
    s_add_u32 s39, s39, s32
    buffer_load_dwordx4 v240, s[12:15], s39 offen lds
    s_add_u32 m0, m0, 1024
    s_add_u32 s39, s39, s32
    buffer_load_dwordx4 v239, s[12:15], s39 offen lds
    s_add_u32 m0, m0, 1024
    s_add_u32 s39, s39, s32
    buffer_load_dwordx4 v240, s[12:15], s39 offen lds
    s_mov_b32 m0, s19
    s_mov_b32 s39, s16
    s_mov_b32 s32, s17
    s_mov_b32 s3, s18
    s_waitcnt vmcnt(32)
    s_barrier
    buffer_load_dwordx4 v239, s[12:15], s39 offen lds
    s_add_u32 m0, m0, 1024
    s_add_u32 s39, s39, s32
    buffer_load_dwordx4 v240, s[12:15], s39 offen lds
    s_add_u32 m0, m0, 1024
    s_add_u32 s39, s39, s32
    buffer_load_dwordx4 v239, s[12:15], s39 offen lds
    s_add_u32 m0, m0, 1024
    s_add_u32 s39, s39, s32
    buffer_load_dwordx4 v240, s[12:15], s39 offen lds
    s_add_u32 s43, s43, 1
    s_cmp_lt_u32 s43, 18
    s_cbranch_scc1 ld_76
    s_call_b64 s[76:77], PREP_w_issue_4
    s_add_u32 m0, m0, 1024
    s_add_u32 s39, s39, s3
    buffer_load_dwordx4 v239, s[12:15], s39 offen lds
    s_add_u32 m0, m0, 1024
    s_add_u32 s39, s39, s32
    buffer_load_dwordx4 v240, s[12:15], s39 offen lds
    s_add_u32 m0, m0, 1024
    s_add_u32 s39, s39, s32
    buffer_load_dwordx4 v239, s[12:15], s39 offen lds
    s_add_u32 m0, m0, 1024
    s_add_u32 s39, s39, s32
    buffer_load_dwordx4 v240, s[12:15], s39 offen lds
    s_mov_b32 m0, s19
    s_mov_b32 s39, s16
    s_mov_b32 s32, s17
    s_mov_b32 s3, s18
    s_waitcnt vmcnt(32)
    s_barrier
    buffer_load_dwordx4 v239, s[12:15], s39 offen lds
    s_add_u32 m0, m0, 1024
    s_add_u32 s39, s39, s32
    buffer_load_dwordx4 v240, s[12:15], s39 offen lds
    s_add_u32 m0, m0, 1024
    s_add_u32 s39, s39, s32
    buffer_load_dwordx4 v239, s[12:15], s39 offen lds
    s_add_u32 m0, m0, 1024
    s_add_u32 s39, s39, s32
    buffer_load_dwordx4 v240, s[12:15], s39 offen lds
    s_add_u32 m0, m0, 1024
    s_add_u32 s39, s39, s3
    buffer_load_dwordx4 v239, s[12:15], s39 offen lds
    s_add_u32 m0, m0, 1024
    s_add_u32 s39, s39, s32
    buffer_load_dwordx4 v240, s[12:15], s39 offen lds
    s_add_u32 m0, m0, 1024
    s_add_u32 s39, s39, s32
    buffer_load_dwordx4 v239, s[12:15], s39 offen lds
    s_add_u32 m0, m0, 1024
    s_add_u32 s39, s39, s32
    buffer_load_dwordx4 v240, s[12:15], s39 offen lds
    s_waitcnt vmcnt(32)
    s_barrier
    s_mov_b64 s[12:13], s[68:69]
    s_mov_b32 s14, 2097152
    s_mov_b32 s15, 0x20000
    s_and_b32 s35, s30, 1
    s_mul_i32 s38, s99, 128
    s_mul_i32 s41, s35, 65536
    s_add_u32 s38, s38, s41
    s_mul_i32 s41, s35, 4096
    s_add_u32 s41, s41, 24576
    s_mov_b32 s42, 0
    s_mov_b32 s44, s67
    s_and_b32 s36, s99, 7
    s_cmp_eq_u32 s36, 3
    s_cselect_b64 s[50:51], 0, -1
    s_mov_b32 s42, 90112
    s_mov_b32 s44, s67
    s_add_u32 s44, s44, 11
    s_and_b32 s44, s44, 15
    s_call_b64 s[76:77], SUB_w_issue_1
    s_mov_b32 s42, 98304
    s_mov_b32 s44, s67
    s_add_u32 s44, s44, 12
    s_and_b32 s44, s44, 15
    s_call_b64 s[76:77], SUB_w_issue_1
    s_mov_b32 s42, 122880
    s_mov_b32 s44, s67
    s_add_u32 s44, s44, 15
    s_and_b32 s44, s44, 15
    s_call_b64 s[76:77], SUB_w_issue_1
    s_waitcnt vmcnt(36)
    s_barrier
    s_mov_b32 s42, 106496
    s_mov_b32 s44, s67
    s_add_u32 s44, s44, 13
    s_and_b32 s44, s44, 15
    s_call_b64 s[76:77], SUB_w_issue_1
    s_mov_b32 s42, 114688
    s_mov_b32 s44, s67
    s_add_u32 s44, s44, 14
    s_and_b32 s44, s44, 15
    s_call_b64 s[76:77], SUB_w_issue_1
    s_waitcnt vmcnt(36)
    s_barrier
    s_mov_b32 s42, 24576
    s_mov_b32 s44, s67
    s_add_u32 s44, s44, 3
    s_and_b32 s44, s44, 15
    s_call_b64 s[76:77], SUB_w_issue_1
    s_mov_b32 s42, 32768
    s_mov_b32 s44, s67
    s_add_u32 s44, s44, 4
    s_and_b32 s44, s44, 15
    s_call_b64 s[76:77], SUB_w_issue_1
    s_waitcnt vmcnt(36)
    s_barrier
    s_mov_b32 s42, 40960
    s_mov_b32 s44, s67
    s_add_u32 s44, s44, 5
    s_and_b32 s44, s44, 15
    s_call_b64 s[76:77], SUB_w_issue_1
    s_mov_b32 s42, 49152
    s_mov_b32 s44, s67
    s_add_u32 s44, s44, 6
    s_and_b32 s44, s44, 15
    s_call_b64 s[76:77], SUB_w_issue_1
    s_mov_b32 s42, 0
    s_mov_b32 s44, s67
    s_add_u32 s44, s44, 0
    s_and_b32 s44, s44, 15
    s_call_b64 s[76:77], SUB_w_issue_1
    s_waitcnt vmcnt(40)
    s_barrier
    s_mov_b32 s42, 65536
    s_mov_b32 s44, s67
    s_add_u32 s44, s44, 8
    s_and_b32 s44, s44, 15
    s_call_b64 s[76:77], SUB_w_issue_1
    s_mov_b32 s42, 8192
    s_mov_b32 s44, s67
    s_add_u32 s44, s44, 1
    s_and_b32 s44, s44, 15
    s_call_b64 s[76:77], SUB_w_issue_1
    s_mov_b32 s42, 16384
    s_mov_b32 s44, s67
    s_add_u32 s44, s44, 2
    s_and_b32 s44, s44, 15
    s_call_b64 s[76:77], SUB_w_issue_1
    s_add_u32 s36, s41, 57344
    v_add_u32 v6, s36, v2
    ds_write_b128 v6, v[204:207] offset:0
    ds_write_b128 v6, v[208:211] offset:1024
    ds_write_b128 v6, v[212:215] offset:2048
    ds_write_b128 v6, v[216:219] offset:3072
    s_barrier
    s_add_u32 s36, s41, 57344
    v_add_u32 v6, s36, v2
    ds_write_b128 v6, v[16:19] offset:16384
    ds_write_b128 v6, v[20:23] offset:17408
    ds_write_b128 v6, v[24:27] offset:18432
    ds_write_b128 v6, v[28:31] offset:19456
    ds_write_b128 v6, v[32:35] offset:24576
    ds_write_b128 v6, v[36:39] offset:25600
    ds_write_b128 v6, v[40:43] offset:26624
    ds_write_b128 v6, v[44:47] offset:27648
    s_waitcnt lgkmcnt(0)
    s_branch NEXT
WL_t1:
    s_call_b64 s[76:77], PREP_w_issue_4
    s_mov_b32 m0, s19
    s_mov_b32 s39, s16
    s_mov_b32 s32, s17
    s_mov_b32 s3, s18
    s_waitcnt vmcnt(0)
    s_barrier
    s_waitcnt vmcnt(0)
    s_barrier
    s_waitcnt vmcnt(0)
    s_barrier
    s_waitcnt vmcnt(0)
    s_barrier
    s_waitcnt vmcnt(0)
    s_barrier
    buffer_load_dwordx4 v239, s[12:15], s39 offen lds
    s_add_u32 m0, m0, 1024
    s_add_u32 s39, s39, s32
    buffer_load_dwordx4 v240, s[12:15], s39 offen lds
    s_add_u32 m0, m0, 1024
    s_add_u32 s39, s39, s32
    buffer_load_dwordx4 v239, s[12:15], s39 offen lds
    s_add_u32 m0, m0, 1024
    s_add_u32 s39, s39, s32
    buffer_load_dwordx4 v240, s[12:15], s39 offen lds
    s_mov_b32 s43, 1
ld_77:
    s_mov_b32 s45, 8192
    s_add_u32 s19, s41, s42
    v_readlane_b32 s16, v249, s44
    s_nop 0
    s_bitcmp1_b32 s16, 0
    s_cselect_b32 s17, 16384, s45
    s_cselect_b32 s18, -40960, s45
    s_andn2_b32 s16, s16, 1
    s_add_u32 s16, s16, s38
    s_add_u32 s44, s44, 1
    s_add_u32 s42, s42, 16384
    s_cmp_eq_u32 s42, 98304
    s_cselect_b32 s42, 0, s42
    s_add_u32 m0, m0, 1024
    s_add_u32 s39, s39, s3
    buffer_load_dwordx4 v239, s[12:15], s39 offen lds
    s_add_u32 m0, m0, 1024
    s_add_u32 s39, s39, s32
    buffer_load_dwordx4 v240, s[12:15], s39 offen lds
    s_add_u32 m0, m0, 1024
    s_add_u32 s39, s39, s32
    buffer_load_dwordx4 v239, s[12:15], s39 offen lds
    s_add_u32 m0, m0, 1024
    s_add_u32 s39, s39, s32
    buffer_load_dwordx4 v240, s[12:15], s39 offen lds
    s_mov_b32 m0, s19
    s_mov_b32 s39, s16
    s_mov_b32 s32, s17
    s_mov_b32 s3, s18
    s_waitcnt vmcnt(8)
    s_barrier
    buffer_load_dwordx4 v239, s[12:15], s39 offen lds
    s_add_u32 m0, m0, 1024
    s_add_u32 s39, s39, s32
    buffer_load_dwordx4 v240, s[12:15], s39 offen lds
    s_add_u32 m0, m0, 1024
    s_add_u32 s39, s39, s32
    buffer_load_dwordx4 v239, s[12:15], s39 offen lds
    s_add_u32 m0, m0, 1024
    s_add_u32 s39, s39, s32
    buffer_load_dwordx4 v240, s[12:15], s39 offen lds
    s_add_u32 s43, s43, 1
    s_cmp_lt_u32 s43, 21
    s_cbranch_scc1 ld_77
    s_call_b64 s[76:77], PREP_w_issue_4
    s_add_u32 m0, m0, 1024
    s_add_u32 s39, s39, s3
    buffer_load_dwordx4 v239, s[12:15], s39 offen lds
    s_add_u32 m0, m0, 1024
    s_add_u32 s39, s39, s32
    buffer_load_dwordx4 v240, s[12:15], s39 offen lds
    s_add_u32 m0, m0, 1024
    s_add_u32 s39, s39, s32
    buffer_load_dwordx4 v239, s[12:15], s39 offen lds
    s_add_u32 m0, m0, 1024
    s_add_u32 s39, s39, s32
    buffer_load_dwordx4 v240, s[12:15], s39 offen lds
    s_mov_b32 m0, s19
    s_mov_b32 s39, s16
    s_mov_b32 s32, s17
    s_mov_b32 s3, s18
    s_waitcnt vmcnt(8)
    s_barrier
    buffer_load_dwordx4 v239, s[12:15], s39 offen lds
    s_add_u32 m0, m0, 1024
    s_add_u32 s39, s39, s32
    buffer_load_dwordx4 v240, s[12:15], s39 offen lds
    s_add_u32 m0, m0, 1024
    s_add_u32 s39, s39, s32
    buffer_load_dwordx4 v239, s[12:15], s39 offen lds
    s_add_u32 m0, m0, 1024
    s_add_u32 s39, s39, s32
    buffer_load_dwordx4 v240, s[12:15], s39 offen lds
    s_add_u32 m0, m0, 1024
    s_add_u32 s39, s39, s3
    buffer_load_dwordx4 v239, s[12:15], s39 offen lds
    s_add_u32 m0, m0, 1024
    s_add_u32 s39, s39, s32
    buffer_load_dwordx4 v240, s[12:15], s39 offen lds
    s_add_u32 m0, m0, 1024
    s_add_u32 s39, s39, s32
    buffer_load_dwordx4 v239, s[12:15], s39 offen lds
    s_add_u32 m0, m0, 1024
    s_add_u32 s39, s39, s32
    buffer_load_dwordx4 v240, s[12:15], s39 offen lds
    s_waitcnt vmcnt(8)
    s_barrier
    s_waitcnt vmcnt(0)
    s_barrier
    s_branch K_fin
NEXT:
    s_setprio 0
    s_add_u32 s60, s60, 1
    s_add_u32 s55, s55, 4194304
    s_add_u32 s62, s62, 4194304
    s_addc_u32 s63, s63, 0
    s_branch LAYER
K_fin:
    s_endpgm
SUB_w1_regs:
    s_mov_b64 s[12:13], s[68:69]
    s_mov_b32 s14, 2097152
    s_mov_b32 s15, 0x20000
    s_and_b32 s35, s30, 3
    s_mul_i32 s35, s35, 294912
    s_lshl_b32 s39, s99, 7
    s_add_u32 s39, s39, s35
    buffer_load_dwordx4 v[176:179], v238, s[12:15], s39 offen
    s_add_u32 s39, s39, 16384
    buffer_load_dwordx4 v[188:191], v238, s[12:15], s39 offen
    s_add_u32 s39, s39, 16384
    buffer_load_dwordx4 v[192:195], v238, s[12:15], s39 offen
    s_add_u32 s39, s39, 16384
    buffer_load_dwordx4 v[200:203], v238, s[12:15], s39 offen
    s_add_u32 s39, s39, 16384
    s_waitcnt vmcnt(8)
    buffer_load_dwordx4 v[204:207], v238, s[12:15], s39 offen
    s_add_u32 s39, s39, 16384
    buffer_load_dwordx4 v[208:211], v238, s[12:15], s39 offen
    s_add_u32 s39, s39, 16384
    buffer_load_dwordx4 v[212:215], v238, s[12:15], s39 offen
    s_add_u32 s39, s39, 16384
    buffer_load_dwordx4 v[216:219], v238, s[12:15], s39 offen
    s_add_u32 s39, s39, 16384
    s_waitcnt vmcnt(8)
    buffer_load_dwordx4 v[220:223], v238, s[12:15], s39 offen
    s_add_u32 s39, s39, 16384
    buffer_load_dwordx4 v[224:227], v238, s[12:15], s39 offen
    s_add_u32 s39, s39, 16384
    buffer_load_dwordx4 v[16:19], v238, s[12:15], s39 offen
    s_add_u32 s39, s39, 16384
    buffer_load_dwordx4 v[20:23], v238, s[12:15], s39 offen
    s_add_u32 s39, s39, 16384
    s_waitcnt vmcnt(8)
    buffer_load_dwordx4 v[24:27], v238, s[12:15], s39 offen
    s_add_u32 s39, s39, 16384
    buffer_load_dwordx4 v[28:31], v238, s[12:15], s39 offen
    s_add_u32 s39, s39, 16384
    buffer_load_dwordx4 v[32:35], v238, s[12:15], s39 offen
    s_add_u32 s39, s39, 16384
    buffer_load_dwordx4 v[36:39], v238, s[12:15], s39 offen
    s_add_u32 s39, s39, 16384
    s_waitcnt vmcnt(8)
    buffer_load_dwordx4 v[40:43], v238, s[12:15], s39 offen
    s_add_u32 s39, s39, 16384
    buffer_load_dwordx4 v[44:47], v238, s[12:15], s39 offen
    s_add_u32 s39, s39, 16384
    s_setpc_b64 s[76:77]
SUB_park:
    s_mov_b64 s[12:13], s[70:71]
    s_mov_b32 s14, 2097152
    s_mov_b32 s15, 0x20000
    s_and_b32 s35, s30, 3
    s_lshl_b32 s35, s35, 19
    s_lshl_b32 s39, s29, 7
    s_add_u32 s39, s39, s35
    buffer_load_dwordx4 v[48:51], v238, s[12:15], s39 offen
    s_add_u32 s39, s39, 16384
    buffer_load_dwordx4 v[52:55], v238, s[12:15], s39 offen
    s_add_u32 s39, s39, 16384
    buffer_load_dwordx4 v[56:59], v238, s[12:15], s39 offen
    s_add_u32 s39, s39, 16384
    buffer_load_dwordx4 v[60:63], v238, s[12:15], s39 offen
    s_add_u32 s39, s39, 16384
    s_waitcnt vmcnt(8)
    buffer_load_dwordx4 v[64:67], v238, s[12:15], s39 offen
    s_add_u32 s39, s39, 16384
    buffer_load_dwordx4 v[68:71], v238, s[12:15], s39 offen
    s_add_u32 s39, s39, 16384
    buffer_load_dwordx4 v[72:75], v238, s[12:15], s39 offen
    s_add_u32 s39, s39, 16384
    buffer_load_dwordx4 v[76:79], v238, s[12:15], s39 offen
    s_add_u32 s39, s39, 16384
    s_waitcnt vmcnt(8)
    buffer_load_dwordx4 v[80:83], v238, s[12:15], s39 offen
    s_add_u32 s39, s39, 16384
    buffer_load_dwordx4 v[84:87], v238, s[12:15], s39 offen
    s_add_u32 s39, s39, 16384
    buffer_load_dwordx4 v[88:91], v238, s[12:15], s39 offen
    s_add_u32 s39, s39, 16384
    buffer_load_dwordx4 v[92:95], v238, s[12:15], s39 offen
    s_add_u32 s39, s39, 16384
    s_waitcnt vmcnt(8)
    buffer_load_dwordx4 v[96:99], v238, s[12:15], s39 offen
    s_add_u32 s39, s39, 16384
    buffer_load_dwordx4 v[100:103], v238, s[12:15], s39 offen
    s_add_u32 s39, s39, 16384
    buffer_load_dwordx4 v[104:107], v238, s[12:15], s39 offen
    s_add_u32 s39, s39, 16384
    buffer_load_dwordx4 v[108:111], v238, s[12:15], s39 offen
    s_add_u32 s39, s39, 16384
    s_waitcnt vmcnt(8)
    buffer_load_dwordx4 v[112:115], v238, s[12:15], s39 offen
    s_add_u32 s39, s39, 16384
    buffer_load_dwordx4 v[116:119], v238, s[12:15], s39 offen
    s_add_u32 s39, s39, 16384
    buffer_load_dwordx4 v[120:123], v238, s[12:15], s39 offen
    s_add_u32 s39, s39, 16384
    buffer_load_dwordx4 v[124:127], v238, s[12:15], s39 offen
    s_add_u32 s39, s39, 16384
    s_waitcnt vmcnt(8)
    buffer_load_dwordx4 v[128:131], v238, s[12:15], s39 offen
    s_add_u32 s39, s39, 16384
    buffer_load_dwordx4 v[132:135], v238, s[12:15], s39 offen
    s_add_u32 s39, s39, 16384
    buffer_load_dwordx4 v[136:139], v238, s[12:15], s39 offen
    s_add_u32 s39, s39, 16384
    buffer_load_dwordx4 v[140:143], v238, s[12:15], s39 offen
    s_add_u32 s39, s39, 16384
    s_waitcnt vmcnt(8)
    s_setpc_b64 s[76:77]
SUB_park2:
    s_mov_b64 s[12:13], s[70:71]
    s_mov_b32 s14, 2097152
    s_mov_b32 s15, 0x20000
    s_and_b32 s35, s30, 3
    s_lshl_b32 s35, s35, 19
    s_lshl_b32 s39, s29, 7
    s_add_u32 s39, s39, s35
    s_add_u32 s39, s39, 393216
    buffer_load_dwordx4 v[144:147], v238, s[12:15], s39 offen
    s_add_u32 s39, s39, 16384
    buffer_load_dwordx4 v[148:151], v238, s[12:15], s39 offen
    s_add_u32 s39, s39, 16384
    buffer_load_dwordx4 v[152:155], v238, s[12:15], s39 offen
    s_add_u32 s39, s39, 16384
    buffer_load_dwordx4 v[156:159], v238, s[12:15], s39 offen
    s_add_u32 s39, s39, 16384
    s_waitcnt vmcnt(8)
    buffer_load_dwordx4 v[160:163], v238, s[12:15], s39 offen
    s_add_u32 s39, s39, 16384
    buffer_load_dwordx4 v[164:167], v238, s[12:15], s39 offen
    s_add_u32 s39, s39, 16384
    buffer_load_dwordx4 v[168:171], v238, s[12:15], s39 offen
    s_add_u32 s39, s39, 16384
    buffer_load_dwordx4 v[172:175], v238, s[12:15], s39 offen
    s_add_u32 s39, s39, 16384
    s_waitcnt vmcnt(8)
    s_setpc_b64 s[76:77]
SUB_w1_put:
    s_and_b32 s35, s30, 3
    s_mul_i32 s35, s35, 18432
    v_add_u32 v8, s35, v2
    v_mov_b32 v6, 162836
spin_78:
    s_sleep 2
    ds_read_b32 v7, v6
    s_waitcnt lgkmcnt(0)
    v_readfirstlane_b32 s53, v7
    s_nop 0
    s_cmp_ge_u32 s53, 8
    s_cbranch_scc0 spin_78
    s_waitcnt vmcnt(24)
    ds_write_b128 v8, v[176:179] offset:24576
    ds_write_b128 v8, v[188:191] offset:25600
    ds_write_b128 v8, v[192:195] offset:26624
    ds_write_b128 v8, v[200:203] offset:27648
    ds_write_b128 v8, v[204:207] offset:28672
    ds_write_b128 v8, v[208:211] offset:29696
    ds_write_b128 v8, v[212:215] offset:30720
    ds_write_b128 v8, v[216:219] offset:31744
    ds_write_b128 v8, v[220:223] offset:32768
    ds_write_b128 v8, v[224:227] offset:33792
    ds_write_b128 v8, v[16:19] offset:34816
    ds_write_b128 v8, v[20:23] offset:35840
    ds_write_b128 v8, v[24:27] offset:36864
    ds_write_b128 v8, v[28:31] offset:37888
    ds_write_b128 v8, v[32:35] offset:38912
    ds_write_b128 v8, v[36:39] offset:39936
    ds_write_b128 v8, v[40:43] offset:40960
    ds_write_b128 v8, v[44:47] offset:41984
    s_waitcnt lgkmcnt(0)
    s_setpc_b64 s[76:77]
SUB_after_g1:
    s_mov_b64 s[12:13], s[72:73]
    s_mov_b32 s14, 7340032
    s_mov_b32 s15, 0x20000
    v_readlane_b32 s36, v251, 0
    v_readlane_b32 s37, v251, 1
    v_readlane_b32 s34, v251, 2
    s_and_b32 s35, s30, 3
    s_mul_i32 s38, s35, 114688
    s_mul_i32 s39, s29, 448
    s_add_u32 s38, s38, s39
    s_and_b32 s36, s36, 15
    s_mul_i32 s36, s36, 458752
    s_add_u32 s36, s36, s38
    s_and_b32 s37, s37, 15
    s_mul_i32 s37, s37, 458752
    s_add_u32 s37, s37, s38
    s_and_b32 s34, s34, 15
    s_mul_i32 s34, s34, 458752
    s_add_u32 s34, s34, s38
    s_mul_i32 s39, s35, 7168
    s_add_u32 m0, s39, 131072
    s_nop 0
    buffer_load_dwordx4 v241, s[12:15], s36 offen lds
    s_add_u32 m0, m0, 1024
    s_nop 0
    buffer_load_dwordx4 v242, s[12:15], s36 offen lds
    s_add_u32 m0, m0, 1024
    s_nop 0
    buffer_load_dwordx4 v243, s[12:15], s36 offen lds
    s_add_u32 m0, m0, 1024
    s_nop 0
    buffer_load_dwordx4 v244, s[12:15], s36 offen lds
    s_add_u32 m0, m0, 1024
    s_nop 0
    buffer_load_dwordx4 v245, s[12:15], s36 offen lds
    s_add_u32 m0, m0, 1024
    s_nop 0
    buffer_load_dwordx4 v246, s[12:15], s36 offen lds
    s_add_u32 m0, m0, 1024
    s_nop 0
    buffer_load_dwordx4 v247, s[12:15], s36 offen lds
    buffer_load_dwordx4 v[176:179], v241, s[12:15], s37 offen
    buffer_load_dwordx4 v[180:183], v242, s[12:15], s37 offen
    buffer_load_dwordx4 v[184:187], v243, s[12:15], s37 offen
    buffer_load_dwordx4 v[188:191], v244, s[12:15], s37 offen
    buffer_load_dwordx4 v[192:195], v245, s[12:15], s37 offen
    buffer_load_dwordx4 v[196:199], v246, s[12:15], s37 offen
    buffer_load_dwordx4 v[200:203], v247, s[12:15], s37 offen
    s_lshr_b32 s36, s67, 2
    s_sub_u32 s36, s35, s36
    s_and_b32 s36, s36, 3
    s_lshl_b32 s36, s36, 15
    v_add_u32 v6, s36, v2
    s_waitcnt vmcnt(14)
    ds_write_b128 v6, v[48:51] offset:0
    ds_write_b128 v6, v[52:55] offset:1024
    ds_write_b128 v6, v[56:59] offset:2048
    ds_write_b128 v6, v[60:63] offset:3072
    ds_write_b128 v6, v[64:67] offset:4096
    ds_write_b128 v6, v[68:71] offset:5120
    ds_write_b128 v6, v[72:75] offset:6144
    ds_write_b128 v6, v[76:79] offset:7168
    ds_write_b128 v6, v[80:83] offset:8192
    ds_write_b128 v6, v[84:87] offset:9216
    ds_write_b128 v6, v[88:91] offset:10240
    ds_write_b128 v6, v[92:95] offset:11264
    ds_write_b128 v6, v[96:99] offset:12288
    ds_write_b128 v6, v[100:103] offset:13312
    ds_write_b128 v6, v[104:107] offset:14336
    ds_write_b128 v6, v[108:111] offset:15360
    ds_write_b128 v6, v[112:115] offset:16384
    ds_write_b128 v6, v[116:119] offset:17408
    ds_write_b128 v6, v[120:123] offset:18432
    ds_write_b128 v6, v[124:127] offset:19456
    ds_write_b128 v6, v[128:131] offset:20480
    ds_write_b128 v6, v[132:135] offset:21504
    ds_write_b128 v6, v[136:139] offset:22528
    ds_write_b128 v6, v[140:143] offset:23552
    ds_write_b128 v6, v[144:147] offset:24576
    ds_write_b128 v6, v[148:151] offset:25600
    ds_write_b128 v6, v[152:155] offset:26624
    ds_write_b128 v6, v[156:159] offset:27648
    ds_write_b128 v6, v[160:163] offset:28672
    ds_write_b128 v6, v[164:167] offset:29696
    ds_write_b128 v6, v[168:171] offset:30720
    ds_write_b128 v6, v[172:175] offset:31744
    s_waitcnt lgkmcnt(0)
    s_setpc_b64 s[76:77]
SUB_after_g2:
    s_and_b32 s35, s30, 3
    s_mul_i32 s39, s35, 7168
    s_add_u32 s39, s39, 73728
    v_add_u32 v7, s39, v2
    ds_write_b128 v7, v[176:179] offset:0
    ds_write_b128 v7, v[180:183] offset:1024
    ds_write_b128 v7, v[184:187] offset:2048
    ds_write_b128 v7, v[188:191] offset:3072
    ds_write_b128 v7, v[192:195] offset:4096
    ds_write_b128 v7, v[196:199] offset:5120
    ds_write_b128 v7, v[200:203] offset:6144
    s_waitcnt lgkmcnt(0)
    s_setpc_b64 s[76:77]
SUB_r_pre:
    v_and_b32 v199, 7, v0
    v_lshrrev_b32 v228, 6, v0
    v_lshlrev_b32 v228, 4, v228
    v_bfe_u32 v229, v0, 3, 3
    v_add_u32 v228, v228, v229
    s_lshr_b32 s78, s29, 1
    s_lshl_b32 s78, s78, 16
    s_and_b32 s79, s29, 1
    s_lshl_b32 s79, s79, 7
    s_add_u32 s78, s78, s79
    s_lshr_b32 s79, s30, 1
    s_lshl_b32 s79, s79, 13
    s_add_u32 s78, s78, s79
    v_lshlrev_b32 v196, 8, v228
    v_lshl_add_u32 v196, v199, 4, v196
    v_add_u32 v196, s78, v196
    s_mov_b32 s84, s62
    s_mov_b32 s85, s63
    s_mov_b32 s86, 0x7e000
    s_mov_b32 s87, 0x20000
    s_add_u32 s88, s62, 0x80000
    s_addc_u32 s89, s63, 0
    s_mov_b32 s90, 0x7e000
    s_mov_b32 s91, 0x20000
    buffer_load_dwordx4 v[180:183], v196, s[84:87], 0 offen offset:0 sc1
    buffer_load_dwordx4 v[188:191], v196, s[88:91], 0 offen offset:0 sc1
    buffer_load_dwordx4 v[184:187], v196, s[84:87], 0 offen offset:2048 sc1
    buffer_load_dwordx4 v[192:195], v196, s[88:91], 0 offen offset:2048 sc1
    s_setpc_b64 s[76:77]
SUB_r_pre0:
    v_and_b32 v199, 7, v0
    v_lshrrev_b32 v228, 6, v0
    v_lshlrev_b32 v228, 4, v228
    v_bfe_u32 v229, v0, 3, 3
    v_add_u32 v228, v228, v229
    s_lshr_b32 s78, s29, 1
    s_lshl_b32 s78, s78, 16
    s_and_b32 s79, s29, 1
    s_lshl_b32 s79, s79, 7
    s_add_u32 s78, s78, s79
    s_lshr_b32 s79, s30, 1
    s_lshl_b32 s79, s79, 13
    s_add_u32 s78, s78, s79
    v_lshlrev_b32 v196, 8, v228
    v_lshl_add_u32 v196, v199, 4, v196
    v_add_u32 v196, s78, v196
    s_mov_b32 s84, s62
    s_mov_b32 s85, s63
    s_mov_b32 s86, 0x7e000
    s_mov_b32 s87, 0x20000
    s_add_u32 s88, s62, 0x80000
    s_addc_u32 s89, s63, 0
    s_mov_b32 s90, 0x7e000
    s_mov_b32 s91, 0x20000
    s_cmp_eq_u32 s60, 0
    s_cselect_b64 exec, -1, 0
    buffer_load_dwordx4 v[180:183], v196, s[84:87], 0 offen offset:0 sc1
    buffer_load_dwordx4 v[188:191], v196, s[88:91], 0 offen offset:0 sc1
    buffer_load_dwordx4 v[184:187], v196, s[84:87], 0 offen offset:2048 sc1
    buffer_load_dwordx4 v[192:195], v196, s[88:91], 0 offen offset:2048 sc1
    s_mov_b64 exec, -1
    s_setpc_b64 s[76:77]
SUB_w_issue_1:
    s_add_u32 s19, s41, s42
    s_mul_i32 s16, s44, 131072
    s_add_u32 s16, s16, s38
    s_add_u32 s44, s44, 1
    s_and_b32 s44, s44, 15
    s_add_u32 s42, s42, 8192
    s_cmp_eq_u32 s42, 131072
    s_cselect_b32 s42, 0, s42
    s_mov_b32 m0, s19
    s_mov_b32 s39, s16
    buffer_load_dwordx4 v238, s[12:15], s39 offen lds
    s_add_u32 m0, m0, 1024
    s_add_u32 s39, s39, 16384
    buffer_load_dwordx4 v238, s[12:15], s39 offen lds
    s_add_u32 m0, m0, 1024
    s_add_u32 s39, s39, 16384
    buffer_load_dwordx4 v238, s[12:15], s39 offen lds
    s_add_u32 m0, m0, 1024
    s_add_u32 s39, s39, 16384
    buffer_load_dwordx4 v238, s[12:15], s39 offen lds
    s_setpc_b64 s[76:77]
PREP_a_issue_4:
    s_add_u32 s19, s41, s42
    v_readlane_b32 s16, v249, s44
    v_readlane_b32 s17, v250, s44
    s_add_u32 s16, s16, s38
    s_add_u32 s17, s17, s38
    s_add_u32 s44, s44, 1
    s_add_u32 s42, s42, 16384
    s_cmp_eq_u32 s42, 49152
    s_cselect_b32 s42, 0, s42
    s_setpc_b64 s[76:77]
PREP_w_issue_4:
    s_mov_b32 s45, 8192
    s_add_u32 s19, s41, s42
    v_readlane_b32 s16, v249, s44
    s_nop 0
    s_bitcmp1_b32 s16, 0
    s_cselect_b32 s17, 16384, s45
    s_cselect_b32 s18, -40960, s45
    s_andn2_b32 s16, s16, 1
    s_add_u32 s16, s16, s38
    s_add_u32 s44, s44, 1
    s_add_u32 s42, s42, 16384
    s_cmp_eq_u32 s42, 98304
    s_cselect_b32 s42, 0, s42
    s_setpc_b64 s[76:77]
K_end:
    s_endpgm
.p2align 6
K_tab:
.short 4096,5137,6178,11379,18660,25941,40502,33223,47784,55065,19706,12427,26988,34269,48830,41551,56096,9264,20736,10448,23824,25008,38384,35296,39568,49856,54128,52944,0,0,0,0
.short 4096,5137,6178,18659,11380,25941,33222,47783,40504,55065,12426,26987,19708,34269,41550,56111,48816,9264,10448,23824,20736,25008,35296,39568,38384,49856,52944,54128,0,0,0,0
.short 4096,5137,6178,11379,25940,18661,33222,40503,55064,47785,12426,19707,34268,26989,41550,48831,9264,56096,10448,20736,25008,23824,35296,38384,49856,39568,52944,54128,0,0,0,0
.short 4096,5137,6178,11379,18660,33221,25942,40503,47784,12425,55066,19707,26988,41549,34270,48831,56096,10448,9264,20736,23824,35296,25008,38384,39568,52944,49856,54128,0,0,0,0
.short 11377,12418,13459,18660,4101,25942,33223,47784,40505,55066,5147,26988,19709,34270,41551,56096,48816,6176,10288,23824,20736,25008,35296,39568,38384,49856,52944,54128,0,0,0,0
.short 11377,12418,13459,4100,25941,18662,33223,40504,55065,47786,5147,19708,34269,26990,41551,48816,6176,56096,10288,20736,25008,23824,35296,38384,49856,39568,52944,54128,0,0,0,0
.short 11377,12418,13459,4100,18661,33222,25943,40504,47785,5146,55067,19708,26989,41550,34271,48816,56096,10288,6176,20736,23824,35296,25008,38384,39568,52944,49856,54128,0,0,0,0
.short 11377,12418,13459,4100,18661,25942,40503,33224,47785,55066,19707,5148,26989,34270,48831,41536,56096,6176,20736,10288,23824,25008,38384,35296,39568,49856,54128,52944,0,0,0,0
.short 18658,19699,20740,4101,25942,11383,33224,40505,55066,47787,5148,12429,34270,26991,41536,48817,6176,56096,9264,10448,25008,23824,35296,38384,49856,39568,52944,54128,0,0,0,0
.short 18658,19699,20740,4101,11382,33223,25944,40505,47786,5147,55068,12429,26990,41551,34256,48817,56096,9264,6176,10448,23824,35296,25008,38384,39568,52944,49856,54128,0,0,0,0
.short 18658,19699,20740,4101,11382,25943,40504,33225,47786,55067,12428,5149,26990,34271,48816,41537,56096,6176,10448,9264,23824,25008,38384,35296,39568,49856,54128,52944,0,0,0,0
.short 18658,19699,20740,11381,4102,25943,33224,47785,40506,55067,5148,26989,12430,34271,41536,56097,48816,6176,9264,23824,10448,25008,35296,39568,38384,49856,52944,54128,0,0,0,0
.short 25939,26980,28021,4102,11383,33224,18665,40506,47787,5148,55069,12430,19711,41536,34257,48818,56096,9264,6176,10448,20736,35296,24848,38384,39568,52944,49856,54128,0,0,0,0
.short 25939,26980,28021,4102,11383,18664,40505,33226,47787,55068,12429,5150,19711,34256,48817,41538,56096,6176,10448,9264,20736,24848,38384,35296,39568,49856,54128,52944,0,0,0,0
.short 25939,26980,28021,11382,4103,18664,33225,47786,40507,55068,5149,19710,12431,34256,41537,56098,48816,6176,9264,20736,10448,24848,35296,39568,38384,49856,52944,54128,0,0,0,0
.short 25939,26980,28021,4102,18663,11384,33225,40506,55067,47788,5149,12430,34271,19696,41537,48818,6176,56096,9264,10448,24848,20736,35296,38384,49856,39568,52944,54128,0,0,0,0
.short 33220,34261,35302,4103,11384,18665,40506,25947,47788,55069,12430,5151,19696,26977,48818,41539,56096,6176,10448,9264,20736,23824,38384,25008,39568,49856,54128,52944,0,0,0,0
.short 33220,34261,35302,11383,4104,18665,25946,47787,40508,55069,5150,19711,12416,26977,41538,56099,48816,6176,9264,20736,10448,23824,25008,39568,38384,49856,52944,54128,0,0,0,0
.short 33220,34261,35302,4103,18664,11385,25946,40507,55068,47789,5150,12431,26976,19697,41538,48819,6176,56096,9264,10448,23824,20736,25008,38384,49856,39568,52944,54128,0,0,0,0
.short 33220,34261,35302,4103,11384,25945,18666,40507,47788,5149,55070,12431,19696,41537,26978,48819,56096,9264,6176,10448,20736,25008,23824,38384,39568,52944,49856,54128,0,0,0,0
.short 40501,41542,42583,11384,4105,18666,25947,47788,33229,55070,5151,19696,12417,26978,34259,56100,48816,6176,9264,20736,10448,23824,25008,39408,35296,49856,52944,54128,0,0,0,0
.short 40501,41542,42583,4104,18665,11386,25947,33228,55069,47790,5151,12416,26977,19698,34259,48820,6176,56096,9264,10448,23824,20736,25008,35296,49856,39408,52944,54128,0,0,0,0
.short 40501,41542,42583,4104,11385,25946,18667,33228,47789,5150,55071,12416,19697,34258,26979,48820,56096,9264,6176,10448,20736,25008,23824,35296,39408,52944,49856,54128,0,0,0,0
.short 40501,41542,42583,4104,11385,18666,33227,25948,47789,55070,12431,5136,19697,26978,48819,34260,56096,6176,10448,9264,20736,23824,35296,25008,39408,49856,54128,52944,0,0,0,0
.short 47782,48823,49864,4105,18666,11387,25948,33229,55070,40511,5136,12417,26978,19699,34260,41541,6176,56096,9264,10448,23824,20736,25008,35296,39568,38384,52944,54128,0,0,0,0
.short 47782,48823,49864,4105,11386,25947,18668,33229,40510,5151,55056,12417,19698,34259,26980,41541,56096,9264,6176,10448,20736,25008,23824,35296,38384,52944,39568,54128,0,0,0,0
.short 47782,48823,49864,4105,11386,18667,33228,25949,40510,55071,12416,5137,19698,26979,41540,34261,56096,6176,10448,9264,20736,23824,35296,25008,38384,39568,54128,52944,0,0,0,0
.short 47782,48823,49864,11385,4106,18667,25948,40509,33230,55071,5136,19697,12418,26979,34260,56101,41536,6176,9264,20736,10448,23824,25008,38384,35296,39568,52944,54128,0,0,0,0
.short 55063,56104,57145,4106,11387,25948,18669,33230,40511,5136,47777,12418,19699,34260,26981,41542,48816,9264,6176,10448,20736,25008,23824,35296,38384,49856,39568,53968,0,0,0,0
.short 55063,56104,57145,4106,11387,18668,33229,25950,40511,47776,12417,5138,19699,26980,41541,34262,48816,6176,10448,9264,20736,23824,35296,25008,38384,39568,53968,49856,0,0,0,0
.short 55063,56104,57145,11386,4107,18668,25949,40510,33231,47776,5137,19698,12419,26980,34261,48822,41536,6176,9264,20736,10448,23824,25008,38384,35296,39568,49856,53968,0,0,0,0
.short 55063,56104,57145,4106,18667,11388,25949,33230,47791,40496,5137,12418,26979,19700,34261,41542,6176,48816,9264,10448,23824,20736,25008,35296,39568,38384,49856,53968,0,0,0,0
.short 4104,5145,6186,11387,18668,25949,40510,33231,47776,55057,19698,12419,26980,34261,48822,41543,56096,9264,20736,10448,23824,25008,38384,35296,39568,49856,54128,52944,0,0,0,0
.short 4104,5145,6186,18667,11388,25949,33230,47791,40496,55057,12418,26979,19700,34261,41542,56103,48816,9264,10448,23824,20736,25008,35296,39568,38384,49856,52944,54128,0,0,0,0
.short 4104,5145,6186,11387,25948,18669,33230,40511,55056,47777,12418,19699,34260,26981,41542,48823,9264,56096,10448,20736,25008,23824,35296,38384,49856,39568,52944,54128,0,0,0,0
.short 4104,5145,6186,11387,18668,33229,25950,40511,47776,12417,55058,19699,26980,41541,34262,48823,56096,10448,9264,20736,23824,35296,25008,38384,39568,52944,49856,54128,0,0,0,0
.short 11385,12426,13467,18668,4109,25950,33231,47776,40497,55058,5139,26980,19701,34262,41543,56104,48816,6176,10288,23824,20736,25008,35296,39568,38384,49856,52944,54128,0,0,0,0
.short 11385,12426,13467,4108,25949,18670,33231,40496,55057,47778,5139,19700,34261,26982,41543,48824,6176,56096,10288,20736,25008,23824,35296,38384,49856,39568,52944,54128,0,0,0,0
.short 11385,12426,13467,4108,18669,33230,25951,40496,47777,5138,55059,19700,26981,41542,34263,48824,56096,10288,6176,20736,23824,35296,25008,38384,39568,52944,49856,54128,0,0,0,0
.short 11385,12426,13467,4108,18669,25950,40511,33216,47777,55058,19699,5140,26981,34262,48823,41544,56096,6176,20736,10288,23824,25008,38384,35296,39568,49856,54128,52944,0,0,0,0
.short 18666,19707,20748,4109,25950,11391,33216,40497,55058,47779,5140,12421,34262,26983,41544,48825,6176,56096,9264,10448,25008,23824,35296,38384,49856,39568,52944,54128,0,0,0,0
.short 18666,19707,20748,4109,11390,33231,25936,40497,47778,5139,55060,12421,26982,41543,34264,48825,56096,9264,6176,10448,23824,35296,25008,38384,39568,52944,49856,54128,0,0,0,0
.short 18666,19707,20748,4109,11390,25951,40496,33217,47778,55059,12420,5141,26982,34263,48824,41545,56096,6176,10448,9264,23824,25008,38384,35296,39568,49856,54128,52944,0,0,0,0
.short 18666,19707,20748,11389,4110,25951,33216,47777,40498,55059,5140,26981,12422,34263,41544,56105,48816,6176,9264,23824,10448,25008,35296,39568,38384,49856,52944,54128,0,0,0,0
.short 25947,26988,28029,4110,11391,33216,18657,40498,47779,5140,55061,12422,19703,41544,34265,48826,56096,9264,6176,10448,20736,35296,24848,38384,39568,52944,49856,54128,0,0,0,0
.short 25947,26988,28029,4110,11391,18656,40497,33218,47779,55060,12421,5142,19703,34264,48825,41546,56096,6176,10448,9264,20736,24848,38384,35296,39568,49856,54128,52944,0,0,0,0
.short 25947,26988,28029,11390,4111,18656,33217,47778,40499,55060,5141,19702,12423,34264,41545,56106,48816,6176,9264,20736,10448,24848,35296,39568,38384,49856,52944,54128,0,0,0,0
.short 25947,26988,28029,4110,18671,11376,33217,40498,55059,47780,5141,12422,34263,19704,41545,48826,6176,56096,9264,10448,24848,20736,35296,38384,49856,39568,52944,54128,0,0,0,0
.short 33228,34269,35310,4111,11376,18657,40498,25939,47780,55061,12422,5143,19704,26985,48826,41547,56096,6176,10448,9264,20736,23824,38384,25008,39568,49856,54128,52944,0,0,0,0
.short 33228,34269,35310,11391,4096,18657,25938,47779,40500,55061,5142,19703,12424,26985,41546,56107,48816,6176,9264,20736,10448,23824,25008,39568,38384,49856,52944,54128,0,0,0,0
.short 33228,34269,35310,4111,18656,11377,25938,40499,55060,47781,5142,12423,26984,19705,41546,48827,6176,56096,9264,10448,23824,20736,25008,38384,49856,39568,52944,54128,0,0,0,0
.short 33228,34269,35310,4111,11376,25937,18658,40499,47780,5141,55062,12423,19704,41545,26986,48827,56096,9264,6176,10448,20736,25008,23824,38384,39568,52944,49856,54128,0,0,0,0
.short 40509,41550,42591,11376,4097,18658,25939,47780,33221,55062,5143,19704,12425,26986,34267,56108,48816,6176,9264,20736,10448,23824,25008,39408,35296,49856,52944,54128,0,0,0,0
.short 40509,41550,42591,4096,18657,11378,25939,33220,55061,47782,5143,12424,26985,19706,34267,48828,6176,56096,9264,10448,23824,20736,25008,35296,49856,39408,52944,54128,0,0,0,0
.short 40509,41550,42591,4096,11377,25938,18659,33220,47781,5142,55063,12424,19705,34266,26987,48828,56096,9264,6176,10448,20736,25008,23824,35296,39408,52944,49856,54128,0,0,0,0
.short 40509,41550,42591,4096,11377,18658,33219,25940,47781,55062,12423,5144,19705,26986,48827,34268,56096,6176,10448,9264,20736,23824,35296,25008,39408,49856,54128,52944,0,0,0,0
.short 47790,48831,49856,4097,18658,11379,25940,33221,55062,40503,5144,12425,26986,19707,34268,41549,6176,56096,9264,10448,23824,20736,25008,35296,39568,38384,52944,54128,0,0,0,0
.short 47790,48831,49856,4097,11378,25939,18660,33221,40502,5143,55064,12425,19706,34267,26988,41549,56096,9264,6176,10448,20736,25008,23824,35296,38384,52944,39568,54128,0,0,0,0
.short 47790,48831,49856,4097,11378,18659,33220,25941,40502,55063,12424,5145,19706,26987,41548,34269,56096,6176,10448,9264,20736,23824,35296,25008,38384,39568,54128,52944,0,0,0,0
.short 47790,48831,49856,11377,4098,18659,25940,40501,33222,55063,5144,19705,12426,26987,34268,56109,41536,6176,9264,20736,10448,23824,25008,38384,35296,39568,52944,54128,0,0,0,0
.short 55071,56096,57137,4098,11379,25940,18661,33222,40503,5144,47785,12426,19707,34268,26989,41550,48816,9264,6176,10448,20736,25008,23824,35296,38384,49856,39568,53968,0,0,0,0
.short 55071,56096,57137,4098,11379,18660,33221,25942,40503,47784,12425,5146,19707,26988,41549,34270,48816,6176,10448,9264,20736,23824,35296,25008,38384,39568,53968,49856,0,0,0,0
.short 55071,56096,57137,11378,4099,18660,25941,40502,33223,47784,5145,19706,12427,26988,34269,48830,41536,6176,9264,20736,10448,23824,25008,38384,35296,39568,49856,53968,0,0,0,0
.short 55071,56096,57137,4098,18659,11380,25941,33222,47783,40504,5145,12426,26987,19708,34269,41550,6176,48816,9264,10448,23824,20736,25008,35296,39568,38384,49856,53968,0,0,0,0
.section .rodata,"a"
.p2align 6
.amdhsa_kernel interleave_layers__ssm_conv_h3__mixer_s_mlp__prompt_kernel
  .amdhsa_next_free_vgpr 256
  .amdhsa_next_free_sgpr 102
  .amdhsa_accum_offset 256
  .amdhsa_group_segment_fixed_size 0
  .amdhsa_kernarg_size 112
  .amdhsa_user_sgpr_count 2
  .amdhsa_user_sgpr_kernarg_segment_ptr 1
  .amdhsa_system_sgpr_workgroup_id_x 1
  .amdhsa_float_denorm_mode_32 3
.end_amdhsa_kernel
```

```asm
; @launch grid=(256,1,1) block=(512,1,1) lds=163840
.amdgcn_target "amdgcn-amd-amdhsa--gfx950"
.text
.globl interleave_layers__ssm_conv_h3__mixer_s_mlp__prompt_kernel
.p2align 8
.type interleave_layers__ssm_conv_h3__mixer_s_mlp__prompt_kernel,@function
interleave_layers__ssm_conv_h3__mixer_s_mlp__prompt_kernel:
    s_cmp_ge_u32 s2, 256
    s_cbranch_scc1 K_end
    s_load_dwordx8 s[8:15], s[0:1], 8
    s_load_dwordx2 s[6:7], s[0:1], 0
    s_load_dwordx8 s[68:75], s[0:1], 56
    s_load_dwordx2 s[4:5], s[0:1], 104
    s_load_dwordx2 s[84:85], s[0:1], 96
    s_memrealtime s[46:47]
    s_load_dwordx2 s[96:97], s[0:1], 40
    v_lshrrev_b32 v1, 6, v0
    s_nop 0
    v_readfirstlane_b32 s30, v1
    s_getpc_b64 s[48:49]
K_pc:
    s_lshr_b32 s36, s2, 3
    s_lshl_b32 s36, s36, 11
    v_lshlrev_b32 v4, 2, v0
    v_add_u32 v4, s36, v4
    v_cmp_gt_u32 vcc, K_end-K_pc-8, v4
    s_nop 0
    s_and_saveexec_b64 s[36:37], vcc
    s_cbranch_execz K_3
    v_mov_b32 v5, s49
    v_add_co_u32 v4, vcc, s48, v4
    s_nop 1
    v_addc_co_u32 v5, vcc, 0, v5, vcc
    global_load_dword v250, v[4:5], off
K_3:
    s_mov_b64 exec, -1
    v_and_b32 v6, 31, v0
    v_lshrrev_b32 v7, 5, v0
    s_and_b32 s34, s2, 7
    s_lshr_b32 s35, s2, 3
    s_lshl_b32 s36, s35, 17
    s_lshl_b32 s37, s34, 8
    s_add_u32 s36, s36, s37
    v_lshlrev_b32 v8, 13, v7
    v_lshl_add_u32 v8, v6, 3, v8
    v_add_u32 v12, s36, v8
    v_add_u32 v14, 4096, v12
    s_mov_b32 s18, 4194304
    s_mov_b32 s19, 0x20000
    s_mov_b32 s22, s18
    s_mov_b32 s23, s19
    s_waitcnt lgkmcnt(0)
    s_mov_b32 s86, 256
    s_mov_b32 s87, 0x20000
    v_mov_b32 v78, 0
    s_lshl_b32 s45, s2, 3
    s_add_u32 s45, s45, s30
    s_cmp_lg_u32 s45, 4
    s_cbranch_scc1 KV_t0
    s_getreg_b32 s45, hwreg(HW_REG_XCC_ID, 0, 3)
    s_lshl_b32 s45, s45, 1
    s_lshl_b32 s44, s46, 6
    s_or_b32 s44, s44, s45
    s_or_b32 s44, s44, 1
    v_mov_b32 v76, s44
    v_mov_b32 v77, 0
    s_mov_b64 exec, 1
    buffer_store_dwordx2 v[76:77], v78, s[84:87], 0 offen sc1
    s_mov_b64 exec, -1
KV_t0:
    s_mov_b64 s[16:17], s[8:9]
    s_mov_b64 s[20:21], s[10:11]
    buffer_load_dwordx2 v[28:29], v12, s[16:19], 0 offen offset:0 nt
    buffer_load_dwordx2 v[30:31], v12, s[16:19], 0 offen offset:2048 nt
    buffer_load_dwordx2 v[32:33], v14, s[16:19], 0 offen offset:0 nt
    buffer_load_dwordx2 v[34:35], v14, s[16:19], 0 offen offset:2048 nt
    buffer_load_dwordx2 v[36:37], v12, s[20:23], 0 offen offset:0 nt
    buffer_load_dwordx2 v[38:39], v12, s[20:23], 0 offen offset:2048 nt
    buffer_load_dwordx2 v[40:41], v14, s[20:23], 0 offen offset:0 nt
    buffer_load_dwordx2 v[42:43], v14, s[20:23], 0 offen offset:2048 nt
    v_subrev_u32 v9, 6144, v12
    v_subrev_u32 v10, 4096, v12
    v_subrev_u32 v11, 2048, v12
    s_lshl_b32 s37, s34, 10
    v_lshlrev_b32 v16, 5, v6
    v_add_u32 v16, s37, v16
    s_mov_b32 s24, s12
    s_mov_b32 s25, s13
    s_mov_b32 s26, 0x2000
    s_mov_b32 s27, 0x20000
    v_and_b32 v8, 1, v7
    v_lshl_add_u32 v16, v8, 4, v16
    buffer_load_dwordx4 v[44:47], v16, s[24:27], 0 offen
    s_cmp_lg_u32 s30, 4
    s_cbranch_scc1 KV_t2
    buffer_load_dword v76, v78, s[84:87], 0 offen sc1
KV_t2:
    s_bfm_b64 exec, 32, 0
    buffer_load_dwordx2 v[22:23], v9, s[16:19], 0 offen nt
    buffer_load_dwordx2 v[24:25], v10, s[16:19], 0 offen nt
    buffer_load_dwordx2 v[26:27], v11, s[16:19], 0 offen nt
    s_mov_b64 exec, -1
    v_and_b32 v1, 63, v0
    v_lshlrev_b32 v2, 4, v1
    v_lshlrev_b32 v3, 2, v1
    s_mov_b32 s67, 0
    s_mov_b32 s60, 0
    s_mov_b32 s61, 40000
    s_mov_b32 s52, 0
    s_mov_b32 s55, 0
    s_mov_b32 s92, 0
    s_mov_b32 s93, 0
    s_mov_b32 s94, 0
    s_mov_b32 s56, s4
    s_mov_b32 s57, s5
    s_mov_b32 s58, 0xa000000
    s_mov_b32 s59, 0x20000
    s_add_u32 s62, s4, 33554432
    s_addc_u32 s63, s5, 0
    s_and_b32 s41, s30, 3
    s_and_b32 s38, s2, 7
    s_lshl_b32 s38, s38, 5
    s_lshr_b32 s39, s2, 3
    s_add_u32 s38, s38, s39
    s_lshl_b32 s39, s38, 2
    s_add_u32 s39, s39, s41
    s_mul_i32 s40, s41, 24576
    s_lshr_b32 s36, s39, 1
    s_lshl_b32 s36, s36, 2
    s_load_dword s98, s[96:97], s36
    s_lshl_b32 s36, s39, 12
    s_add_u32 s12, s14, s36
    s_addc_u32 s13, s15, 0
    s_mov_b32 s14, 4096
    s_mov_b32 s15, 0x20000
    s_lshr_b32 s45, s30, 2
    s_lshl_b32 s45, s45, 11
    s_add_u32 s36, s45, 0xffffffc0
    v_add_u32 v70, s36, v2
    v_add_u32 v71, 16, v70
    s_add_u32 s36, s45, 0x3c0
    v_add_u32 v72, s36, v2
    v_add_u32 v73, 16, v72
    s_mov_b32 s36, 4032
    v_add_u32 v74, s36, v2
    v_add_u32 v75, 16, v74
    s_and_b32 s34, s2, 7
    s_lshr_b32 s35, s2, 3
    v_mov_b32 v80, 0
    v_mov_b32 v81, 0
    v_mov_b32 v82, 0
    v_mov_b32 v83, 0
    v_add_u32 v86, s40, v2
    ds_write_b128 v86, v[80:83] offset:22784
    s_bfm_b64 exec, 26, 0
    ds_write_b128 v86, v[80:83] offset:23808
    s_mov_b64 exec, -1
    v_lshlrev_b32 v8, 2, v7
    v_sub_u32 v8, 60, v8
    v_lshrrev_b32 v85, 3, v8
    v_bfe_u32 v84, v6, 1, 3
    v_xor_b32 v85, v85, v84
    v_lshlrev_b32 v85, 4, v85
    v_and_b32 v8, 7, v8
    v_lshl_add_u32 v85, v8, 1, v85
    v_lshl_add_u32 v84, v6, 9, v85
    v_add_u32 v84, 98304, v84
    s_waitcnt vmcnt(0)
    s_cmp_lg_u32 s30, 4
    s_cbranch_scc1 KV_t1
KV_t1:
    buffer_load_dwordx4 v[52:55], v70, s[12:15], 0 offen nt
    buffer_load_dwordx2 v[56:57], v71, s[12:15], 0 offen nt
    buffer_load_dwordx4 v[58:61], v72, s[12:15], 0 offen nt
    buffer_load_dwordx2 v[62:63], v73, s[12:15], 0 offen nt
    buffer_load_dwordx4 v[64:67], v74, s[12:15], 0 offen nt
    buffer_load_dwordx2 v[68:69], v75, s[12:15], 0 offen nt
    v_mov_b32 v48, v44
    v_mov_b32 v49, v45
    v_mov_b32 v50, v46
    v_mov_b32 v51, v47
    v_mov_b32 v126, v30
    v_mov_b32 v127, v31
    v_mov_b32 v128, v32
    v_mov_b32 v129, v33
    v_mov_b32 v130, v34
    v_mov_b32 v131, v35
    v_permlane32_swap_b32 v44, v48
    v_permlane32_swap_b32 v45, v49
    v_permlane32_swap_b32 v46, v50
    v_permlane32_swap_b32 v47, v51
    v_permlane32_swap_b32 v22, v126
    v_permlane32_swap_b32 v23, v127
    v_permlane32_swap_b32 v24, v128
    v_permlane32_swap_b32 v25, v129
    v_permlane32_swap_b32 v26, v130
    v_permlane32_swap_b32 v27, v131
    v_lshlrev_b32 v88, 16, v44
    v_and_b32 v90, 0xffff0000, v44
    v_lshlrev_b32 v92, 16, v45
    v_and_b32 v94, 0xffff0000, v45
    v_lshlrev_b32 v89, 16, v46
    v_and_b32 v91, 0xffff0000, v46
    v_lshlrev_b32 v93, 16, v47
    v_and_b32 v95, 0xffff0000, v47
    v_lshlrev_b32 v96, 16, v22
    v_and_b32 v97, 0xffff0000, v22
    v_lshlrev_b32 v98, 16, v24
    v_and_b32 v99, 0xffff0000, v24
    v_lshlrev_b32 v100, 16, v26
    v_and_b32 v101, 0xffff0000, v26
    v_lshlrev_b32 v102, 16, v28
    v_and_b32 v103, 0xffff0000, v28
    v_lshlrev_b32 v104, 16, v30
    v_and_b32 v105, 0xffff0000, v30
    v_lshlrev_b32 v106, 16, v32
    v_and_b32 v107, 0xffff0000, v32
    v_lshlrev_b32 v108, 16, v34
    v_and_b32 v109, 0xffff0000, v34
    v_lshlrev_b32 v110, 16, v36
    v_and_b32 v111, 0xffff0000, v36
    v_lshlrev_b32 v112, 16, v38
    v_and_b32 v113, 0xffff0000, v38
    v_lshlrev_b32 v114, 16, v40
    v_and_b32 v115, 0xffff0000, v40
    v_lshlrev_b32 v116, 16, v42
    v_and_b32 v117, 0xffff0000, v42
    v_pk_mul_f32 v[118:119], v[96:97], v[94:95]
    v_pk_mul_f32 v[120:121], v[98:99], v[94:95]
    v_pk_mul_f32 v[122:123], v[100:101], v[94:95]
    v_pk_mul_f32 v[124:125], v[102:103], v[94:95]
    v_pk_fma_f32 v[118:119], v[98:99], v[92:93], v[118:119]
    v_pk_fma_f32 v[120:121], v[100:101], v[92:93], v[120:121]
    v_pk_fma_f32 v[122:123], v[102:103], v[92:93], v[122:123]
    v_pk_fma_f32 v[124:125], v[104:105], v[92:93], v[124:125]
    v_pk_fma_f32 v[118:119], v[100:101], v[90:91], v[118:119]
    v_pk_fma_f32 v[120:121], v[102:103], v[90:91], v[120:121]
    v_pk_fma_f32 v[122:123], v[104:105], v[90:91], v[122:123]
    v_pk_fma_f32 v[124:125], v[106:107], v[90:91], v[124:125]
    v_pk_fma_f32 v[118:119], v[102:103], v[88:89], v[118:119]
    v_pk_fma_f32 v[120:121], v[104:105], v[88:89], v[120:121]
    v_pk_fma_f32 v[122:123], v[106:107], v[88:89], v[122:123]
    v_pk_fma_f32 v[124:125], v[108:109], v[88:89], v[124:125]
    v_pk_mul_f32 v[118:119], v[118:119], v[110:111]
    v_pk_mul_f32 v[120:121], v[120:121], v[112:113]
    v_pk_mul_f32 v[122:123], v[122:123], v[114:115]
    v_pk_mul_f32 v[124:125], v[124:125], v[116:117]
    v_cvt_pk_bf16_f32 v136, v124, v122
    v_cvt_pk_bf16_f32 v137, v120, v118
    ds_write_b64 v84, v[136:137] offset:0
    v_cvt_pk_bf16_f32 v138, v125, v123
    v_cvt_pk_bf16_f32 v139, v121, v119
    ds_write_b64 v84, v[138:139] offset:128
    v_lshlrev_b32 v88, 16, v48
    v_and_b32 v90, 0xffff0000, v48
    v_lshlrev_b32 v92, 16, v49
    v_and_b32 v94, 0xffff0000, v49
    v_lshlrev_b32 v89, 16, v50
    v_and_b32 v91, 0xffff0000, v50
    v_lshlrev_b32 v93, 16, v51
    v_and_b32 v95, 0xffff0000, v51
    v_lshlrev_b32 v96, 16, v23
    v_and_b32 v97, 0xffff0000, v23
    v_lshlrev_b32 v98, 16, v25
    v_and_b32 v99, 0xffff0000, v25
    v_lshlrev_b32 v100, 16, v27
    v_and_b32 v101, 0xffff0000, v27
    v_lshlrev_b32 v102, 16, v29
    v_and_b32 v103, 0xffff0000, v29
    v_lshlrev_b32 v104, 16, v31
    v_and_b32 v105, 0xffff0000, v31
    v_lshlrev_b32 v106, 16, v33
    v_and_b32 v107, 0xffff0000, v33
    v_lshlrev_b32 v108, 16, v35
    v_and_b32 v109, 0xffff0000, v35
    v_lshlrev_b32 v110, 16, v37
    v_and_b32 v111, 0xffff0000, v37
    v_lshlrev_b32 v112, 16, v39
    v_and_b32 v113, 0xffff0000, v39
    v_lshlrev_b32 v114, 16, v41
    v_and_b32 v115, 0xffff0000, v41
    v_lshlrev_b32 v116, 16, v43
    v_and_b32 v117, 0xffff0000, v43
    v_pk_mul_f32 v[118:119], v[96:97], v[94:95]
    v_pk_mul_f32 v[120:121], v[98:99], v[94:95]
    v_pk_mul_f32 v[122:123], v[100:101], v[94:95]
    v_pk_mul_f32 v[124:125], v[102:103], v[94:95]
    v_pk_fma_f32 v[118:119], v[98:99], v[92:93], v[118:119]
    v_pk_fma_f32 v[120:121], v[100:101], v[92:93], v[120:121]
    v_pk_fma_f32 v[122:123], v[102:103], v[92:93], v[122:123]
    v_pk_fma_f32 v[124:125], v[104:105], v[92:93], v[124:125]
    v_pk_fma_f32 v[118:119], v[100:101], v[90:91], v[118:119]
    v_pk_fma_f32 v[120:121], v[102:103], v[90:91], v[120:121]
    v_pk_fma_f32 v[122:123], v[104:105], v[90:91], v[122:123]
    v_pk_fma_f32 v[124:125], v[106:107], v[90:91], v[124:125]
    v_pk_fma_f32 v[118:119], v[102:103], v[88:89], v[118:119]
    v_pk_fma_f32 v[120:121], v[104:105], v[88:89], v[120:121]
    v_pk_fma_f32 v[122:123], v[106:107], v[88:89], v[122:123]
    v_pk_fma_f32 v[124:125], v[108:109], v[88:89], v[124:125]
    v_pk_mul_f32 v[118:119], v[118:119], v[110:111]
    v_pk_mul_f32 v[120:121], v[120:121], v[112:113]
    v_pk_mul_f32 v[122:123], v[122:123], v[114:115]
    v_pk_mul_f32 v[124:125], v[124:125], v[116:117]
    v_cvt_pk_bf16_f32 v140, v124, v122
    v_cvt_pk_bf16_f32 v141, v120, v118
    ds_write_b64 v84, v[140:141] offset:256
    v_cvt_pk_bf16_f32 v142, v125, v123
    v_cvt_pk_bf16_f32 v143, v121, v119
    ds_write_b64 v84, v[142:143] offset:384
    s_cmp_lg_u32 s30, 4
    s_cbranch_scc1 HB_2
    v_add_u32 v18, 162816, v3
    ds_write_b32 v18, v78
    s_mov_b32 s53, 0
    s_waitcnt vmcnt(6)
HB_p:
    v_readfirstlane_b32 s52, v76
    s_nop 0
    s_cmp_eq_u32 s52, 0
    s_cbranch_scc1 HB_r
    s_cmp_ge_u32 s53, 60
    s_cbranch_scc1 HB_q
    s_add_u32 s54, s46, 8192
    s_lshl_b32 s54, s54, 6
    s_sub_u32 s54, s54, s52
    s_cmp_lt_u32 s54, 786432
    s_cbranch_scc1 HB_q
HB_r:
    buffer_load_dword v76, v78, s[84:87], 0 offen sc1
    s_waitcnt vmcnt(0)
    s_add_u32 s53, s53, 1
    s_cmp_lt_u32 s53, s61
    s_cbranch_scc1 HB_p
    s_mov_b32 s52, 1
    s_mov_b32 s61, 0
HB_q:
    v_mov_b32 v18, 162828
    v_mov_b32 v19, s52
    s_waitcnt lgkmcnt(0)
    ds_write_b32 v18, v19
HB_2:
    s_add_u32 s16, s4, 0x2000000
    s_addc_u32 s17, s5, 0
    s_mov_b32 s18, 0x8000000
    s_mov_b32 s19, 0x20000
    v_lshrrev_b32 v8, 3, v0
    v_and_b32 v85, 7, v0
    v_lshlrev_b32 v149, 12, v8
    v_lshl_add_u32 v149, v85, 4, v149
    s_lshl_b32 s36, s34, 24
    s_sub_u32 s37, 31, s35
    s_lshl_b32 s37, s37, 7
    s_add_u32 s36, s36, s37
    s_add_u32 s37, s36, 262144
    v_lshrrev_b32 v148, 3, v8
    v_xor_b32 v148, v148, v85
    v_lshlrev_b32 v148, 4, v148
    v_lshl_add_u32 v148, v8, 7, v148
    v_add_u32 v148, 98304, v148
    v_mov_b32 v18, 162828
    s_waitcnt lgkmcnt(0)
    s_barrier
    ds_read_b128 v[152:155], v148 offset:0
    ds_read_b128 v[156:159], v148 offset:8192
    ds_read_b32 v19, v18
    s_waitcnt lgkmcnt(2)
    v_or_b32 v152, 1, v152
    buffer_store_dwordx4 v[152:155], v149, s[16:19], s36 offen sc1
    s_waitcnt lgkmcnt(1)
    v_or_b32 v156, 1, v156
    buffer_store_dwordx4 v[156:159], v149, s[16:19], s37 offen sc1
    s_waitcnt lgkmcnt(0)
    v_readfirstlane_b32 s52, v19
    s_cmp_lg_u32 s30, 0
    s_cbranch_scc1 KV_ni
    s_cmp_ge_u32 s35, 16
    s_cbranch_scc1 KV_ni
    v_mov_b32 v8, s52
    s_lshl_b32 s37, s34, 7
    s_lshl_b32 s53, s35, 10
    s_add_u32 s37, s37, s53
    s_add_u32 s37, s37, 23101440
    s_mov_b64 exec, 1
    buffer_store_dword v8, v78, s[56:59], s37 offen sc1
    s_mov_b64 exec, -1
KV_ni:
    s_cmp_ge_u32 s2, 32
    s_cbranch_scc1 KV_n3
    s_cmp_lg_u32 s30, 5
    s_cbranch_scc1 KV_n3
    s_and_b32 s42, s2, 7
    s_lshl_b32 s42, s42, 10
    s_lshr_b32 s43, s2, 3
    s_lshl_b32 s43, s43, 14
    s_add_u32 s42, s42, s43
    s_add_u32 s42, s42, 39714816
    v_lshrrev_b32 v8, 5, v1
    v_mul_u32_u24 v8, 7680, v8
    v_add_u32 v8, v8, v2
    buffer_store_dwordx4 v[80:83], v8, s[56:59], s42 offen sc1
KV_n3:
    s_bfe_u32 s32, s52, 0x30001
    s_add_u32 s32, s32, s2
    s_and_b32 s32, s32, 7
    s_lshr_b32 s33, s2, 3
    s_and_b32 s28, s32, 2
    s_lshr_b32 s53, s32, 2
    s_or_b32 s28, s28, s53
    s_lshl_b32 s28, s28, 2
    s_and_b32 s53, s33, 3
    s_add_u32 s28, s28, s53
    s_and_b32 s31, s32, 1
    s_lshr_b32 s33, s33, 2
    s_lshl_b32 s29, s31, 3
    s_add_u32 s29, s29, s33
    s_xor_b32 s99, s29, 1
    v_and_b32 v199, 7, v0
    v_lshrrev_b32 v228, 6, v0
    v_lshlrev_b32 v228, 4, v228
    v_bfe_u32 v229, v0, 3, 3
    v_add_u32 v228, v228, v229
    s_lshr_b32 s78, s29, 1
    s_lshl_b32 s78, s78, 16
    s_and_b32 s79, s29, 1
    s_lshl_b32 s79, s79, 7
    s_add_u32 s78, s78, s79
    s_lshr_b32 s79, s30, 1
    s_lshl_b32 s79, s79, 13
    s_add_u32 s78, s78, s79
    v_lshlrev_b32 v196, 8, v228
    v_lshl_add_u32 v196, v199, 4, v196
    v_add_u32 v196, s78, v196
    s_lshl_b32 s78, s28, 7
    s_lshl_b32 s79, s29, 3
    s_add_u32 s78, s78, s79
    v_add_u32 v197, s78, v199
    v_lshlrev_b32 v198, 11, v197
    v_lshrrev_b32 v229, 2, v228
    v_lshlrev_b32 v229, 3, v229
    v_and_b32 v228, 3, v228
    v_add_u32 v228, v228, v229
    v_lshl_add_u32 v198, v228, 3, v198
    v_and_b32 v197, 15, v197
    v_lshlrev_b32 v197, 4, v197
    v_and_b32 v229, 15, v228
    v_lshl_add_u32 v197, v229, 9, v197
    v_lshrrev_b32 v229, 4, v228
    v_lshl_add_u32 v197, v229, 14, v197
    s_lshr_b32 s78, s28, 3
    s_lshl_b32 s78, s78, 2
    s_and_b32 s79, s28, 3
    s_add_u32 s78, s78, s79
    s_lshl_b32 s78, s78, 24
    s_and_b32 s79, s28, 4
    s_lshl_b32 s79, s79, 11
    s_add_u32 s78, s78, s79
    s_and_b32 s79, s29, 4
    s_lshl_b32 s79, s79, 6
    s_add_u32 s78, s78, s79
    s_and_b32 s79, s29, 2
    s_lshl_b32 s79, s79, 2
    s_add_u32 s78, s78, s79
    s_lshl_b32 s79, s31, 18
    s_add_u32 s78, s78, s79
    v_add_u32 v197, s78, v197
    s_lshl_b32 s36, s34, 5
    s_add_u32 s36, s36, s35
    s_lshl_b32 s36, s36, 7
    s_add_u32 s36, s36, 23068672
    v_mov_b32 v18, 1
    v_mov_b32 v19, 162820
    v_mov_b32 v21, 0
    s_mov_b64 exec, 1
    s_waitcnt vmcnt(0)
    ds_add_rtn_u32 v20, v19, v18
    v_mov_b32 v19, s52
    s_waitcnt lgkmcnt(0)
    v_readfirstlane_b32 s54, v20
    s_nop 0
    s_and_b32 s54, s54, 7
    s_cmp_lg_u32 s54, 7
    s_cbranch_scc1 pub_1
    buffer_store_dword v19, v21, s[56:59], s36 offen sc1
pub_1:
    s_mov_b64 exec, -1
    s_mov_b32 s8, s6
    s_mov_b32 s9, s7
    s_mov_b32 s10, 0x400000
    s_mov_b32 s11, 0x20000
    buffer_load_dwordx2 v[180:181], v198, s[8:11], 0 offen offset:0 nt
    buffer_load_dwordx2 v[182:183], v198, s[8:11], 0 offen offset:32 nt
    buffer_load_dwordx2 v[184:185], v198, s[8:11], 0 offen offset:128 nt
    buffer_load_dwordx2 v[186:187], v198, s[8:11], 0 offen offset:160 nt
    v_add_u32 v160, s45, v86
    v_alignbit_b32 v88, v53, v52, 16
    v_mov_b32 v92, v53
    v_alignbit_b32 v96, v54, v53, 16
    v_alignbit_b32 v89, v54, v53, 16
    v_mov_b32 v93, v54
    v_alignbit_b32 v97, v55, v54, 16
    v_alignbit_b32 v90, v55, v54, 16
    v_mov_b32 v94, v55
    v_alignbit_b32 v98, v56, v55, 16
    v_alignbit_b32 v91, v56, v55, 16
    v_mov_b32 v95, v56
    v_alignbit_b32 v99, v57, v56, 16
    ds_write_b128 v160, v[88:91] offset:0
    ds_write_b128 v160, v[92:95] offset:4160
    ds_write_b128 v160, v[96:99] offset:8320
    ds_write_b128 v160, v[54:57] offset:12480
    v_alignbit_b32 v100, v59, v58, 16
    v_mov_b32 v104, v59
    v_alignbit_b32 v108, v60, v59, 16
    v_alignbit_b32 v101, v60, v59, 16
    v_mov_b32 v105, v60
    v_alignbit_b32 v109, v61, v60, 16
    v_alignbit_b32 v102, v61, v60, 16
    v_mov_b32 v106, v61
    v_alignbit_b32 v110, v62, v61, 16
    v_alignbit_b32 v103, v62, v61, 16
    v_mov_b32 v107, v62
    v_alignbit_b32 v111, v63, v62, 16
    ds_write_b128 v160, v[100:103] offset:1024
    ds_write_b128 v160, v[104:107] offset:5184
    ds_write_b128 v160, v[108:111] offset:9344
    ds_write_b128 v160, v[60:63] offset:13504
    v_alignbit_b32 v112, v65, v64, 16
    v_mov_b32 v116, v65
    v_alignbit_b32 v120, v66, v65, 16
    v_alignbit_b32 v113, v66, v65, 16
    v_mov_b32 v117, v66
    v_alignbit_b32 v121, v67, v66, 16
    v_alignbit_b32 v114, v67, v66, 16
    v_mov_b32 v118, v67
    v_alignbit_b32 v122, v68, v67, 16
    v_alignbit_b32 v115, v68, v67, 16
    v_mov_b32 v119, v68
    v_alignbit_b32 v123, v69, v68, 16
    s_mov_b64 exec, 0xf
    ds_write_b128 v86, v[112:115] offset:4096
    ds_write_b128 v86, v[116:119] offset:8256
    ds_write_b128 v86, v[120:123] offset:12416
    ds_write_b128 v86, v[66:69] offset:16576
    s_mov_b64 exec, -1
    s_waitcnt lgkmcnt(0)
    s_barrier
    v_mov_b32 v238, 0
    v_mov_b32 v239, 0
    v_mov_b32 v240, 0
    v_mov_b32 v241, 0
    v_mov_b32 v242, 0
    v_mov_b32 v243, 0
    v_mov_b32 v244, 0
    v_mov_b32 v245, 0
    v_mov_b32 v246, 0
    v_mov_b32 v247, 0
    s_cmp_ge_u32 s30, 4
    s_cbranch_scc1 FR_b
    s_and_b32 s38, s2, 7
    s_lshl_b32 s38, s38, 5
    s_lshr_b32 s39, s2, 3
    s_add_u32 s38, s38, s39
    s_lshl_b32 s39, s38, 2
    s_add_u32 s39, s39, s30
    s_mul_i32 s40, s30, 24576
    s_and_b32 s36, s39, 127
    s_lshl_b32 s36, s36, 12
    s_lshr_b32 s37, s39, 7
    s_lshl_b32 s37, s37, 24
    s_add_u32 s36, s36, s37
    s_add_u32 s36, s36, 33554432
    s_add_u32 s16, s4, s36
    s_addc_u32 s17, s5, 0
    s_mov_b32 s18, 4096
    s_mov_b32 s19, 0x20000
    v_lshrrev_b32 v6, 2, v1
    v_mul_u32_u24 v12, 96, v6
    v_and_b32 v6, 3, v1
    v_lshl_add_u32 v12, v6, 4, v12
    v_add_u32 v12, s40, v12
    v_and_b32 v35, 15, v1
    v_lshrrev_b32 v36, 4, v1
    v_and_b32 v6, 3, v35
    v_mul_u32_u24 v32, 4160, v6
    v_lshl_add_u32 v32, v36, 4, v32
    v_lshrrev_b32 v6, 2, v35
    v_lshl_add_u32 v32, v6, 3, v32
    v_add_u32 v32, s40, v32
    v_sub_u32 v6, 15, v35
    v_mul_u32_u24 v34, 96, v6
    v_add_u32 v34, s40, v34
    v_lshl_add_u32 v33, v36, 4, v34
    ds_read_b64 v[72:73], v32 offset:0
    ds_read_b64 v[74:75], v32 offset:8
    ds_read_b64 v[76:77], v32 offset:32
    ds_read_b64 v[78:79], v32 offset:40
    ds_read_b64 v[80:81], v32 offset:1024
    ds_read_b64 v[82:83], v32 offset:1032
    ds_read_b64 v[84:85], v32 offset:1056
    ds_read_b64 v[86:87], v32 offset:1064
    ds_read_b64 v[88:89], v32 offset:2048
    ds_read_b64 v[90:91], v32 offset:2056
    ds_read_b64 v[92:93], v32 offset:2080
    ds_read_b64 v[94:95], v32 offset:2088
    ds_read_b64 v[96:97], v32 offset:3072
    ds_read_b64 v[98:99], v32 offset:3080
    ds_read_b64 v[100:101], v32 offset:3104
    ds_read_b64 v[102:103], v32 offset:3112
    s_bitcmp1_b32 s39, 0
    s_cselect_b32 s36, 0, 16
    s_lshl_b32 s41, s98, s36
    s_and_b32 s41, s41, 0xffff0000
    s_lshr_b32 s36, s41, 16
    v_lshl_add_u32 v6, v36, 3, v35
    v_sub_u32 v6, 31, v6
    v_mov_b32 v10, s36
    v_mov_b32 v11, s41
    v_and_b32 v8, 1, v6
    v_cmp_eq_u32 vcc, 1, v8
    s_nop 1
    v_cndmask_b32 v10, v10, v11, vcc
    v_ashrrev_i32 v6, 1, v6
    v_cmp_eq_u32 vcc, 0, v6
    s_nop 1
    v_cndmask_b32 v152, 0, v10, vcc
    v_cmp_eq_u32 vcc, 1, v6
    s_nop 1
    v_cndmask_b32 v153, 0, v10, vcc
    v_cmp_eq_u32 vcc, 2, v6
    s_nop 1
    v_cndmask_b32 v154, 0, v10, vcc
    v_cmp_eq_u32 vcc, 3, v6
    s_nop 1
    v_cndmask_b32 v155, 0, v10, vcc
    v_cmp_eq_u32 vcc, 8, v6
    s_nop 1
    v_cndmask_b32 v156, 0, v10, vcc
    v_cmp_eq_u32 vcc, 9, v6
    s_nop 1
    v_cndmask_b32 v157, 0, v10, vcc
    v_cmp_eq_u32 vcc, 10, v6
    s_nop 1
    v_cndmask_b32 v158, 0, v10, vcc
    v_cmp_eq_u32 vcc, 11, v6
    s_nop 1
    v_cndmask_b32 v159, 0, v10, vcc
    s_add_u32 s12, s4, 0x2100000
    s_addc_u32 s13, s5, 0
    s_mov_b32 s14, 0x7f00000
    s_mov_b32 s15, 0x20000
    v_bfe_u32 v6, v1, 2, 2
    v_mul_u32_u24 v168, 24640, v6
    v_mul_u32_u24 v6, 72, v36
    v_add_u32 v168, v168, v6
    v_and_b32 v6, 3, v1
    v_lshl_add_u32 v168, v6, 3, v168
    s_mul_i32 s36, s30, 1152
    v_add_u32 v168, s36, v168
    v_lshrrev_b32 v6, 5, v1
    v_mul_u32_u24 v169, 261632, v6
    v_add_u32 v169, v169, v2
    s_lshr_b32 s44, s38, 4
    s_lshl_b32 s44, s44, 14
    s_and_b32 s37, s38, 15
    s_lshl_b32 s37, s37, 9
    s_add_u32 s44, s44, s37
    s_and_b32 s37, s30, 1
    s_lshl_b32 s37, s37, 13
    s_add_u32 s44, s44, s37
    s_lshr_b32 s37, s30, 1
    s_lshl_b32 s37, s37, 26
    s_add_u32 s44, s44, s37
    s_and_b32 s47, s44, 0x2000
    s_xor_b32 s47, s47, 8192
    s_lshr_b32 s37, s30, 1
    s_lshl_b32 s37, s37, 12
    s_add_u32 s47, s47, s37
    s_and_b32 s37, s2, 7
    s_lshl_b32 s37, s37, 7
    s_add_u32 s47, s47, s37
    v_mov_b32 v34, 162824
    v_mov_b32 v7, 1
    s_mul_i32 s36, s30, 24640
    v_mul_u32_u24 v170, 72, v35
    v_lshl_add_u32 v170, v36, 3, v170
    v_add_u32 v170, s36, v170
    v_lshlrev_b32 v6, 10, v1
    v_mov_b32 v35, 0
    s_and_b32 s45, s2, 31
    s_lshl_b32 s45, s45, 7
    s_add_u32 s45, s45, 23117824
    s_cmp_lg_u32 s30, 0
    s_cbranch_scc1 CV_w
    s_and_b32 s36, s2, 7
    s_lshl_b32 s36, s36, 12
    s_add_u32 s36, s36, 23068672
    v_lshlrev_b32 v9, 7, v1
    v_add_u32 v9, s36, v9
    s_mov_b32 s53, 0
    s_add_u32 s54, s52, 0
    s_bfm_b64 exec, 32, 0
poll_2:
    buffer_load_dword v8, v9, s[56:59], 0 offen sc1
    s_waitcnt vmcnt(0)
    v_xor_b32 v8, s54, v8
    v_cmp_eq_u32 vcc, 0, v8
    s_nop 0
    s_cmp_eq_u64 vcc, exec
    s_cbranch_scc1 pok_3
    s_sleep 5
    s_add_u32 s53, s53, 1
    s_cmp_lt_u32 s53, s61
    s_cbranch_scc1 poll_2
    s_mov_b32 s61, 0
pok_3:
    s_mov_b64 exec, -1
    v_mov_b32 v8, 162832
    v_mov_b32 v9, 1
    s_waitcnt lgkmcnt(0)
    ds_write_b32 v8, v9
CV_w:
    v_mov_b32 v8, 162832
spin_4:
    ds_read_b32 v9, v8
    s_waitcnt lgkmcnt(0)
    v_readfirstlane_b32 s53, v9
    s_nop 0
    s_cmp_ge_u32 s53, 1
    s_cbranch_scc0 spin_4
    buffer_load_dwordx4 v[16:19], v2, s[16:19], 0 offen offset:0 sc1 nt
    buffer_load_dwordx4 v[20:23], v2, s[16:19], 0 offen offset:1024 sc1 nt
    buffer_load_dwordx4 v[24:27], v2, s[16:19], 0 offen offset:2048 sc1 nt
    buffer_load_dwordx4 v[28:31], v2, s[16:19], 0 offen offset:3072 sc1 nt
    s_waitcnt vmcnt(3)
    ds_write_b128 v12, v[16:19] offset:16640
    s_waitcnt vmcnt(2)
    ds_write_b128 v12, v[20:23] offset:18176
    s_waitcnt vmcnt(1)
    ds_write_b128 v12, v[24:27] offset:19712
    s_waitcnt vmcnt(0)
    ds_write_b128 v12, v[28:31] offset:21248
    v_mov_b32 v8, 162836
    v_mov_b32 v9, 1
    s_mov_b64 exec, 1
    ds_add_u32 v8, v9
    s_mov_b64 exec, -1
    s_waitcnt lgkmcnt(0)
    ds_read_b128 v[136:139], v33 offset:21248
    ds_read_b128 v[140:143], v33 offset:19712
    ds_read_b128 v[144:147], v33 offset:18176
    ds_read_b128 v[148:151], v33 offset:16640
    s_waitcnt lgkmcnt(3)
    v_mfma_f32_16x16x32_bf16 v[40:43], v[152:155], v[136:139], 0
    v_mfma_f32_16x16x32_bf16 v[44:47], v[156:159], v[136:139], 0
    s_waitcnt lgkmcnt(2)
    v_mfma_f32_16x16x32_bf16 v[48:51], v[152:155], v[140:143], 0
    v_mfma_f32_16x16x32_bf16 v[52:55], v[156:159], v[140:143], 0
    s_waitcnt lgkmcnt(1)
    v_mfma_f32_16x16x32_bf16 v[56:59], v[152:155], v[144:147], 0
    v_mfma_f32_16x16x32_bf16 v[60:63], v[156:159], v[144:147], 0
    s_waitcnt lgkmcnt(0)
    v_mfma_f32_16x16x32_bf16 v[64:67], v[152:155], v[148:151], 0
    v_mfma_f32_16x16x32_bf16 v[68:71], v[156:159], v[148:151], 0
    s_mov_b32 s43, 0
CV_r:
    s_waitcnt lgkmcnt(0)
    v_mfma_f32_16x16x32_bf16 v[40:43], v[72:75], v[136:139], v[40:43]
    v_mfma_f32_16x16x32_bf16 v[48:51], v[72:75], v[140:143], v[48:51]
    v_mfma_f32_16x16x32_bf16 v[56:59], v[72:75], v[144:147], v[56:59]
    v_mfma_f32_16x16x32_bf16 v[64:67], v[72:75], v[148:151], v[64:67]
    v_mfma_f32_16x16x32_bf16 v[44:47], v[76:79], v[136:139], v[44:47]
    v_mfma_f32_16x16x32_bf16 v[52:55], v[76:79], v[140:143], v[52:55]
    v_mfma_f32_16x16x32_bf16 v[60:63], v[76:79], v[144:147], v[60:63]
    v_mfma_f32_16x16x32_bf16 v[68:71], v[76:79], v[148:151], v[68:71]
    v_mfma_f32_16x16x32_bf16 v[48:51], v[80:83], v[136:139], v[48:51]
    v_mfma_f32_16x16x32_bf16 v[56:59], v[80:83], v[140:143], v[56:59]
    v_mfma_f32_16x16x32_bf16 v[64:67], v[80:83], v[144:147], v[64:67]
    v_mfma_f32_16x16x32_bf16 v[52:55], v[84:87], v[136:139], v[52:55]
    v_mfma_f32_16x16x32_bf16 v[60:63], v[84:87], v[140:143], v[60:63]
    v_mfma_f32_16x16x32_bf16 v[68:71], v[84:87], v[144:147], v[68:71]
    v_mfma_f32_16x16x32_bf16 v[56:59], v[88:91], v[136:139], v[56:59]
    v_mfma_f32_16x16x32_bf16 v[64:67], v[88:91], v[140:143], v[64:67]
    v_mfma_f32_16x16x32_bf16 v[60:63], v[92:95], v[136:139], v[60:63]
    v_mfma_f32_16x16x32_bf16 v[68:71], v[92:95], v[140:143], v[68:71]
    v_mfma_f32_16x16x32_bf16 v[64:67], v[96:99], v[136:139], v[64:67]
    v_mfma_f32_16x16x32_bf16 v[68:71], v[100:103], v[136:139], v[68:71]
    ds_read_b128 v[152:155], v33 offset:21344
    ds_read_b128 v[156:159], v33 offset:19808
    ds_read_b128 v[160:163], v33 offset:18272
    ds_read_b128 v[164:167], v33 offset:16736
    ds_read_b64 v[104:105], v32 offset:64
    ds_read_b64 v[106:107], v32 offset:72
    ds_read_b64 v[108:109], v32 offset:96
    ds_read_b64 v[110:111], v32 offset:104
    ds_read_b64 v[112:113], v32 offset:1088
    ds_read_b64 v[114:115], v32 offset:1096
    ds_read_b64 v[116:117], v32 offset:1120
    ds_read_b64 v[118:119], v32 offset:1128
    ds_read_b64 v[120:121], v32 offset:2112
    ds_read_b64 v[122:123], v32 offset:2120
    ds_read_b64 v[124:125], v32 offset:2144
    ds_read_b64 v[126:127], v32 offset:2152
    ds_read_b64 v[128:129], v32 offset:3136
    ds_read_b64 v[130:131], v32 offset:3144
    ds_read_b64 v[132:133], v32 offset:3168
    ds_read_b64 v[134:135], v32 offset:3176
    s_waitcnt lgkmcnt(0)
    v_mfma_f32_16x16x32_bf16 v[40:43], v[104:107], v[152:155], v[40:43]
    v_mfma_f32_16x16x32_bf16 v[48:51], v[104:107], v[156:159], v[48:51]
    v_mfma_f32_16x16x32_bf16 v[56:59], v[104:107], v[160:163], v[56:59]
    v_mfma_f32_16x16x32_bf16 v[64:67], v[104:107], v[164:167], v[64:67]
    v_mfma_f32_16x16x32_bf16 v[44:47], v[108:111], v[152:155], v[44:47]
    v_mfma_f32_16x16x32_bf16 v[52:55], v[108:111], v[156:159], v[52:55]
    v_mfma_f32_16x16x32_bf16 v[60:63], v[108:111], v[160:163], v[60:63]
    v_mfma_f32_16x16x32_bf16 v[68:71], v[108:111], v[164:167], v[68:71]
    v_mfma_f32_16x16x32_bf16 v[48:51], v[112:115], v[152:155], v[48:51]
    v_mfma_f32_16x16x32_bf16 v[56:59], v[112:115], v[156:159], v[56:59]
    v_mfma_f32_16x16x32_bf16 v[64:67], v[112:115], v[160:163], v[64:67]
    v_mfma_f32_16x16x32_bf16 v[52:55], v[116:119], v[152:155], v[52:55]
    v_mfma_f32_16x16x32_bf16 v[60:63], v[116:119], v[156:159], v[60:63]
    v_mfma_f32_16x16x32_bf16 v[68:71], v[116:119], v[160:163], v[68:71]
    v_mfma_f32_16x16x32_bf16 v[56:59], v[120:123], v[152:155], v[56:59]
    v_mfma_f32_16x16x32_bf16 v[64:67], v[120:123], v[156:159], v[64:67]
    v_mfma_f32_16x16x32_bf16 v[60:63], v[124:127], v[152:155], v[60:63]
    v_mfma_f32_16x16x32_bf16 v[68:71], v[124:127], v[156:159], v[68:71]
    v_mfma_f32_16x16x32_bf16 v[64:67], v[128:131], v[152:155], v[64:67]
    v_mfma_f32_16x16x32_bf16 v[68:71], v[132:135], v[152:155], v[68:71]
    ds_read_b128 v[136:139], v33 offset:21440
    ds_read_b128 v[140:143], v33 offset:19904
    ds_read_b128 v[144:147], v33 offset:18368
    ds_read_b128 v[148:151], v33 offset:16832
    ds_read_b64 v[72:73], v32 offset:128
    ds_read_b64 v[74:75], v32 offset:136
    ds_read_b64 v[76:77], v32 offset:160
    ds_read_b64 v[78:79], v32 offset:168
    ds_read_b64 v[80:81], v32 offset:1152
    ds_read_b64 v[82:83], v32 offset:1160
    ds_read_b64 v[84:85], v32 offset:1184
    ds_read_b64 v[86:87], v32 offset:1192
    ds_read_b64 v[88:89], v32 offset:2176
    ds_read_b64 v[90:91], v32 offset:2184
    ds_read_b64 v[92:93], v32 offset:2208
    ds_read_b64 v[94:95], v32 offset:2216
    ds_read_b64 v[96:97], v32 offset:3200
    ds_read_b64 v[98:99], v32 offset:3208
    ds_read_b64 v[100:101], v32 offset:3232
    ds_read_b64 v[102:103], v32 offset:3240
    v_add_u32 v32, 128, v32
    v_add_u32 v33, 192, v33
    s_add_u32 s43, s43, 1
    s_cmp_lt_u32 s43, 4
    s_cbranch_scc1 CV_r
CV_l:
    s_waitcnt lgkmcnt(10)
    v_mfma_f32_16x16x32_bf16 v[40:43], v[72:75], v[136:139], v[40:43]
    ds_read_b128 v[152:155], v33 offset:21344
    v_mfma_f32_16x16x32_bf16 v[48:51], v[72:75], v[140:143], v[48:51]
    ds_read_b128 v[156:159], v33 offset:19808
    s_cmp_eq_u32 s43, 5
    v_mfma_f32_16x16x32_bf16 v[56:59], v[72:75], v[144:147], v[56:59]
    ds_read_b128 v[160:163], v33 offset:18272
    s_cselect_b64 exec, 1, 0
    buffer_load_dword v12, v35, s[56:59], s45 offen sc1
    s_mov_b64 exec, -1
    v_mfma_f32_16x16x32_bf16 v[64:67], v[72:75], v[148:151], v[64:67]
    ds_read_b128 v[164:167], v33 offset:16736
    v_mfma_f32_16x16x32_bf16 v[44:47], v[76:79], v[136:139], v[44:47]
    ds_read_b64 v[104:105], v32 offset:64
    v_mfma_f32_16x16x32_bf16 v[52:55], v[76:79], v[140:143], v[52:55]
    ds_read_b64 v[106:107], v32 offset:72
    v_mfma_f32_16x16x32_bf16 v[60:63], v[76:79], v[144:147], v[60:63]
    ds_read_b64 v[108:109], v32 offset:96
    v_mfma_f32_16x16x32_bf16 v[68:71], v[76:79], v[148:151], v[68:71]
    ds_read_b64 v[110:111], v32 offset:104
    v_mfma_f32_16x16x32_bf16 v[48:51], v[80:83], v[136:139], v[48:51]
    ds_read_b64 v[112:113], v32 offset:1088
    v_mfma_f32_16x16x32_bf16 v[56:59], v[80:83], v[140:143], v[56:59]
    ds_read_b64 v[114:115], v32 offset:1096
    s_waitcnt lgkmcnt(10)
    v_mfma_f32_16x16x32_bf16 v[64:67], v[80:83], v[144:147], v[64:67]
    ds_read_b64 v[116:117], v32 offset:1120
    v_mfma_f32_16x16x32_bf16 v[52:55], v[84:87], v[136:139], v[52:55]
    ds_read_b64 v[118:119], v32 offset:1128
    v_mfma_f32_16x16x32_bf16 v[60:63], v[84:87], v[140:143], v[60:63]
    ds_read_b64 v[120:121], v32 offset:2112
    v_mfma_f32_16x16x32_bf16 v[68:71], v[84:87], v[144:147], v[68:71]
    ds_read_b64 v[122:123], v32 offset:2120
    v_mfma_f32_16x16x32_bf16 v[56:59], v[88:91], v[136:139], v[56:59]
    ds_read_b64 v[124:125], v32 offset:2144
    v_mfma_f32_16x16x32_bf16 v[64:67], v[88:91], v[140:143], v[64:67]
    ds_read_b64 v[126:127], v32 offset:2152
    v_mfma_f32_16x16x32_bf16 v[60:63], v[92:95], v[136:139], v[60:63]
    ds_read_b64 v[128:129], v32 offset:3136
    v_mfma_f32_16x16x32_bf16 v[68:71], v[92:95], v[140:143], v[68:71]
    ds_read_b64 v[130:131], v32 offset:3144
    v_mfma_f32_16x16x32_bf16 v[64:67], v[96:99], v[136:139], v[64:67]
    ds_read_b64 v[132:133], v32 offset:3168
    v_mfma_f32_16x16x32_bf16 v[68:71], v[100:103], v[136:139], v[68:71]
    ds_read_b64 v[134:135], v32 offset:3176
    s_waitcnt lgkmcnt(10)
    v_mfma_f32_16x16x32_bf16 v[40:43], v[104:107], v[152:155], v[40:43]
    ds_read_b128 v[136:139], v33 offset:21440
    v_mfma_f32_16x16x32_bf16 v[48:51], v[104:107], v[156:159], v[48:51]
    ds_read_b128 v[140:143], v33 offset:19904
    v_mfma_f32_16x16x32_bf16 v[56:59], v[104:107], v[160:163], v[56:59]
    ds_read_b128 v[144:147], v33 offset:18368
    v_mfma_f32_16x16x32_bf16 v[64:67], v[104:107], v[164:167], v[64:67]
    ds_read_b128 v[148:151], v33 offset:16832
    v_mfma_f32_16x16x32_bf16 v[44:47], v[108:111], v[152:155], v[44:47]
    ds_read_b64 v[72:73], v32 offset:128
    v_mfma_f32_16x16x32_bf16 v[52:55], v[108:111], v[156:159], v[52:55]
    ds_read_b64 v[74:75], v32 offset:136
    v_add_u32 v33, 192, v33
    v_mfma_f32_16x16x32_bf16 v[60:63], v[108:111], v[160:163], v[60:63]
    ds_read_b64 v[76:77], v32 offset:160
    s_add_u32 s43, s43, 1
    v_mfma_f32_16x16x32_bf16 v[68:71], v[108:111], v[164:167], v[68:71]
    ds_read_b64 v[78:79], v32 offset:168
    s_cmp_lt_u32 s43, 8
    v_mfma_f32_16x16x32_bf16 v[48:51], v[112:115], v[152:155], v[48:51]
    ds_read_b64 v[80:81], v32 offset:1152
    v_mfma_f32_16x16x32_bf16 v[56:59], v[112:115], v[156:159], v[56:59]
    ds_read_b64 v[82:83], v32 offset:1160
    s_waitcnt lgkmcnt(10)
    v_mfma_f32_16x16x32_bf16 v[64:67], v[112:115], v[160:163], v[64:67]
    ds_read_b64 v[84:85], v32 offset:1184
    v_mfma_f32_16x16x32_bf16 v[52:55], v[116:119], v[152:155], v[52:55]
    ds_read_b64 v[86:87], v32 offset:1192
    v_mfma_f32_16x16x32_bf16 v[60:63], v[116:119], v[156:159], v[60:63]
    ds_read_b64 v[88:89], v32 offset:2176
    v_mfma_f32_16x16x32_bf16 v[68:71], v[116:119], v[160:163], v[68:71]
    ds_read_b64 v[90:91], v32 offset:2184
    v_mfma_f32_16x16x32_bf16 v[56:59], v[120:123], v[152:155], v[56:59]
    ds_read_b64 v[92:93], v32 offset:2208
    v_mfma_f32_16x16x32_bf16 v[64:67], v[120:123], v[156:159], v[64:67]
    ds_read_b64 v[94:95], v32 offset:2216
    v_mfma_f32_16x16x32_bf16 v[60:63], v[124:127], v[152:155], v[60:63]
    ds_read_b64 v[96:97], v32 offset:3200
    v_mfma_f32_16x16x32_bf16 v[68:71], v[124:127], v[156:159], v[68:71]
    ds_read_b64 v[98:99], v32 offset:3208
    v_mfma_f32_16x16x32_bf16 v[64:67], v[128:131], v[152:155], v[64:67]
    ds_read_b64 v[100:101], v32 offset:3232
    v_mfma_f32_16x16x32_bf16 v[68:71], v[132:135], v[152:155], v[68:71]
    ds_read_b64 v[102:103], v32 offset:3240
    v_add_u32 v32, 128, v32
    s_cbranch_scc1 CV_l
    v_cvt_pk_bf16_f32 v16, v40, v41
    v_cvt_pk_bf16_f32 v17, v42, v43
    ds_write_b64 v170, v[16:17] offset:0
    v_cvt_pk_bf16_f32 v18, v44, v45
    v_cvt_pk_bf16_f32 v19, v46, v47
    ds_write_b64 v170, v[18:19] offset:32
    v_cvt_pk_bf16_f32 v20, v48, v49
    v_cvt_pk_bf16_f32 v21, v50, v51
    ds_write_b64 v170, v[20:21] offset:1152
    v_cvt_pk_bf16_f32 v22, v52, v53
    v_cvt_pk_bf16_f32 v23, v54, v55
    ds_write_b64 v170, v[22:23] offset:1184
    v_cvt_pk_bf16_f32 v24, v56, v57
    v_cvt_pk_bf16_f32 v25, v58, v59
    ds_write_b64 v170, v[24:25] offset:2304
    v_cvt_pk_bf16_f32 v26, v60, v61
    v_cvt_pk_bf16_f32 v27, v62, v63
    ds_write_b64 v170, v[26:27] offset:2336
    v_cvt_pk_bf16_f32 v28, v64, v65
    v_cvt_pk_bf16_f32 v29, v66, v67
    ds_write_b64 v170, v[28:29] offset:3456
    v_cvt_pk_bf16_f32 v30, v68, v69
    v_cvt_pk_bf16_f32 v31, v70, v71
    ds_write_b64 v170, v[30:31] offset:3488
    s_mov_b64 exec, 1
    ds_add_u32 v34, v7
    s_mov_b64 exec, -1
    s_mov_b32 s53, 0
    s_waitcnt vmcnt(0)
CV_v:
    v_readfirstlane_b32 s94, v12
    s_nop 0
    s_sub_u32 s94, s94, s52
    s_and_b32 s37, s94, 0xfffffe01
    s_cbranch_scc0 CV_k
    buffer_load_dword v12, v35, s[56:59], s45 offen sc1
    s_waitcnt vmcnt(0)
    s_add_u32 s53, s53, 1
    s_cmp_lt_u32 s53, s61
    s_cbranch_scc1 CV_v
    s_mov_b32 s61, 0
    s_mov_b32 s94, 0
CV_k:
    s_lshr_b32 s94, s94, 1
    s_add_u32 s37, s94, 65536
    v_mov_b32 v8, 162844
    v_mov_b32 v9, s37
    ds_write_b32 v8, v9
    s_cmp_gt_u32 s94, 10
    s_cselect_b32 s37, 0x2000, 0
    s_xor_b32 s44, s44, s37
    s_xor_b32 s45, s47, s37
    s_add_u32 s45, s45, 23101440
    v_mov_b32 v8, 162824
spin_5:
    ds_read_b32 v9, v8
    s_waitcnt lgkmcnt(0)
    v_readfirstlane_b32 s53, v9
    s_nop 0
    s_cmp_ge_u32 s53, 6
    s_cbranch_scc0 spin_5
    ds_read_b64_tr_b16 v[104:105], v168 offset:0
    ds_read_b64_tr_b16 v[106:107], v168 offset:32
    ds_read_b64_tr_b16 v[108:109], v168 offset:288
    ds_read_b64_tr_b16 v[110:111], v168 offset:320
    ds_read_b64_tr_b16 v[112:113], v168 offset:576
    ds_read_b64_tr_b16 v[114:115], v168 offset:608
    ds_read_b64_tr_b16 v[116:117], v168 offset:864
    ds_read_b64_tr_b16 v[118:119], v168 offset:896
    s_waitcnt lgkmcnt(6)
    v_or_b32 v104, 1, v104
    buffer_store_dwordx4 v[104:107], v169, s[12:15], s44 offen sc1
    s_add_u32 s44, s44, 16777216
    s_waitcnt lgkmcnt(4)
    v_or_b32 v108, 1, v108
    buffer_store_dwordx4 v[108:111], v169, s[12:15], s44 offen sc1
    s_add_u32 s44, s44, 16777216
    s_waitcnt lgkmcnt(2)
    v_or_b32 v112, 1, v112
    buffer_store_dwordx4 v[112:115], v169, s[12:15], s44 offen sc1
    s_add_u32 s44, s44, 16777216
    s_waitcnt lgkmcnt(0)
    v_or_b32 v116, 1, v116
    buffer_store_dwordx4 v[116:119], v169, s[12:15], s44 offen sc1
    s_add_u32 s44, s44, 16777216
    v_mov_b32 v8, 162836
    v_mov_b32 v9, 1
    s_mov_b64 exec, 1
    ds_add_u32 v8, v9
    s_mov_b64 exec, -1
    s_mov_b64 exec, 0xf
    s_waitcnt vmcnt(0)
    buffer_atomic_add v7, v6, s[56:59], s45 offen sc1
    s_mov_b64 exec, -1
    s_branch FR_end
FR_b:
    s_cmp_ge_u32 s2, 32
    s_cbranch_scc1 FB_np
    s_cmp_lg_u32 s30, 5
    s_cbranch_scc1 FB_np
    s_and_b32 s42, s2, 7
    s_lshl_b32 s42, s42, 10
    s_lshr_b32 s43, s2, 3
    s_lshl_b32 s43, s43, 14
    s_add_u32 s42, s42, s43
    s_add_u32 s42, s42, 39714816
    v_mov_b32 v14, 0
    s_mov_b64 exec, 1
    s_mov_b32 s46, -1
    s_mov_b32 s47, -1
    s_add_u32 s48, s4, s42
    s_addc_u32 s49, s5, 0
    s_load_dword s101, s[48:49], 384
    s_waitcnt lgkmcnt(0)
    s_memtime s[34:35]
    s_waitcnt lgkmcnt(0)
    s_load_dword s101, s[48:49], 0
    s_waitcnt lgkmcnt(0)
    s_memtime s[36:37]
    s_waitcnt lgkmcnt(0)
    s_sub_u32 s43, s36, s34
    s_min_u32 s46, s46, s43
    s_load_dword s101, s[48:49], 8192
    s_waitcnt lgkmcnt(0)
    s_memtime s[34:35]
    s_waitcnt lgkmcnt(0)
    s_sub_u32 s43, s34, s36
    s_min_u32 s47, s47, s43
    s_load_dword s101, s[48:49], 128
    s_waitcnt lgkmcnt(0)
    s_memtime s[36:37]
    s_waitcnt lgkmcnt(0)
    s_sub_u32 s43, s36, s34
    s_min_u32 s46, s46, s43
    s_load_dword s101, s[48:49], 8320
    s_waitcnt lgkmcnt(0)
    s_memtime s[34:35]
    s_waitcnt lgkmcnt(0)
    s_sub_u32 s43, s34, s36
    s_min_u32 s47, s47, s43
    s_cmp_lt_u32 s47, s46
    s_cselect_b32 s45, 1, 0
    s_lshr_b32 s46, s28, 2
    s_xor_b32 s45, s45, s46
    s_and_b32 s45, s45, 1
    s_lshl_b32 s45, s45, 8
    s_or_b32 s43, s45, 1
    v_mov_b32 v12, s43
    buffer_atomic_add v12, v14, s[84:87], 0 offen offset:4 sc0 sc1
    s_waitcnt vmcnt(0)
    v_readfirstlane_b32 s36, v12
    s_nop 0
    s_add_u32 s36, s36, s43
    s_and_b32 s37, s36, 255
    s_cmp_lg_u32 s37, 21
    s_cbranch_scc1 FB_np
    s_lshr_b32 s36, s36, 8
    s_lshl_b32 s36, s36, 1
    s_add_u32 s36, s36, s52
    s_bfm_b64 exec, 32, 0
    v_mov_b32 v12, s36
    v_lshlrev_b32 v13, 7, v1
    s_mov_b32 s36, 23117824
    buffer_store_dword v12, v13, s[56:59], s36 offen sc1
FB_np:
    s_mov_b64 exec, -1
    s_getpc_b64 s[34:35]
K_tpc:
    s_lshl_b32 s36, s29, 2
    s_and_b32 s37, s28, 3
    s_add_u32 s36, s36, s37
    s_lshl_b32 s36, s36, 6
    s_add_u32 s36, s36, K_tab-K_tpc
    s_add_u32 s34, s34, s36
    s_addc_u32 s35, s35, 0
    v_and_b32 v248, 31, v1
    v_lshlrev_b32 v248, 1, v248
    global_load_ushort v251, v248, s[34:35]
    v_lshrrev_b32 v253, 3, v1
    v_lshlrev_b32 v238, 11, v253
    v_and_b32 v253, 6, v253
    v_and_b32 v254, 7, v1
    v_xor_b32 v253, v253, v254
    v_lshl_add_u32 v238, v253, 4, v238
    v_lshrrev_b32 v253, 4, v1
    v_lshlrev_b32 v239, 11, v253
    v_add_u32 v253, 0, v253
    v_lshlrev_b32 v253, 1, v253
    v_and_b32 v254, 15, v1
    v_xor_b32 v253, v253, v254
    v_lshl_add_u32 v239, v253, 4, v239
    v_lshrrev_b32 v253, 4, v1
    v_lshlrev_b32 v240, 11, v253
    v_add_u32 v253, 4, v253
    v_lshlrev_b32 v253, 1, v253
    v_and_b32 v254, 15, v1
    v_xor_b32 v253, v253, v254
    v_lshl_add_u32 v240, v253, 4, v240
    v_add_u32 v254, 0, v1
    v_mul_u32_u24 v253, 2341, v254
    v_lshrrev_b32 v253, 16, v253
    v_mul_u32_u24 v241, 28, v253
    v_sub_u32 v254, v254, v241
    v_mul_u32_u24 v241, 7168, v253
    v_lshrrev_b32 v253, 1, v253
    v_and_b32 v253, 2, v253
    v_xor_b32 v254, v254, v253
    v_lshl_add_u32 v241, v254, 4, v241
    v_add_u32 v254, 64, v1
    v_mul_u32_u24 v253, 2341, v254
    v_lshrrev_b32 v253, 16, v253
    v_mul_u32_u24 v242, 28, v253
    v_sub_u32 v254, v254, v242
    v_mul_u32_u24 v242, 7168, v253
    v_lshrrev_b32 v253, 1, v253
    v_and_b32 v253, 2, v253
    v_xor_b32 v254, v254, v253
    v_lshl_add_u32 v242, v254, 4, v242
    v_add_u32 v254, 128, v1
    v_mul_u32_u24 v253, 2341, v254
    v_lshrrev_b32 v253, 16, v253
    v_mul_u32_u24 v243, 28, v253
    v_sub_u32 v254, v254, v243
    v_mul_u32_u24 v243, 7168, v253
    v_lshrrev_b32 v253, 1, v253
    v_and_b32 v253, 2, v253
    v_xor_b32 v254, v254, v253
    v_lshl_add_u32 v243, v254, 4, v243
    v_add_u32 v254, 192, v1
    v_mul_u32_u24 v253, 2341, v254
    v_lshrrev_b32 v253, 16, v253
    v_mul_u32_u24 v244, 28, v253
    v_sub_u32 v254, v254, v244
    v_mul_u32_u24 v244, 7168, v253
    v_lshrrev_b32 v253, 1, v253
    v_and_b32 v253, 2, v253
    v_xor_b32 v254, v254, v253
    v_lshl_add_u32 v244, v254, 4, v244
    v_add_u32 v254, 256, v1
    v_mul_u32_u24 v253, 2341, v254
    v_lshrrev_b32 v253, 16, v253
    v_mul_u32_u24 v245, 28, v253
    v_sub_u32 v254, v254, v245
    v_mul_u32_u24 v245, 7168, v253
    v_lshrrev_b32 v253, 1, v253
    v_and_b32 v253, 2, v253
    v_xor_b32 v254, v254, v253
    v_lshl_add_u32 v245, v254, 4, v245
    v_add_u32 v254, 320, v1
    v_mul_u32_u24 v253, 2341, v254
    v_lshrrev_b32 v253, 16, v253
    v_mul_u32_u24 v246, 28, v253
    v_sub_u32 v254, v254, v246
    v_mul_u32_u24 v246, 7168, v253
    v_lshrrev_b32 v253, 1, v253
    v_and_b32 v253, 2, v253
    v_xor_b32 v254, v254, v253
    v_lshl_add_u32 v246, v254, 4, v246
    v_add_u32 v254, 384, v1
    v_mul_u32_u24 v253, 2341, v254
    v_lshrrev_b32 v253, 16, v253
    v_mul_u32_u24 v247, 28, v253
    v_sub_u32 v254, v254, v247
    v_mul_u32_u24 v247, 7168, v253
    v_lshrrev_b32 v253, 1, v253
    v_and_b32 v253, 2, v253
    v_xor_b32 v254, v254, v253
    v_lshl_add_u32 v247, v254, 4, v247
    s_cmp_ge_u32 s30, 6
    s_cbranch_scc1 FB_cs
    s_cmp_lg_u32 s30, 4
    s_cbranch_scc1 FB_ni
    v_mov_b32 v12, s52
    s_lshr_b32 s53, s28, 3
    s_lshl_b32 s53, s53, 2
    s_and_b32 s54, s28, 3
    s_add_u32 s53, s53, s54
    s_lshl_b32 s53, s53, 24
    s_lshr_b32 s54, s28, 2
    s_xor_b32 s54, s54, s94
    s_and_b32 s54, s54, 1
    s_lshl_b32 s54, s54, 13
    s_add_u32 s37, s53, s54
    s_add_u32 s37, s37, 33554432
    s_andn2_b32 s37, s37, 0x2000
    s_lshl_b32 s53, s29, 7
    s_add_u32 s37, s37, s53
    s_add_u32 s37, s37, 6029312
    v_and_b32 v13, 1, v1
    v_lshlrev_b32 v13, 13, v13
    v_lshrrev_b32 v14, 1, v1
    v_lshl_add_u32 v13, v14, 22, v13
    s_mov_b64 exec, 0xf
    buffer_store_dword v12, v13, s[56:59], s37 offen sc1
    s_cmp_lg_u32 s28, 0
    s_cbranch_scc1 FB_n2
    s_add_u32 s37, s53, 23121920
    s_mov_b64 exec, 1
    buffer_store_dword v12, v13, s[56:59], s37 offen sc1
FB_n2:
    s_mov_b64 exec, -1
FB_ni:
    s_waitcnt vmcnt(0)
    v_bfe_u32 v252, v251, 2, 2
    v_lshlrev_b32 v248, 14, v252
    v_and_b32 v252, 3, v251
    v_lshl_add_u32 v248, v252, 11, v248
    v_bfe_u32 v252, v251, 7, 3
    v_lshlrev_b32 v249, 14, v252
    v_bfe_u32 v252, v251, 4, 3
    v_lshl_add_u32 v249, v252, 10, v249
    v_bfe_u32 v252, v251, 13, 3
    v_lshlrev_b32 v250, 14, v252
    v_bfe_u32 v252, v251, 10, 3
    v_lshl_add_u32 v250, v252, 10, v250
    v_mov_b32 v6, 162836
spin_7:
    s_sleep 2
    ds_read_b32 v7, v6
    s_waitcnt lgkmcnt(0)
    v_readfirstlane_b32 s53, v7
    s_nop 0
    s_cmp_ge_u32 s53, 4
    s_cbranch_scc0 spin_7
    s_load_dwordx2 s[48:49], s[0:1], 64
    s_lshl_b32 s45, s2, 1
    s_and_b32 s50, s30, 1
    s_add_u32 s45, s45, s50
    s_mul_i32 s45, s45, 4096
    s_mov_b32 s50, 2097152
    s_mov_b32 s51, 0x20000
    s_waitcnt lgkmcnt(0)
    buffer_load_dwordx4 v[20:23], v2, s[48:51], s45 offen offset:0
    buffer_load_dwordx4 v[20:23], v2, s[48:51], s45 offen offset:1024
    buffer_load_dwordx4 v[20:23], v2, s[48:51], s45 offen offset:2048
    buffer_load_dwordx4 v[20:23], v2, s[48:51], s45 offen offset:3072
    v_mov_b32 v6, 1
    v_mov_b32 v7, 162824
    s_mov_b64 exec, 1
    s_waitcnt vmcnt(0)
    ds_add_u32 v7, v6
    s_mov_b64 exec, -1
    v_mov_b32 v6, 162840
spin_9:
    s_sleep 4
    ds_read_b32 v7, v6
    s_waitcnt lgkmcnt(0)
    v_readfirstlane_b32 s53, v7
    s_nop 0
    s_cmp_ge_u32 s53, 2
    s_cbranch_scc0 spin_9
    s_call_b64 s[76:77], SUB_w1_regs
    s_call_b64 s[76:77], SUB_park
    v_mov_b32 v6, 162840
spin_10:
    s_sleep 3
    ds_read_b32 v7, v6
    s_waitcnt lgkmcnt(0)
    v_readfirstlane_b32 s53, v7
    s_nop 0
    s_cmp_ge_u32 s53, 4
    s_cbranch_scc0 spin_10
    s_mov_b64 s[12:13], s[68:69]
    s_mov_b32 s14, 2097152
    s_mov_b32 s15, 0x20000
    s_and_b32 s35, s30, 1
    s_mul_i32 s38, s99, 128
    s_mul_i32 s41, s35, 65536
    s_add_u32 s38, s38, s41
    s_mul_i32 s41, s35, 4096
    s_add_u32 s41, s41, 24576
    s_mov_b32 s42, 0
    s_mov_b32 s44, s67
    s_mov_b32 s42, 73728
    s_mov_b32 s44, s67
    s_add_u32 s44, s44, 9
    s_and_b32 s44, s44, 15
    s_call_b64 s[76:77], SUB_w_issue_1
    s_waitcnt vmcnt(8)
    s_mov_b32 s42, 81920
    s_mov_b32 s44, s67
    s_add_u32 s44, s44, 10
    s_and_b32 s44, s44, 15
    s_call_b64 s[76:77], SUB_w_issue_1
    s_waitcnt vmcnt(8)
    s_mov_b32 s42, 90112
    s_mov_b32 s44, s67
    s_add_u32 s44, s44, 11
    s_and_b32 s44, s44, 15
    s_call_b64 s[76:77], SUB_w_issue_1
    s_waitcnt vmcnt(8)
    s_and_b32 s36, s29, 6
    s_cmp_eq_u32 s36, 2
    s_cbranch_scc1 pr_11
    s_call_b64 s[76:77], SUB_park2
pr_11:
    s_call_b64 s[76:77], SUB_w1_put
    s_branch FR_end
FB_cs:
    v_and_b32 v164, 15, v1
    v_mov_b32 v165, 0x3f803f80
    v_cmp_eq_u32 vcc, 0, v164
    s_nop 1
    v_cndmask_b32 v16, 0, v165, vcc
    v_cndmask_b32 v17, 0, v165, vcc
    v_cndmask_b32 v18, 0, v165, vcc
    v_cndmask_b32 v19, 0, v165, vcc
    v_cmp_eq_u32 vcc, 1, v164
    s_nop 1
    v_cndmask_b32 v20, 0, v165, vcc
    v_cndmask_b32 v21, 0, v165, vcc
    v_cndmask_b32 v22, 0, v165, vcc
    v_cndmask_b32 v23, 0, v165, vcc
    v_cmp_eq_u32 vcc, 2, v164
    s_nop 1
    v_cndmask_b32 v24, 0, v165, vcc
    v_cndmask_b32 v25, 0, v165, vcc
    v_cndmask_b32 v26, 0, v165, vcc
    v_cndmask_b32 v27, 0, v165, vcc
    v_cmp_eq_u32 vcc, 3, v164
    s_nop 1
    v_cndmask_b32 v28, 0, v165, vcc
    v_cndmask_b32 v29, 0, v165, vcc
    v_cndmask_b32 v30, 0, v165, vcc
    v_cndmask_b32 v31, 0, v165, vcc
    v_cmp_eq_u32 vcc, 4, v164
    s_nop 1
    v_cndmask_b32 v32, 0, v165, vcc
    v_cndmask_b32 v33, 0, v165, vcc
    v_cndmask_b32 v34, 0, v165, vcc
    v_cndmask_b32 v35, 0, v165, vcc
    v_cmp_eq_u32 vcc, 5, v164
    s_nop 1
    v_cndmask_b32 v36, 0, v165, vcc
    v_cndmask_b32 v37, 0, v165, vcc
    v_cndmask_b32 v38, 0, v165, vcc
    v_cndmask_b32 v39, 0, v165, vcc
    v_cmp_eq_u32 vcc, 6, v164
    s_nop 1
    v_cndmask_b32 v40, 0, v165, vcc
    v_cndmask_b32 v41, 0, v165, vcc
    v_cndmask_b32 v42, 0, v165, vcc
    v_cndmask_b32 v43, 0, v165, vcc
    v_cmp_eq_u32 vcc, 7, v164
    s_nop 1
    v_cndmask_b32 v44, 0, v165, vcc
    v_cndmask_b32 v45, 0, v165, vcc
    v_cndmask_b32 v46, 0, v165, vcc
    v_cndmask_b32 v47, 0, v165, vcc
    v_cmp_eq_u32 vcc, 8, v164
    s_nop 1
    v_cndmask_b32 v48, 0, v165, vcc
    v_cndmask_b32 v49, 0, v165, vcc
    v_cndmask_b32 v50, 0, v165, vcc
    v_cndmask_b32 v51, 0, v165, vcc
    v_cmp_eq_u32 vcc, 9, v164
    s_nop 1
    v_cndmask_b32 v52, 0, v165, vcc
    v_cndmask_b32 v53, 0, v165, vcc
    v_cndmask_b32 v54, 0, v165, vcc
    v_cndmask_b32 v55, 0, v165, vcc
    v_cmp_eq_u32 vcc, 10, v164
    s_nop 1
    v_cndmask_b32 v56, 0, v165, vcc
    v_cndmask_b32 v57, 0, v165, vcc
    v_cndmask_b32 v58, 0, v165, vcc
    v_cndmask_b32 v59, 0, v165, vcc
    v_cmp_eq_u32 vcc, 11, v164
    s_nop 1
    v_cndmask_b32 v60, 0, v165, vcc
    v_cndmask_b32 v61, 0, v165, vcc
    v_cndmask_b32 v62, 0, v165, vcc
    v_cndmask_b32 v63, 0, v165, vcc
    v_cmp_eq_u32 vcc, 12, v164
    s_nop 1
    v_cndmask_b32 v64, 0, v165, vcc
    v_cndmask_b32 v65, 0, v165, vcc
    v_cndmask_b32 v66, 0, v165, vcc
    v_cndmask_b32 v67, 0, v165, vcc
    v_cmp_eq_u32 vcc, 13, v164
    s_nop 1
    v_cndmask_b32 v68, 0, v165, vcc
    v_cndmask_b32 v69, 0, v165, vcc
    v_cndmask_b32 v70, 0, v165, vcc
    v_cndmask_b32 v71, 0, v165, vcc
    s_mov_b32 s35, 0
    v_lshrrev_b32 v253, 2, v1
    v_mul_u32_u24 v144, 128, v253
    v_and_b32 v254, 3, v1
    v_lshl_add_u32 v144, v254, 3, v144
    v_add_u32 v144, 24576, v144
    v_bfe_u32 v253, v253, 1, 2
    s_mul_i32 s36, s35, 4
    s_add_u32 s36, s36, 3
    v_xor_b32 v254, s36, v253
    v_lshl_add_u32 v147, v254, 5, v144
    s_mul_i32 s36, s35, 4
    s_add_u32 s36, s36, 2
    v_xor_b32 v254, s36, v253
    v_lshl_add_u32 v146, v254, 5, v144
    s_mul_i32 s36, s35, 4
    s_add_u32 s36, s36, 1
    v_xor_b32 v254, s36, v253
    v_lshl_add_u32 v145, v254, 5, v144
    s_mul_i32 s36, s35, 4
    s_add_u32 s36, s36, 0
    v_xor_b32 v254, s36, v253
    v_lshl_add_u32 v144, v254, 5, v144
    s_and_b32 s35, s30, 1
    s_mul_i32 s35, s35, 4096
    s_add_u32 s35, s35, 73728
    v_add_u32 v144, s35, v144
    v_add_u32 v145, s35, v145
    v_add_u32 v146, s35, v146
    v_add_u32 v147, s35, v147
    s_mov_b32 s35, 0
    v_lshrrev_b32 v253, 2, v1
    v_mul_u32_u24 v148, 448, v253
    v_and_b32 v254, 3, v1
    v_lshl_add_u32 v148, v254, 3, v148
    v_add_u32 v148, 73728, v148
    s_mul_i32 s36, s35, 224
    v_add_u32 v148, s36, v148
    v_bfe_u32 v253, v1, 4, 1
    v_lshlrev_b32 v253, 5, v253
    s_cmp_eq_u32 s35, 0
    s_cselect_b32 s36, 1, -1
    v_mul_lo_u32 v253, v253, s36
    v_sub_u32 v149, v148, v253
    v_add_u32 v148, v148, v253
    s_and_b32 s35, s30, 1
    s_mul_i32 s35, s35, 14336
    s_add_u32 s35, s35, 32768
    v_add_u32 v148, s35, v148
    v_add_u32 v149, s35, v149
    s_mov_b32 s35, 1
    v_lshrrev_b32 v253, 2, v1
    v_mul_u32_u24 v150, 448, v253
    v_and_b32 v254, 3, v1
    v_lshl_add_u32 v150, v254, 3, v150
    v_add_u32 v150, 73728, v150
    s_mul_i32 s36, s35, 224
    v_add_u32 v150, s36, v150
    v_bfe_u32 v253, v1, 4, 1
    v_lshlrev_b32 v253, 5, v253
    s_cmp_eq_u32 s35, 0
    s_cselect_b32 s36, 1, -1
    v_mul_lo_u32 v253, v253, s36
    v_sub_u32 v151, v150, v253
    v_add_u32 v150, v150, v253
    s_and_b32 s35, s30, 1
    s_mul_i32 s35, s35, 14336
    s_add_u32 s35, s35, 32768
    v_add_u32 v150, s35, v150
    v_add_u32 v151, s35, v151
    v_mov_b32 v156, 0
    v_mov_b32 v157, 0
    v_mov_b32 v158, 0
    v_mov_b32 v159, 0
    v_mov_b32 v160, 0
    v_mov_b32 v161, 0
    v_mov_b32 v162, 0
    v_mov_b32 v163, 0
    v_lshrrev_b32 v166, 4, v1
    v_lshlrev_b32 v166, 4, v166
    v_lshl_add_u32 v166, v164, 6, v166
    v_mov_b32 v165, 0x7f000000
    v_cmp_gt_u32 vcc, 4, v164
    s_nop 1
    v_cndmask_b32 v167, v165, v166, vcc
    v_cmp_gt_u32 vcc, 14, v164
    s_nop 1
    v_cndmask_b32 v168, v165, v166, vcc
    s_waitcnt vmcnt(0)
    v_and_b32 v252, 15, v251
    v_mul_u32_u24 v248, 458752, v252
    s_and_b32 s36, s30, 1
    s_mul_i32 s36, s36, 6
    s_add_u32 s36, s36, 4
    v_bfe_u32 v252, v251, s36, 6
    v_mul_u32_u24 v250, 37, v252
    v_lshrrev_b32 v250, 8, v250
    v_mul_u32_u24 v250, 7, v250
    v_sub_u32 v250, v252, v250
    v_cmp_eq_u32 vcc, 3, v250
    s_nop 1
    v_cndmask_b32 v250, 0, 1, vcc
    v_lshl_add_u32 v249, v252, 16, v250
    v_mov_b32 v6, 162836
spin_12:
    s_sleep 2
    ds_read_b32 v7, v6
    s_waitcnt lgkmcnt(0)
    v_readfirstlane_b32 s53, v7
    s_nop 0
    s_cmp_ge_u32 s53, 4
    s_cbranch_scc0 spin_12
    s_mov_b64 s[12:13], s[68:69]
    s_mov_b32 s14, 2097152
    s_mov_b32 s15, 0x20000
    s_and_b32 s35, s30, 1
    s_mul_i32 s38, s99, 128
    s_mul_i32 s41, s35, 65536
    s_add_u32 s38, s38, s41
    s_mul_i32 s41, s35, 4096
    s_add_u32 s41, s41, 24576
    s_mov_b32 s42, 0
    s_mov_b32 s44, s67
    s_mov_b32 s42, 73728
    s_mov_b32 s44, s28
    s_add_u32 s19, s41, s42
    s_mul_i32 s16, s44, 131072
    s_add_u32 s16, s16, s38
    s_add_u32 s44, s44, 1
    s_and_b32 s44, s44, 15
    s_add_u32 s42, s42, 8192
    s_cmp_eq_u32 s42, 131072
    s_cselect_b32 s42, 0, s42
    s_mov_b32 m0, s19
    s_mov_b32 s39, s16
    buffer_load_dwordx4 v238, s[12:15], s39 offen lds
    s_add_u32 m0, m0, 1024
    s_add_u32 s39, s39, 16384
    buffer_load_dwordx4 v238, s[12:15], s39 offen lds
    s_add_u32 m0, m0, 1024
    s_add_u32 s39, s39, 16384
    buffer_load_dwordx4 v238, s[12:15], s39 offen lds
    s_add_u32 m0, m0, 1024
    s_add_u32 s39, s39, 16384
    buffer_load_dwordx4 v238, s[12:15], s39 offen lds
    s_mov_b64 s[12:13], s[72:73]
    s_mov_b32 s14, 7340032
    s_mov_b32 s15, 0x20000
    s_and_b32 s35, s30, 1
    s_mul_i32 s38, s29, 448
    s_mul_i32 s41, s35, 229376
    s_add_u32 s38, s38, s41
    s_mul_i32 s41, s35, 14336
    s_add_u32 s41, s41, 73728
    s_mov_b32 s42, 0
    s_mov_b32 s44, 0
    s_mov_b32 s42, 32768
    s_mov_b32 s44, s28
    s_add_u32 s19, s41, s42
    s_mul_i32 s16, s44, 458752
    s_add_u32 s16, s16, s38
    s_add_u32 s44, s44, 1
    s_and_b32 s44, s44, 15
    s_add_u32 s42, s42, 28672
    s_cmp_eq_u32 s42, 86016
    s_cselect_b32 s42, 0, s42
    s_mov_b32 m0, s19
    s_mov_b32 s39, s16
    buffer_load_dwordx4 v241, s[12:15], s39 offen lds
    s_add_u32 m0, m0, 1024
    s_nop 0
    buffer_load_dwordx4 v242, s[12:15], s39 offen lds
    s_add_u32 m0, m0, 1024
    s_nop 0
    buffer_load_dwordx4 v243, s[12:15], s39 offen lds
    s_add_u32 m0, m0, 1024
    s_nop 0
    buffer_load_dwordx4 v244, s[12:15], s39 offen lds
    s_add_u32 m0, m0, 1024
    s_nop 0
    buffer_load_dwordx4 v245, s[12:15], s39 offen lds
    s_add_u32 m0, m0, 1024
    s_nop 0
    buffer_load_dwordx4 v246, s[12:15], s39 offen lds
    s_add_u32 m0, m0, 1024
    s_nop 0
    buffer_load_dwordx4 v247, s[12:15], s39 offen lds
    s_add_u32 m0, m0, 1024
    s_add_u32 s39, s39, 114688
    buffer_load_dwordx4 v241, s[12:15], s39 offen lds
    s_add_u32 m0, m0, 1024
    s_nop 0
    buffer_load_dwordx4 v242, s[12:15], s39 offen lds
    s_add_u32 m0, m0, 1024
    s_nop 0
    buffer_load_dwordx4 v243, s[12:15], s39 offen lds
    s_add_u32 m0, m0, 1024
    s_nop 0
    buffer_load_dwordx4 v244, s[12:15], s39 offen lds
    s_add_u32 m0, m0, 1024
    s_nop 0
    buffer_load_dwordx4 v245, s[12:15], s39 offen lds
    s_add_u32 m0, m0, 1024
    s_nop 0
    buffer_load_dwordx4 v246, s[12:15], s39 offen lds
    s_add_u32 m0, m0, 1024
    s_nop 0
    buffer_load_dwordx4 v247, s[12:15], s39 offen lds
    s_waitcnt vmcnt(14)
    s_setprio 1
    ds_read_b64_tr_b16 v[128:129], v144 offset:0
    ds_read_b64_tr_b16 v[130:131], v144 offset:2048
    ds_read_b64_tr_b16 v[132:133], v145 offset:0
    ds_read_b64_tr_b16 v[134:135], v145 offset:2048
    ds_read_b64_tr_b16 v[136:137], v146 offset:0
    ds_read_b64_tr_b16 v[138:139], v146 offset:2048
    ds_read_b64_tr_b16 v[140:141], v147 offset:0
    ds_read_b64_tr_b16 v[142:143], v147 offset:2048
    s_add_u32 s20, s4, 0x1400000
    s_addc_u32 s21, s5, 0
    s_mov_b32 s22, 0x20000
    s_mov_b32 s23, 0x20000
    s_lshl_b32 s35, s28, 1
    s_and_b32 s36, s30, 1
    s_add_u32 s35, s35, s36
    s_mul_i32 s35, s35, 4096
    s_mul_i32 s36, s29, 256
    s_add_u32 s35, s35, s36
    s_waitcnt lgkmcnt(0)
    v_mfma_f32_16x16x32_bf16 v[160:163], v[128:131], v[16:19], v[160:163]
    v_mfma_f32_16x16x32_bf16 v[160:163], v[132:135], v[20:23], v[160:163]
    v_mfma_f32_16x16x32_bf16 v[160:163], v[136:139], v[24:27], v[160:163]
    v_mfma_f32_16x16x32_bf16 v[160:163], v[140:143], v[28:31], v[160:163]
    s_nop 7
    buffer_store_dwordx4 v[160:163], v167, s[20:23], s35 offen sc1
    s_waitcnt vmcnt(1)
    v_mov_b32 v6, 162840
    v_mov_b32 v7, 1
    s_mov_b64 exec, 1
    ds_add_u32 v6, v7
    s_mov_b64 exec, -1
    ds_read_b64_tr_b16 v[72:73], v148 offset:0
    ds_read_b64_tr_b16 v[74:75], v148 offset:7168
    ds_read_b64_tr_b16 v[76:77], v149 offset:32
    ds_read_b64_tr_b16 v[78:79], v149 offset:7200
    ds_read_b64_tr_b16 v[80:81], v148 offset:64
    ds_read_b64_tr_b16 v[82:83], v148 offset:7232
    ds_read_b64_tr_b16 v[84:85], v149 offset:96
    ds_read_b64_tr_b16 v[86:87], v149 offset:7264
    ds_read_b64_tr_b16 v[88:89], v148 offset:128
    ds_read_b64_tr_b16 v[90:91], v148 offset:7296
    ds_read_b64_tr_b16 v[92:93], v149 offset:160
    ds_read_b64_tr_b16 v[94:95], v149 offset:7328
    ds_read_b64_tr_b16 v[96:97], v148 offset:192
    ds_read_b64_tr_b16 v[98:99], v148 offset:7360
    ds_read_b64_tr_b16 v[100:101], v150 offset:0
    ds_read_b64_tr_b16 v[102:103], v150 offset:7168
    ds_read_b64_tr_b16 v[104:105], v151 offset:32
    ds_read_b64_tr_b16 v[106:107], v151 offset:7200
    ds_read_b64_tr_b16 v[108:109], v150 offset:64
    ds_read_b64_tr_b16 v[110:111], v150 offset:7232
    ds_read_b64_tr_b16 v[112:113], v151 offset:96
    ds_read_b64_tr_b16 v[114:115], v151 offset:7264
    ds_read_b64_tr_b16 v[116:117], v150 offset:128
    ds_read_b64_tr_b16 v[118:119], v150 offset:7296
    ds_read_b64_tr_b16 v[120:121], v151 offset:160
    ds_read_b64_tr_b16 v[122:123], v151 offset:7328
    ds_read_b64_tr_b16 v[124:125], v150 offset:192
    ds_read_b64_tr_b16 v[126:127], v150 offset:7360
    s_add_u32 s20, s4, 0x1420000
    s_addc_u32 s21, s5, 0
    s_mov_b32 s22, 0x70000
    s_mov_b32 s23, 0x20000
    s_lshl_b32 s35, s28, 1
    s_and_b32 s36, s30, 1
    s_add_u32 s35, s35, s36
    s_mul_i32 s35, s35, 14336
    s_mul_i32 s36, s29, 896
    s_add_u32 s35, s35, s36
    s_waitcnt lgkmcnt(0)
    v_mfma_f32_16x16x32_bf16 v[156:159], v[72:75], v[16:19], v[156:159]
    v_mfma_f32_16x16x32_bf16 v[156:159], v[76:79], v[20:23], v[156:159]
    v_mfma_f32_16x16x32_bf16 v[156:159], v[80:83], v[24:27], v[156:159]
    v_mfma_f32_16x16x32_bf16 v[156:159], v[84:87], v[28:31], v[156:159]
    v_mfma_f32_16x16x32_bf16 v[156:159], v[88:91], v[32:35], v[156:159]
    v_mfma_f32_16x16x32_bf16 v[156:159], v[92:95], v[36:39], v[156:159]
    v_mfma_f32_16x16x32_bf16 v[156:159], v[96:99], v[40:43], v[156:159]
    v_mfma_f32_16x16x32_bf16 v[156:159], v[100:103], v[44:47], v[156:159]
    v_mfma_f32_16x16x32_bf16 v[156:159], v[104:107], v[48:51], v[156:159]
    v_mfma_f32_16x16x32_bf16 v[156:159], v[108:111], v[52:55], v[156:159]
    v_mfma_f32_16x16x32_bf16 v[156:159], v[112:115], v[56:59], v[156:159]
    v_mfma_f32_16x16x32_bf16 v[156:159], v[116:119], v[60:63], v[156:159]
    v_mfma_f32_16x16x32_bf16 v[156:159], v[120:123], v[64:67], v[156:159]
    v_mfma_f32_16x16x32_bf16 v[156:159], v[124:127], v[68:71], v[156:159]
    s_nop 7
    buffer_store_dwordx4 v[156:159], v168, s[20:23], s35 offen sc1
    v_mov_b32 v6, 162840
    v_mov_b32 v7, 1
    s_mov_b64 exec, 1
    ds_add_u32 v6, v7
    s_mov_b64 exec, -1
    s_setprio 0
    s_call_b64 s[76:77], SUB_w1_regs
    s_call_b64 s[76:77], SUB_park
    v_mov_b32 v6, 162840
spin_14:
    s_sleep 3
    ds_read_b32 v7, v6
    s_waitcnt lgkmcnt(0)
    v_readfirstlane_b32 s53, v7
    s_nop 0
    s_cmp_ge_u32 s53, 4
    s_cbranch_scc0 spin_14
    s_mov_b64 s[12:13], s[68:69]
    s_mov_b32 s14, 2097152
    s_mov_b32 s15, 0x20000
    s_and_b32 s35, s30, 1
    s_mul_i32 s38, s99, 128
    s_mul_i32 s41, s35, 65536
    s_add_u32 s38, s38, s41
    s_mul_i32 s41, s35, 4096
    s_add_u32 s41, s41, 24576
    s_mov_b32 s42, 0
    s_mov_b32 s44, s67
    s_mov_b32 s42, 98304
    s_mov_b32 s44, s67
    s_add_u32 s44, s44, 12
    s_and_b32 s44, s44, 15
    s_call_b64 s[76:77], SUB_w_issue_1
    s_waitcnt vmcnt(8)
    s_mov_b32 s42, 106496
    s_mov_b32 s44, s67
    s_add_u32 s44, s44, 13
    s_and_b32 s44, s44, 15
    s_call_b64 s[76:77], SUB_w_issue_1
    s_waitcnt vmcnt(8)
    s_mov_b32 s42, 114688
    s_mov_b32 s44, s67
    s_add_u32 s44, s44, 14
    s_and_b32 s44, s44, 15
    s_call_b64 s[76:77], SUB_w_issue_1
    s_waitcnt vmcnt(8)
    s_mov_b32 s42, 122880
    s_mov_b32 s44, s67
    s_add_u32 s44, s44, 15
    s_and_b32 s44, s44, 15
    s_call_b64 s[76:77], SUB_w_issue_1
    s_waitcnt vmcnt(8)
    s_and_b32 s36, s29, 6
    s_cmp_eq_u32 s36, 2
    s_cbranch_scc1 pr_15
    s_call_b64 s[76:77], SUB_park2
pr_15:
    s_call_b64 s[76:77], SUB_w1_put
FR_end:
LAYER:
    v_lshlrev_b32 v40, 6, v199
    v_add_u32 v40, 161792, v40
    s_lshl_b32 s35, s30, 3
    v_add_u32 v39, s35, v40
    s_cmp_eq_u32 s60, 0
    s_cbranch_scc1 R_l0
    s_sub_u32 s8, s62, 0x400000
    s_subb_u32 s9, s63, 0
    s_mov_b32 s10, 0x7e000
    s_mov_b32 s11, 0x20000
    s_sub_u32 s12, s62, 0x380000
    s_subb_u32 s13, s63, 0
    s_mov_b32 s14, 0x7e000
    s_mov_b32 s15, 0x20000
    s_mov_b32 s20, s62
    s_mov_b32 s21, s63
    s_mov_b32 s22, 0x7e000
    s_mov_b32 s23, 0x20000
    s_mov_b32 s78, 0x3f80
    s_mov_b32 s79, 0x3f800000
    v_lshlrev_b32 v222, 16, v230
    v_and_b32 v223, 0xffff0000, v230
    v_lshlrev_b32 v206, 16, v180
    v_and_b32 v207, 0xffff0000, v180
    v_lshlrev_b32 v12, 16, v188
    v_and_b32 v13, 0xffff0000, v188
    v_pk_add_f32 v[206:207], v[206:207], v[12:13]
    v_lshlrev_b32 v224, 16, v231
    v_and_b32 v225, 0xffff0000, v231
    v_lshlrev_b32 v208, 16, v181
    v_and_b32 v209, 0xffff0000, v181
    v_lshlrev_b32 v14, 16, v189
    v_and_b32 v15, 0xffff0000, v189
    v_pk_add_f32 v[208:209], v[208:209], v[14:15]
    v_lshlrev_b32 v226, 16, v232
    v_and_b32 v227, 0xffff0000, v232
    v_lshlrev_b32 v210, 16, v182
    v_and_b32 v211, 0xffff0000, v182
    v_lshlrev_b32 v16, 16, v190
    v_and_b32 v17, 0xffff0000, v190
    v_pk_add_f32 v[210:211], v[210:211], v[16:17]
    v_lshlrev_b32 v228, 16, v233
    v_and_b32 v229, 0xffff0000, v233
    v_lshlrev_b32 v212, 16, v183
    v_and_b32 v213, 0xffff0000, v183
    v_lshlrev_b32 v18, 16, v191
    v_and_b32 v19, 0xffff0000, v191
    v_pk_add_f32 v[212:213], v[212:213], v[18:19]
    v_lshlrev_b32 v230, 16, v234
    v_and_b32 v231, 0xffff0000, v234
    v_lshlrev_b32 v214, 16, v184
    v_and_b32 v215, 0xffff0000, v184
    v_lshlrev_b32 v20, 16, v192
    v_and_b32 v21, 0xffff0000, v192
    v_pk_add_f32 v[214:215], v[214:215], v[20:21]
    v_lshlrev_b32 v232, 16, v235
    v_and_b32 v233, 0xffff0000, v235
    v_lshlrev_b32 v216, 16, v185
    v_and_b32 v217, 0xffff0000, v185
    v_lshlrev_b32 v22, 16, v193
    v_and_b32 v23, 0xffff0000, v193
    v_pk_add_f32 v[216:217], v[216:217], v[22:23]
    v_lshlrev_b32 v234, 16, v236
    v_and_b32 v235, 0xffff0000, v236
    v_lshlrev_b32 v218, 16, v186
    v_and_b32 v219, 0xffff0000, v186
    v_lshlrev_b32 v24, 16, v194
    v_and_b32 v25, 0xffff0000, v194
    v_pk_add_f32 v[218:219], v[218:219], v[24:25]
    v_lshlrev_b32 v236, 16, v237
    v_and_b32 v237, 0xffff0000, v237
    v_lshlrev_b32 v220, 16, v187
    v_and_b32 v221, 0xffff0000, v187
    v_lshlrev_b32 v26, 16, v195
    v_and_b32 v27, 0xffff0000, v195
    v_pk_add_f32 v[220:221], v[220:221], v[26:27]
    s_mov_b32 s53, 0
    s_sleep 10
    s_cmp_ge_u32 s30, 6
    s_cbranch_scc1 dp_16
    s_sleep 14
dp_16:
    buffer_load_dwordx4 v[180:183], v196, s[8:11], 0 offen offset:0 sc1
    buffer_load_dwordx4 v[188:191], v196, s[12:15], 0 offen offset:0 sc1
    buffer_load_dwordx4 v[184:187], v196, s[8:11], 0 offen offset:2048 sc1
    buffer_load_dwordx4 v[192:195], v196, s[12:15], 0 offen offset:2048 sc1
    s_waitcnt vmcnt(0)
    v_bitop3_b32 v6, v180, v184, v188 bitop3:0x80
    v_bitop3_b32 v6, v6, v192, 1 bitop3:0x80
    v_cmp_eq_u32 vcc, 0, v6
    s_cbranch_vccz dq_17
    s_sleep 4
    s_add_u32 s53, s53, 1
    s_cmp_lt_u32 s53, s61
    s_cbranch_scc1 dp_16
    s_mov_b32 s61, 0
dq_17:
    v_dot2_f32_bf16 v206, v180, s78, v206
    v_dot2_f32_bf16 v207, v180, s79, v207
    v_dot2_f32_bf16 v208, v181, s78, v208
    v_dot2_f32_bf16 v209, v181, s79, v209
    v_dot2_f32_bf16 v210, v182, s78, v210
    v_dot2_f32_bf16 v211, v182, s79, v211
    v_dot2_f32_bf16 v212, v183, s78, v212
    v_dot2_f32_bf16 v213, v183, s79, v213
    v_dot2_f32_bf16 v214, v184, s78, v214
    v_dot2_f32_bf16 v215, v184, s79, v215
    v_dot2_f32_bf16 v216, v185, s78, v216
    v_dot2_f32_bf16 v217, v185, s79, v217
    v_dot2_f32_bf16 v218, v186, s78, v218
    v_dot2_f32_bf16 v219, v186, s79, v219
    v_dot2_f32_bf16 v220, v187, s78, v220
    v_dot2_f32_bf16 v221, v187, s79, v221
    v_dot2_f32_bf16 v206, v188, s78, v206
    v_dot2_f32_bf16 v207, v188, s79, v207
    v_dot2_f32_bf16 v208, v189, s78, v208
    v_dot2_f32_bf16 v209, v189, s79, v209
    v_dot2_f32_bf16 v210, v190, s78, v210
    v_dot2_f32_bf16 v211, v190, s79, v211
    v_dot2_f32_bf16 v212, v191, s78, v212
    v_dot2_f32_bf16 v213, v191, s79, v213
    v_dot2_f32_bf16 v214, v192, s78, v214
    v_dot2_f32_bf16 v215, v192, s79, v215
    v_dot2_f32_bf16 v216, v193, s78, v216
    v_dot2_f32_bf16 v217, v193, s79, v217
    v_dot2_f32_bf16 v218, v194, s78, v218
    v_dot2_f32_bf16 v219, v194, s79, v219
    v_dot2_f32_bf16 v220, v195, s78, v220
    v_dot2_f32_bf16 v221, v195, s79, v221
    s_nop 2
    v_pk_add_f32 v[32:33], v[206:207], v[208:209]
    v_pk_mul_f32 v[34:35], v[206:207], v[206:207]
    v_pk_fma_f32 v[34:35], v[208:209], v[208:209], v[34:35]
    v_pk_add_f32 v[32:33], v[32:33], v[210:211]
    v_pk_fma_f32 v[34:35], v[210:211], v[210:211], v[34:35]
    v_pk_add_f32 v[32:33], v[32:33], v[212:213]
    v_pk_fma_f32 v[34:35], v[212:213], v[212:213], v[34:35]
    v_pk_add_f32 v[32:33], v[32:33], v[214:215]
    v_pk_fma_f32 v[34:35], v[214:215], v[214:215], v[34:35]
    v_pk_add_f32 v[32:33], v[32:33], v[216:217]
    v_pk_fma_f32 v[34:35], v[216:217], v[216:217], v[34:35]
    v_pk_add_f32 v[32:33], v[32:33], v[218:219]
    v_pk_fma_f32 v[34:35], v[218:219], v[218:219], v[34:35]
    v_pk_add_f32 v[32:33], v[32:33], v[220:221]
    v_pk_fma_f32 v[34:35], v[220:221], v[220:221], v[34:35]
    v_add_f32 v30, v32, v33
    v_add_f32 v31, v34, v35
    s_nop 0
    v_add_f32_dpp v30, v30, v30 row_ror:8 row_mask:0xf bank_mask:0xf
    v_add_f32_dpp v31, v31, v31 row_ror:8 row_mask:0xf bank_mask:0xf
    v_mov_b32 v32, v30
    v_mov_b32 v33, v31
    s_nop 0
    v_permlane16_swap_b32 v30, v32
    v_permlane16_swap_b32 v31, v33
    v_pk_add_f32 v[30:31], v[30:31], v[32:33]
    v_mov_b32 v32, v30
    v_mov_b32 v33, v31
    s_nop 0
    v_permlane32_swap_b32 v30, v32
    v_permlane32_swap_b32 v31, v33
    v_pk_add_f32 v[30:31], v[30:31], v[32:33]
    ds_write_b64 v39, v[30:31] offset:0
    s_waitcnt lgkmcnt(0)
    s_barrier
    ds_read_b128 v[12:15], v40 offset:0
    ds_read_b128 v[16:19], v40 offset:16
    ds_read_b128 v[20:23], v40 offset:32
    ds_read_b128 v[24:27], v40 offset:48
    s_waitcnt lgkmcnt(0)
    v_pk_add_f32 v[12:13], v[12:13], v[14:15]
    v_pk_add_f32 v[16:17], v[16:17], v[18:19]
    v_pk_add_f32 v[20:21], v[20:21], v[22:23]
    v_pk_add_f32 v[24:25], v[24:25], v[26:27]
    v_pk_add_f32 v[12:13], v[12:13], v[16:17]
    v_pk_add_f32 v[20:21], v[20:21], v[24:25]
    v_pk_add_f32 v[12:13], v[12:13], v[20:21]
    v_mul_f32 v36, 0x3a800000, v12
    v_mul_f32 v38, 0x3a800000, v13
    v_fma_f32 v38, -v36, v36, v38
    v_max_f32 v38, 0, v38
    v_add_f32 v38, 0x3727c5ac, v38
    v_rsq_f32 v37, v38
    s_nop 0
    v_mul_f32 v36, v36, v37
    v_pk_fma_f32 v[12:13], v[206:207], v[36:37], v[36:37] op_sel:[0,1,0] op_sel_hi:[1,1,0] neg_lo:[0,0,1] neg_hi:[0,0,1]
    v_pk_fma_f32 v[14:15], v[208:209], v[36:37], v[36:37] op_sel:[0,1,0] op_sel_hi:[1,1,0] neg_lo:[0,0,1] neg_hi:[0,0,1]
    v_pk_fma_f32 v[16:17], v[210:211], v[36:37], v[36:37] op_sel:[0,1,0] op_sel_hi:[1,1,0] neg_lo:[0,0,1] neg_hi:[0,0,1]
    v_pk_fma_f32 v[18:19], v[212:213], v[36:37], v[36:37] op_sel:[0,1,0] op_sel_hi:[1,1,0] neg_lo:[0,0,1] neg_hi:[0,0,1]
    v_pk_fma_f32 v[20:21], v[214:215], v[36:37], v[36:37] op_sel:[0,1,0] op_sel_hi:[1,1,0] neg_lo:[0,0,1] neg_hi:[0,0,1]
    v_pk_fma_f32 v[22:23], v[216:217], v[36:37], v[36:37] op_sel:[0,1,0] op_sel_hi:[1,1,0] neg_lo:[0,0,1] neg_hi:[0,0,1]
    v_pk_fma_f32 v[24:25], v[218:219], v[36:37], v[36:37] op_sel:[0,1,0] op_sel_hi:[1,1,0] neg_lo:[0,0,1] neg_hi:[0,0,1]
    v_pk_fma_f32 v[26:27], v[220:221], v[36:37], v[36:37] op_sel:[0,1,0] op_sel_hi:[1,1,0] neg_lo:[0,0,1] neg_hi:[0,0,1]
    v_pk_fma_f32 v[206:207], v[12:13], v[222:223], v[206:207]
    v_cvt_pk_bf16_f32 v180, v206, v207
    v_pk_fma_f32 v[208:209], v[14:15], v[224:225], v[208:209]
    v_cvt_pk_bf16_f32 v181, v208, v209
    v_and_b32 v180, -2, v180
    v_pk_fma_f32 v[210:211], v[16:17], v[226:227], v[210:211]
    v_cvt_pk_bf16_f32 v182, v210, v211
    v_pk_fma_f32 v[212:213], v[18:19], v[228:229], v[212:213]
    v_cvt_pk_bf16_f32 v183, v212, v213
    buffer_store_dwordx4 v[180:183], v196, s[20:23], 0 offen offset:0 sc1
    v_pk_fma_f32 v[214:215], v[20:21], v[230:231], v[214:215]
    v_cvt_pk_bf16_f32 v184, v214, v215
    v_pk_fma_f32 v[216:217], v[22:23], v[232:233], v[216:217]
    v_cvt_pk_bf16_f32 v185, v216, v217
    v_and_b32 v184, -2, v184
    v_pk_fma_f32 v[218:219], v[24:25], v[234:235], v[218:219]
    v_cvt_pk_bf16_f32 v186, v218, v219
    v_pk_fma_f32 v[220:221], v[26:27], v[236:237], v[220:221]
    v_cvt_pk_bf16_f32 v187, v220, v221
    buffer_store_dwordx4 v[184:187], v196, s[20:23], 0 offen offset:2048 sc1
    s_branch R_s2
R_l0:
    v_lshlrev_b32 v206, 16, v180
    v_and_b32 v207, 0xffff0000, v180
    v_lshlrev_b32 v208, 16, v181
    v_and_b32 v209, 0xffff0000, v181
    v_lshlrev_b32 v210, 16, v182
    v_and_b32 v211, 0xffff0000, v182
    v_lshlrev_b32 v212, 16, v183
    v_and_b32 v213, 0xffff0000, v183
    v_lshlrev_b32 v214, 16, v184
    v_and_b32 v215, 0xffff0000, v184
    v_lshlrev_b32 v216, 16, v185
    v_and_b32 v217, 0xffff0000, v185
    v_lshlrev_b32 v218, 16, v186
    v_and_b32 v219, 0xffff0000, v186
    v_lshlrev_b32 v220, 16, v187
    v_and_b32 v221, 0xffff0000, v187
    v_pk_add_f32 v[32:33], v[206:207], v[208:209]
    v_pk_mul_f32 v[34:35], v[206:207], v[206:207]
    v_pk_fma_f32 v[34:35], v[208:209], v[208:209], v[34:35]
    v_pk_add_f32 v[32:33], v[32:33], v[210:211]
    v_pk_fma_f32 v[34:35], v[210:211], v[210:211], v[34:35]
    v_pk_add_f32 v[32:33], v[32:33], v[212:213]
    v_pk_fma_f32 v[34:35], v[212:213], v[212:213], v[34:35]
    v_pk_add_f32 v[32:33], v[32:33], v[214:215]
    v_pk_fma_f32 v[34:35], v[214:215], v[214:215], v[34:35]
    v_pk_add_f32 v[32:33], v[32:33], v[216:217]
    v_pk_fma_f32 v[34:35], v[216:217], v[216:217], v[34:35]
    v_pk_add_f32 v[32:33], v[32:33], v[218:219]
    v_pk_fma_f32 v[34:35], v[218:219], v[218:219], v[34:35]
    v_pk_add_f32 v[32:33], v[32:33], v[220:221]
    v_pk_fma_f32 v[34:35], v[220:221], v[220:221], v[34:35]
    v_add_f32 v30, v32, v33
    v_add_f32 v31, v34, v35
    s_nop 0
    v_add_f32_dpp v30, v30, v30 row_ror:8 row_mask:0xf bank_mask:0xf
    v_add_f32_dpp v31, v31, v31 row_ror:8 row_mask:0xf bank_mask:0xf
    v_mov_b32 v32, v30
    v_mov_b32 v33, v31
    s_nop 0
    v_permlane16_swap_b32 v30, v32
    v_permlane16_swap_b32 v31, v33
    v_pk_add_f32 v[30:31], v[30:31], v[32:33]
    v_mov_b32 v32, v30
    v_mov_b32 v33, v31
    s_nop 0
    v_permlane32_swap_b32 v30, v32
    v_permlane32_swap_b32 v31, v33
    v_pk_add_f32 v[30:31], v[30:31], v[32:33]
    ds_write_b64 v39, v[30:31] offset:0
    s_waitcnt lgkmcnt(0)
    v_mov_b32 v222, 162844
spin_18:
    ds_read_b32 v223, v222
    s_waitcnt lgkmcnt(0)
    v_readfirstlane_b32 s94, v223
    s_nop 0
    s_cmp_ge_u32 s94, 65536
    s_cbranch_scc0 spin_18
    s_cmp_gt_u32 s94, 65546
    s_cselect_b32 s94, 1, 0
    s_lshl_b32 s53, s94, 13
    v_xor_b32 v197, s53, v197
    s_lshr_b32 s53, s28, 3
    s_lshl_b32 s53, s53, 2
    s_and_b32 s54, s28, 3
    s_add_u32 s53, s53, s54
    s_lshl_b32 s53, s53, 24
    s_lshr_b32 s54, s28, 2
    s_xor_b32 s54, s54, s94
    s_and_b32 s54, s54, 1
    s_lshl_b32 s54, s54, 13
    s_add_u32 s36, s53, s54
    s_add_u32 s36, s36, 33554432
    s_lshr_b32 s53, s53, 14
    s_add_u32 s36, s53, s54
    s_xor_b32 s36, s36, 8192
    s_add_u32 s36, s36, 23101440
    s_lshl_b32 s53, s30, 7
    s_add_u32 s36, s36, s53
    v_mov_b32 v226, s36
    s_waitcnt vmcnt(0)
    s_barrier
    s_mov_b32 s53, 0
    s_add_u32 s54, s52, 32
    s_bfm_b64 exec, 1, 0
poll_19:
    buffer_load_dword v222, v226, s[56:59], 0 offen sc1
    s_waitcnt vmcnt(0)
    v_xor_b32 v222, s54, v222
    v_cmp_eq_u32 vcc, 0, v222
    s_nop 0
    s_cmp_eq_u64 vcc, exec
    s_cbranch_scc1 pok_20
    s_sleep 6
    s_add_u32 s53, s53, 1
    s_cmp_lt_u32 s53, s61
    s_cbranch_scc1 poll_19
    s_mov_b32 s61, 0
pok_20:
    s_mov_b64 exec, -1
    s_add_u32 s80, s4, 0x2100000
    s_addc_u32 s81, s5, 0
    s_mov_b32 s82, 0x7f00000
    s_mov_b32 s83, 0x20000
    s_mov_b32 s78, 0
    buffer_load_dwordx2 v[230:231], v197, s[80:83], s78 offen sc1
    s_mov_b32 s78, 2048
    buffer_load_dwordx2 v[232:233], v197, s[80:83], s78 offen sc1
    s_mov_b32 s78, 16384
    buffer_load_dwordx2 v[234:235], v197, s[80:83], s78 offen sc1
    s_mov_b32 s78, 18432
    buffer_load_dwordx2 v[236:237], v197, s[80:83], s78 offen sc1
    s_lshr_b32 s53, s28, 3
    s_lshl_b32 s53, s53, 2
    s_and_b32 s54, s28, 3
    s_add_u32 s53, s53, s54
    s_lshl_b32 s53, s53, 24
    s_lshr_b32 s54, s28, 2
    s_xor_b32 s54, s54, s94
    s_and_b32 s54, s54, 1
    s_lshl_b32 s54, s54, 13
    s_add_u32 s55, s53, s54
    s_add_u32 s55, s55, 33554432
    s_add_u32 s62, s4, s55
    s_addc_u32 s63, s5, 0
    s_sub_u32 s36, s28, 1
    s_max_i32 s36, s36, 0
    s_lshr_b32 s53, s36, 3
    s_lshl_b32 s53, s53, 2
    s_and_b32 s54, s36, 3
    s_add_u32 s53, s53, s54
    s_lshl_b32 s53, s53, 24
    s_lshr_b32 s54, s36, 2
    s_xor_b32 s54, s54, s94
    s_and_b32 s54, s54, 1
    s_lshl_b32 s54, s54, 13
    s_add_u32 s92, s53, s54
    s_add_u32 s92, s92, 33554432
    s_sub_u32 s92, s92, s55
    s_add_u32 s36, s28, 1
    s_min_u32 s36, s36, 15
    s_lshr_b32 s53, s36, 3
    s_lshl_b32 s53, s53, 2
    s_and_b32 s54, s36, 3
    s_add_u32 s53, s53, s54
    s_lshl_b32 s53, s53, 24
    s_lshr_b32 s54, s36, 2
    s_xor_b32 s54, s54, s94
    s_and_b32 s54, s54, 1
    s_lshl_b32 s54, s54, 13
    s_add_u32 s93, s53, s54
    s_add_u32 s93, s93, 33554432
    s_sub_u32 s93, s93, s55
    s_add_u32 s55, s55, 6029312
    s_mov_b32 s20, s62
    s_mov_b32 s21, s63
    s_mov_b32 s22, 0x7e000
    s_mov_b32 s23, 0x20000
    ds_read_b128 v[12:15], v40 offset:0
    ds_read_b128 v[16:19], v40 offset:16
    ds_read_b128 v[20:23], v40 offset:32
    ds_read_b128 v[24:27], v40 offset:48
    s_waitcnt lgkmcnt(0)
    v_pk_add_f32 v[12:13], v[12:13], v[14:15]
    v_pk_add_f32 v[16:17], v[16:17], v[18:19]
    v_pk_add_f32 v[20:21], v[20:21], v[22:23]
    v_pk_add_f32 v[24:25], v[24:25], v[26:27]
    v_pk_add_f32 v[12:13], v[12:13], v[16:17]
    v_pk_add_f32 v[20:21], v[20:21], v[24:25]
    v_pk_add_f32 v[12:13], v[12:13], v[20:21]
    v_mul_f32 v36, 0x3a800000, v12
    v_mul_f32 v38, 0x3a800000, v13
    v_fma_f32 v38, -v36, v36, v38
    v_max_f32 v38, 0, v38
    v_add_f32 v38, 0x3727c5ac, v38
    v_rsq_f32 v37, v38
    s_nop 0
    v_pk_add_f32 v[12:13], v[206:207], v[36:37] op_sel_hi:[1,0] neg_lo:[0,1] neg_hi:[0,1]
    v_pk_mul_f32 v[12:13], v[12:13], v[36:37] op_sel:[0,1] op_sel_hi:[1,1]
    v_pk_add_f32 v[14:15], v[208:209], v[36:37] op_sel_hi:[1,0] neg_lo:[0,1] neg_hi:[0,1]
    v_pk_mul_f32 v[14:15], v[14:15], v[36:37] op_sel:[0,1] op_sel_hi:[1,1]
    v_pk_add_f32 v[16:17], v[210:211], v[36:37] op_sel_hi:[1,0] neg_lo:[0,1] neg_hi:[0,1]
    v_pk_mul_f32 v[16:17], v[16:17], v[36:37] op_sel:[0,1] op_sel_hi:[1,1]
    v_pk_add_f32 v[18:19], v[212:213], v[36:37] op_sel_hi:[1,0] neg_lo:[0,1] neg_hi:[0,1]
    v_pk_mul_f32 v[18:19], v[18:19], v[36:37] op_sel:[0,1] op_sel_hi:[1,1]
    v_pk_add_f32 v[20:21], v[214:215], v[36:37] op_sel_hi:[1,0] neg_lo:[0,1] neg_hi:[0,1]
    v_pk_mul_f32 v[20:21], v[20:21], v[36:37] op_sel:[0,1] op_sel_hi:[1,1]
    v_pk_add_f32 v[22:23], v[216:217], v[36:37] op_sel_hi:[1,0] neg_lo:[0,1] neg_hi:[0,1]
    v_pk_mul_f32 v[22:23], v[22:23], v[36:37] op_sel:[0,1] op_sel_hi:[1,1]
    v_pk_add_f32 v[24:25], v[218:219], v[36:37] op_sel_hi:[1,0] neg_lo:[0,1] neg_hi:[0,1]
    v_pk_mul_f32 v[24:25], v[24:25], v[36:37] op_sel:[0,1] op_sel_hi:[1,1]
    v_pk_add_f32 v[26:27], v[220:221], v[36:37] op_sel_hi:[1,0] neg_lo:[0,1] neg_hi:[0,1]
    v_pk_mul_f32 v[26:27], v[26:27], v[36:37] op_sel:[0,1] op_sel_hi:[1,1]
    s_barrier
    s_waitcnt vmcnt(0)
    v_lshlrev_b32 v222, 16, v230
    v_and_b32 v223, 0xffff0000, v230
    v_pk_fma_f32 v[206:207], v[12:13], v[222:223], v[206:207]
    v_cvt_pk_bf16_f32 v180, v206, v207
    v_lshlrev_b32 v222, 16, v231
    v_and_b32 v223, 0xffff0000, v231
    v_pk_fma_f32 v[208:209], v[14:15], v[222:223], v[208:209]
    v_cvt_pk_bf16_f32 v181, v208, v209
    v_and_b32 v180, -2, v180
    v_lshlrev_b32 v222, 16, v232
    v_and_b32 v223, 0xffff0000, v232
    v_pk_fma_f32 v[210:211], v[16:17], v[222:223], v[210:211]
    v_cvt_pk_bf16_f32 v182, v210, v211
    v_lshlrev_b32 v222, 16, v233
    v_and_b32 v223, 0xffff0000, v233
    v_pk_fma_f32 v[212:213], v[18:19], v[222:223], v[212:213]
    v_cvt_pk_bf16_f32 v183, v212, v213
    buffer_store_dwordx4 v[180:183], v196, s[20:23], 0 offen offset:0 sc1
    v_lshlrev_b32 v222, 16, v234
    v_and_b32 v223, 0xffff0000, v234
    v_pk_fma_f32 v[214:215], v[20:21], v[222:223], v[214:215]
    v_cvt_pk_bf16_f32 v184, v214, v215
    v_lshlrev_b32 v222, 16, v235
    v_and_b32 v223, 0xffff0000, v235
    v_pk_fma_f32 v[216:217], v[22:23], v[222:223], v[216:217]
    v_cvt_pk_bf16_f32 v185, v216, v217
    v_and_b32 v184, -2, v184
    v_lshlrev_b32 v222, 16, v236
    v_and_b32 v223, 0xffff0000, v236
    v_pk_fma_f32 v[218:219], v[24:25], v[222:223], v[218:219]
    v_cvt_pk_bf16_f32 v186, v218, v219
    v_lshlrev_b32 v222, 16, v237
    v_and_b32 v223, 0xffff0000, v237
    v_pk_fma_f32 v[220:221], v[26:27], v[222:223], v[220:221]
    v_cvt_pk_bf16_f32 v187, v220, v221
    buffer_store_dwordx4 v[184:187], v196, s[20:23], 0 offen offset:2048 sc1
R_s2:
    v_lshlrev_b32 v206, 16, v180
    v_and_b32 v207, 0xffff0000, v180
    v_lshlrev_b32 v208, 16, v181
    v_and_b32 v209, 0xffff0000, v181
    v_lshlrev_b32 v210, 16, v182
    v_and_b32 v211, 0xffff0000, v182
    v_lshlrev_b32 v212, 16, v183
    v_and_b32 v213, 0xffff0000, v183
    v_lshlrev_b32 v214, 16, v184
    v_and_b32 v215, 0xffff0000, v184
    v_lshlrev_b32 v216, 16, v185
    v_and_b32 v217, 0xffff0000, v185
    v_lshlrev_b32 v218, 16, v186
    v_and_b32 v219, 0xffff0000, v186
    v_lshlrev_b32 v220, 16, v187
    v_and_b32 v221, 0xffff0000, v187
    v_pk_add_f32 v[32:33], v[206:207], v[208:209]
    v_pk_mul_f32 v[34:35], v[206:207], v[206:207]
    v_pk_fma_f32 v[34:35], v[208:209], v[208:209], v[34:35]
    v_pk_add_f32 v[32:33], v[32:33], v[210:211]
    v_pk_fma_f32 v[34:35], v[210:211], v[210:211], v[34:35]
    v_pk_add_f32 v[32:33], v[32:33], v[212:213]
    v_pk_fma_f32 v[34:35], v[212:213], v[212:213], v[34:35]
    v_pk_add_f32 v[32:33], v[32:33], v[214:215]
    v_pk_fma_f32 v[34:35], v[214:215], v[214:215], v[34:35]
    v_pk_add_f32 v[32:33], v[32:33], v[216:217]
    v_pk_fma_f32 v[34:35], v[216:217], v[216:217], v[34:35]
    v_pk_add_f32 v[32:33], v[32:33], v[218:219]
    v_pk_fma_f32 v[34:35], v[218:219], v[218:219], v[34:35]
    v_pk_add_f32 v[32:33], v[32:33], v[220:221]
    v_pk_fma_f32 v[34:35], v[220:221], v[220:221], v[34:35]
    v_add_f32 v30, v32, v33
    v_add_f32 v31, v34, v35
    s_nop 0
    v_add_f32_dpp v30, v30, v30 row_ror:8 row_mask:0xf bank_mask:0xf
    v_add_f32_dpp v31, v31, v31 row_ror:8 row_mask:0xf bank_mask:0xf
    v_mov_b32 v32, v30
    v_mov_b32 v33, v31
    s_nop 0
    v_permlane16_swap_b32 v30, v32
    v_permlane16_swap_b32 v31, v33
    v_pk_add_f32 v[30:31], v[30:31], v[32:33]
    v_mov_b32 v32, v30
    v_mov_b32 v33, v31
    s_nop 0
    v_permlane32_swap_b32 v30, v32
    v_permlane32_swap_b32 v31, v33
    v_pk_add_f32 v[30:31], v[30:31], v[32:33]
    ds_write_b64 v39, v[30:31] offset:512
    s_waitcnt lgkmcnt(0)
    s_barrier
    s_cmp_lg_u32 s30, 6
    s_cbranch_scc1 R_n6
    s_cmp_lg_u32 s60, 0
    s_cbranch_scc1 R_n6
    s_lshl_b32 s53, s29, 7
    s_add_u32 s53, s53, 23121920
    v_mov_b32 v8, 1
    v_mov_b32 v9, 0
    s_mov_b64 exec, 1
    buffer_atomic_add v8, v9, s[56:59], s53 offen sc1
    s_mov_b64 exec, -1
R_n6:
    s_cmp_lg_u32 s30, 7
    s_cbranch_scc1 R_nl
    ds_read_b128 v[12:15], v40 offset:512
    ds_read_b128 v[16:19], v40 offset:528
    ds_read_b128 v[20:23], v40 offset:544
    ds_read_b128 v[24:27], v40 offset:560
    s_waitcnt lgkmcnt(0)
    v_pk_add_f32 v[12:13], v[12:13], v[14:15]
    v_pk_add_f32 v[16:17], v[16:17], v[18:19]
    v_pk_add_f32 v[20:21], v[20:21], v[22:23]
    v_pk_add_f32 v[24:25], v[24:25], v[26:27]
    v_pk_add_f32 v[12:13], v[12:13], v[16:17]
    v_pk_add_f32 v[20:21], v[20:21], v[24:25]
    v_pk_add_f32 v[12:13], v[12:13], v[20:21]
    v_mul_f32 v36, 0x3a800000, v12
    v_mul_f32 v38, 0x3a800000, v13
    v_fma_f32 v38, -v36, v36, v38
    v_max_f32 v38, 0, v38
    v_mov_b32 v42, v36
    v_mov_b32 v43, v38
    v_add_f32 v38, 0x3727c5ac, v38
    v_sqrt_f32 v38, v38
    s_nop 0
    v_mov_b32 v41, v38
    v_rcp_f32 v37, v38
    v_sub_f32 v42, v42, v36
    v_mul_f32 v42, v42, v37
    v_mul_f32 v43, v43, v37
    v_mul_f32 v43, v43, v37
    v_add_f32 v43, 0x3727c5ac, v43
    v_rsq_f32 v44, v43
    v_mov_b32 v224, v36
    v_mov_b32 v225, v37
    v_fma_f32 v226, v42, v41, v36
    v_mul_f32 v227, v37, v44
    s_add_u32 s24, s62, 0x5d0000
    s_addc_u32 s25, s63, 0
    s_mov_b32 s26, 0x800
    s_mov_b32 s27, 0x20000
    s_lshl_b32 s36, s29, 3
    v_add_u32 v6, s36, v199
    v_lshlrev_b32 v6, 4, v6
    s_mov_b64 exec, 0xff
    buffer_store_dwordx4 v[224:227], v6, s[24:27], 0 offen sc1
    s_mov_b64 exec, -1
    s_add_u32 s53, s55, 1280
    v_mov_b32 v8, 1
    v_mov_b32 v9, 162816
    v_mov_b32 v11, 0
    s_mov_b64 exec, 1
    s_waitcnt vmcnt(0)
    buffer_atomic_add v8, v11, s[56:59], s53 offen sc1
pub_21:
    s_mov_b64 exec, -1
R_nl:
    s_cmp_ge_u32 s30, 4
    s_cbranch_scc1 LOADERS
    s_setprio 1
    s_mov_b32 s8, s62
    s_mov_b32 s9, s63
    s_mov_b32 s10, 0x7e000
    s_mov_b32 s11, 0x20000
    v_add_u32 v126, 0, v2
    v_add_u32 v127, 65536, v2
    s_lshl_b32 s44, s30, 17
    s_mov_b32 s34, s30
    s_mov_b32 s35, 0
    v_and_b32 v22, 15, v1
    v_lshrrev_b32 v23, 4, v1
    s_mul_i32 s37, s34, 2
    s_mul_i32 s38, s99, 4
    s_mul_i32 s36, s35, 4
    s_add_u32 s38, s38, s36
    v_add_u32 v128, 4096, v2
    v_add_u32 v129, 69632, v2
    s_add_u32 s45, s44, 16384
    s_add_u32 s46, s44, 32768
    s_add_u32 s47, s44, 49152
    v_lshrrev_b32 v6, 2, v1
    v_mul_u32_u24 v13, 128, v6
    v_and_b32 v7, 3, v1
    v_lshl_add_u32 v13, v7, 3, v13
    v_add_u32 v13, 24576, v13
    v_bfe_u32 v6, v6, 1, 2
    s_mul_i32 s36, s35, 4
    s_add_u32 s36, s36, 3
    v_xor_b32 v7, s36, v6
    v_lshl_add_u32 v16, v7, 5, v13
    s_mul_i32 s36, s35, 4
    s_add_u32 s36, s36, 2
    v_xor_b32 v7, s36, v6
    v_lshl_add_u32 v15, v7, 5, v13
    s_mul_i32 s36, s35, 4
    s_add_u32 s36, s36, 1
    v_xor_b32 v7, s36, v6
    v_lshl_add_u32 v14, v7, 5, v13
    s_mul_i32 s36, s35, 4
    s_add_u32 s36, s36, 0
    v_xor_b32 v7, s36, v6
    v_lshl_add_u32 v13, v7, 5, v13
    v_pk_mov_b32 v[24:25], 0, 0
    v_pk_mov_b32 v[26:27], 0, 0
    v_pk_mov_b32 v[28:29], 0, 0
    v_pk_mov_b32 v[30:31], 0, 0
    v_pk_mov_b32 v[32:33], 0, 0
    v_pk_mov_b32 v[34:35], 0, 0
    v_pk_mov_b32 v[36:37], 0, 0
    v_pk_mov_b32 v[38:39], 0, 0
    v_pk_mov_b32 v[40:41], 0, 0
    v_pk_mov_b32 v[42:43], 0, 0
    v_pk_mov_b32 v[44:45], 0, 0
    v_pk_mov_b32 v[46:47], 0, 0
    v_pk_mov_b32 v[48:49], 0, 0
    v_pk_mov_b32 v[50:51], 0, 0
    v_pk_mov_b32 v[52:53], 0, 0
    v_pk_mov_b32 v[54:55], 0, 0
    s_mov_b32 s43, 0
    s_mul_i32 s36, s35, 256
    s_add_u32 s36, s36, 163328
    v_lshlrev_b32 v6, 4, v23
    v_add_u32 v6, s36, v6
    s_lshl_b32 s36, s37, 8
    s_add_u32 s36, s36, 160776
    v_lshlrev_b32 v7, 4, v22
    v_add_u32 v7, s36, v7
    s_add_u32 s16, s62, 0x100000
    s_addc_u32 s17, s63, 0
    s_mov_b32 s18, 0x7e000
    s_mov_b32 s19, 0x20000
    v_lshlrev_b32 v12, 11, v23
    v_lshl_add_u32 v12, v22, 4, v12
    s_lshl_b32 s39, s38, 13
    s_lshl_b32 s36, s37, 8
    s_add_u32 s39, s39, s36
    s_add_u32 s40, s39, 16384
    s_lshl_b32 s36, s29, 1
    s_lshr_b32 s53, s36, 3
    s_lshl_b32 s53, s53, 14
    s_and_b32 s41, s36, 7
    s_lshl_b32 s41, s41, 10
    s_add_u32 s41, s41, s53
    s_lshl_b32 s36, s37, 16
    s_add_u32 s41, s41, s36
    s_mov_b32 s53, 0
    s_mov_b32 s49, s44
    ds_read_b64_tr_b16 v[56:57], v13 offset:0
    ds_read_b64_tr_b16 v[58:59], v13 offset:2048
    ds_read_b64_tr_b16 v[60:61], v14 offset:0
    ds_read_b64_tr_b16 v[62:63], v14 offset:2048
    ds_read_b64_tr_b16 v[64:65], v15 offset:0
    ds_read_b64_tr_b16 v[66:67], v15 offset:2048
    ds_read_b64_tr_b16 v[68:69], v16 offset:0
    ds_read_b64_tr_b16 v[70:71], v16 offset:2048
    ds_read_b64_tr_b16 v[72:73], v13 offset:4096
    ds_read_b64_tr_b16 v[74:75], v13 offset:6144
    ds_read_b64_tr_b16 v[76:77], v14 offset:4096
    ds_read_b64_tr_b16 v[78:79], v14 offset:6144
    ds_read_b64_tr_b16 v[80:81], v15 offset:4096
    ds_read_b64_tr_b16 v[82:83], v15 offset:6144
    ds_read_b64_tr_b16 v[84:85], v16 offset:4096
    ds_read_b64_tr_b16 v[86:87], v16 offset:6144
dm_22p:
    buffer_load_dwordx4 v[164:167], v126, s[8:11], s44 offen offset:0 sc1
    buffer_load_dwordx4 v[168:171], v127, s[8:11], s44 offen offset:0 sc1
    buffer_load_dwordx4 v[172:175], v126, s[8:11], s44 offen offset:1024 sc1
    buffer_load_dwordx4 v[176:179], v127, s[8:11], s44 offen offset:1024 sc1
    buffer_load_dwordx4 v[180:183], v126, s[8:11], s44 offen offset:2048 sc1
    buffer_load_dwordx4 v[184:187], v127, s[8:11], s44 offen offset:2048 sc1
    buffer_load_dwordx4 v[188:191], v126, s[8:11], s44 offen offset:3072 sc1
    buffer_load_dwordx4 v[192:195], v127, s[8:11], s44 offen offset:3072 sc1
dm_22w:
    s_waitcnt vmcnt(4)
    v_or3_b32 v17, v164, v168, v172
    v_bitop3_b32 v17, v17, v176, 1 bitop3:0xa8
    v_cmp_ne_u32 vcc, 0, v17
    s_cbranch_vccz dm_22q
dm_22r:
    s_sleep 2
    buffer_load_dwordx4 v[164:167], v126, s[8:11], s44 offen offset:0 sc1
    buffer_load_dwordx4 v[168:171], v127, s[8:11], s44 offen offset:0 sc1
    buffer_load_dwordx4 v[172:175], v126, s[8:11], s44 offen offset:1024 sc1
    buffer_load_dwordx4 v[176:179], v127, s[8:11], s44 offen offset:1024 sc1
    buffer_load_dwordx4 v[180:183], v126, s[8:11], s44 offen offset:2048 sc1
    buffer_load_dwordx4 v[184:187], v127, s[8:11], s44 offen offset:2048 sc1
    buffer_load_dwordx4 v[188:191], v126, s[8:11], s44 offen offset:3072 sc1
    buffer_load_dwordx4 v[192:195], v127, s[8:11], s44 offen offset:3072 sc1
    s_waitcnt vmcnt(4)
    v_or3_b32 v17, v164, v168, v172
    v_bitop3_b32 v17, v17, v176, 1 bitop3:0xa8
    v_cmp_ne_u32 vcc, 0, v17
    s_cbranch_vccz dm_22t
    s_add_u32 s53, s53, 1
    s_cmp_lt_u32 s53, s61
    s_cbranch_scc1 dm_22r
    s_mov_b32 s61, 0
    s_branch dm_22t
dm_22q:
dm_22t:
    buffer_load_dwordx4 v[196:199], v128, s[8:11], s44 offen offset:0 sc1
    buffer_load_dwordx4 v[200:203], v129, s[8:11], s44 offen offset:0 sc1
    buffer_load_dwordx4 v[204:207], v128, s[8:11], s44 offen offset:1024 sc1
    buffer_load_dwordx4 v[208:211], v129, s[8:11], s44 offen offset:1024 sc1
    buffer_load_dwordx4 v[212:215], v128, s[8:11], s44 offen offset:2048 sc1
    buffer_load_dwordx4 v[216:219], v129, s[8:11], s44 offen offset:2048 sc1
    s_waitcnt lgkmcnt(0)
dm_22:
    v_mfma_f32_16x16x32_bf16 v[24:27], v[56:59], v[164:167], v[24:27]
    ds_read_b64_tr_b16 v[88:89], v13 offset:8192
    buffer_load_dwordx4 v[220:223], v128, s[8:11], s44 offen offset:3072 sc1
    v_mfma_f32_16x16x32_bf16 v[40:43], v[56:59], v[168:171], v[40:43]
    ds_read_b64_tr_b16 v[90:91], v13 offset:10240
    buffer_load_dwordx4 v[224:227], v129, s[8:11], s44 offen offset:3072 sc1
    v_mfma_f32_16x16x32_bf16 v[44:47], v[60:63], v[168:171], v[44:47]
    ds_read_b64_tr_b16 v[92:93], v14 offset:8192
    s_mov_b32 s44, s45
    v_mfma_f32_16x16x32_bf16 v[28:31], v[60:63], v[164:167], v[28:31]
    ds_read_b64_tr_b16 v[94:95], v14 offset:10240
    s_mov_b32 s45, s46
    v_mfma_f32_16x16x32_bf16 v[32:35], v[64:67], v[164:167], v[32:35]
    ds_read_b64_tr_b16 v[96:97], v15 offset:8192
    s_mov_b32 s46, s47
    v_mfma_f32_16x16x32_bf16 v[48:51], v[64:67], v[168:171], v[48:51]
    ds_read_b64_tr_b16 v[98:99], v15 offset:10240
    s_mov_b32 s47, 1048576
    v_mfma_f32_16x16x32_bf16 v[52:55], v[68:71], v[168:171], v[52:55]
    ds_read_b64_tr_b16 v[100:101], v16 offset:8192
    v_mfma_f32_16x16x32_bf16 v[36:39], v[68:71], v[164:167], v[36:39]
    ds_read_b64_tr_b16 v[102:103], v16 offset:10240
    s_waitcnt lgkmcnt(8)
    v_mfma_f32_16x16x32_bf16 v[24:27], v[72:75], v[172:175], v[24:27]
    ds_read_b64_tr_b16 v[104:105], v13 offset:12288
    buffer_load_dwordx4 v[164:167], v126, s[8:11], s44 offen offset:0 sc1
    v_mfma_f32_16x16x32_bf16 v[40:43], v[72:75], v[176:179], v[40:43]
    ds_read_b64_tr_b16 v[106:107], v13 offset:14336
    buffer_load_dwordx4 v[168:171], v127, s[8:11], s44 offen offset:0 sc1
    v_mfma_f32_16x16x32_bf16 v[44:47], v[76:79], v[176:179], v[44:47]
    ds_read_b64_tr_b16 v[108:109], v14 offset:12288
    s_waitcnt vmcnt(10)
    v_mfma_f32_16x16x32_bf16 v[28:31], v[76:79], v[172:175], v[28:31]
    ds_read_b64_tr_b16 v[110:111], v14 offset:14336
    v_or3_b32 v17, v180, v184, v188
    v_mfma_f32_16x16x32_bf16 v[32:35], v[80:83], v[172:175], v[32:35]
    ds_read_b64_tr_b16 v[112:113], v15 offset:12288
    v_bitop3_b32 v17, v17, v192, 1 bitop3:0xa8
    v_mfma_f32_16x16x32_bf16 v[48:51], v[80:83], v[176:179], v[48:51]
    ds_read_b64_tr_b16 v[114:115], v15 offset:14336
    v_cmp_ne_u32 vcc, 0, v17
    v_mfma_f32_16x16x32_bf16 v[52:55], v[84:87], v[176:179], v[52:55]
    ds_read_b64_tr_b16 v[116:117], v16 offset:12288
    ds_read_b64_tr_b16 v[118:119], v16 offset:14336
    v_mfma_f32_16x16x32_bf16 v[36:39], v[84:87], v[172:175], v[36:39]
    s_waitcnt lgkmcnt(8)
    s_cbranch_vccnz dm_22f0
dm_22g0:
    v_mfma_f32_16x16x32_bf16 v[24:27], v[88:91], v[180:183], v[24:27]
    ds_read_b64_tr_b16 v[56:57], v13 offset:16384
    buffer_load_dwordx4 v[172:175], v126, s[8:11], s44 offen offset:1024 sc1
    v_mfma_f32_16x16x32_bf16 v[40:43], v[88:91], v[184:187], v[40:43]
    ds_read_b64_tr_b16 v[58:59], v13 offset:18432
    buffer_load_dwordx4 v[176:179], v127, s[8:11], s44 offen offset:1024 sc1
    v_mfma_f32_16x16x32_bf16 v[44:47], v[92:95], v[184:187], v[44:47]
    ds_read_b64_tr_b16 v[60:61], v14 offset:16384
    v_mfma_f32_16x16x32_bf16 v[28:31], v[92:95], v[180:183], v[28:31]
    ds_read_b64_tr_b16 v[62:63], v14 offset:18432
    v_mfma_f32_16x16x32_bf16 v[32:35], v[96:99], v[180:183], v[32:35]
    ds_read_b64_tr_b16 v[64:65], v15 offset:16384
    v_mfma_f32_16x16x32_bf16 v[48:51], v[96:99], v[184:187], v[48:51]
    ds_read_b64_tr_b16 v[66:67], v15 offset:18432
    v_mfma_f32_16x16x32_bf16 v[52:55], v[100:103], v[184:187], v[52:55]
    ds_read_b64_tr_b16 v[68:69], v16 offset:16384
    v_mfma_f32_16x16x32_bf16 v[36:39], v[100:103], v[180:183], v[36:39]
    ds_read_b64_tr_b16 v[70:71], v16 offset:18432
    s_waitcnt lgkmcnt(8)
    v_mfma_f32_16x16x32_bf16 v[24:27], v[104:107], v[188:191], v[24:27]
    ds_read_b64_tr_b16 v[72:73], v13 offset:20480
    buffer_load_dwordx4 v[180:183], v126, s[8:11], s44 offen offset:2048 sc1
    v_mfma_f32_16x16x32_bf16 v[40:43], v[104:107], v[192:195], v[40:43]
    ds_read_b64_tr_b16 v[74:75], v13 offset:22528
    buffer_load_dwordx4 v[184:187], v127, s[8:11], s44 offen offset:2048 sc1
    v_mfma_f32_16x16x32_bf16 v[44:47], v[108:111], v[192:195], v[44:47]
    ds_read_b64_tr_b16 v[76:77], v14 offset:20480
    s_waitcnt vmcnt(10)
    v_mfma_f32_16x16x32_bf16 v[28:31], v[108:111], v[188:191], v[28:31]
    ds_read_b64_tr_b16 v[78:79], v14 offset:22528
    v_or3_b32 v17, v196, v200, v204
    v_mfma_f32_16x16x32_bf16 v[32:35], v[112:115], v[188:191], v[32:35]
    ds_read_b64_tr_b16 v[80:81], v15 offset:20480
    v_bitop3_b32 v17, v17, v208, 1 bitop3:0xa8
    v_mfma_f32_16x16x32_bf16 v[48:51], v[112:115], v[192:195], v[48:51]
    ds_read_b64_tr_b16 v[82:83], v15 offset:22528
    v_cmp_ne_u32 vcc, 0, v17
    v_mfma_f32_16x16x32_bf16 v[52:55], v[116:119], v[192:195], v[52:55]
    ds_read_b64_tr_b16 v[84:85], v16 offset:20480
    ds_read_b64_tr_b16 v[86:87], v16 offset:22528
    v_mfma_f32_16x16x32_bf16 v[36:39], v[116:119], v[188:191], v[36:39]
    s_waitcnt lgkmcnt(8)
    s_cbranch_vccnz dm_22f1
dm_22g1:
    v_mfma_f32_16x16x32_bf16 v[24:27], v[56:59], v[196:199], v[24:27]
    ds_read_b64_tr_b16 v[88:89], v13 offset:24576
    buffer_load_dwordx4 v[188:191], v126, s[8:11], s44 offen offset:3072 sc1
    v_mfma_f32_16x16x32_bf16 v[40:43], v[56:59], v[200:203], v[40:43]
    ds_read_b64_tr_b16 v[90:91], v13 offset:26624
    buffer_load_dwordx4 v[192:195], v127, s[8:11], s44 offen offset:3072 sc1
    v_mfma_f32_16x16x32_bf16 v[44:47], v[60:63], v[200:203], v[44:47]
    ds_read_b64_tr_b16 v[92:93], v14 offset:24576
    v_mfma_f32_16x16x32_bf16 v[28:31], v[60:63], v[196:199], v[28:31]
    ds_read_b64_tr_b16 v[94:95], v14 offset:26624
    v_mfma_f32_16x16x32_bf16 v[32:35], v[64:67], v[196:199], v[32:35]
    ds_read_b64_tr_b16 v[96:97], v15 offset:24576
    s_add_u32 s43, s43, 1
    v_mfma_f32_16x16x32_bf16 v[48:51], v[64:67], v[200:203], v[48:51]
    ds_read_b64_tr_b16 v[98:99], v15 offset:26624
    v_mfma_f32_16x16x32_bf16 v[52:55], v[68:71], v[200:203], v[52:55]
    ds_read_b64_tr_b16 v[100:101], v16 offset:24576
    v_mfma_f32_16x16x32_bf16 v[36:39], v[68:71], v[196:199], v[36:39]
    ds_read_b64_tr_b16 v[102:103], v16 offset:26624
    s_waitcnt lgkmcnt(8)
    v_mfma_f32_16x16x32_bf16 v[24:27], v[72:75], v[204:207], v[24:27]
    ds_read_b64_tr_b16 v[104:105], v13 offset:28672
    buffer_load_dwordx4 v[196:199], v128, s[8:11], s44 offen offset:0 sc1
    v_mfma_f32_16x16x32_bf16 v[40:43], v[72:75], v[208:211], v[40:43]
    ds_read_b64_tr_b16 v[106:107], v13 offset:30720
    buffer_load_dwordx4 v[200:203], v129, s[8:11], s44 offen offset:0 sc1
    v_mfma_f32_16x16x32_bf16 v[44:47], v[76:79], v[208:211], v[44:47]
    ds_read_b64_tr_b16 v[108:109], v14 offset:28672
    s_waitcnt vmcnt(10)
    v_mfma_f32_16x16x32_bf16 v[28:31], v[76:79], v[204:207], v[28:31]
    ds_read_b64_tr_b16 v[110:111], v14 offset:30720
    v_add_u32 v13, 32768, v13
    v_or3_b32 v17, v212, v216, v220
    v_mfma_f32_16x16x32_bf16 v[32:35], v[80:83], v[204:207], v[32:35]
    ds_read_b64_tr_b16 v[112:113], v15 offset:28672
    v_add_u32 v14, 32768, v14
    v_bitop3_b32 v17, v17, v224, 1 bitop3:0xa8
    v_mfma_f32_16x16x32_bf16 v[48:51], v[80:83], v[208:211], v[48:51]
    ds_read_b64_tr_b16 v[114:115], v15 offset:30720
    v_add_u32 v15, 32768, v15
    v_cmp_ne_u32 vcc, 0, v17
    v_mfma_f32_16x16x32_bf16 v[52:55], v[84:87], v[208:211], v[52:55]
    ds_read_b64_tr_b16 v[116:117], v16 offset:28672
    ds_read_b64_tr_b16 v[118:119], v16 offset:30720
    s_cmp_eq_u32 s43, 4
    v_mfma_f32_16x16x32_bf16 v[36:39], v[84:87], v[204:207], v[36:39]
    v_add_u32 v16, 32768, v16
    s_waitcnt lgkmcnt(8)
    s_cbranch_vccnz dm_22f2
dm_22g2:
    s_cbranch_scc1 dm_22x
    v_mfma_f32_16x16x32_bf16 v[24:27], v[88:91], v[212:215], v[24:27]
    ds_read_b64_tr_b16 v[56:57], v13 offset:0
    buffer_load_dwordx4 v[204:207], v128, s[8:11], s44 offen offset:1024 sc1
    v_mfma_f32_16x16x32_bf16 v[40:43], v[88:91], v[216:219], v[40:43]
    ds_read_b64_tr_b16 v[58:59], v13 offset:2048
    buffer_load_dwordx4 v[208:211], v129, s[8:11], s44 offen offset:1024 sc1
    v_mfma_f32_16x16x32_bf16 v[44:47], v[92:95], v[216:219], v[44:47]
    ds_read_b64_tr_b16 v[60:61], v14 offset:0
    s_mov_b32 s49, s44
    v_mfma_f32_16x16x32_bf16 v[28:31], v[92:95], v[212:215], v[28:31]
    ds_read_b64_tr_b16 v[62:63], v14 offset:2048
    v_mfma_f32_16x16x32_bf16 v[32:35], v[96:99], v[212:215], v[32:35]
    ds_read_b64_tr_b16 v[64:65], v15 offset:0
    v_mfma_f32_16x16x32_bf16 v[48:51], v[96:99], v[216:219], v[48:51]
    ds_read_b64_tr_b16 v[66:67], v15 offset:2048
    v_mfma_f32_16x16x32_bf16 v[52:55], v[100:103], v[216:219], v[52:55]
    ds_read_b64_tr_b16 v[68:69], v16 offset:0
    v_mfma_f32_16x16x32_bf16 v[36:39], v[100:103], v[212:215], v[36:39]
    ds_read_b64_tr_b16 v[70:71], v16 offset:2048
    s_waitcnt lgkmcnt(8)
    v_mfma_f32_16x16x32_bf16 v[24:27], v[104:107], v[220:223], v[24:27]
    ds_read_b64_tr_b16 v[72:73], v13 offset:4096
    buffer_load_dwordx4 v[212:215], v128, s[8:11], s44 offen offset:2048 sc1
    v_mfma_f32_16x16x32_bf16 v[40:43], v[104:107], v[224:227], v[40:43]
    ds_read_b64_tr_b16 v[74:75], v13 offset:6144
    buffer_load_dwordx4 v[216:219], v129, s[8:11], s44 offen offset:2048 sc1
    v_mfma_f32_16x16x32_bf16 v[44:47], v[108:111], v[224:227], v[44:47]
    ds_read_b64_tr_b16 v[76:77], v14 offset:4096
    s_waitcnt vmcnt(10)
    v_mfma_f32_16x16x32_bf16 v[28:31], v[108:111], v[220:223], v[28:31]
    ds_read_b64_tr_b16 v[78:79], v14 offset:6144
    v_or3_b32 v17, v164, v168, v172
    v_mfma_f32_16x16x32_bf16 v[32:35], v[112:115], v[220:223], v[32:35]
    ds_read_b64_tr_b16 v[80:81], v15 offset:4096
    v_bitop3_b32 v17, v17, v176, 1 bitop3:0xa8
    v_mfma_f32_16x16x32_bf16 v[48:51], v[112:115], v[224:227], v[48:51]
    ds_read_b64_tr_b16 v[82:83], v15 offset:6144
    v_cmp_ne_u32 vcc, 0, v17
    v_mfma_f32_16x16x32_bf16 v[52:55], v[116:119], v[224:227], v[52:55]
    ds_read_b64_tr_b16 v[84:85], v16 offset:4096
    ds_read_b64_tr_b16 v[86:87], v16 offset:6144
    v_mfma_f32_16x16x32_bf16 v[36:39], v[116:119], v[220:223], v[36:39]
    s_waitcnt lgkmcnt(8)
    s_cbranch_vccnz dm_22f3
dm_22g3:
    s_branch dm_22
dm_22f0:
    s_cselect_b32 s50, 1, 0
dm_22h0:
    s_sleep 2
    buffer_load_dwordx4 v[180:183], v126, s[8:11], s49 offen offset:2048 sc1
    buffer_load_dwordx4 v[184:187], v127, s[8:11], s49 offen offset:2048 sc1
    buffer_load_dwordx4 v[188:191], v126, s[8:11], s49 offen offset:3072 sc1
    buffer_load_dwordx4 v[192:195], v127, s[8:11], s49 offen offset:3072 sc1
    buffer_load_dwordx4 v[196:199], v128, s[8:11], s49 offen offset:0 sc1
    buffer_load_dwordx4 v[200:203], v129, s[8:11], s49 offen offset:0 sc1
    buffer_load_dwordx4 v[204:207], v128, s[8:11], s49 offen offset:1024 sc1
    buffer_load_dwordx4 v[208:211], v129, s[8:11], s49 offen offset:1024 sc1
    buffer_load_dwordx4 v[212:215], v128, s[8:11], s49 offen offset:2048 sc1
    buffer_load_dwordx4 v[216:219], v129, s[8:11], s49 offen offset:2048 sc1
    buffer_load_dwordx4 v[220:223], v128, s[8:11], s49 offen offset:3072 sc1
    buffer_load_dwordx4 v[224:227], v129, s[8:11], s49 offen offset:3072 sc1
    buffer_load_dwordx4 v[164:167], v126, s[8:11], s44 offen offset:0 sc1
    buffer_load_dwordx4 v[168:171], v127, s[8:11], s44 offen offset:0 sc1
    s_waitcnt vmcnt(10)
    v_or3_b32 v17, v180, v184, v188
    v_bitop3_b32 v17, v17, v192, 1 bitop3:0xa8
    v_cmp_ne_u32 vcc, 0, v17
    s_add_u32 s53, s53, 1
    s_cmp_ge_u32 s53, s61
    s_cselect_b32 s61, 0, s61
    s_cbranch_scc1 dm_22k0
    s_cbranch_vccnz dm_22h0
dm_22k0:
    s_cmp_eq_u32 s50, 1
    s_branch dm_22g0
dm_22f1:
    s_cselect_b32 s50, 1, 0
dm_22h1:
    s_sleep 2
    buffer_load_dwordx4 v[196:199], v128, s[8:11], s49 offen offset:0 sc1
    buffer_load_dwordx4 v[200:203], v129, s[8:11], s49 offen offset:0 sc1
    buffer_load_dwordx4 v[204:207], v128, s[8:11], s49 offen offset:1024 sc1
    buffer_load_dwordx4 v[208:211], v129, s[8:11], s49 offen offset:1024 sc1
    buffer_load_dwordx4 v[212:215], v128, s[8:11], s49 offen offset:2048 sc1
    buffer_load_dwordx4 v[216:219], v129, s[8:11], s49 offen offset:2048 sc1
    buffer_load_dwordx4 v[220:223], v128, s[8:11], s49 offen offset:3072 sc1
    buffer_load_dwordx4 v[224:227], v129, s[8:11], s49 offen offset:3072 sc1
    buffer_load_dwordx4 v[164:167], v126, s[8:11], s44 offen offset:0 sc1
    buffer_load_dwordx4 v[168:171], v127, s[8:11], s44 offen offset:0 sc1
    buffer_load_dwordx4 v[172:175], v126, s[8:11], s44 offen offset:1024 sc1
    buffer_load_dwordx4 v[176:179], v127, s[8:11], s44 offen offset:1024 sc1
    buffer_load_dwordx4 v[180:183], v126, s[8:11], s44 offen offset:2048 sc1
    buffer_load_dwordx4 v[184:187], v127, s[8:11], s44 offen offset:2048 sc1
    s_waitcnt vmcnt(10)
    v_or3_b32 v17, v196, v200, v204
    v_bitop3_b32 v17, v17, v208, 1 bitop3:0xa8
    v_cmp_ne_u32 vcc, 0, v17
    s_add_u32 s53, s53, 1
    s_cmp_ge_u32 s53, s61
    s_cselect_b32 s61, 0, s61
    s_cbranch_scc1 dm_22k1
    s_cbranch_vccnz dm_22h1
dm_22k1:
    s_cmp_eq_u32 s50, 1
    s_branch dm_22g1
dm_22f2:
    s_cselect_b32 s50, 1, 0
dm_22h2:
    s_sleep 2
    buffer_load_dwordx4 v[212:215], v128, s[8:11], s49 offen offset:2048 sc1
    buffer_load_dwordx4 v[216:219], v129, s[8:11], s49 offen offset:2048 sc1
    buffer_load_dwordx4 v[220:223], v128, s[8:11], s49 offen offset:3072 sc1
    buffer_load_dwordx4 v[224:227], v129, s[8:11], s49 offen offset:3072 sc1
    buffer_load_dwordx4 v[164:167], v126, s[8:11], s44 offen offset:0 sc1
    buffer_load_dwordx4 v[168:171], v127, s[8:11], s44 offen offset:0 sc1
    buffer_load_dwordx4 v[172:175], v126, s[8:11], s44 offen offset:1024 sc1
    buffer_load_dwordx4 v[176:179], v127, s[8:11], s44 offen offset:1024 sc1
    buffer_load_dwordx4 v[180:183], v126, s[8:11], s44 offen offset:2048 sc1
    buffer_load_dwordx4 v[184:187], v127, s[8:11], s44 offen offset:2048 sc1
    buffer_load_dwordx4 v[188:191], v126, s[8:11], s44 offen offset:3072 sc1
    buffer_load_dwordx4 v[192:195], v127, s[8:11], s44 offen offset:3072 sc1
    buffer_load_dwordx4 v[196:199], v128, s[8:11], s44 offen offset:0 sc1
    buffer_load_dwordx4 v[200:203], v129, s[8:11], s44 offen offset:0 sc1
    s_waitcnt vmcnt(10)
    v_or3_b32 v17, v212, v216, v220
    v_bitop3_b32 v17, v17, v224, 1 bitop3:0xa8
    v_cmp_ne_u32 vcc, 0, v17
    s_add_u32 s53, s53, 1
    s_cmp_ge_u32 s53, s61
    s_cselect_b32 s61, 0, s61
    s_cbranch_scc1 dm_22k2
    s_cbranch_vccnz dm_22h2
dm_22k2:
    s_cmp_eq_u32 s50, 1
    s_branch dm_22g2
dm_22f3:
    s_cselect_b32 s50, 1, 0
dm_22h3:
    s_sleep 2
    buffer_load_dwordx4 v[164:167], v126, s[8:11], s49 offen offset:0 sc1
    buffer_load_dwordx4 v[168:171], v127, s[8:11], s49 offen offset:0 sc1
    buffer_load_dwordx4 v[172:175], v126, s[8:11], s49 offen offset:1024 sc1
    buffer_load_dwordx4 v[176:179], v127, s[8:11], s49 offen offset:1024 sc1
    buffer_load_dwordx4 v[180:183], v126, s[8:11], s49 offen offset:2048 sc1
    buffer_load_dwordx4 v[184:187], v127, s[8:11], s49 offen offset:2048 sc1
    buffer_load_dwordx4 v[188:191], v126, s[8:11], s49 offen offset:3072 sc1
    buffer_load_dwordx4 v[192:195], v127, s[8:11], s49 offen offset:3072 sc1
    buffer_load_dwordx4 v[196:199], v128, s[8:11], s49 offen offset:0 sc1
    buffer_load_dwordx4 v[200:203], v129, s[8:11], s49 offen offset:0 sc1
    buffer_load_dwordx4 v[204:207], v128, s[8:11], s49 offen offset:1024 sc1
    buffer_load_dwordx4 v[208:211], v129, s[8:11], s49 offen offset:1024 sc1
    buffer_load_dwordx4 v[212:215], v128, s[8:11], s49 offen offset:2048 sc1
    buffer_load_dwordx4 v[216:219], v129, s[8:11], s49 offen offset:2048 sc1
    s_waitcnt vmcnt(10)
    v_or3_b32 v17, v164, v168, v172
    v_bitop3_b32 v17, v17, v176, 1 bitop3:0xa8
    v_cmp_ne_u32 vcc, 0, v17
    s_add_u32 s53, s53, 1
    s_cmp_ge_u32 s53, s61
    s_cselect_b32 s61, 0, s61
    s_cbranch_scc1 dm_22k3
    s_cbranch_vccnz dm_22h3
dm_22k3:
    s_cmp_eq_u32 s50, 1
    s_branch dm_22g3
dm_22x:
    v_mfma_f32_16x16x32_bf16 v[24:27], v[88:91], v[212:215], v[24:27]
    buffer_load_dwordx4 v[148:151], v126, s[8:11], s41 offen offset:0 sc1
    v_mfma_f32_16x16x32_bf16 v[40:43], v[88:91], v[216:219], v[40:43]
    v_mfma_f32_16x16x32_bf16 v[44:47], v[92:95], v[216:219], v[44:47]
    buffer_load_dwordx4 v[152:155], v126, s[8:11], s41 offen offset:1024 sc1
    v_mfma_f32_16x16x32_bf16 v[28:31], v[92:95], v[212:215], v[28:31]
    v_mfma_f32_16x16x32_bf16 v[32:35], v[96:99], v[212:215], v[32:35]
    buffer_load_dwordx4 v[156:159], v127, s[8:11], s41 offen offset:0 sc1
    v_mfma_f32_16x16x32_bf16 v[48:51], v[96:99], v[216:219], v[48:51]
    v_mfma_f32_16x16x32_bf16 v[52:55], v[100:103], v[216:219], v[52:55]
    buffer_load_dwordx4 v[160:163], v127, s[8:11], s41 offen offset:1024 sc1
    v_mfma_f32_16x16x32_bf16 v[36:39], v[100:103], v[212:215], v[36:39]
    s_waitcnt lgkmcnt(0)
    s_barrier
    v_mfma_f32_16x16x32_bf16 v[24:27], v[104:107], v[220:223], v[24:27]
    ds_read_b128 v[56:59], v6 offset:0
    v_mfma_f32_16x16x32_bf16 v[40:43], v[104:107], v[224:227], v[40:43]
    ds_read_b128 v[60:63], v6 offset:64
    v_mfma_f32_16x16x32_bf16 v[44:47], v[108:111], v[224:227], v[44:47]
    ds_read_b128 v[64:67], v6 offset:128
    v_mfma_f32_16x16x32_bf16 v[28:31], v[108:111], v[220:223], v[28:31]
    ds_read_b128 v[68:71], v6 offset:192
    v_mfma_f32_16x16x32_bf16 v[32:35], v[112:115], v[220:223], v[32:35]
    ds_read_b64 v[72:73], v7 offset:0
    v_mfma_f32_16x16x32_bf16 v[48:51], v[112:115], v[224:227], v[48:51]
    ds_read_b64 v[74:75], v7 offset:256
    v_mfma_f32_16x16x32_bf16 v[52:55], v[116:119], v[224:227], v[52:55]
    v_mfma_f32_16x16x32_bf16 v[36:39], v[116:119], v[220:223], v[36:39]
    s_waitcnt lgkmcnt(0)
    v_mul_f32 v134, 0xc0135761, v73
    v_mul_f32 v135, v73, v73
    v_mul_f32 v135, v135, v134
    v_mul_f32 v135, 0x3d372713, v135
    v_rcp_f32 v73, v73
    v_mul_f32 v136, 0xc0135761, v75
    v_mul_f32 v137, v75, v75
    v_mul_f32 v137, v137, v136
    v_mul_f32 v137, 0x3d372713, v137
    v_rcp_f32 v75, v75
    v_pk_fma_f32 v[24:25], v[72:73], v[56:57], v[24:25] op_sel_hi:[0,1,1] neg_lo:[1,0,0] neg_hi:[1,0,0]
    v_pk_fma_f32 v[26:27], v[72:73], v[58:59], v[26:27] op_sel_hi:[0,1,1] neg_lo:[1,0,0] neg_hi:[1,0,0]
    v_pk_mul_f32 v[122:123], v[24:25], v[24:25]
    v_pk_mul_f32 v[124:125], v[26:27], v[26:27]
    v_pk_fma_f32 v[122:123], v[122:123], v[134:135], v[134:135] op_sel:[0,1,0] op_sel_hi:[1,1,0]
    v_pk_fma_f32 v[124:125], v[124:125], v[134:135], v[134:135] op_sel:[0,1,0] op_sel_hi:[1,1,0]
    v_pk_mul_f32 v[122:123], v[122:123], v[24:25]
    v_pk_mul_f32 v[124:125], v[124:125], v[26:27]
    v_exp_f32 v122, v122
    v_exp_f32 v123, v123
    v_exp_f32 v124, v124
    v_exp_f32 v125, v125
    v_pk_fma_f32 v[122:123], v[122:123], v[72:73], v[72:73] op_sel:[0,1,1] op_sel_hi:[1,1,1]
    v_pk_fma_f32 v[124:125], v[124:125], v[72:73], v[72:73] op_sel:[0,1,1] op_sel_hi:[1,1,1]
    v_rcp_f32 v122, v122
    v_rcp_f32 v123, v123
    v_rcp_f32 v124, v124
    v_rcp_f32 v125, v125
    v_pk_mul_f32 v[24:25], v[24:25], v[122:123]
    v_pk_mul_f32 v[26:27], v[26:27], v[124:125]
    v_pk_fma_f32 v[28:29], v[72:73], v[60:61], v[28:29] op_sel_hi:[0,1,1] neg_lo:[1,0,0] neg_hi:[1,0,0]
    v_pk_fma_f32 v[30:31], v[72:73], v[62:63], v[30:31] op_sel_hi:[0,1,1] neg_lo:[1,0,0] neg_hi:[1,0,0]
    v_pk_mul_f32 v[122:123], v[28:29], v[28:29]
    v_pk_mul_f32 v[124:125], v[30:31], v[30:31]
    v_pk_fma_f32 v[122:123], v[122:123], v[134:135], v[134:135] op_sel:[0,1,0] op_sel_hi:[1,1,0]
    v_pk_fma_f32 v[124:125], v[124:125], v[134:135], v[134:135] op_sel:[0,1,0] op_sel_hi:[1,1,0]
    v_pk_mul_f32 v[122:123], v[122:123], v[28:29]
    v_pk_mul_f32 v[124:125], v[124:125], v[30:31]
    v_exp_f32 v122, v122
    v_exp_f32 v123, v123
    v_exp_f32 v124, v124
    v_exp_f32 v125, v125
    v_pk_fma_f32 v[122:123], v[122:123], v[72:73], v[72:73] op_sel:[0,1,1] op_sel_hi:[1,1,1]
    v_pk_fma_f32 v[124:125], v[124:125], v[72:73], v[72:73] op_sel:[0,1,1] op_sel_hi:[1,1,1]
    v_rcp_f32 v122, v122
    v_rcp_f32 v123, v123
    v_rcp_f32 v124, v124
    v_rcp_f32 v125, v125
    v_pk_mul_f32 v[28:29], v[28:29], v[122:123]
    v_pk_mul_f32 v[30:31], v[30:31], v[124:125]
    v_cvt_pk_bf16_f32 v24, v24, v25
    v_cvt_pk_bf16_f32 v25, v26, v27
    v_cvt_pk_bf16_f32 v26, v28, v29
    v_cvt_pk_bf16_f32 v27, v30, v31
    v_and_b32 v24, -2, v24
    buffer_store_dwordx4 v[24:27], v12, s[16:19], s39 offen offset:0 sc1
    v_pk_fma_f32 v[40:41], v[74:75], v[56:57], v[40:41] op_sel_hi:[0,1,1] neg_lo:[1,0,0] neg_hi:[1,0,0]
    v_pk_fma_f32 v[42:43], v[74:75], v[58:59], v[42:43] op_sel_hi:[0,1,1] neg_lo:[1,0,0] neg_hi:[1,0,0]
    v_pk_mul_f32 v[122:123], v[40:41], v[40:41]
    v_pk_mul_f32 v[124:125], v[42:43], v[42:43]
    v_pk_fma_f32 v[122:123], v[122:123], v[136:137], v[136:137] op_sel:[0,1,0] op_sel_hi:[1,1,0]
    v_pk_fma_f32 v[124:125], v[124:125], v[136:137], v[136:137] op_sel:[0,1,0] op_sel_hi:[1,1,0]
    v_pk_mul_f32 v[122:123], v[122:123], v[40:41]
    v_pk_mul_f32 v[124:125], v[124:125], v[42:43]
    v_exp_f32 v122, v122
    v_exp_f32 v123, v123
    v_exp_f32 v124, v124
    v_exp_f32 v125, v125
    v_pk_fma_f32 v[122:123], v[122:123], v[74:75], v[74:75] op_sel:[0,1,1] op_sel_hi:[1,1,1]
    v_pk_fma_f32 v[124:125], v[124:125], v[74:75], v[74:75] op_sel:[0,1,1] op_sel_hi:[1,1,1]
    v_rcp_f32 v122, v122
    v_rcp_f32 v123, v123
    v_rcp_f32 v124, v124
    v_rcp_f32 v125, v125
    v_pk_mul_f32 v[40:41], v[40:41], v[122:123]
    v_pk_mul_f32 v[42:43], v[42:43], v[124:125]
    v_pk_fma_f32 v[44:45], v[74:75], v[60:61], v[44:45] op_sel_hi:[0,1,1] neg_lo:[1,0,0] neg_hi:[1,0,0]
    v_pk_fma_f32 v[46:47], v[74:75], v[62:63], v[46:47] op_sel_hi:[0,1,1] neg_lo:[1,0,0] neg_hi:[1,0,0]
    v_pk_mul_f32 v[122:123], v[44:45], v[44:45]
    v_pk_mul_f32 v[124:125], v[46:47], v[46:47]
    v_pk_fma_f32 v[122:123], v[122:123], v[136:137], v[136:137] op_sel:[0,1,0] op_sel_hi:[1,1,0]
    v_pk_fma_f32 v[124:125], v[124:125], v[136:137], v[136:137] op_sel:[0,1,0] op_sel_hi:[1,1,0]
    v_pk_mul_f32 v[122:123], v[122:123], v[44:45]
    v_pk_mul_f32 v[124:125], v[124:125], v[46:47]
    v_exp_f32 v122, v122
    v_exp_f32 v123, v123
    v_exp_f32 v124, v124
    v_exp_f32 v125, v125
    v_pk_fma_f32 v[122:123], v[122:123], v[74:75], v[74:75] op_sel:[0,1,1] op_sel_hi:[1,1,1]
    v_pk_fma_f32 v[124:125], v[124:125], v[74:75], v[74:75] op_sel:[0,1,1] op_sel_hi:[1,1,1]
    v_rcp_f32 v122, v122
    v_rcp_f32 v123, v123
    v_rcp_f32 v124, v124
    v_rcp_f32 v125, v125
    v_pk_mul_f32 v[44:45], v[44:45], v[122:123]
    v_pk_mul_f32 v[46:47], v[46:47], v[124:125]
    v_cvt_pk_bf16_f32 v40, v40, v41
    v_cvt_pk_bf16_f32 v41, v42, v43
    v_cvt_pk_bf16_f32 v42, v44, v45
    v_cvt_pk_bf16_f32 v43, v46, v47
    v_and_b32 v40, -2, v40
    buffer_store_dwordx4 v[40:43], v12, s[16:19], s39 offen offset:256 sc1
    v_pk_fma_f32 v[32:33], v[72:73], v[64:65], v[32:33] op_sel_hi:[0,1,1] neg_lo:[1,0,0] neg_hi:[1,0,0]
    v_pk_fma_f32 v[34:35], v[72:73], v[66:67], v[34:35] op_sel_hi:[0,1,1] neg_lo:[1,0,0] neg_hi:[1,0,0]
    v_pk_mul_f32 v[122:123], v[32:33], v[32:33]
    v_pk_mul_f32 v[124:125], v[34:35], v[34:35]
    v_pk_fma_f32 v[122:123], v[122:123], v[134:135], v[134:135] op_sel:[0,1,0] op_sel_hi:[1,1,0]
    v_pk_fma_f32 v[124:125], v[124:125], v[134:135], v[134:135] op_sel:[0,1,0] op_sel_hi:[1,1,0]
    v_pk_mul_f32 v[122:123], v[122:123], v[32:33]
    v_pk_mul_f32 v[124:125], v[124:125], v[34:35]
    v_exp_f32 v122, v122
    v_exp_f32 v123, v123
    v_exp_f32 v124, v124
    v_exp_f32 v125, v125
    v_pk_fma_f32 v[122:123], v[122:123], v[72:73], v[72:73] op_sel:[0,1,1] op_sel_hi:[1,1,1]
    v_pk_fma_f32 v[124:125], v[124:125], v[72:73], v[72:73] op_sel:[0,1,1] op_sel_hi:[1,1,1]
    v_rcp_f32 v122, v122
    v_rcp_f32 v123, v123
    v_rcp_f32 v124, v124
    v_rcp_f32 v125, v125
    v_pk_mul_f32 v[32:33], v[32:33], v[122:123]
    v_pk_mul_f32 v[34:35], v[34:35], v[124:125]
    v_pk_fma_f32 v[36:37], v[72:73], v[68:69], v[36:37] op_sel_hi:[0,1,1] neg_lo:[1,0,0] neg_hi:[1,0,0]
    v_pk_fma_f32 v[38:39], v[72:73], v[70:71], v[38:39] op_sel_hi:[0,1,1] neg_lo:[1,0,0] neg_hi:[1,0,0]
    v_pk_mul_f32 v[122:123], v[36:37], v[36:37]
    v_pk_mul_f32 v[124:125], v[38:39], v[38:39]
    v_pk_fma_f32 v[122:123], v[122:123], v[134:135], v[134:135] op_sel:[0,1,0] op_sel_hi:[1,1,0]
    v_pk_fma_f32 v[124:125], v[124:125], v[134:135], v[134:135] op_sel:[0,1,0] op_sel_hi:[1,1,0]
    v_pk_mul_f32 v[122:123], v[122:123], v[36:37]
    v_pk_mul_f32 v[124:125], v[124:125], v[38:39]
    v_exp_f32 v122, v122
    v_exp_f32 v123, v123
    v_exp_f32 v124, v124
    v_exp_f32 v125, v125
    v_pk_fma_f32 v[122:123], v[122:123], v[72:73], v[72:73] op_sel:[0,1,1] op_sel_hi:[1,1,1]
    v_pk_fma_f32 v[124:125], v[124:125], v[72:73], v[72:73] op_sel:[0,1,1] op_sel_hi:[1,1,1]
    v_rcp_f32 v122, v122
    v_rcp_f32 v123, v123
    v_rcp_f32 v124, v124
    v_rcp_f32 v125, v125
    v_pk_mul_f32 v[36:37], v[36:37], v[122:123]
    v_pk_mul_f32 v[38:39], v[38:39], v[124:125]
    v_cvt_pk_bf16_f32 v32, v32, v33
    v_cvt_pk_bf16_f32 v33, v34, v35
    v_cvt_pk_bf16_f32 v34, v36, v37
    v_cvt_pk_bf16_f32 v35, v38, v39
    v_and_b32 v32, -2, v32
    buffer_store_dwordx4 v[32:35], v12, s[16:19], s40 offen offset:0 sc1
    v_pk_fma_f32 v[48:49], v[74:75], v[64:65], v[48:49] op_sel_hi:[0,1,1] neg_lo:[1,0,0] neg_hi:[1,0,0]
    v_pk_fma_f32 v[50:51], v[74:75], v[66:67], v[50:51] op_sel_hi:[0,1,1] neg_lo:[1,0,0] neg_hi:[1,0,0]
    v_pk_mul_f32 v[122:123], v[48:49], v[48:49]
    v_pk_mul_f32 v[124:125], v[50:51], v[50:51]
    v_pk_fma_f32 v[122:123], v[122:123], v[136:137], v[136:137] op_sel:[0,1,0] op_sel_hi:[1,1,0]
    v_pk_fma_f32 v[124:125], v[124:125], v[136:137], v[136:137] op_sel:[0,1,0] op_sel_hi:[1,1,0]
    v_pk_mul_f32 v[122:123], v[122:123], v[48:49]
    v_pk_mul_f32 v[124:125], v[124:125], v[50:51]
    v_exp_f32 v122, v122
    v_exp_f32 v123, v123
    v_exp_f32 v124, v124
    v_exp_f32 v125, v125
    v_pk_fma_f32 v[122:123], v[122:123], v[74:75], v[74:75] op_sel:[0,1,1] op_sel_hi:[1,1,1]
    v_pk_fma_f32 v[124:125], v[124:125], v[74:75], v[74:75] op_sel:[0,1,1] op_sel_hi:[1,1,1]
    v_rcp_f32 v122, v122
    v_rcp_f32 v123, v123
    v_rcp_f32 v124, v124
    v_rcp_f32 v125, v125
    v_pk_mul_f32 v[48:49], v[48:49], v[122:123]
    v_pk_mul_f32 v[50:51], v[50:51], v[124:125]
    v_pk_fma_f32 v[52:53], v[74:75], v[68:69], v[52:53] op_sel_hi:[0,1,1] neg_lo:[1,0,0] neg_hi:[1,0,0]
    v_pk_fma_f32 v[54:55], v[74:75], v[70:71], v[54:55] op_sel_hi:[0,1,1] neg_lo:[1,0,0] neg_hi:[1,0,0]
    v_pk_mul_f32 v[122:123], v[52:53], v[52:53]
    v_pk_mul_f32 v[124:125], v[54:55], v[54:55]
    v_pk_fma_f32 v[122:123], v[122:123], v[136:137], v[136:137] op_sel:[0,1,0] op_sel_hi:[1,1,0]
    v_pk_fma_f32 v[124:125], v[124:125], v[136:137], v[136:137] op_sel:[0,1,0] op_sel_hi:[1,1,0]
    v_pk_mul_f32 v[122:123], v[122:123], v[52:53]
    v_pk_mul_f32 v[124:125], v[124:125], v[54:55]
    v_exp_f32 v122, v122
    v_exp_f32 v123, v123
    v_exp_f32 v124, v124
    v_exp_f32 v125, v125
    v_pk_fma_f32 v[122:123], v[122:123], v[74:75], v[74:75] op_sel:[0,1,1] op_sel_hi:[1,1,1]
    v_pk_fma_f32 v[124:125], v[124:125], v[74:75], v[74:75] op_sel:[0,1,1] op_sel_hi:[1,1,1]
    v_rcp_f32 v122, v122
    v_rcp_f32 v123, v123
    v_rcp_f32 v124, v124
    v_rcp_f32 v125, v125
    v_pk_mul_f32 v[52:53], v[52:53], v[122:123]
    v_pk_mul_f32 v[54:55], v[54:55], v[124:125]
    v_cvt_pk_bf16_f32 v48, v48, v49
    v_cvt_pk_bf16_f32 v49, v50, v51
    v_cvt_pk_bf16_f32 v50, v52, v53
    v_cvt_pk_bf16_f32 v51, v54, v55
    v_and_b32 v48, -2, v48
    buffer_store_dwordx4 v[48:51], v12, s[16:19], s40 offen offset:256 sc1
    s_add_u32 s8, s4, 0x2100000
    s_addc_u32 s9, s5, 0
    s_mov_b32 s10, 0x8400000
    s_mov_b32 s11, 0x20000
    s_sub_u32 s47, s55, 39583744
    s_lshl_b32 s46, s30, 9
    s_add_u32 s47, s47, s46
    s_add_u32 s45, s92, 2048
    s_cmp_eq_u32 s28, 0
    s_cselect_b32 s45, 1073741824, s45
    s_cmp_eq_u32 s30, 0
    s_cselect_b32 s45, s45, 0
    s_add_u32 s53, s47, 0xfffffff0
    v_add_u32 v126, s53, v12
    v_add_u32 v127, 256, v126
    v_add_u32 v134, s45, v126
    v_cmp_gt_u32 vcc, 1, v22
    s_nop 1
    v_cndmask_b32 v126, v126, v134, vcc
    s_mov_b32 s34, s30
    s_mov_b32 s35, 0
    v_and_b32 v22, 15, v1
    v_lshrrev_b32 v23, 4, v1
    s_mul_i32 s37, s34, 2
    s_mul_i32 s38, s29, 4
    s_mul_i32 s36, s35, 4
    s_add_u32 s38, s38, s36
    s_lshr_b32 s36, s38, 1
    s_lshr_b32 s53, s36, 3
    s_lshl_b32 s53, s53, 14
    s_and_b32 s39, s36, 7
    s_lshl_b32 s39, s39, 10
    s_add_u32 s39, s39, s53
    s_lshl_b32 s36, s37, 16
    s_add_u32 s39, s39, s36
    s_sub_u32 s46, s93, 2048
    s_cmp_eq_u32 s28, 15
    s_cselect_b32 s46, 1073741824, s46
    s_cmp_eq_u32 s30, 3
    s_cselect_b32 s46, s46, 0
    s_add_u32 s53, s47, 0x10
    v_add_u32 v128, s53, v12
    v_add_u32 v129, 256, v128
    v_add_u32 v134, s46, v129
    v_cmp_le_u32 vcc, 15, v22
    s_nop 1
    v_cndmask_b32 v129, v129, v134, vcc
    s_add_u32 s53, s47, 0xffffffe0
    v_add_u32 v130, s53, v12
    v_add_u32 v131, 256, v130
    v_add_u32 v134, s45, v130
    v_cmp_gt_u32 vcc, 2, v22
    s_nop 1
    v_cndmask_b32 v130, v130, v134, vcc
    s_add_u32 s53, s47, 0x20
    v_add_u32 v132, s53, v12
    v_add_u32 v133, 256, v132
    v_add_u32 v134, s46, v133
    v_cmp_le_u32 vcc, 14, v22
    s_nop 1
    v_cndmask_b32 v133, v133, v134, vcc
    v_mov_b32 v134, v126
    v_mov_b32 v135, v127
    v_lshrrev_b32 v6, 2, v1
    v_mul_u32_u24 v13, 128, v6
    v_and_b32 v7, 3, v1
    v_lshl_add_u32 v13, v7, 3, v13
    v_add_u32 v13, 0, v13
    v_bfe_u32 v6, v6, 1, 2
    s_mul_i32 s36, s35, 4
    s_add_u32 s36, s36, 3
    v_xor_b32 v7, s36, v6
    v_lshl_add_u32 v16, v7, 5, v13
    s_mul_i32 s36, s35, 4
    s_add_u32 s36, s36, 2
    v_xor_b32 v7, s36, v6
    v_lshl_add_u32 v15, v7, 5, v13
    s_mul_i32 s36, s35, 4
    s_add_u32 s36, s36, 1
    v_xor_b32 v7, s36, v6
    v_lshl_add_u32 v14, v7, 5, v13
    s_mul_i32 s36, s35, 4
    s_add_u32 s36, s36, 0
    v_xor_b32 v7, s36, v6
    v_lshl_add_u32 v13, v7, 5, v13
    s_lshl_b32 s36, s37, 8
    s_add_u32 s36, s36, 160768
    v_lshlrev_b32 v7, 4, v22
    v_add_u32 v7, s36, v7
    ds_read_b64 v[56:57], v7 offset:0
    ds_read_b64 v[58:59], v7 offset:256
    s_waitcnt vmcnt(4) lgkmcnt(0)
    s_sleep 6
    s_cmp_lg_u32 s60, 0
    s_cbranch_scc1 G2_nd
    s_sleep 2
G2_nd:
    s_mov_b32 s44, 0
    buffer_load_dwordx4 v[164:167], v126, s[8:11], s44 offen sc1
    buffer_load_dwordx4 v[168:171], v127, s[8:11], s44 offen sc1
    s_add_u32 s44, s44, 16384
    buffer_load_dwordx4 v[172:175], v126, s[8:11], s44 offen sc1
    buffer_load_dwordx4 v[176:179], v127, s[8:11], s44 offen sc1
    s_add_u32 s44, s44, 16384
    buffer_load_dwordx4 v[180:183], v126, s[8:11], s44 offen
    buffer_load_dwordx4 v[184:187], v127, s[8:11], s44 offen
    s_add_u32 s44, s44, 16384
    buffer_load_dwordx4 v[188:191], v126, s[8:11], s44 offen
    buffer_load_dwordx4 v[192:195], v127, s[8:11], s44 offen
    s_add_u32 s44, s44, 16384
    v_lshlrev_b32 v24, 16, v148
    v_and_b32 v25, 0xffff0000, v148
    v_pk_add_f32 v[24:25], v[24:25], v[56:57] op_sel_hi:[1,0] neg_lo:[0,1] neg_hi:[0,1]
    v_pk_mul_f32 v[24:25], v[24:25], v[56:57] op_sel:[0,1] op_sel_hi:[1,1]
    v_lshlrev_b32 v26, 16, v149
    v_and_b32 v27, 0xffff0000, v149
    v_pk_add_f32 v[26:27], v[26:27], v[56:57] op_sel_hi:[1,0] neg_lo:[0,1] neg_hi:[0,1]
    v_pk_mul_f32 v[26:27], v[26:27], v[56:57] op_sel:[0,1] op_sel_hi:[1,1]
    v_lshlrev_b32 v28, 16, v150
    v_and_b32 v29, 0xffff0000, v150
    v_pk_add_f32 v[28:29], v[28:29], v[56:57] op_sel_hi:[1,0] neg_lo:[0,1] neg_hi:[0,1]
    v_pk_mul_f32 v[28:29], v[28:29], v[56:57] op_sel:[0,1] op_sel_hi:[1,1]
    v_lshlrev_b32 v30, 16, v151
    v_and_b32 v31, 0xffff0000, v151
    v_pk_add_f32 v[30:31], v[30:31], v[56:57] op_sel_hi:[1,0] neg_lo:[0,1] neg_hi:[0,1]
    v_pk_mul_f32 v[30:31], v[30:31], v[56:57] op_sel:[0,1] op_sel_hi:[1,1]
    v_lshlrev_b32 v32, 16, v152
    v_and_b32 v33, 0xffff0000, v152
    v_pk_add_f32 v[32:33], v[32:33], v[56:57] op_sel_hi:[1,0] neg_lo:[0,1] neg_hi:[0,1]
    v_pk_mul_f32 v[32:33], v[32:33], v[56:57] op_sel:[0,1] op_sel_hi:[1,1]
    v_lshlrev_b32 v34, 16, v153
    v_and_b32 v35, 0xffff0000, v153
    v_pk_add_f32 v[34:35], v[34:35], v[56:57] op_sel_hi:[1,0] neg_lo:[0,1] neg_hi:[0,1]
    v_pk_mul_f32 v[34:35], v[34:35], v[56:57] op_sel:[0,1] op_sel_hi:[1,1]
    v_lshlrev_b32 v36, 16, v154
    v_and_b32 v37, 0xffff0000, v154
    v_pk_add_f32 v[36:37], v[36:37], v[56:57] op_sel_hi:[1,0] neg_lo:[0,1] neg_hi:[0,1]
    v_pk_mul_f32 v[36:37], v[36:37], v[56:57] op_sel:[0,1] op_sel_hi:[1,1]
    v_lshlrev_b32 v38, 16, v155
    v_and_b32 v39, 0xffff0000, v155
    v_pk_add_f32 v[38:39], v[38:39], v[56:57] op_sel_hi:[1,0] neg_lo:[0,1] neg_hi:[0,1]
    v_pk_mul_f32 v[38:39], v[38:39], v[56:57] op_sel:[0,1] op_sel_hi:[1,1]
    v_lshlrev_b32 v40, 16, v156
    v_and_b32 v41, 0xffff0000, v156
    v_pk_add_f32 v[40:41], v[40:41], v[58:59] op_sel_hi:[1,0] neg_lo:[0,1] neg_hi:[0,1]
    v_pk_mul_f32 v[40:41], v[40:41], v[58:59] op_sel:[0,1] op_sel_hi:[1,1]
    v_lshlrev_b32 v42, 16, v157
    v_and_b32 v43, 0xffff0000, v157
    v_pk_add_f32 v[42:43], v[42:43], v[58:59] op_sel_hi:[1,0] neg_lo:[0,1] neg_hi:[0,1]
    v_pk_mul_f32 v[42:43], v[42:43], v[58:59] op_sel:[0,1] op_sel_hi:[1,1]
    v_lshlrev_b32 v44, 16, v158
    v_and_b32 v45, 0xffff0000, v158
    v_pk_add_f32 v[44:45], v[44:45], v[58:59] op_sel_hi:[1,0] neg_lo:[0,1] neg_hi:[0,1]
    v_pk_mul_f32 v[44:45], v[44:45], v[58:59] op_sel:[0,1] op_sel_hi:[1,1]
    v_lshlrev_b32 v46, 16, v159
    v_and_b32 v47, 0xffff0000, v159
    v_pk_add_f32 v[46:47], v[46:47], v[58:59] op_sel_hi:[1,0] neg_lo:[0,1] neg_hi:[0,1]
    v_pk_mul_f32 v[46:47], v[46:47], v[58:59] op_sel:[0,1] op_sel_hi:[1,1]
    v_lshlrev_b32 v48, 16, v160
    v_and_b32 v49, 0xffff0000, v160
    v_pk_add_f32 v[48:49], v[48:49], v[58:59] op_sel_hi:[1,0] neg_lo:[0,1] neg_hi:[0,1]
    v_pk_mul_f32 v[48:49], v[48:49], v[58:59] op_sel:[0,1] op_sel_hi:[1,1]
    v_lshlrev_b32 v50, 16, v161
    v_and_b32 v51, 0xffff0000, v161
    v_pk_add_f32 v[50:51], v[50:51], v[58:59] op_sel_hi:[1,0] neg_lo:[0,1] neg_hi:[0,1]
    v_pk_mul_f32 v[50:51], v[50:51], v[58:59] op_sel:[0,1] op_sel_hi:[1,1]
    v_lshlrev_b32 v52, 16, v162
    v_and_b32 v53, 0xffff0000, v162
    v_pk_add_f32 v[52:53], v[52:53], v[58:59] op_sel_hi:[1,0] neg_lo:[0,1] neg_hi:[0,1]
    v_pk_mul_f32 v[52:53], v[52:53], v[58:59] op_sel:[0,1] op_sel_hi:[1,1]
    v_lshlrev_b32 v54, 16, v163
    v_and_b32 v55, 0xffff0000, v163
    v_pk_add_f32 v[54:55], v[54:55], v[58:59] op_sel_hi:[1,0] neg_lo:[0,1] neg_hi:[0,1]
    v_pk_mul_f32 v[54:55], v[54:55], v[58:59] op_sel:[0,1] op_sel_hi:[1,1]
    s_mov_b32 s43, 0
    s_add_u32 s16, s62, 0x80000
    s_addc_u32 s17, s63, 0
    s_mov_b32 s18, 0x7e000
    s_mov_b32 s19, 0x20000
    s_mov_b32 s53, 0
    s_mov_b32 s49, s44
    s_barrier
    ds_read_b64_tr_b16 v[56:57], v13 offset:0
    ds_read_b64_tr_b16 v[58:59], v13 offset:2048
    ds_read_b64_tr_b16 v[60:61], v14 offset:0
    ds_read_b64_tr_b16 v[62:63], v14 offset:2048
    ds_read_b64_tr_b16 v[64:65], v15 offset:0
    ds_read_b64_tr_b16 v[66:67], v15 offset:2048
    ds_read_b64_tr_b16 v[68:69], v16 offset:0
    ds_read_b64_tr_b16 v[70:71], v16 offset:2048
    ds_read_b64_tr_b16 v[72:73], v13 offset:4096
    ds_read_b64_tr_b16 v[74:75], v13 offset:6144
    ds_read_b64_tr_b16 v[76:77], v14 offset:4096
    ds_read_b64_tr_b16 v[78:79], v14 offset:6144
    ds_read_b64_tr_b16 v[80:81], v15 offset:4096
    ds_read_b64_tr_b16 v[82:83], v15 offset:6144
    ds_read_b64_tr_b16 v[84:85], v16 offset:4096
    ds_read_b64_tr_b16 v[86:87], v16 offset:6144
    s_branch dm_23w
dm_23p:
    s_mov_b32 s44, 0
    buffer_load_dwordx4 v[164:167], v126, s[8:11], s44 offen sc1
    buffer_load_dwordx4 v[168:171], v127, s[8:11], s44 offen sc1
    s_add_u32 s44, s44, 16384
    buffer_load_dwordx4 v[172:175], v126, s[8:11], s44 offen sc1
    buffer_load_dwordx4 v[176:179], v127, s[8:11], s44 offen sc1
    s_add_u32 s44, s44, 16384
    buffer_load_dwordx4 v[180:183], v126, s[8:11], s44 offen
    buffer_load_dwordx4 v[184:187], v127, s[8:11], s44 offen
    s_add_u32 s44, s44, 16384
    buffer_load_dwordx4 v[188:191], v126, s[8:11], s44 offen
    buffer_load_dwordx4 v[192:195], v127, s[8:11], s44 offen
    s_add_u32 s44, s44, 16384
dm_23w:
    s_waitcnt vmcnt(4)
    v_or3_b32 v17, v164, v168, v172
    v_bitop3_b32 v17, v17, v176, 1 bitop3:0xa8
    v_cmp_ne_u32 vcc, 0, v17
    s_cbranch_vccz dm_23q
dm_23r:
    s_sleep 2
    s_mov_b32 s44, 0
    buffer_load_dwordx4 v[164:167], v126, s[8:11], s44 offen sc1
    buffer_load_dwordx4 v[168:171], v127, s[8:11], s44 offen sc1
    s_add_u32 s44, s44, 16384
    buffer_load_dwordx4 v[172:175], v126, s[8:11], s44 offen sc1
    buffer_load_dwordx4 v[176:179], v127, s[8:11], s44 offen sc1
    s_add_u32 s44, s44, 16384
    buffer_load_dwordx4 v[180:183], v126, s[8:11], s44 offen sc1
    buffer_load_dwordx4 v[184:187], v127, s[8:11], s44 offen sc1
    s_add_u32 s44, s44, 16384
    buffer_load_dwordx4 v[188:191], v126, s[8:11], s44 offen sc1
    buffer_load_dwordx4 v[192:195], v127, s[8:11], s44 offen sc1
    s_add_u32 s44, s44, 16384
    s_waitcnt vmcnt(4)
    v_or3_b32 v17, v164, v168, v172
    v_bitop3_b32 v17, v17, v176, 1 bitop3:0xa8
    v_cmp_ne_u32 vcc, 0, v17
    s_cbranch_vccz dm_23t
    s_add_u32 s53, s53, 1
    s_cmp_lt_u32 s53, s61
    s_cbranch_scc1 dm_23r
    s_mov_b32 s61, 0
    s_branch dm_23t
dm_23q:
dm_23t:
    buffer_load_dwordx4 v[196:199], v126, s[8:11], s44 offen
    buffer_load_dwordx4 v[200:203], v127, s[8:11], s44 offen
    s_add_u32 s44, s44, 16384
    buffer_load_dwordx4 v[204:207], v126, s[8:11], s44 offen
    buffer_load_dwordx4 v[208:211], v127, s[8:11], s44 offen
    s_add_u32 s44, s44, 16384
    buffer_load_dwordx4 v[212:215], v126, s[8:11], s44 offen
    buffer_load_dwordx4 v[216:219], v127, s[8:11], s44 offen
    s_add_u32 s44, s44, 16384
    s_waitcnt lgkmcnt(0)
dm_23:
    v_mfma_f32_16x16x32_bf16 v[24:27], v[56:59], v[164:167], v[24:27]
    ds_read_b64_tr_b16 v[88:89], v13 offset:8192
    buffer_load_dwordx4 v[220:223], v126, s[8:11], s44 offen
    v_mfma_f32_16x16x32_bf16 v[40:43], v[56:59], v[168:171], v[40:43]
    ds_read_b64_tr_b16 v[90:91], v13 offset:10240
    buffer_load_dwordx4 v[224:227], v127, s[8:11], s44 offen
    v_mfma_f32_16x16x32_bf16 v[44:47], v[60:63], v[168:171], v[44:47]
    ds_read_b64_tr_b16 v[92:93], v14 offset:8192
    s_add_u32 s44, s44, 16384
    v_mfma_f32_16x16x32_bf16 v[28:31], v[60:63], v[164:167], v[28:31]
    ds_read_b64_tr_b16 v[94:95], v14 offset:10240
    v_mov_b32 v126, v128
    v_mfma_f32_16x16x32_bf16 v[32:35], v[64:67], v[164:167], v[32:35]
    ds_read_b64_tr_b16 v[96:97], v15 offset:8192
    v_mov_b32 v127, v129
    v_mfma_f32_16x16x32_bf16 v[48:51], v[64:67], v[168:171], v[48:51]
    ds_read_b64_tr_b16 v[98:99], v15 offset:10240
    v_mov_b32 v128, v130
    v_mfma_f32_16x16x32_bf16 v[52:55], v[68:71], v[168:171], v[52:55]
    ds_read_b64_tr_b16 v[100:101], v16 offset:8192
    v_mov_b32 v129, v131
    v_mfma_f32_16x16x32_bf16 v[36:39], v[68:71], v[164:167], v[36:39]
    ds_read_b64_tr_b16 v[102:103], v16 offset:10240
    s_waitcnt lgkmcnt(8)
    v_mfma_f32_16x16x32_bf16 v[24:27], v[72:75], v[172:175], v[24:27]
    ds_read_b64_tr_b16 v[104:105], v13 offset:12288
    buffer_load_dwordx4 v[164:167], v126, s[8:11], s44 offen
    v_mfma_f32_16x16x32_bf16 v[40:43], v[72:75], v[176:179], v[40:43]
    ds_read_b64_tr_b16 v[106:107], v13 offset:14336
    buffer_load_dwordx4 v[168:171], v127, s[8:11], s44 offen
    v_mfma_f32_16x16x32_bf16 v[44:47], v[76:79], v[176:179], v[44:47]
    ds_read_b64_tr_b16 v[108:109], v14 offset:12288
    s_add_u32 s44, s44, 16384
    s_waitcnt vmcnt(10)
    v_mfma_f32_16x16x32_bf16 v[28:31], v[76:79], v[172:175], v[28:31]
    ds_read_b64_tr_b16 v[110:111], v14 offset:14336
    v_or3_b32 v17, v180, v184, v188
    v_mfma_f32_16x16x32_bf16 v[32:35], v[80:83], v[172:175], v[32:35]
    ds_read_b64_tr_b16 v[112:113], v15 offset:12288
    v_bitop3_b32 v17, v17, v192, 1 bitop3:0xa8
    v_mfma_f32_16x16x32_bf16 v[48:51], v[80:83], v[176:179], v[48:51]
    ds_read_b64_tr_b16 v[114:115], v15 offset:14336
    v_cmp_ne_u32 vcc, 0, v17
    v_mfma_f32_16x16x32_bf16 v[52:55], v[84:87], v[176:179], v[52:55]
    ds_read_b64_tr_b16 v[116:117], v16 offset:12288
    ds_read_b64_tr_b16 v[118:119], v16 offset:14336
    v_mfma_f32_16x16x32_bf16 v[36:39], v[84:87], v[172:175], v[36:39]
    s_waitcnt lgkmcnt(8)
    s_cbranch_vccnz dm_23f0
dm_23g0:
    v_mfma_f32_16x16x32_bf16 v[24:27], v[88:91], v[180:183], v[24:27]
    ds_read_b64_tr_b16 v[56:57], v13 offset:16384
    buffer_load_dwordx4 v[172:175], v126, s[8:11], s44 offen
    v_mfma_f32_16x16x32_bf16 v[40:43], v[88:91], v[184:187], v[40:43]
    ds_read_b64_tr_b16 v[58:59], v13 offset:18432
    buffer_load_dwordx4 v[176:179], v127, s[8:11], s44 offen
    v_mfma_f32_16x16x32_bf16 v[44:47], v[92:95], v[184:187], v[44:47]
    ds_read_b64_tr_b16 v[60:61], v14 offset:16384
    s_add_u32 s44, s44, 16384
    v_mfma_f32_16x16x32_bf16 v[28:31], v[92:95], v[180:183], v[28:31]
    ds_read_b64_tr_b16 v[62:63], v14 offset:18432
    v_mov_b32 v130, v132
    v_mfma_f32_16x16x32_bf16 v[32:35], v[96:99], v[180:183], v[32:35]
    ds_read_b64_tr_b16 v[64:65], v15 offset:16384
    v_mov_b32 v131, v133
    v_mfma_f32_16x16x32_bf16 v[48:51], v[96:99], v[184:187], v[48:51]
    ds_read_b64_tr_b16 v[66:67], v15 offset:18432
    v_mov_b32 v132, 1073741824
    v_mfma_f32_16x16x32_bf16 v[52:55], v[100:103], v[184:187], v[52:55]
    ds_read_b64_tr_b16 v[68:69], v16 offset:16384
    v_mov_b32 v133, 1073741824
    v_mfma_f32_16x16x32_bf16 v[36:39], v[100:103], v[180:183], v[36:39]
    ds_read_b64_tr_b16 v[70:71], v16 offset:18432
    s_waitcnt lgkmcnt(8)
    v_mfma_f32_16x16x32_bf16 v[24:27], v[104:107], v[188:191], v[24:27]
    ds_read_b64_tr_b16 v[72:73], v13 offset:20480
    buffer_load_dwordx4 v[180:183], v126, s[8:11], s44 offen
    v_mfma_f32_16x16x32_bf16 v[40:43], v[104:107], v[192:195], v[40:43]
    ds_read_b64_tr_b16 v[74:75], v13 offset:22528
    buffer_load_dwordx4 v[184:187], v127, s[8:11], s44 offen
    v_mfma_f32_16x16x32_bf16 v[44:47], v[108:111], v[192:195], v[44:47]
    ds_read_b64_tr_b16 v[76:77], v14 offset:20480
    s_add_u32 s44, s44, 16384
    s_waitcnt vmcnt(10)
    v_mfma_f32_16x16x32_bf16 v[28:31], v[108:111], v[188:191], v[28:31]
    ds_read_b64_tr_b16 v[78:79], v14 offset:22528
    v_or3_b32 v17, v196, v200, v204
    v_mfma_f32_16x16x32_bf16 v[32:35], v[112:115], v[188:191], v[32:35]
    ds_read_b64_tr_b16 v[80:81], v15 offset:20480
    v_bitop3_b32 v17, v17, v208, 1 bitop3:0xa8
    v_mfma_f32_16x16x32_bf16 v[48:51], v[112:115], v[192:195], v[48:51]
    ds_read_b64_tr_b16 v[82:83], v15 offset:22528
    v_cmp_ne_u32 vcc, 0, v17
    v_mfma_f32_16x16x32_bf16 v[52:55], v[116:119], v[192:195], v[52:55]
    ds_read_b64_tr_b16 v[84:85], v16 offset:20480
    ds_read_b64_tr_b16 v[86:87], v16 offset:22528
    v_mfma_f32_16x16x32_bf16 v[36:39], v[116:119], v[188:191], v[36:39]
    s_waitcnt lgkmcnt(8)
    s_cbranch_vccnz dm_23f1
dm_23g1:
    v_mfma_f32_16x16x32_bf16 v[24:27], v[56:59], v[196:199], v[24:27]
    ds_read_b64_tr_b16 v[88:89], v13 offset:24576
    buffer_load_dwordx4 v[188:191], v126, s[8:11], s44 offen
    v_mfma_f32_16x16x32_bf16 v[40:43], v[56:59], v[200:203], v[40:43]
    ds_read_b64_tr_b16 v[90:91], v13 offset:26624
    buffer_load_dwordx4 v[192:195], v127, s[8:11], s44 offen
    v_mfma_f32_16x16x32_bf16 v[44:47], v[60:63], v[200:203], v[44:47]
    ds_read_b64_tr_b16 v[92:93], v14 offset:24576
    s_add_u32 s44, s44, 16384
    v_mfma_f32_16x16x32_bf16 v[28:31], v[60:63], v[196:199], v[28:31]
    ds_read_b64_tr_b16 v[94:95], v14 offset:26624
    v_mfma_f32_16x16x32_bf16 v[32:35], v[64:67], v[196:199], v[32:35]
    ds_read_b64_tr_b16 v[96:97], v15 offset:24576
    s_add_u32 s43, s43, 1
    v_mfma_f32_16x16x32_bf16 v[48:51], v[64:67], v[200:203], v[48:51]
    ds_read_b64_tr_b16 v[98:99], v15 offset:26624
    v_mfma_f32_16x16x32_bf16 v[52:55], v[68:71], v[200:203], v[52:55]
    ds_read_b64_tr_b16 v[100:101], v16 offset:24576
    v_mfma_f32_16x16x32_bf16 v[36:39], v[68:71], v[196:199], v[36:39]
    ds_read_b64_tr_b16 v[102:103], v16 offset:26624
    s_waitcnt lgkmcnt(8)
    v_mfma_f32_16x16x32_bf16 v[24:27], v[72:75], v[204:207], v[24:27]
    ds_read_b64_tr_b16 v[104:105], v13 offset:28672
    buffer_load_dwordx4 v[196:199], v126, s[8:11], s44 offen
    v_mfma_f32_16x16x32_bf16 v[40:43], v[72:75], v[208:211], v[40:43]
    ds_read_b64_tr_b16 v[106:107], v13 offset:30720
    buffer_load_dwordx4 v[200:203], v127, s[8:11], s44 offen
    v_mfma_f32_16x16x32_bf16 v[44:47], v[76:79], v[208:211], v[44:47]
    ds_read_b64_tr_b16 v[108:109], v14 offset:28672
    s_add_u32 s44, s44, 16384
    s_waitcnt vmcnt(10)
    v_mfma_f32_16x16x32_bf16 v[28:31], v[76:79], v[204:207], v[28:31]
    ds_read_b64_tr_b16 v[110:111], v14 offset:30720
    v_add_u32 v13, 32768, v13
    v_or3_b32 v17, v212, v216, v220
    v_mfma_f32_16x16x32_bf16 v[32:35], v[80:83], v[204:207], v[32:35]
    ds_read_b64_tr_b16 v[112:113], v15 offset:28672
    v_add_u32 v14, 32768, v14
    v_bitop3_b32 v17, v17, v224, 1 bitop3:0xa8
    v_mfma_f32_16x16x32_bf16 v[48:51], v[80:83], v[208:211], v[48:51]
    ds_read_b64_tr_b16 v[114:115], v15 offset:30720
    v_add_u32 v15, 32768, v15
    v_cmp_ne_u32 vcc, 0, v17
    v_mfma_f32_16x16x32_bf16 v[52:55], v[84:87], v[208:211], v[52:55]
    ds_read_b64_tr_b16 v[116:117], v16 offset:28672
    ds_read_b64_tr_b16 v[118:119], v16 offset:30720
    s_cmp_eq_u32 s43, 4
    v_mfma_f32_16x16x32_bf16 v[36:39], v[84:87], v[204:207], v[36:39]
    v_add_u32 v16, 32768, v16
    s_waitcnt lgkmcnt(8)
    s_cbranch_vccnz dm_23f2
dm_23g2:
    s_cbranch_scc1 dm_23x
    v_mfma_f32_16x16x32_bf16 v[24:27], v[88:91], v[212:215], v[24:27]
    ds_read_b64_tr_b16 v[56:57], v13 offset:0
    buffer_load_dwordx4 v[204:207], v126, s[8:11], s44 offen
    v_mfma_f32_16x16x32_bf16 v[40:43], v[88:91], v[216:219], v[40:43]
    ds_read_b64_tr_b16 v[58:59], v13 offset:2048
    buffer_load_dwordx4 v[208:211], v127, s[8:11], s44 offen
    v_mfma_f32_16x16x32_bf16 v[44:47], v[92:95], v[216:219], v[44:47]
    ds_read_b64_tr_b16 v[60:61], v14 offset:0
    s_add_u32 s44, s44, 16384
    v_mfma_f32_16x16x32_bf16 v[28:31], v[92:95], v[212:215], v[28:31]
    ds_read_b64_tr_b16 v[62:63], v14 offset:2048
    v_mov_b32 v134, v126
    v_mfma_f32_16x16x32_bf16 v[32:35], v[96:99], v[212:215], v[32:35]
    ds_read_b64_tr_b16 v[64:65], v15 offset:0
    v_mov_b32 v135, v127
    v_mfma_f32_16x16x32_bf16 v[48:51], v[96:99], v[216:219], v[48:51]
    ds_read_b64_tr_b16 v[66:67], v15 offset:2048
    v_mfma_f32_16x16x32_bf16 v[52:55], v[100:103], v[216:219], v[52:55]
    ds_read_b64_tr_b16 v[68:69], v16 offset:0
    v_mfma_f32_16x16x32_bf16 v[36:39], v[100:103], v[212:215], v[36:39]
    ds_read_b64_tr_b16 v[70:71], v16 offset:2048
    s_waitcnt lgkmcnt(8)
    v_mfma_f32_16x16x32_bf16 v[24:27], v[104:107], v[220:223], v[24:27]
    ds_read_b64_tr_b16 v[72:73], v13 offset:4096
    buffer_load_dwordx4 v[212:215], v126, s[8:11], s44 offen
    v_mfma_f32_16x16x32_bf16 v[40:43], v[104:107], v[224:227], v[40:43]
    ds_read_b64_tr_b16 v[74:75], v13 offset:6144
    buffer_load_dwordx4 v[216:219], v127, s[8:11], s44 offen
    v_mfma_f32_16x16x32_bf16 v[44:47], v[108:111], v[224:227], v[44:47]
    ds_read_b64_tr_b16 v[76:77], v14 offset:4096
    s_add_u32 s44, s44, 16384
    s_waitcnt vmcnt(10)
    v_mfma_f32_16x16x32_bf16 v[28:31], v[108:111], v[220:223], v[28:31]
    ds_read_b64_tr_b16 v[78:79], v14 offset:6144
    v_or3_b32 v17, v164, v168, v172
    v_mfma_f32_16x16x32_bf16 v[32:35], v[112:115], v[220:223], v[32:35]
    ds_read_b64_tr_b16 v[80:81], v15 offset:4096
    v_bitop3_b32 v17, v17, v176, 1 bitop3:0xa8
    v_mfma_f32_16x16x32_bf16 v[48:51], v[112:115], v[224:227], v[48:51]
    ds_read_b64_tr_b16 v[82:83], v15 offset:6144
    v_cmp_ne_u32 vcc, 0, v17
    v_mfma_f32_16x16x32_bf16 v[52:55], v[116:119], v[224:227], v[52:55]
    ds_read_b64_tr_b16 v[84:85], v16 offset:4096
    ds_read_b64_tr_b16 v[86:87], v16 offset:6144
    v_mfma_f32_16x16x32_bf16 v[36:39], v[116:119], v[220:223], v[36:39]
    s_waitcnt lgkmcnt(8)
    s_cbranch_vccnz dm_23f3
dm_23g3:
    s_branch dm_23
dm_23f0:
    s_cselect_b32 s50, 1, 0
dm_23h0:
    s_sleep 2
    s_sub_u32 s44, s44, 114688
    buffer_load_dwordx4 v[180:183], v134, s[8:11], s44 offen sc1
    buffer_load_dwordx4 v[184:187], v135, s[8:11], s44 offen sc1
    s_add_u32 s44, s44, 16384
    buffer_load_dwordx4 v[188:191], v134, s[8:11], s44 offen sc1
    buffer_load_dwordx4 v[192:195], v135, s[8:11], s44 offen sc1
    s_add_u32 s44, s44, 16384
    buffer_load_dwordx4 v[196:199], v134, s[8:11], s44 offen sc1
    buffer_load_dwordx4 v[200:203], v135, s[8:11], s44 offen sc1
    s_add_u32 s44, s44, 16384
    buffer_load_dwordx4 v[204:207], v134, s[8:11], s44 offen sc1
    buffer_load_dwordx4 v[208:211], v135, s[8:11], s44 offen sc1
    s_add_u32 s44, s44, 16384
    buffer_load_dwordx4 v[212:215], v134, s[8:11], s44 offen sc1
    buffer_load_dwordx4 v[216:219], v135, s[8:11], s44 offen sc1
    s_add_u32 s44, s44, 16384
    buffer_load_dwordx4 v[220:223], v134, s[8:11], s44 offen sc1
    buffer_load_dwordx4 v[224:227], v135, s[8:11], s44 offen sc1
    s_add_u32 s44, s44, 16384
    buffer_load_dwordx4 v[164:167], v126, s[8:11], s44 offen sc1
    buffer_load_dwordx4 v[168:171], v127, s[8:11], s44 offen sc1
    s_add_u32 s44, s44, 16384
    s_waitcnt vmcnt(10)
    v_or3_b32 v17, v180, v184, v188
    v_bitop3_b32 v17, v17, v192, 1 bitop3:0xa8
    v_cmp_ne_u32 vcc, 0, v17
    s_add_u32 s53, s53, 1
    s_cmp_ge_u32 s53, s61
    s_cselect_b32 s61, 0, s61
    s_cbranch_scc1 dm_23k0
    s_cbranch_vccnz dm_23h0
dm_23k0:
    s_cmp_eq_u32 s50, 1
    s_branch dm_23g0
dm_23f1:
    s_cselect_b32 s50, 1, 0
dm_23h1:
    s_sleep 2
    s_sub_u32 s44, s44, 114688
    buffer_load_dwordx4 v[196:199], v134, s[8:11], s44 offen sc1
    buffer_load_dwordx4 v[200:203], v135, s[8:11], s44 offen sc1
    s_add_u32 s44, s44, 16384
    buffer_load_dwordx4 v[204:207], v134, s[8:11], s44 offen sc1
    buffer_load_dwordx4 v[208:211], v135, s[8:11], s44 offen sc1
    s_add_u32 s44, s44, 16384
    buffer_load_dwordx4 v[212:215], v134, s[8:11], s44 offen sc1
    buffer_load_dwordx4 v[216:219], v135, s[8:11], s44 offen sc1
    s_add_u32 s44, s44, 16384
    buffer_load_dwordx4 v[220:223], v134, s[8:11], s44 offen sc1
    buffer_load_dwordx4 v[224:227], v135, s[8:11], s44 offen sc1
    s_add_u32 s44, s44, 16384
    buffer_load_dwordx4 v[164:167], v126, s[8:11], s44 offen sc1
    buffer_load_dwordx4 v[168:171], v127, s[8:11], s44 offen sc1
    s_add_u32 s44, s44, 16384
    buffer_load_dwordx4 v[172:175], v126, s[8:11], s44 offen sc1
    buffer_load_dwordx4 v[176:179], v127, s[8:11], s44 offen sc1
    s_add_u32 s44, s44, 16384
    buffer_load_dwordx4 v[180:183], v126, s[8:11], s44 offen sc1
    buffer_load_dwordx4 v[184:187], v127, s[8:11], s44 offen sc1
    s_add_u32 s44, s44, 16384
    s_waitcnt vmcnt(10)
    v_or3_b32 v17, v196, v200, v204
    v_bitop3_b32 v17, v17, v208, 1 bitop3:0xa8
    v_cmp_ne_u32 vcc, 0, v17
    s_add_u32 s53, s53, 1
    s_cmp_ge_u32 s53, s61
    s_cselect_b32 s61, 0, s61
    s_cbranch_scc1 dm_23k1
    s_cbranch_vccnz dm_23h1
dm_23k1:
    s_cmp_eq_u32 s50, 1
    s_branch dm_23g1
dm_23f2:
    s_cselect_b32 s50, 1, 0
dm_23h2:
    s_sleep 2
    s_sub_u32 s44, s44, 114688
    buffer_load_dwordx4 v[212:215], v134, s[8:11], s44 offen sc1
    buffer_load_dwordx4 v[216:219], v135, s[8:11], s44 offen sc1
    s_add_u32 s44, s44, 16384
    buffer_load_dwordx4 v[220:223], v134, s[8:11], s44 offen sc1
    buffer_load_dwordx4 v[224:227], v135, s[8:11], s44 offen sc1
    s_add_u32 s44, s44, 16384
    buffer_load_dwordx4 v[164:167], v126, s[8:11], s44 offen sc1
    buffer_load_dwordx4 v[168:171], v127, s[8:11], s44 offen sc1
    s_add_u32 s44, s44, 16384
    buffer_load_dwordx4 v[172:175], v126, s[8:11], s44 offen sc1
    buffer_load_dwordx4 v[176:179], v127, s[8:11], s44 offen sc1
    s_add_u32 s44, s44, 16384
    buffer_load_dwordx4 v[180:183], v126, s[8:11], s44 offen sc1
    buffer_load_dwordx4 v[184:187], v127, s[8:11], s44 offen sc1
    s_add_u32 s44, s44, 16384
    buffer_load_dwordx4 v[188:191], v126, s[8:11], s44 offen sc1
    buffer_load_dwordx4 v[192:195], v127, s[8:11], s44 offen sc1
    s_add_u32 s44, s44, 16384
    buffer_load_dwordx4 v[196:199], v126, s[8:11], s44 offen sc1
    buffer_load_dwordx4 v[200:203], v127, s[8:11], s44 offen sc1
    s_add_u32 s44, s44, 16384
    s_waitcnt vmcnt(10)
    v_or3_b32 v17, v212, v216, v220
    v_bitop3_b32 v17, v17, v224, 1 bitop3:0xa8
    v_cmp_ne_u32 vcc, 0, v17
    s_add_u32 s53, s53, 1
    s_cmp_ge_u32 s53, s61
    s_cselect_b32 s61, 0, s61
    s_cbranch_scc1 dm_23k2
    s_cbranch_vccnz dm_23h2
dm_23k2:
    s_cmp_eq_u32 s50, 1
    s_branch dm_23g2
dm_23f3:
    s_cselect_b32 s50, 1, 0
dm_23h3:
    s_sleep 2
    s_sub_u32 s44, s44, 114688
    buffer_load_dwordx4 v[164:167], v134, s[8:11], s44 offen sc1
    buffer_load_dwordx4 v[168:171], v135, s[8:11], s44 offen sc1
    s_add_u32 s44, s44, 16384
    buffer_load_dwordx4 v[172:175], v134, s[8:11], s44 offen sc1
    buffer_load_dwordx4 v[176:179], v135, s[8:11], s44 offen sc1
    s_add_u32 s44, s44, 16384
    buffer_load_dwordx4 v[180:183], v134, s[8:11], s44 offen sc1
    buffer_load_dwordx4 v[184:187], v135, s[8:11], s44 offen sc1
    s_add_u32 s44, s44, 16384
    buffer_load_dwordx4 v[188:191], v134, s[8:11], s44 offen sc1
    buffer_load_dwordx4 v[192:195], v135, s[8:11], s44 offen sc1
    s_add_u32 s44, s44, 16384
    buffer_load_dwordx4 v[196:199], v134, s[8:11], s44 offen sc1
    buffer_load_dwordx4 v[200:203], v135, s[8:11], s44 offen sc1
    s_add_u32 s44, s44, 16384
    buffer_load_dwordx4 v[204:207], v134, s[8:11], s44 offen sc1
    buffer_load_dwordx4 v[208:211], v135, s[8:11], s44 offen sc1
    s_add_u32 s44, s44, 16384
    buffer_load_dwordx4 v[212:215], v134, s[8:11], s44 offen sc1
    buffer_load_dwordx4 v[216:219], v135, s[8:11], s44 offen sc1
    s_add_u32 s44, s44, 16384
    s_waitcnt vmcnt(10)
    v_or3_b32 v17, v164, v168, v172
    v_bitop3_b32 v17, v17, v176, 1 bitop3:0xa8
    v_cmp_ne_u32 vcc, 0, v17
    s_add_u32 s53, s53, 1
    s_cmp_ge_u32 s53, s61
    s_cselect_b32 s61, 0, s61
    s_cbranch_scc1 dm_23k3
    s_cbranch_vccnz dm_23h3
dm_23k3:
    s_cmp_eq_u32 s50, 1
    s_branch dm_23g3
dm_23x:
    v_mfma_f32_16x16x32_bf16 v[24:27], v[88:91], v[212:215], v[24:27]
    v_mfma_f32_16x16x32_bf16 v[40:43], v[88:91], v[216:219], v[40:43]
    v_mfma_f32_16x16x32_bf16 v[44:47], v[92:95], v[216:219], v[44:47]
    v_mfma_f32_16x16x32_bf16 v[28:31], v[92:95], v[212:215], v[28:31]
    v_mfma_f32_16x16x32_bf16 v[32:35], v[96:99], v[212:215], v[32:35]
    v_mfma_f32_16x16x32_bf16 v[48:51], v[96:99], v[216:219], v[48:51]
    v_mfma_f32_16x16x32_bf16 v[52:55], v[100:103], v[216:219], v[52:55]
    v_mfma_f32_16x16x32_bf16 v[36:39], v[100:103], v[212:215], v[36:39]
    s_waitcnt lgkmcnt(0)
    v_mfma_f32_16x16x32_bf16 v[24:27], v[104:107], v[220:223], v[24:27]
    s_add_u32 s44, s62, 0x5c8000
    v_mfma_f32_16x16x32_bf16 v[40:43], v[104:107], v[224:227], v[40:43]
    s_addc_u32 s45, s63, 0
    v_mfma_f32_16x16x32_bf16 v[44:47], v[108:111], v[224:227], v[44:47]
    v_mfma_f32_16x16x32_bf16 v[28:31], v[108:111], v[220:223], v[28:31]
    s_mov_b32 s46, 0x6000
    v_mfma_f32_16x16x32_bf16 v[32:35], v[112:115], v[220:223], v[32:35]
    v_mfma_f32_16x16x32_bf16 v[48:51], v[112:115], v[224:227], v[48:51]
    s_mov_b32 s47, 0x20000
    v_mfma_f32_16x16x32_bf16 v[52:55], v[116:119], v[224:227], v[52:55]
    v_mfma_f32_16x16x32_bf16 v[36:39], v[116:119], v[220:223], v[36:39]
    s_add_u32 s36, s39, 0
    v_cvt_pk_bf16_f32 v148, v24, v25
    v_cvt_pk_bf16_f32 v149, v26, v27
    v_cvt_pk_bf16_f32 v150, v28, v29
    v_cvt_pk_bf16_f32 v151, v30, v31
    v_and_b32 v148, -2, v148
    buffer_store_dwordx4 v[148:151], v2, s[16:19], s36 offen offset:0 sc1
    v_cvt_pk_bf16_f32 v152, v32, v33
    v_cvt_pk_bf16_f32 v153, v34, v35
    v_cvt_pk_bf16_f32 v154, v36, v37
    v_cvt_pk_bf16_f32 v155, v38, v39
    v_and_b32 v152, -2, v152
    buffer_store_dwordx4 v[152:155], v2, s[16:19], s36 offen offset:1024 sc1
    s_add_u32 s36, s39, 65536
    v_cvt_pk_bf16_f32 v156, v40, v41
    v_cvt_pk_bf16_f32 v157, v42, v43
    v_cvt_pk_bf16_f32 v158, v44, v45
    v_cvt_pk_bf16_f32 v159, v46, v47
    v_and_b32 v156, -2, v156
    buffer_store_dwordx4 v[156:159], v2, s[16:19], s36 offen offset:0 sc1
    v_cvt_pk_bf16_f32 v160, v48, v49
    v_cvt_pk_bf16_f32 v161, v50, v51
    v_cvt_pk_bf16_f32 v162, v52, v53
    v_cvt_pk_bf16_f32 v163, v54, v55
    v_and_b32 v160, -2, v160
    buffer_store_dwordx4 v[160:163], v2, s[16:19], s36 offen offset:1024 sc1
    s_barrier
    s_lshl_b32 s36, s37, 11
    v_add_u32 v7, s36, v2
    ds_write_b128 v7, v[148:151] offset:0
    ds_write_b128 v7, v[152:155] offset:1024
    ds_write_b128 v7, v[156:159] offset:2048
    ds_write_b128 v7, v[160:163] offset:3072
    v_lshlrev_b32 v24, 16, v148
    v_and_b32 v25, 0xffff0000, v148
    v_lshlrev_b32 v26, 16, v149
    v_and_b32 v27, 0xffff0000, v149
    v_lshlrev_b32 v28, 16, v150
    v_and_b32 v29, 0xffff0000, v150
    v_lshlrev_b32 v30, 16, v151
    v_and_b32 v31, 0xffff0000, v151
    v_lshlrev_b32 v32, 16, v152
    v_and_b32 v33, 0xffff0000, v152
    v_lshlrev_b32 v34, 16, v153
    v_and_b32 v35, 0xffff0000, v153
    v_lshlrev_b32 v36, 16, v154
    v_and_b32 v37, 0xffff0000, v154
    v_lshlrev_b32 v38, 16, v155
    v_and_b32 v39, 0xffff0000, v155
    v_lshlrev_b32 v40, 16, v156
    v_and_b32 v41, 0xffff0000, v156
    v_lshlrev_b32 v42, 16, v157
    v_and_b32 v43, 0xffff0000, v157
    v_lshlrev_b32 v44, 16, v158
    v_and_b32 v45, 0xffff0000, v158
    v_lshlrev_b32 v46, 16, v159
    v_and_b32 v47, 0xffff0000, v159
    v_lshlrev_b32 v48, 16, v160
    v_and_b32 v49, 0xffff0000, v160
    v_lshlrev_b32 v50, 16, v161
    v_and_b32 v51, 0xffff0000, v161
    v_lshlrev_b32 v52, 16, v162
    v_and_b32 v53, 0xffff0000, v162
    v_lshlrev_b32 v54, 16, v163
    v_and_b32 v55, 0xffff0000, v163
    s_add_u32 s53, s55, 512
    v_mov_b32 v8, 1
    v_mov_b32 v9, 162816
    v_mov_b32 v11, 0
    s_mov_b64 exec, 1
    s_waitcnt vmcnt(0)
    ds_add_rtn_u32 v10, v9, v8
    s_waitcnt lgkmcnt(0)
    v_readfirstlane_b32 s54, v10
    s_nop 0
    s_and_b32 s54, s54, 3
    s_cmp_lg_u32 s54, 3
    s_cbranch_scc1 pub_24
    buffer_atomic_add v8, v11, s[56:59], s53 offen sc1
    v_mov_b32 v9, 162872
    ds_add_u32 v9, v8
pub_24:
    s_mov_b64 exec, -1
    s_waitcnt lgkmcnt(0)
    s_barrier
    v_pk_add_f32 v[142:143], v[24:25], v[26:27]
    v_pk_mul_f32 v[136:137], v[24:25], v[24:25]
    v_pk_fma_f32 v[136:137], v[26:27], v[26:27], v[136:137]
    v_pk_add_f32 v[142:143], v[142:143], v[28:29]
    v_pk_fma_f32 v[136:137], v[28:29], v[28:29], v[136:137]
    v_pk_add_f32 v[142:143], v[142:143], v[30:31]
    v_pk_fma_f32 v[136:137], v[30:31], v[30:31], v[136:137]
    v_pk_add_f32 v[142:143], v[142:143], v[32:33]
    v_pk_fma_f32 v[136:137], v[32:33], v[32:33], v[136:137]
    v_pk_add_f32 v[142:143], v[142:143], v[34:35]
    v_pk_fma_f32 v[136:137], v[34:35], v[34:35], v[136:137]
    v_pk_add_f32 v[142:143], v[142:143], v[36:37]
    v_pk_fma_f32 v[136:137], v[36:37], v[36:37], v[136:137]
    v_pk_add_f32 v[142:143], v[142:143], v[38:39]
    v_pk_fma_f32 v[136:137], v[38:39], v[38:39], v[136:137]
    v_add_f32 v138, v142, v143
    v_add_f32 v139, v136, v137
    v_mov_b32 v142, v138
    v_mov_b32 v143, v139
    s_nop 0
    v_permlane16_swap_b32 v138, v142
    v_permlane16_swap_b32 v139, v143
    v_pk_add_f32 v[138:139], v[138:139], v[142:143]
    v_mov_b32 v142, v138
    v_mov_b32 v143, v139
    s_nop 0
    v_permlane32_swap_b32 v138, v142
    v_permlane32_swap_b32 v139, v143
    v_pk_add_f32 v[138:139], v[138:139], v[142:143]
    v_pk_add_f32 v[142:143], v[40:41], v[42:43]
    v_pk_mul_f32 v[136:137], v[40:41], v[40:41]
    v_pk_fma_f32 v[136:137], v[42:43], v[42:43], v[136:137]
    v_pk_add_f32 v[142:143], v[142:143], v[44:45]
    v_pk_fma_f32 v[136:137], v[44:45], v[44:45], v[136:137]
    v_pk_add_f32 v[142:143], v[142:143], v[46:47]
    v_pk_fma_f32 v[136:137], v[46:47], v[46:47], v[136:137]
    v_pk_add_f32 v[142:143], v[142:143], v[48:49]
    v_pk_fma_f32 v[136:137], v[48:49], v[48:49], v[136:137]
    v_pk_add_f32 v[142:143], v[142:143], v[50:51]
    v_pk_fma_f32 v[136:137], v[50:51], v[50:51], v[136:137]
    v_pk_add_f32 v[142:143], v[142:143], v[52:53]
    v_pk_fma_f32 v[136:137], v[52:53], v[52:53], v[136:137]
    v_pk_add_f32 v[142:143], v[142:143], v[54:55]
    v_pk_fma_f32 v[136:137], v[54:55], v[54:55], v[136:137]
    v_add_f32 v140, v142, v143
    v_add_f32 v141, v136, v137
    v_mov_b32 v142, v140
    v_mov_b32 v143, v141
    s_nop 0
    v_permlane16_swap_b32 v140, v142
    v_permlane16_swap_b32 v141, v143
    v_pk_add_f32 v[140:141], v[140:141], v[142:143]
    v_mov_b32 v142, v140
    v_mov_b32 v143, v141
    s_nop 0
    v_permlane32_swap_b32 v140, v142
    v_permlane32_swap_b32 v141, v143
    v_pk_add_f32 v[140:141], v[140:141], v[142:143]
    v_cmp_eq_u32 vcc, 0, v23
    s_nop 1
    v_cndmask_b32 v138, v140, v138, vcc
    v_cndmask_b32 v139, v141, v139, vcc
    s_lshr_b32 s53, s29, 3
    s_lshl_b32 s53, s53, 14
    s_and_b32 s40, s29, 7
    s_lshl_b32 s40, s40, 10
    s_add_u32 s40, s40, s53
    s_lshl_b32 s36, s34, 8
    s_add_u32 s40, s40, s36
    v_lshlrev_b32 v7, 3, v1
    s_bfm_b64 exec, 32, 0
    buffer_store_dwordx2 v[138:139], v7, s[44:47], s40 offen sc1
    s_mov_b64 exec, -1
    s_lshr_b32 s34, s30, 1
    s_and_b32 s35, s30, 1
    v_and_b32 v22, 15, v1
    v_lshrrev_b32 v23, 4, v1
    s_mul_i32 s37, s34, 4
    s_mul_i32 s38, s29, 14
    s_mul_i32 s36, s35, 7
    s_add_u32 s38, s38, s36
    s_mul_i32 s36, s34, 8192
    v_add_u32 v12, s36, v2
    v_lshrrev_b32 v6, 2, v1
    v_mul_u32_u24 v13, 448, v6
    v_and_b32 v7, 3, v1
    v_lshl_add_u32 v13, v7, 3, v13
    v_add_u32 v13, 73728, v13
    s_mul_i32 s36, s35, 224
    v_add_u32 v13, s36, v13
    v_bfe_u32 v6, v1, 4, 1
    v_lshlrev_b32 v6, 5, v6
    s_cmp_eq_u32 s35, 0
    s_cselect_b32 s36, 1, -1
    v_mul_lo_u32 v6, v6, s36
    v_sub_u32 v14, v13, v6
    v_add_u32 v13, v13, v6
    v_mov_b32 v17, v12
    s_mov_b32 s42, 0
    s_mov_b32 s43, 0
    s_mov_b32 s48, 57344
    v_add_u32 v18, 57344, v13
    v_add_u32 v19, 57344, v14
    ds_read_b128 v[136:139], v17 offset:0
    ds_read_b128 v[140:143], v17 offset:2048
    ds_read_b128 v[144:147], v17 offset:4096
    ds_read_b128 v[148:151], v17 offset:6144
    ds_read_b64_tr_b16 v[152:153], v18 offset:0
    ds_read_b64_tr_b16 v[154:155], v18 offset:7168
    ds_read_b64_tr_b16 v[156:157], v19 offset:32
    ds_read_b64_tr_b16 v[158:159], v19 offset:7200
    ds_read_b64_tr_b16 v[160:161], v18 offset:64
    ds_read_b64_tr_b16 v[162:163], v18 offset:7232
    ds_read_b64_tr_b16 v[164:165], v19 offset:96
    ds_read_b64_tr_b16 v[166:167], v19 offset:7264
    ds_read_b64_tr_b16 v[168:169], v18 offset:128
    ds_read_b64_tr_b16 v[170:171], v18 offset:7296
    ds_read_b64_tr_b16 v[172:173], v19 offset:160
    ds_read_b64_tr_b16 v[174:175], v19 offset:7328
    ds_read_b64_tr_b16 v[176:177], v18 offset:192
    ds_read_b64_tr_b16 v[178:179], v18 offset:7360
    s_waitcnt lgkmcnt(12)
    v_mfma_f32_16x16x32_bf16 v[24:27], v[152:155], v[136:139], 0
    ds_read_b128 v[180:183], v17 offset:1024
    s_add_u32 s42, s42, 16384
    v_mfma_f32_16x16x32_bf16 v[52:55], v[152:155], v[140:143], 0
    ds_read_b128 v[184:187], v17 offset:3072
    s_cmp_eq_u32 s42, 49152
    v_mfma_f32_16x16x32_bf16 v[80:83], v[152:155], v[144:147], 0
    ds_read_b128 v[188:191], v17 offset:5120
    s_cselect_b32 s42, 0, s42
    v_mfma_f32_16x16x32_bf16 v[108:111], v[152:155], v[148:151], 0
    ds_read_b128 v[192:195], v17 offset:7168
    s_waitcnt lgkmcnt(14)
    v_mfma_f32_16x16x32_bf16 v[112:115], v[156:159], v[148:151], 0
    ds_read_b64_tr_b16 v[196:197], v18 offset:14336
    s_add_u32 s48, s48, 28672
    v_mfma_f32_16x16x32_bf16 v[84:87], v[156:159], v[144:147], 0
    ds_read_b64_tr_b16 v[198:199], v18 offset:21504
    s_cmp_eq_u32 s48, 86016
    v_mfma_f32_16x16x32_bf16 v[56:59], v[156:159], v[140:143], 0
    ds_read_b64_tr_b16 v[200:201], v19 offset:14368
    s_cselect_b32 s48, 0, s48
    v_mfma_f32_16x16x32_bf16 v[28:31], v[156:159], v[136:139], 0
    ds_read_b64_tr_b16 v[202:203], v19 offset:21536
    s_waitcnt lgkmcnt(8)
    v_mfma_f32_16x16x32_bf16 v[32:35], v[160:163], v[136:139], 0
    ds_read_b64_tr_b16 v[204:205], v18 offset:14400
    v_add_u32 v17, s42, v12
    v_mfma_f32_16x16x32_bf16 v[60:63], v[160:163], v[140:143], 0
    ds_read_b64_tr_b16 v[206:207], v18 offset:21568
    v_mfma_f32_16x16x32_bf16 v[88:91], v[160:163], v[144:147], 0
    ds_read_b64_tr_b16 v[208:209], v19 offset:14432
    v_mfma_f32_16x16x32_bf16 v[116:119], v[160:163], v[148:151], 0
    ds_read_b64_tr_b16 v[210:211], v19 offset:21600
    v_mfma_f32_16x16x32_bf16 v[120:123], v[164:167], v[148:151], 0
    ds_read_b64_tr_b16 v[212:213], v18 offset:14464
    v_mfma_f32_16x16x32_bf16 v[92:95], v[164:167], v[144:147], 0
    ds_read_b64_tr_b16 v[214:215], v18 offset:21632
    v_mfma_f32_16x16x32_bf16 v[64:67], v[164:167], v[140:143], 0
    ds_read_b64_tr_b16 v[216:217], v19 offset:14496
    v_mfma_f32_16x16x32_bf16 v[36:39], v[164:167], v[136:139], 0
    ds_read_b64_tr_b16 v[218:219], v19 offset:21664
    v_add_u32 v19, s48, v14
    v_mfma_f32_16x16x32_bf16 v[40:43], v[168:171], v[136:139], 0
    ds_read_b64_tr_b16 v[220:221], v18 offset:14528
    v_mfma_f32_16x16x32_bf16 v[68:71], v[168:171], v[140:143], 0
    ds_read_b64_tr_b16 v[222:223], v18 offset:21696
    v_add_u32 v18, s48, v13
    v_mfma_f32_16x16x32_bf16 v[96:99], v[168:171], v[144:147], 0
    v_mfma_f32_16x16x32_bf16 v[124:127], v[168:171], v[148:151], 0
    v_mfma_f32_16x16x32_bf16 v[128:131], v[172:175], v[148:151], 0
    v_mfma_f32_16x16x32_bf16 v[100:103], v[172:175], v[144:147], 0
    v_mfma_f32_16x16x32_bf16 v[72:75], v[172:175], v[140:143], 0
    v_mfma_f32_16x16x32_bf16 v[44:47], v[172:175], v[136:139], 0
    v_mfma_f32_16x16x32_bf16 v[48:51], v[176:179], v[136:139], 0
    v_mfma_f32_16x16x32_bf16 v[76:79], v[176:179], v[140:143], 0
    v_mfma_f32_16x16x32_bf16 v[104:107], v[176:179], v[144:147], 0
    v_mfma_f32_16x16x32_bf16 v[132:135], v[176:179], v[148:151], 0
    s_waitcnt lgkmcnt(12)
    v_mfma_f32_16x16x32_bf16 v[24:27], v[196:199], v[180:183], v[24:27]
    s_add_u32 s43, s43, 1
    s_mul_i32 s36, s35, 448
    s_add_u32 s36, s36, 159744
    v_lshlrev_b32 v6, 4, v23
    v_mfma_f32_16x16x32_bf16 v[52:55], v[196:199], v[184:187], v[52:55]
    v_add_u32 v6, s36, v6
    s_lshl_b32 s36, s37, 8
    s_add_u32 s36, s36, 160768
    v_lshlrev_b32 v7, 4, v22
    v_mfma_f32_16x16x32_bf16 v[80:83], v[196:199], v[188:191], v[80:83]
    v_add_u32 v7, s36, v7
    s_add_u32 s16, s62, 0x400000
    s_addc_u32 s17, s63, 0
    s_mov_b32 s18, 0x1be000
    v_mfma_f32_16x16x32_bf16 v[108:111], v[196:199], v[192:195], v[108:111]
    s_mov_b32 s19, 0x20000
    s_mul_i32 s39, s37, 229376
    s_lshr_b32 s36, s38, 1
    s_waitcnt lgkmcnt(0)
    v_mfma_f32_16x16x32_bf16 v[112:115], v[200:203], v[192:195], v[112:115]
    s_add_u32 s36, s36, 0
    s_lshr_b32 s53, s36, 3
    s_lshl_b32 s53, s53, 14
    s_and_b32 s44, s36, 7
    v_mfma_f32_16x16x32_bf16 v[84:87], v[200:203], v[188:191], v[84:87]
    s_lshl_b32 s44, s44, 10
    s_add_u32 s44, s44, s53
    s_add_u32 s44, s44, s39
    s_lshr_b32 s36, s38, 1
    v_mfma_f32_16x16x32_bf16 v[56:59], v[200:203], v[184:187], v[56:59]
    s_add_u32 s36, s36, 1
    s_lshr_b32 s53, s36, 3
    s_lshl_b32 s53, s53, 14
    s_and_b32 s45, s36, 7
    v_mfma_f32_16x16x32_bf16 v[28:31], v[200:203], v[180:183], v[28:31]
    s_lshl_b32 s45, s45, 10
    s_add_u32 s45, s45, s53
    s_add_u32 s45, s45, s39
    s_lshr_b32 s36, s38, 1
    v_mfma_f32_16x16x32_bf16 v[32:35], v[204:207], v[180:183], v[32:35]
    s_add_u32 s36, s36, 2
    s_lshr_b32 s53, s36, 3
    s_lshl_b32 s53, s53, 14
    s_and_b32 s46, s36, 7
    v_mfma_f32_16x16x32_bf16 v[60:63], v[204:207], v[184:187], v[60:63]
    s_lshl_b32 s46, s46, 10
    s_add_u32 s46, s46, s53
    s_add_u32 s46, s46, s39
    s_lshr_b32 s36, s38, 1
    v_mfma_f32_16x16x32_bf16 v[88:91], v[204:207], v[188:191], v[88:91]
    s_add_u32 s36, s36, 3
    s_lshr_b32 s53, s36, 3
    s_lshl_b32 s53, s53, 14
    s_and_b32 s47, s36, 7
    v_mfma_f32_16x16x32_bf16 v[116:119], v[204:207], v[192:195], v[116:119]
    s_lshl_b32 s47, s47, 10
    s_add_u32 s47, s47, s53
    s_add_u32 s47, s47, s39
    v_lshrrev_b32 v226, 2, v1
    v_mfma_f32_16x16x32_bf16 v[120:123], v[208:211], v[192:195], v[120:123]
    v_mul_u32_u24 v240, 256, v226
    v_and_b32 v227, 3, v1
    v_lshl_add_u32 v240, v227, 3, v240
    v_add_u32 v240, 49152, v240
    v_mfma_f32_16x16x32_bf16 v[92:95], v[208:211], v[188:191], v[92:95]
    v_and_b32 v226, 7, v226
    s_mul_i32 s36, s35, 4
    s_add_u32 s36, s36, 3
    v_xor_b32 v227, s36, v226
    v_mfma_f32_16x16x32_bf16 v[64:67], v[208:211], v[184:187], v[64:67]
    v_lshl_add_u32 v243, v227, 5, v240
    s_mul_i32 s36, s35, 4
    s_add_u32 s36, s36, 2
    v_xor_b32 v227, s36, v226
    v_mfma_f32_16x16x32_bf16 v[36:39], v[208:211], v[180:183], v[36:39]
    v_lshl_add_u32 v242, v227, 5, v240
    s_mul_i32 s36, s35, 4
    s_add_u32 s36, s36, 1
    v_xor_b32 v227, s36, v226
    v_mfma_f32_16x16x32_bf16 v[40:43], v[212:215], v[180:183], v[40:43]
    v_lshl_add_u32 v241, v227, 5, v240
    s_mul_i32 s36, s35, 4
    s_add_u32 s36, s36, 0
    v_xor_b32 v227, s36, v226
    v_mfma_f32_16x16x32_bf16 v[68:71], v[212:215], v[184:187], v[68:71]
    v_lshl_add_u32 v240, v227, 5, v240
    s_lshl_b32 s38, s33, 3
    s_lshl_b32 s36, s35, 2
    s_add_u32 s38, s38, s36
    v_mfma_f32_16x16x32_bf16 v[96:99], v[212:215], v[188:191], v[96:99]
    s_lshr_b32 s36, s38, 1
    s_lshr_b32 s53, s36, 3
    s_lshl_b32 s53, s53, 14
    s_and_b32 s39, s36, 7
    v_mfma_f32_16x16x32_bf16 v[124:127], v[212:215], v[192:195], v[124:127]
    s_lshl_b32 s39, s39, 10
    s_add_u32 s39, s39, s53
    s_lshl_b32 s36, s37, 16
    s_add_u32 s39, s39, s36
    v_mfma_f32_16x16x32_bf16 v[128:131], v[216:219], v[192:195], v[128:131]
    s_lshl_b32 s40, s31, 17
    s_add_u32 s40, s40, s39
    s_xor_b32 s41, s31, 1
    s_lshl_b32 s41, s41, 17
    v_mfma_f32_16x16x32_bf16 v[100:103], v[216:219], v[188:191], v[100:103]
    s_add_u32 s41, s41, s39
    s_mov_b32 s84, s62
    s_mov_b32 s85, s63
    s_mov_b32 s86, 0x7e000
    v_mfma_f32_16x16x32_bf16 v[72:75], v[216:219], v[184:187], v[72:75]
    s_mov_b32 s87, 0x20000
    s_add_u32 s88, s62, 0x80000
    s_addc_u32 s89, s63, 0
    s_mov_b32 s90, 0x7e000
    v_mfma_f32_16x16x32_bf16 v[44:47], v[216:219], v[180:183], v[44:47]
    s_mov_b32 s91, 0x20000
    s_lshl_b32 s36, s37, 1
    s_add_u32 s36, s36, s35
    s_lshl_b32 s36, s36, 10
    v_mfma_f32_16x16x32_bf16 v[48:51], v[220:223], v[180:183], v[48:51]
    v_add_u32 v244, s36, v2
    v_mov_b32 v245, 1
    v_mov_b32 v246, 162880
    v_lshrrev_b32 v238, 1, v23
    v_mfma_f32_16x16x32_bf16 v[76:79], v[220:223], v[184:187], v[76:79]
    v_lshlrev_b32 v238, 8, v238
    v_lshl_add_u32 v238, v22, 4, v238
    v_and_b32 v224, 1, v23
    v_lshl_add_u32 v238, v224, 3, v238
    v_mfma_f32_16x16x32_bf16 v[104:107], v[220:223], v[188:191], v[104:107]
    v_mfma_f32_16x16x32_bf16 v[132:135], v[220:223], v[192:195], v[132:135]
    s_add_u32 s53, s55, 1408
    v_mov_b32 v8, 1
    v_mov_b32 v9, 162864
    v_mov_b32 v11, 0
    s_mov_b64 exec, 1
    s_waitcnt vmcnt(0)
    ds_add_rtn_u32 v10, v9, v8
    s_waitcnt lgkmcnt(0)
    v_readfirstlane_b32 s54, v10
    s_nop 0
    s_and_b32 s54, s54, 3
    s_cmp_lg_u32 s54, 3
    s_cbranch_scc1 pub_25
    buffer_atomic_add v8, v11, s[56:59], s53 offen sc1
pub_25:
    s_mov_b64 exec, -1
    s_barrier
    ds_read_b128 v[136:139], v17 offset:0
    ds_read_b128 v[140:143], v17 offset:2048
    ds_read_b128 v[144:147], v17 offset:4096
    ds_read_b128 v[148:151], v17 offset:6144
    ds_read_b64_tr_b16 v[152:153], v18 offset:0
    ds_read_b64_tr_b16 v[154:155], v18 offset:7168
    ds_read_b64_tr_b16 v[156:157], v19 offset:32
    ds_read_b64_tr_b16 v[158:159], v19 offset:7200
    ds_read_b64_tr_b16 v[160:161], v18 offset:64
    ds_read_b64_tr_b16 v[162:163], v18 offset:7232
    ds_read_b64_tr_b16 v[164:165], v19 offset:96
    ds_read_b64_tr_b16 v[166:167], v19 offset:7264
    ds_read_b64_tr_b16 v[168:169], v18 offset:128
    ds_read_b64_tr_b16 v[170:171], v18 offset:7296
    ds_read_b64_tr_b16 v[172:173], v19 offset:160
    ds_read_b64_tr_b16 v[174:175], v19 offset:7328
    ds_read_b64_tr_b16 v[176:177], v18 offset:192
    ds_read_b64_tr_b16 v[178:179], v18 offset:7360
    s_waitcnt lgkmcnt(12)
mm_26:
    v_mfma_f32_16x16x32_bf16 v[24:27], v[152:155], v[136:139], v[24:27]
    ds_read_b128 v[180:183], v17 offset:1024
    s_add_u32 s42, s42, 16384
    v_mfma_f32_16x16x32_bf16 v[52:55], v[152:155], v[140:143], v[52:55]
    ds_read_b128 v[184:187], v17 offset:3072
    s_cmp_eq_u32 s42, 49152
    v_mfma_f32_16x16x32_bf16 v[80:83], v[152:155], v[144:147], v[80:83]
    ds_read_b128 v[188:191], v17 offset:5120
    s_cselect_b32 s42, 0, s42
    v_mfma_f32_16x16x32_bf16 v[108:111], v[152:155], v[148:151], v[108:111]
    ds_read_b128 v[192:195], v17 offset:7168
    s_waitcnt lgkmcnt(14)
    v_mfma_f32_16x16x32_bf16 v[112:115], v[156:159], v[148:151], v[112:115]
    ds_read_b64_tr_b16 v[196:197], v18 offset:14336
    s_add_u32 s48, s48, 28672
    v_mfma_f32_16x16x32_bf16 v[84:87], v[156:159], v[144:147], v[84:87]
    ds_read_b64_tr_b16 v[198:199], v18 offset:21504
    s_cmp_eq_u32 s48, 86016
    v_mfma_f32_16x16x32_bf16 v[56:59], v[156:159], v[140:143], v[56:59]
    ds_read_b64_tr_b16 v[200:201], v19 offset:14368
    s_cselect_b32 s48, 0, s48
    v_mfma_f32_16x16x32_bf16 v[28:31], v[156:159], v[136:139], v[28:31]
    ds_read_b64_tr_b16 v[202:203], v19 offset:21536
    s_waitcnt lgkmcnt(8)
    v_mfma_f32_16x16x32_bf16 v[32:35], v[160:163], v[136:139], v[32:35]
    ds_read_b64_tr_b16 v[204:205], v18 offset:14400
    v_add_u32 v17, s42, v12
    v_mfma_f32_16x16x32_bf16 v[60:63], v[160:163], v[140:143], v[60:63]
    ds_read_b64_tr_b16 v[206:207], v18 offset:21568
    v_mfma_f32_16x16x32_bf16 v[88:91], v[160:163], v[144:147], v[88:91]
    ds_read_b64_tr_b16 v[208:209], v19 offset:14432
    v_mfma_f32_16x16x32_bf16 v[116:119], v[160:163], v[148:151], v[116:119]
    ds_read_b64_tr_b16 v[210:211], v19 offset:21600
    v_mfma_f32_16x16x32_bf16 v[120:123], v[164:167], v[148:151], v[120:123]
    ds_read_b64_tr_b16 v[212:213], v18 offset:14464
    v_mfma_f32_16x16x32_bf16 v[92:95], v[164:167], v[144:147], v[92:95]
    ds_read_b64_tr_b16 v[214:215], v18 offset:21632
    v_mfma_f32_16x16x32_bf16 v[64:67], v[164:167], v[140:143], v[64:67]
    ds_read_b64_tr_b16 v[216:217], v19 offset:14496
    v_mfma_f32_16x16x32_bf16 v[36:39], v[164:167], v[136:139], v[36:39]
    ds_read_b64_tr_b16 v[218:219], v19 offset:21664
    v_add_u32 v19, s48, v14
    v_mfma_f32_16x16x32_bf16 v[40:43], v[168:171], v[136:139], v[40:43]
    ds_read_b64_tr_b16 v[220:221], v18 offset:14528
    v_mfma_f32_16x16x32_bf16 v[68:71], v[168:171], v[140:143], v[68:71]
    ds_read_b64_tr_b16 v[222:223], v18 offset:21696
    v_add_u32 v18, s48, v13
    v_mfma_f32_16x16x32_bf16 v[96:99], v[168:171], v[144:147], v[96:99]
    v_mfma_f32_16x16x32_bf16 v[124:127], v[168:171], v[148:151], v[124:127]
    v_mfma_f32_16x16x32_bf16 v[128:131], v[172:175], v[148:151], v[128:131]
    v_mfma_f32_16x16x32_bf16 v[100:103], v[172:175], v[144:147], v[100:103]
    v_mfma_f32_16x16x32_bf16 v[72:75], v[172:175], v[140:143], v[72:75]
    v_mfma_f32_16x16x32_bf16 v[44:47], v[172:175], v[136:139], v[44:47]
    v_mfma_f32_16x16x32_bf16 v[48:51], v[176:179], v[136:139], v[48:51]
    v_mfma_f32_16x16x32_bf16 v[76:79], v[176:179], v[140:143], v[76:79]
    v_mfma_f32_16x16x32_bf16 v[104:107], v[176:179], v[144:147], v[104:107]
    v_mfma_f32_16x16x32_bf16 v[132:135], v[176:179], v[148:151], v[132:135]
    s_waitcnt lgkmcnt(12)
    v_mfma_f32_16x16x32_bf16 v[24:27], v[196:199], v[180:183], v[24:27]
    s_add_u32 s43, s43, 1
    s_cmp_lt_u32 s43, 15
    v_mfma_f32_16x16x32_bf16 v[52:55], v[196:199], v[184:187], v[52:55]
    v_mfma_f32_16x16x32_bf16 v[80:83], v[196:199], v[188:191], v[80:83]
    v_mfma_f32_16x16x32_bf16 v[108:111], v[196:199], v[192:195], v[108:111]
    s_waitcnt lgkmcnt(0)
    s_barrier
    v_mfma_f32_16x16x32_bf16 v[112:115], v[200:203], v[192:195], v[112:115]
    ds_read_b128 v[136:139], v17 offset:0
    v_mfma_f32_16x16x32_bf16 v[84:87], v[200:203], v[188:191], v[84:87]
    ds_read_b128 v[140:143], v17 offset:2048
    v_mfma_f32_16x16x32_bf16 v[56:59], v[200:203], v[184:187], v[56:59]
    ds_read_b128 v[144:147], v17 offset:4096
    v_mfma_f32_16x16x32_bf16 v[28:31], v[200:203], v[180:183], v[28:31]
    ds_read_b128 v[148:151], v17 offset:6144
    v_mfma_f32_16x16x32_bf16 v[32:35], v[204:207], v[180:183], v[32:35]
    ds_read_b64_tr_b16 v[152:153], v18 offset:0
    v_mfma_f32_16x16x32_bf16 v[60:63], v[204:207], v[184:187], v[60:63]
    ds_read_b64_tr_b16 v[154:155], v18 offset:7168
    v_mfma_f32_16x16x32_bf16 v[88:91], v[204:207], v[188:191], v[88:91]
    ds_read_b64_tr_b16 v[156:157], v19 offset:32
    v_mfma_f32_16x16x32_bf16 v[116:119], v[204:207], v[192:195], v[116:119]
    ds_read_b64_tr_b16 v[158:159], v19 offset:7200
    v_mfma_f32_16x16x32_bf16 v[120:123], v[208:211], v[192:195], v[120:123]
    ds_read_b64_tr_b16 v[160:161], v18 offset:64
    v_mfma_f32_16x16x32_bf16 v[92:95], v[208:211], v[188:191], v[92:95]
    ds_read_b64_tr_b16 v[162:163], v18 offset:7232
    v_mfma_f32_16x16x32_bf16 v[64:67], v[208:211], v[184:187], v[64:67]
    ds_read_b64_tr_b16 v[164:165], v19 offset:96
    v_mfma_f32_16x16x32_bf16 v[36:39], v[208:211], v[180:183], v[36:39]
    ds_read_b64_tr_b16 v[166:167], v19 offset:7264
    v_mfma_f32_16x16x32_bf16 v[40:43], v[212:215], v[180:183], v[40:43]
    ds_read_b64_tr_b16 v[168:169], v18 offset:128
    v_mfma_f32_16x16x32_bf16 v[68:71], v[212:215], v[184:187], v[68:71]
    ds_read_b64_tr_b16 v[170:171], v18 offset:7296
    v_mfma_f32_16x16x32_bf16 v[96:99], v[212:215], v[188:191], v[96:99]
    ds_read_b64_tr_b16 v[172:173], v19 offset:160
    v_mfma_f32_16x16x32_bf16 v[124:127], v[212:215], v[192:195], v[124:127]
    ds_read_b64_tr_b16 v[174:175], v19 offset:7328
    v_mfma_f32_16x16x32_bf16 v[128:131], v[216:219], v[192:195], v[128:131]
    ds_read_b64_tr_b16 v[176:177], v18 offset:192
    v_mfma_f32_16x16x32_bf16 v[100:103], v[216:219], v[188:191], v[100:103]
    ds_read_b64_tr_b16 v[178:179], v18 offset:7360
    v_mfma_f32_16x16x32_bf16 v[72:75], v[216:219], v[184:187], v[72:75]
    v_mfma_f32_16x16x32_bf16 v[44:47], v[216:219], v[180:183], v[44:47]
    v_mfma_f32_16x16x32_bf16 v[48:51], v[220:223], v[180:183], v[48:51]
    v_mfma_f32_16x16x32_bf16 v[76:79], v[220:223], v[184:187], v[76:79]
    v_mfma_f32_16x16x32_bf16 v[104:107], v[220:223], v[188:191], v[104:107]
    v_mfma_f32_16x16x32_bf16 v[132:135], v[220:223], v[192:195], v[132:135]
    s_waitcnt lgkmcnt(12)
    s_cbranch_scc1 mm_26
    v_mfma_f32_16x16x32_bf16 v[24:27], v[152:155], v[136:139], v[24:27]
    ds_read_b128 v[180:183], v17 offset:1024
    v_mfma_f32_16x16x32_bf16 v[52:55], v[152:155], v[140:143], v[52:55]
    ds_read_b128 v[184:187], v17 offset:3072
    v_mfma_f32_16x16x32_bf16 v[80:83], v[152:155], v[144:147], v[80:83]
    ds_read_b128 v[188:191], v17 offset:5120
    v_mfma_f32_16x16x32_bf16 v[108:111], v[152:155], v[148:151], v[108:111]
    ds_read_b128 v[192:195], v17 offset:7168
    s_waitcnt lgkmcnt(14)
    v_mfma_f32_16x16x32_bf16 v[112:115], v[156:159], v[148:151], v[112:115]
    ds_read_b64_tr_b16 v[196:197], v18 offset:14336
    v_mfma_f32_16x16x32_bf16 v[84:87], v[156:159], v[144:147], v[84:87]
    ds_read_b64_tr_b16 v[198:199], v18 offset:21504
    v_mfma_f32_16x16x32_bf16 v[56:59], v[156:159], v[140:143], v[56:59]
    ds_read_b64_tr_b16 v[200:201], v19 offset:14368
    v_mfma_f32_16x16x32_bf16 v[28:31], v[156:159], v[136:139], v[28:31]
    ds_read_b64_tr_b16 v[202:203], v19 offset:21536
    s_waitcnt lgkmcnt(8)
    v_mfma_f32_16x16x32_bf16 v[32:35], v[160:163], v[136:139], v[32:35]
    ds_read_b64_tr_b16 v[204:205], v18 offset:14400
    v_mfma_f32_16x16x32_bf16 v[60:63], v[160:163], v[140:143], v[60:63]
    ds_read_b64_tr_b16 v[206:207], v18 offset:21568
    v_mfma_f32_16x16x32_bf16 v[88:91], v[160:163], v[144:147], v[88:91]
    ds_read_b64_tr_b16 v[208:209], v19 offset:14432
    v_mfma_f32_16x16x32_bf16 v[116:119], v[160:163], v[148:151], v[116:119]
    ds_read_b64_tr_b16 v[210:211], v19 offset:21600
    v_mfma_f32_16x16x32_bf16 v[120:123], v[164:167], v[148:151], v[120:123]
    ds_read_b64_tr_b16 v[212:213], v18 offset:14464
    v_mfma_f32_16x16x32_bf16 v[92:95], v[164:167], v[144:147], v[92:95]
    ds_read_b64_tr_b16 v[214:215], v18 offset:21632
    v_mfma_f32_16x16x32_bf16 v[64:67], v[164:167], v[140:143], v[64:67]
    ds_read_b64_tr_b16 v[216:217], v19 offset:14496
    v_mfma_f32_16x16x32_bf16 v[36:39], v[164:167], v[136:139], v[36:39]
    ds_read_b64_tr_b16 v[218:219], v19 offset:21664
    v_mfma_f32_16x16x32_bf16 v[40:43], v[168:171], v[136:139], v[40:43]
    ds_read_b64_tr_b16 v[220:221], v18 offset:14528
    v_mfma_f32_16x16x32_bf16 v[68:71], v[168:171], v[140:143], v[68:71]
    ds_read_b64_tr_b16 v[222:223], v18 offset:21696
    v_mfma_f32_16x16x32_bf16 v[96:99], v[168:171], v[144:147], v[96:99]
    v_mfma_f32_16x16x32_bf16 v[124:127], v[168:171], v[148:151], v[124:127]
    v_mfma_f32_16x16x32_bf16 v[128:131], v[172:175], v[148:151], v[128:131]
    v_mfma_f32_16x16x32_bf16 v[100:103], v[172:175], v[144:147], v[100:103]
    v_mfma_f32_16x16x32_bf16 v[72:75], v[172:175], v[140:143], v[72:75]
    v_mfma_f32_16x16x32_bf16 v[44:47], v[172:175], v[136:139], v[44:47]
    v_mfma_f32_16x16x32_bf16 v[48:51], v[176:179], v[136:139], v[48:51]
    v_mfma_f32_16x16x32_bf16 v[76:79], v[176:179], v[140:143], v[76:79]
    v_mfma_f32_16x16x32_bf16 v[104:107], v[176:179], v[144:147], v[104:107]
    v_mfma_f32_16x16x32_bf16 v[132:135], v[176:179], v[148:151], v[132:135]
    s_waitcnt lgkmcnt(0)
    s_barrier
    v_mfma_f32_16x16x32_bf16 v[24:27], v[196:199], v[180:183], v[24:27]
    ds_read_b128 v[136:139], v6 offset:0
    v_mfma_f32_16x16x32_bf16 v[52:55], v[196:199], v[184:187], v[52:55]
    ds_read_b128 v[140:143], v6 offset:64
    v_mfma_f32_16x16x32_bf16 v[80:83], v[196:199], v[188:191], v[80:83]
    ds_read_b128 v[144:147], v6 offset:128
    v_mfma_f32_16x16x32_bf16 v[108:111], v[196:199], v[192:195], v[108:111]
    ds_read_b128 v[148:151], v6 offset:192
    v_mfma_f32_16x16x32_bf16 v[112:115], v[200:203], v[192:195], v[112:115]
    ds_read_b128 v[152:155], v6 offset:256
    v_mfma_f32_16x16x32_bf16 v[84:87], v[200:203], v[188:191], v[84:87]
    ds_read_b128 v[156:159], v6 offset:320
    v_mfma_f32_16x16x32_bf16 v[56:59], v[200:203], v[184:187], v[56:59]
    ds_read_b128 v[160:163], v6 offset:384
    v_mfma_f32_16x16x32_bf16 v[28:31], v[200:203], v[180:183], v[28:31]
    ds_read_b128 v[164:167], v7 offset:0
    v_mfma_f32_16x16x32_bf16 v[32:35], v[204:207], v[180:183], v[32:35]
    ds_read_b128 v[168:171], v7 offset:256
    v_mfma_f32_16x16x32_bf16 v[60:63], v[204:207], v[184:187], v[60:63]
    ds_read_b128 v[172:175], v7 offset:512
    v_mfma_f32_16x16x32_bf16 v[88:91], v[204:207], v[188:191], v[88:91]
    ds_read_b128 v[176:179], v7 offset:768
    v_mov_b32 v13, v240
    v_mfma_f32_16x16x32_bf16 v[116:119], v[204:207], v[192:195], v[116:119]
    v_add_u32 v18, 0, v240
    v_mov_b32 v14, v241
    v_mfma_f32_16x16x32_bf16 v[120:123], v[208:211], v[192:195], v[120:123]
    v_add_u32 v19, 0, v241
    v_mov_b32 v15, v242
    v_mfma_f32_16x16x32_bf16 v[92:95], v[208:211], v[188:191], v[92:95]
    v_add_u32 v20, 0, v242
    v_mov_b32 v16, v243
    v_mfma_f32_16x16x32_bf16 v[64:67], v[208:211], v[184:187], v[64:67]
    v_add_u32 v21, 0, v243
    s_mov_b32 s42, 0
    s_mov_b32 s43, 0
    v_mfma_f32_16x16x32_bf16 v[36:39], v[208:211], v[180:183], v[36:39]
    s_mov_b32 s48, 0
    v_mov_b32 v17, v12
    v_and_b32 v199, 7, v0
    v_mfma_f32_16x16x32_bf16 v[40:43], v[212:215], v[180:183], v[40:43]
    v_lshrrev_b32 v228, 6, v0
    v_lshlrev_b32 v228, 4, v228
    v_mfma_f32_16x16x32_bf16 v[68:71], v[212:215], v[184:187], v[68:71]
    v_bfe_u32 v229, v0, 3, 3
    v_add_u32 v228, v228, v229
    s_lshr_b32 s78, s29, 1
    v_mfma_f32_16x16x32_bf16 v[96:99], v[212:215], v[188:191], v[96:99]
    s_lshl_b32 s78, s78, 16
    s_and_b32 s79, s29, 1
    s_lshl_b32 s79, s79, 7
    v_mfma_f32_16x16x32_bf16 v[124:127], v[212:215], v[192:195], v[124:127]
    s_add_u32 s78, s78, s79
    s_lshr_b32 s79, s30, 1
    s_lshl_b32 s79, s79, 13
    v_mfma_f32_16x16x32_bf16 v[128:131], v[216:219], v[192:195], v[128:131]
    s_add_u32 s78, s78, s79
    v_lshlrev_b32 v196, 8, v228
    v_lshl_add_u32 v196, v199, 4, v196
    v_mfma_f32_16x16x32_bf16 v[100:103], v[216:219], v[188:191], v[100:103]
    v_add_u32 v196, s78, v196
    v_mfma_f32_16x16x32_bf16 v[72:75], v[216:219], v[184:187], v[72:75]
    v_mfma_f32_16x16x32_bf16 v[44:47], v[216:219], v[180:183], v[44:47]
    v_mfma_f32_16x16x32_bf16 v[48:51], v[220:223], v[180:183], v[48:51]
    v_mfma_f32_16x16x32_bf16 v[76:79], v[220:223], v[184:187], v[76:79]
    v_mfma_f32_16x16x32_bf16 v[104:107], v[220:223], v[188:191], v[104:107]
    v_mfma_f32_16x16x32_bf16 v[132:135], v[220:223], v[192:195], v[132:135]
    s_waitcnt lgkmcnt(0)
    s_cmp_eq_u32 s35, 1
    s_cbranch_scc1 G3_e1
    v_pk_fma_f32 v[24:25], v[164:165], v[136:137], v[24:25] op_sel_hi:[0,1,1] neg_lo:[1,0,0] neg_hi:[1,0,0]
    v_pk_fma_f32 v[26:27], v[164:165], v[138:139], v[26:27] op_sel_hi:[0,1,1] neg_lo:[1,0,0] neg_hi:[1,0,0]
    v_pk_mul_f32 v[226:227], v[24:25], v[24:25]
    v_pk_mul_f32 v[228:229], v[26:27], v[26:27]
    v_pk_fma_f32 v[226:227], v[226:227], v[166:167], v[166:167] op_sel:[0,1,0] op_sel_hi:[1,1,0]
    v_pk_fma_f32 v[228:229], v[228:229], v[166:167], v[166:167] op_sel:[0,1,0] op_sel_hi:[1,1,0]
    v_pk_mul_f32 v[226:227], v[226:227], v[24:25]
    v_pk_mul_f32 v[228:229], v[228:229], v[26:27]
    v_exp_f32 v226, v226
    v_exp_f32 v227, v227
    v_exp_f32 v228, v228
    v_exp_f32 v229, v229
    v_pk_fma_f32 v[226:227], v[226:227], v[164:165], v[164:165] op_sel:[0,1,1] op_sel_hi:[1,1,1]
    v_pk_fma_f32 v[228:229], v[228:229], v[164:165], v[164:165] op_sel:[0,1,1] op_sel_hi:[1,1,1]
    v_rcp_f32 v226, v226
    v_rcp_f32 v227, v227
    v_rcp_f32 v228, v228
    v_rcp_f32 v229, v229
    v_pk_mul_f32 v[24:25], v[24:25], v[226:227]
    v_pk_mul_f32 v[26:27], v[26:27], v[228:229]
    v_pk_fma_f32 v[28:29], v[164:165], v[140:141], v[28:29] op_sel_hi:[0,1,1] neg_lo:[1,0,0] neg_hi:[1,0,0]
    v_pk_fma_f32 v[30:31], v[164:165], v[142:143], v[30:31] op_sel_hi:[0,1,1] neg_lo:[1,0,0] neg_hi:[1,0,0]
    v_pk_mul_f32 v[226:227], v[28:29], v[28:29]
    v_pk_mul_f32 v[228:229], v[30:31], v[30:31]
    v_pk_fma_f32 v[226:227], v[226:227], v[166:167], v[166:167] op_sel:[0,1,0] op_sel_hi:[1,1,0]
    v_pk_fma_f32 v[228:229], v[228:229], v[166:167], v[166:167] op_sel:[0,1,0] op_sel_hi:[1,1,0]
    v_pk_mul_f32 v[226:227], v[226:227], v[28:29]
    v_pk_mul_f32 v[228:229], v[228:229], v[30:31]
    v_exp_f32 v226, v226
    v_exp_f32 v227, v227
    v_exp_f32 v228, v228
    v_exp_f32 v229, v229
    v_pk_fma_f32 v[226:227], v[226:227], v[164:165], v[164:165] op_sel:[0,1,1] op_sel_hi:[1,1,1]
    v_pk_fma_f32 v[228:229], v[228:229], v[164:165], v[164:165] op_sel:[0,1,1] op_sel_hi:[1,1,1]
    v_rcp_f32 v226, v226
    v_rcp_f32 v227, v227
    v_rcp_f32 v228, v228
    v_rcp_f32 v229, v229
    v_pk_mul_f32 v[28:29], v[28:29], v[226:227]
    v_pk_mul_f32 v[30:31], v[30:31], v[228:229]
    v_cvt_pk_bf16_f32 v24, v24, v25
    v_cvt_pk_bf16_f32 v25, v26, v27
    v_cvt_pk_bf16_f32 v26, v28, v29
    v_cvt_pk_bf16_f32 v27, v30, v31
    v_or_b32 v24, 1, v24
    ds_write_b128 v244, v[24:27] offset:0
    s_add_u32 s36, s44, 0
    buffer_store_dwordx4 v[24:27], v2, s[16:19], s36 offen sc1
    v_pk_fma_f32 v[52:53], v[168:169], v[136:137], v[52:53] op_sel_hi:[0,1,1] neg_lo:[1,0,0] neg_hi:[1,0,0]
    v_pk_fma_f32 v[54:55], v[168:169], v[138:139], v[54:55] op_sel_hi:[0,1,1] neg_lo:[1,0,0] neg_hi:[1,0,0]
    v_pk_mul_f32 v[226:227], v[52:53], v[52:53]
    v_pk_mul_f32 v[228:229], v[54:55], v[54:55]
    v_pk_fma_f32 v[226:227], v[226:227], v[170:171], v[170:171] op_sel:[0,1,0] op_sel_hi:[1,1,0]
    v_pk_fma_f32 v[228:229], v[228:229], v[170:171], v[170:171] op_sel:[0,1,0] op_sel_hi:[1,1,0]
    v_pk_mul_f32 v[226:227], v[226:227], v[52:53]
    v_pk_mul_f32 v[228:229], v[228:229], v[54:55]
    v_exp_f32 v226, v226
    v_exp_f32 v227, v227
    v_exp_f32 v228, v228
    v_exp_f32 v229, v229
    v_pk_fma_f32 v[226:227], v[226:227], v[168:169], v[168:169] op_sel:[0,1,1] op_sel_hi:[1,1,1]
    v_pk_fma_f32 v[228:229], v[228:229], v[168:169], v[168:169] op_sel:[0,1,1] op_sel_hi:[1,1,1]
    v_rcp_f32 v226, v226
    v_rcp_f32 v227, v227
    v_rcp_f32 v228, v228
    v_rcp_f32 v229, v229
    v_pk_mul_f32 v[52:53], v[52:53], v[226:227]
    v_pk_mul_f32 v[54:55], v[54:55], v[228:229]
    v_pk_fma_f32 v[56:57], v[168:169], v[140:141], v[56:57] op_sel_hi:[0,1,1] neg_lo:[1,0,0] neg_hi:[1,0,0]
    v_pk_fma_f32 v[58:59], v[168:169], v[142:143], v[58:59] op_sel_hi:[0,1,1] neg_lo:[1,0,0] neg_hi:[1,0,0]
    v_pk_mul_f32 v[226:227], v[56:57], v[56:57]
    v_pk_mul_f32 v[228:229], v[58:59], v[58:59]
    v_pk_fma_f32 v[226:227], v[226:227], v[170:171], v[170:171] op_sel:[0,1,0] op_sel_hi:[1,1,0]
    v_pk_fma_f32 v[228:229], v[228:229], v[170:171], v[170:171] op_sel:[0,1,0] op_sel_hi:[1,1,0]
    v_pk_mul_f32 v[226:227], v[226:227], v[56:57]
    v_pk_mul_f32 v[228:229], v[228:229], v[58:59]
    v_exp_f32 v226, v226
    v_exp_f32 v227, v227
    v_exp_f32 v228, v228
    v_exp_f32 v229, v229
    v_pk_fma_f32 v[226:227], v[226:227], v[168:169], v[168:169] op_sel:[0,1,1] op_sel_hi:[1,1,1]
    v_pk_fma_f32 v[228:229], v[228:229], v[168:169], v[168:169] op_sel:[0,1,1] op_sel_hi:[1,1,1]
    v_rcp_f32 v226, v226
    v_rcp_f32 v227, v227
    v_rcp_f32 v228, v228
    v_rcp_f32 v229, v229
    v_pk_mul_f32 v[56:57], v[56:57], v[226:227]
    v_pk_mul_f32 v[58:59], v[58:59], v[228:229]
    v_cvt_pk_bf16_f32 v52, v52, v53
    v_cvt_pk_bf16_f32 v53, v54, v55
    v_cvt_pk_bf16_f32 v54, v56, v57
    v_cvt_pk_bf16_f32 v55, v58, v59
    v_or_b32 v52, 1, v52
    ds_write_b128 v244, v[52:55] offset:2048
    s_add_u32 s36, s44, 229376
    buffer_store_dwordx4 v[52:55], v2, s[16:19], s36 offen sc1
    v_pk_fma_f32 v[80:81], v[172:173], v[136:137], v[80:81] op_sel_hi:[0,1,1] neg_lo:[1,0,0] neg_hi:[1,0,0]
    v_pk_fma_f32 v[82:83], v[172:173], v[138:139], v[82:83] op_sel_hi:[0,1,1] neg_lo:[1,0,0] neg_hi:[1,0,0]
    v_pk_mul_f32 v[226:227], v[80:81], v[80:81]
    v_pk_mul_f32 v[228:229], v[82:83], v[82:83]
    v_pk_fma_f32 v[226:227], v[226:227], v[174:175], v[174:175] op_sel:[0,1,0] op_sel_hi:[1,1,0]
    v_pk_fma_f32 v[228:229], v[228:229], v[174:175], v[174:175] op_sel:[0,1,0] op_sel_hi:[1,1,0]
    v_pk_mul_f32 v[226:227], v[226:227], v[80:81]
    v_pk_mul_f32 v[228:229], v[228:229], v[82:83]
    v_exp_f32 v226, v226
    v_exp_f32 v227, v227
    v_exp_f32 v228, v228
    v_exp_f32 v229, v229
    v_pk_fma_f32 v[226:227], v[226:227], v[172:173], v[172:173] op_sel:[0,1,1] op_sel_hi:[1,1,1]
    v_pk_fma_f32 v[228:229], v[228:229], v[172:173], v[172:173] op_sel:[0,1,1] op_sel_hi:[1,1,1]
    v_rcp_f32 v226, v226
    v_rcp_f32 v227, v227
    v_rcp_f32 v228, v228
    v_rcp_f32 v229, v229
    v_pk_mul_f32 v[80:81], v[80:81], v[226:227]
    v_pk_mul_f32 v[82:83], v[82:83], v[228:229]
    v_pk_fma_f32 v[84:85], v[172:173], v[140:141], v[84:85] op_sel_hi:[0,1,1] neg_lo:[1,0,0] neg_hi:[1,0,0]
    v_pk_fma_f32 v[86:87], v[172:173], v[142:143], v[86:87] op_sel_hi:[0,1,1] neg_lo:[1,0,0] neg_hi:[1,0,0]
    v_pk_mul_f32 v[226:227], v[84:85], v[84:85]
    v_pk_mul_f32 v[228:229], v[86:87], v[86:87]
    v_pk_fma_f32 v[226:227], v[226:227], v[174:175], v[174:175] op_sel:[0,1,0] op_sel_hi:[1,1,0]
    v_pk_fma_f32 v[228:229], v[228:229], v[174:175], v[174:175] op_sel:[0,1,0] op_sel_hi:[1,1,0]
    v_pk_mul_f32 v[226:227], v[226:227], v[84:85]
    v_pk_mul_f32 v[228:229], v[228:229], v[86:87]
    v_exp_f32 v226, v226
    v_exp_f32 v227, v227
    v_exp_f32 v228, v228
    v_exp_f32 v229, v229
    v_pk_fma_f32 v[226:227], v[226:227], v[172:173], v[172:173] op_sel:[0,1,1] op_sel_hi:[1,1,1]
    v_pk_fma_f32 v[228:229], v[228:229], v[172:173], v[172:173] op_sel:[0,1,1] op_sel_hi:[1,1,1]
    v_rcp_f32 v226, v226
    v_rcp_f32 v227, v227
    v_rcp_f32 v228, v228
    v_rcp_f32 v229, v229
    v_pk_mul_f32 v[84:85], v[84:85], v[226:227]
    v_pk_mul_f32 v[86:87], v[86:87], v[228:229]
    v_cvt_pk_bf16_f32 v80, v80, v81
    v_cvt_pk_bf16_f32 v81, v82, v83
    v_cvt_pk_bf16_f32 v82, v84, v85
    v_cvt_pk_bf16_f32 v83, v86, v87
    v_or_b32 v80, 1, v80
    ds_write_b128 v244, v[80:83] offset:4096
    s_add_u32 s36, s44, 458752
    buffer_store_dwordx4 v[80:83], v2, s[16:19], s36 offen sc1
    v_pk_fma_f32 v[108:109], v[176:177], v[136:137], v[108:109] op_sel_hi:[0,1,1] neg_lo:[1,0,0] neg_hi:[1,0,0]
    v_pk_fma_f32 v[110:111], v[176:177], v[138:139], v[110:111] op_sel_hi:[0,1,1] neg_lo:[1,0,0] neg_hi:[1,0,0]
    v_pk_mul_f32 v[226:227], v[108:109], v[108:109]
    v_pk_mul_f32 v[228:229], v[110:111], v[110:111]
    v_pk_fma_f32 v[226:227], v[226:227], v[178:179], v[178:179] op_sel:[0,1,0] op_sel_hi:[1,1,0]
    v_pk_fma_f32 v[228:229], v[228:229], v[178:179], v[178:179] op_sel:[0,1,0] op_sel_hi:[1,1,0]
    v_pk_mul_f32 v[226:227], v[226:227], v[108:109]
    v_pk_mul_f32 v[228:229], v[228:229], v[110:111]
    v_exp_f32 v226, v226
    v_exp_f32 v227, v227
    v_exp_f32 v228, v228
    v_exp_f32 v229, v229
    v_pk_fma_f32 v[226:227], v[226:227], v[176:177], v[176:177] op_sel:[0,1,1] op_sel_hi:[1,1,1]
    v_pk_fma_f32 v[228:229], v[228:229], v[176:177], v[176:177] op_sel:[0,1,1] op_sel_hi:[1,1,1]
    v_rcp_f32 v226, v226
    v_rcp_f32 v227, v227
    v_rcp_f32 v228, v228
    v_rcp_f32 v229, v229
    v_pk_mul_f32 v[108:109], v[108:109], v[226:227]
    v_pk_mul_f32 v[110:111], v[110:111], v[228:229]
    v_pk_fma_f32 v[112:113], v[176:177], v[140:141], v[112:113] op_sel_hi:[0,1,1] neg_lo:[1,0,0] neg_hi:[1,0,0]
    v_pk_fma_f32 v[114:115], v[176:177], v[142:143], v[114:115] op_sel_hi:[0,1,1] neg_lo:[1,0,0] neg_hi:[1,0,0]
    v_pk_mul_f32 v[226:227], v[112:113], v[112:113]
    v_pk_mul_f32 v[228:229], v[114:115], v[114:115]
    v_pk_fma_f32 v[226:227], v[226:227], v[178:179], v[178:179] op_sel:[0,1,0] op_sel_hi:[1,1,0]
    v_pk_fma_f32 v[228:229], v[228:229], v[178:179], v[178:179] op_sel:[0,1,0] op_sel_hi:[1,1,0]
    v_pk_mul_f32 v[226:227], v[226:227], v[112:113]
    v_pk_mul_f32 v[228:229], v[228:229], v[114:115]
    v_exp_f32 v226, v226
    v_exp_f32 v227, v227
    v_exp_f32 v228, v228
    v_exp_f32 v229, v229
    v_pk_fma_f32 v[226:227], v[226:227], v[176:177], v[176:177] op_sel:[0,1,1] op_sel_hi:[1,1,1]
    v_pk_fma_f32 v[228:229], v[228:229], v[176:177], v[176:177] op_sel:[0,1,1] op_sel_hi:[1,1,1]
    v_rcp_f32 v226, v226
    v_rcp_f32 v227, v227
    v_rcp_f32 v228, v228
    v_rcp_f32 v229, v229
    v_pk_mul_f32 v[112:113], v[112:113], v[226:227]
    v_pk_mul_f32 v[114:115], v[114:115], v[228:229]
    v_cvt_pk_bf16_f32 v108, v108, v109
    v_cvt_pk_bf16_f32 v109, v110, v111
    v_cvt_pk_bf16_f32 v110, v112, v113
    v_cvt_pk_bf16_f32 v111, v114, v115
    ds_write_b128 v244, v[108:111] offset:6144
    s_add_u32 s36, s44, 688128
    buffer_store_dwordx4 v[108:111], v2, s[16:19], s36 offen sc1
    v_pk_fma_f32 v[32:33], v[164:165], v[144:145], v[32:33] op_sel_hi:[0,1,1] neg_lo:[1,0,0] neg_hi:[1,0,0]
    v_pk_fma_f32 v[34:35], v[164:165], v[146:147], v[34:35] op_sel_hi:[0,1,1] neg_lo:[1,0,0] neg_hi:[1,0,0]
    v_pk_mul_f32 v[226:227], v[32:33], v[32:33]
    v_pk_mul_f32 v[228:229], v[34:35], v[34:35]
    v_pk_fma_f32 v[226:227], v[226:227], v[166:167], v[166:167] op_sel:[0,1,0] op_sel_hi:[1,1,0]
    v_pk_fma_f32 v[228:229], v[228:229], v[166:167], v[166:167] op_sel:[0,1,0] op_sel_hi:[1,1,0]
    v_pk_mul_f32 v[226:227], v[226:227], v[32:33]
    v_pk_mul_f32 v[228:229], v[228:229], v[34:35]
    v_exp_f32 v226, v226
    v_exp_f32 v227, v227
    v_exp_f32 v228, v228
    v_exp_f32 v229, v229
    v_pk_fma_f32 v[226:227], v[226:227], v[164:165], v[164:165] op_sel:[0,1,1] op_sel_hi:[1,1,1]
    v_pk_fma_f32 v[228:229], v[228:229], v[164:165], v[164:165] op_sel:[0,1,1] op_sel_hi:[1,1,1]
    v_rcp_f32 v226, v226
    v_rcp_f32 v227, v227
    v_rcp_f32 v228, v228
    v_rcp_f32 v229, v229
    v_pk_mul_f32 v[32:33], v[32:33], v[226:227]
    v_pk_mul_f32 v[34:35], v[34:35], v[228:229]
    v_pk_fma_f32 v[36:37], v[164:165], v[148:149], v[36:37] op_sel_hi:[0,1,1] neg_lo:[1,0,0] neg_hi:[1,0,0]
    v_pk_fma_f32 v[38:39], v[164:165], v[150:151], v[38:39] op_sel_hi:[0,1,1] neg_lo:[1,0,0] neg_hi:[1,0,0]
    v_pk_mul_f32 v[226:227], v[36:37], v[36:37]
    v_pk_mul_f32 v[228:229], v[38:39], v[38:39]
    v_pk_fma_f32 v[226:227], v[226:227], v[166:167], v[166:167] op_sel:[0,1,0] op_sel_hi:[1,1,0]
    v_pk_fma_f32 v[228:229], v[228:229], v[166:167], v[166:167] op_sel:[0,1,0] op_sel_hi:[1,1,0]
    v_pk_mul_f32 v[226:227], v[226:227], v[36:37]
    v_pk_mul_f32 v[228:229], v[228:229], v[38:39]
    v_exp_f32 v226, v226
    v_exp_f32 v227, v227
    v_exp_f32 v228, v228
    v_exp_f32 v229, v229
    v_pk_fma_f32 v[226:227], v[226:227], v[164:165], v[164:165] op_sel:[0,1,1] op_sel_hi:[1,1,1]
    v_pk_fma_f32 v[228:229], v[228:229], v[164:165], v[164:165] op_sel:[0,1,1] op_sel_hi:[1,1,1]
    v_rcp_f32 v226, v226
    v_rcp_f32 v227, v227
    v_rcp_f32 v228, v228
    v_rcp_f32 v229, v229
    v_pk_mul_f32 v[36:37], v[36:37], v[226:227]
    v_pk_mul_f32 v[38:39], v[38:39], v[228:229]
    v_cvt_pk_bf16_f32 v32, v32, v33
    v_cvt_pk_bf16_f32 v33, v34, v35
    v_cvt_pk_bf16_f32 v34, v36, v37
    v_cvt_pk_bf16_f32 v35, v38, v39
    v_or_b32 v32, 1, v32
    ds_write_b128 v244, v[32:35] offset:16384
    v_pk_fma_f32 v[60:61], v[168:169], v[144:145], v[60:61] op_sel_hi:[0,1,1] neg_lo:[1,0,0] neg_hi:[1,0,0]
    v_pk_fma_f32 v[62:63], v[168:169], v[146:147], v[62:63] op_sel_hi:[0,1,1] neg_lo:[1,0,0] neg_hi:[1,0,0]
    v_pk_mul_f32 v[226:227], v[60:61], v[60:61]
    v_pk_mul_f32 v[228:229], v[62:63], v[62:63]
    v_pk_fma_f32 v[226:227], v[226:227], v[170:171], v[170:171] op_sel:[0,1,0] op_sel_hi:[1,1,0]
    v_pk_fma_f32 v[228:229], v[228:229], v[170:171], v[170:171] op_sel:[0,1,0] op_sel_hi:[1,1,0]
    v_pk_mul_f32 v[226:227], v[226:227], v[60:61]
    v_pk_mul_f32 v[228:229], v[228:229], v[62:63]
    v_exp_f32 v226, v226
    v_exp_f32 v227, v227
    v_exp_f32 v228, v228
    v_exp_f32 v229, v229
    v_pk_fma_f32 v[226:227], v[226:227], v[168:169], v[168:169] op_sel:[0,1,1] op_sel_hi:[1,1,1]
    v_pk_fma_f32 v[228:229], v[228:229], v[168:169], v[168:169] op_sel:[0,1,1] op_sel_hi:[1,1,1]
    v_rcp_f32 v226, v226
    v_rcp_f32 v227, v227
    v_rcp_f32 v228, v228
    v_rcp_f32 v229, v229
    v_pk_mul_f32 v[60:61], v[60:61], v[226:227]
    v_pk_mul_f32 v[62:63], v[62:63], v[228:229]
    v_pk_fma_f32 v[64:65], v[168:169], v[148:149], v[64:65] op_sel_hi:[0,1,1] neg_lo:[1,0,0] neg_hi:[1,0,0]
    v_pk_fma_f32 v[66:67], v[168:169], v[150:151], v[66:67] op_sel_hi:[0,1,1] neg_lo:[1,0,0] neg_hi:[1,0,0]
    v_pk_mul_f32 v[226:227], v[64:65], v[64:65]
    v_pk_mul_f32 v[228:229], v[66:67], v[66:67]
    v_pk_fma_f32 v[226:227], v[226:227], v[170:171], v[170:171] op_sel:[0,1,0] op_sel_hi:[1,1,0]
    v_pk_fma_f32 v[228:229], v[228:229], v[170:171], v[170:171] op_sel:[0,1,0] op_sel_hi:[1,1,0]
    v_pk_mul_f32 v[226:227], v[226:227], v[64:65]
    v_pk_mul_f32 v[228:229], v[228:229], v[66:67]
    v_exp_f32 v226, v226
    v_exp_f32 v227, v227
    v_exp_f32 v228, v228
    v_exp_f32 v229, v229
    v_pk_fma_f32 v[226:227], v[226:227], v[168:169], v[168:169] op_sel:[0,1,1] op_sel_hi:[1,1,1]
    v_pk_fma_f32 v[228:229], v[228:229], v[168:169], v[168:169] op_sel:[0,1,1] op_sel_hi:[1,1,1]
    v_rcp_f32 v226, v226
    v_rcp_f32 v227, v227
    v_rcp_f32 v228, v228
    v_rcp_f32 v229, v229
    v_pk_mul_f32 v[64:65], v[64:65], v[226:227]
    v_pk_mul_f32 v[66:67], v[66:67], v[228:229]
    v_cvt_pk_bf16_f32 v60, v60, v61
    v_cvt_pk_bf16_f32 v61, v62, v63
    v_cvt_pk_bf16_f32 v62, v64, v65
    v_cvt_pk_bf16_f32 v63, v66, v67
    v_or_b32 v60, 1, v60
    ds_write_b128 v244, v[60:63] offset:18432
    s_waitcnt vmcnt(0)
    s_mov_b64 exec, 1
    ds_add_u32 v246, v245
    s_mov_b64 exec, -1
    v_pk_fma_f32 v[88:89], v[172:173], v[144:145], v[88:89] op_sel_hi:[0,1,1] neg_lo:[1,0,0] neg_hi:[1,0,0]
    v_pk_fma_f32 v[90:91], v[172:173], v[146:147], v[90:91] op_sel_hi:[0,1,1] neg_lo:[1,0,0] neg_hi:[1,0,0]
    v_pk_mul_f32 v[226:227], v[88:89], v[88:89]
    v_pk_mul_f32 v[228:229], v[90:91], v[90:91]
    v_pk_fma_f32 v[226:227], v[226:227], v[174:175], v[174:175] op_sel:[0,1,0] op_sel_hi:[1,1,0]
    v_pk_fma_f32 v[228:229], v[228:229], v[174:175], v[174:175] op_sel:[0,1,0] op_sel_hi:[1,1,0]
    v_pk_mul_f32 v[226:227], v[226:227], v[88:89]
    v_pk_mul_f32 v[228:229], v[228:229], v[90:91]
    v_exp_f32 v226, v226
    v_exp_f32 v227, v227
    v_exp_f32 v228, v228
    v_exp_f32 v229, v229
    v_pk_fma_f32 v[226:227], v[226:227], v[172:173], v[172:173] op_sel:[0,1,1] op_sel_hi:[1,1,1]
    v_pk_fma_f32 v[228:229], v[228:229], v[172:173], v[172:173] op_sel:[0,1,1] op_sel_hi:[1,1,1]
    v_rcp_f32 v226, v226
    v_rcp_f32 v227, v227
    v_rcp_f32 v228, v228
    v_rcp_f32 v229, v229
    v_pk_mul_f32 v[88:89], v[88:89], v[226:227]
    v_pk_mul_f32 v[90:91], v[90:91], v[228:229]
    v_pk_fma_f32 v[92:93], v[172:173], v[148:149], v[92:93] op_sel_hi:[0,1,1] neg_lo:[1,0,0] neg_hi:[1,0,0]
    v_pk_fma_f32 v[94:95], v[172:173], v[150:151], v[94:95] op_sel_hi:[0,1,1] neg_lo:[1,0,0] neg_hi:[1,0,0]
    v_pk_mul_f32 v[226:227], v[92:93], v[92:93]
    v_pk_mul_f32 v[228:229], v[94:95], v[94:95]
    v_pk_fma_f32 v[226:227], v[226:227], v[174:175], v[174:175] op_sel:[0,1,0] op_sel_hi:[1,1,0]
    v_pk_fma_f32 v[228:229], v[228:229], v[174:175], v[174:175] op_sel:[0,1,0] op_sel_hi:[1,1,0]
    v_pk_mul_f32 v[226:227], v[226:227], v[92:93]
    v_pk_mul_f32 v[228:229], v[228:229], v[94:95]
    v_exp_f32 v226, v226
    v_exp_f32 v227, v227
    v_exp_f32 v228, v228
    v_exp_f32 v229, v229
    v_pk_fma_f32 v[226:227], v[226:227], v[172:173], v[172:173] op_sel:[0,1,1] op_sel_hi:[1,1,1]
    v_pk_fma_f32 v[228:229], v[228:229], v[172:173], v[172:173] op_sel:[0,1,1] op_sel_hi:[1,1,1]
    v_rcp_f32 v226, v226
    v_rcp_f32 v227, v227
    v_rcp_f32 v228, v228
    v_rcp_f32 v229, v229
    v_pk_mul_f32 v[92:93], v[92:93], v[226:227]
    v_pk_mul_f32 v[94:95], v[94:95], v[228:229]
    v_cvt_pk_bf16_f32 v88, v88, v89
    v_cvt_pk_bf16_f32 v89, v90, v91
    v_cvt_pk_bf16_f32 v90, v92, v93
    v_cvt_pk_bf16_f32 v91, v94, v95
    v_or_b32 v88, 1, v88
    ds_write_b128 v244, v[88:91] offset:20480
    s_cmp_eq_u32 s60, 1
    s_cbranch_scc1 G4_p10
    buffer_load_dwordx4 v[180:183], v196, s[84:87], 0 offen offset:0 sc1
    buffer_load_dwordx4 v[188:191], v196, s[88:91], 0 offen offset:0 sc1
    buffer_load_dwordx4 v[184:187], v196, s[84:87], 0 offen offset:2048 sc1
    buffer_load_dwordx4 v[192:195], v196, s[88:91], 0 offen offset:2048 sc1
    s_branch G4_p20
G4_p10:
    s_add_u32 s36, s40, 0
    buffer_load_dwordx4 v[180:183], v2, s[84:87], s36 offen offset:0 sc1
    buffer_load_dwordx4 v[184:187], v2, s[88:91], s36 offen offset:0 sc1
    buffer_load_dwordx4 v[188:191], v2, s[84:87], s36 offen offset:1024 sc1
    buffer_load_dwordx4 v[192:195], v2, s[88:91], s36 offen offset:1024 sc1
    s_add_u32 s36, s40, 65536
    buffer_load_dwordx4 v[196:199], v2, s[84:87], s36 offen offset:0 sc1
    buffer_load_dwordx4 v[230:233], v2, s[88:91], s36 offen offset:0 sc1
    buffer_load_dwordx4 v[234:237], v2, s[84:87], s36 offen offset:1024 sc1
    buffer_load_dwordx4 v[248:251], v2, s[88:91], s36 offen offset:1024 sc1
G4_p20:
    v_pk_fma_f32 v[116:117], v[176:177], v[144:145], v[116:117] op_sel_hi:[0,1,1] neg_lo:[1,0,0] neg_hi:[1,0,0]
    v_pk_fma_f32 v[118:119], v[176:177], v[146:147], v[118:119] op_sel_hi:[0,1,1] neg_lo:[1,0,0] neg_hi:[1,0,0]
    v_pk_mul_f32 v[226:227], v[116:117], v[116:117]
    v_pk_mul_f32 v[228:229], v[118:119], v[118:119]
    v_pk_fma_f32 v[226:227], v[226:227], v[178:179], v[178:179] op_sel:[0,1,0] op_sel_hi:[1,1,0]
    v_pk_fma_f32 v[228:229], v[228:229], v[178:179], v[178:179] op_sel:[0,1,0] op_sel_hi:[1,1,0]
    v_pk_mul_f32 v[226:227], v[226:227], v[116:117]
    v_pk_mul_f32 v[228:229], v[228:229], v[118:119]
    v_exp_f32 v226, v226
    v_exp_f32 v227, v227
    v_exp_f32 v228, v228
    v_exp_f32 v229, v229
    v_pk_fma_f32 v[226:227], v[226:227], v[176:177], v[176:177] op_sel:[0,1,1] op_sel_hi:[1,1,1]
    v_pk_fma_f32 v[228:229], v[228:229], v[176:177], v[176:177] op_sel:[0,1,1] op_sel_hi:[1,1,1]
    v_rcp_f32 v226, v226
    v_rcp_f32 v227, v227
    v_rcp_f32 v228, v228
    v_rcp_f32 v229, v229
    v_pk_mul_f32 v[116:117], v[116:117], v[226:227]
    v_pk_mul_f32 v[118:119], v[118:119], v[228:229]
    v_pk_fma_f32 v[120:121], v[176:177], v[148:149], v[120:121] op_sel_hi:[0,1,1] neg_lo:[1,0,0] neg_hi:[1,0,0]
    v_pk_fma_f32 v[122:123], v[176:177], v[150:151], v[122:123] op_sel_hi:[0,1,1] neg_lo:[1,0,0] neg_hi:[1,0,0]
    v_pk_mul_f32 v[226:227], v[120:121], v[120:121]
    v_pk_mul_f32 v[228:229], v[122:123], v[122:123]
    v_pk_fma_f32 v[226:227], v[226:227], v[178:179], v[178:179] op_sel:[0,1,0] op_sel_hi:[1,1,0]
    v_pk_fma_f32 v[228:229], v[228:229], v[178:179], v[178:179] op_sel:[0,1,0] op_sel_hi:[1,1,0]
    v_pk_mul_f32 v[226:227], v[226:227], v[120:121]
    v_pk_mul_f32 v[228:229], v[228:229], v[122:123]
    v_exp_f32 v226, v226
    v_exp_f32 v227, v227
    v_exp_f32 v228, v228
    v_exp_f32 v229, v229
    v_pk_fma_f32 v[226:227], v[226:227], v[176:177], v[176:177] op_sel:[0,1,1] op_sel_hi:[1,1,1]
    v_pk_fma_f32 v[228:229], v[228:229], v[176:177], v[176:177] op_sel:[0,1,1] op_sel_hi:[1,1,1]
    v_rcp_f32 v226, v226
    v_rcp_f32 v227, v227
    v_rcp_f32 v228, v228
    v_rcp_f32 v229, v229
    v_pk_mul_f32 v[120:121], v[120:121], v[226:227]
    v_pk_mul_f32 v[122:123], v[122:123], v[228:229]
    v_cvt_pk_bf16_f32 v116, v116, v117
    v_cvt_pk_bf16_f32 v117, v118, v119
    v_cvt_pk_bf16_f32 v118, v120, v121
    v_cvt_pk_bf16_f32 v119, v122, v123
    ds_write_b128 v244, v[116:119] offset:22528
    v_pk_fma_f32 v[40:41], v[164:165], v[152:153], v[40:41] op_sel_hi:[0,1,1] neg_lo:[1,0,0] neg_hi:[1,0,0]
    v_pk_fma_f32 v[42:43], v[164:165], v[154:155], v[42:43] op_sel_hi:[0,1,1] neg_lo:[1,0,0] neg_hi:[1,0,0]
    v_pk_mul_f32 v[226:227], v[40:41], v[40:41]
    v_pk_mul_f32 v[228:229], v[42:43], v[42:43]
    v_pk_fma_f32 v[226:227], v[226:227], v[166:167], v[166:167] op_sel:[0,1,0] op_sel_hi:[1,1,0]
    v_pk_fma_f32 v[228:229], v[228:229], v[166:167], v[166:167] op_sel:[0,1,0] op_sel_hi:[1,1,0]
    v_pk_mul_f32 v[226:227], v[226:227], v[40:41]
    v_pk_mul_f32 v[228:229], v[228:229], v[42:43]
    v_exp_f32 v226, v226
    v_exp_f32 v227, v227
    v_exp_f32 v228, v228
    v_exp_f32 v229, v229
    v_pk_fma_f32 v[226:227], v[226:227], v[164:165], v[164:165] op_sel:[0,1,1] op_sel_hi:[1,1,1]
    v_pk_fma_f32 v[228:229], v[228:229], v[164:165], v[164:165] op_sel:[0,1,1] op_sel_hi:[1,1,1]
    v_rcp_f32 v226, v226
    v_rcp_f32 v227, v227
    v_rcp_f32 v228, v228
    v_rcp_f32 v229, v229
    v_pk_mul_f32 v[40:41], v[40:41], v[226:227]
    v_pk_mul_f32 v[42:43], v[42:43], v[228:229]
    v_pk_fma_f32 v[44:45], v[164:165], v[156:157], v[44:45] op_sel_hi:[0,1,1] neg_lo:[1,0,0] neg_hi:[1,0,0]
    v_pk_fma_f32 v[46:47], v[164:165], v[158:159], v[46:47] op_sel_hi:[0,1,1] neg_lo:[1,0,0] neg_hi:[1,0,0]
    v_pk_mul_f32 v[226:227], v[44:45], v[44:45]
    v_pk_mul_f32 v[228:229], v[46:47], v[46:47]
    v_pk_fma_f32 v[226:227], v[226:227], v[166:167], v[166:167] op_sel:[0,1,0] op_sel_hi:[1,1,0]
    v_pk_fma_f32 v[228:229], v[228:229], v[166:167], v[166:167] op_sel:[0,1,0] op_sel_hi:[1,1,0]
    v_pk_mul_f32 v[226:227], v[226:227], v[44:45]
    v_pk_mul_f32 v[228:229], v[228:229], v[46:47]
    v_exp_f32 v226, v226
    v_exp_f32 v227, v227
    v_exp_f32 v228, v228
    v_exp_f32 v229, v229
    v_pk_fma_f32 v[226:227], v[226:227], v[164:165], v[164:165] op_sel:[0,1,1] op_sel_hi:[1,1,1]
    v_pk_fma_f32 v[228:229], v[228:229], v[164:165], v[164:165] op_sel:[0,1,1] op_sel_hi:[1,1,1]
    v_rcp_f32 v226, v226
    v_rcp_f32 v227, v227
    v_rcp_f32 v228, v228
    v_rcp_f32 v229, v229
    v_pk_mul_f32 v[44:45], v[44:45], v[226:227]
    v_pk_mul_f32 v[46:47], v[46:47], v[228:229]
    v_cvt_pk_bf16_f32 v200, v40, v41
    v_cvt_pk_bf16_f32 v201, v42, v43
    v_cvt_pk_bf16_f32 v202, v44, v45
    v_cvt_pk_bf16_f32 v203, v46, v47
    v_or_b32 v200, 1, v200
    ds_write_b128 v244, v[200:203] offset:32768
    v_pk_fma_f32 v[68:69], v[168:169], v[152:153], v[68:69] op_sel_hi:[0,1,1] neg_lo:[1,0,0] neg_hi:[1,0,0]
    v_pk_fma_f32 v[70:71], v[168:169], v[154:155], v[70:71] op_sel_hi:[0,1,1] neg_lo:[1,0,0] neg_hi:[1,0,0]
    v_pk_mul_f32 v[226:227], v[68:69], v[68:69]
    v_pk_mul_f32 v[228:229], v[70:71], v[70:71]
    v_pk_fma_f32 v[226:227], v[226:227], v[170:171], v[170:171] op_sel:[0,1,0] op_sel_hi:[1,1,0]
    v_pk_fma_f32 v[228:229], v[228:229], v[170:171], v[170:171] op_sel:[0,1,0] op_sel_hi:[1,1,0]
    v_pk_mul_f32 v[226:227], v[226:227], v[68:69]
    v_pk_mul_f32 v[228:229], v[228:229], v[70:71]
    v_exp_f32 v226, v226
    v_exp_f32 v227, v227
    v_exp_f32 v228, v228
    v_exp_f32 v229, v229
    v_pk_fma_f32 v[226:227], v[226:227], v[168:169], v[168:169] op_sel:[0,1,1] op_sel_hi:[1,1,1]
    v_pk_fma_f32 v[228:229], v[228:229], v[168:169], v[168:169] op_sel:[0,1,1] op_sel_hi:[1,1,1]
    v_rcp_f32 v226, v226
    v_rcp_f32 v227, v227
    v_rcp_f32 v228, v228
    v_rcp_f32 v229, v229
    v_pk_mul_f32 v[68:69], v[68:69], v[226:227]
    v_pk_mul_f32 v[70:71], v[70:71], v[228:229]
    v_pk_fma_f32 v[72:73], v[168:169], v[156:157], v[72:73] op_sel_hi:[0,1,1] neg_lo:[1,0,0] neg_hi:[1,0,0]
    v_pk_fma_f32 v[74:75], v[168:169], v[158:159], v[74:75] op_sel_hi:[0,1,1] neg_lo:[1,0,0] neg_hi:[1,0,0]
    v_pk_mul_f32 v[226:227], v[72:73], v[72:73]
    v_pk_mul_f32 v[228:229], v[74:75], v[74:75]
    v_pk_fma_f32 v[226:227], v[226:227], v[170:171], v[170:171] op_sel:[0,1,0] op_sel_hi:[1,1,0]
    v_pk_fma_f32 v[228:229], v[228:229], v[170:171], v[170:171] op_sel:[0,1,0] op_sel_hi:[1,1,0]
    v_pk_mul_f32 v[226:227], v[226:227], v[72:73]
    v_pk_mul_f32 v[228:229], v[228:229], v[74:75]
    v_exp_f32 v226, v226
    v_exp_f32 v227, v227
    v_exp_f32 v228, v228
    v_exp_f32 v229, v229
    v_pk_fma_f32 v[226:227], v[226:227], v[168:169], v[168:169] op_sel:[0,1,1] op_sel_hi:[1,1,1]
    v_pk_fma_f32 v[228:229], v[228:229], v[168:169], v[168:169] op_sel:[0,1,1] op_sel_hi:[1,1,1]
    v_rcp_f32 v226, v226
    v_rcp_f32 v227, v227
    v_rcp_f32 v228, v228
    v_rcp_f32 v229, v229
    v_pk_mul_f32 v[72:73], v[72:73], v[226:227]
    v_pk_mul_f32 v[74:75], v[74:75], v[228:229]
    v_cvt_pk_bf16_f32 v204, v68, v69
    v_cvt_pk_bf16_f32 v205, v70, v71
    v_cvt_pk_bf16_f32 v206, v72, v73
    v_cvt_pk_bf16_f32 v207, v74, v75
    v_or_b32 v204, 1, v204
    ds_write_b128 v244, v[204:207] offset:34816
    v_pk_fma_f32 v[96:97], v[172:173], v[152:153], v[96:97] op_sel_hi:[0,1,1] neg_lo:[1,0,0] neg_hi:[1,0,0]
    v_pk_fma_f32 v[98:99], v[172:173], v[154:155], v[98:99] op_sel_hi:[0,1,1] neg_lo:[1,0,0] neg_hi:[1,0,0]
    v_pk_mul_f32 v[226:227], v[96:97], v[96:97]
    v_pk_mul_f32 v[228:229], v[98:99], v[98:99]
    v_pk_fma_f32 v[226:227], v[226:227], v[174:175], v[174:175] op_sel:[0,1,0] op_sel_hi:[1,1,0]
    v_pk_fma_f32 v[228:229], v[228:229], v[174:175], v[174:175] op_sel:[0,1,0] op_sel_hi:[1,1,0]
    v_pk_mul_f32 v[226:227], v[226:227], v[96:97]
    v_pk_mul_f32 v[228:229], v[228:229], v[98:99]
    v_exp_f32 v226, v226
    v_exp_f32 v227, v227
    v_exp_f32 v228, v228
    v_exp_f32 v229, v229
    v_pk_fma_f32 v[226:227], v[226:227], v[172:173], v[172:173] op_sel:[0,1,1] op_sel_hi:[1,1,1]
    v_pk_fma_f32 v[228:229], v[228:229], v[172:173], v[172:173] op_sel:[0,1,1] op_sel_hi:[1,1,1]
    v_rcp_f32 v226, v226
    v_rcp_f32 v227, v227
    v_rcp_f32 v228, v228
    v_rcp_f32 v229, v229
    v_pk_mul_f32 v[96:97], v[96:97], v[226:227]
    v_pk_mul_f32 v[98:99], v[98:99], v[228:229]
    v_pk_fma_f32 v[100:101], v[172:173], v[156:157], v[100:101] op_sel_hi:[0,1,1] neg_lo:[1,0,0] neg_hi:[1,0,0]
    v_pk_fma_f32 v[102:103], v[172:173], v[158:159], v[102:103] op_sel_hi:[0,1,1] neg_lo:[1,0,0] neg_hi:[1,0,0]
    v_pk_mul_f32 v[226:227], v[100:101], v[100:101]
    v_pk_mul_f32 v[228:229], v[102:103], v[102:103]
    v_pk_fma_f32 v[226:227], v[226:227], v[174:175], v[174:175] op_sel:[0,1,0] op_sel_hi:[1,1,0]
    v_pk_fma_f32 v[228:229], v[228:229], v[174:175], v[174:175] op_sel:[0,1,0] op_sel_hi:[1,1,0]
    v_pk_mul_f32 v[226:227], v[226:227], v[100:101]
    v_pk_mul_f32 v[228:229], v[228:229], v[102:103]
    v_exp_f32 v226, v226
    v_exp_f32 v227, v227
    v_exp_f32 v228, v228
    v_exp_f32 v229, v229
    v_pk_fma_f32 v[226:227], v[226:227], v[172:173], v[172:173] op_sel:[0,1,1] op_sel_hi:[1,1,1]
    v_pk_fma_f32 v[228:229], v[228:229], v[172:173], v[172:173] op_sel:[0,1,1] op_sel_hi:[1,1,1]
    v_rcp_f32 v226, v226
    v_rcp_f32 v227, v227
    v_rcp_f32 v228, v228
    v_rcp_f32 v229, v229
    v_pk_mul_f32 v[100:101], v[100:101], v[226:227]
    v_pk_mul_f32 v[102:103], v[102:103], v[228:229]
    v_cvt_pk_bf16_f32 v208, v96, v97
    v_cvt_pk_bf16_f32 v209, v98, v99
    v_cvt_pk_bf16_f32 v210, v100, v101
    v_cvt_pk_bf16_f32 v211, v102, v103
    v_or_b32 v208, 1, v208
    ds_write_b128 v244, v[208:211] offset:36864
    v_pk_fma_f32 v[124:125], v[176:177], v[152:153], v[124:125] op_sel_hi:[0,1,1] neg_lo:[1,0,0] neg_hi:[1,0,0]
    v_pk_fma_f32 v[126:127], v[176:177], v[154:155], v[126:127] op_sel_hi:[0,1,1] neg_lo:[1,0,0] neg_hi:[1,0,0]
    v_pk_mul_f32 v[226:227], v[124:125], v[124:125]
    v_pk_mul_f32 v[228:229], v[126:127], v[126:127]
    v_pk_fma_f32 v[226:227], v[226:227], v[178:179], v[178:179] op_sel:[0,1,0] op_sel_hi:[1,1,0]
    v_pk_fma_f32 v[228:229], v[228:229], v[178:179], v[178:179] op_sel:[0,1,0] op_sel_hi:[1,1,0]
    v_pk_mul_f32 v[226:227], v[226:227], v[124:125]
    v_pk_mul_f32 v[228:229], v[228:229], v[126:127]
    v_exp_f32 v226, v226
    v_exp_f32 v227, v227
    v_exp_f32 v228, v228
    v_exp_f32 v229, v229
    v_pk_fma_f32 v[226:227], v[226:227], v[176:177], v[176:177] op_sel:[0,1,1] op_sel_hi:[1,1,1]
    v_pk_fma_f32 v[228:229], v[228:229], v[176:177], v[176:177] op_sel:[0,1,1] op_sel_hi:[1,1,1]
    v_rcp_f32 v226, v226
    v_rcp_f32 v227, v227
    v_rcp_f32 v228, v228
    v_rcp_f32 v229, v229
    v_pk_mul_f32 v[124:125], v[124:125], v[226:227]
    v_pk_mul_f32 v[126:127], v[126:127], v[228:229]
    v_pk_fma_f32 v[128:129], v[176:177], v[156:157], v[128:129] op_sel_hi:[0,1,1] neg_lo:[1,0,0] neg_hi:[1,0,0]
    v_pk_fma_f32 v[130:131], v[176:177], v[158:159], v[130:131] op_sel_hi:[0,1,1] neg_lo:[1,0,0] neg_hi:[1,0,0]
    v_pk_mul_f32 v[226:227], v[128:129], v[128:129]
    v_pk_mul_f32 v[228:229], v[130:131], v[130:131]
    v_pk_fma_f32 v[226:227], v[226:227], v[178:179], v[178:179] op_sel:[0,1,0] op_sel_hi:[1,1,0]
    v_pk_fma_f32 v[228:229], v[228:229], v[178:179], v[178:179] op_sel:[0,1,0] op_sel_hi:[1,1,0]
    v_pk_mul_f32 v[226:227], v[226:227], v[128:129]
    v_pk_mul_f32 v[228:229], v[228:229], v[130:131]
    v_exp_f32 v226, v226
    v_exp_f32 v227, v227
    v_exp_f32 v228, v228
    v_exp_f32 v229, v229
    v_pk_fma_f32 v[226:227], v[226:227], v[176:177], v[176:177] op_sel:[0,1,1] op_sel_hi:[1,1,1]
    v_pk_fma_f32 v[228:229], v[228:229], v[176:177], v[176:177] op_sel:[0,1,1] op_sel_hi:[1,1,1]
    v_rcp_f32 v226, v226
    v_rcp_f32 v227, v227
    v_rcp_f32 v228, v228
    v_rcp_f32 v229, v229
    v_pk_mul_f32 v[128:129], v[128:129], v[226:227]
    v_pk_mul_f32 v[130:131], v[130:131], v[228:229]
    v_cvt_pk_bf16_f32 v212, v124, v125
    v_cvt_pk_bf16_f32 v213, v126, v127
    v_cvt_pk_bf16_f32 v214, v128, v129
    v_cvt_pk_bf16_f32 v215, v130, v131
    ds_write_b128 v244, v[212:215] offset:38912
    v_pk_fma_f32 v[48:49], v[164:165], v[160:161], v[48:49] op_sel_hi:[0,1,1] neg_lo:[1,0,0] neg_hi:[1,0,0]
    v_pk_fma_f32 v[50:51], v[164:165], v[162:163], v[50:51] op_sel_hi:[0,1,1] neg_lo:[1,0,0] neg_hi:[1,0,0]
    v_pk_mul_f32 v[226:227], v[48:49], v[48:49]
    v_pk_mul_f32 v[228:229], v[50:51], v[50:51]
    v_pk_fma_f32 v[226:227], v[226:227], v[166:167], v[166:167] op_sel:[0,1,0] op_sel_hi:[1,1,0]
    v_pk_fma_f32 v[228:229], v[228:229], v[166:167], v[166:167] op_sel:[0,1,0] op_sel_hi:[1,1,0]
    v_pk_mul_f32 v[226:227], v[226:227], v[48:49]
    v_pk_mul_f32 v[228:229], v[228:229], v[50:51]
    v_exp_f32 v226, v226
    v_exp_f32 v227, v227
    v_exp_f32 v228, v228
    v_exp_f32 v229, v229
    v_pk_fma_f32 v[226:227], v[226:227], v[164:165], v[164:165] op_sel:[0,1,1] op_sel_hi:[1,1,1]
    v_pk_fma_f32 v[228:229], v[228:229], v[164:165], v[164:165] op_sel:[0,1,1] op_sel_hi:[1,1,1]
    v_rcp_f32 v226, v226
    v_rcp_f32 v227, v227
    v_rcp_f32 v228, v228
    v_rcp_f32 v229, v229
    v_pk_mul_f32 v[48:49], v[48:49], v[226:227]
    v_pk_mul_f32 v[50:51], v[50:51], v[228:229]
    v_cvt_pk_bf16_f32 v216, v48, v49
    v_cvt_pk_bf16_f32 v217, v50, v51
    v_or_b32 v216, 1, v216
    s_add_u32 s36, s45, 0
    buffer_store_dwordx4 v[32:35], v2, s[16:19], s36 offen sc1
    v_pk_fma_f32 v[76:77], v[168:169], v[160:161], v[76:77] op_sel_hi:[0,1,1] neg_lo:[1,0,0] neg_hi:[1,0,0]
    v_pk_fma_f32 v[78:79], v[168:169], v[162:163], v[78:79] op_sel_hi:[0,1,1] neg_lo:[1,0,0] neg_hi:[1,0,0]
    v_pk_mul_f32 v[226:227], v[76:77], v[76:77]
    v_pk_mul_f32 v[228:229], v[78:79], v[78:79]
    v_pk_fma_f32 v[226:227], v[226:227], v[170:171], v[170:171] op_sel:[0,1,0] op_sel_hi:[1,1,0]
    v_pk_fma_f32 v[228:229], v[228:229], v[170:171], v[170:171] op_sel:[0,1,0] op_sel_hi:[1,1,0]
    v_pk_mul_f32 v[226:227], v[226:227], v[76:77]
    v_pk_mul_f32 v[228:229], v[228:229], v[78:79]
    v_exp_f32 v226, v226
    v_exp_f32 v227, v227
    v_exp_f32 v228, v228
    v_exp_f32 v229, v229
    v_pk_fma_f32 v[226:227], v[226:227], v[168:169], v[168:169] op_sel:[0,1,1] op_sel_hi:[1,1,1]
    v_pk_fma_f32 v[228:229], v[228:229], v[168:169], v[168:169] op_sel:[0,1,1] op_sel_hi:[1,1,1]
    v_rcp_f32 v226, v226
    v_rcp_f32 v227, v227
    v_rcp_f32 v228, v228
    v_rcp_f32 v229, v229
    v_pk_mul_f32 v[76:77], v[76:77], v[226:227]
    v_pk_mul_f32 v[78:79], v[78:79], v[228:229]
    v_cvt_pk_bf16_f32 v218, v76, v77
    v_cvt_pk_bf16_f32 v219, v78, v79
    v_or_b32 v218, 1, v218
    s_add_u32 s36, s45, 229376
    buffer_store_dwordx4 v[60:63], v2, s[16:19], s36 offen sc1
    v_pk_fma_f32 v[104:105], v[172:173], v[160:161], v[104:105] op_sel_hi:[0,1,1] neg_lo:[1,0,0] neg_hi:[1,0,0]
    v_pk_fma_f32 v[106:107], v[172:173], v[162:163], v[106:107] op_sel_hi:[0,1,1] neg_lo:[1,0,0] neg_hi:[1,0,0]
    v_pk_mul_f32 v[226:227], v[104:105], v[104:105]
    v_pk_mul_f32 v[228:229], v[106:107], v[106:107]
    v_pk_fma_f32 v[226:227], v[226:227], v[174:175], v[174:175] op_sel:[0,1,0] op_sel_hi:[1,1,0]
    v_pk_fma_f32 v[228:229], v[228:229], v[174:175], v[174:175] op_sel:[0,1,0] op_sel_hi:[1,1,0]
    v_pk_mul_f32 v[226:227], v[226:227], v[104:105]
    v_pk_mul_f32 v[228:229], v[228:229], v[106:107]
    v_exp_f32 v226, v226
    v_exp_f32 v227, v227
    v_exp_f32 v228, v228
    v_exp_f32 v229, v229
    v_pk_fma_f32 v[226:227], v[226:227], v[172:173], v[172:173] op_sel:[0,1,1] op_sel_hi:[1,1,1]
    v_pk_fma_f32 v[228:229], v[228:229], v[172:173], v[172:173] op_sel:[0,1,1] op_sel_hi:[1,1,1]
    v_rcp_f32 v226, v226
    v_rcp_f32 v227, v227
    v_rcp_f32 v228, v228
    v_rcp_f32 v229, v229
    v_pk_mul_f32 v[104:105], v[104:105], v[226:227]
    v_pk_mul_f32 v[106:107], v[106:107], v[228:229]
    v_cvt_pk_bf16_f32 v220, v104, v105
    v_cvt_pk_bf16_f32 v221, v106, v107
    v_or_b32 v220, 1, v220
    s_add_u32 s36, s45, 458752
    buffer_store_dwordx4 v[88:91], v2, s[16:19], s36 offen sc1
    v_pk_fma_f32 v[132:133], v[176:177], v[160:161], v[132:133] op_sel_hi:[0,1,1] neg_lo:[1,0,0] neg_hi:[1,0,0]
    v_pk_fma_f32 v[134:135], v[176:177], v[162:163], v[134:135] op_sel_hi:[0,1,1] neg_lo:[1,0,0] neg_hi:[1,0,0]
    v_pk_mul_f32 v[226:227], v[132:133], v[132:133]
    v_pk_mul_f32 v[228:229], v[134:135], v[134:135]
    v_pk_fma_f32 v[226:227], v[226:227], v[178:179], v[178:179] op_sel:[0,1,0] op_sel_hi:[1,1,0]
    v_pk_fma_f32 v[228:229], v[228:229], v[178:179], v[178:179] op_sel:[0,1,0] op_sel_hi:[1,1,0]
    v_pk_mul_f32 v[226:227], v[226:227], v[132:133]
    v_pk_mul_f32 v[228:229], v[228:229], v[134:135]
    v_exp_f32 v226, v226
    v_exp_f32 v227, v227
    v_exp_f32 v228, v228
    v_exp_f32 v229, v229
    v_pk_fma_f32 v[226:227], v[226:227], v[176:177], v[176:177] op_sel:[0,1,1] op_sel_hi:[1,1,1]
    v_pk_fma_f32 v[228:229], v[228:229], v[176:177], v[176:177] op_sel:[0,1,1] op_sel_hi:[1,1,1]
    v_rcp_f32 v226, v226
    v_rcp_f32 v227, v227
    v_rcp_f32 v228, v228
    v_rcp_f32 v229, v229
    v_pk_mul_f32 v[132:133], v[132:133], v[226:227]
    v_pk_mul_f32 v[134:135], v[134:135], v[228:229]
    v_cvt_pk_bf16_f32 v222, v132, v133
    v_cvt_pk_bf16_f32 v223, v134, v135
    s_add_u32 s36, s45, 688128
    buffer_store_dwordx4 v[116:119], v2, s[16:19], s36 offen sc1
    s_waitcnt lgkmcnt(0)
    s_mov_b32 s44, s46
    s_mov_b32 s45, s47
    s_branch G3_e2
G3_e1:
    v_pk_fma_f32 v[28:29], v[164:165], v[140:141], v[28:29] op_sel_hi:[0,1,1] neg_lo:[1,0,0] neg_hi:[1,0,0]
    v_pk_fma_f32 v[30:31], v[164:165], v[142:143], v[30:31] op_sel_hi:[0,1,1] neg_lo:[1,0,0] neg_hi:[1,0,0]
    v_pk_mul_f32 v[226:227], v[28:29], v[28:29]
    v_pk_mul_f32 v[228:229], v[30:31], v[30:31]
    v_pk_fma_f32 v[226:227], v[226:227], v[166:167], v[166:167] op_sel:[0,1,0] op_sel_hi:[1,1,0]
    v_pk_fma_f32 v[228:229], v[228:229], v[166:167], v[166:167] op_sel:[0,1,0] op_sel_hi:[1,1,0]
    v_pk_mul_f32 v[226:227], v[226:227], v[28:29]
    v_pk_mul_f32 v[228:229], v[228:229], v[30:31]
    v_exp_f32 v226, v226
    v_exp_f32 v227, v227
    v_exp_f32 v228, v228
    v_exp_f32 v229, v229
    v_pk_fma_f32 v[226:227], v[226:227], v[164:165], v[164:165] op_sel:[0,1,1] op_sel_hi:[1,1,1]
    v_pk_fma_f32 v[228:229], v[228:229], v[164:165], v[164:165] op_sel:[0,1,1] op_sel_hi:[1,1,1]
    v_rcp_f32 v226, v226
    v_rcp_f32 v227, v227
    v_rcp_f32 v228, v228
    v_rcp_f32 v229, v229
    v_pk_mul_f32 v[28:29], v[28:29], v[226:227]
    v_pk_mul_f32 v[30:31], v[30:31], v[228:229]
    v_pk_fma_f32 v[32:33], v[164:165], v[144:145], v[32:33] op_sel_hi:[0,1,1] neg_lo:[1,0,0] neg_hi:[1,0,0]
    v_pk_fma_f32 v[34:35], v[164:165], v[146:147], v[34:35] op_sel_hi:[0,1,1] neg_lo:[1,0,0] neg_hi:[1,0,0]
    v_pk_mul_f32 v[226:227], v[32:33], v[32:33]
    v_pk_mul_f32 v[228:229], v[34:35], v[34:35]
    v_pk_fma_f32 v[226:227], v[226:227], v[166:167], v[166:167] op_sel:[0,1,0] op_sel_hi:[1,1,0]
    v_pk_fma_f32 v[228:229], v[228:229], v[166:167], v[166:167] op_sel:[0,1,0] op_sel_hi:[1,1,0]
    v_pk_mul_f32 v[226:227], v[226:227], v[32:33]
    v_pk_mul_f32 v[228:229], v[228:229], v[34:35]
    v_exp_f32 v226, v226
    v_exp_f32 v227, v227
    v_exp_f32 v228, v228
    v_exp_f32 v229, v229
    v_pk_fma_f32 v[226:227], v[226:227], v[164:165], v[164:165] op_sel:[0,1,1] op_sel_hi:[1,1,1]
    v_pk_fma_f32 v[228:229], v[228:229], v[164:165], v[164:165] op_sel:[0,1,1] op_sel_hi:[1,1,1]
    v_rcp_f32 v226, v226
    v_rcp_f32 v227, v227
    v_rcp_f32 v228, v228
    v_rcp_f32 v229, v229
    v_pk_mul_f32 v[32:33], v[32:33], v[226:227]
    v_pk_mul_f32 v[34:35], v[34:35], v[228:229]
    v_cvt_pk_bf16_f32 v28, v28, v29
    v_cvt_pk_bf16_f32 v29, v30, v31
    v_cvt_pk_bf16_f32 v30, v32, v33
    v_cvt_pk_bf16_f32 v31, v34, v35
    v_or_b32 v28, 1, v28
    ds_write_b128 v244, v[28:31] offset:0
    s_add_u32 s36, s45, 0
    buffer_store_dwordx4 v[28:31], v2, s[16:19], s36 offen sc1
    v_pk_fma_f32 v[56:57], v[168:169], v[140:141], v[56:57] op_sel_hi:[0,1,1] neg_lo:[1,0,0] neg_hi:[1,0,0]
    v_pk_fma_f32 v[58:59], v[168:169], v[142:143], v[58:59] op_sel_hi:[0,1,1] neg_lo:[1,0,0] neg_hi:[1,0,0]
    v_pk_mul_f32 v[226:227], v[56:57], v[56:57]
    v_pk_mul_f32 v[228:229], v[58:59], v[58:59]
    v_pk_fma_f32 v[226:227], v[226:227], v[170:171], v[170:171] op_sel:[0,1,0] op_sel_hi:[1,1,0]
    v_pk_fma_f32 v[228:229], v[228:229], v[170:171], v[170:171] op_sel:[0,1,0] op_sel_hi:[1,1,0]
    v_pk_mul_f32 v[226:227], v[226:227], v[56:57]
    v_pk_mul_f32 v[228:229], v[228:229], v[58:59]
    v_exp_f32 v226, v226
    v_exp_f32 v227, v227
    v_exp_f32 v228, v228
    v_exp_f32 v229, v229
    v_pk_fma_f32 v[226:227], v[226:227], v[168:169], v[168:169] op_sel:[0,1,1] op_sel_hi:[1,1,1]
    v_pk_fma_f32 v[228:229], v[228:229], v[168:169], v[168:169] op_sel:[0,1,1] op_sel_hi:[1,1,1]
    v_rcp_f32 v226, v226
    v_rcp_f32 v227, v227
    v_rcp_f32 v228, v228
    v_rcp_f32 v229, v229
    v_pk_mul_f32 v[56:57], v[56:57], v[226:227]
    v_pk_mul_f32 v[58:59], v[58:59], v[228:229]
    v_pk_fma_f32 v[60:61], v[168:169], v[144:145], v[60:61] op_sel_hi:[0,1,1] neg_lo:[1,0,0] neg_hi:[1,0,0]
    v_pk_fma_f32 v[62:63], v[168:169], v[146:147], v[62:63] op_sel_hi:[0,1,1] neg_lo:[1,0,0] neg_hi:[1,0,0]
    v_pk_mul_f32 v[226:227], v[60:61], v[60:61]
    v_pk_mul_f32 v[228:229], v[62:63], v[62:63]
    v_pk_fma_f32 v[226:227], v[226:227], v[170:171], v[170:171] op_sel:[0,1,0] op_sel_hi:[1,1,0]
    v_pk_fma_f32 v[228:229], v[228:229], v[170:171], v[170:171] op_sel:[0,1,0] op_sel_hi:[1,1,0]
    v_pk_mul_f32 v[226:227], v[226:227], v[60:61]
    v_pk_mul_f32 v[228:229], v[228:229], v[62:63]
    v_exp_f32 v226, v226
    v_exp_f32 v227, v227
    v_exp_f32 v228, v228
    v_exp_f32 v229, v229
    v_pk_fma_f32 v[226:227], v[226:227], v[168:169], v[168:169] op_sel:[0,1,1] op_sel_hi:[1,1,1]
    v_pk_fma_f32 v[228:229], v[228:229], v[168:169], v[168:169] op_sel:[0,1,1] op_sel_hi:[1,1,1]
    v_rcp_f32 v226, v226
    v_rcp_f32 v227, v227
    v_rcp_f32 v228, v228
    v_rcp_f32 v229, v229
    v_pk_mul_f32 v[60:61], v[60:61], v[226:227]
    v_pk_mul_f32 v[62:63], v[62:63], v[228:229]
    v_cvt_pk_bf16_f32 v56, v56, v57
    v_cvt_pk_bf16_f32 v57, v58, v59
    v_cvt_pk_bf16_f32 v58, v60, v61
    v_cvt_pk_bf16_f32 v59, v62, v63
    v_or_b32 v56, 1, v56
    ds_write_b128 v244, v[56:59] offset:2048
    s_add_u32 s36, s45, 229376
    buffer_store_dwordx4 v[56:59], v2, s[16:19], s36 offen sc1
    v_pk_fma_f32 v[84:85], v[172:173], v[140:141], v[84:85] op_sel_hi:[0,1,1] neg_lo:[1,0,0] neg_hi:[1,0,0]
    v_pk_fma_f32 v[86:87], v[172:173], v[142:143], v[86:87] op_sel_hi:[0,1,1] neg_lo:[1,0,0] neg_hi:[1,0,0]
    v_pk_mul_f32 v[226:227], v[84:85], v[84:85]
    v_pk_mul_f32 v[228:229], v[86:87], v[86:87]
    v_pk_fma_f32 v[226:227], v[226:227], v[174:175], v[174:175] op_sel:[0,1,0] op_sel_hi:[1,1,0]
    v_pk_fma_f32 v[228:229], v[228:229], v[174:175], v[174:175] op_sel:[0,1,0] op_sel_hi:[1,1,0]
    v_pk_mul_f32 v[226:227], v[226:227], v[84:85]
    v_pk_mul_f32 v[228:229], v[228:229], v[86:87]
    v_exp_f32 v226, v226
    v_exp_f32 v227, v227
    v_exp_f32 v228, v228
    v_exp_f32 v229, v229
    v_pk_fma_f32 v[226:227], v[226:227], v[172:173], v[172:173] op_sel:[0,1,1] op_sel_hi:[1,1,1]
    v_pk_fma_f32 v[228:229], v[228:229], v[172:173], v[172:173] op_sel:[0,1,1] op_sel_hi:[1,1,1]
    v_rcp_f32 v226, v226
    v_rcp_f32 v227, v227
    v_rcp_f32 v228, v228
    v_rcp_f32 v229, v229
    v_pk_mul_f32 v[84:85], v[84:85], v[226:227]
    v_pk_mul_f32 v[86:87], v[86:87], v[228:229]
    v_pk_fma_f32 v[88:89], v[172:173], v[144:145], v[88:89] op_sel_hi:[0,1,1] neg_lo:[1,0,0] neg_hi:[1,0,0]
    v_pk_fma_f32 v[90:91], v[172:173], v[146:147], v[90:91] op_sel_hi:[0,1,1] neg_lo:[1,0,0] neg_hi:[1,0,0]
    v_pk_mul_f32 v[226:227], v[88:89], v[88:89]
    v_pk_mul_f32 v[228:229], v[90:91], v[90:91]
    v_pk_fma_f32 v[226:227], v[226:227], v[174:175], v[174:175] op_sel:[0,1,0] op_sel_hi:[1,1,0]
    v_pk_fma_f32 v[228:229], v[228:229], v[174:175], v[174:175] op_sel:[0,1,0] op_sel_hi:[1,1,0]
    v_pk_mul_f32 v[226:227], v[226:227], v[88:89]
    v_pk_mul_f32 v[228:229], v[228:229], v[90:91]
    v_exp_f32 v226, v226
    v_exp_f32 v227, v227
    v_exp_f32 v228, v228
    v_exp_f32 v229, v229
    v_pk_fma_f32 v[226:227], v[226:227], v[172:173], v[172:173] op_sel:[0,1,1] op_sel_hi:[1,1,1]
    v_pk_fma_f32 v[228:229], v[228:229], v[172:173], v[172:173] op_sel:[0,1,1] op_sel_hi:[1,1,1]
    v_rcp_f32 v226, v226
    v_rcp_f32 v227, v227
    v_rcp_f32 v228, v228
    v_rcp_f32 v229, v229
    v_pk_mul_f32 v[88:89], v[88:89], v[226:227]
    v_pk_mul_f32 v[90:91], v[90:91], v[228:229]
    v_cvt_pk_bf16_f32 v84, v84, v85
    v_cvt_pk_bf16_f32 v85, v86, v87
    v_cvt_pk_bf16_f32 v86, v88, v89
    v_cvt_pk_bf16_f32 v87, v90, v91
    v_or_b32 v84, 1, v84
    ds_write_b128 v244, v[84:87] offset:4096
    s_add_u32 s36, s45, 458752
    buffer_store_dwordx4 v[84:87], v2, s[16:19], s36 offen sc1
    v_pk_fma_f32 v[112:113], v[176:177], v[140:141], v[112:113] op_sel_hi:[0,1,1] neg_lo:[1,0,0] neg_hi:[1,0,0]
    v_pk_fma_f32 v[114:115], v[176:177], v[142:143], v[114:115] op_sel_hi:[0,1,1] neg_lo:[1,0,0] neg_hi:[1,0,0]
    v_pk_mul_f32 v[226:227], v[112:113], v[112:113]
    v_pk_mul_f32 v[228:229], v[114:115], v[114:115]
    v_pk_fma_f32 v[226:227], v[226:227], v[178:179], v[178:179] op_sel:[0,1,0] op_sel_hi:[1,1,0]
    v_pk_fma_f32 v[228:229], v[228:229], v[178:179], v[178:179] op_sel:[0,1,0] op_sel_hi:[1,1,0]
    v_pk_mul_f32 v[226:227], v[226:227], v[112:113]
    v_pk_mul_f32 v[228:229], v[228:229], v[114:115]
    v_exp_f32 v226, v226
    v_exp_f32 v227, v227
    v_exp_f32 v228, v228
    v_exp_f32 v229, v229
    v_pk_fma_f32 v[226:227], v[226:227], v[176:177], v[176:177] op_sel:[0,1,1] op_sel_hi:[1,1,1]
    v_pk_fma_f32 v[228:229], v[228:229], v[176:177], v[176:177] op_sel:[0,1,1] op_sel_hi:[1,1,1]
    v_rcp_f32 v226, v226
    v_rcp_f32 v227, v227
    v_rcp_f32 v228, v228
    v_rcp_f32 v229, v229
    v_pk_mul_f32 v[112:113], v[112:113], v[226:227]
    v_pk_mul_f32 v[114:115], v[114:115], v[228:229]
    v_pk_fma_f32 v[116:117], v[176:177], v[144:145], v[116:117] op_sel_hi:[0,1,1] neg_lo:[1,0,0] neg_hi:[1,0,0]
    v_pk_fma_f32 v[118:119], v[176:177], v[146:147], v[118:119] op_sel_hi:[0,1,1] neg_lo:[1,0,0] neg_hi:[1,0,0]
    v_pk_mul_f32 v[226:227], v[116:117], v[116:117]
    v_pk_mul_f32 v[228:229], v[118:119], v[118:119]
    v_pk_fma_f32 v[226:227], v[226:227], v[178:179], v[178:179] op_sel:[0,1,0] op_sel_hi:[1,1,0]
    v_pk_fma_f32 v[228:229], v[228:229], v[178:179], v[178:179] op_sel:[0,1,0] op_sel_hi:[1,1,0]
    v_pk_mul_f32 v[226:227], v[226:227], v[116:117]
    v_pk_mul_f32 v[228:229], v[228:229], v[118:119]
    v_exp_f32 v226, v226
    v_exp_f32 v227, v227
    v_exp_f32 v228, v228
    v_exp_f32 v229, v229
    v_pk_fma_f32 v[226:227], v[226:227], v[176:177], v[176:177] op_sel:[0,1,1] op_sel_hi:[1,1,1]
    v_pk_fma_f32 v[228:229], v[228:229], v[176:177], v[176:177] op_sel:[0,1,1] op_sel_hi:[1,1,1]
    v_rcp_f32 v226, v226
    v_rcp_f32 v227, v227
    v_rcp_f32 v228, v228
    v_rcp_f32 v229, v229
    v_pk_mul_f32 v[116:117], v[116:117], v[226:227]
    v_pk_mul_f32 v[118:119], v[118:119], v[228:229]
    v_cvt_pk_bf16_f32 v112, v112, v113
    v_cvt_pk_bf16_f32 v113, v114, v115
    v_cvt_pk_bf16_f32 v114, v116, v117
    v_cvt_pk_bf16_f32 v115, v118, v119
    ds_write_b128 v244, v[112:115] offset:6144
    s_add_u32 s36, s45, 688128
    buffer_store_dwordx4 v[112:115], v2, s[16:19], s36 offen sc1
    v_pk_fma_f32 v[36:37], v[164:165], v[148:149], v[36:37] op_sel_hi:[0,1,1] neg_lo:[1,0,0] neg_hi:[1,0,0]
    v_pk_fma_f32 v[38:39], v[164:165], v[150:151], v[38:39] op_sel_hi:[0,1,1] neg_lo:[1,0,0] neg_hi:[1,0,0]
    v_pk_mul_f32 v[226:227], v[36:37], v[36:37]
    v_pk_mul_f32 v[228:229], v[38:39], v[38:39]
    v_pk_fma_f32 v[226:227], v[226:227], v[166:167], v[166:167] op_sel:[0,1,0] op_sel_hi:[1,1,0]
    v_pk_fma_f32 v[228:229], v[228:229], v[166:167], v[166:167] op_sel:[0,1,0] op_sel_hi:[1,1,0]
    v_pk_mul_f32 v[226:227], v[226:227], v[36:37]
    v_pk_mul_f32 v[228:229], v[228:229], v[38:39]
    v_exp_f32 v226, v226
    v_exp_f32 v227, v227
    v_exp_f32 v228, v228
    v_exp_f32 v229, v229
    v_pk_fma_f32 v[226:227], v[226:227], v[164:165], v[164:165] op_sel:[0,1,1] op_sel_hi:[1,1,1]
    v_pk_fma_f32 v[228:229], v[228:229], v[164:165], v[164:165] op_sel:[0,1,1] op_sel_hi:[1,1,1]
    v_rcp_f32 v226, v226
    v_rcp_f32 v227, v227
    v_rcp_f32 v228, v228
    v_rcp_f32 v229, v229
    v_pk_mul_f32 v[36:37], v[36:37], v[226:227]
    v_pk_mul_f32 v[38:39], v[38:39], v[228:229]
    v_pk_fma_f32 v[40:41], v[164:165], v[152:153], v[40:41] op_sel_hi:[0,1,1] neg_lo:[1,0,0] neg_hi:[1,0,0]
    v_pk_fma_f32 v[42:43], v[164:165], v[154:155], v[42:43] op_sel_hi:[0,1,1] neg_lo:[1,0,0] neg_hi:[1,0,0]
    v_pk_mul_f32 v[226:227], v[40:41], v[40:41]
    v_pk_mul_f32 v[228:229], v[42:43], v[42:43]
    v_pk_fma_f32 v[226:227], v[226:227], v[166:167], v[166:167] op_sel:[0,1,0] op_sel_hi:[1,1,0]
    v_pk_fma_f32 v[228:229], v[228:229], v[166:167], v[166:167] op_sel:[0,1,0] op_sel_hi:[1,1,0]
    v_pk_mul_f32 v[226:227], v[226:227], v[40:41]
    v_pk_mul_f32 v[228:229], v[228:229], v[42:43]
    v_exp_f32 v226, v226
    v_exp_f32 v227, v227
    v_exp_f32 v228, v228
    v_exp_f32 v229, v229
    v_pk_fma_f32 v[226:227], v[226:227], v[164:165], v[164:165] op_sel:[0,1,1] op_sel_hi:[1,1,1]
    v_pk_fma_f32 v[228:229], v[228:229], v[164:165], v[164:165] op_sel:[0,1,1] op_sel_hi:[1,1,1]
    v_rcp_f32 v226, v226
    v_rcp_f32 v227, v227
    v_rcp_f32 v228, v228
    v_rcp_f32 v229, v229
    v_pk_mul_f32 v[40:41], v[40:41], v[226:227]
    v_pk_mul_f32 v[42:43], v[42:43], v[228:229]
    v_cvt_pk_bf16_f32 v36, v36, v37
    v_cvt_pk_bf16_f32 v37, v38, v39
    v_cvt_pk_bf16_f32 v38, v40, v41
    v_cvt_pk_bf16_f32 v39, v42, v43
    v_or_b32 v36, 1, v36
    ds_write_b128 v244, v[36:39] offset:16384
    v_pk_fma_f32 v[64:65], v[168:169], v[148:149], v[64:65] op_sel_hi:[0,1,1] neg_lo:[1,0,0] neg_hi:[1,0,0]
    v_pk_fma_f32 v[66:67], v[168:169], v[150:151], v[66:67] op_sel_hi:[0,1,1] neg_lo:[1,0,0] neg_hi:[1,0,0]
    v_pk_mul_f32 v[226:227], v[64:65], v[64:65]
    v_pk_mul_f32 v[228:229], v[66:67], v[66:67]
    v_pk_fma_f32 v[226:227], v[226:227], v[170:171], v[170:171] op_sel:[0,1,0] op_sel_hi:[1,1,0]
    v_pk_fma_f32 v[228:229], v[228:229], v[170:171], v[170:171] op_sel:[0,1,0] op_sel_hi:[1,1,0]
    v_pk_mul_f32 v[226:227], v[226:227], v[64:65]
    v_pk_mul_f32 v[228:229], v[228:229], v[66:67]
    v_exp_f32 v226, v226
    v_exp_f32 v227, v227
    v_exp_f32 v228, v228
    v_exp_f32 v229, v229
    v_pk_fma_f32 v[226:227], v[226:227], v[168:169], v[168:169] op_sel:[0,1,1] op_sel_hi:[1,1,1]
    v_pk_fma_f32 v[228:229], v[228:229], v[168:169], v[168:169] op_sel:[0,1,1] op_sel_hi:[1,1,1]
    v_rcp_f32 v226, v226
    v_rcp_f32 v227, v227
    v_rcp_f32 v228, v228
    v_rcp_f32 v229, v229
    v_pk_mul_f32 v[64:65], v[64:65], v[226:227]
    v_pk_mul_f32 v[66:67], v[66:67], v[228:229]
    v_pk_fma_f32 v[68:69], v[168:169], v[152:153], v[68:69] op_sel_hi:[0,1,1] neg_lo:[1,0,0] neg_hi:[1,0,0]
    v_pk_fma_f32 v[70:71], v[168:169], v[154:155], v[70:71] op_sel_hi:[0,1,1] neg_lo:[1,0,0] neg_hi:[1,0,0]
    v_pk_mul_f32 v[226:227], v[68:69], v[68:69]
    v_pk_mul_f32 v[228:229], v[70:71], v[70:71]
    v_pk_fma_f32 v[226:227], v[226:227], v[170:171], v[170:171] op_sel:[0,1,0] op_sel_hi:[1,1,0]
    v_pk_fma_f32 v[228:229], v[228:229], v[170:171], v[170:171] op_sel:[0,1,0] op_sel_hi:[1,1,0]
    v_pk_mul_f32 v[226:227], v[226:227], v[68:69]
    v_pk_mul_f32 v[228:229], v[228:229], v[70:71]
    v_exp_f32 v226, v226
    v_exp_f32 v227, v227
    v_exp_f32 v228, v228
    v_exp_f32 v229, v229
    v_pk_fma_f32 v[226:227], v[226:227], v[168:169], v[168:169] op_sel:[0,1,1] op_sel_hi:[1,1,1]
    v_pk_fma_f32 v[228:229], v[228:229], v[168:169], v[168:169] op_sel:[0,1,1] op_sel_hi:[1,1,1]
    v_rcp_f32 v226, v226
    v_rcp_f32 v227, v227
    v_rcp_f32 v228, v228
    v_rcp_f32 v229, v229
    v_pk_mul_f32 v[68:69], v[68:69], v[226:227]
    v_pk_mul_f32 v[70:71], v[70:71], v[228:229]
    v_cvt_pk_bf16_f32 v64, v64, v65
    v_cvt_pk_bf16_f32 v65, v66, v67
    v_cvt_pk_bf16_f32 v66, v68, v69
    v_cvt_pk_bf16_f32 v67, v70, v71
    v_or_b32 v64, 1, v64
    ds_write_b128 v244, v[64:67] offset:18432
    s_waitcnt vmcnt(0)
    s_mov_b64 exec, 1
    ds_add_u32 v246, v245
    s_mov_b64 exec, -1
    v_pk_fma_f32 v[92:93], v[172:173], v[148:149], v[92:93] op_sel_hi:[0,1,1] neg_lo:[1,0,0] neg_hi:[1,0,0]
    v_pk_fma_f32 v[94:95], v[172:173], v[150:151], v[94:95] op_sel_hi:[0,1,1] neg_lo:[1,0,0] neg_hi:[1,0,0]
    v_pk_mul_f32 v[226:227], v[92:93], v[92:93]
    v_pk_mul_f32 v[228:229], v[94:95], v[94:95]
    v_pk_fma_f32 v[226:227], v[226:227], v[174:175], v[174:175] op_sel:[0,1,0] op_sel_hi:[1,1,0]
    v_pk_fma_f32 v[228:229], v[228:229], v[174:175], v[174:175] op_sel:[0,1,0] op_sel_hi:[1,1,0]
    v_pk_mul_f32 v[226:227], v[226:227], v[92:93]
    v_pk_mul_f32 v[228:229], v[228:229], v[94:95]
    v_exp_f32 v226, v226
    v_exp_f32 v227, v227
    v_exp_f32 v228, v228
    v_exp_f32 v229, v229
    v_pk_fma_f32 v[226:227], v[226:227], v[172:173], v[172:173] op_sel:[0,1,1] op_sel_hi:[1,1,1]
    v_pk_fma_f32 v[228:229], v[228:229], v[172:173], v[172:173] op_sel:[0,1,1] op_sel_hi:[1,1,1]
    v_rcp_f32 v226, v226
    v_rcp_f32 v227, v227
    v_rcp_f32 v228, v228
    v_rcp_f32 v229, v229
    v_pk_mul_f32 v[92:93], v[92:93], v[226:227]
    v_pk_mul_f32 v[94:95], v[94:95], v[228:229]
    v_pk_fma_f32 v[96:97], v[172:173], v[152:153], v[96:97] op_sel_hi:[0,1,1] neg_lo:[1,0,0] neg_hi:[1,0,0]
    v_pk_fma_f32 v[98:99], v[172:173], v[154:155], v[98:99] op_sel_hi:[0,1,1] neg_lo:[1,0,0] neg_hi:[1,0,0]
    v_pk_mul_f32 v[226:227], v[96:97], v[96:97]
    v_pk_mul_f32 v[228:229], v[98:99], v[98:99]
    v_pk_fma_f32 v[226:227], v[226:227], v[174:175], v[174:175] op_sel:[0,1,0] op_sel_hi:[1,1,0]
    v_pk_fma_f32 v[228:229], v[228:229], v[174:175], v[174:175] op_sel:[0,1,0] op_sel_hi:[1,1,0]
    v_pk_mul_f32 v[226:227], v[226:227], v[96:97]
    v_pk_mul_f32 v[228:229], v[228:229], v[98:99]
    v_exp_f32 v226, v226
    v_exp_f32 v227, v227
    v_exp_f32 v228, v228
    v_exp_f32 v229, v229
    v_pk_fma_f32 v[226:227], v[226:227], v[172:173], v[172:173] op_sel:[0,1,1] op_sel_hi:[1,1,1]
    v_pk_fma_f32 v[228:229], v[228:229], v[172:173], v[172:173] op_sel:[0,1,1] op_sel_hi:[1,1,1]
    v_rcp_f32 v226, v226
    v_rcp_f32 v227, v227
    v_rcp_f32 v228, v228
    v_rcp_f32 v229, v229
    v_pk_mul_f32 v[96:97], v[96:97], v[226:227]
    v_pk_mul_f32 v[98:99], v[98:99], v[228:229]
    v_cvt_pk_bf16_f32 v92, v92, v93
    v_cvt_pk_bf16_f32 v93, v94, v95
    v_cvt_pk_bf16_f32 v94, v96, v97
    v_cvt_pk_bf16_f32 v95, v98, v99
    v_or_b32 v92, 1, v92
    ds_write_b128 v244, v[92:95] offset:20480
    s_cmp_eq_u32 s60, 1
    s_cbranch_scc1 G4_p11
    buffer_load_dwordx4 v[180:183], v196, s[84:87], 0 offen offset:0 sc1
    buffer_load_dwordx4 v[188:191], v196, s[88:91], 0 offen offset:0 sc1
    buffer_load_dwordx4 v[184:187], v196, s[84:87], 0 offen offset:2048 sc1
    buffer_load_dwordx4 v[192:195], v196, s[88:91], 0 offen offset:2048 sc1
    s_branch G4_p21
G4_p11:
    s_add_u32 s36, s40, 0
    buffer_load_dwordx4 v[180:183], v2, s[84:87], s36 offen offset:0 sc1
    buffer_load_dwordx4 v[184:187], v2, s[88:91], s36 offen offset:0 sc1
    buffer_load_dwordx4 v[188:191], v2, s[84:87], s36 offen offset:1024 sc1
    buffer_load_dwordx4 v[192:195], v2, s[88:91], s36 offen offset:1024 sc1
    s_add_u32 s36, s40, 65536
    buffer_load_dwordx4 v[196:199], v2, s[84:87], s36 offen offset:0 sc1
    buffer_load_dwordx4 v[230:233], v2, s[88:91], s36 offen offset:0 sc1
    buffer_load_dwordx4 v[234:237], v2, s[84:87], s36 offen offset:1024 sc1
    buffer_load_dwordx4 v[248:251], v2, s[88:91], s36 offen offset:1024 sc1
G4_p21:
    v_pk_fma_f32 v[120:121], v[176:177], v[148:149], v[120:121] op_sel_hi:[0,1,1] neg_lo:[1,0,0] neg_hi:[1,0,0]
    v_pk_fma_f32 v[122:123], v[176:177], v[150:151], v[122:123] op_sel_hi:[0,1,1] neg_lo:[1,0,0] neg_hi:[1,0,0]
    v_pk_mul_f32 v[226:227], v[120:121], v[120:121]
    v_pk_mul_f32 v[228:229], v[122:123], v[122:123]
    v_pk_fma_f32 v[226:227], v[226:227], v[178:179], v[178:179] op_sel:[0,1,0] op_sel_hi:[1,1,0]
    v_pk_fma_f32 v[228:229], v[228:229], v[178:179], v[178:179] op_sel:[0,1,0] op_sel_hi:[1,1,0]
    v_pk_mul_f32 v[226:227], v[226:227], v[120:121]
    v_pk_mul_f32 v[228:229], v[228:229], v[122:123]
    v_exp_f32 v226, v226
    v_exp_f32 v227, v227
    v_exp_f32 v228, v228
    v_exp_f32 v229, v229
    v_pk_fma_f32 v[226:227], v[226:227], v[176:177], v[176:177] op_sel:[0,1,1] op_sel_hi:[1,1,1]
    v_pk_fma_f32 v[228:229], v[228:229], v[176:177], v[176:177] op_sel:[0,1,1] op_sel_hi:[1,1,1]
    v_rcp_f32 v226, v226
    v_rcp_f32 v227, v227
    v_rcp_f32 v228, v228
    v_rcp_f32 v229, v229
    v_pk_mul_f32 v[120:121], v[120:121], v[226:227]
    v_pk_mul_f32 v[122:123], v[122:123], v[228:229]
    v_pk_fma_f32 v[124:125], v[176:177], v[152:153], v[124:125] op_sel_hi:[0,1,1] neg_lo:[1,0,0] neg_hi:[1,0,0]
    v_pk_fma_f32 v[126:127], v[176:177], v[154:155], v[126:127] op_sel_hi:[0,1,1] neg_lo:[1,0,0] neg_hi:[1,0,0]
    v_pk_mul_f32 v[226:227], v[124:125], v[124:125]
    v_pk_mul_f32 v[228:229], v[126:127], v[126:127]
    v_pk_fma_f32 v[226:227], v[226:227], v[178:179], v[178:179] op_sel:[0,1,0] op_sel_hi:[1,1,0]
    v_pk_fma_f32 v[228:229], v[228:229], v[178:179], v[178:179] op_sel:[0,1,0] op_sel_hi:[1,1,0]
    v_pk_mul_f32 v[226:227], v[226:227], v[124:125]
    v_pk_mul_f32 v[228:229], v[228:229], v[126:127]
    v_exp_f32 v226, v226
    v_exp_f32 v227, v227
    v_exp_f32 v228, v228
    v_exp_f32 v229, v229
    v_pk_fma_f32 v[226:227], v[226:227], v[176:177], v[176:177] op_sel:[0,1,1] op_sel_hi:[1,1,1]
    v_pk_fma_f32 v[228:229], v[228:229], v[176:177], v[176:177] op_sel:[0,1,1] op_sel_hi:[1,1,1]
    v_rcp_f32 v226, v226
    v_rcp_f32 v227, v227
    v_rcp_f32 v228, v228
    v_rcp_f32 v229, v229
    v_pk_mul_f32 v[124:125], v[124:125], v[226:227]
    v_pk_mul_f32 v[126:127], v[126:127], v[228:229]
    v_cvt_pk_bf16_f32 v120, v120, v121
    v_cvt_pk_bf16_f32 v121, v122, v123
    v_cvt_pk_bf16_f32 v122, v124, v125
    v_cvt_pk_bf16_f32 v123, v126, v127
    ds_write_b128 v244, v[120:123] offset:22528
    v_pk_fma_f32 v[44:45], v[164:165], v[156:157], v[44:45] op_sel_hi:[0,1,1] neg_lo:[1,0,0] neg_hi:[1,0,0]
    v_pk_fma_f32 v[46:47], v[164:165], v[158:159], v[46:47] op_sel_hi:[0,1,1] neg_lo:[1,0,0] neg_hi:[1,0,0]
    v_pk_mul_f32 v[226:227], v[44:45], v[44:45]
    v_pk_mul_f32 v[228:229], v[46:47], v[46:47]
    v_pk_fma_f32 v[226:227], v[226:227], v[166:167], v[166:167] op_sel:[0,1,0] op_sel_hi:[1,1,0]
    v_pk_fma_f32 v[228:229], v[228:229], v[166:167], v[166:167] op_sel:[0,1,0] op_sel_hi:[1,1,0]
    v_pk_mul_f32 v[226:227], v[226:227], v[44:45]
    v_pk_mul_f32 v[228:229], v[228:229], v[46:47]
    v_exp_f32 v226, v226
    v_exp_f32 v227, v227
    v_exp_f32 v228, v228
    v_exp_f32 v229, v229
    v_pk_fma_f32 v[226:227], v[226:227], v[164:165], v[164:165] op_sel:[0,1,1] op_sel_hi:[1,1,1]
    v_pk_fma_f32 v[228:229], v[228:229], v[164:165], v[164:165] op_sel:[0,1,1] op_sel_hi:[1,1,1]
    v_rcp_f32 v226, v226
    v_rcp_f32 v227, v227
    v_rcp_f32 v228, v228
    v_rcp_f32 v229, v229
    v_pk_mul_f32 v[44:45], v[44:45], v[226:227]
    v_pk_mul_f32 v[46:47], v[46:47], v[228:229]
    v_pk_fma_f32 v[48:49], v[164:165], v[160:161], v[48:49] op_sel_hi:[0,1,1] neg_lo:[1,0,0] neg_hi:[1,0,0]
    v_pk_fma_f32 v[50:51], v[164:165], v[162:163], v[50:51] op_sel_hi:[0,1,1] neg_lo:[1,0,0] neg_hi:[1,0,0]
    v_pk_mul_f32 v[226:227], v[48:49], v[48:49]
    v_pk_mul_f32 v[228:229], v[50:51], v[50:51]
    v_pk_fma_f32 v[226:227], v[226:227], v[166:167], v[166:167] op_sel:[0,1,0] op_sel_hi:[1,1,0]
    v_pk_fma_f32 v[228:229], v[228:229], v[166:167], v[166:167] op_sel:[0,1,0] op_sel_hi:[1,1,0]
    v_pk_mul_f32 v[226:227], v[226:227], v[48:49]
    v_pk_mul_f32 v[228:229], v[228:229], v[50:51]
    v_exp_f32 v226, v226
    v_exp_f32 v227, v227
    v_exp_f32 v228, v228
    v_exp_f32 v229, v229
    v_pk_fma_f32 v[226:227], v[226:227], v[164:165], v[164:165] op_sel:[0,1,1] op_sel_hi:[1,1,1]
    v_pk_fma_f32 v[228:229], v[228:229], v[164:165], v[164:165] op_sel:[0,1,1] op_sel_hi:[1,1,1]
    v_rcp_f32 v226, v226
    v_rcp_f32 v227, v227
    v_rcp_f32 v228, v228
    v_rcp_f32 v229, v229
    v_pk_mul_f32 v[48:49], v[48:49], v[226:227]
    v_pk_mul_f32 v[50:51], v[50:51], v[228:229]
    v_cvt_pk_bf16_f32 v200, v44, v45
    v_cvt_pk_bf16_f32 v201, v46, v47
    v_cvt_pk_bf16_f32 v202, v48, v49
    v_cvt_pk_bf16_f32 v203, v50, v51
    v_or_b32 v200, 1, v200
    ds_write_b128 v244, v[200:203] offset:32768
    v_pk_fma_f32 v[72:73], v[168:169], v[156:157], v[72:73] op_sel_hi:[0,1,1] neg_lo:[1,0,0] neg_hi:[1,0,0]
    v_pk_fma_f32 v[74:75], v[168:169], v[158:159], v[74:75] op_sel_hi:[0,1,1] neg_lo:[1,0,0] neg_hi:[1,0,0]
    v_pk_mul_f32 v[226:227], v[72:73], v[72:73]
    v_pk_mul_f32 v[228:229], v[74:75], v[74:75]
    v_pk_fma_f32 v[226:227], v[226:227], v[170:171], v[170:171] op_sel:[0,1,0] op_sel_hi:[1,1,0]
    v_pk_fma_f32 v[228:229], v[228:229], v[170:171], v[170:171] op_sel:[0,1,0] op_sel_hi:[1,1,0]
    v_pk_mul_f32 v[226:227], v[226:227], v[72:73]
    v_pk_mul_f32 v[228:229], v[228:229], v[74:75]
    v_exp_f32 v226, v226
    v_exp_f32 v227, v227
    v_exp_f32 v228, v228
    v_exp_f32 v229, v229
    v_pk_fma_f32 v[226:227], v[226:227], v[168:169], v[168:169] op_sel:[0,1,1] op_sel_hi:[1,1,1]
    v_pk_fma_f32 v[228:229], v[228:229], v[168:169], v[168:169] op_sel:[0,1,1] op_sel_hi:[1,1,1]
    v_rcp_f32 v226, v226
    v_rcp_f32 v227, v227
    v_rcp_f32 v228, v228
    v_rcp_f32 v229, v229
    v_pk_mul_f32 v[72:73], v[72:73], v[226:227]
    v_pk_mul_f32 v[74:75], v[74:75], v[228:229]
    v_pk_fma_f32 v[76:77], v[168:169], v[160:161], v[76:77] op_sel_hi:[0,1,1] neg_lo:[1,0,0] neg_hi:[1,0,0]
    v_pk_fma_f32 v[78:79], v[168:169], v[162:163], v[78:79] op_sel_hi:[0,1,1] neg_lo:[1,0,0] neg_hi:[1,0,0]
    v_pk_mul_f32 v[226:227], v[76:77], v[76:77]
    v_pk_mul_f32 v[228:229], v[78:79], v[78:79]
    v_pk_fma_f32 v[226:227], v[226:227], v[170:171], v[170:171] op_sel:[0,1,0] op_sel_hi:[1,1,0]
    v_pk_fma_f32 v[228:229], v[228:229], v[170:171], v[170:171] op_sel:[0,1,0] op_sel_hi:[1,1,0]
    v_pk_mul_f32 v[226:227], v[226:227], v[76:77]
    v_pk_mul_f32 v[228:229], v[228:229], v[78:79]
    v_exp_f32 v226, v226
    v_exp_f32 v227, v227
    v_exp_f32 v228, v228
    v_exp_f32 v229, v229
    v_pk_fma_f32 v[226:227], v[226:227], v[168:169], v[168:169] op_sel:[0,1,1] op_sel_hi:[1,1,1]
    v_pk_fma_f32 v[228:229], v[228:229], v[168:169], v[168:169] op_sel:[0,1,1] op_sel_hi:[1,1,1]
    v_rcp_f32 v226, v226
    v_rcp_f32 v227, v227
    v_rcp_f32 v228, v228
    v_rcp_f32 v229, v229
    v_pk_mul_f32 v[76:77], v[76:77], v[226:227]
    v_pk_mul_f32 v[78:79], v[78:79], v[228:229]
    v_cvt_pk_bf16_f32 v204, v72, v73
    v_cvt_pk_bf16_f32 v205, v74, v75
    v_cvt_pk_bf16_f32 v206, v76, v77
    v_cvt_pk_bf16_f32 v207, v78, v79
    v_or_b32 v204, 1, v204
    ds_write_b128 v244, v[204:207] offset:34816
    v_pk_fma_f32 v[100:101], v[172:173], v[156:157], v[100:101] op_sel_hi:[0,1,1] neg_lo:[1,0,0] neg_hi:[1,0,0]
    v_pk_fma_f32 v[102:103], v[172:173], v[158:159], v[102:103] op_sel_hi:[0,1,1] neg_lo:[1,0,0] neg_hi:[1,0,0]
    v_pk_mul_f32 v[226:227], v[100:101], v[100:101]
    v_pk_mul_f32 v[228:229], v[102:103], v[102:103]
    v_pk_fma_f32 v[226:227], v[226:227], v[174:175], v[174:175] op_sel:[0,1,0] op_sel_hi:[1,1,0]
    v_pk_fma_f32 v[228:229], v[228:229], v[174:175], v[174:175] op_sel:[0,1,0] op_sel_hi:[1,1,0]
    v_pk_mul_f32 v[226:227], v[226:227], v[100:101]
    v_pk_mul_f32 v[228:229], v[228:229], v[102:103]
    v_exp_f32 v226, v226
    v_exp_f32 v227, v227
    v_exp_f32 v228, v228
    v_exp_f32 v229, v229
    v_pk_fma_f32 v[226:227], v[226:227], v[172:173], v[172:173] op_sel:[0,1,1] op_sel_hi:[1,1,1]
    v_pk_fma_f32 v[228:229], v[228:229], v[172:173], v[172:173] op_sel:[0,1,1] op_sel_hi:[1,1,1]
    v_rcp_f32 v226, v226
    v_rcp_f32 v227, v227
    v_rcp_f32 v228, v228
    v_rcp_f32 v229, v229
    v_pk_mul_f32 v[100:101], v[100:101], v[226:227]
    v_pk_mul_f32 v[102:103], v[102:103], v[228:229]
    v_pk_fma_f32 v[104:105], v[172:173], v[160:161], v[104:105] op_sel_hi:[0,1,1] neg_lo:[1,0,0] neg_hi:[1,0,0]
    v_pk_fma_f32 v[106:107], v[172:173], v[162:163], v[106:107] op_sel_hi:[0,1,1] neg_lo:[1,0,0] neg_hi:[1,0,0]
    v_pk_mul_f32 v[226:227], v[104:105], v[104:105]
    v_pk_mul_f32 v[228:229], v[106:107], v[106:107]
    v_pk_fma_f32 v[226:227], v[226:227], v[174:175], v[174:175] op_sel:[0,1,0] op_sel_hi:[1,1,0]
    v_pk_fma_f32 v[228:229], v[228:229], v[174:175], v[174:175] op_sel:[0,1,0] op_sel_hi:[1,1,0]
    v_pk_mul_f32 v[226:227], v[226:227], v[104:105]
    v_pk_mul_f32 v[228:229], v[228:229], v[106:107]
    v_exp_f32 v226, v226
    v_exp_f32 v227, v227
    v_exp_f32 v228, v228
    v_exp_f32 v229, v229
    v_pk_fma_f32 v[226:227], v[226:227], v[172:173], v[172:173] op_sel:[0,1,1] op_sel_hi:[1,1,1]
    v_pk_fma_f32 v[228:229], v[228:229], v[172:173], v[172:173] op_sel:[0,1,1] op_sel_hi:[1,1,1]
    v_rcp_f32 v226, v226
    v_rcp_f32 v227, v227
    v_rcp_f32 v228, v228
    v_rcp_f32 v229, v229
    v_pk_mul_f32 v[104:105], v[104:105], v[226:227]
    v_pk_mul_f32 v[106:107], v[106:107], v[228:229]
    v_cvt_pk_bf16_f32 v208, v100, v101
    v_cvt_pk_bf16_f32 v209, v102, v103
    v_cvt_pk_bf16_f32 v210, v104, v105
    v_cvt_pk_bf16_f32 v211, v106, v107
    v_or_b32 v208, 1, v208
    ds_write_b128 v244, v[208:211] offset:36864
    v_pk_fma_f32 v[128:129], v[176:177], v[156:157], v[128:129] op_sel_hi:[0,1,1] neg_lo:[1,0,0] neg_hi:[1,0,0]
    v_pk_fma_f32 v[130:131], v[176:177], v[158:159], v[130:131] op_sel_hi:[0,1,1] neg_lo:[1,0,0] neg_hi:[1,0,0]
    v_pk_mul_f32 v[226:227], v[128:129], v[128:129]
    v_pk_mul_f32 v[228:229], v[130:131], v[130:131]
    v_pk_fma_f32 v[226:227], v[226:227], v[178:179], v[178:179] op_sel:[0,1,0] op_sel_hi:[1,1,0]
    v_pk_fma_f32 v[228:229], v[228:229], v[178:179], v[178:179] op_sel:[0,1,0] op_sel_hi:[1,1,0]
    v_pk_mul_f32 v[226:227], v[226:227], v[128:129]
    v_pk_mul_f32 v[228:229], v[228:229], v[130:131]
    v_exp_f32 v226, v226
    v_exp_f32 v227, v227
    v_exp_f32 v228, v228
    v_exp_f32 v229, v229
    v_pk_fma_f32 v[226:227], v[226:227], v[176:177], v[176:177] op_sel:[0,1,1] op_sel_hi:[1,1,1]
    v_pk_fma_f32 v[228:229], v[228:229], v[176:177], v[176:177] op_sel:[0,1,1] op_sel_hi:[1,1,1]
    v_rcp_f32 v226, v226
    v_rcp_f32 v227, v227
    v_rcp_f32 v228, v228
    v_rcp_f32 v229, v229
    v_pk_mul_f32 v[128:129], v[128:129], v[226:227]
    v_pk_mul_f32 v[130:131], v[130:131], v[228:229]
    v_pk_fma_f32 v[132:133], v[176:177], v[160:161], v[132:133] op_sel_hi:[0,1,1] neg_lo:[1,0,0] neg_hi:[1,0,0]
    v_pk_fma_f32 v[134:135], v[176:177], v[162:163], v[134:135] op_sel_hi:[0,1,1] neg_lo:[1,0,0] neg_hi:[1,0,0]
    v_pk_mul_f32 v[226:227], v[132:133], v[132:133]
    v_pk_mul_f32 v[228:229], v[134:135], v[134:135]
    v_pk_fma_f32 v[226:227], v[226:227], v[178:179], v[178:179] op_sel:[0,1,0] op_sel_hi:[1,1,0]
    v_pk_fma_f32 v[228:229], v[228:229], v[178:179], v[178:179] op_sel:[0,1,0] op_sel_hi:[1,1,0]
    v_pk_mul_f32 v[226:227], v[226:227], v[132:133]
    v_pk_mul_f32 v[228:229], v[228:229], v[134:135]
    v_exp_f32 v226, v226
    v_exp_f32 v227, v227
    v_exp_f32 v228, v228
    v_exp_f32 v229, v229
    v_pk_fma_f32 v[226:227], v[226:227], v[176:177], v[176:177] op_sel:[0,1,1] op_sel_hi:[1,1,1]
    v_pk_fma_f32 v[228:229], v[228:229], v[176:177], v[176:177] op_sel:[0,1,1] op_sel_hi:[1,1,1]
    v_rcp_f32 v226, v226
    v_rcp_f32 v227, v227
    v_rcp_f32 v228, v228
    v_rcp_f32 v229, v229
    v_pk_mul_f32 v[132:133], v[132:133], v[226:227]
    v_pk_mul_f32 v[134:135], v[134:135], v[228:229]
    v_cvt_pk_bf16_f32 v212, v128, v129
    v_cvt_pk_bf16_f32 v213, v130, v131
    v_cvt_pk_bf16_f32 v214, v132, v133
    v_cvt_pk_bf16_f32 v215, v134, v135
    ds_write_b128 v244, v[212:215] offset:38912
    v_pk_fma_f32 v[24:25], v[164:165], v[136:137], v[24:25] op_sel_hi:[0,1,1] neg_lo:[1,0,0] neg_hi:[1,0,0]
    v_pk_fma_f32 v[26:27], v[164:165], v[138:139], v[26:27] op_sel_hi:[0,1,1] neg_lo:[1,0,0] neg_hi:[1,0,0]
    v_pk_mul_f32 v[226:227], v[24:25], v[24:25]
    v_pk_mul_f32 v[228:229], v[26:27], v[26:27]
    v_pk_fma_f32 v[226:227], v[226:227], v[166:167], v[166:167] op_sel:[0,1,0] op_sel_hi:[1,1,0]
    v_pk_fma_f32 v[228:229], v[228:229], v[166:167], v[166:167] op_sel:[0,1,0] op_sel_hi:[1,1,0]
    v_pk_mul_f32 v[226:227], v[226:227], v[24:25]
    v_pk_mul_f32 v[228:229], v[228:229], v[26:27]
    v_exp_f32 v226, v226
    v_exp_f32 v227, v227
    v_exp_f32 v228, v228
    v_exp_f32 v229, v229
    v_pk_fma_f32 v[226:227], v[226:227], v[164:165], v[164:165] op_sel:[0,1,1] op_sel_hi:[1,1,1]
    v_pk_fma_f32 v[228:229], v[228:229], v[164:165], v[164:165] op_sel:[0,1,1] op_sel_hi:[1,1,1]
    v_rcp_f32 v226, v226
    v_rcp_f32 v227, v227
    v_rcp_f32 v228, v228
    v_rcp_f32 v229, v229
    v_pk_mul_f32 v[24:25], v[24:25], v[226:227]
    v_pk_mul_f32 v[26:27], v[26:27], v[228:229]
    v_cvt_pk_bf16_f32 v216, v24, v25
    v_cvt_pk_bf16_f32 v217, v26, v27
    v_or_b32 v216, 1, v216
    s_add_u32 s36, s46, 0
    buffer_store_dwordx4 v[36:39], v2, s[16:19], s36 offen sc1
    v_pk_fma_f32 v[52:53], v[168:169], v[136:137], v[52:53] op_sel_hi:[0,1,1] neg_lo:[1,0,0] neg_hi:[1,0,0]
    v_pk_fma_f32 v[54:55], v[168:169], v[138:139], v[54:55] op_sel_hi:[0,1,1] neg_lo:[1,0,0] neg_hi:[1,0,0]
    v_pk_mul_f32 v[226:227], v[52:53], v[52:53]
    v_pk_mul_f32 v[228:229], v[54:55], v[54:55]
    v_pk_fma_f32 v[226:227], v[226:227], v[170:171], v[170:171] op_sel:[0,1,0] op_sel_hi:[1,1,0]
    v_pk_fma_f32 v[228:229], v[228:229], v[170:171], v[170:171] op_sel:[0,1,0] op_sel_hi:[1,1,0]
    v_pk_mul_f32 v[226:227], v[226:227], v[52:53]
    v_pk_mul_f32 v[228:229], v[228:229], v[54:55]
    v_exp_f32 v226, v226
    v_exp_f32 v227, v227
    v_exp_f32 v228, v228
    v_exp_f32 v229, v229
    v_pk_fma_f32 v[226:227], v[226:227], v[168:169], v[168:169] op_sel:[0,1,1] op_sel_hi:[1,1,1]
    v_pk_fma_f32 v[228:229], v[228:229], v[168:169], v[168:169] op_sel:[0,1,1] op_sel_hi:[1,1,1]
    v_rcp_f32 v226, v226
    v_rcp_f32 v227, v227
    v_rcp_f32 v228, v228
    v_rcp_f32 v229, v229
    v_pk_mul_f32 v[52:53], v[52:53], v[226:227]
    v_pk_mul_f32 v[54:55], v[54:55], v[228:229]
    v_cvt_pk_bf16_f32 v218, v52, v53
    v_cvt_pk_bf16_f32 v219, v54, v55
    v_or_b32 v218, 1, v218
    s_add_u32 s36, s46, 229376
    buffer_store_dwordx4 v[64:67], v2, s[16:19], s36 offen sc1
    v_pk_fma_f32 v[80:81], v[172:173], v[136:137], v[80:81] op_sel_hi:[0,1,1] neg_lo:[1,0,0] neg_hi:[1,0,0]
    v_pk_fma_f32 v[82:83], v[172:173], v[138:139], v[82:83] op_sel_hi:[0,1,1] neg_lo:[1,0,0] neg_hi:[1,0,0]
    v_pk_mul_f32 v[226:227], v[80:81], v[80:81]
    v_pk_mul_f32 v[228:229], v[82:83], v[82:83]
    v_pk_fma_f32 v[226:227], v[226:227], v[174:175], v[174:175] op_sel:[0,1,0] op_sel_hi:[1,1,0]
    v_pk_fma_f32 v[228:229], v[228:229], v[174:175], v[174:175] op_sel:[0,1,0] op_sel_hi:[1,1,0]
    v_pk_mul_f32 v[226:227], v[226:227], v[80:81]
    v_pk_mul_f32 v[228:229], v[228:229], v[82:83]
    v_exp_f32 v226, v226
    v_exp_f32 v227, v227
    v_exp_f32 v228, v228
    v_exp_f32 v229, v229
    v_pk_fma_f32 v[226:227], v[226:227], v[172:173], v[172:173] op_sel:[0,1,1] op_sel_hi:[1,1,1]
    v_pk_fma_f32 v[228:229], v[228:229], v[172:173], v[172:173] op_sel:[0,1,1] op_sel_hi:[1,1,1]
    v_rcp_f32 v226, v226
    v_rcp_f32 v227, v227
    v_rcp_f32 v228, v228
    v_rcp_f32 v229, v229
    v_pk_mul_f32 v[80:81], v[80:81], v[226:227]
    v_pk_mul_f32 v[82:83], v[82:83], v[228:229]
    v_cvt_pk_bf16_f32 v220, v80, v81
    v_cvt_pk_bf16_f32 v221, v82, v83
    v_or_b32 v220, 1, v220
    s_add_u32 s36, s46, 458752
    buffer_store_dwordx4 v[92:95], v2, s[16:19], s36 offen sc1
    v_pk_fma_f32 v[108:109], v[176:177], v[136:137], v[108:109] op_sel_hi:[0,1,1] neg_lo:[1,0,0] neg_hi:[1,0,0]
    v_pk_fma_f32 v[110:111], v[176:177], v[138:139], v[110:111] op_sel_hi:[0,1,1] neg_lo:[1,0,0] neg_hi:[1,0,0]
    v_pk_mul_f32 v[226:227], v[108:109], v[108:109]
    v_pk_mul_f32 v[228:229], v[110:111], v[110:111]
    v_pk_fma_f32 v[226:227], v[226:227], v[178:179], v[178:179] op_sel:[0,1,0] op_sel_hi:[1,1,0]
    v_pk_fma_f32 v[228:229], v[228:229], v[178:179], v[178:179] op_sel:[0,1,0] op_sel_hi:[1,1,0]
    v_pk_mul_f32 v[226:227], v[226:227], v[108:109]
    v_pk_mul_f32 v[228:229], v[228:229], v[110:111]
    v_exp_f32 v226, v226
    v_exp_f32 v227, v227
    v_exp_f32 v228, v228
    v_exp_f32 v229, v229
    v_pk_fma_f32 v[226:227], v[226:227], v[176:177], v[176:177] op_sel:[0,1,1] op_sel_hi:[1,1,1]
    v_pk_fma_f32 v[228:229], v[228:229], v[176:177], v[176:177] op_sel:[0,1,1] op_sel_hi:[1,1,1]
    v_rcp_f32 v226, v226
    v_rcp_f32 v227, v227
    v_rcp_f32 v228, v228
    v_rcp_f32 v229, v229
    v_pk_mul_f32 v[108:109], v[108:109], v[226:227]
    v_pk_mul_f32 v[110:111], v[110:111], v[228:229]
    v_cvt_pk_bf16_f32 v222, v108, v109
    v_cvt_pk_bf16_f32 v223, v110, v111
    s_add_u32 s36, s46, 688128
    buffer_store_dwordx4 v[120:123], v2, s[16:19], s36 offen sc1
    s_waitcnt lgkmcnt(0)
    s_add_u32 s45, s44, 512
    s_mov_b32 s44, s47
G3_e2:
    s_waitcnt lgkmcnt(0)
    s_barrier
    ds_read_b128 v[88:91], v17 offset:0
    ds_read_b128 v[92:95], v17 offset:2048
    ds_read_b128 v[96:99], v17 offset:4096
    ds_read_b128 v[100:103], v17 offset:6144
    ds_read_b64_tr_b16 v[104:105], v18 offset:0
    ds_read_b64_tr_b16 v[106:107], v18 offset:4096
    ds_read_b64_tr_b16 v[108:109], v19 offset:0
    ds_read_b64_tr_b16 v[110:111], v19 offset:4096
    ds_read_b64_tr_b16 v[112:113], v20 offset:0
    ds_read_b64_tr_b16 v[114:115], v20 offset:4096
    ds_read_b64_tr_b16 v[116:117], v21 offset:0
    ds_read_b64_tr_b16 v[118:119], v21 offset:4096
    s_waitcnt lgkmcnt(6)
    v_mfma_f32_16x16x32_bf16 v[24:27], v[104:107], v[88:91], 0
    ds_read_b128 v[120:123], v17 offset:1024
    s_add_u32 s42, s42, 16384
    v_mfma_f32_16x16x32_bf16 v[40:43], v[104:107], v[92:95], 0
    ds_read_b128 v[124:127], v17 offset:3072
    s_cmp_eq_u32 s42, 49152
    v_mfma_f32_16x16x32_bf16 v[56:59], v[104:107], v[96:99], 0
    ds_read_b128 v[128:131], v17 offset:5120
    s_cselect_b32 s42, 0, s42
    v_mfma_f32_16x16x32_bf16 v[72:75], v[104:107], v[100:103], 0
    ds_read_b128 v[132:135], v17 offset:7168
    s_waitcnt lgkmcnt(8)
    v_mfma_f32_16x16x32_bf16 v[76:79], v[108:111], v[100:103], 0
    ds_read_b64_tr_b16 v[136:137], v18 offset:8192
    s_add_u32 s48, s48, 16384
    v_mfma_f32_16x16x32_bf16 v[60:63], v[108:111], v[96:99], 0
    ds_read_b64_tr_b16 v[138:139], v18 offset:12288
    s_cmp_eq_u32 s48, 98304
    v_mfma_f32_16x16x32_bf16 v[44:47], v[108:111], v[92:95], 0
    ds_read_b64_tr_b16 v[140:141], v19 offset:8192
    s_cselect_b32 s48, 0, s48
    v_mfma_f32_16x16x32_bf16 v[28:31], v[108:111], v[88:91], 0
    ds_read_b64_tr_b16 v[142:143], v19 offset:12288
    s_waitcnt lgkmcnt(8)
    v_mfma_f32_16x16x32_bf16 v[32:35], v[112:115], v[88:91], 0
    ds_read_b64_tr_b16 v[144:145], v20 offset:8192
    v_add_u32 v17, s42, v12
    v_mfma_f32_16x16x32_bf16 v[48:51], v[112:115], v[92:95], 0
    ds_read_b64_tr_b16 v[146:147], v20 offset:12288
    s_add_u32 s36, s44, 0
    v_mfma_f32_16x16x32_bf16 v[64:67], v[112:115], v[96:99], 0
    ds_read_b64_tr_b16 v[148:149], v21 offset:8192
    buffer_store_dwordx4 v[200:203], v2, s[16:19], s36 offen sc1
    v_mfma_f32_16x16x32_bf16 v[80:83], v[112:115], v[100:103], 0
    ds_read_b64_tr_b16 v[150:151], v21 offset:12288
    s_add_u32 s36, s45, 0
    v_mfma_f32_16x16x32_bf16 v[84:87], v[116:119], v[100:103], 0
    buffer_store_dwordx2 v[216:217], v238, s[16:19], s36 offen sc1
    v_add_u32 v18, s48, v13
    v_mfma_f32_16x16x32_bf16 v[68:71], v[116:119], v[96:99], 0
    v_add_u32 v19, s48, v14
    v_mfma_f32_16x16x32_bf16 v[52:55], v[116:119], v[92:95], 0
    v_add_u32 v20, s48, v15
    v_mfma_f32_16x16x32_bf16 v[36:39], v[116:119], v[88:91], 0
    v_add_u32 v21, s48, v16
    s_waitcnt lgkmcnt(6)
    v_mfma_f32_16x16x32_bf16 v[24:27], v[136:139], v[120:123], v[24:27]
    v_mfma_f32_16x16x32_bf16 v[40:43], v[136:139], v[124:127], v[40:43]
    v_mfma_f32_16x16x32_bf16 v[56:59], v[136:139], v[128:131], v[56:59]
    s_waitcnt lgkmcnt(0)
    s_barrier
    v_mfma_f32_16x16x32_bf16 v[72:75], v[136:139], v[132:135], v[72:75]
    ds_read_b128 v[88:91], v17 offset:0
    s_add_u32 s36, s44, 229376
    v_mfma_f32_16x16x32_bf16 v[76:79], v[140:143], v[132:135], v[76:79]
    ds_read_b128 v[92:95], v17 offset:2048
    buffer_store_dwordx4 v[204:207], v2, s[16:19], s36 offen sc1
    v_mfma_f32_16x16x32_bf16 v[60:63], v[140:143], v[128:131], v[60:63]
    ds_read_b128 v[96:99], v17 offset:4096
    s_add_u32 s36, s45, 229376
    v_mfma_f32_16x16x32_bf16 v[44:47], v[140:143], v[124:127], v[44:47]
    ds_read_b128 v[100:103], v17 offset:6144
    buffer_store_dwordx2 v[218:219], v238, s[16:19], s36 offen sc1
    v_mfma_f32_16x16x32_bf16 v[28:31], v[140:143], v[120:123], v[28:31]
    ds_read_b64_tr_b16 v[104:105], v18 offset:0
    s_add_u32 s43, s43, 1
    v_mfma_f32_16x16x32_bf16 v[32:35], v[144:147], v[120:123], v[32:35]
    ds_read_b64_tr_b16 v[106:107], v18 offset:4096
    s_cmp_lt_u32 s43, 27
    v_mfma_f32_16x16x32_bf16 v[48:51], v[144:147], v[124:127], v[48:51]
    ds_read_b64_tr_b16 v[108:109], v19 offset:0
    v_mfma_f32_16x16x32_bf16 v[64:67], v[144:147], v[128:131], v[64:67]
    ds_read_b64_tr_b16 v[110:111], v19 offset:4096
    v_mfma_f32_16x16x32_bf16 v[80:83], v[144:147], v[132:135], v[80:83]
    ds_read_b64_tr_b16 v[112:113], v20 offset:0
    v_mfma_f32_16x16x32_bf16 v[84:87], v[148:151], v[132:135], v[84:87]
    ds_read_b64_tr_b16 v[114:115], v20 offset:4096
    v_mfma_f32_16x16x32_bf16 v[68:71], v[148:151], v[128:131], v[68:71]
    ds_read_b64_tr_b16 v[116:117], v21 offset:0
    v_mfma_f32_16x16x32_bf16 v[52:55], v[148:151], v[124:127], v[52:55]
    ds_read_b64_tr_b16 v[118:119], v21 offset:4096
    v_mfma_f32_16x16x32_bf16 v[36:39], v[148:151], v[120:123], v[36:39]
    s_waitcnt lgkmcnt(6)
    v_mfma_f32_16x16x32_bf16 v[24:27], v[104:107], v[88:91], v[24:27]
    ds_read_b128 v[120:123], v17 offset:1024
    s_add_u32 s42, s42, 16384
    v_mfma_f32_16x16x32_bf16 v[40:43], v[104:107], v[92:95], v[40:43]
    ds_read_b128 v[124:127], v17 offset:3072
    s_cmp_eq_u32 s42, 49152
    v_mfma_f32_16x16x32_bf16 v[56:59], v[104:107], v[96:99], v[56:59]
    ds_read_b128 v[128:131], v17 offset:5120
    s_cselect_b32 s42, 0, s42
    v_mfma_f32_16x16x32_bf16 v[72:75], v[104:107], v[100:103], v[72:75]
    ds_read_b128 v[132:135], v17 offset:7168
    s_waitcnt lgkmcnt(8)
    v_mfma_f32_16x16x32_bf16 v[76:79], v[108:111], v[100:103], v[76:79]
    ds_read_b64_tr_b16 v[136:137], v18 offset:8192
    s_add_u32 s48, s48, 16384
    v_mfma_f32_16x16x32_bf16 v[60:63], v[108:111], v[96:99], v[60:63]
    ds_read_b64_tr_b16 v[138:139], v18 offset:12288
    s_cmp_eq_u32 s48, 98304
    v_mfma_f32_16x16x32_bf16 v[44:47], v[108:111], v[92:95], v[44:47]
    ds_read_b64_tr_b16 v[140:141], v19 offset:8192
    s_cselect_b32 s48, 0, s48
    v_mfma_f32_16x16x32_bf16 v[28:31], v[108:111], v[88:91], v[28:31]
    ds_read_b64_tr_b16 v[142:143], v19 offset:12288
    s_waitcnt lgkmcnt(8)
    v_mfma_f32_16x16x32_bf16 v[32:35], v[112:115], v[88:91], v[32:35]
    ds_read_b64_tr_b16 v[144:145], v20 offset:8192
    v_add_u32 v17, s42, v12
    v_mfma_f32_16x16x32_bf16 v[48:51], v[112:115], v[92:95], v[48:51]
    ds_read_b64_tr_b16 v[146:147], v20 offset:12288
    s_add_u32 s36, s44, 458752
    v_mfma_f32_16x16x32_bf16 v[64:67], v[112:115], v[96:99], v[64:67]
    ds_read_b64_tr_b16 v[148:149], v21 offset:8192
    buffer_store_dwordx4 v[208:211], v2, s[16:19], s36 offen sc1
    v_mfma_f32_16x16x32_bf16 v[80:83], v[112:115], v[100:103], v[80:83]
    ds_read_b64_tr_b16 v[150:151], v21 offset:12288
    s_add_u32 s36, s45, 458752
    v_mfma_f32_16x16x32_bf16 v[84:87], v[116:119], v[100:103], v[84:87]
    buffer_store_dwordx2 v[220:221], v238, s[16:19], s36 offen sc1
    v_add_u32 v18, s48, v13
    v_mfma_f32_16x16x32_bf16 v[68:71], v[116:119], v[96:99], v[68:71]
    v_add_u32 v19, s48, v14
    v_mfma_f32_16x16x32_bf16 v[52:55], v[116:119], v[92:95], v[52:55]
    v_add_u32 v20, s48, v15
    v_mfma_f32_16x16x32_bf16 v[36:39], v[116:119], v[88:91], v[36:39]
    v_add_u32 v21, s48, v16
    s_waitcnt lgkmcnt(6)
    v_mfma_f32_16x16x32_bf16 v[24:27], v[136:139], v[120:123], v[24:27]
    v_mfma_f32_16x16x32_bf16 v[40:43], v[136:139], v[124:127], v[40:43]
    s_waitcnt vmcnt(6)
    v_mfma_f32_16x16x32_bf16 v[56:59], v[136:139], v[128:131], v[56:59]
    s_waitcnt lgkmcnt(0)
    s_barrier
    v_mfma_f32_16x16x32_bf16 v[72:75], v[136:139], v[132:135], v[72:75]
    ds_read_b128 v[88:91], v17 offset:0
    s_add_u32 s36, s44, 688128
    v_mfma_f32_16x16x32_bf16 v[76:79], v[140:143], v[132:135], v[76:79]
    ds_read_b128 v[92:95], v17 offset:2048
    buffer_store_dwordx4 v[212:215], v2, s[16:19], s36 offen sc1
    v_mfma_f32_16x16x32_bf16 v[60:63], v[140:143], v[128:131], v[60:63]
    ds_read_b128 v[96:99], v17 offset:4096
    s_add_u32 s36, s45, 688128
    v_mfma_f32_16x16x32_bf16 v[44:47], v[140:143], v[124:127], v[44:47]
    ds_read_b128 v[100:103], v17 offset:6144
    buffer_store_dwordx2 v[222:223], v238, s[16:19], s36 offen sc1
    v_mfma_f32_16x16x32_bf16 v[28:31], v[140:143], v[120:123], v[28:31]
    ds_read_b64_tr_b16 v[104:105], v18 offset:0
    s_add_u32 s43, s43, 1
    v_mfma_f32_16x16x32_bf16 v[32:35], v[144:147], v[120:123], v[32:35]
    ds_read_b64_tr_b16 v[106:107], v18 offset:4096
    s_cmp_lt_u32 s43, 27
    v_mfma_f32_16x16x32_bf16 v[48:51], v[144:147], v[124:127], v[48:51]
    ds_read_b64_tr_b16 v[108:109], v19 offset:0
    v_mfma_f32_16x16x32_bf16 v[64:67], v[144:147], v[128:131], v[64:67]
    ds_read_b64_tr_b16 v[110:111], v19 offset:4096
    v_mfma_f32_16x16x32_bf16 v[80:83], v[144:147], v[132:135], v[80:83]
    ds_read_b64_tr_b16 v[112:113], v20 offset:0
    v_mfma_f32_16x16x32_bf16 v[84:87], v[148:151], v[132:135], v[84:87]
    ds_read_b64_tr_b16 v[114:115], v20 offset:4096
    v_mfma_f32_16x16x32_bf16 v[68:71], v[148:151], v[128:131], v[68:71]
    ds_read_b64_tr_b16 v[116:117], v21 offset:0
    v_mfma_f32_16x16x32_bf16 v[52:55], v[148:151], v[124:127], v[52:55]
    ds_read_b64_tr_b16 v[118:119], v21 offset:4096
    v_mfma_f32_16x16x32_bf16 v[36:39], v[148:151], v[120:123], v[36:39]
    s_waitcnt lgkmcnt(6)
mm_27:
    v_mfma_f32_16x16x32_bf16 v[24:27], v[104:107], v[88:91], v[24:27]
    ds_read_b128 v[120:123], v17 offset:1024
    s_add_u32 s42, s42, 16384
    v_mfma_f32_16x16x32_bf16 v[40:43], v[104:107], v[92:95], v[40:43]
    ds_read_b128 v[124:127], v17 offset:3072
    s_cmp_eq_u32 s42, 49152
    v_mfma_f32_16x16x32_bf16 v[56:59], v[104:107], v[96:99], v[56:59]
    ds_read_b128 v[128:131], v17 offset:5120
    s_cselect_b32 s42, 0, s42
    v_mfma_f32_16x16x32_bf16 v[72:75], v[104:107], v[100:103], v[72:75]
    ds_read_b128 v[132:135], v17 offset:7168
    s_waitcnt lgkmcnt(8)
    v_mfma_f32_16x16x32_bf16 v[76:79], v[108:111], v[100:103], v[76:79]
    ds_read_b64_tr_b16 v[136:137], v18 offset:8192
    s_add_u32 s48, s48, 16384
    v_mfma_f32_16x16x32_bf16 v[60:63], v[108:111], v[96:99], v[60:63]
    ds_read_b64_tr_b16 v[138:139], v18 offset:12288
    s_cmp_eq_u32 s48, 98304
    v_mfma_f32_16x16x32_bf16 v[44:47], v[108:111], v[92:95], v[44:47]
    ds_read_b64_tr_b16 v[140:141], v19 offset:8192
    s_cselect_b32 s48, 0, s48
    v_mfma_f32_16x16x32_bf16 v[28:31], v[108:111], v[88:91], v[28:31]
    ds_read_b64_tr_b16 v[142:143], v19 offset:12288
    s_waitcnt lgkmcnt(8)
    v_mfma_f32_16x16x32_bf16 v[32:35], v[112:115], v[88:91], v[32:35]
    ds_read_b64_tr_b16 v[144:145], v20 offset:8192
    v_add_u32 v17, s42, v12
    v_mfma_f32_16x16x32_bf16 v[48:51], v[112:115], v[92:95], v[48:51]
    ds_read_b64_tr_b16 v[146:147], v20 offset:12288
    v_add_u32 v18, s48, v13
    v_mfma_f32_16x16x32_bf16 v[64:67], v[112:115], v[96:99], v[64:67]
    ds_read_b64_tr_b16 v[148:149], v21 offset:8192
    v_add_u32 v19, s48, v14
    v_mfma_f32_16x16x32_bf16 v[80:83], v[112:115], v[100:103], v[80:83]
    ds_read_b64_tr_b16 v[150:151], v21 offset:12288
    v_add_u32 v20, s48, v15
    v_mfma_f32_16x16x32_bf16 v[84:87], v[116:119], v[100:103], v[84:87]
    v_add_u32 v21, s48, v16
    v_mfma_f32_16x16x32_bf16 v[68:71], v[116:119], v[96:99], v[68:71]
    v_mfma_f32_16x16x32_bf16 v[52:55], v[116:119], v[92:95], v[52:55]
    v_mfma_f32_16x16x32_bf16 v[36:39], v[116:119], v[88:91], v[36:39]
    s_waitcnt lgkmcnt(6)
    v_mfma_f32_16x16x32_bf16 v[24:27], v[136:139], v[120:123], v[24:27]
    s_add_u32 s43, s43, 1
    s_cmp_lt_u32 s43, 4
    v_mfma_f32_16x16x32_bf16 v[40:43], v[136:139], v[124:127], v[40:43]
    v_mfma_f32_16x16x32_bf16 v[56:59], v[136:139], v[128:131], v[56:59]
    s_waitcnt lgkmcnt(0)
    s_barrier
    v_mfma_f32_16x16x32_bf16 v[72:75], v[136:139], v[132:135], v[72:75]
    ds_read_b128 v[88:91], v17 offset:0
    v_mfma_f32_16x16x32_bf16 v[76:79], v[140:143], v[132:135], v[76:79]
    ds_read_b128 v[92:95], v17 offset:2048
    v_mfma_f32_16x16x32_bf16 v[60:63], v[140:143], v[128:131], v[60:63]
    ds_read_b128 v[96:99], v17 offset:4096
    v_mfma_f32_16x16x32_bf16 v[44:47], v[140:143], v[124:127], v[44:47]
    ds_read_b128 v[100:103], v17 offset:6144
    v_mfma_f32_16x16x32_bf16 v[28:31], v[140:143], v[120:123], v[28:31]
    ds_read_b64_tr_b16 v[104:105], v18 offset:0
    v_mfma_f32_16x16x32_bf16 v[32:35], v[144:147], v[120:123], v[32:35]
    ds_read_b64_tr_b16 v[106:107], v18 offset:4096
    v_mfma_f32_16x16x32_bf16 v[48:51], v[144:147], v[124:127], v[48:51]
    ds_read_b64_tr_b16 v[108:109], v19 offset:0
    v_mfma_f32_16x16x32_bf16 v[64:67], v[144:147], v[128:131], v[64:67]
    ds_read_b64_tr_b16 v[110:111], v19 offset:4096
    v_mfma_f32_16x16x32_bf16 v[80:83], v[144:147], v[132:135], v[80:83]
    ds_read_b64_tr_b16 v[112:113], v20 offset:0
    v_mfma_f32_16x16x32_bf16 v[84:87], v[148:151], v[132:135], v[84:87]
    ds_read_b64_tr_b16 v[114:115], v20 offset:4096
    v_mfma_f32_16x16x32_bf16 v[68:71], v[148:151], v[128:131], v[68:71]
    ds_read_b64_tr_b16 v[116:117], v21 offset:0
    v_mfma_f32_16x16x32_bf16 v[52:55], v[148:151], v[124:127], v[52:55]
    ds_read_b64_tr_b16 v[118:119], v21 offset:4096
    v_mfma_f32_16x16x32_bf16 v[36:39], v[148:151], v[120:123], v[36:39]
    s_waitcnt lgkmcnt(6)
    s_cbranch_scc1 mm_27
mm_28:
    v_mfma_f32_16x16x32_bf16 v[24:27], v[104:107], v[88:91], v[24:27]
    ds_read_b128 v[120:123], v17 offset:1024
    s_add_u32 s42, s42, 16384
    v_mfma_f32_16x16x32_bf16 v[40:43], v[104:107], v[92:95], v[40:43]
    ds_read_b128 v[124:127], v17 offset:3072
    s_cmp_eq_u32 s42, 49152
    v_mfma_f32_16x16x32_bf16 v[56:59], v[104:107], v[96:99], v[56:59]
    ds_read_b128 v[128:131], v17 offset:5120
    s_cselect_b32 s42, 0, s42
    v_mfma_f32_16x16x32_bf16 v[72:75], v[104:107], v[100:103], v[72:75]
    ds_read_b128 v[132:135], v17 offset:7168
    s_waitcnt lgkmcnt(8)
    v_mfma_f32_16x16x32_bf16 v[76:79], v[108:111], v[100:103], v[76:79]
    ds_read_b64_tr_b16 v[136:137], v18 offset:8192
    s_add_u32 s48, s48, 16384
    v_mfma_f32_16x16x32_bf16 v[60:63], v[108:111], v[96:99], v[60:63]
    ds_read_b64_tr_b16 v[138:139], v18 offset:12288
    s_cmp_eq_u32 s48, 98304
    v_mfma_f32_16x16x32_bf16 v[44:47], v[108:111], v[92:95], v[44:47]
    ds_read_b64_tr_b16 v[140:141], v19 offset:8192
    s_cselect_b32 s48, 0, s48
    v_mfma_f32_16x16x32_bf16 v[28:31], v[108:111], v[88:91], v[28:31]
    ds_read_b64_tr_b16 v[142:143], v19 offset:12288
    s_waitcnt lgkmcnt(8)
    v_mfma_f32_16x16x32_bf16 v[32:35], v[112:115], v[88:91], v[32:35]
    ds_read_b64_tr_b16 v[144:145], v20 offset:8192
    v_add_u32 v17, s42, v12
    v_mfma_f32_16x16x32_bf16 v[48:51], v[112:115], v[92:95], v[48:51]
    ds_read_b64_tr_b16 v[146:147], v20 offset:12288
    v_add_u32 v18, s48, v13
    v_mfma_f32_16x16x32_bf16 v[64:67], v[112:115], v[96:99], v[64:67]
    ds_read_b64_tr_b16 v[148:149], v21 offset:8192
    v_add_u32 v19, s48, v14
    v_mfma_f32_16x16x32_bf16 v[80:83], v[112:115], v[100:103], v[80:83]
    ds_read_b64_tr_b16 v[150:151], v21 offset:12288
    v_add_u32 v20, s48, v15
    v_mfma_f32_16x16x32_bf16 v[84:87], v[116:119], v[100:103], v[84:87]
    v_add_u32 v21, s48, v16
    v_mfma_f32_16x16x32_bf16 v[68:71], v[116:119], v[96:99], v[68:71]
    v_mfma_f32_16x16x32_bf16 v[52:55], v[116:119], v[92:95], v[52:55]
    v_mfma_f32_16x16x32_bf16 v[36:39], v[116:119], v[88:91], v[36:39]
    s_waitcnt lgkmcnt(6)
    v_mfma_f32_16x16x32_bf16 v[24:27], v[136:139], v[120:123], v[24:27]
    s_add_u32 s43, s43, 1
    s_cmp_lt_u32 s43, 27
    v_mfma_f32_16x16x32_bf16 v[40:43], v[136:139], v[124:127], v[40:43]
    s_waitcnt vmcnt(0)
    v_mfma_f32_16x16x32_bf16 v[56:59], v[136:139], v[128:131], v[56:59]
    s_waitcnt lgkmcnt(0)
    s_barrier
    v_mfma_f32_16x16x32_bf16 v[72:75], v[136:139], v[132:135], v[72:75]
    ds_read_b128 v[88:91], v17 offset:0
    v_mfma_f32_16x16x32_bf16 v[76:79], v[140:143], v[132:135], v[76:79]
    ds_read_b128 v[92:95], v17 offset:2048
    v_mfma_f32_16x16x32_bf16 v[60:63], v[140:143], v[128:131], v[60:63]
    ds_read_b128 v[96:99], v17 offset:4096
    v_mfma_f32_16x16x32_bf16 v[44:47], v[140:143], v[124:127], v[44:47]
    ds_read_b128 v[100:103], v17 offset:6144
    v_mfma_f32_16x16x32_bf16 v[28:31], v[140:143], v[120:123], v[28:31]
    ds_read_b64_tr_b16 v[104:105], v18 offset:0
    v_mfma_f32_16x16x32_bf16 v[32:35], v[144:147], v[120:123], v[32:35]
    ds_read_b64_tr_b16 v[106:107], v18 offset:4096
    v_mfma_f32_16x16x32_bf16 v[48:51], v[144:147], v[124:127], v[48:51]
    ds_read_b64_tr_b16 v[108:109], v19 offset:0
    v_mfma_f32_16x16x32_bf16 v[64:67], v[144:147], v[128:131], v[64:67]
    ds_read_b64_tr_b16 v[110:111], v19 offset:4096
    v_mfma_f32_16x16x32_bf16 v[80:83], v[144:147], v[132:135], v[80:83]
    ds_read_b64_tr_b16 v[112:113], v20 offset:0
    v_mfma_f32_16x16x32_bf16 v[84:87], v[148:151], v[132:135], v[84:87]
    ds_read_b64_tr_b16 v[114:115], v20 offset:4096
    v_mfma_f32_16x16x32_bf16 v[68:71], v[148:151], v[128:131], v[68:71]
    ds_read_b64_tr_b16 v[116:117], v21 offset:0
    v_mfma_f32_16x16x32_bf16 v[52:55], v[148:151], v[124:127], v[52:55]
    ds_read_b64_tr_b16 v[118:119], v21 offset:4096
    v_mfma_f32_16x16x32_bf16 v[36:39], v[148:151], v[120:123], v[36:39]
    s_waitcnt lgkmcnt(6)
    s_cbranch_scc1 mm_28
    s_cmp_eq_u32 s60, 1
    s_cbranch_scc1 G4_last
    v_mfma_f32_16x16x32_bf16 v[24:27], v[104:107], v[88:91], v[24:27]
    ds_read_b128 v[120:123], v17 offset:1024
    v_mfma_f32_16x16x32_bf16 v[40:43], v[104:107], v[92:95], v[40:43]
    ds_read_b128 v[124:127], v17 offset:3072
    v_mfma_f32_16x16x32_bf16 v[56:59], v[104:107], v[96:99], v[56:59]
    ds_read_b128 v[128:131], v17 offset:5120
    v_mfma_f32_16x16x32_bf16 v[72:75], v[104:107], v[100:103], v[72:75]
    ds_read_b128 v[132:135], v17 offset:7168
    s_waitcnt lgkmcnt(8)
    v_mfma_f32_16x16x32_bf16 v[76:79], v[108:111], v[100:103], v[76:79]
    ds_read_b64_tr_b16 v[136:137], v18 offset:8192
    v_mfma_f32_16x16x32_bf16 v[60:63], v[108:111], v[96:99], v[60:63]
    ds_read_b64_tr_b16 v[138:139], v18 offset:12288
    v_mfma_f32_16x16x32_bf16 v[44:47], v[108:111], v[92:95], v[44:47]
    ds_read_b64_tr_b16 v[140:141], v19 offset:8192
    v_mfma_f32_16x16x32_bf16 v[28:31], v[108:111], v[88:91], v[28:31]
    ds_read_b64_tr_b16 v[142:143], v19 offset:12288
    s_waitcnt lgkmcnt(8)
    v_mfma_f32_16x16x32_bf16 v[32:35], v[112:115], v[88:91], v[32:35]
    ds_read_b64_tr_b16 v[144:145], v20 offset:8192
    v_mfma_f32_16x16x32_bf16 v[48:51], v[112:115], v[92:95], v[48:51]
    ds_read_b64_tr_b16 v[146:147], v20 offset:12288
    v_mfma_f32_16x16x32_bf16 v[64:67], v[112:115], v[96:99], v[64:67]
    ds_read_b64_tr_b16 v[148:149], v21 offset:8192
    v_mfma_f32_16x16x32_bf16 v[80:83], v[112:115], v[100:103], v[80:83]
    ds_read_b64_tr_b16 v[150:151], v21 offset:12288
    v_mfma_f32_16x16x32_bf16 v[84:87], v[116:119], v[100:103], v[84:87]
    v_mfma_f32_16x16x32_bf16 v[68:71], v[116:119], v[96:99], v[68:71]
    v_mfma_f32_16x16x32_bf16 v[52:55], v[116:119], v[92:95], v[52:55]
    v_mfma_f32_16x16x32_bf16 v[36:39], v[116:119], v[88:91], v[36:39]
    s_waitcnt lgkmcnt(0)
    v_mfma_f32_16x16x32_bf16 v[24:27], v[136:139], v[120:123], v[24:27]
    s_mul_i32 s36, s31, 524288
    s_add_u32 s36, s36, 0
    s_add_u32 s16, s62, s36
    v_mfma_f32_16x16x32_bf16 v[40:43], v[136:139], v[124:127], v[40:43]
    s_addc_u32 s17, s63, 0
    s_mov_b32 s18, 516096
    s_mov_b32 s19, 0x20000
    v_mfma_f32_16x16x32_bf16 v[56:59], v[136:139], v[128:131], v[56:59]
    v_mfma_f32_16x16x32_bf16 v[72:75], v[136:139], v[132:135], v[72:75]
    v_mfma_f32_16x16x32_bf16 v[76:79], v[140:143], v[132:135], v[76:79]
    v_mfma_f32_16x16x32_bf16 v[60:63], v[140:143], v[128:131], v[60:63]
    v_mfma_f32_16x16x32_bf16 v[44:47], v[140:143], v[124:127], v[44:47]
    v_mfma_f32_16x16x32_bf16 v[28:31], v[140:143], v[120:123], v[28:31]
    v_mfma_f32_16x16x32_bf16 v[32:35], v[144:147], v[120:123], v[32:35]
    v_mfma_f32_16x16x32_bf16 v[48:51], v[144:147], v[124:127], v[48:51]
    v_mfma_f32_16x16x32_bf16 v[64:67], v[144:147], v[128:131], v[64:67]
    v_mfma_f32_16x16x32_bf16 v[80:83], v[144:147], v[132:135], v[80:83]
    v_mfma_f32_16x16x32_bf16 v[84:87], v[148:151], v[132:135], v[84:87]
    v_mfma_f32_16x16x32_bf16 v[68:71], v[148:151], v[128:131], v[68:71]
    v_mfma_f32_16x16x32_bf16 v[52:55], v[148:151], v[124:127], v[52:55]
    v_mfma_f32_16x16x32_bf16 v[36:39], v[148:151], v[120:123], v[36:39]
    s_add_u32 s36, s39, 0
    v_cvt_pk_bf16_f32 v24, v24, v25
    v_cvt_pk_bf16_f32 v25, v26, v27
    v_cvt_pk_bf16_f32 v26, v28, v29
    v_cvt_pk_bf16_f32 v27, v30, v31
    v_or_b32 v24, 1, v24
    buffer_store_dwordx4 v[24:27], v2, s[16:19], s36 offen offset:0 sc1
    v_cvt_pk_bf16_f32 v32, v32, v33
    v_cvt_pk_bf16_f32 v33, v34, v35
    v_cvt_pk_bf16_f32 v34, v36, v37
    v_cvt_pk_bf16_f32 v35, v38, v39
    v_or_b32 v32, 1, v32
    buffer_store_dwordx4 v[32:35], v2, s[16:19], s36 offen offset:1024 sc1
    s_add_u32 s36, s39, 65536
    v_cvt_pk_bf16_f32 v40, v40, v41
    v_cvt_pk_bf16_f32 v41, v42, v43
    v_cvt_pk_bf16_f32 v42, v44, v45
    v_cvt_pk_bf16_f32 v43, v46, v47
    v_or_b32 v40, 1, v40
    buffer_store_dwordx4 v[40:43], v2, s[16:19], s36 offen offset:0 sc1
    v_cvt_pk_bf16_f32 v48, v48, v49
    v_cvt_pk_bf16_f32 v49, v50, v51
    v_cvt_pk_bf16_f32 v50, v52, v53
    v_cvt_pk_bf16_f32 v51, v54, v55
    v_or_b32 v48, 1, v48
    buffer_store_dwordx4 v[48:51], v2, s[16:19], s36 offen offset:1024 sc1
    s_add_u32 s36, s39, 131072
    v_cvt_pk_bf16_f32 v56, v56, v57
    v_cvt_pk_bf16_f32 v57, v58, v59
    v_cvt_pk_bf16_f32 v58, v60, v61
    v_cvt_pk_bf16_f32 v59, v62, v63
    v_or_b32 v56, 1, v56
    buffer_store_dwordx4 v[56:59], v2, s[16:19], s36 offen offset:0 sc1
    v_cvt_pk_bf16_f32 v64, v64, v65
    v_cvt_pk_bf16_f32 v65, v66, v67
    v_cvt_pk_bf16_f32 v66, v68, v69
    v_cvt_pk_bf16_f32 v67, v70, v71
    v_or_b32 v64, 1, v64
    buffer_store_dwordx4 v[64:67], v2, s[16:19], s36 offen offset:1024 sc1
    s_add_u32 s36, s39, 196608
    v_cvt_pk_bf16_f32 v72, v72, v73
    v_cvt_pk_bf16_f32 v73, v74, v75
    v_cvt_pk_bf16_f32 v74, v76, v77
    v_cvt_pk_bf16_f32 v75, v78, v79
    v_or_b32 v72, 1, v72
    buffer_store_dwordx4 v[72:75], v2, s[16:19], s36 offen offset:0 sc1
    v_cvt_pk_bf16_f32 v80, v80, v81
    v_cvt_pk_bf16_f32 v81, v82, v83
    v_cvt_pk_bf16_f32 v82, v84, v85
    v_cvt_pk_bf16_f32 v83, v86, v87
    v_or_b32 v80, 1, v80
    buffer_store_dwordx4 v[80:83], v2, s[16:19], s36 offen offset:1024 sc1
    s_barrier
    s_branch NEXT
G4_last:
    v_mfma_f32_16x16x32_bf16 v[24:27], v[104:107], v[88:91], v[24:27]
    ds_read_b128 v[120:123], v17 offset:1024
    v_mfma_f32_16x16x32_bf16 v[40:43], v[104:107], v[92:95], v[40:43]
    ds_read_b128 v[124:127], v17 offset:3072
    v_mfma_f32_16x16x32_bf16 v[56:59], v[104:107], v[96:99], v[56:59]
    ds_read_b128 v[128:131], v17 offset:5120
    v_mfma_f32_16x16x32_bf16 v[72:75], v[104:107], v[100:103], v[72:75]
    ds_read_b128 v[132:135], v17 offset:7168
    s_waitcnt lgkmcnt(8)
    v_mfma_f32_16x16x32_bf16 v[76:79], v[108:111], v[100:103], v[76:79]
    ds_read_b64_tr_b16 v[136:137], v18 offset:8192
    v_mfma_f32_16x16x32_bf16 v[60:63], v[108:111], v[96:99], v[60:63]
    ds_read_b64_tr_b16 v[138:139], v18 offset:12288
    v_mfma_f32_16x16x32_bf16 v[44:47], v[108:111], v[92:95], v[44:47]
    ds_read_b64_tr_b16 v[140:141], v19 offset:8192
    v_mfma_f32_16x16x32_bf16 v[28:31], v[108:111], v[88:91], v[28:31]
    ds_read_b64_tr_b16 v[142:143], v19 offset:12288
    s_waitcnt lgkmcnt(8)
    v_mfma_f32_16x16x32_bf16 v[32:35], v[112:115], v[88:91], v[32:35]
    ds_read_b64_tr_b16 v[144:145], v20 offset:8192
    v_mfma_f32_16x16x32_bf16 v[48:51], v[112:115], v[92:95], v[48:51]
    ds_read_b64_tr_b16 v[146:147], v20 offset:12288
    s_load_dwordx2 s[6:7], s[0:1], 88
    v_mfma_f32_16x16x32_bf16 v[64:67], v[112:115], v[96:99], v[64:67]
    ds_read_b64_tr_b16 v[148:149], v21 offset:8192
    v_mfma_f32_16x16x32_bf16 v[80:83], v[112:115], v[100:103], v[80:83]
    ds_read_b64_tr_b16 v[150:151], v21 offset:12288
    v_mfma_f32_16x16x32_bf16 v[84:87], v[116:119], v[100:103], v[84:87]
    v_mfma_f32_16x16x32_bf16 v[68:71], v[116:119], v[96:99], v[68:71]
    v_mfma_f32_16x16x32_bf16 v[52:55], v[116:119], v[92:95], v[52:55]
    v_mfma_f32_16x16x32_bf16 v[36:39], v[116:119], v[88:91], v[36:39]
    s_waitcnt lgkmcnt(0)
    v_mfma_f32_16x16x32_bf16 v[24:27], v[136:139], v[120:123], v[24:27]
    s_add_u32 s16, s62, 0x80000
    s_addc_u32 s17, s63, 0
    s_mov_b32 s18, 0x7e000
    v_mfma_f32_16x16x32_bf16 v[40:43], v[136:139], v[124:127], v[40:43]
    s_mov_b32 s19, 0x20000
    s_mov_b32 s20, s6
    s_mov_b32 s21, s7
    v_mfma_f32_16x16x32_bf16 v[56:59], v[136:139], v[128:131], v[56:59]
    s_mov_b32 s22, 0x400000
    s_mov_b32 s23, 0x20000
    s_add_u32 s44, s40, 65536
    v_mfma_f32_16x16x32_bf16 v[72:75], v[136:139], v[132:135], v[72:75]
    s_lshl_b32 s46, s28, 3
    s_add_u32 s46, s46, s37
    s_lshl_b32 s47, s31, 1
    v_mfma_f32_16x16x32_bf16 v[76:79], v[140:143], v[132:135], v[76:79]
    s_add_u32 s46, s46, s47
    s_lshl_b32 s46, s46, 15
    s_lshl_b32 s47, s38, 5
    v_mfma_f32_16x16x32_bf16 v[60:63], v[140:143], v[128:131], v[60:63]
    s_add_u32 s46, s46, s47
    s_add_u32 s47, s46, 32768
    v_and_b32 v225, 1, v23
    v_mfma_f32_16x16x32_bf16 v[44:47], v[140:143], v[124:127], v[44:47]
    v_lshlrev_b32 v224, 11, v22
    v_lshl_add_u32 v224, v225, 5, v224
    v_mfma_f32_16x16x32_bf16 v[28:31], v[140:143], v[120:123], v[28:31]
    v_lshrrev_b32 v225, 1, v23
    v_lshl_add_u32 v224, v225, 4, v224
    v_mfma_f32_16x16x32_bf16 v[32:35], v[144:147], v[120:123], v[32:35]
    v_lshrrev_b32 v225, 3, v22
    v_mul_u32_u24 v225, 16320, v225
    v_mfma_f32_16x16x32_bf16 v[48:51], v[144:147], v[124:127], v[48:51]
    v_sub_u32 v224, v224, v225
    v_add_u32 v225, 16384, v224
    v_mfma_f32_16x16x32_bf16 v[64:67], v[144:147], v[128:131], v[64:67]
    v_mfma_f32_16x16x32_bf16 v[80:83], v[144:147], v[132:135], v[80:83]
    v_mfma_f32_16x16x32_bf16 v[84:87], v[148:151], v[132:135], v[84:87]
    v_mfma_f32_16x16x32_bf16 v[68:71], v[148:151], v[128:131], v[68:71]
    v_mfma_f32_16x16x32_bf16 v[52:55], v[148:151], v[124:127], v[52:55]
    v_mfma_f32_16x16x32_bf16 v[36:39], v[148:151], v[120:123], v[36:39]
    s_cmp_eq_u32 s31, 0
    s_cbranch_scc1 G4_k0
    s_add_u32 s36, s41, 0
    v_cvt_pk_bf16_f32 v24, v24, v25
    v_cvt_pk_bf16_f32 v25, v26, v27
    v_cvt_pk_bf16_f32 v26, v28, v29
    v_cvt_pk_bf16_f32 v27, v30, v31
    v_or_b32 v24, 1, v24
    buffer_store_dwordx4 v[24:27], v2, s[16:19], s36 offen offset:0 sc1
    v_cvt_pk_bf16_f32 v32, v32, v33
    v_cvt_pk_bf16_f32 v33, v34, v35
    v_cvt_pk_bf16_f32 v34, v36, v37
    v_cvt_pk_bf16_f32 v35, v38, v39
    v_or_b32 v32, 1, v32
    buffer_store_dwordx4 v[32:35], v2, s[16:19], s36 offen offset:1024 sc1
    s_add_u32 s36, s41, 65536
    v_cvt_pk_bf16_f32 v40, v40, v41
    v_cvt_pk_bf16_f32 v41, v42, v43
    v_cvt_pk_bf16_f32 v42, v44, v45
    v_cvt_pk_bf16_f32 v43, v46, v47
    v_or_b32 v40, 1, v40
    buffer_store_dwordx4 v[40:43], v2, s[16:19], s36 offen offset:0 sc1
    v_cvt_pk_bf16_f32 v48, v48, v49
    v_cvt_pk_bf16_f32 v49, v50, v51
    v_cvt_pk_bf16_f32 v50, v52, v53
    v_cvt_pk_bf16_f32 v51, v54, v55
    v_or_b32 v48, 1, v48
    buffer_store_dwordx4 v[48:51], v2, s[16:19], s36 offen offset:1024 sc1
    v_pk_mov_b32 v[24:25], v[56:57], v[56:57] op_sel:[0,1]
    v_pk_mov_b32 v[26:27], v[58:59], v[58:59] op_sel:[0,1]
    v_pk_mov_b32 v[28:29], v[60:61], v[60:61] op_sel:[0,1]
    v_pk_mov_b32 v[30:31], v[62:63], v[62:63] op_sel:[0,1]
    v_pk_mov_b32 v[32:33], v[64:65], v[64:65] op_sel:[0,1]
    v_pk_mov_b32 v[34:35], v[66:67], v[66:67] op_sel:[0,1]
    v_pk_mov_b32 v[36:37], v[68:69], v[68:69] op_sel:[0,1]
    v_pk_mov_b32 v[38:39], v[70:71], v[70:71] op_sel:[0,1]
    v_pk_mov_b32 v[40:41], v[72:73], v[72:73] op_sel:[0,1]
    v_pk_mov_b32 v[42:43], v[74:75], v[74:75] op_sel:[0,1]
    v_pk_mov_b32 v[44:45], v[76:77], v[76:77] op_sel:[0,1]
    v_pk_mov_b32 v[46:47], v[78:79], v[78:79] op_sel:[0,1]
    v_pk_mov_b32 v[48:49], v[80:81], v[80:81] op_sel:[0,1]
    v_pk_mov_b32 v[50:51], v[82:83], v[82:83] op_sel:[0,1]
    v_pk_mov_b32 v[52:53], v[84:85], v[84:85] op_sel:[0,1]
    v_pk_mov_b32 v[54:55], v[86:87], v[86:87] op_sel:[0,1]
    s_branch G4_k1
G4_k0:
    s_add_u32 s36, s41, 0
    v_cvt_pk_bf16_f32 v56, v56, v57
    v_cvt_pk_bf16_f32 v57, v58, v59
    v_cvt_pk_bf16_f32 v58, v60, v61
    v_cvt_pk_bf16_f32 v59, v62, v63
    v_or_b32 v56, 1, v56
    buffer_store_dwordx4 v[56:59], v2, s[16:19], s36 offen offset:0 sc1
    v_cvt_pk_bf16_f32 v64, v64, v65
    v_cvt_pk_bf16_f32 v65, v66, v67
    v_cvt_pk_bf16_f32 v66, v68, v69
    v_cvt_pk_bf16_f32 v67, v70, v71
    v_or_b32 v64, 1, v64
    buffer_store_dwordx4 v[64:67], v2, s[16:19], s36 offen offset:1024 sc1
    s_add_u32 s36, s41, 65536
    v_cvt_pk_bf16_f32 v72, v72, v73
    v_cvt_pk_bf16_f32 v73, v74, v75
    v_cvt_pk_bf16_f32 v74, v76, v77
    v_cvt_pk_bf16_f32 v75, v78, v79
    v_or_b32 v72, 1, v72
    buffer_store_dwordx4 v[72:75], v2, s[16:19], s36 offen offset:0 sc1
    v_cvt_pk_bf16_f32 v80, v80, v81
    v_cvt_pk_bf16_f32 v81, v82, v83
    v_cvt_pk_bf16_f32 v82, v84, v85
    v_cvt_pk_bf16_f32 v83, v86, v87
    v_or_b32 v80, 1, v80
    buffer_store_dwordx4 v[80:83], v2, s[16:19], s36 offen offset:1024 sc1
G4_k1:
    s_mov_b32 s78, 0x3f80
    s_mov_b32 s79, 0x3f800000
    v_dot2_f32_bf16 v24, v180, s78, v24
    v_dot2_f32_bf16 v25, v180, s79, v25
    v_dot2_f32_bf16 v26, v181, s78, v26
    v_dot2_f32_bf16 v27, v181, s79, v27
    v_dot2_f32_bf16 v28, v182, s78, v28
    v_dot2_f32_bf16 v29, v182, s79, v29
    v_dot2_f32_bf16 v30, v183, s78, v30
    v_dot2_f32_bf16 v31, v183, s79, v31
    v_dot2_f32_bf16 v32, v188, s78, v32
    v_dot2_f32_bf16 v33, v188, s79, v33
    v_dot2_f32_bf16 v34, v189, s78, v34
    v_dot2_f32_bf16 v35, v189, s79, v35
    v_dot2_f32_bf16 v36, v190, s78, v36
    v_dot2_f32_bf16 v37, v190, s79, v37
    v_dot2_f32_bf16 v38, v191, s78, v38
    v_dot2_f32_bf16 v39, v191, s79, v39
    v_dot2_f32_bf16 v40, v196, s78, v40
    v_dot2_f32_bf16 v41, v196, s79, v41
    v_dot2_f32_bf16 v42, v197, s78, v42
    v_dot2_f32_bf16 v43, v197, s79, v43
    v_dot2_f32_bf16 v44, v198, s78, v44
    v_dot2_f32_bf16 v45, v198, s79, v45
    v_dot2_f32_bf16 v46, v199, s78, v46
    v_dot2_f32_bf16 v47, v199, s79, v47
    v_dot2_f32_bf16 v48, v234, s78, v48
    v_dot2_f32_bf16 v49, v234, s79, v49
    v_dot2_f32_bf16 v50, v235, s78, v50
    v_dot2_f32_bf16 v51, v235, s79, v51
    v_dot2_f32_bf16 v52, v236, s78, v52
    v_dot2_f32_bf16 v53, v236, s79, v53
    v_dot2_f32_bf16 v54, v237, s78, v54
    v_dot2_f32_bf16 v55, v237, s79, v55
    v_dot2_f32_bf16 v24, v184, s78, v24
    v_dot2_f32_bf16 v25, v184, s79, v25
    v_dot2_f32_bf16 v26, v185, s78, v26
    v_dot2_f32_bf16 v27, v185, s79, v27
    v_dot2_f32_bf16 v28, v186, s78, v28
    v_dot2_f32_bf16 v29, v186, s79, v29
    v_dot2_f32_bf16 v30, v187, s78, v30
    v_dot2_f32_bf16 v31, v187, s79, v31
    v_dot2_f32_bf16 v32, v192, s78, v32
    v_dot2_f32_bf16 v33, v192, s79, v33
    v_dot2_f32_bf16 v34, v193, s78, v34
    v_dot2_f32_bf16 v35, v193, s79, v35
    v_dot2_f32_bf16 v36, v194, s78, v36
    v_dot2_f32_bf16 v37, v194, s79, v37
    v_dot2_f32_bf16 v38, v195, s78, v38
    v_dot2_f32_bf16 v39, v195, s79, v39
    v_dot2_f32_bf16 v40, v230, s78, v40
    v_dot2_f32_bf16 v41, v230, s79, v41
    v_dot2_f32_bf16 v42, v231, s78, v42
    v_dot2_f32_bf16 v43, v231, s79, v43
    v_dot2_f32_bf16 v44, v232, s78, v44
    v_dot2_f32_bf16 v45, v232, s79, v45
    v_dot2_f32_bf16 v46, v233, s78, v46
    v_dot2_f32_bf16 v47, v233, s79, v47
    v_dot2_f32_bf16 v48, v248, s78, v48
    v_dot2_f32_bf16 v49, v248, s79, v49
    v_dot2_f32_bf16 v50, v249, s78, v50
    v_dot2_f32_bf16 v51, v249, s79, v51
    v_dot2_f32_bf16 v52, v250, s78, v52
    v_dot2_f32_bf16 v53, v250, s79, v53
    v_dot2_f32_bf16 v54, v251, s78, v54
    v_dot2_f32_bf16 v55, v251, s79, v55
    s_mov_b32 s53, 0
dp_29:
    buffer_load_dwordx4 v[208:211], v2, s[16:19], s40 offen offset:0 sc1
    buffer_load_dwordx4 v[212:215], v2, s[16:19], s40 offen offset:1024 sc1
    buffer_load_dwordx4 v[216:219], v2, s[16:19], s44 offen offset:0 sc1
    buffer_load_dwordx4 v[220:223], v2, s[16:19], s44 offen offset:1024 sc1
    s_waitcnt vmcnt(0)
    v_bitop3_b32 v6, v208, v212, v216 bitop3:0x80
    v_bitop3_b32 v6, v6, v220, 1 bitop3:0x80
    v_cmp_eq_u32 vcc, 0, v6
    s_cbranch_vccz dq_30
    s_sleep 2
    s_add_u32 s53, s53, 1
    s_cmp_lt_u32 s53, s61
    s_cbranch_scc1 dp_29
    s_mov_b32 s61, 0
dq_30:
    v_dot2_f32_bf16 v24, v208, s78, v24
    v_dot2_f32_bf16 v25, v208, s79, v25
    v_dot2_f32_bf16 v26, v209, s78, v26
    v_dot2_f32_bf16 v27, v209, s79, v27
    v_dot2_f32_bf16 v28, v210, s78, v28
    v_dot2_f32_bf16 v29, v210, s79, v29
    v_dot2_f32_bf16 v30, v211, s78, v30
    v_dot2_f32_bf16 v31, v211, s79, v31
    v_cvt_pk_bf16_f32 v24, v24, v25
    v_cvt_pk_bf16_f32 v25, v26, v27
    v_cvt_pk_bf16_f32 v26, v28, v29
    v_cvt_pk_bf16_f32 v27, v30, v31
    s_nop 0
    v_permlane16_swap_b32 v24, v26
    v_permlane16_swap_b32 v25, v27
    v_dot2_f32_bf16 v32, v212, s78, v32
    v_dot2_f32_bf16 v33, v212, s79, v33
    v_dot2_f32_bf16 v34, v213, s78, v34
    v_dot2_f32_bf16 v35, v213, s79, v35
    v_dot2_f32_bf16 v36, v214, s78, v36
    v_dot2_f32_bf16 v37, v214, s79, v37
    v_dot2_f32_bf16 v38, v215, s78, v38
    v_dot2_f32_bf16 v39, v215, s79, v39
    v_cvt_pk_bf16_f32 v32, v32, v33
    v_cvt_pk_bf16_f32 v33, v34, v35
    v_cvt_pk_bf16_f32 v34, v36, v37
    v_cvt_pk_bf16_f32 v35, v38, v39
    s_nop 0
    v_permlane16_swap_b32 v32, v34
    v_permlane16_swap_b32 v33, v35
    v_mov_b32 v36, v24
    v_mov_b32 v37, v25
    v_mov_b32 v38, v26
    v_mov_b32 v39, v27
    v_mov_b32_dpp v24, v32 row_ror:8 row_mask:0xf bank_mask:0xc
    v_mov_b32_dpp v25, v33 row_ror:8 row_mask:0xf bank_mask:0xc
    v_mov_b32_dpp v26, v34 row_ror:8 row_mask:0xf bank_mask:0xc
    v_mov_b32_dpp v27, v35 row_ror:8 row_mask:0xf bank_mask:0xc
    v_mov_b32_dpp v32, v36 row_ror:8 row_mask:0xf bank_mask:0x3
    v_mov_b32_dpp v33, v37 row_ror:8 row_mask:0xf bank_mask:0x3
    v_mov_b32_dpp v34, v38 row_ror:8 row_mask:0xf bank_mask:0x3
    v_mov_b32_dpp v35, v39 row_ror:8 row_mask:0xf bank_mask:0x3
    buffer_store_dwordx4 v[24:27], v224, s[20:23], s46 offen sc1
    buffer_store_dwordx4 v[32:35], v225, s[20:23], s46 offen sc1
    v_dot2_f32_bf16 v40, v216, s78, v40
    v_dot2_f32_bf16 v41, v216, s79, v41
    v_dot2_f32_bf16 v42, v217, s78, v42
    v_dot2_f32_bf16 v43, v217, s79, v43
    v_dot2_f32_bf16 v44, v218, s78, v44
    v_dot2_f32_bf16 v45, v218, s79, v45
    v_dot2_f32_bf16 v46, v219, s78, v46
    v_dot2_f32_bf16 v47, v219, s79, v47
    v_cvt_pk_bf16_f32 v40, v40, v41
    v_cvt_pk_bf16_f32 v41, v42, v43
    v_cvt_pk_bf16_f32 v42, v44, v45
    v_cvt_pk_bf16_f32 v43, v46, v47
    s_nop 0
    v_permlane16_swap_b32 v40, v42
    v_permlane16_swap_b32 v41, v43
    v_dot2_f32_bf16 v48, v220, s78, v48
    v_dot2_f32_bf16 v49, v220, s79, v49
    v_dot2_f32_bf16 v50, v221, s78, v50
    v_dot2_f32_bf16 v51, v221, s79, v51
    v_dot2_f32_bf16 v52, v222, s78, v52
    v_dot2_f32_bf16 v53, v222, s79, v53
    v_dot2_f32_bf16 v54, v223, s78, v54
    v_dot2_f32_bf16 v55, v223, s79, v55
    v_cvt_pk_bf16_f32 v48, v48, v49
    v_cvt_pk_bf16_f32 v49, v50, v51
    v_cvt_pk_bf16_f32 v50, v52, v53
    v_cvt_pk_bf16_f32 v51, v54, v55
    s_nop 0
    v_permlane16_swap_b32 v48, v50
    v_permlane16_swap_b32 v49, v51
    v_mov_b32 v52, v40
    v_mov_b32 v53, v41
    v_mov_b32 v54, v42
    v_mov_b32 v55, v43
    v_mov_b32_dpp v40, v48 row_ror:8 row_mask:0xf bank_mask:0xc
    v_mov_b32_dpp v41, v49 row_ror:8 row_mask:0xf bank_mask:0xc
    v_mov_b32_dpp v42, v50 row_ror:8 row_mask:0xf bank_mask:0xc
    v_mov_b32_dpp v43, v51 row_ror:8 row_mask:0xf bank_mask:0xc
    v_mov_b32_dpp v48, v52 row_ror:8 row_mask:0xf bank_mask:0x3
    v_mov_b32_dpp v49, v53 row_ror:8 row_mask:0xf bank_mask:0x3
    v_mov_b32_dpp v50, v54 row_ror:8 row_mask:0xf bank_mask:0x3
    v_mov_b32_dpp v51, v55 row_ror:8 row_mask:0xf bank_mask:0x3
    buffer_store_dwordx4 v[40:43], v224, s[20:23], s47 offen sc1
    buffer_store_dwordx4 v[48:51], v225, s[20:23], s47 offen sc1
    s_branch K_fin
LOADERS:
    s_cmp_lg_u32 s60, 0
    s_cbranch_scc1 pr_31
    s_and_b32 s36, s29, 6
    s_cmp_eq_u32 s36, 2
    s_cbranch_scc0 pr_31
    s_call_b64 s[76:77], SUB_park2
pr_31:
    s_cmp_ge_u32 s30, 6
    s_cbranch_scc1 WLOAD
    s_add_u32 s54, s55, 0x500
    v_mov_b32 v222, s54
    s_lshl_b32 s53, s29, 7
    s_add_u32 s53, s53, 23121920
    v_mov_b32 v226, s53
    s_sleep 30
    s_mov_b64 exec, 1
    buffer_load_dword v227, v226, s[56:59], 0 offen sc1
    s_mov_b64 exec, -1
    s_waitcnt vmcnt(0)
    v_readfirstlane_b32 s53, v227
    s_add_u32 s54, s52, 16
    s_cmp_eq_u32 s53, s54
    s_cbranch_scc1 fok_32
    s_mov_b32 s53, 0
    s_add_u32 s54, s52, 16
    s_bfm_b64 exec, 1, 0
poll_33:
    buffer_load_dword v227, v226, s[56:59], 0 offen sc1
    s_waitcnt vmcnt(0)
    v_xor_b32 v227, s54, v227
    v_cmp_eq_u32 vcc, 0, v227
    s_nop 0
    s_cmp_eq_u64 vcc, exec
    s_cbranch_scc1 pok_34
    s_sleep 5
    s_add_u32 s53, s53, 1
    s_cmp_lt_u32 s53, s61
    s_cbranch_scc1 poll_33
    s_mov_b32 s61, 0
pok_34:
    s_mov_b64 exec, -1
fok_32:
    s_add_u32 s24, s4, 0x1400000
    s_addc_u32 s25, s5, 0
    s_mov_b32 s26, 0x20000
    s_mov_b32 s27, 0x20000
    s_cmp_eq_u32 s60, 0
    s_cselect_b32 s26, s26, 0
    s_and_b32 s36, s30, 1
    s_mul_i32 s36, s36, 128
    s_mul_i32 s37, s29, 256
    s_add_u32 s37, s36, s37
    v_lshrrev_b32 v224, 3, v1
    v_mul_u32_u24 v224, 4096, v224
    v_and_b32 v23, 112, v2
    v_add_u32 v224, v224, v23
    s_cmp_eq_u32 s60, 0
    s_cselect_b64 exec, -1, 0
    buffer_load_dwordx4 v[24:27], v224, s[24:27], s37 offen sc1
    s_add_u32 s37, s37, 32768
    buffer_load_dwordx4 v[28:31], v224, s[24:27], s37 offen sc1
    s_add_u32 s37, s37, 32768
    buffer_load_dwordx4 v[32:35], v224, s[24:27], s37 offen sc1
    s_add_u32 s37, s37, 32768
    buffer_load_dwordx4 v[36:39], v224, s[24:27], s37 offen sc1
    s_add_u32 s37, s37, 32768
    s_mov_b64 exec, -1
    s_mov_b64 exec, 1
    buffer_load_dword v223, v222, s[56:59], 0 offen sc1
    s_mov_b64 exec, -1
    s_waitcnt vmcnt(0)
    v_readfirstlane_b32 s53, v223
    s_add_u32 s54, s52, 16
    s_cmp_eq_u32 s53, s54
    s_cbranch_scc1 fok_35
    s_mov_b32 s53, 0
    s_add_u32 s54, s52, 16
    s_bfm_b64 exec, 1, 0
poll_36:
    buffer_load_dword v223, v222, s[56:59], 0 offen sc1
    s_waitcnt vmcnt(0)
    v_xor_b32 v223, s54, v223
    v_cmp_eq_u32 vcc, 0, v223
    s_nop 0
    s_cmp_eq_u64 vcc, exec
    s_cbranch_scc1 pok_37
    s_sleep 5
    s_add_u32 s53, s53, 1
    s_cmp_lt_u32 s53, s61
    s_cbranch_scc1 poll_36
    s_mov_b32 s61, 0
pok_37:
    s_mov_b64 exec, -1
fok_35:
    s_add_u32 s20, s62, 0x5d0000
    s_addc_u32 s21, s63, 0
    s_mov_b32 s22, 0x800
    s_mov_b32 s23, 0x20000
    s_and_b32 s35, s30, 1
    s_lshl_b32 s35, s35, 10
    buffer_load_dwordx4 v[16:19], v2, s[20:23], s35 offen sc1
    s_cmp_lg_u32 s60, 0
    s_cbranch_scc1 pc_38
    v_add_f32 v24, v24, v28
    v_add_f32 v25, v25, v29
    v_add_f32 v26, v26, v30
    v_add_f32 v27, v27, v31
    v_add_f32 v24, v24, v32
    v_add_f32 v25, v25, v33
    v_add_f32 v26, v26, v34
    v_add_f32 v27, v27, v35
    v_add_f32 v24, v24, v36
    v_add_f32 v25, v25, v37
    v_add_f32 v26, v26, v38
    v_add_f32 v27, v27, v39
    v_add_f32_dpp v24, v24, v24 row_ror:8 row_mask:0xf bank_mask:0xf
    v_add_f32_dpp v25, v25, v25 row_ror:8 row_mask:0xf bank_mask:0xf
    v_add_f32_dpp v26, v26, v26 row_ror:8 row_mask:0xf bank_mask:0xf
    v_add_f32_dpp v27, v27, v27 row_ror:8 row_mask:0xf bank_mask:0xf
    v_mov_b32 v28, v24
    v_mov_b32 v29, v25
    v_mov_b32 v30, v26
    v_mov_b32 v31, v27
    v_permlane16_swap_b32 v24, v28
    v_permlane16_swap_b32 v25, v29
    v_permlane16_swap_b32 v26, v30
    v_permlane16_swap_b32 v27, v31
    v_add_f32 v24, v24, v28
    v_add_f32 v25, v25, v29
    v_add_f32 v26, v26, v30
    v_add_f32 v27, v27, v31
    v_mov_b32 v28, v24
    v_mov_b32 v29, v25
    v_mov_b32 v30, v26
    v_mov_b32 v31, v27
    v_permlane32_swap_b32 v24, v28
    v_permlane32_swap_b32 v25, v29
    v_permlane32_swap_b32 v26, v30
    v_permlane32_swap_b32 v27, v31
    v_add_f32 v24, v24, v28
    v_add_f32 v25, v25, v29
    v_add_f32 v26, v26, v30
    v_add_f32 v27, v27, v31
pc_38:
    s_cmp_lg_u32 s60, 0
    s_cbranch_scc1 pc_39
    s_and_b32 s36, s30, 1
    s_mul_i32 s36, s36, 128
    s_add_u32 s36, s36, 163328
    v_add_u32 v23, s36, v2
    s_bfm_b64 exec, 8, 0
    ds_write_b128 v23, v[24:27]
    s_mov_b64 exec, -1
    s_waitcnt lgkmcnt(0)
pc_39:
    s_waitcnt vmcnt(0)
    s_and_b32 s36, s30, 1
    s_lshl_b32 s36, s36, 10
    s_add_u32 s36, s36, 160768
    v_add_u32 v221, s36, v2
    ds_write_b128 v221, v[16:19]
    s_waitcnt lgkmcnt(0)
    s_cmp_lg_u32 s30, 4
    s_cbranch_scc1 AL_nw
    s_cmp_eq_u32 s60, 0
    s_cbranch_scc1 AL_nw
    s_add_u32 s54, s55, 0xffc00300
    s_add_u32 s53, s54, s92
    v_mov_b32 v9, s53
    s_add_u32 s53, s53, 128
    v_writelane_b32 v9, s53, 1
    s_add_u32 s53, s54, s93
    v_writelane_b32 v9, s53, 2
    s_add_u32 s53, s53, 128
    v_writelane_b32 v9, s53, 3
    s_mov_b32 s53, 0
    s_add_u32 s54, s52, 8
    s_bfm_b64 exec, 4, 0
poll_41:
    buffer_load_dword v8, v9, s[56:59], 0 offen sc1
    s_waitcnt vmcnt(0)
    v_xor_b32 v8, s54, v8
    v_cmp_eq_u32 vcc, 0, v8
    s_nop 0
    s_cmp_eq_u64 vcc, exec
    s_cbranch_scc1 pok_42
    s_sleep 5
    s_add_u32 s53, s53, 1
    s_cmp_lt_u32 s53, s61
    s_cbranch_scc1 poll_41
    s_mov_b32 s61, 0
pok_42:
    s_mov_b64 exec, -1
AL_nw:
    s_and_b32 s36, s30, 1
    s_lshl_b32 s36, s36, 12
    s_add_u32 s36, s36, 32768
    v_add_u32 v6, s36, v2
    ds_read_b128 v[16:19], v6 offset:0
    ds_read_b128 v[20:23], v6 offset:1024
    ds_read_b128 v[24:27], v6 offset:2048
    ds_read_b128 v[28:31], v6 offset:3072
    ds_read_b128 v[32:35], v6 offset:8192
    ds_read_b128 v[36:39], v6 offset:9216
    ds_read_b128 v[40:43], v6 offset:10240
    ds_read_b128 v[44:47], v6 offset:11264
    s_waitcnt lgkmcnt(0)
    s_barrier
    s_call_b64 s[76:77], SUB_after_g1
    s_barrier
    s_waitcnt vmcnt(0)
    s_barrier
    s_call_b64 s[76:77], SUB_after_g2
    s_and_b32 s35, s30, 1
    s_add_u32 s12, s62, 0x80000
    s_addc_u32 s13, s63, 0
    s_mov_b32 s14, 0x7e000
    s_mov_b32 s15, 0x20000
    s_mul_i32 s38, s35, 262144
    s_lshl_b32 s41, s35, 13
    s_mov_b32 s42, 0
    s_mov_b32 s44, 0
    s_add_u32 s54, s55, 0x200
    v_mov_b32 v9, s54
    s_mov_b32 s44, 1
    s_mov_b32 s42, 16384
    s_add_u32 s54, s55, 0x580
    v_mov_b32 v222, s54
    v_lshlrev_b32 v221, 3, v1
    s_add_u32 s19, s41, s42
    v_readlane_b32 s16, v248, s44
    s_nop 0
    s_add_u32 s16, s16, s38
    s_add_u32 s44, s44, 1
    s_and_b32 s44, s44, 15
    s_add_u32 s42, s42, 16384
    s_cmp_eq_u32 s42, 49152
    s_cselect_b32 s42, 0, s42
    s_mov_b32 m0, s19
    s_mov_b32 s39, s16
    s_waitcnt vmcnt(63)
    s_barrier
    s_sleep 6
    s_mov_b32 s53, 0
    s_add_u32 s54, s52, 16
    s_bfm_b64 exec, 1, 0
poll_43:
    buffer_load_dword v8, v9, s[56:59], 0 offen sc1
    s_waitcnt vmcnt(0)
    v_xor_b32 v8, s54, v8
    v_cmp_eq_u32 vcc, 0, v8
    s_nop 0
    s_cmp_eq_u64 vcc, exec
    s_cbranch_scc1 pok_44
    s_sleep 5
    s_add_u32 s53, s53, 1
    s_cmp_lt_u32 s53, s61
    s_cbranch_scc1 poll_43
    s_mov_b32 s61, 0
pok_44:
    s_mov_b64 exec, -1
    buffer_load_dwordx4 v2, s[12:15], s39 offen sc1 lds
    buffer_load_dwordx4 v2, s[12:15], s39 offen offset:1024 sc1 lds
    s_add_u32 m0, m0, 2048
    s_add_u32 s39, s39, 65536
    buffer_load_dwordx4 v2, s[12:15], s39 offen sc1 lds
    buffer_load_dwordx4 v2, s[12:15], s39 offen offset:1024 sc1 lds
    s_add_u32 s19, s41, s42
    v_readlane_b32 s16, v248, s44
    s_nop 0
    s_add_u32 s16, s16, s38
    s_add_u32 s44, s44, 1
    s_and_b32 s44, s44, 15
    s_add_u32 s42, s42, 16384
    s_cmp_eq_u32 s42, 49152
    s_cselect_b32 s42, 0, s42
    s_add_u32 m0, m0, 2048
    s_add_u32 s39, s39, 65536
    buffer_load_dwordx4 v2, s[12:15], s39 offen sc1 lds
    buffer_load_dwordx4 v2, s[12:15], s39 offen offset:1024 sc1 lds
    s_add_u32 m0, m0, 2048
    s_add_u32 s39, s39, 65536
    buffer_load_dwordx4 v2, s[12:15], s39 offen sc1 lds
    buffer_load_dwordx4 v2, s[12:15], s39 offen offset:1024 sc1 lds
    s_mov_b32 m0, s19
    s_mov_b32 s39, s16
    buffer_load_dwordx4 v2, s[12:15], s39 offen sc1 lds
    buffer_load_dwordx4 v2, s[12:15], s39 offen offset:1024 sc1 lds
    s_add_u32 m0, m0, 2048
    s_add_u32 s39, s39, 65536
    buffer_load_dwordx4 v2, s[12:15], s39 offen sc1 lds
    buffer_load_dwordx4 v2, s[12:15], s39 offen offset:1024 sc1 lds
    s_add_u32 s19, s41, s42
    v_readlane_b32 s16, v248, s44
    s_nop 0
    s_add_u32 s16, s16, s38
    s_add_u32 s44, s44, 1
    s_and_b32 s44, s44, 15
    s_add_u32 s42, s42, 16384
    s_cmp_eq_u32 s42, 49152
    s_cselect_b32 s42, 0, s42
    s_add_u32 m0, m0, 2048
    s_add_u32 s39, s39, 65536
    buffer_load_dwordx4 v2, s[12:15], s39 offen sc1 lds
    buffer_load_dwordx4 v2, s[12:15], s39 offen offset:1024 sc1 lds
    s_add_u32 m0, m0, 2048
    s_add_u32 s39, s39, 65536
    buffer_load_dwordx4 v2, s[12:15], s39 offen sc1 lds
    buffer_load_dwordx4 v2, s[12:15], s39 offen offset:1024 sc1 lds
    s_mov_b32 m0, s19
    s_mov_b32 s39, s16
    s_waitcnt vmcnt(8)
    s_barrier
    buffer_load_dwordx4 v2, s[12:15], s39 offen sc1 lds
    buffer_load_dwordx4 v2, s[12:15], s39 offen offset:1024 sc1 lds
    s_add_u32 m0, m0, 2048
    s_add_u32 s39, s39, 65536
    buffer_load_dwordx4 v2, s[12:15], s39 offen sc1 lds
    buffer_load_dwordx4 v2, s[12:15], s39 offen offset:1024 sc1 lds
    s_add_u32 s19, s41, s42
    v_readlane_b32 s16, v248, s44
    s_nop 0
    s_add_u32 s16, s16, s38
    s_add_u32 s44, s44, 1
    s_and_b32 s44, s44, 15
    s_add_u32 s42, s42, 16384
    s_cmp_eq_u32 s42, 49152
    s_cselect_b32 s42, 0, s42
    s_add_u32 m0, m0, 2048
    s_add_u32 s39, s39, 65536
    buffer_load_dwordx4 v2, s[12:15], s39 offen sc1 lds
    buffer_load_dwordx4 v2, s[12:15], s39 offen offset:1024 sc1 lds
    s_add_u32 m0, m0, 2048
    s_add_u32 s39, s39, 65536
    buffer_load_dwordx4 v2, s[12:15], s39 offen sc1 lds
    buffer_load_dwordx4 v2, s[12:15], s39 offen offset:1024 sc1 lds
    s_mov_b32 m0, s19
    s_mov_b32 s39, s16
    s_add_u32 s24, s4, 0x1420000
    s_addc_u32 s25, s5, 0
    s_mov_b32 s26, 0x70000
    s_mov_b32 s27, 0x20000
    s_cmp_eq_u32 s60, 0
    s_cselect_b32 s26, s26, 0
    s_and_b32 s36, s30, 1
    s_mul_i32 s36, s36, 448
    s_mul_i32 s37, s29, 896
    s_add_u32 s37, s36, s37
    v_lshrrev_b32 v224, 5, v1
    v_mul_u32_u24 v224, 14336, v224
    v_and_b32 v179, 496, v2
    v_add_u32 v224, v224, v179
    s_cmp_eq_u32 s60, 0
    s_cselect_b64 exec, -1, 0
    buffer_load_dwordx4 v[180:183], v224, s[24:27], s37 offen sc1
    s_add_u32 s37, s37, 28672
    buffer_load_dwordx4 v[184:187], v224, s[24:27], s37 offen sc1
    s_add_u32 s37, s37, 28672
    buffer_load_dwordx4 v[188:191], v224, s[24:27], s37 offen sc1
    s_add_u32 s37, s37, 28672
    buffer_load_dwordx4 v[192:195], v224, s[24:27], s37 offen sc1
    s_add_u32 s37, s37, 28672
    buffer_load_dwordx4 v[196:199], v224, s[24:27], s37 offen sc1
    s_add_u32 s37, s37, 28672
    s_mov_b64 exec, -1
    s_waitcnt vmcnt(13)
    s_barrier
    buffer_load_dwordx4 v2, s[12:15], s39 offen sc1 lds
    buffer_load_dwordx4 v2, s[12:15], s39 offen offset:1024 sc1 lds
    s_add_u32 m0, m0, 2048
    s_add_u32 s39, s39, 65536
    buffer_load_dwordx4 v2, s[12:15], s39 offen sc1 lds
    buffer_load_dwordx4 v2, s[12:15], s39 offen offset:1024 sc1 lds
    s_add_u32 s19, s41, s42
    v_readlane_b32 s16, v248, s44
    s_nop 0
    s_add_u32 s16, s16, s38
    s_add_u32 s44, s44, 1
    s_and_b32 s44, s44, 15
    s_add_u32 s42, s42, 16384
    s_cmp_eq_u32 s42, 49152
    s_cselect_b32 s42, 0, s42
    s_add_u32 m0, m0, 2048
    s_add_u32 s39, s39, 65536
    buffer_load_dwordx4 v2, s[12:15], s39 offen sc1 lds
    buffer_load_dwordx4 v2, s[12:15], s39 offen offset:1024 sc1 lds
    s_add_u32 m0, m0, 2048
    s_add_u32 s39, s39, 65536
    buffer_load_dwordx4 v2, s[12:15], s39 offen sc1 lds
    buffer_load_dwordx4 v2, s[12:15], s39 offen offset:1024 sc1 lds
    s_mov_b32 m0, s19
    s_mov_b32 s39, s16
    s_cmp_eq_u32 s60, 0
    s_cselect_b64 exec, -1, 0
    buffer_load_dwordx4 v[200:203], v224, s[24:27], s37 offen sc1
    s_add_u32 s37, s37, 28672
    buffer_load_dwordx4 v[204:207], v224, s[24:27], s37 offen sc1
    s_add_u32 s37, s37, 28672
    buffer_load_dwordx4 v[208:211], v224, s[24:27], s37 offen sc1
    s_add_u32 s37, s37, 28672
    buffer_load_dwordx4 v[212:215], v224, s[24:27], s37 offen sc1
    s_add_u32 s37, s37, 28672
    s_mov_b64 exec, -1
    s_waitcnt vmcnt(17)
    s_barrier
    buffer_load_dwordx4 v2, s[12:15], s39 offen sc1 lds
    buffer_load_dwordx4 v2, s[12:15], s39 offen offset:1024 sc1 lds
    s_add_u32 m0, m0, 2048
    s_add_u32 s39, s39, 65536
    buffer_load_dwordx4 v2, s[12:15], s39 offen sc1 lds
    buffer_load_dwordx4 v2, s[12:15], s39 offen offset:1024 sc1 lds
    s_add_u32 s19, s41, s42
    v_readlane_b32 s16, v248, s44
    s_nop 0
    s_add_u32 s16, s16, s38
    s_add_u32 s44, s44, 1
    s_and_b32 s44, s44, 15
    s_add_u32 s42, s42, 16384
    s_cmp_eq_u32 s42, 49152
    s_cselect_b32 s42, 0, s42
    s_add_u32 m0, m0, 2048
    s_add_u32 s39, s39, 65536
    buffer_load_dwordx4 v2, s[12:15], s39 offen sc1 lds
    buffer_load_dwordx4 v2, s[12:15], s39 offen offset:1024 sc1 lds
    s_add_u32 m0, m0, 2048
    s_add_u32 s39, s39, 65536
    buffer_load_dwordx4 v2, s[12:15], s39 offen sc1 lds
    buffer_load_dwordx4 v2, s[12:15], s39 offen offset:1024 sc1 lds
    s_mov_b32 m0, s19
    s_mov_b32 s39, s16
    s_waitcnt vmcnt(12)
    s_barrier
    buffer_load_dwordx4 v2, s[12:15], s39 offen sc1 lds
    buffer_load_dwordx4 v2, s[12:15], s39 offen offset:1024 sc1 lds
    s_add_u32 m0, m0, 2048
    s_add_u32 s39, s39, 65536
    buffer_load_dwordx4 v2, s[12:15], s39 offen sc1 lds
    buffer_load_dwordx4 v2, s[12:15], s39 offen offset:1024 sc1 lds
    s_add_u32 s19, s41, s42
    v_readlane_b32 s16, v248, s44
    s_nop 0
    s_add_u32 s16, s16, s38
    s_add_u32 s44, s44, 1
    s_and_b32 s44, s44, 15
    s_add_u32 s42, s42, 16384
    s_cmp_eq_u32 s42, 49152
    s_cselect_b32 s42, 0, s42
    s_add_u32 m0, m0, 2048
    s_add_u32 s39, s39, 65536
    buffer_load_dwordx4 v2, s[12:15], s39 offen sc1 lds
    buffer_load_dwordx4 v2, s[12:15], s39 offen offset:1024 sc1 lds
    s_add_u32 m0, m0, 2048
    s_add_u32 s39, s39, 65536
    buffer_load_dwordx4 v2, s[12:15], s39 offen sc1 lds
    buffer_load_dwordx4 v2, s[12:15], s39 offen offset:1024 sc1 lds
    s_mov_b32 m0, s19
    s_mov_b32 s39, s16
    s_waitcnt vmcnt(16)
    s_cmp_lg_u32 s60, 0
    s_cbranch_scc1 pc_45
    v_add_f32 v180, v180, v184
    v_add_f32 v181, v181, v185
    v_add_f32 v182, v182, v186
    v_add_f32 v183, v183, v187
    v_add_f32 v180, v180, v188
    v_add_f32 v181, v181, v189
    v_add_f32 v182, v182, v190
    v_add_f32 v183, v183, v191
    v_add_f32 v180, v180, v192
    v_add_f32 v181, v181, v193
    v_add_f32 v182, v182, v194
    v_add_f32 v183, v183, v195
    v_add_f32 v180, v180, v196
    v_add_f32 v181, v181, v197
    v_add_f32 v182, v182, v198
    v_add_f32 v183, v183, v199
    v_add_f32 v180, v180, v200
    v_add_f32 v181, v181, v201
    v_add_f32 v182, v182, v202
    v_add_f32 v183, v183, v203
    v_add_f32 v180, v180, v204
    v_add_f32 v181, v181, v205
    v_add_f32 v182, v182, v206
    v_add_f32 v183, v183, v207
    v_add_f32 v180, v180, v208
    v_add_f32 v181, v181, v209
    v_add_f32 v182, v182, v210
    v_add_f32 v183, v183, v211
    v_add_f32 v180, v180, v212
    v_add_f32 v181, v181, v213
    v_add_f32 v182, v182, v214
    v_add_f32 v183, v183, v215
pc_45:
    s_cmp_eq_u32 s60, 0
    s_cselect_b64 exec, -1, 0
    buffer_load_dwordx4 v[184:187], v224, s[24:27], s37 offen sc1
    s_add_u32 s37, s37, 28672
    buffer_load_dwordx4 v[188:191], v224, s[24:27], s37 offen sc1
    s_add_u32 s37, s37, 28672
    buffer_load_dwordx4 v[192:195], v224, s[24:27], s37 offen sc1
    s_add_u32 s37, s37, 28672
    buffer_load_dwordx4 v[196:199], v224, s[24:27], s37 offen sc1
    s_add_u32 s37, s37, 28672
    buffer_load_dwordx4 v[200:203], v224, s[24:27], s37 offen sc1
    s_add_u32 s37, s37, 28672
    buffer_load_dwordx4 v[204:207], v224, s[24:27], s37 offen sc1
    s_add_u32 s37, s37, 28672
    buffer_load_dwordx4 v[208:211], v224, s[24:27], s37 offen sc1
    s_add_u32 s37, s37, 28672
    s_mov_b64 exec, -1
    s_waitcnt vmcnt(15)
    s_barrier
    buffer_load_dwordx4 v2, s[12:15], s39 offen sc1 lds
    buffer_load_dwordx4 v2, s[12:15], s39 offen offset:1024 sc1 lds
    s_add_u32 m0, m0, 2048
    s_add_u32 s39, s39, 65536
    buffer_load_dwordx4 v2, s[12:15], s39 offen sc1 lds
    buffer_load_dwordx4 v2, s[12:15], s39 offen offset:1024 sc1 lds
    s_add_u32 s19, s41, s42
    v_readlane_b32 s16, v248, s44
    s_nop 0
    s_add_u32 s16, s16, s38
    s_add_u32 s44, s44, 1
    s_and_b32 s44, s44, 15
    s_add_u32 s42, s42, 16384
    s_cmp_eq_u32 s42, 49152
    s_cselect_b32 s42, 0, s42
    s_add_u32 m0, m0, 2048
    s_add_u32 s39, s39, 65536
    buffer_load_dwordx4 v2, s[12:15], s39 offen sc1 lds
    buffer_load_dwordx4 v2, s[12:15], s39 offen offset:1024 sc1 lds
    s_add_u32 m0, m0, 2048
    s_add_u32 s39, s39, 65536
    buffer_load_dwordx4 v2, s[12:15], s39 offen sc1 lds
    buffer_load_dwordx4 v2, s[12:15], s39 offen offset:1024 sc1 lds
    s_mov_b32 m0, s19
    s_mov_b32 s39, s16
    s_mov_b64 exec, 1
    buffer_load_dword v223, v222, s[56:59], 0 offen sc1
    s_mov_b64 exec, -1
    s_waitcnt vmcnt(16)
    s_barrier
    buffer_load_dwordx4 v2, s[12:15], s39 offen sc1 lds
    buffer_load_dwordx4 v2, s[12:15], s39 offen offset:1024 sc1 lds
    s_add_u32 m0, m0, 2048
    s_add_u32 s39, s39, 65536
    buffer_load_dwordx4 v2, s[12:15], s39 offen sc1 lds
    buffer_load_dwordx4 v2, s[12:15], s39 offen offset:1024 sc1 lds
    s_add_u32 s19, s41, s42
    v_readlane_b32 s16, v248, s44
    s_nop 0
    s_add_u32 s16, s16, s38
    s_add_u32 s44, s44, 1
    s_and_b32 s44, s44, 15
    s_add_u32 s42, s42, 16384
    s_cmp_eq_u32 s42, 49152
    s_cselect_b32 s42, 0, s42
    s_add_u32 m0, m0, 2048
    s_add_u32 s39, s39, 65536
    buffer_load_dwordx4 v2, s[12:15], s39 offen sc1 lds
    buffer_load_dwordx4 v2, s[12:15], s39 offen offset:1024 sc1 lds
    s_add_u32 m0, m0, 2048
    s_add_u32 s39, s39, 65536
    buffer_load_dwordx4 v2, s[12:15], s39 offen sc1 lds
    buffer_load_dwordx4 v2, s[12:15], s39 offen offset:1024 sc1 lds
    s_mov_b32 m0, s19
    s_mov_b32 s39, s16
    s_waitcnt vmcnt(17)
    s_cmp_lg_u32 s60, 0
    s_cbranch_scc1 pc_46
    v_add_f32 v180, v180, v184
    v_add_f32 v181, v181, v185
    v_add_f32 v182, v182, v186
    v_add_f32 v183, v183, v187
    v_add_f32 v180, v180, v188
    v_add_f32 v181, v181, v189
    v_add_f32 v182, v182, v190
    v_add_f32 v183, v183, v191
    v_add_f32 v180, v180, v192
    v_add_f32 v181, v181, v193
    v_add_f32 v182, v182, v194
    v_add_f32 v183, v183, v195
    v_add_f32 v180, v180, v196
    v_add_f32 v181, v181, v197
    v_add_f32 v182, v182, v198
    v_add_f32 v183, v183, v199
    v_add_f32 v180, v180, v200
    v_add_f32 v181, v181, v201
    v_add_f32 v182, v182, v202
    v_add_f32 v183, v183, v203
    v_add_f32 v180, v180, v204
    v_add_f32 v181, v181, v205
    v_add_f32 v182, v182, v206
    v_add_f32 v183, v183, v207
    v_add_f32 v180, v180, v208
    v_add_f32 v181, v181, v209
    v_add_f32 v182, v182, v210
    v_add_f32 v183, v183, v211
pc_46:
    s_waitcnt vmcnt(9)
    s_barrier
    buffer_load_dwordx4 v2, s[12:15], s39 offen sc1 lds
    buffer_load_dwordx4 v2, s[12:15], s39 offen offset:1024 sc1 lds
    s_add_u32 m0, m0, 2048
    s_add_u32 s39, s39, 65536
    buffer_load_dwordx4 v2, s[12:15], s39 offen sc1 lds
    buffer_load_dwordx4 v2, s[12:15], s39 offen offset:1024 sc1 lds
    s_add_u32 s19, s41, s42
    v_readlane_b32 s16, v248, s44
    s_nop 0
    s_add_u32 s16, s16, s38
    s_add_u32 s44, s44, 1
    s_and_b32 s44, s44, 15
    s_add_u32 s42, s42, 16384
    s_cmp_eq_u32 s42, 49152
    s_cselect_b32 s42, 0, s42
    s_add_u32 m0, m0, 2048
    s_add_u32 s39, s39, 65536
    buffer_load_dwordx4 v2, s[12:15], s39 offen sc1 lds
    buffer_load_dwordx4 v2, s[12:15], s39 offen offset:1024 sc1 lds
    s_add_u32 m0, m0, 2048
    s_add_u32 s39, s39, 65536
    buffer_load_dwordx4 v2, s[12:15], s39 offen sc1 lds
    buffer_load_dwordx4 v2, s[12:15], s39 offen offset:1024 sc1 lds
    s_mov_b32 m0, s19
    s_mov_b32 s39, s16
    s_cmp_lg_u32 s60, 0
    s_cbranch_scc1 pc_47
    v_mov_b32 v184, v180
    v_mov_b32 v185, v181
    v_mov_b32 v186, v182
    v_mov_b32 v187, v183
    v_permlane32_swap_b32 v180, v184
    v_permlane32_swap_b32 v181, v185
    v_permlane32_swap_b32 v182, v186
    v_permlane32_swap_b32 v183, v187
    v_add_f32 v180, v180, v184
    v_add_f32 v181, v181, v185
    v_add_f32 v182, v182, v186
    v_add_f32 v183, v183, v187
    s_and_b32 s36, s30, 1
    s_mul_i32 s36, s36, 448
    s_add_u32 s36, s36, 159744
    v_add_u32 v179, s36, v2
    s_bfm_b64 exec, 28, 0
    ds_write_b128 v179, v[180:183]
    s_mov_b64 exec, -1
    s_waitcnt lgkmcnt(0)
pc_47:
    s_waitcnt vmcnt(16)
    v_readfirstlane_b32 s53, v223
    s_add_u32 s54, s52, 16
    s_cmp_eq_u32 s53, s54
    s_cbranch_scc1 fok_48
    s_mov_b32 s53, 0
    s_add_u32 s54, s52, 16
    s_bfm_b64 exec, 1, 0
poll_49:
    buffer_load_dword v223, v222, s[56:59], 0 offen sc1
    s_waitcnt vmcnt(0)
    v_xor_b32 v223, s54, v223
    v_cmp_eq_u32 vcc, 0, v223
    s_nop 0
    s_cmp_eq_u64 vcc, exec
    s_cbranch_scc1 pok_50
    s_sleep 5
    s_add_u32 s53, s53, 1
    s_cmp_lt_u32 s53, s61
    s_cbranch_scc1 poll_49
    s_mov_b32 s61, 0
pok_50:
    s_mov_b64 exec, -1
fok_48:
    s_add_u32 s20, s62, 0x5c8000
    s_addc_u32 s21, s63, 0
    s_mov_b32 s22, 0x6000
    s_mov_b32 s23, 0x20000
    s_and_b32 s35, s30, 1
    s_lshl_b32 s35, s35, 9
    s_add_u32 s36, s35, 0
    buffer_load_dwordx2 v[184:185], v221, s[20:23], s36 offen offset:0 sc1
    buffer_load_dwordx2 v[186:187], v221, s[20:23], s36 offen offset:1024 sc1
    buffer_load_dwordx2 v[188:189], v221, s[20:23], s36 offen offset:2048 sc1
    buffer_load_dwordx2 v[190:191], v221, s[20:23], s36 offen offset:3072 sc1
    s_waitcnt vmcnt(12)
    s_barrier
    buffer_load_dwordx4 v2, s[12:15], s39 offen sc1 lds
    buffer_load_dwordx4 v2, s[12:15], s39 offen offset:1024 sc1 lds
    s_add_u32 m0, m0, 2048
    s_add_u32 s39, s39, 65536
    buffer_load_dwordx4 v2, s[12:15], s39 offen sc1 lds
    buffer_load_dwordx4 v2, s[12:15], s39 offen offset:1024 sc1 lds
    s_add_u32 s19, s41, s42
    v_readlane_b32 s16, v248, s44
    s_nop 0
    s_add_u32 s16, s16, s38
    s_add_u32 s44, s44, 1
    s_and_b32 s44, s44, 15
    s_add_u32 s42, s42, 16384
    s_cmp_eq_u32 s42, 49152
    s_cselect_b32 s42, 0, s42
    s_add_u32 m0, m0, 2048
    s_add_u32 s39, s39, 65536
    buffer_load_dwordx4 v2, s[12:15], s39 offen sc1 lds
    buffer_load_dwordx4 v2, s[12:15], s39 offen offset:1024 sc1 lds
    s_add_u32 m0, m0, 2048
    s_add_u32 s39, s39, 65536
    buffer_load_dwordx4 v2, s[12:15], s39 offen sc1 lds
    buffer_load_dwordx4 v2, s[12:15], s39 offen offset:1024 sc1 lds
    s_mov_b32 m0, s19
    s_mov_b32 s39, s16
    s_add_u32 s36, s35, 4096
    buffer_load_dwordx2 v[192:193], v221, s[20:23], s36 offen offset:0 sc1
    buffer_load_dwordx2 v[194:195], v221, s[20:23], s36 offen offset:1024 sc1
    buffer_load_dwordx2 v[196:197], v221, s[20:23], s36 offen offset:2048 sc1
    buffer_load_dwordx2 v[198:199], v221, s[20:23], s36 offen offset:3072 sc1
    s_add_u32 s36, s35, 16384
    buffer_load_dwordx2 v[200:201], v221, s[20:23], s36 offen offset:0 sc1
    buffer_load_dwordx2 v[202:203], v221, s[20:23], s36 offen offset:1024 sc1
    s_waitcnt vmcnt(18)
    s_barrier
    buffer_load_dwordx4 v2, s[12:15], s39 offen sc1 lds
    buffer_load_dwordx4 v2, s[12:15], s39 offen offset:1024 sc1 lds
    s_add_u32 m0, m0, 2048
    s_add_u32 s39, s39, 65536
    buffer_load_dwordx4 v2, s[12:15], s39 offen sc1 lds
    buffer_load_dwordx4 v2, s[12:15], s39 offen offset:1024 sc1 lds
    s_add_u32 s19, s41, s42
    v_readlane_b32 s16, v248, s44
    s_nop 0
    s_add_u32 s16, s16, s38
    s_add_u32 s44, s44, 1
    s_and_b32 s44, s44, 15
    s_add_u32 s42, s42, 16384
    s_cmp_eq_u32 s42, 49152
    s_cselect_b32 s42, 0, s42
    s_add_u32 m0, m0, 2048
    s_add_u32 s39, s39, 65536
    buffer_load_dwordx4 v2, s[12:15], s39 offen sc1 lds
    buffer_load_dwordx4 v2, s[12:15], s39 offen offset:1024 sc1 lds
    s_add_u32 m0, m0, 2048
    s_add_u32 s39, s39, 65536
    buffer_load_dwordx4 v2, s[12:15], s39 offen sc1 lds
    buffer_load_dwordx4 v2, s[12:15], s39 offen offset:1024 sc1 lds
    s_mov_b32 m0, s19
    s_mov_b32 s39, s16
    s_add_u32 s36, s35, 16384
    buffer_load_dwordx2 v[204:205], v221, s[20:23], s36 offen offset:2048 sc1
    buffer_load_dwordx2 v[206:207], v221, s[20:23], s36 offen offset:3072 sc1
    s_add_u32 s36, s35, 20480
    buffer_load_dwordx2 v[208:209], v221, s[20:23], s36 offen offset:0 sc1
    buffer_load_dwordx2 v[210:211], v221, s[20:23], s36 offen offset:1024 sc1
    buffer_load_dwordx2 v[212:213], v221, s[20:23], s36 offen offset:2048 sc1
    buffer_load_dwordx2 v[214:215], v221, s[20:23], s36 offen offset:3072 sc1
    s_waitcnt vmcnt(20)
    s_barrier
    buffer_load_dwordx4 v2, s[12:15], s39 offen sc1 lds
    buffer_load_dwordx4 v2, s[12:15], s39 offen offset:1024 sc1 lds
    s_add_u32 m0, m0, 2048
    s_add_u32 s39, s39, 65536
    buffer_load_dwordx4 v2, s[12:15], s39 offen sc1 lds
    buffer_load_dwordx4 v2, s[12:15], s39 offen offset:1024 sc1 lds
    s_add_u32 s19, s41, s42
    v_readlane_b32 s16, v248, s44
    s_nop 0
    s_add_u32 s16, s16, s38
    s_add_u32 s44, s44, 1
    s_and_b32 s44, s44, 15
    s_add_u32 s42, s42, 16384
    s_cmp_eq_u32 s42, 49152
    s_cselect_b32 s42, 0, s42
    s_add_u32 m0, m0, 2048
    s_add_u32 s39, s39, 65536
    buffer_load_dwordx4 v2, s[12:15], s39 offen sc1 lds
    buffer_load_dwordx4 v2, s[12:15], s39 offen offset:1024 sc1 lds
    s_add_u32 m0, m0, 2048
    s_add_u32 s39, s39, 65536
    buffer_load_dwordx4 v2, s[12:15], s39 offen sc1 lds
    buffer_load_dwordx4 v2, s[12:15], s39 offen offset:1024 sc1 lds
    s_mov_b32 m0, s19
    s_mov_b32 s39, s16
    s_waitcnt vmcnt(14)
    s_barrier
    buffer_load_dwordx4 v2, s[12:15], s39 offen sc1 lds
    buffer_load_dwordx4 v2, s[12:15], s39 offen offset:1024 sc1 lds
    s_add_u32 m0, m0, 2048
    s_add_u32 s39, s39, 65536
    buffer_load_dwordx4 v2, s[12:15], s39 offen sc1 lds
    buffer_load_dwordx4 v2, s[12:15], s39 offen offset:1024 sc1 lds
    s_add_u32 s19, s41, s42
    v_readlane_b32 s16, v248, s44
    s_nop 0
    s_add_u32 s16, s16, s38
    s_add_u32 s44, s44, 1
    s_and_b32 s44, s44, 15
    s_add_u32 s42, s42, 16384
    s_cmp_eq_u32 s42, 49152
    s_cselect_b32 s42, 0, s42
    s_add_u32 m0, m0, 2048
    s_add_u32 s39, s39, 65536
    buffer_load_dwordx4 v2, s[12:15], s39 offen sc1 lds
    buffer_load_dwordx4 v2, s[12:15], s39 offen offset:1024 sc1 lds
    s_add_u32 m0, m0, 2048
    s_add_u32 s39, s39, 65536
    buffer_load_dwordx4 v2, s[12:15], s39 offen sc1 lds
    buffer_load_dwordx4 v2, s[12:15], s39 offen offset:1024 sc1 lds
    s_mov_b32 m0, s19
    s_mov_b32 s39, s16
    s_waitcnt vmcnt(16)
    v_add_f32 v184, v184, v200
    v_add_f32 v185, v185, v201
    v_add_f32 v186, v186, v202
    v_add_f32 v187, v187, v203
    v_add_f32 v188, v188, v204
    v_add_f32 v189, v189, v205
    v_add_f32 v190, v190, v206
    v_add_f32 v191, v191, v207
    v_add_f32 v192, v192, v208
    v_add_f32 v193, v193, v209
    v_add_f32 v194, v194, v210
    v_add_f32 v195, v195, v211
    v_add_f32 v196, v196, v212
    v_add_f32 v197, v197, v213
    v_add_f32 v198, v198, v214
    v_add_f32 v199, v199, v215
    s_waitcnt vmcnt(8)
    s_barrier
    buffer_load_dwordx4 v2, s[12:15], s39 offen sc1 lds
    buffer_load_dwordx4 v2, s[12:15], s39 offen offset:1024 sc1 lds
    s_add_u32 m0, m0, 2048
    s_add_u32 s39, s39, 65536
    buffer_load_dwordx4 v2, s[12:15], s39 offen sc1 lds
    buffer_load_dwordx4 v2, s[12:15], s39 offen offset:1024 sc1 lds
    s_add_u32 s19, s41, s42
    v_readlane_b32 s16, v248, s44
    s_nop 0
    s_add_u32 s16, s16, s38
    s_add_u32 s44, s44, 1
    s_and_b32 s44, s44, 15
    s_add_u32 s42, s42, 16384
    s_cmp_eq_u32 s42, 49152
    s_cselect_b32 s42, 0, s42
    s_add_u32 m0, m0, 2048
    s_add_u32 s39, s39, 65536
    buffer_load_dwordx4 v2, s[12:15], s39 offen sc1 lds
    buffer_load_dwordx4 v2, s[12:15], s39 offen offset:1024 sc1 lds
    s_add_u32 m0, m0, 2048
    s_add_u32 s39, s39, 65536
    buffer_load_dwordx4 v2, s[12:15], s39 offen sc1 lds
    buffer_load_dwordx4 v2, s[12:15], s39 offen offset:1024 sc1 lds
    s_mov_b32 m0, s19
    s_mov_b32 s39, s16
    v_add_f32 v184, v184, v192
    v_add_f32 v185, v185, v193
    v_add_f32 v186, v186, v194
    v_add_f32 v187, v187, v195
    v_add_f32 v188, v188, v196
    v_add_f32 v189, v189, v197
    v_add_f32 v190, v190, v198
    v_add_f32 v191, v191, v199
    v_add_f32 v184, v184, v188
    v_add_f32 v185, v185, v189
    v_add_f32 v186, v186, v190
    v_add_f32 v187, v187, v191
    v_add_f32 v184, v184, v186
    v_add_f32 v185, v185, v187
    v_mul_f32 v188, 0x3a800000, v184
    v_mul_f32 v217, 0x3a800000, v185
    s_waitcnt vmcnt(8)
    s_barrier
    buffer_load_dwordx4 v2, s[12:15], s39 offen sc1 lds
    buffer_load_dwordx4 v2, s[12:15], s39 offen offset:1024 sc1 lds
    s_add_u32 m0, m0, 2048
    s_add_u32 s39, s39, 65536
    buffer_load_dwordx4 v2, s[12:15], s39 offen sc1 lds
    buffer_load_dwordx4 v2, s[12:15], s39 offen offset:1024 sc1 lds
    s_add_u32 m0, m0, 2048
    s_add_u32 s39, s39, 65536
    buffer_load_dwordx4 v2, s[12:15], s39 offen sc1 lds
    buffer_load_dwordx4 v2, s[12:15], s39 offen offset:1024 sc1 lds
    s_add_u32 m0, m0, 2048
    s_add_u32 s39, s39, 65536
    buffer_load_dwordx4 v2, s[12:15], s39 offen sc1 lds
    buffer_load_dwordx4 v2, s[12:15], s39 offen offset:1024 sc1 lds
    v_fma_f32 v217, -v188, v188, v217
    v_max_f32 v217, 0, v217
    v_add_f32 v217, 0x3727c5ac, v217
    v_sqrt_f32 v217, v217
    s_nop 0
    v_mov_b32 v189, v217
    v_rcp_f32 v219, v217
    s_nop 0
    v_mul_f32 v190, 0xc0135761, v219
    v_mul_f32 v191, v219, v219
    v_mul_f32 v191, v191, v190
    v_mul_f32 v191, 0x3d372713, v191
    s_lshl_b32 s35, s35, 1
    s_add_u32 s35, s35, 160768
    v_add_u32 v220, s35, v2
    ds_write_b128 v220, v[188:191]
    s_waitcnt lgkmcnt(0)
    s_waitcnt vmcnt(8)
    s_barrier
    s_waitcnt vmcnt(0)
    s_barrier
    s_cmp_lg_u32 s60, 0
    s_cbranch_scc1 tw4_54
    s_load_dwordx2 s[48:49], s[0:1], 80
    s_lshl_b32 s45, s2, 1
    s_and_b32 s50, s30, 1
    s_add_u32 s45, s45, s50
    s_mul_i32 s45, s45, 14336
    s_mov_b32 s50, 7340032
    s_mov_b32 s51, 0x20000
    s_waitcnt lgkmcnt(0)
    buffer_load_dwordx4 v[200:203], v2, s[48:51], s45 offen offset:0
    buffer_load_dwordx4 v[200:203], v2, s[48:51], s45 offen offset:1024
    buffer_load_dwordx4 v[200:203], v2, s[48:51], s45 offen offset:2048
    buffer_load_dwordx4 v[200:203], v2, s[48:51], s45 offen offset:3072
    s_add_u32 s45, s45, 4096
    buffer_load_dwordx4 v[200:203], v2, s[48:51], s45 offen offset:0
    buffer_load_dwordx4 v[200:203], v2, s[48:51], s45 offen offset:1024
    buffer_load_dwordx4 v[200:203], v2, s[48:51], s45 offen offset:2048
    buffer_load_dwordx4 v[200:203], v2, s[48:51], s45 offen offset:3072
    s_add_u32 s45, s45, 4096
    buffer_load_dwordx4 v[200:203], v2, s[48:51], s45 offen offset:0
    buffer_load_dwordx4 v[200:203], v2, s[48:51], s45 offen offset:1024
    buffer_load_dwordx4 v[200:203], v2, s[48:51], s45 offen offset:2048
    buffer_load_dwordx4 v[200:203], v2, s[48:51], s45 offen offset:3072
    s_add_u32 s45, s45, 4096
    buffer_load_dwordx4 v[200:203], v2, s[48:51], s45 offen offset:0
    buffer_load_dwordx4 v[200:203], v2, s[48:51], s45 offen offset:1024
tw4_54:
    s_barrier
    s_cmp_lg_u32 s60, 0
    s_cbranch_scc1 rp_55
    s_call_b64 s[76:77], SUB_r_pre
rp_55:
    s_and_b32 s35, s30, 1
    s_add_u32 s12, s62, 0x400000
    s_addc_u32 s13, s63, 0
    s_mov_b32 s14, 0x1be000
    s_mov_b32 s15, 0x20000
    s_mul_i32 s38, s35, 917504
    s_mul_i32 s36, s31, 114688
    s_add_u32 s38, s38, s36
    s_lshl_b32 s41, s35, 13
    s_mov_b32 s42, 0
    s_mov_b32 s44, 0
    s_add_u32 s54, s55, 0x700
    s_lshl_b32 s53, s31, 7
    s_add_u32 s54, s54, s53
    v_mov_b32 v9, s54
    s_add_u32 s54, s55, 0x600
    s_lshl_b32 s53, s31, 7
    s_add_u32 s54, s54, s53
    v_mov_b32 v10, s54
    s_add_u32 s54, s55, 0x300
    s_lshl_b32 s53, s31, 7
    s_add_u32 s54, s54, s53
    v_mov_b32 v12, s54
    v_mov_b32 v13, 1
    s_and_b32 s51, s30, 1
    s_lshl_b32 s51, s51, 30
    s_lshl_b32 s54, s60, 2
    s_add_u32 s54, s54, 4
    v_mov_b32 v14, 162880
spin_56:
    s_sleep 2
    ds_read_b32 v15, v14
    s_waitcnt lgkmcnt(0)
    v_readfirstlane_b32 s53, v15
    s_nop 0
    s_cmp_ge_u32 s53, s54
    s_cbranch_scc0 spin_56
    s_mov_b64 exec, 1
    buffer_atomic_add v13, v9, s[56:59], s51 offen sc1
    s_mov_b64 exec, -1
    v_xor_b32 v15, 128, v12
    s_mov_b32 s44, 3
    s_call_b64 s[76:77], PREP_a_issue_4
    s_mov_b32 m0, s19
    s_mov_b32 s39, s16
    s_mov_b32 s40, s17
    s_waitcnt vmcnt(16)
    s_barrier
    s_mov_b64 exec, 1
    buffer_load_dword v8, v9, s[56:59], 0 offen sc1
    s_mov_b64 exec, -1
    s_waitcnt vmcnt(9)
    s_barrier
    s_waitcnt vmcnt(0)
    v_readfirstlane_b32 s53, v8
    s_add_u32 s54, s52, 8
    s_cmp_eq_u32 s53, s54
    s_cbranch_scc1 fok_57
    s_mov_b32 s53, 0
    s_add_u32 s54, s52, 8
    s_bfm_b64 exec, 1, 0
poll_58:
    buffer_load_dword v8, v9, s[56:59], 0 offen sc1
    s_waitcnt vmcnt(0)
    v_xor_b32 v8, s54, v8
    v_cmp_eq_u32 vcc, 0, v8
    s_nop 0
    s_cmp_eq_u64 vcc, exec
    s_cbranch_scc1 pok_59
    s_sleep 5
    s_add_u32 s53, s53, 1
    s_cmp_lt_u32 s53, s61
    s_cbranch_scc1 poll_58
    s_mov_b32 s61, 0
pok_59:
    s_mov_b64 exec, -1
fok_57:
    buffer_load_dwordx4 v2, s[12:15], s39 offen sc1 lds
    s_add_u32 m0, m0, 1024
    s_nop 0
    buffer_load_dwordx4 v2, s[12:15], s40 offen sc1 lds
    s_add_u32 m0, m0, 1024
    s_add_u32 s39, s39, 229376
    buffer_load_dwordx4 v2, s[12:15], s39 offen sc1 lds
    s_add_u32 m0, m0, 1024
    s_add_u32 s40, s40, 229376
    buffer_load_dwordx4 v2, s[12:15], s40 offen sc1 lds
    s_call_b64 s[76:77], PREP_a_issue_4
    s_add_u32 m0, m0, 1024
    s_add_u32 s39, s39, 229376
    buffer_load_dwordx4 v2, s[12:15], s39 offen sc1 lds
    s_add_u32 m0, m0, 1024
    s_add_u32 s40, s40, 229376
    buffer_load_dwordx4 v2, s[12:15], s40 offen sc1 lds
    s_add_u32 m0, m0, 1024
    s_add_u32 s39, s39, 229376
    buffer_load_dwordx4 v2, s[12:15], s39 offen sc1 lds
    s_add_u32 m0, m0, 1024
    s_add_u32 s40, s40, 229376
    buffer_load_dwordx4 v2, s[12:15], s40 offen sc1 lds
    s_mov_b32 m0, s19
    s_mov_b32 s39, s16
    s_mov_b32 s40, s17
    s_waitcnt vmcnt(9)
    s_barrier
    s_mov_b64 exec, 1
    buffer_atomic_add v13, v10, s[56:59], s51 offen sc1
    s_mov_b64 exec, -1
    buffer_load_dwordx4 v2, s[12:15], s39 offen sc1 lds
    s_add_u32 m0, m0, 1024
    s_nop 0
    buffer_load_dwordx4 v2, s[12:15], s40 offen sc1 lds
    s_add_u32 m0, m0, 1024
    s_add_u32 s39, s39, 229376
    buffer_load_dwordx4 v2, s[12:15], s39 offen sc1 lds
    s_add_u32 m0, m0, 1024
    s_add_u32 s40, s40, 229376
    buffer_load_dwordx4 v2, s[12:15], s40 offen sc1 lds
    s_call_b64 s[76:77], PREP_a_issue_4
    s_add_u32 m0, m0, 1024
    s_add_u32 s39, s39, 229376
    buffer_load_dwordx4 v2, s[12:15], s39 offen sc1 lds
    s_add_u32 m0, m0, 1024
    s_add_u32 s40, s40, 229376
    buffer_load_dwordx4 v2, s[12:15], s40 offen sc1 lds
    s_add_u32 m0, m0, 1024
    s_add_u32 s39, s39, 229376
    buffer_load_dwordx4 v2, s[12:15], s39 offen sc1 lds
    s_add_u32 m0, m0, 1024
    s_add_u32 s40, s40, 229376
    buffer_load_dwordx4 v2, s[12:15], s40 offen sc1 lds
    s_mov_b32 m0, s19
    s_mov_b32 s39, s16
    s_mov_b32 s40, s17
    s_waitcnt vmcnt(9)
    s_barrier
    buffer_load_dwordx4 v2, s[12:15], s39 offen sc1 lds
    s_add_u32 m0, m0, 1024
    s_nop 0
    buffer_load_dwordx4 v2, s[12:15], s40 offen sc1 lds
    s_add_u32 m0, m0, 1024
    s_add_u32 s39, s39, 229376
    buffer_load_dwordx4 v2, s[12:15], s39 offen sc1 lds
    s_add_u32 m0, m0, 1024
    s_add_u32 s40, s40, 229376
    buffer_load_dwordx4 v2, s[12:15], s40 offen sc1 lds
    s_call_b64 s[76:77], PREP_a_issue_4
    s_add_u32 m0, m0, 1024
    s_add_u32 s39, s39, 229376
    buffer_load_dwordx4 v2, s[12:15], s39 offen sc1 lds
    s_add_u32 m0, m0, 1024
    s_add_u32 s40, s40, 229376
    buffer_load_dwordx4 v2, s[12:15], s40 offen sc1 lds
    s_add_u32 m0, m0, 1024
    s_add_u32 s39, s39, 229376
    buffer_load_dwordx4 v2, s[12:15], s39 offen sc1 lds
    s_add_u32 m0, m0, 1024
    s_add_u32 s40, s40, 229376
    buffer_load_dwordx4 v2, s[12:15], s40 offen sc1 lds
    s_mov_b32 m0, s19
    s_mov_b32 s39, s16
    s_mov_b32 s40, s17
    s_waitcnt vmcnt(8)
    s_barrier
    buffer_load_dwordx4 v2, s[12:15], s39 offen sc1 lds
    s_add_u32 m0, m0, 1024
    s_nop 0
    buffer_load_dwordx4 v2, s[12:15], s40 offen sc1 lds
    s_add_u32 m0, m0, 1024
    s_add_u32 s39, s39, 229376
    buffer_load_dwordx4 v2, s[12:15], s39 offen sc1 lds
    s_add_u32 m0, m0, 1024
    s_add_u32 s40, s40, 229376
    buffer_load_dwordx4 v2, s[12:15], s40 offen sc1 lds
    s_mov_b64 exec, 1
    buffer_load_dword v11, v10, s[56:59], 0 offen sc1
    s_mov_b64 exec, -1
    s_call_b64 s[76:77], PREP_a_issue_4
    s_add_u32 m0, m0, 1024
    s_add_u32 s39, s39, 229376
    buffer_load_dwordx4 v2, s[12:15], s39 offen sc1 lds
    s_add_u32 m0, m0, 1024
    s_add_u32 s40, s40, 229376
    buffer_load_dwordx4 v2, s[12:15], s40 offen sc1 lds
    s_add_u32 m0, m0, 1024
    s_add_u32 s39, s39, 229376
    buffer_load_dwordx4 v2, s[12:15], s39 offen sc1 lds
    s_add_u32 m0, m0, 1024
    s_add_u32 s40, s40, 229376
    buffer_load_dwordx4 v2, s[12:15], s40 offen sc1 lds
    s_mov_b32 m0, s19
    s_mov_b32 s39, s16
    s_mov_b32 s40, s17
    s_waitcnt vmcnt(9)
    s_barrier
    s_mov_b64 exec, 1
    buffer_atomic_add v13, v12, s[56:59], s51 offen sc1
    s_mov_b64 exec, -1
    buffer_load_dwordx4 v2, s[12:15], s39 offen sc1 lds
    s_add_u32 m0, m0, 1024
    s_nop 0
    buffer_load_dwordx4 v2, s[12:15], s40 offen sc1 lds
    s_add_u32 m0, m0, 1024
    s_add_u32 s39, s39, 229376
    buffer_load_dwordx4 v2, s[12:15], s39 offen sc1 lds
    s_add_u32 m0, m0, 1024
    s_add_u32 s40, s40, 229376
    buffer_load_dwordx4 v2, s[12:15], s40 offen sc1 lds
    s_call_b64 s[76:77], PREP_a_issue_4
    s_add_u32 m0, m0, 1024
    s_add_u32 s39, s39, 229376
    buffer_load_dwordx4 v2, s[12:15], s39 offen sc1 lds
    s_add_u32 m0, m0, 1024
    s_add_u32 s40, s40, 229376
    buffer_load_dwordx4 v2, s[12:15], s40 offen sc1 lds
    s_add_u32 m0, m0, 1024
    s_add_u32 s39, s39, 229376
    buffer_load_dwordx4 v2, s[12:15], s39 offen sc1 lds
    s_add_u32 m0, m0, 1024
    s_add_u32 s40, s40, 229376
    buffer_load_dwordx4 v2, s[12:15], s40 offen sc1 lds
    s_mov_b32 m0, s19
    s_mov_b32 s39, s16
    s_mov_b32 s40, s17
    s_waitcnt vmcnt(9)
    s_barrier
    buffer_load_dwordx4 v2, s[12:15], s39 offen sc1 lds
    s_add_u32 m0, m0, 1024
    s_nop 0
    buffer_load_dwordx4 v2, s[12:15], s40 offen sc1 lds
    s_add_u32 m0, m0, 1024
    s_add_u32 s39, s39, 229376
    buffer_load_dwordx4 v2, s[12:15], s39 offen sc1 lds
    s_add_u32 m0, m0, 1024
    s_add_u32 s40, s40, 229376
    buffer_load_dwordx4 v2, s[12:15], s40 offen sc1 lds
    s_waitcnt vmcnt(17)
    v_readfirstlane_b32 s53, v11
    s_add_u32 s54, s52, 8
    s_cmp_eq_u32 s53, s54
    s_cbranch_scc1 fok_60
    s_mov_b32 s53, 0
    s_add_u32 s54, s52, 8
    s_bfm_b64 exec, 1, 0
poll_61:
    buffer_load_dword v11, v10, s[56:59], 0 offen sc1
    s_waitcnt vmcnt(0)
    v_xor_b32 v11, s54, v11
    v_cmp_eq_u32 vcc, 0, v11
    s_nop 0
    s_cmp_eq_u64 vcc, exec
    s_cbranch_scc1 pok_62
    s_sleep 5
    s_add_u32 s53, s53, 1
    s_cmp_lt_u32 s53, s61
    s_cbranch_scc1 poll_61
    s_mov_b32 s61, 0
pok_62:
    s_mov_b64 exec, -1
fok_60:
    s_call_b64 s[76:77], PREP_a_issue_4
    s_add_u32 m0, m0, 1024
    s_add_u32 s39, s39, 229376
    buffer_load_dwordx4 v2, s[12:15], s39 offen sc1 lds
    s_add_u32 m0, m0, 1024
    s_add_u32 s40, s40, 229376
    buffer_load_dwordx4 v2, s[12:15], s40 offen sc1 lds
    s_add_u32 m0, m0, 1024
    s_add_u32 s39, s39, 229376
    buffer_load_dwordx4 v2, s[12:15], s39 offen sc1 lds
    s_add_u32 m0, m0, 1024
    s_add_u32 s40, s40, 229376
    buffer_load_dwordx4 v2, s[12:15], s40 offen sc1 lds
    s_mov_b32 m0, s19
    s_mov_b32 s39, s16
    s_mov_b32 s40, s17
    s_waitcnt vmcnt(8)
    s_barrier
    buffer_load_dwordx4 v2, s[12:15], s39 offen sc1 lds
    s_add_u32 m0, m0, 1024
    s_nop 0
    buffer_load_dwordx4 v2, s[12:15], s40 offen sc1 lds
    s_add_u32 m0, m0, 1024
    s_add_u32 s39, s39, 229376
    buffer_load_dwordx4 v2, s[12:15], s39 offen sc1 lds
    s_add_u32 m0, m0, 1024
    s_add_u32 s40, s40, 229376
    buffer_load_dwordx4 v2, s[12:15], s40 offen sc1 lds
    s_mov_b32 s43, 1
ld_63:
    s_add_u32 s19, s41, s42
    v_readlane_b32 s16, v249, s44
    v_readlane_b32 s17, v250, s44
    s_add_u32 s16, s16, s38
    s_add_u32 s17, s17, s38
    s_add_u32 s44, s44, 1
    s_add_u32 s42, s42, 16384
    s_cmp_eq_u32 s42, 49152
    s_cselect_b32 s42, 0, s42
    s_add_u32 m0, m0, 1024
    s_add_u32 s39, s39, 229376
    buffer_load_dwordx4 v2, s[12:15], s39 offen sc1 lds
    s_add_u32 m0, m0, 1024
    s_add_u32 s40, s40, 229376
    buffer_load_dwordx4 v2, s[12:15], s40 offen sc1 lds
    s_add_u32 m0, m0, 1024
    s_add_u32 s39, s39, 229376
    buffer_load_dwordx4 v2, s[12:15], s39 offen sc1 lds
    s_add_u32 m0, m0, 1024
    s_add_u32 s40, s40, 229376
    buffer_load_dwordx4 v2, s[12:15], s40 offen sc1 lds
    s_mov_b32 m0, s19
    s_mov_b32 s39, s16
    s_mov_b32 s40, s17
    s_waitcnt vmcnt(8)
    s_barrier
    buffer_load_dwordx4 v2, s[12:15], s39 offen sc1 lds
    s_add_u32 m0, m0, 1024
    s_nop 0
    buffer_load_dwordx4 v2, s[12:15], s40 offen sc1 lds
    s_add_u32 m0, m0, 1024
    s_add_u32 s39, s39, 229376
    buffer_load_dwordx4 v2, s[12:15], s39 offen sc1 lds
    s_add_u32 m0, m0, 1024
    s_add_u32 s40, s40, 229376
    buffer_load_dwordx4 v2, s[12:15], s40 offen sc1 lds
    s_add_u32 s43, s43, 1
    s_cmp_lt_u32 s43, 4
    s_cbranch_scc1 ld_63
    s_call_b64 s[76:77], PREP_a_issue_4
    s_add_u32 m0, m0, 1024
    s_add_u32 s39, s39, 229376
    buffer_load_dwordx4 v2, s[12:15], s39 offen sc1 lds
    s_add_u32 m0, m0, 1024
    s_add_u32 s40, s40, 229376
    buffer_load_dwordx4 v2, s[12:15], s40 offen sc1 lds
    s_add_u32 m0, m0, 1024
    s_add_u32 s39, s39, 229376
    buffer_load_dwordx4 v2, s[12:15], s39 offen sc1 lds
    s_add_u32 m0, m0, 1024
    s_add_u32 s40, s40, 229376
    buffer_load_dwordx4 v2, s[12:15], s40 offen sc1 lds
    s_mov_b32 m0, s19
    s_mov_b32 s39, s16
    s_mov_b32 s40, s17
    s_waitcnt vmcnt(8)
    s_barrier
    buffer_load_dwordx4 v2, s[12:15], s39 offen sc1 lds
    s_add_u32 m0, m0, 1024
    s_nop 0
    buffer_load_dwordx4 v2, s[12:15], s40 offen sc1 lds
    s_add_u32 m0, m0, 1024
    s_add_u32 s39, s39, 229376
    buffer_load_dwordx4 v2, s[12:15], s39 offen sc1 lds
    s_add_u32 m0, m0, 1024
    s_add_u32 s40, s40, 229376
    buffer_load_dwordx4 v2, s[12:15], s40 offen sc1 lds
    s_mov_b64 exec, 1
    buffer_load_dword v11, v12, s[56:59], 0 offen sc1
    s_mov_b64 exec, -1
    s_call_b64 s[76:77], PREP_a_issue_4
    s_add_u32 m0, m0, 1024
    s_add_u32 s39, s39, 229376
    buffer_load_dwordx4 v2, s[12:15], s39 offen sc1 lds
    s_add_u32 m0, m0, 1024
    s_add_u32 s40, s40, 229376
    buffer_load_dwordx4 v2, s[12:15], s40 offen sc1 lds
    s_add_u32 m0, m0, 1024
    s_add_u32 s39, s39, 229376
    buffer_load_dwordx4 v2, s[12:15], s39 offen sc1 lds
    s_add_u32 m0, m0, 1024
    s_add_u32 s40, s40, 229376
    buffer_load_dwordx4 v2, s[12:15], s40 offen sc1 lds
    s_mov_b32 m0, s19
    s_mov_b32 s39, s16
    s_mov_b32 s40, s17
    s_waitcnt vmcnt(9)
    s_barrier
    buffer_load_dwordx4 v2, s[12:15], s39 offen sc1 lds
    s_add_u32 m0, m0, 1024
    s_nop 0
    buffer_load_dwordx4 v2, s[12:15], s40 offen sc1 lds
    s_add_u32 m0, m0, 1024
    s_add_u32 s39, s39, 229376
    buffer_load_dwordx4 v2, s[12:15], s39 offen sc1 lds
    s_add_u32 m0, m0, 1024
    s_add_u32 s40, s40, 229376
    buffer_load_dwordx4 v2, s[12:15], s40 offen sc1 lds
    s_call_b64 s[76:77], PREP_a_issue_4
    s_add_u32 m0, m0, 1024
    s_add_u32 s39, s39, 229376
    buffer_load_dwordx4 v2, s[12:15], s39 offen sc1 lds
    s_add_u32 m0, m0, 1024
    s_add_u32 s40, s40, 229376
    buffer_load_dwordx4 v2, s[12:15], s40 offen sc1 lds
    s_add_u32 m0, m0, 1024
    s_add_u32 s39, s39, 229376
    buffer_load_dwordx4 v2, s[12:15], s39 offen sc1 lds
    s_add_u32 m0, m0, 1024
    s_add_u32 s40, s40, 229376
    buffer_load_dwordx4 v2, s[12:15], s40 offen sc1 lds
    s_mov_b32 m0, s19
    s_mov_b32 s39, s16
    s_mov_b32 s40, s17
    s_waitcnt vmcnt(8)
    s_barrier
    buffer_load_dwordx4 v2, s[12:15], s39 offen sc1 lds
    s_add_u32 m0, m0, 1024
    s_nop 0
    buffer_load_dwordx4 v2, s[12:15], s40 offen sc1 lds
    s_add_u32 m0, m0, 1024
    s_add_u32 s39, s39, 229376
    buffer_load_dwordx4 v2, s[12:15], s39 offen sc1 lds
    s_add_u32 m0, m0, 1024
    s_add_u32 s40, s40, 229376
    buffer_load_dwordx4 v2, s[12:15], s40 offen sc1 lds
    s_waitcnt vmcnt(16)
    v_readfirstlane_b32 s53, v11
    s_add_u32 s54, s52, 8
    s_cmp_eq_u32 s53, s54
    s_cbranch_scc1 fok_64
    s_mov_b32 s53, 0
    s_add_u32 s54, s52, 8
    s_bfm_b64 exec, 1, 0
poll_65:
    buffer_load_dword v11, v12, s[56:59], 0 offen sc1
    s_waitcnt vmcnt(0)
    v_xor_b32 v11, s54, v11
    v_cmp_eq_u32 vcc, 0, v11
    s_nop 0
    s_cmp_eq_u64 vcc, exec
    s_cbranch_scc1 pok_66
    s_sleep 5
    s_add_u32 s53, s53, 1
    s_cmp_lt_u32 s53, s61
    s_cbranch_scc1 poll_65
    s_mov_b32 s61, 0
pok_66:
    s_mov_b64 exec, -1
fok_64:
    s_call_b64 s[76:77], PREP_a_issue_4
    s_add_u32 m0, m0, 1024
    s_add_u32 s39, s39, 229376
    buffer_load_dwordx4 v2, s[12:15], s39 offen sc1 lds
    s_add_u32 m0, m0, 1024
    s_add_u32 s40, s40, 229376
    buffer_load_dwordx4 v2, s[12:15], s40 offen sc1 lds
    s_add_u32 m0, m0, 1024
    s_add_u32 s39, s39, 229376
    buffer_load_dwordx4 v2, s[12:15], s39 offen sc1 lds
    s_add_u32 m0, m0, 1024
    s_add_u32 s40, s40, 229376
    buffer_load_dwordx4 v2, s[12:15], s40 offen sc1 lds
    s_mov_b32 m0, s19
    s_mov_b32 s39, s16
    s_mov_b32 s40, s17
    s_waitcnt vmcnt(8)
    s_barrier
    buffer_load_dwordx4 v2, s[12:15], s39 offen sc1 lds
    s_add_u32 m0, m0, 1024
    s_nop 0
    buffer_load_dwordx4 v2, s[12:15], s40 offen sc1 lds
    s_add_u32 m0, m0, 1024
    s_add_u32 s39, s39, 229376
    buffer_load_dwordx4 v2, s[12:15], s39 offen sc1 lds
    s_add_u32 m0, m0, 1024
    s_add_u32 s40, s40, 229376
    buffer_load_dwordx4 v2, s[12:15], s40 offen sc1 lds
    s_mov_b32 s43, 1
ld_67:
    s_add_u32 s19, s41, s42
    v_readlane_b32 s16, v249, s44
    v_readlane_b32 s17, v250, s44
    s_add_u32 s16, s16, s38
    s_add_u32 s17, s17, s38
    s_add_u32 s44, s44, 1
    s_add_u32 s42, s42, 16384
    s_cmp_eq_u32 s42, 49152
    s_cselect_b32 s42, 0, s42
    s_add_u32 m0, m0, 1024
    s_add_u32 s39, s39, 229376
    buffer_load_dwordx4 v2, s[12:15], s39 offen sc1 lds
    s_add_u32 m0, m0, 1024
    s_add_u32 s40, s40, 229376
    buffer_load_dwordx4 v2, s[12:15], s40 offen sc1 lds
    s_add_u32 m0, m0, 1024
    s_add_u32 s39, s39, 229376
    buffer_load_dwordx4 v2, s[12:15], s39 offen sc1 lds
    s_add_u32 m0, m0, 1024
    s_add_u32 s40, s40, 229376
    buffer_load_dwordx4 v2, s[12:15], s40 offen sc1 lds
    s_mov_b32 m0, s19
    s_mov_b32 s39, s16
    s_mov_b32 s40, s17
    s_waitcnt vmcnt(8)
    s_barrier
    buffer_load_dwordx4 v2, s[12:15], s39 offen sc1 lds
    s_add_u32 m0, m0, 1024
    s_nop 0
    buffer_load_dwordx4 v2, s[12:15], s40 offen sc1 lds
    s_add_u32 m0, m0, 1024
    s_add_u32 s39, s39, 229376
    buffer_load_dwordx4 v2, s[12:15], s39 offen sc1 lds
    s_add_u32 m0, m0, 1024
    s_add_u32 s40, s40, 229376
    buffer_load_dwordx4 v2, s[12:15], s40 offen sc1 lds
    s_add_u32 s43, s43, 1
    s_cmp_lt_u32 s43, 5
    s_cbranch_scc1 ld_67
    s_call_b64 s[76:77], PREP_a_issue_4
    s_add_u32 m0, m0, 1024
    s_add_u32 s39, s39, 229376
    buffer_load_dwordx4 v2, s[12:15], s39 offen sc1 lds
    s_add_u32 m0, m0, 1024
    s_add_u32 s40, s40, 229376
    buffer_load_dwordx4 v2, s[12:15], s40 offen sc1 lds
    s_add_u32 m0, m0, 1024
    s_add_u32 s39, s39, 229376
    buffer_load_dwordx4 v2, s[12:15], s39 offen sc1 lds
    s_add_u32 m0, m0, 1024
    s_add_u32 s40, s40, 229376
    buffer_load_dwordx4 v2, s[12:15], s40 offen sc1 lds
    s_mov_b32 m0, s19
    s_mov_b32 s39, s16
    s_mov_b32 s40, s17
    s_waitcnt vmcnt(8)
    s_barrier
    buffer_load_dwordx4 v2, s[12:15], s39 offen sc1 lds
    s_add_u32 m0, m0, 1024
    s_nop 0
    buffer_load_dwordx4 v2, s[12:15], s40 offen sc1 lds
    s_add_u32 m0, m0, 1024
    s_add_u32 s39, s39, 229376
    buffer_load_dwordx4 v2, s[12:15], s39 offen sc1 lds
    s_add_u32 m0, m0, 1024
    s_add_u32 s40, s40, 229376
    buffer_load_dwordx4 v2, s[12:15], s40 offen sc1 lds
    s_mov_b64 exec, 1
    buffer_load_dword v11, v15, s[56:59], 0 offen sc1
    s_mov_b64 exec, -1
    s_call_b64 s[76:77], PREP_a_issue_4
    s_add_u32 m0, m0, 1024
    s_add_u32 s39, s39, 229376
    buffer_load_dwordx4 v2, s[12:15], s39 offen sc1 lds
    s_add_u32 m0, m0, 1024
    s_add_u32 s40, s40, 229376
    buffer_load_dwordx4 v2, s[12:15], s40 offen sc1 lds
    s_add_u32 m0, m0, 1024
    s_add_u32 s39, s39, 229376
    buffer_load_dwordx4 v2, s[12:15], s39 offen sc1 lds
    s_add_u32 m0, m0, 1024
    s_add_u32 s40, s40, 229376
    buffer_load_dwordx4 v2, s[12:15], s40 offen sc1 lds
    s_mov_b32 m0, s19
    s_mov_b32 s39, s16
    s_mov_b32 s40, s17
    s_waitcnt vmcnt(9)
    s_barrier
    buffer_load_dwordx4 v2, s[12:15], s39 offen sc1 lds
    s_add_u32 m0, m0, 1024
    s_nop 0
    buffer_load_dwordx4 v2, s[12:15], s40 offen sc1 lds
    s_add_u32 m0, m0, 1024
    s_add_u32 s39, s39, 229376
    buffer_load_dwordx4 v2, s[12:15], s39 offen sc1 lds
    s_add_u32 m0, m0, 1024
    s_add_u32 s40, s40, 229376
    buffer_load_dwordx4 v2, s[12:15], s40 offen sc1 lds
    s_call_b64 s[76:77], PREP_a_issue_4
    s_add_u32 m0, m0, 1024
    s_add_u32 s39, s39, 229376
    buffer_load_dwordx4 v2, s[12:15], s39 offen sc1 lds
    s_add_u32 m0, m0, 1024
    s_add_u32 s40, s40, 229376
    buffer_load_dwordx4 v2, s[12:15], s40 offen sc1 lds
    s_add_u32 m0, m0, 1024
    s_add_u32 s39, s39, 229376
    buffer_load_dwordx4 v2, s[12:15], s39 offen sc1 lds
    s_add_u32 m0, m0, 1024
    s_add_u32 s40, s40, 229376
    buffer_load_dwordx4 v2, s[12:15], s40 offen sc1 lds
    s_mov_b32 m0, s19
    s_mov_b32 s39, s16
    s_mov_b32 s40, s17
    s_waitcnt vmcnt(8)
    s_barrier
    buffer_load_dwordx4 v2, s[12:15], s39 offen sc1 lds
    s_add_u32 m0, m0, 1024
    s_nop 0
    buffer_load_dwordx4 v2, s[12:15], s40 offen sc1 lds
    s_add_u32 m0, m0, 1024
    s_add_u32 s39, s39, 229376
    buffer_load_dwordx4 v2, s[12:15], s39 offen sc1 lds
    s_add_u32 m0, m0, 1024
    s_add_u32 s40, s40, 229376
    buffer_load_dwordx4 v2, s[12:15], s40 offen sc1 lds
    s_waitcnt vmcnt(16)
    v_readfirstlane_b32 s53, v11
    s_add_u32 s54, s52, 8
    s_cmp_eq_u32 s53, s54
    s_cbranch_scc1 fok_68
    s_mov_b32 s53, 0
    s_add_u32 s54, s52, 8
    s_bfm_b64 exec, 1, 0
poll_69:
    buffer_load_dword v11, v15, s[56:59], 0 offen sc1
    s_waitcnt vmcnt(0)
    v_xor_b32 v11, s54, v11
    v_cmp_eq_u32 vcc, 0, v11
    s_nop 0
    s_cmp_eq_u64 vcc, exec
    s_cbranch_scc1 pok_70
    s_sleep 5
    s_add_u32 s53, s53, 1
    s_cmp_lt_u32 s53, s61
    s_cbranch_scc1 poll_69
    s_mov_b32 s61, 0
pok_70:
    s_mov_b64 exec, -1
fok_68:
    s_call_b64 s[76:77], PREP_a_issue_4
    s_add_u32 m0, m0, 1024
    s_add_u32 s39, s39, 229376
    buffer_load_dwordx4 v2, s[12:15], s39 offen sc1 lds
    s_add_u32 m0, m0, 1024
    s_add_u32 s40, s40, 229376
    buffer_load_dwordx4 v2, s[12:15], s40 offen sc1 lds
    s_add_u32 m0, m0, 1024
    s_add_u32 s39, s39, 229376
    buffer_load_dwordx4 v2, s[12:15], s39 offen sc1 lds
    s_add_u32 m0, m0, 1024
    s_add_u32 s40, s40, 229376
    buffer_load_dwordx4 v2, s[12:15], s40 offen sc1 lds
    s_mov_b32 m0, s19
    s_mov_b32 s39, s16
    s_mov_b32 s40, s17
    s_waitcnt vmcnt(8)
    s_barrier
    buffer_load_dwordx4 v2, s[12:15], s39 offen sc1 lds
    s_add_u32 m0, m0, 1024
    s_nop 0
    buffer_load_dwordx4 v2, s[12:15], s40 offen sc1 lds
    s_add_u32 m0, m0, 1024
    s_add_u32 s39, s39, 229376
    buffer_load_dwordx4 v2, s[12:15], s39 offen sc1 lds
    s_add_u32 m0, m0, 1024
    s_add_u32 s40, s40, 229376
    buffer_load_dwordx4 v2, s[12:15], s40 offen sc1 lds
    s_mov_b32 s43, 1
ld_71:
    s_add_u32 s19, s41, s42
    v_readlane_b32 s16, v249, s44
    v_readlane_b32 s17, v250, s44
    s_add_u32 s16, s16, s38
    s_add_u32 s17, s17, s38
    s_add_u32 s44, s44, 1
    s_add_u32 s42, s42, 16384
    s_cmp_eq_u32 s42, 49152
    s_cselect_b32 s42, 0, s42
    s_add_u32 m0, m0, 1024
    s_add_u32 s39, s39, 229376
    buffer_load_dwordx4 v2, s[12:15], s39 offen sc1 lds
    s_add_u32 m0, m0, 1024
    s_add_u32 s40, s40, 229376
    buffer_load_dwordx4 v2, s[12:15], s40 offen sc1 lds
    s_add_u32 m0, m0, 1024
    s_add_u32 s39, s39, 229376
    buffer_load_dwordx4 v2, s[12:15], s39 offen sc1 lds
    s_add_u32 m0, m0, 1024
    s_add_u32 s40, s40, 229376
    buffer_load_dwordx4 v2, s[12:15], s40 offen sc1 lds
    s_mov_b32 m0, s19
    s_mov_b32 s39, s16
    s_mov_b32 s40, s17
    s_waitcnt vmcnt(8)
    s_barrier
    buffer_load_dwordx4 v2, s[12:15], s39 offen sc1 lds
    s_add_u32 m0, m0, 1024
    s_nop 0
    buffer_load_dwordx4 v2, s[12:15], s40 offen sc1 lds
    s_add_u32 m0, m0, 1024
    s_add_u32 s39, s39, 229376
    buffer_load_dwordx4 v2, s[12:15], s39 offen sc1 lds
    s_add_u32 m0, m0, 1024
    s_add_u32 s40, s40, 229376
    buffer_load_dwordx4 v2, s[12:15], s40 offen sc1 lds
    s_add_u32 s43, s43, 1
    s_cmp_lt_u32 s43, 3
    s_cbranch_scc1 ld_71
    s_call_b64 s[76:77], PREP_a_issue_4
    s_add_u32 m0, m0, 1024
    s_add_u32 s39, s39, 229376
    buffer_load_dwordx4 v2, s[12:15], s39 offen sc1 lds
    s_add_u32 m0, m0, 1024
    s_add_u32 s40, s40, 229376
    buffer_load_dwordx4 v2, s[12:15], s40 offen sc1 lds
    s_add_u32 m0, m0, 1024
    s_add_u32 s39, s39, 229376
    buffer_load_dwordx4 v2, s[12:15], s39 offen sc1 lds
    s_add_u32 m0, m0, 1024
    s_add_u32 s40, s40, 229376
    buffer_load_dwordx4 v2, s[12:15], s40 offen sc1 lds
    s_mov_b32 m0, s19
    s_mov_b32 s39, s16
    s_mov_b32 s40, s17
    s_waitcnt vmcnt(8)
    s_barrier
    buffer_load_dwordx4 v2, s[12:15], s39 offen sc1 lds
    s_add_u32 m0, m0, 1024
    s_nop 0
    buffer_load_dwordx4 v2, s[12:15], s40 offen sc1 lds
    s_add_u32 m0, m0, 1024
    s_add_u32 s39, s39, 229376
    buffer_load_dwordx4 v2, s[12:15], s39 offen sc1 lds
    s_add_u32 m0, m0, 1024
    s_add_u32 s40, s40, 229376
    buffer_load_dwordx4 v2, s[12:15], s40 offen sc1 lds
    s_add_u32 m0, m0, 1024
    s_add_u32 s39, s39, 229376
    buffer_load_dwordx4 v2, s[12:15], s39 offen sc1 lds
    s_add_u32 m0, m0, 1024
    s_add_u32 s40, s40, 229376
    buffer_load_dwordx4 v2, s[12:15], s40 offen sc1 lds
    s_add_u32 m0, m0, 1024
    s_add_u32 s39, s39, 229376
    buffer_load_dwordx4 v2, s[12:15], s39 offen sc1 lds
    s_add_u32 m0, m0, 1024
    s_add_u32 s40, s40, 229376
    buffer_load_dwordx4 v2, s[12:15], s40 offen sc1 lds
    s_waitcnt vmcnt(8)
    s_barrier
    s_waitcnt vmcnt(0)
    s_barrier
    s_cmp_eq_u32 s60, 1
    s_cbranch_scc1 K_fin
    s_and_b32 s36, s30, 1
    s_lshl_b32 s36, s36, 12
    s_add_u32 s36, s36, 32768
    v_add_u32 v6, s36, v2
    ds_write_b128 v6, v[16:19] offset:0
    ds_write_b128 v6, v[20:23] offset:1024
    ds_write_b128 v6, v[24:27] offset:2048
    ds_write_b128 v6, v[28:31] offset:3072
    ds_write_b128 v6, v[32:35] offset:8192
    ds_write_b128 v6, v[36:39] offset:9216
    ds_write_b128 v6, v[40:43] offset:10240
    ds_write_b128 v6, v[44:47] offset:11264
    s_waitcnt lgkmcnt(0)
    s_barrier
    s_branch NEXT
WLOAD:
    s_cmp_eq_u32 s60, 1
    s_cbranch_scc1 WL_1
    s_mov_b64 s[12:13], s[68:69]
    s_mov_b32 s14, 2097152
    s_mov_b32 s15, 0x20000
    s_and_b32 s35, s30, 1
    s_mul_i32 s38, s99, 128
    s_mul_i32 s41, s35, 65536
    s_add_u32 s38, s38, s41
    s_mul_i32 s41, s35, 4096
    s_add_u32 s41, s41, 24576
    s_mov_b32 s42, 0
    s_mov_b32 s44, s67
    s_branch WL_2
WL_1:
    s_mov_b64 s[12:13], s[68:69]
    s_mov_b32 s14, 2097152
    s_mov_b32 s15, 0x20000
    s_and_b32 s35, s30, 1
    s_mul_i32 s38, s99, 128
    s_mul_i32 s41, s35, 65536
    s_add_u32 s38, s38, s41
    s_mul_i32 s41, s35, 4096
    s_add_u32 s41, s41, 24576
    s_mov_b32 s42, 0
    s_mov_b32 s44, s67
WL_2:
    s_waitcnt vmcnt(0)
    s_and_b32 s36, s30, 1
    s_lshl_b32 s36, s36, 12
    s_add_u32 s36, s36, 81920
    v_add_u32 v6, s36, v2
    ds_read_b128 v[16:19], v6 offset:16384
    ds_read_b128 v[20:23], v6 offset:17408
    ds_read_b128 v[24:27], v6 offset:18432
    ds_read_b128 v[28:31], v6 offset:19456
    ds_read_b128 v[32:35], v6 offset:24576
    ds_read_b128 v[36:39], v6 offset:25600
    ds_read_b128 v[40:43], v6 offset:26624
    ds_read_b128 v[44:47], v6 offset:27648
    ds_read_b128 v[204:207], v6 offset:0
    ds_read_b128 v[208:211], v6 offset:1024
    ds_read_b128 v[212:215], v6 offset:2048
    ds_read_b128 v[216:219], v6 offset:3072
    s_waitcnt lgkmcnt(0)
    s_barrier
    s_call_b64 s[76:77], SUB_after_g1
    s_barrier
    s_waitcnt vmcnt(0)
    s_barrier
    s_call_b64 s[76:77], SUB_after_g2
    s_mov_b64 s[12:13], s[72:73]
    s_mov_b32 s14, 7340032
    s_mov_b32 s15, 0x20000
    s_and_b32 s35, s30, 1
    s_mul_i32 s38, s29, 448
    s_mul_i32 s41, s35, 229376
    s_add_u32 s38, s38, s41
    s_mul_i32 s41, s35, 14336
    s_add_u32 s41, s41, 73728
    s_mov_b32 s42, 0
    s_mov_b32 s44, 0
    s_mov_b32 s42, 28672
    s_mov_b32 s44, 2
    s_add_u32 s19, s41, s42
    v_readlane_b32 s16, v248, s44
    s_nop 0
    s_add_u32 s16, s16, s38
    s_add_u32 s44, s44, 1
    s_and_b32 s44, s44, 15
    s_add_u32 s42, s42, 28672
    s_cmp_eq_u32 s42, 86016
    s_cselect_b32 s42, 0, s42
    s_mov_b32 m0, s19
    s_mov_b32 s39, s16
    s_waitcnt vmcnt(63)
    s_barrier
    buffer_load_dwordx4 v241, s[12:15], s39 offen lds
    s_add_u32 m0, m0, 1024
    s_nop 0
    buffer_load_dwordx4 v242, s[12:15], s39 offen lds
    s_add_u32 m0, m0, 1024
    s_nop 0
    buffer_load_dwordx4 v243, s[12:15], s39 offen lds
    s_add_u32 m0, m0, 1024
    s_nop 0
    buffer_load_dwordx4 v244, s[12:15], s39 offen lds
    s_add_u32 m0, m0, 1024
    s_nop 0
    buffer_load_dwordx4 v245, s[12:15], s39 offen lds
    s_add_u32 m0, m0, 1024
    s_nop 0
    buffer_load_dwordx4 v246, s[12:15], s39 offen lds
    s_add_u32 m0, m0, 1024
    s_nop 0
    buffer_load_dwordx4 v247, s[12:15], s39 offen lds
    s_mov_b32 s43, 1
ld_72:
    s_add_u32 s19, s41, s42
    v_readlane_b32 s16, v248, s44
    s_nop 0
    s_add_u32 s16, s16, s38
    s_add_u32 s44, s44, 1
    s_and_b32 s44, s44, 15
    s_add_u32 s42, s42, 28672
    s_cmp_eq_u32 s42, 86016
    s_cselect_b32 s42, 0, s42
    s_add_u32 m0, m0, 1024
    s_add_u32 s39, s39, 114688
    buffer_load_dwordx4 v241, s[12:15], s39 offen lds
    s_add_u32 m0, m0, 1024
    s_nop 0
    buffer_load_dwordx4 v242, s[12:15], s39 offen lds
    s_add_u32 m0, m0, 1024
    s_nop 0
    buffer_load_dwordx4 v243, s[12:15], s39 offen lds
    s_add_u32 m0, m0, 1024
    s_nop 0
    buffer_load_dwordx4 v244, s[12:15], s39 offen lds
    s_add_u32 m0, m0, 1024
    s_nop 0
    buffer_load_dwordx4 v245, s[12:15], s39 offen lds
    s_add_u32 m0, m0, 1024
    s_nop 0
    buffer_load_dwordx4 v246, s[12:15], s39 offen lds
    s_add_u32 m0, m0, 1024
    s_nop 0
    buffer_load_dwordx4 v247, s[12:15], s39 offen lds
    s_mov_b32 m0, s19
    s_mov_b32 s39, s16
    s_waitcnt vmcnt(14)
    s_barrier
    buffer_load_dwordx4 v241, s[12:15], s39 offen lds
    s_add_u32 m0, m0, 1024
    s_nop 0
    buffer_load_dwordx4 v242, s[12:15], s39 offen lds
    s_add_u32 m0, m0, 1024
    s_nop 0
    buffer_load_dwordx4 v243, s[12:15], s39 offen lds
    s_add_u32 m0, m0, 1024
    s_nop 0
    buffer_load_dwordx4 v244, s[12:15], s39 offen lds
    s_add_u32 m0, m0, 1024
    s_nop 0
    buffer_load_dwordx4 v245, s[12:15], s39 offen lds
    s_add_u32 m0, m0, 1024
    s_nop 0
    buffer_load_dwordx4 v246, s[12:15], s39 offen lds
    s_add_u32 m0, m0, 1024
    s_nop 0
    buffer_load_dwordx4 v247, s[12:15], s39 offen lds
    s_add_u32 s43, s43, 1
    s_cmp_lt_u32 s43, 13
    s_cbranch_scc1 ld_72
    s_add_u32 s19, s41, s42
    v_readlane_b32 s16, v248, s44
    s_nop 0
    s_add_u32 s16, s16, s38
    s_add_u32 s44, s44, 1
    s_and_b32 s44, s44, 15
    s_add_u32 s42, s42, 28672
    s_cmp_eq_u32 s42, 86016
    s_cselect_b32 s42, 0, s42
    s_add_u32 m0, m0, 1024
    s_add_u32 s39, s39, 114688
    buffer_load_dwordx4 v241, s[12:15], s39 offen lds
    s_add_u32 m0, m0, 1024
    s_nop 0
    buffer_load_dwordx4 v242, s[12:15], s39 offen lds
    s_add_u32 m0, m0, 1024
    s_nop 0
    buffer_load_dwordx4 v243, s[12:15], s39 offen lds
    s_add_u32 m0, m0, 1024
    s_nop 0
    buffer_load_dwordx4 v244, s[12:15], s39 offen lds
    s_add_u32 m0, m0, 1024
    s_nop 0
    buffer_load_dwordx4 v245, s[12:15], s39 offen lds
    s_add_u32 m0, m0, 1024
    s_nop 0
    buffer_load_dwordx4 v246, s[12:15], s39 offen lds
    s_add_u32 m0, m0, 1024
    s_nop 0
    buffer_load_dwordx4 v247, s[12:15], s39 offen lds
    s_mov_b32 m0, s19
    s_mov_b32 s39, s16
    s_waitcnt vmcnt(14)
    s_barrier
    buffer_load_dwordx4 v241, s[12:15], s39 offen lds
    s_add_u32 m0, m0, 1024
    s_nop 0
    buffer_load_dwordx4 v242, s[12:15], s39 offen lds
    s_add_u32 m0, m0, 1024
    s_nop 0
    buffer_load_dwordx4 v243, s[12:15], s39 offen lds
    s_add_u32 m0, m0, 1024
    s_nop 0
    buffer_load_dwordx4 v244, s[12:15], s39 offen lds
    s_add_u32 m0, m0, 1024
    s_nop 0
    buffer_load_dwordx4 v245, s[12:15], s39 offen lds
    s_add_u32 m0, m0, 1024
    s_nop 0
    buffer_load_dwordx4 v246, s[12:15], s39 offen lds
    s_add_u32 m0, m0, 1024
    s_nop 0
    buffer_load_dwordx4 v247, s[12:15], s39 offen lds
    s_add_u32 m0, m0, 1024
    s_add_u32 s39, s39, 114688
    buffer_load_dwordx4 v241, s[12:15], s39 offen lds
    s_add_u32 m0, m0, 1024
    s_nop 0
    buffer_load_dwordx4 v242, s[12:15], s39 offen lds
    s_add_u32 m0, m0, 1024
    s_nop 0
    buffer_load_dwordx4 v243, s[12:15], s39 offen lds
    s_add_u32 m0, m0, 1024
    s_nop 0
    buffer_load_dwordx4 v244, s[12:15], s39 offen lds
    s_add_u32 m0, m0, 1024
    s_nop 0
    buffer_load_dwordx4 v245, s[12:15], s39 offen lds
    s_add_u32 m0, m0, 1024
    s_nop 0
    buffer_load_dwordx4 v246, s[12:15], s39 offen lds
    s_add_u32 m0, m0, 1024
    s_nop 0
    buffer_load_dwordx4 v247, s[12:15], s39 offen lds
    s_waitcnt vmcnt(14)
    s_barrier
    s_call_b64 s[76:77], SUB_r_pre0
    s_waitcnt vmcnt(4)
    s_barrier
    s_barrier
    s_mov_b64 s[12:13], s[74:75]
    s_mov_b32 s14, 7340032
    s_mov_b32 s15, 0x20000
    s_and_b32 s35, s30, 1
    s_mul_i32 s38, s33, 256
    s_mul_i32 s41, s31, 3670016
    s_add_u32 s38, s38, s41
    s_mul_i32 s41, s35, 8192
    s_add_u32 s41, s41, 49152
    s_mov_b32 s42, 0
    s_mov_b32 s44, 0
    s_mov_b32 s49, s44
    s_and_b32 s43, s28, 3
    s_mul_i32 s43, s43, 6
    s_lshr_b32 s43, s43, 2
    s_mov_b32 s50, 0
wpre_73:
    s_mul_i32 s42, s43, 16384
    s_add_u32 s44, s49, s43
    s_mov_b32 s45, 8192
    s_add_u32 s19, s41, s42
    v_readlane_b32 s16, v249, s44
    s_nop 0
    s_bitcmp1_b32 s16, 0
    s_cselect_b32 s17, 16384, s45
    s_cselect_b32 s18, -40960, s45
    s_andn2_b32 s16, s16, 1
    s_add_u32 s16, s16, s38
    s_add_u32 s44, s44, 1
    s_add_u32 s42, s42, 16384
    s_cmp_eq_u32 s42, 98304
    s_cselect_b32 s42, 0, s42
    s_mov_b32 m0, s19
    s_mov_b32 s39, s16
    s_mov_b32 s32, s17
    s_mov_b32 s3, s18
    buffer_load_dwordx4 v239, s[12:15], s39 offen lds
    s_add_u32 m0, m0, 1024
    s_add_u32 s39, s39, s32
    buffer_load_dwordx4 v240, s[12:15], s39 offen lds
    s_add_u32 m0, m0, 1024
    s_add_u32 s39, s39, s32
    buffer_load_dwordx4 v239, s[12:15], s39 offen lds
    s_add_u32 m0, m0, 1024
    s_add_u32 s39, s39, s32
    buffer_load_dwordx4 v240, s[12:15], s39 offen lds
    s_waitcnt vmcnt(8)
    s_add_u32 m0, m0, 1024
    s_add_u32 s39, s39, s3
    buffer_load_dwordx4 v239, s[12:15], s39 offen lds
    s_add_u32 m0, m0, 1024
    s_add_u32 s39, s39, s32
    buffer_load_dwordx4 v240, s[12:15], s39 offen lds
    s_add_u32 m0, m0, 1024
    s_add_u32 s39, s39, s32
    buffer_load_dwordx4 v239, s[12:15], s39 offen lds
    s_add_u32 m0, m0, 1024
    s_add_u32 s39, s39, s32
    buffer_load_dwordx4 v240, s[12:15], s39 offen lds
    s_waitcnt vmcnt(8)
    s_add_u32 s43, s43, 1
    s_cmp_eq_u32 s43, 6
    s_cselect_b32 s43, 0, s43
    s_add_u32 s50, s50, 1
    s_cmp_lt_u32 s50, 6
    s_cbranch_scc1 wpre_73
    s_mov_b32 s42, 0
    s_add_u32 s44, s49, 6
    s_cmp_eq_u32 s60, 1
    s_cbranch_scc1 WL_t1
    s_call_b64 s[76:77], PREP_w_issue_4
    s_mov_b32 m0, s19
    s_mov_b32 s39, s16
    s_mov_b32 s32, s17
    s_mov_b32 s3, s18
    s_waitcnt vmcnt(0)
    s_barrier
    s_waitcnt vmcnt(0)
    s_barrier
    buffer_load_dwordx4 v239, s[12:15], s39 offen lds
    s_add_u32 m0, m0, 1024
    s_add_u32 s39, s39, s32
    buffer_load_dwordx4 v240, s[12:15], s39 offen lds
    s_add_u32 m0, m0, 1024
    s_add_u32 s39, s39, s32
    buffer_load_dwordx4 v239, s[12:15], s39 offen lds
    s_add_u32 m0, m0, 1024
    s_add_u32 s39, s39, s32
    buffer_load_dwordx4 v240, s[12:15], s39 offen lds
    s_call_b64 s[76:77], PREP_w_issue_4
    s_add_u32 m0, m0, 1024
    s_add_u32 s39, s39, s3
    buffer_load_dwordx4 v239, s[12:15], s39 offen lds
    s_add_u32 m0, m0, 1024
    s_add_u32 s39, s39, s32
    buffer_load_dwordx4 v240, s[12:15], s39 offen lds
    s_add_u32 m0, m0, 1024
    s_add_u32 s39, s39, s32
    buffer_load_dwordx4 v239, s[12:15], s39 offen lds
    s_add_u32 m0, m0, 1024
    s_add_u32 s39, s39, s32
    buffer_load_dwordx4 v240, s[12:15], s39 offen lds
    s_mov_b32 m0, s19
    s_mov_b32 s39, s16
    s_mov_b32 s32, s17
    s_mov_b32 s3, s18
    s_waitcnt vmcnt(8)
    s_barrier
    buffer_load_dwordx4 v239, s[12:15], s39 offen lds
    s_add_u32 m0, m0, 1024
    s_add_u32 s39, s39, s32
    buffer_load_dwordx4 v240, s[12:15], s39 offen lds
    s_add_u32 m0, m0, 1024
    s_add_u32 s39, s39, s32
    buffer_load_dwordx4 v239, s[12:15], s39 offen lds
    s_add_u32 m0, m0, 1024
    s_add_u32 s39, s39, s32
    buffer_load_dwordx4 v240, s[12:15], s39 offen lds
    s_call_b64 s[76:77], PREP_w_issue_4
    s_add_u32 m0, m0, 1024
    s_add_u32 s39, s39, s3
    buffer_load_dwordx4 v239, s[12:15], s39 offen lds
    s_add_u32 m0, m0, 1024
    s_add_u32 s39, s39, s32
    buffer_load_dwordx4 v240, s[12:15], s39 offen lds
    s_add_u32 m0, m0, 1024
    s_add_u32 s39, s39, s32
    buffer_load_dwordx4 v239, s[12:15], s39 offen lds
    s_add_u32 m0, m0, 1024
    s_add_u32 s39, s39, s32
    buffer_load_dwordx4 v240, s[12:15], s39 offen lds
    s_mov_b32 m0, s19
    s_mov_b32 s39, s16
    s_mov_b32 s32, s17
    s_mov_b32 s3, s18
    s_waitcnt vmcnt(16)
    s_barrier
    buffer_load_dwordx4 v239, s[12:15], s39 offen lds
    s_add_u32 m0, m0, 1024
    s_add_u32 s39, s39, s32
    buffer_load_dwordx4 v240, s[12:15], s39 offen lds
    s_add_u32 m0, m0, 1024
    s_add_u32 s39, s39, s32
    buffer_load_dwordx4 v239, s[12:15], s39 offen lds
    s_add_u32 m0, m0, 1024
    s_add_u32 s39, s39, s32
    buffer_load_dwordx4 v240, s[12:15], s39 offen lds
    s_call_b64 s[76:77], PREP_w_issue_4
    s_add_u32 m0, m0, 1024
    s_add_u32 s39, s39, s3
    buffer_load_dwordx4 v239, s[12:15], s39 offen lds
    s_add_u32 m0, m0, 1024
    s_add_u32 s39, s39, s32
    buffer_load_dwordx4 v240, s[12:15], s39 offen lds
    s_add_u32 m0, m0, 1024
    s_add_u32 s39, s39, s32
    buffer_load_dwordx4 v239, s[12:15], s39 offen lds
    s_add_u32 m0, m0, 1024
    s_add_u32 s39, s39, s32
    buffer_load_dwordx4 v240, s[12:15], s39 offen lds
    s_mov_b32 m0, s19
    s_mov_b32 s39, s16
    s_mov_b32 s32, s17
    s_mov_b32 s3, s18
    s_waitcnt vmcnt(24)
    s_barrier
    buffer_load_dwordx4 v239, s[12:15], s39 offen lds
    s_add_u32 m0, m0, 1024
    s_add_u32 s39, s39, s32
    buffer_load_dwordx4 v240, s[12:15], s39 offen lds
    s_add_u32 m0, m0, 1024
    s_add_u32 s39, s39, s32
    buffer_load_dwordx4 v239, s[12:15], s39 offen lds
    s_add_u32 m0, m0, 1024
    s_add_u32 s39, s39, s32
    buffer_load_dwordx4 v240, s[12:15], s39 offen lds
    s_mov_b32 s43, 1
ld_74:
    s_mov_b32 s45, 8192
    s_add_u32 s19, s41, s42
    v_readlane_b32 s16, v249, s44
    s_nop 0
    s_bitcmp1_b32 s16, 0
    s_cselect_b32 s17, 16384, s45
    s_cselect_b32 s18, -40960, s45
    s_andn2_b32 s16, s16, 1
    s_add_u32 s16, s16, s38
    s_add_u32 s44, s44, 1
    s_add_u32 s42, s42, 16384
    s_cmp_eq_u32 s42, 98304
    s_cselect_b32 s42, 0, s42
    s_add_u32 m0, m0, 1024
    s_add_u32 s39, s39, s3
    buffer_load_dwordx4 v239, s[12:15], s39 offen lds
    s_add_u32 m0, m0, 1024
    s_add_u32 s39, s39, s32
    buffer_load_dwordx4 v240, s[12:15], s39 offen lds
    s_add_u32 m0, m0, 1024
    s_add_u32 s39, s39, s32
    buffer_load_dwordx4 v239, s[12:15], s39 offen lds
    s_add_u32 m0, m0, 1024
    s_add_u32 s39, s39, s32
    buffer_load_dwordx4 v240, s[12:15], s39 offen lds
    s_mov_b32 m0, s19
    s_mov_b32 s39, s16
    s_mov_b32 s32, s17
    s_mov_b32 s3, s18
    s_waitcnt vmcnt(32)
    s_barrier
    buffer_load_dwordx4 v239, s[12:15], s39 offen lds
    s_add_u32 m0, m0, 1024
    s_add_u32 s39, s39, s32
    buffer_load_dwordx4 v240, s[12:15], s39 offen lds
    s_add_u32 m0, m0, 1024
    s_add_u32 s39, s39, s32
    buffer_load_dwordx4 v239, s[12:15], s39 offen lds
    s_add_u32 m0, m0, 1024
    s_add_u32 s39, s39, s32
    buffer_load_dwordx4 v240, s[12:15], s39 offen lds
    s_add_u32 s43, s43, 1
    s_cmp_lt_u32 s43, 18
    s_cbranch_scc1 ld_74
    s_call_b64 s[76:77], PREP_w_issue_4
    s_add_u32 m0, m0, 1024
    s_add_u32 s39, s39, s3
    buffer_load_dwordx4 v239, s[12:15], s39 offen lds
    s_add_u32 m0, m0, 1024
    s_add_u32 s39, s39, s32
    buffer_load_dwordx4 v240, s[12:15], s39 offen lds
    s_add_u32 m0, m0, 1024
    s_add_u32 s39, s39, s32
    buffer_load_dwordx4 v239, s[12:15], s39 offen lds
    s_add_u32 m0, m0, 1024
    s_add_u32 s39, s39, s32
    buffer_load_dwordx4 v240, s[12:15], s39 offen lds
    s_mov_b32 m0, s19
    s_mov_b32 s39, s16
    s_mov_b32 s32, s17
    s_mov_b32 s3, s18
    s_waitcnt vmcnt(32)
    s_barrier
    buffer_load_dwordx4 v239, s[12:15], s39 offen lds
    s_add_u32 m0, m0, 1024
    s_add_u32 s39, s39, s32
    buffer_load_dwordx4 v240, s[12:15], s39 offen lds
    s_add_u32 m0, m0, 1024
    s_add_u32 s39, s39, s32
    buffer_load_dwordx4 v239, s[12:15], s39 offen lds
    s_add_u32 m0, m0, 1024
    s_add_u32 s39, s39, s32
    buffer_load_dwordx4 v240, s[12:15], s39 offen lds
    s_add_u32 m0, m0, 1024
    s_add_u32 s39, s39, s3
    buffer_load_dwordx4 v239, s[12:15], s39 offen lds
    s_add_u32 m0, m0, 1024
    s_add_u32 s39, s39, s32
    buffer_load_dwordx4 v240, s[12:15], s39 offen lds
    s_add_u32 m0, m0, 1024
    s_add_u32 s39, s39, s32
    buffer_load_dwordx4 v239, s[12:15], s39 offen lds
    s_add_u32 m0, m0, 1024
    s_add_u32 s39, s39, s32
    buffer_load_dwordx4 v240, s[12:15], s39 offen lds
    s_waitcnt vmcnt(32)
    s_barrier
    s_mov_b64 s[12:13], s[68:69]
    s_mov_b32 s14, 2097152
    s_mov_b32 s15, 0x20000
    s_and_b32 s35, s30, 1
    s_mul_i32 s38, s99, 128
    s_mul_i32 s41, s35, 65536
    s_add_u32 s38, s38, s41
    s_mul_i32 s41, s35, 4096
    s_add_u32 s41, s41, 24576
    s_mov_b32 s42, 0
    s_mov_b32 s44, s67
    s_and_b32 s36, s99, 7
    s_cmp_eq_u32 s36, 3
    s_cselect_b64 s[50:51], 0, -1
    s_mov_b32 s42, 90112
    s_mov_b32 s44, s67
    s_add_u32 s44, s44, 11
    s_and_b32 s44, s44, 15
    s_call_b64 s[76:77], SUB_w_issue_1
    s_mov_b32 s42, 98304
    s_mov_b32 s44, s67
    s_add_u32 s44, s44, 12
    s_and_b32 s44, s44, 15
    s_call_b64 s[76:77], SUB_w_issue_1
    s_waitcnt vmcnt(32)
    s_barrier
    s_mov_b32 s42, 106496
    s_mov_b32 s44, s67
    s_add_u32 s44, s44, 13
    s_and_b32 s44, s44, 15
    s_call_b64 s[76:77], SUB_w_issue_1
    s_mov_b32 s42, 114688
    s_mov_b32 s44, s67
    s_add_u32 s44, s44, 14
    s_and_b32 s44, s44, 15
    s_call_b64 s[76:77], SUB_w_issue_1
    s_waitcnt vmcnt(32)
    s_barrier
    s_mov_b32 s42, 24576
    s_mov_b32 s44, s67
    s_add_u32 s44, s44, 3
    s_and_b32 s44, s44, 15
    s_call_b64 s[76:77], SUB_w_issue_1
    s_mov_b32 s42, 32768
    s_mov_b32 s44, s67
    s_add_u32 s44, s44, 4
    s_and_b32 s44, s44, 15
    s_call_b64 s[76:77], SUB_w_issue_1
    s_waitcnt vmcnt(32)
    s_barrier
    s_mov_b32 s42, 40960
    s_mov_b32 s44, s67
    s_add_u32 s44, s44, 5
    s_and_b32 s44, s44, 15
    s_call_b64 s[76:77], SUB_w_issue_1
    s_mov_b32 s42, 49152
    s_mov_b32 s44, s67
    s_add_u32 s44, s44, 6
    s_and_b32 s44, s44, 15
    s_call_b64 s[76:77], SUB_w_issue_1
    s_mov_b32 s42, 0
    s_mov_b32 s44, s67
    s_add_u32 s44, s44, 0
    s_and_b32 s44, s44, 15
    s_call_b64 s[76:77], SUB_w_issue_1
    s_waitcnt vmcnt(36)
    s_barrier
    s_mov_b32 s42, 65536
    s_mov_b32 s44, s67
    s_add_u32 s44, s44, 8
    s_and_b32 s44, s44, 15
    s_call_b64 s[76:77], SUB_w_issue_1
    s_mov_b32 s42, 122880
    s_mov_b32 s44, s67
    s_add_u32 s44, s44, 15
    s_and_b32 s44, s44, 15
    s_call_b64 s[76:77], SUB_w_issue_1
    s_add_u32 s36, s41, 57344
    v_add_u32 v6, s36, v2
    ds_write_b128 v6, v[204:207] offset:0
    ds_write_b128 v6, v[208:211] offset:1024
    ds_write_b128 v6, v[212:215] offset:2048
    ds_write_b128 v6, v[216:219] offset:3072
    s_barrier
    s_add_u32 s36, s41, 57344
    v_add_u32 v6, s36, v2
    ds_write_b128 v6, v[16:19] offset:16384
    ds_write_b128 v6, v[20:23] offset:17408
    ds_write_b128 v6, v[24:27] offset:18432
    ds_write_b128 v6, v[28:31] offset:19456
    ds_write_b128 v6, v[32:35] offset:24576
    ds_write_b128 v6, v[36:39] offset:25600
    ds_write_b128 v6, v[40:43] offset:26624
    ds_write_b128 v6, v[44:47] offset:27648
    s_waitcnt lgkmcnt(0)
    s_branch NEXT
WL_t1:
    s_call_b64 s[76:77], PREP_w_issue_4
    s_mov_b32 m0, s19
    s_mov_b32 s39, s16
    s_mov_b32 s32, s17
    s_mov_b32 s3, s18
    s_waitcnt vmcnt(0)
    s_barrier
    s_waitcnt vmcnt(0)
    s_barrier
    s_waitcnt vmcnt(0)
    s_barrier
    s_waitcnt vmcnt(0)
    s_barrier
    s_waitcnt vmcnt(0)
    s_barrier
    buffer_load_dwordx4 v239, s[12:15], s39 offen lds
    s_add_u32 m0, m0, 1024
    s_add_u32 s39, s39, s32
    buffer_load_dwordx4 v240, s[12:15], s39 offen lds
    s_add_u32 m0, m0, 1024
    s_add_u32 s39, s39, s32
    buffer_load_dwordx4 v239, s[12:15], s39 offen lds
    s_add_u32 m0, m0, 1024
    s_add_u32 s39, s39, s32
    buffer_load_dwordx4 v240, s[12:15], s39 offen lds
    s_mov_b32 s43, 1
ld_75:
    s_mov_b32 s45, 8192
    s_add_u32 s19, s41, s42
    v_readlane_b32 s16, v249, s44
    s_nop 0
    s_bitcmp1_b32 s16, 0
    s_cselect_b32 s17, 16384, s45
    s_cselect_b32 s18, -40960, s45
    s_andn2_b32 s16, s16, 1
    s_add_u32 s16, s16, s38
    s_add_u32 s44, s44, 1
    s_add_u32 s42, s42, 16384
    s_cmp_eq_u32 s42, 98304
    s_cselect_b32 s42, 0, s42
    s_add_u32 m0, m0, 1024
    s_add_u32 s39, s39, s3
    buffer_load_dwordx4 v239, s[12:15], s39 offen lds
    s_add_u32 m0, m0, 1024
    s_add_u32 s39, s39, s32
    buffer_load_dwordx4 v240, s[12:15], s39 offen lds
    s_add_u32 m0, m0, 1024
    s_add_u32 s39, s39, s32
    buffer_load_dwordx4 v239, s[12:15], s39 offen lds
    s_add_u32 m0, m0, 1024
    s_add_u32 s39, s39, s32
    buffer_load_dwordx4 v240, s[12:15], s39 offen lds
    s_mov_b32 m0, s19
    s_mov_b32 s39, s16
    s_mov_b32 s32, s17
    s_mov_b32 s3, s18
    s_waitcnt vmcnt(8)
    s_barrier
    buffer_load_dwordx4 v239, s[12:15], s39 offen lds
    s_add_u32 m0, m0, 1024
    s_add_u32 s39, s39, s32
    buffer_load_dwordx4 v240, s[12:15], s39 offen lds
    s_add_u32 m0, m0, 1024
    s_add_u32 s39, s39, s32
    buffer_load_dwordx4 v239, s[12:15], s39 offen lds
    s_add_u32 m0, m0, 1024
    s_add_u32 s39, s39, s32
    buffer_load_dwordx4 v240, s[12:15], s39 offen lds
    s_add_u32 s43, s43, 1
    s_cmp_lt_u32 s43, 21
    s_cbranch_scc1 ld_75
    s_call_b64 s[76:77], PREP_w_issue_4
    s_add_u32 m0, m0, 1024
    s_add_u32 s39, s39, s3
    buffer_load_dwordx4 v239, s[12:15], s39 offen lds
    s_add_u32 m0, m0, 1024
    s_add_u32 s39, s39, s32
    buffer_load_dwordx4 v240, s[12:15], s39 offen lds
    s_add_u32 m0, m0, 1024
    s_add_u32 s39, s39, s32
    buffer_load_dwordx4 v239, s[12:15], s39 offen lds
    s_add_u32 m0, m0, 1024
    s_add_u32 s39, s39, s32
    buffer_load_dwordx4 v240, s[12:15], s39 offen lds
    s_mov_b32 m0, s19
    s_mov_b32 s39, s16
    s_mov_b32 s32, s17
    s_mov_b32 s3, s18
    s_waitcnt vmcnt(8)
    s_barrier
    buffer_load_dwordx4 v239, s[12:15], s39 offen lds
    s_add_u32 m0, m0, 1024
    s_add_u32 s39, s39, s32
    buffer_load_dwordx4 v240, s[12:15], s39 offen lds
    s_add_u32 m0, m0, 1024
    s_add_u32 s39, s39, s32
    buffer_load_dwordx4 v239, s[12:15], s39 offen lds
    s_add_u32 m0, m0, 1024
    s_add_u32 s39, s39, s32
    buffer_load_dwordx4 v240, s[12:15], s39 offen lds
    s_add_u32 m0, m0, 1024
    s_add_u32 s39, s39, s3
    buffer_load_dwordx4 v239, s[12:15], s39 offen lds
    s_add_u32 m0, m0, 1024
    s_add_u32 s39, s39, s32
    buffer_load_dwordx4 v240, s[12:15], s39 offen lds
    s_add_u32 m0, m0, 1024
    s_add_u32 s39, s39, s32
    buffer_load_dwordx4 v239, s[12:15], s39 offen lds
    s_add_u32 m0, m0, 1024
    s_add_u32 s39, s39, s32
    buffer_load_dwordx4 v240, s[12:15], s39 offen lds
    s_waitcnt vmcnt(8)
    s_barrier
    s_waitcnt vmcnt(0)
    s_barrier
    s_branch K_fin
NEXT:
    s_setprio 0
    s_add_u32 s60, s60, 1
    s_add_u32 s55, s55, 4194304
    s_add_u32 s62, s62, 4194304
    s_addc_u32 s63, s63, 0
    s_branch LAYER
K_fin:
    s_endpgm
SUB_w1_regs:
    s_mov_b64 s[12:13], s[68:69]
    s_mov_b32 s14, 2097152
    s_mov_b32 s15, 0x20000
    s_and_b32 s35, s30, 3
    s_mul_i32 s35, s35, 294912
    s_lshl_b32 s39, s99, 7
    s_add_u32 s39, s39, s35
    buffer_load_dwordx4 v[176:179], v238, s[12:15], s39 offen
    s_add_u32 s39, s39, 16384
    buffer_load_dwordx4 v[188:191], v238, s[12:15], s39 offen
    s_add_u32 s39, s39, 16384
    buffer_load_dwordx4 v[192:195], v238, s[12:15], s39 offen
    s_add_u32 s39, s39, 16384
    buffer_load_dwordx4 v[200:203], v238, s[12:15], s39 offen
    s_add_u32 s39, s39, 16384
    s_waitcnt vmcnt(8)
    buffer_load_dwordx4 v[204:207], v238, s[12:15], s39 offen
    s_add_u32 s39, s39, 16384
    buffer_load_dwordx4 v[208:211], v238, s[12:15], s39 offen
    s_add_u32 s39, s39, 16384
    buffer_load_dwordx4 v[212:215], v238, s[12:15], s39 offen
    s_add_u32 s39, s39, 16384
    buffer_load_dwordx4 v[216:219], v238, s[12:15], s39 offen
    s_add_u32 s39, s39, 16384
    s_waitcnt vmcnt(8)
    buffer_load_dwordx4 v[220:223], v238, s[12:15], s39 offen
    s_add_u32 s39, s39, 16384
    buffer_load_dwordx4 v[224:227], v238, s[12:15], s39 offen
    s_add_u32 s39, s39, 16384
    buffer_load_dwordx4 v[16:19], v238, s[12:15], s39 offen
    s_add_u32 s39, s39, 16384
    buffer_load_dwordx4 v[20:23], v238, s[12:15], s39 offen
    s_add_u32 s39, s39, 16384
    s_waitcnt vmcnt(8)
    buffer_load_dwordx4 v[24:27], v238, s[12:15], s39 offen
    s_add_u32 s39, s39, 16384
    buffer_load_dwordx4 v[28:31], v238, s[12:15], s39 offen
    s_add_u32 s39, s39, 16384
    buffer_load_dwordx4 v[32:35], v238, s[12:15], s39 offen
    s_add_u32 s39, s39, 16384
    buffer_load_dwordx4 v[36:39], v238, s[12:15], s39 offen
    s_add_u32 s39, s39, 16384
    s_waitcnt vmcnt(8)
    buffer_load_dwordx4 v[40:43], v238, s[12:15], s39 offen
    s_add_u32 s39, s39, 16384
    buffer_load_dwordx4 v[44:47], v238, s[12:15], s39 offen
    s_add_u32 s39, s39, 16384
    s_setpc_b64 s[76:77]
SUB_park:
    s_mov_b64 s[12:13], s[70:71]
    s_mov_b32 s14, 2097152
    s_mov_b32 s15, 0x20000
    s_and_b32 s35, s30, 3
    s_lshl_b32 s35, s35, 19
    s_lshl_b32 s39, s29, 7
    s_add_u32 s39, s39, s35
    buffer_load_dwordx4 v[48:51], v238, s[12:15], s39 offen
    s_add_u32 s39, s39, 16384
    buffer_load_dwordx4 v[52:55], v238, s[12:15], s39 offen
    s_add_u32 s39, s39, 16384
    buffer_load_dwordx4 v[56:59], v238, s[12:15], s39 offen
    s_add_u32 s39, s39, 16384
    buffer_load_dwordx4 v[60:63], v238, s[12:15], s39 offen
    s_add_u32 s39, s39, 16384
    s_waitcnt vmcnt(8)
    buffer_load_dwordx4 v[64:67], v238, s[12:15], s39 offen
    s_add_u32 s39, s39, 16384
    buffer_load_dwordx4 v[68:71], v238, s[12:15], s39 offen
    s_add_u32 s39, s39, 16384
    buffer_load_dwordx4 v[72:75], v238, s[12:15], s39 offen
    s_add_u32 s39, s39, 16384
    buffer_load_dwordx4 v[76:79], v238, s[12:15], s39 offen
    s_add_u32 s39, s39, 16384
    s_waitcnt vmcnt(8)
    buffer_load_dwordx4 v[80:83], v238, s[12:15], s39 offen
    s_add_u32 s39, s39, 16384
    buffer_load_dwordx4 v[84:87], v238, s[12:15], s39 offen
    s_add_u32 s39, s39, 16384
    buffer_load_dwordx4 v[88:91], v238, s[12:15], s39 offen
    s_add_u32 s39, s39, 16384
    buffer_load_dwordx4 v[92:95], v238, s[12:15], s39 offen
    s_add_u32 s39, s39, 16384
    s_waitcnt vmcnt(8)
    buffer_load_dwordx4 v[96:99], v238, s[12:15], s39 offen
    s_add_u32 s39, s39, 16384
    buffer_load_dwordx4 v[100:103], v238, s[12:15], s39 offen
    s_add_u32 s39, s39, 16384
    buffer_load_dwordx4 v[104:107], v238, s[12:15], s39 offen
    s_add_u32 s39, s39, 16384
    buffer_load_dwordx4 v[108:111], v238, s[12:15], s39 offen
    s_add_u32 s39, s39, 16384
    s_waitcnt vmcnt(8)
    buffer_load_dwordx4 v[112:115], v238, s[12:15], s39 offen
    s_add_u32 s39, s39, 16384
    buffer_load_dwordx4 v[116:119], v238, s[12:15], s39 offen
    s_add_u32 s39, s39, 16384
    buffer_load_dwordx4 v[120:123], v238, s[12:15], s39 offen
    s_add_u32 s39, s39, 16384
    buffer_load_dwordx4 v[124:127], v238, s[12:15], s39 offen
    s_add_u32 s39, s39, 16384
    s_waitcnt vmcnt(8)
    buffer_load_dwordx4 v[128:131], v238, s[12:15], s39 offen
    s_add_u32 s39, s39, 16384
    buffer_load_dwordx4 v[132:135], v238, s[12:15], s39 offen
    s_add_u32 s39, s39, 16384
    buffer_load_dwordx4 v[136:139], v238, s[12:15], s39 offen
    s_add_u32 s39, s39, 16384
    buffer_load_dwordx4 v[140:143], v238, s[12:15], s39 offen
    s_add_u32 s39, s39, 16384
    s_waitcnt vmcnt(8)
    s_setpc_b64 s[76:77]
SUB_park2:
    s_mov_b64 s[12:13], s[70:71]
    s_mov_b32 s14, 2097152
    s_mov_b32 s15, 0x20000
    s_and_b32 s35, s30, 3
    s_lshl_b32 s35, s35, 19
    s_lshl_b32 s39, s29, 7
    s_add_u32 s39, s39, s35
    s_add_u32 s39, s39, 393216
    buffer_load_dwordx4 v[144:147], v238, s[12:15], s39 offen
    s_add_u32 s39, s39, 16384
    buffer_load_dwordx4 v[148:151], v238, s[12:15], s39 offen
    s_add_u32 s39, s39, 16384
    buffer_load_dwordx4 v[152:155], v238, s[12:15], s39 offen
    s_add_u32 s39, s39, 16384
    buffer_load_dwordx4 v[156:159], v238, s[12:15], s39 offen
    s_add_u32 s39, s39, 16384
    s_waitcnt vmcnt(8)
    buffer_load_dwordx4 v[160:163], v238, s[12:15], s39 offen
    s_add_u32 s39, s39, 16384
    buffer_load_dwordx4 v[164:167], v238, s[12:15], s39 offen
    s_add_u32 s39, s39, 16384
    buffer_load_dwordx4 v[168:171], v238, s[12:15], s39 offen
    s_add_u32 s39, s39, 16384
    buffer_load_dwordx4 v[172:175], v238, s[12:15], s39 offen
    s_add_u32 s39, s39, 16384
    s_waitcnt vmcnt(8)
    s_setpc_b64 s[76:77]
SUB_w1_put:
    s_and_b32 s35, s30, 3
    s_mul_i32 s35, s35, 18432
    v_add_u32 v8, s35, v2
    v_mov_b32 v6, 162836
spin_76:
    s_sleep 2
    ds_read_b32 v7, v6
    s_waitcnt lgkmcnt(0)
    v_readfirstlane_b32 s53, v7
    s_nop 0
    s_cmp_ge_u32 s53, 8
    s_cbranch_scc0 spin_76
    s_waitcnt vmcnt(24)
    ds_write_b128 v8, v[176:179] offset:24576
    ds_write_b128 v8, v[188:191] offset:25600
    ds_write_b128 v8, v[192:195] offset:26624
    ds_write_b128 v8, v[200:203] offset:27648
    ds_write_b128 v8, v[204:207] offset:28672
    ds_write_b128 v8, v[208:211] offset:29696
    ds_write_b128 v8, v[212:215] offset:30720
    ds_write_b128 v8, v[216:219] offset:31744
    ds_write_b128 v8, v[220:223] offset:32768
    ds_write_b128 v8, v[224:227] offset:33792
    ds_write_b128 v8, v[16:19] offset:34816
    ds_write_b128 v8, v[20:23] offset:35840
    ds_write_b128 v8, v[24:27] offset:36864
    ds_write_b128 v8, v[28:31] offset:37888
    ds_write_b128 v8, v[32:35] offset:38912
    ds_write_b128 v8, v[36:39] offset:39936
    ds_write_b128 v8, v[40:43] offset:40960
    ds_write_b128 v8, v[44:47] offset:41984
    s_waitcnt lgkmcnt(0)
    s_setpc_b64 s[76:77]
SUB_after_g1:
    s_mov_b64 s[12:13], s[72:73]
    s_mov_b32 s14, 7340032
    s_mov_b32 s15, 0x20000
    v_readlane_b32 s36, v251, 0
    v_readlane_b32 s37, v251, 1
    v_readlane_b32 s34, v251, 2
    s_and_b32 s35, s30, 3
    s_mul_i32 s38, s35, 114688
    s_mul_i32 s39, s29, 448
    s_add_u32 s38, s38, s39
    s_and_b32 s36, s36, 15
    s_mul_i32 s36, s36, 458752
    s_add_u32 s36, s36, s38
    s_and_b32 s37, s37, 15
    s_mul_i32 s37, s37, 458752
    s_add_u32 s37, s37, s38
    s_and_b32 s34, s34, 15
    s_mul_i32 s34, s34, 458752
    s_add_u32 s34, s34, s38
    s_mul_i32 s39, s35, 7168
    s_add_u32 m0, s39, 131072
    s_nop 0
    buffer_load_dwordx4 v241, s[12:15], s36 offen lds
    s_add_u32 m0, m0, 1024
    s_nop 0
    buffer_load_dwordx4 v242, s[12:15], s36 offen lds
    s_add_u32 m0, m0, 1024
    s_nop 0
    buffer_load_dwordx4 v243, s[12:15], s36 offen lds
    s_add_u32 m0, m0, 1024
    s_nop 0
    buffer_load_dwordx4 v244, s[12:15], s36 offen lds
    s_add_u32 m0, m0, 1024
    s_nop 0
    buffer_load_dwordx4 v245, s[12:15], s36 offen lds
    s_add_u32 m0, m0, 1024
    s_nop 0
    buffer_load_dwordx4 v246, s[12:15], s36 offen lds
    s_add_u32 m0, m0, 1024
    s_nop 0
    buffer_load_dwordx4 v247, s[12:15], s36 offen lds
    buffer_load_dwordx4 v[176:179], v241, s[12:15], s37 offen
    buffer_load_dwordx4 v[180:183], v242, s[12:15], s37 offen
    buffer_load_dwordx4 v[184:187], v243, s[12:15], s37 offen
    buffer_load_dwordx4 v[188:191], v244, s[12:15], s37 offen
    buffer_load_dwordx4 v[192:195], v245, s[12:15], s37 offen
    buffer_load_dwordx4 v[196:199], v246, s[12:15], s37 offen
    buffer_load_dwordx4 v[200:203], v247, s[12:15], s37 offen
    s_lshr_b32 s36, s67, 2
    s_sub_u32 s36, s35, s36
    s_and_b32 s36, s36, 3
    s_lshl_b32 s36, s36, 15
    v_add_u32 v6, s36, v2
    s_waitcnt vmcnt(14)
    ds_write_b128 v6, v[48:51] offset:0
    ds_write_b128 v6, v[52:55] offset:1024
    ds_write_b128 v6, v[56:59] offset:2048
    ds_write_b128 v6, v[60:63] offset:3072
    ds_write_b128 v6, v[64:67] offset:4096
    ds_write_b128 v6, v[68:71] offset:5120
    ds_write_b128 v6, v[72:75] offset:6144
    ds_write_b128 v6, v[76:79] offset:7168
    ds_write_b128 v6, v[80:83] offset:8192
    ds_write_b128 v6, v[84:87] offset:9216
    ds_write_b128 v6, v[88:91] offset:10240
    ds_write_b128 v6, v[92:95] offset:11264
    ds_write_b128 v6, v[96:99] offset:12288
    ds_write_b128 v6, v[100:103] offset:13312
    ds_write_b128 v6, v[104:107] offset:14336
    ds_write_b128 v6, v[108:111] offset:15360
    ds_write_b128 v6, v[112:115] offset:16384
    ds_write_b128 v6, v[116:119] offset:17408
    ds_write_b128 v6, v[120:123] offset:18432
    ds_write_b128 v6, v[124:127] offset:19456
    ds_write_b128 v6, v[128:131] offset:20480
    ds_write_b128 v6, v[132:135] offset:21504
    ds_write_b128 v6, v[136:139] offset:22528
    ds_write_b128 v6, v[140:143] offset:23552
    ds_write_b128 v6, v[144:147] offset:24576
    ds_write_b128 v6, v[148:151] offset:25600
    ds_write_b128 v6, v[152:155] offset:26624
    ds_write_b128 v6, v[156:159] offset:27648
    ds_write_b128 v6, v[160:163] offset:28672
    ds_write_b128 v6, v[164:167] offset:29696
    ds_write_b128 v6, v[168:171] offset:30720
    ds_write_b128 v6, v[172:175] offset:31744
    s_waitcnt lgkmcnt(0)
    s_setpc_b64 s[76:77]
SUB_after_g2:
    s_and_b32 s35, s30, 3
    s_mul_i32 s39, s35, 7168
    s_add_u32 s39, s39, 73728
    v_add_u32 v7, s39, v2
    ds_write_b128 v7, v[176:179] offset:0
    ds_write_b128 v7, v[180:183] offset:1024
    ds_write_b128 v7, v[184:187] offset:2048
    ds_write_b128 v7, v[188:191] offset:3072
    ds_write_b128 v7, v[192:195] offset:4096
    ds_write_b128 v7, v[196:199] offset:5120
    ds_write_b128 v7, v[200:203] offset:6144
    s_waitcnt lgkmcnt(0)
    s_setpc_b64 s[76:77]
SUB_r_pre:
    v_and_b32 v199, 7, v0
    v_lshrrev_b32 v228, 6, v0
    v_lshlrev_b32 v228, 4, v228
    v_bfe_u32 v229, v0, 3, 3
    v_add_u32 v228, v228, v229
    s_lshr_b32 s78, s29, 1
    s_lshl_b32 s78, s78, 16
    s_and_b32 s79, s29, 1
    s_lshl_b32 s79, s79, 7
    s_add_u32 s78, s78, s79
    s_lshr_b32 s79, s30, 1
    s_lshl_b32 s79, s79, 13
    s_add_u32 s78, s78, s79
    v_lshlrev_b32 v196, 8, v228
    v_lshl_add_u32 v196, v199, 4, v196
    v_add_u32 v196, s78, v196
    s_mov_b32 s84, s62
    s_mov_b32 s85, s63
    s_mov_b32 s86, 0x7e000
    s_mov_b32 s87, 0x20000
    s_add_u32 s88, s62, 0x80000
    s_addc_u32 s89, s63, 0
    s_mov_b32 s90, 0x7e000
    s_mov_b32 s91, 0x20000
    buffer_load_dwordx4 v[180:183], v196, s[84:87], 0 offen offset:0 sc1
    buffer_load_dwordx4 v[188:191], v196, s[88:91], 0 offen offset:0 sc1
    buffer_load_dwordx4 v[184:187], v196, s[84:87], 0 offen offset:2048 sc1
    buffer_load_dwordx4 v[192:195], v196, s[88:91], 0 offen offset:2048 sc1
    s_setpc_b64 s[76:77]
SUB_r_pre0:
    v_and_b32 v199, 7, v0
    v_lshrrev_b32 v228, 6, v0
    v_lshlrev_b32 v228, 4, v228
    v_bfe_u32 v229, v0, 3, 3
    v_add_u32 v228, v228, v229
    s_lshr_b32 s78, s29, 1
    s_lshl_b32 s78, s78, 16
    s_and_b32 s79, s29, 1
    s_lshl_b32 s79, s79, 7
    s_add_u32 s78, s78, s79
    s_lshr_b32 s79, s30, 1
    s_lshl_b32 s79, s79, 13
    s_add_u32 s78, s78, s79
    v_lshlrev_b32 v196, 8, v228
    v_lshl_add_u32 v196, v199, 4, v196
    v_add_u32 v196, s78, v196
    s_mov_b32 s84, s62
    s_mov_b32 s85, s63
    s_mov_b32 s86, 0x7e000
    s_mov_b32 s87, 0x20000
    s_add_u32 s88, s62, 0x80000
    s_addc_u32 s89, s63, 0
    s_mov_b32 s90, 0x7e000
    s_mov_b32 s91, 0x20000
    s_cmp_eq_u32 s60, 0
    s_cselect_b64 exec, -1, 0
    buffer_load_dwordx4 v[180:183], v196, s[84:87], 0 offen offset:0 sc1
    buffer_load_dwordx4 v[188:191], v196, s[88:91], 0 offen offset:0 sc1
    buffer_load_dwordx4 v[184:187], v196, s[84:87], 0 offen offset:2048 sc1
    buffer_load_dwordx4 v[192:195], v196, s[88:91], 0 offen offset:2048 sc1
    s_mov_b64 exec, -1
    s_setpc_b64 s[76:77]
SUB_w_issue_1:
    s_add_u32 s19, s41, s42
    s_mul_i32 s16, s44, 131072
    s_add_u32 s16, s16, s38
    s_add_u32 s44, s44, 1
    s_and_b32 s44, s44, 15
    s_add_u32 s42, s42, 8192
    s_cmp_eq_u32 s42, 131072
    s_cselect_b32 s42, 0, s42
    s_mov_b32 m0, s19
    s_mov_b32 s39, s16
    buffer_load_dwordx4 v238, s[12:15], s39 offen lds
    s_add_u32 m0, m0, 1024
    s_add_u32 s39, s39, 16384
    buffer_load_dwordx4 v238, s[12:15], s39 offen lds
    s_add_u32 m0, m0, 1024
    s_add_u32 s39, s39, 16384
    buffer_load_dwordx4 v238, s[12:15], s39 offen lds
    s_add_u32 m0, m0, 1024
    s_add_u32 s39, s39, 16384
    buffer_load_dwordx4 v238, s[12:15], s39 offen lds
    s_setpc_b64 s[76:77]
PREP_a_issue_4:
    s_add_u32 s19, s41, s42
    v_readlane_b32 s16, v249, s44
    v_readlane_b32 s17, v250, s44
    s_add_u32 s16, s16, s38
    s_add_u32 s17, s17, s38
    s_add_u32 s44, s44, 1
    s_add_u32 s42, s42, 16384
    s_cmp_eq_u32 s42, 49152
    s_cselect_b32 s42, 0, s42
    s_setpc_b64 s[76:77]
PREP_w_issue_4:
    s_mov_b32 s45, 8192
    s_add_u32 s19, s41, s42
    v_readlane_b32 s16, v249, s44
    s_nop 0
    s_bitcmp1_b32 s16, 0
    s_cselect_b32 s17, 16384, s45
    s_cselect_b32 s18, -40960, s45
    s_andn2_b32 s16, s16, 1
    s_add_u32 s16, s16, s38
    s_add_u32 s44, s44, 1
    s_add_u32 s42, s42, 16384
    s_cmp_eq_u32 s42, 98304
    s_cselect_b32 s42, 0, s42
    s_setpc_b64 s[76:77]
K_end:
    s_endpgm
.p2align 6
K_tab:
.short 4096,5137,6178,11379,18660,25941,40502,33223,47784,55065,19706,12427,26988,34269,48830,41551,56096,9264,20736,10448,23824,25008,38384,35296,39568,49856,54128,52944,0,0,0,0
.short 4096,5137,6178,18659,11380,25941,33222,47783,40504,55065,12426,26987,19708,34269,41550,56111,48816,9264,10448,23824,20736,25008,35296,39568,38384,49856,52944,54128,0,0,0,0
.short 4096,5137,6178,11379,25940,18661,33222,40503,55064,47785,12426,19707,34268,26989,41550,48831,9264,56096,10448,20736,25008,23824,35296,38384,49856,39568,52944,54128,0,0,0,0
.short 4096,5137,6178,11379,18660,33221,25942,40503,47784,12425,55066,19707,26988,41549,34270,48831,56096,10448,9264,20736,23824,35296,25008,38384,39568,52944,49856,54128,0,0,0,0
.short 11377,12418,13459,18660,4101,25942,33223,47784,40505,55066,5147,26988,19709,34270,41551,56096,48816,6176,10288,23824,20736,25008,35296,39568,38384,49856,52944,54128,0,0,0,0
.short 11377,12418,13459,4100,25941,18662,33223,40504,55065,47786,5147,19708,34269,26990,41551,48816,6176,56096,10288,20736,25008,23824,35296,38384,49856,39568,52944,54128,0,0,0,0
.short 11377,12418,13459,4100,18661,33222,25943,40504,47785,5146,55067,19708,26989,41550,34271,48816,56096,10288,6176,20736,23824,35296,25008,38384,39568,52944,49856,54128,0,0,0,0
.short 11377,12418,13459,4100,18661,25942,40503,33224,47785,55066,19707,5148,26989,34270,48831,41536,56096,6176,20736,10288,23824,25008,38384,35296,39568,49856,54128,52944,0,0,0,0
.short 18658,19699,20740,4101,25942,11383,33224,40505,55066,47787,5148,12429,34270,26991,41536,48817,6176,56096,9264,10448,25008,23824,35296,38384,49856,39568,52944,54128,0,0,0,0
.short 18658,19699,20740,4101,11382,33223,25944,40505,47786,5147,55068,12429,26990,41551,34256,48817,56096,9264,6176,10448,23824,35296,25008,38384,39568,52944,49856,54128,0,0,0,0
.short 18658,19699,20740,4101,11382,25943,40504,33225,47786,55067,12428,5149,26990,34271,48816,41537,56096,6176,10448,9264,23824,25008,38384,35296,39568,49856,54128,52944,0,0,0,0
.short 18658,19699,20740,11381,4102,25943,33224,47785,40506,55067,5148,26989,12430,34271,41536,56097,48816,6176,9264,23824,10448,25008,35296,39568,38384,49856,52944,54128,0,0,0,0
.short 25939,26980,28021,4102,11383,33224,18665,40506,47787,5148,55069,12430,19711,41536,34257,48818,56096,9264,6176,10448,20736,35296,24848,38384,39568,52944,49856,54128,0,0,0,0
.short 25939,26980,28021,4102,11383,18664,40505,33226,47787,55068,12429,5150,19711,34256,48817,41538,56096,6176,10448,9264,20736,24848,38384,35296,39568,49856,54128,52944,0,0,0,0
.short 25939,26980,28021,11382,4103,18664,33225,47786,40507,55068,5149,19710,12431,34256,41537,56098,48816,6176,9264,20736,10448,24848,35296,39568,38384,49856,52944,54128,0,0,0,0
.short 25939,26980,28021,4102,18663,11384,33225,40506,55067,47788,5149,12430,34271,19696,41537,48818,6176,56096,9264,10448,24848,20736,35296,38384,49856,39568,52944,54128,0,0,0,0
.short 33220,34261,35302,4103,11384,18665,40506,25947,47788,55069,12430,5151,19696,26977,48818,41539,56096,6176,10448,9264,20736,23824,38384,25008,39568,49856,54128,52944,0,0,0,0
.short 33220,34261,35302,11383,4104,18665,25946,47787,40508,55069,5150,19711,12416,26977,41538,56099,48816,6176,9264,20736,10448,23824,25008,39568,38384,49856,52944,54128,0,0,0,0
.short 33220,34261,35302,4103,18664,11385,25946,40507,55068,47789,5150,12431,26976,19697,41538,48819,6176,56096,9264,10448,23824,20736,25008,38384,49856,39568,52944,54128,0,0,0,0
.short 33220,34261,35302,4103,11384,25945,18666,40507,47788,5149,55070,12431,19696,41537,26978,48819,56096,9264,6176,10448,20736,25008,23824,38384,39568,52944,49856,54128,0,0,0,0
.short 40501,41542,42583,11384,4105,18666,25947,47788,33229,55070,5151,19696,12417,26978,34259,56100,48816,6176,9264,20736,10448,23824,25008,39408,35296,49856,52944,54128,0,0,0,0
.short 40501,41542,42583,4104,18665,11386,25947,33228,55069,47790,5151,12416,26977,19698,34259,48820,6176,56096,9264,10448,23824,20736,25008,35296,49856,39408,52944,54128,0,0,0,0
.short 40501,41542,42583,4104,11385,25946,18667,33228,47789,5150,55071,12416,19697,34258,26979,48820,56096,9264,6176,10448,20736,25008,23824,35296,39408,52944,49856,54128,0,0,0,0
.short 40501,41542,42583,4104,11385,18666,33227,25948,47789,55070,12431,5136,19697,26978,48819,34260,56096,6176,10448,9264,20736,23824,35296,25008,39408,49856,54128,52944,0,0,0,0
.short 47782,48823,49864,4105,18666,11387,25948,33229,55070,40511,5136,12417,26978,19699,34260,41541,6176,56096,9264,10448,23824,20736,25008,35296,39568,38384,52944,54128,0,0,0,0
.short 47782,48823,49864,4105,11386,25947,18668,33229,40510,5151,55056,12417,19698,34259,26980,41541,56096,9264,6176,10448,20736,25008,23824,35296,38384,52944,39568,54128,0,0,0,0
.short 47782,48823,49864,4105,11386,18667,33228,25949,40510,55071,12416,5137,19698,26979,41540,34261,56096,6176,10448,9264,20736,23824,35296,25008,38384,39568,54128,52944,0,0,0,0
.short 47782,48823,49864,11385,4106,18667,25948,40509,33230,55071,5136,19697,12418,26979,34260,56101,41536,6176,9264,20736,10448,23824,25008,38384,35296,39568,52944,54128,0,0,0,0
.short 55063,56104,57145,4106,11387,25948,18669,33230,40511,5136,47777,12418,19699,34260,26981,41542,48816,9264,6176,10448,20736,25008,23824,35296,38384,49856,39568,53968,0,0,0,0
.short 55063,56104,57145,4106,11387,18668,33229,25950,40511,47776,12417,5138,19699,26980,41541,34262,48816,6176,10448,9264,20736,23824,35296,25008,38384,39568,53968,49856,0,0,0,0
.short 55063,56104,57145,11386,4107,18668,25949,40510,33231,47776,5137,19698,12419,26980,34261,48822,41536,6176,9264,20736,10448,23824,25008,38384,35296,39568,49856,53968,0,0,0,0
.short 55063,56104,57145,4106,18667,11388,25949,33230,47791,40496,5137,12418,26979,19700,34261,41542,6176,48816,9264,10448,23824,20736,25008,35296,39568,38384,49856,53968,0,0,0,0
.short 4104,5145,6186,11387,18668,25949,40510,33231,47776,55057,19698,12419,26980,34261,48822,41543,56096,9264,20736,10448,23824,25008,38384,35296,39568,49856,54128,52944,0,0,0,0
.short 4104,5145,6186,18667,11388,25949,33230,47791,40496,55057,12418,26979,19700,34261,41542,56103,48816,9264,10448,23824,20736,25008,35296,39568,38384,49856,52944,54128,0,0,0,0
.short 4104,5145,6186,11387,25948,18669,33230,40511,55056,47777,12418,19699,34260,26981,41542,48823,9264,56096,10448,20736,25008,23824,35296,38384,49856,39568,52944,54128,0,0,0,0
.short 4104,5145,6186,11387,18668,33229,25950,40511,47776,12417,55058,19699,26980,41541,34262,48823,56096,10448,9264,20736,23824,35296,25008,38384,39568,52944,49856,54128,0,0,0,0
.short 11385,12426,13467,18668,4109,25950,33231,47776,40497,55058,5139,26980,19701,34262,41543,56104,48816,6176,10288,23824,20736,25008,35296,39568,38384,49856,52944,54128,0,0,0,0
.short 11385,12426,13467,4108,25949,18670,33231,40496,55057,47778,5139,19700,34261,26982,41543,48824,6176,56096,10288,20736,25008,23824,35296,38384,49856,39568,52944,54128,0,0,0,0
.short 11385,12426,13467,4108,18669,33230,25951,40496,47777,5138,55059,19700,26981,41542,34263,48824,56096,10288,6176,20736,23824,35296,25008,38384,39568,52944,49856,54128,0,0,0,0
.short 11385,12426,13467,4108,18669,25950,40511,33216,47777,55058,19699,5140,26981,34262,48823,41544,56096,6176,20736,10288,23824,25008,38384,35296,39568,49856,54128,52944,0,0,0,0
.short 18666,19707,20748,4109,25950,11391,33216,40497,55058,47779,5140,12421,34262,26983,41544,48825,6176,56096,9264,10448,25008,23824,35296,38384,49856,39568,52944,54128,0,0,0,0
.short 18666,19707,20748,4109,11390,33231,25936,40497,47778,5139,55060,12421,26982,41543,34264,48825,56096,9264,6176,10448,23824,35296,25008,38384,39568,52944,49856,54128,0,0,0,0
.short 18666,19707,20748,4109,11390,25951,40496,33217,47778,55059,12420,5141,26982,34263,48824,41545,56096,6176,10448,9264,23824,25008,38384,35296,39568,49856,54128,52944,0,0,0,0
.short 18666,19707,20748,11389,4110,25951,33216,47777,40498,55059,5140,26981,12422,34263,41544,56105,48816,6176,9264,23824,10448,25008,35296,39568,38384,49856,52944,54128,0,0,0,0
.short 25947,26988,28029,4110,11391,33216,18657,40498,47779,5140,55061,12422,19703,41544,34265,48826,56096,9264,6176,10448,20736,35296,24848,38384,39568,52944,49856,54128,0,0,0,0
.short 25947,26988,28029,4110,11391,18656,40497,33218,47779,55060,12421,5142,19703,34264,48825,41546,56096,6176,10448,9264,20736,24848,38384,35296,39568,49856,54128,52944,0,0,0,0
.short 25947,26988,28029,11390,4111,18656,33217,47778,40499,55060,5141,19702,12423,34264,41545,56106,48816,6176,9264,20736,10448,24848,35296,39568,38384,49856,52944,54128,0,0,0,0
.short 25947,26988,28029,4110,18671,11376,33217,40498,55059,47780,5141,12422,34263,19704,41545,48826,6176,56096,9264,10448,24848,20736,35296,38384,49856,39568,52944,54128,0,0,0,0
.short 33228,34269,35310,4111,11376,18657,40498,25939,47780,55061,12422,5143,19704,26985,48826,41547,56096,6176,10448,9264,20736,23824,38384,25008,39568,49856,54128,52944,0,0,0,0
.short 33228,34269,35310,11391,4096,18657,25938,47779,40500,55061,5142,19703,12424,26985,41546,56107,48816,6176,9264,20736,10448,23824,25008,39568,38384,49856,52944,54128,0,0,0,0
.short 33228,34269,35310,4111,18656,11377,25938,40499,55060,47781,5142,12423,26984,19705,41546,48827,6176,56096,9264,10448,23824,20736,25008,38384,49856,39568,52944,54128,0,0,0,0
.short 33228,34269,35310,4111,11376,25937,18658,40499,47780,5141,55062,12423,19704,41545,26986,48827,56096,9264,6176,10448,20736,25008,23824,38384,39568,52944,49856,54128,0,0,0,0
.short 40509,41550,42591,11376,4097,18658,25939,47780,33221,55062,5143,19704,12425,26986,34267,56108,48816,6176,9264,20736,10448,23824,25008,39408,35296,49856,52944,54128,0,0,0,0
.short 40509,41550,42591,4096,18657,11378,25939,33220,55061,47782,5143,12424,26985,19706,34267,48828,6176,56096,9264,10448,23824,20736,25008,35296,49856,39408,52944,54128,0,0,0,0
.short 40509,41550,42591,4096,11377,25938,18659,33220,47781,5142,55063,12424,19705,34266,26987,48828,56096,9264,6176,10448,20736,25008,23824,35296,39408,52944,49856,54128,0,0,0,0
.short 40509,41550,42591,4096,11377,18658,33219,25940,47781,55062,12423,5144,19705,26986,48827,34268,56096,6176,10448,9264,20736,23824,35296,25008,39408,49856,54128,52944,0,0,0,0
.short 47790,48831,49856,4097,18658,11379,25940,33221,55062,40503,5144,12425,26986,19707,34268,41549,6176,56096,9264,10448,23824,20736,25008,35296,39568,38384,52944,54128,0,0,0,0
.short 47790,48831,49856,4097,11378,25939,18660,33221,40502,5143,55064,12425,19706,34267,26988,41549,56096,9264,6176,10448,20736,25008,23824,35296,38384,52944,39568,54128,0,0,0,0
.short 47790,48831,49856,4097,11378,18659,33220,25941,40502,55063,12424,5145,19706,26987,41548,34269,56096,6176,10448,9264,20736,23824,35296,25008,38384,39568,54128,52944,0,0,0,0
.short 47790,48831,49856,11377,4098,18659,25940,40501,33222,55063,5144,19705,12426,26987,34268,56109,41536,6176,9264,20736,10448,23824,25008,38384,35296,39568,52944,54128,0,0,0,0
.short 55071,56096,57137,4098,11379,25940,18661,33222,40503,5144,47785,12426,19707,34268,26989,41550,48816,9264,6176,10448,20736,25008,23824,35296,38384,49856,39568,53968,0,0,0,0
.short 55071,56096,57137,4098,11379,18660,33221,25942,40503,47784,12425,5146,19707,26988,41549,34270,48816,6176,10448,9264,20736,23824,35296,25008,38384,39568,53968,49856,0,0,0,0
.short 55071,56096,57137,11378,4099,18660,25941,40502,33223,47784,5145,19706,12427,26988,34269,48830,41536,6176,9264,20736,10448,23824,25008,38384,35296,39568,49856,53968,0,0,0,0
.short 55071,56096,57137,4098,18659,11380,25941,33222,47783,40504,5145,12426,26987,19708,34269,41550,6176,48816,9264,10448,23824,20736,25008,35296,39568,38384,49856,53968,0,0,0,0
.section .rodata,"a"
.p2align 6
.amdhsa_kernel interleave_layers__ssm_conv_h3__mixer_s_mlp__prompt_kernel
  .amdhsa_next_free_vgpr 256
  .amdhsa_next_free_sgpr 102
  .amdhsa_accum_offset 256
  .amdhsa_group_segment_fixed_size 0
  .amdhsa_kernarg_size 112
  .amdhsa_user_sgpr_count 2
  .amdhsa_user_sgpr_kernarg_segment_ptr 1
  .amdhsa_system_sgpr_workgroup_id_x 1
  .amdhsa_float_denorm_mode_32 3
.end_amdhsa_kernel
```

```asm
; @launch grid=(256,1,1) block=(512,1,1) lds=163840
.amdgcn_target "amdgcn-amd-amdhsa--gfx950"
.text
.globl interleave_layers__ssm_conv_h3__mixer_s_mlp__prompt_kernel
.p2align 8
.type interleave_layers__ssm_conv_h3__mixer_s_mlp__prompt_kernel,@function
interleave_layers__ssm_conv_h3__mixer_s_mlp__prompt_kernel:
    s_cmp_ge_u32 s2, 256
    s_cbranch_scc1 K_end
    s_load_dwordx8 s[8:15], s[0:1], 8
    s_load_dwordx2 s[6:7], s[0:1], 0
    s_load_dwordx8 s[68:75], s[0:1], 56
    s_load_dwordx2 s[4:5], s[0:1], 104
    s_load_dwordx2 s[84:85], s[0:1], 96
    s_memrealtime s[46:47]
    s_load_dwordx2 s[96:97], s[0:1], 40
    v_lshrrev_b32 v1, 6, v0
    s_nop 0
    v_readfirstlane_b32 s30, v1
    s_getpc_b64 s[48:49]
K_pc:
    s_lshr_b32 s36, s2, 3
    s_lshl_b32 s36, s36, 11
    v_lshlrev_b32 v4, 2, v0
    v_add_u32 v4, s36, v4
    v_cmp_gt_u32 vcc, K_end-K_pc-8, v4
    s_nop 0
    s_and_saveexec_b64 s[36:37], vcc
    s_cbranch_execz K_3
    v_mov_b32 v5, s49
    v_add_co_u32 v4, vcc, s48, v4
    s_nop 1
    v_addc_co_u32 v5, vcc, 0, v5, vcc
    global_load_dword v250, v[4:5], off
K_3:
    s_mov_b64 exec, -1
    v_and_b32 v6, 31, v0
    v_lshrrev_b32 v7, 5, v0
    s_and_b32 s34, s2, 7
    s_lshr_b32 s35, s2, 3
    s_lshl_b32 s36, s35, 17
    s_lshl_b32 s37, s34, 8
    s_add_u32 s36, s36, s37
    v_lshlrev_b32 v8, 13, v7
    v_lshl_add_u32 v8, v6, 3, v8
    v_add_u32 v12, s36, v8
    v_add_u32 v14, 4096, v12
    s_mov_b32 s18, 4194304
    s_mov_b32 s19, 0x20000
    s_mov_b32 s22, s18
    s_mov_b32 s23, s19
    s_waitcnt lgkmcnt(0)
    s_mov_b32 s86, 256
    s_mov_b32 s87, 0x20000
    v_mov_b32 v78, 0
    s_lshl_b32 s45, s2, 3
    s_add_u32 s45, s45, s30
    s_cmp_lg_u32 s45, 4
    s_cbranch_scc1 KV_t0
    s_getreg_b32 s45, hwreg(HW_REG_XCC_ID, 0, 3)
    s_lshl_b32 s45, s45, 1
    s_lshl_b32 s44, s46, 6
    s_or_b32 s44, s44, s45
    s_or_b32 s44, s44, 1
    v_mov_b32 v76, s44
    v_mov_b32 v77, 0
    s_mov_b64 exec, 1
    buffer_store_dwordx2 v[76:77], v78, s[84:87], 0 offen sc1
    s_mov_b64 exec, -1
KV_t0:
    s_mov_b64 s[16:17], s[8:9]
    s_mov_b64 s[20:21], s[10:11]
    buffer_load_dwordx2 v[28:29], v12, s[16:19], 0 offen offset:0 nt
    buffer_load_dwordx2 v[30:31], v12, s[16:19], 0 offen offset:2048 nt
    buffer_load_dwordx2 v[32:33], v14, s[16:19], 0 offen offset:0 nt
    buffer_load_dwordx2 v[34:35], v14, s[16:19], 0 offen offset:2048 nt
    buffer_load_dwordx2 v[36:37], v12, s[20:23], 0 offen offset:0 nt
    buffer_load_dwordx2 v[38:39], v12, s[20:23], 0 offen offset:2048 nt
    buffer_load_dwordx2 v[40:41], v14, s[20:23], 0 offen offset:0 nt
    buffer_load_dwordx2 v[42:43], v14, s[20:23], 0 offen offset:2048 nt
    v_subrev_u32 v9, 6144, v12
    v_subrev_u32 v10, 4096, v12
    v_subrev_u32 v11, 2048, v12
    s_lshl_b32 s37, s34, 10
    v_lshlrev_b32 v16, 5, v6
    v_add_u32 v16, s37, v16
    s_mov_b32 s24, s12
    s_mov_b32 s25, s13
    s_mov_b32 s26, 0x2000
    s_mov_b32 s27, 0x20000
    v_and_b32 v8, 1, v7
    v_lshl_add_u32 v16, v8, 4, v16
    buffer_load_dwordx4 v[44:47], v16, s[24:27], 0 offen
    s_cmp_lg_u32 s30, 4
    s_cbranch_scc1 KV_t2
    buffer_load_dword v76, v78, s[84:87], 0 offen sc1
KV_t2:
    s_bfm_b64 exec, 32, 0
    buffer_load_dwordx2 v[22:23], v9, s[16:19], 0 offen nt
    buffer_load_dwordx2 v[24:25], v10, s[16:19], 0 offen nt
    buffer_load_dwordx2 v[26:27], v11, s[16:19], 0 offen nt
    s_mov_b64 exec, -1
    v_and_b32 v1, 63, v0
    v_lshlrev_b32 v2, 4, v1
    v_lshlrev_b32 v3, 2, v1
    s_mov_b32 s67, 0
    s_mov_b32 s60, 0
    s_mov_b32 s61, 40000
    s_mov_b32 s52, 0
    s_mov_b32 s55, 0
    s_mov_b32 s92, 0
    s_mov_b32 s93, 0
    s_mov_b32 s94, 0
    s_mov_b32 s56, s4
    s_mov_b32 s57, s5
    s_mov_b32 s58, 0xa000000
    s_mov_b32 s59, 0x20000
    s_add_u32 s62, s4, 33554432
    s_addc_u32 s63, s5, 0
    s_and_b32 s41, s30, 3
    s_and_b32 s38, s2, 7
    s_lshl_b32 s38, s38, 5
    s_lshr_b32 s39, s2, 3
    s_add_u32 s38, s38, s39
    s_lshl_b32 s39, s38, 2
    s_add_u32 s39, s39, s41
    s_mul_i32 s40, s41, 24576
    s_lshr_b32 s36, s39, 1
    s_lshl_b32 s36, s36, 2
    s_load_dword s98, s[96:97], s36
    s_lshl_b32 s36, s39, 12
    s_add_u32 s12, s14, s36
    s_addc_u32 s13, s15, 0
    s_mov_b32 s14, 4096
    s_mov_b32 s15, 0x20000
    s_lshr_b32 s45, s30, 2
    s_lshl_b32 s45, s45, 11
    s_add_u32 s36, s45, 0xffffffc0
    v_add_u32 v70, s36, v2
    v_add_u32 v71, 16, v70
    s_add_u32 s36, s45, 0x3c0
    v_add_u32 v72, s36, v2
    v_add_u32 v73, 16, v72
    s_mov_b32 s36, 4032
    v_add_u32 v74, s36, v2
    v_add_u32 v75, 16, v74
    s_and_b32 s34, s2, 7
    s_lshr_b32 s35, s2, 3
    v_mov_b32 v80, 0
    v_mov_b32 v81, 0
    v_mov_b32 v82, 0
    v_mov_b32 v83, 0
    v_add_u32 v86, s40, v2
    ds_write_b128 v86, v[80:83] offset:22784
    s_bfm_b64 exec, 26, 0
    ds_write_b128 v86, v[80:83] offset:23808
    s_mov_b64 exec, -1
    v_lshlrev_b32 v8, 2, v7
    v_sub_u32 v8, 60, v8
    v_lshrrev_b32 v85, 3, v8
    v_bfe_u32 v84, v6, 1, 3
    v_xor_b32 v85, v85, v84
    v_lshlrev_b32 v85, 4, v85
    v_and_b32 v8, 7, v8
    v_lshl_add_u32 v85, v8, 1, v85
    v_lshl_add_u32 v84, v6, 9, v85
    v_add_u32 v84, 98304, v84
    s_waitcnt vmcnt(0)
    s_cmp_lg_u32 s30, 4
    s_cbranch_scc1 KV_t1
KV_t1:
    buffer_load_dwordx4 v[52:55], v70, s[12:15], 0 offen nt
    buffer_load_dwordx2 v[56:57], v71, s[12:15], 0 offen nt
    buffer_load_dwordx4 v[58:61], v72, s[12:15], 0 offen nt
    buffer_load_dwordx2 v[62:63], v73, s[12:15], 0 offen nt
    buffer_load_dwordx4 v[64:67], v74, s[12:15], 0 offen nt
    buffer_load_dwordx2 v[68:69], v75, s[12:15], 0 offen nt
    v_mov_b32 v48, v44
    v_mov_b32 v49, v45
    v_mov_b32 v50, v46
    v_mov_b32 v51, v47
    v_mov_b32 v126, v30
    v_mov_b32 v127, v31
    v_mov_b32 v128, v32
    v_mov_b32 v129, v33
    v_mov_b32 v130, v34
    v_mov_b32 v131, v35
    v_permlane32_swap_b32 v44, v48
    v_permlane32_swap_b32 v45, v49
    v_permlane32_swap_b32 v46, v50
    v_permlane32_swap_b32 v47, v51
    v_permlane32_swap_b32 v22, v126
    v_permlane32_swap_b32 v23, v127
    v_permlane32_swap_b32 v24, v128
    v_permlane32_swap_b32 v25, v129
    v_permlane32_swap_b32 v26, v130
    v_permlane32_swap_b32 v27, v131
    v_lshlrev_b32 v88, 16, v44
    v_and_b32 v90, 0xffff0000, v44
    v_lshlrev_b32 v92, 16, v45
    v_and_b32 v94, 0xffff0000, v45
    v_lshlrev_b32 v89, 16, v46
    v_and_b32 v91, 0xffff0000, v46
    v_lshlrev_b32 v93, 16, v47
    v_and_b32 v95, 0xffff0000, v47
    v_lshlrev_b32 v96, 16, v22
    v_and_b32 v97, 0xffff0000, v22
    v_lshlrev_b32 v98, 16, v24
    v_and_b32 v99, 0xffff0000, v24
    v_lshlrev_b32 v100, 16, v26
    v_and_b32 v101, 0xffff0000, v26
    v_lshlrev_b32 v102, 16, v28
    v_and_b32 v103, 0xffff0000, v28
    v_lshlrev_b32 v104, 16, v30
    v_and_b32 v105, 0xffff0000, v30
    v_lshlrev_b32 v106, 16, v32
    v_and_b32 v107, 0xffff0000, v32
    v_lshlrev_b32 v108, 16, v34
    v_and_b32 v109, 0xffff0000, v34
    v_lshlrev_b32 v110, 16, v36
    v_and_b32 v111, 0xffff0000, v36
    v_lshlrev_b32 v112, 16, v38
    v_and_b32 v113, 0xffff0000, v38
    v_lshlrev_b32 v114, 16, v40
    v_and_b32 v115, 0xffff0000, v40
    v_lshlrev_b32 v116, 16, v42
    v_and_b32 v117, 0xffff0000, v42
    v_pk_mul_f32 v[118:119], v[96:97], v[94:95]
    v_pk_mul_f32 v[120:121], v[98:99], v[94:95]
    v_pk_mul_f32 v[122:123], v[100:101], v[94:95]
    v_pk_mul_f32 v[124:125], v[102:103], v[94:95]
    v_pk_fma_f32 v[118:119], v[98:99], v[92:93], v[118:119]
    v_pk_fma_f32 v[120:121], v[100:101], v[92:93], v[120:121]
    v_pk_fma_f32 v[122:123], v[102:103], v[92:93], v[122:123]
    v_pk_fma_f32 v[124:125], v[104:105], v[92:93], v[124:125]
    v_pk_fma_f32 v[118:119], v[100:101], v[90:91], v[118:119]
    v_pk_fma_f32 v[120:121], v[102:103], v[90:91], v[120:121]
    v_pk_fma_f32 v[122:123], v[104:105], v[90:91], v[122:123]
    v_pk_fma_f32 v[124:125], v[106:107], v[90:91], v[124:125]
    v_pk_fma_f32 v[118:119], v[102:103], v[88:89], v[118:119]
    v_pk_fma_f32 v[120:121], v[104:105], v[88:89], v[120:121]
    v_pk_fma_f32 v[122:123], v[106:107], v[88:89], v[122:123]
    v_pk_fma_f32 v[124:125], v[108:109], v[88:89], v[124:125]
    v_pk_mul_f32 v[118:119], v[118:119], v[110:111]
    v_pk_mul_f32 v[120:121], v[120:121], v[112:113]
    v_pk_mul_f32 v[122:123], v[122:123], v[114:115]
    v_pk_mul_f32 v[124:125], v[124:125], v[116:117]
    v_cvt_pk_bf16_f32 v136, v124, v122
    v_cvt_pk_bf16_f32 v137, v120, v118
    ds_write_b64 v84, v[136:137] offset:0
    v_cvt_pk_bf16_f32 v138, v125, v123
    v_cvt_pk_bf16_f32 v139, v121, v119
    ds_write_b64 v84, v[138:139] offset:128
    v_lshlrev_b32 v88, 16, v48
    v_and_b32 v90, 0xffff0000, v48
    v_lshlrev_b32 v92, 16, v49
    v_and_b32 v94, 0xffff0000, v49
    v_lshlrev_b32 v89, 16, v50
    v_and_b32 v91, 0xffff0000, v50
    v_lshlrev_b32 v93, 16, v51
    v_and_b32 v95, 0xffff0000, v51
    v_lshlrev_b32 v96, 16, v23
    v_and_b32 v97, 0xffff0000, v23
    v_lshlrev_b32 v98, 16, v25
    v_and_b32 v99, 0xffff0000, v25
    v_lshlrev_b32 v100, 16, v27
    v_and_b32 v101, 0xffff0000, v27
    v_lshlrev_b32 v102, 16, v29
    v_and_b32 v103, 0xffff0000, v29
    v_lshlrev_b32 v104, 16, v31
    v_and_b32 v105, 0xffff0000, v31
    v_lshlrev_b32 v106, 16, v33
    v_and_b32 v107, 0xffff0000, v33
    v_lshlrev_b32 v108, 16, v35
    v_and_b32 v109, 0xffff0000, v35
    v_lshlrev_b32 v110, 16, v37
    v_and_b32 v111, 0xffff0000, v37
    v_lshlrev_b32 v112, 16, v39
    v_and_b32 v113, 0xffff0000, v39
    v_lshlrev_b32 v114, 16, v41
    v_and_b32 v115, 0xffff0000, v41
    v_lshlrev_b32 v116, 16, v43
    v_and_b32 v117, 0xffff0000, v43
    v_pk_mul_f32 v[118:119], v[96:97], v[94:95]
    v_pk_mul_f32 v[120:121], v[98:99], v[94:95]
    v_pk_mul_f32 v[122:123], v[100:101], v[94:95]
    v_pk_mul_f32 v[124:125], v[102:103], v[94:95]
    v_pk_fma_f32 v[118:119], v[98:99], v[92:93], v[118:119]
    v_pk_fma_f32 v[120:121], v[100:101], v[92:93], v[120:121]
    v_pk_fma_f32 v[122:123], v[102:103], v[92:93], v[122:123]
    v_pk_fma_f32 v[124:125], v[104:105], v[92:93], v[124:125]
    v_pk_fma_f32 v[118:119], v[100:101], v[90:91], v[118:119]
    v_pk_fma_f32 v[120:121], v[102:103], v[90:91], v[120:121]
    v_pk_fma_f32 v[122:123], v[104:105], v[90:91], v[122:123]
    v_pk_fma_f32 v[124:125], v[106:107], v[90:91], v[124:125]
    v_pk_fma_f32 v[118:119], v[102:103], v[88:89], v[118:119]
    v_pk_fma_f32 v[120:121], v[104:105], v[88:89], v[120:121]
    v_pk_fma_f32 v[122:123], v[106:107], v[88:89], v[122:123]
    v_pk_fma_f32 v[124:125], v[108:109], v[88:89], v[124:125]
    v_pk_mul_f32 v[118:119], v[118:119], v[110:111]
    v_pk_mul_f32 v[120:121], v[120:121], v[112:113]
    v_pk_mul_f32 v[122:123], v[122:123], v[114:115]
    v_pk_mul_f32 v[124:125], v[124:125], v[116:117]
    v_cvt_pk_bf16_f32 v140, v124, v122
    v_cvt_pk_bf16_f32 v141, v120, v118
    ds_write_b64 v84, v[140:141] offset:256
    v_cvt_pk_bf16_f32 v142, v125, v123
    v_cvt_pk_bf16_f32 v143, v121, v119
    ds_write_b64 v84, v[142:143] offset:384
    s_cmp_lg_u32 s30, 4
    s_cbranch_scc1 HB_2
    v_add_u32 v18, 162816, v3
    ds_write_b32 v18, v78
    s_mov_b32 s53, 0
    s_waitcnt vmcnt(6)
HB_p:
    v_readfirstlane_b32 s52, v76
    s_nop 0
    s_cmp_eq_u32 s52, 0
    s_cbranch_scc1 HB_r
    s_cmp_ge_u32 s53, 60
    s_cbranch_scc1 HB_q
    s_add_u32 s54, s46, 8192
    s_lshl_b32 s54, s54, 6
    s_sub_u32 s54, s54, s52
    s_cmp_lt_u32 s54, 786432
    s_cbranch_scc1 HB_q
HB_r:
    buffer_load_dword v76, v78, s[84:87], 0 offen sc1
    s_waitcnt vmcnt(0)
    s_add_u32 s53, s53, 1
    s_cmp_lt_u32 s53, s61
    s_cbranch_scc1 HB_p
    s_mov_b32 s52, 1
    s_mov_b32 s61, 0
HB_q:
    v_mov_b32 v18, 162828
    v_mov_b32 v19, s52
    s_waitcnt lgkmcnt(0)
    ds_write_b32 v18, v19
HB_2:
    s_add_u32 s16, s4, 0x2000000
    s_addc_u32 s17, s5, 0
    s_mov_b32 s18, 0x8000000
    s_mov_b32 s19, 0x20000
    v_lshrrev_b32 v8, 3, v0
    v_and_b32 v85, 7, v0
    v_lshlrev_b32 v149, 12, v8
    v_lshl_add_u32 v149, v85, 4, v149
    s_lshl_b32 s36, s34, 24
    s_sub_u32 s37, 31, s35
    s_lshl_b32 s37, s37, 7
    s_add_u32 s36, s36, s37
    s_add_u32 s37, s36, 262144
    v_lshrrev_b32 v148, 3, v8
    v_xor_b32 v148, v148, v85
    v_lshlrev_b32 v148, 4, v148
    v_lshl_add_u32 v148, v8, 7, v148
    v_add_u32 v148, 98304, v148
    v_mov_b32 v18, 162828
    s_waitcnt lgkmcnt(0)
    s_barrier
    ds_read_b128 v[152:155], v148 offset:0
    ds_read_b128 v[156:159], v148 offset:8192
    ds_read_b32 v19, v18
    s_waitcnt lgkmcnt(2)
    v_or_b32 v152, 1, v152
    buffer_store_dwordx4 v[152:155], v149, s[16:19], s36 offen sc1
    s_waitcnt lgkmcnt(1)
    v_or_b32 v156, 1, v156
    buffer_store_dwordx4 v[156:159], v149, s[16:19], s37 offen sc1
    s_waitcnt lgkmcnt(0)
    v_readfirstlane_b32 s52, v19
    s_cmp_lg_u32 s30, 0
    s_cbranch_scc1 KV_ni
    s_cmp_ge_u32 s35, 16
    s_cbranch_scc1 KV_ni
    v_mov_b32 v8, s52
    s_lshl_b32 s37, s34, 7
    s_lshl_b32 s53, s35, 10
    s_add_u32 s37, s37, s53
    s_add_u32 s37, s37, 23101440
    s_mov_b64 exec, 1
    buffer_store_dword v8, v78, s[56:59], s37 offen sc1
    s_mov_b64 exec, -1
KV_ni:
    s_cmp_ge_u32 s2, 32
    s_cbranch_scc1 KV_n3
    s_cmp_lg_u32 s30, 5
    s_cbranch_scc1 KV_n3
    s_and_b32 s42, s2, 7
    s_lshl_b32 s42, s42, 10
    s_lshr_b32 s43, s2, 3
    s_lshl_b32 s43, s43, 14
    s_add_u32 s42, s42, s43
    s_add_u32 s42, s42, 39714816
    v_lshrrev_b32 v8, 5, v1
    v_mul_u32_u24 v8, 7680, v8
    v_add_u32 v8, v8, v2
    buffer_store_dwordx4 v[80:83], v8, s[56:59], s42 offen sc1
KV_n3:
    s_bfe_u32 s32, s52, 0x30001
    s_add_u32 s32, s32, s2
    s_and_b32 s32, s32, 7
    s_lshr_b32 s33, s2, 3
    s_and_b32 s28, s32, 2
    s_lshr_b32 s53, s32, 2
    s_or_b32 s28, s28, s53
    s_lshl_b32 s28, s28, 2
    s_and_b32 s53, s33, 3
    s_add_u32 s28, s28, s53
    s_and_b32 s31, s32, 1
    s_lshr_b32 s33, s33, 2
    s_lshl_b32 s29, s31, 3
    s_add_u32 s29, s29, s33
    s_xor_b32 s99, s29, 1
    v_and_b32 v199, 7, v0
    v_lshrrev_b32 v228, 6, v0
    v_lshlrev_b32 v228, 4, v228
    v_bfe_u32 v229, v0, 3, 3
    v_add_u32 v228, v228, v229
    s_lshr_b32 s78, s29, 1
    s_lshl_b32 s78, s78, 16
    s_and_b32 s79, s29, 1
    s_lshl_b32 s79, s79, 7
    s_add_u32 s78, s78, s79
    s_lshr_b32 s79, s30, 1
    s_lshl_b32 s79, s79, 13
    s_add_u32 s78, s78, s79
    v_lshlrev_b32 v196, 8, v228
    v_lshl_add_u32 v196, v199, 4, v196
    v_add_u32 v196, s78, v196
    s_lshl_b32 s78, s28, 7
    s_lshl_b32 s79, s29, 3
    s_add_u32 s78, s78, s79
    v_add_u32 v197, s78, v199
    v_lshlrev_b32 v198, 11, v197
    v_lshrrev_b32 v229, 2, v228
    v_lshlrev_b32 v229, 3, v229
    v_and_b32 v228, 3, v228
    v_add_u32 v228, v228, v229
    v_lshl_add_u32 v198, v228, 3, v198
    v_and_b32 v197, 15, v197
    v_lshlrev_b32 v197, 4, v197
    v_and_b32 v229, 15, v228
    v_lshl_add_u32 v197, v229, 9, v197
    v_lshrrev_b32 v229, 4, v228
    v_lshl_add_u32 v197, v229, 14, v197
    s_lshr_b32 s78, s28, 3
    s_lshl_b32 s78, s78, 2
    s_and_b32 s79, s28, 3
    s_add_u32 s78, s78, s79
    s_lshl_b32 s78, s78, 24
    s_and_b32 s79, s28, 4
    s_lshl_b32 s79, s79, 11
    s_add_u32 s78, s78, s79
    s_and_b32 s79, s29, 4
    s_lshl_b32 s79, s79, 6
    s_add_u32 s78, s78, s79
    s_and_b32 s79, s29, 2
    s_lshl_b32 s79, s79, 2
    s_add_u32 s78, s78, s79
    s_lshl_b32 s79, s31, 18
    s_add_u32 s78, s78, s79
    v_add_u32 v197, s78, v197
    s_lshl_b32 s36, s34, 5
    s_add_u32 s36, s36, s35
    s_lshl_b32 s36, s36, 7
    s_add_u32 s36, s36, 23068672
    v_mov_b32 v18, 1
    v_mov_b32 v19, 162820
    v_mov_b32 v21, 0
    s_mov_b64 exec, 1
    s_waitcnt vmcnt(0)
    ds_add_rtn_u32 v20, v19, v18
    v_mov_b32 v19, s52
    s_waitcnt lgkmcnt(0)
    v_readfirstlane_b32 s54, v20
    s_nop 0
    s_and_b32 s54, s54, 7
    s_cmp_lg_u32 s54, 7
    s_cbranch_scc1 pub_1
    buffer_store_dword v19, v21, s[56:59], s36 offen sc1
pub_1:
    s_mov_b64 exec, -1
    s_mov_b32 s8, s6
    s_mov_b32 s9, s7
    s_mov_b32 s10, 0x400000
    s_mov_b32 s11, 0x20000
    buffer_load_dwordx2 v[180:181], v198, s[8:11], 0 offen offset:0 nt
    buffer_load_dwordx2 v[182:183], v198, s[8:11], 0 offen offset:32 nt
    buffer_load_dwordx2 v[184:185], v198, s[8:11], 0 offen offset:128 nt
    buffer_load_dwordx2 v[186:187], v198, s[8:11], 0 offen offset:160 nt
    v_add_u32 v160, s45, v86
    v_alignbit_b32 v88, v53, v52, 16
    v_mov_b32 v92, v53
    v_alignbit_b32 v96, v54, v53, 16
    v_alignbit_b32 v89, v54, v53, 16
    v_mov_b32 v93, v54
    v_alignbit_b32 v97, v55, v54, 16
    v_alignbit_b32 v90, v55, v54, 16
    v_mov_b32 v94, v55
    v_alignbit_b32 v98, v56, v55, 16
    v_alignbit_b32 v91, v56, v55, 16
    v_mov_b32 v95, v56
    v_alignbit_b32 v99, v57, v56, 16
    ds_write_b128 v160, v[88:91] offset:0
    ds_write_b128 v160, v[92:95] offset:4160
    ds_write_b128 v160, v[96:99] offset:8320
    ds_write_b128 v160, v[54:57] offset:12480
    v_alignbit_b32 v100, v59, v58, 16
    v_mov_b32 v104, v59
    v_alignbit_b32 v108, v60, v59, 16
    v_alignbit_b32 v101, v60, v59, 16
    v_mov_b32 v105, v60
    v_alignbit_b32 v109, v61, v60, 16
    v_alignbit_b32 v102, v61, v60, 16
    v_mov_b32 v106, v61
    v_alignbit_b32 v110, v62, v61, 16
    v_alignbit_b32 v103, v62, v61, 16
    v_mov_b32 v107, v62
    v_alignbit_b32 v111, v63, v62, 16
    ds_write_b128 v160, v[100:103] offset:1024
    ds_write_b128 v160, v[104:107] offset:5184
    ds_write_b128 v160, v[108:111] offset:9344
    ds_write_b128 v160, v[60:63] offset:13504
    v_alignbit_b32 v112, v65, v64, 16
    v_mov_b32 v116, v65
    v_alignbit_b32 v120, v66, v65, 16
    v_alignbit_b32 v113, v66, v65, 16
    v_mov_b32 v117, v66
    v_alignbit_b32 v121, v67, v66, 16
    v_alignbit_b32 v114, v67, v66, 16
    v_mov_b32 v118, v67
    v_alignbit_b32 v122, v68, v67, 16
    v_alignbit_b32 v115, v68, v67, 16
    v_mov_b32 v119, v68
    v_alignbit_b32 v123, v69, v68, 16
    s_mov_b64 exec, 0xf
    ds_write_b128 v86, v[112:115] offset:4096
    ds_write_b128 v86, v[116:119] offset:8256
    ds_write_b128 v86, v[120:123] offset:12416
    ds_write_b128 v86, v[66:69] offset:16576
    s_mov_b64 exec, -1
    s_waitcnt lgkmcnt(0)
    s_barrier
    v_mov_b32 v238, 0
    v_mov_b32 v239, 0
    v_mov_b32 v240, 0
    v_mov_b32 v241, 0
    v_mov_b32 v242, 0
    v_mov_b32 v243, 0
    v_mov_b32 v244, 0
    v_mov_b32 v245, 0
    v_mov_b32 v246, 0
    v_mov_b32 v247, 0
    s_cmp_ge_u32 s30, 4
    s_cbranch_scc1 FR_b
    s_and_b32 s38, s2, 7
    s_lshl_b32 s38, s38, 5
    s_lshr_b32 s39, s2, 3
    s_add_u32 s38, s38, s39
    s_lshl_b32 s39, s38, 2
    s_add_u32 s39, s39, s30
    s_mul_i32 s40, s30, 24576
    s_and_b32 s36, s39, 127
    s_lshl_b32 s36, s36, 12
    s_lshr_b32 s37, s39, 7
    s_lshl_b32 s37, s37, 24
    s_add_u32 s36, s36, s37
    s_add_u32 s36, s36, 33554432
    s_add_u32 s16, s4, s36
    s_addc_u32 s17, s5, 0
    s_mov_b32 s18, 4096
    s_mov_b32 s19, 0x20000
    v_lshrrev_b32 v6, 2, v1
    v_mul_u32_u24 v12, 96, v6
    v_and_b32 v6, 3, v1
    v_lshl_add_u32 v12, v6, 4, v12
    v_add_u32 v12, s40, v12
    v_and_b32 v35, 15, v1
    v_lshrrev_b32 v36, 4, v1
    v_and_b32 v6, 3, v35
    v_mul_u32_u24 v32, 4160, v6
    v_lshl_add_u32 v32, v36, 4, v32
    v_lshrrev_b32 v6, 2, v35
    v_lshl_add_u32 v32, v6, 3, v32
    v_add_u32 v32, s40, v32
    v_sub_u32 v6, 15, v35
    v_mul_u32_u24 v34, 96, v6
    v_add_u32 v34, s40, v34
    v_lshl_add_u32 v33, v36, 4, v34
    ds_read_b64 v[72:73], v32 offset:0
    ds_read_b64 v[74:75], v32 offset:8
    ds_read_b64 v[76:77], v32 offset:32
    ds_read_b64 v[78:79], v32 offset:40
    ds_read_b64 v[80:81], v32 offset:1024
    ds_read_b64 v[82:83], v32 offset:1032
    ds_read_b64 v[84:85], v32 offset:1056
    ds_read_b64 v[86:87], v32 offset:1064
    ds_read_b64 v[88:89], v32 offset:2048
    ds_read_b64 v[90:91], v32 offset:2056
    ds_read_b64 v[92:93], v32 offset:2080
    ds_read_b64 v[94:95], v32 offset:2088
    ds_read_b64 v[96:97], v32 offset:3072
    ds_read_b64 v[98:99], v32 offset:3080
    ds_read_b64 v[100:101], v32 offset:3104
    ds_read_b64 v[102:103], v32 offset:3112
    s_bitcmp1_b32 s39, 0
    s_cselect_b32 s36, 0, 16
    s_lshl_b32 s41, s98, s36
    s_and_b32 s41, s41, 0xffff0000
    s_lshr_b32 s36, s41, 16
    v_lshl_add_u32 v6, v36, 3, v35
    v_sub_u32 v6, 31, v6
    v_mov_b32 v10, s36
    v_mov_b32 v11, s41
    v_and_b32 v8, 1, v6
    v_cmp_eq_u32 vcc, 1, v8
    s_nop 1
    v_cndmask_b32 v10, v10, v11, vcc
    v_ashrrev_i32 v6, 1, v6
    v_cmp_eq_u32 vcc, 0, v6
    s_nop 1
    v_cndmask_b32 v152, 0, v10, vcc
    v_cmp_eq_u32 vcc, 1, v6
    s_nop 1
    v_cndmask_b32 v153, 0, v10, vcc
    v_cmp_eq_u32 vcc, 2, v6
    s_nop 1
    v_cndmask_b32 v154, 0, v10, vcc
    v_cmp_eq_u32 vcc, 3, v6
    s_nop 1
    v_cndmask_b32 v155, 0, v10, vcc
    v_cmp_eq_u32 vcc, 8, v6
    s_nop 1
    v_cndmask_b32 v156, 0, v10, vcc
    v_cmp_eq_u32 vcc, 9, v6
    s_nop 1
    v_cndmask_b32 v157, 0, v10, vcc
    v_cmp_eq_u32 vcc, 10, v6
    s_nop 1
    v_cndmask_b32 v158, 0, v10, vcc
    v_cmp_eq_u32 vcc, 11, v6
    s_nop 1
    v_cndmask_b32 v159, 0, v10, vcc
    s_add_u32 s12, s4, 0x2100000
    s_addc_u32 s13, s5, 0
    s_mov_b32 s14, 0x7f00000
    s_mov_b32 s15, 0x20000
    v_bfe_u32 v6, v1, 2, 2
    v_mul_u32_u24 v168, 24640, v6
    v_mul_u32_u24 v6, 72, v36
    v_add_u32 v168, v168, v6
    v_and_b32 v6, 3, v1
    v_lshl_add_u32 v168, v6, 3, v168
    s_mul_i32 s36, s30, 1152
    v_add_u32 v168, s36, v168
    v_lshrrev_b32 v6, 5, v1
    v_mul_u32_u24 v169, 261632, v6
    v_add_u32 v169, v169, v2
    s_lshr_b32 s44, s38, 4
    s_lshl_b32 s44, s44, 14
    s_and_b32 s37, s38, 15
    s_lshl_b32 s37, s37, 9
    s_add_u32 s44, s44, s37
    s_and_b32 s37, s30, 1
    s_lshl_b32 s37, s37, 13
    s_add_u32 s44, s44, s37
    s_lshr_b32 s37, s30, 1
    s_lshl_b32 s37, s37, 26
    s_add_u32 s44, s44, s37
    s_and_b32 s47, s44, 0x2000
    s_xor_b32 s47, s47, 8192
    s_lshr_b32 s37, s30, 1
    s_lshl_b32 s37, s37, 12
    s_add_u32 s47, s47, s37
    s_and_b32 s37, s2, 7
    s_lshl_b32 s37, s37, 7
    s_add_u32 s47, s47, s37
    v_mov_b32 v34, 162824
    v_mov_b32 v7, 1
    s_mul_i32 s36, s30, 24640
    v_mul_u32_u24 v170, 72, v35
    v_lshl_add_u32 v170, v36, 3, v170
    v_add_u32 v170, s36, v170
    v_lshlrev_b32 v6, 10, v1
    v_mov_b32 v35, 0
    s_and_b32 s45, s2, 31
    s_lshl_b32 s45, s45, 7
    s_add_u32 s45, s45, 23117824
    s_cmp_lg_u32 s30, 0
    s_cbranch_scc1 CV_w
    s_and_b32 s36, s2, 7
    s_lshl_b32 s36, s36, 12
    s_add_u32 s36, s36, 23068672
    v_lshlrev_b32 v9, 7, v1
    v_add_u32 v9, s36, v9
    s_mov_b32 s53, 0
    s_add_u32 s54, s52, 0
    s_bfm_b64 exec, 32, 0
poll_2:
    buffer_load_dword v8, v9, s[56:59], 0 offen sc1
    s_waitcnt vmcnt(0)
    v_xor_b32 v8, s54, v8
    v_cmp_eq_u32 vcc, 0, v8
    s_nop 0
    s_cmp_eq_u64 vcc, exec
    s_cbranch_scc1 pok_3
    s_sleep 5
    s_add_u32 s53, s53, 1
    s_cmp_lt_u32 s53, s61
    s_cbranch_scc1 poll_2
    s_mov_b32 s61, 0
pok_3:
    s_mov_b64 exec, -1
    v_mov_b32 v8, 162832
    v_mov_b32 v9, 1
    s_waitcnt lgkmcnt(0)
    ds_write_b32 v8, v9
CV_w:
    v_mov_b32 v8, 162832
spin_4:
    ds_read_b32 v9, v8
    s_waitcnt lgkmcnt(0)
    v_readfirstlane_b32 s53, v9
    s_nop 0
    s_cmp_ge_u32 s53, 1
    s_cbranch_scc0 spin_4
    buffer_load_dwordx4 v[16:19], v2, s[16:19], 0 offen offset:0 sc1 nt
    buffer_load_dwordx4 v[20:23], v2, s[16:19], 0 offen offset:1024 sc1 nt
    buffer_load_dwordx4 v[24:27], v2, s[16:19], 0 offen offset:2048 sc1 nt
    buffer_load_dwordx4 v[28:31], v2, s[16:19], 0 offen offset:3072 sc1 nt
    s_waitcnt vmcnt(3)
    ds_write_b128 v12, v[16:19] offset:16640
    s_waitcnt vmcnt(2)
    ds_write_b128 v12, v[20:23] offset:18176
    s_waitcnt vmcnt(1)
    ds_write_b128 v12, v[24:27] offset:19712
    s_waitcnt vmcnt(0)
    ds_write_b128 v12, v[28:31] offset:21248
    v_mov_b32 v8, 162836
    v_mov_b32 v9, 1
    s_mov_b64 exec, 1
    ds_add_u32 v8, v9
    s_mov_b64 exec, -1
    s_waitcnt lgkmcnt(0)
    ds_read_b128 v[136:139], v33 offset:21248
    ds_read_b128 v[140:143], v33 offset:19712
    ds_read_b128 v[144:147], v33 offset:18176
    ds_read_b128 v[148:151], v33 offset:16640
    s_waitcnt lgkmcnt(3)
    v_mfma_f32_16x16x32_bf16 v[40:43], v[152:155], v[136:139], 0
    v_mfma_f32_16x16x32_bf16 v[44:47], v[156:159], v[136:139], 0
    s_waitcnt lgkmcnt(2)
    v_mfma_f32_16x16x32_bf16 v[48:51], v[152:155], v[140:143], 0
    v_mfma_f32_16x16x32_bf16 v[52:55], v[156:159], v[140:143], 0
    s_waitcnt lgkmcnt(1)
    v_mfma_f32_16x16x32_bf16 v[56:59], v[152:155], v[144:147], 0
    v_mfma_f32_16x16x32_bf16 v[60:63], v[156:159], v[144:147], 0
    s_waitcnt lgkmcnt(0)
    v_mfma_f32_16x16x32_bf16 v[64:67], v[152:155], v[148:151], 0
    v_mfma_f32_16x16x32_bf16 v[68:71], v[156:159], v[148:151], 0
    s_mov_b32 s43, 0
CV_r:
    s_waitcnt lgkmcnt(0)
    v_mfma_f32_16x16x32_bf16 v[40:43], v[72:75], v[136:139], v[40:43]
    v_mfma_f32_16x16x32_bf16 v[48:51], v[72:75], v[140:143], v[48:51]
    v_mfma_f32_16x16x32_bf16 v[56:59], v[72:75], v[144:147], v[56:59]
    v_mfma_f32_16x16x32_bf16 v[64:67], v[72:75], v[148:151], v[64:67]
    v_mfma_f32_16x16x32_bf16 v[44:47], v[76:79], v[136:139], v[44:47]
    v_mfma_f32_16x16x32_bf16 v[52:55], v[76:79], v[140:143], v[52:55]
    v_mfma_f32_16x16x32_bf16 v[60:63], v[76:79], v[144:147], v[60:63]
    v_mfma_f32_16x16x32_bf16 v[68:71], v[76:79], v[148:151], v[68:71]
    v_mfma_f32_16x16x32_bf16 v[48:51], v[80:83], v[136:139], v[48:51]
    v_mfma_f32_16x16x32_bf16 v[56:59], v[80:83], v[140:143], v[56:59]
    v_mfma_f32_16x16x32_bf16 v[64:67], v[80:83], v[144:147], v[64:67]
    v_mfma_f32_16x16x32_bf16 v[52:55], v[84:87], v[136:139], v[52:55]
    v_mfma_f32_16x16x32_bf16 v[60:63], v[84:87], v[140:143], v[60:63]
    v_mfma_f32_16x16x32_bf16 v[68:71], v[84:87], v[144:147], v[68:71]
    v_mfma_f32_16x16x32_bf16 v[56:59], v[88:91], v[136:139], v[56:59]
    v_mfma_f32_16x16x32_bf16 v[64:67], v[88:91], v[140:143], v[64:67]
    v_mfma_f32_16x16x32_bf16 v[60:63], v[92:95], v[136:139], v[60:63]
    v_mfma_f32_16x16x32_bf16 v[68:71], v[92:95], v[140:143], v[68:71]
    v_mfma_f32_16x16x32_bf16 v[64:67], v[96:99], v[136:139], v[64:67]
    v_mfma_f32_16x16x32_bf16 v[68:71], v[100:103], v[136:139], v[68:71]
    ds_read_b128 v[152:155], v33 offset:21344
    ds_read_b128 v[156:159], v33 offset:19808
    ds_read_b128 v[160:163], v33 offset:18272
    ds_read_b128 v[164:167], v33 offset:16736
    ds_read_b64 v[104:105], v32 offset:64
    ds_read_b64 v[106:107], v32 offset:72
    ds_read_b64 v[108:109], v32 offset:96
    ds_read_b64 v[110:111], v32 offset:104
    ds_read_b64 v[112:113], v32 offset:1088
    ds_read_b64 v[114:115], v32 offset:1096
    ds_read_b64 v[116:117], v32 offset:1120
    ds_read_b64 v[118:119], v32 offset:1128
    ds_read_b64 v[120:121], v32 offset:2112
    ds_read_b64 v[122:123], v32 offset:2120
    ds_read_b64 v[124:125], v32 offset:2144
    ds_read_b64 v[126:127], v32 offset:2152
    ds_read_b64 v[128:129], v32 offset:3136
    ds_read_b64 v[130:131], v32 offset:3144
    ds_read_b64 v[132:133], v32 offset:3168
    ds_read_b64 v[134:135], v32 offset:3176
    s_waitcnt lgkmcnt(0)
    v_mfma_f32_16x16x32_bf16 v[40:43], v[104:107], v[152:155], v[40:43]
    v_mfma_f32_16x16x32_bf16 v[48:51], v[104:107], v[156:159], v[48:51]
    v_mfma_f32_16x16x32_bf16 v[56:59], v[104:107], v[160:163], v[56:59]
    v_mfma_f32_16x16x32_bf16 v[64:67], v[104:107], v[164:167], v[64:67]
    v_mfma_f32_16x16x32_bf16 v[44:47], v[108:111], v[152:155], v[44:47]
    v_mfma_f32_16x16x32_bf16 v[52:55], v[108:111], v[156:159], v[52:55]
    v_mfma_f32_16x16x32_bf16 v[60:63], v[108:111], v[160:163], v[60:63]
    v_mfma_f32_16x16x32_bf16 v[68:71], v[108:111], v[164:167], v[68:71]
    v_mfma_f32_16x16x32_bf16 v[48:51], v[112:115], v[152:155], v[48:51]
    v_mfma_f32_16x16x32_bf16 v[56:59], v[112:115], v[156:159], v[56:59]
    v_mfma_f32_16x16x32_bf16 v[64:67], v[112:115], v[160:163], v[64:67]
    v_mfma_f32_16x16x32_bf16 v[52:55], v[116:119], v[152:155], v[52:55]
    v_mfma_f32_16x16x32_bf16 v[60:63], v[116:119], v[156:159], v[60:63]
    v_mfma_f32_16x16x32_bf16 v[68:71], v[116:119], v[160:163], v[68:71]
    v_mfma_f32_16x16x32_bf16 v[56:59], v[120:123], v[152:155], v[56:59]
    v_mfma_f32_16x16x32_bf16 v[64:67], v[120:123], v[156:159], v[64:67]
    v_mfma_f32_16x16x32_bf16 v[60:63], v[124:127], v[152:155], v[60:63]
    v_mfma_f32_16x16x32_bf16 v[68:71], v[124:127], v[156:159], v[68:71]
    v_mfma_f32_16x16x32_bf16 v[64:67], v[128:131], v[152:155], v[64:67]
    v_mfma_f32_16x16x32_bf16 v[68:71], v[132:135], v[152:155], v[68:71]
    ds_read_b128 v[136:139], v33 offset:21440
    ds_read_b128 v[140:143], v33 offset:19904
    ds_read_b128 v[144:147], v33 offset:18368
    ds_read_b128 v[148:151], v33 offset:16832
    ds_read_b64 v[72:73], v32 offset:128
    ds_read_b64 v[74:75], v32 offset:136
    ds_read_b64 v[76:77], v32 offset:160
    ds_read_b64 v[78:79], v32 offset:168
    ds_read_b64 v[80:81], v32 offset:1152
    ds_read_b64 v[82:83], v32 offset:1160
    ds_read_b64 v[84:85], v32 offset:1184
    ds_read_b64 v[86:87], v32 offset:1192
    ds_read_b64 v[88:89], v32 offset:2176
    ds_read_b64 v[90:91], v32 offset:2184
    ds_read_b64 v[92:93], v32 offset:2208
    ds_read_b64 v[94:95], v32 offset:2216
    ds_read_b64 v[96:97], v32 offset:3200
    ds_read_b64 v[98:99], v32 offset:3208
    ds_read_b64 v[100:101], v32 offset:3232
    ds_read_b64 v[102:103], v32 offset:3240
    v_add_u32 v32, 128, v32
    v_add_u32 v33, 192, v33
    s_add_u32 s43, s43, 1
    s_cmp_lt_u32 s43, 4
    s_cbranch_scc1 CV_r
CV_l:
    s_waitcnt lgkmcnt(10)
    v_mfma_f32_16x16x32_bf16 v[40:43], v[72:75], v[136:139], v[40:43]
    ds_read_b128 v[152:155], v33 offset:21344
    v_mfma_f32_16x16x32_bf16 v[48:51], v[72:75], v[140:143], v[48:51]
    ds_read_b128 v[156:159], v33 offset:19808
    s_cmp_eq_u32 s43, 5
    v_mfma_f32_16x16x32_bf16 v[56:59], v[72:75], v[144:147], v[56:59]
    ds_read_b128 v[160:163], v33 offset:18272
    s_cselect_b64 exec, 1, 0
    buffer_load_dword v12, v35, s[56:59], s45 offen sc1
    s_mov_b64 exec, -1
    v_mfma_f32_16x16x32_bf16 v[64:67], v[72:75], v[148:151], v[64:67]
    ds_read_b128 v[164:167], v33 offset:16736
    v_mfma_f32_16x16x32_bf16 v[44:47], v[76:79], v[136:139], v[44:47]
    ds_read_b64 v[104:105], v32 offset:64
    v_mfma_f32_16x16x32_bf16 v[52:55], v[76:79], v[140:143], v[52:55]
    ds_read_b64 v[106:107], v32 offset:72
    v_mfma_f32_16x16x32_bf16 v[60:63], v[76:79], v[144:147], v[60:63]
    ds_read_b64 v[108:109], v32 offset:96
    v_mfma_f32_16x16x32_bf16 v[68:71], v[76:79], v[148:151], v[68:71]
    ds_read_b64 v[110:111], v32 offset:104
    v_mfma_f32_16x16x32_bf16 v[48:51], v[80:83], v[136:139], v[48:51]
    ds_read_b64 v[112:113], v32 offset:1088
    v_mfma_f32_16x16x32_bf16 v[56:59], v[80:83], v[140:143], v[56:59]
    ds_read_b64 v[114:115], v32 offset:1096
    s_waitcnt lgkmcnt(10)
    v_mfma_f32_16x16x32_bf16 v[64:67], v[80:83], v[144:147], v[64:67]
    ds_read_b64 v[116:117], v32 offset:1120
    v_mfma_f32_16x16x32_bf16 v[52:55], v[84:87], v[136:139], v[52:55]
    ds_read_b64 v[118:119], v32 offset:1128
    v_mfma_f32_16x16x32_bf16 v[60:63], v[84:87], v[140:143], v[60:63]
    ds_read_b64 v[120:121], v32 offset:2112
    v_mfma_f32_16x16x32_bf16 v[68:71], v[84:87], v[144:147], v[68:71]
    ds_read_b64 v[122:123], v32 offset:2120
    v_mfma_f32_16x16x32_bf16 v[56:59], v[88:91], v[136:139], v[56:59]
    ds_read_b64 v[124:125], v32 offset:2144
    v_mfma_f32_16x16x32_bf16 v[64:67], v[88:91], v[140:143], v[64:67]
    ds_read_b64 v[126:127], v32 offset:2152
    v_mfma_f32_16x16x32_bf16 v[60:63], v[92:95], v[136:139], v[60:63]
    ds_read_b64 v[128:129], v32 offset:3136
    v_mfma_f32_16x16x32_bf16 v[68:71], v[92:95], v[140:143], v[68:71]
    ds_read_b64 v[130:131], v32 offset:3144
    v_mfma_f32_16x16x32_bf16 v[64:67], v[96:99], v[136:139], v[64:67]
    ds_read_b64 v[132:133], v32 offset:3168
    v_mfma_f32_16x16x32_bf16 v[68:71], v[100:103], v[136:139], v[68:71]
    ds_read_b64 v[134:135], v32 offset:3176
    s_waitcnt lgkmcnt(10)
    v_mfma_f32_16x16x32_bf16 v[40:43], v[104:107], v[152:155], v[40:43]
    ds_read_b128 v[136:139], v33 offset:21440
    v_mfma_f32_16x16x32_bf16 v[48:51], v[104:107], v[156:159], v[48:51]
    ds_read_b128 v[140:143], v33 offset:19904
    v_mfma_f32_16x16x32_bf16 v[56:59], v[104:107], v[160:163], v[56:59]
    ds_read_b128 v[144:147], v33 offset:18368
    v_mfma_f32_16x16x32_bf16 v[64:67], v[104:107], v[164:167], v[64:67]
    ds_read_b128 v[148:151], v33 offset:16832
    v_mfma_f32_16x16x32_bf16 v[44:47], v[108:111], v[152:155], v[44:47]
    ds_read_b64 v[72:73], v32 offset:128
    v_mfma_f32_16x16x32_bf16 v[52:55], v[108:111], v[156:159], v[52:55]
    ds_read_b64 v[74:75], v32 offset:136
    v_add_u32 v33, 192, v33
    v_mfma_f32_16x16x32_bf16 v[60:63], v[108:111], v[160:163], v[60:63]
    ds_read_b64 v[76:77], v32 offset:160
    s_add_u32 s43, s43, 1
    v_mfma_f32_16x16x32_bf16 v[68:71], v[108:111], v[164:167], v[68:71]
    ds_read_b64 v[78:79], v32 offset:168
    s_cmp_lt_u32 s43, 8
    v_mfma_f32_16x16x32_bf16 v[48:51], v[112:115], v[152:155], v[48:51]
    ds_read_b64 v[80:81], v32 offset:1152
    v_mfma_f32_16x16x32_bf16 v[56:59], v[112:115], v[156:159], v[56:59]
    ds_read_b64 v[82:83], v32 offset:1160
    s_waitcnt lgkmcnt(10)
    v_mfma_f32_16x16x32_bf16 v[64:67], v[112:115], v[160:163], v[64:67]
    ds_read_b64 v[84:85], v32 offset:1184
    v_mfma_f32_16x16x32_bf16 v[52:55], v[116:119], v[152:155], v[52:55]
    ds_read_b64 v[86:87], v32 offset:1192
    v_mfma_f32_16x16x32_bf16 v[60:63], v[116:119], v[156:159], v[60:63]
    ds_read_b64 v[88:89], v32 offset:2176
    v_mfma_f32_16x16x32_bf16 v[68:71], v[116:119], v[160:163], v[68:71]
    ds_read_b64 v[90:91], v32 offset:2184
    v_mfma_f32_16x16x32_bf16 v[56:59], v[120:123], v[152:155], v[56:59]
    ds_read_b64 v[92:93], v32 offset:2208
    v_mfma_f32_16x16x32_bf16 v[64:67], v[120:123], v[156:159], v[64:67]
    ds_read_b64 v[94:95], v32 offset:2216
    v_mfma_f32_16x16x32_bf16 v[60:63], v[124:127], v[152:155], v[60:63]
    ds_read_b64 v[96:97], v32 offset:3200
    v_mfma_f32_16x16x32_bf16 v[68:71], v[124:127], v[156:159], v[68:71]
    ds_read_b64 v[98:99], v32 offset:3208
    v_mfma_f32_16x16x32_bf16 v[64:67], v[128:131], v[152:155], v[64:67]
    ds_read_b64 v[100:101], v32 offset:3232
    v_mfma_f32_16x16x32_bf16 v[68:71], v[132:135], v[152:155], v[68:71]
    ds_read_b64 v[102:103], v32 offset:3240
    v_add_u32 v32, 128, v32
    s_cbranch_scc1 CV_l
    v_cvt_pk_bf16_f32 v16, v40, v41
    v_cvt_pk_bf16_f32 v17, v42, v43
    ds_write_b64 v170, v[16:17] offset:0
    v_cvt_pk_bf16_f32 v18, v44, v45
    v_cvt_pk_bf16_f32 v19, v46, v47
    ds_write_b64 v170, v[18:19] offset:32
    v_cvt_pk_bf16_f32 v20, v48, v49
    v_cvt_pk_bf16_f32 v21, v50, v51
    ds_write_b64 v170, v[20:21] offset:1152
    v_cvt_pk_bf16_f32 v22, v52, v53
    v_cvt_pk_bf16_f32 v23, v54, v55
    ds_write_b64 v170, v[22:23] offset:1184
    v_cvt_pk_bf16_f32 v24, v56, v57
    v_cvt_pk_bf16_f32 v25, v58, v59
    ds_write_b64 v170, v[24:25] offset:2304
    v_cvt_pk_bf16_f32 v26, v60, v61
    v_cvt_pk_bf16_f32 v27, v62, v63
    ds_write_b64 v170, v[26:27] offset:2336
    v_cvt_pk_bf16_f32 v28, v64, v65
    v_cvt_pk_bf16_f32 v29, v66, v67
    ds_write_b64 v170, v[28:29] offset:3456
    v_cvt_pk_bf16_f32 v30, v68, v69
    v_cvt_pk_bf16_f32 v31, v70, v71
    ds_write_b64 v170, v[30:31] offset:3488
    s_mov_b64 exec, 1
    ds_add_u32 v34, v7
    s_mov_b64 exec, -1
    s_mov_b32 s53, 0
    s_waitcnt vmcnt(0)
CV_v:
    v_readfirstlane_b32 s94, v12
    s_nop 0
    s_sub_u32 s94, s94, s52
    s_and_b32 s37, s94, 0xfffffe01
    s_cbranch_scc0 CV_k
    buffer_load_dword v12, v35, s[56:59], s45 offen sc1
    s_waitcnt vmcnt(0)
    s_add_u32 s53, s53, 1
    s_cmp_lt_u32 s53, s61
    s_cbranch_scc1 CV_v
    s_mov_b32 s61, 0
    s_mov_b32 s94, 0
CV_k:
    s_lshr_b32 s94, s94, 1
    s_add_u32 s37, s94, 65536
    v_mov_b32 v8, 162844
    v_mov_b32 v9, s37
    ds_write_b32 v8, v9
    s_cmp_gt_u32 s94, 10
    s_cselect_b32 s37, 0x2000, 0
    s_xor_b32 s44, s44, s37
    s_xor_b32 s45, s47, s37
    s_add_u32 s45, s45, 23101440
    v_mov_b32 v8, 162824
spin_5:
    ds_read_b32 v9, v8
    s_waitcnt lgkmcnt(0)
    v_readfirstlane_b32 s53, v9
    s_nop 0
    s_cmp_ge_u32 s53, 6
    s_cbranch_scc0 spin_5
    ds_read_b64_tr_b16 v[104:105], v168 offset:0
    ds_read_b64_tr_b16 v[106:107], v168 offset:32
    ds_read_b64_tr_b16 v[108:109], v168 offset:288
    ds_read_b64_tr_b16 v[110:111], v168 offset:320
    ds_read_b64_tr_b16 v[112:113], v168 offset:576
    ds_read_b64_tr_b16 v[114:115], v168 offset:608
    ds_read_b64_tr_b16 v[116:117], v168 offset:864
    ds_read_b64_tr_b16 v[118:119], v168 offset:896
    s_waitcnt lgkmcnt(6)
    v_or_b32 v104, 1, v104
    buffer_store_dwordx4 v[104:107], v169, s[12:15], s44 offen sc1
    s_add_u32 s44, s44, 16777216
    s_waitcnt lgkmcnt(4)
    v_or_b32 v108, 1, v108
    buffer_store_dwordx4 v[108:111], v169, s[12:15], s44 offen sc1
    s_add_u32 s44, s44, 16777216
    s_waitcnt lgkmcnt(2)
    v_or_b32 v112, 1, v112
    buffer_store_dwordx4 v[112:115], v169, s[12:15], s44 offen sc1
    s_add_u32 s44, s44, 16777216
    s_waitcnt lgkmcnt(0)
    v_or_b32 v116, 1, v116
    buffer_store_dwordx4 v[116:119], v169, s[12:15], s44 offen sc1
    s_add_u32 s44, s44, 16777216
    v_mov_b32 v8, 162836
    v_mov_b32 v9, 1
    s_mov_b64 exec, 1
    ds_add_u32 v8, v9
    s_mov_b64 exec, -1
    s_mov_b64 exec, 0xf
    s_waitcnt vmcnt(0)
    buffer_atomic_add v7, v6, s[56:59], s45 offen sc1
    s_mov_b64 exec, -1
    s_branch FR_end
FR_b:
    s_cmp_ge_u32 s2, 32
    s_cbranch_scc1 FB_np
    s_cmp_lg_u32 s30, 5
    s_cbranch_scc1 FB_np
    s_and_b32 s42, s2, 7
    s_lshl_b32 s42, s42, 10
    s_lshr_b32 s43, s2, 3
    s_lshl_b32 s43, s43, 14
    s_add_u32 s42, s42, s43
    s_add_u32 s42, s42, 39714816
    v_mov_b32 v14, 0
    s_mov_b64 exec, 1
    s_mov_b32 s46, -1
    s_mov_b32 s47, -1
    s_add_u32 s48, s4, s42
    s_addc_u32 s49, s5, 0
    s_load_dword s101, s[48:49], 384
    s_waitcnt lgkmcnt(0)
    s_memtime s[34:35]
    s_waitcnt lgkmcnt(0)
    s_load_dword s101, s[48:49], 0
    s_waitcnt lgkmcnt(0)
    s_memtime s[36:37]
    s_waitcnt lgkmcnt(0)
    s_sub_u32 s43, s36, s34
    s_min_u32 s46, s46, s43
    s_load_dword s101, s[48:49], 8192
    s_waitcnt lgkmcnt(0)
    s_memtime s[34:35]
    s_waitcnt lgkmcnt(0)
    s_sub_u32 s43, s34, s36
    s_min_u32 s47, s47, s43
    s_load_dword s101, s[48:49], 128
    s_waitcnt lgkmcnt(0)
    s_memtime s[36:37]
    s_waitcnt lgkmcnt(0)
    s_sub_u32 s43, s36, s34
    s_min_u32 s46, s46, s43
    s_load_dword s101, s[48:49], 8320
    s_waitcnt lgkmcnt(0)
    s_memtime s[34:35]
    s_waitcnt lgkmcnt(0)
    s_sub_u32 s43, s34, s36
    s_min_u32 s47, s47, s43
    s_cmp_lt_u32 s47, s46
    s_cselect_b32 s45, 1, 0
    s_lshr_b32 s46, s28, 2
    s_xor_b32 s45, s45, s46
    s_and_b32 s45, s45, 1
    s_lshl_b32 s45, s45, 8
    s_or_b32 s43, s45, 1
    v_mov_b32 v12, s43
    buffer_atomic_add v12, v14, s[84:87], 0 offen offset:4 sc0 sc1
    s_waitcnt vmcnt(0)
    v_readfirstlane_b32 s36, v12
    s_nop 0
    s_add_u32 s36, s36, s43
    s_and_b32 s37, s36, 255
    s_cmp_lg_u32 s37, 21
    s_cbranch_scc1 FB_np
    s_lshr_b32 s36, s36, 8
    s_lshl_b32 s36, s36, 1
    s_add_u32 s36, s36, s52
    s_bfm_b64 exec, 32, 0
    v_mov_b32 v12, s36
    v_lshlrev_b32 v13, 7, v1
    s_mov_b32 s36, 23117824
    buffer_store_dword v12, v13, s[56:59], s36 offen sc1
FB_np:
    s_mov_b64 exec, -1
    s_getpc_b64 s[34:35]
K_tpc:
    s_lshl_b32 s36, s29, 2
    s_and_b32 s37, s28, 3
    s_add_u32 s36, s36, s37
    s_lshl_b32 s36, s36, 6
    s_add_u32 s36, s36, K_tab-K_tpc
    s_add_u32 s34, s34, s36
    s_addc_u32 s35, s35, 0
    v_and_b32 v248, 31, v1
    v_lshlrev_b32 v248, 1, v248
    global_load_ushort v251, v248, s[34:35]
    v_lshrrev_b32 v253, 3, v1
    v_lshlrev_b32 v238, 11, v253
    v_and_b32 v253, 6, v253
    v_and_b32 v254, 7, v1
    v_xor_b32 v253, v253, v254
    v_lshl_add_u32 v238, v253, 4, v238
    v_lshrrev_b32 v253, 4, v1
    v_lshlrev_b32 v239, 11, v253
    v_add_u32 v253, 0, v253
    v_lshlrev_b32 v253, 1, v253
    v_and_b32 v254, 15, v1
    v_xor_b32 v253, v253, v254
    v_lshl_add_u32 v239, v253, 4, v239
    v_lshrrev_b32 v253, 4, v1
    v_lshlrev_b32 v240, 11, v253
    v_add_u32 v253, 4, v253
    v_lshlrev_b32 v253, 1, v253
    v_and_b32 v254, 15, v1
    v_xor_b32 v253, v253, v254
    v_lshl_add_u32 v240, v253, 4, v240
    v_add_u32 v254, 0, v1
    v_mul_u32_u24 v253, 2341, v254
    v_lshrrev_b32 v253, 16, v253
    v_mul_u32_u24 v241, 28, v253
    v_sub_u32 v254, v254, v241
    v_mul_u32_u24 v241, 7168, v253
    v_lshrrev_b32 v253, 1, v253
    v_and_b32 v253, 2, v253
    v_xor_b32 v254, v254, v253
    v_lshl_add_u32 v241, v254, 4, v241
    v_add_u32 v254, 64, v1
    v_mul_u32_u24 v253, 2341, v254
    v_lshrrev_b32 v253, 16, v253
    v_mul_u32_u24 v242, 28, v253
    v_sub_u32 v254, v254, v242
    v_mul_u32_u24 v242, 7168, v253
    v_lshrrev_b32 v253, 1, v253
    v_and_b32 v253, 2, v253
    v_xor_b32 v254, v254, v253
    v_lshl_add_u32 v242, v254, 4, v242
    v_add_u32 v254, 128, v1
    v_mul_u32_u24 v253, 2341, v254
    v_lshrrev_b32 v253, 16, v253
    v_mul_u32_u24 v243, 28, v253
    v_sub_u32 v254, v254, v243
    v_mul_u32_u24 v243, 7168, v253
    v_lshrrev_b32 v253, 1, v253
    v_and_b32 v253, 2, v253
    v_xor_b32 v254, v254, v253
    v_lshl_add_u32 v243, v254, 4, v243
    v_add_u32 v254, 192, v1
    v_mul_u32_u24 v253, 2341, v254
    v_lshrrev_b32 v253, 16, v253
    v_mul_u32_u24 v244, 28, v253
    v_sub_u32 v254, v254, v244
    v_mul_u32_u24 v244, 7168, v253
    v_lshrrev_b32 v253, 1, v253
    v_and_b32 v253, 2, v253
    v_xor_b32 v254, v254, v253
    v_lshl_add_u32 v244, v254, 4, v244
    v_add_u32 v254, 256, v1
    v_mul_u32_u24 v253, 2341, v254
    v_lshrrev_b32 v253, 16, v253
    v_mul_u32_u24 v245, 28, v253
    v_sub_u32 v254, v254, v245
    v_mul_u32_u24 v245, 7168, v253
    v_lshrrev_b32 v253, 1, v253
    v_and_b32 v253, 2, v253
    v_xor_b32 v254, v254, v253
    v_lshl_add_u32 v245, v254, 4, v245
    v_add_u32 v254, 320, v1
    v_mul_u32_u24 v253, 2341, v254
    v_lshrrev_b32 v253, 16, v253
    v_mul_u32_u24 v246, 28, v253
    v_sub_u32 v254, v254, v246
    v_mul_u32_u24 v246, 7168, v253
    v_lshrrev_b32 v253, 1, v253
    v_and_b32 v253, 2, v253
    v_xor_b32 v254, v254, v253
    v_lshl_add_u32 v246, v254, 4, v246
    v_add_u32 v254, 384, v1
    v_mul_u32_u24 v253, 2341, v254
    v_lshrrev_b32 v253, 16, v253
    v_mul_u32_u24 v247, 28, v253
    v_sub_u32 v254, v254, v247
    v_mul_u32_u24 v247, 7168, v253
    v_lshrrev_b32 v253, 1, v253
    v_and_b32 v253, 2, v253
    v_xor_b32 v254, v254, v253
    v_lshl_add_u32 v247, v254, 4, v247
    s_cmp_ge_u32 s30, 6
    s_cbranch_scc1 FB_cs
    s_cmp_lg_u32 s30, 4
    s_cbranch_scc1 FB_ni
    v_mov_b32 v12, s52
    s_lshr_b32 s53, s28, 3
    s_lshl_b32 s53, s53, 2
    s_and_b32 s54, s28, 3
    s_add_u32 s53, s53, s54
    s_lshl_b32 s53, s53, 24
    s_lshr_b32 s54, s28, 2
    s_xor_b32 s54, s54, s94
    s_and_b32 s54, s54, 1
    s_lshl_b32 s54, s54, 13
    s_add_u32 s37, s53, s54
    s_add_u32 s37, s37, 33554432
    s_andn2_b32 s37, s37, 0x2000
    s_lshl_b32 s53, s29, 7
    s_add_u32 s37, s37, s53
    s_add_u32 s37, s37, 6029312
    v_and_b32 v13, 1, v1
    v_lshlrev_b32 v13, 13, v13
    v_lshrrev_b32 v14, 1, v1
    v_lshl_add_u32 v13, v14, 22, v13
    s_mov_b64 exec, 0xf
    buffer_store_dword v12, v13, s[56:59], s37 offen sc1
    s_cmp_lg_u32 s28, 0
    s_cbranch_scc1 FB_n2
    s_add_u32 s37, s53, 23121920
    s_mov_b64 exec, 1
    buffer_store_dword v12, v13, s[56:59], s37 offen sc1
FB_n2:
    s_mov_b64 exec, -1
FB_ni:
    s_waitcnt vmcnt(0)
    v_bfe_u32 v252, v251, 2, 2
    v_lshlrev_b32 v248, 14, v252
    v_and_b32 v252, 3, v251
    v_lshl_add_u32 v248, v252, 11, v248
    v_bfe_u32 v252, v251, 7, 3
    v_lshlrev_b32 v249, 14, v252
    v_bfe_u32 v252, v251, 4, 3
    v_lshl_add_u32 v249, v252, 10, v249
    v_bfe_u32 v252, v251, 13, 3
    v_lshlrev_b32 v250, 14, v252
    v_bfe_u32 v252, v251, 10, 3
    v_lshl_add_u32 v250, v252, 10, v250
    v_mov_b32 v6, 162836
spin_7:
    s_sleep 2
    ds_read_b32 v7, v6
    s_waitcnt lgkmcnt(0)
    v_readfirstlane_b32 s53, v7
    s_nop 0
    s_cmp_ge_u32 s53, 4
    s_cbranch_scc0 spin_7
    s_load_dwordx2 s[48:49], s[0:1], 64
    s_lshl_b32 s45, s2, 1
    s_and_b32 s50, s30, 1
    s_add_u32 s45, s45, s50
    s_mul_i32 s45, s45, 4096
    s_mov_b32 s50, 2097152
    s_mov_b32 s51, 0x20000
    s_waitcnt lgkmcnt(0)
    buffer_load_dwordx4 v[20:23], v2, s[48:51], s45 offen offset:0
    buffer_load_dwordx4 v[20:23], v2, s[48:51], s45 offen offset:1024
    buffer_load_dwordx4 v[20:23], v2, s[48:51], s45 offen offset:2048
    buffer_load_dwordx4 v[20:23], v2, s[48:51], s45 offen offset:3072
    v_mov_b32 v6, 1
    v_mov_b32 v7, 162824
    s_mov_b64 exec, 1
    s_waitcnt vmcnt(0)
    ds_add_u32 v7, v6
    s_mov_b64 exec, -1
    v_mov_b32 v6, 162840
spin_9:
    s_sleep 4
    ds_read_b32 v7, v6
    s_waitcnt lgkmcnt(0)
    v_readfirstlane_b32 s53, v7
    s_nop 0
    s_cmp_ge_u32 s53, 2
    s_cbranch_scc0 spin_9
    s_call_b64 s[76:77], SUB_w1_regs
    s_call_b64 s[76:77], SUB_park
    v_mov_b32 v6, 162840
spin_10:
    s_sleep 3
    ds_read_b32 v7, v6
    s_waitcnt lgkmcnt(0)
    v_readfirstlane_b32 s53, v7
    s_nop 0
    s_cmp_ge_u32 s53, 4
    s_cbranch_scc0 spin_10
    s_mov_b64 s[12:13], s[68:69]
    s_mov_b32 s14, 2097152
    s_mov_b32 s15, 0x20000
    s_and_b32 s35, s30, 1
    s_mul_i32 s38, s99, 128
    s_mul_i32 s41, s35, 65536
    s_add_u32 s38, s38, s41
    s_mul_i32 s41, s35, 4096
    s_add_u32 s41, s41, 24576
    s_mov_b32 s42, 0
    s_mov_b32 s44, s67
    s_mov_b32 s42, 73728
    s_mov_b32 s44, s67
    s_add_u32 s44, s44, 9
    s_and_b32 s44, s44, 15
    s_call_b64 s[76:77], SUB_w_issue_1
    s_waitcnt vmcnt(8)
    s_mov_b32 s42, 81920
    s_mov_b32 s44, s67
    s_add_u32 s44, s44, 10
    s_and_b32 s44, s44, 15
    s_call_b64 s[76:77], SUB_w_issue_1
    s_waitcnt vmcnt(8)
    s_mov_b32 s42, 90112
    s_mov_b32 s44, s67
    s_add_u32 s44, s44, 11
    s_and_b32 s44, s44, 15
    s_call_b64 s[76:77], SUB_w_issue_1
    s_waitcnt vmcnt(8)
    s_and_b32 s36, s29, 6
    s_cmp_eq_u32 s36, 2
    s_cbranch_scc1 pr_11
    s_call_b64 s[76:77], SUB_park2
pr_11:
    s_call_b64 s[76:77], SUB_w1_put
    s_branch FR_end
FB_cs:
    v_and_b32 v164, 15, v1
    v_mov_b32 v165, 0x3f803f80
    v_cmp_eq_u32 vcc, 0, v164
    s_nop 1
    v_cndmask_b32 v16, 0, v165, vcc
    v_cndmask_b32 v17, 0, v165, vcc
    v_cndmask_b32 v18, 0, v165, vcc
    v_cndmask_b32 v19, 0, v165, vcc
    v_cmp_eq_u32 vcc, 1, v164
    s_nop 1
    v_cndmask_b32 v20, 0, v165, vcc
    v_cndmask_b32 v21, 0, v165, vcc
    v_cndmask_b32 v22, 0, v165, vcc
    v_cndmask_b32 v23, 0, v165, vcc
    v_cmp_eq_u32 vcc, 2, v164
    s_nop 1
    v_cndmask_b32 v24, 0, v165, vcc
    v_cndmask_b32 v25, 0, v165, vcc
    v_cndmask_b32 v26, 0, v165, vcc
    v_cndmask_b32 v27, 0, v165, vcc
    v_cmp_eq_u32 vcc, 3, v164
    s_nop 1
    v_cndmask_b32 v28, 0, v165, vcc
    v_cndmask_b32 v29, 0, v165, vcc
    v_cndmask_b32 v30, 0, v165, vcc
    v_cndmask_b32 v31, 0, v165, vcc
    v_cmp_eq_u32 vcc, 4, v164
    s_nop 1
    v_cndmask_b32 v32, 0, v165, vcc
    v_cndmask_b32 v33, 0, v165, vcc
    v_cndmask_b32 v34, 0, v165, vcc
    v_cndmask_b32 v35, 0, v165, vcc
    v_cmp_eq_u32 vcc, 5, v164
    s_nop 1
    v_cndmask_b32 v36, 0, v165, vcc
    v_cndmask_b32 v37, 0, v165, vcc
    v_cndmask_b32 v38, 0, v165, vcc
    v_cndmask_b32 v39, 0, v165, vcc
    v_cmp_eq_u32 vcc, 6, v164
    s_nop 1
    v_cndmask_b32 v40, 0, v165, vcc
    v_cndmask_b32 v41, 0, v165, vcc
    v_cndmask_b32 v42, 0, v165, vcc
    v_cndmask_b32 v43, 0, v165, vcc
    v_cmp_eq_u32 vcc, 7, v164
    s_nop 1
    v_cndmask_b32 v44, 0, v165, vcc
    v_cndmask_b32 v45, 0, v165, vcc
    v_cndmask_b32 v46, 0, v165, vcc
    v_cndmask_b32 v47, 0, v165, vcc
    v_cmp_eq_u32 vcc, 8, v164
    s_nop 1
    v_cndmask_b32 v48, 0, v165, vcc
    v_cndmask_b32 v49, 0, v165, vcc
    v_cndmask_b32 v50, 0, v165, vcc
    v_cndmask_b32 v51, 0, v165, vcc
    v_cmp_eq_u32 vcc, 9, v164
    s_nop 1
    v_cndmask_b32 v52, 0, v165, vcc
    v_cndmask_b32 v53, 0, v165, vcc
    v_cndmask_b32 v54, 0, v165, vcc
    v_cndmask_b32 v55, 0, v165, vcc
    v_cmp_eq_u32 vcc, 10, v164
    s_nop 1
    v_cndmask_b32 v56, 0, v165, vcc
    v_cndmask_b32 v57, 0, v165, vcc
    v_cndmask_b32 v58, 0, v165, vcc
    v_cndmask_b32 v59, 0, v165, vcc
    v_cmp_eq_u32 vcc, 11, v164
    s_nop 1
    v_cndmask_b32 v60, 0, v165, vcc
    v_cndmask_b32 v61, 0, v165, vcc
    v_cndmask_b32 v62, 0, v165, vcc
    v_cndmask_b32 v63, 0, v165, vcc
    v_cmp_eq_u32 vcc, 12, v164
    s_nop 1
    v_cndmask_b32 v64, 0, v165, vcc
    v_cndmask_b32 v65, 0, v165, vcc
    v_cndmask_b32 v66, 0, v165, vcc
    v_cndmask_b32 v67, 0, v165, vcc
    v_cmp_eq_u32 vcc, 13, v164
    s_nop 1
    v_cndmask_b32 v68, 0, v165, vcc
    v_cndmask_b32 v69, 0, v165, vcc
    v_cndmask_b32 v70, 0, v165, vcc
    v_cndmask_b32 v71, 0, v165, vcc
    s_mov_b32 s35, 0
    v_lshrrev_b32 v253, 2, v1
    v_mul_u32_u24 v144, 128, v253
    v_and_b32 v254, 3, v1
    v_lshl_add_u32 v144, v254, 3, v144
    v_add_u32 v144, 24576, v144
    v_bfe_u32 v253, v253, 1, 2
    s_mul_i32 s36, s35, 4
    s_add_u32 s36, s36, 3
    v_xor_b32 v254, s36, v253
    v_lshl_add_u32 v147, v254, 5, v144
    s_mul_i32 s36, s35, 4
    s_add_u32 s36, s36, 2
    v_xor_b32 v254, s36, v253
    v_lshl_add_u32 v146, v254, 5, v144
    s_mul_i32 s36, s35, 4
    s_add_u32 s36, s36, 1
    v_xor_b32 v254, s36, v253
    v_lshl_add_u32 v145, v254, 5, v144
    s_mul_i32 s36, s35, 4
    s_add_u32 s36, s36, 0
    v_xor_b32 v254, s36, v253
    v_lshl_add_u32 v144, v254, 5, v144
    s_and_b32 s35, s30, 1
    s_mul_i32 s35, s35, 4096
    s_add_u32 s35, s35, 73728
    v_add_u32 v144, s35, v144
    v_add_u32 v145, s35, v145
    v_add_u32 v146, s35, v146
    v_add_u32 v147, s35, v147
    s_mov_b32 s35, 0
    v_lshrrev_b32 v253, 2, v1
    v_mul_u32_u24 v148, 448, v253
    v_and_b32 v254, 3, v1
    v_lshl_add_u32 v148, v254, 3, v148
    v_add_u32 v148, 73728, v148
    s_mul_i32 s36, s35, 224
    v_add_u32 v148, s36, v148
    v_bfe_u32 v253, v1, 4, 1
    v_lshlrev_b32 v253, 5, v253
    s_cmp_eq_u32 s35, 0
    s_cselect_b32 s36, 1, -1
    v_mul_lo_u32 v253, v253, s36
    v_sub_u32 v149, v148, v253
    v_add_u32 v148, v148, v253
    s_and_b32 s35, s30, 1
    s_mul_i32 s35, s35, 14336
    s_add_u32 s35, s35, 32768
    v_add_u32 v148, s35, v148
    v_add_u32 v149, s35, v149
    s_mov_b32 s35, 1
    v_lshrrev_b32 v253, 2, v1
    v_mul_u32_u24 v150, 448, v253
    v_and_b32 v254, 3, v1
    v_lshl_add_u32 v150, v254, 3, v150
    v_add_u32 v150, 73728, v150
    s_mul_i32 s36, s35, 224
    v_add_u32 v150, s36, v150
    v_bfe_u32 v253, v1, 4, 1
    v_lshlrev_b32 v253, 5, v253
    s_cmp_eq_u32 s35, 0
    s_cselect_b32 s36, 1, -1
    v_mul_lo_u32 v253, v253, s36
    v_sub_u32 v151, v150, v253
    v_add_u32 v150, v150, v253
    s_and_b32 s35, s30, 1
    s_mul_i32 s35, s35, 14336
    s_add_u32 s35, s35, 32768
    v_add_u32 v150, s35, v150
    v_add_u32 v151, s35, v151
    v_mov_b32 v156, 0
    v_mov_b32 v157, 0
    v_mov_b32 v158, 0
    v_mov_b32 v159, 0
    v_mov_b32 v160, 0
    v_mov_b32 v161, 0
    v_mov_b32 v162, 0
    v_mov_b32 v163, 0
    v_lshrrev_b32 v166, 4, v1
    v_lshlrev_b32 v166, 4, v166
    v_lshl_add_u32 v166, v164, 6, v166
    v_mov_b32 v165, 0x7f000000
    v_cmp_gt_u32 vcc, 4, v164
    s_nop 1
    v_cndmask_b32 v167, v165, v166, vcc
    v_cmp_gt_u32 vcc, 14, v164
    s_nop 1
    v_cndmask_b32 v168, v165, v166, vcc
    s_waitcnt vmcnt(0)
    v_and_b32 v252, 15, v251
    v_mul_u32_u24 v248, 458752, v252
    s_and_b32 s36, s30, 1
    s_mul_i32 s36, s36, 6
    s_add_u32 s36, s36, 4
    v_bfe_u32 v252, v251, s36, 6
    v_mul_u32_u24 v250, 37, v252
    v_lshrrev_b32 v250, 8, v250
    v_mul_u32_u24 v250, 7, v250
    v_sub_u32 v250, v252, v250
    v_cmp_eq_u32 vcc, 3, v250
    s_nop 1
    v_cndmask_b32 v250, 0, 1, vcc
    v_lshl_add_u32 v249, v252, 16, v250
    v_mov_b32 v6, 162836
spin_12:
    s_sleep 2
    ds_read_b32 v7, v6
    s_waitcnt lgkmcnt(0)
    v_readfirstlane_b32 s53, v7
    s_nop 0
    s_cmp_ge_u32 s53, 4
    s_cbranch_scc0 spin_12
    s_mov_b64 s[12:13], s[68:69]
    s_mov_b32 s14, 2097152
    s_mov_b32 s15, 0x20000
    s_and_b32 s35, s30, 1
    s_mul_i32 s38, s99, 128
    s_mul_i32 s41, s35, 65536
    s_add_u32 s38, s38, s41
    s_mul_i32 s41, s35, 4096
    s_add_u32 s41, s41, 24576
    s_mov_b32 s42, 0
    s_mov_b32 s44, s67
    s_mov_b32 s42, 73728
    s_mov_b32 s44, s28
    s_add_u32 s19, s41, s42
    s_mul_i32 s16, s44, 131072
    s_add_u32 s16, s16, s38
    s_add_u32 s44, s44, 1
    s_and_b32 s44, s44, 15
    s_add_u32 s42, s42, 8192
    s_cmp_eq_u32 s42, 131072
    s_cselect_b32 s42, 0, s42
    s_mov_b32 m0, s19
    s_mov_b32 s39, s16
    buffer_load_dwordx4 v238, s[12:15], s39 offen lds
    s_add_u32 m0, m0, 1024
    s_add_u32 s39, s39, 16384
    buffer_load_dwordx4 v238, s[12:15], s39 offen lds
    s_add_u32 m0, m0, 1024
    s_add_u32 s39, s39, 16384
    buffer_load_dwordx4 v238, s[12:15], s39 offen lds
    s_add_u32 m0, m0, 1024
    s_add_u32 s39, s39, 16384
    buffer_load_dwordx4 v238, s[12:15], s39 offen lds
    s_mov_b64 s[12:13], s[72:73]
    s_mov_b32 s14, 7340032
    s_mov_b32 s15, 0x20000
    s_and_b32 s35, s30, 1
    s_mul_i32 s38, s29, 448
    s_mul_i32 s41, s35, 229376
    s_add_u32 s38, s38, s41
    s_mul_i32 s41, s35, 14336
    s_add_u32 s41, s41, 73728
    s_mov_b32 s42, 0
    s_mov_b32 s44, 0
    s_mov_b32 s42, 32768
    s_mov_b32 s44, s28
    s_add_u32 s19, s41, s42
    s_mul_i32 s16, s44, 458752
    s_add_u32 s16, s16, s38
    s_add_u32 s44, s44, 1
    s_and_b32 s44, s44, 15
    s_add_u32 s42, s42, 28672
    s_cmp_eq_u32 s42, 86016
    s_cselect_b32 s42, 0, s42
    s_mov_b32 m0, s19
    s_mov_b32 s39, s16
    buffer_load_dwordx4 v241, s[12:15], s39 offen lds
    s_add_u32 m0, m0, 1024
    s_nop 0
    buffer_load_dwordx4 v242, s[12:15], s39 offen lds
    s_add_u32 m0, m0, 1024
    s_nop 0
    buffer_load_dwordx4 v243, s[12:15], s39 offen lds
    s_add_u32 m0, m0, 1024
    s_nop 0
    buffer_load_dwordx4 v244, s[12:15], s39 offen lds
    s_add_u32 m0, m0, 1024
    s_nop 0
    buffer_load_dwordx4 v245, s[12:15], s39 offen lds
    s_add_u32 m0, m0, 1024
    s_nop 0
    buffer_load_dwordx4 v246, s[12:15], s39 offen lds
    s_add_u32 m0, m0, 1024
    s_nop 0
    buffer_load_dwordx4 v247, s[12:15], s39 offen lds
    s_add_u32 m0, m0, 1024
    s_add_u32 s39, s39, 114688
    buffer_load_dwordx4 v241, s[12:15], s39 offen lds
    s_add_u32 m0, m0, 1024
    s_nop 0
    buffer_load_dwordx4 v242, s[12:15], s39 offen lds
    s_add_u32 m0, m0, 1024
    s_nop 0
    buffer_load_dwordx4 v243, s[12:15], s39 offen lds
    s_add_u32 m0, m0, 1024
    s_nop 0
    buffer_load_dwordx4 v244, s[12:15], s39 offen lds
    s_add_u32 m0, m0, 1024
    s_nop 0
    buffer_load_dwordx4 v245, s[12:15], s39 offen lds
    s_add_u32 m0, m0, 1024
    s_nop 0
    buffer_load_dwordx4 v246, s[12:15], s39 offen lds
    s_add_u32 m0, m0, 1024
    s_nop 0
    buffer_load_dwordx4 v247, s[12:15], s39 offen lds
    s_waitcnt vmcnt(14)
    s_setprio 1
    ds_read_b64_tr_b16 v[128:129], v144 offset:0
    ds_read_b64_tr_b16 v[130:131], v144 offset:2048
    ds_read_b64_tr_b16 v[132:133], v145 offset:0
    ds_read_b64_tr_b16 v[134:135], v145 offset:2048
    ds_read_b64_tr_b16 v[136:137], v146 offset:0
    ds_read_b64_tr_b16 v[138:139], v146 offset:2048
    ds_read_b64_tr_b16 v[140:141], v147 offset:0
    ds_read_b64_tr_b16 v[142:143], v147 offset:2048
    s_add_u32 s20, s4, 0x1400000
    s_addc_u32 s21, s5, 0
    s_mov_b32 s22, 0x20000
    s_mov_b32 s23, 0x20000
    s_lshl_b32 s35, s28, 1
    s_and_b32 s36, s30, 1
    s_add_u32 s35, s35, s36
    s_mul_i32 s35, s35, 4096
    s_mul_i32 s36, s29, 256
    s_add_u32 s35, s35, s36
    s_waitcnt lgkmcnt(0)
    v_mfma_f32_16x16x32_bf16 v[160:163], v[128:131], v[16:19], v[160:163]
    v_mfma_f32_16x16x32_bf16 v[160:163], v[132:135], v[20:23], v[160:163]
    v_mfma_f32_16x16x32_bf16 v[160:163], v[136:139], v[24:27], v[160:163]
    v_mfma_f32_16x16x32_bf16 v[160:163], v[140:143], v[28:31], v[160:163]
    s_nop 7
    buffer_store_dwordx4 v[160:163], v167, s[20:23], s35 offen sc1
    s_waitcnt vmcnt(1)
    v_mov_b32 v6, 162840
    v_mov_b32 v7, 1
    s_mov_b64 exec, 1
    ds_add_u32 v6, v7
    s_mov_b64 exec, -1
    ds_read_b64_tr_b16 v[72:73], v148 offset:0
    ds_read_b64_tr_b16 v[74:75], v148 offset:7168
    ds_read_b64_tr_b16 v[76:77], v149 offset:32
    ds_read_b64_tr_b16 v[78:79], v149 offset:7200
    ds_read_b64_tr_b16 v[80:81], v148 offset:64
    ds_read_b64_tr_b16 v[82:83], v148 offset:7232
    ds_read_b64_tr_b16 v[84:85], v149 offset:96
    ds_read_b64_tr_b16 v[86:87], v149 offset:7264
    ds_read_b64_tr_b16 v[88:89], v148 offset:128
    ds_read_b64_tr_b16 v[90:91], v148 offset:7296
    ds_read_b64_tr_b16 v[92:93], v149 offset:160
    ds_read_b64_tr_b16 v[94:95], v149 offset:7328
    ds_read_b64_tr_b16 v[96:97], v148 offset:192
    ds_read_b64_tr_b16 v[98:99], v148 offset:7360
    ds_read_b64_tr_b16 v[100:101], v150 offset:0
    ds_read_b64_tr_b16 v[102:103], v150 offset:7168
    ds_read_b64_tr_b16 v[104:105], v151 offset:32
    ds_read_b64_tr_b16 v[106:107], v151 offset:7200
    ds_read_b64_tr_b16 v[108:109], v150 offset:64
    ds_read_b64_tr_b16 v[110:111], v150 offset:7232
    ds_read_b64_tr_b16 v[112:113], v151 offset:96
    ds_read_b64_tr_b16 v[114:115], v151 offset:7264
    ds_read_b64_tr_b16 v[116:117], v150 offset:128
    ds_read_b64_tr_b16 v[118:119], v150 offset:7296
    ds_read_b64_tr_b16 v[120:121], v151 offset:160
    ds_read_b64_tr_b16 v[122:123], v151 offset:7328
    ds_read_b64_tr_b16 v[124:125], v150 offset:192
    ds_read_b64_tr_b16 v[126:127], v150 offset:7360
    s_add_u32 s20, s4, 0x1420000
    s_addc_u32 s21, s5, 0
    s_mov_b32 s22, 0x70000
    s_mov_b32 s23, 0x20000
    s_lshl_b32 s35, s28, 1
    s_and_b32 s36, s30, 1
    s_add_u32 s35, s35, s36
    s_mul_i32 s35, s35, 14336
    s_mul_i32 s36, s29, 896
    s_add_u32 s35, s35, s36
    s_waitcnt lgkmcnt(0)
    v_mfma_f32_16x16x32_bf16 v[156:159], v[72:75], v[16:19], v[156:159]
    v_mfma_f32_16x16x32_bf16 v[156:159], v[76:79], v[20:23], v[156:159]
    v_mfma_f32_16x16x32_bf16 v[156:159], v[80:83], v[24:27], v[156:159]
    v_mfma_f32_16x16x32_bf16 v[156:159], v[84:87], v[28:31], v[156:159]
    v_mfma_f32_16x16x32_bf16 v[156:159], v[88:91], v[32:35], v[156:159]
    v_mfma_f32_16x16x32_bf16 v[156:159], v[92:95], v[36:39], v[156:159]
    v_mfma_f32_16x16x32_bf16 v[156:159], v[96:99], v[40:43], v[156:159]
    v_mfma_f32_16x16x32_bf16 v[156:159], v[100:103], v[44:47], v[156:159]
    v_mfma_f32_16x16x32_bf16 v[156:159], v[104:107], v[48:51], v[156:159]
    v_mfma_f32_16x16x32_bf16 v[156:159], v[108:111], v[52:55], v[156:159]
    v_mfma_f32_16x16x32_bf16 v[156:159], v[112:115], v[56:59], v[156:159]
    v_mfma_f32_16x16x32_bf16 v[156:159], v[116:119], v[60:63], v[156:159]
    v_mfma_f32_16x16x32_bf16 v[156:159], v[120:123], v[64:67], v[156:159]
    v_mfma_f32_16x16x32_bf16 v[156:159], v[124:127], v[68:71], v[156:159]
    s_nop 7
    buffer_store_dwordx4 v[156:159], v168, s[20:23], s35 offen sc1
    v_mov_b32 v6, 162840
    v_mov_b32 v7, 1
    s_mov_b64 exec, 1
    ds_add_u32 v6, v7
    s_mov_b64 exec, -1
    s_setprio 0
    s_call_b64 s[76:77], SUB_w1_regs
    s_call_b64 s[76:77], SUB_park
    v_mov_b32 v6, 162840
spin_14:
    s_sleep 3
    ds_read_b32 v7, v6
    s_waitcnt lgkmcnt(0)
    v_readfirstlane_b32 s53, v7
    s_nop 0
    s_cmp_ge_u32 s53, 4
    s_cbranch_scc0 spin_14
    s_mov_b64 s[12:13], s[68:69]
    s_mov_b32 s14, 2097152
    s_mov_b32 s15, 0x20000
    s_and_b32 s35, s30, 1
    s_mul_i32 s38, s99, 128
    s_mul_i32 s41, s35, 65536
    s_add_u32 s38, s38, s41
    s_mul_i32 s41, s35, 4096
    s_add_u32 s41, s41, 24576
    s_mov_b32 s42, 0
    s_mov_b32 s44, s67
    s_mov_b32 s42, 98304
    s_mov_b32 s44, s67
    s_add_u32 s44, s44, 12
    s_and_b32 s44, s44, 15
    s_call_b64 s[76:77], SUB_w_issue_1
    s_waitcnt vmcnt(8)
    s_mov_b32 s42, 106496
    s_mov_b32 s44, s67
    s_add_u32 s44, s44, 13
    s_and_b32 s44, s44, 15
    s_call_b64 s[76:77], SUB_w_issue_1
    s_waitcnt vmcnt(8)
    s_mov_b32 s42, 114688
    s_mov_b32 s44, s67
    s_add_u32 s44, s44, 14
    s_and_b32 s44, s44, 15
    s_call_b64 s[76:77], SUB_w_issue_1
    s_waitcnt vmcnt(8)
    s_mov_b32 s42, 122880
    s_mov_b32 s44, s67
    s_add_u32 s44, s44, 15
    s_and_b32 s44, s44, 15
    s_call_b64 s[76:77], SUB_w_issue_1
    s_waitcnt vmcnt(8)
    s_and_b32 s36, s29, 6
    s_cmp_eq_u32 s36, 2
    s_cbranch_scc1 pr_15
    s_call_b64 s[76:77], SUB_park2
pr_15:
    s_call_b64 s[76:77], SUB_w1_put
FR_end:
LAYER:
    v_lshlrev_b32 v40, 6, v199
    v_add_u32 v40, 161792, v40
    s_lshl_b32 s35, s30, 3
    v_add_u32 v39, s35, v40
    s_cmp_eq_u32 s60, 0
    s_cbranch_scc1 R_l0
    s_sub_u32 s8, s62, 0x400000
    s_subb_u32 s9, s63, 0
    s_mov_b32 s10, 0x7e000
    s_mov_b32 s11, 0x20000
    s_sub_u32 s12, s62, 0x380000
    s_subb_u32 s13, s63, 0
    s_mov_b32 s14, 0x7e000
    s_mov_b32 s15, 0x20000
    s_mov_b32 s20, s62
    s_mov_b32 s21, s63
    s_mov_b32 s22, 0x7e000
    s_mov_b32 s23, 0x20000
    s_mov_b32 s78, 0x3f80
    s_mov_b32 s79, 0x3f800000
    v_lshlrev_b32 v222, 16, v230
    v_and_b32 v223, 0xffff0000, v230
    v_lshlrev_b32 v206, 16, v180
    v_and_b32 v207, 0xffff0000, v180
    v_lshlrev_b32 v12, 16, v188
    v_and_b32 v13, 0xffff0000, v188
    v_pk_add_f32 v[206:207], v[206:207], v[12:13]
    v_lshlrev_b32 v224, 16, v231
    v_and_b32 v225, 0xffff0000, v231
    v_lshlrev_b32 v208, 16, v181
    v_and_b32 v209, 0xffff0000, v181
    v_lshlrev_b32 v14, 16, v189
    v_and_b32 v15, 0xffff0000, v189
    v_pk_add_f32 v[208:209], v[208:209], v[14:15]
    v_lshlrev_b32 v226, 16, v232
    v_and_b32 v227, 0xffff0000, v232
    v_lshlrev_b32 v210, 16, v182
    v_and_b32 v211, 0xffff0000, v182
    v_lshlrev_b32 v16, 16, v190
    v_and_b32 v17, 0xffff0000, v190
    v_pk_add_f32 v[210:211], v[210:211], v[16:17]
    v_lshlrev_b32 v228, 16, v233
    v_and_b32 v229, 0xffff0000, v233
    v_lshlrev_b32 v212, 16, v183
    v_and_b32 v213, 0xffff0000, v183
    v_lshlrev_b32 v18, 16, v191
    v_and_b32 v19, 0xffff0000, v191
    v_pk_add_f32 v[212:213], v[212:213], v[18:19]
    v_lshlrev_b32 v230, 16, v234
    v_and_b32 v231, 0xffff0000, v234
    v_lshlrev_b32 v214, 16, v184
    v_and_b32 v215, 0xffff0000, v184
    v_lshlrev_b32 v20, 16, v192
    v_and_b32 v21, 0xffff0000, v192
    v_pk_add_f32 v[214:215], v[214:215], v[20:21]
    v_lshlrev_b32 v232, 16, v235
    v_and_b32 v233, 0xffff0000, v235
    v_lshlrev_b32 v216, 16, v185
    v_and_b32 v217, 0xffff0000, v185
    v_lshlrev_b32 v22, 16, v193
    v_and_b32 v23, 0xffff0000, v193
    v_pk_add_f32 v[216:217], v[216:217], v[22:23]
    v_lshlrev_b32 v234, 16, v236
    v_and_b32 v235, 0xffff0000, v236
    v_lshlrev_b32 v218, 16, v186
    v_and_b32 v219, 0xffff0000, v186
    v_lshlrev_b32 v24, 16, v194
    v_and_b32 v25, 0xffff0000, v194
    v_pk_add_f32 v[218:219], v[218:219], v[24:25]
    v_lshlrev_b32 v236, 16, v237
    v_and_b32 v237, 0xffff0000, v237
    v_lshlrev_b32 v220, 16, v187
    v_and_b32 v221, 0xffff0000, v187
    v_lshlrev_b32 v26, 16, v195
    v_and_b32 v27, 0xffff0000, v195
    v_pk_add_f32 v[220:221], v[220:221], v[26:27]
    s_mov_b32 s53, 0
    s_sleep 10
    s_cmp_ge_u32 s30, 6
    s_cbranch_scc1 dp_16
    s_sleep 14
dp_16:
    buffer_load_dwordx4 v[180:183], v196, s[8:11], 0 offen offset:0 sc1
    buffer_load_dwordx4 v[188:191], v196, s[12:15], 0 offen offset:0 sc1
    buffer_load_dwordx4 v[184:187], v196, s[8:11], 0 offen offset:2048 sc1
    buffer_load_dwordx4 v[192:195], v196, s[12:15], 0 offen offset:2048 sc1
    s_waitcnt vmcnt(0)
    v_bitop3_b32 v6, v180, v184, v188 bitop3:0x80
    v_bitop3_b32 v6, v6, v192, 1 bitop3:0x80
    v_cmp_eq_u32 vcc, 0, v6
    s_cbranch_vccz dq_17
    s_sleep 4
    s_add_u32 s53, s53, 1
    s_cmp_lt_u32 s53, s61
    s_cbranch_scc1 dp_16
    s_mov_b32 s61, 0
dq_17:
    v_dot2_f32_bf16 v206, v180, s78, v206
    v_dot2_f32_bf16 v207, v180, s79, v207
    v_dot2_f32_bf16 v208, v181, s78, v208
    v_dot2_f32_bf16 v209, v181, s79, v209
    v_dot2_f32_bf16 v210, v182, s78, v210
    v_dot2_f32_bf16 v211, v182, s79, v211
    v_dot2_f32_bf16 v212, v183, s78, v212
    v_dot2_f32_bf16 v213, v183, s79, v213
    v_dot2_f32_bf16 v214, v184, s78, v214
    v_dot2_f32_bf16 v215, v184, s79, v215
    v_dot2_f32_bf16 v216, v185, s78, v216
    v_dot2_f32_bf16 v217, v185, s79, v217
    v_dot2_f32_bf16 v218, v186, s78, v218
    v_dot2_f32_bf16 v219, v186, s79, v219
    v_dot2_f32_bf16 v220, v187, s78, v220
    v_dot2_f32_bf16 v221, v187, s79, v221
    v_dot2_f32_bf16 v206, v188, s78, v206
    v_dot2_f32_bf16 v207, v188, s79, v207
    v_dot2_f32_bf16 v208, v189, s78, v208
    v_dot2_f32_bf16 v209, v189, s79, v209
    v_dot2_f32_bf16 v210, v190, s78, v210
    v_dot2_f32_bf16 v211, v190, s79, v211
    v_dot2_f32_bf16 v212, v191, s78, v212
    v_dot2_f32_bf16 v213, v191, s79, v213
    v_dot2_f32_bf16 v214, v192, s78, v214
    v_dot2_f32_bf16 v215, v192, s79, v215
    v_dot2_f32_bf16 v216, v193, s78, v216
    v_dot2_f32_bf16 v217, v193, s79, v217
    v_dot2_f32_bf16 v218, v194, s78, v218
    v_dot2_f32_bf16 v219, v194, s79, v219
    v_dot2_f32_bf16 v220, v195, s78, v220
    v_dot2_f32_bf16 v221, v195, s79, v221
    s_nop 2
    v_pk_add_f32 v[32:33], v[206:207], v[208:209]
    v_pk_mul_f32 v[34:35], v[206:207], v[206:207]
    v_pk_fma_f32 v[34:35], v[208:209], v[208:209], v[34:35]
    v_pk_add_f32 v[32:33], v[32:33], v[210:211]
    v_pk_fma_f32 v[34:35], v[210:211], v[210:211], v[34:35]
    v_pk_add_f32 v[32:33], v[32:33], v[212:213]
    v_pk_fma_f32 v[34:35], v[212:213], v[212:213], v[34:35]
    v_pk_add_f32 v[32:33], v[32:33], v[214:215]
    v_pk_fma_f32 v[34:35], v[214:215], v[214:215], v[34:35]
    v_pk_add_f32 v[32:33], v[32:33], v[216:217]
    v_pk_fma_f32 v[34:35], v[216:217], v[216:217], v[34:35]
    v_pk_add_f32 v[32:33], v[32:33], v[218:219]
    v_pk_fma_f32 v[34:35], v[218:219], v[218:219], v[34:35]
    v_pk_add_f32 v[32:33], v[32:33], v[220:221]
    v_pk_fma_f32 v[34:35], v[220:221], v[220:221], v[34:35]
    v_add_f32 v30, v32, v33
    v_add_f32 v31, v34, v35
    s_nop 0
    v_add_f32_dpp v30, v30, v30 row_ror:8 row_mask:0xf bank_mask:0xf
    v_add_f32_dpp v31, v31, v31 row_ror:8 row_mask:0xf bank_mask:0xf
    v_mov_b32 v32, v30
    v_mov_b32 v33, v31
    s_nop 0
    v_permlane16_swap_b32 v30, v32
    v_permlane16_swap_b32 v31, v33
    v_pk_add_f32 v[30:31], v[30:31], v[32:33]
    v_mov_b32 v32, v30
    v_mov_b32 v33, v31
    s_nop 0
    v_permlane32_swap_b32 v30, v32
    v_permlane32_swap_b32 v31, v33
    v_pk_add_f32 v[30:31], v[30:31], v[32:33]
    ds_write_b64 v39, v[30:31] offset:0
    s_waitcnt lgkmcnt(0)
    s_barrier
    ds_read_b128 v[12:15], v40 offset:0
    ds_read_b128 v[16:19], v40 offset:16
    ds_read_b128 v[20:23], v40 offset:32
    ds_read_b128 v[24:27], v40 offset:48
    s_waitcnt lgkmcnt(0)
    v_pk_add_f32 v[12:13], v[12:13], v[14:15]
    v_pk_add_f32 v[16:17], v[16:17], v[18:19]
    v_pk_add_f32 v[20:21], v[20:21], v[22:23]
    v_pk_add_f32 v[24:25], v[24:25], v[26:27]
    v_pk_add_f32 v[12:13], v[12:13], v[16:17]
    v_pk_add_f32 v[20:21], v[20:21], v[24:25]
    v_pk_add_f32 v[12:13], v[12:13], v[20:21]
    v_mul_f32 v36, 0x3a800000, v12
    v_mul_f32 v38, 0x3a800000, v13
    v_fma_f32 v38, -v36, v36, v38
    v_max_f32 v38, 0, v38
    v_add_f32 v38, 0x3727c5ac, v38
    v_rsq_f32 v37, v38
    s_nop 0
    v_mul_f32 v36, v36, v37
    v_pk_fma_f32 v[12:13], v[206:207], v[36:37], v[36:37] op_sel:[0,1,0] op_sel_hi:[1,1,0] neg_lo:[0,0,1] neg_hi:[0,0,1]
    v_pk_fma_f32 v[14:15], v[208:209], v[36:37], v[36:37] op_sel:[0,1,0] op_sel_hi:[1,1,0] neg_lo:[0,0,1] neg_hi:[0,0,1]
    v_pk_fma_f32 v[16:17], v[210:211], v[36:37], v[36:37] op_sel:[0,1,0] op_sel_hi:[1,1,0] neg_lo:[0,0,1] neg_hi:[0,0,1]
    v_pk_fma_f32 v[18:19], v[212:213], v[36:37], v[36:37] op_sel:[0,1,0] op_sel_hi:[1,1,0] neg_lo:[0,0,1] neg_hi:[0,0,1]
    v_pk_fma_f32 v[20:21], v[214:215], v[36:37], v[36:37] op_sel:[0,1,0] op_sel_hi:[1,1,0] neg_lo:[0,0,1] neg_hi:[0,0,1]
    v_pk_fma_f32 v[22:23], v[216:217], v[36:37], v[36:37] op_sel:[0,1,0] op_sel_hi:[1,1,0] neg_lo:[0,0,1] neg_hi:[0,0,1]
    v_pk_fma_f32 v[24:25], v[218:219], v[36:37], v[36:37] op_sel:[0,1,0] op_sel_hi:[1,1,0] neg_lo:[0,0,1] neg_hi:[0,0,1]
    v_pk_fma_f32 v[26:27], v[220:221], v[36:37], v[36:37] op_sel:[0,1,0] op_sel_hi:[1,1,0] neg_lo:[0,0,1] neg_hi:[0,0,1]
    v_pk_fma_f32 v[206:207], v[12:13], v[222:223], v[206:207]
    v_cvt_pk_bf16_f32 v180, v206, v207
    v_pk_fma_f32 v[208:209], v[14:15], v[224:225], v[208:209]
    v_cvt_pk_bf16_f32 v181, v208, v209
    v_and_b32 v180, -2, v180
    v_pk_fma_f32 v[210:211], v[16:17], v[226:227], v[210:211]
    v_cvt_pk_bf16_f32 v182, v210, v211
    v_pk_fma_f32 v[212:213], v[18:19], v[228:229], v[212:213]
    v_cvt_pk_bf16_f32 v183, v212, v213
    buffer_store_dwordx4 v[180:183], v196, s[20:23], 0 offen offset:0 sc1
    v_pk_fma_f32 v[214:215], v[20:21], v[230:231], v[214:215]
    v_cvt_pk_bf16_f32 v184, v214, v215
    v_pk_fma_f32 v[216:217], v[22:23], v[232:233], v[216:217]
    v_cvt_pk_bf16_f32 v185, v216, v217
    v_and_b32 v184, -2, v184
    v_pk_fma_f32 v[218:219], v[24:25], v[234:235], v[218:219]
    v_cvt_pk_bf16_f32 v186, v218, v219
    v_pk_fma_f32 v[220:221], v[26:27], v[236:237], v[220:221]
    v_cvt_pk_bf16_f32 v187, v220, v221
    buffer_store_dwordx4 v[184:187], v196, s[20:23], 0 offen offset:2048 sc1
    s_branch R_s2
R_l0:
    v_lshlrev_b32 v206, 16, v180
    v_and_b32 v207, 0xffff0000, v180
    v_lshlrev_b32 v208, 16, v181
    v_and_b32 v209, 0xffff0000, v181
    v_lshlrev_b32 v210, 16, v182
    v_and_b32 v211, 0xffff0000, v182
    v_lshlrev_b32 v212, 16, v183
    v_and_b32 v213, 0xffff0000, v183
    v_lshlrev_b32 v214, 16, v184
    v_and_b32 v215, 0xffff0000, v184
    v_lshlrev_b32 v216, 16, v185
    v_and_b32 v217, 0xffff0000, v185
    v_lshlrev_b32 v218, 16, v186
    v_and_b32 v219, 0xffff0000, v186
    v_lshlrev_b32 v220, 16, v187
    v_and_b32 v221, 0xffff0000, v187
    v_pk_add_f32 v[32:33], v[206:207], v[208:209]
    v_pk_mul_f32 v[34:35], v[206:207], v[206:207]
    v_pk_fma_f32 v[34:35], v[208:209], v[208:209], v[34:35]
    v_pk_add_f32 v[32:33], v[32:33], v[210:211]
    v_pk_fma_f32 v[34:35], v[210:211], v[210:211], v[34:35]
    v_pk_add_f32 v[32:33], v[32:33], v[212:213]
    v_pk_fma_f32 v[34:35], v[212:213], v[212:213], v[34:35]
    v_pk_add_f32 v[32:33], v[32:33], v[214:215]
    v_pk_fma_f32 v[34:35], v[214:215], v[214:215], v[34:35]
    v_pk_add_f32 v[32:33], v[32:33], v[216:217]
    v_pk_fma_f32 v[34:35], v[216:217], v[216:217], v[34:35]
    v_pk_add_f32 v[32:33], v[32:33], v[218:219]
    v_pk_fma_f32 v[34:35], v[218:219], v[218:219], v[34:35]
    v_pk_add_f32 v[32:33], v[32:33], v[220:221]
    v_pk_fma_f32 v[34:35], v[220:221], v[220:221], v[34:35]
    v_add_f32 v30, v32, v33
    v_add_f32 v31, v34, v35
    s_nop 0
    v_add_f32_dpp v30, v30, v30 row_ror:8 row_mask:0xf bank_mask:0xf
    v_add_f32_dpp v31, v31, v31 row_ror:8 row_mask:0xf bank_mask:0xf
    v_mov_b32 v32, v30
    v_mov_b32 v33, v31
    s_nop 0
    v_permlane16_swap_b32 v30, v32
    v_permlane16_swap_b32 v31, v33
    v_pk_add_f32 v[30:31], v[30:31], v[32:33]
    v_mov_b32 v32, v30
    v_mov_b32 v33, v31
    s_nop 0
    v_permlane32_swap_b32 v30, v32
    v_permlane32_swap_b32 v31, v33
    v_pk_add_f32 v[30:31], v[30:31], v[32:33]
    ds_write_b64 v39, v[30:31] offset:0
    s_waitcnt lgkmcnt(0)
    v_mov_b32 v222, 162844
spin_18:
    ds_read_b32 v223, v222
    s_waitcnt lgkmcnt(0)
    v_readfirstlane_b32 s94, v223
    s_nop 0
    s_cmp_ge_u32 s94, 65536
    s_cbranch_scc0 spin_18
    s_cmp_gt_u32 s94, 65546
    s_cselect_b32 s94, 1, 0
    s_lshl_b32 s53, s94, 13
    v_xor_b32 v197, s53, v197
    s_lshr_b32 s53, s28, 3
    s_lshl_b32 s53, s53, 2
    s_and_b32 s54, s28, 3
    s_add_u32 s53, s53, s54
    s_lshl_b32 s53, s53, 24
    s_lshr_b32 s54, s28, 2
    s_xor_b32 s54, s54, s94
    s_and_b32 s54, s54, 1
    s_lshl_b32 s54, s54, 13
    s_add_u32 s36, s53, s54
    s_add_u32 s36, s36, 33554432
    s_lshr_b32 s53, s53, 14
    s_add_u32 s36, s53, s54
    s_xor_b32 s36, s36, 8192
    s_add_u32 s36, s36, 23101440
    s_lshl_b32 s53, s30, 7
    s_add_u32 s36, s36, s53
    v_mov_b32 v226, s36
    s_waitcnt vmcnt(0)
    s_barrier
    s_mov_b32 s53, 0
    s_add_u32 s54, s52, 32
    s_bfm_b64 exec, 1, 0
poll_19:
    buffer_load_dword v222, v226, s[56:59], 0 offen sc1
    s_waitcnt vmcnt(0)
    v_xor_b32 v222, s54, v222
    v_cmp_eq_u32 vcc, 0, v222
    s_nop 0
    s_cmp_eq_u64 vcc, exec
    s_cbranch_scc1 pok_20
    s_sleep 6
    s_add_u32 s53, s53, 1
    s_cmp_lt_u32 s53, s61
    s_cbranch_scc1 poll_19
    s_mov_b32 s61, 0
pok_20:
    s_mov_b64 exec, -1
    s_add_u32 s80, s4, 0x2100000
    s_addc_u32 s81, s5, 0
    s_mov_b32 s82, 0x7f00000
    s_mov_b32 s83, 0x20000
    s_mov_b32 s78, 0
    buffer_load_dwordx2 v[230:231], v197, s[80:83], s78 offen sc1
    s_mov_b32 s78, 2048
    buffer_load_dwordx2 v[232:233], v197, s[80:83], s78 offen sc1
    s_mov_b32 s78, 16384
    buffer_load_dwordx2 v[234:235], v197, s[80:83], s78 offen sc1
    s_mov_b32 s78, 18432
    buffer_load_dwordx2 v[236:237], v197, s[80:83], s78 offen sc1
    s_lshr_b32 s53, s28, 3
    s_lshl_b32 s53, s53, 2
    s_and_b32 s54, s28, 3
    s_add_u32 s53, s53, s54
    s_lshl_b32 s53, s53, 24
    s_lshr_b32 s54, s28, 2
    s_xor_b32 s54, s54, s94
    s_and_b32 s54, s54, 1
    s_lshl_b32 s54, s54, 13
    s_add_u32 s55, s53, s54
    s_add_u32 s55, s55, 33554432
    s_add_u32 s62, s4, s55
    s_addc_u32 s63, s5, 0
    s_sub_u32 s36, s28, 1
    s_max_i32 s36, s36, 0
    s_lshr_b32 s53, s36, 3
    s_lshl_b32 s53, s53, 2
    s_and_b32 s54, s36, 3
    s_add_u32 s53, s53, s54
    s_lshl_b32 s53, s53, 24
    s_lshr_b32 s54, s36, 2
    s_xor_b32 s54, s54, s94
    s_and_b32 s54, s54, 1
    s_lshl_b32 s54, s54, 13
    s_add_u32 s92, s53, s54
    s_add_u32 s92, s92, 33554432
    s_sub_u32 s92, s92, s55
    s_add_u32 s36, s28, 1
    s_min_u32 s36, s36, 15
    s_lshr_b32 s53, s36, 3
    s_lshl_b32 s53, s53, 2
    s_and_b32 s54, s36, 3
    s_add_u32 s53, s53, s54
    s_lshl_b32 s53, s53, 24
    s_lshr_b32 s54, s36, 2
    s_xor_b32 s54, s54, s94
    s_and_b32 s54, s54, 1
    s_lshl_b32 s54, s54, 13
    s_add_u32 s93, s53, s54
    s_add_u32 s93, s93, 33554432
    s_sub_u32 s93, s93, s55
    s_add_u32 s55, s55, 6029312
    s_mov_b32 s20, s62
    s_mov_b32 s21, s63
    s_mov_b32 s22, 0x7e000
    s_mov_b32 s23, 0x20000
    ds_read_b128 v[12:15], v40 offset:0
    ds_read_b128 v[16:19], v40 offset:16
    ds_read_b128 v[20:23], v40 offset:32
    ds_read_b128 v[24:27], v40 offset:48
    s_waitcnt lgkmcnt(0)
    v_pk_add_f32 v[12:13], v[12:13], v[14:15]
    v_pk_add_f32 v[16:17], v[16:17], v[18:19]
    v_pk_add_f32 v[20:21], v[20:21], v[22:23]
    v_pk_add_f32 v[24:25], v[24:25], v[26:27]
    v_pk_add_f32 v[12:13], v[12:13], v[16:17]
    v_pk_add_f32 v[20:21], v[20:21], v[24:25]
    v_pk_add_f32 v[12:13], v[12:13], v[20:21]
    v_mul_f32 v36, 0x3a800000, v12
    v_mul_f32 v38, 0x3a800000, v13
    v_fma_f32 v38, -v36, v36, v38
    v_max_f32 v38, 0, v38
    v_add_f32 v38, 0x3727c5ac, v38
    v_rsq_f32 v37, v38
    s_nop 0
    v_pk_add_f32 v[12:13], v[206:207], v[36:37] op_sel_hi:[1,0] neg_lo:[0,1] neg_hi:[0,1]
    v_pk_mul_f32 v[12:13], v[12:13], v[36:37] op_sel:[0,1] op_sel_hi:[1,1]
    v_pk_add_f32 v[14:15], v[208:209], v[36:37] op_sel_hi:[1,0] neg_lo:[0,1] neg_hi:[0,1]
    v_pk_mul_f32 v[14:15], v[14:15], v[36:37] op_sel:[0,1] op_sel_hi:[1,1]
    v_pk_add_f32 v[16:17], v[210:211], v[36:37] op_sel_hi:[1,0] neg_lo:[0,1] neg_hi:[0,1]
    v_pk_mul_f32 v[16:17], v[16:17], v[36:37] op_sel:[0,1] op_sel_hi:[1,1]
    v_pk_add_f32 v[18:19], v[212:213], v[36:37] op_sel_hi:[1,0] neg_lo:[0,1] neg_hi:[0,1]
    v_pk_mul_f32 v[18:19], v[18:19], v[36:37] op_sel:[0,1] op_sel_hi:[1,1]
    v_pk_add_f32 v[20:21], v[214:215], v[36:37] op_sel_hi:[1,0] neg_lo:[0,1] neg_hi:[0,1]
    v_pk_mul_f32 v[20:21], v[20:21], v[36:37] op_sel:[0,1] op_sel_hi:[1,1]
    v_pk_add_f32 v[22:23], v[216:217], v[36:37] op_sel_hi:[1,0] neg_lo:[0,1] neg_hi:[0,1]
    v_pk_mul_f32 v[22:23], v[22:23], v[36:37] op_sel:[0,1] op_sel_hi:[1,1]
    v_pk_add_f32 v[24:25], v[218:219], v[36:37] op_sel_hi:[1,0] neg_lo:[0,1] neg_hi:[0,1]
    v_pk_mul_f32 v[24:25], v[24:25], v[36:37] op_sel:[0,1] op_sel_hi:[1,1]
    v_pk_add_f32 v[26:27], v[220:221], v[36:37] op_sel_hi:[1,0] neg_lo:[0,1] neg_hi:[0,1]
    v_pk_mul_f32 v[26:27], v[26:27], v[36:37] op_sel:[0,1] op_sel_hi:[1,1]
    s_barrier
    s_waitcnt vmcnt(0)
    v_lshlrev_b32 v222, 16, v230
    v_and_b32 v223, 0xffff0000, v230
    v_pk_fma_f32 v[206:207], v[12:13], v[222:223], v[206:207]
    v_cvt_pk_bf16_f32 v180, v206, v207
    v_lshlrev_b32 v222, 16, v231
    v_and_b32 v223, 0xffff0000, v231
    v_pk_fma_f32 v[208:209], v[14:15], v[222:223], v[208:209]
    v_cvt_pk_bf16_f32 v181, v208, v209
    v_and_b32 v180, -2, v180
    v_lshlrev_b32 v222, 16, v232
    v_and_b32 v223, 0xffff0000, v232
    v_pk_fma_f32 v[210:211], v[16:17], v[222:223], v[210:211]
    v_cvt_pk_bf16_f32 v182, v210, v211
    v_lshlrev_b32 v222, 16, v233
    v_and_b32 v223, 0xffff0000, v233
    v_pk_fma_f32 v[212:213], v[18:19], v[222:223], v[212:213]
    v_cvt_pk_bf16_f32 v183, v212, v213
    buffer_store_dwordx4 v[180:183], v196, s[20:23], 0 offen offset:0 sc1
    v_lshlrev_b32 v222, 16, v234
    v_and_b32 v223, 0xffff0000, v234
    v_pk_fma_f32 v[214:215], v[20:21], v[222:223], v[214:215]
    v_cvt_pk_bf16_f32 v184, v214, v215
    v_lshlrev_b32 v222, 16, v235
    v_and_b32 v223, 0xffff0000, v235
    v_pk_fma_f32 v[216:217], v[22:23], v[222:223], v[216:217]
    v_cvt_pk_bf16_f32 v185, v216, v217
    v_and_b32 v184, -2, v184
    v_lshlrev_b32 v222, 16, v236
    v_and_b32 v223, 0xffff0000, v236
    v_pk_fma_f32 v[218:219], v[24:25], v[222:223], v[218:219]
    v_cvt_pk_bf16_f32 v186, v218, v219
    v_lshlrev_b32 v222, 16, v237
    v_and_b32 v223, 0xffff0000, v237
    v_pk_fma_f32 v[220:221], v[26:27], v[222:223], v[220:221]
    v_cvt_pk_bf16_f32 v187, v220, v221
    buffer_store_dwordx4 v[184:187], v196, s[20:23], 0 offen offset:2048 sc1
R_s2:
    v_lshlrev_b32 v206, 16, v180
    v_and_b32 v207, 0xffff0000, v180
    v_lshlrev_b32 v208, 16, v181
    v_and_b32 v209, 0xffff0000, v181
    v_lshlrev_b32 v210, 16, v182
    v_and_b32 v211, 0xffff0000, v182
    v_lshlrev_b32 v212, 16, v183
    v_and_b32 v213, 0xffff0000, v183
    v_lshlrev_b32 v214, 16, v184
    v_and_b32 v215, 0xffff0000, v184
    v_lshlrev_b32 v216, 16, v185
    v_and_b32 v217, 0xffff0000, v185
    v_lshlrev_b32 v218, 16, v186
    v_and_b32 v219, 0xffff0000, v186
    v_lshlrev_b32 v220, 16, v187
    v_and_b32 v221, 0xffff0000, v187
    v_pk_add_f32 v[32:33], v[206:207], v[208:209]
    v_pk_mul_f32 v[34:35], v[206:207], v[206:207]
    v_pk_fma_f32 v[34:35], v[208:209], v[208:209], v[34:35]
    v_pk_add_f32 v[32:33], v[32:33], v[210:211]
    v_pk_fma_f32 v[34:35], v[210:211], v[210:211], v[34:35]
    v_pk_add_f32 v[32:33], v[32:33], v[212:213]
    v_pk_fma_f32 v[34:35], v[212:213], v[212:213], v[34:35]
    v_pk_add_f32 v[32:33], v[32:33], v[214:215]
    v_pk_fma_f32 v[34:35], v[214:215], v[214:215], v[34:35]
    v_pk_add_f32 v[32:33], v[32:33], v[216:217]
    v_pk_fma_f32 v[34:35], v[216:217], v[216:217], v[34:35]
    v_pk_add_f32 v[32:33], v[32:33], v[218:219]
    v_pk_fma_f32 v[34:35], v[218:219], v[218:219], v[34:35]
    v_pk_add_f32 v[32:33], v[32:33], v[220:221]
    v_pk_fma_f32 v[34:35], v[220:221], v[220:221], v[34:35]
    v_add_f32 v30, v32, v33
    v_add_f32 v31, v34, v35
    s_nop 0
    v_add_f32_dpp v30, v30, v30 row_ror:8 row_mask:0xf bank_mask:0xf
    v_add_f32_dpp v31, v31, v31 row_ror:8 row_mask:0xf bank_mask:0xf
    v_mov_b32 v32, v30
    v_mov_b32 v33, v31
    s_nop 0
    v_permlane16_swap_b32 v30, v32
    v_permlane16_swap_b32 v31, v33
    v_pk_add_f32 v[30:31], v[30:31], v[32:33]
    v_mov_b32 v32, v30
    v_mov_b32 v33, v31
    s_nop 0
    v_permlane32_swap_b32 v30, v32
    v_permlane32_swap_b32 v31, v33
    v_pk_add_f32 v[30:31], v[30:31], v[32:33]
    ds_write_b64 v39, v[30:31] offset:512
    s_waitcnt lgkmcnt(0)
    s_barrier
    s_cmp_lg_u32 s30, 6
    s_cbranch_scc1 R_n6
    s_cmp_lg_u32 s60, 0
    s_cbranch_scc1 R_n6
    s_lshl_b32 s53, s29, 7
    s_add_u32 s53, s53, 23121920
    v_mov_b32 v8, 1
    v_mov_b32 v9, 0
    s_mov_b64 exec, 1
    buffer_atomic_add v8, v9, s[56:59], s53 offen sc1
    s_mov_b64 exec, -1
R_n6:
    s_cmp_lg_u32 s30, 7
    s_cbranch_scc1 R_nl
    ds_read_b128 v[12:15], v40 offset:512
    ds_read_b128 v[16:19], v40 offset:528
    ds_read_b128 v[20:23], v40 offset:544
    ds_read_b128 v[24:27], v40 offset:560
    s_waitcnt lgkmcnt(0)
    v_pk_add_f32 v[12:13], v[12:13], v[14:15]
    v_pk_add_f32 v[16:17], v[16:17], v[18:19]
    v_pk_add_f32 v[20:21], v[20:21], v[22:23]
    v_pk_add_f32 v[24:25], v[24:25], v[26:27]
    v_pk_add_f32 v[12:13], v[12:13], v[16:17]
    v_pk_add_f32 v[20:21], v[20:21], v[24:25]
    v_pk_add_f32 v[12:13], v[12:13], v[20:21]
    v_mul_f32 v36, 0x3a800000, v12
    v_mul_f32 v38, 0x3a800000, v13
    v_fma_f32 v38, -v36, v36, v38
    v_max_f32 v38, 0, v38
    v_mov_b32 v42, v36
    v_mov_b32 v43, v38
    v_add_f32 v38, 0x3727c5ac, v38
    v_sqrt_f32 v38, v38
    s_nop 0
    v_mov_b32 v41, v38
    v_rcp_f32 v37, v38
    v_sub_f32 v42, v42, v36
    v_mul_f32 v42, v42, v37
    v_mul_f32 v43, v43, v37
    v_mul_f32 v43, v43, v37
    v_add_f32 v43, 0x3727c5ac, v43
    v_rsq_f32 v44, v43
    v_mov_b32 v224, v36
    v_mov_b32 v225, v37
    v_fma_f32 v226, v42, v41, v36
    v_mul_f32 v227, v37, v44
    s_add_u32 s24, s62, 0x5d0000
    s_addc_u32 s25, s63, 0
    s_mov_b32 s26, 0x800
    s_mov_b32 s27, 0x20000
    s_lshl_b32 s36, s29, 3
    v_add_u32 v6, s36, v199
    v_lshlrev_b32 v6, 4, v6
    s_mov_b64 exec, 0xff
    buffer_store_dwordx4 v[224:227], v6, s[24:27], 0 offen sc1
    s_mov_b64 exec, -1
    s_add_u32 s53, s55, 1280
    v_mov_b32 v8, 1
    v_mov_b32 v9, 162816
    v_mov_b32 v11, 0
    s_mov_b64 exec, 1
    s_waitcnt vmcnt(0)
    buffer_atomic_add v8, v11, s[56:59], s53 offen sc1
pub_21:
    s_mov_b64 exec, -1
R_nl:
    s_cmp_ge_u32 s30, 4
    s_cbranch_scc1 LOADERS
    s_setprio 1
    s_mov_b32 s8, s62
    s_mov_b32 s9, s63
    s_mov_b32 s10, 0x7e000
    s_mov_b32 s11, 0x20000
    v_add_u32 v126, 0, v2
    v_add_u32 v127, 65536, v2
    s_lshl_b32 s44, s30, 17
    s_mov_b32 s34, s30
    s_mov_b32 s35, 0
    v_and_b32 v22, 15, v1
    v_lshrrev_b32 v23, 4, v1
    s_mul_i32 s37, s34, 2
    s_mul_i32 s38, s99, 4
    s_mul_i32 s36, s35, 4
    s_add_u32 s38, s38, s36
    v_add_u32 v128, 4096, v2
    v_add_u32 v129, 69632, v2
    s_add_u32 s45, s44, 16384
    s_add_u32 s46, s44, 32768
    s_add_u32 s47, s44, 49152
    v_lshrrev_b32 v6, 2, v1
    v_mul_u32_u24 v13, 128, v6
    v_and_b32 v7, 3, v1
    v_lshl_add_u32 v13, v7, 3, v13
    v_add_u32 v13, 24576, v13
    v_bfe_u32 v6, v6, 1, 2
    s_mul_i32 s36, s35, 4
    s_add_u32 s36, s36, 3
    v_xor_b32 v7, s36, v6
    v_lshl_add_u32 v16, v7, 5, v13
    s_mul_i32 s36, s35, 4
    s_add_u32 s36, s36, 2
    v_xor_b32 v7, s36, v6
    v_lshl_add_u32 v15, v7, 5, v13
    s_mul_i32 s36, s35, 4
    s_add_u32 s36, s36, 1
    v_xor_b32 v7, s36, v6
    v_lshl_add_u32 v14, v7, 5, v13
    s_mul_i32 s36, s35, 4
    s_add_u32 s36, s36, 0
    v_xor_b32 v7, s36, v6
    v_lshl_add_u32 v13, v7, 5, v13
    v_pk_mov_b32 v[24:25], 0, 0
    v_pk_mov_b32 v[26:27], 0, 0
    v_pk_mov_b32 v[28:29], 0, 0
    v_pk_mov_b32 v[30:31], 0, 0
    v_pk_mov_b32 v[32:33], 0, 0
    v_pk_mov_b32 v[34:35], 0, 0
    v_pk_mov_b32 v[36:37], 0, 0
    v_pk_mov_b32 v[38:39], 0, 0
    v_pk_mov_b32 v[40:41], 0, 0
    v_pk_mov_b32 v[42:43], 0, 0
    v_pk_mov_b32 v[44:45], 0, 0
    v_pk_mov_b32 v[46:47], 0, 0
    v_pk_mov_b32 v[48:49], 0, 0
    v_pk_mov_b32 v[50:51], 0, 0
    v_pk_mov_b32 v[52:53], 0, 0
    v_pk_mov_b32 v[54:55], 0, 0
    s_mov_b32 s43, 0
    s_mul_i32 s36, s35, 256
    s_add_u32 s36, s36, 163328
    v_lshlrev_b32 v6, 4, v23
    v_add_u32 v6, s36, v6
    s_lshl_b32 s36, s37, 8
    s_add_u32 s36, s36, 160776
    v_lshlrev_b32 v7, 4, v22
    v_add_u32 v7, s36, v7
    s_add_u32 s16, s62, 0x100000
    s_addc_u32 s17, s63, 0
    s_mov_b32 s18, 0x7e000
    s_mov_b32 s19, 0x20000
    v_lshlrev_b32 v12, 11, v23
    v_lshl_add_u32 v12, v22, 4, v12
    s_lshl_b32 s39, s38, 13
    s_lshl_b32 s36, s37, 8
    s_add_u32 s39, s39, s36
    s_add_u32 s40, s39, 16384
    s_lshl_b32 s36, s29, 1
    s_lshr_b32 s53, s36, 3
    s_lshl_b32 s53, s53, 14
    s_and_b32 s41, s36, 7
    s_lshl_b32 s41, s41, 10
    s_add_u32 s41, s41, s53
    s_lshl_b32 s36, s37, 16
    s_add_u32 s41, s41, s36
    s_mov_b32 s53, 0
    s_mov_b32 s49, s44
    ds_read_b64_tr_b16 v[56:57], v13 offset:0
    ds_read_b64_tr_b16 v[58:59], v13 offset:2048
    ds_read_b64_tr_b16 v[60:61], v14 offset:0
    ds_read_b64_tr_b16 v[62:63], v14 offset:2048
    ds_read_b64_tr_b16 v[64:65], v15 offset:0
    ds_read_b64_tr_b16 v[66:67], v15 offset:2048
    ds_read_b64_tr_b16 v[68:69], v16 offset:0
    ds_read_b64_tr_b16 v[70:71], v16 offset:2048
    ds_read_b64_tr_b16 v[72:73], v13 offset:4096
    ds_read_b64_tr_b16 v[74:75], v13 offset:6144
    ds_read_b64_tr_b16 v[76:77], v14 offset:4096
    ds_read_b64_tr_b16 v[78:79], v14 offset:6144
    ds_read_b64_tr_b16 v[80:81], v15 offset:4096
    ds_read_b64_tr_b16 v[82:83], v15 offset:6144
    ds_read_b64_tr_b16 v[84:85], v16 offset:4096
    ds_read_b64_tr_b16 v[86:87], v16 offset:6144
dm_22p:
    buffer_load_dwordx4 v[164:167], v126, s[8:11], s44 offen offset:0 sc1
    buffer_load_dwordx4 v[168:171], v127, s[8:11], s44 offen offset:0 sc1
    buffer_load_dwordx4 v[172:175], v126, s[8:11], s44 offen offset:1024 sc1
    buffer_load_dwordx4 v[176:179], v127, s[8:11], s44 offen offset:1024 sc1
    buffer_load_dwordx4 v[180:183], v126, s[8:11], s44 offen offset:2048 sc1
    buffer_load_dwordx4 v[184:187], v127, s[8:11], s44 offen offset:2048 sc1
    buffer_load_dwordx4 v[188:191], v126, s[8:11], s44 offen offset:3072 sc1
    buffer_load_dwordx4 v[192:195], v127, s[8:11], s44 offen offset:3072 sc1
dm_22w:
    s_waitcnt vmcnt(4)
    v_or3_b32 v17, v164, v168, v172
    v_bitop3_b32 v17, v17, v176, 1 bitop3:0xa8
    v_cmp_ne_u32 vcc, 0, v17
    s_cbranch_vccz dm_22q
dm_22r:
    s_sleep 2
    buffer_load_dwordx4 v[164:167], v126, s[8:11], s44 offen offset:0 sc1
    buffer_load_dwordx4 v[168:171], v127, s[8:11], s44 offen offset:0 sc1
    buffer_load_dwordx4 v[172:175], v126, s[8:11], s44 offen offset:1024 sc1
    buffer_load_dwordx4 v[176:179], v127, s[8:11], s44 offen offset:1024 sc1
    buffer_load_dwordx4 v[180:183], v126, s[8:11], s44 offen offset:2048 sc1
    buffer_load_dwordx4 v[184:187], v127, s[8:11], s44 offen offset:2048 sc1
    buffer_load_dwordx4 v[188:191], v126, s[8:11], s44 offen offset:3072 sc1
    buffer_load_dwordx4 v[192:195], v127, s[8:11], s44 offen offset:3072 sc1
    s_waitcnt vmcnt(4)
    v_or3_b32 v17, v164, v168, v172
    v_bitop3_b32 v17, v17, v176, 1 bitop3:0xa8
    v_cmp_ne_u32 vcc, 0, v17
    s_cbranch_vccz dm_22t
    s_add_u32 s53, s53, 1
    s_cmp_lt_u32 s53, s61
    s_cbranch_scc1 dm_22r
    s_mov_b32 s61, 0
    s_branch dm_22t
dm_22q:
dm_22t:
    buffer_load_dwordx4 v[196:199], v128, s[8:11], s44 offen offset:0 sc1
    buffer_load_dwordx4 v[200:203], v129, s[8:11], s44 offen offset:0 sc1
    buffer_load_dwordx4 v[204:207], v128, s[8:11], s44 offen offset:1024 sc1
    buffer_load_dwordx4 v[208:211], v129, s[8:11], s44 offen offset:1024 sc1
    buffer_load_dwordx4 v[212:215], v128, s[8:11], s44 offen offset:2048 sc1
    buffer_load_dwordx4 v[216:219], v129, s[8:11], s44 offen offset:2048 sc1
    s_waitcnt lgkmcnt(0)
dm_22:
    v_mfma_f32_16x16x32_bf16 v[24:27], v[56:59], v[164:167], v[24:27]
    ds_read_b64_tr_b16 v[88:89], v13 offset:8192
    buffer_load_dwordx4 v[220:223], v128, s[8:11], s44 offen offset:3072 sc1
    v_mfma_f32_16x16x32_bf16 v[40:43], v[56:59], v[168:171], v[40:43]
    ds_read_b64_tr_b16 v[90:91], v13 offset:10240
    buffer_load_dwordx4 v[224:227], v129, s[8:11], s44 offen offset:3072 sc1
    v_mfma_f32_16x16x32_bf16 v[44:47], v[60:63], v[168:171], v[44:47]
    ds_read_b64_tr_b16 v[92:93], v14 offset:8192
    s_mov_b32 s44, s45
    v_mfma_f32_16x16x32_bf16 v[28:31], v[60:63], v[164:167], v[28:31]
    ds_read_b64_tr_b16 v[94:95], v14 offset:10240
    s_mov_b32 s45, s46
    v_mfma_f32_16x16x32_bf16 v[32:35], v[64:67], v[164:167], v[32:35]
    ds_read_b64_tr_b16 v[96:97], v15 offset:8192
    s_mov_b32 s46, s47
    v_mfma_f32_16x16x32_bf16 v[48:51], v[64:67], v[168:171], v[48:51]
    ds_read_b64_tr_b16 v[98:99], v15 offset:10240
    s_mov_b32 s47, 1048576
    v_mfma_f32_16x16x32_bf16 v[52:55], v[68:71], v[168:171], v[52:55]
    ds_read_b64_tr_b16 v[100:101], v16 offset:8192
    v_mfma_f32_16x16x32_bf16 v[36:39], v[68:71], v[164:167], v[36:39]
    ds_read_b64_tr_b16 v[102:103], v16 offset:10240
    s_waitcnt lgkmcnt(8)
    v_mfma_f32_16x16x32_bf16 v[24:27], v[72:75], v[172:175], v[24:27]
    ds_read_b64_tr_b16 v[104:105], v13 offset:12288
    buffer_load_dwordx4 v[164:167], v126, s[8:11], s44 offen offset:0 sc1
    v_mfma_f32_16x16x32_bf16 v[40:43], v[72:75], v[176:179], v[40:43]
    ds_read_b64_tr_b16 v[106:107], v13 offset:14336
    buffer_load_dwordx4 v[168:171], v127, s[8:11], s44 offen offset:0 sc1
    v_mfma_f32_16x16x32_bf16 v[44:47], v[76:79], v[176:179], v[44:47]
    ds_read_b64_tr_b16 v[108:109], v14 offset:12288
    s_waitcnt vmcnt(10)
    v_mfma_f32_16x16x32_bf16 v[28:31], v[76:79], v[172:175], v[28:31]
    ds_read_b64_tr_b16 v[110:111], v14 offset:14336
    v_or3_b32 v17, v180, v184, v188
    v_mfma_f32_16x16x32_bf16 v[32:35], v[80:83], v[172:175], v[32:35]
    ds_read_b64_tr_b16 v[112:113], v15 offset:12288
    v_bitop3_b32 v17, v17, v192, 1 bitop3:0xa8
    v_mfma_f32_16x16x32_bf16 v[48:51], v[80:83], v[176:179], v[48:51]
    ds_read_b64_tr_b16 v[114:115], v15 offset:14336
    v_cmp_ne_u32 vcc, 0, v17
    v_mfma_f32_16x16x32_bf16 v[52:55], v[84:87], v[176:179], v[52:55]
    ds_read_b64_tr_b16 v[116:117], v16 offset:12288
    ds_read_b64_tr_b16 v[118:119], v16 offset:14336
    v_mfma_f32_16x16x32_bf16 v[36:39], v[84:87], v[172:175], v[36:39]
    s_waitcnt lgkmcnt(8)
    s_cbranch_vccnz dm_22f0
dm_22g0:
    v_mfma_f32_16x16x32_bf16 v[24:27], v[88:91], v[180:183], v[24:27]
    ds_read_b64_tr_b16 v[56:57], v13 offset:16384
    buffer_load_dwordx4 v[172:175], v126, s[8:11], s44 offen offset:1024 sc1
    v_mfma_f32_16x16x32_bf16 v[40:43], v[88:91], v[184:187], v[40:43]
    ds_read_b64_tr_b16 v[58:59], v13 offset:18432
    buffer_load_dwordx4 v[176:179], v127, s[8:11], s44 offen offset:1024 sc1
    v_mfma_f32_16x16x32_bf16 v[44:47], v[92:95], v[184:187], v[44:47]
    ds_read_b64_tr_b16 v[60:61], v14 offset:16384
    v_mfma_f32_16x16x32_bf16 v[28:31], v[92:95], v[180:183], v[28:31]
    ds_read_b64_tr_b16 v[62:63], v14 offset:18432
    v_mfma_f32_16x16x32_bf16 v[32:35], v[96:99], v[180:183], v[32:35]
    ds_read_b64_tr_b16 v[64:65], v15 offset:16384
    v_mfma_f32_16x16x32_bf16 v[48:51], v[96:99], v[184:187], v[48:51]
    ds_read_b64_tr_b16 v[66:67], v15 offset:18432
    v_mfma_f32_16x16x32_bf16 v[52:55], v[100:103], v[184:187], v[52:55]
    ds_read_b64_tr_b16 v[68:69], v16 offset:16384
    v_mfma_f32_16x16x32_bf16 v[36:39], v[100:103], v[180:183], v[36:39]
    ds_read_b64_tr_b16 v[70:71], v16 offset:18432
    s_waitcnt lgkmcnt(8)
    v_mfma_f32_16x16x32_bf16 v[24:27], v[104:107], v[188:191], v[24:27]
    ds_read_b64_tr_b16 v[72:73], v13 offset:20480
    buffer_load_dwordx4 v[180:183], v126, s[8:11], s44 offen offset:2048 sc1
    v_mfma_f32_16x16x32_bf16 v[40:43], v[104:107], v[192:195], v[40:43]
    ds_read_b64_tr_b16 v[74:75], v13 offset:22528
    buffer_load_dwordx4 v[184:187], v127, s[8:11], s44 offen offset:2048 sc1
    v_mfma_f32_16x16x32_bf16 v[44:47], v[108:111], v[192:195], v[44:47]
    ds_read_b64_tr_b16 v[76:77], v14 offset:20480
    s_waitcnt vmcnt(10)
    v_mfma_f32_16x16x32_bf16 v[28:31], v[108:111], v[188:191], v[28:31]
    ds_read_b64_tr_b16 v[78:79], v14 offset:22528
    v_or3_b32 v17, v196, v200, v204
    v_mfma_f32_16x16x32_bf16 v[32:35], v[112:115], v[188:191], v[32:35]
    ds_read_b64_tr_b16 v[80:81], v15 offset:20480
    v_bitop3_b32 v17, v17, v208, 1 bitop3:0xa8
    v_mfma_f32_16x16x32_bf16 v[48:51], v[112:115], v[192:195], v[48:51]
    ds_read_b64_tr_b16 v[82:83], v15 offset:22528
    v_cmp_ne_u32 vcc, 0, v17
    v_mfma_f32_16x16x32_bf16 v[52:55], v[116:119], v[192:195], v[52:55]
    ds_read_b64_tr_b16 v[84:85], v16 offset:20480
    ds_read_b64_tr_b16 v[86:87], v16 offset:22528
    v_mfma_f32_16x16x32_bf16 v[36:39], v[116:119], v[188:191], v[36:39]
    s_waitcnt lgkmcnt(8)
    s_cbranch_vccnz dm_22f1
dm_22g1:
    v_mfma_f32_16x16x32_bf16 v[24:27], v[56:59], v[196:199], v[24:27]
    ds_read_b64_tr_b16 v[88:89], v13 offset:24576
    buffer_load_dwordx4 v[188:191], v126, s[8:11], s44 offen offset:3072 sc1
    v_mfma_f32_16x16x32_bf16 v[40:43], v[56:59], v[200:203], v[40:43]
    ds_read_b64_tr_b16 v[90:91], v13 offset:26624
    buffer_load_dwordx4 v[192:195], v127, s[8:11], s44 offen offset:3072 sc1
    v_mfma_f32_16x16x32_bf16 v[44:47], v[60:63], v[200:203], v[44:47]
    ds_read_b64_tr_b16 v[92:93], v14 offset:24576
    v_mfma_f32_16x16x32_bf16 v[28:31], v[60:63], v[196:199], v[28:31]
    ds_read_b64_tr_b16 v[94:95], v14 offset:26624
    v_mfma_f32_16x16x32_bf16 v[32:35], v[64:67], v[196:199], v[32:35]
    ds_read_b64_tr_b16 v[96:97], v15 offset:24576
    s_add_u32 s43, s43, 1
    v_mfma_f32_16x16x32_bf16 v[48:51], v[64:67], v[200:203], v[48:51]
    ds_read_b64_tr_b16 v[98:99], v15 offset:26624
    v_mfma_f32_16x16x32_bf16 v[52:55], v[68:71], v[200:203], v[52:55]
    ds_read_b64_tr_b16 v[100:101], v16 offset:24576
    v_mfma_f32_16x16x32_bf16 v[36:39], v[68:71], v[196:199], v[36:39]
    ds_read_b64_tr_b16 v[102:103], v16 offset:26624
    s_waitcnt lgkmcnt(8)
    v_mfma_f32_16x16x32_bf16 v[24:27], v[72:75], v[204:207], v[24:27]
    ds_read_b64_tr_b16 v[104:105], v13 offset:28672
    buffer_load_dwordx4 v[196:199], v128, s[8:11], s44 offen offset:0 sc1
    v_mfma_f32_16x16x32_bf16 v[40:43], v[72:75], v[208:211], v[40:43]
    ds_read_b64_tr_b16 v[106:107], v13 offset:30720
    buffer_load_dwordx4 v[200:203], v129, s[8:11], s44 offen offset:0 sc1
    v_mfma_f32_16x16x32_bf16 v[44:47], v[76:79], v[208:211], v[44:47]
    ds_read_b64_tr_b16 v[108:109], v14 offset:28672
    s_waitcnt vmcnt(10)
    v_mfma_f32_16x16x32_bf16 v[28:31], v[76:79], v[204:207], v[28:31]
    ds_read_b64_tr_b16 v[110:111], v14 offset:30720
    v_add_u32 v13, 32768, v13
    v_or3_b32 v17, v212, v216, v220
    v_mfma_f32_16x16x32_bf16 v[32:35], v[80:83], v[204:207], v[32:35]
    ds_read_b64_tr_b16 v[112:113], v15 offset:28672
    v_add_u32 v14, 32768, v14
    v_bitop3_b32 v17, v17, v224, 1 bitop3:0xa8
    v_mfma_f32_16x16x32_bf16 v[48:51], v[80:83], v[208:211], v[48:51]
    ds_read_b64_tr_b16 v[114:115], v15 offset:30720
    v_add_u32 v15, 32768, v15
    v_cmp_ne_u32 vcc, 0, v17
    v_mfma_f32_16x16x32_bf16 v[52:55], v[84:87], v[208:211], v[52:55]
    ds_read_b64_tr_b16 v[116:117], v16 offset:28672
    ds_read_b64_tr_b16 v[118:119], v16 offset:30720
    s_cmp_eq_u32 s43, 4
    v_mfma_f32_16x16x32_bf16 v[36:39], v[84:87], v[204:207], v[36:39]
    v_add_u32 v16, 32768, v16
    s_waitcnt lgkmcnt(8)
    s_cbranch_vccnz dm_22f2
dm_22g2:
    s_cbranch_scc1 dm_22x
    v_mfma_f32_16x16x32_bf16 v[24:27], v[88:91], v[212:215], v[24:27]
    ds_read_b64_tr_b16 v[56:57], v13 offset:0
    buffer_load_dwordx4 v[204:207], v128, s[8:11], s44 offen offset:1024 sc1
    v_mfma_f32_16x16x32_bf16 v[40:43], v[88:91], v[216:219], v[40:43]
    ds_read_b64_tr_b16 v[58:59], v13 offset:2048
    buffer_load_dwordx4 v[208:211], v129, s[8:11], s44 offen offset:1024 sc1
    v_mfma_f32_16x16x32_bf16 v[44:47], v[92:95], v[216:219], v[44:47]
    ds_read_b64_tr_b16 v[60:61], v14 offset:0
    s_mov_b32 s49, s44
    v_mfma_f32_16x16x32_bf16 v[28:31], v[92:95], v[212:215], v[28:31]
    ds_read_b64_tr_b16 v[62:63], v14 offset:2048
    v_mfma_f32_16x16x32_bf16 v[32:35], v[96:99], v[212:215], v[32:35]
    ds_read_b64_tr_b16 v[64:65], v15 offset:0
    v_mfma_f32_16x16x32_bf16 v[48:51], v[96:99], v[216:219], v[48:51]
    ds_read_b64_tr_b16 v[66:67], v15 offset:2048
    v_mfma_f32_16x16x32_bf16 v[52:55], v[100:103], v[216:219], v[52:55]
    ds_read_b64_tr_b16 v[68:69], v16 offset:0
    v_mfma_f32_16x16x32_bf16 v[36:39], v[100:103], v[212:215], v[36:39]
    ds_read_b64_tr_b16 v[70:71], v16 offset:2048
    s_waitcnt lgkmcnt(8)
    v_mfma_f32_16x16x32_bf16 v[24:27], v[104:107], v[220:223], v[24:27]
    ds_read_b64_tr_b16 v[72:73], v13 offset:4096
    buffer_load_dwordx4 v[212:215], v128, s[8:11], s44 offen offset:2048 sc1
    v_mfma_f32_16x16x32_bf16 v[40:43], v[104:107], v[224:227], v[40:43]
    ds_read_b64_tr_b16 v[74:75], v13 offset:6144
    buffer_load_dwordx4 v[216:219], v129, s[8:11], s44 offen offset:2048 sc1
    v_mfma_f32_16x16x32_bf16 v[44:47], v[108:111], v[224:227], v[44:47]
    ds_read_b64_tr_b16 v[76:77], v14 offset:4096
    s_waitcnt vmcnt(10)
    v_mfma_f32_16x16x32_bf16 v[28:31], v[108:111], v[220:223], v[28:31]
    ds_read_b64_tr_b16 v[78:79], v14 offset:6144
    v_or3_b32 v17, v164, v168, v172
    v_mfma_f32_16x16x32_bf16 v[32:35], v[112:115], v[220:223], v[32:35]
    ds_read_b64_tr_b16 v[80:81], v15 offset:4096
    v_bitop3_b32 v17, v17, v176, 1 bitop3:0xa8
    v_mfma_f32_16x16x32_bf16 v[48:51], v[112:115], v[224:227], v[48:51]
    ds_read_b64_tr_b16 v[82:83], v15 offset:6144
    v_cmp_ne_u32 vcc, 0, v17
    v_mfma_f32_16x16x32_bf16 v[52:55], v[116:119], v[224:227], v[52:55]
    ds_read_b64_tr_b16 v[84:85], v16 offset:4096
    ds_read_b64_tr_b16 v[86:87], v16 offset:6144
    v_mfma_f32_16x16x32_bf16 v[36:39], v[116:119], v[220:223], v[36:39]
    s_waitcnt lgkmcnt(8)
    s_cbranch_vccnz dm_22f3
dm_22g3:
    s_branch dm_22
dm_22f0:
    s_cselect_b32 s50, 1, 0
dm_22h0:
    s_sleep 2
    buffer_load_dwordx4 v[180:183], v126, s[8:11], s49 offen offset:2048 sc1
    buffer_load_dwordx4 v[184:187], v127, s[8:11], s49 offen offset:2048 sc1
    buffer_load_dwordx4 v[188:191], v126, s[8:11], s49 offen offset:3072 sc1
    buffer_load_dwordx4 v[192:195], v127, s[8:11], s49 offen offset:3072 sc1
    buffer_load_dwordx4 v[196:199], v128, s[8:11], s49 offen offset:0 sc1
    buffer_load_dwordx4 v[200:203], v129, s[8:11], s49 offen offset:0 sc1
    buffer_load_dwordx4 v[204:207], v128, s[8:11], s49 offen offset:1024 sc1
    buffer_load_dwordx4 v[208:211], v129, s[8:11], s49 offen offset:1024 sc1
    buffer_load_dwordx4 v[212:215], v128, s[8:11], s49 offen offset:2048 sc1
    buffer_load_dwordx4 v[216:219], v129, s[8:11], s49 offen offset:2048 sc1
    buffer_load_dwordx4 v[220:223], v128, s[8:11], s49 offen offset:3072 sc1
    buffer_load_dwordx4 v[224:227], v129, s[8:11], s49 offen offset:3072 sc1
    buffer_load_dwordx4 v[164:167], v126, s[8:11], s44 offen offset:0 sc1
    buffer_load_dwordx4 v[168:171], v127, s[8:11], s44 offen offset:0 sc1
    s_waitcnt vmcnt(10)
    v_or3_b32 v17, v180, v184, v188
    v_bitop3_b32 v17, v17, v192, 1 bitop3:0xa8
    v_cmp_ne_u32 vcc, 0, v17
    s_add_u32 s53, s53, 1
    s_cmp_ge_u32 s53, s61
    s_cselect_b32 s61, 0, s61
    s_cbranch_scc1 dm_22k0
    s_cbranch_vccnz dm_22h0
dm_22k0:
    s_cmp_eq_u32 s50, 1
    s_branch dm_22g0
dm_22f1:
    s_cselect_b32 s50, 1, 0
dm_22h1:
    s_sleep 2
    buffer_load_dwordx4 v[196:199], v128, s[8:11], s49 offen offset:0 sc1
    buffer_load_dwordx4 v[200:203], v129, s[8:11], s49 offen offset:0 sc1
    buffer_load_dwordx4 v[204:207], v128, s[8:11], s49 offen offset:1024 sc1
    buffer_load_dwordx4 v[208:211], v129, s[8:11], s49 offen offset:1024 sc1
    buffer_load_dwordx4 v[212:215], v128, s[8:11], s49 offen offset:2048 sc1
    buffer_load_dwordx4 v[216:219], v129, s[8:11], s49 offen offset:2048 sc1
    buffer_load_dwordx4 v[220:223], v128, s[8:11], s49 offen offset:3072 sc1
    buffer_load_dwordx4 v[224:227], v129, s[8:11], s49 offen offset:3072 sc1
    buffer_load_dwordx4 v[164:167], v126, s[8:11], s44 offen offset:0 sc1
    buffer_load_dwordx4 v[168:171], v127, s[8:11], s44 offen offset:0 sc1
    buffer_load_dwordx4 v[172:175], v126, s[8:11], s44 offen offset:1024 sc1
    buffer_load_dwordx4 v[176:179], v127, s[8:11], s44 offen offset:1024 sc1
    buffer_load_dwordx4 v[180:183], v126, s[8:11], s44 offen offset:2048 sc1
    buffer_load_dwordx4 v[184:187], v127, s[8:11], s44 offen offset:2048 sc1
    s_waitcnt vmcnt(10)
    v_or3_b32 v17, v196, v200, v204
    v_bitop3_b32 v17, v17, v208, 1 bitop3:0xa8
    v_cmp_ne_u32 vcc, 0, v17
    s_add_u32 s53, s53, 1
    s_cmp_ge_u32 s53, s61
    s_cselect_b32 s61, 0, s61
    s_cbranch_scc1 dm_22k1
    s_cbranch_vccnz dm_22h1
dm_22k1:
    s_cmp_eq_u32 s50, 1
    s_branch dm_22g1
dm_22f2:
    s_cselect_b32 s50, 1, 0
dm_22h2:
    s_sleep 2
    buffer_load_dwordx4 v[212:215], v128, s[8:11], s49 offen offset:2048 sc1
    buffer_load_dwordx4 v[216:219], v129, s[8:11], s49 offen offset:2048 sc1
    buffer_load_dwordx4 v[220:223], v128, s[8:11], s49 offen offset:3072 sc1
    buffer_load_dwordx4 v[224:227], v129, s[8:11], s49 offen offset:3072 sc1
    buffer_load_dwordx4 v[164:167], v126, s[8:11], s44 offen offset:0 sc1
    buffer_load_dwordx4 v[168:171], v127, s[8:11], s44 offen offset:0 sc1
    buffer_load_dwordx4 v[172:175], v126, s[8:11], s44 offen offset:1024 sc1
    buffer_load_dwordx4 v[176:179], v127, s[8:11], s44 offen offset:1024 sc1
    buffer_load_dwordx4 v[180:183], v126, s[8:11], s44 offen offset:2048 sc1
    buffer_load_dwordx4 v[184:187], v127, s[8:11], s44 offen offset:2048 sc1
    buffer_load_dwordx4 v[188:191], v126, s[8:11], s44 offen offset:3072 sc1
    buffer_load_dwordx4 v[192:195], v127, s[8:11], s44 offen offset:3072 sc1
    buffer_load_dwordx4 v[196:199], v128, s[8:11], s44 offen offset:0 sc1
    buffer_load_dwordx4 v[200:203], v129, s[8:11], s44 offen offset:0 sc1
    s_waitcnt vmcnt(10)
    v_or3_b32 v17, v212, v216, v220
    v_bitop3_b32 v17, v17, v224, 1 bitop3:0xa8
    v_cmp_ne_u32 vcc, 0, v17
    s_add_u32 s53, s53, 1
    s_cmp_ge_u32 s53, s61
    s_cselect_b32 s61, 0, s61
    s_cbranch_scc1 dm_22k2
    s_cbranch_vccnz dm_22h2
dm_22k2:
    s_cmp_eq_u32 s50, 1
    s_branch dm_22g2
dm_22f3:
    s_cselect_b32 s50, 1, 0
dm_22h3:
    s_sleep 2
    buffer_load_dwordx4 v[164:167], v126, s[8:11], s49 offen offset:0 sc1
    buffer_load_dwordx4 v[168:171], v127, s[8:11], s49 offen offset:0 sc1
    buffer_load_dwordx4 v[172:175], v126, s[8:11], s49 offen offset:1024 sc1
    buffer_load_dwordx4 v[176:179], v127, s[8:11], s49 offen offset:1024 sc1
    buffer_load_dwordx4 v[180:183], v126, s[8:11], s49 offen offset:2048 sc1
    buffer_load_dwordx4 v[184:187], v127, s[8:11], s49 offen offset:2048 sc1
    buffer_load_dwordx4 v[188:191], v126, s[8:11], s49 offen offset:3072 sc1
    buffer_load_dwordx4 v[192:195], v127, s[8:11], s49 offen offset:3072 sc1
    buffer_load_dwordx4 v[196:199], v128, s[8:11], s49 offen offset:0 sc1
    buffer_load_dwordx4 v[200:203], v129, s[8:11], s49 offen offset:0 sc1
    buffer_load_dwordx4 v[204:207], v128, s[8:11], s49 offen offset:1024 sc1
    buffer_load_dwordx4 v[208:211], v129, s[8:11], s49 offen offset:1024 sc1
    buffer_load_dwordx4 v[212:215], v128, s[8:11], s49 offen offset:2048 sc1
    buffer_load_dwordx4 v[216:219], v129, s[8:11], s49 offen offset:2048 sc1
    s_waitcnt vmcnt(10)
    v_or3_b32 v17, v164, v168, v172
    v_bitop3_b32 v17, v17, v176, 1 bitop3:0xa8
    v_cmp_ne_u32 vcc, 0, v17
    s_add_u32 s53, s53, 1
    s_cmp_ge_u32 s53, s61
    s_cselect_b32 s61, 0, s61
    s_cbranch_scc1 dm_22k3
    s_cbranch_vccnz dm_22h3
dm_22k3:
    s_cmp_eq_u32 s50, 1
    s_branch dm_22g3
dm_22x:
    v_mfma_f32_16x16x32_bf16 v[24:27], v[88:91], v[212:215], v[24:27]
    buffer_load_dwordx4 v[148:151], v126, s[8:11], s41 offen offset:0 sc1
    v_mfma_f32_16x16x32_bf16 v[40:43], v[88:91], v[216:219], v[40:43]
    v_mfma_f32_16x16x32_bf16 v[44:47], v[92:95], v[216:219], v[44:47]
    buffer_load_dwordx4 v[152:155], v126, s[8:11], s41 offen offset:1024 sc1
    v_mfma_f32_16x16x32_bf16 v[28:31], v[92:95], v[212:215], v[28:31]
    v_mfma_f32_16x16x32_bf16 v[32:35], v[96:99], v[212:215], v[32:35]
    buffer_load_dwordx4 v[156:159], v127, s[8:11], s41 offen offset:0 sc1
    v_mfma_f32_16x16x32_bf16 v[48:51], v[96:99], v[216:219], v[48:51]
    v_mfma_f32_16x16x32_bf16 v[52:55], v[100:103], v[216:219], v[52:55]
    buffer_load_dwordx4 v[160:163], v127, s[8:11], s41 offen offset:1024 sc1
    v_mfma_f32_16x16x32_bf16 v[36:39], v[100:103], v[212:215], v[36:39]
    s_waitcnt lgkmcnt(0)
    s_barrier
    v_mfma_f32_16x16x32_bf16 v[24:27], v[104:107], v[220:223], v[24:27]
    ds_read_b128 v[56:59], v6 offset:0
    v_mfma_f32_16x16x32_bf16 v[40:43], v[104:107], v[224:227], v[40:43]
    ds_read_b128 v[60:63], v6 offset:64
    v_mfma_f32_16x16x32_bf16 v[44:47], v[108:111], v[224:227], v[44:47]
    ds_read_b128 v[64:67], v6 offset:128
    v_mfma_f32_16x16x32_bf16 v[28:31], v[108:111], v[220:223], v[28:31]
    ds_read_b128 v[68:71], v6 offset:192
    v_mfma_f32_16x16x32_bf16 v[32:35], v[112:115], v[220:223], v[32:35]
    ds_read_b64 v[72:73], v7 offset:0
    v_mfma_f32_16x16x32_bf16 v[48:51], v[112:115], v[224:227], v[48:51]
    ds_read_b64 v[74:75], v7 offset:256
    v_mfma_f32_16x16x32_bf16 v[52:55], v[116:119], v[224:227], v[52:55]
    v_mfma_f32_16x16x32_bf16 v[36:39], v[116:119], v[220:223], v[36:39]
    s_waitcnt lgkmcnt(0)
    v_mul_f32 v134, 0xc0135761, v73
    v_mul_f32 v135, v73, v73
    v_mul_f32 v135, v135, v134
    v_mul_f32 v135, 0x3d372713, v135
    v_rcp_f32 v73, v73
    v_mul_f32 v136, 0xc0135761, v75
    v_mul_f32 v137, v75, v75
    v_mul_f32 v137, v137, v136
    v_mul_f32 v137, 0x3d372713, v137
    v_rcp_f32 v75, v75
    v_pk_fma_f32 v[24:25], v[72:73], v[56:57], v[24:25] op_sel_hi:[0,1,1] neg_lo:[1,0,0] neg_hi:[1,0,0]
    v_pk_fma_f32 v[26:27], v[72:73], v[58:59], v[26:27] op_sel_hi:[0,1,1] neg_lo:[1,0,0] neg_hi:[1,0,0]
    v_pk_mul_f32 v[122:123], v[24:25], v[24:25]
    v_pk_mul_f32 v[124:125], v[26:27], v[26:27]
    v_pk_fma_f32 v[122:123], v[122:123], v[134:135], v[134:135] op_sel:[0,1,0] op_sel_hi:[1,1,0]
    v_pk_fma_f32 v[124:125], v[124:125], v[134:135], v[134:135] op_sel:[0,1,0] op_sel_hi:[1,1,0]
    v_pk_mul_f32 v[122:123], v[122:123], v[24:25]
    v_pk_mul_f32 v[124:125], v[124:125], v[26:27]
    v_exp_f32 v122, v122
    v_exp_f32 v123, v123
    v_exp_f32 v124, v124
    v_exp_f32 v125, v125
    v_pk_fma_f32 v[122:123], v[122:123], v[72:73], v[72:73] op_sel:[0,1,1] op_sel_hi:[1,1,1]
    v_pk_fma_f32 v[124:125], v[124:125], v[72:73], v[72:73] op_sel:[0,1,1] op_sel_hi:[1,1,1]
    v_rcp_f32 v122, v122
    v_rcp_f32 v123, v123
    v_rcp_f32 v124, v124
    v_rcp_f32 v125, v125
    v_pk_mul_f32 v[24:25], v[24:25], v[122:123]
    v_pk_mul_f32 v[26:27], v[26:27], v[124:125]
    v_pk_fma_f32 v[28:29], v[72:73], v[60:61], v[28:29] op_sel_hi:[0,1,1] neg_lo:[1,0,0] neg_hi:[1,0,0]
    v_pk_fma_f32 v[30:31], v[72:73], v[62:63], v[30:31] op_sel_hi:[0,1,1] neg_lo:[1,0,0] neg_hi:[1,0,0]
    v_pk_mul_f32 v[122:123], v[28:29], v[28:29]
    v_pk_mul_f32 v[124:125], v[30:31], v[30:31]
    v_pk_fma_f32 v[122:123], v[122:123], v[134:135], v[134:135] op_sel:[0,1,0] op_sel_hi:[1,1,0]
    v_pk_fma_f32 v[124:125], v[124:125], v[134:135], v[134:135] op_sel:[0,1,0] op_sel_hi:[1,1,0]
    v_pk_mul_f32 v[122:123], v[122:123], v[28:29]
    v_pk_mul_f32 v[124:125], v[124:125], v[30:31]
    v_exp_f32 v122, v122
    v_exp_f32 v123, v123
    v_exp_f32 v124, v124
    v_exp_f32 v125, v125
    v_pk_fma_f32 v[122:123], v[122:123], v[72:73], v[72:73] op_sel:[0,1,1] op_sel_hi:[1,1,1]
    v_pk_fma_f32 v[124:125], v[124:125], v[72:73], v[72:73] op_sel:[0,1,1] op_sel_hi:[1,1,1]
    v_rcp_f32 v122, v122
    v_rcp_f32 v123, v123
    v_rcp_f32 v124, v124
    v_rcp_f32 v125, v125
    v_pk_mul_f32 v[28:29], v[28:29], v[122:123]
    v_pk_mul_f32 v[30:31], v[30:31], v[124:125]
    v_cvt_pk_bf16_f32 v24, v24, v25
    v_cvt_pk_bf16_f32 v25, v26, v27
    v_cvt_pk_bf16_f32 v26, v28, v29
    v_cvt_pk_bf16_f32 v27, v30, v31
    v_and_b32 v24, -2, v24
    buffer_store_dwordx4 v[24:27], v12, s[16:19], s39 offen offset:0 sc1
    v_pk_fma_f32 v[40:41], v[74:75], v[56:57], v[40:41] op_sel_hi:[0,1,1] neg_lo:[1,0,0] neg_hi:[1,0,0]
    v_pk_fma_f32 v[42:43], v[74:75], v[58:59], v[42:43] op_sel_hi:[0,1,1] neg_lo:[1,0,0] neg_hi:[1,0,0]
    v_pk_mul_f32 v[122:123], v[40:41], v[40:41]
    v_pk_mul_f32 v[124:125], v[42:43], v[42:43]
    v_pk_fma_f32 v[122:123], v[122:123], v[136:137], v[136:137] op_sel:[0,1,0] op_sel_hi:[1,1,0]
    v_pk_fma_f32 v[124:125], v[124:125], v[136:137], v[136:137] op_sel:[0,1,0] op_sel_hi:[1,1,0]
    v_pk_mul_f32 v[122:123], v[122:123], v[40:41]
    v_pk_mul_f32 v[124:125], v[124:125], v[42:43]
    v_exp_f32 v122, v122
    v_exp_f32 v123, v123
    v_exp_f32 v124, v124
    v_exp_f32 v125, v125
    v_pk_fma_f32 v[122:123], v[122:123], v[74:75], v[74:75] op_sel:[0,1,1] op_sel_hi:[1,1,1]
    v_pk_fma_f32 v[124:125], v[124:125], v[74:75], v[74:75] op_sel:[0,1,1] op_sel_hi:[1,1,1]
    v_rcp_f32 v122, v122
    v_rcp_f32 v123, v123
    v_rcp_f32 v124, v124
    v_rcp_f32 v125, v125
    v_pk_mul_f32 v[40:41], v[40:41], v[122:123]
    v_pk_mul_f32 v[42:43], v[42:43], v[124:125]
    v_pk_fma_f32 v[44:45], v[74:75], v[60:61], v[44:45] op_sel_hi:[0,1,1] neg_lo:[1,0,0] neg_hi:[1,0,0]
    v_pk_fma_f32 v[46:47], v[74:75], v[62:63], v[46:47] op_sel_hi:[0,1,1] neg_lo:[1,0,0] neg_hi:[1,0,0]
    v_pk_mul_f32 v[122:123], v[44:45], v[44:45]
    v_pk_mul_f32 v[124:125], v[46:47], v[46:47]
    v_pk_fma_f32 v[122:123], v[122:123], v[136:137], v[136:137] op_sel:[0,1,0] op_sel_hi:[1,1,0]
    v_pk_fma_f32 v[124:125], v[124:125], v[136:137], v[136:137] op_sel:[0,1,0] op_sel_hi:[1,1,0]
    v_pk_mul_f32 v[122:123], v[122:123], v[44:45]
    v_pk_mul_f32 v[124:125], v[124:125], v[46:47]
    v_exp_f32 v122, v122
    v_exp_f32 v123, v123
    v_exp_f32 v124, v124
    v_exp_f32 v125, v125
    v_pk_fma_f32 v[122:123], v[122:123], v[74:75], v[74:75] op_sel:[0,1,1] op_sel_hi:[1,1,1]
    v_pk_fma_f32 v[124:125], v[124:125], v[74:75], v[74:75] op_sel:[0,1,1] op_sel_hi:[1,1,1]
    v_rcp_f32 v122, v122
    v_rcp_f32 v123, v123
    v_rcp_f32 v124, v124
    v_rcp_f32 v125, v125
    v_pk_mul_f32 v[44:45], v[44:45], v[122:123]
    v_pk_mul_f32 v[46:47], v[46:47], v[124:125]
    v_cvt_pk_bf16_f32 v40, v40, v41
    v_cvt_pk_bf16_f32 v41, v42, v43
    v_cvt_pk_bf16_f32 v42, v44, v45
    v_cvt_pk_bf16_f32 v43, v46, v47
    v_and_b32 v40, -2, v40
    buffer_store_dwordx4 v[40:43], v12, s[16:19], s39 offen offset:256 sc1
    v_pk_fma_f32 v[32:33], v[72:73], v[64:65], v[32:33] op_sel_hi:[0,1,1] neg_lo:[1,0,0] neg_hi:[1,0,0]
    v_pk_fma_f32 v[34:35], v[72:73], v[66:67], v[34:35] op_sel_hi:[0,1,1] neg_lo:[1,0,0] neg_hi:[1,0,0]
    v_pk_mul_f32 v[122:123], v[32:33], v[32:33]
    v_pk_mul_f32 v[124:125], v[34:35], v[34:35]
    v_pk_fma_f32 v[122:123], v[122:123], v[134:135], v[134:135] op_sel:[0,1,0] op_sel_hi:[1,1,0]
    v_pk_fma_f32 v[124:125], v[124:125], v[134:135], v[134:135] op_sel:[0,1,0] op_sel_hi:[1,1,0]
    v_pk_mul_f32 v[122:123], v[122:123], v[32:33]
    v_pk_mul_f32 v[124:125], v[124:125], v[34:35]
    v_exp_f32 v122, v122
    v_exp_f32 v123, v123
    v_exp_f32 v124, v124
    v_exp_f32 v125, v125
    v_pk_fma_f32 v[122:123], v[122:123], v[72:73], v[72:73] op_sel:[0,1,1] op_sel_hi:[1,1,1]
    v_pk_fma_f32 v[124:125], v[124:125], v[72:73], v[72:73] op_sel:[0,1,1] op_sel_hi:[1,1,1]
    v_rcp_f32 v122, v122
    v_rcp_f32 v123, v123
    v_rcp_f32 v124, v124
    v_rcp_f32 v125, v125
    v_pk_mul_f32 v[32:33], v[32:33], v[122:123]
    v_pk_mul_f32 v[34:35], v[34:35], v[124:125]
    v_pk_fma_f32 v[36:37], v[72:73], v[68:69], v[36:37] op_sel_hi:[0,1,1] neg_lo:[1,0,0] neg_hi:[1,0,0]
    v_pk_fma_f32 v[38:39], v[72:73], v[70:71], v[38:39] op_sel_hi:[0,1,1] neg_lo:[1,0,0] neg_hi:[1,0,0]
    v_pk_mul_f32 v[122:123], v[36:37], v[36:37]
    v_pk_mul_f32 v[124:125], v[38:39], v[38:39]
    v_pk_fma_f32 v[122:123], v[122:123], v[134:135], v[134:135] op_sel:[0,1,0] op_sel_hi:[1,1,0]
    v_pk_fma_f32 v[124:125], v[124:125], v[134:135], v[134:135] op_sel:[0,1,0] op_sel_hi:[1,1,0]
    v_pk_mul_f32 v[122:123], v[122:123], v[36:37]
    v_pk_mul_f32 v[124:125], v[124:125], v[38:39]
    v_exp_f32 v122, v122
    v_exp_f32 v123, v123
    v_exp_f32 v124, v124
    v_exp_f32 v125, v125
    v_pk_fma_f32 v[122:123], v[122:123], v[72:73], v[72:73] op_sel:[0,1,1] op_sel_hi:[1,1,1]
    v_pk_fma_f32 v[124:125], v[124:125], v[72:73], v[72:73] op_sel:[0,1,1] op_sel_hi:[1,1,1]
    v_rcp_f32 v122, v122
    v_rcp_f32 v123, v123
    v_rcp_f32 v124, v124
    v_rcp_f32 v125, v125
    v_pk_mul_f32 v[36:37], v[36:37], v[122:123]
    v_pk_mul_f32 v[38:39], v[38:39], v[124:125]
    v_cvt_pk_bf16_f32 v32, v32, v33
    v_cvt_pk_bf16_f32 v33, v34, v35
    v_cvt_pk_bf16_f32 v34, v36, v37
    v_cvt_pk_bf16_f32 v35, v38, v39
    v_and_b32 v32, -2, v32
    buffer_store_dwordx4 v[32:35], v12, s[16:19], s40 offen offset:0 sc1
    v_pk_fma_f32 v[48:49], v[74:75], v[64:65], v[48:49] op_sel_hi:[0,1,1] neg_lo:[1,0,0] neg_hi:[1,0,0]
    v_pk_fma_f32 v[50:51], v[74:75], v[66:67], v[50:51] op_sel_hi:[0,1,1] neg_lo:[1,0,0] neg_hi:[1,0,0]
    v_pk_mul_f32 v[122:123], v[48:49], v[48:49]
    v_pk_mul_f32 v[124:125], v[50:51], v[50:51]
    v_pk_fma_f32 v[122:123], v[122:123], v[136:137], v[136:137] op_sel:[0,1,0] op_sel_hi:[1,1,0]
    v_pk_fma_f32 v[124:125], v[124:125], v[136:137], v[136:137] op_sel:[0,1,0] op_sel_hi:[1,1,0]
    v_pk_mul_f32 v[122:123], v[122:123], v[48:49]
    v_pk_mul_f32 v[124:125], v[124:125], v[50:51]
    v_exp_f32 v122, v122
    v_exp_f32 v123, v123
    v_exp_f32 v124, v124
    v_exp_f32 v125, v125
    v_pk_fma_f32 v[122:123], v[122:123], v[74:75], v[74:75] op_sel:[0,1,1] op_sel_hi:[1,1,1]
    v_pk_fma_f32 v[124:125], v[124:125], v[74:75], v[74:75] op_sel:[0,1,1] op_sel_hi:[1,1,1]
    v_rcp_f32 v122, v122
    v_rcp_f32 v123, v123
    v_rcp_f32 v124, v124
    v_rcp_f32 v125, v125
    v_pk_mul_f32 v[48:49], v[48:49], v[122:123]
    v_pk_mul_f32 v[50:51], v[50:51], v[124:125]
    v_pk_fma_f32 v[52:53], v[74:75], v[68:69], v[52:53] op_sel_hi:[0,1,1] neg_lo:[1,0,0] neg_hi:[1,0,0]
    v_pk_fma_f32 v[54:55], v[74:75], v[70:71], v[54:55] op_sel_hi:[0,1,1] neg_lo:[1,0,0] neg_hi:[1,0,0]
    v_pk_mul_f32 v[122:123], v[52:53], v[52:53]
    v_pk_mul_f32 v[124:125], v[54:55], v[54:55]
    v_pk_fma_f32 v[122:123], v[122:123], v[136:137], v[136:137] op_sel:[0,1,0] op_sel_hi:[1,1,0]
    v_pk_fma_f32 v[124:125], v[124:125], v[136:137], v[136:137] op_sel:[0,1,0] op_sel_hi:[1,1,0]
    v_pk_mul_f32 v[122:123], v[122:123], v[52:53]
    v_pk_mul_f32 v[124:125], v[124:125], v[54:55]
    v_exp_f32 v122, v122
    v_exp_f32 v123, v123
    v_exp_f32 v124, v124
    v_exp_f32 v125, v125
    v_pk_fma_f32 v[122:123], v[122:123], v[74:75], v[74:75] op_sel:[0,1,1] op_sel_hi:[1,1,1]
    v_pk_fma_f32 v[124:125], v[124:125], v[74:75], v[74:75] op_sel:[0,1,1] op_sel_hi:[1,1,1]
    v_rcp_f32 v122, v122
    v_rcp_f32 v123, v123
    v_rcp_f32 v124, v124
    v_rcp_f32 v125, v125
    v_pk_mul_f32 v[52:53], v[52:53], v[122:123]
    v_pk_mul_f32 v[54:55], v[54:55], v[124:125]
    v_cvt_pk_bf16_f32 v48, v48, v49
    v_cvt_pk_bf16_f32 v49, v50, v51
    v_cvt_pk_bf16_f32 v50, v52, v53
    v_cvt_pk_bf16_f32 v51, v54, v55
    v_and_b32 v48, -2, v48
    buffer_store_dwordx4 v[48:51], v12, s[16:19], s40 offen offset:256 sc1
    s_add_u32 s8, s4, 0x2100000
    s_addc_u32 s9, s5, 0
    s_mov_b32 s10, 0x8400000
    s_mov_b32 s11, 0x20000
    s_sub_u32 s47, s55, 39583744
    s_lshl_b32 s46, s30, 9
    s_add_u32 s47, s47, s46
    s_add_u32 s45, s92, 2048
    s_cmp_eq_u32 s28, 0
    s_cselect_b32 s45, 1073741824, s45
    s_cmp_eq_u32 s30, 0
    s_cselect_b32 s45, s45, 0
    s_add_u32 s53, s47, 0xfffffff0
    v_add_u32 v126, s53, v12
    v_add_u32 v127, 256, v126
    v_add_u32 v134, s45, v126
    v_cmp_gt_u32 vcc, 1, v22
    s_nop 1
    v_cndmask_b32 v126, v126, v134, vcc
    s_mov_b32 s34, s30
    s_mov_b32 s35, 0
    v_and_b32 v22, 15, v1
    v_lshrrev_b32 v23, 4, v1
    s_mul_i32 s37, s34, 2
    s_mul_i32 s38, s29, 4
    s_mul_i32 s36, s35, 4
    s_add_u32 s38, s38, s36
    s_lshr_b32 s36, s38, 1
    s_lshr_b32 s53, s36, 3
    s_lshl_b32 s53, s53, 14
    s_and_b32 s39, s36, 7
    s_lshl_b32 s39, s39, 10
    s_add_u32 s39, s39, s53
    s_lshl_b32 s36, s37, 16
    s_add_u32 s39, s39, s36
    s_sub_u32 s46, s93, 2048
    s_cmp_eq_u32 s28, 15
    s_cselect_b32 s46, 1073741824, s46
    s_cmp_eq_u32 s30, 3
    s_cselect_b32 s46, s46, 0
    s_add_u32 s53, s47, 0x10
    v_add_u32 v128, s53, v12
    v_add_u32 v129, 256, v128
    v_add_u32 v134, s46, v129
    v_cmp_le_u32 vcc, 15, v22
    s_nop 1
    v_cndmask_b32 v129, v129, v134, vcc
    s_add_u32 s53, s47, 0xffffffe0
    v_add_u32 v130, s53, v12
    v_add_u32 v131, 256, v130
    v_add_u32 v134, s45, v130
    v_cmp_gt_u32 vcc, 2, v22
    s_nop 1
    v_cndmask_b32 v130, v130, v134, vcc
    s_add_u32 s53, s47, 0x20
    v_add_u32 v132, s53, v12
    v_add_u32 v133, 256, v132
    v_add_u32 v134, s46, v133
    v_cmp_le_u32 vcc, 14, v22
    s_nop 1
    v_cndmask_b32 v133, v133, v134, vcc
    v_mov_b32 v134, v126
    v_mov_b32 v135, v127
    v_lshrrev_b32 v6, 2, v1
    v_mul_u32_u24 v13, 128, v6
    v_and_b32 v7, 3, v1
    v_lshl_add_u32 v13, v7, 3, v13
    v_add_u32 v13, 0, v13
    v_bfe_u32 v6, v6, 1, 2
    s_mul_i32 s36, s35, 4
    s_add_u32 s36, s36, 3
    v_xor_b32 v7, s36, v6
    v_lshl_add_u32 v16, v7, 5, v13
    s_mul_i32 s36, s35, 4
    s_add_u32 s36, s36, 2
    v_xor_b32 v7, s36, v6
    v_lshl_add_u32 v15, v7, 5, v13
    s_mul_i32 s36, s35, 4
    s_add_u32 s36, s36, 1
    v_xor_b32 v7, s36, v6
    v_lshl_add_u32 v14, v7, 5, v13
    s_mul_i32 s36, s35, 4
    s_add_u32 s36, s36, 0
    v_xor_b32 v7, s36, v6
    v_lshl_add_u32 v13, v7, 5, v13
    s_lshl_b32 s36, s37, 8
    s_add_u32 s36, s36, 160768
    v_lshlrev_b32 v7, 4, v22
    v_add_u32 v7, s36, v7
    ds_read_b64 v[56:57], v7 offset:0
    ds_read_b64 v[58:59], v7 offset:256
    s_waitcnt vmcnt(4) lgkmcnt(0)
    s_sleep 6
    s_cmp_lg_u32 s60, 0
    s_cbranch_scc1 G2_nd
    s_sleep 2
G2_nd:
    s_mov_b32 s44, 0
    buffer_load_dwordx4 v[164:167], v126, s[8:11], s44 offen sc1
    buffer_load_dwordx4 v[168:171], v127, s[8:11], s44 offen sc1
    s_add_u32 s44, s44, 16384
    buffer_load_dwordx4 v[172:175], v126, s[8:11], s44 offen sc1
    buffer_load_dwordx4 v[176:179], v127, s[8:11], s44 offen sc1
    s_add_u32 s44, s44, 16384
    buffer_load_dwordx4 v[180:183], v126, s[8:11], s44 offen
    buffer_load_dwordx4 v[184:187], v127, s[8:11], s44 offen
    s_add_u32 s44, s44, 16384
    buffer_load_dwordx4 v[188:191], v126, s[8:11], s44 offen
    buffer_load_dwordx4 v[192:195], v127, s[8:11], s44 offen
    s_add_u32 s44, s44, 16384
    v_lshlrev_b32 v24, 16, v148
    v_and_b32 v25, 0xffff0000, v148
    v_pk_add_f32 v[24:25], v[24:25], v[56:57] op_sel_hi:[1,0] neg_lo:[0,1] neg_hi:[0,1]
    v_pk_mul_f32 v[24:25], v[24:25], v[56:57] op_sel:[0,1] op_sel_hi:[1,1]
    v_lshlrev_b32 v26, 16, v149
    v_and_b32 v27, 0xffff0000, v149
    v_pk_add_f32 v[26:27], v[26:27], v[56:57] op_sel_hi:[1,0] neg_lo:[0,1] neg_hi:[0,1]
    v_pk_mul_f32 v[26:27], v[26:27], v[56:57] op_sel:[0,1] op_sel_hi:[1,1]
    v_lshlrev_b32 v28, 16, v150
    v_and_b32 v29, 0xffff0000, v150
    v_pk_add_f32 v[28:29], v[28:29], v[56:57] op_sel_hi:[1,0] neg_lo:[0,1] neg_hi:[0,1]
    v_pk_mul_f32 v[28:29], v[28:29], v[56:57] op_sel:[0,1] op_sel_hi:[1,1]
    v_lshlrev_b32 v30, 16, v151
    v_and_b32 v31, 0xffff0000, v151
    v_pk_add_f32 v[30:31], v[30:31], v[56:57] op_sel_hi:[1,0] neg_lo:[0,1] neg_hi:[0,1]
    v_pk_mul_f32 v[30:31], v[30:31], v[56:57] op_sel:[0,1] op_sel_hi:[1,1]
    v_lshlrev_b32 v32, 16, v152
    v_and_b32 v33, 0xffff0000, v152
    v_pk_add_f32 v[32:33], v[32:33], v[56:57] op_sel_hi:[1,0] neg_lo:[0,1] neg_hi:[0,1]
    v_pk_mul_f32 v[32:33], v[32:33], v[56:57] op_sel:[0,1] op_sel_hi:[1,1]
    v_lshlrev_b32 v34, 16, v153
    v_and_b32 v35, 0xffff0000, v153
    v_pk_add_f32 v[34:35], v[34:35], v[56:57] op_sel_hi:[1,0] neg_lo:[0,1] neg_hi:[0,1]
    v_pk_mul_f32 v[34:35], v[34:35], v[56:57] op_sel:[0,1] op_sel_hi:[1,1]
    v_lshlrev_b32 v36, 16, v154
    v_and_b32 v37, 0xffff0000, v154
    v_pk_add_f32 v[36:37], v[36:37], v[56:57] op_sel_hi:[1,0] neg_lo:[0,1] neg_hi:[0,1]
    v_pk_mul_f32 v[36:37], v[36:37], v[56:57] op_sel:[0,1] op_sel_hi:[1,1]
    v_lshlrev_b32 v38, 16, v155
    v_and_b32 v39, 0xffff0000, v155
    v_pk_add_f32 v[38:39], v[38:39], v[56:57] op_sel_hi:[1,0] neg_lo:[0,1] neg_hi:[0,1]
    v_pk_mul_f32 v[38:39], v[38:39], v[56:57] op_sel:[0,1] op_sel_hi:[1,1]
    v_lshlrev_b32 v40, 16, v156
    v_and_b32 v41, 0xffff0000, v156
    v_pk_add_f32 v[40:41], v[40:41], v[58:59] op_sel_hi:[1,0] neg_lo:[0,1] neg_hi:[0,1]
    v_pk_mul_f32 v[40:41], v[40:41], v[58:59] op_sel:[0,1] op_sel_hi:[1,1]
    v_lshlrev_b32 v42, 16, v157
    v_and_b32 v43, 0xffff0000, v157
    v_pk_add_f32 v[42:43], v[42:43], v[58:59] op_sel_hi:[1,0] neg_lo:[0,1] neg_hi:[0,1]
    v_pk_mul_f32 v[42:43], v[42:43], v[58:59] op_sel:[0,1] op_sel_hi:[1,1]
    v_lshlrev_b32 v44, 16, v158
    v_and_b32 v45, 0xffff0000, v158
    v_pk_add_f32 v[44:45], v[44:45], v[58:59] op_sel_hi:[1,0] neg_lo:[0,1] neg_hi:[0,1]
    v_pk_mul_f32 v[44:45], v[44:45], v[58:59] op_sel:[0,1] op_sel_hi:[1,1]
    v_lshlrev_b32 v46, 16, v159
    v_and_b32 v47, 0xffff0000, v159
    v_pk_add_f32 v[46:47], v[46:47], v[58:59] op_sel_hi:[1,0] neg_lo:[0,1] neg_hi:[0,1]
    v_pk_mul_f32 v[46:47], v[46:47], v[58:59] op_sel:[0,1] op_sel_hi:[1,1]
    v_lshlrev_b32 v48, 16, v160
    v_and_b32 v49, 0xffff0000, v160
    v_pk_add_f32 v[48:49], v[48:49], v[58:59] op_sel_hi:[1,0] neg_lo:[0,1] neg_hi:[0,1]
    v_pk_mul_f32 v[48:49], v[48:49], v[58:59] op_sel:[0,1] op_sel_hi:[1,1]
    v_lshlrev_b32 v50, 16, v161
    v_and_b32 v51, 0xffff0000, v161
    v_pk_add_f32 v[50:51], v[50:51], v[58:59] op_sel_hi:[1,0] neg_lo:[0,1] neg_hi:[0,1]
    v_pk_mul_f32 v[50:51], v[50:51], v[58:59] op_sel:[0,1] op_sel_hi:[1,1]
    v_lshlrev_b32 v52, 16, v162
    v_and_b32 v53, 0xffff0000, v162
    v_pk_add_f32 v[52:53], v[52:53], v[58:59] op_sel_hi:[1,0] neg_lo:[0,1] neg_hi:[0,1]
    v_pk_mul_f32 v[52:53], v[52:53], v[58:59] op_sel:[0,1] op_sel_hi:[1,1]
    v_lshlrev_b32 v54, 16, v163
    v_and_b32 v55, 0xffff0000, v163
    v_pk_add_f32 v[54:55], v[54:55], v[58:59] op_sel_hi:[1,0] neg_lo:[0,1] neg_hi:[0,1]
    v_pk_mul_f32 v[54:55], v[54:55], v[58:59] op_sel:[0,1] op_sel_hi:[1,1]
    s_mov_b32 s43, 0
    s_add_u32 s16, s62, 0x80000
    s_addc_u32 s17, s63, 0
    s_mov_b32 s18, 0x7e000
    s_mov_b32 s19, 0x20000
    s_mov_b32 s53, 0
    s_mov_b32 s49, s44
    s_barrier
    ds_read_b64_tr_b16 v[56:57], v13 offset:0
    ds_read_b64_tr_b16 v[58:59], v13 offset:2048
    ds_read_b64_tr_b16 v[60:61], v14 offset:0
    ds_read_b64_tr_b16 v[62:63], v14 offset:2048
    ds_read_b64_tr_b16 v[64:65], v15 offset:0
    ds_read_b64_tr_b16 v[66:67], v15 offset:2048
    ds_read_b64_tr_b16 v[68:69], v16 offset:0
    ds_read_b64_tr_b16 v[70:71], v16 offset:2048
    ds_read_b64_tr_b16 v[72:73], v13 offset:4096
    ds_read_b64_tr_b16 v[74:75], v13 offset:6144
    ds_read_b64_tr_b16 v[76:77], v14 offset:4096
    ds_read_b64_tr_b16 v[78:79], v14 offset:6144
    ds_read_b64_tr_b16 v[80:81], v15 offset:4096
    ds_read_b64_tr_b16 v[82:83], v15 offset:6144
    ds_read_b64_tr_b16 v[84:85], v16 offset:4096
    ds_read_b64_tr_b16 v[86:87], v16 offset:6144
    s_branch dm_23w
dm_23p:
    s_mov_b32 s44, 0
    buffer_load_dwordx4 v[164:167], v126, s[8:11], s44 offen sc1
    buffer_load_dwordx4 v[168:171], v127, s[8:11], s44 offen sc1
    s_add_u32 s44, s44, 16384
    buffer_load_dwordx4 v[172:175], v126, s[8:11], s44 offen sc1
    buffer_load_dwordx4 v[176:179], v127, s[8:11], s44 offen sc1
    s_add_u32 s44, s44, 16384
    buffer_load_dwordx4 v[180:183], v126, s[8:11], s44 offen
    buffer_load_dwordx4 v[184:187], v127, s[8:11], s44 offen
    s_add_u32 s44, s44, 16384
    buffer_load_dwordx4 v[188:191], v126, s[8:11], s44 offen
    buffer_load_dwordx4 v[192:195], v127, s[8:11], s44 offen
    s_add_u32 s44, s44, 16384
dm_23w:
    s_waitcnt vmcnt(4)
    v_or3_b32 v17, v164, v168, v172
    v_bitop3_b32 v17, v17, v176, 1 bitop3:0xa8
    v_cmp_ne_u32 vcc, 0, v17
    s_cbranch_vccz dm_23q
dm_23r:
    s_sleep 2
    s_mov_b32 s44, 0
    buffer_load_dwordx4 v[164:167], v126, s[8:11], s44 offen sc1
    buffer_load_dwordx4 v[168:171], v127, s[8:11], s44 offen sc1
    s_add_u32 s44, s44, 16384
    buffer_load_dwordx4 v[172:175], v126, s[8:11], s44 offen sc1
    buffer_load_dwordx4 v[176:179], v127, s[8:11], s44 offen sc1
    s_add_u32 s44, s44, 16384
    buffer_load_dwordx4 v[180:183], v126, s[8:11], s44 offen sc1
    buffer_load_dwordx4 v[184:187], v127, s[8:11], s44 offen sc1
    s_add_u32 s44, s44, 16384
    buffer_load_dwordx4 v[188:191], v126, s[8:11], s44 offen sc1
    buffer_load_dwordx4 v[192:195], v127, s[8:11], s44 offen sc1
    s_add_u32 s44, s44, 16384
    s_waitcnt vmcnt(4)
    v_or3_b32 v17, v164, v168, v172
    v_bitop3_b32 v17, v17, v176, 1 bitop3:0xa8
    v_cmp_ne_u32 vcc, 0, v17
    s_cbranch_vccz dm_23t
    s_add_u32 s53, s53, 1
    s_cmp_lt_u32 s53, s61
    s_cbranch_scc1 dm_23r
    s_mov_b32 s61, 0
    s_branch dm_23t
dm_23q:
dm_23t:
    buffer_load_dwordx4 v[196:199], v126, s[8:11], s44 offen
    buffer_load_dwordx4 v[200:203], v127, s[8:11], s44 offen
    s_add_u32 s44, s44, 16384
    buffer_load_dwordx4 v[204:207], v126, s[8:11], s44 offen
    buffer_load_dwordx4 v[208:211], v127, s[8:11], s44 offen
    s_add_u32 s44, s44, 16384
    buffer_load_dwordx4 v[212:215], v126, s[8:11], s44 offen
    buffer_load_dwordx4 v[216:219], v127, s[8:11], s44 offen
    s_add_u32 s44, s44, 16384
    s_waitcnt lgkmcnt(0)
dm_23:
    v_mfma_f32_16x16x32_bf16 v[24:27], v[56:59], v[164:167], v[24:27]
    ds_read_b64_tr_b16 v[88:89], v13 offset:8192
    buffer_load_dwordx4 v[220:223], v126, s[8:11], s44 offen
    v_mfma_f32_16x16x32_bf16 v[40:43], v[56:59], v[168:171], v[40:43]
    ds_read_b64_tr_b16 v[90:91], v13 offset:10240
    buffer_load_dwordx4 v[224:227], v127, s[8:11], s44 offen
    v_mfma_f32_16x16x32_bf16 v[44:47], v[60:63], v[168:171], v[44:47]
    ds_read_b64_tr_b16 v[92:93], v14 offset:8192
    s_add_u32 s44, s44, 16384
    v_mfma_f32_16x16x32_bf16 v[28:31], v[60:63], v[164:167], v[28:31]
    ds_read_b64_tr_b16 v[94:95], v14 offset:10240
    v_mov_b32 v126, v128
    v_mfma_f32_16x16x32_bf16 v[32:35], v[64:67], v[164:167], v[32:35]
    ds_read_b64_tr_b16 v[96:97], v15 offset:8192
    v_mov_b32 v127, v129
    v_mfma_f32_16x16x32_bf16 v[48:51], v[64:67], v[168:171], v[48:51]
    ds_read_b64_tr_b16 v[98:99], v15 offset:10240
    v_mov_b32 v128, v130
    v_mfma_f32_16x16x32_bf16 v[52:55], v[68:71], v[168:171], v[52:55]
    ds_read_b64_tr_b16 v[100:101], v16 offset:8192
    v_mov_b32 v129, v131
    v_mfma_f32_16x16x32_bf16 v[36:39], v[68:71], v[164:167], v[36:39]
    ds_read_b64_tr_b16 v[102:103], v16 offset:10240
    s_waitcnt lgkmcnt(8)
    v_mfma_f32_16x16x32_bf16 v[24:27], v[72:75], v[172:175], v[24:27]
    ds_read_b64_tr_b16 v[104:105], v13 offset:12288
    buffer_load_dwordx4 v[164:167], v126, s[8:11], s44 offen
    v_mfma_f32_16x16x32_bf16 v[40:43], v[72:75], v[176:179], v[40:43]
    ds_read_b64_tr_b16 v[106:107], v13 offset:14336
    buffer_load_dwordx4 v[168:171], v127, s[8:11], s44 offen
    v_mfma_f32_16x16x32_bf16 v[44:47], v[76:79], v[176:179], v[44:47]
    ds_read_b64_tr_b16 v[108:109], v14 offset:12288
    s_add_u32 s44, s44, 16384
    s_waitcnt vmcnt(10)
    v_mfma_f32_16x16x32_bf16 v[28:31], v[76:79], v[172:175], v[28:31]
    ds_read_b64_tr_b16 v[110:111], v14 offset:14336
    v_or3_b32 v17, v180, v184, v188
    v_mfma_f32_16x16x32_bf16 v[32:35], v[80:83], v[172:175], v[32:35]
    ds_read_b64_tr_b16 v[112:113], v15 offset:12288
    v_bitop3_b32 v17, v17, v192, 1 bitop3:0xa8
    v_mfma_f32_16x16x32_bf16 v[48:51], v[80:83], v[176:179], v[48:51]
    ds_read_b64_tr_b16 v[114:115], v15 offset:14336
    v_cmp_ne_u32 vcc, 0, v17
    v_mfma_f32_16x16x32_bf16 v[52:55], v[84:87], v[176:179], v[52:55]
    ds_read_b64_tr_b16 v[116:117], v16 offset:12288
    ds_read_b64_tr_b16 v[118:119], v16 offset:14336
    v_mfma_f32_16x16x32_bf16 v[36:39], v[84:87], v[172:175], v[36:39]
    s_waitcnt lgkmcnt(8)
    s_cbranch_vccnz dm_23f0
dm_23g0:
    v_mfma_f32_16x16x32_bf16 v[24:27], v[88:91], v[180:183], v[24:27]
    ds_read_b64_tr_b16 v[56:57], v13 offset:16384
    buffer_load_dwordx4 v[172:175], v126, s[8:11], s44 offen
    v_mfma_f32_16x16x32_bf16 v[40:43], v[88:91], v[184:187], v[40:43]
    ds_read_b64_tr_b16 v[58:59], v13 offset:18432
    buffer_load_dwordx4 v[176:179], v127, s[8:11], s44 offen
    v_mfma_f32_16x16x32_bf16 v[44:47], v[92:95], v[184:187], v[44:47]
    ds_read_b64_tr_b16 v[60:61], v14 offset:16384
    s_add_u32 s44, s44, 16384
    v_mfma_f32_16x16x32_bf16 v[28:31], v[92:95], v[180:183], v[28:31]
    ds_read_b64_tr_b16 v[62:63], v14 offset:18432
    v_mov_b32 v130, v132
    v_mfma_f32_16x16x32_bf16 v[32:35], v[96:99], v[180:183], v[32:35]
    ds_read_b64_tr_b16 v[64:65], v15 offset:16384
    v_mov_b32 v131, v133
    v_mfma_f32_16x16x32_bf16 v[48:51], v[96:99], v[184:187], v[48:51]
    ds_read_b64_tr_b16 v[66:67], v15 offset:18432
    v_mov_b32 v132, 1073741824
    v_mfma_f32_16x16x32_bf16 v[52:55], v[100:103], v[184:187], v[52:55]
    ds_read_b64_tr_b16 v[68:69], v16 offset:16384
    v_mov_b32 v133, 1073741824
    v_mfma_f32_16x16x32_bf16 v[36:39], v[100:103], v[180:183], v[36:39]
    ds_read_b64_tr_b16 v[70:71], v16 offset:18432
    s_waitcnt lgkmcnt(8)
    v_mfma_f32_16x16x32_bf16 v[24:27], v[104:107], v[188:191], v[24:27]
    ds_read_b64_tr_b16 v[72:73], v13 offset:20480
    buffer_load_dwordx4 v[180:183], v126, s[8:11], s44 offen
    v_mfma_f32_16x16x32_bf16 v[40:43], v[104:107], v[192:195], v[40:43]
    ds_read_b64_tr_b16 v[74:75], v13 offset:22528
    buffer_load_dwordx4 v[184:187], v127, s[8:11], s44 offen
    v_mfma_f32_16x16x32_bf16 v[44:47], v[108:111], v[192:195], v[44:47]
    ds_read_b64_tr_b16 v[76:77], v14 offset:20480
    s_add_u32 s44, s44, 16384
    s_waitcnt vmcnt(10)
    v_mfma_f32_16x16x32_bf16 v[28:31], v[108:111], v[188:191], v[28:31]
    ds_read_b64_tr_b16 v[78:79], v14 offset:22528
    v_or3_b32 v17, v196, v200, v204
    v_mfma_f32_16x16x32_bf16 v[32:35], v[112:115], v[188:191], v[32:35]
    ds_read_b64_tr_b16 v[80:81], v15 offset:20480
    v_bitop3_b32 v17, v17, v208, 1 bitop3:0xa8
    v_mfma_f32_16x16x32_bf16 v[48:51], v[112:115], v[192:195], v[48:51]
    ds_read_b64_tr_b16 v[82:83], v15 offset:22528
    v_cmp_ne_u32 vcc, 0, v17
    v_mfma_f32_16x16x32_bf16 v[52:55], v[116:119], v[192:195], v[52:55]
    ds_read_b64_tr_b16 v[84:85], v16 offset:20480
    ds_read_b64_tr_b16 v[86:87], v16 offset:22528
    v_mfma_f32_16x16x32_bf16 v[36:39], v[116:119], v[188:191], v[36:39]
    s_waitcnt lgkmcnt(8)
    s_cbranch_vccnz dm_23f1
dm_23g1:
    v_mfma_f32_16x16x32_bf16 v[24:27], v[56:59], v[196:199], v[24:27]
    ds_read_b64_tr_b16 v[88:89], v13 offset:24576
    buffer_load_dwordx4 v[188:191], v126, s[8:11], s44 offen
    v_mfma_f32_16x16x32_bf16 v[40:43], v[56:59], v[200:203], v[40:43]
    ds_read_b64_tr_b16 v[90:91], v13 offset:26624
    buffer_load_dwordx4 v[192:195], v127, s[8:11], s44 offen
    v_mfma_f32_16x16x32_bf16 v[44:47], v[60:63], v[200:203], v[44:47]
    ds_read_b64_tr_b16 v[92:93], v14 offset:24576
    s_add_u32 s44, s44, 16384
    v_mfma_f32_16x16x32_bf16 v[28:31], v[60:63], v[196:199], v[28:31]
    ds_read_b64_tr_b16 v[94:95], v14 offset:26624
    v_mfma_f32_16x16x32_bf16 v[32:35], v[64:67], v[196:199], v[32:35]
    ds_read_b64_tr_b16 v[96:97], v15 offset:24576
    s_add_u32 s43, s43, 1
    v_mfma_f32_16x16x32_bf16 v[48:51], v[64:67], v[200:203], v[48:51]
    ds_read_b64_tr_b16 v[98:99], v15 offset:26624
    v_mfma_f32_16x16x32_bf16 v[52:55], v[68:71], v[200:203], v[52:55]
    ds_read_b64_tr_b16 v[100:101], v16 offset:24576
    v_mfma_f32_16x16x32_bf16 v[36:39], v[68:71], v[196:199], v[36:39]
    ds_read_b64_tr_b16 v[102:103], v16 offset:26624
    s_waitcnt lgkmcnt(8)
    v_mfma_f32_16x16x32_bf16 v[24:27], v[72:75], v[204:207], v[24:27]
    ds_read_b64_tr_b16 v[104:105], v13 offset:28672
    buffer_load_dwordx4 v[196:199], v126, s[8:11], s44 offen
    v_mfma_f32_16x16x32_bf16 v[40:43], v[72:75], v[208:211], v[40:43]
    ds_read_b64_tr_b16 v[106:107], v13 offset:30720
    buffer_load_dwordx4 v[200:203], v127, s[8:11], s44 offen
    v_mfma_f32_16x16x32_bf16 v[44:47], v[76:79], v[208:211], v[44:47]
    ds_read_b64_tr_b16 v[108:109], v14 offset:28672
    s_add_u32 s44, s44, 16384
    s_waitcnt vmcnt(10)
    v_mfma_f32_16x16x32_bf16 v[28:31], v[76:79], v[204:207], v[28:31]
    ds_read_b64_tr_b16 v[110:111], v14 offset:30720
    v_add_u32 v13, 32768, v13
    v_or3_b32 v17, v212, v216, v220
    v_mfma_f32_16x16x32_bf16 v[32:35], v[80:83], v[204:207], v[32:35]
    ds_read_b64_tr_b16 v[112:113], v15 offset:28672
    v_add_u32 v14, 32768, v14
    v_bitop3_b32 v17, v17, v224, 1 bitop3:0xa8
    v_mfma_f32_16x16x32_bf16 v[48:51], v[80:83], v[208:211], v[48:51]
    ds_read_b64_tr_b16 v[114:115], v15 offset:30720
    v_add_u32 v15, 32768, v15
    v_cmp_ne_u32 vcc, 0, v17
    v_mfma_f32_16x16x32_bf16 v[52:55], v[84:87], v[208:211], v[52:55]
    ds_read_b64_tr_b16 v[116:117], v16 offset:28672
    ds_read_b64_tr_b16 v[118:119], v16 offset:30720
    s_cmp_eq_u32 s43, 4
    v_mfma_f32_16x16x32_bf16 v[36:39], v[84:87], v[204:207], v[36:39]
    v_add_u32 v16, 32768, v16
    s_waitcnt lgkmcnt(8)
    s_cbranch_vccnz dm_23f2
dm_23g2:
    s_cbranch_scc1 dm_23x
    v_mfma_f32_16x16x32_bf16 v[24:27], v[88:91], v[212:215], v[24:27]
    ds_read_b64_tr_b16 v[56:57], v13 offset:0
    buffer_load_dwordx4 v[204:207], v126, s[8:11], s44 offen
    v_mfma_f32_16x16x32_bf16 v[40:43], v[88:91], v[216:219], v[40:43]
    ds_read_b64_tr_b16 v[58:59], v13 offset:2048
    buffer_load_dwordx4 v[208:211], v127, s[8:11], s44 offen
    v_mfma_f32_16x16x32_bf16 v[44:47], v[92:95], v[216:219], v[44:47]
    ds_read_b64_tr_b16 v[60:61], v14 offset:0
    s_add_u32 s44, s44, 16384
    v_mfma_f32_16x16x32_bf16 v[28:31], v[92:95], v[212:215], v[28:31]
    ds_read_b64_tr_b16 v[62:63], v14 offset:2048
    v_mov_b32 v134, v126
    v_mfma_f32_16x16x32_bf16 v[32:35], v[96:99], v[212:215], v[32:35]
    ds_read_b64_tr_b16 v[64:65], v15 offset:0
    v_mov_b32 v135, v127
    v_mfma_f32_16x16x32_bf16 v[48:51], v[96:99], v[216:219], v[48:51]
    ds_read_b64_tr_b16 v[66:67], v15 offset:2048
    v_mfma_f32_16x16x32_bf16 v[52:55], v[100:103], v[216:219], v[52:55]
    ds_read_b64_tr_b16 v[68:69], v16 offset:0
    v_mfma_f32_16x16x32_bf16 v[36:39], v[100:103], v[212:215], v[36:39]
    ds_read_b64_tr_b16 v[70:71], v16 offset:2048
    s_waitcnt lgkmcnt(8)
    v_mfma_f32_16x16x32_bf16 v[24:27], v[104:107], v[220:223], v[24:27]
    ds_read_b64_tr_b16 v[72:73], v13 offset:4096
    buffer_load_dwordx4 v[212:215], v126, s[8:11], s44 offen
    v_mfma_f32_16x16x32_bf16 v[40:43], v[104:107], v[224:227], v[40:43]
    ds_read_b64_tr_b16 v[74:75], v13 offset:6144
    buffer_load_dwordx4 v[216:219], v127, s[8:11], s44 offen
    v_mfma_f32_16x16x32_bf16 v[44:47], v[108:111], v[224:227], v[44:47]
    ds_read_b64_tr_b16 v[76:77], v14 offset:4096
    s_add_u32 s44, s44, 16384
    s_waitcnt vmcnt(10)
    v_mfma_f32_16x16x32_bf16 v[28:31], v[108:111], v[220:223], v[28:31]
    ds_read_b64_tr_b16 v[78:79], v14 offset:6144
    v_or3_b32 v17, v164, v168, v172
    v_mfma_f32_16x16x32_bf16 v[32:35], v[112:115], v[220:223], v[32:35]
    ds_read_b64_tr_b16 v[80:81], v15 offset:4096
    v_bitop3_b32 v17, v17, v176, 1 bitop3:0xa8
    v_mfma_f32_16x16x32_bf16 v[48:51], v[112:115], v[224:227], v[48:51]
    ds_read_b64_tr_b16 v[82:83], v15 offset:6144
    v_cmp_ne_u32 vcc, 0, v17
    v_mfma_f32_16x16x32_bf16 v[52:55], v[116:119], v[224:227], v[52:55]
    ds_read_b64_tr_b16 v[84:85], v16 offset:4096
    ds_read_b64_tr_b16 v[86:87], v16 offset:6144
    v_mfma_f32_16x16x32_bf16 v[36:39], v[116:119], v[220:223], v[36:39]
    s_waitcnt lgkmcnt(8)
    s_cbranch_vccnz dm_23f3
dm_23g3:
    s_branch dm_23
dm_23f0:
    s_cselect_b32 s50, 1, 0
dm_23h0:
    s_sleep 2
    s_sub_u32 s44, s44, 114688
    buffer_load_dwordx4 v[180:183], v134, s[8:11], s44 offen sc1
    buffer_load_dwordx4 v[184:187], v135, s[8:11], s44 offen sc1
    s_add_u32 s44, s44, 16384
    buffer_load_dwordx4 v[188:191], v134, s[8:11], s44 offen sc1
    buffer_load_dwordx4 v[192:195], v135, s[8:11], s44 offen sc1
    s_add_u32 s44, s44, 16384
    buffer_load_dwordx4 v[196:199], v134, s[8:11], s44 offen sc1
    buffer_load_dwordx4 v[200:203], v135, s[8:11], s44 offen sc1
    s_add_u32 s44, s44, 16384
    buffer_load_dwordx4 v[204:207], v134, s[8:11], s44 offen sc1
    buffer_load_dwordx4 v[208:211], v135, s[8:11], s44 offen sc1
    s_add_u32 s44, s44, 16384
    buffer_load_dwordx4 v[212:215], v134, s[8:11], s44 offen sc1
    buffer_load_dwordx4 v[216:219], v135, s[8:11], s44 offen sc1
    s_add_u32 s44, s44, 16384
    buffer_load_dwordx4 v[220:223], v134, s[8:11], s44 offen sc1
    buffer_load_dwordx4 v[224:227], v135, s[8:11], s44 offen sc1
    s_add_u32 s44, s44, 16384
    buffer_load_dwordx4 v[164:167], v126, s[8:11], s44 offen sc1
    buffer_load_dwordx4 v[168:171], v127, s[8:11], s44 offen sc1
    s_add_u32 s44, s44, 16384
    s_waitcnt vmcnt(10)
    v_or3_b32 v17, v180, v184, v188
    v_bitop3_b32 v17, v17, v192, 1 bitop3:0xa8
    v_cmp_ne_u32 vcc, 0, v17
    s_add_u32 s53, s53, 1
    s_cmp_ge_u32 s53, s61
    s_cselect_b32 s61, 0, s61
    s_cbranch_scc1 dm_23k0
    s_cbranch_vccnz dm_23h0
dm_23k0:
    s_cmp_eq_u32 s50, 1
    s_branch dm_23g0
dm_23f1:
    s_cselect_b32 s50, 1, 0
dm_23h1:
    s_sleep 2
    s_sub_u32 s44, s44, 114688
    buffer_load_dwordx4 v[196:199], v134, s[8:11], s44 offen sc1
    buffer_load_dwordx4 v[200:203], v135, s[8:11], s44 offen sc1
    s_add_u32 s44, s44, 16384
    buffer_load_dwordx4 v[204:207], v134, s[8:11], s44 offen sc1
    buffer_load_dwordx4 v[208:211], v135, s[8:11], s44 offen sc1
    s_add_u32 s44, s44, 16384
    buffer_load_dwordx4 v[212:215], v134, s[8:11], s44 offen sc1
    buffer_load_dwordx4 v[216:219], v135, s[8:11], s44 offen sc1
    s_add_u32 s44, s44, 16384
    buffer_load_dwordx4 v[220:223], v134, s[8:11], s44 offen sc1
    buffer_load_dwordx4 v[224:227], v135, s[8:11], s44 offen sc1
    s_add_u32 s44, s44, 16384
    buffer_load_dwordx4 v[164:167], v126, s[8:11], s44 offen sc1
    buffer_load_dwordx4 v[168:171], v127, s[8:11], s44 offen sc1
    s_add_u32 s44, s44, 16384
    buffer_load_dwordx4 v[172:175], v126, s[8:11], s44 offen sc1
    buffer_load_dwordx4 v[176:179], v127, s[8:11], s44 offen sc1
    s_add_u32 s44, s44, 16384
    buffer_load_dwordx4 v[180:183], v126, s[8:11], s44 offen sc1
    buffer_load_dwordx4 v[184:187], v127, s[8:11], s44 offen sc1
    s_add_u32 s44, s44, 16384
    s_waitcnt vmcnt(10)
    v_or3_b32 v17, v196, v200, v204
    v_bitop3_b32 v17, v17, v208, 1 bitop3:0xa8
    v_cmp_ne_u32 vcc, 0, v17
    s_add_u32 s53, s53, 1
    s_cmp_ge_u32 s53, s61
    s_cselect_b32 s61, 0, s61
    s_cbranch_scc1 dm_23k1
    s_cbranch_vccnz dm_23h1
dm_23k1:
    s_cmp_eq_u32 s50, 1
    s_branch dm_23g1
dm_23f2:
    s_cselect_b32 s50, 1, 0
dm_23h2:
    s_sleep 2
    s_sub_u32 s44, s44, 114688
    buffer_load_dwordx4 v[212:215], v134, s[8:11], s44 offen sc1
    buffer_load_dwordx4 v[216:219], v135, s[8:11], s44 offen sc1
    s_add_u32 s44, s44, 16384
    buffer_load_dwordx4 v[220:223], v134, s[8:11], s44 offen sc1
    buffer_load_dwordx4 v[224:227], v135, s[8:11], s44 offen sc1
    s_add_u32 s44, s44, 16384
    buffer_load_dwordx4 v[164:167], v126, s[8:11], s44 offen sc1
    buffer_load_dwordx4 v[168:171], v127, s[8:11], s44 offen sc1
    s_add_u32 s44, s44, 16384
    buffer_load_dwordx4 v[172:175], v126, s[8:11], s44 offen sc1
    buffer_load_dwordx4 v[176:179], v127, s[8:11], s44 offen sc1
    s_add_u32 s44, s44, 16384
    buffer_load_dwordx4 v[180:183], v126, s[8:11], s44 offen sc1
    buffer_load_dwordx4 v[184:187], v127, s[8:11], s44 offen sc1
    s_add_u32 s44, s44, 16384
    buffer_load_dwordx4 v[188:191], v126, s[8:11], s44 offen sc1
    buffer_load_dwordx4 v[192:195], v127, s[8:11], s44 offen sc1
    s_add_u32 s44, s44, 16384
    buffer_load_dwordx4 v[196:199], v126, s[8:11], s44 offen sc1
    buffer_load_dwordx4 v[200:203], v127, s[8:11], s44 offen sc1
    s_add_u32 s44, s44, 16384
    s_waitcnt vmcnt(10)
    v_or3_b32 v17, v212, v216, v220
    v_bitop3_b32 v17, v17, v224, 1 bitop3:0xa8
    v_cmp_ne_u32 vcc, 0, v17
    s_add_u32 s53, s53, 1
    s_cmp_ge_u32 s53, s61
    s_cselect_b32 s61, 0, s61
    s_cbranch_scc1 dm_23k2
    s_cbranch_vccnz dm_23h2
dm_23k2:
    s_cmp_eq_u32 s50, 1
    s_branch dm_23g2
dm_23f3:
    s_cselect_b32 s50, 1, 0
dm_23h3:
    s_sleep 2
    s_sub_u32 s44, s44, 114688
    buffer_load_dwordx4 v[164:167], v134, s[8:11], s44 offen sc1
    buffer_load_dwordx4 v[168:171], v135, s[8:11], s44 offen sc1
    s_add_u32 s44, s44, 16384
    buffer_load_dwordx4 v[172:175], v134, s[8:11], s44 offen sc1
    buffer_load_dwordx4 v[176:179], v135, s[8:11], s44 offen sc1
    s_add_u32 s44, s44, 16384
    buffer_load_dwordx4 v[180:183], v134, s[8:11], s44 offen sc1
    buffer_load_dwordx4 v[184:187], v135, s[8:11], s44 offen sc1
    s_add_u32 s44, s44, 16384
    buffer_load_dwordx4 v[188:191], v134, s[8:11], s44 offen sc1
    buffer_load_dwordx4 v[192:195], v135, s[8:11], s44 offen sc1
    s_add_u32 s44, s44, 16384
    buffer_load_dwordx4 v[196:199], v134, s[8:11], s44 offen sc1
    buffer_load_dwordx4 v[200:203], v135, s[8:11], s44 offen sc1
    s_add_u32 s44, s44, 16384
    buffer_load_dwordx4 v[204:207], v134, s[8:11], s44 offen sc1
    buffer_load_dwordx4 v[208:211], v135, s[8:11], s44 offen sc1
    s_add_u32 s44, s44, 16384
    buffer_load_dwordx4 v[212:215], v134, s[8:11], s44 offen sc1
    buffer_load_dwordx4 v[216:219], v135, s[8:11], s44 offen sc1
    s_add_u32 s44, s44, 16384
    s_waitcnt vmcnt(10)
    v_or3_b32 v17, v164, v168, v172
    v_bitop3_b32 v17, v17, v176, 1 bitop3:0xa8
    v_cmp_ne_u32 vcc, 0, v17
    s_add_u32 s53, s53, 1
    s_cmp_ge_u32 s53, s61
    s_cselect_b32 s61, 0, s61
    s_cbranch_scc1 dm_23k3
    s_cbranch_vccnz dm_23h3
dm_23k3:
    s_cmp_eq_u32 s50, 1
    s_branch dm_23g3
dm_23x:
    v_mfma_f32_16x16x32_bf16 v[24:27], v[88:91], v[212:215], v[24:27]
    v_mfma_f32_16x16x32_bf16 v[40:43], v[88:91], v[216:219], v[40:43]
    v_mfma_f32_16x16x32_bf16 v[44:47], v[92:95], v[216:219], v[44:47]
    v_mfma_f32_16x16x32_bf16 v[28:31], v[92:95], v[212:215], v[28:31]
    v_mfma_f32_16x16x32_bf16 v[32:35], v[96:99], v[212:215], v[32:35]
    v_mfma_f32_16x16x32_bf16 v[48:51], v[96:99], v[216:219], v[48:51]
    v_mfma_f32_16x16x32_bf16 v[52:55], v[100:103], v[216:219], v[52:55]
    v_mfma_f32_16x16x32_bf16 v[36:39], v[100:103], v[212:215], v[36:39]
    s_waitcnt lgkmcnt(0)
    v_mfma_f32_16x16x32_bf16 v[24:27], v[104:107], v[220:223], v[24:27]
    s_add_u32 s44, s62, 0x5c8000
    v_mfma_f32_16x16x32_bf16 v[40:43], v[104:107], v[224:227], v[40:43]
    s_addc_u32 s45, s63, 0
    v_mfma_f32_16x16x32_bf16 v[44:47], v[108:111], v[224:227], v[44:47]
    v_mfma_f32_16x16x32_bf16 v[28:31], v[108:111], v[220:223], v[28:31]
    s_mov_b32 s46, 0x6000
    v_mfma_f32_16x16x32_bf16 v[32:35], v[112:115], v[220:223], v[32:35]
    v_mfma_f32_16x16x32_bf16 v[48:51], v[112:115], v[224:227], v[48:51]
    s_mov_b32 s47, 0x20000
    v_mfma_f32_16x16x32_bf16 v[52:55], v[116:119], v[224:227], v[52:55]
    v_mfma_f32_16x16x32_bf16 v[36:39], v[116:119], v[220:223], v[36:39]
    s_add_u32 s36, s39, 0
    v_cvt_pk_bf16_f32 v148, v24, v25
    v_cvt_pk_bf16_f32 v149, v26, v27
    v_cvt_pk_bf16_f32 v150, v28, v29
    v_cvt_pk_bf16_f32 v151, v30, v31
    v_and_b32 v148, -2, v148
    buffer_store_dwordx4 v[148:151], v2, s[16:19], s36 offen offset:0 sc1
    v_cvt_pk_bf16_f32 v152, v32, v33
    v_cvt_pk_bf16_f32 v153, v34, v35
    v_cvt_pk_bf16_f32 v154, v36, v37
    v_cvt_pk_bf16_f32 v155, v38, v39
    v_and_b32 v152, -2, v152
    buffer_store_dwordx4 v[152:155], v2, s[16:19], s36 offen offset:1024 sc1
    s_add_u32 s36, s39, 65536
    v_cvt_pk_bf16_f32 v156, v40, v41
    v_cvt_pk_bf16_f32 v157, v42, v43
    v_cvt_pk_bf16_f32 v158, v44, v45
    v_cvt_pk_bf16_f32 v159, v46, v47
    v_and_b32 v156, -2, v156
    buffer_store_dwordx4 v[156:159], v2, s[16:19], s36 offen offset:0 sc1
    v_cvt_pk_bf16_f32 v160, v48, v49
    v_cvt_pk_bf16_f32 v161, v50, v51
    v_cvt_pk_bf16_f32 v162, v52, v53
    v_cvt_pk_bf16_f32 v163, v54, v55
    v_and_b32 v160, -2, v160
    buffer_store_dwordx4 v[160:163], v2, s[16:19], s36 offen offset:1024 sc1
    s_barrier
    s_lshl_b32 s36, s37, 11
    v_add_u32 v7, s36, v2
    ds_write_b128 v7, v[148:151] offset:0
    ds_write_b128 v7, v[152:155] offset:1024
    ds_write_b128 v7, v[156:159] offset:2048
    ds_write_b128 v7, v[160:163] offset:3072
    v_lshlrev_b32 v24, 16, v148
    v_and_b32 v25, 0xffff0000, v148
    v_lshlrev_b32 v26, 16, v149
    v_and_b32 v27, 0xffff0000, v149
    v_lshlrev_b32 v28, 16, v150
    v_and_b32 v29, 0xffff0000, v150
    v_lshlrev_b32 v30, 16, v151
    v_and_b32 v31, 0xffff0000, v151
    v_lshlrev_b32 v32, 16, v152
    v_and_b32 v33, 0xffff0000, v152
    v_lshlrev_b32 v34, 16, v153
    v_and_b32 v35, 0xffff0000, v153
    v_lshlrev_b32 v36, 16, v154
    v_and_b32 v37, 0xffff0000, v154
    v_lshlrev_b32 v38, 16, v155
    v_and_b32 v39, 0xffff0000, v155
    v_lshlrev_b32 v40, 16, v156
    v_and_b32 v41, 0xffff0000, v156
    v_lshlrev_b32 v42, 16, v157
    v_and_b32 v43, 0xffff0000, v157
    v_lshlrev_b32 v44, 16, v158
    v_and_b32 v45, 0xffff0000, v158
    v_lshlrev_b32 v46, 16, v159
    v_and_b32 v47, 0xffff0000, v159
    v_lshlrev_b32 v48, 16, v160
    v_and_b32 v49, 0xffff0000, v160
    v_lshlrev_b32 v50, 16, v161
    v_and_b32 v51, 0xffff0000, v161
    v_lshlrev_b32 v52, 16, v162
    v_and_b32 v53, 0xffff0000, v162
    v_lshlrev_b32 v54, 16, v163
    v_and_b32 v55, 0xffff0000, v163
    s_add_u32 s53, s55, 512
    v_mov_b32 v8, 1
    v_mov_b32 v9, 162816
    v_mov_b32 v11, 0
    s_mov_b64 exec, 1
    s_waitcnt vmcnt(0)
    ds_add_rtn_u32 v10, v9, v8
    s_waitcnt lgkmcnt(0)
    v_readfirstlane_b32 s54, v10
    s_nop 0
    s_and_b32 s54, s54, 3
    s_cmp_lg_u32 s54, 3
    s_cbranch_scc1 pub_24
    buffer_atomic_add v8, v11, s[56:59], s53 offen sc1
    v_mov_b32 v9, 162872
    ds_add_u32 v9, v8
pub_24:
    s_mov_b64 exec, -1
    s_waitcnt lgkmcnt(0)
    s_barrier
    v_pk_add_f32 v[142:143], v[24:25], v[26:27]
    v_pk_mul_f32 v[136:137], v[24:25], v[24:25]
    v_pk_fma_f32 v[136:137], v[26:27], v[26:27], v[136:137]
    v_pk_add_f32 v[142:143], v[142:143], v[28:29]
    v_pk_fma_f32 v[136:137], v[28:29], v[28:29], v[136:137]
    v_pk_add_f32 v[142:143], v[142:143], v[30:31]
    v_pk_fma_f32 v[136:137], v[30:31], v[30:31], v[136:137]
    v_pk_add_f32 v[142:143], v[142:143], v[32:33]
    v_pk_fma_f32 v[136:137], v[32:33], v[32:33], v[136:137]
    v_pk_add_f32 v[142:143], v[142:143], v[34:35]
    v_pk_fma_f32 v[136:137], v[34:35], v[34:35], v[136:137]
    v_pk_add_f32 v[142:143], v[142:143], v[36:37]
    v_pk_fma_f32 v[136:137], v[36:37], v[36:37], v[136:137]
    v_pk_add_f32 v[142:143], v[142:143], v[38:39]
    v_pk_fma_f32 v[136:137], v[38:39], v[38:39], v[136:137]
    v_add_f32 v138, v142, v143
    v_add_f32 v139, v136, v137
    v_mov_b32 v142, v138
    v_mov_b32 v143, v139
    s_nop 0
    v_permlane16_swap_b32 v138, v142
    v_permlane16_swap_b32 v139, v143
    v_pk_add_f32 v[138:139], v[138:139], v[142:143]
    v_mov_b32 v142, v138
    v_mov_b32 v143, v139
    s_nop 0
    v_permlane32_swap_b32 v138, v142
    v_permlane32_swap_b32 v139, v143
    v_pk_add_f32 v[138:139], v[138:139], v[142:143]
    v_pk_add_f32 v[142:143], v[40:41], v[42:43]
    v_pk_mul_f32 v[136:137], v[40:41], v[40:41]
    v_pk_fma_f32 v[136:137], v[42:43], v[42:43], v[136:137]
    v_pk_add_f32 v[142:143], v[142:143], v[44:45]
    v_pk_fma_f32 v[136:137], v[44:45], v[44:45], v[136:137]
    v_pk_add_f32 v[142:143], v[142:143], v[46:47]
    v_pk_fma_f32 v[136:137], v[46:47], v[46:47], v[136:137]
    v_pk_add_f32 v[142:143], v[142:143], v[48:49]
    v_pk_fma_f32 v[136:137], v[48:49], v[48:49], v[136:137]
    v_pk_add_f32 v[142:143], v[142:143], v[50:51]
    v_pk_fma_f32 v[136:137], v[50:51], v[50:51], v[136:137]
    v_pk_add_f32 v[142:143], v[142:143], v[52:53]
    v_pk_fma_f32 v[136:137], v[52:53], v[52:53], v[136:137]
    v_pk_add_f32 v[142:143], v[142:143], v[54:55]
    v_pk_fma_f32 v[136:137], v[54:55], v[54:55], v[136:137]
    v_add_f32 v140, v142, v143
    v_add_f32 v141, v136, v137
    v_mov_b32 v142, v140
    v_mov_b32 v143, v141
    s_nop 0
    v_permlane16_swap_b32 v140, v142
    v_permlane16_swap_b32 v141, v143
    v_pk_add_f32 v[140:141], v[140:141], v[142:143]
    v_mov_b32 v142, v140
    v_mov_b32 v143, v141
    s_nop 0
    v_permlane32_swap_b32 v140, v142
    v_permlane32_swap_b32 v141, v143
    v_pk_add_f32 v[140:141], v[140:141], v[142:143]
    v_cmp_eq_u32 vcc, 0, v23
    s_nop 1
    v_cndmask_b32 v138, v140, v138, vcc
    v_cndmask_b32 v139, v141, v139, vcc
    s_lshr_b32 s53, s29, 3
    s_lshl_b32 s53, s53, 14
    s_and_b32 s40, s29, 7
    s_lshl_b32 s40, s40, 10
    s_add_u32 s40, s40, s53
    s_lshl_b32 s36, s34, 8
    s_add_u32 s40, s40, s36
    v_lshlrev_b32 v7, 3, v1
    s_bfm_b64 exec, 32, 0
    buffer_store_dwordx2 v[138:139], v7, s[44:47], s40 offen sc1
    s_mov_b64 exec, -1
    s_lshr_b32 s34, s30, 1
    s_and_b32 s35, s30, 1
    v_and_b32 v22, 15, v1
    v_lshrrev_b32 v23, 4, v1
    s_mul_i32 s37, s34, 4
    s_mul_i32 s38, s29, 14
    s_mul_i32 s36, s35, 7
    s_add_u32 s38, s38, s36
    s_mul_i32 s36, s34, 8192
    v_add_u32 v12, s36, v2
    v_lshrrev_b32 v6, 2, v1
    v_mul_u32_u24 v13, 448, v6
    v_and_b32 v7, 3, v1
    v_lshl_add_u32 v13, v7, 3, v13
    v_add_u32 v13, 73728, v13
    s_mul_i32 s36, s35, 224
    v_add_u32 v13, s36, v13
    v_bfe_u32 v6, v1, 4, 1
    v_lshlrev_b32 v6, 5, v6
    s_cmp_eq_u32 s35, 0
    s_cselect_b32 s36, 1, -1
    v_mul_lo_u32 v6, v6, s36
    v_sub_u32 v14, v13, v6
    v_add_u32 v13, v13, v6
    v_mov_b32 v17, v12
    s_mov_b32 s42, 0
    s_mov_b32 s43, 0
    s_mov_b32 s48, 57344
    v_add_u32 v18, 57344, v13
    v_add_u32 v19, 57344, v14
    ds_read_b128 v[136:139], v17 offset:0
    ds_read_b128 v[140:143], v17 offset:2048
    ds_read_b128 v[144:147], v17 offset:4096
    ds_read_b128 v[148:151], v17 offset:6144
    ds_read_b64_tr_b16 v[152:153], v18 offset:0
    ds_read_b64_tr_b16 v[154:155], v18 offset:7168
    ds_read_b64_tr_b16 v[156:157], v19 offset:32
    ds_read_b64_tr_b16 v[158:159], v19 offset:7200
    ds_read_b64_tr_b16 v[160:161], v18 offset:64
    ds_read_b64_tr_b16 v[162:163], v18 offset:7232
    ds_read_b64_tr_b16 v[164:165], v19 offset:96
    ds_read_b64_tr_b16 v[166:167], v19 offset:7264
    ds_read_b64_tr_b16 v[168:169], v18 offset:128
    ds_read_b64_tr_b16 v[170:171], v18 offset:7296
    ds_read_b64_tr_b16 v[172:173], v19 offset:160
    ds_read_b64_tr_b16 v[174:175], v19 offset:7328
    ds_read_b64_tr_b16 v[176:177], v18 offset:192
    ds_read_b64_tr_b16 v[178:179], v18 offset:7360
    s_waitcnt lgkmcnt(12)
    v_mfma_f32_16x16x32_bf16 v[24:27], v[152:155], v[136:139], 0
    ds_read_b128 v[180:183], v17 offset:1024
    s_add_u32 s42, s42, 16384
    v_mfma_f32_16x16x32_bf16 v[52:55], v[152:155], v[140:143], 0
    ds_read_b128 v[184:187], v17 offset:3072
    s_cmp_eq_u32 s42, 49152
    v_mfma_f32_16x16x32_bf16 v[80:83], v[152:155], v[144:147], 0
    ds_read_b128 v[188:191], v17 offset:5120
    s_cselect_b32 s42, 0, s42
    v_mfma_f32_16x16x32_bf16 v[108:111], v[152:155], v[148:151], 0
    ds_read_b128 v[192:195], v17 offset:7168
    s_waitcnt lgkmcnt(14)
    v_mfma_f32_16x16x32_bf16 v[112:115], v[156:159], v[148:151], 0
    ds_read_b64_tr_b16 v[196:197], v18 offset:14336
    s_add_u32 s48, s48, 28672
    v_mfma_f32_16x16x32_bf16 v[84:87], v[156:159], v[144:147], 0
    ds_read_b64_tr_b16 v[198:199], v18 offset:21504
    s_cmp_eq_u32 s48, 86016
    v_mfma_f32_16x16x32_bf16 v[56:59], v[156:159], v[140:143], 0
    ds_read_b64_tr_b16 v[200:201], v19 offset:14368
    s_cselect_b32 s48, 0, s48
    v_mfma_f32_16x16x32_bf16 v[28:31], v[156:159], v[136:139], 0
    ds_read_b64_tr_b16 v[202:203], v19 offset:21536
    s_waitcnt lgkmcnt(8)
    v_mfma_f32_16x16x32_bf16 v[32:35], v[160:163], v[136:139], 0
    ds_read_b64_tr_b16 v[204:205], v18 offset:14400
    v_add_u32 v17, s42, v12
    v_mfma_f32_16x16x32_bf16 v[60:63], v[160:163], v[140:143], 0
    ds_read_b64_tr_b16 v[206:207], v18 offset:21568
    v_mfma_f32_16x16x32_bf16 v[88:91], v[160:163], v[144:147], 0
    ds_read_b64_tr_b16 v[208:209], v19 offset:14432
    v_mfma_f32_16x16x32_bf16 v[116:119], v[160:163], v[148:151], 0
    ds_read_b64_tr_b16 v[210:211], v19 offset:21600
    v_mfma_f32_16x16x32_bf16 v[120:123], v[164:167], v[148:151], 0
    ds_read_b64_tr_b16 v[212:213], v18 offset:14464
    v_mfma_f32_16x16x32_bf16 v[92:95], v[164:167], v[144:147], 0
    ds_read_b64_tr_b16 v[214:215], v18 offset:21632
    v_mfma_f32_16x16x32_bf16 v[64:67], v[164:167], v[140:143], 0
    ds_read_b64_tr_b16 v[216:217], v19 offset:14496
    v_mfma_f32_16x16x32_bf16 v[36:39], v[164:167], v[136:139], 0
    ds_read_b64_tr_b16 v[218:219], v19 offset:21664
    v_add_u32 v19, s48, v14
    v_mfma_f32_16x16x32_bf16 v[40:43], v[168:171], v[136:139], 0
    ds_read_b64_tr_b16 v[220:221], v18 offset:14528
    v_mfma_f32_16x16x32_bf16 v[68:71], v[168:171], v[140:143], 0
    ds_read_b64_tr_b16 v[222:223], v18 offset:21696
    v_add_u32 v18, s48, v13
    v_mfma_f32_16x16x32_bf16 v[96:99], v[168:171], v[144:147], 0
    v_mfma_f32_16x16x32_bf16 v[124:127], v[168:171], v[148:151], 0
    v_mfma_f32_16x16x32_bf16 v[128:131], v[172:175], v[148:151], 0
    v_mfma_f32_16x16x32_bf16 v[100:103], v[172:175], v[144:147], 0
    v_mfma_f32_16x16x32_bf16 v[72:75], v[172:175], v[140:143], 0
    v_mfma_f32_16x16x32_bf16 v[44:47], v[172:175], v[136:139], 0
    v_mfma_f32_16x16x32_bf16 v[48:51], v[176:179], v[136:139], 0
    v_mfma_f32_16x16x32_bf16 v[76:79], v[176:179], v[140:143], 0
    v_mfma_f32_16x16x32_bf16 v[104:107], v[176:179], v[144:147], 0
    v_mfma_f32_16x16x32_bf16 v[132:135], v[176:179], v[148:151], 0
    s_waitcnt lgkmcnt(12)
    v_mfma_f32_16x16x32_bf16 v[24:27], v[196:199], v[180:183], v[24:27]
    s_add_u32 s43, s43, 1
    s_mul_i32 s36, s35, 448
    s_add_u32 s36, s36, 159744
    v_lshlrev_b32 v6, 4, v23
    v_mfma_f32_16x16x32_bf16 v[52:55], v[196:199], v[184:187], v[52:55]
    v_add_u32 v6, s36, v6
    s_lshl_b32 s36, s37, 8
    s_add_u32 s36, s36, 160768
    v_lshlrev_b32 v7, 4, v22
    v_mfma_f32_16x16x32_bf16 v[80:83], v[196:199], v[188:191], v[80:83]
    v_add_u32 v7, s36, v7
    s_add_u32 s16, s62, 0x400000
    s_addc_u32 s17, s63, 0
    s_mov_b32 s18, 0x1be000
    v_mfma_f32_16x16x32_bf16 v[108:111], v[196:199], v[192:195], v[108:111]
    s_mov_b32 s19, 0x20000
    s_mul_i32 s39, s37, 229376
    s_lshr_b32 s36, s38, 1
    s_waitcnt lgkmcnt(0)
    v_mfma_f32_16x16x32_bf16 v[112:115], v[200:203], v[192:195], v[112:115]
    s_add_u32 s36, s36, 0
    s_lshr_b32 s53, s36, 3
    s_lshl_b32 s53, s53, 14
    s_and_b32 s44, s36, 7
    v_mfma_f32_16x16x32_bf16 v[84:87], v[200:203], v[188:191], v[84:87]
    s_lshl_b32 s44, s44, 10
    s_add_u32 s44, s44, s53
    s_add_u32 s44, s44, s39
    s_lshr_b32 s36, s38, 1
    v_mfma_f32_16x16x32_bf16 v[56:59], v[200:203], v[184:187], v[56:59]
    s_add_u32 s36, s36, 1
    s_lshr_b32 s53, s36, 3
    s_lshl_b32 s53, s53, 14
    s_and_b32 s45, s36, 7
    v_mfma_f32_16x16x32_bf16 v[28:31], v[200:203], v[180:183], v[28:31]
    s_lshl_b32 s45, s45, 10
    s_add_u32 s45, s45, s53
    s_add_u32 s45, s45, s39
    s_lshr_b32 s36, s38, 1
    v_mfma_f32_16x16x32_bf16 v[32:35], v[204:207], v[180:183], v[32:35]
    s_add_u32 s36, s36, 2
    s_lshr_b32 s53, s36, 3
    s_lshl_b32 s53, s53, 14
    s_and_b32 s46, s36, 7
    v_mfma_f32_16x16x32_bf16 v[60:63], v[204:207], v[184:187], v[60:63]
    s_lshl_b32 s46, s46, 10
    s_add_u32 s46, s46, s53
    s_add_u32 s46, s46, s39
    s_lshr_b32 s36, s38, 1
    v_mfma_f32_16x16x32_bf16 v[88:91], v[204:207], v[188:191], v[88:91]
    s_add_u32 s36, s36, 3
    s_lshr_b32 s53, s36, 3
    s_lshl_b32 s53, s53, 14
    s_and_b32 s47, s36, 7
    v_mfma_f32_16x16x32_bf16 v[116:119], v[204:207], v[192:195], v[116:119]
    s_lshl_b32 s47, s47, 10
    s_add_u32 s47, s47, s53
    s_add_u32 s47, s47, s39
    v_lshrrev_b32 v226, 2, v1
    v_mfma_f32_16x16x32_bf16 v[120:123], v[208:211], v[192:195], v[120:123]
    v_mul_u32_u24 v240, 256, v226
    v_and_b32 v227, 3, v1
    v_lshl_add_u32 v240, v227, 3, v240
    v_add_u32 v240, 49152, v240
    v_mfma_f32_16x16x32_bf16 v[92:95], v[208:211], v[188:191], v[92:95]
    v_and_b32 v226, 7, v226
    s_mul_i32 s36, s35, 4
    s_add_u32 s36, s36, 3
    v_xor_b32 v227, s36, v226
    v_mfma_f32_16x16x32_bf16 v[64:67], v[208:211], v[184:187], v[64:67]
    v_lshl_add_u32 v243, v227, 5, v240
    s_mul_i32 s36, s35, 4
    s_add_u32 s36, s36, 2
    v_xor_b32 v227, s36, v226
    v_mfma_f32_16x16x32_bf16 v[36:39], v[208:211], v[180:183], v[36:39]
    v_lshl_add_u32 v242, v227, 5, v240
    s_mul_i32 s36, s35, 4
    s_add_u32 s36, s36, 1
    v_xor_b32 v227, s36, v226
    v_mfma_f32_16x16x32_bf16 v[40:43], v[212:215], v[180:183], v[40:43]
    v_lshl_add_u32 v241, v227, 5, v240
    s_mul_i32 s36, s35, 4
    s_add_u32 s36, s36, 0
    v_xor_b32 v227, s36, v226
    v_mfma_f32_16x16x32_bf16 v[68:71], v[212:215], v[184:187], v[68:71]
    v_lshl_add_u32 v240, v227, 5, v240
    s_lshl_b32 s38, s33, 3
    s_lshl_b32 s36, s35, 2
    s_add_u32 s38, s38, s36
    v_mfma_f32_16x16x32_bf16 v[96:99], v[212:215], v[188:191], v[96:99]
    s_lshr_b32 s36, s38, 1
    s_lshr_b32 s53, s36, 3
    s_lshl_b32 s53, s53, 14
    s_and_b32 s39, s36, 7
    v_mfma_f32_16x16x32_bf16 v[124:127], v[212:215], v[192:195], v[124:127]
    s_lshl_b32 s39, s39, 10
    s_add_u32 s39, s39, s53
    s_lshl_b32 s36, s37, 16
    s_add_u32 s39, s39, s36
    v_mfma_f32_16x16x32_bf16 v[128:131], v[216:219], v[192:195], v[128:131]
    s_lshl_b32 s40, s31, 17
    s_add_u32 s40, s40, s39
    s_xor_b32 s41, s31, 1
    s_lshl_b32 s41, s41, 17
    v_mfma_f32_16x16x32_bf16 v[100:103], v[216:219], v[188:191], v[100:103]
    s_add_u32 s41, s41, s39
    s_mov_b32 s84, s62
    s_mov_b32 s85, s63
    s_mov_b32 s86, 0x7e000
    v_mfma_f32_16x16x32_bf16 v[72:75], v[216:219], v[184:187], v[72:75]
    s_mov_b32 s87, 0x20000
    s_add_u32 s88, s62, 0x80000
    s_addc_u32 s89, s63, 0
    s_mov_b32 s90, 0x7e000
    v_mfma_f32_16x16x32_bf16 v[44:47], v[216:219], v[180:183], v[44:47]
    s_mov_b32 s91, 0x20000
    s_lshl_b32 s36, s37, 1
    s_add_u32 s36, s36, s35
    s_lshl_b32 s36, s36, 10
    v_mfma_f32_16x16x32_bf16 v[48:51], v[220:223], v[180:183], v[48:51]
    v_add_u32 v244, s36, v2
    v_mov_b32 v245, 1
    v_mov_b32 v246, 162880
    v_lshrrev_b32 v238, 1, v23
    v_mfma_f32_16x16x32_bf16 v[76:79], v[220:223], v[184:187], v[76:79]
    v_lshlrev_b32 v238, 8, v238
    v_lshl_add_u32 v238, v22, 4, v238
    v_and_b32 v224, 1, v23
    v_lshl_add_u32 v238, v224, 3, v238
    v_mfma_f32_16x16x32_bf16 v[104:107], v[220:223], v[188:191], v[104:107]
    v_mfma_f32_16x16x32_bf16 v[132:135], v[220:223], v[192:195], v[132:135]
    s_add_u32 s53, s55, 1408
    v_mov_b32 v8, 1
    v_mov_b32 v9, 162864
    v_mov_b32 v11, 0
    s_mov_b64 exec, 1
    s_waitcnt vmcnt(0)
    ds_add_rtn_u32 v10, v9, v8
    s_waitcnt lgkmcnt(0)
    v_readfirstlane_b32 s54, v10
    s_nop 0
    s_and_b32 s54, s54, 3
    s_cmp_lg_u32 s54, 3
    s_cbranch_scc1 pub_25
    buffer_atomic_add v8, v11, s[56:59], s53 offen sc1
pub_25:
    s_mov_b64 exec, -1
    s_barrier
    ds_read_b128 v[136:139], v17 offset:0
    ds_read_b128 v[140:143], v17 offset:2048
    ds_read_b128 v[144:147], v17 offset:4096
    ds_read_b128 v[148:151], v17 offset:6144
    ds_read_b64_tr_b16 v[152:153], v18 offset:0
    ds_read_b64_tr_b16 v[154:155], v18 offset:7168
    ds_read_b64_tr_b16 v[156:157], v19 offset:32
    ds_read_b64_tr_b16 v[158:159], v19 offset:7200
    ds_read_b64_tr_b16 v[160:161], v18 offset:64
    ds_read_b64_tr_b16 v[162:163], v18 offset:7232
    ds_read_b64_tr_b16 v[164:165], v19 offset:96
    ds_read_b64_tr_b16 v[166:167], v19 offset:7264
    ds_read_b64_tr_b16 v[168:169], v18 offset:128
    ds_read_b64_tr_b16 v[170:171], v18 offset:7296
    ds_read_b64_tr_b16 v[172:173], v19 offset:160
    ds_read_b64_tr_b16 v[174:175], v19 offset:7328
    ds_read_b64_tr_b16 v[176:177], v18 offset:192
    ds_read_b64_tr_b16 v[178:179], v18 offset:7360
    s_waitcnt lgkmcnt(12)
mm_26:
    v_mfma_f32_16x16x32_bf16 v[24:27], v[152:155], v[136:139], v[24:27]
    ds_read_b128 v[180:183], v17 offset:1024
    s_add_u32 s42, s42, 16384
    v_mfma_f32_16x16x32_bf16 v[52:55], v[152:155], v[140:143], v[52:55]
    ds_read_b128 v[184:187], v17 offset:3072
    s_cmp_eq_u32 s42, 49152
    v_mfma_f32_16x16x32_bf16 v[80:83], v[152:155], v[144:147], v[80:83]
    ds_read_b128 v[188:191], v17 offset:5120
    s_cselect_b32 s42, 0, s42
    v_mfma_f32_16x16x32_bf16 v[108:111], v[152:155], v[148:151], v[108:111]
    ds_read_b128 v[192:195], v17 offset:7168
    s_waitcnt lgkmcnt(14)
    v_mfma_f32_16x16x32_bf16 v[112:115], v[156:159], v[148:151], v[112:115]
    ds_read_b64_tr_b16 v[196:197], v18 offset:14336
    s_add_u32 s48, s48, 28672
    v_mfma_f32_16x16x32_bf16 v[84:87], v[156:159], v[144:147], v[84:87]
    ds_read_b64_tr_b16 v[198:199], v18 offset:21504
    s_cmp_eq_u32 s48, 86016
    v_mfma_f32_16x16x32_bf16 v[56:59], v[156:159], v[140:143], v[56:59]
    ds_read_b64_tr_b16 v[200:201], v19 offset:14368
    s_cselect_b32 s48, 0, s48
    v_mfma_f32_16x16x32_bf16 v[28:31], v[156:159], v[136:139], v[28:31]
    ds_read_b64_tr_b16 v[202:203], v19 offset:21536
    s_waitcnt lgkmcnt(8)
    v_mfma_f32_16x16x32_bf16 v[32:35], v[160:163], v[136:139], v[32:35]
    ds_read_b64_tr_b16 v[204:205], v18 offset:14400
    v_add_u32 v17, s42, v12
    v_mfma_f32_16x16x32_bf16 v[60:63], v[160:163], v[140:143], v[60:63]
    ds_read_b64_tr_b16 v[206:207], v18 offset:21568
    v_mfma_f32_16x16x32_bf16 v[88:91], v[160:163], v[144:147], v[88:91]
    ds_read_b64_tr_b16 v[208:209], v19 offset:14432
    v_mfma_f32_16x16x32_bf16 v[116:119], v[160:163], v[148:151], v[116:119]
    ds_read_b64_tr_b16 v[210:211], v19 offset:21600
    v_mfma_f32_16x16x32_bf16 v[120:123], v[164:167], v[148:151], v[120:123]
    ds_read_b64_tr_b16 v[212:213], v18 offset:14464
    v_mfma_f32_16x16x32_bf16 v[92:95], v[164:167], v[144:147], v[92:95]
    ds_read_b64_tr_b16 v[214:215], v18 offset:21632
    v_mfma_f32_16x16x32_bf16 v[64:67], v[164:167], v[140:143], v[64:67]
    ds_read_b64_tr_b16 v[216:217], v19 offset:14496
    v_mfma_f32_16x16x32_bf16 v[36:39], v[164:167], v[136:139], v[36:39]
    ds_read_b64_tr_b16 v[218:219], v19 offset:21664
    v_add_u32 v19, s48, v14
    v_mfma_f32_16x16x32_bf16 v[40:43], v[168:171], v[136:139], v[40:43]
    ds_read_b64_tr_b16 v[220:221], v18 offset:14528
    v_mfma_f32_16x16x32_bf16 v[68:71], v[168:171], v[140:143], v[68:71]
    ds_read_b64_tr_b16 v[222:223], v18 offset:21696
    v_add_u32 v18, s48, v13
    v_mfma_f32_16x16x32_bf16 v[96:99], v[168:171], v[144:147], v[96:99]
    v_mfma_f32_16x16x32_bf16 v[124:127], v[168:171], v[148:151], v[124:127]
    v_mfma_f32_16x16x32_bf16 v[128:131], v[172:175], v[148:151], v[128:131]
    v_mfma_f32_16x16x32_bf16 v[100:103], v[172:175], v[144:147], v[100:103]
    v_mfma_f32_16x16x32_bf16 v[72:75], v[172:175], v[140:143], v[72:75]
    v_mfma_f32_16x16x32_bf16 v[44:47], v[172:175], v[136:139], v[44:47]
    v_mfma_f32_16x16x32_bf16 v[48:51], v[176:179], v[136:139], v[48:51]
    v_mfma_f32_16x16x32_bf16 v[76:79], v[176:179], v[140:143], v[76:79]
    v_mfma_f32_16x16x32_bf16 v[104:107], v[176:179], v[144:147], v[104:107]
    v_mfma_f32_16x16x32_bf16 v[132:135], v[176:179], v[148:151], v[132:135]
    s_waitcnt lgkmcnt(12)
    v_mfma_f32_16x16x32_bf16 v[24:27], v[196:199], v[180:183], v[24:27]
    s_add_u32 s43, s43, 1
    s_cmp_lt_u32 s43, 15
    v_mfma_f32_16x16x32_bf16 v[52:55], v[196:199], v[184:187], v[52:55]
    v_mfma_f32_16x16x32_bf16 v[80:83], v[196:199], v[188:191], v[80:83]
    v_mfma_f32_16x16x32_bf16 v[108:111], v[196:199], v[192:195], v[108:111]
    s_waitcnt lgkmcnt(0)
    s_barrier
    v_mfma_f32_16x16x32_bf16 v[112:115], v[200:203], v[192:195], v[112:115]
    ds_read_b128 v[136:139], v17 offset:0
    v_mfma_f32_16x16x32_bf16 v[84:87], v[200:203], v[188:191], v[84:87]
    ds_read_b128 v[140:143], v17 offset:2048
    v_mfma_f32_16x16x32_bf16 v[56:59], v[200:203], v[184:187], v[56:59]
    ds_read_b128 v[144:147], v17 offset:4096
    v_mfma_f32_16x16x32_bf16 v[28:31], v[200:203], v[180:183], v[28:31]
    ds_read_b128 v[148:151], v17 offset:6144
    v_mfma_f32_16x16x32_bf16 v[32:35], v[204:207], v[180:183], v[32:35]
    ds_read_b64_tr_b16 v[152:153], v18 offset:0
    v_mfma_f32_16x16x32_bf16 v[60:63], v[204:207], v[184:187], v[60:63]
    ds_read_b64_tr_b16 v[154:155], v18 offset:7168
    v_mfma_f32_16x16x32_bf16 v[88:91], v[204:207], v[188:191], v[88:91]
    ds_read_b64_tr_b16 v[156:157], v19 offset:32
    v_mfma_f32_16x16x32_bf16 v[116:119], v[204:207], v[192:195], v[116:119]
    ds_read_b64_tr_b16 v[158:159], v19 offset:7200
    v_mfma_f32_16x16x32_bf16 v[120:123], v[208:211], v[192:195], v[120:123]
    ds_read_b64_tr_b16 v[160:161], v18 offset:64
    v_mfma_f32_16x16x32_bf16 v[92:95], v[208:211], v[188:191], v[92:95]
    ds_read_b64_tr_b16 v[162:163], v18 offset:7232
    v_mfma_f32_16x16x32_bf16 v[64:67], v[208:211], v[184:187], v[64:67]
    ds_read_b64_tr_b16 v[164:165], v19 offset:96
    v_mfma_f32_16x16x32_bf16 v[36:39], v[208:211], v[180:183], v[36:39]
    ds_read_b64_tr_b16 v[166:167], v19 offset:7264
    v_mfma_f32_16x16x32_bf16 v[40:43], v[212:215], v[180:183], v[40:43]
    ds_read_b64_tr_b16 v[168:169], v18 offset:128
    v_mfma_f32_16x16x32_bf16 v[68:71], v[212:215], v[184:187], v[68:71]
    ds_read_b64_tr_b16 v[170:171], v18 offset:7296
    v_mfma_f32_16x16x32_bf16 v[96:99], v[212:215], v[188:191], v[96:99]
    ds_read_b64_tr_b16 v[172:173], v19 offset:160
    v_mfma_f32_16x16x32_bf16 v[124:127], v[212:215], v[192:195], v[124:127]
    ds_read_b64_tr_b16 v[174:175], v19 offset:7328
    v_mfma_f32_16x16x32_bf16 v[128:131], v[216:219], v[192:195], v[128:131]
    ds_read_b64_tr_b16 v[176:177], v18 offset:192
    v_mfma_f32_16x16x32_bf16 v[100:103], v[216:219], v[188:191], v[100:103]
    ds_read_b64_tr_b16 v[178:179], v18 offset:7360
    v_mfma_f32_16x16x32_bf16 v[72:75], v[216:219], v[184:187], v[72:75]
    v_mfma_f32_16x16x32_bf16 v[44:47], v[216:219], v[180:183], v[44:47]
    v_mfma_f32_16x16x32_bf16 v[48:51], v[220:223], v[180:183], v[48:51]
    v_mfma_f32_16x16x32_bf16 v[76:79], v[220:223], v[184:187], v[76:79]
    v_mfma_f32_16x16x32_bf16 v[104:107], v[220:223], v[188:191], v[104:107]
    v_mfma_f32_16x16x32_bf16 v[132:135], v[220:223], v[192:195], v[132:135]
    s_waitcnt lgkmcnt(12)
    s_cbranch_scc1 mm_26
    v_mfma_f32_16x16x32_bf16 v[24:27], v[152:155], v[136:139], v[24:27]
    ds_read_b128 v[180:183], v17 offset:1024
    v_mfma_f32_16x16x32_bf16 v[52:55], v[152:155], v[140:143], v[52:55]
    ds_read_b128 v[184:187], v17 offset:3072
    v_mfma_f32_16x16x32_bf16 v[80:83], v[152:155], v[144:147], v[80:83]
    ds_read_b128 v[188:191], v17 offset:5120
    v_mfma_f32_16x16x32_bf16 v[108:111], v[152:155], v[148:151], v[108:111]
    ds_read_b128 v[192:195], v17 offset:7168
    s_waitcnt lgkmcnt(14)
    v_mfma_f32_16x16x32_bf16 v[112:115], v[156:159], v[148:151], v[112:115]
    ds_read_b64_tr_b16 v[196:197], v18 offset:14336
    v_mfma_f32_16x16x32_bf16 v[84:87], v[156:159], v[144:147], v[84:87]
    ds_read_b64_tr_b16 v[198:199], v18 offset:21504
    v_mfma_f32_16x16x32_bf16 v[56:59], v[156:159], v[140:143], v[56:59]
    ds_read_b64_tr_b16 v[200:201], v19 offset:14368
    v_mfma_f32_16x16x32_bf16 v[28:31], v[156:159], v[136:139], v[28:31]
    ds_read_b64_tr_b16 v[202:203], v19 offset:21536
    s_waitcnt lgkmcnt(8)
    v_mfma_f32_16x16x32_bf16 v[32:35], v[160:163], v[136:139], v[32:35]
    ds_read_b64_tr_b16 v[204:205], v18 offset:14400
    v_mfma_f32_16x16x32_bf16 v[60:63], v[160:163], v[140:143], v[60:63]
    ds_read_b64_tr_b16 v[206:207], v18 offset:21568
    v_mfma_f32_16x16x32_bf16 v[88:91], v[160:163], v[144:147], v[88:91]
    ds_read_b64_tr_b16 v[208:209], v19 offset:14432
    v_mfma_f32_16x16x32_bf16 v[116:119], v[160:163], v[148:151], v[116:119]
    ds_read_b64_tr_b16 v[210:211], v19 offset:21600
    v_mfma_f32_16x16x32_bf16 v[120:123], v[164:167], v[148:151], v[120:123]
    ds_read_b64_tr_b16 v[212:213], v18 offset:14464
    v_mfma_f32_16x16x32_bf16 v[92:95], v[164:167], v[144:147], v[92:95]
    ds_read_b64_tr_b16 v[214:215], v18 offset:21632
    v_mfma_f32_16x16x32_bf16 v[64:67], v[164:167], v[140:143], v[64:67]
    ds_read_b64_tr_b16 v[216:217], v19 offset:14496
    v_mfma_f32_16x16x32_bf16 v[36:39], v[164:167], v[136:139], v[36:39]
    ds_read_b64_tr_b16 v[218:219], v19 offset:21664
    v_mfma_f32_16x16x32_bf16 v[40:43], v[168:171], v[136:139], v[40:43]
    ds_read_b64_tr_b16 v[220:221], v18 offset:14528
    v_mfma_f32_16x16x32_bf16 v[68:71], v[168:171], v[140:143], v[68:71]
    ds_read_b64_tr_b16 v[222:223], v18 offset:21696
    v_mfma_f32_16x16x32_bf16 v[96:99], v[168:171], v[144:147], v[96:99]
    v_mfma_f32_16x16x32_bf16 v[124:127], v[168:171], v[148:151], v[124:127]
    v_mfma_f32_16x16x32_bf16 v[128:131], v[172:175], v[148:151], v[128:131]
    v_mfma_f32_16x16x32_bf16 v[100:103], v[172:175], v[144:147], v[100:103]
    v_mfma_f32_16x16x32_bf16 v[72:75], v[172:175], v[140:143], v[72:75]
    v_mfma_f32_16x16x32_bf16 v[44:47], v[172:175], v[136:139], v[44:47]
    v_mfma_f32_16x16x32_bf16 v[48:51], v[176:179], v[136:139], v[48:51]
    v_mfma_f32_16x16x32_bf16 v[76:79], v[176:179], v[140:143], v[76:79]
    v_mfma_f32_16x16x32_bf16 v[104:107], v[176:179], v[144:147], v[104:107]
    v_mfma_f32_16x16x32_bf16 v[132:135], v[176:179], v[148:151], v[132:135]
    s_waitcnt lgkmcnt(0)
    s_barrier
    v_mfma_f32_16x16x32_bf16 v[24:27], v[196:199], v[180:183], v[24:27]
    ds_read_b128 v[136:139], v6 offset:0
    v_mfma_f32_16x16x32_bf16 v[52:55], v[196:199], v[184:187], v[52:55]
    ds_read_b128 v[140:143], v6 offset:64
    v_mfma_f32_16x16x32_bf16 v[80:83], v[196:199], v[188:191], v[80:83]
    ds_read_b128 v[144:147], v6 offset:128
    v_mfma_f32_16x16x32_bf16 v[108:111], v[196:199], v[192:195], v[108:111]
    ds_read_b128 v[148:151], v6 offset:192
    v_mfma_f32_16x16x32_bf16 v[112:115], v[200:203], v[192:195], v[112:115]
    ds_read_b128 v[152:155], v6 offset:256
    v_mfma_f32_16x16x32_bf16 v[84:87], v[200:203], v[188:191], v[84:87]
    ds_read_b128 v[156:159], v6 offset:320
    v_mfma_f32_16x16x32_bf16 v[56:59], v[200:203], v[184:187], v[56:59]
    ds_read_b128 v[160:163], v6 offset:384
    v_mfma_f32_16x16x32_bf16 v[28:31], v[200:203], v[180:183], v[28:31]
    ds_read_b128 v[164:167], v7 offset:0
    v_mfma_f32_16x16x32_bf16 v[32:35], v[204:207], v[180:183], v[32:35]
    ds_read_b128 v[168:171], v7 offset:256
    v_mfma_f32_16x16x32_bf16 v[60:63], v[204:207], v[184:187], v[60:63]
    ds_read_b128 v[172:175], v7 offset:512
    v_mfma_f32_16x16x32_bf16 v[88:91], v[204:207], v[188:191], v[88:91]
    ds_read_b128 v[176:179], v7 offset:768
    v_mov_b32 v13, v240
    v_mfma_f32_16x16x32_bf16 v[116:119], v[204:207], v[192:195], v[116:119]
    v_add_u32 v18, 0, v240
    v_mov_b32 v14, v241
    v_mfma_f32_16x16x32_bf16 v[120:123], v[208:211], v[192:195], v[120:123]
    v_add_u32 v19, 0, v241
    v_mov_b32 v15, v242
    v_mfma_f32_16x16x32_bf16 v[92:95], v[208:211], v[188:191], v[92:95]
    v_add_u32 v20, 0, v242
    v_mov_b32 v16, v243
    v_mfma_f32_16x16x32_bf16 v[64:67], v[208:211], v[184:187], v[64:67]
    v_add_u32 v21, 0, v243
    s_mov_b32 s42, 0
    s_mov_b32 s43, 0
    v_mfma_f32_16x16x32_bf16 v[36:39], v[208:211], v[180:183], v[36:39]
    s_mov_b32 s48, 0
    v_mov_b32 v17, v12
    v_and_b32 v199, 7, v0
    v_mfma_f32_16x16x32_bf16 v[40:43], v[212:215], v[180:183], v[40:43]
    v_lshrrev_b32 v228, 6, v0
    v_lshlrev_b32 v228, 4, v228
    v_mfma_f32_16x16x32_bf16 v[68:71], v[212:215], v[184:187], v[68:71]
    v_bfe_u32 v229, v0, 3, 3
    v_add_u32 v228, v228, v229
    s_lshr_b32 s78, s29, 1
    v_mfma_f32_16x16x32_bf16 v[96:99], v[212:215], v[188:191], v[96:99]
    s_lshl_b32 s78, s78, 16
    s_and_b32 s79, s29, 1
    s_lshl_b32 s79, s79, 7
    v_mfma_f32_16x16x32_bf16 v[124:127], v[212:215], v[192:195], v[124:127]
    s_add_u32 s78, s78, s79
    s_lshr_b32 s79, s30, 1
    s_lshl_b32 s79, s79, 13
    v_mfma_f32_16x16x32_bf16 v[128:131], v[216:219], v[192:195], v[128:131]
    s_add_u32 s78, s78, s79
    v_lshlrev_b32 v196, 8, v228
    v_lshl_add_u32 v196, v199, 4, v196
    v_mfma_f32_16x16x32_bf16 v[100:103], v[216:219], v[188:191], v[100:103]
    v_add_u32 v196, s78, v196
    v_mfma_f32_16x16x32_bf16 v[72:75], v[216:219], v[184:187], v[72:75]
    v_mfma_f32_16x16x32_bf16 v[44:47], v[216:219], v[180:183], v[44:47]
    v_mfma_f32_16x16x32_bf16 v[48:51], v[220:223], v[180:183], v[48:51]
    v_mfma_f32_16x16x32_bf16 v[76:79], v[220:223], v[184:187], v[76:79]
    v_mfma_f32_16x16x32_bf16 v[104:107], v[220:223], v[188:191], v[104:107]
    v_mfma_f32_16x16x32_bf16 v[132:135], v[220:223], v[192:195], v[132:135]
    s_waitcnt lgkmcnt(0)
    s_cmp_eq_u32 s35, 1
    s_cbranch_scc1 G3_e1
    v_pk_fma_f32 v[24:25], v[164:165], v[136:137], v[24:25] op_sel_hi:[0,1,1] neg_lo:[1,0,0] neg_hi:[1,0,0]
    v_pk_fma_f32 v[26:27], v[164:165], v[138:139], v[26:27] op_sel_hi:[0,1,1] neg_lo:[1,0,0] neg_hi:[1,0,0]
    v_pk_mul_f32 v[226:227], v[24:25], v[24:25]
    v_pk_mul_f32 v[228:229], v[26:27], v[26:27]
    v_pk_fma_f32 v[226:227], v[226:227], v[166:167], v[166:167] op_sel:[0,1,0] op_sel_hi:[1,1,0]
    v_pk_fma_f32 v[228:229], v[228:229], v[166:167], v[166:167] op_sel:[0,1,0] op_sel_hi:[1,1,0]
    v_pk_mul_f32 v[226:227], v[226:227], v[24:25]
    v_pk_mul_f32 v[228:229], v[228:229], v[26:27]
    v_exp_f32 v226, v226
    v_exp_f32 v227, v227
    v_exp_f32 v228, v228
    v_exp_f32 v229, v229
    v_pk_fma_f32 v[226:227], v[226:227], v[164:165], v[164:165] op_sel:[0,1,1] op_sel_hi:[1,1,1]
    v_pk_fma_f32 v[228:229], v[228:229], v[164:165], v[164:165] op_sel:[0,1,1] op_sel_hi:[1,1,1]
    v_rcp_f32 v226, v226
    v_rcp_f32 v227, v227
    v_rcp_f32 v228, v228
    v_rcp_f32 v229, v229
    v_pk_mul_f32 v[24:25], v[24:25], v[226:227]
    v_pk_mul_f32 v[26:27], v[26:27], v[228:229]
    v_pk_fma_f32 v[28:29], v[164:165], v[140:141], v[28:29] op_sel_hi:[0,1,1] neg_lo:[1,0,0] neg_hi:[1,0,0]
    v_pk_fma_f32 v[30:31], v[164:165], v[142:143], v[30:31] op_sel_hi:[0,1,1] neg_lo:[1,0,0] neg_hi:[1,0,0]
    v_pk_mul_f32 v[226:227], v[28:29], v[28:29]
    v_pk_mul_f32 v[228:229], v[30:31], v[30:31]
    v_pk_fma_f32 v[226:227], v[226:227], v[166:167], v[166:167] op_sel:[0,1,0] op_sel_hi:[1,1,0]
    v_pk_fma_f32 v[228:229], v[228:229], v[166:167], v[166:167] op_sel:[0,1,0] op_sel_hi:[1,1,0]
    v_pk_mul_f32 v[226:227], v[226:227], v[28:29]
    v_pk_mul_f32 v[228:229], v[228:229], v[30:31]
    v_exp_f32 v226, v226
    v_exp_f32 v227, v227
    v_exp_f32 v228, v228
    v_exp_f32 v229, v229
    v_pk_fma_f32 v[226:227], v[226:227], v[164:165], v[164:165] op_sel:[0,1,1] op_sel_hi:[1,1,1]
    v_pk_fma_f32 v[228:229], v[228:229], v[164:165], v[164:165] op_sel:[0,1,1] op_sel_hi:[1,1,1]
    v_rcp_f32 v226, v226
    v_rcp_f32 v227, v227
    v_rcp_f32 v228, v228
    v_rcp_f32 v229, v229
    v_pk_mul_f32 v[28:29], v[28:29], v[226:227]
    v_pk_mul_f32 v[30:31], v[30:31], v[228:229]
    v_cvt_pk_bf16_f32 v24, v24, v25
    v_cvt_pk_bf16_f32 v25, v26, v27
    v_cvt_pk_bf16_f32 v26, v28, v29
    v_cvt_pk_bf16_f32 v27, v30, v31
    v_or_b32 v24, 1, v24
    ds_write_b128 v244, v[24:27] offset:0
    s_add_u32 s36, s44, 0
    buffer_store_dwordx4 v[24:27], v2, s[16:19], s36 offen sc1
    v_pk_fma_f32 v[52:53], v[168:169], v[136:137], v[52:53] op_sel_hi:[0,1,1] neg_lo:[1,0,0] neg_hi:[1,0,0]
    v_pk_fma_f32 v[54:55], v[168:169], v[138:139], v[54:55] op_sel_hi:[0,1,1] neg_lo:[1,0,0] neg_hi:[1,0,0]
    v_pk_mul_f32 v[226:227], v[52:53], v[52:53]
    v_pk_mul_f32 v[228:229], v[54:55], v[54:55]
    v_pk_fma_f32 v[226:227], v[226:227], v[170:171], v[170:171] op_sel:[0,1,0] op_sel_hi:[1,1,0]
    v_pk_fma_f32 v[228:229], v[228:229], v[170:171], v[170:171] op_sel:[0,1,0] op_sel_hi:[1,1,0]
    v_pk_mul_f32 v[226:227], v[226:227], v[52:53]
    v_pk_mul_f32 v[228:229], v[228:229], v[54:55]
    v_exp_f32 v226, v226
    v_exp_f32 v227, v227
    v_exp_f32 v228, v228
    v_exp_f32 v229, v229
    v_pk_fma_f32 v[226:227], v[226:227], v[168:169], v[168:169] op_sel:[0,1,1] op_sel_hi:[1,1,1]
    v_pk_fma_f32 v[228:229], v[228:229], v[168:169], v[168:169] op_sel:[0,1,1] op_sel_hi:[1,1,1]
    v_rcp_f32 v226, v226
    v_rcp_f32 v227, v227
    v_rcp_f32 v228, v228
    v_rcp_f32 v229, v229
    v_pk_mul_f32 v[52:53], v[52:53], v[226:227]
    v_pk_mul_f32 v[54:55], v[54:55], v[228:229]
    v_pk_fma_f32 v[56:57], v[168:169], v[140:141], v[56:57] op_sel_hi:[0,1,1] neg_lo:[1,0,0] neg_hi:[1,0,0]
    v_pk_fma_f32 v[58:59], v[168:169], v[142:143], v[58:59] op_sel_hi:[0,1,1] neg_lo:[1,0,0] neg_hi:[1,0,0]
    v_pk_mul_f32 v[226:227], v[56:57], v[56:57]
    v_pk_mul_f32 v[228:229], v[58:59], v[58:59]
    v_pk_fma_f32 v[226:227], v[226:227], v[170:171], v[170:171] op_sel:[0,1,0] op_sel_hi:[1,1,0]
    v_pk_fma_f32 v[228:229], v[228:229], v[170:171], v[170:171] op_sel:[0,1,0] op_sel_hi:[1,1,0]
    v_pk_mul_f32 v[226:227], v[226:227], v[56:57]
    v_pk_mul_f32 v[228:229], v[228:229], v[58:59]
    v_exp_f32 v226, v226
    v_exp_f32 v227, v227
    v_exp_f32 v228, v228
    v_exp_f32 v229, v229
    v_pk_fma_f32 v[226:227], v[226:227], v[168:169], v[168:169] op_sel:[0,1,1] op_sel_hi:[1,1,1]
    v_pk_fma_f32 v[228:229], v[228:229], v[168:169], v[168:169] op_sel:[0,1,1] op_sel_hi:[1,1,1]
    v_rcp_f32 v226, v226
    v_rcp_f32 v227, v227
    v_rcp_f32 v228, v228
    v_rcp_f32 v229, v229
    v_pk_mul_f32 v[56:57], v[56:57], v[226:227]
    v_pk_mul_f32 v[58:59], v[58:59], v[228:229]
    v_cvt_pk_bf16_f32 v52, v52, v53
    v_cvt_pk_bf16_f32 v53, v54, v55
    v_cvt_pk_bf16_f32 v54, v56, v57
    v_cvt_pk_bf16_f32 v55, v58, v59
    v_or_b32 v52, 1, v52
    ds_write_b128 v244, v[52:55] offset:2048
    s_add_u32 s36, s44, 229376
    buffer_store_dwordx4 v[52:55], v2, s[16:19], s36 offen sc1
    v_pk_fma_f32 v[80:81], v[172:173], v[136:137], v[80:81] op_sel_hi:[0,1,1] neg_lo:[1,0,0] neg_hi:[1,0,0]
    v_pk_fma_f32 v[82:83], v[172:173], v[138:139], v[82:83] op_sel_hi:[0,1,1] neg_lo:[1,0,0] neg_hi:[1,0,0]
    v_pk_mul_f32 v[226:227], v[80:81], v[80:81]
    v_pk_mul_f32 v[228:229], v[82:83], v[82:83]
    v_pk_fma_f32 v[226:227], v[226:227], v[174:175], v[174:175] op_sel:[0,1,0] op_sel_hi:[1,1,0]
    v_pk_fma_f32 v[228:229], v[228:229], v[174:175], v[174:175] op_sel:[0,1,0] op_sel_hi:[1,1,0]
    v_pk_mul_f32 v[226:227], v[226:227], v[80:81]
    v_pk_mul_f32 v[228:229], v[228:229], v[82:83]
    v_exp_f32 v226, v226
    v_exp_f32 v227, v227
    v_exp_f32 v228, v228
    v_exp_f32 v229, v229
    v_pk_fma_f32 v[226:227], v[226:227], v[172:173], v[172:173] op_sel:[0,1,1] op_sel_hi:[1,1,1]
    v_pk_fma_f32 v[228:229], v[228:229], v[172:173], v[172:173] op_sel:[0,1,1] op_sel_hi:[1,1,1]
    v_rcp_f32 v226, v226
    v_rcp_f32 v227, v227
    v_rcp_f32 v228, v228
    v_rcp_f32 v229, v229
    v_pk_mul_f32 v[80:81], v[80:81], v[226:227]
    v_pk_mul_f32 v[82:83], v[82:83], v[228:229]
    v_pk_fma_f32 v[84:85], v[172:173], v[140:141], v[84:85] op_sel_hi:[0,1,1] neg_lo:[1,0,0] neg_hi:[1,0,0]
    v_pk_fma_f32 v[86:87], v[172:173], v[142:143], v[86:87] op_sel_hi:[0,1,1] neg_lo:[1,0,0] neg_hi:[1,0,0]
    v_pk_mul_f32 v[226:227], v[84:85], v[84:85]
    v_pk_mul_f32 v[228:229], v[86:87], v[86:87]
    v_pk_fma_f32 v[226:227], v[226:227], v[174:175], v[174:175] op_sel:[0,1,0] op_sel_hi:[1,1,0]
    v_pk_fma_f32 v[228:229], v[228:229], v[174:175], v[174:175] op_sel:[0,1,0] op_sel_hi:[1,1,0]
    v_pk_mul_f32 v[226:227], v[226:227], v[84:85]
    v_pk_mul_f32 v[228:229], v[228:229], v[86:87]
    v_exp_f32 v226, v226
    v_exp_f32 v227, v227
    v_exp_f32 v228, v228
    v_exp_f32 v229, v229
    v_pk_fma_f32 v[226:227], v[226:227], v[172:173], v[172:173] op_sel:[0,1,1] op_sel_hi:[1,1,1]
    v_pk_fma_f32 v[228:229], v[228:229], v[172:173], v[172:173] op_sel:[0,1,1] op_sel_hi:[1,1,1]
    v_rcp_f32 v226, v226
    v_rcp_f32 v227, v227
    v_rcp_f32 v228, v228
    v_rcp_f32 v229, v229
    v_pk_mul_f32 v[84:85], v[84:85], v[226:227]
    v_pk_mul_f32 v[86:87], v[86:87], v[228:229]
    v_cvt_pk_bf16_f32 v80, v80, v81
    v_cvt_pk_bf16_f32 v81, v82, v83
    v_cvt_pk_bf16_f32 v82, v84, v85
    v_cvt_pk_bf16_f32 v83, v86, v87
    v_or_b32 v80, 1, v80
    ds_write_b128 v244, v[80:83] offset:4096
    s_add_u32 s36, s44, 458752
    buffer_store_dwordx4 v[80:83], v2, s[16:19], s36 offen sc1
    v_pk_fma_f32 v[108:109], v[176:177], v[136:137], v[108:109] op_sel_hi:[0,1,1] neg_lo:[1,0,0] neg_hi:[1,0,0]
    v_pk_fma_f32 v[110:111], v[176:177], v[138:139], v[110:111] op_sel_hi:[0,1,1] neg_lo:[1,0,0] neg_hi:[1,0,0]
    v_pk_mul_f32 v[226:227], v[108:109], v[108:109]
    v_pk_mul_f32 v[228:229], v[110:111], v[110:111]
    v_pk_fma_f32 v[226:227], v[226:227], v[178:179], v[178:179] op_sel:[0,1,0] op_sel_hi:[1,1,0]
    v_pk_fma_f32 v[228:229], v[228:229], v[178:179], v[178:179] op_sel:[0,1,0] op_sel_hi:[1,1,0]
    v_pk_mul_f32 v[226:227], v[226:227], v[108:109]
    v_pk_mul_f32 v[228:229], v[228:229], v[110:111]
    v_exp_f32 v226, v226
    v_exp_f32 v227, v227
    v_exp_f32 v228, v228
    v_exp_f32 v229, v229
    v_pk_fma_f32 v[226:227], v[226:227], v[176:177], v[176:177] op_sel:[0,1,1] op_sel_hi:[1,1,1]
    v_pk_fma_f32 v[228:229], v[228:229], v[176:177], v[176:177] op_sel:[0,1,1] op_sel_hi:[1,1,1]
    v_rcp_f32 v226, v226
    v_rcp_f32 v227, v227
    v_rcp_f32 v228, v228
    v_rcp_f32 v229, v229
    v_pk_mul_f32 v[108:109], v[108:109], v[226:227]
    v_pk_mul_f32 v[110:111], v[110:111], v[228:229]
    v_pk_fma_f32 v[112:113], v[176:177], v[140:141], v[112:113] op_sel_hi:[0,1,1] neg_lo:[1,0,0] neg_hi:[1,0,0]
    v_pk_fma_f32 v[114:115], v[176:177], v[142:143], v[114:115] op_sel_hi:[0,1,1] neg_lo:[1,0,0] neg_hi:[1,0,0]
    v_pk_mul_f32 v[226:227], v[112:113], v[112:113]
    v_pk_mul_f32 v[228:229], v[114:115], v[114:115]
    v_pk_fma_f32 v[226:227], v[226:227], v[178:179], v[178:179] op_sel:[0,1,0] op_sel_hi:[1,1,0]
    v_pk_fma_f32 v[228:229], v[228:229], v[178:179], v[178:179] op_sel:[0,1,0] op_sel_hi:[1,1,0]
    v_pk_mul_f32 v[226:227], v[226:227], v[112:113]
    v_pk_mul_f32 v[228:229], v[228:229], v[114:115]
    v_exp_f32 v226, v226
    v_exp_f32 v227, v227
    v_exp_f32 v228, v228
    v_exp_f32 v229, v229
    v_pk_fma_f32 v[226:227], v[226:227], v[176:177], v[176:177] op_sel:[0,1,1] op_sel_hi:[1,1,1]
    v_pk_fma_f32 v[228:229], v[228:229], v[176:177], v[176:177] op_sel:[0,1,1] op_sel_hi:[1,1,1]
    v_rcp_f32 v226, v226
    v_rcp_f32 v227, v227
    v_rcp_f32 v228, v228
    v_rcp_f32 v229, v229
    v_pk_mul_f32 v[112:113], v[112:113], v[226:227]
    v_pk_mul_f32 v[114:115], v[114:115], v[228:229]
    v_cvt_pk_bf16_f32 v108, v108, v109
    v_cvt_pk_bf16_f32 v109, v110, v111
    v_cvt_pk_bf16_f32 v110, v112, v113
    v_cvt_pk_bf16_f32 v111, v114, v115
    ds_write_b128 v244, v[108:111] offset:6144
    s_add_u32 s36, s44, 688128
    buffer_store_dwordx4 v[108:111], v2, s[16:19], s36 offen sc1
    v_pk_fma_f32 v[32:33], v[164:165], v[144:145], v[32:33] op_sel_hi:[0,1,1] neg_lo:[1,0,0] neg_hi:[1,0,0]
    v_pk_fma_f32 v[34:35], v[164:165], v[146:147], v[34:35] op_sel_hi:[0,1,1] neg_lo:[1,0,0] neg_hi:[1,0,0]
    v_pk_mul_f32 v[226:227], v[32:33], v[32:33]
    v_pk_mul_f32 v[228:229], v[34:35], v[34:35]
    v_pk_fma_f32 v[226:227], v[226:227], v[166:167], v[166:167] op_sel:[0,1,0] op_sel_hi:[1,1,0]
    v_pk_fma_f32 v[228:229], v[228:229], v[166:167], v[166:167] op_sel:[0,1,0] op_sel_hi:[1,1,0]
    v_pk_mul_f32 v[226:227], v[226:227], v[32:33]
    v_pk_mul_f32 v[228:229], v[228:229], v[34:35]
    v_exp_f32 v226, v226
    v_exp_f32 v227, v227
    v_exp_f32 v228, v228
    v_exp_f32 v229, v229
    v_pk_fma_f32 v[226:227], v[226:227], v[164:165], v[164:165] op_sel:[0,1,1] op_sel_hi:[1,1,1]
    v_pk_fma_f32 v[228:229], v[228:229], v[164:165], v[164:165] op_sel:[0,1,1] op_sel_hi:[1,1,1]
    v_rcp_f32 v226, v226
    v_rcp_f32 v227, v227
    v_rcp_f32 v228, v228
    v_rcp_f32 v229, v229
    v_pk_mul_f32 v[32:33], v[32:33], v[226:227]
    v_pk_mul_f32 v[34:35], v[34:35], v[228:229]
    v_pk_fma_f32 v[36:37], v[164:165], v[148:149], v[36:37] op_sel_hi:[0,1,1] neg_lo:[1,0,0] neg_hi:[1,0,0]
    v_pk_fma_f32 v[38:39], v[164:165], v[150:151], v[38:39] op_sel_hi:[0,1,1] neg_lo:[1,0,0] neg_hi:[1,0,0]
    v_pk_mul_f32 v[226:227], v[36:37], v[36:37]
    v_pk_mul_f32 v[228:229], v[38:39], v[38:39]
    v_pk_fma_f32 v[226:227], v[226:227], v[166:167], v[166:167] op_sel:[0,1,0] op_sel_hi:[1,1,0]
    v_pk_fma_f32 v[228:229], v[228:229], v[166:167], v[166:167] op_sel:[0,1,0] op_sel_hi:[1,1,0]
    v_pk_mul_f32 v[226:227], v[226:227], v[36:37]
    v_pk_mul_f32 v[228:229], v[228:229], v[38:39]
    v_exp_f32 v226, v226
    v_exp_f32 v227, v227
    v_exp_f32 v228, v228
    v_exp_f32 v229, v229
    v_pk_fma_f32 v[226:227], v[226:227], v[164:165], v[164:165] op_sel:[0,1,1] op_sel_hi:[1,1,1]
    v_pk_fma_f32 v[228:229], v[228:229], v[164:165], v[164:165] op_sel:[0,1,1] op_sel_hi:[1,1,1]
    v_rcp_f32 v226, v226
    v_rcp_f32 v227, v227
    v_rcp_f32 v228, v228
    v_rcp_f32 v229, v229
    v_pk_mul_f32 v[36:37], v[36:37], v[226:227]
    v_pk_mul_f32 v[38:39], v[38:39], v[228:229]
    v_cvt_pk_bf16_f32 v32, v32, v33
    v_cvt_pk_bf16_f32 v33, v34, v35
    v_cvt_pk_bf16_f32 v34, v36, v37
    v_cvt_pk_bf16_f32 v35, v38, v39
    v_or_b32 v32, 1, v32
    ds_write_b128 v244, v[32:35] offset:16384
    v_pk_fma_f32 v[60:61], v[168:169], v[144:145], v[60:61] op_sel_hi:[0,1,1] neg_lo:[1,0,0] neg_hi:[1,0,0]
    v_pk_fma_f32 v[62:63], v[168:169], v[146:147], v[62:63] op_sel_hi:[0,1,1] neg_lo:[1,0,0] neg_hi:[1,0,0]
    v_pk_mul_f32 v[226:227], v[60:61], v[60:61]
    v_pk_mul_f32 v[228:229], v[62:63], v[62:63]
    v_pk_fma_f32 v[226:227], v[226:227], v[170:171], v[170:171] op_sel:[0,1,0] op_sel_hi:[1,1,0]
    v_pk_fma_f32 v[228:229], v[228:229], v[170:171], v[170:171] op_sel:[0,1,0] op_sel_hi:[1,1,0]
    v_pk_mul_f32 v[226:227], v[226:227], v[60:61]
    v_pk_mul_f32 v[228:229], v[228:229], v[62:63]
    v_exp_f32 v226, v226
    v_exp_f32 v227, v227
    v_exp_f32 v228, v228
    v_exp_f32 v229, v229
    v_pk_fma_f32 v[226:227], v[226:227], v[168:169], v[168:169] op_sel:[0,1,1] op_sel_hi:[1,1,1]
    v_pk_fma_f32 v[228:229], v[228:229], v[168:169], v[168:169] op_sel:[0,1,1] op_sel_hi:[1,1,1]
    v_rcp_f32 v226, v226
    v_rcp_f32 v227, v227
    v_rcp_f32 v228, v228
    v_rcp_f32 v229, v229
    v_pk_mul_f32 v[60:61], v[60:61], v[226:227]
    v_pk_mul_f32 v[62:63], v[62:63], v[228:229]
    v_pk_fma_f32 v[64:65], v[168:169], v[148:149], v[64:65] op_sel_hi:[0,1,1] neg_lo:[1,0,0] neg_hi:[1,0,0]
    v_pk_fma_f32 v[66:67], v[168:169], v[150:151], v[66:67] op_sel_hi:[0,1,1] neg_lo:[1,0,0] neg_hi:[1,0,0]
    v_pk_mul_f32 v[226:227], v[64:65], v[64:65]
    v_pk_mul_f32 v[228:229], v[66:67], v[66:67]
    v_pk_fma_f32 v[226:227], v[226:227], v[170:171], v[170:171] op_sel:[0,1,0] op_sel_hi:[1,1,0]
    v_pk_fma_f32 v[228:229], v[228:229], v[170:171], v[170:171] op_sel:[0,1,0] op_sel_hi:[1,1,0]
    v_pk_mul_f32 v[226:227], v[226:227], v[64:65]
    v_pk_mul_f32 v[228:229], v[228:229], v[66:67]
    v_exp_f32 v226, v226
    v_exp_f32 v227, v227
    v_exp_f32 v228, v228
    v_exp_f32 v229, v229
    v_pk_fma_f32 v[226:227], v[226:227], v[168:169], v[168:169] op_sel:[0,1,1] op_sel_hi:[1,1,1]
    v_pk_fma_f32 v[228:229], v[228:229], v[168:169], v[168:169] op_sel:[0,1,1] op_sel_hi:[1,1,1]
    v_rcp_f32 v226, v226
    v_rcp_f32 v227, v227
    v_rcp_f32 v228, v228
    v_rcp_f32 v229, v229
    v_pk_mul_f32 v[64:65], v[64:65], v[226:227]
    v_pk_mul_f32 v[66:67], v[66:67], v[228:229]
    v_cvt_pk_bf16_f32 v60, v60, v61
    v_cvt_pk_bf16_f32 v61, v62, v63
    v_cvt_pk_bf16_f32 v62, v64, v65
    v_cvt_pk_bf16_f32 v63, v66, v67
    v_or_b32 v60, 1, v60
    ds_write_b128 v244, v[60:63] offset:18432
    s_waitcnt vmcnt(0)
    s_mov_b64 exec, 1
    ds_add_u32 v246, v245
    s_mov_b64 exec, -1
    v_pk_fma_f32 v[88:89], v[172:173], v[144:145], v[88:89] op_sel_hi:[0,1,1] neg_lo:[1,0,0] neg_hi:[1,0,0]
    v_pk_fma_f32 v[90:91], v[172:173], v[146:147], v[90:91] op_sel_hi:[0,1,1] neg_lo:[1,0,0] neg_hi:[1,0,0]
    v_pk_mul_f32 v[226:227], v[88:89], v[88:89]
    v_pk_mul_f32 v[228:229], v[90:91], v[90:91]
    v_pk_fma_f32 v[226:227], v[226:227], v[174:175], v[174:175] op_sel:[0,1,0] op_sel_hi:[1,1,0]
    v_pk_fma_f32 v[228:229], v[228:229], v[174:175], v[174:175] op_sel:[0,1,0] op_sel_hi:[1,1,0]
    v_pk_mul_f32 v[226:227], v[226:227], v[88:89]
    v_pk_mul_f32 v[228:229], v[228:229], v[90:91]
    v_exp_f32 v226, v226
    v_exp_f32 v227, v227
    v_exp_f32 v228, v228
    v_exp_f32 v229, v229
    v_pk_fma_f32 v[226:227], v[226:227], v[172:173], v[172:173] op_sel:[0,1,1] op_sel_hi:[1,1,1]
    v_pk_fma_f32 v[228:229], v[228:229], v[172:173], v[172:173] op_sel:[0,1,1] op_sel_hi:[1,1,1]
    v_rcp_f32 v226, v226
    v_rcp_f32 v227, v227
    v_rcp_f32 v228, v228
    v_rcp_f32 v229, v229
    v_pk_mul_f32 v[88:89], v[88:89], v[226:227]
    v_pk_mul_f32 v[90:91], v[90:91], v[228:229]
    v_pk_fma_f32 v[92:93], v[172:173], v[148:149], v[92:93] op_sel_hi:[0,1,1] neg_lo:[1,0,0] neg_hi:[1,0,0]
    v_pk_fma_f32 v[94:95], v[172:173], v[150:151], v[94:95] op_sel_hi:[0,1,1] neg_lo:[1,0,0] neg_hi:[1,0,0]
    v_pk_mul_f32 v[226:227], v[92:93], v[92:93]
    v_pk_mul_f32 v[228:229], v[94:95], v[94:95]
    v_pk_fma_f32 v[226:227], v[226:227], v[174:175], v[174:175] op_sel:[0,1,0] op_sel_hi:[1,1,0]
    v_pk_fma_f32 v[228:229], v[228:229], v[174:175], v[174:175] op_sel:[0,1,0] op_sel_hi:[1,1,0]
    v_pk_mul_f32 v[226:227], v[226:227], v[92:93]
    v_pk_mul_f32 v[228:229], v[228:229], v[94:95]
    v_exp_f32 v226, v226
    v_exp_f32 v227, v227
    v_exp_f32 v228, v228
    v_exp_f32 v229, v229
    v_pk_fma_f32 v[226:227], v[226:227], v[172:173], v[172:173] op_sel:[0,1,1] op_sel_hi:[1,1,1]
    v_pk_fma_f32 v[228:229], v[228:229], v[172:173], v[172:173] op_sel:[0,1,1] op_sel_hi:[1,1,1]
    v_rcp_f32 v226, v226
    v_rcp_f32 v227, v227
    v_rcp_f32 v228, v228
    v_rcp_f32 v229, v229
    v_pk_mul_f32 v[92:93], v[92:93], v[226:227]
    v_pk_mul_f32 v[94:95], v[94:95], v[228:229]
    v_cvt_pk_bf16_f32 v88, v88, v89
    v_cvt_pk_bf16_f32 v89, v90, v91
    v_cvt_pk_bf16_f32 v90, v92, v93
    v_cvt_pk_bf16_f32 v91, v94, v95
    v_or_b32 v88, 1, v88
    ds_write_b128 v244, v[88:91] offset:20480
    s_cmp_eq_u32 s60, 1
    s_cbranch_scc1 G4_p10
    buffer_load_dwordx4 v[180:183], v196, s[84:87], 0 offen offset:0 sc1
    buffer_load_dwordx4 v[188:191], v196, s[88:91], 0 offen offset:0 sc1
    buffer_load_dwordx4 v[184:187], v196, s[84:87], 0 offen offset:2048 sc1
    buffer_load_dwordx4 v[192:195], v196, s[88:91], 0 offen offset:2048 sc1
    s_branch G4_p20
G4_p10:
    s_add_u32 s36, s40, 0
    buffer_load_dwordx4 v[180:183], v2, s[84:87], s36 offen offset:0 sc1
    buffer_load_dwordx4 v[184:187], v2, s[88:91], s36 offen offset:0 sc1
    buffer_load_dwordx4 v[188:191], v2, s[84:87], s36 offen offset:1024 sc1
    buffer_load_dwordx4 v[192:195], v2, s[88:91], s36 offen offset:1024 sc1
    s_add_u32 s36, s40, 65536
    buffer_load_dwordx4 v[196:199], v2, s[84:87], s36 offen offset:0 sc1
    buffer_load_dwordx4 v[230:233], v2, s[88:91], s36 offen offset:0 sc1
    buffer_load_dwordx4 v[234:237], v2, s[84:87], s36 offen offset:1024 sc1
    buffer_load_dwordx4 v[248:251], v2, s[88:91], s36 offen offset:1024 sc1
G4_p20:
    v_pk_fma_f32 v[116:117], v[176:177], v[144:145], v[116:117] op_sel_hi:[0,1,1] neg_lo:[1,0,0] neg_hi:[1,0,0]
    v_pk_fma_f32 v[118:119], v[176:177], v[146:147], v[118:119] op_sel_hi:[0,1,1] neg_lo:[1,0,0] neg_hi:[1,0,0]
    v_pk_mul_f32 v[226:227], v[116:117], v[116:117]
    v_pk_mul_f32 v[228:229], v[118:119], v[118:119]
    v_pk_fma_f32 v[226:227], v[226:227], v[178:179], v[178:179] op_sel:[0,1,0] op_sel_hi:[1,1,0]
    v_pk_fma_f32 v[228:229], v[228:229], v[178:179], v[178:179] op_sel:[0,1,0] op_sel_hi:[1,1,0]
    v_pk_mul_f32 v[226:227], v[226:227], v[116:117]
    v_pk_mul_f32 v[228:229], v[228:229], v[118:119]
    v_exp_f32 v226, v226
    v_exp_f32 v227, v227
    v_exp_f32 v228, v228
    v_exp_f32 v229, v229
    v_pk_fma_f32 v[226:227], v[226:227], v[176:177], v[176:177] op_sel:[0,1,1] op_sel_hi:[1,1,1]
    v_pk_fma_f32 v[228:229], v[228:229], v[176:177], v[176:177] op_sel:[0,1,1] op_sel_hi:[1,1,1]
    v_rcp_f32 v226, v226
    v_rcp_f32 v227, v227
    v_rcp_f32 v228, v228
    v_rcp_f32 v229, v229
    v_pk_mul_f32 v[116:117], v[116:117], v[226:227]
    v_pk_mul_f32 v[118:119], v[118:119], v[228:229]
    v_pk_fma_f32 v[120:121], v[176:177], v[148:149], v[120:121] op_sel_hi:[0,1,1] neg_lo:[1,0,0] neg_hi:[1,0,0]
    v_pk_fma_f32 v[122:123], v[176:177], v[150:151], v[122:123] op_sel_hi:[0,1,1] neg_lo:[1,0,0] neg_hi:[1,0,0]
    v_pk_mul_f32 v[226:227], v[120:121], v[120:121]
    v_pk_mul_f32 v[228:229], v[122:123], v[122:123]
    v_pk_fma_f32 v[226:227], v[226:227], v[178:179], v[178:179] op_sel:[0,1,0] op_sel_hi:[1,1,0]
    v_pk_fma_f32 v[228:229], v[228:229], v[178:179], v[178:179] op_sel:[0,1,0] op_sel_hi:[1,1,0]
    v_pk_mul_f32 v[226:227], v[226:227], v[120:121]
    v_pk_mul_f32 v[228:229], v[228:229], v[122:123]
    v_exp_f32 v226, v226
    v_exp_f32 v227, v227
    v_exp_f32 v228, v228
    v_exp_f32 v229, v229
    v_pk_fma_f32 v[226:227], v[226:227], v[176:177], v[176:177] op_sel:[0,1,1] op_sel_hi:[1,1,1]
    v_pk_fma_f32 v[228:229], v[228:229], v[176:177], v[176:177] op_sel:[0,1,1] op_sel_hi:[1,1,1]
    v_rcp_f32 v226, v226
    v_rcp_f32 v227, v227
    v_rcp_f32 v228, v228
    v_rcp_f32 v229, v229
    v_pk_mul_f32 v[120:121], v[120:121], v[226:227]
    v_pk_mul_f32 v[122:123], v[122:123], v[228:229]
    v_cvt_pk_bf16_f32 v116, v116, v117
    v_cvt_pk_bf16_f32 v117, v118, v119
    v_cvt_pk_bf16_f32 v118, v120, v121
    v_cvt_pk_bf16_f32 v119, v122, v123
    ds_write_b128 v244, v[116:119] offset:22528
    v_pk_fma_f32 v[40:41], v[164:165], v[152:153], v[40:41] op_sel_hi:[0,1,1] neg_lo:[1,0,0] neg_hi:[1,0,0]
    v_pk_fma_f32 v[42:43], v[164:165], v[154:155], v[42:43] op_sel_hi:[0,1,1] neg_lo:[1,0,0] neg_hi:[1,0,0]
    v_pk_mul_f32 v[226:227], v[40:41], v[40:41]
    v_pk_mul_f32 v[228:229], v[42:43], v[42:43]
    v_pk_fma_f32 v[226:227], v[226:227], v[166:167], v[166:167] op_sel:[0,1,0] op_sel_hi:[1,1,0]
    v_pk_fma_f32 v[228:229], v[228:229], v[166:167], v[166:167] op_sel:[0,1,0] op_sel_hi:[1,1,0]
    v_pk_mul_f32 v[226:227], v[226:227], v[40:41]
    v_pk_mul_f32 v[228:229], v[228:229], v[42:43]
    v_exp_f32 v226, v226
    v_exp_f32 v227, v227
    v_exp_f32 v228, v228
    v_exp_f32 v229, v229
    v_pk_fma_f32 v[226:227], v[226:227], v[164:165], v[164:165] op_sel:[0,1,1] op_sel_hi:[1,1,1]
    v_pk_fma_f32 v[228:229], v[228:229], v[164:165], v[164:165] op_sel:[0,1,1] op_sel_hi:[1,1,1]
    v_rcp_f32 v226, v226
    v_rcp_f32 v227, v227
    v_rcp_f32 v228, v228
    v_rcp_f32 v229, v229
    v_pk_mul_f32 v[40:41], v[40:41], v[226:227]
    v_pk_mul_f32 v[42:43], v[42:43], v[228:229]
    v_pk_fma_f32 v[44:45], v[164:165], v[156:157], v[44:45] op_sel_hi:[0,1,1] neg_lo:[1,0,0] neg_hi:[1,0,0]
    v_pk_fma_f32 v[46:47], v[164:165], v[158:159], v[46:47] op_sel_hi:[0,1,1] neg_lo:[1,0,0] neg_hi:[1,0,0]
    v_pk_mul_f32 v[226:227], v[44:45], v[44:45]
    v_pk_mul_f32 v[228:229], v[46:47], v[46:47]
    v_pk_fma_f32 v[226:227], v[226:227], v[166:167], v[166:167] op_sel:[0,1,0] op_sel_hi:[1,1,0]
    v_pk_fma_f32 v[228:229], v[228:229], v[166:167], v[166:167] op_sel:[0,1,0] op_sel_hi:[1,1,0]
    v_pk_mul_f32 v[226:227], v[226:227], v[44:45]
    v_pk_mul_f32 v[228:229], v[228:229], v[46:47]
    v_exp_f32 v226, v226
    v_exp_f32 v227, v227
    v_exp_f32 v228, v228
    v_exp_f32 v229, v229
    v_pk_fma_f32 v[226:227], v[226:227], v[164:165], v[164:165] op_sel:[0,1,1] op_sel_hi:[1,1,1]
    v_pk_fma_f32 v[228:229], v[228:229], v[164:165], v[164:165] op_sel:[0,1,1] op_sel_hi:[1,1,1]
    v_rcp_f32 v226, v226
    v_rcp_f32 v227, v227
    v_rcp_f32 v228, v228
    v_rcp_f32 v229, v229
    v_pk_mul_f32 v[44:45], v[44:45], v[226:227]
    v_pk_mul_f32 v[46:47], v[46:47], v[228:229]
    v_cvt_pk_bf16_f32 v200, v40, v41
    v_cvt_pk_bf16_f32 v201, v42, v43
    v_cvt_pk_bf16_f32 v202, v44, v45
    v_cvt_pk_bf16_f32 v203, v46, v47
    v_or_b32 v200, 1, v200
    ds_write_b128 v244, v[200:203] offset:32768
    v_pk_fma_f32 v[68:69], v[168:169], v[152:153], v[68:69] op_sel_hi:[0,1,1] neg_lo:[1,0,0] neg_hi:[1,0,0]
    v_pk_fma_f32 v[70:71], v[168:169], v[154:155], v[70:71] op_sel_hi:[0,1,1] neg_lo:[1,0,0] neg_hi:[1,0,0]
    v_pk_mul_f32 v[226:227], v[68:69], v[68:69]
    v_pk_mul_f32 v[228:229], v[70:71], v[70:71]
    v_pk_fma_f32 v[226:227], v[226:227], v[170:171], v[170:171] op_sel:[0,1,0] op_sel_hi:[1,1,0]
    v_pk_fma_f32 v[228:229], v[228:229], v[170:171], v[170:171] op_sel:[0,1,0] op_sel_hi:[1,1,0]
    v_pk_mul_f32 v[226:227], v[226:227], v[68:69]
    v_pk_mul_f32 v[228:229], v[228:229], v[70:71]
    v_exp_f32 v226, v226
    v_exp_f32 v227, v227
    v_exp_f32 v228, v228
    v_exp_f32 v229, v229
    v_pk_fma_f32 v[226:227], v[226:227], v[168:169], v[168:169] op_sel:[0,1,1] op_sel_hi:[1,1,1]
    v_pk_fma_f32 v[228:229], v[228:229], v[168:169], v[168:169] op_sel:[0,1,1] op_sel_hi:[1,1,1]
    v_rcp_f32 v226, v226
    v_rcp_f32 v227, v227
    v_rcp_f32 v228, v228
    v_rcp_f32 v229, v229
    v_pk_mul_f32 v[68:69], v[68:69], v[226:227]
    v_pk_mul_f32 v[70:71], v[70:71], v[228:229]
    v_pk_fma_f32 v[72:73], v[168:169], v[156:157], v[72:73] op_sel_hi:[0,1,1] neg_lo:[1,0,0] neg_hi:[1,0,0]
    v_pk_fma_f32 v[74:75], v[168:169], v[158:159], v[74:75] op_sel_hi:[0,1,1] neg_lo:[1,0,0] neg_hi:[1,0,0]
    v_pk_mul_f32 v[226:227], v[72:73], v[72:73]
    v_pk_mul_f32 v[228:229], v[74:75], v[74:75]
    v_pk_fma_f32 v[226:227], v[226:227], v[170:171], v[170:171] op_sel:[0,1,0] op_sel_hi:[1,1,0]
    v_pk_fma_f32 v[228:229], v[228:229], v[170:171], v[170:171] op_sel:[0,1,0] op_sel_hi:[1,1,0]
    v_pk_mul_f32 v[226:227], v[226:227], v[72:73]
    v_pk_mul_f32 v[228:229], v[228:229], v[74:75]
    v_exp_f32 v226, v226
    v_exp_f32 v227, v227
    v_exp_f32 v228, v228
    v_exp_f32 v229, v229
    v_pk_fma_f32 v[226:227], v[226:227], v[168:169], v[168:169] op_sel:[0,1,1] op_sel_hi:[1,1,1]
    v_pk_fma_f32 v[228:229], v[228:229], v[168:169], v[168:169] op_sel:[0,1,1] op_sel_hi:[1,1,1]
    v_rcp_f32 v226, v226
    v_rcp_f32 v227, v227
    v_rcp_f32 v228, v228
    v_rcp_f32 v229, v229
    v_pk_mul_f32 v[72:73], v[72:73], v[226:227]
    v_pk_mul_f32 v[74:75], v[74:75], v[228:229]
    v_cvt_pk_bf16_f32 v204, v68, v69
    v_cvt_pk_bf16_f32 v205, v70, v71
    v_cvt_pk_bf16_f32 v206, v72, v73
    v_cvt_pk_bf16_f32 v207, v74, v75
    v_or_b32 v204, 1, v204
    ds_write_b128 v244, v[204:207] offset:34816
    v_pk_fma_f32 v[96:97], v[172:173], v[152:153], v[96:97] op_sel_hi:[0,1,1] neg_lo:[1,0,0] neg_hi:[1,0,0]
    v_pk_fma_f32 v[98:99], v[172:173], v[154:155], v[98:99] op_sel_hi:[0,1,1] neg_lo:[1,0,0] neg_hi:[1,0,0]
    v_pk_mul_f32 v[226:227], v[96:97], v[96:97]
    v_pk_mul_f32 v[228:229], v[98:99], v[98:99]
    v_pk_fma_f32 v[226:227], v[226:227], v[174:175], v[174:175] op_sel:[0,1,0] op_sel_hi:[1,1,0]
    v_pk_fma_f32 v[228:229], v[228:229], v[174:175], v[174:175] op_sel:[0,1,0] op_sel_hi:[1,1,0]
    v_pk_mul_f32 v[226:227], v[226:227], v[96:97]
    v_pk_mul_f32 v[228:229], v[228:229], v[98:99]
    v_exp_f32 v226, v226
    v_exp_f32 v227, v227
    v_exp_f32 v228, v228
    v_exp_f32 v229, v229
    v_pk_fma_f32 v[226:227], v[226:227], v[172:173], v[172:173] op_sel:[0,1,1] op_sel_hi:[1,1,1]
    v_pk_fma_f32 v[228:229], v[228:229], v[172:173], v[172:173] op_sel:[0,1,1] op_sel_hi:[1,1,1]
    v_rcp_f32 v226, v226
    v_rcp_f32 v227, v227
    v_rcp_f32 v228, v228
    v_rcp_f32 v229, v229
    v_pk_mul_f32 v[96:97], v[96:97], v[226:227]
    v_pk_mul_f32 v[98:99], v[98:99], v[228:229]
    v_pk_fma_f32 v[100:101], v[172:173], v[156:157], v[100:101] op_sel_hi:[0,1,1] neg_lo:[1,0,0] neg_hi:[1,0,0]
    v_pk_fma_f32 v[102:103], v[172:173], v[158:159], v[102:103] op_sel_hi:[0,1,1] neg_lo:[1,0,0] neg_hi:[1,0,0]
    v_pk_mul_f32 v[226:227], v[100:101], v[100:101]
    v_pk_mul_f32 v[228:229], v[102:103], v[102:103]
    v_pk_fma_f32 v[226:227], v[226:227], v[174:175], v[174:175] op_sel:[0,1,0] op_sel_hi:[1,1,0]
    v_pk_fma_f32 v[228:229], v[228:229], v[174:175], v[174:175] op_sel:[0,1,0] op_sel_hi:[1,1,0]
    v_pk_mul_f32 v[226:227], v[226:227], v[100:101]
    v_pk_mul_f32 v[228:229], v[228:229], v[102:103]
    v_exp_f32 v226, v226
    v_exp_f32 v227, v227
    v_exp_f32 v228, v228
    v_exp_f32 v229, v229
    v_pk_fma_f32 v[226:227], v[226:227], v[172:173], v[172:173] op_sel:[0,1,1] op_sel_hi:[1,1,1]
    v_pk_fma_f32 v[228:229], v[228:229], v[172:173], v[172:173] op_sel:[0,1,1] op_sel_hi:[1,1,1]
    v_rcp_f32 v226, v226
    v_rcp_f32 v227, v227
    v_rcp_f32 v228, v228
    v_rcp_f32 v229, v229
    v_pk_mul_f32 v[100:101], v[100:101], v[226:227]
    v_pk_mul_f32 v[102:103], v[102:103], v[228:229]
    v_cvt_pk_bf16_f32 v208, v96, v97
    v_cvt_pk_bf16_f32 v209, v98, v99
    v_cvt_pk_bf16_f32 v210, v100, v101
    v_cvt_pk_bf16_f32 v211, v102, v103
    v_or_b32 v208, 1, v208
    ds_write_b128 v244, v[208:211] offset:36864
    v_pk_fma_f32 v[124:125], v[176:177], v[152:153], v[124:125] op_sel_hi:[0,1,1] neg_lo:[1,0,0] neg_hi:[1,0,0]
    v_pk_fma_f32 v[126:127], v[176:177], v[154:155], v[126:127] op_sel_hi:[0,1,1] neg_lo:[1,0,0] neg_hi:[1,0,0]
    v_pk_mul_f32 v[226:227], v[124:125], v[124:125]
    v_pk_mul_f32 v[228:229], v[126:127], v[126:127]
    v_pk_fma_f32 v[226:227], v[226:227], v[178:179], v[178:179] op_sel:[0,1,0] op_sel_hi:[1,1,0]
    v_pk_fma_f32 v[228:229], v[228:229], v[178:179], v[178:179] op_sel:[0,1,0] op_sel_hi:[1,1,0]
    v_pk_mul_f32 v[226:227], v[226:227], v[124:125]
    v_pk_mul_f32 v[228:229], v[228:229], v[126:127]
    v_exp_f32 v226, v226
    v_exp_f32 v227, v227
    v_exp_f32 v228, v228
    v_exp_f32 v229, v229
    v_pk_fma_f32 v[226:227], v[226:227], v[176:177], v[176:177] op_sel:[0,1,1] op_sel_hi:[1,1,1]
    v_pk_fma_f32 v[228:229], v[228:229], v[176:177], v[176:177] op_sel:[0,1,1] op_sel_hi:[1,1,1]
    v_rcp_f32 v226, v226
    v_rcp_f32 v227, v227
    v_rcp_f32 v228, v228
    v_rcp_f32 v229, v229
    v_pk_mul_f32 v[124:125], v[124:125], v[226:227]
    v_pk_mul_f32 v[126:127], v[126:127], v[228:229]
    v_pk_fma_f32 v[128:129], v[176:177], v[156:157], v[128:129] op_sel_hi:[0,1,1] neg_lo:[1,0,0] neg_hi:[1,0,0]
    v_pk_fma_f32 v[130:131], v[176:177], v[158:159], v[130:131] op_sel_hi:[0,1,1] neg_lo:[1,0,0] neg_hi:[1,0,0]
    v_pk_mul_f32 v[226:227], v[128:129], v[128:129]
    v_pk_mul_f32 v[228:229], v[130:131], v[130:131]
    v_pk_fma_f32 v[226:227], v[226:227], v[178:179], v[178:179] op_sel:[0,1,0] op_sel_hi:[1,1,0]
    v_pk_fma_f32 v[228:229], v[228:229], v[178:179], v[178:179] op_sel:[0,1,0] op_sel_hi:[1,1,0]
    v_pk_mul_f32 v[226:227], v[226:227], v[128:129]
    v_pk_mul_f32 v[228:229], v[228:229], v[130:131]
    v_exp_f32 v226, v226
    v_exp_f32 v227, v227
    v_exp_f32 v228, v228
    v_exp_f32 v229, v229
    v_pk_fma_f32 v[226:227], v[226:227], v[176:177], v[176:177] op_sel:[0,1,1] op_sel_hi:[1,1,1]
    v_pk_fma_f32 v[228:229], v[228:229], v[176:177], v[176:177] op_sel:[0,1,1] op_sel_hi:[1,1,1]
    v_rcp_f32 v226, v226
    v_rcp_f32 v227, v227
    v_rcp_f32 v228, v228
    v_rcp_f32 v229, v229
    v_pk_mul_f32 v[128:129], v[128:129], v[226:227]
    v_pk_mul_f32 v[130:131], v[130:131], v[228:229]
    v_cvt_pk_bf16_f32 v212, v124, v125
    v_cvt_pk_bf16_f32 v213, v126, v127
    v_cvt_pk_bf16_f32 v214, v128, v129
    v_cvt_pk_bf16_f32 v215, v130, v131
    ds_write_b128 v244, v[212:215] offset:38912
    v_pk_fma_f32 v[48:49], v[164:165], v[160:161], v[48:49] op_sel_hi:[0,1,1] neg_lo:[1,0,0] neg_hi:[1,0,0]
    v_pk_fma_f32 v[50:51], v[164:165], v[162:163], v[50:51] op_sel_hi:[0,1,1] neg_lo:[1,0,0] neg_hi:[1,0,0]
    v_pk_mul_f32 v[226:227], v[48:49], v[48:49]
    v_pk_mul_f32 v[228:229], v[50:51], v[50:51]
    v_pk_fma_f32 v[226:227], v[226:227], v[166:167], v[166:167] op_sel:[0,1,0] op_sel_hi:[1,1,0]
    v_pk_fma_f32 v[228:229], v[228:229], v[166:167], v[166:167] op_sel:[0,1,0] op_sel_hi:[1,1,0]
    v_pk_mul_f32 v[226:227], v[226:227], v[48:49]
    v_pk_mul_f32 v[228:229], v[228:229], v[50:51]
    v_exp_f32 v226, v226
    v_exp_f32 v227, v227
    v_exp_f32 v228, v228
    v_exp_f32 v229, v229
    v_pk_fma_f32 v[226:227], v[226:227], v[164:165], v[164:165] op_sel:[0,1,1] op_sel_hi:[1,1,1]
    v_pk_fma_f32 v[228:229], v[228:229], v[164:165], v[164:165] op_sel:[0,1,1] op_sel_hi:[1,1,1]
    v_rcp_f32 v226, v226
    v_rcp_f32 v227, v227
    v_rcp_f32 v228, v228
    v_rcp_f32 v229, v229
    v_pk_mul_f32 v[48:49], v[48:49], v[226:227]
    v_pk_mul_f32 v[50:51], v[50:51], v[228:229]
    v_cvt_pk_bf16_f32 v216, v48, v49
    v_cvt_pk_bf16_f32 v217, v50, v51
    v_or_b32 v216, 1, v216
    s_add_u32 s36, s45, 0
    buffer_store_dwordx4 v[32:35], v2, s[16:19], s36 offen sc1
    v_pk_fma_f32 v[76:77], v[168:169], v[160:161], v[76:77] op_sel_hi:[0,1,1] neg_lo:[1,0,0] neg_hi:[1,0,0]
    v_pk_fma_f32 v[78:79], v[168:169], v[162:163], v[78:79] op_sel_hi:[0,1,1] neg_lo:[1,0,0] neg_hi:[1,0,0]
    v_pk_mul_f32 v[226:227], v[76:77], v[76:77]
    v_pk_mul_f32 v[228:229], v[78:79], v[78:79]
    v_pk_fma_f32 v[226:227], v[226:227], v[170:171], v[170:171] op_sel:[0,1,0] op_sel_hi:[1,1,0]
    v_pk_fma_f32 v[228:229], v[228:229], v[170:171], v[170:171] op_sel:[0,1,0] op_sel_hi:[1,1,0]
    v_pk_mul_f32 v[226:227], v[226:227], v[76:77]
    v_pk_mul_f32 v[228:229], v[228:229], v[78:79]
    v_exp_f32 v226, v226
    v_exp_f32 v227, v227
    v_exp_f32 v228, v228
    v_exp_f32 v229, v229
    v_pk_fma_f32 v[226:227], v[226:227], v[168:169], v[168:169] op_sel:[0,1,1] op_sel_hi:[1,1,1]
    v_pk_fma_f32 v[228:229], v[228:229], v[168:169], v[168:169] op_sel:[0,1,1] op_sel_hi:[1,1,1]
    v_rcp_f32 v226, v226
    v_rcp_f32 v227, v227
    v_rcp_f32 v228, v228
    v_rcp_f32 v229, v229
    v_pk_mul_f32 v[76:77], v[76:77], v[226:227]
    v_pk_mul_f32 v[78:79], v[78:79], v[228:229]
    v_cvt_pk_bf16_f32 v218, v76, v77
    v_cvt_pk_bf16_f32 v219, v78, v79
    v_or_b32 v218, 1, v218
    s_add_u32 s36, s45, 229376
    buffer_store_dwordx4 v[60:63], v2, s[16:19], s36 offen sc1
    v_pk_fma_f32 v[104:105], v[172:173], v[160:161], v[104:105] op_sel_hi:[0,1,1] neg_lo:[1,0,0] neg_hi:[1,0,0]
    v_pk_fma_f32 v[106:107], v[172:173], v[162:163], v[106:107] op_sel_hi:[0,1,1] neg_lo:[1,0,0] neg_hi:[1,0,0]
    v_pk_mul_f32 v[226:227], v[104:105], v[104:105]
    v_pk_mul_f32 v[228:229], v[106:107], v[106:107]
    v_pk_fma_f32 v[226:227], v[226:227], v[174:175], v[174:175] op_sel:[0,1,0] op_sel_hi:[1,1,0]
    v_pk_fma_f32 v[228:229], v[228:229], v[174:175], v[174:175] op_sel:[0,1,0] op_sel_hi:[1,1,0]
    v_pk_mul_f32 v[226:227], v[226:227], v[104:105]
    v_pk_mul_f32 v[228:229], v[228:229], v[106:107]
    v_exp_f32 v226, v226
    v_exp_f32 v227, v227
    v_exp_f32 v228, v228
    v_exp_f32 v229, v229
    v_pk_fma_f32 v[226:227], v[226:227], v[172:173], v[172:173] op_sel:[0,1,1] op_sel_hi:[1,1,1]
    v_pk_fma_f32 v[228:229], v[228:229], v[172:173], v[172:173] op_sel:[0,1,1] op_sel_hi:[1,1,1]
    v_rcp_f32 v226, v226
    v_rcp_f32 v227, v227
    v_rcp_f32 v228, v228
    v_rcp_f32 v229, v229
    v_pk_mul_f32 v[104:105], v[104:105], v[226:227]
    v_pk_mul_f32 v[106:107], v[106:107], v[228:229]
    v_cvt_pk_bf16_f32 v220, v104, v105
    v_cvt_pk_bf16_f32 v221, v106, v107
    v_or_b32 v220, 1, v220
    s_add_u32 s36, s45, 458752
    buffer_store_dwordx4 v[88:91], v2, s[16:19], s36 offen sc1
    v_pk_fma_f32 v[132:133], v[176:177], v[160:161], v[132:133] op_sel_hi:[0,1,1] neg_lo:[1,0,0] neg_hi:[1,0,0]
    v_pk_fma_f32 v[134:135], v[176:177], v[162:163], v[134:135] op_sel_hi:[0,1,1] neg_lo:[1,0,0] neg_hi:[1,0,0]
    v_pk_mul_f32 v[226:227], v[132:133], v[132:133]
    v_pk_mul_f32 v[228:229], v[134:135], v[134:135]
    v_pk_fma_f32 v[226:227], v[226:227], v[178:179], v[178:179] op_sel:[0,1,0] op_sel_hi:[1,1,0]
    v_pk_fma_f32 v[228:229], v[228:229], v[178:179], v[178:179] op_sel:[0,1,0] op_sel_hi:[1,1,0]
    v_pk_mul_f32 v[226:227], v[226:227], v[132:133]
    v_pk_mul_f32 v[228:229], v[228:229], v[134:135]
    v_exp_f32 v226, v226
    v_exp_f32 v227, v227
    v_exp_f32 v228, v228
    v_exp_f32 v229, v229
    v_pk_fma_f32 v[226:227], v[226:227], v[176:177], v[176:177] op_sel:[0,1,1] op_sel_hi:[1,1,1]
    v_pk_fma_f32 v[228:229], v[228:229], v[176:177], v[176:177] op_sel:[0,1,1] op_sel_hi:[1,1,1]
    v_rcp_f32 v226, v226
    v_rcp_f32 v227, v227
    v_rcp_f32 v228, v228
    v_rcp_f32 v229, v229
    v_pk_mul_f32 v[132:133], v[132:133], v[226:227]
    v_pk_mul_f32 v[134:135], v[134:135], v[228:229]
    v_cvt_pk_bf16_f32 v222, v132, v133
    v_cvt_pk_bf16_f32 v223, v134, v135
    s_add_u32 s36, s45, 688128
    buffer_store_dwordx4 v[116:119], v2, s[16:19], s36 offen sc1
    s_waitcnt lgkmcnt(0)
    s_mov_b32 s44, s46
    s_mov_b32 s45, s47
    s_branch G3_e2
G3_e1:
    v_pk_fma_f32 v[28:29], v[164:165], v[140:141], v[28:29] op_sel_hi:[0,1,1] neg_lo:[1,0,0] neg_hi:[1,0,0]
    v_pk_fma_f32 v[30:31], v[164:165], v[142:143], v[30:31] op_sel_hi:[0,1,1] neg_lo:[1,0,0] neg_hi:[1,0,0]
    v_pk_mul_f32 v[226:227], v[28:29], v[28:29]
    v_pk_mul_f32 v[228:229], v[30:31], v[30:31]
    v_pk_fma_f32 v[226:227], v[226:227], v[166:167], v[166:167] op_sel:[0,1,0] op_sel_hi:[1,1,0]
    v_pk_fma_f32 v[228:229], v[228:229], v[166:167], v[166:167] op_sel:[0,1,0] op_sel_hi:[1,1,0]
    v_pk_mul_f32 v[226:227], v[226:227], v[28:29]
    v_pk_mul_f32 v[228:229], v[228:229], v[30:31]
    v_exp_f32 v226, v226
    v_exp_f32 v227, v227
    v_exp_f32 v228, v228
    v_exp_f32 v229, v229
    v_pk_fma_f32 v[226:227], v[226:227], v[164:165], v[164:165] op_sel:[0,1,1] op_sel_hi:[1,1,1]
    v_pk_fma_f32 v[228:229], v[228:229], v[164:165], v[164:165] op_sel:[0,1,1] op_sel_hi:[1,1,1]
    v_rcp_f32 v226, v226
    v_rcp_f32 v227, v227
    v_rcp_f32 v228, v228
    v_rcp_f32 v229, v229
    v_pk_mul_f32 v[28:29], v[28:29], v[226:227]
    v_pk_mul_f32 v[30:31], v[30:31], v[228:229]
    v_pk_fma_f32 v[32:33], v[164:165], v[144:145], v[32:33] op_sel_hi:[0,1,1] neg_lo:[1,0,0] neg_hi:[1,0,0]
    v_pk_fma_f32 v[34:35], v[164:165], v[146:147], v[34:35] op_sel_hi:[0,1,1] neg_lo:[1,0,0] neg_hi:[1,0,0]
    v_pk_mul_f32 v[226:227], v[32:33], v[32:33]
    v_pk_mul_f32 v[228:229], v[34:35], v[34:35]
    v_pk_fma_f32 v[226:227], v[226:227], v[166:167], v[166:167] op_sel:[0,1,0] op_sel_hi:[1,1,0]
    v_pk_fma_f32 v[228:229], v[228:229], v[166:167], v[166:167] op_sel:[0,1,0] op_sel_hi:[1,1,0]
    v_pk_mul_f32 v[226:227], v[226:227], v[32:33]
    v_pk_mul_f32 v[228:229], v[228:229], v[34:35]
    v_exp_f32 v226, v226
    v_exp_f32 v227, v227
    v_exp_f32 v228, v228
    v_exp_f32 v229, v229
    v_pk_fma_f32 v[226:227], v[226:227], v[164:165], v[164:165] op_sel:[0,1,1] op_sel_hi:[1,1,1]
    v_pk_fma_f32 v[228:229], v[228:229], v[164:165], v[164:165] op_sel:[0,1,1] op_sel_hi:[1,1,1]
    v_rcp_f32 v226, v226
    v_rcp_f32 v227, v227
    v_rcp_f32 v228, v228
    v_rcp_f32 v229, v229
    v_pk_mul_f32 v[32:33], v[32:33], v[226:227]
    v_pk_mul_f32 v[34:35], v[34:35], v[228:229]
    v_cvt_pk_bf16_f32 v28, v28, v29
    v_cvt_pk_bf16_f32 v29, v30, v31
    v_cvt_pk_bf16_f32 v30, v32, v33
    v_cvt_pk_bf16_f32 v31, v34, v35
    v_or_b32 v28, 1, v28
    ds_write_b128 v244, v[28:31] offset:0
    s_add_u32 s36, s45, 0
    buffer_store_dwordx4 v[28:31], v2, s[16:19], s36 offen sc1
    v_pk_fma_f32 v[56:57], v[168:169], v[140:141], v[56:57] op_sel_hi:[0,1,1] neg_lo:[1,0,0] neg_hi:[1,0,0]
    v_pk_fma_f32 v[58:59], v[168:169], v[142:143], v[58:59] op_sel_hi:[0,1,1] neg_lo:[1,0,0] neg_hi:[1,0,0]
    v_pk_mul_f32 v[226:227], v[56:57], v[56:57]
    v_pk_mul_f32 v[228:229], v[58:59], v[58:59]
    v_pk_fma_f32 v[226:227], v[226:227], v[170:171], v[170:171] op_sel:[0,1,0] op_sel_hi:[1,1,0]
    v_pk_fma_f32 v[228:229], v[228:229], v[170:171], v[170:171] op_sel:[0,1,0] op_sel_hi:[1,1,0]
    v_pk_mul_f32 v[226:227], v[226:227], v[56:57]
    v_pk_mul_f32 v[228:229], v[228:229], v[58:59]
    v_exp_f32 v226, v226
    v_exp_f32 v227, v227
    v_exp_f32 v228, v228
    v_exp_f32 v229, v229
    v_pk_fma_f32 v[226:227], v[226:227], v[168:169], v[168:169] op_sel:[0,1,1] op_sel_hi:[1,1,1]
    v_pk_fma_f32 v[228:229], v[228:229], v[168:169], v[168:169] op_sel:[0,1,1] op_sel_hi:[1,1,1]
    v_rcp_f32 v226, v226
    v_rcp_f32 v227, v227
    v_rcp_f32 v228, v228
    v_rcp_f32 v229, v229
    v_pk_mul_f32 v[56:57], v[56:57], v[226:227]
    v_pk_mul_f32 v[58:59], v[58:59], v[228:229]
    v_pk_fma_f32 v[60:61], v[168:169], v[144:145], v[60:61] op_sel_hi:[0,1,1] neg_lo:[1,0,0] neg_hi:[1,0,0]
    v_pk_fma_f32 v[62:63], v[168:169], v[146:147], v[62:63] op_sel_hi:[0,1,1] neg_lo:[1,0,0] neg_hi:[1,0,0]
    v_pk_mul_f32 v[226:227], v[60:61], v[60:61]
    v_pk_mul_f32 v[228:229], v[62:63], v[62:63]
    v_pk_fma_f32 v[226:227], v[226:227], v[170:171], v[170:171] op_sel:[0,1,0] op_sel_hi:[1,1,0]
    v_pk_fma_f32 v[228:229], v[228:229], v[170:171], v[170:171] op_sel:[0,1,0] op_sel_hi:[1,1,0]
    v_pk_mul_f32 v[226:227], v[226:227], v[60:61]
    v_pk_mul_f32 v[228:229], v[228:229], v[62:63]
    v_exp_f32 v226, v226
    v_exp_f32 v227, v227
    v_exp_f32 v228, v228
    v_exp_f32 v229, v229
    v_pk_fma_f32 v[226:227], v[226:227], v[168:169], v[168:169] op_sel:[0,1,1] op_sel_hi:[1,1,1]
    v_pk_fma_f32 v[228:229], v[228:229], v[168:169], v[168:169] op_sel:[0,1,1] op_sel_hi:[1,1,1]
    v_rcp_f32 v226, v226
    v_rcp_f32 v227, v227
    v_rcp_f32 v228, v228
    v_rcp_f32 v229, v229
    v_pk_mul_f32 v[60:61], v[60:61], v[226:227]
    v_pk_mul_f32 v[62:63], v[62:63], v[228:229]
    v_cvt_pk_bf16_f32 v56, v56, v57
    v_cvt_pk_bf16_f32 v57, v58, v59
    v_cvt_pk_bf16_f32 v58, v60, v61
    v_cvt_pk_bf16_f32 v59, v62, v63
    v_or_b32 v56, 1, v56
    ds_write_b128 v244, v[56:59] offset:2048
    s_add_u32 s36, s45, 229376
    buffer_store_dwordx4 v[56:59], v2, s[16:19], s36 offen sc1
    v_pk_fma_f32 v[84:85], v[172:173], v[140:141], v[84:85] op_sel_hi:[0,1,1] neg_lo:[1,0,0] neg_hi:[1,0,0]
    v_pk_fma_f32 v[86:87], v[172:173], v[142:143], v[86:87] op_sel_hi:[0,1,1] neg_lo:[1,0,0] neg_hi:[1,0,0]
    v_pk_mul_f32 v[226:227], v[84:85], v[84:85]
    v_pk_mul_f32 v[228:229], v[86:87], v[86:87]
    v_pk_fma_f32 v[226:227], v[226:227], v[174:175], v[174:175] op_sel:[0,1,0] op_sel_hi:[1,1,0]
    v_pk_fma_f32 v[228:229], v[228:229], v[174:175], v[174:175] op_sel:[0,1,0] op_sel_hi:[1,1,0]
    v_pk_mul_f32 v[226:227], v[226:227], v[84:85]
    v_pk_mul_f32 v[228:229], v[228:229], v[86:87]
    v_exp_f32 v226, v226
    v_exp_f32 v227, v227
    v_exp_f32 v228, v228
    v_exp_f32 v229, v229
    v_pk_fma_f32 v[226:227], v[226:227], v[172:173], v[172:173] op_sel:[0,1,1] op_sel_hi:[1,1,1]
    v_pk_fma_f32 v[228:229], v[228:229], v[172:173], v[172:173] op_sel:[0,1,1] op_sel_hi:[1,1,1]
    v_rcp_f32 v226, v226
    v_rcp_f32 v227, v227
    v_rcp_f32 v228, v228
    v_rcp_f32 v229, v229
    v_pk_mul_f32 v[84:85], v[84:85], v[226:227]
    v_pk_mul_f32 v[86:87], v[86:87], v[228:229]
    v_pk_fma_f32 v[88:89], v[172:173], v[144:145], v[88:89] op_sel_hi:[0,1,1] neg_lo:[1,0,0] neg_hi:[1,0,0]
    v_pk_fma_f32 v[90:91], v[172:173], v[146:147], v[90:91] op_sel_hi:[0,1,1] neg_lo:[1,0,0] neg_hi:[1,0,0]
    v_pk_mul_f32 v[226:227], v[88:89], v[88:89]
    v_pk_mul_f32 v[228:229], v[90:91], v[90:91]
    v_pk_fma_f32 v[226:227], v[226:227], v[174:175], v[174:175] op_sel:[0,1,0] op_sel_hi:[1,1,0]
    v_pk_fma_f32 v[228:229], v[228:229], v[174:175], v[174:175] op_sel:[0,1,0] op_sel_hi:[1,1,0]
    v_pk_mul_f32 v[226:227], v[226:227], v[88:89]
    v_pk_mul_f32 v[228:229], v[228:229], v[90:91]
    v_exp_f32 v226, v226
    v_exp_f32 v227, v227
    v_exp_f32 v228, v228
    v_exp_f32 v229, v229
    v_pk_fma_f32 v[226:227], v[226:227], v[172:173], v[172:173] op_sel:[0,1,1] op_sel_hi:[1,1,1]
    v_pk_fma_f32 v[228:229], v[228:229], v[172:173], v[172:173] op_sel:[0,1,1] op_sel_hi:[1,1,1]
    v_rcp_f32 v226, v226
    v_rcp_f32 v227, v227
    v_rcp_f32 v228, v228
    v_rcp_f32 v229, v229
    v_pk_mul_f32 v[88:89], v[88:89], v[226:227]
    v_pk_mul_f32 v[90:91], v[90:91], v[228:229]
    v_cvt_pk_bf16_f32 v84, v84, v85
    v_cvt_pk_bf16_f32 v85, v86, v87
    v_cvt_pk_bf16_f32 v86, v88, v89
    v_cvt_pk_bf16_f32 v87, v90, v91
    v_or_b32 v84, 1, v84
    ds_write_b128 v244, v[84:87] offset:4096
    s_add_u32 s36, s45, 458752
    buffer_store_dwordx4 v[84:87], v2, s[16:19], s36 offen sc1
    v_pk_fma_f32 v[112:113], v[176:177], v[140:141], v[112:113] op_sel_hi:[0,1,1] neg_lo:[1,0,0] neg_hi:[1,0,0]
    v_pk_fma_f32 v[114:115], v[176:177], v[142:143], v[114:115] op_sel_hi:[0,1,1] neg_lo:[1,0,0] neg_hi:[1,0,0]
    v_pk_mul_f32 v[226:227], v[112:113], v[112:113]
    v_pk_mul_f32 v[228:229], v[114:115], v[114:115]
    v_pk_fma_f32 v[226:227], v[226:227], v[178:179], v[178:179] op_sel:[0,1,0] op_sel_hi:[1,1,0]
    v_pk_fma_f32 v[228:229], v[228:229], v[178:179], v[178:179] op_sel:[0,1,0] op_sel_hi:[1,1,0]
    v_pk_mul_f32 v[226:227], v[226:227], v[112:113]
    v_pk_mul_f32 v[228:229], v[228:229], v[114:115]
    v_exp_f32 v226, v226
    v_exp_f32 v227, v227
    v_exp_f32 v228, v228
    v_exp_f32 v229, v229
    v_pk_fma_f32 v[226:227], v[226:227], v[176:177], v[176:177] op_sel:[0,1,1] op_sel_hi:[1,1,1]
    v_pk_fma_f32 v[228:229], v[228:229], v[176:177], v[176:177] op_sel:[0,1,1] op_sel_hi:[1,1,1]
    v_rcp_f32 v226, v226
    v_rcp_f32 v227, v227
    v_rcp_f32 v228, v228
    v_rcp_f32 v229, v229
    v_pk_mul_f32 v[112:113], v[112:113], v[226:227]
    v_pk_mul_f32 v[114:115], v[114:115], v[228:229]
    v_pk_fma_f32 v[116:117], v[176:177], v[144:145], v[116:117] op_sel_hi:[0,1,1] neg_lo:[1,0,0] neg_hi:[1,0,0]
    v_pk_fma_f32 v[118:119], v[176:177], v[146:147], v[118:119] op_sel_hi:[0,1,1] neg_lo:[1,0,0] neg_hi:[1,0,0]
    v_pk_mul_f32 v[226:227], v[116:117], v[116:117]
    v_pk_mul_f32 v[228:229], v[118:119], v[118:119]
    v_pk_fma_f32 v[226:227], v[226:227], v[178:179], v[178:179] op_sel:[0,1,0] op_sel_hi:[1,1,0]
    v_pk_fma_f32 v[228:229], v[228:229], v[178:179], v[178:179] op_sel:[0,1,0] op_sel_hi:[1,1,0]
    v_pk_mul_f32 v[226:227], v[226:227], v[116:117]
    v_pk_mul_f32 v[228:229], v[228:229], v[118:119]
    v_exp_f32 v226, v226
    v_exp_f32 v227, v227
    v_exp_f32 v228, v228
    v_exp_f32 v229, v229
    v_pk_fma_f32 v[226:227], v[226:227], v[176:177], v[176:177] op_sel:[0,1,1] op_sel_hi:[1,1,1]
    v_pk_fma_f32 v[228:229], v[228:229], v[176:177], v[176:177] op_sel:[0,1,1] op_sel_hi:[1,1,1]
    v_rcp_f32 v226, v226
    v_rcp_f32 v227, v227
    v_rcp_f32 v228, v228
    v_rcp_f32 v229, v229
    v_pk_mul_f32 v[116:117], v[116:117], v[226:227]
    v_pk_mul_f32 v[118:119], v[118:119], v[228:229]
    v_cvt_pk_bf16_f32 v112, v112, v113
    v_cvt_pk_bf16_f32 v113, v114, v115
    v_cvt_pk_bf16_f32 v114, v116, v117
    v_cvt_pk_bf16_f32 v115, v118, v119
    ds_write_b128 v244, v[112:115] offset:6144
    s_add_u32 s36, s45, 688128
    buffer_store_dwordx4 v[112:115], v2, s[16:19], s36 offen sc1
    v_pk_fma_f32 v[36:37], v[164:165], v[148:149], v[36:37] op_sel_hi:[0,1,1] neg_lo:[1,0,0] neg_hi:[1,0,0]
    v_pk_fma_f32 v[38:39], v[164:165], v[150:151], v[38:39] op_sel_hi:[0,1,1] neg_lo:[1,0,0] neg_hi:[1,0,0]
    v_pk_mul_f32 v[226:227], v[36:37], v[36:37]
    v_pk_mul_f32 v[228:229], v[38:39], v[38:39]
    v_pk_fma_f32 v[226:227], v[226:227], v[166:167], v[166:167] op_sel:[0,1,0] op_sel_hi:[1,1,0]
    v_pk_fma_f32 v[228:229], v[228:229], v[166:167], v[166:167] op_sel:[0,1,0] op_sel_hi:[1,1,0]
    v_pk_mul_f32 v[226:227], v[226:227], v[36:37]
    v_pk_mul_f32 v[228:229], v[228:229], v[38:39]
    v_exp_f32 v226, v226
    v_exp_f32 v227, v227
    v_exp_f32 v228, v228
    v_exp_f32 v229, v229
    v_pk_fma_f32 v[226:227], v[226:227], v[164:165], v[164:165] op_sel:[0,1,1] op_sel_hi:[1,1,1]
    v_pk_fma_f32 v[228:229], v[228:229], v[164:165], v[164:165] op_sel:[0,1,1] op_sel_hi:[1,1,1]
    v_rcp_f32 v226, v226
    v_rcp_f32 v227, v227
    v_rcp_f32 v228, v228
    v_rcp_f32 v229, v229
    v_pk_mul_f32 v[36:37], v[36:37], v[226:227]
    v_pk_mul_f32 v[38:39], v[38:39], v[228:229]
    v_pk_fma_f32 v[40:41], v[164:165], v[152:153], v[40:41] op_sel_hi:[0,1,1] neg_lo:[1,0,0] neg_hi:[1,0,0]
    v_pk_fma_f32 v[42:43], v[164:165], v[154:155], v[42:43] op_sel_hi:[0,1,1] neg_lo:[1,0,0] neg_hi:[1,0,0]
    v_pk_mul_f32 v[226:227], v[40:41], v[40:41]
    v_pk_mul_f32 v[228:229], v[42:43], v[42:43]
    v_pk_fma_f32 v[226:227], v[226:227], v[166:167], v[166:167] op_sel:[0,1,0] op_sel_hi:[1,1,0]
    v_pk_fma_f32 v[228:229], v[228:229], v[166:167], v[166:167] op_sel:[0,1,0] op_sel_hi:[1,1,0]
    v_pk_mul_f32 v[226:227], v[226:227], v[40:41]
    v_pk_mul_f32 v[228:229], v[228:229], v[42:43]
    v_exp_f32 v226, v226
    v_exp_f32 v227, v227
    v_exp_f32 v228, v228
    v_exp_f32 v229, v229
    v_pk_fma_f32 v[226:227], v[226:227], v[164:165], v[164:165] op_sel:[0,1,1] op_sel_hi:[1,1,1]
    v_pk_fma_f32 v[228:229], v[228:229], v[164:165], v[164:165] op_sel:[0,1,1] op_sel_hi:[1,1,1]
    v_rcp_f32 v226, v226
    v_rcp_f32 v227, v227
    v_rcp_f32 v228, v228
    v_rcp_f32 v229, v229
    v_pk_mul_f32 v[40:41], v[40:41], v[226:227]
    v_pk_mul_f32 v[42:43], v[42:43], v[228:229]
    v_cvt_pk_bf16_f32 v36, v36, v37
    v_cvt_pk_bf16_f32 v37, v38, v39
    v_cvt_pk_bf16_f32 v38, v40, v41
    v_cvt_pk_bf16_f32 v39, v42, v43
    v_or_b32 v36, 1, v36
    ds_write_b128 v244, v[36:39] offset:16384
    v_pk_fma_f32 v[64:65], v[168:169], v[148:149], v[64:65] op_sel_hi:[0,1,1] neg_lo:[1,0,0] neg_hi:[1,0,0]
    v_pk_fma_f32 v[66:67], v[168:169], v[150:151], v[66:67] op_sel_hi:[0,1,1] neg_lo:[1,0,0] neg_hi:[1,0,0]
    v_pk_mul_f32 v[226:227], v[64:65], v[64:65]
    v_pk_mul_f32 v[228:229], v[66:67], v[66:67]
    v_pk_fma_f32 v[226:227], v[226:227], v[170:171], v[170:171] op_sel:[0,1,0] op_sel_hi:[1,1,0]
    v_pk_fma_f32 v[228:229], v[228:229], v[170:171], v[170:171] op_sel:[0,1,0] op_sel_hi:[1,1,0]
    v_pk_mul_f32 v[226:227], v[226:227], v[64:65]
    v_pk_mul_f32 v[228:229], v[228:229], v[66:67]
    v_exp_f32 v226, v226
    v_exp_f32 v227, v227
    v_exp_f32 v228, v228
    v_exp_f32 v229, v229
    v_pk_fma_f32 v[226:227], v[226:227], v[168:169], v[168:169] op_sel:[0,1,1] op_sel_hi:[1,1,1]
    v_pk_fma_f32 v[228:229], v[228:229], v[168:169], v[168:169] op_sel:[0,1,1] op_sel_hi:[1,1,1]
    v_rcp_f32 v226, v226
    v_rcp_f32 v227, v227
    v_rcp_f32 v228, v228
    v_rcp_f32 v229, v229
    v_pk_mul_f32 v[64:65], v[64:65], v[226:227]
    v_pk_mul_f32 v[66:67], v[66:67], v[228:229]
    v_pk_fma_f32 v[68:69], v[168:169], v[152:153], v[68:69] op_sel_hi:[0,1,1] neg_lo:[1,0,0] neg_hi:[1,0,0]
    v_pk_fma_f32 v[70:71], v[168:169], v[154:155], v[70:71] op_sel_hi:[0,1,1] neg_lo:[1,0,0] neg_hi:[1,0,0]
    v_pk_mul_f32 v[226:227], v[68:69], v[68:69]
    v_pk_mul_f32 v[228:229], v[70:71], v[70:71]
    v_pk_fma_f32 v[226:227], v[226:227], v[170:171], v[170:171] op_sel:[0,1,0] op_sel_hi:[1,1,0]
    v_pk_fma_f32 v[228:229], v[228:229], v[170:171], v[170:171] op_sel:[0,1,0] op_sel_hi:[1,1,0]
    v_pk_mul_f32 v[226:227], v[226:227], v[68:69]
    v_pk_mul_f32 v[228:229], v[228:229], v[70:71]
    v_exp_f32 v226, v226
    v_exp_f32 v227, v227
    v_exp_f32 v228, v228
    v_exp_f32 v229, v229
    v_pk_fma_f32 v[226:227], v[226:227], v[168:169], v[168:169] op_sel:[0,1,1] op_sel_hi:[1,1,1]
    v_pk_fma_f32 v[228:229], v[228:229], v[168:169], v[168:169] op_sel:[0,1,1] op_sel_hi:[1,1,1]
    v_rcp_f32 v226, v226
    v_rcp_f32 v227, v227
    v_rcp_f32 v228, v228
    v_rcp_f32 v229, v229
    v_pk_mul_f32 v[68:69], v[68:69], v[226:227]
    v_pk_mul_f32 v[70:71], v[70:71], v[228:229]
    v_cvt_pk_bf16_f32 v64, v64, v65
    v_cvt_pk_bf16_f32 v65, v66, v67
    v_cvt_pk_bf16_f32 v66, v68, v69
    v_cvt_pk_bf16_f32 v67, v70, v71
    v_or_b32 v64, 1, v64
    ds_write_b128 v244, v[64:67] offset:18432
    s_waitcnt vmcnt(0)
    s_mov_b64 exec, 1
    ds_add_u32 v246, v245
    s_mov_b64 exec, -1
    v_pk_fma_f32 v[92:93], v[172:173], v[148:149], v[92:93] op_sel_hi:[0,1,1] neg_lo:[1,0,0] neg_hi:[1,0,0]
    v_pk_fma_f32 v[94:95], v[172:173], v[150:151], v[94:95] op_sel_hi:[0,1,1] neg_lo:[1,0,0] neg_hi:[1,0,0]
    v_pk_mul_f32 v[226:227], v[92:93], v[92:93]
    v_pk_mul_f32 v[228:229], v[94:95], v[94:95]
    v_pk_fma_f32 v[226:227], v[226:227], v[174:175], v[174:175] op_sel:[0,1,0] op_sel_hi:[1,1,0]
    v_pk_fma_f32 v[228:229], v[228:229], v[174:175], v[174:175] op_sel:[0,1,0] op_sel_hi:[1,1,0]
    v_pk_mul_f32 v[226:227], v[226:227], v[92:93]
    v_pk_mul_f32 v[228:229], v[228:229], v[94:95]
    v_exp_f32 v226, v226
    v_exp_f32 v227, v227
    v_exp_f32 v228, v228
    v_exp_f32 v229, v229
    v_pk_fma_f32 v[226:227], v[226:227], v[172:173], v[172:173] op_sel:[0,1,1] op_sel_hi:[1,1,1]
    v_pk_fma_f32 v[228:229], v[228:229], v[172:173], v[172:173] op_sel:[0,1,1] op_sel_hi:[1,1,1]
    v_rcp_f32 v226, v226
    v_rcp_f32 v227, v227
    v_rcp_f32 v228, v228
    v_rcp_f32 v229, v229
    v_pk_mul_f32 v[92:93], v[92:93], v[226:227]
    v_pk_mul_f32 v[94:95], v[94:95], v[228:229]
    v_pk_fma_f32 v[96:97], v[172:173], v[152:153], v[96:97] op_sel_hi:[0,1,1] neg_lo:[1,0,0] neg_hi:[1,0,0]
    v_pk_fma_f32 v[98:99], v[172:173], v[154:155], v[98:99] op_sel_hi:[0,1,1] neg_lo:[1,0,0] neg_hi:[1,0,0]
    v_pk_mul_f32 v[226:227], v[96:97], v[96:97]
    v_pk_mul_f32 v[228:229], v[98:99], v[98:99]
    v_pk_fma_f32 v[226:227], v[226:227], v[174:175], v[174:175] op_sel:[0,1,0] op_sel_hi:[1,1,0]
    v_pk_fma_f32 v[228:229], v[228:229], v[174:175], v[174:175] op_sel:[0,1,0] op_sel_hi:[1,1,0]
    v_pk_mul_f32 v[226:227], v[226:227], v[96:97]
    v_pk_mul_f32 v[228:229], v[228:229], v[98:99]
    v_exp_f32 v226, v226
    v_exp_f32 v227, v227
    v_exp_f32 v228, v228
    v_exp_f32 v229, v229
    v_pk_fma_f32 v[226:227], v[226:227], v[172:173], v[172:173] op_sel:[0,1,1] op_sel_hi:[1,1,1]
    v_pk_fma_f32 v[228:229], v[228:229], v[172:173], v[172:173] op_sel:[0,1,1] op_sel_hi:[1,1,1]
    v_rcp_f32 v226, v226
    v_rcp_f32 v227, v227
    v_rcp_f32 v228, v228
    v_rcp_f32 v229, v229
    v_pk_mul_f32 v[96:97], v[96:97], v[226:227]
    v_pk_mul_f32 v[98:99], v[98:99], v[228:229]
    v_cvt_pk_bf16_f32 v92, v92, v93
    v_cvt_pk_bf16_f32 v93, v94, v95
    v_cvt_pk_bf16_f32 v94, v96, v97
    v_cvt_pk_bf16_f32 v95, v98, v99
    v_or_b32 v92, 1, v92
    ds_write_b128 v244, v[92:95] offset:20480
    s_cmp_eq_u32 s60, 1
    s_cbranch_scc1 G4_p11
    buffer_load_dwordx4 v[180:183], v196, s[84:87], 0 offen offset:0 sc1
    buffer_load_dwordx4 v[188:191], v196, s[88:91], 0 offen offset:0 sc1
    buffer_load_dwordx4 v[184:187], v196, s[84:87], 0 offen offset:2048 sc1
    buffer_load_dwordx4 v[192:195], v196, s[88:91], 0 offen offset:2048 sc1
    s_branch G4_p21
G4_p11:
    s_add_u32 s36, s40, 0
    buffer_load_dwordx4 v[180:183], v2, s[84:87], s36 offen offset:0 sc1
    buffer_load_dwordx4 v[184:187], v2, s[88:91], s36 offen offset:0 sc1
    buffer_load_dwordx4 v[188:191], v2, s[84:87], s36 offen offset:1024 sc1
    buffer_load_dwordx4 v[192:195], v2, s[88:91], s36 offen offset:1024 sc1
    s_add_u32 s36, s40, 65536
    buffer_load_dwordx4 v[196:199], v2, s[84:87], s36 offen offset:0 sc1
    buffer_load_dwordx4 v[230:233], v2, s[88:91], s36 offen offset:0 sc1
    buffer_load_dwordx4 v[234:237], v2, s[84:87], s36 offen offset:1024 sc1
    buffer_load_dwordx4 v[248:251], v2, s[88:91], s36 offen offset:1024 sc1
G4_p21:
    v_pk_fma_f32 v[120:121], v[176:177], v[148:149], v[120:121] op_sel_hi:[0,1,1] neg_lo:[1,0,0] neg_hi:[1,0,0]
    v_pk_fma_f32 v[122:123], v[176:177], v[150:151], v[122:123] op_sel_hi:[0,1,1] neg_lo:[1,0,0] neg_hi:[1,0,0]
    v_pk_mul_f32 v[226:227], v[120:121], v[120:121]
    v_pk_mul_f32 v[228:229], v[122:123], v[122:123]
    v_pk_fma_f32 v[226:227], v[226:227], v[178:179], v[178:179] op_sel:[0,1,0] op_sel_hi:[1,1,0]
    v_pk_fma_f32 v[228:229], v[228:229], v[178:179], v[178:179] op_sel:[0,1,0] op_sel_hi:[1,1,0]
    v_pk_mul_f32 v[226:227], v[226:227], v[120:121]
    v_pk_mul_f32 v[228:229], v[228:229], v[122:123]
    v_exp_f32 v226, v226
    v_exp_f32 v227, v227
    v_exp_f32 v228, v228
    v_exp_f32 v229, v229
    v_pk_fma_f32 v[226:227], v[226:227], v[176:177], v[176:177] op_sel:[0,1,1] op_sel_hi:[1,1,1]
    v_pk_fma_f32 v[228:229], v[228:229], v[176:177], v[176:177] op_sel:[0,1,1] op_sel_hi:[1,1,1]
    v_rcp_f32 v226, v226
    v_rcp_f32 v227, v227
    v_rcp_f32 v228, v228
    v_rcp_f32 v229, v229
    v_pk_mul_f32 v[120:121], v[120:121], v[226:227]
    v_pk_mul_f32 v[122:123], v[122:123], v[228:229]
    v_pk_fma_f32 v[124:125], v[176:177], v[152:153], v[124:125] op_sel_hi:[0,1,1] neg_lo:[1,0,0] neg_hi:[1,0,0]
    v_pk_fma_f32 v[126:127], v[176:177], v[154:155], v[126:127] op_sel_hi:[0,1,1] neg_lo:[1,0,0] neg_hi:[1,0,0]
    v_pk_mul_f32 v[226:227], v[124:125], v[124:125]
    v_pk_mul_f32 v[228:229], v[126:127], v[126:127]
    v_pk_fma_f32 v[226:227], v[226:227], v[178:179], v[178:179] op_sel:[0,1,0] op_sel_hi:[1,1,0]
    v_pk_fma_f32 v[228:229], v[228:229], v[178:179], v[178:179] op_sel:[0,1,0] op_sel_hi:[1,1,0]
    v_pk_mul_f32 v[226:227], v[226:227], v[124:125]
    v_pk_mul_f32 v[228:229], v[228:229], v[126:127]
    v_exp_f32 v226, v226
    v_exp_f32 v227, v227
    v_exp_f32 v228, v228
    v_exp_f32 v229, v229
    v_pk_fma_f32 v[226:227], v[226:227], v[176:177], v[176:177] op_sel:[0,1,1] op_sel_hi:[1,1,1]
    v_pk_fma_f32 v[228:229], v[228:229], v[176:177], v[176:177] op_sel:[0,1,1] op_sel_hi:[1,1,1]
    v_rcp_f32 v226, v226
    v_rcp_f32 v227, v227
    v_rcp_f32 v228, v228
    v_rcp_f32 v229, v229
    v_pk_mul_f32 v[124:125], v[124:125], v[226:227]
    v_pk_mul_f32 v[126:127], v[126:127], v[228:229]
    v_cvt_pk_bf16_f32 v120, v120, v121
    v_cvt_pk_bf16_f32 v121, v122, v123
    v_cvt_pk_bf16_f32 v122, v124, v125
    v_cvt_pk_bf16_f32 v123, v126, v127
    ds_write_b128 v244, v[120:123] offset:22528
    v_pk_fma_f32 v[44:45], v[164:165], v[156:157], v[44:45] op_sel_hi:[0,1,1] neg_lo:[1,0,0] neg_hi:[1,0,0]
    v_pk_fma_f32 v[46:47], v[164:165], v[158:159], v[46:47] op_sel_hi:[0,1,1] neg_lo:[1,0,0] neg_hi:[1,0,0]
    v_pk_mul_f32 v[226:227], v[44:45], v[44:45]
    v_pk_mul_f32 v[228:229], v[46:47], v[46:47]
    v_pk_fma_f32 v[226:227], v[226:227], v[166:167], v[166:167] op_sel:[0,1,0] op_sel_hi:[1,1,0]
    v_pk_fma_f32 v[228:229], v[228:229], v[166:167], v[166:167] op_sel:[0,1,0] op_sel_hi:[1,1,0]
    v_pk_mul_f32 v[226:227], v[226:227], v[44:45]
    v_pk_mul_f32 v[228:229], v[228:229], v[46:47]
    v_exp_f32 v226, v226
    v_exp_f32 v227, v227
    v_exp_f32 v228, v228
    v_exp_f32 v229, v229
    v_pk_fma_f32 v[226:227], v[226:227], v[164:165], v[164:165] op_sel:[0,1,1] op_sel_hi:[1,1,1]
    v_pk_fma_f32 v[228:229], v[228:229], v[164:165], v[164:165] op_sel:[0,1,1] op_sel_hi:[1,1,1]
    v_rcp_f32 v226, v226
    v_rcp_f32 v227, v227
    v_rcp_f32 v228, v228
    v_rcp_f32 v229, v229
    v_pk_mul_f32 v[44:45], v[44:45], v[226:227]
    v_pk_mul_f32 v[46:47], v[46:47], v[228:229]
    v_pk_fma_f32 v[48:49], v[164:165], v[160:161], v[48:49] op_sel_hi:[0,1,1] neg_lo:[1,0,0] neg_hi:[1,0,0]
    v_pk_fma_f32 v[50:51], v[164:165], v[162:163], v[50:51] op_sel_hi:[0,1,1] neg_lo:[1,0,0] neg_hi:[1,0,0]
    v_pk_mul_f32 v[226:227], v[48:49], v[48:49]
    v_pk_mul_f32 v[228:229], v[50:51], v[50:51]
    v_pk_fma_f32 v[226:227], v[226:227], v[166:167], v[166:167] op_sel:[0,1,0] op_sel_hi:[1,1,0]
    v_pk_fma_f32 v[228:229], v[228:229], v[166:167], v[166:167] op_sel:[0,1,0] op_sel_hi:[1,1,0]
    v_pk_mul_f32 v[226:227], v[226:227], v[48:49]
    v_pk_mul_f32 v[228:229], v[228:229], v[50:51]
    v_exp_f32 v226, v226
    v_exp_f32 v227, v227
    v_exp_f32 v228, v228
    v_exp_f32 v229, v229
    v_pk_fma_f32 v[226:227], v[226:227], v[164:165], v[164:165] op_sel:[0,1,1] op_sel_hi:[1,1,1]
    v_pk_fma_f32 v[228:229], v[228:229], v[164:165], v[164:165] op_sel:[0,1,1] op_sel_hi:[1,1,1]
    v_rcp_f32 v226, v226
    v_rcp_f32 v227, v227
    v_rcp_f32 v228, v228
    v_rcp_f32 v229, v229
    v_pk_mul_f32 v[48:49], v[48:49], v[226:227]
    v_pk_mul_f32 v[50:51], v[50:51], v[228:229]
    v_cvt_pk_bf16_f32 v200, v44, v45
    v_cvt_pk_bf16_f32 v201, v46, v47
    v_cvt_pk_bf16_f32 v202, v48, v49
    v_cvt_pk_bf16_f32 v203, v50, v51
    v_or_b32 v200, 1, v200
    ds_write_b128 v244, v[200:203] offset:32768
    v_pk_fma_f32 v[72:73], v[168:169], v[156:157], v[72:73] op_sel_hi:[0,1,1] neg_lo:[1,0,0] neg_hi:[1,0,0]
    v_pk_fma_f32 v[74:75], v[168:169], v[158:159], v[74:75] op_sel_hi:[0,1,1] neg_lo:[1,0,0] neg_hi:[1,0,0]
    v_pk_mul_f32 v[226:227], v[72:73], v[72:73]
    v_pk_mul_f32 v[228:229], v[74:75], v[74:75]
    v_pk_fma_f32 v[226:227], v[226:227], v[170:171], v[170:171] op_sel:[0,1,0] op_sel_hi:[1,1,0]
    v_pk_fma_f32 v[228:229], v[228:229], v[170:171], v[170:171] op_sel:[0,1,0] op_sel_hi:[1,1,0]
    v_pk_mul_f32 v[226:227], v[226:227], v[72:73]
    v_pk_mul_f32 v[228:229], v[228:229], v[74:75]
    v_exp_f32 v226, v226
    v_exp_f32 v227, v227
    v_exp_f32 v228, v228
    v_exp_f32 v229, v229
    v_pk_fma_f32 v[226:227], v[226:227], v[168:169], v[168:169] op_sel:[0,1,1] op_sel_hi:[1,1,1]
    v_pk_fma_f32 v[228:229], v[228:229], v[168:169], v[168:169] op_sel:[0,1,1] op_sel_hi:[1,1,1]
    v_rcp_f32 v226, v226
    v_rcp_f32 v227, v227
    v_rcp_f32 v228, v228
    v_rcp_f32 v229, v229
    v_pk_mul_f32 v[72:73], v[72:73], v[226:227]
    v_pk_mul_f32 v[74:75], v[74:75], v[228:229]
    v_pk_fma_f32 v[76:77], v[168:169], v[160:161], v[76:77] op_sel_hi:[0,1,1] neg_lo:[1,0,0] neg_hi:[1,0,0]
    v_pk_fma_f32 v[78:79], v[168:169], v[162:163], v[78:79] op_sel_hi:[0,1,1] neg_lo:[1,0,0] neg_hi:[1,0,0]
    v_pk_mul_f32 v[226:227], v[76:77], v[76:77]
    v_pk_mul_f32 v[228:229], v[78:79], v[78:79]
    v_pk_fma_f32 v[226:227], v[226:227], v[170:171], v[170:171] op_sel:[0,1,0] op_sel_hi:[1,1,0]
    v_pk_fma_f32 v[228:229], v[228:229], v[170:171], v[170:171] op_sel:[0,1,0] op_sel_hi:[1,1,0]
    v_pk_mul_f32 v[226:227], v[226:227], v[76:77]
    v_pk_mul_f32 v[228:229], v[228:229], v[78:79]
    v_exp_f32 v226, v226
    v_exp_f32 v227, v227
    v_exp_f32 v228, v228
    v_exp_f32 v229, v229
    v_pk_fma_f32 v[226:227], v[226:227], v[168:169], v[168:169] op_sel:[0,1,1] op_sel_hi:[1,1,1]
    v_pk_fma_f32 v[228:229], v[228:229], v[168:169], v[168:169] op_sel:[0,1,1] op_sel_hi:[1,1,1]
    v_rcp_f32 v226, v226
    v_rcp_f32 v227, v227
    v_rcp_f32 v228, v228
    v_rcp_f32 v229, v229
    v_pk_mul_f32 v[76:77], v[76:77], v[226:227]
    v_pk_mul_f32 v[78:79], v[78:79], v[228:229]
    v_cvt_pk_bf16_f32 v204, v72, v73
    v_cvt_pk_bf16_f32 v205, v74, v75
    v_cvt_pk_bf16_f32 v206, v76, v77
    v_cvt_pk_bf16_f32 v207, v78, v79
    v_or_b32 v204, 1, v204
    ds_write_b128 v244, v[204:207] offset:34816
    v_pk_fma_f32 v[100:101], v[172:173], v[156:157], v[100:101] op_sel_hi:[0,1,1] neg_lo:[1,0,0] neg_hi:[1,0,0]
    v_pk_fma_f32 v[102:103], v[172:173], v[158:159], v[102:103] op_sel_hi:[0,1,1] neg_lo:[1,0,0] neg_hi:[1,0,0]
    v_pk_mul_f32 v[226:227], v[100:101], v[100:101]
    v_pk_mul_f32 v[228:229], v[102:103], v[102:103]
    v_pk_fma_f32 v[226:227], v[226:227], v[174:175], v[174:175] op_sel:[0,1,0] op_sel_hi:[1,1,0]
    v_pk_fma_f32 v[228:229], v[228:229], v[174:175], v[174:175] op_sel:[0,1,0] op_sel_hi:[1,1,0]
    v_pk_mul_f32 v[226:227], v[226:227], v[100:101]
    v_pk_mul_f32 v[228:229], v[228:229], v[102:103]
    v_exp_f32 v226, v226
    v_exp_f32 v227, v227
    v_exp_f32 v228, v228
    v_exp_f32 v229, v229
    v_pk_fma_f32 v[226:227], v[226:227], v[172:173], v[172:173] op_sel:[0,1,1] op_sel_hi:[1,1,1]
    v_pk_fma_f32 v[228:229], v[228:229], v[172:173], v[172:173] op_sel:[0,1,1] op_sel_hi:[1,1,1]
    v_rcp_f32 v226, v226
    v_rcp_f32 v227, v227
    v_rcp_f32 v228, v228
    v_rcp_f32 v229, v229
    v_pk_mul_f32 v[100:101], v[100:101], v[226:227]
    v_pk_mul_f32 v[102:103], v[102:103], v[228:229]
    v_pk_fma_f32 v[104:105], v[172:173], v[160:161], v[104:105] op_sel_hi:[0,1,1] neg_lo:[1,0,0] neg_hi:[1,0,0]
    v_pk_fma_f32 v[106:107], v[172:173], v[162:163], v[106:107] op_sel_hi:[0,1,1] neg_lo:[1,0,0] neg_hi:[1,0,0]
    v_pk_mul_f32 v[226:227], v[104:105], v[104:105]
    v_pk_mul_f32 v[228:229], v[106:107], v[106:107]
    v_pk_fma_f32 v[226:227], v[226:227], v[174:175], v[174:175] op_sel:[0,1,0] op_sel_hi:[1,1,0]
    v_pk_fma_f32 v[228:229], v[228:229], v[174:175], v[174:175] op_sel:[0,1,0] op_sel_hi:[1,1,0]
    v_pk_mul_f32 v[226:227], v[226:227], v[104:105]
    v_pk_mul_f32 v[228:229], v[228:229], v[106:107]
    v_exp_f32 v226, v226
    v_exp_f32 v227, v227
    v_exp_f32 v228, v228
    v_exp_f32 v229, v229
    v_pk_fma_f32 v[226:227], v[226:227], v[172:173], v[172:173] op_sel:[0,1,1] op_sel_hi:[1,1,1]
    v_pk_fma_f32 v[228:229], v[228:229], v[172:173], v[172:173] op_sel:[0,1,1] op_sel_hi:[1,1,1]
    v_rcp_f32 v226, v226
    v_rcp_f32 v227, v227
    v_rcp_f32 v228, v228
    v_rcp_f32 v229, v229
    v_pk_mul_f32 v[104:105], v[104:105], v[226:227]
    v_pk_mul_f32 v[106:107], v[106:107], v[228:229]
    v_cvt_pk_bf16_f32 v208, v100, v101
    v_cvt_pk_bf16_f32 v209, v102, v103
    v_cvt_pk_bf16_f32 v210, v104, v105
    v_cvt_pk_bf16_f32 v211, v106, v107
    v_or_b32 v208, 1, v208
    ds_write_b128 v244, v[208:211] offset:36864
    v_pk_fma_f32 v[128:129], v[176:177], v[156:157], v[128:129] op_sel_hi:[0,1,1] neg_lo:[1,0,0] neg_hi:[1,0,0]
    v_pk_fma_f32 v[130:131], v[176:177], v[158:159], v[130:131] op_sel_hi:[0,1,1] neg_lo:[1,0,0] neg_hi:[1,0,0]
    v_pk_mul_f32 v[226:227], v[128:129], v[128:129]
    v_pk_mul_f32 v[228:229], v[130:131], v[130:131]
    v_pk_fma_f32 v[226:227], v[226:227], v[178:179], v[178:179] op_sel:[0,1,0] op_sel_hi:[1,1,0]
    v_pk_fma_f32 v[228:229], v[228:229], v[178:179], v[178:179] op_sel:[0,1,0] op_sel_hi:[1,1,0]
    v_pk_mul_f32 v[226:227], v[226:227], v[128:129]
    v_pk_mul_f32 v[228:229], v[228:229], v[130:131]
    v_exp_f32 v226, v226
    v_exp_f32 v227, v227
    v_exp_f32 v228, v228
    v_exp_f32 v229, v229
    v_pk_fma_f32 v[226:227], v[226:227], v[176:177], v[176:177] op_sel:[0,1,1] op_sel_hi:[1,1,1]
    v_pk_fma_f32 v[228:229], v[228:229], v[176:177], v[176:177] op_sel:[0,1,1] op_sel_hi:[1,1,1]
    v_rcp_f32 v226, v226
    v_rcp_f32 v227, v227
    v_rcp_f32 v228, v228
    v_rcp_f32 v229, v229
    v_pk_mul_f32 v[128:129], v[128:129], v[226:227]
    v_pk_mul_f32 v[130:131], v[130:131], v[228:229]
    v_pk_fma_f32 v[132:133], v[176:177], v[160:161], v[132:133] op_sel_hi:[0,1,1] neg_lo:[1,0,0] neg_hi:[1,0,0]
    v_pk_fma_f32 v[134:135], v[176:177], v[162:163], v[134:135] op_sel_hi:[0,1,1] neg_lo:[1,0,0] neg_hi:[1,0,0]
    v_pk_mul_f32 v[226:227], v[132:133], v[132:133]
    v_pk_mul_f32 v[228:229], v[134:135], v[134:135]
    v_pk_fma_f32 v[226:227], v[226:227], v[178:179], v[178:179] op_sel:[0,1,0] op_sel_hi:[1,1,0]
    v_pk_fma_f32 v[228:229], v[228:229], v[178:179], v[178:179] op_sel:[0,1,0] op_sel_hi:[1,1,0]
    v_pk_mul_f32 v[226:227], v[226:227], v[132:133]
    v_pk_mul_f32 v[228:229], v[228:229], v[134:135]
    v_exp_f32 v226, v226
    v_exp_f32 v227, v227
    v_exp_f32 v228, v228
    v_exp_f32 v229, v229
    v_pk_fma_f32 v[226:227], v[226:227], v[176:177], v[176:177] op_sel:[0,1,1] op_sel_hi:[1,1,1]
    v_pk_fma_f32 v[228:229], v[228:229], v[176:177], v[176:177] op_sel:[0,1,1] op_sel_hi:[1,1,1]
    v_rcp_f32 v226, v226
    v_rcp_f32 v227, v227
    v_rcp_f32 v228, v228
    v_rcp_f32 v229, v229
    v_pk_mul_f32 v[132:133], v[132:133], v[226:227]
    v_pk_mul_f32 v[134:135], v[134:135], v[228:229]
    v_cvt_pk_bf16_f32 v212, v128, v129
    v_cvt_pk_bf16_f32 v213, v130, v131
    v_cvt_pk_bf16_f32 v214, v132, v133
    v_cvt_pk_bf16_f32 v215, v134, v135
    ds_write_b128 v244, v[212:215] offset:38912
    v_pk_fma_f32 v[24:25], v[164:165], v[136:137], v[24:25] op_sel_hi:[0,1,1] neg_lo:[1,0,0] neg_hi:[1,0,0]
    v_pk_fma_f32 v[26:27], v[164:165], v[138:139], v[26:27] op_sel_hi:[0,1,1] neg_lo:[1,0,0] neg_hi:[1,0,0]
    v_pk_mul_f32 v[226:227], v[24:25], v[24:25]
    v_pk_mul_f32 v[228:229], v[26:27], v[26:27]
    v_pk_fma_f32 v[226:227], v[226:227], v[166:167], v[166:167] op_sel:[0,1,0] op_sel_hi:[1,1,0]
    v_pk_fma_f32 v[228:229], v[228:229], v[166:167], v[166:167] op_sel:[0,1,0] op_sel_hi:[1,1,0]
    v_pk_mul_f32 v[226:227], v[226:227], v[24:25]
    v_pk_mul_f32 v[228:229], v[228:229], v[26:27]
    v_exp_f32 v226, v226
    v_exp_f32 v227, v227
    v_exp_f32 v228, v228
    v_exp_f32 v229, v229
    v_pk_fma_f32 v[226:227], v[226:227], v[164:165], v[164:165] op_sel:[0,1,1] op_sel_hi:[1,1,1]
    v_pk_fma_f32 v[228:229], v[228:229], v[164:165], v[164:165] op_sel:[0,1,1] op_sel_hi:[1,1,1]
    v_rcp_f32 v226, v226
    v_rcp_f32 v227, v227
    v_rcp_f32 v228, v228
    v_rcp_f32 v229, v229
    v_pk_mul_f32 v[24:25], v[24:25], v[226:227]
    v_pk_mul_f32 v[26:27], v[26:27], v[228:229]
    v_cvt_pk_bf16_f32 v216, v24, v25
    v_cvt_pk_bf16_f32 v217, v26, v27
    v_or_b32 v216, 1, v216
    s_add_u32 s36, s46, 0
    buffer_store_dwordx4 v[36:39], v2, s[16:19], s36 offen sc1
    v_pk_fma_f32 v[52:53], v[168:169], v[136:137], v[52:53] op_sel_hi:[0,1,1] neg_lo:[1,0,0] neg_hi:[1,0,0]
    v_pk_fma_f32 v[54:55], v[168:169], v[138:139], v[54:55] op_sel_hi:[0,1,1] neg_lo:[1,0,0] neg_hi:[1,0,0]
    v_pk_mul_f32 v[226:227], v[52:53], v[52:53]
    v_pk_mul_f32 v[228:229], v[54:55], v[54:55]
    v_pk_fma_f32 v[226:227], v[226:227], v[170:171], v[170:171] op_sel:[0,1,0] op_sel_hi:[1,1,0]
    v_pk_fma_f32 v[228:229], v[228:229], v[170:171], v[170:171] op_sel:[0,1,0] op_sel_hi:[1,1,0]
    v_pk_mul_f32 v[226:227], v[226:227], v[52:53]
    v_pk_mul_f32 v[228:229], v[228:229], v[54:55]
    v_exp_f32 v226, v226
    v_exp_f32 v227, v227
    v_exp_f32 v228, v228
    v_exp_f32 v229, v229
    v_pk_fma_f32 v[226:227], v[226:227], v[168:169], v[168:169] op_sel:[0,1,1] op_sel_hi:[1,1,1]
    v_pk_fma_f32 v[228:229], v[228:229], v[168:169], v[168:169] op_sel:[0,1,1] op_sel_hi:[1,1,1]
    v_rcp_f32 v226, v226
    v_rcp_f32 v227, v227
    v_rcp_f32 v228, v228
    v_rcp_f32 v229, v229
    v_pk_mul_f32 v[52:53], v[52:53], v[226:227]
    v_pk_mul_f32 v[54:55], v[54:55], v[228:229]
    v_cvt_pk_bf16_f32 v218, v52, v53
    v_cvt_pk_bf16_f32 v219, v54, v55
    v_or_b32 v218, 1, v218
    s_add_u32 s36, s46, 229376
    buffer_store_dwordx4 v[64:67], v2, s[16:19], s36 offen sc1
    v_pk_fma_f32 v[80:81], v[172:173], v[136:137], v[80:81] op_sel_hi:[0,1,1] neg_lo:[1,0,0] neg_hi:[1,0,0]
    v_pk_fma_f32 v[82:83], v[172:173], v[138:139], v[82:83] op_sel_hi:[0,1,1] neg_lo:[1,0,0] neg_hi:[1,0,0]
    v_pk_mul_f32 v[226:227], v[80:81], v[80:81]
    v_pk_mul_f32 v[228:229], v[82:83], v[82:83]
    v_pk_fma_f32 v[226:227], v[226:227], v[174:175], v[174:175] op_sel:[0,1,0] op_sel_hi:[1,1,0]
    v_pk_fma_f32 v[228:229], v[228:229], v[174:175], v[174:175] op_sel:[0,1,0] op_sel_hi:[1,1,0]
    v_pk_mul_f32 v[226:227], v[226:227], v[80:81]
    v_pk_mul_f32 v[228:229], v[228:229], v[82:83]
    v_exp_f32 v226, v226
    v_exp_f32 v227, v227
    v_exp_f32 v228, v228
    v_exp_f32 v229, v229
    v_pk_fma_f32 v[226:227], v[226:227], v[172:173], v[172:173] op_sel:[0,1,1] op_sel_hi:[1,1,1]
    v_pk_fma_f32 v[228:229], v[228:229], v[172:173], v[172:173] op_sel:[0,1,1] op_sel_hi:[1,1,1]
    v_rcp_f32 v226, v226
    v_rcp_f32 v227, v227
    v_rcp_f32 v228, v228
    v_rcp_f32 v229, v229
    v_pk_mul_f32 v[80:81], v[80:81], v[226:227]
    v_pk_mul_f32 v[82:83], v[82:83], v[228:229]
    v_cvt_pk_bf16_f32 v220, v80, v81
    v_cvt_pk_bf16_f32 v221, v82, v83
    v_or_b32 v220, 1, v220
    s_add_u32 s36, s46, 458752
    buffer_store_dwordx4 v[92:95], v2, s[16:19], s36 offen sc1
    v_pk_fma_f32 v[108:109], v[176:177], v[136:137], v[108:109] op_sel_hi:[0,1,1] neg_lo:[1,0,0] neg_hi:[1,0,0]
    v_pk_fma_f32 v[110:111], v[176:177], v[138:139], v[110:111] op_sel_hi:[0,1,1] neg_lo:[1,0,0] neg_hi:[1,0,0]
    v_pk_mul_f32 v[226:227], v[108:109], v[108:109]
    v_pk_mul_f32 v[228:229], v[110:111], v[110:111]
    v_pk_fma_f32 v[226:227], v[226:227], v[178:179], v[178:179] op_sel:[0,1,0] op_sel_hi:[1,1,0]
    v_pk_fma_f32 v[228:229], v[228:229], v[178:179], v[178:179] op_sel:[0,1,0] op_sel_hi:[1,1,0]
    v_pk_mul_f32 v[226:227], v[226:227], v[108:109]
    v_pk_mul_f32 v[228:229], v[228:229], v[110:111]
    v_exp_f32 v226, v226
    v_exp_f32 v227, v227
    v_exp_f32 v228, v228
    v_exp_f32 v229, v229
    v_pk_fma_f32 v[226:227], v[226:227], v[176:177], v[176:177] op_sel:[0,1,1] op_sel_hi:[1,1,1]
    v_pk_fma_f32 v[228:229], v[228:229], v[176:177], v[176:177] op_sel:[0,1,1] op_sel_hi:[1,1,1]
    v_rcp_f32 v226, v226
    v_rcp_f32 v227, v227
    v_rcp_f32 v228, v228
    v_rcp_f32 v229, v229
    v_pk_mul_f32 v[108:109], v[108:109], v[226:227]
    v_pk_mul_f32 v[110:111], v[110:111], v[228:229]
    v_cvt_pk_bf16_f32 v222, v108, v109
    v_cvt_pk_bf16_f32 v223, v110, v111
    s_add_u32 s36, s46, 688128
    buffer_store_dwordx4 v[120:123], v2, s[16:19], s36 offen sc1
    s_waitcnt lgkmcnt(0)
    s_add_u32 s45, s44, 512
    s_mov_b32 s44, s47
G3_e2:
    s_waitcnt lgkmcnt(0)
    s_barrier
    ds_read_b128 v[88:91], v17 offset:0
    ds_read_b128 v[92:95], v17 offset:2048
    ds_read_b128 v[96:99], v17 offset:4096
    ds_read_b128 v[100:103], v17 offset:6144
    ds_read_b64_tr_b16 v[104:105], v18 offset:0
    ds_read_b64_tr_b16 v[106:107], v18 offset:4096
    ds_read_b64_tr_b16 v[108:109], v19 offset:0
    ds_read_b64_tr_b16 v[110:111], v19 offset:4096
    ds_read_b64_tr_b16 v[112:113], v20 offset:0
    ds_read_b64_tr_b16 v[114:115], v20 offset:4096
    ds_read_b64_tr_b16 v[116:117], v21 offset:0
    ds_read_b64_tr_b16 v[118:119], v21 offset:4096
    s_waitcnt lgkmcnt(6)
    v_mfma_f32_16x16x32_bf16 v[24:27], v[104:107], v[88:91], 0
    ds_read_b128 v[120:123], v17 offset:1024
    s_add_u32 s42, s42, 16384
    v_mfma_f32_16x16x32_bf16 v[40:43], v[104:107], v[92:95], 0
    ds_read_b128 v[124:127], v17 offset:3072
    s_cmp_eq_u32 s42, 49152
    v_mfma_f32_16x16x32_bf16 v[56:59], v[104:107], v[96:99], 0
    ds_read_b128 v[128:131], v17 offset:5120
    s_cselect_b32 s42, 0, s42
    v_mfma_f32_16x16x32_bf16 v[72:75], v[104:107], v[100:103], 0
    ds_read_b128 v[132:135], v17 offset:7168
    s_waitcnt lgkmcnt(8)
    v_mfma_f32_16x16x32_bf16 v[76:79], v[108:111], v[100:103], 0
    ds_read_b64_tr_b16 v[136:137], v18 offset:8192
    s_add_u32 s48, s48, 16384
    v_mfma_f32_16x16x32_bf16 v[60:63], v[108:111], v[96:99], 0
    ds_read_b64_tr_b16 v[138:139], v18 offset:12288
    s_cmp_eq_u32 s48, 98304
    v_mfma_f32_16x16x32_bf16 v[44:47], v[108:111], v[92:95], 0
    ds_read_b64_tr_b16 v[140:141], v19 offset:8192
    s_cselect_b32 s48, 0, s48
    v_mfma_f32_16x16x32_bf16 v[28:31], v[108:111], v[88:91], 0
    ds_read_b64_tr_b16 v[142:143], v19 offset:12288
    s_waitcnt lgkmcnt(8)
    v_mfma_f32_16x16x32_bf16 v[32:35], v[112:115], v[88:91], 0
    ds_read_b64_tr_b16 v[144:145], v20 offset:8192
    v_add_u32 v17, s42, v12
    v_mfma_f32_16x16x32_bf16 v[48:51], v[112:115], v[92:95], 0
    ds_read_b64_tr_b16 v[146:147], v20 offset:12288
    s_add_u32 s36, s44, 0
    v_mfma_f32_16x16x32_bf16 v[64:67], v[112:115], v[96:99], 0
    ds_read_b64_tr_b16 v[148:149], v21 offset:8192
    buffer_store_dwordx4 v[200:203], v2, s[16:19], s36 offen sc1
    v_mfma_f32_16x16x32_bf16 v[80:83], v[112:115], v[100:103], 0
    ds_read_b64_tr_b16 v[150:151], v21 offset:12288
    s_add_u32 s36, s45, 0
    v_mfma_f32_16x16x32_bf16 v[84:87], v[116:119], v[100:103], 0
    buffer_store_dwordx2 v[216:217], v238, s[16:19], s36 offen sc1
    v_add_u32 v18, s48, v13
    v_mfma_f32_16x16x32_bf16 v[68:71], v[116:119], v[96:99], 0
    v_add_u32 v19, s48, v14
    v_mfma_f32_16x16x32_bf16 v[52:55], v[116:119], v[92:95], 0
    v_add_u32 v20, s48, v15
    v_mfma_f32_16x16x32_bf16 v[36:39], v[116:119], v[88:91], 0
    v_add_u32 v21, s48, v16
    s_waitcnt lgkmcnt(6)
    v_mfma_f32_16x16x32_bf16 v[24:27], v[136:139], v[120:123], v[24:27]
    v_mfma_f32_16x16x32_bf16 v[40:43], v[136:139], v[124:127], v[40:43]
    v_mfma_f32_16x16x32_bf16 v[56:59], v[136:139], v[128:131], v[56:59]
    s_waitcnt lgkmcnt(0)
    s_barrier
    v_mfma_f32_16x16x32_bf16 v[72:75], v[136:139], v[132:135], v[72:75]
    ds_read_b128 v[88:91], v17 offset:0
    s_add_u32 s36, s44, 229376
    v_mfma_f32_16x16x32_bf16 v[76:79], v[140:143], v[132:135], v[76:79]
    ds_read_b128 v[92:95], v17 offset:2048
    buffer_store_dwordx4 v[204:207], v2, s[16:19], s36 offen sc1
    v_mfma_f32_16x16x32_bf16 v[60:63], v[140:143], v[128:131], v[60:63]
    ds_read_b128 v[96:99], v17 offset:4096
    s_add_u32 s36, s45, 229376
    v_mfma_f32_16x16x32_bf16 v[44:47], v[140:143], v[124:127], v[44:47]
    ds_read_b128 v[100:103], v17 offset:6144
    buffer_store_dwordx2 v[218:219], v238, s[16:19], s36 offen sc1
    v_mfma_f32_16x16x32_bf16 v[28:31], v[140:143], v[120:123], v[28:31]
    ds_read_b64_tr_b16 v[104:105], v18 offset:0
    s_add_u32 s43, s43, 1
    v_mfma_f32_16x16x32_bf16 v[32:35], v[144:147], v[120:123], v[32:35]
    ds_read_b64_tr_b16 v[106:107], v18 offset:4096
    s_cmp_lt_u32 s43, 27
    v_mfma_f32_16x16x32_bf16 v[48:51], v[144:147], v[124:127], v[48:51]
    ds_read_b64_tr_b16 v[108:109], v19 offset:0
    v_mfma_f32_16x16x32_bf16 v[64:67], v[144:147], v[128:131], v[64:67]
    ds_read_b64_tr_b16 v[110:111], v19 offset:4096
    v_mfma_f32_16x16x32_bf16 v[80:83], v[144:147], v[132:135], v[80:83]
    ds_read_b64_tr_b16 v[112:113], v20 offset:0
    v_mfma_f32_16x16x32_bf16 v[84:87], v[148:151], v[132:135], v[84:87]
    ds_read_b64_tr_b16 v[114:115], v20 offset:4096
    v_mfma_f32_16x16x32_bf16 v[68:71], v[148:151], v[128:131], v[68:71]
    ds_read_b64_tr_b16 v[116:117], v21 offset:0
    v_mfma_f32_16x16x32_bf16 v[52:55], v[148:151], v[124:127], v[52:55]
    ds_read_b64_tr_b16 v[118:119], v21 offset:4096
    v_mfma_f32_16x16x32_bf16 v[36:39], v[148:151], v[120:123], v[36:39]
    s_waitcnt lgkmcnt(6)
    v_mfma_f32_16x16x32_bf16 v[24:27], v[104:107], v[88:91], v[24:27]
    ds_read_b128 v[120:123], v17 offset:1024
    s_add_u32 s42, s42, 16384
    v_mfma_f32_16x16x32_bf16 v[40:43], v[104:107], v[92:95], v[40:43]
    ds_read_b128 v[124:127], v17 offset:3072
    s_cmp_eq_u32 s42, 49152
    v_mfma_f32_16x16x32_bf16 v[56:59], v[104:107], v[96:99], v[56:59]
    ds_read_b128 v[128:131], v17 offset:5120
    s_cselect_b32 s42, 0, s42
    v_mfma_f32_16x16x32_bf16 v[72:75], v[104:107], v[100:103], v[72:75]
    ds_read_b128 v[132:135], v17 offset:7168
    s_waitcnt lgkmcnt(8)
    v_mfma_f32_16x16x32_bf16 v[76:79], v[108:111], v[100:103], v[76:79]
    ds_read_b64_tr_b16 v[136:137], v18 offset:8192
    s_add_u32 s48, s48, 16384
    v_mfma_f32_16x16x32_bf16 v[60:63], v[108:111], v[96:99], v[60:63]
    ds_read_b64_tr_b16 v[138:139], v18 offset:12288
    s_cmp_eq_u32 s48, 98304
    v_mfma_f32_16x16x32_bf16 v[44:47], v[108:111], v[92:95], v[44:47]
    ds_read_b64_tr_b16 v[140:141], v19 offset:8192
    s_cselect_b32 s48, 0, s48
    v_mfma_f32_16x16x32_bf16 v[28:31], v[108:111], v[88:91], v[28:31]
    ds_read_b64_tr_b16 v[142:143], v19 offset:12288
    s_waitcnt lgkmcnt(8)
    v_mfma_f32_16x16x32_bf16 v[32:35], v[112:115], v[88:91], v[32:35]
    ds_read_b64_tr_b16 v[144:145], v20 offset:8192
    v_add_u32 v17, s42, v12
    v_mfma_f32_16x16x32_bf16 v[48:51], v[112:115], v[92:95], v[48:51]
    ds_read_b64_tr_b16 v[146:147], v20 offset:12288
    s_add_u32 s36, s44, 458752
    v_mfma_f32_16x16x32_bf16 v[64:67], v[112:115], v[96:99], v[64:67]
    ds_read_b64_tr_b16 v[148:149], v21 offset:8192
    buffer_store_dwordx4 v[208:211], v2, s[16:19], s36 offen sc1
    v_mfma_f32_16x16x32_bf16 v[80:83], v[112:115], v[100:103], v[80:83]
    ds_read_b64_tr_b16 v[150:151], v21 offset:12288
    s_add_u32 s36, s45, 458752
    v_mfma_f32_16x16x32_bf16 v[84:87], v[116:119], v[100:103], v[84:87]
    buffer_store_dwordx2 v[220:221], v238, s[16:19], s36 offen sc1
    v_add_u32 v18, s48, v13
    v_mfma_f32_16x16x32_bf16 v[68:71], v[116:119], v[96:99], v[68:71]
    v_add_u32 v19, s48, v14
    v_mfma_f32_16x16x32_bf16 v[52:55], v[116:119], v[92:95], v[52:55]
    v_add_u32 v20, s48, v15
    v_mfma_f32_16x16x32_bf16 v[36:39], v[116:119], v[88:91], v[36:39]
    v_add_u32 v21, s48, v16
    s_waitcnt lgkmcnt(6)
    v_mfma_f32_16x16x32_bf16 v[24:27], v[136:139], v[120:123], v[24:27]
    v_mfma_f32_16x16x32_bf16 v[40:43], v[136:139], v[124:127], v[40:43]
    s_waitcnt vmcnt(6)
    v_mfma_f32_16x16x32_bf16 v[56:59], v[136:139], v[128:131], v[56:59]
    s_waitcnt lgkmcnt(0)
    s_barrier
    v_mfma_f32_16x16x32_bf16 v[72:75], v[136:139], v[132:135], v[72:75]
    ds_read_b128 v[88:91], v17 offset:0
    s_add_u32 s36, s44, 688128
    v_mfma_f32_16x16x32_bf16 v[76:79], v[140:143], v[132:135], v[76:79]
    ds_read_b128 v[92:95], v17 offset:2048
    buffer_store_dwordx4 v[212:215], v2, s[16:19], s36 offen sc1
    v_mfma_f32_16x16x32_bf16 v[60:63], v[140:143], v[128:131], v[60:63]
    ds_read_b128 v[96:99], v17 offset:4096
    s_add_u32 s36, s45, 688128
    v_mfma_f32_16x16x32_bf16 v[44:47], v[140:143], v[124:127], v[44:47]
    ds_read_b128 v[100:103], v17 offset:6144
    buffer_store_dwordx2 v[222:223], v238, s[16:19], s36 offen sc1
    v_mfma_f32_16x16x32_bf16 v[28:31], v[140:143], v[120:123], v[28:31]
    ds_read_b64_tr_b16 v[104:105], v18 offset:0
    s_add_u32 s43, s43, 1
    v_mfma_f32_16x16x32_bf16 v[32:35], v[144:147], v[120:123], v[32:35]
    ds_read_b64_tr_b16 v[106:107], v18 offset:4096
    s_cmp_lt_u32 s43, 27
    v_mfma_f32_16x16x32_bf16 v[48:51], v[144:147], v[124:127], v[48:51]
    ds_read_b64_tr_b16 v[108:109], v19 offset:0
    v_mfma_f32_16x16x32_bf16 v[64:67], v[144:147], v[128:131], v[64:67]
    ds_read_b64_tr_b16 v[110:111], v19 offset:4096
    v_mfma_f32_16x16x32_bf16 v[80:83], v[144:147], v[132:135], v[80:83]
    ds_read_b64_tr_b16 v[112:113], v20 offset:0
    v_mfma_f32_16x16x32_bf16 v[84:87], v[148:151], v[132:135], v[84:87]
    ds_read_b64_tr_b16 v[114:115], v20 offset:4096
    v_mfma_f32_16x16x32_bf16 v[68:71], v[148:151], v[128:131], v[68:71]
    ds_read_b64_tr_b16 v[116:117], v21 offset:0
    v_mfma_f32_16x16x32_bf16 v[52:55], v[148:151], v[124:127], v[52:55]
    ds_read_b64_tr_b16 v[118:119], v21 offset:4096
    v_mfma_f32_16x16x32_bf16 v[36:39], v[148:151], v[120:123], v[36:39]
    s_waitcnt lgkmcnt(6)
mm_27:
    v_mfma_f32_16x16x32_bf16 v[24:27], v[104:107], v[88:91], v[24:27]
    ds_read_b128 v[120:123], v17 offset:1024
    s_add_u32 s42, s42, 16384
    v_mfma_f32_16x16x32_bf16 v[40:43], v[104:107], v[92:95], v[40:43]
    ds_read_b128 v[124:127], v17 offset:3072
    s_cmp_eq_u32 s42, 49152
    v_mfma_f32_16x16x32_bf16 v[56:59], v[104:107], v[96:99], v[56:59]
    ds_read_b128 v[128:131], v17 offset:5120
    s_cselect_b32 s42, 0, s42
    v_mfma_f32_16x16x32_bf16 v[72:75], v[104:107], v[100:103], v[72:75]
    ds_read_b128 v[132:135], v17 offset:7168
    s_waitcnt lgkmcnt(8)
    v_mfma_f32_16x16x32_bf16 v[76:79], v[108:111], v[100:103], v[76:79]
    ds_read_b64_tr_b16 v[136:137], v18 offset:8192
    s_add_u32 s48, s48, 16384
    v_mfma_f32_16x16x32_bf16 v[60:63], v[108:111], v[96:99], v[60:63]
    ds_read_b64_tr_b16 v[138:139], v18 offset:12288
    s_cmp_eq_u32 s48, 98304
    v_mfma_f32_16x16x32_bf16 v[44:47], v[108:111], v[92:95], v[44:47]
    ds_read_b64_tr_b16 v[140:141], v19 offset:8192
    s_cselect_b32 s48, 0, s48
    v_mfma_f32_16x16x32_bf16 v[28:31], v[108:111], v[88:91], v[28:31]
    ds_read_b64_tr_b16 v[142:143], v19 offset:12288
    s_waitcnt lgkmcnt(8)
    v_mfma_f32_16x16x32_bf16 v[32:35], v[112:115], v[88:91], v[32:35]
    ds_read_b64_tr_b16 v[144:145], v20 offset:8192
    v_add_u32 v17, s42, v12
    v_mfma_f32_16x16x32_bf16 v[48:51], v[112:115], v[92:95], v[48:51]
    ds_read_b64_tr_b16 v[146:147], v20 offset:12288
    v_add_u32 v18, s48, v13
    v_mfma_f32_16x16x32_bf16 v[64:67], v[112:115], v[96:99], v[64:67]
    ds_read_b64_tr_b16 v[148:149], v21 offset:8192
    v_add_u32 v19, s48, v14
    v_mfma_f32_16x16x32_bf16 v[80:83], v[112:115], v[100:103], v[80:83]
    ds_read_b64_tr_b16 v[150:151], v21 offset:12288
    v_add_u32 v20, s48, v15
    v_mfma_f32_16x16x32_bf16 v[84:87], v[116:119], v[100:103], v[84:87]
    v_add_u32 v21, s48, v16
    v_mfma_f32_16x16x32_bf16 v[68:71], v[116:119], v[96:99], v[68:71]
    v_mfma_f32_16x16x32_bf16 v[52:55], v[116:119], v[92:95], v[52:55]
    v_mfma_f32_16x16x32_bf16 v[36:39], v[116:119], v[88:91], v[36:39]
    s_waitcnt lgkmcnt(6)
    v_mfma_f32_16x16x32_bf16 v[24:27], v[136:139], v[120:123], v[24:27]
    s_add_u32 s43, s43, 1
    s_cmp_lt_u32 s43, 4
    v_mfma_f32_16x16x32_bf16 v[40:43], v[136:139], v[124:127], v[40:43]
    v_mfma_f32_16x16x32_bf16 v[56:59], v[136:139], v[128:131], v[56:59]
    s_waitcnt lgkmcnt(0)
    s_barrier
    v_mfma_f32_16x16x32_bf16 v[72:75], v[136:139], v[132:135], v[72:75]
    ds_read_b128 v[88:91], v17 offset:0
    v_mfma_f32_16x16x32_bf16 v[76:79], v[140:143], v[132:135], v[76:79]
    ds_read_b128 v[92:95], v17 offset:2048
    v_mfma_f32_16x16x32_bf16 v[60:63], v[140:143], v[128:131], v[60:63]
    ds_read_b128 v[96:99], v17 offset:4096
    v_mfma_f32_16x16x32_bf16 v[44:47], v[140:143], v[124:127], v[44:47]
    ds_read_b128 v[100:103], v17 offset:6144
    v_mfma_f32_16x16x32_bf16 v[28:31], v[140:143], v[120:123], v[28:31]
    ds_read_b64_tr_b16 v[104:105], v18 offset:0
    v_mfma_f32_16x16x32_bf16 v[32:35], v[144:147], v[120:123], v[32:35]
    ds_read_b64_tr_b16 v[106:107], v18 offset:4096
    v_mfma_f32_16x16x32_bf16 v[48:51], v[144:147], v[124:127], v[48:51]
    ds_read_b64_tr_b16 v[108:109], v19 offset:0
    v_mfma_f32_16x16x32_bf16 v[64:67], v[144:147], v[128:131], v[64:67]
    ds_read_b64_tr_b16 v[110:111], v19 offset:4096
    v_mfma_f32_16x16x32_bf16 v[80:83], v[144:147], v[132:135], v[80:83]
    ds_read_b64_tr_b16 v[112:113], v20 offset:0
    v_mfma_f32_16x16x32_bf16 v[84:87], v[148:151], v[132:135], v[84:87]
    ds_read_b64_tr_b16 v[114:115], v20 offset:4096
    v_mfma_f32_16x16x32_bf16 v[68:71], v[148:151], v[128:131], v[68:71]
    ds_read_b64_tr_b16 v[116:117], v21 offset:0
    v_mfma_f32_16x16x32_bf16 v[52:55], v[148:151], v[124:127], v[52:55]
    ds_read_b64_tr_b16 v[118:119], v21 offset:4096
    v_mfma_f32_16x16x32_bf16 v[36:39], v[148:151], v[120:123], v[36:39]
    s_waitcnt lgkmcnt(6)
    s_cbranch_scc1 mm_27
mm_28:
    v_mfma_f32_16x16x32_bf16 v[24:27], v[104:107], v[88:91], v[24:27]
    ds_read_b128 v[120:123], v17 offset:1024
    s_add_u32 s42, s42, 16384
    v_mfma_f32_16x16x32_bf16 v[40:43], v[104:107], v[92:95], v[40:43]
    ds_read_b128 v[124:127], v17 offset:3072
    s_cmp_eq_u32 s42, 49152
    v_mfma_f32_16x16x32_bf16 v[56:59], v[104:107], v[96:99], v[56:59]
    ds_read_b128 v[128:131], v17 offset:5120
    s_cselect_b32 s42, 0, s42
    v_mfma_f32_16x16x32_bf16 v[72:75], v[104:107], v[100:103], v[72:75]
    ds_read_b128 v[132:135], v17 offset:7168
    s_waitcnt lgkmcnt(8)
    v_mfma_f32_16x16x32_bf16 v[76:79], v[108:111], v[100:103], v[76:79]
    ds_read_b64_tr_b16 v[136:137], v18 offset:8192
    s_add_u32 s48, s48, 16384
    v_mfma_f32_16x16x32_bf16 v[60:63], v[108:111], v[96:99], v[60:63]
    ds_read_b64_tr_b16 v[138:139], v18 offset:12288
    s_cmp_eq_u32 s48, 98304
    v_mfma_f32_16x16x32_bf16 v[44:47], v[108:111], v[92:95], v[44:47]
    ds_read_b64_tr_b16 v[140:141], v19 offset:8192
    s_cselect_b32 s48, 0, s48
    v_mfma_f32_16x16x32_bf16 v[28:31], v[108:111], v[88:91], v[28:31]
    ds_read_b64_tr_b16 v[142:143], v19 offset:12288
    s_waitcnt lgkmcnt(8)
    v_mfma_f32_16x16x32_bf16 v[32:35], v[112:115], v[88:91], v[32:35]
    ds_read_b64_tr_b16 v[144:145], v20 offset:8192
    v_add_u32 v17, s42, v12
    v_mfma_f32_16x16x32_bf16 v[48:51], v[112:115], v[92:95], v[48:51]
    ds_read_b64_tr_b16 v[146:147], v20 offset:12288
    v_add_u32 v18, s48, v13
    v_mfma_f32_16x16x32_bf16 v[64:67], v[112:115], v[96:99], v[64:67]
    ds_read_b64_tr_b16 v[148:149], v21 offset:8192
    v_add_u32 v19, s48, v14
    v_mfma_f32_16x16x32_bf16 v[80:83], v[112:115], v[100:103], v[80:83]
    ds_read_b64_tr_b16 v[150:151], v21 offset:12288
    v_add_u32 v20, s48, v15
    v_mfma_f32_16x16x32_bf16 v[84:87], v[116:119], v[100:103], v[84:87]
    v_add_u32 v21, s48, v16
    v_mfma_f32_16x16x32_bf16 v[68:71], v[116:119], v[96:99], v[68:71]
    v_mfma_f32_16x16x32_bf16 v[52:55], v[116:119], v[92:95], v[52:55]
    v_mfma_f32_16x16x32_bf16 v[36:39], v[116:119], v[88:91], v[36:39]
    s_waitcnt lgkmcnt(6)
    v_mfma_f32_16x16x32_bf16 v[24:27], v[136:139], v[120:123], v[24:27]
    s_add_u32 s43, s43, 1
    s_cmp_lt_u32 s43, 27
    v_mfma_f32_16x16x32_bf16 v[40:43], v[136:139], v[124:127], v[40:43]
    s_waitcnt vmcnt(0)
    v_mfma_f32_16x16x32_bf16 v[56:59], v[136:139], v[128:131], v[56:59]
    s_waitcnt lgkmcnt(0)
    s_barrier
    v_mfma_f32_16x16x32_bf16 v[72:75], v[136:139], v[132:135], v[72:75]
    ds_read_b128 v[88:91], v17 offset:0
    v_mfma_f32_16x16x32_bf16 v[76:79], v[140:143], v[132:135], v[76:79]
    ds_read_b128 v[92:95], v17 offset:2048
    v_mfma_f32_16x16x32_bf16 v[60:63], v[140:143], v[128:131], v[60:63]
    ds_read_b128 v[96:99], v17 offset:4096
    v_mfma_f32_16x16x32_bf16 v[44:47], v[140:143], v[124:127], v[44:47]
    ds_read_b128 v[100:103], v17 offset:6144
    v_mfma_f32_16x16x32_bf16 v[28:31], v[140:143], v[120:123], v[28:31]
    ds_read_b64_tr_b16 v[104:105], v18 offset:0
    v_mfma_f32_16x16x32_bf16 v[32:35], v[144:147], v[120:123], v[32:35]
    ds_read_b64_tr_b16 v[106:107], v18 offset:4096
    v_mfma_f32_16x16x32_bf16 v[48:51], v[144:147], v[124:127], v[48:51]
    ds_read_b64_tr_b16 v[108:109], v19 offset:0
    v_mfma_f32_16x16x32_bf16 v[64:67], v[144:147], v[128:131], v[64:67]
    ds_read_b64_tr_b16 v[110:111], v19 offset:4096
    v_mfma_f32_16x16x32_bf16 v[80:83], v[144:147], v[132:135], v[80:83]
    ds_read_b64_tr_b16 v[112:113], v20 offset:0
    v_mfma_f32_16x16x32_bf16 v[84:87], v[148:151], v[132:135], v[84:87]
    ds_read_b64_tr_b16 v[114:115], v20 offset:4096
    v_mfma_f32_16x16x32_bf16 v[68:71], v[148:151], v[128:131], v[68:71]
    ds_read_b64_tr_b16 v[116:117], v21 offset:0
    v_mfma_f32_16x16x32_bf16 v[52:55], v[148:151], v[124:127], v[52:55]
    ds_read_b64_tr_b16 v[118:119], v21 offset:4096
    v_mfma_f32_16x16x32_bf16 v[36:39], v[148:151], v[120:123], v[36:39]
    s_waitcnt lgkmcnt(6)
    s_cbranch_scc1 mm_28
    s_cmp_eq_u32 s60, 1
    s_cbranch_scc1 G4_last
    v_mfma_f32_16x16x32_bf16 v[24:27], v[104:107], v[88:91], v[24:27]
    ds_read_b128 v[120:123], v17 offset:1024
    v_mfma_f32_16x16x32_bf16 v[40:43], v[104:107], v[92:95], v[40:43]
    ds_read_b128 v[124:127], v17 offset:3072
    v_mfma_f32_16x16x32_bf16 v[56:59], v[104:107], v[96:99], v[56:59]
    ds_read_b128 v[128:131], v17 offset:5120
    v_mfma_f32_16x16x32_bf16 v[72:75], v[104:107], v[100:103], v[72:75]
    ds_read_b128 v[132:135], v17 offset:7168
    s_waitcnt lgkmcnt(8)
    v_mfma_f32_16x16x32_bf16 v[76:79], v[108:111], v[100:103], v[76:79]
    ds_read_b64_tr_b16 v[136:137], v18 offset:8192
    v_mfma_f32_16x16x32_bf16 v[60:63], v[108:111], v[96:99], v[60:63]
    ds_read_b64_tr_b16 v[138:139], v18 offset:12288
    v_mfma_f32_16x16x32_bf16 v[44:47], v[108:111], v[92:95], v[44:47]
    ds_read_b64_tr_b16 v[140:141], v19 offset:8192
    v_mfma_f32_16x16x32_bf16 v[28:31], v[108:111], v[88:91], v[28:31]
    ds_read_b64_tr_b16 v[142:143], v19 offset:12288
    s_waitcnt lgkmcnt(8)
    v_mfma_f32_16x16x32_bf16 v[32:35], v[112:115], v[88:91], v[32:35]
    ds_read_b64_tr_b16 v[144:145], v20 offset:8192
    v_mfma_f32_16x16x32_bf16 v[48:51], v[112:115], v[92:95], v[48:51]
    ds_read_b64_tr_b16 v[146:147], v20 offset:12288
    v_mfma_f32_16x16x32_bf16 v[64:67], v[112:115], v[96:99], v[64:67]
    ds_read_b64_tr_b16 v[148:149], v21 offset:8192
    v_mfma_f32_16x16x32_bf16 v[80:83], v[112:115], v[100:103], v[80:83]
    ds_read_b64_tr_b16 v[150:151], v21 offset:12288
    v_mfma_f32_16x16x32_bf16 v[84:87], v[116:119], v[100:103], v[84:87]
    v_mfma_f32_16x16x32_bf16 v[68:71], v[116:119], v[96:99], v[68:71]
    v_mfma_f32_16x16x32_bf16 v[52:55], v[116:119], v[92:95], v[52:55]
    v_mfma_f32_16x16x32_bf16 v[36:39], v[116:119], v[88:91], v[36:39]
    s_waitcnt lgkmcnt(0)
    v_mfma_f32_16x16x32_bf16 v[24:27], v[136:139], v[120:123], v[24:27]
    s_mul_i32 s36, s31, 524288
    s_add_u32 s36, s36, 0
    s_add_u32 s16, s62, s36
    v_mfma_f32_16x16x32_bf16 v[40:43], v[136:139], v[124:127], v[40:43]
    s_addc_u32 s17, s63, 0
    s_mov_b32 s18, 516096
    s_mov_b32 s19, 0x20000
    v_mfma_f32_16x16x32_bf16 v[56:59], v[136:139], v[128:131], v[56:59]
    v_mfma_f32_16x16x32_bf16 v[72:75], v[136:139], v[132:135], v[72:75]
    v_mfma_f32_16x16x32_bf16 v[76:79], v[140:143], v[132:135], v[76:79]
    v_mfma_f32_16x16x32_bf16 v[60:63], v[140:143], v[128:131], v[60:63]
    v_mfma_f32_16x16x32_bf16 v[44:47], v[140:143], v[124:127], v[44:47]
    v_mfma_f32_16x16x32_bf16 v[28:31], v[140:143], v[120:123], v[28:31]
    v_mfma_f32_16x16x32_bf16 v[32:35], v[144:147], v[120:123], v[32:35]
    v_mfma_f32_16x16x32_bf16 v[48:51], v[144:147], v[124:127], v[48:51]
    v_mfma_f32_16x16x32_bf16 v[64:67], v[144:147], v[128:131], v[64:67]
    v_mfma_f32_16x16x32_bf16 v[80:83], v[144:147], v[132:135], v[80:83]
    v_mfma_f32_16x16x32_bf16 v[84:87], v[148:151], v[132:135], v[84:87]
    v_mfma_f32_16x16x32_bf16 v[68:71], v[148:151], v[128:131], v[68:71]
    v_mfma_f32_16x16x32_bf16 v[52:55], v[148:151], v[124:127], v[52:55]
    v_mfma_f32_16x16x32_bf16 v[36:39], v[148:151], v[120:123], v[36:39]
    s_add_u32 s36, s39, 0
    v_cvt_pk_bf16_f32 v24, v24, v25
    v_cvt_pk_bf16_f32 v25, v26, v27
    v_cvt_pk_bf16_f32 v26, v28, v29
    v_cvt_pk_bf16_f32 v27, v30, v31
    v_or_b32 v24, 1, v24
    buffer_store_dwordx4 v[24:27], v2, s[16:19], s36 offen offset:0 sc1
    v_cvt_pk_bf16_f32 v32, v32, v33
    v_cvt_pk_bf16_f32 v33, v34, v35
    v_cvt_pk_bf16_f32 v34, v36, v37
    v_cvt_pk_bf16_f32 v35, v38, v39
    v_or_b32 v32, 1, v32
    buffer_store_dwordx4 v[32:35], v2, s[16:19], s36 offen offset:1024 sc1
    s_add_u32 s36, s39, 65536
    v_cvt_pk_bf16_f32 v40, v40, v41
    v_cvt_pk_bf16_f32 v41, v42, v43
    v_cvt_pk_bf16_f32 v42, v44, v45
    v_cvt_pk_bf16_f32 v43, v46, v47
    v_or_b32 v40, 1, v40
    buffer_store_dwordx4 v[40:43], v2, s[16:19], s36 offen offset:0 sc1
    v_cvt_pk_bf16_f32 v48, v48, v49
    v_cvt_pk_bf16_f32 v49, v50, v51
    v_cvt_pk_bf16_f32 v50, v52, v53
    v_cvt_pk_bf16_f32 v51, v54, v55
    v_or_b32 v48, 1, v48
    buffer_store_dwordx4 v[48:51], v2, s[16:19], s36 offen offset:1024 sc1
    s_add_u32 s36, s39, 131072
    v_cvt_pk_bf16_f32 v56, v56, v57
    v_cvt_pk_bf16_f32 v57, v58, v59
    v_cvt_pk_bf16_f32 v58, v60, v61
    v_cvt_pk_bf16_f32 v59, v62, v63
    v_or_b32 v56, 1, v56
    buffer_store_dwordx4 v[56:59], v2, s[16:19], s36 offen offset:0 sc1
    v_cvt_pk_bf16_f32 v64, v64, v65
    v_cvt_pk_bf16_f32 v65, v66, v67
    v_cvt_pk_bf16_f32 v66, v68, v69
    v_cvt_pk_bf16_f32 v67, v70, v71
    v_or_b32 v64, 1, v64
    buffer_store_dwordx4 v[64:67], v2, s[16:19], s36 offen offset:1024 sc1
    s_add_u32 s36, s39, 196608
    v_cvt_pk_bf16_f32 v72, v72, v73
    v_cvt_pk_bf16_f32 v73, v74, v75
    v_cvt_pk_bf16_f32 v74, v76, v77
    v_cvt_pk_bf16_f32 v75, v78, v79
    v_or_b32 v72, 1, v72
    buffer_store_dwordx4 v[72:75], v2, s[16:19], s36 offen offset:0 sc1
    v_cvt_pk_bf16_f32 v80, v80, v81
    v_cvt_pk_bf16_f32 v81, v82, v83
    v_cvt_pk_bf16_f32 v82, v84, v85
    v_cvt_pk_bf16_f32 v83, v86, v87
    v_or_b32 v80, 1, v80
    buffer_store_dwordx4 v[80:83], v2, s[16:19], s36 offen offset:1024 sc1
    s_barrier
    s_branch NEXT
G4_last:
    v_mfma_f32_16x16x32_bf16 v[24:27], v[104:107], v[88:91], v[24:27]
    ds_read_b128 v[120:123], v17 offset:1024
    v_mfma_f32_16x16x32_bf16 v[40:43], v[104:107], v[92:95], v[40:43]
    ds_read_b128 v[124:127], v17 offset:3072
    v_mfma_f32_16x16x32_bf16 v[56:59], v[104:107], v[96:99], v[56:59]
    ds_read_b128 v[128:131], v17 offset:5120
    v_mfma_f32_16x16x32_bf16 v[72:75], v[104:107], v[100:103], v[72:75]
    ds_read_b128 v[132:135], v17 offset:7168
    s_waitcnt lgkmcnt(8)
    v_mfma_f32_16x16x32_bf16 v[76:79], v[108:111], v[100:103], v[76:79]
    ds_read_b64_tr_b16 v[136:137], v18 offset:8192
    v_mfma_f32_16x16x32_bf16 v[60:63], v[108:111], v[96:99], v[60:63]
    ds_read_b64_tr_b16 v[138:139], v18 offset:12288
    v_mfma_f32_16x16x32_bf16 v[44:47], v[108:111], v[92:95], v[44:47]
    ds_read_b64_tr_b16 v[140:141], v19 offset:8192
    v_mfma_f32_16x16x32_bf16 v[28:31], v[108:111], v[88:91], v[28:31]
    ds_read_b64_tr_b16 v[142:143], v19 offset:12288
    s_waitcnt lgkmcnt(8)
    v_mfma_f32_16x16x32_bf16 v[32:35], v[112:115], v[88:91], v[32:35]
    ds_read_b64_tr_b16 v[144:145], v20 offset:8192
    v_mfma_f32_16x16x32_bf16 v[48:51], v[112:115], v[92:95], v[48:51]
    ds_read_b64_tr_b16 v[146:147], v20 offset:12288
    s_load_dwordx2 s[6:7], s[0:1], 88
    v_mfma_f32_16x16x32_bf16 v[64:67], v[112:115], v[96:99], v[64:67]
    ds_read_b64_tr_b16 v[148:149], v21 offset:8192
    v_mfma_f32_16x16x32_bf16 v[80:83], v[112:115], v[100:103], v[80:83]
    ds_read_b64_tr_b16 v[150:151], v21 offset:12288
    v_mfma_f32_16x16x32_bf16 v[84:87], v[116:119], v[100:103], v[84:87]
    v_mfma_f32_16x16x32_bf16 v[68:71], v[116:119], v[96:99], v[68:71]
    v_mfma_f32_16x16x32_bf16 v[52:55], v[116:119], v[92:95], v[52:55]
    v_mfma_f32_16x16x32_bf16 v[36:39], v[116:119], v[88:91], v[36:39]
    s_waitcnt lgkmcnt(0)
    v_mfma_f32_16x16x32_bf16 v[24:27], v[136:139], v[120:123], v[24:27]
    s_add_u32 s16, s62, 0x80000
    s_addc_u32 s17, s63, 0
    s_mov_b32 s18, 0x7e000
    v_mfma_f32_16x16x32_bf16 v[40:43], v[136:139], v[124:127], v[40:43]
    s_mov_b32 s19, 0x20000
    s_mov_b32 s20, s6
    s_mov_b32 s21, s7
    v_mfma_f32_16x16x32_bf16 v[56:59], v[136:139], v[128:131], v[56:59]
    s_mov_b32 s22, 0x400000
    s_mov_b32 s23, 0x20000
    s_add_u32 s44, s40, 65536
    v_mfma_f32_16x16x32_bf16 v[72:75], v[136:139], v[132:135], v[72:75]
    s_lshl_b32 s46, s28, 3
    s_add_u32 s46, s46, s37
    s_lshl_b32 s47, s31, 1
    v_mfma_f32_16x16x32_bf16 v[76:79], v[140:143], v[132:135], v[76:79]
    s_add_u32 s46, s46, s47
    s_lshl_b32 s46, s46, 15
    s_lshl_b32 s47, s38, 5
    v_mfma_f32_16x16x32_bf16 v[60:63], v[140:143], v[128:131], v[60:63]
    s_add_u32 s46, s46, s47
    s_add_u32 s47, s46, 32768
    v_and_b32 v225, 1, v23
    v_mfma_f32_16x16x32_bf16 v[44:47], v[140:143], v[124:127], v[44:47]
    v_lshlrev_b32 v224, 11, v22
    v_lshl_add_u32 v224, v225, 5, v224
    v_mfma_f32_16x16x32_bf16 v[28:31], v[140:143], v[120:123], v[28:31]
    v_lshrrev_b32 v225, 1, v23
    v_lshl_add_u32 v224, v225, 4, v224
    v_mfma_f32_16x16x32_bf16 v[32:35], v[144:147], v[120:123], v[32:35]
    v_lshrrev_b32 v225, 3, v22
    v_mul_u32_u24 v225, 16320, v225
    v_mfma_f32_16x16x32_bf16 v[48:51], v[144:147], v[124:127], v[48:51]
    v_sub_u32 v224, v224, v225
    v_add_u32 v225, 16384, v224
    v_mfma_f32_16x16x32_bf16 v[64:67], v[144:147], v[128:131], v[64:67]
    v_mfma_f32_16x16x32_bf16 v[80:83], v[144:147], v[132:135], v[80:83]
    v_mfma_f32_16x16x32_bf16 v[84:87], v[148:151], v[132:135], v[84:87]
    v_mfma_f32_16x16x32_bf16 v[68:71], v[148:151], v[128:131], v[68:71]
    v_mfma_f32_16x16x32_bf16 v[52:55], v[148:151], v[124:127], v[52:55]
    v_mfma_f32_16x16x32_bf16 v[36:39], v[148:151], v[120:123], v[36:39]
    s_cmp_eq_u32 s31, 0
    s_cbranch_scc1 G4_k0
    s_add_u32 s36, s41, 0
    v_cvt_pk_bf16_f32 v24, v24, v25
    v_cvt_pk_bf16_f32 v25, v26, v27
    v_cvt_pk_bf16_f32 v26, v28, v29
    v_cvt_pk_bf16_f32 v27, v30, v31
    v_or_b32 v24, 1, v24
    buffer_store_dwordx4 v[24:27], v2, s[16:19], s36 offen offset:0 sc1
    v_cvt_pk_bf16_f32 v32, v32, v33
    v_cvt_pk_bf16_f32 v33, v34, v35
    v_cvt_pk_bf16_f32 v34, v36, v37
    v_cvt_pk_bf16_f32 v35, v38, v39
    v_or_b32 v32, 1, v32
    buffer_store_dwordx4 v[32:35], v2, s[16:19], s36 offen offset:1024 sc1
    s_add_u32 s36, s41, 65536
    v_cvt_pk_bf16_f32 v40, v40, v41
    v_cvt_pk_bf16_f32 v41, v42, v43
    v_cvt_pk_bf16_f32 v42, v44, v45
    v_cvt_pk_bf16_f32 v43, v46, v47
    v_or_b32 v40, 1, v40
    buffer_store_dwordx4 v[40:43], v2, s[16:19], s36 offen offset:0 sc1
    v_cvt_pk_bf16_f32 v48, v48, v49
    v_cvt_pk_bf16_f32 v49, v50, v51
    v_cvt_pk_bf16_f32 v50, v52, v53
    v_cvt_pk_bf16_f32 v51, v54, v55
    v_or_b32 v48, 1, v48
    buffer_store_dwordx4 v[48:51], v2, s[16:19], s36 offen offset:1024 sc1
    v_pk_mov_b32 v[24:25], v[56:57], v[56:57] op_sel:[0,1]
    v_pk_mov_b32 v[26:27], v[58:59], v[58:59] op_sel:[0,1]
    v_pk_mov_b32 v[28:29], v[60:61], v[60:61] op_sel:[0,1]
    v_pk_mov_b32 v[30:31], v[62:63], v[62:63] op_sel:[0,1]
    v_pk_mov_b32 v[32:33], v[64:65], v[64:65] op_sel:[0,1]
    v_pk_mov_b32 v[34:35], v[66:67], v[66:67] op_sel:[0,1]
    v_pk_mov_b32 v[36:37], v[68:69], v[68:69] op_sel:[0,1]
    v_pk_mov_b32 v[38:39], v[70:71], v[70:71] op_sel:[0,1]
    v_pk_mov_b32 v[40:41], v[72:73], v[72:73] op_sel:[0,1]
    v_pk_mov_b32 v[42:43], v[74:75], v[74:75] op_sel:[0,1]
    v_pk_mov_b32 v[44:45], v[76:77], v[76:77] op_sel:[0,1]
    v_pk_mov_b32 v[46:47], v[78:79], v[78:79] op_sel:[0,1]
    v_pk_mov_b32 v[48:49], v[80:81], v[80:81] op_sel:[0,1]
    v_pk_mov_b32 v[50:51], v[82:83], v[82:83] op_sel:[0,1]
    v_pk_mov_b32 v[52:53], v[84:85], v[84:85] op_sel:[0,1]
    v_pk_mov_b32 v[54:55], v[86:87], v[86:87] op_sel:[0,1]
    s_branch G4_k1
G4_k0:
    s_add_u32 s36, s41, 0
    v_cvt_pk_bf16_f32 v56, v56, v57
    v_cvt_pk_bf16_f32 v57, v58, v59
    v_cvt_pk_bf16_f32 v58, v60, v61
    v_cvt_pk_bf16_f32 v59, v62, v63
    v_or_b32 v56, 1, v56
    buffer_store_dwordx4 v[56:59], v2, s[16:19], s36 offen offset:0 sc1
    v_cvt_pk_bf16_f32 v64, v64, v65
    v_cvt_pk_bf16_f32 v65, v66, v67
    v_cvt_pk_bf16_f32 v66, v68, v69
    v_cvt_pk_bf16_f32 v67, v70, v71
    v_or_b32 v64, 1, v64
    buffer_store_dwordx4 v[64:67], v2, s[16:19], s36 offen offset:1024 sc1
    s_add_u32 s36, s41, 65536
    v_cvt_pk_bf16_f32 v72, v72, v73
    v_cvt_pk_bf16_f32 v73, v74, v75
    v_cvt_pk_bf16_f32 v74, v76, v77
    v_cvt_pk_bf16_f32 v75, v78, v79
    v_or_b32 v72, 1, v72
    buffer_store_dwordx4 v[72:75], v2, s[16:19], s36 offen offset:0 sc1
    v_cvt_pk_bf16_f32 v80, v80, v81
    v_cvt_pk_bf16_f32 v81, v82, v83
    v_cvt_pk_bf16_f32 v82, v84, v85
    v_cvt_pk_bf16_f32 v83, v86, v87
    v_or_b32 v80, 1, v80
    buffer_store_dwordx4 v[80:83], v2, s[16:19], s36 offen offset:1024 sc1
G4_k1:
    s_mov_b32 s78, 0x3f80
    s_mov_b32 s79, 0x3f800000
    v_dot2_f32_bf16 v24, v180, s78, v24
    v_dot2_f32_bf16 v25, v180, s79, v25
    v_dot2_f32_bf16 v26, v181, s78, v26
    v_dot2_f32_bf16 v27, v181, s79, v27
    v_dot2_f32_bf16 v28, v182, s78, v28
    v_dot2_f32_bf16 v29, v182, s79, v29
    v_dot2_f32_bf16 v30, v183, s78, v30
    v_dot2_f32_bf16 v31, v183, s79, v31
    v_dot2_f32_bf16 v32, v188, s78, v32
    v_dot2_f32_bf16 v33, v188, s79, v33
    v_dot2_f32_bf16 v34, v189, s78, v34
    v_dot2_f32_bf16 v35, v189, s79, v35
    v_dot2_f32_bf16 v36, v190, s78, v36
    v_dot2_f32_bf16 v37, v190, s79, v37
    v_dot2_f32_bf16 v38, v191, s78, v38
    v_dot2_f32_bf16 v39, v191, s79, v39
    v_dot2_f32_bf16 v40, v196, s78, v40
    v_dot2_f32_bf16 v41, v196, s79, v41
    v_dot2_f32_bf16 v42, v197, s78, v42
    v_dot2_f32_bf16 v43, v197, s79, v43
    v_dot2_f32_bf16 v44, v198, s78, v44
    v_dot2_f32_bf16 v45, v198, s79, v45
    v_dot2_f32_bf16 v46, v199, s78, v46
    v_dot2_f32_bf16 v47, v199, s79, v47
    v_dot2_f32_bf16 v48, v234, s78, v48
    v_dot2_f32_bf16 v49, v234, s79, v49
    v_dot2_f32_bf16 v50, v235, s78, v50
    v_dot2_f32_bf16 v51, v235, s79, v51
    v_dot2_f32_bf16 v52, v236, s78, v52
    v_dot2_f32_bf16 v53, v236, s79, v53
    v_dot2_f32_bf16 v54, v237, s78, v54
    v_dot2_f32_bf16 v55, v237, s79, v55
    v_dot2_f32_bf16 v24, v184, s78, v24
    v_dot2_f32_bf16 v25, v184, s79, v25
    v_dot2_f32_bf16 v26, v185, s78, v26
    v_dot2_f32_bf16 v27, v185, s79, v27
    v_dot2_f32_bf16 v28, v186, s78, v28
    v_dot2_f32_bf16 v29, v186, s79, v29
    v_dot2_f32_bf16 v30, v187, s78, v30
    v_dot2_f32_bf16 v31, v187, s79, v31
    v_dot2_f32_bf16 v32, v192, s78, v32
    v_dot2_f32_bf16 v33, v192, s79, v33
    v_dot2_f32_bf16 v34, v193, s78, v34
    v_dot2_f32_bf16 v35, v193, s79, v35
    v_dot2_f32_bf16 v36, v194, s78, v36
    v_dot2_f32_bf16 v37, v194, s79, v37
    v_dot2_f32_bf16 v38, v195, s78, v38
    v_dot2_f32_bf16 v39, v195, s79, v39
    v_dot2_f32_bf16 v40, v230, s78, v40
    v_dot2_f32_bf16 v41, v230, s79, v41
    v_dot2_f32_bf16 v42, v231, s78, v42
    v_dot2_f32_bf16 v43, v231, s79, v43
    v_dot2_f32_bf16 v44, v232, s78, v44
    v_dot2_f32_bf16 v45, v232, s79, v45
    v_dot2_f32_bf16 v46, v233, s78, v46
    v_dot2_f32_bf16 v47, v233, s79, v47
    v_dot2_f32_bf16 v48, v248, s78, v48
    v_dot2_f32_bf16 v49, v248, s79, v49
    v_dot2_f32_bf16 v50, v249, s78, v50
    v_dot2_f32_bf16 v51, v249, s79, v51
    v_dot2_f32_bf16 v52, v250, s78, v52
    v_dot2_f32_bf16 v53, v250, s79, v53
    v_dot2_f32_bf16 v54, v251, s78, v54
    v_dot2_f32_bf16 v55, v251, s79, v55
    s_mov_b32 s53, 0
dp_29:
    buffer_load_dwordx4 v[208:211], v2, s[16:19], s40 offen offset:0 sc1
    buffer_load_dwordx4 v[212:215], v2, s[16:19], s40 offen offset:1024 sc1
    buffer_load_dwordx4 v[216:219], v2, s[16:19], s44 offen offset:0 sc1
    buffer_load_dwordx4 v[220:223], v2, s[16:19], s44 offen offset:1024 sc1
    s_waitcnt vmcnt(0)
    v_bitop3_b32 v6, v208, v212, v216 bitop3:0x80
    v_bitop3_b32 v6, v6, v220, 1 bitop3:0x80
    v_cmp_eq_u32 vcc, 0, v6
    s_cbranch_vccz dq_30
    s_sleep 2
    s_add_u32 s53, s53, 1
    s_cmp_lt_u32 s53, s61
    s_cbranch_scc1 dp_29
    s_mov_b32 s61, 0
dq_30:
    v_dot2_f32_bf16 v24, v208, s78, v24
    v_dot2_f32_bf16 v25, v208, s79, v25
    v_dot2_f32_bf16 v26, v209, s78, v26
    v_dot2_f32_bf16 v27, v209, s79, v27
    v_dot2_f32_bf16 v28, v210, s78, v28
    v_dot2_f32_bf16 v29, v210, s79, v29
    v_dot2_f32_bf16 v30, v211, s78, v30
    v_dot2_f32_bf16 v31, v211, s79, v31
    v_cvt_pk_bf16_f32 v24, v24, v25
    v_cvt_pk_bf16_f32 v25, v26, v27
    v_cvt_pk_bf16_f32 v26, v28, v29
    v_cvt_pk_bf16_f32 v27, v30, v31
    s_nop 0
    v_permlane16_swap_b32 v24, v26
    v_permlane16_swap_b32 v25, v27
    v_dot2_f32_bf16 v32, v212, s78, v32
    v_dot2_f32_bf16 v33, v212, s79, v33
    v_dot2_f32_bf16 v34, v213, s78, v34
    v_dot2_f32_bf16 v35, v213, s79, v35
    v_dot2_f32_bf16 v36, v214, s78, v36
    v_dot2_f32_bf16 v37, v214, s79, v37
    v_dot2_f32_bf16 v38, v215, s78, v38
    v_dot2_f32_bf16 v39, v215, s79, v39
    v_cvt_pk_bf16_f32 v32, v32, v33
    v_cvt_pk_bf16_f32 v33, v34, v35
    v_cvt_pk_bf16_f32 v34, v36, v37
    v_cvt_pk_bf16_f32 v35, v38, v39
    s_nop 0
    v_permlane16_swap_b32 v32, v34
    v_permlane16_swap_b32 v33, v35
    v_mov_b32 v36, v24
    v_mov_b32 v37, v25
    v_mov_b32 v38, v26
    v_mov_b32 v39, v27
    v_mov_b32_dpp v24, v32 row_ror:8 row_mask:0xf bank_mask:0xc
    v_mov_b32_dpp v25, v33 row_ror:8 row_mask:0xf bank_mask:0xc
    v_mov_b32_dpp v26, v34 row_ror:8 row_mask:0xf bank_mask:0xc
    v_mov_b32_dpp v27, v35 row_ror:8 row_mask:0xf bank_mask:0xc
    v_mov_b32_dpp v32, v36 row_ror:8 row_mask:0xf bank_mask:0x3
    v_mov_b32_dpp v33, v37 row_ror:8 row_mask:0xf bank_mask:0x3
    v_mov_b32_dpp v34, v38 row_ror:8 row_mask:0xf bank_mask:0x3
    v_mov_b32_dpp v35, v39 row_ror:8 row_mask:0xf bank_mask:0x3
    buffer_store_dwordx4 v[24:27], v224, s[20:23], s46 offen sc1
    buffer_store_dwordx4 v[32:35], v225, s[20:23], s46 offen sc1
    v_dot2_f32_bf16 v40, v216, s78, v40
    v_dot2_f32_bf16 v41, v216, s79, v41
    v_dot2_f32_bf16 v42, v217, s78, v42
    v_dot2_f32_bf16 v43, v217, s79, v43
    v_dot2_f32_bf16 v44, v218, s78, v44
    v_dot2_f32_bf16 v45, v218, s79, v45
    v_dot2_f32_bf16 v46, v219, s78, v46
    v_dot2_f32_bf16 v47, v219, s79, v47
    v_cvt_pk_bf16_f32 v40, v40, v41
    v_cvt_pk_bf16_f32 v41, v42, v43
    v_cvt_pk_bf16_f32 v42, v44, v45
    v_cvt_pk_bf16_f32 v43, v46, v47
    s_nop 0
    v_permlane16_swap_b32 v40, v42
    v_permlane16_swap_b32 v41, v43
    v_dot2_f32_bf16 v48, v220, s78, v48
    v_dot2_f32_bf16 v49, v220, s79, v49
    v_dot2_f32_bf16 v50, v221, s78, v50
    v_dot2_f32_bf16 v51, v221, s79, v51
    v_dot2_f32_bf16 v52, v222, s78, v52
    v_dot2_f32_bf16 v53, v222, s79, v53
    v_dot2_f32_bf16 v54, v223, s78, v54
    v_dot2_f32_bf16 v55, v223, s79, v55
    v_cvt_pk_bf16_f32 v48, v48, v49
    v_cvt_pk_bf16_f32 v49, v50, v51
    v_cvt_pk_bf16_f32 v50, v52, v53
    v_cvt_pk_bf16_f32 v51, v54, v55
    s_nop 0
    v_permlane16_swap_b32 v48, v50
    v_permlane16_swap_b32 v49, v51
    v_mov_b32 v52, v40
    v_mov_b32 v53, v41
    v_mov_b32 v54, v42
    v_mov_b32 v55, v43
    v_mov_b32_dpp v40, v48 row_ror:8 row_mask:0xf bank_mask:0xc
    v_mov_b32_dpp v41, v49 row_ror:8 row_mask:0xf bank_mask:0xc
    v_mov_b32_dpp v42, v50 row_ror:8 row_mask:0xf bank_mask:0xc
    v_mov_b32_dpp v43, v51 row_ror:8 row_mask:0xf bank_mask:0xc
    v_mov_b32_dpp v48, v52 row_ror:8 row_mask:0xf bank_mask:0x3
    v_mov_b32_dpp v49, v53 row_ror:8 row_mask:0xf bank_mask:0x3
    v_mov_b32_dpp v50, v54 row_ror:8 row_mask:0xf bank_mask:0x3
    v_mov_b32_dpp v51, v55 row_ror:8 row_mask:0xf bank_mask:0x3
    buffer_store_dwordx4 v[40:43], v224, s[20:23], s47 offen sc1
    buffer_store_dwordx4 v[48:51], v225, s[20:23], s47 offen sc1
    s_branch K_fin
LOADERS:
    s_cmp_lg_u32 s60, 0
    s_cbranch_scc1 pr_31
    s_and_b32 s36, s29, 6
    s_cmp_eq_u32 s36, 2
    s_cbranch_scc0 pr_31
    s_call_b64 s[76:77], SUB_park2
pr_31:
    s_cmp_ge_u32 s30, 6
    s_cbranch_scc1 WLOAD
    s_add_u32 s54, s55, 0x500
    v_mov_b32 v222, s54
    s_lshl_b32 s53, s29, 7
    s_add_u32 s53, s53, 23121920
    v_mov_b32 v226, s53
    s_sleep 30
    s_mov_b64 exec, 1
    buffer_load_dword v227, v226, s[56:59], 0 offen sc1
    s_mov_b64 exec, -1
    s_waitcnt vmcnt(0)
    v_readfirstlane_b32 s53, v227
    s_add_u32 s54, s52, 16
    s_cmp_eq_u32 s53, s54
    s_cbranch_scc1 fok_32
    s_mov_b32 s53, 0
    s_add_u32 s54, s52, 16
    s_bfm_b64 exec, 1, 0
poll_33:
    buffer_load_dword v227, v226, s[56:59], 0 offen sc1
    s_waitcnt vmcnt(0)
    v_xor_b32 v227, s54, v227
    v_cmp_eq_u32 vcc, 0, v227
    s_nop 0
    s_cmp_eq_u64 vcc, exec
    s_cbranch_scc1 pok_34
    s_sleep 5
    s_add_u32 s53, s53, 1
    s_cmp_lt_u32 s53, s61
    s_cbranch_scc1 poll_33
    s_mov_b32 s61, 0
pok_34:
    s_mov_b64 exec, -1
fok_32:
    s_add_u32 s24, s4, 0x1400000
    s_addc_u32 s25, s5, 0
    s_mov_b32 s26, 0x20000
    s_mov_b32 s27, 0x20000
    s_cmp_eq_u32 s60, 0
    s_cselect_b32 s26, s26, 0
    s_and_b32 s36, s30, 1
    s_mul_i32 s36, s36, 128
    s_mul_i32 s37, s29, 256
    s_add_u32 s37, s36, s37
    v_lshrrev_b32 v224, 3, v1
    v_mul_u32_u24 v224, 4096, v224
    v_and_b32 v23, 112, v2
    v_add_u32 v224, v224, v23
    s_cmp_eq_u32 s60, 0
    s_cselect_b64 exec, -1, 0
    buffer_load_dwordx4 v[24:27], v224, s[24:27], s37 offen sc1
    s_add_u32 s37, s37, 32768
    buffer_load_dwordx4 v[28:31], v224, s[24:27], s37 offen sc1
    s_add_u32 s37, s37, 32768
    buffer_load_dwordx4 v[32:35], v224, s[24:27], s37 offen sc1
    s_add_u32 s37, s37, 32768
    buffer_load_dwordx4 v[36:39], v224, s[24:27], s37 offen sc1
    s_add_u32 s37, s37, 32768
    s_mov_b64 exec, -1
    s_mov_b64 exec, 1
    buffer_load_dword v223, v222, s[56:59], 0 offen sc1
    s_mov_b64 exec, -1
    s_waitcnt vmcnt(0)
    v_readfirstlane_b32 s53, v223
    s_add_u32 s54, s52, 16
    s_cmp_eq_u32 s53, s54
    s_cbranch_scc1 fok_35
    s_mov_b32 s53, 0
    s_add_u32 s54, s52, 16
    s_bfm_b64 exec, 1, 0
poll_36:
    buffer_load_dword v223, v222, s[56:59], 0 offen sc1
    s_waitcnt vmcnt(0)
    v_xor_b32 v223, s54, v223
    v_cmp_eq_u32 vcc, 0, v223
    s_nop 0
    s_cmp_eq_u64 vcc, exec
    s_cbranch_scc1 pok_37
    s_sleep 5
    s_add_u32 s53, s53, 1
    s_cmp_lt_u32 s53, s61
    s_cbranch_scc1 poll_36
    s_mov_b32 s61, 0
pok_37:
    s_mov_b64 exec, -1
fok_35:
    s_add_u32 s20, s62, 0x5d0000
    s_addc_u32 s21, s63, 0
    s_mov_b32 s22, 0x800
    s_mov_b32 s23, 0x20000
    s_and_b32 s35, s30, 1
    s_lshl_b32 s35, s35, 10
    buffer_load_dwordx4 v[16:19], v2, s[20:23], s35 offen sc1
    s_cmp_lg_u32 s60, 0
    s_cbranch_scc1 pc_38
    v_add_f32 v24, v24, v28
    v_add_f32 v25, v25, v29
    v_add_f32 v26, v26, v30
    v_add_f32 v27, v27, v31
    v_add_f32 v24, v24, v32
    v_add_f32 v25, v25, v33
    v_add_f32 v26, v26, v34
    v_add_f32 v27, v27, v35
    v_add_f32 v24, v24, v36
    v_add_f32 v25, v25, v37
    v_add_f32 v26, v26, v38
    v_add_f32 v27, v27, v39
    v_add_f32_dpp v24, v24, v24 row_ror:8 row_mask:0xf bank_mask:0xf
    v_add_f32_dpp v25, v25, v25 row_ror:8 row_mask:0xf bank_mask:0xf
    v_add_f32_dpp v26, v26, v26 row_ror:8 row_mask:0xf bank_mask:0xf
    v_add_f32_dpp v27, v27, v27 row_ror:8 row_mask:0xf bank_mask:0xf
    v_mov_b32 v28, v24
    v_mov_b32 v29, v25
    v_mov_b32 v30, v26
    v_mov_b32 v31, v27
    v_permlane16_swap_b32 v24, v28
    v_permlane16_swap_b32 v25, v29
    v_permlane16_swap_b32 v26, v30
    v_permlane16_swap_b32 v27, v31
    v_add_f32 v24, v24, v28
    v_add_f32 v25, v25, v29
    v_add_f32 v26, v26, v30
    v_add_f32 v27, v27, v31
    v_mov_b32 v28, v24
    v_mov_b32 v29, v25
    v_mov_b32 v30, v26
    v_mov_b32 v31, v27
    v_permlane32_swap_b32 v24, v28
    v_permlane32_swap_b32 v25, v29
    v_permlane32_swap_b32 v26, v30
    v_permlane32_swap_b32 v27, v31
    v_add_f32 v24, v24, v28
    v_add_f32 v25, v25, v29
    v_add_f32 v26, v26, v30
    v_add_f32 v27, v27, v31
pc_38:
    s_cmp_lg_u32 s60, 0
    s_cbranch_scc1 pc_39
    s_and_b32 s36, s30, 1
    s_mul_i32 s36, s36, 128
    s_add_u32 s36, s36, 163328
    v_add_u32 v23, s36, v2
    s_bfm_b64 exec, 8, 0
    ds_write_b128 v23, v[24:27]
    s_mov_b64 exec, -1
    s_waitcnt lgkmcnt(0)
pc_39:
    s_waitcnt vmcnt(0)
    s_and_b32 s36, s30, 1
    s_lshl_b32 s36, s36, 10
    s_add_u32 s36, s36, 160768
    v_add_u32 v221, s36, v2
    ds_write_b128 v221, v[16:19]
    s_waitcnt lgkmcnt(0)
    s_cmp_lg_u32 s30, 4
    s_cbranch_scc1 AL_nw
    s_cmp_eq_u32 s60, 0
    s_cbranch_scc1 AL_nw
    s_add_u32 s54, s55, 0xffc00300
    s_add_u32 s53, s54, s92
    v_mov_b32 v9, s53
    s_add_u32 s53, s53, 128
    v_writelane_b32 v9, s53, 1
    s_add_u32 s53, s54, s93
    v_writelane_b32 v9, s53, 2
    s_add_u32 s53, s53, 128
    v_writelane_b32 v9, s53, 3
    s_mov_b32 s53, 0
    s_add_u32 s54, s52, 8
    s_bfm_b64 exec, 4, 0
poll_41:
    buffer_load_dword v8, v9, s[56:59], 0 offen sc1
    s_waitcnt vmcnt(0)
    v_xor_b32 v8, s54, v8
    v_cmp_eq_u32 vcc, 0, v8
    s_nop 0
    s_cmp_eq_u64 vcc, exec
    s_cbranch_scc1 pok_42
    s_sleep 5
    s_add_u32 s53, s53, 1
    s_cmp_lt_u32 s53, s61
    s_cbranch_scc1 poll_41
    s_mov_b32 s61, 0
pok_42:
    s_mov_b64 exec, -1
AL_nw:
    s_and_b32 s36, s30, 1
    s_lshl_b32 s36, s36, 12
    s_add_u32 s36, s36, 32768
    v_add_u32 v6, s36, v2
    ds_read_b128 v[16:19], v6 offset:0
    ds_read_b128 v[20:23], v6 offset:1024
    ds_read_b128 v[24:27], v6 offset:2048
    ds_read_b128 v[28:31], v6 offset:3072
    ds_read_b128 v[32:35], v6 offset:8192
    ds_read_b128 v[36:39], v6 offset:9216
    ds_read_b128 v[40:43], v6 offset:10240
    ds_read_b128 v[44:47], v6 offset:11264
    s_waitcnt lgkmcnt(0)
    s_barrier
    s_call_b64 s[76:77], SUB_after_g1
    s_barrier
    s_waitcnt vmcnt(0)
    s_barrier
    s_call_b64 s[76:77], SUB_after_g2
    s_and_b32 s35, s30, 1
    s_add_u32 s12, s62, 0x80000
    s_addc_u32 s13, s63, 0
    s_mov_b32 s14, 0x7e000
    s_mov_b32 s15, 0x20000
    s_mul_i32 s38, s35, 262144
    s_lshl_b32 s41, s35, 13
    s_mov_b32 s42, 0
    s_mov_b32 s44, 0
    s_add_u32 s54, s55, 0x200
    v_mov_b32 v9, s54
    s_mov_b32 s44, 1
    s_mov_b32 s42, 16384
    s_add_u32 s54, s55, 0x580
    v_mov_b32 v222, s54
    v_lshlrev_b32 v221, 3, v1
    s_add_u32 s19, s41, s42
    v_readlane_b32 s16, v248, s44
    s_nop 0
    s_add_u32 s16, s16, s38
    s_add_u32 s44, s44, 1
    s_and_b32 s44, s44, 15
    s_add_u32 s42, s42, 16384
    s_cmp_eq_u32 s42, 49152
    s_cselect_b32 s42, 0, s42
    s_mov_b32 m0, s19
    s_mov_b32 s39, s16
    s_waitcnt vmcnt(63)
    s_barrier
    s_sleep 6
    s_mov_b32 s53, 0
    s_add_u32 s54, s52, 16
    s_bfm_b64 exec, 1, 0
poll_43:
    buffer_load_dword v8, v9, s[56:59], 0 offen sc1
    s_waitcnt vmcnt(0)
    v_xor_b32 v8, s54, v8
    v_cmp_eq_u32 vcc, 0, v8
    s_nop 0
    s_cmp_eq_u64 vcc, exec
    s_cbranch_scc1 pok_44
    s_sleep 5
    s_add_u32 s53, s53, 1
    s_cmp_lt_u32 s53, s61
    s_cbranch_scc1 poll_43
    s_mov_b32 s61, 0
pok_44:
    s_mov_b64 exec, -1
    buffer_load_dwordx4 v2, s[12:15], s39 offen sc1 lds
    buffer_load_dwordx4 v2, s[12:15], s39 offen offset:1024 sc1 lds
    s_add_u32 m0, m0, 2048
    s_add_u32 s39, s39, 65536
    buffer_load_dwordx4 v2, s[12:15], s39 offen sc1 lds
    buffer_load_dwordx4 v2, s[12:15], s39 offen offset:1024 sc1 lds
    s_add_u32 s19, s41, s42
    v_readlane_b32 s16, v248, s44
    s_nop 0
    s_add_u32 s16, s16, s38
    s_add_u32 s44, s44, 1
    s_and_b32 s44, s44, 15
    s_add_u32 s42, s42, 16384
    s_cmp_eq_u32 s42, 49152
    s_cselect_b32 s42, 0, s42
    s_add_u32 m0, m0, 2048
    s_add_u32 s39, s39, 65536
    buffer_load_dwordx4 v2, s[12:15], s39 offen sc1 lds
    buffer_load_dwordx4 v2, s[12:15], s39 offen offset:1024 sc1 lds
    s_add_u32 m0, m0, 2048
    s_add_u32 s39, s39, 65536
    buffer_load_dwordx4 v2, s[12:15], s39 offen sc1 lds
    buffer_load_dwordx4 v2, s[12:15], s39 offen offset:1024 sc1 lds
    s_mov_b32 m0, s19
    s_mov_b32 s39, s16
    buffer_load_dwordx4 v2, s[12:15], s39 offen sc1 lds
    buffer_load_dwordx4 v2, s[12:15], s39 offen offset:1024 sc1 lds
    s_add_u32 m0, m0, 2048
    s_add_u32 s39, s39, 65536
    buffer_load_dwordx4 v2, s[12:15], s39 offen sc1 lds
    buffer_load_dwordx4 v2, s[12:15], s39 offen offset:1024 sc1 lds
    s_add_u32 s19, s41, s42
    v_readlane_b32 s16, v248, s44
    s_nop 0
    s_add_u32 s16, s16, s38
    s_add_u32 s44, s44, 1
    s_and_b32 s44, s44, 15
    s_add_u32 s42, s42, 16384
    s_cmp_eq_u32 s42, 49152
    s_cselect_b32 s42, 0, s42
    s_add_u32 m0, m0, 2048
    s_add_u32 s39, s39, 65536
    buffer_load_dwordx4 v2, s[12:15], s39 offen sc1 lds
    buffer_load_dwordx4 v2, s[12:15], s39 offen offset:1024 sc1 lds
    s_add_u32 m0, m0, 2048
    s_add_u32 s39, s39, 65536
    buffer_load_dwordx4 v2, s[12:15], s39 offen sc1 lds
    buffer_load_dwordx4 v2, s[12:15], s39 offen offset:1024 sc1 lds
    s_mov_b32 m0, s19
    s_mov_b32 s39, s16
    s_waitcnt vmcnt(8)
    s_barrier
    buffer_load_dwordx4 v2, s[12:15], s39 offen sc1 lds
    buffer_load_dwordx4 v2, s[12:15], s39 offen offset:1024 sc1 lds
    s_add_u32 m0, m0, 2048
    s_add_u32 s39, s39, 65536
    buffer_load_dwordx4 v2, s[12:15], s39 offen sc1 lds
    buffer_load_dwordx4 v2, s[12:15], s39 offen offset:1024 sc1 lds
    s_add_u32 s19, s41, s42
    v_readlane_b32 s16, v248, s44
    s_nop 0
    s_add_u32 s16, s16, s38
    s_add_u32 s44, s44, 1
    s_and_b32 s44, s44, 15
    s_add_u32 s42, s42, 16384
    s_cmp_eq_u32 s42, 49152
    s_cselect_b32 s42, 0, s42
    s_add_u32 m0, m0, 2048
    s_add_u32 s39, s39, 65536
    buffer_load_dwordx4 v2, s[12:15], s39 offen sc1 lds
    buffer_load_dwordx4 v2, s[12:15], s39 offen offset:1024 sc1 lds
    s_add_u32 m0, m0, 2048
    s_add_u32 s39, s39, 65536
    buffer_load_dwordx4 v2, s[12:15], s39 offen sc1 lds
    buffer_load_dwordx4 v2, s[12:15], s39 offen offset:1024 sc1 lds
    s_mov_b32 m0, s19
    s_mov_b32 s39, s16
    s_add_u32 s24, s4, 0x1420000
    s_addc_u32 s25, s5, 0
    s_mov_b32 s26, 0x70000
    s_mov_b32 s27, 0x20000
    s_cmp_eq_u32 s60, 0
    s_cselect_b32 s26, s26, 0
    s_and_b32 s36, s30, 1
    s_mul_i32 s36, s36, 448
    s_mul_i32 s37, s29, 896
    s_add_u32 s37, s36, s37
    v_lshrrev_b32 v224, 5, v1
    v_mul_u32_u24 v224, 14336, v224
    v_and_b32 v179, 496, v2
    v_add_u32 v224, v224, v179
    s_cmp_eq_u32 s60, 0
    s_cselect_b64 exec, -1, 0
    buffer_load_dwordx4 v[180:183], v224, s[24:27], s37 offen sc1
    s_add_u32 s37, s37, 28672
    buffer_load_dwordx4 v[184:187], v224, s[24:27], s37 offen sc1
    s_add_u32 s37, s37, 28672
    buffer_load_dwordx4 v[188:191], v224, s[24:27], s37 offen sc1
    s_add_u32 s37, s37, 28672
    buffer_load_dwordx4 v[192:195], v224, s[24:27], s37 offen sc1
    s_add_u32 s37, s37, 28672
    buffer_load_dwordx4 v[196:199], v224, s[24:27], s37 offen sc1
    s_add_u32 s37, s37, 28672
    s_mov_b64 exec, -1
    s_waitcnt vmcnt(13)
    s_barrier
    buffer_load_dwordx4 v2, s[12:15], s39 offen sc1 lds
    buffer_load_dwordx4 v2, s[12:15], s39 offen offset:1024 sc1 lds
    s_add_u32 m0, m0, 2048
    s_add_u32 s39, s39, 65536
    buffer_load_dwordx4 v2, s[12:15], s39 offen sc1 lds
    buffer_load_dwordx4 v2, s[12:15], s39 offen offset:1024 sc1 lds
    s_add_u32 s19, s41, s42
    v_readlane_b32 s16, v248, s44
    s_nop 0
    s_add_u32 s16, s16, s38
    s_add_u32 s44, s44, 1
    s_and_b32 s44, s44, 15
    s_add_u32 s42, s42, 16384
    s_cmp_eq_u32 s42, 49152
    s_cselect_b32 s42, 0, s42
    s_add_u32 m0, m0, 2048
    s_add_u32 s39, s39, 65536
    buffer_load_dwordx4 v2, s[12:15], s39 offen sc1 lds
    buffer_load_dwordx4 v2, s[12:15], s39 offen offset:1024 sc1 lds
    s_add_u32 m0, m0, 2048
    s_add_u32 s39, s39, 65536
    buffer_load_dwordx4 v2, s[12:15], s39 offen sc1 lds
    buffer_load_dwordx4 v2, s[12:15], s39 offen offset:1024 sc1 lds
    s_mov_b32 m0, s19
    s_mov_b32 s39, s16
    s_cmp_eq_u32 s60, 0
    s_cselect_b64 exec, -1, 0
    buffer_load_dwordx4 v[200:203], v224, s[24:27], s37 offen sc1
    s_add_u32 s37, s37, 28672
    buffer_load_dwordx4 v[204:207], v224, s[24:27], s37 offen sc1
    s_add_u32 s37, s37, 28672
    buffer_load_dwordx4 v[208:211], v224, s[24:27], s37 offen sc1
    s_add_u32 s37, s37, 28672
    buffer_load_dwordx4 v[212:215], v224, s[24:27], s37 offen sc1
    s_add_u32 s37, s37, 28672
    s_mov_b64 exec, -1
    s_waitcnt vmcnt(17)
    s_barrier
    buffer_load_dwordx4 v2, s[12:15], s39 offen sc1 lds
    buffer_load_dwordx4 v2, s[12:15], s39 offen offset:1024 sc1 lds
    s_add_u32 m0, m0, 2048
    s_add_u32 s39, s39, 65536
    buffer_load_dwordx4 v2, s[12:15], s39 offen sc1 lds
    buffer_load_dwordx4 v2, s[12:15], s39 offen offset:1024 sc1 lds
    s_add_u32 s19, s41, s42
    v_readlane_b32 s16, v248, s44
    s_nop 0
    s_add_u32 s16, s16, s38
    s_add_u32 s44, s44, 1
    s_and_b32 s44, s44, 15
    s_add_u32 s42, s42, 16384
    s_cmp_eq_u32 s42, 49152
    s_cselect_b32 s42, 0, s42
    s_add_u32 m0, m0, 2048
    s_add_u32 s39, s39, 65536
    buffer_load_dwordx4 v2, s[12:15], s39 offen sc1 lds
    buffer_load_dwordx4 v2, s[12:15], s39 offen offset:1024 sc1 lds
    s_add_u32 m0, m0, 2048
    s_add_u32 s39, s39, 65536
    buffer_load_dwordx4 v2, s[12:15], s39 offen sc1 lds
    buffer_load_dwordx4 v2, s[12:15], s39 offen offset:1024 sc1 lds
    s_mov_b32 m0, s19
    s_mov_b32 s39, s16
    s_waitcnt vmcnt(12)
    s_barrier
    buffer_load_dwordx4 v2, s[12:15], s39 offen sc1 lds
    buffer_load_dwordx4 v2, s[12:15], s39 offen offset:1024 sc1 lds
    s_add_u32 m0, m0, 2048
    s_add_u32 s39, s39, 65536
    buffer_load_dwordx4 v2, s[12:15], s39 offen sc1 lds
    buffer_load_dwordx4 v2, s[12:15], s39 offen offset:1024 sc1 lds
    s_add_u32 s19, s41, s42
    v_readlane_b32 s16, v248, s44
    s_nop 0
    s_add_u32 s16, s16, s38
    s_add_u32 s44, s44, 1
    s_and_b32 s44, s44, 15
    s_add_u32 s42, s42, 16384
    s_cmp_eq_u32 s42, 49152
    s_cselect_b32 s42, 0, s42
    s_add_u32 m0, m0, 2048
    s_add_u32 s39, s39, 65536
    buffer_load_dwordx4 v2, s[12:15], s39 offen sc1 lds
    buffer_load_dwordx4 v2, s[12:15], s39 offen offset:1024 sc1 lds
    s_add_u32 m0, m0, 2048
    s_add_u32 s39, s39, 65536
    buffer_load_dwordx4 v2, s[12:15], s39 offen sc1 lds
    buffer_load_dwordx4 v2, s[12:15], s39 offen offset:1024 sc1 lds
    s_mov_b32 m0, s19
    s_mov_b32 s39, s16
    s_waitcnt vmcnt(16)
    s_cmp_lg_u32 s60, 0
    s_cbranch_scc1 pc_45
    v_add_f32 v180, v180, v184
    v_add_f32 v181, v181, v185
    v_add_f32 v182, v182, v186
    v_add_f32 v183, v183, v187
    v_add_f32 v180, v180, v188
    v_add_f32 v181, v181, v189
    v_add_f32 v182, v182, v190
    v_add_f32 v183, v183, v191
    v_add_f32 v180, v180, v192
    v_add_f32 v181, v181, v193
    v_add_f32 v182, v182, v194
    v_add_f32 v183, v183, v195
    v_add_f32 v180, v180, v196
    v_add_f32 v181, v181, v197
    v_add_f32 v182, v182, v198
    v_add_f32 v183, v183, v199
    v_add_f32 v180, v180, v200
    v_add_f32 v181, v181, v201
    v_add_f32 v182, v182, v202
    v_add_f32 v183, v183, v203
    v_add_f32 v180, v180, v204
    v_add_f32 v181, v181, v205
    v_add_f32 v182, v182, v206
    v_add_f32 v183, v183, v207
    v_add_f32 v180, v180, v208
    v_add_f32 v181, v181, v209
    v_add_f32 v182, v182, v210
    v_add_f32 v183, v183, v211
    v_add_f32 v180, v180, v212
    v_add_f32 v181, v181, v213
    v_add_f32 v182, v182, v214
    v_add_f32 v183, v183, v215
pc_45:
    s_cmp_eq_u32 s60, 0
    s_cselect_b64 exec, -1, 0
    buffer_load_dwordx4 v[184:187], v224, s[24:27], s37 offen sc1
    s_add_u32 s37, s37, 28672
    buffer_load_dwordx4 v[188:191], v224, s[24:27], s37 offen sc1
    s_add_u32 s37, s37, 28672
    buffer_load_dwordx4 v[192:195], v224, s[24:27], s37 offen sc1
    s_add_u32 s37, s37, 28672
    buffer_load_dwordx4 v[196:199], v224, s[24:27], s37 offen sc1
    s_add_u32 s37, s37, 28672
    buffer_load_dwordx4 v[200:203], v224, s[24:27], s37 offen sc1
    s_add_u32 s37, s37, 28672
    buffer_load_dwordx4 v[204:207], v224, s[24:27], s37 offen sc1
    s_add_u32 s37, s37, 28672
    buffer_load_dwordx4 v[208:211], v224, s[24:27], s37 offen sc1
    s_add_u32 s37, s37, 28672
    s_mov_b64 exec, -1
    s_waitcnt vmcnt(15)
    s_barrier
    buffer_load_dwordx4 v2, s[12:15], s39 offen sc1 lds
    buffer_load_dwordx4 v2, s[12:15], s39 offen offset:1024 sc1 lds
    s_add_u32 m0, m0, 2048
    s_add_u32 s39, s39, 65536
    buffer_load_dwordx4 v2, s[12:15], s39 offen sc1 lds
    buffer_load_dwordx4 v2, s[12:15], s39 offen offset:1024 sc1 lds
    s_add_u32 s19, s41, s42
    v_readlane_b32 s16, v248, s44
    s_nop 0
    s_add_u32 s16, s16, s38
    s_add_u32 s44, s44, 1
    s_and_b32 s44, s44, 15
    s_add_u32 s42, s42, 16384
    s_cmp_eq_u32 s42, 49152
    s_cselect_b32 s42, 0, s42
    s_add_u32 m0, m0, 2048
    s_add_u32 s39, s39, 65536
    buffer_load_dwordx4 v2, s[12:15], s39 offen sc1 lds
    buffer_load_dwordx4 v2, s[12:15], s39 offen offset:1024 sc1 lds
    s_add_u32 m0, m0, 2048
    s_add_u32 s39, s39, 65536
    buffer_load_dwordx4 v2, s[12:15], s39 offen sc1 lds
    buffer_load_dwordx4 v2, s[12:15], s39 offen offset:1024 sc1 lds
    s_mov_b32 m0, s19
    s_mov_b32 s39, s16
    s_mov_b64 exec, 1
    buffer_load_dword v223, v222, s[56:59], 0 offen sc1
    s_mov_b64 exec, -1
    s_waitcnt vmcnt(16)
    s_barrier
    buffer_load_dwordx4 v2, s[12:15], s39 offen sc1 lds
    buffer_load_dwordx4 v2, s[12:15], s39 offen offset:1024 sc1 lds
    s_add_u32 m0, m0, 2048
    s_add_u32 s39, s39, 65536
    buffer_load_dwordx4 v2, s[12:15], s39 offen sc1 lds
    buffer_load_dwordx4 v2, s[12:15], s39 offen offset:1024 sc1 lds
    s_add_u32 s19, s41, s42
    v_readlane_b32 s16, v248, s44
    s_nop 0
    s_add_u32 s16, s16, s38
    s_add_u32 s44, s44, 1
    s_and_b32 s44, s44, 15
    s_add_u32 s42, s42, 16384
    s_cmp_eq_u32 s42, 49152
    s_cselect_b32 s42, 0, s42
    s_add_u32 m0, m0, 2048
    s_add_u32 s39, s39, 65536
    buffer_load_dwordx4 v2, s[12:15], s39 offen sc1 lds
    buffer_load_dwordx4 v2, s[12:15], s39 offen offset:1024 sc1 lds
    s_add_u32 m0, m0, 2048
    s_add_u32 s39, s39, 65536
    buffer_load_dwordx4 v2, s[12:15], s39 offen sc1 lds
    buffer_load_dwordx4 v2, s[12:15], s39 offen offset:1024 sc1 lds
    s_mov_b32 m0, s19
    s_mov_b32 s39, s16
    s_waitcnt vmcnt(17)
    s_cmp_lg_u32 s60, 0
    s_cbranch_scc1 pc_46
    v_add_f32 v180, v180, v184
    v_add_f32 v181, v181, v185
    v_add_f32 v182, v182, v186
    v_add_f32 v183, v183, v187
    v_add_f32 v180, v180, v188
    v_add_f32 v181, v181, v189
    v_add_f32 v182, v182, v190
    v_add_f32 v183, v183, v191
    v_add_f32 v180, v180, v192
    v_add_f32 v181, v181, v193
    v_add_f32 v182, v182, v194
    v_add_f32 v183, v183, v195
    v_add_f32 v180, v180, v196
    v_add_f32 v181, v181, v197
    v_add_f32 v182, v182, v198
    v_add_f32 v183, v183, v199
    v_add_f32 v180, v180, v200
    v_add_f32 v181, v181, v201
    v_add_f32 v182, v182, v202
    v_add_f32 v183, v183, v203
    v_add_f32 v180, v180, v204
    v_add_f32 v181, v181, v205
    v_add_f32 v182, v182, v206
    v_add_f32 v183, v183, v207
    v_add_f32 v180, v180, v208
    v_add_f32 v181, v181, v209
    v_add_f32 v182, v182, v210
    v_add_f32 v183, v183, v211
pc_46:
    s_waitcnt vmcnt(9)
    s_barrier
    buffer_load_dwordx4 v2, s[12:15], s39 offen sc1 lds
    buffer_load_dwordx4 v2, s[12:15], s39 offen offset:1024 sc1 lds
    s_add_u32 m0, m0, 2048
    s_add_u32 s39, s39, 65536
    buffer_load_dwordx4 v2, s[12:15], s39 offen sc1 lds
    buffer_load_dwordx4 v2, s[12:15], s39 offen offset:1024 sc1 lds
    s_add_u32 s19, s41, s42
    v_readlane_b32 s16, v248, s44
    s_nop 0
    s_add_u32 s16, s16, s38
    s_add_u32 s44, s44, 1
    s_and_b32 s44, s44, 15
    s_add_u32 s42, s42, 16384
    s_cmp_eq_u32 s42, 49152
    s_cselect_b32 s42, 0, s42
    s_add_u32 m0, m0, 2048
    s_add_u32 s39, s39, 65536
    buffer_load_dwordx4 v2, s[12:15], s39 offen sc1 lds
    buffer_load_dwordx4 v2, s[12:15], s39 offen offset:1024 sc1 lds
    s_add_u32 m0, m0, 2048
    s_add_u32 s39, s39, 65536
    buffer_load_dwordx4 v2, s[12:15], s39 offen sc1 lds
    buffer_load_dwordx4 v2, s[12:15], s39 offen offset:1024 sc1 lds
    s_mov_b32 m0, s19
    s_mov_b32 s39, s16
    s_cmp_lg_u32 s60, 0
    s_cbranch_scc1 pc_47
    v_mov_b32 v184, v180
    v_mov_b32 v185, v181
    v_mov_b32 v186, v182
    v_mov_b32 v187, v183
    v_permlane32_swap_b32 v180, v184
    v_permlane32_swap_b32 v181, v185
    v_permlane32_swap_b32 v182, v186
    v_permlane32_swap_b32 v183, v187
    v_add_f32 v180, v180, v184
    v_add_f32 v181, v181, v185
    v_add_f32 v182, v182, v186
    v_add_f32 v183, v183, v187
    s_and_b32 s36, s30, 1
    s_mul_i32 s36, s36, 448
    s_add_u32 s36, s36, 159744
    v_add_u32 v179, s36, v2
    s_bfm_b64 exec, 28, 0
    ds_write_b128 v179, v[180:183]
    s_mov_b64 exec, -1
    s_waitcnt lgkmcnt(0)
pc_47:
    s_waitcnt vmcnt(16)
    v_readfirstlane_b32 s53, v223
    s_add_u32 s54, s52, 16
    s_cmp_eq_u32 s53, s54
    s_cbranch_scc1 fok_48
    s_mov_b32 s53, 0
    s_add_u32 s54, s52, 16
    s_bfm_b64 exec, 1, 0
poll_49:
    buffer_load_dword v223, v222, s[56:59], 0 offen sc1
    s_waitcnt vmcnt(0)
    v_xor_b32 v223, s54, v223
    v_cmp_eq_u32 vcc, 0, v223
    s_nop 0
    s_cmp_eq_u64 vcc, exec
    s_cbranch_scc1 pok_50
    s_sleep 5
    s_add_u32 s53, s53, 1
    s_cmp_lt_u32 s53, s61
    s_cbranch_scc1 poll_49
    s_mov_b32 s61, 0
pok_50:
    s_mov_b64 exec, -1
fok_48:
    s_add_u32 s20, s62, 0x5c8000
    s_addc_u32 s21, s63, 0
    s_mov_b32 s22, 0x6000
    s_mov_b32 s23, 0x20000
    s_and_b32 s35, s30, 1
    s_lshl_b32 s35, s35, 9
    s_add_u32 s36, s35, 0
    buffer_load_dwordx2 v[184:185], v221, s[20:23], s36 offen offset:0 sc1
    buffer_load_dwordx2 v[186:187], v221, s[20:23], s36 offen offset:1024 sc1
    buffer_load_dwordx2 v[188:189], v221, s[20:23], s36 offen offset:2048 sc1
    buffer_load_dwordx2 v[190:191], v221, s[20:23], s36 offen offset:3072 sc1
    s_waitcnt vmcnt(12)
    s_barrier
    buffer_load_dwordx4 v2, s[12:15], s39 offen sc1 lds
    buffer_load_dwordx4 v2, s[12:15], s39 offen offset:1024 sc1 lds
    s_add_u32 m0, m0, 2048
    s_add_u32 s39, s39, 65536
    buffer_load_dwordx4 v2, s[12:15], s39 offen sc1 lds
    buffer_load_dwordx4 v2, s[12:15], s39 offen offset:1024 sc1 lds
    s_add_u32 s19, s41, s42
    v_readlane_b32 s16, v248, s44
    s_nop 0
    s_add_u32 s16, s16, s38
    s_add_u32 s44, s44, 1
    s_and_b32 s44, s44, 15
    s_add_u32 s42, s42, 16384
    s_cmp_eq_u32 s42, 49152
    s_cselect_b32 s42, 0, s42
    s_add_u32 m0, m0, 2048
    s_add_u32 s39, s39, 65536
    buffer_load_dwordx4 v2, s[12:15], s39 offen sc1 lds
    buffer_load_dwordx4 v2, s[12:15], s39 offen offset:1024 sc1 lds
    s_add_u32 m0, m0, 2048
    s_add_u32 s39, s39, 65536
    buffer_load_dwordx4 v2, s[12:15], s39 offen sc1 lds
    buffer_load_dwordx4 v2, s[12:15], s39 offen offset:1024 sc1 lds
    s_mov_b32 m0, s19
    s_mov_b32 s39, s16
    s_add_u32 s36, s35, 4096
    buffer_load_dwordx2 v[192:193], v221, s[20:23], s36 offen offset:0 sc1
    buffer_load_dwordx2 v[194:195], v221, s[20:23], s36 offen offset:1024 sc1
    buffer_load_dwordx2 v[196:197], v221, s[20:23], s36 offen offset:2048 sc1
    buffer_load_dwordx2 v[198:199], v221, s[20:23], s36 offen offset:3072 sc1
    s_add_u32 s36, s35, 16384
    buffer_load_dwordx2 v[200:201], v221, s[20:23], s36 offen offset:0 sc1
    buffer_load_dwordx2 v[202:203], v221, s[20:23], s36 offen offset:1024 sc1
    s_waitcnt vmcnt(18)
    s_barrier
    buffer_load_dwordx4 v2, s[12:15], s39 offen sc1 lds
    buffer_load_dwordx4 v2, s[12:15], s39 offen offset:1024 sc1 lds
    s_add_u32 m0, m0, 2048
    s_add_u32 s39, s39, 65536
    buffer_load_dwordx4 v2, s[12:15], s39 offen sc1 lds
    buffer_load_dwordx4 v2, s[12:15], s39 offen offset:1024 sc1 lds
    s_add_u32 s19, s41, s42
    v_readlane_b32 s16, v248, s44
    s_nop 0
    s_add_u32 s16, s16, s38
    s_add_u32 s44, s44, 1
    s_and_b32 s44, s44, 15
    s_add_u32 s42, s42, 16384
    s_cmp_eq_u32 s42, 49152
    s_cselect_b32 s42, 0, s42
    s_add_u32 m0, m0, 2048
    s_add_u32 s39, s39, 65536
    buffer_load_dwordx4 v2, s[12:15], s39 offen sc1 lds
    buffer_load_dwordx4 v2, s[12:15], s39 offen offset:1024 sc1 lds
    s_add_u32 m0, m0, 2048
    s_add_u32 s39, s39, 65536
    buffer_load_dwordx4 v2, s[12:15], s39 offen sc1 lds
    buffer_load_dwordx4 v2, s[12:15], s39 offen offset:1024 sc1 lds
    s_mov_b32 m0, s19
    s_mov_b32 s39, s16
    s_add_u32 s36, s35, 16384
    buffer_load_dwordx2 v[204:205], v221, s[20:23], s36 offen offset:2048 sc1
    buffer_load_dwordx2 v[206:207], v221, s[20:23], s36 offen offset:3072 sc1
    s_add_u32 s36, s35, 20480
    buffer_load_dwordx2 v[208:209], v221, s[20:23], s36 offen offset:0 sc1
    buffer_load_dwordx2 v[210:211], v221, s[20:23], s36 offen offset:1024 sc1
    buffer_load_dwordx2 v[212:213], v221, s[20:23], s36 offen offset:2048 sc1
    buffer_load_dwordx2 v[214:215], v221, s[20:23], s36 offen offset:3072 sc1
    s_waitcnt vmcnt(20)
    s_barrier
    buffer_load_dwordx4 v2, s[12:15], s39 offen sc1 lds
    buffer_load_dwordx4 v2, s[12:15], s39 offen offset:1024 sc1 lds
    s_add_u32 m0, m0, 2048
    s_add_u32 s39, s39, 65536
    buffer_load_dwordx4 v2, s[12:15], s39 offen sc1 lds
    buffer_load_dwordx4 v2, s[12:15], s39 offen offset:1024 sc1 lds
    s_add_u32 s19, s41, s42
    v_readlane_b32 s16, v248, s44
    s_nop 0
    s_add_u32 s16, s16, s38
    s_add_u32 s44, s44, 1
    s_and_b32 s44, s44, 15
    s_add_u32 s42, s42, 16384
    s_cmp_eq_u32 s42, 49152
    s_cselect_b32 s42, 0, s42
    s_add_u32 m0, m0, 2048
    s_add_u32 s39, s39, 65536
    buffer_load_dwordx4 v2, s[12:15], s39 offen sc1 lds
    buffer_load_dwordx4 v2, s[12:15], s39 offen offset:1024 sc1 lds
    s_add_u32 m0, m0, 2048
    s_add_u32 s39, s39, 65536
    buffer_load_dwordx4 v2, s[12:15], s39 offen sc1 lds
    buffer_load_dwordx4 v2, s[12:15], s39 offen offset:1024 sc1 lds
    s_mov_b32 m0, s19
    s_mov_b32 s39, s16
    s_waitcnt vmcnt(14)
    s_barrier
    buffer_load_dwordx4 v2, s[12:15], s39 offen sc1 lds
    buffer_load_dwordx4 v2, s[12:15], s39 offen offset:1024 sc1 lds
    s_add_u32 m0, m0, 2048
    s_add_u32 s39, s39, 65536
    buffer_load_dwordx4 v2, s[12:15], s39 offen sc1 lds
    buffer_load_dwordx4 v2, s[12:15], s39 offen offset:1024 sc1 lds
    s_add_u32 s19, s41, s42
    v_readlane_b32 s16, v248, s44
    s_nop 0
    s_add_u32 s16, s16, s38
    s_add_u32 s44, s44, 1
    s_and_b32 s44, s44, 15
    s_add_u32 s42, s42, 16384
    s_cmp_eq_u32 s42, 49152
    s_cselect_b32 s42, 0, s42
    s_add_u32 m0, m0, 2048
    s_add_u32 s39, s39, 65536
    buffer_load_dwordx4 v2, s[12:15], s39 offen sc1 lds
    buffer_load_dwordx4 v2, s[12:15], s39 offen offset:1024 sc1 lds
    s_add_u32 m0, m0, 2048
    s_add_u32 s39, s39, 65536
    buffer_load_dwordx4 v2, s[12:15], s39 offen sc1 lds
    buffer_load_dwordx4 v2, s[12:15], s39 offen offset:1024 sc1 lds
    s_mov_b32 m0, s19
    s_mov_b32 s39, s16
    s_waitcnt vmcnt(16)
    v_add_f32 v184, v184, v200
    v_add_f32 v185, v185, v201
    v_add_f32 v186, v186, v202
    v_add_f32 v187, v187, v203
    v_add_f32 v188, v188, v204
    v_add_f32 v189, v189, v205
    v_add_f32 v190, v190, v206
    v_add_f32 v191, v191, v207
    v_add_f32 v192, v192, v208
    v_add_f32 v193, v193, v209
    v_add_f32 v194, v194, v210
    v_add_f32 v195, v195, v211
    v_add_f32 v196, v196, v212
    v_add_f32 v197, v197, v213
    v_add_f32 v198, v198, v214
    v_add_f32 v199, v199, v215
    s_waitcnt vmcnt(8)
    s_barrier
    buffer_load_dwordx4 v2, s[12:15], s39 offen sc1 lds
    buffer_load_dwordx4 v2, s[12:15], s39 offen offset:1024 sc1 lds
    s_add_u32 m0, m0, 2048
    s_add_u32 s39, s39, 65536
    buffer_load_dwordx4 v2, s[12:15], s39 offen sc1 lds
    buffer_load_dwordx4 v2, s[12:15], s39 offen offset:1024 sc1 lds
    s_add_u32 s19, s41, s42
    v_readlane_b32 s16, v248, s44
    s_nop 0
    s_add_u32 s16, s16, s38
    s_add_u32 s44, s44, 1
    s_and_b32 s44, s44, 15
    s_add_u32 s42, s42, 16384
    s_cmp_eq_u32 s42, 49152
    s_cselect_b32 s42, 0, s42
    s_add_u32 m0, m0, 2048
    s_add_u32 s39, s39, 65536
    buffer_load_dwordx4 v2, s[12:15], s39 offen sc1 lds
    buffer_load_dwordx4 v2, s[12:15], s39 offen offset:1024 sc1 lds
    s_add_u32 m0, m0, 2048
    s_add_u32 s39, s39, 65536
    buffer_load_dwordx4 v2, s[12:15], s39 offen sc1 lds
    buffer_load_dwordx4 v2, s[12:15], s39 offen offset:1024 sc1 lds
    s_mov_b32 m0, s19
    s_mov_b32 s39, s16
    v_add_f32 v184, v184, v192
    v_add_f32 v185, v185, v193
    v_add_f32 v186, v186, v194
    v_add_f32 v187, v187, v195
    v_add_f32 v188, v188, v196
    v_add_f32 v189, v189, v197
    v_add_f32 v190, v190, v198
    v_add_f32 v191, v191, v199
    v_add_f32 v184, v184, v188
    v_add_f32 v185, v185, v189
    v_add_f32 v186, v186, v190
    v_add_f32 v187, v187, v191
    v_add_f32 v184, v184, v186
    v_add_f32 v185, v185, v187
    v_mul_f32 v188, 0x3a800000, v184
    v_mul_f32 v217, 0x3a800000, v185
    s_waitcnt vmcnt(8)
    s_barrier
    buffer_load_dwordx4 v2, s[12:15], s39 offen sc1 lds
    buffer_load_dwordx4 v2, s[12:15], s39 offen offset:1024 sc1 lds
    s_add_u32 m0, m0, 2048
    s_add_u32 s39, s39, 65536
    buffer_load_dwordx4 v2, s[12:15], s39 offen sc1 lds
    buffer_load_dwordx4 v2, s[12:15], s39 offen offset:1024 sc1 lds
    s_add_u32 m0, m0, 2048
    s_add_u32 s39, s39, 65536
    buffer_load_dwordx4 v2, s[12:15], s39 offen sc1 lds
    buffer_load_dwordx4 v2, s[12:15], s39 offen offset:1024 sc1 lds
    s_add_u32 m0, m0, 2048
    s_add_u32 s39, s39, 65536
    buffer_load_dwordx4 v2, s[12:15], s39 offen sc1 lds
    buffer_load_dwordx4 v2, s[12:15], s39 offen offset:1024 sc1 lds
    v_fma_f32 v217, -v188, v188, v217
    v_max_f32 v217, 0, v217
    v_add_f32 v217, 0x3727c5ac, v217
    v_sqrt_f32 v217, v217
    s_nop 0
    v_mov_b32 v189, v217
    v_rcp_f32 v219, v217
    s_nop 0
    v_mul_f32 v190, 0xc0135761, v219
    v_mul_f32 v191, v219, v219
    v_mul_f32 v191, v191, v190
    v_mul_f32 v191, 0x3d372713, v191
    s_lshl_b32 s35, s35, 1
    s_add_u32 s35, s35, 160768
    v_add_u32 v220, s35, v2
    ds_write_b128 v220, v[188:191]
    s_waitcnt lgkmcnt(0)
    s_waitcnt vmcnt(8)
    s_barrier
    s_waitcnt vmcnt(0)
    s_barrier
    s_cmp_lg_u32 s60, 0
    s_cbranch_scc1 tw4_54
    s_load_dwordx2 s[48:49], s[0:1], 80
    s_lshl_b32 s45, s2, 1
    s_and_b32 s50, s30, 1
    s_add_u32 s45, s45, s50
    s_mul_i32 s45, s45, 14336
    s_mov_b32 s50, 7340032
    s_mov_b32 s51, 0x20000
    s_waitcnt lgkmcnt(0)
    buffer_load_dwordx4 v[200:203], v2, s[48:51], s45 offen offset:0
    buffer_load_dwordx4 v[200:203], v2, s[48:51], s45 offen offset:1024
    buffer_load_dwordx4 v[200:203], v2, s[48:51], s45 offen offset:2048
    buffer_load_dwordx4 v[200:203], v2, s[48:51], s45 offen offset:3072
    s_add_u32 s45, s45, 4096
    buffer_load_dwordx4 v[200:203], v2, s[48:51], s45 offen offset:0
    buffer_load_dwordx4 v[200:203], v2, s[48:51], s45 offen offset:1024
    buffer_load_dwordx4 v[200:203], v2, s[48:51], s45 offen offset:2048
    buffer_load_dwordx4 v[200:203], v2, s[48:51], s45 offen offset:3072
    s_add_u32 s45, s45, 4096
    buffer_load_dwordx4 v[200:203], v2, s[48:51], s45 offen offset:0
    buffer_load_dwordx4 v[200:203], v2, s[48:51], s45 offen offset:1024
    buffer_load_dwordx4 v[200:203], v2, s[48:51], s45 offen offset:2048
    buffer_load_dwordx4 v[200:203], v2, s[48:51], s45 offen offset:3072
    s_add_u32 s45, s45, 4096
    buffer_load_dwordx4 v[200:203], v2, s[48:51], s45 offen offset:0
    buffer_load_dwordx4 v[200:203], v2, s[48:51], s45 offen offset:1024
tw4_54:
    s_barrier
    s_cmp_lg_u32 s60, 0
    s_cbranch_scc1 rp_55
    s_call_b64 s[76:77], SUB_r_pre
rp_55:
    s_and_b32 s35, s30, 1
    s_add_u32 s12, s62, 0x400000
    s_addc_u32 s13, s63, 0
    s_mov_b32 s14, 0x1be000
    s_mov_b32 s15, 0x20000
    s_mul_i32 s38, s35, 917504
    s_mul_i32 s36, s31, 114688
    s_add_u32 s38, s38, s36
    s_lshl_b32 s41, s35, 13
    s_mov_b32 s42, 0
    s_mov_b32 s44, 0
    s_add_u32 s54, s55, 0x700
    s_lshl_b32 s53, s31, 7
    s_add_u32 s54, s54, s53
    v_mov_b32 v9, s54
    s_add_u32 s54, s55, 0x600
    s_lshl_b32 s53, s31, 7
    s_add_u32 s54, s54, s53
    v_mov_b32 v10, s54
    s_add_u32 s54, s55, 0x300
    s_lshl_b32 s53, s31, 7
    s_add_u32 s54, s54, s53
    v_mov_b32 v12, s54
    v_mov_b32 v13, 1
    s_and_b32 s51, s30, 1
    s_lshl_b32 s51, s51, 30
    s_lshl_b32 s54, s60, 2
    s_add_u32 s54, s54, 4
    v_mov_b32 v14, 162880
spin_56:
    s_sleep 2
    ds_read_b32 v15, v14
    s_waitcnt lgkmcnt(0)
    v_readfirstlane_b32 s53, v15
    s_nop 0
    s_cmp_ge_u32 s53, s54
    s_cbranch_scc0 spin_56
    s_mov_b64 exec, 1
    buffer_atomic_add v13, v9, s[56:59], s51 offen sc1
    s_mov_b64 exec, -1
    v_xor_b32 v15, 128, v12
    s_mov_b32 s44, 3
    s_call_b64 s[76:77], PREP_a_issue_4
    s_mov_b32 m0, s19
    s_mov_b32 s39, s16
    s_mov_b32 s40, s17
    s_waitcnt vmcnt(16)
    s_barrier
    s_mov_b64 exec, 1
    buffer_load_dword v8, v9, s[56:59], 0 offen sc1
    s_mov_b64 exec, -1
    s_waitcnt vmcnt(9)
    s_barrier
    s_waitcnt vmcnt(0)
    v_readfirstlane_b32 s53, v8
    s_add_u32 s54, s52, 8
    s_cmp_eq_u32 s53, s54
    s_cbranch_scc1 fok_57
    s_mov_b32 s53, 0
    s_add_u32 s54, s52, 8
    s_bfm_b64 exec, 1, 0
poll_58:
    buffer_load_dword v8, v9, s[56:59], 0 offen sc1
    s_waitcnt vmcnt(0)
    v_xor_b32 v8, s54, v8
    v_cmp_eq_u32 vcc, 0, v8
    s_nop 0
    s_cmp_eq_u64 vcc, exec
    s_cbranch_scc1 pok_59
    s_sleep 5
    s_add_u32 s53, s53, 1
    s_cmp_lt_u32 s53, s61
    s_cbranch_scc1 poll_58
    s_mov_b32 s61, 0
pok_59:
    s_mov_b64 exec, -1
fok_57:
    buffer_load_dwordx4 v2, s[12:15], s39 offen sc1 lds
    s_add_u32 m0, m0, 1024
    s_nop 0
    buffer_load_dwordx4 v2, s[12:15], s40 offen sc1 lds
    s_add_u32 m0, m0, 1024
    s_add_u32 s39, s39, 229376
    buffer_load_dwordx4 v2, s[12:15], s39 offen sc1 lds
    s_add_u32 m0, m0, 1024
    s_add_u32 s40, s40, 229376
    buffer_load_dwordx4 v2, s[12:15], s40 offen sc1 lds
    s_call_b64 s[76:77], PREP_a_issue_4
    s_add_u32 m0, m0, 1024
    s_add_u32 s39, s39, 229376
    buffer_load_dwordx4 v2, s[12:15], s39 offen sc1 lds
    s_add_u32 m0, m0, 1024
    s_add_u32 s40, s40, 229376
    buffer_load_dwordx4 v2, s[12:15], s40 offen sc1 lds
    s_add_u32 m0, m0, 1024
    s_add_u32 s39, s39, 229376
    buffer_load_dwordx4 v2, s[12:15], s39 offen sc1 lds
    s_add_u32 m0, m0, 1024
    s_add_u32 s40, s40, 229376
    buffer_load_dwordx4 v2, s[12:15], s40 offen sc1 lds
    s_mov_b32 m0, s19
    s_mov_b32 s39, s16
    s_mov_b32 s40, s17
    s_waitcnt vmcnt(9)
    s_barrier
    s_mov_b64 exec, 1
    buffer_atomic_add v13, v10, s[56:59], s51 offen sc1
    s_mov_b64 exec, -1
    buffer_load_dwordx4 v2, s[12:15], s39 offen sc1 lds
    s_add_u32 m0, m0, 1024
    s_nop 0
    buffer_load_dwordx4 v2, s[12:15], s40 offen sc1 lds
    s_add_u32 m0, m0, 1024
    s_add_u32 s39, s39, 229376
    buffer_load_dwordx4 v2, s[12:15], s39 offen sc1 lds
    s_add_u32 m0, m0, 1024
    s_add_u32 s40, s40, 229376
    buffer_load_dwordx4 v2, s[12:15], s40 offen sc1 lds
    s_call_b64 s[76:77], PREP_a_issue_4
    s_add_u32 m0, m0, 1024
    s_add_u32 s39, s39, 229376
    buffer_load_dwordx4 v2, s[12:15], s39 offen sc1 lds
    s_add_u32 m0, m0, 1024
    s_add_u32 s40, s40, 229376
    buffer_load_dwordx4 v2, s[12:15], s40 offen sc1 lds
    s_add_u32 m0, m0, 1024
    s_add_u32 s39, s39, 229376
    buffer_load_dwordx4 v2, s[12:15], s39 offen sc1 lds
    s_add_u32 m0, m0, 1024
    s_add_u32 s40, s40, 229376
    buffer_load_dwordx4 v2, s[12:15], s40 offen sc1 lds
    s_mov_b32 m0, s19
    s_mov_b32 s39, s16
    s_mov_b32 s40, s17
    s_waitcnt vmcnt(9)
    s_barrier
    buffer_load_dwordx4 v2, s[12:15], s39 offen sc1 lds
    s_add_u32 m0, m0, 1024
    s_nop 0
    buffer_load_dwordx4 v2, s[12:15], s40 offen sc1 lds
    s_add_u32 m0, m0, 1024
    s_add_u32 s39, s39, 229376
    buffer_load_dwordx4 v2, s[12:15], s39 offen sc1 lds
    s_add_u32 m0, m0, 1024
    s_add_u32 s40, s40, 229376
    buffer_load_dwordx4 v2, s[12:15], s40 offen sc1 lds
    s_call_b64 s[76:77], PREP_a_issue_4
    s_add_u32 m0, m0, 1024
    s_add_u32 s39, s39, 229376
    buffer_load_dwordx4 v2, s[12:15], s39 offen sc1 lds
    s_add_u32 m0, m0, 1024
    s_add_u32 s40, s40, 229376
    buffer_load_dwordx4 v2, s[12:15], s40 offen sc1 lds
    s_add_u32 m0, m0, 1024
    s_add_u32 s39, s39, 229376
    buffer_load_dwordx4 v2, s[12:15], s39 offen sc1 lds
    s_add_u32 m0, m0, 1024
    s_add_u32 s40, s40, 229376
    buffer_load_dwordx4 v2, s[12:15], s40 offen sc1 lds
    s_mov_b32 m0, s19
    s_mov_b32 s39, s16
    s_mov_b32 s40, s17
    s_waitcnt vmcnt(8)
    s_barrier
    buffer_load_dwordx4 v2, s[12:15], s39 offen sc1 lds
    s_add_u32 m0, m0, 1024
    s_nop 0
    buffer_load_dwordx4 v2, s[12:15], s40 offen sc1 lds
    s_add_u32 m0, m0, 1024
    s_add_u32 s39, s39, 229376
    buffer_load_dwordx4 v2, s[12:15], s39 offen sc1 lds
    s_add_u32 m0, m0, 1024
    s_add_u32 s40, s40, 229376
    buffer_load_dwordx4 v2, s[12:15], s40 offen sc1 lds
    s_mov_b64 exec, 1
    buffer_load_dword v11, v10, s[56:59], 0 offen sc1
    s_mov_b64 exec, -1
    s_call_b64 s[76:77], PREP_a_issue_4
    s_add_u32 m0, m0, 1024
    s_add_u32 s39, s39, 229376
    buffer_load_dwordx4 v2, s[12:15], s39 offen sc1 lds
    s_add_u32 m0, m0, 1024
    s_add_u32 s40, s40, 229376
    buffer_load_dwordx4 v2, s[12:15], s40 offen sc1 lds
    s_add_u32 m0, m0, 1024
    s_add_u32 s39, s39, 229376
    buffer_load_dwordx4 v2, s[12:15], s39 offen sc1 lds
    s_add_u32 m0, m0, 1024
    s_add_u32 s40, s40, 229376
    buffer_load_dwordx4 v2, s[12:15], s40 offen sc1 lds
    s_mov_b32 m0, s19
    s_mov_b32 s39, s16
    s_mov_b32 s40, s17
    s_waitcnt vmcnt(9)
    s_barrier
    s_mov_b64 exec, 1
    buffer_atomic_add v13, v12, s[56:59], s51 offen sc1
    s_mov_b64 exec, -1
    buffer_load_dwordx4 v2, s[12:15], s39 offen sc1 lds
    s_add_u32 m0, m0, 1024
    s_nop 0
    buffer_load_dwordx4 v2, s[12:15], s40 offen sc1 lds
    s_add_u32 m0, m0, 1024
    s_add_u32 s39, s39, 229376
    buffer_load_dwordx4 v2, s[12:15], s39 offen sc1 lds
    s_add_u32 m0, m0, 1024
    s_add_u32 s40, s40, 229376
    buffer_load_dwordx4 v2, s[12:15], s40 offen sc1 lds
    s_call_b64 s[76:77], PREP_a_issue_4
    s_add_u32 m0, m0, 1024
    s_add_u32 s39, s39, 229376
    buffer_load_dwordx4 v2, s[12:15], s39 offen sc1 lds
    s_add_u32 m0, m0, 1024
    s_add_u32 s40, s40, 229376
    buffer_load_dwordx4 v2, s[12:15], s40 offen sc1 lds
    s_add_u32 m0, m0, 1024
    s_add_u32 s39, s39, 229376
    buffer_load_dwordx4 v2, s[12:15], s39 offen sc1 lds
    s_add_u32 m0, m0, 1024
    s_add_u32 s40, s40, 229376
    buffer_load_dwordx4 v2, s[12:15], s40 offen sc1 lds
    s_mov_b32 m0, s19
    s_mov_b32 s39, s16
    s_mov_b32 s40, s17
    s_waitcnt vmcnt(9)
    s_barrier
    buffer_load_dwordx4 v2, s[12:15], s39 offen sc1 lds
    s_add_u32 m0, m0, 1024
    s_nop 0
    buffer_load_dwordx4 v2, s[12:15], s40 offen sc1 lds
    s_add_u32 m0, m0, 1024
    s_add_u32 s39, s39, 229376
    buffer_load_dwordx4 v2, s[12:15], s39 offen sc1 lds
    s_add_u32 m0, m0, 1024
    s_add_u32 s40, s40, 229376
    buffer_load_dwordx4 v2, s[12:15], s40 offen sc1 lds
    s_waitcnt vmcnt(17)
    v_readfirstlane_b32 s53, v11
    s_add_u32 s54, s52, 8
    s_cmp_eq_u32 s53, s54
    s_cbranch_scc1 fok_60
    s_mov_b32 s53, 0
    s_add_u32 s54, s52, 8
    s_bfm_b64 exec, 1, 0
poll_61:
    buffer_load_dword v11, v10, s[56:59], 0 offen sc1
    s_waitcnt vmcnt(0)
    v_xor_b32 v11, s54, v11
    v_cmp_eq_u32 vcc, 0, v11
    s_nop 0
    s_cmp_eq_u64 vcc, exec
    s_cbranch_scc1 pok_62
    s_sleep 5
    s_add_u32 s53, s53, 1
    s_cmp_lt_u32 s53, s61
    s_cbranch_scc1 poll_61
    s_mov_b32 s61, 0
pok_62:
    s_mov_b64 exec, -1
fok_60:
    s_call_b64 s[76:77], PREP_a_issue_4
    s_add_u32 m0, m0, 1024
    s_add_u32 s39, s39, 229376
    buffer_load_dwordx4 v2, s[12:15], s39 offen sc1 lds
    s_add_u32 m0, m0, 1024
    s_add_u32 s40, s40, 229376
    buffer_load_dwordx4 v2, s[12:15], s40 offen sc1 lds
    s_add_u32 m0, m0, 1024
    s_add_u32 s39, s39, 229376
    buffer_load_dwordx4 v2, s[12:15], s39 offen sc1 lds
    s_add_u32 m0, m0, 1024
    s_add_u32 s40, s40, 229376
    buffer_load_dwordx4 v2, s[12:15], s40 offen sc1 lds
    s_mov_b32 m0, s19
    s_mov_b32 s39, s16
    s_mov_b32 s40, s17
    s_waitcnt vmcnt(8)
    s_barrier
    buffer_load_dwordx4 v2, s[12:15], s39 offen sc1 lds
    s_add_u32 m0, m0, 1024
    s_nop 0
    buffer_load_dwordx4 v2, s[12:15], s40 offen sc1 lds
    s_add_u32 m0, m0, 1024
    s_add_u32 s39, s39, 229376
    buffer_load_dwordx4 v2, s[12:15], s39 offen sc1 lds
    s_add_u32 m0, m0, 1024
    s_add_u32 s40, s40, 229376
    buffer_load_dwordx4 v2, s[12:15], s40 offen sc1 lds
    s_mov_b32 s43, 1
ld_63:
    s_add_u32 s19, s41, s42
    v_readlane_b32 s16, v249, s44
    v_readlane_b32 s17, v250, s44
    s_add_u32 s16, s16, s38
    s_add_u32 s17, s17, s38
    s_add_u32 s44, s44, 1
    s_add_u32 s42, s42, 16384
    s_cmp_eq_u32 s42, 49152
    s_cselect_b32 s42, 0, s42
    s_add_u32 m0, m0, 1024
    s_add_u32 s39, s39, 229376
    buffer_load_dwordx4 v2, s[12:15], s39 offen sc1 lds
    s_add_u32 m0, m0, 1024
    s_add_u32 s40, s40, 229376
    buffer_load_dwordx4 v2, s[12:15], s40 offen sc1 lds
    s_add_u32 m0, m0, 1024
    s_add_u32 s39, s39, 229376
    buffer_load_dwordx4 v2, s[12:15], s39 offen sc1 lds
    s_add_u32 m0, m0, 1024
    s_add_u32 s40, s40, 229376
    buffer_load_dwordx4 v2, s[12:15], s40 offen sc1 lds
    s_mov_b32 m0, s19
    s_mov_b32 s39, s16
    s_mov_b32 s40, s17
    s_waitcnt vmcnt(8)
    s_barrier
    buffer_load_dwordx4 v2, s[12:15], s39 offen sc1 lds
    s_add_u32 m0, m0, 1024
    s_nop 0
    buffer_load_dwordx4 v2, s[12:15], s40 offen sc1 lds
    s_add_u32 m0, m0, 1024
    s_add_u32 s39, s39, 229376
    buffer_load_dwordx4 v2, s[12:15], s39 offen sc1 lds
    s_add_u32 m0, m0, 1024
    s_add_u32 s40, s40, 229376
    buffer_load_dwordx4 v2, s[12:15], s40 offen sc1 lds
    s_add_u32 s43, s43, 1
    s_cmp_lt_u32 s43, 4
    s_cbranch_scc1 ld_63
    s_call_b64 s[76:77], PREP_a_issue_4
    s_add_u32 m0, m0, 1024
    s_add_u32 s39, s39, 229376
    buffer_load_dwordx4 v2, s[12:15], s39 offen sc1 lds
    s_add_u32 m0, m0, 1024
    s_add_u32 s40, s40, 229376
    buffer_load_dwordx4 v2, s[12:15], s40 offen sc1 lds
    s_add_u32 m0, m0, 1024
    s_add_u32 s39, s39, 229376
    buffer_load_dwordx4 v2, s[12:15], s39 offen sc1 lds
    s_add_u32 m0, m0, 1024
    s_add_u32 s40, s40, 229376
    buffer_load_dwordx4 v2, s[12:15], s40 offen sc1 lds
    s_mov_b32 m0, s19
    s_mov_b32 s39, s16
    s_mov_b32 s40, s17
    s_waitcnt vmcnt(8)
    s_barrier
    buffer_load_dwordx4 v2, s[12:15], s39 offen sc1 lds
    s_add_u32 m0, m0, 1024
    s_nop 0
    buffer_load_dwordx4 v2, s[12:15], s40 offen sc1 lds
    s_add_u32 m0, m0, 1024
    s_add_u32 s39, s39, 229376
    buffer_load_dwordx4 v2, s[12:15], s39 offen sc1 lds
    s_add_u32 m0, m0, 1024
    s_add_u32 s40, s40, 229376
    buffer_load_dwordx4 v2, s[12:15], s40 offen sc1 lds
    s_mov_b64 exec, 1
    buffer_load_dword v11, v12, s[56:59], 0 offen sc1
    s_mov_b64 exec, -1
    s_call_b64 s[76:77], PREP_a_issue_4
    s_add_u32 m0, m0, 1024
    s_add_u32 s39, s39, 229376
    buffer_load_dwordx4 v2, s[12:15], s39 offen sc1 lds
    s_add_u32 m0, m0, 1024
    s_add_u32 s40, s40, 229376
    buffer_load_dwordx4 v2, s[12:15], s40 offen sc1 lds
    s_add_u32 m0, m0, 1024
    s_add_u32 s39, s39, 229376
    buffer_load_dwordx4 v2, s[12:15], s39 offen sc1 lds
    s_add_u32 m0, m0, 1024
    s_add_u32 s40, s40, 229376
    buffer_load_dwordx4 v2, s[12:15], s40 offen sc1 lds
    s_mov_b32 m0, s19
    s_mov_b32 s39, s16
    s_mov_b32 s40, s17
    s_waitcnt vmcnt(9)
    s_barrier
    buffer_load_dwordx4 v2, s[12:15], s39 offen sc1 lds
    s_add_u32 m0, m0, 1024
    s_nop 0
    buffer_load_dwordx4 v2, s[12:15], s40 offen sc1 lds
    s_add_u32 m0, m0, 1024
    s_add_u32 s39, s39, 229376
    buffer_load_dwordx4 v2, s[12:15], s39 offen sc1 lds
    s_add_u32 m0, m0, 1024
    s_add_u32 s40, s40, 229376
    buffer_load_dwordx4 v2, s[12:15], s40 offen sc1 lds
    s_call_b64 s[76:77], PREP_a_issue_4
    s_add_u32 m0, m0, 1024
    s_add_u32 s39, s39, 229376
    buffer_load_dwordx4 v2, s[12:15], s39 offen sc1 lds
    s_add_u32 m0, m0, 1024
    s_add_u32 s40, s40, 229376
    buffer_load_dwordx4 v2, s[12:15], s40 offen sc1 lds
    s_add_u32 m0, m0, 1024
    s_add_u32 s39, s39, 229376
    buffer_load_dwordx4 v2, s[12:15], s39 offen sc1 lds
    s_add_u32 m0, m0, 1024
    s_add_u32 s40, s40, 229376
    buffer_load_dwordx4 v2, s[12:15], s40 offen sc1 lds
    s_mov_b32 m0, s19
    s_mov_b32 s39, s16
    s_mov_b32 s40, s17
    s_waitcnt vmcnt(8)
    s_barrier
    buffer_load_dwordx4 v2, s[12:15], s39 offen sc1 lds
    s_add_u32 m0, m0, 1024
    s_nop 0
    buffer_load_dwordx4 v2, s[12:15], s40 offen sc1 lds
    s_add_u32 m0, m0, 1024
    s_add_u32 s39, s39, 229376
    buffer_load_dwordx4 v2, s[12:15], s39 offen sc1 lds
    s_add_u32 m0, m0, 1024
    s_add_u32 s40, s40, 229376
    buffer_load_dwordx4 v2, s[12:15], s40 offen sc1 lds
    s_waitcnt vmcnt(16)
    v_readfirstlane_b32 s53, v11
    s_add_u32 s54, s52, 8
    s_cmp_eq_u32 s53, s54
    s_cbranch_scc1 fok_64
    s_mov_b32 s53, 0
    s_add_u32 s54, s52, 8
    s_bfm_b64 exec, 1, 0
poll_65:
    buffer_load_dword v11, v12, s[56:59], 0 offen sc1
    s_waitcnt vmcnt(0)
    v_xor_b32 v11, s54, v11
    v_cmp_eq_u32 vcc, 0, v11
    s_nop 0
    s_cmp_eq_u64 vcc, exec
    s_cbranch_scc1 pok_66
    s_sleep 5
    s_add_u32 s53, s53, 1
    s_cmp_lt_u32 s53, s61
    s_cbranch_scc1 poll_65
    s_mov_b32 s61, 0
pok_66:
    s_mov_b64 exec, -1
fok_64:
    s_call_b64 s[76:77], PREP_a_issue_4
    s_add_u32 m0, m0, 1024
    s_add_u32 s39, s39, 229376
    buffer_load_dwordx4 v2, s[12:15], s39 offen sc1 lds
    s_add_u32 m0, m0, 1024
    s_add_u32 s40, s40, 229376
    buffer_load_dwordx4 v2, s[12:15], s40 offen sc1 lds
    s_add_u32 m0, m0, 1024
    s_add_u32 s39, s39, 229376
    buffer_load_dwordx4 v2, s[12:15], s39 offen sc1 lds
    s_add_u32 m0, m0, 1024
    s_add_u32 s40, s40, 229376
    buffer_load_dwordx4 v2, s[12:15], s40 offen sc1 lds
    s_mov_b32 m0, s19
    s_mov_b32 s39, s16
    s_mov_b32 s40, s17
    s_waitcnt vmcnt(8)
    s_barrier
    buffer_load_dwordx4 v2, s[12:15], s39 offen sc1 lds
    s_add_u32 m0, m0, 1024
    s_nop 0
    buffer_load_dwordx4 v2, s[12:15], s40 offen sc1 lds
    s_add_u32 m0, m0, 1024
    s_add_u32 s39, s39, 229376
    buffer_load_dwordx4 v2, s[12:15], s39 offen sc1 lds
    s_add_u32 m0, m0, 1024
    s_add_u32 s40, s40, 229376
    buffer_load_dwordx4 v2, s[12:15], s40 offen sc1 lds
    s_mov_b32 s43, 1
ld_67:
    s_add_u32 s19, s41, s42
    v_readlane_b32 s16, v249, s44
    v_readlane_b32 s17, v250, s44
    s_add_u32 s16, s16, s38
    s_add_u32 s17, s17, s38
    s_add_u32 s44, s44, 1
    s_add_u32 s42, s42, 16384
    s_cmp_eq_u32 s42, 49152
    s_cselect_b32 s42, 0, s42
    s_add_u32 m0, m0, 1024
    s_add_u32 s39, s39, 229376
    buffer_load_dwordx4 v2, s[12:15], s39 offen sc1 lds
    s_add_u32 m0, m0, 1024
    s_add_u32 s40, s40, 229376
    buffer_load_dwordx4 v2, s[12:15], s40 offen sc1 lds
    s_add_u32 m0, m0, 1024
    s_add_u32 s39, s39, 229376
    buffer_load_dwordx4 v2, s[12:15], s39 offen sc1 lds
    s_add_u32 m0, m0, 1024
    s_add_u32 s40, s40, 229376
    buffer_load_dwordx4 v2, s[12:15], s40 offen sc1 lds
    s_mov_b32 m0, s19
    s_mov_b32 s39, s16
    s_mov_b32 s40, s17
    s_waitcnt vmcnt(8)
    s_barrier
    buffer_load_dwordx4 v2, s[12:15], s39 offen sc1 lds
    s_add_u32 m0, m0, 1024
    s_nop 0
    buffer_load_dwordx4 v2, s[12:15], s40 offen sc1 lds
    s_add_u32 m0, m0, 1024
    s_add_u32 s39, s39, 229376
    buffer_load_dwordx4 v2, s[12:15], s39 offen sc1 lds
    s_add_u32 m0, m0, 1024
    s_add_u32 s40, s40, 229376
    buffer_load_dwordx4 v2, s[12:15], s40 offen sc1 lds
    s_add_u32 s43, s43, 1
    s_cmp_lt_u32 s43, 5
    s_cbranch_scc1 ld_67
    s_call_b64 s[76:77], PREP_a_issue_4
    s_add_u32 m0, m0, 1024
    s_add_u32 s39, s39, 229376
    buffer_load_dwordx4 v2, s[12:15], s39 offen sc1 lds
    s_add_u32 m0, m0, 1024
    s_add_u32 s40, s40, 229376
    buffer_load_dwordx4 v2, s[12:15], s40 offen sc1 lds
    s_add_u32 m0, m0, 1024
    s_add_u32 s39, s39, 229376
    buffer_load_dwordx4 v2, s[12:15], s39 offen sc1 lds
    s_add_u32 m0, m0, 1024
    s_add_u32 s40, s40, 229376
    buffer_load_dwordx4 v2, s[12:15], s40 offen sc1 lds
    s_mov_b32 m0, s19
    s_mov_b32 s39, s16
    s_mov_b32 s40, s17
    s_waitcnt vmcnt(8)
    s_barrier
    buffer_load_dwordx4 v2, s[12:15], s39 offen sc1 lds
    s_add_u32 m0, m0, 1024
    s_nop 0
    buffer_load_dwordx4 v2, s[12:15], s40 offen sc1 lds
    s_add_u32 m0, m0, 1024
    s_add_u32 s39, s39, 229376
    buffer_load_dwordx4 v2, s[12:15], s39 offen sc1 lds
    s_add_u32 m0, m0, 1024
    s_add_u32 s40, s40, 229376
    buffer_load_dwordx4 v2, s[12:15], s40 offen sc1 lds
    s_mov_b64 exec, 1
    buffer_load_dword v11, v15, s[56:59], 0 offen sc1
    s_mov_b64 exec, -1
    s_call_b64 s[76:77], PREP_a_issue_4
    s_add_u32 m0, m0, 1024
    s_add_u32 s39, s39, 229376
    buffer_load_dwordx4 v2, s[12:15], s39 offen sc1 lds
    s_add_u32 m0, m0, 1024
    s_add_u32 s40, s40, 229376
    buffer_load_dwordx4 v2, s[12:15], s40 offen sc1 lds
    s_add_u32 m0, m0, 1024
    s_add_u32 s39, s39, 229376
    buffer_load_dwordx4 v2, s[12:15], s39 offen sc1 lds
    s_add_u32 m0, m0, 1024
    s_add_u32 s40, s40, 229376
    buffer_load_dwordx4 v2, s[12:15], s40 offen sc1 lds
    s_mov_b32 m0, s19
    s_mov_b32 s39, s16
    s_mov_b32 s40, s17
    s_waitcnt vmcnt(9)
    s_barrier
    buffer_load_dwordx4 v2, s[12:15], s39 offen sc1 lds
    s_add_u32 m0, m0, 1024
    s_nop 0
    buffer_load_dwordx4 v2, s[12:15], s40 offen sc1 lds
    s_add_u32 m0, m0, 1024
    s_add_u32 s39, s39, 229376
    buffer_load_dwordx4 v2, s[12:15], s39 offen sc1 lds
    s_add_u32 m0, m0, 1024
    s_add_u32 s40, s40, 229376
    buffer_load_dwordx4 v2, s[12:15], s40 offen sc1 lds
    s_call_b64 s[76:77], PREP_a_issue_4
    s_add_u32 m0, m0, 1024
    s_add_u32 s39, s39, 229376
    buffer_load_dwordx4 v2, s[12:15], s39 offen sc1 lds
    s_add_u32 m0, m0, 1024
    s_add_u32 s40, s40, 229376
    buffer_load_dwordx4 v2, s[12:15], s40 offen sc1 lds
    s_add_u32 m0, m0, 1024
    s_add_u32 s39, s39, 229376
    buffer_load_dwordx4 v2, s[12:15], s39 offen sc1 lds
    s_add_u32 m0, m0, 1024
    s_add_u32 s40, s40, 229376
    buffer_load_dwordx4 v2, s[12:15], s40 offen sc1 lds
    s_mov_b32 m0, s19
    s_mov_b32 s39, s16
    s_mov_b32 s40, s17
    s_waitcnt vmcnt(8)
    s_barrier
    buffer_load_dwordx4 v2, s[12:15], s39 offen sc1 lds
    s_add_u32 m0, m0, 1024
    s_nop 0
    buffer_load_dwordx4 v2, s[12:15], s40 offen sc1 lds
    s_add_u32 m0, m0, 1024
    s_add_u32 s39, s39, 229376
    buffer_load_dwordx4 v2, s[12:15], s39 offen sc1 lds
    s_add_u32 m0, m0, 1024
    s_add_u32 s40, s40, 229376
    buffer_load_dwordx4 v2, s[12:15], s40 offen sc1 lds
    s_waitcnt vmcnt(16)
    v_readfirstlane_b32 s53, v11
    s_add_u32 s54, s52, 8
    s_cmp_eq_u32 s53, s54
    s_cbranch_scc1 fok_68
    s_mov_b32 s53, 0
    s_add_u32 s54, s52, 8
    s_bfm_b64 exec, 1, 0
poll_69:
    buffer_load_dword v11, v15, s[56:59], 0 offen sc1
    s_waitcnt vmcnt(0)
    v_xor_b32 v11, s54, v11
    v_cmp_eq_u32 vcc, 0, v11
    s_nop 0
    s_cmp_eq_u64 vcc, exec
    s_cbranch_scc1 pok_70
    s_sleep 5
    s_add_u32 s53, s53, 1
    s_cmp_lt_u32 s53, s61
    s_cbranch_scc1 poll_69
    s_mov_b32 s61, 0
pok_70:
    s_mov_b64 exec, -1
fok_68:
    s_call_b64 s[76:77], PREP_a_issue_4
    s_add_u32 m0, m0, 1024
    s_add_u32 s39, s39, 229376
    buffer_load_dwordx4 v2, s[12:15], s39 offen sc1 lds
    s_add_u32 m0, m0, 1024
    s_add_u32 s40, s40, 229376
    buffer_load_dwordx4 v2, s[12:15], s40 offen sc1 lds
    s_add_u32 m0, m0, 1024
    s_add_u32 s39, s39, 229376
    buffer_load_dwordx4 v2, s[12:15], s39 offen sc1 lds
    s_add_u32 m0, m0, 1024
    s_add_u32 s40, s40, 229376
    buffer_load_dwordx4 v2, s[12:15], s40 offen sc1 lds
    s_mov_b32 m0, s19
    s_mov_b32 s39, s16
    s_mov_b32 s40, s17
    s_waitcnt vmcnt(8)
    s_barrier
    buffer_load_dwordx4 v2, s[12:15], s39 offen sc1 lds
    s_add_u32 m0, m0, 1024
    s_nop 0
    buffer_load_dwordx4 v2, s[12:15], s40 offen sc1 lds
    s_add_u32 m0, m0, 1024
    s_add_u32 s39, s39, 229376
    buffer_load_dwordx4 v2, s[12:15], s39 offen sc1 lds
    s_add_u32 m0, m0, 1024
    s_add_u32 s40, s40, 229376
    buffer_load_dwordx4 v2, s[12:15], s40 offen sc1 lds
    s_mov_b32 s43, 1
ld_71:
    s_add_u32 s19, s41, s42
    v_readlane_b32 s16, v249, s44
    v_readlane_b32 s17, v250, s44
    s_add_u32 s16, s16, s38
    s_add_u32 s17, s17, s38
    s_add_u32 s44, s44, 1
    s_add_u32 s42, s42, 16384
    s_cmp_eq_u32 s42, 49152
    s_cselect_b32 s42, 0, s42
    s_add_u32 m0, m0, 1024
    s_add_u32 s39, s39, 229376
    buffer_load_dwordx4 v2, s[12:15], s39 offen sc1 lds
    s_add_u32 m0, m0, 1024
    s_add_u32 s40, s40, 229376
    buffer_load_dwordx4 v2, s[12:15], s40 offen sc1 lds
    s_add_u32 m0, m0, 1024
    s_add_u32 s39, s39, 229376
    buffer_load_dwordx4 v2, s[12:15], s39 offen sc1 lds
    s_add_u32 m0, m0, 1024
    s_add_u32 s40, s40, 229376
    buffer_load_dwordx4 v2, s[12:15], s40 offen sc1 lds
    s_mov_b32 m0, s19
    s_mov_b32 s39, s16
    s_mov_b32 s40, s17
    s_waitcnt vmcnt(8)
    s_barrier
    buffer_load_dwordx4 v2, s[12:15], s39 offen sc1 lds
    s_add_u32 m0, m0, 1024
    s_nop 0
    buffer_load_dwordx4 v2, s[12:15], s40 offen sc1 lds
    s_add_u32 m0, m0, 1024
    s_add_u32 s39, s39, 229376
    buffer_load_dwordx4 v2, s[12:15], s39 offen sc1 lds
    s_add_u32 m0, m0, 1024
    s_add_u32 s40, s40, 229376
    buffer_load_dwordx4 v2, s[12:15], s40 offen sc1 lds
    s_add_u32 s43, s43, 1
    s_cmp_lt_u32 s43, 3
    s_cbranch_scc1 ld_71
    s_call_b64 s[76:77], PREP_a_issue_4
    s_add_u32 m0, m0, 1024
    s_add_u32 s39, s39, 229376
    buffer_load_dwordx4 v2, s[12:15], s39 offen sc1 lds
    s_add_u32 m0, m0, 1024
    s_add_u32 s40, s40, 229376
    buffer_load_dwordx4 v2, s[12:15], s40 offen sc1 lds
    s_add_u32 m0, m0, 1024
    s_add_u32 s39, s39, 229376
    buffer_load_dwordx4 v2, s[12:15], s39 offen sc1 lds
    s_add_u32 m0, m0, 1024
    s_add_u32 s40, s40, 229376
    buffer_load_dwordx4 v2, s[12:15], s40 offen sc1 lds
    s_mov_b32 m0, s19
    s_mov_b32 s39, s16
    s_mov_b32 s40, s17
    s_waitcnt vmcnt(8)
    s_barrier
    buffer_load_dwordx4 v2, s[12:15], s39 offen sc1 lds
    s_add_u32 m0, m0, 1024
    s_nop 0
    buffer_load_dwordx4 v2, s[12:15], s40 offen sc1 lds
    s_add_u32 m0, m0, 1024
    s_add_u32 s39, s39, 229376
    buffer_load_dwordx4 v2, s[12:15], s39 offen sc1 lds
    s_add_u32 m0, m0, 1024
    s_add_u32 s40, s40, 229376
    buffer_load_dwordx4 v2, s[12:15], s40 offen sc1 lds
    s_add_u32 m0, m0, 1024
    s_add_u32 s39, s39, 229376
    buffer_load_dwordx4 v2, s[12:15], s39 offen sc1 lds
    s_add_u32 m0, m0, 1024
    s_add_u32 s40, s40, 229376
    buffer_load_dwordx4 v2, s[12:15], s40 offen sc1 lds
    s_add_u32 m0, m0, 1024
    s_add_u32 s39, s39, 229376
    buffer_load_dwordx4 v2, s[12:15], s39 offen sc1 lds
    s_add_u32 m0, m0, 1024
    s_add_u32 s40, s40, 229376
    buffer_load_dwordx4 v2, s[12:15], s40 offen sc1 lds
    s_waitcnt vmcnt(8)
    s_barrier
    s_waitcnt vmcnt(0)
    s_barrier
    s_cmp_eq_u32 s60, 1
    s_cbranch_scc1 K_fin
    s_barrier
    s_and_b32 s36, s30, 1
    s_lshl_b32 s36, s36, 12
    s_add_u32 s36, s36, 32768
    v_add_u32 v6, s36, v2
    ds_write_b128 v6, v[16:19] offset:0
    ds_write_b128 v6, v[20:23] offset:1024
    ds_write_b128 v6, v[24:27] offset:2048
    ds_write_b128 v6, v[28:31] offset:3072
    ds_write_b128 v6, v[32:35] offset:8192
    ds_write_b128 v6, v[36:39] offset:9216
    ds_write_b128 v6, v[40:43] offset:10240
    ds_write_b128 v6, v[44:47] offset:11264
    s_waitcnt lgkmcnt(0)
    s_branch NEXT
WLOAD:
    s_cmp_eq_u32 s60, 1
    s_cbranch_scc1 WL_1
    s_mov_b64 s[12:13], s[68:69]
    s_mov_b32 s14, 2097152
    s_mov_b32 s15, 0x20000
    s_and_b32 s35, s30, 1
    s_mul_i32 s38, s99, 128
    s_mul_i32 s41, s35, 65536
    s_add_u32 s38, s38, s41
    s_mul_i32 s41, s35, 4096
    s_add_u32 s41, s41, 24576
    s_mov_b32 s42, 0
    s_mov_b32 s44, s67
    s_branch WL_2
WL_1:
    s_mov_b64 s[12:13], s[68:69]
    s_mov_b32 s14, 2097152
    s_mov_b32 s15, 0x20000
    s_and_b32 s35, s30, 1
    s_mul_i32 s38, s99, 128
    s_mul_i32 s41, s35, 65536
    s_add_u32 s38, s38, s41
    s_mul_i32 s41, s35, 4096
    s_add_u32 s41, s41, 24576
    s_mov_b32 s42, 0
    s_mov_b32 s44, s67
WL_2:
    s_waitcnt vmcnt(0)
    s_and_b32 s36, s30, 1
    s_lshl_b32 s36, s36, 12
    s_add_u32 s36, s36, 81920
    v_add_u32 v6, s36, v2
    ds_read_b128 v[16:19], v6 offset:16384
    ds_read_b128 v[20:23], v6 offset:17408
    ds_read_b128 v[24:27], v6 offset:18432
    ds_read_b128 v[28:31], v6 offset:19456
    ds_read_b128 v[32:35], v6 offset:24576
    ds_read_b128 v[36:39], v6 offset:25600
    ds_read_b128 v[40:43], v6 offset:26624
    ds_read_b128 v[44:47], v6 offset:27648
    ds_read_b128 v[204:207], v6 offset:0
    ds_read_b128 v[208:211], v6 offset:1024
    ds_read_b128 v[212:215], v6 offset:2048
    ds_read_b128 v[216:219], v6 offset:3072
    s_waitcnt lgkmcnt(0)
    s_barrier
    s_call_b64 s[76:77], SUB_after_g1
    s_barrier
    s_waitcnt vmcnt(0)
    s_barrier
    s_call_b64 s[76:77], SUB_after_g2
    s_mov_b64 s[12:13], s[72:73]
    s_mov_b32 s14, 7340032
    s_mov_b32 s15, 0x20000
    s_and_b32 s35, s30, 1
    s_mul_i32 s38, s29, 448
    s_mul_i32 s41, s35, 229376
    s_add_u32 s38, s38, s41
    s_mul_i32 s41, s35, 14336
    s_add_u32 s41, s41, 73728
    s_mov_b32 s42, 0
    s_mov_b32 s44, 0
    s_mov_b32 s42, 28672
    s_mov_b32 s44, 2
    s_add_u32 s19, s41, s42
    v_readlane_b32 s16, v248, s44
    s_nop 0
    s_add_u32 s16, s16, s38
    s_add_u32 s44, s44, 1
    s_and_b32 s44, s44, 15
    s_add_u32 s42, s42, 28672
    s_cmp_eq_u32 s42, 86016
    s_cselect_b32 s42, 0, s42
    s_mov_b32 m0, s19
    s_mov_b32 s39, s16
    s_waitcnt vmcnt(63)
    s_barrier
    buffer_load_dwordx4 v241, s[12:15], s39 offen lds
    s_add_u32 m0, m0, 1024
    s_nop 0
    buffer_load_dwordx4 v242, s[12:15], s39 offen lds
    s_add_u32 m0, m0, 1024
    s_nop 0
    buffer_load_dwordx4 v243, s[12:15], s39 offen lds
    s_add_u32 m0, m0, 1024
    s_nop 0
    buffer_load_dwordx4 v244, s[12:15], s39 offen lds
    s_add_u32 m0, m0, 1024
    s_nop 0
    buffer_load_dwordx4 v245, s[12:15], s39 offen lds
    s_add_u32 m0, m0, 1024
    s_nop 0
    buffer_load_dwordx4 v246, s[12:15], s39 offen lds
    s_add_u32 m0, m0, 1024
    s_nop 0
    buffer_load_dwordx4 v247, s[12:15], s39 offen lds
    s_mov_b32 s43, 1
ld_72:
    s_add_u32 s19, s41, s42
    v_readlane_b32 s16, v248, s44
    s_nop 0
    s_add_u32 s16, s16, s38
    s_add_u32 s44, s44, 1
    s_and_b32 s44, s44, 15
    s_add_u32 s42, s42, 28672
    s_cmp_eq_u32 s42, 86016
    s_cselect_b32 s42, 0, s42
    s_add_u32 m0, m0, 1024
    s_add_u32 s39, s39, 114688
    buffer_load_dwordx4 v241, s[12:15], s39 offen lds
    s_add_u32 m0, m0, 1024
    s_nop 0
    buffer_load_dwordx4 v242, s[12:15], s39 offen lds
    s_add_u32 m0, m0, 1024
    s_nop 0
    buffer_load_dwordx4 v243, s[12:15], s39 offen lds
    s_add_u32 m0, m0, 1024
    s_nop 0
    buffer_load_dwordx4 v244, s[12:15], s39 offen lds
    s_add_u32 m0, m0, 1024
    s_nop 0
    buffer_load_dwordx4 v245, s[12:15], s39 offen lds
    s_add_u32 m0, m0, 1024
    s_nop 0
    buffer_load_dwordx4 v246, s[12:15], s39 offen lds
    s_add_u32 m0, m0, 1024
    s_nop 0
    buffer_load_dwordx4 v247, s[12:15], s39 offen lds
    s_mov_b32 m0, s19
    s_mov_b32 s39, s16
    s_waitcnt vmcnt(14)
    s_barrier
    buffer_load_dwordx4 v241, s[12:15], s39 offen lds
    s_add_u32 m0, m0, 1024
    s_nop 0
    buffer_load_dwordx4 v242, s[12:15], s39 offen lds
    s_add_u32 m0, m0, 1024
    s_nop 0
    buffer_load_dwordx4 v243, s[12:15], s39 offen lds
    s_add_u32 m0, m0, 1024
    s_nop 0
    buffer_load_dwordx4 v244, s[12:15], s39 offen lds
    s_add_u32 m0, m0, 1024
    s_nop 0
    buffer_load_dwordx4 v245, s[12:15], s39 offen lds
    s_add_u32 m0, m0, 1024
    s_nop 0
    buffer_load_dwordx4 v246, s[12:15], s39 offen lds
    s_add_u32 m0, m0, 1024
    s_nop 0
    buffer_load_dwordx4 v247, s[12:15], s39 offen lds
    s_add_u32 s43, s43, 1
    s_cmp_lt_u32 s43, 13
    s_cbranch_scc1 ld_72
    s_add_u32 s19, s41, s42
    v_readlane_b32 s16, v248, s44
    s_nop 0
    s_add_u32 s16, s16, s38
    s_add_u32 s44, s44, 1
    s_and_b32 s44, s44, 15
    s_add_u32 s42, s42, 28672
    s_cmp_eq_u32 s42, 86016
    s_cselect_b32 s42, 0, s42
    s_add_u32 m0, m0, 1024
    s_add_u32 s39, s39, 114688
    buffer_load_dwordx4 v241, s[12:15], s39 offen lds
    s_add_u32 m0, m0, 1024
    s_nop 0
    buffer_load_dwordx4 v242, s[12:15], s39 offen lds
    s_add_u32 m0, m0, 1024
    s_nop 0
    buffer_load_dwordx4 v243, s[12:15], s39 offen lds
    s_add_u32 m0, m0, 1024
    s_nop 0
    buffer_load_dwordx4 v244, s[12:15], s39 offen lds
    s_add_u32 m0, m0, 1024
    s_nop 0
    buffer_load_dwordx4 v245, s[12:15], s39 offen lds
    s_add_u32 m0, m0, 1024
    s_nop 0
    buffer_load_dwordx4 v246, s[12:15], s39 offen lds
    s_add_u32 m0, m0, 1024
    s_nop 0
    buffer_load_dwordx4 v247, s[12:15], s39 offen lds
    s_mov_b32 m0, s19
    s_mov_b32 s39, s16
    s_waitcnt vmcnt(14)
    s_barrier
    buffer_load_dwordx4 v241, s[12:15], s39 offen lds
    s_add_u32 m0, m0, 1024
    s_nop 0
    buffer_load_dwordx4 v242, s[12:15], s39 offen lds
    s_add_u32 m0, m0, 1024
    s_nop 0
    buffer_load_dwordx4 v243, s[12:15], s39 offen lds
    s_add_u32 m0, m0, 1024
    s_nop 0
    buffer_load_dwordx4 v244, s[12:15], s39 offen lds
    s_add_u32 m0, m0, 1024
    s_nop 0
    buffer_load_dwordx4 v245, s[12:15], s39 offen lds
    s_add_u32 m0, m0, 1024
    s_nop 0
    buffer_load_dwordx4 v246, s[12:15], s39 offen lds
    s_add_u32 m0, m0, 1024
    s_nop 0
    buffer_load_dwordx4 v247, s[12:15], s39 offen lds
    s_add_u32 m0, m0, 1024
    s_add_u32 s39, s39, 114688
    buffer_load_dwordx4 v241, s[12:15], s39 offen lds
    s_add_u32 m0, m0, 1024
    s_nop 0
    buffer_load_dwordx4 v242, s[12:15], s39 offen lds
    s_add_u32 m0, m0, 1024
    s_nop 0
    buffer_load_dwordx4 v243, s[12:15], s39 offen lds
    s_add_u32 m0, m0, 1024
    s_nop 0
    buffer_load_dwordx4 v244, s[12:15], s39 offen lds
    s_add_u32 m0, m0, 1024
    s_nop 0
    buffer_load_dwordx4 v245, s[12:15], s39 offen lds
    s_add_u32 m0, m0, 1024
    s_nop 0
    buffer_load_dwordx4 v246, s[12:15], s39 offen lds
    s_add_u32 m0, m0, 1024
    s_nop 0
    buffer_load_dwordx4 v247, s[12:15], s39 offen lds
    s_waitcnt vmcnt(14)
    s_barrier
    s_call_b64 s[76:77], SUB_r_pre0
    s_waitcnt vmcnt(4)
    s_barrier
    s_barrier
    s_mov_b64 s[12:13], s[74:75]
    s_mov_b32 s14, 7340032
    s_mov_b32 s15, 0x20000
    s_and_b32 s35, s30, 1
    s_mul_i32 s38, s33, 256
    s_mul_i32 s41, s31, 3670016
    s_add_u32 s38, s38, s41
    s_mul_i32 s41, s35, 8192
    s_add_u32 s41, s41, 49152
    s_mov_b32 s42, 0
    s_mov_b32 s44, 0
    s_mov_b32 s49, s44
    s_and_b32 s43, s28, 3
    s_mul_i32 s43, s43, 6
    s_lshr_b32 s43, s43, 2
    s_mov_b32 s50, 0
wpre_73:
    s_mul_i32 s42, s43, 16384
    s_add_u32 s44, s49, s43
    s_mov_b32 s45, 8192
    s_add_u32 s19, s41, s42
    v_readlane_b32 s16, v249, s44
    s_nop 0
    s_bitcmp1_b32 s16, 0
    s_cselect_b32 s17, 16384, s45
    s_cselect_b32 s18, -40960, s45
    s_andn2_b32 s16, s16, 1
    s_add_u32 s16, s16, s38
    s_add_u32 s44, s44, 1
    s_add_u32 s42, s42, 16384
    s_cmp_eq_u32 s42, 98304
    s_cselect_b32 s42, 0, s42
    s_mov_b32 m0, s19
    s_mov_b32 s39, s16
    s_mov_b32 s32, s17
    s_mov_b32 s3, s18
    buffer_load_dwordx4 v239, s[12:15], s39 offen lds
    s_add_u32 m0, m0, 1024
    s_add_u32 s39, s39, s32
    buffer_load_dwordx4 v240, s[12:15], s39 offen lds
    s_add_u32 m0, m0, 1024
    s_add_u32 s39, s39, s32
    buffer_load_dwordx4 v239, s[12:15], s39 offen lds
    s_add_u32 m0, m0, 1024
    s_add_u32 s39, s39, s32
    buffer_load_dwordx4 v240, s[12:15], s39 offen lds
    s_waitcnt vmcnt(8)
    s_add_u32 m0, m0, 1024
    s_add_u32 s39, s39, s3
    buffer_load_dwordx4 v239, s[12:15], s39 offen lds
    s_add_u32 m0, m0, 1024
    s_add_u32 s39, s39, s32
    buffer_load_dwordx4 v240, s[12:15], s39 offen lds
    s_add_u32 m0, m0, 1024
    s_add_u32 s39, s39, s32
    buffer_load_dwordx4 v239, s[12:15], s39 offen lds
    s_add_u32 m0, m0, 1024
    s_add_u32 s39, s39, s32
    buffer_load_dwordx4 v240, s[12:15], s39 offen lds
    s_waitcnt vmcnt(8)
    s_add_u32 s43, s43, 1
    s_cmp_eq_u32 s43, 6
    s_cselect_b32 s43, 0, s43
    s_add_u32 s50, s50, 1
    s_cmp_lt_u32 s50, 6
    s_cbranch_scc1 wpre_73
    s_mov_b32 s42, 0
    s_add_u32 s44, s49, 6
    s_cmp_eq_u32 s60, 1
    s_cbranch_scc1 WL_t1
    s_call_b64 s[76:77], PREP_w_issue_4
    s_mov_b32 m0, s19
    s_mov_b32 s39, s16
    s_mov_b32 s32, s17
    s_mov_b32 s3, s18
    s_waitcnt vmcnt(0)
    s_barrier
    s_waitcnt vmcnt(0)
    s_barrier
    buffer_load_dwordx4 v239, s[12:15], s39 offen lds
    s_add_u32 m0, m0, 1024
    s_add_u32 s39, s39, s32
    buffer_load_dwordx4 v240, s[12:15], s39 offen lds
    s_add_u32 m0, m0, 1024
    s_add_u32 s39, s39, s32
    buffer_load_dwordx4 v239, s[12:15], s39 offen lds
    s_add_u32 m0, m0, 1024
    s_add_u32 s39, s39, s32
    buffer_load_dwordx4 v240, s[12:15], s39 offen lds
    s_call_b64 s[76:77], PREP_w_issue_4
    s_add_u32 m0, m0, 1024
    s_add_u32 s39, s39, s3
    buffer_load_dwordx4 v239, s[12:15], s39 offen lds
    s_add_u32 m0, m0, 1024
    s_add_u32 s39, s39, s32
    buffer_load_dwordx4 v240, s[12:15], s39 offen lds
    s_add_u32 m0, m0, 1024
    s_add_u32 s39, s39, s32
    buffer_load_dwordx4 v239, s[12:15], s39 offen lds
    s_add_u32 m0, m0, 1024
    s_add_u32 s39, s39, s32
    buffer_load_dwordx4 v240, s[12:15], s39 offen lds
    s_mov_b32 m0, s19
    s_mov_b32 s39, s16
    s_mov_b32 s32, s17
    s_mov_b32 s3, s18
    s_waitcnt vmcnt(8)
    s_barrier
    buffer_load_dwordx4 v239, s[12:15], s39 offen lds
    s_add_u32 m0, m0, 1024
    s_add_u32 s39, s39, s32
    buffer_load_dwordx4 v240, s[12:15], s39 offen lds
    s_add_u32 m0, m0, 1024
    s_add_u32 s39, s39, s32
    buffer_load_dwordx4 v239, s[12:15], s39 offen lds
    s_add_u32 m0, m0, 1024
    s_add_u32 s39, s39, s32
    buffer_load_dwordx4 v240, s[12:15], s39 offen lds
    s_call_b64 s[76:77], PREP_w_issue_4
    s_add_u32 m0, m0, 1024
    s_add_u32 s39, s39, s3
    buffer_load_dwordx4 v239, s[12:15], s39 offen lds
    s_add_u32 m0, m0, 1024
    s_add_u32 s39, s39, s32
    buffer_load_dwordx4 v240, s[12:15], s39 offen lds
    s_add_u32 m0, m0, 1024
    s_add_u32 s39, s39, s32
    buffer_load_dwordx4 v239, s[12:15], s39 offen lds
    s_add_u32 m0, m0, 1024
    s_add_u32 s39, s39, s32
    buffer_load_dwordx4 v240, s[12:15], s39 offen lds
    s_mov_b32 m0, s19
    s_mov_b32 s39, s16
    s_mov_b32 s32, s17
    s_mov_b32 s3, s18
    s_waitcnt vmcnt(16)
    s_barrier
    buffer_load_dwordx4 v239, s[12:15], s39 offen lds
    s_add_u32 m0, m0, 1024
    s_add_u32 s39, s39, s32
    buffer_load_dwordx4 v240, s[12:15], s39 offen lds
    s_add_u32 m0, m0, 1024
    s_add_u32 s39, s39, s32
    buffer_load_dwordx4 v239, s[12:15], s39 offen lds
    s_add_u32 m0, m0, 1024
    s_add_u32 s39, s39, s32
    buffer_load_dwordx4 v240, s[12:15], s39 offen lds
    s_call_b64 s[76:77], PREP_w_issue_4
    s_add_u32 m0, m0, 1024
    s_add_u32 s39, s39, s3
    buffer_load_dwordx4 v239, s[12:15], s39 offen lds
    s_add_u32 m0, m0, 1024
    s_add_u32 s39, s39, s32
    buffer_load_dwordx4 v240, s[12:15], s39 offen lds
    s_add_u32 m0, m0, 1024
    s_add_u32 s39, s39, s32
    buffer_load_dwordx4 v239, s[12:15], s39 offen lds
    s_add_u32 m0, m0, 1024
    s_add_u32 s39, s39, s32
    buffer_load_dwordx4 v240, s[12:15], s39 offen lds
    s_mov_b32 m0, s19
    s_mov_b32 s39, s16
    s_mov_b32 s32, s17
    s_mov_b32 s3, s18
    s_waitcnt vmcnt(24)
    s_barrier
    buffer_load_dwordx4 v239, s[12:15], s39 offen lds
    s_add_u32 m0, m0, 1024
    s_add_u32 s39, s39, s32
    buffer_load_dwordx4 v240, s[12:15], s39 offen lds
    s_add_u32 m0, m0, 1024
    s_add_u32 s39, s39, s32
    buffer_load_dwordx4 v239, s[12:15], s39 offen lds
    s_add_u32 m0, m0, 1024
    s_add_u32 s39, s39, s32
    buffer_load_dwordx4 v240, s[12:15], s39 offen lds
    s_mov_b32 s43, 1
ld_74:
    s_mov_b32 s45, 8192
    s_add_u32 s19, s41, s42
    v_readlane_b32 s16, v249, s44
    s_nop 0
    s_bitcmp1_b32 s16, 0
    s_cselect_b32 s17, 16384, s45
    s_cselect_b32 s18, -40960, s45
    s_andn2_b32 s16, s16, 1
    s_add_u32 s16, s16, s38
    s_add_u32 s44, s44, 1
    s_add_u32 s42, s42, 16384
    s_cmp_eq_u32 s42, 98304
    s_cselect_b32 s42, 0, s42
    s_add_u32 m0, m0, 1024
    s_add_u32 s39, s39, s3
    buffer_load_dwordx4 v239, s[12:15], s39 offen lds
    s_add_u32 m0, m0, 1024
    s_add_u32 s39, s39, s32
    buffer_load_dwordx4 v240, s[12:15], s39 offen lds
    s_add_u32 m0, m0, 1024
    s_add_u32 s39, s39, s32
    buffer_load_dwordx4 v239, s[12:15], s39 offen lds
    s_add_u32 m0, m0, 1024
    s_add_u32 s39, s39, s32
    buffer_load_dwordx4 v240, s[12:15], s39 offen lds
    s_mov_b32 m0, s19
    s_mov_b32 s39, s16
    s_mov_b32 s32, s17
    s_mov_b32 s3, s18
    s_waitcnt vmcnt(32)
    s_barrier
    buffer_load_dwordx4 v239, s[12:15], s39 offen lds
    s_add_u32 m0, m0, 1024
    s_add_u32 s39, s39, s32
    buffer_load_dwordx4 v240, s[12:15], s39 offen lds
    s_add_u32 m0, m0, 1024
    s_add_u32 s39, s39, s32
    buffer_load_dwordx4 v239, s[12:15], s39 offen lds
    s_add_u32 m0, m0, 1024
    s_add_u32 s39, s39, s32
    buffer_load_dwordx4 v240, s[12:15], s39 offen lds
    s_add_u32 s43, s43, 1
    s_cmp_lt_u32 s43, 18
    s_cbranch_scc1 ld_74
    s_call_b64 s[76:77], PREP_w_issue_4
    s_add_u32 m0, m0, 1024
    s_add_u32 s39, s39, s3
    buffer_load_dwordx4 v239, s[12:15], s39 offen lds
    s_add_u32 m0, m0, 1024
    s_add_u32 s39, s39, s32
    buffer_load_dwordx4 v240, s[12:15], s39 offen lds
    s_add_u32 m0, m0, 1024
    s_add_u32 s39, s39, s32
    buffer_load_dwordx4 v239, s[12:15], s39 offen lds
    s_add_u32 m0, m0, 1024
    s_add_u32 s39, s39, s32
    buffer_load_dwordx4 v240, s[12:15], s39 offen lds
    s_mov_b32 m0, s19
    s_mov_b32 s39, s16
    s_mov_b32 s32, s17
    s_mov_b32 s3, s18
    s_waitcnt vmcnt(32)
    s_barrier
    buffer_load_dwordx4 v239, s[12:15], s39 offen lds
    s_add_u32 m0, m0, 1024
    s_add_u32 s39, s39, s32
    buffer_load_dwordx4 v240, s[12:15], s39 offen lds
    s_add_u32 m0, m0, 1024
    s_add_u32 s39, s39, s32
    buffer_load_dwordx4 v239, s[12:15], s39 offen lds
    s_add_u32 m0, m0, 1024
    s_add_u32 s39, s39, s32
    buffer_load_dwordx4 v240, s[12:15], s39 offen lds
    s_add_u32 m0, m0, 1024
    s_add_u32 s39, s39, s3
    buffer_load_dwordx4 v239, s[12:15], s39 offen lds
    s_add_u32 m0, m0, 1024
    s_add_u32 s39, s39, s32
    buffer_load_dwordx4 v240, s[12:15], s39 offen lds
    s_add_u32 m0, m0, 1024
    s_add_u32 s39, s39, s32
    buffer_load_dwordx4 v239, s[12:15], s39 offen lds
    s_add_u32 m0, m0, 1024
    s_add_u32 s39, s39, s32
    buffer_load_dwordx4 v240, s[12:15], s39 offen lds
    s_waitcnt vmcnt(32)
    s_barrier
    s_mov_b64 s[12:13], s[68:69]
    s_mov_b32 s14, 2097152
    s_mov_b32 s15, 0x20000
    s_and_b32 s35, s30, 1
    s_mul_i32 s38, s99, 128
    s_mul_i32 s41, s35, 65536
    s_add_u32 s38, s38, s41
    s_mul_i32 s41, s35, 4096
    s_add_u32 s41, s41, 24576
    s_mov_b32 s42, 0
    s_mov_b32 s44, s67
    s_and_b32 s36, s99, 7
    s_cmp_eq_u32 s36, 3
    s_cselect_b64 s[50:51], 0, -1
    s_mov_b32 s42, 90112
    s_mov_b32 s44, s67
    s_add_u32 s44, s44, 11
    s_and_b32 s44, s44, 15
    s_call_b64 s[76:77], SUB_w_issue_1
    s_mov_b32 s42, 98304
    s_mov_b32 s44, s67
    s_add_u32 s44, s44, 12
    s_and_b32 s44, s44, 15
    s_call_b64 s[76:77], SUB_w_issue_1
    s_waitcnt vmcnt(32)
    s_barrier
    s_mov_b32 s42, 106496
    s_mov_b32 s44, s67
    s_add_u32 s44, s44, 13
    s_and_b32 s44, s44, 15
    s_call_b64 s[76:77], SUB_w_issue_1
    s_mov_b32 s42, 114688
    s_mov_b32 s44, s67
    s_add_u32 s44, s44, 14
    s_and_b32 s44, s44, 15
    s_call_b64 s[76:77], SUB_w_issue_1
    s_waitcnt vmcnt(32)
    s_barrier
    s_mov_b32 s42, 24576
    s_mov_b32 s44, s67
    s_add_u32 s44, s44, 3
    s_and_b32 s44, s44, 15
    s_call_b64 s[76:77], SUB_w_issue_1
    s_mov_b32 s42, 32768
    s_mov_b32 s44, s67
    s_add_u32 s44, s44, 4
    s_and_b32 s44, s44, 15
    s_call_b64 s[76:77], SUB_w_issue_1
    s_waitcnt vmcnt(32)
    s_barrier
    s_mov_b32 s42, 40960
    s_mov_b32 s44, s67
    s_add_u32 s44, s44, 5
    s_and_b32 s44, s44, 15
    s_call_b64 s[76:77], SUB_w_issue_1
    s_mov_b32 s42, 49152
    s_mov_b32 s44, s67
    s_add_u32 s44, s44, 6
    s_and_b32 s44, s44, 15
    s_call_b64 s[76:77], SUB_w_issue_1
    s_mov_b32 s42, 0
    s_mov_b32 s44, s67
    s_add_u32 s44, s44, 0
    s_and_b32 s44, s44, 15
    s_call_b64 s[76:77], SUB_w_issue_1
    s_waitcnt vmcnt(36)
    s_barrier
    s_mov_b32 s42, 65536
    s_mov_b32 s44, s67
    s_add_u32 s44, s44, 8
    s_and_b32 s44, s44, 15
    s_call_b64 s[76:77], SUB_w_issue_1
    s_mov_b32 s42, 122880
    s_mov_b32 s44, s67
    s_add_u32 s44, s44, 15
    s_and_b32 s44, s44, 15
    s_call_b64 s[76:77], SUB_w_issue_1
    s_add_u32 s36, s41, 57344
    v_add_u32 v6, s36, v2
    s_barrier
    s_add_u32 s36, s41, 57344
    v_add_u32 v6, s36, v2
    ds_write_b128 v6, v[16:19] offset:16384
    ds_write_b128 v6, v[20:23] offset:17408
    ds_write_b128 v6, v[24:27] offset:18432
    ds_write_b128 v6, v[28:31] offset:19456
    ds_write_b128 v6, v[32:35] offset:24576
    ds_write_b128 v6, v[36:39] offset:25600
    ds_write_b128 v6, v[40:43] offset:26624
    ds_write_b128 v6, v[44:47] offset:27648
    ds_write_b128 v6, v[204:207] offset:0
    ds_write_b128 v6, v[208:211] offset:1024
    ds_write_b128 v6, v[212:215] offset:2048
    ds_write_b128 v6, v[216:219] offset:3072
    s_waitcnt lgkmcnt(0)
    s_branch NEXT
WL_t1:
    s_call_b64 s[76:77], PREP_w_issue_4
    s_mov_b32 m0, s19
    s_mov_b32 s39, s16
    s_mov_b32 s32, s17
    s_mov_b32 s3, s18
    s_waitcnt vmcnt(0)
    s_barrier
    s_waitcnt vmcnt(0)
    s_barrier
    s_waitcnt vmcnt(0)
    s_barrier
    s_waitcnt vmcnt(0)
    s_barrier
    s_waitcnt vmcnt(0)
    s_barrier
    buffer_load_dwordx4 v239, s[12:15], s39 offen lds
    s_add_u32 m0, m0, 1024
    s_add_u32 s39, s39, s32
    buffer_load_dwordx4 v240, s[12:15], s39 offen lds
    s_add_u32 m0, m0, 1024
    s_add_u32 s39, s39, s32
    buffer_load_dwordx4 v239, s[12:15], s39 offen lds
    s_add_u32 m0, m0, 1024
    s_add_u32 s39, s39, s32
    buffer_load_dwordx4 v240, s[12:15], s39 offen lds
    s_mov_b32 s43, 1
ld_75:
    s_mov_b32 s45, 8192
    s_add_u32 s19, s41, s42
    v_readlane_b32 s16, v249, s44
    s_nop 0
    s_bitcmp1_b32 s16, 0
    s_cselect_b32 s17, 16384, s45
    s_cselect_b32 s18, -40960, s45
    s_andn2_b32 s16, s16, 1
    s_add_u32 s16, s16, s38
    s_add_u32 s44, s44, 1
    s_add_u32 s42, s42, 16384
    s_cmp_eq_u32 s42, 98304
    s_cselect_b32 s42, 0, s42
    s_add_u32 m0, m0, 1024
    s_add_u32 s39, s39, s3
    buffer_load_dwordx4 v239, s[12:15], s39 offen lds
    s_add_u32 m0, m0, 1024
    s_add_u32 s39, s39, s32
    buffer_load_dwordx4 v240, s[12:15], s39 offen lds
    s_add_u32 m0, m0, 1024
    s_add_u32 s39, s39, s32
    buffer_load_dwordx4 v239, s[12:15], s39 offen lds
    s_add_u32 m0, m0, 1024
    s_add_u32 s39, s39, s32
    buffer_load_dwordx4 v240, s[12:15], s39 offen lds
    s_mov_b32 m0, s19
    s_mov_b32 s39, s16
    s_mov_b32 s32, s17
    s_mov_b32 s3, s18
    s_waitcnt vmcnt(8)
    s_barrier
    buffer_load_dwordx4 v239, s[12:15], s39 offen lds
    s_add_u32 m0, m0, 1024
    s_add_u32 s39, s39, s32
    buffer_load_dwordx4 v240, s[12:15], s39 offen lds
    s_add_u32 m0, m0, 1024
    s_add_u32 s39, s39, s32
    buffer_load_dwordx4 v239, s[12:15], s39 offen lds
    s_add_u32 m0, m0, 1024
    s_add_u32 s39, s39, s32
    buffer_load_dwordx4 v240, s[12:15], s39 offen lds
    s_add_u32 s43, s43, 1
    s_cmp_lt_u32 s43, 21
    s_cbranch_scc1 ld_75
    s_call_b64 s[76:77], PREP_w_issue_4
    s_add_u32 m0, m0, 1024
    s_add_u32 s39, s39, s3
    buffer_load_dwordx4 v239, s[12:15], s39 offen lds
    s_add_u32 m0, m0, 1024
    s_add_u32 s39, s39, s32
    buffer_load_dwordx4 v240, s[12:15], s39 offen lds
    s_add_u32 m0, m0, 1024
    s_add_u32 s39, s39, s32
    buffer_load_dwordx4 v239, s[12:15], s39 offen lds
    s_add_u32 m0, m0, 1024
    s_add_u32 s39, s39, s32
    buffer_load_dwordx4 v240, s[12:15], s39 offen lds
    s_mov_b32 m0, s19
    s_mov_b32 s39, s16
    s_mov_b32 s32, s17
    s_mov_b32 s3, s18
    s_waitcnt vmcnt(8)
    s_barrier
    buffer_load_dwordx4 v239, s[12:15], s39 offen lds
    s_add_u32 m0, m0, 1024
    s_add_u32 s39, s39, s32
    buffer_load_dwordx4 v240, s[12:15], s39 offen lds
    s_add_u32 m0, m0, 1024
    s_add_u32 s39, s39, s32
    buffer_load_dwordx4 v239, s[12:15], s39 offen lds
    s_add_u32 m0, m0, 1024
    s_add_u32 s39, s39, s32
    buffer_load_dwordx4 v240, s[12:15], s39 offen lds
    s_add_u32 m0, m0, 1024
    s_add_u32 s39, s39, s3
    buffer_load_dwordx4 v239, s[12:15], s39 offen lds
    s_add_u32 m0, m0, 1024
    s_add_u32 s39, s39, s32
    buffer_load_dwordx4 v240, s[12:15], s39 offen lds
    s_add_u32 m0, m0, 1024
    s_add_u32 s39, s39, s32
    buffer_load_dwordx4 v239, s[12:15], s39 offen lds
    s_add_u32 m0, m0, 1024
    s_add_u32 s39, s39, s32
    buffer_load_dwordx4 v240, s[12:15], s39 offen lds
    s_waitcnt vmcnt(8)
    s_barrier
    s_waitcnt vmcnt(0)
    s_barrier
    s_branch K_fin
NEXT:
    s_setprio 0
    s_add_u32 s60, s60, 1
    s_add_u32 s55, s55, 4194304
    s_add_u32 s62, s62, 4194304
    s_addc_u32 s63, s63, 0
    s_branch LAYER
K_fin:
    s_endpgm
SUB_w1_regs:
    s_mov_b64 s[12:13], s[68:69]
    s_mov_b32 s14, 2097152
    s_mov_b32 s15, 0x20000
    s_and_b32 s35, s30, 3
    s_mul_i32 s35, s35, 294912
    s_lshl_b32 s39, s99, 7
    s_add_u32 s39, s39, s35
    buffer_load_dwordx4 v[176:179], v238, s[12:15], s39 offen
    s_add_u32 s39, s39, 16384
    buffer_load_dwordx4 v[188:191], v238, s[12:15], s39 offen
    s_add_u32 s39, s39, 16384
    buffer_load_dwordx4 v[192:195], v238, s[12:15], s39 offen
    s_add_u32 s39, s39, 16384
    buffer_load_dwordx4 v[200:203], v238, s[12:15], s39 offen
    s_add_u32 s39, s39, 16384
    s_waitcnt vmcnt(8)
    buffer_load_dwordx4 v[204:207], v238, s[12:15], s39 offen
    s_add_u32 s39, s39, 16384
    buffer_load_dwordx4 v[208:211], v238, s[12:15], s39 offen
    s_add_u32 s39, s39, 16384
    buffer_load_dwordx4 v[212:215], v238, s[12:15], s39 offen
    s_add_u32 s39, s39, 16384
    buffer_load_dwordx4 v[216:219], v238, s[12:15], s39 offen
    s_add_u32 s39, s39, 16384
    s_waitcnt vmcnt(8)
    buffer_load_dwordx4 v[220:223], v238, s[12:15], s39 offen
    s_add_u32 s39, s39, 16384
    buffer_load_dwordx4 v[224:227], v238, s[12:15], s39 offen
    s_add_u32 s39, s39, 16384
    buffer_load_dwordx4 v[16:19], v238, s[12:15], s39 offen
    s_add_u32 s39, s39, 16384
    buffer_load_dwordx4 v[20:23], v238, s[12:15], s39 offen
    s_add_u32 s39, s39, 16384
    s_waitcnt vmcnt(8)
    buffer_load_dwordx4 v[24:27], v238, s[12:15], s39 offen
    s_add_u32 s39, s39, 16384
    buffer_load_dwordx4 v[28:31], v238, s[12:15], s39 offen
    s_add_u32 s39, s39, 16384
    buffer_load_dwordx4 v[32:35], v238, s[12:15], s39 offen
    s_add_u32 s39, s39, 16384
    buffer_load_dwordx4 v[36:39], v238, s[12:15], s39 offen
    s_add_u32 s39, s39, 16384
    s_waitcnt vmcnt(8)
    buffer_load_dwordx4 v[40:43], v238, s[12:15], s39 offen
    s_add_u32 s39, s39, 16384
    buffer_load_dwordx4 v[44:47], v238, s[12:15], s39 offen
    s_add_u32 s39, s39, 16384
    s_setpc_b64 s[76:77]
SUB_park:
    s_mov_b64 s[12:13], s[70:71]
    s_mov_b32 s14, 2097152
    s_mov_b32 s15, 0x20000
    s_and_b32 s35, s30, 3
    s_lshl_b32 s35, s35, 19
    s_lshl_b32 s39, s29, 7
    s_add_u32 s39, s39, s35
    buffer_load_dwordx4 v[48:51], v238, s[12:15], s39 offen
    s_add_u32 s39, s39, 16384
    buffer_load_dwordx4 v[52:55], v238, s[12:15], s39 offen
    s_add_u32 s39, s39, 16384
    buffer_load_dwordx4 v[56:59], v238, s[12:15], s39 offen
    s_add_u32 s39, s39, 16384
    buffer_load_dwordx4 v[60:63], v238, s[12:15], s39 offen
    s_add_u32 s39, s39, 16384
    s_waitcnt vmcnt(8)
    buffer_load_dwordx4 v[64:67], v238, s[12:15], s39 offen
    s_add_u32 s39, s39, 16384
    buffer_load_dwordx4 v[68:71], v238, s[12:15], s39 offen
    s_add_u32 s39, s39, 16384
    buffer_load_dwordx4 v[72:75], v238, s[12:15], s39 offen
    s_add_u32 s39, s39, 16384
    buffer_load_dwordx4 v[76:79], v238, s[12:15], s39 offen
    s_add_u32 s39, s39, 16384
    s_waitcnt vmcnt(8)
    buffer_load_dwordx4 v[80:83], v238, s[12:15], s39 offen
    s_add_u32 s39, s39, 16384
    buffer_load_dwordx4 v[84:87], v238, s[12:15], s39 offen
    s_add_u32 s39, s39, 16384
    buffer_load_dwordx4 v[88:91], v238, s[12:15], s39 offen
    s_add_u32 s39, s39, 16384
    buffer_load_dwordx4 v[92:95], v238, s[12:15], s39 offen
    s_add_u32 s39, s39, 16384
    s_waitcnt vmcnt(8)
    buffer_load_dwordx4 v[96:99], v238, s[12:15], s39 offen
    s_add_u32 s39, s39, 16384
    buffer_load_dwordx4 v[100:103], v238, s[12:15], s39 offen
    s_add_u32 s39, s39, 16384
    buffer_load_dwordx4 v[104:107], v238, s[12:15], s39 offen
    s_add_u32 s39, s39, 16384
    buffer_load_dwordx4 v[108:111], v238, s[12:15], s39 offen
    s_add_u32 s39, s39, 16384
    s_waitcnt vmcnt(8)
    buffer_load_dwordx4 v[112:115], v238, s[12:15], s39 offen
    s_add_u32 s39, s39, 16384
    buffer_load_dwordx4 v[116:119], v238, s[12:15], s39 offen
    s_add_u32 s39, s39, 16384
    buffer_load_dwordx4 v[120:123], v238, s[12:15], s39 offen
    s_add_u32 s39, s39, 16384
    buffer_load_dwordx4 v[124:127], v238, s[12:15], s39 offen
    s_add_u32 s39, s39, 16384
    s_waitcnt vmcnt(8)
    buffer_load_dwordx4 v[128:131], v238, s[12:15], s39 offen
    s_add_u32 s39, s39, 16384
    buffer_load_dwordx4 v[132:135], v238, s[12:15], s39 offen
    s_add_u32 s39, s39, 16384
    buffer_load_dwordx4 v[136:139], v238, s[12:15], s39 offen
    s_add_u32 s39, s39, 16384
    buffer_load_dwordx4 v[140:143], v238, s[12:15], s39 offen
    s_add_u32 s39, s39, 16384
    s_waitcnt vmcnt(8)
    s_setpc_b64 s[76:77]
SUB_park2:
    s_mov_b64 s[12:13], s[70:71]
    s_mov_b32 s14, 2097152
    s_mov_b32 s15, 0x20000
    s_and_b32 s35, s30, 3
    s_lshl_b32 s35, s35, 19
    s_lshl_b32 s39, s29, 7
    s_add_u32 s39, s39, s35
    s_add_u32 s39, s39, 393216
    buffer_load_dwordx4 v[144:147], v238, s[12:15], s39 offen
    s_add_u32 s39, s39, 16384
    buffer_load_dwordx4 v[148:151], v238, s[12:15], s39 offen
    s_add_u32 s39, s39, 16384
    buffer_load_dwordx4 v[152:155], v238, s[12:15], s39 offen
    s_add_u32 s39, s39, 16384
    buffer_load_dwordx4 v[156:159], v238, s[12:15], s39 offen
    s_add_u32 s39, s39, 16384
    s_waitcnt vmcnt(8)
    buffer_load_dwordx4 v[160:163], v238, s[12:15], s39 offen
    s_add_u32 s39, s39, 16384
    buffer_load_dwordx4 v[164:167], v238, s[12:15], s39 offen
    s_add_u32 s39, s39, 16384
    buffer_load_dwordx4 v[168:171], v238, s[12:15], s39 offen
    s_add_u32 s39, s39, 16384
    buffer_load_dwordx4 v[172:175], v238, s[12:15], s39 offen
    s_add_u32 s39, s39, 16384
    s_waitcnt vmcnt(8)
    s_setpc_b64 s[76:77]
SUB_w1_put:
    s_and_b32 s35, s30, 3
    s_mul_i32 s35, s35, 18432
    v_add_u32 v8, s35, v2
    v_mov_b32 v6, 162836
spin_76:
    s_sleep 2
    ds_read_b32 v7, v6
    s_waitcnt lgkmcnt(0)
    v_readfirstlane_b32 s53, v7
    s_nop 0
    s_cmp_ge_u32 s53, 8
    s_cbranch_scc0 spin_76
    s_waitcnt vmcnt(24)
    ds_write_b128 v8, v[176:179] offset:24576
    ds_write_b128 v8, v[188:191] offset:25600
    ds_write_b128 v8, v[192:195] offset:26624
    ds_write_b128 v8, v[200:203] offset:27648
    ds_write_b128 v8, v[204:207] offset:28672
    ds_write_b128 v8, v[208:211] offset:29696
    ds_write_b128 v8, v[212:215] offset:30720
    ds_write_b128 v8, v[216:219] offset:31744
    ds_write_b128 v8, v[220:223] offset:32768
    ds_write_b128 v8, v[224:227] offset:33792
    ds_write_b128 v8, v[16:19] offset:34816
    ds_write_b128 v8, v[20:23] offset:35840
    ds_write_b128 v8, v[24:27] offset:36864
    ds_write_b128 v8, v[28:31] offset:37888
    ds_write_b128 v8, v[32:35] offset:38912
    ds_write_b128 v8, v[36:39] offset:39936
    ds_write_b128 v8, v[40:43] offset:40960
    ds_write_b128 v8, v[44:47] offset:41984
    s_waitcnt lgkmcnt(0)
    s_setpc_b64 s[76:77]
SUB_after_g1:
    s_mov_b64 s[12:13], s[72:73]
    s_mov_b32 s14, 7340032
    s_mov_b32 s15, 0x20000
    v_readlane_b32 s36, v251, 0
    v_readlane_b32 s37, v251, 1
    v_readlane_b32 s34, v251, 2
    s_and_b32 s35, s30, 3
    s_mul_i32 s38, s35, 114688
    s_mul_i32 s39, s29, 448
    s_add_u32 s38, s38, s39
    s_and_b32 s36, s36, 15
    s_mul_i32 s36, s36, 458752
    s_add_u32 s36, s36, s38
    s_and_b32 s37, s37, 15
    s_mul_i32 s37, s37, 458752
    s_add_u32 s37, s37, s38
    s_and_b32 s34, s34, 15
    s_mul_i32 s34, s34, 458752
    s_add_u32 s34, s34, s38
    s_mul_i32 s39, s35, 7168
    s_add_u32 m0, s39, 131072
    s_nop 0
    buffer_load_dwordx4 v241, s[12:15], s36 offen lds
    s_add_u32 m0, m0, 1024
    s_nop 0
    buffer_load_dwordx4 v242, s[12:15], s36 offen lds
    s_add_u32 m0, m0, 1024
    s_nop 0
    buffer_load_dwordx4 v243, s[12:15], s36 offen lds
    s_add_u32 m0, m0, 1024
    s_nop 0
    buffer_load_dwordx4 v244, s[12:15], s36 offen lds
    s_add_u32 m0, m0, 1024
    s_nop 0
    buffer_load_dwordx4 v245, s[12:15], s36 offen lds
    s_add_u32 m0, m0, 1024
    s_nop 0
    buffer_load_dwordx4 v246, s[12:15], s36 offen lds
    s_add_u32 m0, m0, 1024
    s_nop 0
    buffer_load_dwordx4 v247, s[12:15], s36 offen lds
    buffer_load_dwordx4 v[176:179], v241, s[12:15], s37 offen
    buffer_load_dwordx4 v[180:183], v242, s[12:15], s37 offen
    buffer_load_dwordx4 v[184:187], v243, s[12:15], s37 offen
    buffer_load_dwordx4 v[188:191], v244, s[12:15], s37 offen
    buffer_load_dwordx4 v[192:195], v245, s[12:15], s37 offen
    buffer_load_dwordx4 v[196:199], v246, s[12:15], s37 offen
    buffer_load_dwordx4 v[200:203], v247, s[12:15], s37 offen
    s_lshr_b32 s36, s67, 2
    s_sub_u32 s36, s35, s36
    s_and_b32 s36, s36, 3
    s_lshl_b32 s36, s36, 15
    v_add_u32 v6, s36, v2
    s_waitcnt vmcnt(14)
    ds_write_b128 v6, v[48:51] offset:0
    ds_write_b128 v6, v[52:55] offset:1024
    ds_write_b128 v6, v[56:59] offset:2048
    ds_write_b128 v6, v[60:63] offset:3072
    ds_write_b128 v6, v[64:67] offset:4096
    ds_write_b128 v6, v[68:71] offset:5120
    ds_write_b128 v6, v[72:75] offset:6144
    ds_write_b128 v6, v[76:79] offset:7168
    ds_write_b128 v6, v[80:83] offset:8192
    ds_write_b128 v6, v[84:87] offset:9216
    ds_write_b128 v6, v[88:91] offset:10240
    ds_write_b128 v6, v[92:95] offset:11264
    ds_write_b128 v6, v[96:99] offset:12288
    ds_write_b128 v6, v[100:103] offset:13312
    ds_write_b128 v6, v[104:107] offset:14336
    ds_write_b128 v6, v[108:111] offset:15360
    ds_write_b128 v6, v[112:115] offset:16384
    ds_write_b128 v6, v[116:119] offset:17408
    ds_write_b128 v6, v[120:123] offset:18432
    ds_write_b128 v6, v[124:127] offset:19456
    ds_write_b128 v6, v[128:131] offset:20480
    ds_write_b128 v6, v[132:135] offset:21504
    ds_write_b128 v6, v[136:139] offset:22528
    ds_write_b128 v6, v[140:143] offset:23552
    ds_write_b128 v6, v[144:147] offset:24576
    ds_write_b128 v6, v[148:151] offset:25600
    ds_write_b128 v6, v[152:155] offset:26624
    ds_write_b128 v6, v[156:159] offset:27648
    ds_write_b128 v6, v[160:163] offset:28672
    ds_write_b128 v6, v[164:167] offset:29696
    ds_write_b128 v6, v[168:171] offset:30720
    ds_write_b128 v6, v[172:175] offset:31744
    s_waitcnt lgkmcnt(0)
    s_setpc_b64 s[76:77]
SUB_after_g2:
    s_and_b32 s35, s30, 3
    s_mul_i32 s39, s35, 7168
    s_add_u32 s39, s39, 73728
    v_add_u32 v7, s39, v2
    ds_write_b128 v7, v[176:179] offset:0
    ds_write_b128 v7, v[180:183] offset:1024
    ds_write_b128 v7, v[184:187] offset:2048
    ds_write_b128 v7, v[188:191] offset:3072
    ds_write_b128 v7, v[192:195] offset:4096
    ds_write_b128 v7, v[196:199] offset:5120
    ds_write_b128 v7, v[200:203] offset:6144
    s_waitcnt lgkmcnt(0)
    s_setpc_b64 s[76:77]
SUB_r_pre:
    v_and_b32 v199, 7, v0
    v_lshrrev_b32 v228, 6, v0
    v_lshlrev_b32 v228, 4, v228
    v_bfe_u32 v229, v0, 3, 3
    v_add_u32 v228, v228, v229
    s_lshr_b32 s78, s29, 1
    s_lshl_b32 s78, s78, 16
    s_and_b32 s79, s29, 1
    s_lshl_b32 s79, s79, 7
    s_add_u32 s78, s78, s79
    s_lshr_b32 s79, s30, 1
    s_lshl_b32 s79, s79, 13
    s_add_u32 s78, s78, s79
    v_lshlrev_b32 v196, 8, v228
    v_lshl_add_u32 v196, v199, 4, v196
    v_add_u32 v196, s78, v196
    s_mov_b32 s84, s62
    s_mov_b32 s85, s63
    s_mov_b32 s86, 0x7e000
    s_mov_b32 s87, 0x20000
    s_add_u32 s88, s62, 0x80000
    s_addc_u32 s89, s63, 0
    s_mov_b32 s90, 0x7e000
    s_mov_b32 s91, 0x20000
    buffer_load_dwordx4 v[180:183], v196, s[84:87], 0 offen offset:0 sc1
    buffer_load_dwordx4 v[188:191], v196, s[88:91], 0 offen offset:0 sc1
    buffer_load_dwordx4 v[184:187], v196, s[84:87], 0 offen offset:2048 sc1
    buffer_load_dwordx4 v[192:195], v196, s[88:91], 0 offen offset:2048 sc1
    s_setpc_b64 s[76:77]
SUB_r_pre0:
    v_and_b32 v199, 7, v0
    v_lshrrev_b32 v228, 6, v0
    v_lshlrev_b32 v228, 4, v228
    v_bfe_u32 v229, v0, 3, 3
    v_add_u32 v228, v228, v229
    s_lshr_b32 s78, s29, 1
    s_lshl_b32 s78, s78, 16
    s_and_b32 s79, s29, 1
    s_lshl_b32 s79, s79, 7
    s_add_u32 s78, s78, s79
    s_lshr_b32 s79, s30, 1
    s_lshl_b32 s79, s79, 13
    s_add_u32 s78, s78, s79
    v_lshlrev_b32 v196, 8, v228
    v_lshl_add_u32 v196, v199, 4, v196
    v_add_u32 v196, s78, v196
    s_mov_b32 s84, s62
    s_mov_b32 s85, s63
    s_mov_b32 s86, 0x7e000
    s_mov_b32 s87, 0x20000
    s_add_u32 s88, s62, 0x80000
    s_addc_u32 s89, s63, 0
    s_mov_b32 s90, 0x7e000
    s_mov_b32 s91, 0x20000
    s_cmp_eq_u32 s60, 0
    s_cselect_b64 exec, -1, 0
    buffer_load_dwordx4 v[180:183], v196, s[84:87], 0 offen offset:0 sc1
    buffer_load_dwordx4 v[188:191], v196, s[88:91], 0 offen offset:0 sc1
    buffer_load_dwordx4 v[184:187], v196, s[84:87], 0 offen offset:2048 sc1
    buffer_load_dwordx4 v[192:195], v196, s[88:91], 0 offen offset:2048 sc1
    s_mov_b64 exec, -1
    s_setpc_b64 s[76:77]
SUB_w_issue_1:
    s_add_u32 s19, s41, s42
    s_mul_i32 s16, s44, 131072
    s_add_u32 s16, s16, s38
    s_add_u32 s44, s44, 1
    s_and_b32 s44, s44, 15
    s_add_u32 s42, s42, 8192
    s_cmp_eq_u32 s42, 131072
    s_cselect_b32 s42, 0, s42
    s_mov_b32 m0, s19
    s_mov_b32 s39, s16
    buffer_load_dwordx4 v238, s[12:15], s39 offen lds
    s_add_u32 m0, m0, 1024
    s_add_u32 s39, s39, 16384
    buffer_load_dwordx4 v238, s[12:15], s39 offen lds
    s_add_u32 m0, m0, 1024
    s_add_u32 s39, s39, 16384
    buffer_load_dwordx4 v238, s[12:15], s39 offen lds
    s_add_u32 m0, m0, 1024
    s_add_u32 s39, s39, 16384
    buffer_load_dwordx4 v238, s[12:15], s39 offen lds
    s_setpc_b64 s[76:77]
PREP_a_issue_4:
    s_add_u32 s19, s41, s42
    v_readlane_b32 s16, v249, s44
    v_readlane_b32 s17, v250, s44
    s_add_u32 s16, s16, s38
    s_add_u32 s17, s17, s38
    s_add_u32 s44, s44, 1
    s_add_u32 s42, s42, 16384
    s_cmp_eq_u32 s42, 49152
    s_cselect_b32 s42, 0, s42
    s_setpc_b64 s[76:77]
PREP_w_issue_4:
    s_mov_b32 s45, 8192
    s_add_u32 s19, s41, s42
    v_readlane_b32 s16, v249, s44
    s_nop 0
    s_bitcmp1_b32 s16, 0
    s_cselect_b32 s17, 16384, s45
    s_cselect_b32 s18, -40960, s45
    s_andn2_b32 s16, s16, 1
    s_add_u32 s16, s16, s38
    s_add_u32 s44, s44, 1
    s_add_u32 s42, s42, 16384
    s_cmp_eq_u32 s42, 98304
    s_cselect_b32 s42, 0, s42
    s_setpc_b64 s[76:77]
K_end:
    s_endpgm
.p2align 6
K_tab:
.short 4096,5137,6178,11379,18660,25941,40502,33223,47784,55065,19706,12427,26988,34269,48830,41551,56096,9264,20736,10448,23824,25008,38384,35296,39568,49856,54128,52944,0,0,0,0
.short 4096,5137,6178,18659,11380,25941,33222,47783,40504,55065,12426,26987,19708,34269,41550,56111,48816,9264,10448,23824,20736,25008,35296,39568,38384,49856,52944,54128,0,0,0,0
.short 4096,5137,6178,11379,25940,18661,33222,40503,55064,47785,12426,19707,34268,26989,41550,48831,9264,56096,10448,20736,25008,23824,35296,38384,49856,39568,52944,54128,0,0,0,0
.short 4096,5137,6178,11379,18660,33221,25942,40503,47784,12425,55066,19707,26988,41549,34270,48831,56096,10448,9264,20736,23824,35296,25008,38384,39568,52944,49856,54128,0,0,0,0
.short 11377,12418,13459,18660,4101,25942,33223,47784,40505,55066,5147,26988,19709,34270,41551,56096,48816,6176,10288,23824,20736,25008,35296,39568,38384,49856,52944,54128,0,0,0,0
.short 11377,12418,13459,4100,25941,18662,33223,40504,55065,47786,5147,19708,34269,26990,41551,48816,6176,56096,10288,20736,25008,23824,35296,38384,49856,39568,52944,54128,0,0,0,0
.short 11377,12418,13459,4100,18661,33222,25943,40504,47785,5146,55067,19708,26989,41550,34271,48816,56096,10288,6176,20736,23824,35296,25008,38384,39568,52944,49856,54128,0,0,0,0
.short 11377,12418,13459,4100,18661,25942,40503,33224,47785,55066,19707,5148,26989,34270,48831,41536,56096,6176,20736,10288,23824,25008,38384,35296,39568,49856,54128,52944,0,0,0,0
.short 18658,19699,20740,4101,25942,11383,33224,40505,55066,47787,5148,12429,34270,26991,41536,48817,6176,56096,9264,10448,25008,23824,35296,38384,49856,39568,52944,54128,0,0,0,0
.short 18658,19699,20740,4101,11382,33223,25944,40505,47786,5147,55068,12429,26990,41551,34256,48817,56096,9264,6176,10448,23824,35296,25008,38384,39568,52944,49856,54128,0,0,0,0
.short 18658,19699,20740,4101,11382,25943,40504,33225,47786,55067,12428,5149,26990,34271,48816,41537,56096,6176,10448,9264,23824,25008,38384,35296,39568,49856,54128,52944,0,0,0,0
.short 18658,19699,20740,11381,4102,25943,33224,47785,40506,55067,5148,26989,12430,34271,41536,56097,48816,6176,9264,23824,10448,25008,35296,39568,38384,49856,52944,54128,0,0,0,0
.short 25939,26980,28021,4102,11383,33224,18665,40506,47787,5148,55069,12430,19711,41536,34257,48818,56096,9264,6176,10448,20736,35296,24848,38384,39568,52944,49856,54128,0,0,0,0
.short 25939,26980,28021,4102,11383,18664,40505,33226,47787,55068,12429,5150,19711,34256,48817,41538,56096,6176,10448,9264,20736,24848,38384,35296,39568,49856,54128,52944,0,0,0,0
.short 25939,26980,28021,11382,4103,18664,33225,47786,40507,55068,5149,19710,12431,34256,41537,56098,48816,6176,9264,20736,10448,24848,35296,39568,38384,49856,52944,54128,0,0,0,0
.short 25939,26980,28021,4102,18663,11384,33225,40506,55067,47788,5149,12430,34271,19696,41537,48818,6176,56096,9264,10448,24848,20736,35296,38384,49856,39568,52944,54128,0,0,0,0
.short 33220,34261,35302,4103,11384,18665,40506,25947,47788,55069,12430,5151,19696,26977,48818,41539,56096,6176,10448,9264,20736,23824,38384,25008,39568,49856,54128,52944,0,0,0,0
.short 33220,34261,35302,11383,4104,18665,25946,47787,40508,55069,5150,19711,12416,26977,41538,56099,48816,6176,9264,20736,10448,23824,25008,39568,38384,49856,52944,54128,0,0,0,0
.short 33220,34261,35302,4103,18664,11385,25946,40507,55068,47789,5150,12431,26976,19697,41538,48819,6176,56096,9264,10448,23824,20736,25008,38384,49856,39568,52944,54128,0,0,0,0
.short 33220,34261,35302,4103,11384,25945,18666,40507,47788,5149,55070,12431,19696,41537,26978,48819,56096,9264,6176,10448,20736,25008,23824,38384,39568,52944,49856,54128,0,0,0,0
.short 40501,41542,42583,11384,4105,18666,25947,47788,33229,55070,5151,19696,12417,26978,34259,56100,48816,6176,9264,20736,10448,23824,25008,39408,35296,49856,52944,54128,0,0,0,0
.short 40501,41542,42583,4104,18665,11386,25947,33228,55069,47790,5151,12416,26977,19698,34259,48820,6176,56096,9264,10448,23824,20736,25008,35296,49856,39408,52944,54128,0,0,0,0
.short 40501,41542,42583,4104,11385,25946,18667,33228,47789,5150,55071,12416,19697,34258,26979,48820,56096,9264,6176,10448,20736,25008,23824,35296,39408,52944,49856,54128,0,0,0,0
.short 40501,41542,42583,4104,11385,18666,33227,25948,47789,55070,12431,5136,19697,26978,48819,34260,56096,6176,10448,9264,20736,23824,35296,25008,39408,49856,54128,52944,0,0,0,0
.short 47782,48823,49864,4105,18666,11387,25948,33229,55070,40511,5136,12417,26978,19699,34260,41541,6176,56096,9264,10448,23824,20736,25008,35296,39568,38384,52944,54128,0,0,0,0
.short 47782,48823,49864,4105,11386,25947,18668,33229,40510,5151,55056,12417,19698,34259,26980,41541,56096,9264,6176,10448,20736,25008,23824,35296,38384,52944,39568,54128,0,0,0,0
.short 47782,48823,49864,4105,11386,18667,33228,25949,40510,55071,12416,5137,19698,26979,41540,34261,56096,6176,10448,9264,20736,23824,35296,25008,38384,39568,54128,52944,0,0,0,0
.short 47782,48823,49864,11385,4106,18667,25948,40509,33230,55071,5136,19697,12418,26979,34260,56101,41536,6176,9264,20736,10448,23824,25008,38384,35296,39568,52944,54128,0,0,0,0
.short 55063,56104,57145,4106,11387,25948,18669,33230,40511,5136,47777,12418,19699,34260,26981,41542,48816,9264,6176,10448,20736,25008,23824,35296,38384,49856,39568,53968,0,0,0,0
.short 55063,56104,57145,4106,11387,18668,33229,25950,40511,47776,12417,5138,19699,26980,41541,34262,48816,6176,10448,9264,20736,23824,35296,25008,38384,39568,53968,49856,0,0,0,0
.short 55063,56104,57145,11386,4107,18668,25949,40510,33231,47776,5137,19698,12419,26980,34261,48822,41536,6176,9264,20736,10448,23824,25008,38384,35296,39568,49856,53968,0,0,0,0
.short 55063,56104,57145,4106,18667,11388,25949,33230,47791,40496,5137,12418,26979,19700,34261,41542,6176,48816,9264,10448,23824,20736,25008,35296,39568,38384,49856,53968,0,0,0,0
.short 4104,5145,6186,11387,18668,25949,40510,33231,47776,55057,19698,12419,26980,34261,48822,41543,56096,9264,20736,10448,23824,25008,38384,35296,39568,49856,54128,52944,0,0,0,0
.short 4104,5145,6186,18667,11388,25949,33230,47791,40496,55057,12418,26979,19700,34261,41542,56103,48816,9264,10448,23824,20736,25008,35296,39568,38384,49856,52944,54128,0,0,0,0
.short 4104,5145,6186,11387,25948,18669,33230,40511,55056,47777,12418,19699,34260,26981,41542,48823,9264,56096,10448,20736,25008,23824,35296,38384,49856,39568,52944,54128,0,0,0,0
.short 4104,5145,6186,11387,18668,33229,25950,40511,47776,12417,55058,19699,26980,41541,34262,48823,56096,10448,9264,20736,23824,35296,25008,38384,39568,52944,49856,54128,0,0,0,0
.short 11385,12426,13467,18668,4109,25950,33231,47776,40497,55058,5139,26980,19701,34262,41543,56104,48816,6176,10288,23824,20736,25008,35296,39568,38384,49856,52944,54128,0,0,0,0
.short 11385,12426,13467,4108,25949,18670,33231,40496,55057,47778,5139,19700,34261,26982,41543,48824,6176,56096,10288,20736,25008,23824,35296,38384,49856,39568,52944,54128,0,0,0,0
.short 11385,12426,13467,4108,18669,33230,25951,40496,47777,5138,55059,19700,26981,41542,34263,48824,56096,10288,6176,20736,23824,35296,25008,38384,39568,52944,49856,54128,0,0,0,0
.short 11385,12426,13467,4108,18669,25950,40511,33216,47777,55058,19699,5140,26981,34262,48823,41544,56096,6176,20736,10288,23824,25008,38384,35296,39568,49856,54128,52944,0,0,0,0
.short 18666,19707,20748,4109,25950,11391,33216,40497,55058,47779,5140,12421,34262,26983,41544,48825,6176,56096,9264,10448,25008,23824,35296,38384,49856,39568,52944,54128,0,0,0,0
.short 18666,19707,20748,4109,11390,33231,25936,40497,47778,5139,55060,12421,26982,41543,34264,48825,56096,9264,6176,10448,23824,35296,25008,38384,39568,52944,49856,54128,0,0,0,0
.short 18666,19707,20748,4109,11390,25951,40496,33217,47778,55059,12420,5141,26982,34263,48824,41545,56096,6176,10448,9264,23824,25008,38384,35296,39568,49856,54128,52944,0,0,0,0
.short 18666,19707,20748,11389,4110,25951,33216,47777,40498,55059,5140,26981,12422,34263,41544,56105,48816,6176,9264,23824,10448,25008,35296,39568,38384,49856,52944,54128,0,0,0,0
.short 25947,26988,28029,4110,11391,33216,18657,40498,47779,5140,55061,12422,19703,41544,34265,48826,56096,9264,6176,10448,20736,35296,24848,38384,39568,52944,49856,54128,0,0,0,0
.short 25947,26988,28029,4110,11391,18656,40497,33218,47779,55060,12421,5142,19703,34264,48825,41546,56096,6176,10448,9264,20736,24848,38384,35296,39568,49856,54128,52944,0,0,0,0
.short 25947,26988,28029,11390,4111,18656,33217,47778,40499,55060,5141,19702,12423,34264,41545,56106,48816,6176,9264,20736,10448,24848,35296,39568,38384,49856,52944,54128,0,0,0,0
.short 25947,26988,28029,4110,18671,11376,33217,40498,55059,47780,5141,12422,34263,19704,41545,48826,6176,56096,9264,10448,24848,20736,35296,38384,49856,39568,52944,54128,0,0,0,0
.short 33228,34269,35310,4111,11376,18657,40498,25939,47780,55061,12422,5143,19704,26985,48826,41547,56096,6176,10448,9264,20736,23824,38384,25008,39568,49856,54128,52944,0,0,0,0
.short 33228,34269,35310,11391,4096,18657,25938,47779,40500,55061,5142,19703,12424,26985,41546,56107,48816,6176,9264,20736,10448,23824,25008,39568,38384,49856,52944,54128,0,0,0,0
.short 33228,34269,35310,4111,18656,11377,25938,40499,55060,47781,5142,12423,26984,19705,41546,48827,6176,56096,9264,10448,23824,20736,25008,38384,49856,39568,52944,54128,0,0,0,0
.short 33228,34269,35310,4111,11376,25937,18658,40499,47780,5141,55062,12423,19704,41545,26986,48827,56096,9264,6176,10448,20736,25008,23824,38384,39568,52944,49856,54128,0,0,0,0
.short 40509,41550,42591,11376,4097,18658,25939,47780,33221,55062,5143,19704,12425,26986,34267,56108,48816,6176,9264,20736,10448,23824,25008,39408,35296,49856,52944,54128,0,0,0,0
.short 40509,41550,42591,4096,18657,11378,25939,33220,55061,47782,5143,12424,26985,19706,34267,48828,6176,56096,9264,10448,23824,20736,25008,35296,49856,39408,52944,54128,0,0,0,0
.short 40509,41550,42591,4096,11377,25938,18659,33220,47781,5142,55063,12424,19705,34266,26987,48828,56096,9264,6176,10448,20736,25008,23824,35296,39408,52944,49856,54128,0,0,0,0
.short 40509,41550,42591,4096,11377,18658,33219,25940,47781,55062,12423,5144,19705,26986,48827,34268,56096,6176,10448,9264,20736,23824,35296,25008,39408,49856,54128,52944,0,0,0,0
.short 47790,48831,49856,4097,18658,11379,25940,33221,55062,40503,5144,12425,26986,19707,34268,41549,6176,56096,9264,10448,23824,20736,25008,35296,39568,38384,52944,54128,0,0,0,0
.short 47790,48831,49856,4097,11378,25939,18660,33221,40502,5143,55064,12425,19706,34267,26988,41549,56096,9264,6176,10448,20736,25008,23824,35296,38384,52944,39568,54128,0,0,0,0
.short 47790,48831,49856,4097,11378,18659,33220,25941,40502,55063,12424,5145,19706,26987,41548,34269,56096,6176,10448,9264,20736,23824,35296,25008,38384,39568,54128,52944,0,0,0,0
.short 47790,48831,49856,11377,4098,18659,25940,40501,33222,55063,5144,19705,12426,26987,34268,56109,41536,6176,9264,20736,10448,23824,25008,38384,35296,39568,52944,54128,0,0,0,0
.short 55071,56096,57137,4098,11379,25940,18661,33222,40503,5144,47785,12426,19707,34268,26989,41550,48816,9264,6176,10448,20736,25008,23824,35296,38384,49856,39568,53968,0,0,0,0
.short 55071,56096,57137,4098,11379,18660,33221,25942,40503,47784,12425,5146,19707,26988,41549,34270,48816,6176,10448,9264,20736,23824,35296,25008,38384,39568,53968,49856,0,0,0,0
.short 55071,56096,57137,11378,4099,18660,25941,40502,33223,47784,5145,19706,12427,26988,34269,48830,41536,6176,9264,20736,10448,23824,25008,38384,35296,39568,49856,53968,0,0,0,0
.short 55071,56096,57137,4098,18659,11380,25941,33222,47783,40504,5145,12426,26987,19708,34269,41550,6176,48816,9264,10448,23824,20736,25008,35296,39568,38384,49856,53968,0,0,0,0
.section .rodata,"a"
.p2align 6
.amdhsa_kernel interleave_layers__ssm_conv_h3__mixer_s_mlp__prompt_kernel
  .amdhsa_next_free_vgpr 256
  .amdhsa_next_free_sgpr 102
  .amdhsa_accum_offset 256
  .amdhsa_group_segment_fixed_size 0
  .amdhsa_kernarg_size 112
  .amdhsa_user_sgpr_count 2
  .amdhsa_user_sgpr_kernarg_segment_ptr 1
  .amdhsa_system_sgpr_workgroup_id_x 1
  .amdhsa_float_denorm_mode_32 3
.end_amdhsa_kernel
```

```asm
; @launch grid=(256,1,1) block=(512,1,1) lds=163840
.amdgcn_target "amdgcn-amd-amdhsa--gfx950"
.text
.globl interleave_layers__ssm_conv_h3__mixer_s_mlp__prompt_kernel
.p2align 8
.type interleave_layers__ssm_conv_h3__mixer_s_mlp__prompt_kernel,@function
interleave_layers__ssm_conv_h3__mixer_s_mlp__prompt_kernel:
    s_cmp_ge_u32 s2, 256
    s_cbranch_scc1 K_end
    s_load_dwordx8 s[8:15], s[0:1], 8
    s_load_dwordx2 s[6:7], s[0:1], 0
    s_load_dwordx8 s[68:75], s[0:1], 56
    s_load_dwordx2 s[4:5], s[0:1], 104
    s_load_dwordx2 s[84:85], s[0:1], 96
    s_memrealtime s[46:47]
    s_load_dwordx2 s[96:97], s[0:1], 40
    v_lshrrev_b32 v1, 6, v0
    s_nop 0
    v_readfirstlane_b32 s30, v1
    s_getpc_b64 s[48:49]
K_pc:
    s_lshr_b32 s36, s2, 3
    s_lshl_b32 s36, s36, 11
    v_lshlrev_b32 v4, 2, v0
    v_add_u32 v4, s36, v4
    v_cmp_gt_u32 vcc, K_end-K_pc-8, v4
    s_nop 0
    s_and_saveexec_b64 s[36:37], vcc
    s_cbranch_execz K_3
    v_mov_b32 v5, s49
    v_add_co_u32 v4, vcc, s48, v4
    s_nop 1
    v_addc_co_u32 v5, vcc, 0, v5, vcc
    global_load_dword v250, v[4:5], off
K_3:
    s_mov_b64 exec, -1
    v_and_b32 v6, 31, v0
    v_lshrrev_b32 v7, 5, v0
    s_and_b32 s34, s2, 7
    s_lshr_b32 s35, s2, 3
    s_lshl_b32 s36, s35, 17
    s_lshl_b32 s37, s34, 8
    s_add_u32 s36, s36, s37
    v_lshlrev_b32 v8, 13, v7
    v_lshl_add_u32 v8, v6, 3, v8
    v_add_u32 v12, s36, v8
    v_add_u32 v14, 4096, v12
    s_mov_b32 s18, 4194304
    s_mov_b32 s19, 0x20000
    s_mov_b32 s22, s18
    s_mov_b32 s23, s19
    s_waitcnt lgkmcnt(0)
    s_mov_b32 s86, 256
    s_mov_b32 s87, 0x20000
    v_mov_b32 v78, 0
    s_lshl_b32 s45, s2, 3
    s_add_u32 s45, s45, s30
    s_cmp_lg_u32 s45, 4
    s_cbranch_scc1 KV_t0
    s_getreg_b32 s45, hwreg(HW_REG_XCC_ID, 0, 3)
    s_lshl_b32 s45, s45, 1
    s_lshl_b32 s44, s46, 6
    s_or_b32 s44, s44, s45
    s_or_b32 s44, s44, 1
    v_mov_b32 v76, s44
    v_mov_b32 v77, 0
    s_mov_b64 exec, 1
    buffer_store_dwordx2 v[76:77], v78, s[84:87], 0 offen sc1
    s_mov_b64 exec, -1
KV_t0:
    s_mov_b64 s[16:17], s[8:9]
    s_mov_b64 s[20:21], s[10:11]
    buffer_load_dwordx2 v[28:29], v12, s[16:19], 0 offen offset:0 nt
    buffer_load_dwordx2 v[30:31], v12, s[16:19], 0 offen offset:2048 nt
    buffer_load_dwordx2 v[32:33], v14, s[16:19], 0 offen offset:0 nt
    buffer_load_dwordx2 v[34:35], v14, s[16:19], 0 offen offset:2048 nt
    buffer_load_dwordx2 v[36:37], v12, s[20:23], 0 offen offset:0 nt
    buffer_load_dwordx2 v[38:39], v12, s[20:23], 0 offen offset:2048 nt
    buffer_load_dwordx2 v[40:41], v14, s[20:23], 0 offen offset:0 nt
    buffer_load_dwordx2 v[42:43], v14, s[20:23], 0 offen offset:2048 nt
    v_subrev_u32 v9, 6144, v12
    v_subrev_u32 v10, 4096, v12
    v_subrev_u32 v11, 2048, v12
    s_lshl_b32 s37, s34, 10
    v_lshlrev_b32 v16, 5, v6
    v_add_u32 v16, s37, v16
    s_mov_b32 s24, s12
    s_mov_b32 s25, s13
    s_mov_b32 s26, 0x2000
    s_mov_b32 s27, 0x20000
    v_and_b32 v8, 1, v7
    v_lshl_add_u32 v16, v8, 4, v16
    buffer_load_dwordx4 v[44:47], v16, s[24:27], 0 offen
    s_cmp_lg_u32 s30, 4
    s_cbranch_scc1 KV_t2
    buffer_load_dword v76, v78, s[84:87], 0 offen sc1
KV_t2:
    s_bfm_b64 exec, 32, 0
    buffer_load_dwordx2 v[22:23], v9, s[16:19], 0 offen nt
    buffer_load_dwordx2 v[24:25], v10, s[16:19], 0 offen nt
    buffer_load_dwordx2 v[26:27], v11, s[16:19], 0 offen nt
    s_mov_b64 exec, -1
    v_and_b32 v1, 63, v0
    v_lshlrev_b32 v2, 4, v1
    v_lshlrev_b32 v3, 2, v1
    s_mov_b32 s67, 0
    s_mov_b32 s60, 0
    s_mov_b32 s61, 40000
    s_mov_b32 s52, 0
    s_mov_b32 s55, 0
    s_mov_b32 s92, 0
    s_mov_b32 s93, 0
    s_mov_b32 s94, 0
    s_mov_b32 s56, s4
    s_mov_b32 s57, s5
    s_mov_b32 s58, 0xa000000
    s_mov_b32 s59, 0x20000
    s_add_u32 s62, s4, 33554432
    s_addc_u32 s63, s5, 0
    s_and_b32 s41, s30, 3
    s_and_b32 s38, s2, 7
    s_lshl_b32 s38, s38, 5
    s_lshr_b32 s39, s2, 3
    s_add_u32 s38, s38, s39
    s_lshl_b32 s39, s38, 2
    s_add_u32 s39, s39, s41
    s_mul_i32 s40, s41, 24576
    s_lshr_b32 s36, s39, 1
    s_lshl_b32 s36, s36, 2
    s_load_dword s98, s[96:97], s36
    s_lshl_b32 s36, s39, 12
    s_add_u32 s12, s14, s36
    s_addc_u32 s13, s15, 0
    s_mov_b32 s14, 4096
    s_mov_b32 s15, 0x20000
    s_lshr_b32 s45, s30, 2
    s_lshl_b32 s45, s45, 11
    s_add_u32 s36, s45, 0xffffffc0
    v_add_u32 v70, s36, v2
    v_add_u32 v71, 16, v70
    s_add_u32 s36, s45, 0x3c0
    v_add_u32 v72, s36, v2
    v_add_u32 v73, 16, v72
    s_mov_b32 s36, 4032
    v_add_u32 v74, s36, v2
    v_add_u32 v75, 16, v74
    s_and_b32 s34, s2, 7
    s_lshr_b32 s35, s2, 3
    v_mov_b32 v80, 0
    v_mov_b32 v81, 0
    v_mov_b32 v82, 0
    v_mov_b32 v83, 0
    v_add_u32 v86, s40, v2
    ds_write_b128 v86, v[80:83] offset:22784
    s_bfm_b64 exec, 26, 0
    ds_write_b128 v86, v[80:83] offset:23808
    s_mov_b64 exec, -1
    v_lshlrev_b32 v8, 2, v7
    v_sub_u32 v8, 60, v8
    v_lshrrev_b32 v85, 3, v8
    v_bfe_u32 v84, v6, 1, 3
    v_xor_b32 v85, v85, v84
    v_lshlrev_b32 v85, 4, v85
    v_and_b32 v8, 7, v8
    v_lshl_add_u32 v85, v8, 1, v85
    v_lshl_add_u32 v84, v6, 9, v85
    v_add_u32 v84, 98304, v84
    s_waitcnt vmcnt(0)
    s_cmp_lg_u32 s30, 4
    s_cbranch_scc1 KV_t1
KV_t1:
    buffer_load_dwordx4 v[52:55], v70, s[12:15], 0 offen nt
    buffer_load_dwordx2 v[56:57], v71, s[12:15], 0 offen nt
    buffer_load_dwordx4 v[58:61], v72, s[12:15], 0 offen nt
    buffer_load_dwordx2 v[62:63], v73, s[12:15], 0 offen nt
    buffer_load_dwordx4 v[64:67], v74, s[12:15], 0 offen nt
    buffer_load_dwordx2 v[68:69], v75, s[12:15], 0 offen nt
    v_mov_b32 v48, v44
    v_mov_b32 v49, v45
    v_mov_b32 v50, v46
    v_mov_b32 v51, v47
    v_mov_b32 v126, v30
    v_mov_b32 v127, v31
    v_mov_b32 v128, v32
    v_mov_b32 v129, v33
    v_mov_b32 v130, v34
    v_mov_b32 v131, v35
    v_permlane32_swap_b32 v44, v48
    v_permlane32_swap_b32 v45, v49
    v_permlane32_swap_b32 v46, v50
    v_permlane32_swap_b32 v47, v51
    v_permlane32_swap_b32 v22, v126
    v_permlane32_swap_b32 v23, v127
    v_permlane32_swap_b32 v24, v128
    v_permlane32_swap_b32 v25, v129
    v_permlane32_swap_b32 v26, v130
    v_permlane32_swap_b32 v27, v131
    v_lshlrev_b32 v88, 16, v44
    v_and_b32 v90, 0xffff0000, v44
    v_lshlrev_b32 v92, 16, v45
    v_and_b32 v94, 0xffff0000, v45
    v_lshlrev_b32 v89, 16, v46
    v_and_b32 v91, 0xffff0000, v46
    v_lshlrev_b32 v93, 16, v47
    v_and_b32 v95, 0xffff0000, v47
    v_lshlrev_b32 v96, 16, v22
    v_and_b32 v97, 0xffff0000, v22
    v_lshlrev_b32 v98, 16, v24
    v_and_b32 v99, 0xffff0000, v24
    v_lshlrev_b32 v100, 16, v26
    v_and_b32 v101, 0xffff0000, v26
    v_lshlrev_b32 v102, 16, v28
    v_and_b32 v103, 0xffff0000, v28
    v_lshlrev_b32 v104, 16, v30
    v_and_b32 v105, 0xffff0000, v30
    v_lshlrev_b32 v106, 16, v32
    v_and_b32 v107, 0xffff0000, v32
    v_lshlrev_b32 v108, 16, v34
    v_and_b32 v109, 0xffff0000, v34
    v_lshlrev_b32 v110, 16, v36
    v_and_b32 v111, 0xffff0000, v36
    v_lshlrev_b32 v112, 16, v38
    v_and_b32 v113, 0xffff0000, v38
    v_lshlrev_b32 v114, 16, v40
    v_and_b32 v115, 0xffff0000, v40
    v_lshlrev_b32 v116, 16, v42
    v_and_b32 v117, 0xffff0000, v42
    v_pk_mul_f32 v[118:119], v[96:97], v[94:95]
    v_pk_mul_f32 v[120:121], v[98:99], v[94:95]
    v_pk_mul_f32 v[122:123], v[100:101], v[94:95]
    v_pk_mul_f32 v[124:125], v[102:103], v[94:95]
    v_pk_fma_f32 v[118:119], v[98:99], v[92:93], v[118:119]
    v_pk_fma_f32 v[120:121], v[100:101], v[92:93], v[120:121]
    v_pk_fma_f32 v[122:123], v[102:103], v[92:93], v[122:123]
    v_pk_fma_f32 v[124:125], v[104:105], v[92:93], v[124:125]
    v_pk_fma_f32 v[118:119], v[100:101], v[90:91], v[118:119]
    v_pk_fma_f32 v[120:121], v[102:103], v[90:91], v[120:121]
    v_pk_fma_f32 v[122:123], v[104:105], v[90:91], v[122:123]
    v_pk_fma_f32 v[124:125], v[106:107], v[90:91], v[124:125]
    v_pk_fma_f32 v[118:119], v[102:103], v[88:89], v[118:119]
    v_pk_fma_f32 v[120:121], v[104:105], v[88:89], v[120:121]
    v_pk_fma_f32 v[122:123], v[106:107], v[88:89], v[122:123]
    v_pk_fma_f32 v[124:125], v[108:109], v[88:89], v[124:125]
    v_pk_mul_f32 v[118:119], v[118:119], v[110:111]
    v_pk_mul_f32 v[120:121], v[120:121], v[112:113]
    v_pk_mul_f32 v[122:123], v[122:123], v[114:115]
    v_pk_mul_f32 v[124:125], v[124:125], v[116:117]
    v_cvt_pk_bf16_f32 v136, v124, v122
    v_cvt_pk_bf16_f32 v137, v120, v118
    ds_write_b64 v84, v[136:137] offset:0
    v_cvt_pk_bf16_f32 v138, v125, v123
    v_cvt_pk_bf16_f32 v139, v121, v119
    ds_write_b64 v84, v[138:139] offset:128
    v_lshlrev_b32 v88, 16, v48
    v_and_b32 v90, 0xffff0000, v48
    v_lshlrev_b32 v92, 16, v49
    v_and_b32 v94, 0xffff0000, v49
    v_lshlrev_b32 v89, 16, v50
    v_and_b32 v91, 0xffff0000, v50
    v_lshlrev_b32 v93, 16, v51
    v_and_b32 v95, 0xffff0000, v51
    v_lshlrev_b32 v96, 16, v23
    v_and_b32 v97, 0xffff0000, v23
    v_lshlrev_b32 v98, 16, v25
    v_and_b32 v99, 0xffff0000, v25
    v_lshlrev_b32 v100, 16, v27
    v_and_b32 v101, 0xffff0000, v27
    v_lshlrev_b32 v102, 16, v29
    v_and_b32 v103, 0xffff0000, v29
    v_lshlrev_b32 v104, 16, v31
    v_and_b32 v105, 0xffff0000, v31
    v_lshlrev_b32 v106, 16, v33
    v_and_b32 v107, 0xffff0000, v33
    v_lshlrev_b32 v108, 16, v35
    v_and_b32 v109, 0xffff0000, v35
    v_lshlrev_b32 v110, 16, v37
    v_and_b32 v111, 0xffff0000, v37
    v_lshlrev_b32 v112, 16, v39
    v_and_b32 v113, 0xffff0000, v39
    v_lshlrev_b32 v114, 16, v41
    v_and_b32 v115, 0xffff0000, v41
    v_lshlrev_b32 v116, 16, v43
    v_and_b32 v117, 0xffff0000, v43
    v_pk_mul_f32 v[118:119], v[96:97], v[94:95]
    v_pk_mul_f32 v[120:121], v[98:99], v[94:95]
    v_pk_mul_f32 v[122:123], v[100:101], v[94:95]
    v_pk_mul_f32 v[124:125], v[102:103], v[94:95]
    v_pk_fma_f32 v[118:119], v[98:99], v[92:93], v[118:119]
    v_pk_fma_f32 v[120:121], v[100:101], v[92:93], v[120:121]
    v_pk_fma_f32 v[122:123], v[102:103], v[92:93], v[122:123]
    v_pk_fma_f32 v[124:125], v[104:105], v[92:93], v[124:125]
    v_pk_fma_f32 v[118:119], v[100:101], v[90:91], v[118:119]
    v_pk_fma_f32 v[120:121], v[102:103], v[90:91], v[120:121]
    v_pk_fma_f32 v[122:123], v[104:105], v[90:91], v[122:123]
    v_pk_fma_f32 v[124:125], v[106:107], v[90:91], v[124:125]
    v_pk_fma_f32 v[118:119], v[102:103], v[88:89], v[118:119]
    v_pk_fma_f32 v[120:121], v[104:105], v[88:89], v[120:121]
    v_pk_fma_f32 v[122:123], v[106:107], v[88:89], v[122:123]
    v_pk_fma_f32 v[124:125], v[108:109], v[88:89], v[124:125]
    v_pk_mul_f32 v[118:119], v[118:119], v[110:111]
    v_pk_mul_f32 v[120:121], v[120:121], v[112:113]
    v_pk_mul_f32 v[122:123], v[122:123], v[114:115]
    v_pk_mul_f32 v[124:125], v[124:125], v[116:117]
    v_cvt_pk_bf16_f32 v140, v124, v122
    v_cvt_pk_bf16_f32 v141, v120, v118
    ds_write_b64 v84, v[140:141] offset:256
    v_cvt_pk_bf16_f32 v142, v125, v123
    v_cvt_pk_bf16_f32 v143, v121, v119
    ds_write_b64 v84, v[142:143] offset:384
    s_cmp_lg_u32 s30, 4
    s_cbranch_scc1 HB_2
    v_add_u32 v18, 162816, v3
    ds_write_b32 v18, v78
    s_mov_b32 s53, 0
    s_waitcnt vmcnt(6)
HB_p:
    v_readfirstlane_b32 s52, v76
    s_nop 0
    s_cmp_eq_u32 s52, 0
    s_cbranch_scc1 HB_r
    s_cmp_ge_u32 s53, 60
    s_cbranch_scc1 HB_q
    s_add_u32 s54, s46, 8192
    s_lshl_b32 s54, s54, 6
    s_sub_u32 s54, s54, s52
    s_cmp_lt_u32 s54, 786432
    s_cbranch_scc1 HB_q
HB_r:
    buffer_load_dword v76, v78, s[84:87], 0 offen sc1
    s_waitcnt vmcnt(0)
    s_add_u32 s53, s53, 1
    s_cmp_lt_u32 s53, s61
    s_cbranch_scc1 HB_p
    s_mov_b32 s52, 1
    s_mov_b32 s61, 0
HB_q:
    v_mov_b32 v18, 162828
    v_mov_b32 v19, s52
    s_waitcnt lgkmcnt(0)
    ds_write_b32 v18, v19
HB_2:
    s_add_u32 s16, s4, 0x2000000
    s_addc_u32 s17, s5, 0
    s_mov_b32 s18, 0x8000000
    s_mov_b32 s19, 0x20000
    v_lshrrev_b32 v8, 3, v0
    v_and_b32 v85, 7, v0
    v_lshlrev_b32 v149, 12, v8
    v_lshl_add_u32 v149, v85, 4, v149
    s_lshl_b32 s36, s34, 24
    s_sub_u32 s37, 31, s35
    s_lshl_b32 s37, s37, 7
    s_add_u32 s36, s36, s37
    s_add_u32 s37, s36, 262144
    v_lshrrev_b32 v148, 3, v8
    v_xor_b32 v148, v148, v85
    v_lshlrev_b32 v148, 4, v148
    v_lshl_add_u32 v148, v8, 7, v148
    v_add_u32 v148, 98304, v148
    v_mov_b32 v18, 162828
    s_waitcnt lgkmcnt(0)
    s_barrier
    ds_read_b128 v[152:155], v148 offset:0
    ds_read_b128 v[156:159], v148 offset:8192
    ds_read_b32 v19, v18
    s_waitcnt lgkmcnt(2)
    v_or_b32 v152, 1, v152
    buffer_store_dwordx4 v[152:155], v149, s[16:19], s36 offen sc1
    s_waitcnt lgkmcnt(1)
    v_or_b32 v156, 1, v156
    buffer_store_dwordx4 v[156:159], v149, s[16:19], s37 offen sc1
    s_waitcnt lgkmcnt(0)
    v_readfirstlane_b32 s52, v19
    s_cmp_lg_u32 s30, 0
    s_cbranch_scc1 KV_ni
    s_cmp_ge_u32 s35, 16
    s_cbranch_scc1 KV_ni
    v_mov_b32 v8, s52
    s_lshl_b32 s37, s34, 7
    s_lshl_b32 s53, s35, 10
    s_add_u32 s37, s37, s53
    s_add_u32 s37, s37, 23101440
    s_mov_b64 exec, 1
    buffer_store_dword v8, v78, s[56:59], s37 offen sc1
    s_mov_b64 exec, -1
KV_ni:
    s_cmp_ge_u32 s2, 32
    s_cbranch_scc1 KV_n3
    s_cmp_lg_u32 s30, 5
    s_cbranch_scc1 KV_n3
    s_and_b32 s42, s2, 7
    s_lshl_b32 s42, s42, 10
    s_lshr_b32 s43, s2, 3
    s_lshl_b32 s43, s43, 14
    s_add_u32 s42, s42, s43
    s_add_u32 s42, s42, 39714816
    v_lshrrev_b32 v8, 5, v1
    v_mul_u32_u24 v8, 7680, v8
    v_add_u32 v8, v8, v2
    buffer_store_dwordx4 v[80:83], v8, s[56:59], s42 offen sc1
KV_n3:
    s_bfe_u32 s32, s52, 0x30001
    s_add_u32 s32, s32, s2
    s_and_b32 s32, s32, 7
    s_lshr_b32 s33, s2, 3
    s_and_b32 s28, s32, 2
    s_lshr_b32 s53, s32, 2
    s_or_b32 s28, s28, s53
    s_lshl_b32 s28, s28, 2
    s_and_b32 s53, s33, 3
    s_add_u32 s28, s28, s53
    s_and_b32 s31, s32, 1
    s_lshr_b32 s33, s33, 2
    s_lshl_b32 s29, s31, 3
    s_add_u32 s29, s29, s33
    s_xor_b32 s99, s29, 1
    v_and_b32 v199, 7, v0
    v_lshrrev_b32 v228, 6, v0
    v_lshlrev_b32 v228, 4, v228
    v_bfe_u32 v229, v0, 3, 3
    v_add_u32 v228, v228, v229
    s_lshr_b32 s78, s29, 1
    s_lshl_b32 s78, s78, 16
    s_and_b32 s79, s29, 1
    s_lshl_b32 s79, s79, 7
    s_add_u32 s78, s78, s79
    s_lshr_b32 s79, s30, 1
    s_lshl_b32 s79, s79, 13
    s_add_u32 s78, s78, s79
    v_lshlrev_b32 v196, 8, v228
    v_lshl_add_u32 v196, v199, 4, v196
    v_add_u32 v196, s78, v196
    s_lshl_b32 s78, s28, 7
    s_lshl_b32 s79, s29, 3
    s_add_u32 s78, s78, s79
    v_add_u32 v197, s78, v199
    v_lshlrev_b32 v198, 11, v197
    v_lshrrev_b32 v229, 2, v228
    v_lshlrev_b32 v229, 3, v229
    v_and_b32 v228, 3, v228
    v_add_u32 v228, v228, v229
    v_lshl_add_u32 v198, v228, 3, v198
    v_and_b32 v197, 15, v197
    v_lshlrev_b32 v197, 4, v197
    v_and_b32 v229, 15, v228
    v_lshl_add_u32 v197, v229, 9, v197
    v_lshrrev_b32 v229, 4, v228
    v_lshl_add_u32 v197, v229, 14, v197
    s_lshr_b32 s78, s28, 3
    s_lshl_b32 s78, s78, 2
    s_and_b32 s79, s28, 3
    s_add_u32 s78, s78, s79
    s_lshl_b32 s78, s78, 24
    s_and_b32 s79, s28, 4
    s_lshl_b32 s79, s79, 11
    s_add_u32 s78, s78, s79
    s_and_b32 s79, s29, 4
    s_lshl_b32 s79, s79, 6
    s_add_u32 s78, s78, s79
    s_and_b32 s79, s29, 2
    s_lshl_b32 s79, s79, 2
    s_add_u32 s78, s78, s79
    s_lshl_b32 s79, s31, 18
    s_add_u32 s78, s78, s79
    v_add_u32 v197, s78, v197
    s_lshl_b32 s36, s34, 5
    s_add_u32 s36, s36, s35
    s_lshl_b32 s36, s36, 7
    s_add_u32 s36, s36, 23068672
    v_mov_b32 v18, 1
    v_mov_b32 v19, 162820
    v_mov_b32 v21, 0
    s_mov_b64 exec, 1
    s_waitcnt vmcnt(0)
    ds_add_rtn_u32 v20, v19, v18
    v_mov_b32 v19, s52
    s_waitcnt lgkmcnt(0)
    v_readfirstlane_b32 s54, v20
    s_nop 0
    s_and_b32 s54, s54, 7
    s_cmp_lg_u32 s54, 7
    s_cbranch_scc1 pub_1
    buffer_store_dword v19, v21, s[56:59], s36 offen sc1
pub_1:
    s_mov_b64 exec, -1
    s_mov_b32 s8, s6
    s_mov_b32 s9, s7
    s_mov_b32 s10, 0x400000
    s_mov_b32 s11, 0x20000
    buffer_load_dwordx2 v[180:181], v198, s[8:11], 0 offen offset:0 nt
    buffer_load_dwordx2 v[182:183], v198, s[8:11], 0 offen offset:32 nt
    buffer_load_dwordx2 v[184:185], v198, s[8:11], 0 offen offset:128 nt
    buffer_load_dwordx2 v[186:187], v198, s[8:11], 0 offen offset:160 nt
    v_add_u32 v160, s45, v86
    v_alignbit_b32 v88, v53, v52, 16
    v_mov_b32 v92, v53
    v_alignbit_b32 v96, v54, v53, 16
    v_alignbit_b32 v89, v54, v53, 16
    v_mov_b32 v93, v54
    v_alignbit_b32 v97, v55, v54, 16
    v_alignbit_b32 v90, v55, v54, 16
    v_mov_b32 v94, v55
    v_alignbit_b32 v98, v56, v55, 16
    v_alignbit_b32 v91, v56, v55, 16
    v_mov_b32 v95, v56
    v_alignbit_b32 v99, v57, v56, 16
    ds_write_b128 v160, v[88:91] offset:0
    ds_write_b128 v160, v[92:95] offset:4160
    ds_write_b128 v160, v[96:99] offset:8320
    ds_write_b128 v160, v[54:57] offset:12480
    v_alignbit_b32 v100, v59, v58, 16
    v_mov_b32 v104, v59
    v_alignbit_b32 v108, v60, v59, 16
    v_alignbit_b32 v101, v60, v59, 16
    v_mov_b32 v105, v60
    v_alignbit_b32 v109, v61, v60, 16
    v_alignbit_b32 v102, v61, v60, 16
    v_mov_b32 v106, v61
    v_alignbit_b32 v110, v62, v61, 16
    v_alignbit_b32 v103, v62, v61, 16
    v_mov_b32 v107, v62
    v_alignbit_b32 v111, v63, v62, 16
    ds_write_b128 v160, v[100:103] offset:1024
    ds_write_b128 v160, v[104:107] offset:5184
    ds_write_b128 v160, v[108:111] offset:9344
    ds_write_b128 v160, v[60:63] offset:13504
    v_alignbit_b32 v112, v65, v64, 16
    v_mov_b32 v116, v65
    v_alignbit_b32 v120, v66, v65, 16
    v_alignbit_b32 v113, v66, v65, 16
    v_mov_b32 v117, v66
    v_alignbit_b32 v121, v67, v66, 16
    v_alignbit_b32 v114, v67, v66, 16
    v_mov_b32 v118, v67
    v_alignbit_b32 v122, v68, v67, 16
    v_alignbit_b32 v115, v68, v67, 16
    v_mov_b32 v119, v68
    v_alignbit_b32 v123, v69, v68, 16
    s_mov_b64 exec, 0xf
    ds_write_b128 v86, v[112:115] offset:4096
    ds_write_b128 v86, v[116:119] offset:8256
    ds_write_b128 v86, v[120:123] offset:12416
    ds_write_b128 v86, v[66:69] offset:16576
    s_mov_b64 exec, -1
    s_waitcnt lgkmcnt(0)
    s_barrier
    v_mov_b32 v238, 0
    v_mov_b32 v239, 0
    v_mov_b32 v240, 0
    v_mov_b32 v241, 0
    v_mov_b32 v242, 0
    v_mov_b32 v243, 0
    v_mov_b32 v244, 0
    v_mov_b32 v245, 0
    v_mov_b32 v246, 0
    v_mov_b32 v247, 0
    s_cmp_ge_u32 s30, 4
    s_cbranch_scc1 FR_b
    s_and_b32 s38, s2, 7
    s_lshl_b32 s38, s38, 5
    s_lshr_b32 s39, s2, 3
    s_add_u32 s38, s38, s39
    s_lshl_b32 s39, s38, 2
    s_add_u32 s39, s39, s30
    s_mul_i32 s40, s30, 24576
    s_and_b32 s36, s39, 127
    s_lshl_b32 s36, s36, 12
    s_lshr_b32 s37, s39, 7
    s_lshl_b32 s37, s37, 24
    s_add_u32 s36, s36, s37
    s_add_u32 s36, s36, 33554432
    s_add_u32 s16, s4, s36
    s_addc_u32 s17, s5, 0
    s_mov_b32 s18, 4096
    s_mov_b32 s19, 0x20000
    v_lshrrev_b32 v6, 2, v1
    v_mul_u32_u24 v12, 96, v6
    v_and_b32 v6, 3, v1
    v_lshl_add_u32 v12, v6, 4, v12
    v_add_u32 v12, s40, v12
    v_and_b32 v35, 15, v1
    v_lshrrev_b32 v36, 4, v1
    v_and_b32 v6, 3, v35
    v_mul_u32_u24 v32, 4160, v6
    v_lshl_add_u32 v32, v36, 4, v32
    v_lshrrev_b32 v6, 2, v35
    v_lshl_add_u32 v32, v6, 3, v32
    v_add_u32 v32, s40, v32
    v_sub_u32 v6, 15, v35
    v_mul_u32_u24 v34, 96, v6
    v_add_u32 v34, s40, v34
    v_lshl_add_u32 v33, v36, 4, v34
    ds_read_b64 v[72:73], v32 offset:0
    ds_read_b64 v[74:75], v32 offset:8
    ds_read_b64 v[76:77], v32 offset:32
    ds_read_b64 v[78:79], v32 offset:40
    ds_read_b64 v[80:81], v32 offset:1024
    ds_read_b64 v[82:83], v32 offset:1032
    ds_read_b64 v[84:85], v32 offset:1056
    ds_read_b64 v[86:87], v32 offset:1064
    ds_read_b64 v[88:89], v32 offset:2048
    ds_read_b64 v[90:91], v32 offset:2056
    ds_read_b64 v[92:93], v32 offset:2080
    ds_read_b64 v[94:95], v32 offset:2088
    ds_read_b64 v[96:97], v32 offset:3072
    ds_read_b64 v[98:99], v32 offset:3080
    ds_read_b64 v[100:101], v32 offset:3104
    ds_read_b64 v[102:103], v32 offset:3112
    s_bitcmp1_b32 s39, 0
    s_cselect_b32 s36, 0, 16
    s_lshl_b32 s41, s98, s36
    s_and_b32 s41, s41, 0xffff0000
    s_lshr_b32 s36, s41, 16
    v_lshl_add_u32 v6, v36, 3, v35
    v_sub_u32 v6, 31, v6
    v_mov_b32 v10, s36
    v_mov_b32 v11, s41
    v_and_b32 v8, 1, v6
    v_cmp_eq_u32 vcc, 1, v8
    s_nop 1
    v_cndmask_b32 v10, v10, v11, vcc
    v_ashrrev_i32 v6, 1, v6
    v_cmp_eq_u32 vcc, 0, v6
    s_nop 1
    v_cndmask_b32 v152, 0, v10, vcc
    v_cmp_eq_u32 vcc, 1, v6
    s_nop 1
    v_cndmask_b32 v153, 0, v10, vcc
    v_cmp_eq_u32 vcc, 2, v6
    s_nop 1
    v_cndmask_b32 v154, 0, v10, vcc
    v_cmp_eq_u32 vcc, 3, v6
    s_nop 1
    v_cndmask_b32 v155, 0, v10, vcc
    v_cmp_eq_u32 vcc, 8, v6
    s_nop 1
    v_cndmask_b32 v156, 0, v10, vcc
    v_cmp_eq_u32 vcc, 9, v6
    s_nop 1
    v_cndmask_b32 v157, 0, v10, vcc
    v_cmp_eq_u32 vcc, 10, v6
    s_nop 1
    v_cndmask_b32 v158, 0, v10, vcc
    v_cmp_eq_u32 vcc, 11, v6
    s_nop 1
    v_cndmask_b32 v159, 0, v10, vcc
    s_add_u32 s12, s4, 0x2100000
    s_addc_u32 s13, s5, 0
    s_mov_b32 s14, 0x7f00000
    s_mov_b32 s15, 0x20000
    v_bfe_u32 v6, v1, 2, 2
    v_mul_u32_u24 v168, 24640, v6
    v_mul_u32_u24 v6, 72, v36
    v_add_u32 v168, v168, v6
    v_and_b32 v6, 3, v1
    v_lshl_add_u32 v168, v6, 3, v168
    s_mul_i32 s36, s30, 1152
    v_add_u32 v168, s36, v168
    v_lshrrev_b32 v6, 5, v1
    v_mul_u32_u24 v169, 261632, v6
    v_add_u32 v169, v169, v2
    s_lshr_b32 s44, s38, 4
    s_lshl_b32 s44, s44, 14
    s_and_b32 s37, s38, 15
    s_lshl_b32 s37, s37, 9
    s_add_u32 s44, s44, s37
    s_and_b32 s37, s30, 1
    s_lshl_b32 s37, s37, 13
    s_add_u32 s44, s44, s37
    s_lshr_b32 s37, s30, 1
    s_lshl_b32 s37, s37, 26
    s_add_u32 s44, s44, s37
    s_and_b32 s47, s44, 0x2000
    s_xor_b32 s47, s47, 8192
    s_lshr_b32 s37, s30, 1
    s_lshl_b32 s37, s37, 12
    s_add_u32 s47, s47, s37
    s_and_b32 s37, s2, 7
    s_lshl_b32 s37, s37, 7
    s_add_u32 s47, s47, s37
    v_mov_b32 v34, 162824
    v_mov_b32 v7, 1
    s_mul_i32 s36, s30, 24640
    v_mul_u32_u24 v170, 72, v35
    v_lshl_add_u32 v170, v36, 3, v170
    v_add_u32 v170, s36, v170
    v_lshlrev_b32 v6, 10, v1
    v_mov_b32 v35, 0
    s_and_b32 s45, s2, 31
    s_lshl_b32 s45, s45, 7
    s_add_u32 s45, s45, 23117824
    s_cmp_lg_u32 s30, 0
    s_cbranch_scc1 CV_w
    s_and_b32 s36, s2, 7
    s_lshl_b32 s36, s36, 12
    s_add_u32 s36, s36, 23068672
    v_lshlrev_b32 v9, 7, v1
    v_add_u32 v9, s36, v9
    s_mov_b32 s53, 0
    s_add_u32 s54, s52, 0
    s_bfm_b64 exec, 32, 0
poll_2:
    buffer_load_dword v8, v9, s[56:59], 0 offen sc1
    s_waitcnt vmcnt(0)
    v_xor_b32 v8, s54, v8
    v_cmp_eq_u32 vcc, 0, v8
    s_nop 0
    s_cmp_eq_u64 vcc, exec
    s_cbranch_scc1 pok_3
    s_sleep 5
    s_add_u32 s53, s53, 1
    s_cmp_lt_u32 s53, s61
    s_cbranch_scc1 poll_2
    s_mov_b32 s61, 0
pok_3:
    s_mov_b64 exec, -1
    v_mov_b32 v8, 162832
    v_mov_b32 v9, 1
    s_waitcnt lgkmcnt(0)
    ds_write_b32 v8, v9
CV_w:
    v_mov_b32 v8, 162832
spin_4:
    ds_read_b32 v9, v8
    s_waitcnt lgkmcnt(0)
    v_readfirstlane_b32 s53, v9
    s_nop 0
    s_cmp_ge_u32 s53, 1
    s_cbranch_scc0 spin_4
    buffer_load_dwordx4 v[16:19], v2, s[16:19], 0 offen offset:0 sc1 nt
    buffer_load_dwordx4 v[20:23], v2, s[16:19], 0 offen offset:1024 sc1 nt
    buffer_load_dwordx4 v[24:27], v2, s[16:19], 0 offen offset:2048 sc1 nt
    buffer_load_dwordx4 v[28:31], v2, s[16:19], 0 offen offset:3072 sc1 nt
    s_waitcnt vmcnt(3)
    ds_write_b128 v12, v[16:19] offset:16640
    s_waitcnt vmcnt(2)
    ds_write_b128 v12, v[20:23] offset:18176
    s_waitcnt vmcnt(1)
    ds_write_b128 v12, v[24:27] offset:19712
    s_waitcnt vmcnt(0)
    ds_write_b128 v12, v[28:31] offset:21248
    v_mov_b32 v8, 162836
    v_mov_b32 v9, 1
    s_mov_b64 exec, 1
    ds_add_u32 v8, v9
    s_mov_b64 exec, -1
    s_waitcnt lgkmcnt(0)
    ds_read_b128 v[136:139], v33 offset:21248
    ds_read_b128 v[140:143], v33 offset:19712
    ds_read_b128 v[144:147], v33 offset:18176
    ds_read_b128 v[148:151], v33 offset:16640
    s_waitcnt lgkmcnt(3)
    v_mfma_f32_16x16x32_bf16 v[40:43], v[152:155], v[136:139], 0
    v_mfma_f32_16x16x32_bf16 v[44:47], v[156:159], v[136:139], 0
    s_waitcnt lgkmcnt(2)
    v_mfma_f32_16x16x32_bf16 v[48:51], v[152:155], v[140:143], 0
    v_mfma_f32_16x16x32_bf16 v[52:55], v[156:159], v[140:143], 0
    s_waitcnt lgkmcnt(1)
    v_mfma_f32_16x16x32_bf16 v[56:59], v[152:155], v[144:147], 0
    v_mfma_f32_16x16x32_bf16 v[60:63], v[156:159], v[144:147], 0
    s_waitcnt lgkmcnt(0)
    v_mfma_f32_16x16x32_bf16 v[64:67], v[152:155], v[148:151], 0
    v_mfma_f32_16x16x32_bf16 v[68:71], v[156:159], v[148:151], 0
    s_mov_b32 s43, 0
CV_r:
    s_waitcnt lgkmcnt(0)
    v_mfma_f32_16x16x32_bf16 v[40:43], v[72:75], v[136:139], v[40:43]
    v_mfma_f32_16x16x32_bf16 v[48:51], v[72:75], v[140:143], v[48:51]
    v_mfma_f32_16x16x32_bf16 v[56:59], v[72:75], v[144:147], v[56:59]
    v_mfma_f32_16x16x32_bf16 v[64:67], v[72:75], v[148:151], v[64:67]
    v_mfma_f32_16x16x32_bf16 v[44:47], v[76:79], v[136:139], v[44:47]
    v_mfma_f32_16x16x32_bf16 v[52:55], v[76:79], v[140:143], v[52:55]
    v_mfma_f32_16x16x32_bf16 v[60:63], v[76:79], v[144:147], v[60:63]
    v_mfma_f32_16x16x32_bf16 v[68:71], v[76:79], v[148:151], v[68:71]
    v_mfma_f32_16x16x32_bf16 v[48:51], v[80:83], v[136:139], v[48:51]
    v_mfma_f32_16x16x32_bf16 v[56:59], v[80:83], v[140:143], v[56:59]
    v_mfma_f32_16x16x32_bf16 v[64:67], v[80:83], v[144:147], v[64:67]
    v_mfma_f32_16x16x32_bf16 v[52:55], v[84:87], v[136:139], v[52:55]
    v_mfma_f32_16x16x32_bf16 v[60:63], v[84:87], v[140:143], v[60:63]
    v_mfma_f32_16x16x32_bf16 v[68:71], v[84:87], v[144:147], v[68:71]
    v_mfma_f32_16x16x32_bf16 v[56:59], v[88:91], v[136:139], v[56:59]
    v_mfma_f32_16x16x32_bf16 v[64:67], v[88:91], v[140:143], v[64:67]
    v_mfma_f32_16x16x32_bf16 v[60:63], v[92:95], v[136:139], v[60:63]
    v_mfma_f32_16x16x32_bf16 v[68:71], v[92:95], v[140:143], v[68:71]
    v_mfma_f32_16x16x32_bf16 v[64:67], v[96:99], v[136:139], v[64:67]
    v_mfma_f32_16x16x32_bf16 v[68:71], v[100:103], v[136:139], v[68:71]
    ds_read_b128 v[152:155], v33 offset:21344
    ds_read_b128 v[156:159], v33 offset:19808
    ds_read_b128 v[160:163], v33 offset:18272
    ds_read_b128 v[164:167], v33 offset:16736
    ds_read_b64 v[104:105], v32 offset:64
    ds_read_b64 v[106:107], v32 offset:72
    ds_read_b64 v[108:109], v32 offset:96
    ds_read_b64 v[110:111], v32 offset:104
    ds_read_b64 v[112:113], v32 offset:1088
    ds_read_b64 v[114:115], v32 offset:1096
    ds_read_b64 v[116:117], v32 offset:1120
    ds_read_b64 v[118:119], v32 offset:1128
    ds_read_b64 v[120:121], v32 offset:2112
    ds_read_b64 v[122:123], v32 offset:2120
    ds_read_b64 v[124:125], v32 offset:2144
    ds_read_b64 v[126:127], v32 offset:2152
    ds_read_b64 v[128:129], v32 offset:3136
    ds_read_b64 v[130:131], v32 offset:3144
    ds_read_b64 v[132:133], v32 offset:3168
    ds_read_b64 v[134:135], v32 offset:3176
    s_waitcnt lgkmcnt(0)
    v_mfma_f32_16x16x32_bf16 v[40:43], v[104:107], v[152:155], v[40:43]
    v_mfma_f32_16x16x32_bf16 v[48:51], v[104:107], v[156:159], v[48:51]
    v_mfma_f32_16x16x32_bf16 v[56:59], v[104:107], v[160:163], v[56:59]
    v_mfma_f32_16x16x32_bf16 v[64:67], v[104:107], v[164:167], v[64:67]
    v_mfma_f32_16x16x32_bf16 v[44:47], v[108:111], v[152:155], v[44:47]
    v_mfma_f32_16x16x32_bf16 v[52:55], v[108:111], v[156:159], v[52:55]
    v_mfma_f32_16x16x32_bf16 v[60:63], v[108:111], v[160:163], v[60:63]
    v_mfma_f32_16x16x32_bf16 v[68:71], v[108:111], v[164:167], v[68:71]
    v_mfma_f32_16x16x32_bf16 v[48:51], v[112:115], v[152:155], v[48:51]
    v_mfma_f32_16x16x32_bf16 v[56:59], v[112:115], v[156:159], v[56:59]
    v_mfma_f32_16x16x32_bf16 v[64:67], v[112:115], v[160:163], v[64:67]
    v_mfma_f32_16x16x32_bf16 v[52:55], v[116:119], v[152:155], v[52:55]
    v_mfma_f32_16x16x32_bf16 v[60:63], v[116:119], v[156:159], v[60:63]
    v_mfma_f32_16x16x32_bf16 v[68:71], v[116:119], v[160:163], v[68:71]
    v_mfma_f32_16x16x32_bf16 v[56:59], v[120:123], v[152:155], v[56:59]
    v_mfma_f32_16x16x32_bf16 v[64:67], v[120:123], v[156:159], v[64:67]
    v_mfma_f32_16x16x32_bf16 v[60:63], v[124:127], v[152:155], v[60:63]
    v_mfma_f32_16x16x32_bf16 v[68:71], v[124:127], v[156:159], v[68:71]
    v_mfma_f32_16x16x32_bf16 v[64:67], v[128:131], v[152:155], v[64:67]
    v_mfma_f32_16x16x32_bf16 v[68:71], v[132:135], v[152:155], v[68:71]
    ds_read_b128 v[136:139], v33 offset:21440
    ds_read_b128 v[140:143], v33 offset:19904
    ds_read_b128 v[144:147], v33 offset:18368
    ds_read_b128 v[148:151], v33 offset:16832
    ds_read_b64 v[72:73], v32 offset:128
    ds_read_b64 v[74:75], v32 offset:136
    ds_read_b64 v[76:77], v32 offset:160
    ds_read_b64 v[78:79], v32 offset:168
    ds_read_b64 v[80:81], v32 offset:1152
    ds_read_b64 v[82:83], v32 offset:1160
    ds_read_b64 v[84:85], v32 offset:1184
    ds_read_b64 v[86:87], v32 offset:1192
    ds_read_b64 v[88:89], v32 offset:2176
    ds_read_b64 v[90:91], v32 offset:2184
    ds_read_b64 v[92:93], v32 offset:2208
    ds_read_b64 v[94:95], v32 offset:2216
    ds_read_b64 v[96:97], v32 offset:3200
    ds_read_b64 v[98:99], v32 offset:3208
    ds_read_b64 v[100:101], v32 offset:3232
    ds_read_b64 v[102:103], v32 offset:3240
    v_add_u32 v32, 128, v32
    v_add_u32 v33, 192, v33
    s_add_u32 s43, s43, 1
    s_cmp_lt_u32 s43, 4
    s_cbranch_scc1 CV_r
CV_l:
    s_waitcnt lgkmcnt(10)
    v_mfma_f32_16x16x32_bf16 v[40:43], v[72:75], v[136:139], v[40:43]
    ds_read_b128 v[152:155], v33 offset:21344
    v_mfma_f32_16x16x32_bf16 v[48:51], v[72:75], v[140:143], v[48:51]
    ds_read_b128 v[156:159], v33 offset:19808
    s_cmp_eq_u32 s43, 5
    v_mfma_f32_16x16x32_bf16 v[56:59], v[72:75], v[144:147], v[56:59]
    ds_read_b128 v[160:163], v33 offset:18272
    s_cselect_b64 exec, 1, 0
    buffer_load_dword v12, v35, s[56:59], s45 offen sc1
    s_mov_b64 exec, -1
    v_mfma_f32_16x16x32_bf16 v[64:67], v[72:75], v[148:151], v[64:67]
    ds_read_b128 v[164:167], v33 offset:16736
    v_mfma_f32_16x16x32_bf16 v[44:47], v[76:79], v[136:139], v[44:47]
    ds_read_b64 v[104:105], v32 offset:64
    v_mfma_f32_16x16x32_bf16 v[52:55], v[76:79], v[140:143], v[52:55]
    ds_read_b64 v[106:107], v32 offset:72
    v_mfma_f32_16x16x32_bf16 v[60:63], v[76:79], v[144:147], v[60:63]
    ds_read_b64 v[108:109], v32 offset:96
    v_mfma_f32_16x16x32_bf16 v[68:71], v[76:79], v[148:151], v[68:71]
    ds_read_b64 v[110:111], v32 offset:104
    v_mfma_f32_16x16x32_bf16 v[48:51], v[80:83], v[136:139], v[48:51]
    ds_read_b64 v[112:113], v32 offset:1088
    v_mfma_f32_16x16x32_bf16 v[56:59], v[80:83], v[140:143], v[56:59]
    ds_read_b64 v[114:115], v32 offset:1096
    s_waitcnt lgkmcnt(10)
    v_mfma_f32_16x16x32_bf16 v[64:67], v[80:83], v[144:147], v[64:67]
    ds_read_b64 v[116:117], v32 offset:1120
    v_mfma_f32_16x16x32_bf16 v[52:55], v[84:87], v[136:139], v[52:55]
    ds_read_b64 v[118:119], v32 offset:1128
    v_mfma_f32_16x16x32_bf16 v[60:63], v[84:87], v[140:143], v[60:63]
    ds_read_b64 v[120:121], v32 offset:2112
    v_mfma_f32_16x16x32_bf16 v[68:71], v[84:87], v[144:147], v[68:71]
    ds_read_b64 v[122:123], v32 offset:2120
    v_mfma_f32_16x16x32_bf16 v[56:59], v[88:91], v[136:139], v[56:59]
    ds_read_b64 v[124:125], v32 offset:2144
    v_mfma_f32_16x16x32_bf16 v[64:67], v[88:91], v[140:143], v[64:67]
    ds_read_b64 v[126:127], v32 offset:2152
    v_mfma_f32_16x16x32_bf16 v[60:63], v[92:95], v[136:139], v[60:63]
    ds_read_b64 v[128:129], v32 offset:3136
    v_mfma_f32_16x16x32_bf16 v[68:71], v[92:95], v[140:143], v[68:71]
    ds_read_b64 v[130:131], v32 offset:3144
    v_mfma_f32_16x16x32_bf16 v[64:67], v[96:99], v[136:139], v[64:67]
    ds_read_b64 v[132:133], v32 offset:3168
    v_mfma_f32_16x16x32_bf16 v[68:71], v[100:103], v[136:139], v[68:71]
    ds_read_b64 v[134:135], v32 offset:3176
    s_waitcnt lgkmcnt(10)
    v_mfma_f32_16x16x32_bf16 v[40:43], v[104:107], v[152:155], v[40:43]
    ds_read_b128 v[136:139], v33 offset:21440
    v_mfma_f32_16x16x32_bf16 v[48:51], v[104:107], v[156:159], v[48:51]
    ds_read_b128 v[140:143], v33 offset:19904
    v_mfma_f32_16x16x32_bf16 v[56:59], v[104:107], v[160:163], v[56:59]
    ds_read_b128 v[144:147], v33 offset:18368
    v_mfma_f32_16x16x32_bf16 v[64:67], v[104:107], v[164:167], v[64:67]
    ds_read_b128 v[148:151], v33 offset:16832
    v_mfma_f32_16x16x32_bf16 v[44:47], v[108:111], v[152:155], v[44:47]
    ds_read_b64 v[72:73], v32 offset:128
    v_mfma_f32_16x16x32_bf16 v[52:55], v[108:111], v[156:159], v[52:55]
    ds_read_b64 v[74:75], v32 offset:136
    v_add_u32 v33, 192, v33
    v_mfma_f32_16x16x32_bf16 v[60:63], v[108:111], v[160:163], v[60:63]
    ds_read_b64 v[76:77], v32 offset:160
    s_add_u32 s43, s43, 1
    v_mfma_f32_16x16x32_bf16 v[68:71], v[108:111], v[164:167], v[68:71]
    ds_read_b64 v[78:79], v32 offset:168
    s_cmp_lt_u32 s43, 8
    v_mfma_f32_16x16x32_bf16 v[48:51], v[112:115], v[152:155], v[48:51]
    ds_read_b64 v[80:81], v32 offset:1152
    v_mfma_f32_16x16x32_bf16 v[56:59], v[112:115], v[156:159], v[56:59]
    ds_read_b64 v[82:83], v32 offset:1160
    s_waitcnt lgkmcnt(10)
    v_mfma_f32_16x16x32_bf16 v[64:67], v[112:115], v[160:163], v[64:67]
    ds_read_b64 v[84:85], v32 offset:1184
    v_mfma_f32_16x16x32_bf16 v[52:55], v[116:119], v[152:155], v[52:55]
    ds_read_b64 v[86:87], v32 offset:1192
    v_mfma_f32_16x16x32_bf16 v[60:63], v[116:119], v[156:159], v[60:63]
    ds_read_b64 v[88:89], v32 offset:2176
    v_mfma_f32_16x16x32_bf16 v[68:71], v[116:119], v[160:163], v[68:71]
    ds_read_b64 v[90:91], v32 offset:2184
    v_mfma_f32_16x16x32_bf16 v[56:59], v[120:123], v[152:155], v[56:59]
    ds_read_b64 v[92:93], v32 offset:2208
    v_mfma_f32_16x16x32_bf16 v[64:67], v[120:123], v[156:159], v[64:67]
    ds_read_b64 v[94:95], v32 offset:2216
    v_mfma_f32_16x16x32_bf16 v[60:63], v[124:127], v[152:155], v[60:63]
    ds_read_b64 v[96:97], v32 offset:3200
    v_mfma_f32_16x16x32_bf16 v[68:71], v[124:127], v[156:159], v[68:71]
    ds_read_b64 v[98:99], v32 offset:3208
    v_mfma_f32_16x16x32_bf16 v[64:67], v[128:131], v[152:155], v[64:67]
    ds_read_b64 v[100:101], v32 offset:3232
    v_mfma_f32_16x16x32_bf16 v[68:71], v[132:135], v[152:155], v[68:71]
    ds_read_b64 v[102:103], v32 offset:3240
    v_add_u32 v32, 128, v32
    s_cbranch_scc1 CV_l
    v_cvt_pk_bf16_f32 v16, v40, v41
    v_cvt_pk_bf16_f32 v17, v42, v43
    ds_write_b64 v170, v[16:17] offset:0
    v_cvt_pk_bf16_f32 v18, v44, v45
    v_cvt_pk_bf16_f32 v19, v46, v47
    ds_write_b64 v170, v[18:19] offset:32
    v_cvt_pk_bf16_f32 v20, v48, v49
    v_cvt_pk_bf16_f32 v21, v50, v51
    ds_write_b64 v170, v[20:21] offset:1152
    v_cvt_pk_bf16_f32 v22, v52, v53
    v_cvt_pk_bf16_f32 v23, v54, v55
    ds_write_b64 v170, v[22:23] offset:1184
    v_cvt_pk_bf16_f32 v24, v56, v57
    v_cvt_pk_bf16_f32 v25, v58, v59
    ds_write_b64 v170, v[24:25] offset:2304
    v_cvt_pk_bf16_f32 v26, v60, v61
    v_cvt_pk_bf16_f32 v27, v62, v63
    ds_write_b64 v170, v[26:27] offset:2336
    v_cvt_pk_bf16_f32 v28, v64, v65
    v_cvt_pk_bf16_f32 v29, v66, v67
    ds_write_b64 v170, v[28:29] offset:3456
    v_cvt_pk_bf16_f32 v30, v68, v69
    v_cvt_pk_bf16_f32 v31, v70, v71
    ds_write_b64 v170, v[30:31] offset:3488
    s_mov_b64 exec, 1
    ds_add_u32 v34, v7
    s_mov_b64 exec, -1
    s_mov_b32 s53, 0
    s_waitcnt vmcnt(0)
CV_v:
    v_readfirstlane_b32 s94, v12
    s_nop 0
    s_sub_u32 s94, s94, s52
    s_and_b32 s37, s94, 0xfffffe01
    s_cbranch_scc0 CV_k
    buffer_load_dword v12, v35, s[56:59], s45 offen sc1
    s_waitcnt vmcnt(0)
    s_add_u32 s53, s53, 1
    s_cmp_lt_u32 s53, s61
    s_cbranch_scc1 CV_v
    s_mov_b32 s61, 0
    s_mov_b32 s94, 0
CV_k:
    s_lshr_b32 s94, s94, 1
    s_add_u32 s37, s94, 65536
    v_mov_b32 v8, 162844
    v_mov_b32 v9, s37
    ds_write_b32 v8, v9
    s_cmp_gt_u32 s94, 10
    s_cselect_b32 s37, 0x2000, 0
    s_xor_b32 s44, s44, s37
    s_xor_b32 s45, s47, s37
    s_add_u32 s45, s45, 23101440
    v_mov_b32 v8, 162824
spin_5:
    ds_read_b32 v9, v8
    s_waitcnt lgkmcnt(0)
    v_readfirstlane_b32 s53, v9
    s_nop 0
    s_cmp_ge_u32 s53, 6
    s_cbranch_scc0 spin_5
    ds_read_b64_tr_b16 v[104:105], v168 offset:0
    ds_read_b64_tr_b16 v[106:107], v168 offset:32
    ds_read_b64_tr_b16 v[108:109], v168 offset:288
    ds_read_b64_tr_b16 v[110:111], v168 offset:320
    ds_read_b64_tr_b16 v[112:113], v168 offset:576
    ds_read_b64_tr_b16 v[114:115], v168 offset:608
    ds_read_b64_tr_b16 v[116:117], v168 offset:864
    ds_read_b64_tr_b16 v[118:119], v168 offset:896
    s_waitcnt lgkmcnt(6)
    v_or_b32 v104, 1, v104
    buffer_store_dwordx4 v[104:107], v169, s[12:15], s44 offen sc1
    s_add_u32 s44, s44, 16777216
    s_waitcnt lgkmcnt(4)
    v_or_b32 v108, 1, v108
    buffer_store_dwordx4 v[108:111], v169, s[12:15], s44 offen sc1
    s_add_u32 s44, s44, 16777216
    s_waitcnt lgkmcnt(2)
    v_or_b32 v112, 1, v112
    buffer_store_dwordx4 v[112:115], v169, s[12:15], s44 offen sc1
    s_add_u32 s44, s44, 16777216
    s_waitcnt lgkmcnt(0)
    v_or_b32 v116, 1, v116
    buffer_store_dwordx4 v[116:119], v169, s[12:15], s44 offen sc1
    s_add_u32 s44, s44, 16777216
    v_mov_b32 v8, 162836
    v_mov_b32 v9, 1
    s_mov_b64 exec, 1
    ds_add_u32 v8, v9
    s_mov_b64 exec, -1
    s_mov_b64 exec, 0xf
    s_waitcnt vmcnt(0)
    buffer_atomic_add v7, v6, s[56:59], s45 offen sc1
    s_mov_b64 exec, -1
    s_branch FR_end
FR_b:
    s_cmp_ge_u32 s2, 32
    s_cbranch_scc1 FB_np
    s_cmp_lg_u32 s30, 5
    s_cbranch_scc1 FB_np
    s_and_b32 s42, s2, 7
    s_lshl_b32 s42, s42, 10
    s_lshr_b32 s43, s2, 3
    s_lshl_b32 s43, s43, 14
    s_add_u32 s42, s42, s43
    s_add_u32 s42, s42, 39714816
    v_mov_b32 v14, 0
    s_mov_b64 exec, 1
    s_mov_b32 s46, -1
    s_mov_b32 s47, -1
    s_add_u32 s48, s4, s42
    s_addc_u32 s49, s5, 0
    s_load_dword s101, s[48:49], 384
    s_waitcnt lgkmcnt(0)
    s_memtime s[34:35]
    s_waitcnt lgkmcnt(0)
    s_load_dword s101, s[48:49], 0
    s_waitcnt lgkmcnt(0)
    s_memtime s[36:37]
    s_waitcnt lgkmcnt(0)
    s_sub_u32 s43, s36, s34
    s_min_u32 s46, s46, s43
    s_load_dword s101, s[48:49], 8192
    s_waitcnt lgkmcnt(0)
    s_memtime s[34:35]
    s_waitcnt lgkmcnt(0)
    s_sub_u32 s43, s34, s36
    s_min_u32 s47, s47, s43
    s_load_dword s101, s[48:49], 128
    s_waitcnt lgkmcnt(0)
    s_memtime s[36:37]
    s_waitcnt lgkmcnt(0)
    s_sub_u32 s43, s36, s34
    s_min_u32 s46, s46, s43
    s_load_dword s101, s[48:49], 8320
    s_waitcnt lgkmcnt(0)
    s_memtime s[34:35]
    s_waitcnt lgkmcnt(0)
    s_sub_u32 s43, s34, s36
    s_min_u32 s47, s47, s43
    s_cmp_lt_u32 s47, s46
    s_cselect_b32 s45, 1, 0
    s_lshr_b32 s46, s28, 2
    s_xor_b32 s45, s45, s46
    s_and_b32 s45, s45, 1
    s_lshl_b32 s45, s45, 8
    s_or_b32 s43, s45, 1
    v_mov_b32 v12, s43
    buffer_atomic_add v12, v14, s[84:87], 0 offen offset:4 sc0 sc1
    s_waitcnt vmcnt(0)
    v_readfirstlane_b32 s36, v12
    s_nop 0
    s_add_u32 s36, s36, s43
    s_and_b32 s37, s36, 255
    s_cmp_lg_u32 s37, 21
    s_cbranch_scc1 FB_np
    s_lshr_b32 s36, s36, 8
    s_lshl_b32 s36, s36, 1
    s_add_u32 s36, s36, s52
    s_bfm_b64 exec, 32, 0
    v_mov_b32 v12, s36
    v_lshlrev_b32 v13, 7, v1
    s_mov_b32 s36, 23117824
    buffer_store_dword v12, v13, s[56:59], s36 offen sc1
FB_np:
    s_mov_b64 exec, -1
    s_getpc_b64 s[34:35]
K_tpc:
    s_lshl_b32 s36, s29, 2
    s_and_b32 s37, s28, 3
    s_add_u32 s36, s36, s37
    s_lshl_b32 s36, s36, 6
    s_add_u32 s36, s36, K_tab-K_tpc
    s_add_u32 s34, s34, s36
    s_addc_u32 s35, s35, 0
    v_and_b32 v248, 31, v1
    v_lshlrev_b32 v248, 1, v248
    global_load_ushort v251, v248, s[34:35]
    v_lshrrev_b32 v253, 3, v1
    v_lshlrev_b32 v238, 11, v253
    v_and_b32 v253, 6, v253
    v_and_b32 v254, 7, v1
    v_xor_b32 v253, v253, v254
    v_lshl_add_u32 v238, v253, 4, v238
    v_lshrrev_b32 v253, 4, v1
    v_lshlrev_b32 v239, 11, v253
    v_add_u32 v253, 0, v253
    v_lshlrev_b32 v253, 1, v253
    v_and_b32 v254, 15, v1
    v_xor_b32 v253, v253, v254
    v_lshl_add_u32 v239, v253, 4, v239
    v_lshrrev_b32 v253, 4, v1
    v_lshlrev_b32 v240, 11, v253
    v_add_u32 v253, 4, v253
    v_lshlrev_b32 v253, 1, v253
    v_and_b32 v254, 15, v1
    v_xor_b32 v253, v253, v254
    v_lshl_add_u32 v240, v253, 4, v240
    v_add_u32 v254, 0, v1
    v_mul_u32_u24 v253, 2341, v254
    v_lshrrev_b32 v253, 16, v253
    v_mul_u32_u24 v241, 28, v253
    v_sub_u32 v254, v254, v241
    v_mul_u32_u24 v241, 7168, v253
    v_lshrrev_b32 v253, 1, v253
    v_and_b32 v253, 2, v253
    v_xor_b32 v254, v254, v253
    v_lshl_add_u32 v241, v254, 4, v241
    v_add_u32 v254, 64, v1
    v_mul_u32_u24 v253, 2341, v254
    v_lshrrev_b32 v253, 16, v253
    v_mul_u32_u24 v242, 28, v253
    v_sub_u32 v254, v254, v242
    v_mul_u32_u24 v242, 7168, v253
    v_lshrrev_b32 v253, 1, v253
    v_and_b32 v253, 2, v253
    v_xor_b32 v254, v254, v253
    v_lshl_add_u32 v242, v254, 4, v242
    v_add_u32 v254, 128, v1
    v_mul_u32_u24 v253, 2341, v254
    v_lshrrev_b32 v253, 16, v253
    v_mul_u32_u24 v243, 28, v253
    v_sub_u32 v254, v254, v243
    v_mul_u32_u24 v243, 7168, v253
    v_lshrrev_b32 v253, 1, v253
    v_and_b32 v253, 2, v253
    v_xor_b32 v254, v254, v253
    v_lshl_add_u32 v243, v254, 4, v243
    v_add_u32 v254, 192, v1
    v_mul_u32_u24 v253, 2341, v254
    v_lshrrev_b32 v253, 16, v253
    v_mul_u32_u24 v244, 28, v253
    v_sub_u32 v254, v254, v244
    v_mul_u32_u24 v244, 7168, v253
    v_lshrrev_b32 v253, 1, v253
    v_and_b32 v253, 2, v253
    v_xor_b32 v254, v254, v253
    v_lshl_add_u32 v244, v254, 4, v244
    v_add_u32 v254, 256, v1
    v_mul_u32_u24 v253, 2341, v254
    v_lshrrev_b32 v253, 16, v253
    v_mul_u32_u24 v245, 28, v253
    v_sub_u32 v254, v254, v245
    v_mul_u32_u24 v245, 7168, v253
    v_lshrrev_b32 v253, 1, v253
    v_and_b32 v253, 2, v253
    v_xor_b32 v254, v254, v253
    v_lshl_add_u32 v245, v254, 4, v245
    v_add_u32 v254, 320, v1
    v_mul_u32_u24 v253, 2341, v254
    v_lshrrev_b32 v253, 16, v253
    v_mul_u32_u24 v246, 28, v253
    v_sub_u32 v254, v254, v246
    v_mul_u32_u24 v246, 7168, v253
    v_lshrrev_b32 v253, 1, v253
    v_and_b32 v253, 2, v253
    v_xor_b32 v254, v254, v253
    v_lshl_add_u32 v246, v254, 4, v246
    v_add_u32 v254, 384, v1
    v_mul_u32_u24 v253, 2341, v254
    v_lshrrev_b32 v253, 16, v253
    v_mul_u32_u24 v247, 28, v253
    v_sub_u32 v254, v254, v247
    v_mul_u32_u24 v247, 7168, v253
    v_lshrrev_b32 v253, 1, v253
    v_and_b32 v253, 2, v253
    v_xor_b32 v254, v254, v253
    v_lshl_add_u32 v247, v254, 4, v247
    s_cmp_ge_u32 s30, 6
    s_cbranch_scc1 FB_cs
    s_cmp_lg_u32 s30, 4
    s_cbranch_scc1 FB_ni
    v_mov_b32 v12, s52
    s_lshr_b32 s53, s28, 3
    s_lshl_b32 s53, s53, 2
    s_and_b32 s54, s28, 3
    s_add_u32 s53, s53, s54
    s_lshl_b32 s53, s53, 24
    s_lshr_b32 s54, s28, 2
    s_xor_b32 s54, s54, s94
    s_and_b32 s54, s54, 1
    s_lshl_b32 s54, s54, 13
    s_add_u32 s37, s53, s54
    s_add_u32 s37, s37, 33554432
    s_andn2_b32 s37, s37, 0x2000
    s_lshl_b32 s53, s29, 7
    s_add_u32 s37, s37, s53
    s_add_u32 s37, s37, 6029312
    v_and_b32 v13, 1, v1
    v_lshlrev_b32 v13, 13, v13
    v_lshrrev_b32 v14, 1, v1
    v_lshl_add_u32 v13, v14, 22, v13
    s_mov_b64 exec, 0xf
    buffer_store_dword v12, v13, s[56:59], s37 offen sc1
    s_cmp_lg_u32 s28, 0
    s_cbranch_scc1 FB_n2
    s_add_u32 s37, s53, 23121920
    s_mov_b64 exec, 1
    buffer_store_dword v12, v13, s[56:59], s37 offen sc1
FB_n2:
    s_mov_b64 exec, -1
FB_ni:
    s_waitcnt vmcnt(0)
    v_bfe_u32 v252, v251, 2, 2
    v_lshlrev_b32 v248, 14, v252
    v_and_b32 v252, 3, v251
    v_lshl_add_u32 v248, v252, 11, v248
    v_bfe_u32 v252, v251, 7, 3
    v_lshlrev_b32 v249, 14, v252
    v_bfe_u32 v252, v251, 4, 3
    v_lshl_add_u32 v249, v252, 10, v249
    v_bfe_u32 v252, v251, 13, 3
    v_lshlrev_b32 v250, 14, v252
    v_bfe_u32 v252, v251, 10, 3
    v_lshl_add_u32 v250, v252, 10, v250
    v_mov_b32 v6, 162836
spin_7:
    s_sleep 2
    ds_read_b32 v7, v6
    s_waitcnt lgkmcnt(0)
    v_readfirstlane_b32 s53, v7
    s_nop 0
    s_cmp_ge_u32 s53, 4
    s_cbranch_scc0 spin_7
    s_load_dwordx2 s[48:49], s[0:1], 64
    s_lshl_b32 s45, s2, 1
    s_and_b32 s50, s30, 1
    s_add_u32 s45, s45, s50
    s_mul_i32 s45, s45, 4096
    s_mov_b32 s50, 2097152
    s_mov_b32 s51, 0x20000
    s_waitcnt lgkmcnt(0)
    buffer_load_dwordx4 v[20:23], v2, s[48:51], s45 offen offset:0
    buffer_load_dwordx4 v[20:23], v2, s[48:51], s45 offen offset:1024
    buffer_load_dwordx4 v[20:23], v2, s[48:51], s45 offen offset:2048
    buffer_load_dwordx4 v[20:23], v2, s[48:51], s45 offen offset:3072
    v_mov_b32 v6, 1
    v_mov_b32 v7, 162824
    s_mov_b64 exec, 1
    s_waitcnt vmcnt(0)
    ds_add_u32 v7, v6
    s_mov_b64 exec, -1
    v_mov_b32 v6, 162840
spin_9:
    s_sleep 4
    ds_read_b32 v7, v6
    s_waitcnt lgkmcnt(0)
    v_readfirstlane_b32 s53, v7
    s_nop 0
    s_cmp_ge_u32 s53, 2
    s_cbranch_scc0 spin_9
    s_call_b64 s[76:77], SUB_w1_regs
    s_call_b64 s[76:77], SUB_park
    v_mov_b32 v6, 162840
spin_10:
    s_sleep 3
    ds_read_b32 v7, v6
    s_waitcnt lgkmcnt(0)
    v_readfirstlane_b32 s53, v7
    s_nop 0
    s_cmp_ge_u32 s53, 4
    s_cbranch_scc0 spin_10
    s_mov_b64 s[12:13], s[68:69]
    s_mov_b32 s14, 2097152
    s_mov_b32 s15, 0x20000
    s_and_b32 s35, s30, 1
    s_mul_i32 s38, s99, 128
    s_mul_i32 s41, s35, 65536
    s_add_u32 s38, s38, s41
    s_mul_i32 s41, s35, 4096
    s_add_u32 s41, s41, 24576
    s_mov_b32 s42, 0
    s_mov_b32 s44, s67
    s_mov_b32 s42, 73728
    s_mov_b32 s44, s67
    s_add_u32 s44, s44, 9
    s_and_b32 s44, s44, 15
    s_call_b64 s[76:77], SUB_w_issue_1
    s_waitcnt vmcnt(8)
    s_mov_b32 s42, 81920
    s_mov_b32 s44, s67
    s_add_u32 s44, s44, 10
    s_and_b32 s44, s44, 15
    s_call_b64 s[76:77], SUB_w_issue_1
    s_waitcnt vmcnt(8)
    s_mov_b32 s42, 90112
    s_mov_b32 s44, s67
    s_add_u32 s44, s44, 11
    s_and_b32 s44, s44, 15
    s_call_b64 s[76:77], SUB_w_issue_1
    s_waitcnt vmcnt(8)
    s_and_b32 s36, s29, 6
    s_cmp_eq_u32 s36, 2
    s_cbranch_scc1 pr_11
    s_call_b64 s[76:77], SUB_park2
pr_11:
    s_call_b64 s[76:77], SUB_w1_put
    s_branch FR_end
FB_cs:
    v_and_b32 v164, 15, v1
    v_mov_b32 v165, 0x3f803f80
    v_cmp_eq_u32 vcc, 0, v164
    s_nop 1
    v_cndmask_b32 v16, 0, v165, vcc
    v_cndmask_b32 v17, 0, v165, vcc
    v_cndmask_b32 v18, 0, v165, vcc
    v_cndmask_b32 v19, 0, v165, vcc
    v_cmp_eq_u32 vcc, 1, v164
    s_nop 1
    v_cndmask_b32 v20, 0, v165, vcc
    v_cndmask_b32 v21, 0, v165, vcc
    v_cndmask_b32 v22, 0, v165, vcc
    v_cndmask_b32 v23, 0, v165, vcc
    v_cmp_eq_u32 vcc, 2, v164
    s_nop 1
    v_cndmask_b32 v24, 0, v165, vcc
    v_cndmask_b32 v25, 0, v165, vcc
    v_cndmask_b32 v26, 0, v165, vcc
    v_cndmask_b32 v27, 0, v165, vcc
    v_cmp_eq_u32 vcc, 3, v164
    s_nop 1
    v_cndmask_b32 v28, 0, v165, vcc
    v_cndmask_b32 v29, 0, v165, vcc
    v_cndmask_b32 v30, 0, v165, vcc
    v_cndmask_b32 v31, 0, v165, vcc
    v_cmp_eq_u32 vcc, 4, v164
    s_nop 1
    v_cndmask_b32 v32, 0, v165, vcc
    v_cndmask_b32 v33, 0, v165, vcc
    v_cndmask_b32 v34, 0, v165, vcc
    v_cndmask_b32 v35, 0, v165, vcc
    v_cmp_eq_u32 vcc, 5, v164
    s_nop 1
    v_cndmask_b32 v36, 0, v165, vcc
    v_cndmask_b32 v37, 0, v165, vcc
    v_cndmask_b32 v38, 0, v165, vcc
    v_cndmask_b32 v39, 0, v165, vcc
    v_cmp_eq_u32 vcc, 6, v164
    s_nop 1
    v_cndmask_b32 v40, 0, v165, vcc
    v_cndmask_b32 v41, 0, v165, vcc
    v_cndmask_b32 v42, 0, v165, vcc
    v_cndmask_b32 v43, 0, v165, vcc
    v_cmp_eq_u32 vcc, 7, v164
    s_nop 1
    v_cndmask_b32 v44, 0, v165, vcc
    v_cndmask_b32 v45, 0, v165, vcc
    v_cndmask_b32 v46, 0, v165, vcc
    v_cndmask_b32 v47, 0, v165, vcc
    v_cmp_eq_u32 vcc, 8, v164
    s_nop 1
    v_cndmask_b32 v48, 0, v165, vcc
    v_cndmask_b32 v49, 0, v165, vcc
    v_cndmask_b32 v50, 0, v165, vcc
    v_cndmask_b32 v51, 0, v165, vcc
    v_cmp_eq_u32 vcc, 9, v164
    s_nop 1
    v_cndmask_b32 v52, 0, v165, vcc
    v_cndmask_b32 v53, 0, v165, vcc
    v_cndmask_b32 v54, 0, v165, vcc
    v_cndmask_b32 v55, 0, v165, vcc
    v_cmp_eq_u32 vcc, 10, v164
    s_nop 1
    v_cndmask_b32 v56, 0, v165, vcc
    v_cndmask_b32 v57, 0, v165, vcc
    v_cndmask_b32 v58, 0, v165, vcc
    v_cndmask_b32 v59, 0, v165, vcc
    v_cmp_eq_u32 vcc, 11, v164
    s_nop 1
    v_cndmask_b32 v60, 0, v165, vcc
    v_cndmask_b32 v61, 0, v165, vcc
    v_cndmask_b32 v62, 0, v165, vcc
    v_cndmask_b32 v63, 0, v165, vcc
    v_cmp_eq_u32 vcc, 12, v164
    s_nop 1
    v_cndmask_b32 v64, 0, v165, vcc
    v_cndmask_b32 v65, 0, v165, vcc
    v_cndmask_b32 v66, 0, v165, vcc
    v_cndmask_b32 v67, 0, v165, vcc
    v_cmp_eq_u32 vcc, 13, v164
    s_nop 1
    v_cndmask_b32 v68, 0, v165, vcc
    v_cndmask_b32 v69, 0, v165, vcc
    v_cndmask_b32 v70, 0, v165, vcc
    v_cndmask_b32 v71, 0, v165, vcc
    s_mov_b32 s35, 0
    v_lshrrev_b32 v253, 2, v1
    v_mul_u32_u24 v144, 128, v253
    v_and_b32 v254, 3, v1
    v_lshl_add_u32 v144, v254, 3, v144
    v_add_u32 v144, 24576, v144
    v_bfe_u32 v253, v253, 1, 2
    s_mul_i32 s36, s35, 4
    s_add_u32 s36, s36, 3
    v_xor_b32 v254, s36, v253
    v_lshl_add_u32 v147, v254, 5, v144
    s_mul_i32 s36, s35, 4
    s_add_u32 s36, s36, 2
    v_xor_b32 v254, s36, v253
    v_lshl_add_u32 v146, v254, 5, v144
    s_mul_i32 s36, s35, 4
    s_add_u32 s36, s36, 1
    v_xor_b32 v254, s36, v253
    v_lshl_add_u32 v145, v254, 5, v144
    s_mul_i32 s36, s35, 4
    s_add_u32 s36, s36, 0
    v_xor_b32 v254, s36, v253
    v_lshl_add_u32 v144, v254, 5, v144
    s_and_b32 s35, s30, 1
    s_mul_i32 s35, s35, 4096
    s_add_u32 s35, s35, 73728
    v_add_u32 v144, s35, v144
    v_add_u32 v145, s35, v145
    v_add_u32 v146, s35, v146
    v_add_u32 v147, s35, v147
    s_mov_b32 s35, 0
    v_lshrrev_b32 v253, 2, v1
    v_mul_u32_u24 v148, 448, v253
    v_and_b32 v254, 3, v1
    v_lshl_add_u32 v148, v254, 3, v148
    v_add_u32 v148, 73728, v148
    s_mul_i32 s36, s35, 224
    v_add_u32 v148, s36, v148
    v_bfe_u32 v253, v1, 4, 1
    v_lshlrev_b32 v253, 5, v253
    s_cmp_eq_u32 s35, 0
    s_cselect_b32 s36, 1, -1
    v_mul_lo_u32 v253, v253, s36
    v_sub_u32 v149, v148, v253
    v_add_u32 v148, v148, v253
    s_and_b32 s35, s30, 1
    s_mul_i32 s35, s35, 14336
    s_add_u32 s35, s35, 32768
    v_add_u32 v148, s35, v148
    v_add_u32 v149, s35, v149
    s_mov_b32 s35, 1
    v_lshrrev_b32 v253, 2, v1
    v_mul_u32_u24 v150, 448, v253
    v_and_b32 v254, 3, v1
    v_lshl_add_u32 v150, v254, 3, v150
    v_add_u32 v150, 73728, v150
    s_mul_i32 s36, s35, 224
    v_add_u32 v150, s36, v150
    v_bfe_u32 v253, v1, 4, 1
    v_lshlrev_b32 v253, 5, v253
    s_cmp_eq_u32 s35, 0
    s_cselect_b32 s36, 1, -1
    v_mul_lo_u32 v253, v253, s36
    v_sub_u32 v151, v150, v253
    v_add_u32 v150, v150, v253
    s_and_b32 s35, s30, 1
    s_mul_i32 s35, s35, 14336
    s_add_u32 s35, s35, 32768
    v_add_u32 v150, s35, v150
    v_add_u32 v151, s35, v151
    v_mov_b32 v156, 0
    v_mov_b32 v157, 0
    v_mov_b32 v158, 0
    v_mov_b32 v159, 0
    v_mov_b32 v160, 0
    v_mov_b32 v161, 0
    v_mov_b32 v162, 0
    v_mov_b32 v163, 0
    v_lshrrev_b32 v166, 4, v1
    v_lshlrev_b32 v166, 4, v166
    v_lshl_add_u32 v166, v164, 6, v166
    v_mov_b32 v165, 0x7f000000
    v_cmp_gt_u32 vcc, 4, v164
    s_nop 1
    v_cndmask_b32 v167, v165, v166, vcc
    v_cmp_gt_u32 vcc, 14, v164
    s_nop 1
    v_cndmask_b32 v168, v165, v166, vcc
    s_waitcnt vmcnt(0)
    v_and_b32 v252, 15, v251
    v_mul_u32_u24 v248, 458752, v252
    s_and_b32 s36, s30, 1
    s_mul_i32 s36, s36, 6
    s_add_u32 s36, s36, 4
    v_bfe_u32 v252, v251, s36, 6
    v_mul_u32_u24 v250, 37, v252
    v_lshrrev_b32 v250, 8, v250
    v_mul_u32_u24 v250, 7, v250
    v_sub_u32 v250, v252, v250
    v_cmp_eq_u32 vcc, 3, v250
    s_nop 1
    v_cndmask_b32 v250, 0, 1, vcc
    v_lshl_add_u32 v249, v252, 16, v250
    v_mov_b32 v6, 162836
spin_12:
    s_sleep 2
    ds_read_b32 v7, v6
    s_waitcnt lgkmcnt(0)
    v_readfirstlane_b32 s53, v7
    s_nop 0
    s_cmp_ge_u32 s53, 4
    s_cbranch_scc0 spin_12
    s_mov_b64 s[12:13], s[68:69]
    s_mov_b32 s14, 2097152
    s_mov_b32 s15, 0x20000
    s_and_b32 s35, s30, 1
    s_mul_i32 s38, s99, 128
    s_mul_i32 s41, s35, 65536
    s_add_u32 s38, s38, s41
    s_mul_i32 s41, s35, 4096
    s_add_u32 s41, s41, 24576
    s_mov_b32 s42, 0
    s_mov_b32 s44, s67
    s_mov_b32 s42, 73728
    s_mov_b32 s44, s28
    s_add_u32 s19, s41, s42
    s_mul_i32 s16, s44, 131072
    s_add_u32 s16, s16, s38
    s_add_u32 s44, s44, 1
    s_and_b32 s44, s44, 15
    s_add_u32 s42, s42, 8192
    s_cmp_eq_u32 s42, 131072
    s_cselect_b32 s42, 0, s42
    s_mov_b32 m0, s19
    s_mov_b32 s39, s16
    buffer_load_dwordx4 v238, s[12:15], s39 offen lds
    s_add_u32 m0, m0, 1024
    s_add_u32 s39, s39, 16384
    buffer_load_dwordx4 v238, s[12:15], s39 offen lds
    s_add_u32 m0, m0, 1024
    s_add_u32 s39, s39, 16384
    buffer_load_dwordx4 v238, s[12:15], s39 offen lds
    s_add_u32 m0, m0, 1024
    s_add_u32 s39, s39, 16384
    buffer_load_dwordx4 v238, s[12:15], s39 offen lds
    s_mov_b64 s[12:13], s[72:73]
    s_mov_b32 s14, 7340032
    s_mov_b32 s15, 0x20000
    s_and_b32 s35, s30, 1
    s_mul_i32 s38, s29, 448
    s_mul_i32 s41, s35, 229376
    s_add_u32 s38, s38, s41
    s_mul_i32 s41, s35, 14336
    s_add_u32 s41, s41, 73728
    s_mov_b32 s42, 0
    s_mov_b32 s44, 0
    s_mov_b32 s42, 32768
    s_mov_b32 s44, s28
    s_add_u32 s19, s41, s42
    s_mul_i32 s16, s44, 458752
    s_add_u32 s16, s16, s38
    s_add_u32 s44, s44, 1
    s_and_b32 s44, s44, 15
    s_add_u32 s42, s42, 28672
    s_cmp_eq_u32 s42, 86016
    s_cselect_b32 s42, 0, s42
    s_mov_b32 m0, s19
    s_mov_b32 s39, s16
    buffer_load_dwordx4 v241, s[12:15], s39 offen lds
    s_add_u32 m0, m0, 1024
    s_nop 0
    buffer_load_dwordx4 v242, s[12:15], s39 offen lds
    s_add_u32 m0, m0, 1024
    s_nop 0
    buffer_load_dwordx4 v243, s[12:15], s39 offen lds
    s_add_u32 m0, m0, 1024
    s_nop 0
    buffer_load_dwordx4 v244, s[12:15], s39 offen lds
    s_add_u32 m0, m0, 1024
    s_nop 0
    buffer_load_dwordx4 v245, s[12:15], s39 offen lds
    s_add_u32 m0, m0, 1024
    s_nop 0
    buffer_load_dwordx4 v246, s[12:15], s39 offen lds
    s_add_u32 m0, m0, 1024
    s_nop 0
    buffer_load_dwordx4 v247, s[12:15], s39 offen lds
    s_add_u32 m0, m0, 1024
    s_add_u32 s39, s39, 114688
    buffer_load_dwordx4 v241, s[12:15], s39 offen lds
    s_add_u32 m0, m0, 1024
    s_nop 0
    buffer_load_dwordx4 v242, s[12:15], s39 offen lds
    s_add_u32 m0, m0, 1024
    s_nop 0
    buffer_load_dwordx4 v243, s[12:15], s39 offen lds
    s_add_u32 m0, m0, 1024
    s_nop 0
    buffer_load_dwordx4 v244, s[12:15], s39 offen lds
    s_add_u32 m0, m0, 1024
    s_nop 0
    buffer_load_dwordx4 v245, s[12:15], s39 offen lds
    s_add_u32 m0, m0, 1024
    s_nop 0
    buffer_load_dwordx4 v246, s[12:15], s39 offen lds
    s_add_u32 m0, m0, 1024
    s_nop 0
    buffer_load_dwordx4 v247, s[12:15], s39 offen lds
    s_waitcnt vmcnt(14)
    s_setprio 1
    ds_read_b64_tr_b16 v[128:129], v144 offset:0
    ds_read_b64_tr_b16 v[130:131], v144 offset:2048
    ds_read_b64_tr_b16 v[132:133], v145 offset:0
    ds_read_b64_tr_b16 v[134:135], v145 offset:2048
    ds_read_b64_tr_b16 v[136:137], v146 offset:0
    ds_read_b64_tr_b16 v[138:139], v146 offset:2048
    ds_read_b64_tr_b16 v[140:141], v147 offset:0
    ds_read_b64_tr_b16 v[142:143], v147 offset:2048
    s_add_u32 s20, s4, 0x1400000
    s_addc_u32 s21, s5, 0
    s_mov_b32 s22, 0x20000
    s_mov_b32 s23, 0x20000
    s_lshl_b32 s35, s28, 1
    s_and_b32 s36, s30, 1
    s_add_u32 s35, s35, s36
    s_mul_i32 s35, s35, 4096
    s_mul_i32 s36, s29, 256
    s_add_u32 s35, s35, s36
    s_waitcnt lgkmcnt(0)
    v_mfma_f32_16x16x32_bf16 v[160:163], v[128:131], v[16:19], v[160:163]
    v_mfma_f32_16x16x32_bf16 v[160:163], v[132:135], v[20:23], v[160:163]
    v_mfma_f32_16x16x32_bf16 v[160:163], v[136:139], v[24:27], v[160:163]
    v_mfma_f32_16x16x32_bf16 v[160:163], v[140:143], v[28:31], v[160:163]
    s_nop 7
    buffer_store_dwordx4 v[160:163], v167, s[20:23], s35 offen sc1
    s_waitcnt vmcnt(1)
    v_mov_b32 v6, 162840
    v_mov_b32 v7, 1
    s_mov_b64 exec, 1
    ds_add_u32 v6, v7
    s_mov_b64 exec, -1
    ds_read_b64_tr_b16 v[72:73], v148 offset:0
    ds_read_b64_tr_b16 v[74:75], v148 offset:7168
    ds_read_b64_tr_b16 v[76:77], v149 offset:32
    ds_read_b64_tr_b16 v[78:79], v149 offset:7200
    ds_read_b64_tr_b16 v[80:81], v148 offset:64
    ds_read_b64_tr_b16 v[82:83], v148 offset:7232
    ds_read_b64_tr_b16 v[84:85], v149 offset:96
    ds_read_b64_tr_b16 v[86:87], v149 offset:7264
    ds_read_b64_tr_b16 v[88:89], v148 offset:128
    ds_read_b64_tr_b16 v[90:91], v148 offset:7296
    ds_read_b64_tr_b16 v[92:93], v149 offset:160
    ds_read_b64_tr_b16 v[94:95], v149 offset:7328
    ds_read_b64_tr_b16 v[96:97], v148 offset:192
    ds_read_b64_tr_b16 v[98:99], v148 offset:7360
    ds_read_b64_tr_b16 v[100:101], v150 offset:0
    ds_read_b64_tr_b16 v[102:103], v150 offset:7168
    ds_read_b64_tr_b16 v[104:105], v151 offset:32
    ds_read_b64_tr_b16 v[106:107], v151 offset:7200
    ds_read_b64_tr_b16 v[108:109], v150 offset:64
    ds_read_b64_tr_b16 v[110:111], v150 offset:7232
    ds_read_b64_tr_b16 v[112:113], v151 offset:96
    ds_read_b64_tr_b16 v[114:115], v151 offset:7264
    ds_read_b64_tr_b16 v[116:117], v150 offset:128
    ds_read_b64_tr_b16 v[118:119], v150 offset:7296
    ds_read_b64_tr_b16 v[120:121], v151 offset:160
    ds_read_b64_tr_b16 v[122:123], v151 offset:7328
    ds_read_b64_tr_b16 v[124:125], v150 offset:192
    ds_read_b64_tr_b16 v[126:127], v150 offset:7360
    s_add_u32 s20, s4, 0x1420000
    s_addc_u32 s21, s5, 0
    s_mov_b32 s22, 0x70000
    s_mov_b32 s23, 0x20000
    s_lshl_b32 s35, s28, 1
    s_and_b32 s36, s30, 1
    s_add_u32 s35, s35, s36
    s_mul_i32 s35, s35, 14336
    s_mul_i32 s36, s29, 896
    s_add_u32 s35, s35, s36
    s_waitcnt lgkmcnt(0)
    v_mfma_f32_16x16x32_bf16 v[156:159], v[72:75], v[16:19], v[156:159]
    v_mfma_f32_16x16x32_bf16 v[156:159], v[76:79], v[20:23], v[156:159]
    v_mfma_f32_16x16x32_bf16 v[156:159], v[80:83], v[24:27], v[156:159]
    v_mfma_f32_16x16x32_bf16 v[156:159], v[84:87], v[28:31], v[156:159]
    v_mfma_f32_16x16x32_bf16 v[156:159], v[88:91], v[32:35], v[156:159]
    v_mfma_f32_16x16x32_bf16 v[156:159], v[92:95], v[36:39], v[156:159]
    v_mfma_f32_16x16x32_bf16 v[156:159], v[96:99], v[40:43], v[156:159]
    v_mfma_f32_16x16x32_bf16 v[156:159], v[100:103], v[44:47], v[156:159]
    v_mfma_f32_16x16x32_bf16 v[156:159], v[104:107], v[48:51], v[156:159]
    v_mfma_f32_16x16x32_bf16 v[156:159], v[108:111], v[52:55], v[156:159]
    v_mfma_f32_16x16x32_bf16 v[156:159], v[112:115], v[56:59], v[156:159]
    v_mfma_f32_16x16x32_bf16 v[156:159], v[116:119], v[60:63], v[156:159]
    v_mfma_f32_16x16x32_bf16 v[156:159], v[120:123], v[64:67], v[156:159]
    v_mfma_f32_16x16x32_bf16 v[156:159], v[124:127], v[68:71], v[156:159]
    s_nop 7
    buffer_store_dwordx4 v[156:159], v168, s[20:23], s35 offen sc1
    v_mov_b32 v6, 162840
    v_mov_b32 v7, 1
    s_mov_b64 exec, 1
    ds_add_u32 v6, v7
    s_mov_b64 exec, -1
    s_setprio 0
    s_call_b64 s[76:77], SUB_w1_regs
    s_call_b64 s[76:77], SUB_park
    v_mov_b32 v6, 162840
spin_14:
    s_sleep 3
    ds_read_b32 v7, v6
    s_waitcnt lgkmcnt(0)
    v_readfirstlane_b32 s53, v7
    s_nop 0
    s_cmp_ge_u32 s53, 4
    s_cbranch_scc0 spin_14
    s_mov_b64 s[12:13], s[68:69]
    s_mov_b32 s14, 2097152
    s_mov_b32 s15, 0x20000
    s_and_b32 s35, s30, 1
    s_mul_i32 s38, s99, 128
    s_mul_i32 s41, s35, 65536
    s_add_u32 s38, s38, s41
    s_mul_i32 s41, s35, 4096
    s_add_u32 s41, s41, 24576
    s_mov_b32 s42, 0
    s_mov_b32 s44, s67
    s_mov_b32 s42, 98304
    s_mov_b32 s44, s67
    s_add_u32 s44, s44, 12
    s_and_b32 s44, s44, 15
    s_call_b64 s[76:77], SUB_w_issue_1
    s_waitcnt vmcnt(8)
    s_mov_b32 s42, 106496
    s_mov_b32 s44, s67
    s_add_u32 s44, s44, 13
    s_and_b32 s44, s44, 15
    s_call_b64 s[76:77], SUB_w_issue_1
    s_waitcnt vmcnt(8)
    s_mov_b32 s42, 114688
    s_mov_b32 s44, s67
    s_add_u32 s44, s44, 14
    s_and_b32 s44, s44, 15
    s_call_b64 s[76:77], SUB_w_issue_1
    s_waitcnt vmcnt(8)
    s_mov_b32 s42, 122880
    s_mov_b32 s44, s67
    s_add_u32 s44, s44, 15
    s_and_b32 s44, s44, 15
    s_call_b64 s[76:77], SUB_w_issue_1
    s_waitcnt vmcnt(8)
    s_and_b32 s36, s29, 6
    s_cmp_eq_u32 s36, 2
    s_cbranch_scc1 pr_15
    s_call_b64 s[76:77], SUB_park2
pr_15:
    s_call_b64 s[76:77], SUB_w1_put
FR_end:
LAYER:
    v_lshlrev_b32 v40, 6, v199
    v_add_u32 v40, 161792, v40
    s_lshl_b32 s35, s30, 3
    v_add_u32 v39, s35, v40
    s_cmp_eq_u32 s60, 0
    s_cbranch_scc1 R_l0
    s_sub_u32 s8, s62, 0x400000
    s_subb_u32 s9, s63, 0
    s_mov_b32 s10, 0x7e000
    s_mov_b32 s11, 0x20000
    s_sub_u32 s12, s62, 0x380000
    s_subb_u32 s13, s63, 0
    s_mov_b32 s14, 0x7e000
    s_mov_b32 s15, 0x20000
    s_mov_b32 s20, s62
    s_mov_b32 s21, s63
    s_mov_b32 s22, 0x7e000
    s_mov_b32 s23, 0x20000
    s_mov_b32 s78, 0x3f80
    s_mov_b32 s79, 0x3f800000
    v_lshlrev_b32 v222, 16, v230
    v_and_b32 v223, 0xffff0000, v230
    v_lshlrev_b32 v206, 16, v180
    v_and_b32 v207, 0xffff0000, v180
    v_lshlrev_b32 v12, 16, v188
    v_and_b32 v13, 0xffff0000, v188
    v_pk_add_f32 v[206:207], v[206:207], v[12:13]
    v_lshlrev_b32 v224, 16, v231
    v_and_b32 v225, 0xffff0000, v231
    v_lshlrev_b32 v208, 16, v181
    v_and_b32 v209, 0xffff0000, v181
    v_lshlrev_b32 v14, 16, v189
    v_and_b32 v15, 0xffff0000, v189
    v_pk_add_f32 v[208:209], v[208:209], v[14:15]
    v_lshlrev_b32 v226, 16, v232
    v_and_b32 v227, 0xffff0000, v232
    v_lshlrev_b32 v210, 16, v182
    v_and_b32 v211, 0xffff0000, v182
    v_lshlrev_b32 v16, 16, v190
    v_and_b32 v17, 0xffff0000, v190
    v_pk_add_f32 v[210:211], v[210:211], v[16:17]
    v_lshlrev_b32 v228, 16, v233
    v_and_b32 v229, 0xffff0000, v233
    v_lshlrev_b32 v212, 16, v183
    v_and_b32 v213, 0xffff0000, v183
    v_lshlrev_b32 v18, 16, v191
    v_and_b32 v19, 0xffff0000, v191
    v_pk_add_f32 v[212:213], v[212:213], v[18:19]
    v_lshlrev_b32 v230, 16, v234
    v_and_b32 v231, 0xffff0000, v234
    v_lshlrev_b32 v214, 16, v184
    v_and_b32 v215, 0xffff0000, v184
    v_lshlrev_b32 v20, 16, v192
    v_and_b32 v21, 0xffff0000, v192
    v_pk_add_f32 v[214:215], v[214:215], v[20:21]
    v_lshlrev_b32 v232, 16, v235
    v_and_b32 v233, 0xffff0000, v235
    v_lshlrev_b32 v216, 16, v185
    v_and_b32 v217, 0xffff0000, v185
    v_lshlrev_b32 v22, 16, v193
    v_and_b32 v23, 0xffff0000, v193
    v_pk_add_f32 v[216:217], v[216:217], v[22:23]
    v_lshlrev_b32 v234, 16, v236
    v_and_b32 v235, 0xffff0000, v236
    v_lshlrev_b32 v218, 16, v186
    v_and_b32 v219, 0xffff0000, v186
    v_lshlrev_b32 v24, 16, v194
    v_and_b32 v25, 0xffff0000, v194
    v_pk_add_f32 v[218:219], v[218:219], v[24:25]
    v_lshlrev_b32 v236, 16, v237
    v_and_b32 v237, 0xffff0000, v237
    v_lshlrev_b32 v220, 16, v187
    v_and_b32 v221, 0xffff0000, v187
    v_lshlrev_b32 v26, 16, v195
    v_and_b32 v27, 0xffff0000, v195
    v_pk_add_f32 v[220:221], v[220:221], v[26:27]
    s_mov_b32 s53, 0
    s_sleep 10
    s_cmp_ge_u32 s30, 6
    s_cbranch_scc1 dp_16
    s_sleep 14
dp_16:
    buffer_load_dwordx4 v[180:183], v196, s[8:11], 0 offen offset:0 sc1
    buffer_load_dwordx4 v[188:191], v196, s[12:15], 0 offen offset:0 sc1
    buffer_load_dwordx4 v[184:187], v196, s[8:11], 0 offen offset:2048 sc1
    buffer_load_dwordx4 v[192:195], v196, s[12:15], 0 offen offset:2048 sc1
    s_waitcnt vmcnt(0)
    v_bitop3_b32 v6, v180, v184, v188 bitop3:0x80
    v_bitop3_b32 v6, v6, v192, 1 bitop3:0x80
    v_cmp_eq_u32 vcc, 0, v6
    s_cbranch_vccz dq_17
    s_sleep 4
    s_add_u32 s53, s53, 1
    s_cmp_lt_u32 s53, s61
    s_cbranch_scc1 dp_16
    s_mov_b32 s61, 0
dq_17:
    v_dot2_f32_bf16 v206, v180, s78, v206
    v_dot2_f32_bf16 v207, v180, s79, v207
    v_dot2_f32_bf16 v208, v181, s78, v208
    v_dot2_f32_bf16 v209, v181, s79, v209
    v_dot2_f32_bf16 v210, v182, s78, v210
    v_dot2_f32_bf16 v211, v182, s79, v211
    v_dot2_f32_bf16 v212, v183, s78, v212
    v_dot2_f32_bf16 v213, v183, s79, v213
    v_dot2_f32_bf16 v214, v184, s78, v214
    v_dot2_f32_bf16 v215, v184, s79, v215
    v_dot2_f32_bf16 v216, v185, s78, v216
    v_dot2_f32_bf16 v217, v185, s79, v217
    v_dot2_f32_bf16 v218, v186, s78, v218
    v_dot2_f32_bf16 v219, v186, s79, v219
    v_dot2_f32_bf16 v220, v187, s78, v220
    v_dot2_f32_bf16 v221, v187, s79, v221
    v_dot2_f32_bf16 v206, v188, s78, v206
    v_dot2_f32_bf16 v207, v188, s79, v207
    v_dot2_f32_bf16 v208, v189, s78, v208
    v_dot2_f32_bf16 v209, v189, s79, v209
    v_dot2_f32_bf16 v210, v190, s78, v210
    v_dot2_f32_bf16 v211, v190, s79, v211
    v_dot2_f32_bf16 v212, v191, s78, v212
    v_dot2_f32_bf16 v213, v191, s79, v213
    v_dot2_f32_bf16 v214, v192, s78, v214
    v_dot2_f32_bf16 v215, v192, s79, v215
    v_dot2_f32_bf16 v216, v193, s78, v216
    v_dot2_f32_bf16 v217, v193, s79, v217
    v_dot2_f32_bf16 v218, v194, s78, v218
    v_dot2_f32_bf16 v219, v194, s79, v219
    v_dot2_f32_bf16 v220, v195, s78, v220
    v_dot2_f32_bf16 v221, v195, s79, v221
    s_nop 2
    v_pk_add_f32 v[32:33], v[206:207], v[208:209]
    v_pk_mul_f32 v[34:35], v[206:207], v[206:207]
    v_pk_fma_f32 v[34:35], v[208:209], v[208:209], v[34:35]
    v_pk_add_f32 v[32:33], v[32:33], v[210:211]
    v_pk_fma_f32 v[34:35], v[210:211], v[210:211], v[34:35]
    v_pk_add_f32 v[32:33], v[32:33], v[212:213]
    v_pk_fma_f32 v[34:35], v[212:213], v[212:213], v[34:35]
    v_pk_add_f32 v[32:33], v[32:33], v[214:215]
    v_pk_fma_f32 v[34:35], v[214:215], v[214:215], v[34:35]
    v_pk_add_f32 v[32:33], v[32:33], v[216:217]
    v_pk_fma_f32 v[34:35], v[216:217], v[216:217], v[34:35]
    v_pk_add_f32 v[32:33], v[32:33], v[218:219]
    v_pk_fma_f32 v[34:35], v[218:219], v[218:219], v[34:35]
    v_pk_add_f32 v[32:33], v[32:33], v[220:221]
    v_pk_fma_f32 v[34:35], v[220:221], v[220:221], v[34:35]
    v_add_f32 v30, v32, v33
    v_add_f32 v31, v34, v35
    s_nop 0
    v_add_f32_dpp v30, v30, v30 row_ror:8 row_mask:0xf bank_mask:0xf
    v_add_f32_dpp v31, v31, v31 row_ror:8 row_mask:0xf bank_mask:0xf
    v_mov_b32 v32, v30
    v_mov_b32 v33, v31
    s_nop 0
    v_permlane16_swap_b32 v30, v32
    v_permlane16_swap_b32 v31, v33
    v_pk_add_f32 v[30:31], v[30:31], v[32:33]
    v_mov_b32 v32, v30
    v_mov_b32 v33, v31
    s_nop 0
    v_permlane32_swap_b32 v30, v32
    v_permlane32_swap_b32 v31, v33
    v_pk_add_f32 v[30:31], v[30:31], v[32:33]
    ds_write_b64 v39, v[30:31] offset:0
    s_waitcnt lgkmcnt(0)
    s_barrier
    ds_read_b128 v[12:15], v40 offset:0
    ds_read_b128 v[16:19], v40 offset:16
    ds_read_b128 v[20:23], v40 offset:32
    ds_read_b128 v[24:27], v40 offset:48
    s_waitcnt lgkmcnt(0)
    v_pk_add_f32 v[12:13], v[12:13], v[14:15]
    v_pk_add_f32 v[16:17], v[16:17], v[18:19]
    v_pk_add_f32 v[20:21], v[20:21], v[22:23]
    v_pk_add_f32 v[24:25], v[24:25], v[26:27]
    v_pk_add_f32 v[12:13], v[12:13], v[16:17]
    v_pk_add_f32 v[20:21], v[20:21], v[24:25]
    v_pk_add_f32 v[12:13], v[12:13], v[20:21]
    v_mul_f32 v36, 0x3a800000, v12
    v_mul_f32 v38, 0x3a800000, v13
    v_fma_f32 v38, -v36, v36, v38
    v_max_f32 v38, 0, v38
    v_add_f32 v38, 0x3727c5ac, v38
    v_rsq_f32 v37, v38
    s_nop 0
    v_mul_f32 v36, v36, v37
    v_pk_fma_f32 v[12:13], v[206:207], v[36:37], v[36:37] op_sel:[0,1,0] op_sel_hi:[1,1,0] neg_lo:[0,0,1] neg_hi:[0,0,1]
    v_pk_fma_f32 v[14:15], v[208:209], v[36:37], v[36:37] op_sel:[0,1,0] op_sel_hi:[1,1,0] neg_lo:[0,0,1] neg_hi:[0,0,1]
    v_pk_fma_f32 v[16:17], v[210:211], v[36:37], v[36:37] op_sel:[0,1,0] op_sel_hi:[1,1,0] neg_lo:[0,0,1] neg_hi:[0,0,1]
    v_pk_fma_f32 v[18:19], v[212:213], v[36:37], v[36:37] op_sel:[0,1,0] op_sel_hi:[1,1,0] neg_lo:[0,0,1] neg_hi:[0,0,1]
    v_pk_fma_f32 v[20:21], v[214:215], v[36:37], v[36:37] op_sel:[0,1,0] op_sel_hi:[1,1,0] neg_lo:[0,0,1] neg_hi:[0,0,1]
    v_pk_fma_f32 v[22:23], v[216:217], v[36:37], v[36:37] op_sel:[0,1,0] op_sel_hi:[1,1,0] neg_lo:[0,0,1] neg_hi:[0,0,1]
    v_pk_fma_f32 v[24:25], v[218:219], v[36:37], v[36:37] op_sel:[0,1,0] op_sel_hi:[1,1,0] neg_lo:[0,0,1] neg_hi:[0,0,1]
    v_pk_fma_f32 v[26:27], v[220:221], v[36:37], v[36:37] op_sel:[0,1,0] op_sel_hi:[1,1,0] neg_lo:[0,0,1] neg_hi:[0,0,1]
    v_pk_fma_f32 v[206:207], v[12:13], v[222:223], v[206:207]
    v_cvt_pk_bf16_f32 v180, v206, v207
    v_pk_fma_f32 v[208:209], v[14:15], v[224:225], v[208:209]
    v_cvt_pk_bf16_f32 v181, v208, v209
    v_and_b32 v180, -2, v180
    v_pk_fma_f32 v[210:211], v[16:17], v[226:227], v[210:211]
    v_cvt_pk_bf16_f32 v182, v210, v211
    v_pk_fma_f32 v[212:213], v[18:19], v[228:229], v[212:213]
    v_cvt_pk_bf16_f32 v183, v212, v213
    buffer_store_dwordx4 v[180:183], v196, s[20:23], 0 offen offset:0 sc1
    v_pk_fma_f32 v[214:215], v[20:21], v[230:231], v[214:215]
    v_cvt_pk_bf16_f32 v184, v214, v215
    v_pk_fma_f32 v[216:217], v[22:23], v[232:233], v[216:217]
    v_cvt_pk_bf16_f32 v185, v216, v217
    v_and_b32 v184, -2, v184
    v_pk_fma_f32 v[218:219], v[24:25], v[234:235], v[218:219]
    v_cvt_pk_bf16_f32 v186, v218, v219
    v_pk_fma_f32 v[220:221], v[26:27], v[236:237], v[220:221]
    v_cvt_pk_bf16_f32 v187, v220, v221
    buffer_store_dwordx4 v[184:187], v196, s[20:23], 0 offen offset:2048 sc1
    s_branch R_s2
R_l0:
    v_lshlrev_b32 v206, 16, v180
    v_and_b32 v207, 0xffff0000, v180
    v_lshlrev_b32 v208, 16, v181
    v_and_b32 v209, 0xffff0000, v181
    v_lshlrev_b32 v210, 16, v182
    v_and_b32 v211, 0xffff0000, v182
    v_lshlrev_b32 v212, 16, v183
    v_and_b32 v213, 0xffff0000, v183
    v_lshlrev_b32 v214, 16, v184
    v_and_b32 v215, 0xffff0000, v184
    v_lshlrev_b32 v216, 16, v185
    v_and_b32 v217, 0xffff0000, v185
    v_lshlrev_b32 v218, 16, v186
    v_and_b32 v219, 0xffff0000, v186
    v_lshlrev_b32 v220, 16, v187
    v_and_b32 v221, 0xffff0000, v187
    v_pk_add_f32 v[32:33], v[206:207], v[208:209]
    v_pk_mul_f32 v[34:35], v[206:207], v[206:207]
    v_pk_fma_f32 v[34:35], v[208:209], v[208:209], v[34:35]
    v_pk_add_f32 v[32:33], v[32:33], v[210:211]
    v_pk_fma_f32 v[34:35], v[210:211], v[210:211], v[34:35]
    v_pk_add_f32 v[32:33], v[32:33], v[212:213]
    v_pk_fma_f32 v[34:35], v[212:213], v[212:213], v[34:35]
    v_pk_add_f32 v[32:33], v[32:33], v[214:215]
    v_pk_fma_f32 v[34:35], v[214:215], v[214:215], v[34:35]
    v_pk_add_f32 v[32:33], v[32:33], v[216:217]
    v_pk_fma_f32 v[34:35], v[216:217], v[216:217], v[34:35]
    v_pk_add_f32 v[32:33], v[32:33], v[218:219]
    v_pk_fma_f32 v[34:35], v[218:219], v[218:219], v[34:35]
    v_pk_add_f32 v[32:33], v[32:33], v[220:221]
    v_pk_fma_f32 v[34:35], v[220:221], v[220:221], v[34:35]
    v_add_f32 v30, v32, v33
    v_add_f32 v31, v34, v35
    s_nop 0
    v_add_f32_dpp v30, v30, v30 row_ror:8 row_mask:0xf bank_mask:0xf
    v_add_f32_dpp v31, v31, v31 row_ror:8 row_mask:0xf bank_mask:0xf
    v_mov_b32 v32, v30
    v_mov_b32 v33, v31
    s_nop 0
    v_permlane16_swap_b32 v30, v32
    v_permlane16_swap_b32 v31, v33
    v_pk_add_f32 v[30:31], v[30:31], v[32:33]
    v_mov_b32 v32, v30
    v_mov_b32 v33, v31
    s_nop 0
    v_permlane32_swap_b32 v30, v32
    v_permlane32_swap_b32 v31, v33
    v_pk_add_f32 v[30:31], v[30:31], v[32:33]
    ds_write_b64 v39, v[30:31] offset:0
    s_waitcnt lgkmcnt(0)
    v_mov_b32 v222, 162844
spin_18:
    ds_read_b32 v223, v222
    s_waitcnt lgkmcnt(0)
    v_readfirstlane_b32 s94, v223
    s_nop 0
    s_cmp_ge_u32 s94, 65536
    s_cbranch_scc0 spin_18
    s_cmp_gt_u32 s94, 65546
    s_cselect_b32 s94, 1, 0
    s_lshl_b32 s53, s94, 13
    v_xor_b32 v197, s53, v197
    s_lshr_b32 s53, s28, 3
    s_lshl_b32 s53, s53, 2
    s_and_b32 s54, s28, 3
    s_add_u32 s53, s53, s54
    s_lshl_b32 s53, s53, 24
    s_lshr_b32 s54, s28, 2
    s_xor_b32 s54, s54, s94
    s_and_b32 s54, s54, 1
    s_lshl_b32 s54, s54, 13
    s_add_u32 s36, s53, s54
    s_add_u32 s36, s36, 33554432
    s_lshr_b32 s53, s53, 14
    s_add_u32 s36, s53, s54
    s_xor_b32 s36, s36, 8192
    s_add_u32 s36, s36, 23101440
    s_lshl_b32 s53, s30, 7
    s_add_u32 s36, s36, s53
    v_mov_b32 v226, s36
    s_waitcnt vmcnt(0)
    s_barrier
    s_mov_b32 s53, 0
    s_add_u32 s54, s52, 32
    s_bfm_b64 exec, 1, 0
poll_19:
    buffer_load_dword v222, v226, s[56:59], 0 offen sc1
    s_waitcnt vmcnt(0)
    v_xor_b32 v222, s54, v222
    v_cmp_eq_u32 vcc, 0, v222
    s_nop 0
    s_cmp_eq_u64 vcc, exec
    s_cbranch_scc1 pok_20
    s_sleep 6
    s_add_u32 s53, s53, 1
    s_cmp_lt_u32 s53, s61
    s_cbranch_scc1 poll_19
    s_mov_b32 s61, 0
pok_20:
    s_mov_b64 exec, -1
    s_add_u32 s80, s4, 0x2100000
    s_addc_u32 s81, s5, 0
    s_mov_b32 s82, 0x7f00000
    s_mov_b32 s83, 0x20000
    s_mov_b32 s78, 0
    buffer_load_dwordx2 v[230:231], v197, s[80:83], s78 offen sc1
    s_mov_b32 s78, 2048
    buffer_load_dwordx2 v[232:233], v197, s[80:83], s78 offen sc1
    s_mov_b32 s78, 16384
    buffer_load_dwordx2 v[234:235], v197, s[80:83], s78 offen sc1
    s_mov_b32 s78, 18432
    buffer_load_dwordx2 v[236:237], v197, s[80:83], s78 offen sc1
    s_lshr_b32 s53, s28, 3
    s_lshl_b32 s53, s53, 2
    s_and_b32 s54, s28, 3
    s_add_u32 s53, s53, s54
    s_lshl_b32 s53, s53, 24
    s_lshr_b32 s54, s28, 2
    s_xor_b32 s54, s54, s94
    s_and_b32 s54, s54, 1
    s_lshl_b32 s54, s54, 13
    s_add_u32 s55, s53, s54
    s_add_u32 s55, s55, 33554432
    s_add_u32 s62, s4, s55
    s_addc_u32 s63, s5, 0
    s_sub_u32 s36, s28, 1
    s_max_i32 s36, s36, 0
    s_lshr_b32 s53, s36, 3
    s_lshl_b32 s53, s53, 2
    s_and_b32 s54, s36, 3
    s_add_u32 s53, s53, s54
    s_lshl_b32 s53, s53, 24
    s_lshr_b32 s54, s36, 2
    s_xor_b32 s54, s54, s94
    s_and_b32 s54, s54, 1
    s_lshl_b32 s54, s54, 13
    s_add_u32 s92, s53, s54
    s_add_u32 s92, s92, 33554432
    s_sub_u32 s92, s92, s55
    s_add_u32 s36, s28, 1
    s_min_u32 s36, s36, 15
    s_lshr_b32 s53, s36, 3
    s_lshl_b32 s53, s53, 2
    s_and_b32 s54, s36, 3
    s_add_u32 s53, s53, s54
    s_lshl_b32 s53, s53, 24
    s_lshr_b32 s54, s36, 2
    s_xor_b32 s54, s54, s94
    s_and_b32 s54, s54, 1
    s_lshl_b32 s54, s54, 13
    s_add_u32 s93, s53, s54
    s_add_u32 s93, s93, 33554432
    s_sub_u32 s93, s93, s55
    s_add_u32 s55, s55, 6029312
    s_mov_b32 s20, s62
    s_mov_b32 s21, s63
    s_mov_b32 s22, 0x7e000
    s_mov_b32 s23, 0x20000
    ds_read_b128 v[12:15], v40 offset:0
    ds_read_b128 v[16:19], v40 offset:16
    ds_read_b128 v[20:23], v40 offset:32
    ds_read_b128 v[24:27], v40 offset:48
    s_waitcnt lgkmcnt(0)
    v_pk_add_f32 v[12:13], v[12:13], v[14:15]
    v_pk_add_f32 v[16:17], v[16:17], v[18:19]
    v_pk_add_f32 v[20:21], v[20:21], v[22:23]
    v_pk_add_f32 v[24:25], v[24:25], v[26:27]
    v_pk_add_f32 v[12:13], v[12:13], v[16:17]
    v_pk_add_f32 v[20:21], v[20:21], v[24:25]
    v_pk_add_f32 v[12:13], v[12:13], v[20:21]
    v_mul_f32 v36, 0x3a800000, v12
    v_mul_f32 v38, 0x3a800000, v13
    v_fma_f32 v38, -v36, v36, v38
    v_max_f32 v38, 0, v38
    v_add_f32 v38, 0x3727c5ac, v38
    v_rsq_f32 v37, v38
    s_nop 0
    v_pk_add_f32 v[12:13], v[206:207], v[36:37] op_sel_hi:[1,0] neg_lo:[0,1] neg_hi:[0,1]
    v_pk_mul_f32 v[12:13], v[12:13], v[36:37] op_sel:[0,1] op_sel_hi:[1,1]
    v_pk_add_f32 v[14:15], v[208:209], v[36:37] op_sel_hi:[1,0] neg_lo:[0,1] neg_hi:[0,1]
    v_pk_mul_f32 v[14:15], v[14:15], v[36:37] op_sel:[0,1] op_sel_hi:[1,1]
    v_pk_add_f32 v[16:17], v[210:211], v[36:37] op_sel_hi:[1,0] neg_lo:[0,1] neg_hi:[0,1]
    v_pk_mul_f32 v[16:17], v[16:17], v[36:37] op_sel:[0,1] op_sel_hi:[1,1]
    v_pk_add_f32 v[18:19], v[212:213], v[36:37] op_sel_hi:[1,0] neg_lo:[0,1] neg_hi:[0,1]
    v_pk_mul_f32 v[18:19], v[18:19], v[36:37] op_sel:[0,1] op_sel_hi:[1,1]
    v_pk_add_f32 v[20:21], v[214:215], v[36:37] op_sel_hi:[1,0] neg_lo:[0,1] neg_hi:[0,1]
    v_pk_mul_f32 v[20:21], v[20:21], v[36:37] op_sel:[0,1] op_sel_hi:[1,1]
    v_pk_add_f32 v[22:23], v[216:217], v[36:37] op_sel_hi:[1,0] neg_lo:[0,1] neg_hi:[0,1]
    v_pk_mul_f32 v[22:23], v[22:23], v[36:37] op_sel:[0,1] op_sel_hi:[1,1]
    v_pk_add_f32 v[24:25], v[218:219], v[36:37] op_sel_hi:[1,0] neg_lo:[0,1] neg_hi:[0,1]
    v_pk_mul_f32 v[24:25], v[24:25], v[36:37] op_sel:[0,1] op_sel_hi:[1,1]
    v_pk_add_f32 v[26:27], v[220:221], v[36:37] op_sel_hi:[1,0] neg_lo:[0,1] neg_hi:[0,1]
    v_pk_mul_f32 v[26:27], v[26:27], v[36:37] op_sel:[0,1] op_sel_hi:[1,1]
    s_barrier
    s_waitcnt vmcnt(0)
    v_lshlrev_b32 v222, 16, v230
    v_and_b32 v223, 0xffff0000, v230
    v_pk_fma_f32 v[206:207], v[12:13], v[222:223], v[206:207]
    v_cvt_pk_bf16_f32 v180, v206, v207
    v_lshlrev_b32 v222, 16, v231
    v_and_b32 v223, 0xffff0000, v231
    v_pk_fma_f32 v[208:209], v[14:15], v[222:223], v[208:209]
    v_cvt_pk_bf16_f32 v181, v208, v209
    v_and_b32 v180, -2, v180
    v_lshlrev_b32 v222, 16, v232
    v_and_b32 v223, 0xffff0000, v232
    v_pk_fma_f32 v[210:211], v[16:17], v[222:223], v[210:211]
    v_cvt_pk_bf16_f32 v182, v210, v211
    v_lshlrev_b32 v222, 16, v233
    v_and_b32 v223, 0xffff0000, v233
    v_pk_fma_f32 v[212:213], v[18:19], v[222:223], v[212:213]
    v_cvt_pk_bf16_f32 v183, v212, v213
    buffer_store_dwordx4 v[180:183], v196, s[20:23], 0 offen offset:0 sc1
    v_lshlrev_b32 v222, 16, v234
    v_and_b32 v223, 0xffff0000, v234
    v_pk_fma_f32 v[214:215], v[20:21], v[222:223], v[214:215]
    v_cvt_pk_bf16_f32 v184, v214, v215
    v_lshlrev_b32 v222, 16, v235
    v_and_b32 v223, 0xffff0000, v235
    v_pk_fma_f32 v[216:217], v[22:23], v[222:223], v[216:217]
    v_cvt_pk_bf16_f32 v185, v216, v217
    v_and_b32 v184, -2, v184
    v_lshlrev_b32 v222, 16, v236
    v_and_b32 v223, 0xffff0000, v236
    v_pk_fma_f32 v[218:219], v[24:25], v[222:223], v[218:219]
    v_cvt_pk_bf16_f32 v186, v218, v219
    v_lshlrev_b32 v222, 16, v237
    v_and_b32 v223, 0xffff0000, v237
    v_pk_fma_f32 v[220:221], v[26:27], v[222:223], v[220:221]
    v_cvt_pk_bf16_f32 v187, v220, v221
    buffer_store_dwordx4 v[184:187], v196, s[20:23], 0 offen offset:2048 sc1
R_s2:
    v_lshlrev_b32 v206, 16, v180
    v_and_b32 v207, 0xffff0000, v180
    v_lshlrev_b32 v208, 16, v181
    v_and_b32 v209, 0xffff0000, v181
    v_lshlrev_b32 v210, 16, v182
    v_and_b32 v211, 0xffff0000, v182
    v_lshlrev_b32 v212, 16, v183
    v_and_b32 v213, 0xffff0000, v183
    v_lshlrev_b32 v214, 16, v184
    v_and_b32 v215, 0xffff0000, v184
    v_lshlrev_b32 v216, 16, v185
    v_and_b32 v217, 0xffff0000, v185
    v_lshlrev_b32 v218, 16, v186
    v_and_b32 v219, 0xffff0000, v186
    v_lshlrev_b32 v220, 16, v187
    v_and_b32 v221, 0xffff0000, v187
    v_pk_add_f32 v[32:33], v[206:207], v[208:209]
    v_pk_mul_f32 v[34:35], v[206:207], v[206:207]
    v_pk_fma_f32 v[34:35], v[208:209], v[208:209], v[34:35]
    v_pk_add_f32 v[32:33], v[32:33], v[210:211]
    v_pk_fma_f32 v[34:35], v[210:211], v[210:211], v[34:35]
    v_pk_add_f32 v[32:33], v[32:33], v[212:213]
    v_pk_fma_f32 v[34:35], v[212:213], v[212:213], v[34:35]
    v_pk_add_f32 v[32:33], v[32:33], v[214:215]
    v_pk_fma_f32 v[34:35], v[214:215], v[214:215], v[34:35]
    v_pk_add_f32 v[32:33], v[32:33], v[216:217]
    v_pk_fma_f32 v[34:35], v[216:217], v[216:217], v[34:35]
    v_pk_add_f32 v[32:33], v[32:33], v[218:219]
    v_pk_fma_f32 v[34:35], v[218:219], v[218:219], v[34:35]
    v_pk_add_f32 v[32:33], v[32:33], v[220:221]
    v_pk_fma_f32 v[34:35], v[220:221], v[220:221], v[34:35]
    v_add_f32 v30, v32, v33
    v_add_f32 v31, v34, v35
    s_nop 0
    v_add_f32_dpp v30, v30, v30 row_ror:8 row_mask:0xf bank_mask:0xf
    v_add_f32_dpp v31, v31, v31 row_ror:8 row_mask:0xf bank_mask:0xf
    v_mov_b32 v32, v30
    v_mov_b32 v33, v31
    s_nop 0
    v_permlane16_swap_b32 v30, v32
    v_permlane16_swap_b32 v31, v33
    v_pk_add_f32 v[30:31], v[30:31], v[32:33]
    v_mov_b32 v32, v30
    v_mov_b32 v33, v31
    s_nop 0
    v_permlane32_swap_b32 v30, v32
    v_permlane32_swap_b32 v31, v33
    v_pk_add_f32 v[30:31], v[30:31], v[32:33]
    ds_write_b64 v39, v[30:31] offset:512
    s_waitcnt lgkmcnt(0)
    s_barrier
    s_cmp_lg_u32 s30, 6
    s_cbranch_scc1 R_n6
    s_cmp_lg_u32 s60, 0
    s_cbranch_scc1 R_n6
    s_lshl_b32 s53, s29, 7
    s_add_u32 s53, s53, 23121920
    v_mov_b32 v8, 1
    v_mov_b32 v9, 0
    s_mov_b64 exec, 1
    buffer_atomic_add v8, v9, s[56:59], s53 offen sc1
    s_mov_b64 exec, -1
R_n6:
    s_cmp_lg_u32 s30, 7
    s_cbranch_scc1 R_nl
    ds_read_b128 v[12:15], v40 offset:512
    ds_read_b128 v[16:19], v40 offset:528
    ds_read_b128 v[20:23], v40 offset:544
    ds_read_b128 v[24:27], v40 offset:560
    s_waitcnt lgkmcnt(0)
    v_pk_add_f32 v[12:13], v[12:13], v[14:15]
    v_pk_add_f32 v[16:17], v[16:17], v[18:19]
    v_pk_add_f32 v[20:21], v[20:21], v[22:23]
    v_pk_add_f32 v[24:25], v[24:25], v[26:27]
    v_pk_add_f32 v[12:13], v[12:13], v[16:17]
    v_pk_add_f32 v[20:21], v[20:21], v[24:25]
    v_pk_add_f32 v[12:13], v[12:13], v[20:21]
    v_mul_f32 v36, 0x3a800000, v12
    v_mul_f32 v38, 0x3a800000, v13
    v_fma_f32 v38, -v36, v36, v38
    v_max_f32 v38, 0, v38
    v_mov_b32 v42, v36
    v_mov_b32 v43, v38
    v_add_f32 v38, 0x3727c5ac, v38
    v_sqrt_f32 v38, v38
    s_nop 0
    v_mov_b32 v41, v38
    v_rcp_f32 v37, v38
    v_sub_f32 v42, v42, v36
    v_mul_f32 v42, v42, v37
    v_mul_f32 v43, v43, v37
    v_mul_f32 v43, v43, v37
    v_add_f32 v43, 0x3727c5ac, v43
    v_rsq_f32 v44, v43
    v_mov_b32 v224, v36
    v_mov_b32 v225, v37
    v_fma_f32 v226, v42, v41, v36
    v_mul_f32 v227, v37, v44
    s_add_u32 s24, s62, 0x5d0000
    s_addc_u32 s25, s63, 0
    s_mov_b32 s26, 0x800
    s_mov_b32 s27, 0x20000
    s_lshl_b32 s36, s29, 3
    v_add_u32 v6, s36, v199
    v_lshlrev_b32 v6, 4, v6
    s_mov_b64 exec, 0xff
    buffer_store_dwordx4 v[224:227], v6, s[24:27], 0 offen sc1
    s_mov_b64 exec, -1
    s_add_u32 s53, s55, 1280
    v_mov_b32 v8, 1
    v_mov_b32 v9, 162816
    v_mov_b32 v11, 0
    s_mov_b64 exec, 1
    s_waitcnt vmcnt(0)
    buffer_atomic_add v8, v11, s[56:59], s53 offen sc1
pub_21:
    s_mov_b64 exec, -1
R_nl:
    s_cmp_ge_u32 s30, 4
    s_cbranch_scc1 LOADERS
    s_setprio 1
    s_mov_b32 s8, s62
    s_mov_b32 s9, s63
    s_mov_b32 s10, 0x7e000
    s_mov_b32 s11, 0x20000
    v_add_u32 v126, 0, v2
    v_add_u32 v127, 65536, v2
    s_lshl_b32 s44, s30, 17
    s_mov_b32 s34, s30
    s_mov_b32 s35, 0
    v_and_b32 v22, 15, v1
    v_lshrrev_b32 v23, 4, v1
    s_mul_i32 s37, s34, 2
    s_mul_i32 s38, s99, 4
    s_mul_i32 s36, s35, 4
    s_add_u32 s38, s38, s36
    v_add_u32 v128, 4096, v2
    v_add_u32 v129, 69632, v2
    s_add_u32 s45, s44, 16384
    s_add_u32 s46, s44, 32768
    s_add_u32 s47, s44, 49152
    v_lshrrev_b32 v6, 2, v1
    v_mul_u32_u24 v13, 128, v6
    v_and_b32 v7, 3, v1
    v_lshl_add_u32 v13, v7, 3, v13
    v_add_u32 v13, 24576, v13
    v_bfe_u32 v6, v6, 1, 2
    s_mul_i32 s36, s35, 4
    s_add_u32 s36, s36, 3
    v_xor_b32 v7, s36, v6
    v_lshl_add_u32 v16, v7, 5, v13
    s_mul_i32 s36, s35, 4
    s_add_u32 s36, s36, 2
    v_xor_b32 v7, s36, v6
    v_lshl_add_u32 v15, v7, 5, v13
    s_mul_i32 s36, s35, 4
    s_add_u32 s36, s36, 1
    v_xor_b32 v7, s36, v6
    v_lshl_add_u32 v14, v7, 5, v13
    s_mul_i32 s36, s35, 4
    s_add_u32 s36, s36, 0
    v_xor_b32 v7, s36, v6
    v_lshl_add_u32 v13, v7, 5, v13
    v_pk_mov_b32 v[24:25], 0, 0
    v_pk_mov_b32 v[26:27], 0, 0
    v_pk_mov_b32 v[28:29], 0, 0
    v_pk_mov_b32 v[30:31], 0, 0
    v_pk_mov_b32 v[32:33], 0, 0
    v_pk_mov_b32 v[34:35], 0, 0
    v_pk_mov_b32 v[36:37], 0, 0
    v_pk_mov_b32 v[38:39], 0, 0
    v_pk_mov_b32 v[40:41], 0, 0
    v_pk_mov_b32 v[42:43], 0, 0
    v_pk_mov_b32 v[44:45], 0, 0
    v_pk_mov_b32 v[46:47], 0, 0
    v_pk_mov_b32 v[48:49], 0, 0
    v_pk_mov_b32 v[50:51], 0, 0
    v_pk_mov_b32 v[52:53], 0, 0
    v_pk_mov_b32 v[54:55], 0, 0
    s_mov_b32 s43, 0
    s_mul_i32 s36, s35, 256
    s_add_u32 s36, s36, 163328
    v_lshlrev_b32 v6, 4, v23
    v_add_u32 v6, s36, v6
    s_lshl_b32 s36, s37, 8
    s_add_u32 s36, s36, 160776
    v_lshlrev_b32 v7, 4, v22
    v_add_u32 v7, s36, v7
    s_add_u32 s16, s62, 0x100000
    s_addc_u32 s17, s63, 0
    s_mov_b32 s18, 0x7e000
    s_mov_b32 s19, 0x20000
    v_lshlrev_b32 v12, 11, v23
    v_lshl_add_u32 v12, v22, 4, v12
    s_lshl_b32 s39, s38, 13
    s_lshl_b32 s36, s37, 8
    s_add_u32 s39, s39, s36
    s_add_u32 s40, s39, 16384
    s_lshl_b32 s36, s29, 1
    s_lshr_b32 s53, s36, 3
    s_lshl_b32 s53, s53, 14
    s_and_b32 s41, s36, 7
    s_lshl_b32 s41, s41, 10
    s_add_u32 s41, s41, s53
    s_lshl_b32 s36, s37, 16
    s_add_u32 s41, s41, s36
    s_mov_b32 s53, 0
    s_mov_b32 s49, s44
    ds_read_b64_tr_b16 v[56:57], v13 offset:0
    ds_read_b64_tr_b16 v[58:59], v13 offset:2048
    ds_read_b64_tr_b16 v[60:61], v14 offset:0
    ds_read_b64_tr_b16 v[62:63], v14 offset:2048
    ds_read_b64_tr_b16 v[64:65], v15 offset:0
    ds_read_b64_tr_b16 v[66:67], v15 offset:2048
    ds_read_b64_tr_b16 v[68:69], v16 offset:0
    ds_read_b64_tr_b16 v[70:71], v16 offset:2048
    ds_read_b64_tr_b16 v[72:73], v13 offset:4096
    ds_read_b64_tr_b16 v[74:75], v13 offset:6144
    ds_read_b64_tr_b16 v[76:77], v14 offset:4096
    ds_read_b64_tr_b16 v[78:79], v14 offset:6144
    ds_read_b64_tr_b16 v[80:81], v15 offset:4096
    ds_read_b64_tr_b16 v[82:83], v15 offset:6144
    ds_read_b64_tr_b16 v[84:85], v16 offset:4096
    ds_read_b64_tr_b16 v[86:87], v16 offset:6144
dm_22p:
    buffer_load_dwordx4 v[164:167], v126, s[8:11], s44 offen offset:0 sc1
    buffer_load_dwordx4 v[168:171], v127, s[8:11], s44 offen offset:0 sc1
    buffer_load_dwordx4 v[172:175], v126, s[8:11], s44 offen offset:1024 sc1
    buffer_load_dwordx4 v[176:179], v127, s[8:11], s44 offen offset:1024 sc1
    buffer_load_dwordx4 v[180:183], v126, s[8:11], s44 offen offset:2048 sc1
    buffer_load_dwordx4 v[184:187], v127, s[8:11], s44 offen offset:2048 sc1
    buffer_load_dwordx4 v[188:191], v126, s[8:11], s44 offen offset:3072 sc1
    buffer_load_dwordx4 v[192:195], v127, s[8:11], s44 offen offset:3072 sc1
dm_22w:
    s_waitcnt vmcnt(4)
    v_or3_b32 v17, v164, v168, v172
    v_bitop3_b32 v17, v17, v176, 1 bitop3:0xa8
    v_cmp_ne_u32 vcc, 0, v17
    s_cbranch_vccz dm_22q
dm_22r:
    s_sleep 2
    buffer_load_dwordx4 v[164:167], v126, s[8:11], s44 offen offset:0 sc1
    buffer_load_dwordx4 v[168:171], v127, s[8:11], s44 offen offset:0 sc1
    buffer_load_dwordx4 v[172:175], v126, s[8:11], s44 offen offset:1024 sc1
    buffer_load_dwordx4 v[176:179], v127, s[8:11], s44 offen offset:1024 sc1
    buffer_load_dwordx4 v[180:183], v126, s[8:11], s44 offen offset:2048 sc1
    buffer_load_dwordx4 v[184:187], v127, s[8:11], s44 offen offset:2048 sc1
    buffer_load_dwordx4 v[188:191], v126, s[8:11], s44 offen offset:3072 sc1
    buffer_load_dwordx4 v[192:195], v127, s[8:11], s44 offen offset:3072 sc1
    s_waitcnt vmcnt(4)
    v_or3_b32 v17, v164, v168, v172
    v_bitop3_b32 v17, v17, v176, 1 bitop3:0xa8
    v_cmp_ne_u32 vcc, 0, v17
    s_cbranch_vccz dm_22t
    s_add_u32 s53, s53, 1
    s_cmp_lt_u32 s53, s61
    s_cbranch_scc1 dm_22r
    s_mov_b32 s61, 0
    s_branch dm_22t
dm_22q:
dm_22t:
    buffer_load_dwordx4 v[196:199], v128, s[8:11], s44 offen offset:0 sc1
    buffer_load_dwordx4 v[200:203], v129, s[8:11], s44 offen offset:0 sc1
    buffer_load_dwordx4 v[204:207], v128, s[8:11], s44 offen offset:1024 sc1
    buffer_load_dwordx4 v[208:211], v129, s[8:11], s44 offen offset:1024 sc1
    buffer_load_dwordx4 v[212:215], v128, s[8:11], s44 offen offset:2048 sc1
    buffer_load_dwordx4 v[216:219], v129, s[8:11], s44 offen offset:2048 sc1
    s_waitcnt lgkmcnt(0)
dm_22:
    v_mfma_f32_16x16x32_bf16 v[24:27], v[56:59], v[164:167], v[24:27]
    ds_read_b64_tr_b16 v[88:89], v13 offset:8192
    buffer_load_dwordx4 v[220:223], v128, s[8:11], s44 offen offset:3072 sc1
    v_mfma_f32_16x16x32_bf16 v[40:43], v[56:59], v[168:171], v[40:43]
    ds_read_b64_tr_b16 v[90:91], v13 offset:10240
    buffer_load_dwordx4 v[224:227], v129, s[8:11], s44 offen offset:3072 sc1
    v_mfma_f32_16x16x32_bf16 v[44:47], v[60:63], v[168:171], v[44:47]
    ds_read_b64_tr_b16 v[92:93], v14 offset:8192
    s_mov_b32 s44, s45
    v_mfma_f32_16x16x32_bf16 v[28:31], v[60:63], v[164:167], v[28:31]
    ds_read_b64_tr_b16 v[94:95], v14 offset:10240
    s_mov_b32 s45, s46
    v_mfma_f32_16x16x32_bf16 v[32:35], v[64:67], v[164:167], v[32:35]
    ds_read_b64_tr_b16 v[96:97], v15 offset:8192
    s_mov_b32 s46, s47
    v_mfma_f32_16x16x32_bf16 v[48:51], v[64:67], v[168:171], v[48:51]
    ds_read_b64_tr_b16 v[98:99], v15 offset:10240
    s_mov_b32 s47, 1048576
    v_mfma_f32_16x16x32_bf16 v[52:55], v[68:71], v[168:171], v[52:55]
    ds_read_b64_tr_b16 v[100:101], v16 offset:8192
    v_mfma_f32_16x16x32_bf16 v[36:39], v[68:71], v[164:167], v[36:39]
    ds_read_b64_tr_b16 v[102:103], v16 offset:10240
    s_waitcnt lgkmcnt(8)
    v_mfma_f32_16x16x32_bf16 v[24:27], v[72:75], v[172:175], v[24:27]
    ds_read_b64_tr_b16 v[104:105], v13 offset:12288
    buffer_load_dwordx4 v[164:167], v126, s[8:11], s44 offen offset:0 sc1
    v_mfma_f32_16x16x32_bf16 v[40:43], v[72:75], v[176:179], v[40:43]
    ds_read_b64_tr_b16 v[106:107], v13 offset:14336
    buffer_load_dwordx4 v[168:171], v127, s[8:11], s44 offen offset:0 sc1
    v_mfma_f32_16x16x32_bf16 v[44:47], v[76:79], v[176:179], v[44:47]
    ds_read_b64_tr_b16 v[108:109], v14 offset:12288
    s_waitcnt vmcnt(10)
    v_mfma_f32_16x16x32_bf16 v[28:31], v[76:79], v[172:175], v[28:31]
    ds_read_b64_tr_b16 v[110:111], v14 offset:14336
    v_or3_b32 v17, v180, v184, v188
    v_mfma_f32_16x16x32_bf16 v[32:35], v[80:83], v[172:175], v[32:35]
    ds_read_b64_tr_b16 v[112:113], v15 offset:12288
    v_bitop3_b32 v17, v17, v192, 1 bitop3:0xa8
    v_mfma_f32_16x16x32_bf16 v[48:51], v[80:83], v[176:179], v[48:51]
    ds_read_b64_tr_b16 v[114:115], v15 offset:14336
    v_cmp_ne_u32 vcc, 0, v17
    v_mfma_f32_16x16x32_bf16 v[52:55], v[84:87], v[176:179], v[52:55]
    ds_read_b64_tr_b16 v[116:117], v16 offset:12288
    ds_read_b64_tr_b16 v[118:119], v16 offset:14336
    v_mfma_f32_16x16x32_bf16 v[36:39], v[84:87], v[172:175], v[36:39]
    s_waitcnt lgkmcnt(8)
    s_cbranch_vccnz dm_22f0
dm_22g0:
    v_mfma_f32_16x16x32_bf16 v[24:27], v[88:91], v[180:183], v[24:27]
    ds_read_b64_tr_b16 v[56:57], v13 offset:16384
    buffer_load_dwordx4 v[172:175], v126, s[8:11], s44 offen offset:1024 sc1
    v_mfma_f32_16x16x32_bf16 v[40:43], v[88:91], v[184:187], v[40:43]
    ds_read_b64_tr_b16 v[58:59], v13 offset:18432
    buffer_load_dwordx4 v[176:179], v127, s[8:11], s44 offen offset:1024 sc1
    v_mfma_f32_16x16x32_bf16 v[44:47], v[92:95], v[184:187], v[44:47]
    ds_read_b64_tr_b16 v[60:61], v14 offset:16384
    v_mfma_f32_16x16x32_bf16 v[28:31], v[92:95], v[180:183], v[28:31]
    ds_read_b64_tr_b16 v[62:63], v14 offset:18432
    v_mfma_f32_16x16x32_bf16 v[32:35], v[96:99], v[180:183], v[32:35]
    ds_read_b64_tr_b16 v[64:65], v15 offset:16384
    v_mfma_f32_16x16x32_bf16 v[48:51], v[96:99], v[184:187], v[48:51]
    ds_read_b64_tr_b16 v[66:67], v15 offset:18432
    v_mfma_f32_16x16x32_bf16 v[52:55], v[100:103], v[184:187], v[52:55]
    ds_read_b64_tr_b16 v[68:69], v16 offset:16384
    v_mfma_f32_16x16x32_bf16 v[36:39], v[100:103], v[180:183], v[36:39]
    ds_read_b64_tr_b16 v[70:71], v16 offset:18432
    s_waitcnt lgkmcnt(8)
    v_mfma_f32_16x16x32_bf16 v[24:27], v[104:107], v[188:191], v[24:27]
    ds_read_b64_tr_b16 v[72:73], v13 offset:20480
    buffer_load_dwordx4 v[180:183], v126, s[8:11], s44 offen offset:2048 sc1
    v_mfma_f32_16x16x32_bf16 v[40:43], v[104:107], v[192:195], v[40:43]
    ds_read_b64_tr_b16 v[74:75], v13 offset:22528
    buffer_load_dwordx4 v[184:187], v127, s[8:11], s44 offen offset:2048 sc1
    v_mfma_f32_16x16x32_bf16 v[44:47], v[108:111], v[192:195], v[44:47]
    ds_read_b64_tr_b16 v[76:77], v14 offset:20480
    s_waitcnt vmcnt(10)
    v_mfma_f32_16x16x32_bf16 v[28:31], v[108:111], v[188:191], v[28:31]
    ds_read_b64_tr_b16 v[78:79], v14 offset:22528
    v_or3_b32 v17, v196, v200, v204
    v_mfma_f32_16x16x32_bf16 v[32:35], v[112:115], v[188:191], v[32:35]
    ds_read_b64_tr_b16 v[80:81], v15 offset:20480
    v_bitop3_b32 v17, v17, v208, 1 bitop3:0xa8
    v_mfma_f32_16x16x32_bf16 v[48:51], v[112:115], v[192:195], v[48:51]
    ds_read_b64_tr_b16 v[82:83], v15 offset:22528
    v_cmp_ne_u32 vcc, 0, v17
    v_mfma_f32_16x16x32_bf16 v[52:55], v[116:119], v[192:195], v[52:55]
    ds_read_b64_tr_b16 v[84:85], v16 offset:20480
    ds_read_b64_tr_b16 v[86:87], v16 offset:22528
    v_mfma_f32_16x16x32_bf16 v[36:39], v[116:119], v[188:191], v[36:39]
    s_waitcnt lgkmcnt(8)
    s_cbranch_vccnz dm_22f1
dm_22g1:
    v_mfma_f32_16x16x32_bf16 v[24:27], v[56:59], v[196:199], v[24:27]
    ds_read_b64_tr_b16 v[88:89], v13 offset:24576
    buffer_load_dwordx4 v[188:191], v126, s[8:11], s44 offen offset:3072 sc1
    v_mfma_f32_16x16x32_bf16 v[40:43], v[56:59], v[200:203], v[40:43]
    ds_read_b64_tr_b16 v[90:91], v13 offset:26624
    buffer_load_dwordx4 v[192:195], v127, s[8:11], s44 offen offset:3072 sc1
    v_mfma_f32_16x16x32_bf16 v[44:47], v[60:63], v[200:203], v[44:47]
    ds_read_b64_tr_b16 v[92:93], v14 offset:24576
    v_mfma_f32_16x16x32_bf16 v[28:31], v[60:63], v[196:199], v[28:31]
    ds_read_b64_tr_b16 v[94:95], v14 offset:26624
    v_mfma_f32_16x16x32_bf16 v[32:35], v[64:67], v[196:199], v[32:35]
    ds_read_b64_tr_b16 v[96:97], v15 offset:24576
    s_add_u32 s43, s43, 1
    v_mfma_f32_16x16x32_bf16 v[48:51], v[64:67], v[200:203], v[48:51]
    ds_read_b64_tr_b16 v[98:99], v15 offset:26624
    v_mfma_f32_16x16x32_bf16 v[52:55], v[68:71], v[200:203], v[52:55]
    ds_read_b64_tr_b16 v[100:101], v16 offset:24576
    v_mfma_f32_16x16x32_bf16 v[36:39], v[68:71], v[196:199], v[36:39]
    ds_read_b64_tr_b16 v[102:103], v16 offset:26624
    s_waitcnt lgkmcnt(8)
    v_mfma_f32_16x16x32_bf16 v[24:27], v[72:75], v[204:207], v[24:27]
    ds_read_b64_tr_b16 v[104:105], v13 offset:28672
    buffer_load_dwordx4 v[196:199], v128, s[8:11], s44 offen offset:0 sc1
    v_mfma_f32_16x16x32_bf16 v[40:43], v[72:75], v[208:211], v[40:43]
    ds_read_b64_tr_b16 v[106:107], v13 offset:30720
    buffer_load_dwordx4 v[200:203], v129, s[8:11], s44 offen offset:0 sc1
    v_mfma_f32_16x16x32_bf16 v[44:47], v[76:79], v[208:211], v[44:47]
    ds_read_b64_tr_b16 v[108:109], v14 offset:28672
    s_waitcnt vmcnt(10)
    v_mfma_f32_16x16x32_bf16 v[28:31], v[76:79], v[204:207], v[28:31]
    ds_read_b64_tr_b16 v[110:111], v14 offset:30720
    v_add_u32 v13, 32768, v13
    v_or3_b32 v17, v212, v216, v220
    v_mfma_f32_16x16x32_bf16 v[32:35], v[80:83], v[204:207], v[32:35]
    ds_read_b64_tr_b16 v[112:113], v15 offset:28672
    v_add_u32 v14, 32768, v14
    v_bitop3_b32 v17, v17, v224, 1 bitop3:0xa8
    v_mfma_f32_16x16x32_bf16 v[48:51], v[80:83], v[208:211], v[48:51]
    ds_read_b64_tr_b16 v[114:115], v15 offset:30720
    v_add_u32 v15, 32768, v15
    v_cmp_ne_u32 vcc, 0, v17
    v_mfma_f32_16x16x32_bf16 v[52:55], v[84:87], v[208:211], v[52:55]
    ds_read_b64_tr_b16 v[116:117], v16 offset:28672
    ds_read_b64_tr_b16 v[118:119], v16 offset:30720
    s_cmp_eq_u32 s43, 4
    v_mfma_f32_16x16x32_bf16 v[36:39], v[84:87], v[204:207], v[36:39]
    v_add_u32 v16, 32768, v16
    s_waitcnt lgkmcnt(8)
    s_cbranch_vccnz dm_22f2
dm_22g2:
    s_cbranch_scc1 dm_22x
    v_mfma_f32_16x16x32_bf16 v[24:27], v[88:91], v[212:215], v[24:27]
    ds_read_b64_tr_b16 v[56:57], v13 offset:0
    buffer_load_dwordx4 v[204:207], v128, s[8:11], s44 offen offset:1024 sc1
    v_mfma_f32_16x16x32_bf16 v[40:43], v[88:91], v[216:219], v[40:43]
    ds_read_b64_tr_b16 v[58:59], v13 offset:2048
    buffer_load_dwordx4 v[208:211], v129, s[8:11], s44 offen offset:1024 sc1
    v_mfma_f32_16x16x32_bf16 v[44:47], v[92:95], v[216:219], v[44:47]
    ds_read_b64_tr_b16 v[60:61], v14 offset:0
    s_mov_b32 s49, s44
    v_mfma_f32_16x16x32_bf16 v[28:31], v[92:95], v[212:215], v[28:31]
    ds_read_b64_tr_b16 v[62:63], v14 offset:2048
    v_mfma_f32_16x16x32_bf16 v[32:35], v[96:99], v[212:215], v[32:35]
    ds_read_b64_tr_b16 v[64:65], v15 offset:0
    v_mfma_f32_16x16x32_bf16 v[48:51], v[96:99], v[216:219], v[48:51]
    ds_read_b64_tr_b16 v[66:67], v15 offset:2048
    v_mfma_f32_16x16x32_bf16 v[52:55], v[100:103], v[216:219], v[52:55]
    ds_read_b64_tr_b16 v[68:69], v16 offset:0
    v_mfma_f32_16x16x32_bf16 v[36:39], v[100:103], v[212:215], v[36:39]
    ds_read_b64_tr_b16 v[70:71], v16 offset:2048
    s_waitcnt lgkmcnt(8)
    v_mfma_f32_16x16x32_bf16 v[24:27], v[104:107], v[220:223], v[24:27]
    ds_read_b64_tr_b16 v[72:73], v13 offset:4096
    buffer_load_dwordx4 v[212:215], v128, s[8:11], s44 offen offset:2048 sc1
    v_mfma_f32_16x16x32_bf16 v[40:43], v[104:107], v[224:227], v[40:43]
    ds_read_b64_tr_b16 v[74:75], v13 offset:6144
    buffer_load_dwordx4 v[216:219], v129, s[8:11], s44 offen offset:2048 sc1
    v_mfma_f32_16x16x32_bf16 v[44:47], v[108:111], v[224:227], v[44:47]
    ds_read_b64_tr_b16 v[76:77], v14 offset:4096
    s_waitcnt vmcnt(10)
    v_mfma_f32_16x16x32_bf16 v[28:31], v[108:111], v[220:223], v[28:31]
    ds_read_b64_tr_b16 v[78:79], v14 offset:6144
    v_or3_b32 v17, v164, v168, v172
    v_mfma_f32_16x16x32_bf16 v[32:35], v[112:115], v[220:223], v[32:35]
    ds_read_b64_tr_b16 v[80:81], v15 offset:4096
    v_bitop3_b32 v17, v17, v176, 1 bitop3:0xa8
    v_mfma_f32_16x16x32_bf16 v[48:51], v[112:115], v[224:227], v[48:51]
    ds_read_b64_tr_b16 v[82:83], v15 offset:6144
    v_cmp_ne_u32 vcc, 0, v17
    v_mfma_f32_16x16x32_bf16 v[52:55], v[116:119], v[224:227], v[52:55]
    ds_read_b64_tr_b16 v[84:85], v16 offset:4096
    ds_read_b64_tr_b16 v[86:87], v16 offset:6144
    v_mfma_f32_16x16x32_bf16 v[36:39], v[116:119], v[220:223], v[36:39]
    s_waitcnt lgkmcnt(8)
    s_cbranch_vccnz dm_22f3
dm_22g3:
    s_branch dm_22
dm_22f0:
    s_cselect_b32 s50, 1, 0
dm_22h0:
    s_sleep 2
    buffer_load_dwordx4 v[180:183], v126, s[8:11], s49 offen offset:2048 sc1
    buffer_load_dwordx4 v[184:187], v127, s[8:11], s49 offen offset:2048 sc1
    buffer_load_dwordx4 v[188:191], v126, s[8:11], s49 offen offset:3072 sc1
    buffer_load_dwordx4 v[192:195], v127, s[8:11], s49 offen offset:3072 sc1
    buffer_load_dwordx4 v[196:199], v128, s[8:11], s49 offen offset:0 sc1
    buffer_load_dwordx4 v[200:203], v129, s[8:11], s49 offen offset:0 sc1
    buffer_load_dwordx4 v[204:207], v128, s[8:11], s49 offen offset:1024 sc1
    buffer_load_dwordx4 v[208:211], v129, s[8:11], s49 offen offset:1024 sc1
    buffer_load_dwordx4 v[212:215], v128, s[8:11], s49 offen offset:2048 sc1
    buffer_load_dwordx4 v[216:219], v129, s[8:11], s49 offen offset:2048 sc1
    buffer_load_dwordx4 v[220:223], v128, s[8:11], s49 offen offset:3072 sc1
    buffer_load_dwordx4 v[224:227], v129, s[8:11], s49 offen offset:3072 sc1
    buffer_load_dwordx4 v[164:167], v126, s[8:11], s44 offen offset:0 sc1
    buffer_load_dwordx4 v[168:171], v127, s[8:11], s44 offen offset:0 sc1
    s_waitcnt vmcnt(10)
    v_or3_b32 v17, v180, v184, v188
    v_bitop3_b32 v17, v17, v192, 1 bitop3:0xa8
    v_cmp_ne_u32 vcc, 0, v17
    s_add_u32 s53, s53, 1
    s_cmp_ge_u32 s53, s61
    s_cselect_b32 s61, 0, s61
    s_cbranch_scc1 dm_22k0
    s_cbranch_vccnz dm_22h0
dm_22k0:
    s_cmp_eq_u32 s50, 1
    s_branch dm_22g0
dm_22f1:
    s_cselect_b32 s50, 1, 0
dm_22h1:
    s_sleep 2
    buffer_load_dwordx4 v[196:199], v128, s[8:11], s49 offen offset:0 sc1
    buffer_load_dwordx4 v[200:203], v129, s[8:11], s49 offen offset:0 sc1
    buffer_load_dwordx4 v[204:207], v128, s[8:11], s49 offen offset:1024 sc1
    buffer_load_dwordx4 v[208:211], v129, s[8:11], s49 offen offset:1024 sc1
    buffer_load_dwordx4 v[212:215], v128, s[8:11], s49 offen offset:2048 sc1
    buffer_load_dwordx4 v[216:219], v129, s[8:11], s49 offen offset:2048 sc1
    buffer_load_dwordx4 v[220:223], v128, s[8:11], s49 offen offset:3072 sc1
    buffer_load_dwordx4 v[224:227], v129, s[8:11], s49 offen offset:3072 sc1
    buffer_load_dwordx4 v[164:167], v126, s[8:11], s44 offen offset:0 sc1
    buffer_load_dwordx4 v[168:171], v127, s[8:11], s44 offen offset:0 sc1
    buffer_load_dwordx4 v[172:175], v126, s[8:11], s44 offen offset:1024 sc1
    buffer_load_dwordx4 v[176:179], v127, s[8:11], s44 offen offset:1024 sc1
    buffer_load_dwordx4 v[180:183], v126, s[8:11], s44 offen offset:2048 sc1
    buffer_load_dwordx4 v[184:187], v127, s[8:11], s44 offen offset:2048 sc1
    s_waitcnt vmcnt(10)
    v_or3_b32 v17, v196, v200, v204
    v_bitop3_b32 v17, v17, v208, 1 bitop3:0xa8
    v_cmp_ne_u32 vcc, 0, v17
    s_add_u32 s53, s53, 1
    s_cmp_ge_u32 s53, s61
    s_cselect_b32 s61, 0, s61
    s_cbranch_scc1 dm_22k1
    s_cbranch_vccnz dm_22h1
dm_22k1:
    s_cmp_eq_u32 s50, 1
    s_branch dm_22g1
dm_22f2:
    s_cselect_b32 s50, 1, 0
dm_22h2:
    s_sleep 2
    buffer_load_dwordx4 v[212:215], v128, s[8:11], s49 offen offset:2048 sc1
    buffer_load_dwordx4 v[216:219], v129, s[8:11], s49 offen offset:2048 sc1
    buffer_load_dwordx4 v[220:223], v128, s[8:11], s49 offen offset:3072 sc1
    buffer_load_dwordx4 v[224:227], v129, s[8:11], s49 offen offset:3072 sc1
    buffer_load_dwordx4 v[164:167], v126, s[8:11], s44 offen offset:0 sc1
    buffer_load_dwordx4 v[168:171], v127, s[8:11], s44 offen offset:0 sc1
    buffer_load_dwordx4 v[172:175], v126, s[8:11], s44 offen offset:1024 sc1
    buffer_load_dwordx4 v[176:179], v127, s[8:11], s44 offen offset:1024 sc1
    buffer_load_dwordx4 v[180:183], v126, s[8:11], s44 offen offset:2048 sc1
    buffer_load_dwordx4 v[184:187], v127, s[8:11], s44 offen offset:2048 sc1
    buffer_load_dwordx4 v[188:191], v126, s[8:11], s44 offen offset:3072 sc1
    buffer_load_dwordx4 v[192:195], v127, s[8:11], s44 offen offset:3072 sc1
    buffer_load_dwordx4 v[196:199], v128, s[8:11], s44 offen offset:0 sc1
    buffer_load_dwordx4 v[200:203], v129, s[8:11], s44 offen offset:0 sc1
    s_waitcnt vmcnt(10)
    v_or3_b32 v17, v212, v216, v220
    v_bitop3_b32 v17, v17, v224, 1 bitop3:0xa8
    v_cmp_ne_u32 vcc, 0, v17
    s_add_u32 s53, s53, 1
    s_cmp_ge_u32 s53, s61
    s_cselect_b32 s61, 0, s61
    s_cbranch_scc1 dm_22k2
    s_cbranch_vccnz dm_22h2
dm_22k2:
    s_cmp_eq_u32 s50, 1
    s_branch dm_22g2
dm_22f3:
    s_cselect_b32 s50, 1, 0
dm_22h3:
    s_sleep 2
    buffer_load_dwordx4 v[164:167], v126, s[8:11], s49 offen offset:0 sc1
    buffer_load_dwordx4 v[168:171], v127, s[8:11], s49 offen offset:0 sc1
    buffer_load_dwordx4 v[172:175], v126, s[8:11], s49 offen offset:1024 sc1
    buffer_load_dwordx4 v[176:179], v127, s[8:11], s49 offen offset:1024 sc1
    buffer_load_dwordx4 v[180:183], v126, s[8:11], s49 offen offset:2048 sc1
    buffer_load_dwordx4 v[184:187], v127, s[8:11], s49 offen offset:2048 sc1
    buffer_load_dwordx4 v[188:191], v126, s[8:11], s49 offen offset:3072 sc1
    buffer_load_dwordx4 v[192:195], v127, s[8:11], s49 offen offset:3072 sc1
    buffer_load_dwordx4 v[196:199], v128, s[8:11], s49 offen offset:0 sc1
    buffer_load_dwordx4 v[200:203], v129, s[8:11], s49 offen offset:0 sc1
    buffer_load_dwordx4 v[204:207], v128, s[8:11], s49 offen offset:1024 sc1
    buffer_load_dwordx4 v[208:211], v129, s[8:11], s49 offen offset:1024 sc1
    buffer_load_dwordx4 v[212:215], v128, s[8:11], s49 offen offset:2048 sc1
    buffer_load_dwordx4 v[216:219], v129, s[8:11], s49 offen offset:2048 sc1
    s_waitcnt vmcnt(10)
    v_or3_b32 v17, v164, v168, v172
    v_bitop3_b32 v17, v17, v176, 1 bitop3:0xa8
    v_cmp_ne_u32 vcc, 0, v17
    s_add_u32 s53, s53, 1
    s_cmp_ge_u32 s53, s61
    s_cselect_b32 s61, 0, s61
    s_cbranch_scc1 dm_22k3
    s_cbranch_vccnz dm_22h3
dm_22k3:
    s_cmp_eq_u32 s50, 1
    s_branch dm_22g3
dm_22x:
    v_mfma_f32_16x16x32_bf16 v[24:27], v[88:91], v[212:215], v[24:27]
    buffer_load_dwordx4 v[148:151], v126, s[8:11], s41 offen offset:0 sc1
    v_mfma_f32_16x16x32_bf16 v[40:43], v[88:91], v[216:219], v[40:43]
    v_mfma_f32_16x16x32_bf16 v[44:47], v[92:95], v[216:219], v[44:47]
    buffer_load_dwordx4 v[152:155], v126, s[8:11], s41 offen offset:1024 sc1
    v_mfma_f32_16x16x32_bf16 v[28:31], v[92:95], v[212:215], v[28:31]
    v_mfma_f32_16x16x32_bf16 v[32:35], v[96:99], v[212:215], v[32:35]
    buffer_load_dwordx4 v[156:159], v127, s[8:11], s41 offen offset:0 sc1
    v_mfma_f32_16x16x32_bf16 v[48:51], v[96:99], v[216:219], v[48:51]
    v_mfma_f32_16x16x32_bf16 v[52:55], v[100:103], v[216:219], v[52:55]
    buffer_load_dwordx4 v[160:163], v127, s[8:11], s41 offen offset:1024 sc1
    v_mfma_f32_16x16x32_bf16 v[36:39], v[100:103], v[212:215], v[36:39]
    s_waitcnt lgkmcnt(0)
    s_barrier
    v_mfma_f32_16x16x32_bf16 v[24:27], v[104:107], v[220:223], v[24:27]
    ds_read_b128 v[56:59], v6 offset:0
    v_mfma_f32_16x16x32_bf16 v[40:43], v[104:107], v[224:227], v[40:43]
    ds_read_b128 v[60:63], v6 offset:64
    v_mfma_f32_16x16x32_bf16 v[44:47], v[108:111], v[224:227], v[44:47]
    ds_read_b128 v[64:67], v6 offset:128
    v_mfma_f32_16x16x32_bf16 v[28:31], v[108:111], v[220:223], v[28:31]
    ds_read_b128 v[68:71], v6 offset:192
    v_mfma_f32_16x16x32_bf16 v[32:35], v[112:115], v[220:223], v[32:35]
    ds_read_b64 v[72:73], v7 offset:0
    v_mfma_f32_16x16x32_bf16 v[48:51], v[112:115], v[224:227], v[48:51]
    ds_read_b64 v[74:75], v7 offset:256
    v_mfma_f32_16x16x32_bf16 v[52:55], v[116:119], v[224:227], v[52:55]
    v_mfma_f32_16x16x32_bf16 v[36:39], v[116:119], v[220:223], v[36:39]
    s_waitcnt lgkmcnt(0)
    v_mul_f32 v134, 0xc0135761, v73
    v_mul_f32 v135, v73, v73
    v_mul_f32 v135, v135, v134
    v_mul_f32 v135, 0x3d372713, v135
    v_rcp_f32 v73, v73
    v_mul_f32 v136, 0xc0135761, v75
    v_mul_f32 v137, v75, v75
    v_mul_f32 v137, v137, v136
    v_mul_f32 v137, 0x3d372713, v137
    v_rcp_f32 v75, v75
    v_pk_fma_f32 v[24:25], v[72:73], v[56:57], v[24:25] op_sel_hi:[0,1,1] neg_lo:[1,0,0] neg_hi:[1,0,0]
    v_pk_fma_f32 v[26:27], v[72:73], v[58:59], v[26:27] op_sel_hi:[0,1,1] neg_lo:[1,0,0] neg_hi:[1,0,0]
    v_pk_mul_f32 v[122:123], v[24:25], v[24:25]
    v_pk_mul_f32 v[124:125], v[26:27], v[26:27]
    v_pk_fma_f32 v[122:123], v[122:123], v[134:135], v[134:135] op_sel:[0,1,0] op_sel_hi:[1,1,0]
    v_pk_fma_f32 v[124:125], v[124:125], v[134:135], v[134:135] op_sel:[0,1,0] op_sel_hi:[1,1,0]
    v_pk_mul_f32 v[122:123], v[122:123], v[24:25]
    v_pk_mul_f32 v[124:125], v[124:125], v[26:27]
    v_exp_f32 v122, v122
    v_exp_f32 v123, v123
    v_exp_f32 v124, v124
    v_exp_f32 v125, v125
    v_pk_fma_f32 v[122:123], v[122:123], v[72:73], v[72:73] op_sel:[0,1,1] op_sel_hi:[1,1,1]
    v_pk_fma_f32 v[124:125], v[124:125], v[72:73], v[72:73] op_sel:[0,1,1] op_sel_hi:[1,1,1]
    v_rcp_f32 v122, v122
    v_rcp_f32 v123, v123
    v_rcp_f32 v124, v124
    v_rcp_f32 v125, v125
    v_pk_mul_f32 v[24:25], v[24:25], v[122:123]
    v_pk_mul_f32 v[26:27], v[26:27], v[124:125]
    v_pk_fma_f32 v[28:29], v[72:73], v[60:61], v[28:29] op_sel_hi:[0,1,1] neg_lo:[1,0,0] neg_hi:[1,0,0]
    v_pk_fma_f32 v[30:31], v[72:73], v[62:63], v[30:31] op_sel_hi:[0,1,1] neg_lo:[1,0,0] neg_hi:[1,0,0]
    v_pk_mul_f32 v[122:123], v[28:29], v[28:29]
    v_pk_mul_f32 v[124:125], v[30:31], v[30:31]
    v_pk_fma_f32 v[122:123], v[122:123], v[134:135], v[134:135] op_sel:[0,1,0] op_sel_hi:[1,1,0]
    v_pk_fma_f32 v[124:125], v[124:125], v[134:135], v[134:135] op_sel:[0,1,0] op_sel_hi:[1,1,0]
    v_pk_mul_f32 v[122:123], v[122:123], v[28:29]
    v_pk_mul_f32 v[124:125], v[124:125], v[30:31]
    v_exp_f32 v122, v122
    v_exp_f32 v123, v123
    v_exp_f32 v124, v124
    v_exp_f32 v125, v125
    v_pk_fma_f32 v[122:123], v[122:123], v[72:73], v[72:73] op_sel:[0,1,1] op_sel_hi:[1,1,1]
    v_pk_fma_f32 v[124:125], v[124:125], v[72:73], v[72:73] op_sel:[0,1,1] op_sel_hi:[1,1,1]
    v_rcp_f32 v122, v122
    v_rcp_f32 v123, v123
    v_rcp_f32 v124, v124
    v_rcp_f32 v125, v125
    v_pk_mul_f32 v[28:29], v[28:29], v[122:123]
    v_pk_mul_f32 v[30:31], v[30:31], v[124:125]
    v_cvt_pk_bf16_f32 v24, v24, v25
    v_cvt_pk_bf16_f32 v25, v26, v27
    v_cvt_pk_bf16_f32 v26, v28, v29
    v_cvt_pk_bf16_f32 v27, v30, v31
    v_and_b32 v24, -2, v24
    buffer_store_dwordx4 v[24:27], v12, s[16:19], s39 offen offset:0 sc1
    v_pk_fma_f32 v[40:41], v[74:75], v[56:57], v[40:41] op_sel_hi:[0,1,1] neg_lo:[1,0,0] neg_hi:[1,0,0]
    v_pk_fma_f32 v[42:43], v[74:75], v[58:59], v[42:43] op_sel_hi:[0,1,1] neg_lo:[1,0,0] neg_hi:[1,0,0]
    v_pk_mul_f32 v[122:123], v[40:41], v[40:41]
    v_pk_mul_f32 v[124:125], v[42:43], v[42:43]
    v_pk_fma_f32 v[122:123], v[122:123], v[136:137], v[136:137] op_sel:[0,1,0] op_sel_hi:[1,1,0]
    v_pk_fma_f32 v[124:125], v[124:125], v[136:137], v[136:137] op_sel:[0,1,0] op_sel_hi:[1,1,0]
    v_pk_mul_f32 v[122:123], v[122:123], v[40:41]
    v_pk_mul_f32 v[124:125], v[124:125], v[42:43]
    v_exp_f32 v122, v122
    v_exp_f32 v123, v123
    v_exp_f32 v124, v124
    v_exp_f32 v125, v125
    v_pk_fma_f32 v[122:123], v[122:123], v[74:75], v[74:75] op_sel:[0,1,1] op_sel_hi:[1,1,1]
    v_pk_fma_f32 v[124:125], v[124:125], v[74:75], v[74:75] op_sel:[0,1,1] op_sel_hi:[1,1,1]
    v_rcp_f32 v122, v122
    v_rcp_f32 v123, v123
    v_rcp_f32 v124, v124
    v_rcp_f32 v125, v125
    v_pk_mul_f32 v[40:41], v[40:41], v[122:123]
    v_pk_mul_f32 v[42:43], v[42:43], v[124:125]
    v_pk_fma_f32 v[44:45], v[74:75], v[60:61], v[44:45] op_sel_hi:[0,1,1] neg_lo:[1,0,0] neg_hi:[1,0,0]
    v_pk_fma_f32 v[46:47], v[74:75], v[62:63], v[46:47] op_sel_hi:[0,1,1] neg_lo:[1,0,0] neg_hi:[1,0,0]
    v_pk_mul_f32 v[122:123], v[44:45], v[44:45]
    v_pk_mul_f32 v[124:125], v[46:47], v[46:47]
    v_pk_fma_f32 v[122:123], v[122:123], v[136:137], v[136:137] op_sel:[0,1,0] op_sel_hi:[1,1,0]
    v_pk_fma_f32 v[124:125], v[124:125], v[136:137], v[136:137] op_sel:[0,1,0] op_sel_hi:[1,1,0]
    v_pk_mul_f32 v[122:123], v[122:123], v[44:45]
    v_pk_mul_f32 v[124:125], v[124:125], v[46:47]
    v_exp_f32 v122, v122
    v_exp_f32 v123, v123
    v_exp_f32 v124, v124
    v_exp_f32 v125, v125
    v_pk_fma_f32 v[122:123], v[122:123], v[74:75], v[74:75] op_sel:[0,1,1] op_sel_hi:[1,1,1]
    v_pk_fma_f32 v[124:125], v[124:125], v[74:75], v[74:75] op_sel:[0,1,1] op_sel_hi:[1,1,1]
    v_rcp_f32 v122, v122
    v_rcp_f32 v123, v123
    v_rcp_f32 v124, v124
    v_rcp_f32 v125, v125
    v_pk_mul_f32 v[44:45], v[44:45], v[122:123]
    v_pk_mul_f32 v[46:47], v[46:47], v[124:125]
    v_cvt_pk_bf16_f32 v40, v40, v41
    v_cvt_pk_bf16_f32 v41, v42, v43
    v_cvt_pk_bf16_f32 v42, v44, v45
    v_cvt_pk_bf16_f32 v43, v46, v47
    v_and_b32 v40, -2, v40
    buffer_store_dwordx4 v[40:43], v12, s[16:19], s39 offen offset:256 sc1
    v_pk_fma_f32 v[32:33], v[72:73], v[64:65], v[32:33] op_sel_hi:[0,1,1] neg_lo:[1,0,0] neg_hi:[1,0,0]
    v_pk_fma_f32 v[34:35], v[72:73], v[66:67], v[34:35] op_sel_hi:[0,1,1] neg_lo:[1,0,0] neg_hi:[1,0,0]
    v_pk_mul_f32 v[122:123], v[32:33], v[32:33]
    v_pk_mul_f32 v[124:125], v[34:35], v[34:35]
    v_pk_fma_f32 v[122:123], v[122:123], v[134:135], v[134:135] op_sel:[0,1,0] op_sel_hi:[1,1,0]
    v_pk_fma_f32 v[124:125], v[124:125], v[134:135], v[134:135] op_sel:[0,1,0] op_sel_hi:[1,1,0]
    v_pk_mul_f32 v[122:123], v[122:123], v[32:33]
    v_pk_mul_f32 v[124:125], v[124:125], v[34:35]
    v_exp_f32 v122, v122
    v_exp_f32 v123, v123
    v_exp_f32 v124, v124
    v_exp_f32 v125, v125
    v_pk_fma_f32 v[122:123], v[122:123], v[72:73], v[72:73] op_sel:[0,1,1] op_sel_hi:[1,1,1]
    v_pk_fma_f32 v[124:125], v[124:125], v[72:73], v[72:73] op_sel:[0,1,1] op_sel_hi:[1,1,1]
    v_rcp_f32 v122, v122
    v_rcp_f32 v123, v123
    v_rcp_f32 v124, v124
    v_rcp_f32 v125, v125
    v_pk_mul_f32 v[32:33], v[32:33], v[122:123]
    v_pk_mul_f32 v[34:35], v[34:35], v[124:125]
    v_pk_fma_f32 v[36:37], v[72:73], v[68:69], v[36:37] op_sel_hi:[0,1,1] neg_lo:[1,0,0] neg_hi:[1,0,0]
    v_pk_fma_f32 v[38:39], v[72:73], v[70:71], v[38:39] op_sel_hi:[0,1,1] neg_lo:[1,0,0] neg_hi:[1,0,0]
    v_pk_mul_f32 v[122:123], v[36:37], v[36:37]
    v_pk_mul_f32 v[124:125], v[38:39], v[38:39]
    v_pk_fma_f32 v[122:123], v[122:123], v[134:135], v[134:135] op_sel:[0,1,0] op_sel_hi:[1,1,0]
    v_pk_fma_f32 v[124:125], v[124:125], v[134:135], v[134:135] op_sel:[0,1,0] op_sel_hi:[1,1,0]
    v_pk_mul_f32 v[122:123], v[122:123], v[36:37]
    v_pk_mul_f32 v[124:125], v[124:125], v[38:39]
    v_exp_f32 v122, v122
    v_exp_f32 v123, v123
    v_exp_f32 v124, v124
    v_exp_f32 v125, v125
    v_pk_fma_f32 v[122:123], v[122:123], v[72:73], v[72:73] op_sel:[0,1,1] op_sel_hi:[1,1,1]
    v_pk_fma_f32 v[124:125], v[124:125], v[72:73], v[72:73] op_sel:[0,1,1] op_sel_hi:[1,1,1]
    v_rcp_f32 v122, v122
    v_rcp_f32 v123, v123
    v_rcp_f32 v124, v124
    v_rcp_f32 v125, v125
    v_pk_mul_f32 v[36:37], v[36:37], v[122:123]
    v_pk_mul_f32 v[38:39], v[38:39], v[124:125]
    v_cvt_pk_bf16_f32 v32, v32, v33
    v_cvt_pk_bf16_f32 v33, v34, v35
    v_cvt_pk_bf16_f32 v34, v36, v37
    v_cvt_pk_bf16_f32 v35, v38, v39
    v_and_b32 v32, -2, v32
    buffer_store_dwordx4 v[32:35], v12, s[16:19], s40 offen offset:0 sc1
    v_pk_fma_f32 v[48:49], v[74:75], v[64:65], v[48:49] op_sel_hi:[0,1,1] neg_lo:[1,0,0] neg_hi:[1,0,0]
    v_pk_fma_f32 v[50:51], v[74:75], v[66:67], v[50:51] op_sel_hi:[0,1,1] neg_lo:[1,0,0] neg_hi:[1,0,0]
    v_pk_mul_f32 v[122:123], v[48:49], v[48:49]
    v_pk_mul_f32 v[124:125], v[50:51], v[50:51]
    v_pk_fma_f32 v[122:123], v[122:123], v[136:137], v[136:137] op_sel:[0,1,0] op_sel_hi:[1,1,0]
    v_pk_fma_f32 v[124:125], v[124:125], v[136:137], v[136:137] op_sel:[0,1,0] op_sel_hi:[1,1,0]
    v_pk_mul_f32 v[122:123], v[122:123], v[48:49]
    v_pk_mul_f32 v[124:125], v[124:125], v[50:51]
    v_exp_f32 v122, v122
    v_exp_f32 v123, v123
    v_exp_f32 v124, v124
    v_exp_f32 v125, v125
    v_pk_fma_f32 v[122:123], v[122:123], v[74:75], v[74:75] op_sel:[0,1,1] op_sel_hi:[1,1,1]
    v_pk_fma_f32 v[124:125], v[124:125], v[74:75], v[74:75] op_sel:[0,1,1] op_sel_hi:[1,1,1]
    v_rcp_f32 v122, v122
    v_rcp_f32 v123, v123
    v_rcp_f32 v124, v124
    v_rcp_f32 v125, v125
    v_pk_mul_f32 v[48:49], v[48:49], v[122:123]
    v_pk_mul_f32 v[50:51], v[50:51], v[124:125]
    v_pk_fma_f32 v[52:53], v[74:75], v[68:69], v[52:53] op_sel_hi:[0,1,1] neg_lo:[1,0,0] neg_hi:[1,0,0]
    v_pk_fma_f32 v[54:55], v[74:75], v[70:71], v[54:55] op_sel_hi:[0,1,1] neg_lo:[1,0,0] neg_hi:[1,0,0]
    v_pk_mul_f32 v[122:123], v[52:53], v[52:53]
    v_pk_mul_f32 v[124:125], v[54:55], v[54:55]
    v_pk_fma_f32 v[122:123], v[122:123], v[136:137], v[136:137] op_sel:[0,1,0] op_sel_hi:[1,1,0]
    v_pk_fma_f32 v[124:125], v[124:125], v[136:137], v[136:137] op_sel:[0,1,0] op_sel_hi:[1,1,0]
    v_pk_mul_f32 v[122:123], v[122:123], v[52:53]
    v_pk_mul_f32 v[124:125], v[124:125], v[54:55]
    v_exp_f32 v122, v122
    v_exp_f32 v123, v123
    v_exp_f32 v124, v124
    v_exp_f32 v125, v125
    v_pk_fma_f32 v[122:123], v[122:123], v[74:75], v[74:75] op_sel:[0,1,1] op_sel_hi:[1,1,1]
    v_pk_fma_f32 v[124:125], v[124:125], v[74:75], v[74:75] op_sel:[0,1,1] op_sel_hi:[1,1,1]
    v_rcp_f32 v122, v122
    v_rcp_f32 v123, v123
    v_rcp_f32 v124, v124
    v_rcp_f32 v125, v125
    v_pk_mul_f32 v[52:53], v[52:53], v[122:123]
    v_pk_mul_f32 v[54:55], v[54:55], v[124:125]
    v_cvt_pk_bf16_f32 v48, v48, v49
    v_cvt_pk_bf16_f32 v49, v50, v51
    v_cvt_pk_bf16_f32 v50, v52, v53
    v_cvt_pk_bf16_f32 v51, v54, v55
    v_and_b32 v48, -2, v48
    buffer_store_dwordx4 v[48:51], v12, s[16:19], s40 offen offset:256 sc1
    s_add_u32 s8, s4, 0x2100000
    s_addc_u32 s9, s5, 0
    s_mov_b32 s10, 0x8400000
    s_mov_b32 s11, 0x20000
    s_sub_u32 s47, s55, 39583744
    s_lshl_b32 s46, s30, 9
    s_add_u32 s47, s47, s46
    s_add_u32 s45, s92, 2048
    s_cmp_eq_u32 s28, 0
    s_cselect_b32 s45, 1073741824, s45
    s_cmp_eq_u32 s30, 0
    s_cselect_b32 s45, s45, 0
    s_add_u32 s53, s47, 0xfffffff0
    v_add_u32 v126, s53, v12
    v_add_u32 v127, 256, v126
    v_add_u32 v134, s45, v126
    v_cmp_gt_u32 vcc, 1, v22
    s_nop 1
    v_cndmask_b32 v126, v126, v134, vcc
    s_mov_b32 s34, s30
    s_mov_b32 s35, 0
    v_and_b32 v22, 15, v1
    v_lshrrev_b32 v23, 4, v1
    s_mul_i32 s37, s34, 2
    s_mul_i32 s38, s29, 4
    s_mul_i32 s36, s35, 4
    s_add_u32 s38, s38, s36
    s_lshr_b32 s36, s38, 1
    s_lshr_b32 s53, s36, 3
    s_lshl_b32 s53, s53, 14
    s_and_b32 s39, s36, 7
    s_lshl_b32 s39, s39, 10
    s_add_u32 s39, s39, s53
    s_lshl_b32 s36, s37, 16
    s_add_u32 s39, s39, s36
    s_sub_u32 s46, s93, 2048
    s_cmp_eq_u32 s28, 15
    s_cselect_b32 s46, 1073741824, s46
    s_cmp_eq_u32 s30, 3
    s_cselect_b32 s46, s46, 0
    s_add_u32 s53, s47, 0x10
    v_add_u32 v128, s53, v12
    v_add_u32 v129, 256, v128
    v_add_u32 v134, s46, v129
    v_cmp_le_u32 vcc, 15, v22
    s_nop 1
    v_cndmask_b32 v129, v129, v134, vcc
    s_add_u32 s53, s47, 0xffffffe0
    v_add_u32 v130, s53, v12
    v_add_u32 v131, 256, v130
    v_add_u32 v134, s45, v130
    v_cmp_gt_u32 vcc, 2, v22
    s_nop 1
    v_cndmask_b32 v130, v130, v134, vcc
    s_add_u32 s53, s47, 0x20
    v_add_u32 v132, s53, v12
    v_add_u32 v133, 256, v132
    v_add_u32 v134, s46, v133
    v_cmp_le_u32 vcc, 14, v22
    s_nop 1
    v_cndmask_b32 v133, v133, v134, vcc
    v_mov_b32 v134, v126
    v_mov_b32 v135, v127
    v_lshrrev_b32 v6, 2, v1
    v_mul_u32_u24 v13, 128, v6
    v_and_b32 v7, 3, v1
    v_lshl_add_u32 v13, v7, 3, v13
    v_add_u32 v13, 0, v13
    v_bfe_u32 v6, v6, 1, 2
    s_mul_i32 s36, s35, 4
    s_add_u32 s36, s36, 3
    v_xor_b32 v7, s36, v6
    v_lshl_add_u32 v16, v7, 5, v13
    s_mul_i32 s36, s35, 4
    s_add_u32 s36, s36, 2
    v_xor_b32 v7, s36, v6
    v_lshl_add_u32 v15, v7, 5, v13
    s_mul_i32 s36, s35, 4
    s_add_u32 s36, s36, 1
    v_xor_b32 v7, s36, v6
    v_lshl_add_u32 v14, v7, 5, v13
    s_mul_i32 s36, s35, 4
    s_add_u32 s36, s36, 0
    v_xor_b32 v7, s36, v6
    v_lshl_add_u32 v13, v7, 5, v13
    s_lshl_b32 s36, s37, 8
    s_add_u32 s36, s36, 160768
    v_lshlrev_b32 v7, 4, v22
    v_add_u32 v7, s36, v7
    ds_read_b64 v[56:57], v7 offset:0
    ds_read_b64 v[58:59], v7 offset:256
    s_waitcnt vmcnt(4) lgkmcnt(0)
    s_sleep 6
    s_cmp_lg_u32 s60, 0
    s_cbranch_scc1 G2_nd
    s_sleep 2
G2_nd:
    s_mov_b32 s44, 0
    buffer_load_dwordx4 v[164:167], v126, s[8:11], s44 offen sc1
    buffer_load_dwordx4 v[168:171], v127, s[8:11], s44 offen sc1
    s_add_u32 s44, s44, 16384
    buffer_load_dwordx4 v[172:175], v126, s[8:11], s44 offen sc1
    buffer_load_dwordx4 v[176:179], v127, s[8:11], s44 offen sc1
    s_add_u32 s44, s44, 16384
    buffer_load_dwordx4 v[180:183], v126, s[8:11], s44 offen
    buffer_load_dwordx4 v[184:187], v127, s[8:11], s44 offen
    s_add_u32 s44, s44, 16384
    buffer_load_dwordx4 v[188:191], v126, s[8:11], s44 offen
    buffer_load_dwordx4 v[192:195], v127, s[8:11], s44 offen
    s_add_u32 s44, s44, 16384
    v_lshlrev_b32 v24, 16, v148
    v_and_b32 v25, 0xffff0000, v148
    v_pk_add_f32 v[24:25], v[24:25], v[56:57] op_sel_hi:[1,0] neg_lo:[0,1] neg_hi:[0,1]
    v_pk_mul_f32 v[24:25], v[24:25], v[56:57] op_sel:[0,1] op_sel_hi:[1,1]
    v_lshlrev_b32 v26, 16, v149
    v_and_b32 v27, 0xffff0000, v149
    v_pk_add_f32 v[26:27], v[26:27], v[56:57] op_sel_hi:[1,0] neg_lo:[0,1] neg_hi:[0,1]
    v_pk_mul_f32 v[26:27], v[26:27], v[56:57] op_sel:[0,1] op_sel_hi:[1,1]
    v_lshlrev_b32 v28, 16, v150
    v_and_b32 v29, 0xffff0000, v150
    v_pk_add_f32 v[28:29], v[28:29], v[56:57] op_sel_hi:[1,0] neg_lo:[0,1] neg_hi:[0,1]
    v_pk_mul_f32 v[28:29], v[28:29], v[56:57] op_sel:[0,1] op_sel_hi:[1,1]
    v_lshlrev_b32 v30, 16, v151
    v_and_b32 v31, 0xffff0000, v151
    v_pk_add_f32 v[30:31], v[30:31], v[56:57] op_sel_hi:[1,0] neg_lo:[0,1] neg_hi:[0,1]
    v_pk_mul_f32 v[30:31], v[30:31], v[56:57] op_sel:[0,1] op_sel_hi:[1,1]
    v_lshlrev_b32 v32, 16, v152
    v_and_b32 v33, 0xffff0000, v152
    v_pk_add_f32 v[32:33], v[32:33], v[56:57] op_sel_hi:[1,0] neg_lo:[0,1] neg_hi:[0,1]
    v_pk_mul_f32 v[32:33], v[32:33], v[56:57] op_sel:[0,1] op_sel_hi:[1,1]
    v_lshlrev_b32 v34, 16, v153
    v_and_b32 v35, 0xffff0000, v153
    v_pk_add_f32 v[34:35], v[34:35], v[56:57] op_sel_hi:[1,0] neg_lo:[0,1] neg_hi:[0,1]
    v_pk_mul_f32 v[34:35], v[34:35], v[56:57] op_sel:[0,1] op_sel_hi:[1,1]
    v_lshlrev_b32 v36, 16, v154
    v_and_b32 v37, 0xffff0000, v154
    v_pk_add_f32 v[36:37], v[36:37], v[56:57] op_sel_hi:[1,0] neg_lo:[0,1] neg_hi:[0,1]
    v_pk_mul_f32 v[36:37], v[36:37], v[56:57] op_sel:[0,1] op_sel_hi:[1,1]
    v_lshlrev_b32 v38, 16, v155
    v_and_b32 v39, 0xffff0000, v155
    v_pk_add_f32 v[38:39], v[38:39], v[56:57] op_sel_hi:[1,0] neg_lo:[0,1] neg_hi:[0,1]
    v_pk_mul_f32 v[38:39], v[38:39], v[56:57] op_sel:[0,1] op_sel_hi:[1,1]
    v_lshlrev_b32 v40, 16, v156
    v_and_b32 v41, 0xffff0000, v156
    v_pk_add_f32 v[40:41], v[40:41], v[58:59] op_sel_hi:[1,0] neg_lo:[0,1] neg_hi:[0,1]
    v_pk_mul_f32 v[40:41], v[40:41], v[58:59] op_sel:[0,1] op_sel_hi:[1,1]
    v_lshlrev_b32 v42, 16, v157
    v_and_b32 v43, 0xffff0000, v157
    v_pk_add_f32 v[42:43], v[42:43], v[58:59] op_sel_hi:[1,0] neg_lo:[0,1] neg_hi:[0,1]
    v_pk_mul_f32 v[42:43], v[42:43], v[58:59] op_sel:[0,1] op_sel_hi:[1,1]
    v_lshlrev_b32 v44, 16, v158
    v_and_b32 v45, 0xffff0000, v158
    v_pk_add_f32 v[44:45], v[44:45], v[58:59] op_sel_hi:[1,0] neg_lo:[0,1] neg_hi:[0,1]
    v_pk_mul_f32 v[44:45], v[44:45], v[58:59] op_sel:[0,1] op_sel_hi:[1,1]
    v_lshlrev_b32 v46, 16, v159
    v_and_b32 v47, 0xffff0000, v159
    v_pk_add_f32 v[46:47], v[46:47], v[58:59] op_sel_hi:[1,0] neg_lo:[0,1] neg_hi:[0,1]
    v_pk_mul_f32 v[46:47], v[46:47], v[58:59] op_sel:[0,1] op_sel_hi:[1,1]
    v_lshlrev_b32 v48, 16, v160
    v_and_b32 v49, 0xffff0000, v160
    v_pk_add_f32 v[48:49], v[48:49], v[58:59] op_sel_hi:[1,0] neg_lo:[0,1] neg_hi:[0,1]
    v_pk_mul_f32 v[48:49], v[48:49], v[58:59] op_sel:[0,1] op_sel_hi:[1,1]
    v_lshlrev_b32 v50, 16, v161
    v_and_b32 v51, 0xffff0000, v161
    v_pk_add_f32 v[50:51], v[50:51], v[58:59] op_sel_hi:[1,0] neg_lo:[0,1] neg_hi:[0,1]
    v_pk_mul_f32 v[50:51], v[50:51], v[58:59] op_sel:[0,1] op_sel_hi:[1,1]
    v_lshlrev_b32 v52, 16, v162
    v_and_b32 v53, 0xffff0000, v162
    v_pk_add_f32 v[52:53], v[52:53], v[58:59] op_sel_hi:[1,0] neg_lo:[0,1] neg_hi:[0,1]
    v_pk_mul_f32 v[52:53], v[52:53], v[58:59] op_sel:[0,1] op_sel_hi:[1,1]
    v_lshlrev_b32 v54, 16, v163
    v_and_b32 v55, 0xffff0000, v163
    v_pk_add_f32 v[54:55], v[54:55], v[58:59] op_sel_hi:[1,0] neg_lo:[0,1] neg_hi:[0,1]
    v_pk_mul_f32 v[54:55], v[54:55], v[58:59] op_sel:[0,1] op_sel_hi:[1,1]
    s_mov_b32 s43, 0
    s_add_u32 s16, s62, 0x80000
    s_addc_u32 s17, s63, 0
    s_mov_b32 s18, 0x7e000
    s_mov_b32 s19, 0x20000
    s_mov_b32 s53, 0
    s_mov_b32 s49, s44
    s_barrier
    ds_read_b64_tr_b16 v[56:57], v13 offset:0
    ds_read_b64_tr_b16 v[58:59], v13 offset:2048
    ds_read_b64_tr_b16 v[60:61], v14 offset:0
    ds_read_b64_tr_b16 v[62:63], v14 offset:2048
    ds_read_b64_tr_b16 v[64:65], v15 offset:0
    ds_read_b64_tr_b16 v[66:67], v15 offset:2048
    ds_read_b64_tr_b16 v[68:69], v16 offset:0
    ds_read_b64_tr_b16 v[70:71], v16 offset:2048
    ds_read_b64_tr_b16 v[72:73], v13 offset:4096
    ds_read_b64_tr_b16 v[74:75], v13 offset:6144
    ds_read_b64_tr_b16 v[76:77], v14 offset:4096
    ds_read_b64_tr_b16 v[78:79], v14 offset:6144
    ds_read_b64_tr_b16 v[80:81], v15 offset:4096
    ds_read_b64_tr_b16 v[82:83], v15 offset:6144
    ds_read_b64_tr_b16 v[84:85], v16 offset:4096
    ds_read_b64_tr_b16 v[86:87], v16 offset:6144
    s_branch dm_23w
dm_23p:
    s_mov_b32 s44, 0
    buffer_load_dwordx4 v[164:167], v126, s[8:11], s44 offen sc1
    buffer_load_dwordx4 v[168:171], v127, s[8:11], s44 offen sc1
    s_add_u32 s44, s44, 16384
    buffer_load_dwordx4 v[172:175], v126, s[8:11], s44 offen sc1
    buffer_load_dwordx4 v[176:179], v127, s[8:11], s44 offen sc1
    s_add_u32 s44, s44, 16384
    buffer_load_dwordx4 v[180:183], v126, s[8:11], s44 offen
    buffer_load_dwordx4 v[184:187], v127, s[8:11], s44 offen
    s_add_u32 s44, s44, 16384
    buffer_load_dwordx4 v[188:191], v126, s[8:11], s44 offen
    buffer_load_dwordx4 v[192:195], v127, s[8:11], s44 offen
    s_add_u32 s44, s44, 16384
dm_23w:
    s_waitcnt vmcnt(4)
    v_or3_b32 v17, v164, v168, v172
    v_bitop3_b32 v17, v17, v176, 1 bitop3:0xa8
    v_cmp_ne_u32 vcc, 0, v17
    s_cbranch_vccz dm_23q
dm_23r:
    s_sleep 2
    s_mov_b32 s44, 0
    buffer_load_dwordx4 v[164:167], v126, s[8:11], s44 offen sc1
    buffer_load_dwordx4 v[168:171], v127, s[8:11], s44 offen sc1
    s_add_u32 s44, s44, 16384
    buffer_load_dwordx4 v[172:175], v126, s[8:11], s44 offen sc1
    buffer_load_dwordx4 v[176:179], v127, s[8:11], s44 offen sc1
    s_add_u32 s44, s44, 16384
    buffer_load_dwordx4 v[180:183], v126, s[8:11], s44 offen sc1
    buffer_load_dwordx4 v[184:187], v127, s[8:11], s44 offen sc1
    s_add_u32 s44, s44, 16384
    buffer_load_dwordx4 v[188:191], v126, s[8:11], s44 offen sc1
    buffer_load_dwordx4 v[192:195], v127, s[8:11], s44 offen sc1
    s_add_u32 s44, s44, 16384
    s_waitcnt vmcnt(4)
    v_or3_b32 v17, v164, v168, v172
    v_bitop3_b32 v17, v17, v176, 1 bitop3:0xa8
    v_cmp_ne_u32 vcc, 0, v17
    s_cbranch_vccz dm_23t
    s_add_u32 s53, s53, 1
    s_cmp_lt_u32 s53, s61
    s_cbranch_scc1 dm_23r
    s_mov_b32 s61, 0
    s_branch dm_23t
dm_23q:
dm_23t:
    buffer_load_dwordx4 v[196:199], v126, s[8:11], s44 offen
    buffer_load_dwordx4 v[200:203], v127, s[8:11], s44 offen
    s_add_u32 s44, s44, 16384
    buffer_load_dwordx4 v[204:207], v126, s[8:11], s44 offen
    buffer_load_dwordx4 v[208:211], v127, s[8:11], s44 offen
    s_add_u32 s44, s44, 16384
    buffer_load_dwordx4 v[212:215], v126, s[8:11], s44 offen
    buffer_load_dwordx4 v[216:219], v127, s[8:11], s44 offen
    s_add_u32 s44, s44, 16384
    s_waitcnt lgkmcnt(0)
dm_23:
    v_mfma_f32_16x16x32_bf16 v[24:27], v[56:59], v[164:167], v[24:27]
    ds_read_b64_tr_b16 v[88:89], v13 offset:8192
    buffer_load_dwordx4 v[220:223], v126, s[8:11], s44 offen
    v_mfma_f32_16x16x32_bf16 v[40:43], v[56:59], v[168:171], v[40:43]
    ds_read_b64_tr_b16 v[90:91], v13 offset:10240
    buffer_load_dwordx4 v[224:227], v127, s[8:11], s44 offen
    v_mfma_f32_16x16x32_bf16 v[44:47], v[60:63], v[168:171], v[44:47]
    ds_read_b64_tr_b16 v[92:93], v14 offset:8192
    s_add_u32 s44, s44, 16384
    v_mfma_f32_16x16x32_bf16 v[28:31], v[60:63], v[164:167], v[28:31]
    ds_read_b64_tr_b16 v[94:95], v14 offset:10240
    v_mov_b32 v126, v128
    v_mfma_f32_16x16x32_bf16 v[32:35], v[64:67], v[164:167], v[32:35]
    ds_read_b64_tr_b16 v[96:97], v15 offset:8192
    v_mov_b32 v127, v129
    v_mfma_f32_16x16x32_bf16 v[48:51], v[64:67], v[168:171], v[48:51]
    ds_read_b64_tr_b16 v[98:99], v15 offset:10240
    v_mov_b32 v128, v130
    v_mfma_f32_16x16x32_bf16 v[52:55], v[68:71], v[168:171], v[52:55]
    ds_read_b64_tr_b16 v[100:101], v16 offset:8192
    v_mov_b32 v129, v131
    v_mfma_f32_16x16x32_bf16 v[36:39], v[68:71], v[164:167], v[36:39]
    ds_read_b64_tr_b16 v[102:103], v16 offset:10240
    s_waitcnt lgkmcnt(8)
    v_mfma_f32_16x16x32_bf16 v[24:27], v[72:75], v[172:175], v[24:27]
    ds_read_b64_tr_b16 v[104:105], v13 offset:12288
    buffer_load_dwordx4 v[164:167], v126, s[8:11], s44 offen
    v_mfma_f32_16x16x32_bf16 v[40:43], v[72:75], v[176:179], v[40:43]
    ds_read_b64_tr_b16 v[106:107], v13 offset:14336
    buffer_load_dwordx4 v[168:171], v127, s[8:11], s44 offen
    v_mfma_f32_16x16x32_bf16 v[44:47], v[76:79], v[176:179], v[44:47]
    ds_read_b64_tr_b16 v[108:109], v14 offset:12288
    s_add_u32 s44, s44, 16384
    s_waitcnt vmcnt(10)
    v_mfma_f32_16x16x32_bf16 v[28:31], v[76:79], v[172:175], v[28:31]
    ds_read_b64_tr_b16 v[110:111], v14 offset:14336
    v_or3_b32 v17, v180, v184, v188
    v_mfma_f32_16x16x32_bf16 v[32:35], v[80:83], v[172:175], v[32:35]
    ds_read_b64_tr_b16 v[112:113], v15 offset:12288
    v_bitop3_b32 v17, v17, v192, 1 bitop3:0xa8
    v_mfma_f32_16x16x32_bf16 v[48:51], v[80:83], v[176:179], v[48:51]
    ds_read_b64_tr_b16 v[114:115], v15 offset:14336
    v_cmp_ne_u32 vcc, 0, v17
    v_mfma_f32_16x16x32_bf16 v[52:55], v[84:87], v[176:179], v[52:55]
    ds_read_b64_tr_b16 v[116:117], v16 offset:12288
    ds_read_b64_tr_b16 v[118:119], v16 offset:14336
    v_mfma_f32_16x16x32_bf16 v[36:39], v[84:87], v[172:175], v[36:39]
    s_waitcnt lgkmcnt(8)
    s_cbranch_vccnz dm_23f0
dm_23g0:
    v_mfma_f32_16x16x32_bf16 v[24:27], v[88:91], v[180:183], v[24:27]
    ds_read_b64_tr_b16 v[56:57], v13 offset:16384
    buffer_load_dwordx4 v[172:175], v126, s[8:11], s44 offen
    v_mfma_f32_16x16x32_bf16 v[40:43], v[88:91], v[184:187], v[40:43]
    ds_read_b64_tr_b16 v[58:59], v13 offset:18432
    buffer_load_dwordx4 v[176:179], v127, s[8:11], s44 offen
    v_mfma_f32_16x16x32_bf16 v[44:47], v[92:95], v[184:187], v[44:47]
    ds_read_b64_tr_b16 v[60:61], v14 offset:16384
    s_add_u32 s44, s44, 16384
    v_mfma_f32_16x16x32_bf16 v[28:31], v[92:95], v[180:183], v[28:31]
    ds_read_b64_tr_b16 v[62:63], v14 offset:18432
    v_mov_b32 v130, v132
    v_mfma_f32_16x16x32_bf16 v[32:35], v[96:99], v[180:183], v[32:35]
    ds_read_b64_tr_b16 v[64:65], v15 offset:16384
    v_mov_b32 v131, v133
    v_mfma_f32_16x16x32_bf16 v[48:51], v[96:99], v[184:187], v[48:51]
    ds_read_b64_tr_b16 v[66:67], v15 offset:18432
    v_mov_b32 v132, 1073741824
    v_mfma_f32_16x16x32_bf16 v[52:55], v[100:103], v[184:187], v[52:55]
    ds_read_b64_tr_b16 v[68:69], v16 offset:16384
    v_mov_b32 v133, 1073741824
    v_mfma_f32_16x16x32_bf16 v[36:39], v[100:103], v[180:183], v[36:39]
    ds_read_b64_tr_b16 v[70:71], v16 offset:18432
    s_waitcnt lgkmcnt(8)
    v_mfma_f32_16x16x32_bf16 v[24:27], v[104:107], v[188:191], v[24:27]
    ds_read_b64_tr_b16 v[72:73], v13 offset:20480
    buffer_load_dwordx4 v[180:183], v126, s[8:11], s44 offen
    v_mfma_f32_16x16x32_bf16 v[40:43], v[104:107], v[192:195], v[40:43]
    ds_read_b64_tr_b16 v[74:75], v13 offset:22528
    buffer_load_dwordx4 v[184:187], v127, s[8:11], s44 offen
    v_mfma_f32_16x16x32_bf16 v[44:47], v[108:111], v[192:195], v[44:47]
    ds_read_b64_tr_b16 v[76:77], v14 offset:20480
    s_add_u32 s44, s44, 16384
    s_waitcnt vmcnt(10)
    v_mfma_f32_16x16x32_bf16 v[28:31], v[108:111], v[188:191], v[28:31]
    ds_read_b64_tr_b16 v[78:79], v14 offset:22528
    v_or3_b32 v17, v196, v200, v204
    v_mfma_f32_16x16x32_bf16 v[32:35], v[112:115], v[188:191], v[32:35]
    ds_read_b64_tr_b16 v[80:81], v15 offset:20480
    v_bitop3_b32 v17, v17, v208, 1 bitop3:0xa8
    v_mfma_f32_16x16x32_bf16 v[48:51], v[112:115], v[192:195], v[48:51]
    ds_read_b64_tr_b16 v[82:83], v15 offset:22528
    v_cmp_ne_u32 vcc, 0, v17
    v_mfma_f32_16x16x32_bf16 v[52:55], v[116:119], v[192:195], v[52:55]
    ds_read_b64_tr_b16 v[84:85], v16 offset:20480
    ds_read_b64_tr_b16 v[86:87], v16 offset:22528
    v_mfma_f32_16x16x32_bf16 v[36:39], v[116:119], v[188:191], v[36:39]
    s_waitcnt lgkmcnt(8)
    s_cbranch_vccnz dm_23f1
dm_23g1:
    v_mfma_f32_16x16x32_bf16 v[24:27], v[56:59], v[196:199], v[24:27]
    ds_read_b64_tr_b16 v[88:89], v13 offset:24576
    buffer_load_dwordx4 v[188:191], v126, s[8:11], s44 offen
    v_mfma_f32_16x16x32_bf16 v[40:43], v[56:59], v[200:203], v[40:43]
    ds_read_b64_tr_b16 v[90:91], v13 offset:26624
    buffer_load_dwordx4 v[192:195], v127, s[8:11], s44 offen
    v_mfma_f32_16x16x32_bf16 v[44:47], v[60:63], v[200:203], v[44:47]
    ds_read_b64_tr_b16 v[92:93], v14 offset:24576
    s_add_u32 s44, s44, 16384
    v_mfma_f32_16x16x32_bf16 v[28:31], v[60:63], v[196:199], v[28:31]
    ds_read_b64_tr_b16 v[94:95], v14 offset:26624
    v_mfma_f32_16x16x32_bf16 v[32:35], v[64:67], v[196:199], v[32:35]
    ds_read_b64_tr_b16 v[96:97], v15 offset:24576
    s_add_u32 s43, s43, 1
    v_mfma_f32_16x16x32_bf16 v[48:51], v[64:67], v[200:203], v[48:51]
    ds_read_b64_tr_b16 v[98:99], v15 offset:26624
    v_mfma_f32_16x16x32_bf16 v[52:55], v[68:71], v[200:203], v[52:55]
    ds_read_b64_tr_b16 v[100:101], v16 offset:24576
    v_mfma_f32_16x16x32_bf16 v[36:39], v[68:71], v[196:199], v[36:39]
    ds_read_b64_tr_b16 v[102:103], v16 offset:26624
    s_waitcnt lgkmcnt(8)
    v_mfma_f32_16x16x32_bf16 v[24:27], v[72:75], v[204:207], v[24:27]
    ds_read_b64_tr_b16 v[104:105], v13 offset:28672
    buffer_load_dwordx4 v[196:199], v126, s[8:11], s44 offen
    v_mfma_f32_16x16x32_bf16 v[40:43], v[72:75], v[208:211], v[40:43]
    ds_read_b64_tr_b16 v[106:107], v13 offset:30720
    buffer_load_dwordx4 v[200:203], v127, s[8:11], s44 offen
    v_mfma_f32_16x16x32_bf16 v[44:47], v[76:79], v[208:211], v[44:47]
    ds_read_b64_tr_b16 v[108:109], v14 offset:28672
    s_add_u32 s44, s44, 16384
    s_waitcnt vmcnt(10)
    v_mfma_f32_16x16x32_bf16 v[28:31], v[76:79], v[204:207], v[28:31]
    ds_read_b64_tr_b16 v[110:111], v14 offset:30720
    v_add_u32 v13, 32768, v13
    v_or3_b32 v17, v212, v216, v220
    v_mfma_f32_16x16x32_bf16 v[32:35], v[80:83], v[204:207], v[32:35]
    ds_read_b64_tr_b16 v[112:113], v15 offset:28672
    v_add_u32 v14, 32768, v14
    v_bitop3_b32 v17, v17, v224, 1 bitop3:0xa8
    v_mfma_f32_16x16x32_bf16 v[48:51], v[80:83], v[208:211], v[48:51]
    ds_read_b64_tr_b16 v[114:115], v15 offset:30720
    v_add_u32 v15, 32768, v15
    v_cmp_ne_u32 vcc, 0, v17
    v_mfma_f32_16x16x32_bf16 v[52:55], v[84:87], v[208:211], v[52:55]
    ds_read_b64_tr_b16 v[116:117], v16 offset:28672
    ds_read_b64_tr_b16 v[118:119], v16 offset:30720
    s_cmp_eq_u32 s43, 4
    v_mfma_f32_16x16x32_bf16 v[36:39], v[84:87], v[204:207], v[36:39]
    v_add_u32 v16, 32768, v16
    s_waitcnt lgkmcnt(8)
    s_cbranch_vccnz dm_23f2
dm_23g2:
    s_cbranch_scc1 dm_23x
    v_mfma_f32_16x16x32_bf16 v[24:27], v[88:91], v[212:215], v[24:27]
    ds_read_b64_tr_b16 v[56:57], v13 offset:0
    buffer_load_dwordx4 v[204:207], v126, s[8:11], s44 offen
    v_mfma_f32_16x16x32_bf16 v[40:43], v[88:91], v[216:219], v[40:43]
    ds_read_b64_tr_b16 v[58:59], v13 offset:2048
    buffer_load_dwordx4 v[208:211], v127, s[8:11], s44 offen
    v_mfma_f32_16x16x32_bf16 v[44:47], v[92:95], v[216:219], v[44:47]
    ds_read_b64_tr_b16 v[60:61], v14 offset:0
    s_add_u32 s44, s44, 16384
    v_mfma_f32_16x16x32_bf16 v[28:31], v[92:95], v[212:215], v[28:31]
    ds_read_b64_tr_b16 v[62:63], v14 offset:2048
    v_mov_b32 v134, v126
    v_mfma_f32_16x16x32_bf16 v[32:35], v[96:99], v[212:215], v[32:35]
    ds_read_b64_tr_b16 v[64:65], v15 offset:0
    v_mov_b32 v135, v127
    v_mfma_f32_16x16x32_bf16 v[48:51], v[96:99], v[216:219], v[48:51]
    ds_read_b64_tr_b16 v[66:67], v15 offset:2048
    v_mfma_f32_16x16x32_bf16 v[52:55], v[100:103], v[216:219], v[52:55]
    ds_read_b64_tr_b16 v[68:69], v16 offset:0
    v_mfma_f32_16x16x32_bf16 v[36:39], v[100:103], v[212:215], v[36:39]
    ds_read_b64_tr_b16 v[70:71], v16 offset:2048
    s_waitcnt lgkmcnt(8)
    v_mfma_f32_16x16x32_bf16 v[24:27], v[104:107], v[220:223], v[24:27]
    ds_read_b64_tr_b16 v[72:73], v13 offset:4096
    buffer_load_dwordx4 v[212:215], v126, s[8:11], s44 offen
    v_mfma_f32_16x16x32_bf16 v[40:43], v[104:107], v[224:227], v[40:43]
    ds_read_b64_tr_b16 v[74:75], v13 offset:6144
    buffer_load_dwordx4 v[216:219], v127, s[8:11], s44 offen
    v_mfma_f32_16x16x32_bf16 v[44:47], v[108:111], v[224:227], v[44:47]
    ds_read_b64_tr_b16 v[76:77], v14 offset:4096
    s_add_u32 s44, s44, 16384
    s_waitcnt vmcnt(10)
    v_mfma_f32_16x16x32_bf16 v[28:31], v[108:111], v[220:223], v[28:31]
    ds_read_b64_tr_b16 v[78:79], v14 offset:6144
    v_or3_b32 v17, v164, v168, v172
    v_mfma_f32_16x16x32_bf16 v[32:35], v[112:115], v[220:223], v[32:35]
    ds_read_b64_tr_b16 v[80:81], v15 offset:4096
    v_bitop3_b32 v17, v17, v176, 1 bitop3:0xa8
    v_mfma_f32_16x16x32_bf16 v[48:51], v[112:115], v[224:227], v[48:51]
    ds_read_b64_tr_b16 v[82:83], v15 offset:6144
    v_cmp_ne_u32 vcc, 0, v17
    v_mfma_f32_16x16x32_bf16 v[52:55], v[116:119], v[224:227], v[52:55]
    ds_read_b64_tr_b16 v[84:85], v16 offset:4096
    ds_read_b64_tr_b16 v[86:87], v16 offset:6144
    v_mfma_f32_16x16x32_bf16 v[36:39], v[116:119], v[220:223], v[36:39]
    s_waitcnt lgkmcnt(8)
    s_cbranch_vccnz dm_23f3
dm_23g3:
    s_branch dm_23
dm_23f0:
    s_cselect_b32 s50, 1, 0
dm_23h0:
    s_sleep 2
    s_sub_u32 s44, s44, 114688
    buffer_load_dwordx4 v[180:183], v134, s[8:11], s44 offen sc1
    buffer_load_dwordx4 v[184:187], v135, s[8:11], s44 offen sc1
    s_add_u32 s44, s44, 16384
    buffer_load_dwordx4 v[188:191], v134, s[8:11], s44 offen sc1
    buffer_load_dwordx4 v[192:195], v135, s[8:11], s44 offen sc1
    s_add_u32 s44, s44, 16384
    buffer_load_dwordx4 v[196:199], v134, s[8:11], s44 offen sc1
    buffer_load_dwordx4 v[200:203], v135, s[8:11], s44 offen sc1
    s_add_u32 s44, s44, 16384
    buffer_load_dwordx4 v[204:207], v134, s[8:11], s44 offen sc1
    buffer_load_dwordx4 v[208:211], v135, s[8:11], s44 offen sc1
    s_add_u32 s44, s44, 16384
    buffer_load_dwordx4 v[212:215], v134, s[8:11], s44 offen sc1
    buffer_load_dwordx4 v[216:219], v135, s[8:11], s44 offen sc1
    s_add_u32 s44, s44, 16384
    buffer_load_dwordx4 v[220:223], v134, s[8:11], s44 offen sc1
    buffer_load_dwordx4 v[224:227], v135, s[8:11], s44 offen sc1
    s_add_u32 s44, s44, 16384
    buffer_load_dwordx4 v[164:167], v126, s[8:11], s44 offen sc1
    buffer_load_dwordx4 v[168:171], v127, s[8:11], s44 offen sc1
    s_add_u32 s44, s44, 16384
    s_waitcnt vmcnt(10)
    v_or3_b32 v17, v180, v184, v188
    v_bitop3_b32 v17, v17, v192, 1 bitop3:0xa8
    v_cmp_ne_u32 vcc, 0, v17
    s_add_u32 s53, s53, 1
    s_cmp_ge_u32 s53, s61
    s_cselect_b32 s61, 0, s61
    s_cbranch_scc1 dm_23k0
    s_cbranch_vccnz dm_23h0
dm_23k0:
    s_cmp_eq_u32 s50, 1
    s_branch dm_23g0
dm_23f1:
    s_cselect_b32 s50, 1, 0
dm_23h1:
    s_sleep 2
    s_sub_u32 s44, s44, 114688
    buffer_load_dwordx4 v[196:199], v134, s[8:11], s44 offen sc1
    buffer_load_dwordx4 v[200:203], v135, s[8:11], s44 offen sc1
    s_add_u32 s44, s44, 16384
    buffer_load_dwordx4 v[204:207], v134, s[8:11], s44 offen sc1
    buffer_load_dwordx4 v[208:211], v135, s[8:11], s44 offen sc1
    s_add_u32 s44, s44, 16384
    buffer_load_dwordx4 v[212:215], v134, s[8:11], s44 offen sc1
    buffer_load_dwordx4 v[216:219], v135, s[8:11], s44 offen sc1
    s_add_u32 s44, s44, 16384
    buffer_load_dwordx4 v[220:223], v134, s[8:11], s44 offen sc1
    buffer_load_dwordx4 v[224:227], v135, s[8:11], s44 offen sc1
    s_add_u32 s44, s44, 16384
    buffer_load_dwordx4 v[164:167], v126, s[8:11], s44 offen sc1
    buffer_load_dwordx4 v[168:171], v127, s[8:11], s44 offen sc1
    s_add_u32 s44, s44, 16384
    buffer_load_dwordx4 v[172:175], v126, s[8:11], s44 offen sc1
    buffer_load_dwordx4 v[176:179], v127, s[8:11], s44 offen sc1
    s_add_u32 s44, s44, 16384
    buffer_load_dwordx4 v[180:183], v126, s[8:11], s44 offen sc1
    buffer_load_dwordx4 v[184:187], v127, s[8:11], s44 offen sc1
    s_add_u32 s44, s44, 16384
    s_waitcnt vmcnt(10)
    v_or3_b32 v17, v196, v200, v204
    v_bitop3_b32 v17, v17, v208, 1 bitop3:0xa8
    v_cmp_ne_u32 vcc, 0, v17
    s_add_u32 s53, s53, 1
    s_cmp_ge_u32 s53, s61
    s_cselect_b32 s61, 0, s61
    s_cbranch_scc1 dm_23k1
    s_cbranch_vccnz dm_23h1
dm_23k1:
    s_cmp_eq_u32 s50, 1
    s_branch dm_23g1
dm_23f2:
    s_cselect_b32 s50, 1, 0
dm_23h2:
    s_sleep 2
    s_sub_u32 s44, s44, 114688
    buffer_load_dwordx4 v[212:215], v134, s[8:11], s44 offen sc1
    buffer_load_dwordx4 v[216:219], v135, s[8:11], s44 offen sc1
    s_add_u32 s44, s44, 16384
    buffer_load_dwordx4 v[220:223], v134, s[8:11], s44 offen sc1
    buffer_load_dwordx4 v[224:227], v135, s[8:11], s44 offen sc1
    s_add_u32 s44, s44, 16384
    buffer_load_dwordx4 v[164:167], v126, s[8:11], s44 offen sc1
    buffer_load_dwordx4 v[168:171], v127, s[8:11], s44 offen sc1
    s_add_u32 s44, s44, 16384
    buffer_load_dwordx4 v[172:175], v126, s[8:11], s44 offen sc1
    buffer_load_dwordx4 v[176:179], v127, s[8:11], s44 offen sc1
    s_add_u32 s44, s44, 16384
    buffer_load_dwordx4 v[180:183], v126, s[8:11], s44 offen sc1
    buffer_load_dwordx4 v[184:187], v127, s[8:11], s44 offen sc1
    s_add_u32 s44, s44, 16384
    buffer_load_dwordx4 v[188:191], v126, s[8:11], s44 offen sc1
    buffer_load_dwordx4 v[192:195], v127, s[8:11], s44 offen sc1
    s_add_u32 s44, s44, 16384
    buffer_load_dwordx4 v[196:199], v126, s[8:11], s44 offen sc1
    buffer_load_dwordx4 v[200:203], v127, s[8:11], s44 offen sc1
    s_add_u32 s44, s44, 16384
    s_waitcnt vmcnt(10)
    v_or3_b32 v17, v212, v216, v220
    v_bitop3_b32 v17, v17, v224, 1 bitop3:0xa8
    v_cmp_ne_u32 vcc, 0, v17
    s_add_u32 s53, s53, 1
    s_cmp_ge_u32 s53, s61
    s_cselect_b32 s61, 0, s61
    s_cbranch_scc1 dm_23k2
    s_cbranch_vccnz dm_23h2
dm_23k2:
    s_cmp_eq_u32 s50, 1
    s_branch dm_23g2
dm_23f3:
    s_cselect_b32 s50, 1, 0
dm_23h3:
    s_sleep 2
    s_sub_u32 s44, s44, 114688
    buffer_load_dwordx4 v[164:167], v134, s[8:11], s44 offen sc1
    buffer_load_dwordx4 v[168:171], v135, s[8:11], s44 offen sc1
    s_add_u32 s44, s44, 16384
    buffer_load_dwordx4 v[172:175], v134, s[8:11], s44 offen sc1
    buffer_load_dwordx4 v[176:179], v135, s[8:11], s44 offen sc1
    s_add_u32 s44, s44, 16384
    buffer_load_dwordx4 v[180:183], v134, s[8:11], s44 offen sc1
    buffer_load_dwordx4 v[184:187], v135, s[8:11], s44 offen sc1
    s_add_u32 s44, s44, 16384
    buffer_load_dwordx4 v[188:191], v134, s[8:11], s44 offen sc1
    buffer_load_dwordx4 v[192:195], v135, s[8:11], s44 offen sc1
    s_add_u32 s44, s44, 16384
    buffer_load_dwordx4 v[196:199], v134, s[8:11], s44 offen sc1
    buffer_load_dwordx4 v[200:203], v135, s[8:11], s44 offen sc1
    s_add_u32 s44, s44, 16384
    buffer_load_dwordx4 v[204:207], v134, s[8:11], s44 offen sc1
    buffer_load_dwordx4 v[208:211], v135, s[8:11], s44 offen sc1
    s_add_u32 s44, s44, 16384
    buffer_load_dwordx4 v[212:215], v134, s[8:11], s44 offen sc1
    buffer_load_dwordx4 v[216:219], v135, s[8:11], s44 offen sc1
    s_add_u32 s44, s44, 16384
    s_waitcnt vmcnt(10)
    v_or3_b32 v17, v164, v168, v172
    v_bitop3_b32 v17, v17, v176, 1 bitop3:0xa8
    v_cmp_ne_u32 vcc, 0, v17
    s_add_u32 s53, s53, 1
    s_cmp_ge_u32 s53, s61
    s_cselect_b32 s61, 0, s61
    s_cbranch_scc1 dm_23k3
    s_cbranch_vccnz dm_23h3
dm_23k3:
    s_cmp_eq_u32 s50, 1
    s_branch dm_23g3
dm_23x:
    v_mfma_f32_16x16x32_bf16 v[24:27], v[88:91], v[212:215], v[24:27]
    v_mfma_f32_16x16x32_bf16 v[40:43], v[88:91], v[216:219], v[40:43]
    v_mfma_f32_16x16x32_bf16 v[44:47], v[92:95], v[216:219], v[44:47]
    v_mfma_f32_16x16x32_bf16 v[28:31], v[92:95], v[212:215], v[28:31]
    v_mfma_f32_16x16x32_bf16 v[32:35], v[96:99], v[212:215], v[32:35]
    v_mfma_f32_16x16x32_bf16 v[48:51], v[96:99], v[216:219], v[48:51]
    v_mfma_f32_16x16x32_bf16 v[52:55], v[100:103], v[216:219], v[52:55]
    v_mfma_f32_16x16x32_bf16 v[36:39], v[100:103], v[212:215], v[36:39]
    s_waitcnt lgkmcnt(0)
    v_mfma_f32_16x16x32_bf16 v[24:27], v[104:107], v[220:223], v[24:27]
    s_add_u32 s44, s62, 0x5c8000
    v_mfma_f32_16x16x32_bf16 v[40:43], v[104:107], v[224:227], v[40:43]
    s_addc_u32 s45, s63, 0
    v_mfma_f32_16x16x32_bf16 v[44:47], v[108:111], v[224:227], v[44:47]
    v_mfma_f32_16x16x32_bf16 v[28:31], v[108:111], v[220:223], v[28:31]
    s_mov_b32 s46, 0x6000
    v_mfma_f32_16x16x32_bf16 v[32:35], v[112:115], v[220:223], v[32:35]
    v_mfma_f32_16x16x32_bf16 v[48:51], v[112:115], v[224:227], v[48:51]
    s_mov_b32 s47, 0x20000
    v_mfma_f32_16x16x32_bf16 v[52:55], v[116:119], v[224:227], v[52:55]
    v_mfma_f32_16x16x32_bf16 v[36:39], v[116:119], v[220:223], v[36:39]
    s_add_u32 s36, s39, 0
    v_cvt_pk_bf16_f32 v148, v24, v25
    v_cvt_pk_bf16_f32 v149, v26, v27
    v_cvt_pk_bf16_f32 v150, v28, v29
    v_cvt_pk_bf16_f32 v151, v30, v31
    v_and_b32 v148, -2, v148
    buffer_store_dwordx4 v[148:151], v2, s[16:19], s36 offen offset:0 sc1
    v_cvt_pk_bf16_f32 v152, v32, v33
    v_cvt_pk_bf16_f32 v153, v34, v35
    v_cvt_pk_bf16_f32 v154, v36, v37
    v_cvt_pk_bf16_f32 v155, v38, v39
    v_and_b32 v152, -2, v152
    buffer_store_dwordx4 v[152:155], v2, s[16:19], s36 offen offset:1024 sc1
    s_add_u32 s36, s39, 65536
    v_cvt_pk_bf16_f32 v156, v40, v41
    v_cvt_pk_bf16_f32 v157, v42, v43
    v_cvt_pk_bf16_f32 v158, v44, v45
    v_cvt_pk_bf16_f32 v159, v46, v47
    v_and_b32 v156, -2, v156
    buffer_store_dwordx4 v[156:159], v2, s[16:19], s36 offen offset:0 sc1
    v_cvt_pk_bf16_f32 v160, v48, v49
    v_cvt_pk_bf16_f32 v161, v50, v51
    v_cvt_pk_bf16_f32 v162, v52, v53
    v_cvt_pk_bf16_f32 v163, v54, v55
    v_and_b32 v160, -2, v160
    buffer_store_dwordx4 v[160:163], v2, s[16:19], s36 offen offset:1024 sc1
    s_barrier
    s_lshl_b32 s36, s37, 11
    v_add_u32 v7, s36, v2
    ds_write_b128 v7, v[148:151] offset:0
    ds_write_b128 v7, v[152:155] offset:1024
    ds_write_b128 v7, v[156:159] offset:2048
    ds_write_b128 v7, v[160:163] offset:3072
    v_lshlrev_b32 v24, 16, v148
    v_and_b32 v25, 0xffff0000, v148
    v_lshlrev_b32 v26, 16, v149
    v_and_b32 v27, 0xffff0000, v149
    v_lshlrev_b32 v28, 16, v150
    v_and_b32 v29, 0xffff0000, v150
    v_lshlrev_b32 v30, 16, v151
    v_and_b32 v31, 0xffff0000, v151
    v_lshlrev_b32 v32, 16, v152
    v_and_b32 v33, 0xffff0000, v152
    v_lshlrev_b32 v34, 16, v153
    v_and_b32 v35, 0xffff0000, v153
    v_lshlrev_b32 v36, 16, v154
    v_and_b32 v37, 0xffff0000, v154
    v_lshlrev_b32 v38, 16, v155
    v_and_b32 v39, 0xffff0000, v155
    v_lshlrev_b32 v40, 16, v156
    v_and_b32 v41, 0xffff0000, v156
    v_lshlrev_b32 v42, 16, v157
    v_and_b32 v43, 0xffff0000, v157
    v_lshlrev_b32 v44, 16, v158
    v_and_b32 v45, 0xffff0000, v158
    v_lshlrev_b32 v46, 16, v159
    v_and_b32 v47, 0xffff0000, v159
    v_lshlrev_b32 v48, 16, v160
    v_and_b32 v49, 0xffff0000, v160
    v_lshlrev_b32 v50, 16, v161
    v_and_b32 v51, 0xffff0000, v161
    v_lshlrev_b32 v52, 16, v162
    v_and_b32 v53, 0xffff0000, v162
    v_lshlrev_b32 v54, 16, v163
    v_and_b32 v55, 0xffff0000, v163
    s_add_u32 s53, s55, 512
    v_mov_b32 v8, 1
    v_mov_b32 v9, 162816
    v_mov_b32 v11, 0
    s_mov_b64 exec, 1
    s_waitcnt vmcnt(0)
    ds_add_rtn_u32 v10, v9, v8
    s_waitcnt lgkmcnt(0)
    v_readfirstlane_b32 s54, v10
    s_nop 0
    s_and_b32 s54, s54, 3
    s_cmp_lg_u32 s54, 3
    s_cbranch_scc1 pub_24
    buffer_atomic_add v8, v11, s[56:59], s53 offen sc1
    v_mov_b32 v9, 162872
    ds_add_u32 v9, v8
pub_24:
    s_mov_b64 exec, -1
    s_waitcnt lgkmcnt(0)
    s_barrier
    v_pk_add_f32 v[142:143], v[24:25], v[26:27]
    v_pk_mul_f32 v[136:137], v[24:25], v[24:25]
    v_pk_fma_f32 v[136:137], v[26:27], v[26:27], v[136:137]
    v_pk_add_f32 v[142:143], v[142:143], v[28:29]
    v_pk_fma_f32 v[136:137], v[28:29], v[28:29], v[136:137]
    v_pk_add_f32 v[142:143], v[142:143], v[30:31]
    v_pk_fma_f32 v[136:137], v[30:31], v[30:31], v[136:137]
    v_pk_add_f32 v[142:143], v[142:143], v[32:33]
    v_pk_fma_f32 v[136:137], v[32:33], v[32:33], v[136:137]
    v_pk_add_f32 v[142:143], v[142:143], v[34:35]
    v_pk_fma_f32 v[136:137], v[34:35], v[34:35], v[136:137]
    v_pk_add_f32 v[142:143], v[142:143], v[36:37]
    v_pk_fma_f32 v[136:137], v[36:37], v[36:37], v[136:137]
    v_pk_add_f32 v[142:143], v[142:143], v[38:39]
    v_pk_fma_f32 v[136:137], v[38:39], v[38:39], v[136:137]
    v_add_f32 v138, v142, v143
    v_add_f32 v139, v136, v137
    v_mov_b32 v142, v138
    v_mov_b32 v143, v139
    s_nop 0
    v_permlane16_swap_b32 v138, v142
    v_permlane16_swap_b32 v139, v143
    v_pk_add_f32 v[138:139], v[138:139], v[142:143]
    v_mov_b32 v142, v138
    v_mov_b32 v143, v139
    s_nop 0
    v_permlane32_swap_b32 v138, v142
    v_permlane32_swap_b32 v139, v143
    v_pk_add_f32 v[138:139], v[138:139], v[142:143]
    v_pk_add_f32 v[142:143], v[40:41], v[42:43]
    v_pk_mul_f32 v[136:137], v[40:41], v[40:41]
    v_pk_fma_f32 v[136:137], v[42:43], v[42:43], v[136:137]
    v_pk_add_f32 v[142:143], v[142:143], v[44:45]
    v_pk_fma_f32 v[136:137], v[44:45], v[44:45], v[136:137]
    v_pk_add_f32 v[142:143], v[142:143], v[46:47]
    v_pk_fma_f32 v[136:137], v[46:47], v[46:47], v[136:137]
    v_pk_add_f32 v[142:143], v[142:143], v[48:49]
    v_pk_fma_f32 v[136:137], v[48:49], v[48:49], v[136:137]
    v_pk_add_f32 v[142:143], v[142:143], v[50:51]
    v_pk_fma_f32 v[136:137], v[50:51], v[50:51], v[136:137]
    v_pk_add_f32 v[142:143], v[142:143], v[52:53]
    v_pk_fma_f32 v[136:137], v[52:53], v[52:53], v[136:137]
    v_pk_add_f32 v[142:143], v[142:143], v[54:55]
    v_pk_fma_f32 v[136:137], v[54:55], v[54:55], v[136:137]
    v_add_f32 v140, v142, v143
    v_add_f32 v141, v136, v137
    v_mov_b32 v142, v140
    v_mov_b32 v143, v141
    s_nop 0
    v_permlane16_swap_b32 v140, v142
    v_permlane16_swap_b32 v141, v143
    v_pk_add_f32 v[140:141], v[140:141], v[142:143]
    v_mov_b32 v142, v140
    v_mov_b32 v143, v141
    s_nop 0
    v_permlane32_swap_b32 v140, v142
    v_permlane32_swap_b32 v141, v143
    v_pk_add_f32 v[140:141], v[140:141], v[142:143]
    v_cmp_eq_u32 vcc, 0, v23
    s_nop 1
    v_cndmask_b32 v138, v140, v138, vcc
    v_cndmask_b32 v139, v141, v139, vcc
    s_lshr_b32 s53, s29, 3
    s_lshl_b32 s53, s53, 14
    s_and_b32 s40, s29, 7
    s_lshl_b32 s40, s40, 10
    s_add_u32 s40, s40, s53
    s_lshl_b32 s36, s34, 8
    s_add_u32 s40, s40, s36
    v_lshlrev_b32 v7, 3, v1
    s_bfm_b64 exec, 32, 0
    buffer_store_dwordx2 v[138:139], v7, s[44:47], s40 offen sc1
    s_mov_b64 exec, -1
    s_lshr_b32 s34, s30, 1
    s_and_b32 s35, s30, 1
    v_and_b32 v22, 15, v1
    v_lshrrev_b32 v23, 4, v1
    s_mul_i32 s37, s34, 4
    s_mul_i32 s38, s29, 14
    s_mul_i32 s36, s35, 7
    s_add_u32 s38, s38, s36
    s_mul_i32 s36, s34, 8192
    v_add_u32 v12, s36, v2
    v_lshrrev_b32 v6, 2, v1
    v_mul_u32_u24 v13, 448, v6
    v_and_b32 v7, 3, v1
    v_lshl_add_u32 v13, v7, 3, v13
    v_add_u32 v13, 73728, v13
    s_mul_i32 s36, s35, 224
    v_add_u32 v13, s36, v13
    v_bfe_u32 v6, v1, 4, 1
    v_lshlrev_b32 v6, 5, v6
    s_cmp_eq_u32 s35, 0
    s_cselect_b32 s36, 1, -1
    v_mul_lo_u32 v6, v6, s36
    v_sub_u32 v14, v13, v6
    v_add_u32 v13, v13, v6
    v_mov_b32 v17, v12
    s_mov_b32 s42, 0
    s_mov_b32 s43, 0
    s_mov_b32 s48, 57344
    v_add_u32 v18, 57344, v13
    v_add_u32 v19, 57344, v14
    ds_read_b128 v[136:139], v17 offset:0
    ds_read_b128 v[140:143], v17 offset:2048
    ds_read_b128 v[144:147], v17 offset:4096
    ds_read_b128 v[148:151], v17 offset:6144
    ds_read_b64_tr_b16 v[152:153], v18 offset:0
    ds_read_b64_tr_b16 v[154:155], v18 offset:7168
    ds_read_b64_tr_b16 v[156:157], v19 offset:32
    ds_read_b64_tr_b16 v[158:159], v19 offset:7200
    ds_read_b64_tr_b16 v[160:161], v18 offset:64
    ds_read_b64_tr_b16 v[162:163], v18 offset:7232
    ds_read_b64_tr_b16 v[164:165], v19 offset:96
    ds_read_b64_tr_b16 v[166:167], v19 offset:7264
    ds_read_b64_tr_b16 v[168:169], v18 offset:128
    ds_read_b64_tr_b16 v[170:171], v18 offset:7296
    ds_read_b64_tr_b16 v[172:173], v19 offset:160
    ds_read_b64_tr_b16 v[174:175], v19 offset:7328
    ds_read_b64_tr_b16 v[176:177], v18 offset:192
    ds_read_b64_tr_b16 v[178:179], v18 offset:7360
    s_waitcnt lgkmcnt(12)
    v_mfma_f32_16x16x32_bf16 v[24:27], v[152:155], v[136:139], 0
    ds_read_b128 v[180:183], v17 offset:1024
    s_add_u32 s42, s42, 16384
    v_mfma_f32_16x16x32_bf16 v[52:55], v[152:155], v[140:143], 0
    ds_read_b128 v[184:187], v17 offset:3072
    s_cmp_eq_u32 s42, 49152
    v_mfma_f32_16x16x32_bf16 v[80:83], v[152:155], v[144:147], 0
    ds_read_b128 v[188:191], v17 offset:5120
    s_cselect_b32 s42, 0, s42
    v_mfma_f32_16x16x32_bf16 v[108:111], v[152:155], v[148:151], 0
    ds_read_b128 v[192:195], v17 offset:7168
    s_waitcnt lgkmcnt(14)
    v_mfma_f32_16x16x32_bf16 v[112:115], v[156:159], v[148:151], 0
    ds_read_b64_tr_b16 v[196:197], v18 offset:14336
    s_add_u32 s48, s48, 28672
    v_mfma_f32_16x16x32_bf16 v[84:87], v[156:159], v[144:147], 0
    ds_read_b64_tr_b16 v[198:199], v18 offset:21504
    s_cmp_eq_u32 s48, 86016
    v_mfma_f32_16x16x32_bf16 v[56:59], v[156:159], v[140:143], 0
    ds_read_b64_tr_b16 v[200:201], v19 offset:14368
    s_cselect_b32 s48, 0, s48
    v_mfma_f32_16x16x32_bf16 v[28:31], v[156:159], v[136:139], 0
    ds_read_b64_tr_b16 v[202:203], v19 offset:21536
    s_waitcnt lgkmcnt(8)
    v_mfma_f32_16x16x32_bf16 v[32:35], v[160:163], v[136:139], 0
    ds_read_b64_tr_b16 v[204:205], v18 offset:14400
    v_add_u32 v17, s42, v12
    v_mfma_f32_16x16x32_bf16 v[60:63], v[160:163], v[140:143], 0
    ds_read_b64_tr_b16 v[206:207], v18 offset:21568
    v_mfma_f32_16x16x32_bf16 v[88:91], v[160:163], v[144:147], 0
    ds_read_b64_tr_b16 v[208:209], v19 offset:14432
    v_mfma_f32_16x16x32_bf16 v[116:119], v[160:163], v[148:151], 0
    ds_read_b64_tr_b16 v[210:211], v19 offset:21600
    v_mfma_f32_16x16x32_bf16 v[120:123], v[164:167], v[148:151], 0
    ds_read_b64_tr_b16 v[212:213], v18 offset:14464
    v_mfma_f32_16x16x32_bf16 v[92:95], v[164:167], v[144:147], 0
    ds_read_b64_tr_b16 v[214:215], v18 offset:21632
    v_mfma_f32_16x16x32_bf16 v[64:67], v[164:167], v[140:143], 0
    ds_read_b64_tr_b16 v[216:217], v19 offset:14496
    v_mfma_f32_16x16x32_bf16 v[36:39], v[164:167], v[136:139], 0
    ds_read_b64_tr_b16 v[218:219], v19 offset:21664
    v_add_u32 v19, s48, v14
    v_mfma_f32_16x16x32_bf16 v[40:43], v[168:171], v[136:139], 0
    ds_read_b64_tr_b16 v[220:221], v18 offset:14528
    v_mfma_f32_16x16x32_bf16 v[68:71], v[168:171], v[140:143], 0
    ds_read_b64_tr_b16 v[222:223], v18 offset:21696
    v_add_u32 v18, s48, v13
    v_mfma_f32_16x16x32_bf16 v[96:99], v[168:171], v[144:147], 0
    v_mfma_f32_16x16x32_bf16 v[124:127], v[168:171], v[148:151], 0
    v_mfma_f32_16x16x32_bf16 v[128:131], v[172:175], v[148:151], 0
    v_mfma_f32_16x16x32_bf16 v[100:103], v[172:175], v[144:147], 0
    v_mfma_f32_16x16x32_bf16 v[72:75], v[172:175], v[140:143], 0
    v_mfma_f32_16x16x32_bf16 v[44:47], v[172:175], v[136:139], 0
    v_mfma_f32_16x16x32_bf16 v[48:51], v[176:179], v[136:139], 0
    v_mfma_f32_16x16x32_bf16 v[76:79], v[176:179], v[140:143], 0
    v_mfma_f32_16x16x32_bf16 v[104:107], v[176:179], v[144:147], 0
    v_mfma_f32_16x16x32_bf16 v[132:135], v[176:179], v[148:151], 0
    s_waitcnt lgkmcnt(12)
    v_mfma_f32_16x16x32_bf16 v[24:27], v[196:199], v[180:183], v[24:27]
    s_add_u32 s43, s43, 1
    s_mul_i32 s36, s35, 448
    s_add_u32 s36, s36, 159744
    v_lshlrev_b32 v6, 4, v23
    v_mfma_f32_16x16x32_bf16 v[52:55], v[196:199], v[184:187], v[52:55]
    v_add_u32 v6, s36, v6
    s_lshl_b32 s36, s37, 8
    s_add_u32 s36, s36, 160768
    v_lshlrev_b32 v7, 4, v22
    v_mfma_f32_16x16x32_bf16 v[80:83], v[196:199], v[188:191], v[80:83]
    v_add_u32 v7, s36, v7
    s_add_u32 s16, s62, 0x400000
    s_addc_u32 s17, s63, 0
    s_mov_b32 s18, 0x1be000
    v_mfma_f32_16x16x32_bf16 v[108:111], v[196:199], v[192:195], v[108:111]
    s_mov_b32 s19, 0x20000
    s_mul_i32 s39, s37, 229376
    s_lshr_b32 s36, s38, 1
    s_waitcnt lgkmcnt(0)
    v_mfma_f32_16x16x32_bf16 v[112:115], v[200:203], v[192:195], v[112:115]
    s_add_u32 s36, s36, 0
    s_lshr_b32 s53, s36, 3
    s_lshl_b32 s53, s53, 14
    s_and_b32 s44, s36, 7
    v_mfma_f32_16x16x32_bf16 v[84:87], v[200:203], v[188:191], v[84:87]
    s_lshl_b32 s44, s44, 10
    s_add_u32 s44, s44, s53
    s_add_u32 s44, s44, s39
    s_lshr_b32 s36, s38, 1
    v_mfma_f32_16x16x32_bf16 v[56:59], v[200:203], v[184:187], v[56:59]
    s_add_u32 s36, s36, 1
    s_lshr_b32 s53, s36, 3
    s_lshl_b32 s53, s53, 14
    s_and_b32 s45, s36, 7
    v_mfma_f32_16x16x32_bf16 v[28:31], v[200:203], v[180:183], v[28:31]
    s_lshl_b32 s45, s45, 10
    s_add_u32 s45, s45, s53
    s_add_u32 s45, s45, s39
    s_lshr_b32 s36, s38, 1
    v_mfma_f32_16x16x32_bf16 v[32:35], v[204:207], v[180:183], v[32:35]
    s_add_u32 s36, s36, 2
    s_lshr_b32 s53, s36, 3
    s_lshl_b32 s53, s53, 14
    s_and_b32 s46, s36, 7
    v_mfma_f32_16x16x32_bf16 v[60:63], v[204:207], v[184:187], v[60:63]
    s_lshl_b32 s46, s46, 10
    s_add_u32 s46, s46, s53
    s_add_u32 s46, s46, s39
    s_lshr_b32 s36, s38, 1
    v_mfma_f32_16x16x32_bf16 v[88:91], v[204:207], v[188:191], v[88:91]
    s_add_u32 s36, s36, 3
    s_lshr_b32 s53, s36, 3
    s_lshl_b32 s53, s53, 14
    s_and_b32 s47, s36, 7
    v_mfma_f32_16x16x32_bf16 v[116:119], v[204:207], v[192:195], v[116:119]
    s_lshl_b32 s47, s47, 10
    s_add_u32 s47, s47, s53
    s_add_u32 s47, s47, s39
    v_lshrrev_b32 v226, 2, v1
    v_mfma_f32_16x16x32_bf16 v[120:123], v[208:211], v[192:195], v[120:123]
    v_mul_u32_u24 v240, 256, v226
    v_and_b32 v227, 3, v1
    v_lshl_add_u32 v240, v227, 3, v240
    v_add_u32 v240, 49152, v240
    v_mfma_f32_16x16x32_bf16 v[92:95], v[208:211], v[188:191], v[92:95]
    v_and_b32 v226, 7, v226
    s_mul_i32 s36, s35, 4
    s_add_u32 s36, s36, 3
    v_xor_b32 v227, s36, v226
    v_mfma_f32_16x16x32_bf16 v[64:67], v[208:211], v[184:187], v[64:67]
    v_lshl_add_u32 v243, v227, 5, v240
    s_mul_i32 s36, s35, 4
    s_add_u32 s36, s36, 2
    v_xor_b32 v227, s36, v226
    v_mfma_f32_16x16x32_bf16 v[36:39], v[208:211], v[180:183], v[36:39]
    v_lshl_add_u32 v242, v227, 5, v240
    s_mul_i32 s36, s35, 4
    s_add_u32 s36, s36, 1
    v_xor_b32 v227, s36, v226
    v_mfma_f32_16x16x32_bf16 v[40:43], v[212:215], v[180:183], v[40:43]
    v_lshl_add_u32 v241, v227, 5, v240
    s_mul_i32 s36, s35, 4
    s_add_u32 s36, s36, 0
    v_xor_b32 v227, s36, v226
    v_mfma_f32_16x16x32_bf16 v[68:71], v[212:215], v[184:187], v[68:71]
    v_lshl_add_u32 v240, v227, 5, v240
    s_lshl_b32 s38, s33, 3
    s_lshl_b32 s36, s35, 2
    s_add_u32 s38, s38, s36
    v_mfma_f32_16x16x32_bf16 v[96:99], v[212:215], v[188:191], v[96:99]
    s_lshr_b32 s36, s38, 1
    s_lshr_b32 s53, s36, 3
    s_lshl_b32 s53, s53, 14
    s_and_b32 s39, s36, 7
    v_mfma_f32_16x16x32_bf16 v[124:127], v[212:215], v[192:195], v[124:127]
    s_lshl_b32 s39, s39, 10
    s_add_u32 s39, s39, s53
    s_lshl_b32 s36, s37, 16
    s_add_u32 s39, s39, s36
    v_mfma_f32_16x16x32_bf16 v[128:131], v[216:219], v[192:195], v[128:131]
    s_lshl_b32 s40, s31, 17
    s_add_u32 s40, s40, s39
    s_xor_b32 s41, s31, 1
    s_lshl_b32 s41, s41, 17
    v_mfma_f32_16x16x32_bf16 v[100:103], v[216:219], v[188:191], v[100:103]
    s_add_u32 s41, s41, s39
    s_mov_b32 s84, s62
    s_mov_b32 s85, s63
    s_mov_b32 s86, 0x7e000
    v_mfma_f32_16x16x32_bf16 v[72:75], v[216:219], v[184:187], v[72:75]
    s_mov_b32 s87, 0x20000
    s_add_u32 s88, s62, 0x80000
    s_addc_u32 s89, s63, 0
    s_mov_b32 s90, 0x7e000
    v_mfma_f32_16x16x32_bf16 v[44:47], v[216:219], v[180:183], v[44:47]
    s_mov_b32 s91, 0x20000
    s_lshl_b32 s36, s37, 1
    s_add_u32 s36, s36, s35
    s_lshl_b32 s36, s36, 10
    v_mfma_f32_16x16x32_bf16 v[48:51], v[220:223], v[180:183], v[48:51]
    v_add_u32 v244, s36, v2
    v_mov_b32 v245, 1
    v_mov_b32 v246, 162880
    v_lshrrev_b32 v238, 1, v23
    v_mfma_f32_16x16x32_bf16 v[76:79], v[220:223], v[184:187], v[76:79]
    v_lshlrev_b32 v238, 8, v238
    v_lshl_add_u32 v238, v22, 4, v238
    v_and_b32 v224, 1, v23
    v_lshl_add_u32 v238, v224, 3, v238
    v_mfma_f32_16x16x32_bf16 v[104:107], v[220:223], v[188:191], v[104:107]
    v_mfma_f32_16x16x32_bf16 v[132:135], v[220:223], v[192:195], v[132:135]
    s_add_u32 s53, s55, 1408
    v_mov_b32 v8, 1
    v_mov_b32 v9, 162864
    v_mov_b32 v11, 0
    s_mov_b64 exec, 1
    s_waitcnt vmcnt(0)
    ds_add_rtn_u32 v10, v9, v8
    s_waitcnt lgkmcnt(0)
    v_readfirstlane_b32 s54, v10
    s_nop 0
    s_and_b32 s54, s54, 3
    s_cmp_lg_u32 s54, 3
    s_cbranch_scc1 pub_25
    buffer_atomic_add v8, v11, s[56:59], s53 offen sc1
pub_25:
    s_mov_b64 exec, -1
    s_barrier
    ds_read_b128 v[136:139], v17 offset:0
    ds_read_b128 v[140:143], v17 offset:2048
    ds_read_b128 v[144:147], v17 offset:4096
    ds_read_b128 v[148:151], v17 offset:6144
    ds_read_b64_tr_b16 v[152:153], v18 offset:0
    ds_read_b64_tr_b16 v[154:155], v18 offset:7168
    ds_read_b64_tr_b16 v[156:157], v19 offset:32
    ds_read_b64_tr_b16 v[158:159], v19 offset:7200
    ds_read_b64_tr_b16 v[160:161], v18 offset:64
    ds_read_b64_tr_b16 v[162:163], v18 offset:7232
    ds_read_b64_tr_b16 v[164:165], v19 offset:96
    ds_read_b64_tr_b16 v[166:167], v19 offset:7264
    ds_read_b64_tr_b16 v[168:169], v18 offset:128
    ds_read_b64_tr_b16 v[170:171], v18 offset:7296
    ds_read_b64_tr_b16 v[172:173], v19 offset:160
    ds_read_b64_tr_b16 v[174:175], v19 offset:7328
    ds_read_b64_tr_b16 v[176:177], v18 offset:192
    ds_read_b64_tr_b16 v[178:179], v18 offset:7360
    s_waitcnt lgkmcnt(12)
mm_26:
    v_mfma_f32_16x16x32_bf16 v[24:27], v[152:155], v[136:139], v[24:27]
    ds_read_b128 v[180:183], v17 offset:1024
    s_add_u32 s42, s42, 16384
    v_mfma_f32_16x16x32_bf16 v[52:55], v[152:155], v[140:143], v[52:55]
    ds_read_b128 v[184:187], v17 offset:3072
    s_cmp_eq_u32 s42, 49152
    v_mfma_f32_16x16x32_bf16 v[80:83], v[152:155], v[144:147], v[80:83]
    ds_read_b128 v[188:191], v17 offset:5120
    s_cselect_b32 s42, 0, s42
    v_mfma_f32_16x16x32_bf16 v[108:111], v[152:155], v[148:151], v[108:111]
    ds_read_b128 v[192:195], v17 offset:7168
    s_waitcnt lgkmcnt(14)
    v_mfma_f32_16x16x32_bf16 v[112:115], v[156:159], v[148:151], v[112:115]
    ds_read_b64_tr_b16 v[196:197], v18 offset:14336
    s_add_u32 s48, s48, 28672
    v_mfma_f32_16x16x32_bf16 v[84:87], v[156:159], v[144:147], v[84:87]
    ds_read_b64_tr_b16 v[198:199], v18 offset:21504
    s_cmp_eq_u32 s48, 86016
    v_mfma_f32_16x16x32_bf16 v[56:59], v[156:159], v[140:143], v[56:59]
    ds_read_b64_tr_b16 v[200:201], v19 offset:14368
    s_cselect_b32 s48, 0, s48
    v_mfma_f32_16x16x32_bf16 v[28:31], v[156:159], v[136:139], v[28:31]
    ds_read_b64_tr_b16 v[202:203], v19 offset:21536
    s_waitcnt lgkmcnt(8)
    v_mfma_f32_16x16x32_bf16 v[32:35], v[160:163], v[136:139], v[32:35]
    ds_read_b64_tr_b16 v[204:205], v18 offset:14400
    v_add_u32 v17, s42, v12
    v_mfma_f32_16x16x32_bf16 v[60:63], v[160:163], v[140:143], v[60:63]
    ds_read_b64_tr_b16 v[206:207], v18 offset:21568
    v_mfma_f32_16x16x32_bf16 v[88:91], v[160:163], v[144:147], v[88:91]
    ds_read_b64_tr_b16 v[208:209], v19 offset:14432
    v_mfma_f32_16x16x32_bf16 v[116:119], v[160:163], v[148:151], v[116:119]
    ds_read_b64_tr_b16 v[210:211], v19 offset:21600
    v_mfma_f32_16x16x32_bf16 v[120:123], v[164:167], v[148:151], v[120:123]
    ds_read_b64_tr_b16 v[212:213], v18 offset:14464
    v_mfma_f32_16x16x32_bf16 v[92:95], v[164:167], v[144:147], v[92:95]
    ds_read_b64_tr_b16 v[214:215], v18 offset:21632
    v_mfma_f32_16x16x32_bf16 v[64:67], v[164:167], v[140:143], v[64:67]
    ds_read_b64_tr_b16 v[216:217], v19 offset:14496
    v_mfma_f32_16x16x32_bf16 v[36:39], v[164:167], v[136:139], v[36:39]
    ds_read_b64_tr_b16 v[218:219], v19 offset:21664
    v_add_u32 v19, s48, v14
    v_mfma_f32_16x16x32_bf16 v[40:43], v[168:171], v[136:139], v[40:43]
    ds_read_b64_tr_b16 v[220:221], v18 offset:14528
    v_mfma_f32_16x16x32_bf16 v[68:71], v[168:171], v[140:143], v[68:71]
    ds_read_b64_tr_b16 v[222:223], v18 offset:21696
    v_add_u32 v18, s48, v13
    v_mfma_f32_16x16x32_bf16 v[96:99], v[168:171], v[144:147], v[96:99]
    v_mfma_f32_16x16x32_bf16 v[124:127], v[168:171], v[148:151], v[124:127]
    v_mfma_f32_16x16x32_bf16 v[128:131], v[172:175], v[148:151], v[128:131]
    v_mfma_f32_16x16x32_bf16 v[100:103], v[172:175], v[144:147], v[100:103]
    v_mfma_f32_16x16x32_bf16 v[72:75], v[172:175], v[140:143], v[72:75]
    v_mfma_f32_16x16x32_bf16 v[44:47], v[172:175], v[136:139], v[44:47]
    v_mfma_f32_16x16x32_bf16 v[48:51], v[176:179], v[136:139], v[48:51]
    v_mfma_f32_16x16x32_bf16 v[76:79], v[176:179], v[140:143], v[76:79]
    v_mfma_f32_16x16x32_bf16 v[104:107], v[176:179], v[144:147], v[104:107]
    v_mfma_f32_16x16x32_bf16 v[132:135], v[176:179], v[148:151], v[132:135]
    s_waitcnt lgkmcnt(12)
    v_mfma_f32_16x16x32_bf16 v[24:27], v[196:199], v[180:183], v[24:27]
    s_add_u32 s43, s43, 1
    s_cmp_lt_u32 s43, 15
    v_mfma_f32_16x16x32_bf16 v[52:55], v[196:199], v[184:187], v[52:55]
    v_mfma_f32_16x16x32_bf16 v[80:83], v[196:199], v[188:191], v[80:83]
    v_mfma_f32_16x16x32_bf16 v[108:111], v[196:199], v[192:195], v[108:111]
    s_waitcnt lgkmcnt(0)
    s_barrier
    v_mfma_f32_16x16x32_bf16 v[112:115], v[200:203], v[192:195], v[112:115]
    ds_read_b128 v[136:139], v17 offset:0
    v_mfma_f32_16x16x32_bf16 v[84:87], v[200:203], v[188:191], v[84:87]
    ds_read_b128 v[140:143], v17 offset:2048
    v_mfma_f32_16x16x32_bf16 v[56:59], v[200:203], v[184:187], v[56:59]
    ds_read_b128 v[144:147], v17 offset:4096
    v_mfma_f32_16x16x32_bf16 v[28:31], v[200:203], v[180:183], v[28:31]
    ds_read_b128 v[148:151], v17 offset:6144
    v_mfma_f32_16x16x32_bf16 v[32:35], v[204:207], v[180:183], v[32:35]
    ds_read_b64_tr_b16 v[152:153], v18 offset:0
    v_mfma_f32_16x16x32_bf16 v[60:63], v[204:207], v[184:187], v[60:63]
    ds_read_b64_tr_b16 v[154:155], v18 offset:7168
    v_mfma_f32_16x16x32_bf16 v[88:91], v[204:207], v[188:191], v[88:91]
    ds_read_b64_tr_b16 v[156:157], v19 offset:32
    v_mfma_f32_16x16x32_bf16 v[116:119], v[204:207], v[192:195], v[116:119]
    ds_read_b64_tr_b16 v[158:159], v19 offset:7200
    v_mfma_f32_16x16x32_bf16 v[120:123], v[208:211], v[192:195], v[120:123]
    ds_read_b64_tr_b16 v[160:161], v18 offset:64
    v_mfma_f32_16x16x32_bf16 v[92:95], v[208:211], v[188:191], v[92:95]
    ds_read_b64_tr_b16 v[162:163], v18 offset:7232
    v_mfma_f32_16x16x32_bf16 v[64:67], v[208:211], v[184:187], v[64:67]
    ds_read_b64_tr_b16 v[164:165], v19 offset:96
    v_mfma_f32_16x16x32_bf16 v[36:39], v[208:211], v[180:183], v[36:39]
    ds_read_b64_tr_b16 v[166:167], v19 offset:7264
    v_mfma_f32_16x16x32_bf16 v[40:43], v[212:215], v[180:183], v[40:43]
    ds_read_b64_tr_b16 v[168:169], v18 offset:128
    v_mfma_f32_16x16x32_bf16 v[68:71], v[212:215], v[184:187], v[68:71]
    ds_read_b64_tr_b16 v[170:171], v18 offset:7296
    v_mfma_f32_16x16x32_bf16 v[96:99], v[212:215], v[188:191], v[96:99]
    ds_read_b64_tr_b16 v[172:173], v19 offset:160
    v_mfma_f32_16x16x32_bf16 v[124:127], v[212:215], v[192:195], v[124:127]
    ds_read_b64_tr_b16 v[174:175], v19 offset:7328
    v_mfma_f32_16x16x32_bf16 v[128:131], v[216:219], v[192:195], v[128:131]
    ds_read_b64_tr_b16 v[176:177], v18 offset:192
    v_mfma_f32_16x16x32_bf16 v[100:103], v[216:219], v[188:191], v[100:103]
    ds_read_b64_tr_b16 v[178:179], v18 offset:7360
    v_mfma_f32_16x16x32_bf16 v[72:75], v[216:219], v[184:187], v[72:75]
    v_mfma_f32_16x16x32_bf16 v[44:47], v[216:219], v[180:183], v[44:47]
    v_mfma_f32_16x16x32_bf16 v[48:51], v[220:223], v[180:183], v[48:51]
    v_mfma_f32_16x16x32_bf16 v[76:79], v[220:223], v[184:187], v[76:79]
    v_mfma_f32_16x16x32_bf16 v[104:107], v[220:223], v[188:191], v[104:107]
    v_mfma_f32_16x16x32_bf16 v[132:135], v[220:223], v[192:195], v[132:135]
    s_waitcnt lgkmcnt(12)
    s_cbranch_scc1 mm_26
    v_mfma_f32_16x16x32_bf16 v[24:27], v[152:155], v[136:139], v[24:27]
    ds_read_b128 v[180:183], v17 offset:1024
    v_mfma_f32_16x16x32_bf16 v[52:55], v[152:155], v[140:143], v[52:55]
    ds_read_b128 v[184:187], v17 offset:3072
    v_mfma_f32_16x16x32_bf16 v[80:83], v[152:155], v[144:147], v[80:83]
    ds_read_b128 v[188:191], v17 offset:5120
    v_mfma_f32_16x16x32_bf16 v[108:111], v[152:155], v[148:151], v[108:111]
    ds_read_b128 v[192:195], v17 offset:7168
    s_waitcnt lgkmcnt(14)
    v_mfma_f32_16x16x32_bf16 v[112:115], v[156:159], v[148:151], v[112:115]
    ds_read_b64_tr_b16 v[196:197], v18 offset:14336
    v_mfma_f32_16x16x32_bf16 v[84:87], v[156:159], v[144:147], v[84:87]
    ds_read_b64_tr_b16 v[198:199], v18 offset:21504
    v_mfma_f32_16x16x32_bf16 v[56:59], v[156:159], v[140:143], v[56:59]
    ds_read_b64_tr_b16 v[200:201], v19 offset:14368
    v_mfma_f32_16x16x32_bf16 v[28:31], v[156:159], v[136:139], v[28:31]
    ds_read_b64_tr_b16 v[202:203], v19 offset:21536
    s_waitcnt lgkmcnt(8)
    v_mfma_f32_16x16x32_bf16 v[32:35], v[160:163], v[136:139], v[32:35]
    ds_read_b64_tr_b16 v[204:205], v18 offset:14400
    v_mfma_f32_16x16x32_bf16 v[60:63], v[160:163], v[140:143], v[60:63]
    ds_read_b64_tr_b16 v[206:207], v18 offset:21568
    v_mfma_f32_16x16x32_bf16 v[88:91], v[160:163], v[144:147], v[88:91]
    ds_read_b64_tr_b16 v[208:209], v19 offset:14432
    v_mfma_f32_16x16x32_bf16 v[116:119], v[160:163], v[148:151], v[116:119]
    ds_read_b64_tr_b16 v[210:211], v19 offset:21600
    v_mfma_f32_16x16x32_bf16 v[120:123], v[164:167], v[148:151], v[120:123]
    ds_read_b64_tr_b16 v[212:213], v18 offset:14464
    v_mfma_f32_16x16x32_bf16 v[92:95], v[164:167], v[144:147], v[92:95]
    ds_read_b64_tr_b16 v[214:215], v18 offset:21632
    v_mfma_f32_16x16x32_bf16 v[64:67], v[164:167], v[140:143], v[64:67]
    ds_read_b64_tr_b16 v[216:217], v19 offset:14496
    v_mfma_f32_16x16x32_bf16 v[36:39], v[164:167], v[136:139], v[36:39]
    ds_read_b64_tr_b16 v[218:219], v19 offset:21664
    v_mfma_f32_16x16x32_bf16 v[40:43], v[168:171], v[136:139], v[40:43]
    ds_read_b64_tr_b16 v[220:221], v18 offset:14528
    v_mfma_f32_16x16x32_bf16 v[68:71], v[168:171], v[140:143], v[68:71]
    ds_read_b64_tr_b16 v[222:223], v18 offset:21696
    v_mfma_f32_16x16x32_bf16 v[96:99], v[168:171], v[144:147], v[96:99]
    v_mfma_f32_16x16x32_bf16 v[124:127], v[168:171], v[148:151], v[124:127]
    v_mfma_f32_16x16x32_bf16 v[128:131], v[172:175], v[148:151], v[128:131]
    v_mfma_f32_16x16x32_bf16 v[100:103], v[172:175], v[144:147], v[100:103]
    v_mfma_f32_16x16x32_bf16 v[72:75], v[172:175], v[140:143], v[72:75]
    v_mfma_f32_16x16x32_bf16 v[44:47], v[172:175], v[136:139], v[44:47]
    v_mfma_f32_16x16x32_bf16 v[48:51], v[176:179], v[136:139], v[48:51]
    v_mfma_f32_16x16x32_bf16 v[76:79], v[176:179], v[140:143], v[76:79]
    v_mfma_f32_16x16x32_bf16 v[104:107], v[176:179], v[144:147], v[104:107]
    v_mfma_f32_16x16x32_bf16 v[132:135], v[176:179], v[148:151], v[132:135]
    s_waitcnt lgkmcnt(0)
    s_barrier
    v_mfma_f32_16x16x32_bf16 v[24:27], v[196:199], v[180:183], v[24:27]
    ds_read_b128 v[136:139], v6 offset:0
    v_mfma_f32_16x16x32_bf16 v[52:55], v[196:199], v[184:187], v[52:55]
    ds_read_b128 v[140:143], v6 offset:64
    v_mfma_f32_16x16x32_bf16 v[80:83], v[196:199], v[188:191], v[80:83]
    ds_read_b128 v[144:147], v6 offset:128
    v_mfma_f32_16x16x32_bf16 v[108:111], v[196:199], v[192:195], v[108:111]
    ds_read_b128 v[148:151], v6 offset:192
    v_mfma_f32_16x16x32_bf16 v[112:115], v[200:203], v[192:195], v[112:115]
    ds_read_b128 v[152:155], v6 offset:256
    v_mfma_f32_16x16x32_bf16 v[84:87], v[200:203], v[188:191], v[84:87]
    ds_read_b128 v[156:159], v6 offset:320
    v_mfma_f32_16x16x32_bf16 v[56:59], v[200:203], v[184:187], v[56:59]
    ds_read_b128 v[160:163], v6 offset:384
    v_mfma_f32_16x16x32_bf16 v[28:31], v[200:203], v[180:183], v[28:31]
    ds_read_b128 v[164:167], v7 offset:0
    v_mfma_f32_16x16x32_bf16 v[32:35], v[204:207], v[180:183], v[32:35]
    ds_read_b128 v[168:171], v7 offset:256
    v_mfma_f32_16x16x32_bf16 v[60:63], v[204:207], v[184:187], v[60:63]
    ds_read_b128 v[172:175], v7 offset:512
    v_mfma_f32_16x16x32_bf16 v[88:91], v[204:207], v[188:191], v[88:91]
    ds_read_b128 v[176:179], v7 offset:768
    v_mov_b32 v13, v240
    v_mfma_f32_16x16x32_bf16 v[116:119], v[204:207], v[192:195], v[116:119]
    v_add_u32 v18, 0, v240
    v_mov_b32 v14, v241
    v_mfma_f32_16x16x32_bf16 v[120:123], v[208:211], v[192:195], v[120:123]
    v_add_u32 v19, 0, v241
    v_mov_b32 v15, v242
    v_mfma_f32_16x16x32_bf16 v[92:95], v[208:211], v[188:191], v[92:95]
    v_add_u32 v20, 0, v242
    v_mov_b32 v16, v243
    v_mfma_f32_16x16x32_bf16 v[64:67], v[208:211], v[184:187], v[64:67]
    v_add_u32 v21, 0, v243
    s_mov_b32 s42, 0
    s_mov_b32 s43, 0
    v_mfma_f32_16x16x32_bf16 v[36:39], v[208:211], v[180:183], v[36:39]
    s_mov_b32 s48, 0
    v_mov_b32 v17, v12
    v_and_b32 v199, 7, v0
    v_mfma_f32_16x16x32_bf16 v[40:43], v[212:215], v[180:183], v[40:43]
    v_lshrrev_b32 v228, 6, v0
    v_lshlrev_b32 v228, 4, v228
    v_mfma_f32_16x16x32_bf16 v[68:71], v[212:215], v[184:187], v[68:71]
    v_bfe_u32 v229, v0, 3, 3
    v_add_u32 v228, v228, v229
    s_lshr_b32 s78, s29, 1
    v_mfma_f32_16x16x32_bf16 v[96:99], v[212:215], v[188:191], v[96:99]
    s_lshl_b32 s78, s78, 16
    s_and_b32 s79, s29, 1
    s_lshl_b32 s79, s79, 7
    v_mfma_f32_16x16x32_bf16 v[124:127], v[212:215], v[192:195], v[124:127]
    s_add_u32 s78, s78, s79
    s_lshr_b32 s79, s30, 1
    s_lshl_b32 s79, s79, 13
    v_mfma_f32_16x16x32_bf16 v[128:131], v[216:219], v[192:195], v[128:131]
    s_add_u32 s78, s78, s79
    v_lshlrev_b32 v196, 8, v228
    v_lshl_add_u32 v196, v199, 4, v196
    v_mfma_f32_16x16x32_bf16 v[100:103], v[216:219], v[188:191], v[100:103]
    v_add_u32 v196, s78, v196
    v_mfma_f32_16x16x32_bf16 v[72:75], v[216:219], v[184:187], v[72:75]
    v_mfma_f32_16x16x32_bf16 v[44:47], v[216:219], v[180:183], v[44:47]
    v_mfma_f32_16x16x32_bf16 v[48:51], v[220:223], v[180:183], v[48:51]
    v_mfma_f32_16x16x32_bf16 v[76:79], v[220:223], v[184:187], v[76:79]
    v_mfma_f32_16x16x32_bf16 v[104:107], v[220:223], v[188:191], v[104:107]
    v_mfma_f32_16x16x32_bf16 v[132:135], v[220:223], v[192:195], v[132:135]
    s_waitcnt lgkmcnt(0)
    s_cmp_eq_u32 s35, 1
    s_cbranch_scc1 G3_e1
    v_pk_fma_f32 v[24:25], v[164:165], v[136:137], v[24:25] op_sel_hi:[0,1,1] neg_lo:[1,0,0] neg_hi:[1,0,0]
    v_pk_fma_f32 v[26:27], v[164:165], v[138:139], v[26:27] op_sel_hi:[0,1,1] neg_lo:[1,0,0] neg_hi:[1,0,0]
    v_pk_mul_f32 v[226:227], v[24:25], v[24:25]
    v_pk_mul_f32 v[228:229], v[26:27], v[26:27]
    v_pk_fma_f32 v[226:227], v[226:227], v[166:167], v[166:167] op_sel:[0,1,0] op_sel_hi:[1,1,0]
    v_pk_fma_f32 v[228:229], v[228:229], v[166:167], v[166:167] op_sel:[0,1,0] op_sel_hi:[1,1,0]
    v_pk_mul_f32 v[226:227], v[226:227], v[24:25]
    v_pk_mul_f32 v[228:229], v[228:229], v[26:27]
    v_exp_f32 v226, v226
    v_exp_f32 v227, v227
    v_exp_f32 v228, v228
    v_exp_f32 v229, v229
    v_pk_fma_f32 v[226:227], v[226:227], v[164:165], v[164:165] op_sel:[0,1,1] op_sel_hi:[1,1,1]
    v_pk_fma_f32 v[228:229], v[228:229], v[164:165], v[164:165] op_sel:[0,1,1] op_sel_hi:[1,1,1]
    v_rcp_f32 v226, v226
    v_rcp_f32 v227, v227
    v_rcp_f32 v228, v228
    v_rcp_f32 v229, v229
    v_pk_mul_f32 v[24:25], v[24:25], v[226:227]
    v_pk_mul_f32 v[26:27], v[26:27], v[228:229]
    v_pk_fma_f32 v[28:29], v[164:165], v[140:141], v[28:29] op_sel_hi:[0,1,1] neg_lo:[1,0,0] neg_hi:[1,0,0]
    v_pk_fma_f32 v[30:31], v[164:165], v[142:143], v[30:31] op_sel_hi:[0,1,1] neg_lo:[1,0,0] neg_hi:[1,0,0]
    v_pk_mul_f32 v[226:227], v[28:29], v[28:29]
    v_pk_mul_f32 v[228:229], v[30:31], v[30:31]
    v_pk_fma_f32 v[226:227], v[226:227], v[166:167], v[166:167] op_sel:[0,1,0] op_sel_hi:[1,1,0]
    v_pk_fma_f32 v[228:229], v[228:229], v[166:167], v[166:167] op_sel:[0,1,0] op_sel_hi:[1,1,0]
    v_pk_mul_f32 v[226:227], v[226:227], v[28:29]
    v_pk_mul_f32 v[228:229], v[228:229], v[30:31]
    v_exp_f32 v226, v226
    v_exp_f32 v227, v227
    v_exp_f32 v228, v228
    v_exp_f32 v229, v229
    v_pk_fma_f32 v[226:227], v[226:227], v[164:165], v[164:165] op_sel:[0,1,1] op_sel_hi:[1,1,1]
    v_pk_fma_f32 v[228:229], v[228:229], v[164:165], v[164:165] op_sel:[0,1,1] op_sel_hi:[1,1,1]
    v_rcp_f32 v226, v226
    v_rcp_f32 v227, v227
    v_rcp_f32 v228, v228
    v_rcp_f32 v229, v229
    v_pk_mul_f32 v[28:29], v[28:29], v[226:227]
    v_pk_mul_f32 v[30:31], v[30:31], v[228:229]
    v_cvt_pk_bf16_f32 v24, v24, v25
    v_cvt_pk_bf16_f32 v25, v26, v27
    v_cvt_pk_bf16_f32 v26, v28, v29
    v_cvt_pk_bf16_f32 v27, v30, v31
    v_or_b32 v24, 1, v24
    ds_write_b128 v244, v[24:27] offset:0
    s_add_u32 s36, s44, 0
    buffer_store_dwordx4 v[24:27], v2, s[16:19], s36 offen sc1
    v_pk_fma_f32 v[52:53], v[168:169], v[136:137], v[52:53] op_sel_hi:[0,1,1] neg_lo:[1,0,0] neg_hi:[1,0,0]
    v_pk_fma_f32 v[54:55], v[168:169], v[138:139], v[54:55] op_sel_hi:[0,1,1] neg_lo:[1,0,0] neg_hi:[1,0,0]
    v_pk_mul_f32 v[226:227], v[52:53], v[52:53]
    v_pk_mul_f32 v[228:229], v[54:55], v[54:55]
    v_pk_fma_f32 v[226:227], v[226:227], v[170:171], v[170:171] op_sel:[0,1,0] op_sel_hi:[1,1,0]
    v_pk_fma_f32 v[228:229], v[228:229], v[170:171], v[170:171] op_sel:[0,1,0] op_sel_hi:[1,1,0]
    v_pk_mul_f32 v[226:227], v[226:227], v[52:53]
    v_pk_mul_f32 v[228:229], v[228:229], v[54:55]
    v_exp_f32 v226, v226
    v_exp_f32 v227, v227
    v_exp_f32 v228, v228
    v_exp_f32 v229, v229
    v_pk_fma_f32 v[226:227], v[226:227], v[168:169], v[168:169] op_sel:[0,1,1] op_sel_hi:[1,1,1]
    v_pk_fma_f32 v[228:229], v[228:229], v[168:169], v[168:169] op_sel:[0,1,1] op_sel_hi:[1,1,1]
    v_rcp_f32 v226, v226
    v_rcp_f32 v227, v227
    v_rcp_f32 v228, v228
    v_rcp_f32 v229, v229
    v_pk_mul_f32 v[52:53], v[52:53], v[226:227]
    v_pk_mul_f32 v[54:55], v[54:55], v[228:229]
    v_pk_fma_f32 v[56:57], v[168:169], v[140:141], v[56:57] op_sel_hi:[0,1,1] neg_lo:[1,0,0] neg_hi:[1,0,0]
    v_pk_fma_f32 v[58:59], v[168:169], v[142:143], v[58:59] op_sel_hi:[0,1,1] neg_lo:[1,0,0] neg_hi:[1,0,0]
    v_pk_mul_f32 v[226:227], v[56:57], v[56:57]
    v_pk_mul_f32 v[228:229], v[58:59], v[58:59]
    v_pk_fma_f32 v[226:227], v[226:227], v[170:171], v[170:171] op_sel:[0,1,0] op_sel_hi:[1,1,0]
    v_pk_fma_f32 v[228:229], v[228:229], v[170:171], v[170:171] op_sel:[0,1,0] op_sel_hi:[1,1,0]
    v_pk_mul_f32 v[226:227], v[226:227], v[56:57]
    v_pk_mul_f32 v[228:229], v[228:229], v[58:59]
    v_exp_f32 v226, v226
    v_exp_f32 v227, v227
    v_exp_f32 v228, v228
    v_exp_f32 v229, v229
    v_pk_fma_f32 v[226:227], v[226:227], v[168:169], v[168:169] op_sel:[0,1,1] op_sel_hi:[1,1,1]
    v_pk_fma_f32 v[228:229], v[228:229], v[168:169], v[168:169] op_sel:[0,1,1] op_sel_hi:[1,1,1]
    v_rcp_f32 v226, v226
    v_rcp_f32 v227, v227
    v_rcp_f32 v228, v228
    v_rcp_f32 v229, v229
    v_pk_mul_f32 v[56:57], v[56:57], v[226:227]
    v_pk_mul_f32 v[58:59], v[58:59], v[228:229]
    v_cvt_pk_bf16_f32 v52, v52, v53
    v_cvt_pk_bf16_f32 v53, v54, v55
    v_cvt_pk_bf16_f32 v54, v56, v57
    v_cvt_pk_bf16_f32 v55, v58, v59
    v_or_b32 v52, 1, v52
    ds_write_b128 v244, v[52:55] offset:2048
    s_add_u32 s36, s44, 229376
    buffer_store_dwordx4 v[52:55], v2, s[16:19], s36 offen sc1
    v_pk_fma_f32 v[80:81], v[172:173], v[136:137], v[80:81] op_sel_hi:[0,1,1] neg_lo:[1,0,0] neg_hi:[1,0,0]
    v_pk_fma_f32 v[82:83], v[172:173], v[138:139], v[82:83] op_sel_hi:[0,1,1] neg_lo:[1,0,0] neg_hi:[1,0,0]
    v_pk_mul_f32 v[226:227], v[80:81], v[80:81]
    v_pk_mul_f32 v[228:229], v[82:83], v[82:83]
    v_pk_fma_f32 v[226:227], v[226:227], v[174:175], v[174:175] op_sel:[0,1,0] op_sel_hi:[1,1,0]
    v_pk_fma_f32 v[228:229], v[228:229], v[174:175], v[174:175] op_sel:[0,1,0] op_sel_hi:[1,1,0]
    v_pk_mul_f32 v[226:227], v[226:227], v[80:81]
    v_pk_mul_f32 v[228:229], v[228:229], v[82:83]
    v_exp_f32 v226, v226
    v_exp_f32 v227, v227
    v_exp_f32 v228, v228
    v_exp_f32 v229, v229
    v_pk_fma_f32 v[226:227], v[226:227], v[172:173], v[172:173] op_sel:[0,1,1] op_sel_hi:[1,1,1]
    v_pk_fma_f32 v[228:229], v[228:229], v[172:173], v[172:173] op_sel:[0,1,1] op_sel_hi:[1,1,1]
    v_rcp_f32 v226, v226
    v_rcp_f32 v227, v227
    v_rcp_f32 v228, v228
    v_rcp_f32 v229, v229
    v_pk_mul_f32 v[80:81], v[80:81], v[226:227]
    v_pk_mul_f32 v[82:83], v[82:83], v[228:229]
    v_pk_fma_f32 v[84:85], v[172:173], v[140:141], v[84:85] op_sel_hi:[0,1,1] neg_lo:[1,0,0] neg_hi:[1,0,0]
    v_pk_fma_f32 v[86:87], v[172:173], v[142:143], v[86:87] op_sel_hi:[0,1,1] neg_lo:[1,0,0] neg_hi:[1,0,0]
    v_pk_mul_f32 v[226:227], v[84:85], v[84:85]
    v_pk_mul_f32 v[228:229], v[86:87], v[86:87]
    v_pk_fma_f32 v[226:227], v[226:227], v[174:175], v[174:175] op_sel:[0,1,0] op_sel_hi:[1,1,0]
    v_pk_fma_f32 v[228:229], v[228:229], v[174:175], v[174:175] op_sel:[0,1,0] op_sel_hi:[1,1,0]
    v_pk_mul_f32 v[226:227], v[226:227], v[84:85]
    v_pk_mul_f32 v[228:229], v[228:229], v[86:87]
    v_exp_f32 v226, v226
    v_exp_f32 v227, v227
    v_exp_f32 v228, v228
    v_exp_f32 v229, v229
    v_pk_fma_f32 v[226:227], v[226:227], v[172:173], v[172:173] op_sel:[0,1,1] op_sel_hi:[1,1,1]
    v_pk_fma_f32 v[228:229], v[228:229], v[172:173], v[172:173] op_sel:[0,1,1] op_sel_hi:[1,1,1]
    v_rcp_f32 v226, v226
    v_rcp_f32 v227, v227
    v_rcp_f32 v228, v228
    v_rcp_f32 v229, v229
    v_pk_mul_f32 v[84:85], v[84:85], v[226:227]
    v_pk_mul_f32 v[86:87], v[86:87], v[228:229]
    v_cvt_pk_bf16_f32 v80, v80, v81
    v_cvt_pk_bf16_f32 v81, v82, v83
    v_cvt_pk_bf16_f32 v82, v84, v85
    v_cvt_pk_bf16_f32 v83, v86, v87
    v_or_b32 v80, 1, v80
    ds_write_b128 v244, v[80:83] offset:4096
    s_add_u32 s36, s44, 458752
    buffer_store_dwordx4 v[80:83], v2, s[16:19], s36 offen sc1
    v_pk_fma_f32 v[108:109], v[176:177], v[136:137], v[108:109] op_sel_hi:[0,1,1] neg_lo:[1,0,0] neg_hi:[1,0,0]
    v_pk_fma_f32 v[110:111], v[176:177], v[138:139], v[110:111] op_sel_hi:[0,1,1] neg_lo:[1,0,0] neg_hi:[1,0,0]
    v_pk_mul_f32 v[226:227], v[108:109], v[108:109]
    v_pk_mul_f32 v[228:229], v[110:111], v[110:111]
    v_pk_fma_f32 v[226:227], v[226:227], v[178:179], v[178:179] op_sel:[0,1,0] op_sel_hi:[1,1,0]
    v_pk_fma_f32 v[228:229], v[228:229], v[178:179], v[178:179] op_sel:[0,1,0] op_sel_hi:[1,1,0]
    v_pk_mul_f32 v[226:227], v[226:227], v[108:109]
    v_pk_mul_f32 v[228:229], v[228:229], v[110:111]
    v_exp_f32 v226, v226
    v_exp_f32 v227, v227
    v_exp_f32 v228, v228
    v_exp_f32 v229, v229
    v_pk_fma_f32 v[226:227], v[226:227], v[176:177], v[176:177] op_sel:[0,1,1] op_sel_hi:[1,1,1]
    v_pk_fma_f32 v[228:229], v[228:229], v[176:177], v[176:177] op_sel:[0,1,1] op_sel_hi:[1,1,1]
    v_rcp_f32 v226, v226
    v_rcp_f32 v227, v227
    v_rcp_f32 v228, v228
    v_rcp_f32 v229, v229
    v_pk_mul_f32 v[108:109], v[108:109], v[226:227]
    v_pk_mul_f32 v[110:111], v[110:111], v[228:229]
    v_pk_fma_f32 v[112:113], v[176:177], v[140:141], v[112:113] op_sel_hi:[0,1,1] neg_lo:[1,0,0] neg_hi:[1,0,0]
    v_pk_fma_f32 v[114:115], v[176:177], v[142:143], v[114:115] op_sel_hi:[0,1,1] neg_lo:[1,0,0] neg_hi:[1,0,0]
    v_pk_mul_f32 v[226:227], v[112:113], v[112:113]
    v_pk_mul_f32 v[228:229], v[114:115], v[114:115]
    v_pk_fma_f32 v[226:227], v[226:227], v[178:179], v[178:179] op_sel:[0,1,0] op_sel_hi:[1,1,0]
    v_pk_fma_f32 v[228:229], v[228:229], v[178:179], v[178:179] op_sel:[0,1,0] op_sel_hi:[1,1,0]
    v_pk_mul_f32 v[226:227], v[226:227], v[112:113]
    v_pk_mul_f32 v[228:229], v[228:229], v[114:115]
    v_exp_f32 v226, v226
    v_exp_f32 v227, v227
    v_exp_f32 v228, v228
    v_exp_f32 v229, v229
    v_pk_fma_f32 v[226:227], v[226:227], v[176:177], v[176:177] op_sel:[0,1,1] op_sel_hi:[1,1,1]
    v_pk_fma_f32 v[228:229], v[228:229], v[176:177], v[176:177] op_sel:[0,1,1] op_sel_hi:[1,1,1]
    v_rcp_f32 v226, v226
    v_rcp_f32 v227, v227
    v_rcp_f32 v228, v228
    v_rcp_f32 v229, v229
    v_pk_mul_f32 v[112:113], v[112:113], v[226:227]
    v_pk_mul_f32 v[114:115], v[114:115], v[228:229]
    v_cvt_pk_bf16_f32 v108, v108, v109
    v_cvt_pk_bf16_f32 v109, v110, v111
    v_cvt_pk_bf16_f32 v110, v112, v113
    v_cvt_pk_bf16_f32 v111, v114, v115
    ds_write_b128 v244, v[108:111] offset:6144
    s_add_u32 s36, s44, 688128
    buffer_store_dwordx4 v[108:111], v2, s[16:19], s36 offen sc1
    v_pk_fma_f32 v[32:33], v[164:165], v[144:145], v[32:33] op_sel_hi:[0,1,1] neg_lo:[1,0,0] neg_hi:[1,0,0]
    v_pk_fma_f32 v[34:35], v[164:165], v[146:147], v[34:35] op_sel_hi:[0,1,1] neg_lo:[1,0,0] neg_hi:[1,0,0]
    v_pk_mul_f32 v[226:227], v[32:33], v[32:33]
    v_pk_mul_f32 v[228:229], v[34:35], v[34:35]
    v_pk_fma_f32 v[226:227], v[226:227], v[166:167], v[166:167] op_sel:[0,1,0] op_sel_hi:[1,1,0]
    v_pk_fma_f32 v[228:229], v[228:229], v[166:167], v[166:167] op_sel:[0,1,0] op_sel_hi:[1,1,0]
    v_pk_mul_f32 v[226:227], v[226:227], v[32:33]
    v_pk_mul_f32 v[228:229], v[228:229], v[34:35]
    v_exp_f32 v226, v226
    v_exp_f32 v227, v227
    v_exp_f32 v228, v228
    v_exp_f32 v229, v229
    v_pk_fma_f32 v[226:227], v[226:227], v[164:165], v[164:165] op_sel:[0,1,1] op_sel_hi:[1,1,1]
    v_pk_fma_f32 v[228:229], v[228:229], v[164:165], v[164:165] op_sel:[0,1,1] op_sel_hi:[1,1,1]
    v_rcp_f32 v226, v226
    v_rcp_f32 v227, v227
    v_rcp_f32 v228, v228
    v_rcp_f32 v229, v229
    v_pk_mul_f32 v[32:33], v[32:33], v[226:227]
    v_pk_mul_f32 v[34:35], v[34:35], v[228:229]
    v_pk_fma_f32 v[36:37], v[164:165], v[148:149], v[36:37] op_sel_hi:[0,1,1] neg_lo:[1,0,0] neg_hi:[1,0,0]
    v_pk_fma_f32 v[38:39], v[164:165], v[150:151], v[38:39] op_sel_hi:[0,1,1] neg_lo:[1,0,0] neg_hi:[1,0,0]
    v_pk_mul_f32 v[226:227], v[36:37], v[36:37]
    v_pk_mul_f32 v[228:229], v[38:39], v[38:39]
    v_pk_fma_f32 v[226:227], v[226:227], v[166:167], v[166:167] op_sel:[0,1,0] op_sel_hi:[1,1,0]
    v_pk_fma_f32 v[228:229], v[228:229], v[166:167], v[166:167] op_sel:[0,1,0] op_sel_hi:[1,1,0]
    v_pk_mul_f32 v[226:227], v[226:227], v[36:37]
    v_pk_mul_f32 v[228:229], v[228:229], v[38:39]
    v_exp_f32 v226, v226
    v_exp_f32 v227, v227
    v_exp_f32 v228, v228
    v_exp_f32 v229, v229
    v_pk_fma_f32 v[226:227], v[226:227], v[164:165], v[164:165] op_sel:[0,1,1] op_sel_hi:[1,1,1]
    v_pk_fma_f32 v[228:229], v[228:229], v[164:165], v[164:165] op_sel:[0,1,1] op_sel_hi:[1,1,1]
    v_rcp_f32 v226, v226
    v_rcp_f32 v227, v227
    v_rcp_f32 v228, v228
    v_rcp_f32 v229, v229
    v_pk_mul_f32 v[36:37], v[36:37], v[226:227]
    v_pk_mul_f32 v[38:39], v[38:39], v[228:229]
    v_cvt_pk_bf16_f32 v32, v32, v33
    v_cvt_pk_bf16_f32 v33, v34, v35
    v_cvt_pk_bf16_f32 v34, v36, v37
    v_cvt_pk_bf16_f32 v35, v38, v39
    v_or_b32 v32, 1, v32
    ds_write_b128 v244, v[32:35] offset:16384
    v_pk_fma_f32 v[60:61], v[168:169], v[144:145], v[60:61] op_sel_hi:[0,1,1] neg_lo:[1,0,0] neg_hi:[1,0,0]
    v_pk_fma_f32 v[62:63], v[168:169], v[146:147], v[62:63] op_sel_hi:[0,1,1] neg_lo:[1,0,0] neg_hi:[1,0,0]
    v_pk_mul_f32 v[226:227], v[60:61], v[60:61]
    v_pk_mul_f32 v[228:229], v[62:63], v[62:63]
    v_pk_fma_f32 v[226:227], v[226:227], v[170:171], v[170:171] op_sel:[0,1,0] op_sel_hi:[1,1,0]
    v_pk_fma_f32 v[228:229], v[228:229], v[170:171], v[170:171] op_sel:[0,1,0] op_sel_hi:[1,1,0]
    v_pk_mul_f32 v[226:227], v[226:227], v[60:61]
    v_pk_mul_f32 v[228:229], v[228:229], v[62:63]
    v_exp_f32 v226, v226
    v_exp_f32 v227, v227
    v_exp_f32 v228, v228
    v_exp_f32 v229, v229
    v_pk_fma_f32 v[226:227], v[226:227], v[168:169], v[168:169] op_sel:[0,1,1] op_sel_hi:[1,1,1]
    v_pk_fma_f32 v[228:229], v[228:229], v[168:169], v[168:169] op_sel:[0,1,1] op_sel_hi:[1,1,1]
    v_rcp_f32 v226, v226
    v_rcp_f32 v227, v227
    v_rcp_f32 v228, v228
    v_rcp_f32 v229, v229
    v_pk_mul_f32 v[60:61], v[60:61], v[226:227]
    v_pk_mul_f32 v[62:63], v[62:63], v[228:229]
    v_pk_fma_f32 v[64:65], v[168:169], v[148:149], v[64:65] op_sel_hi:[0,1,1] neg_lo:[1,0,0] neg_hi:[1,0,0]
    v_pk_fma_f32 v[66:67], v[168:169], v[150:151], v[66:67] op_sel_hi:[0,1,1] neg_lo:[1,0,0] neg_hi:[1,0,0]
    v_pk_mul_f32 v[226:227], v[64:65], v[64:65]
    v_pk_mul_f32 v[228:229], v[66:67], v[66:67]
    v_pk_fma_f32 v[226:227], v[226:227], v[170:171], v[170:171] op_sel:[0,1,0] op_sel_hi:[1,1,0]
    v_pk_fma_f32 v[228:229], v[228:229], v[170:171], v[170:171] op_sel:[0,1,0] op_sel_hi:[1,1,0]
    v_pk_mul_f32 v[226:227], v[226:227], v[64:65]
    v_pk_mul_f32 v[228:229], v[228:229], v[66:67]
    v_exp_f32 v226, v226
    v_exp_f32 v227, v227
    v_exp_f32 v228, v228
    v_exp_f32 v229, v229
    v_pk_fma_f32 v[226:227], v[226:227], v[168:169], v[168:169] op_sel:[0,1,1] op_sel_hi:[1,1,1]
    v_pk_fma_f32 v[228:229], v[228:229], v[168:169], v[168:169] op_sel:[0,1,1] op_sel_hi:[1,1,1]
    v_rcp_f32 v226, v226
    v_rcp_f32 v227, v227
    v_rcp_f32 v228, v228
    v_rcp_f32 v229, v229
    v_pk_mul_f32 v[64:65], v[64:65], v[226:227]
    v_pk_mul_f32 v[66:67], v[66:67], v[228:229]
    v_cvt_pk_bf16_f32 v60, v60, v61
    v_cvt_pk_bf16_f32 v61, v62, v63
    v_cvt_pk_bf16_f32 v62, v64, v65
    v_cvt_pk_bf16_f32 v63, v66, v67
    v_or_b32 v60, 1, v60
    ds_write_b128 v244, v[60:63] offset:18432
    s_waitcnt vmcnt(0)
    s_mov_b64 exec, 1
    ds_add_u32 v246, v245
    s_mov_b64 exec, -1
    v_pk_fma_f32 v[88:89], v[172:173], v[144:145], v[88:89] op_sel_hi:[0,1,1] neg_lo:[1,0,0] neg_hi:[1,0,0]
    v_pk_fma_f32 v[90:91], v[172:173], v[146:147], v[90:91] op_sel_hi:[0,1,1] neg_lo:[1,0,0] neg_hi:[1,0,0]
    v_pk_mul_f32 v[226:227], v[88:89], v[88:89]
    v_pk_mul_f32 v[228:229], v[90:91], v[90:91]
    v_pk_fma_f32 v[226:227], v[226:227], v[174:175], v[174:175] op_sel:[0,1,0] op_sel_hi:[1,1,0]
    v_pk_fma_f32 v[228:229], v[228:229], v[174:175], v[174:175] op_sel:[0,1,0] op_sel_hi:[1,1,0]
    v_pk_mul_f32 v[226:227], v[226:227], v[88:89]
    v_pk_mul_f32 v[228:229], v[228:229], v[90:91]
    v_exp_f32 v226, v226
    v_exp_f32 v227, v227
    v_exp_f32 v228, v228
    v_exp_f32 v229, v229
    v_pk_fma_f32 v[226:227], v[226:227], v[172:173], v[172:173] op_sel:[0,1,1] op_sel_hi:[1,1,1]
    v_pk_fma_f32 v[228:229], v[228:229], v[172:173], v[172:173] op_sel:[0,1,1] op_sel_hi:[1,1,1]
    v_rcp_f32 v226, v226
    v_rcp_f32 v227, v227
    v_rcp_f32 v228, v228
    v_rcp_f32 v229, v229
    v_pk_mul_f32 v[88:89], v[88:89], v[226:227]
    v_pk_mul_f32 v[90:91], v[90:91], v[228:229]
    v_pk_fma_f32 v[92:93], v[172:173], v[148:149], v[92:93] op_sel_hi:[0,1,1] neg_lo:[1,0,0] neg_hi:[1,0,0]
    v_pk_fma_f32 v[94:95], v[172:173], v[150:151], v[94:95] op_sel_hi:[0,1,1] neg_lo:[1,0,0] neg_hi:[1,0,0]
    v_pk_mul_f32 v[226:227], v[92:93], v[92:93]
    v_pk_mul_f32 v[228:229], v[94:95], v[94:95]
    v_pk_fma_f32 v[226:227], v[226:227], v[174:175], v[174:175] op_sel:[0,1,0] op_sel_hi:[1,1,0]
    v_pk_fma_f32 v[228:229], v[228:229], v[174:175], v[174:175] op_sel:[0,1,0] op_sel_hi:[1,1,0]
    v_pk_mul_f32 v[226:227], v[226:227], v[92:93]
    v_pk_mul_f32 v[228:229], v[228:229], v[94:95]
    v_exp_f32 v226, v226
    v_exp_f32 v227, v227
    v_exp_f32 v228, v228
    v_exp_f32 v229, v229
    v_pk_fma_f32 v[226:227], v[226:227], v[172:173], v[172:173] op_sel:[0,1,1] op_sel_hi:[1,1,1]
    v_pk_fma_f32 v[228:229], v[228:229], v[172:173], v[172:173] op_sel:[0,1,1] op_sel_hi:[1,1,1]
    v_rcp_f32 v226, v226
    v_rcp_f32 v227, v227
    v_rcp_f32 v228, v228
    v_rcp_f32 v229, v229
    v_pk_mul_f32 v[92:93], v[92:93], v[226:227]
    v_pk_mul_f32 v[94:95], v[94:95], v[228:229]
    v_cvt_pk_bf16_f32 v88, v88, v89
    v_cvt_pk_bf16_f32 v89, v90, v91
    v_cvt_pk_bf16_f32 v90, v92, v93
    v_cvt_pk_bf16_f32 v91, v94, v95
    v_or_b32 v88, 1, v88
    ds_write_b128 v244, v[88:91] offset:20480
    s_cmp_eq_u32 s60, 1
    s_cbranch_scc1 G4_p10
    buffer_load_dwordx4 v[180:183], v196, s[84:87], 0 offen offset:0 sc1
    buffer_load_dwordx4 v[188:191], v196, s[88:91], 0 offen offset:0 sc1
    buffer_load_dwordx4 v[184:187], v196, s[84:87], 0 offen offset:2048 sc1
    buffer_load_dwordx4 v[192:195], v196, s[88:91], 0 offen offset:2048 sc1
    s_branch G4_p20
G4_p10:
    s_add_u32 s36, s40, 0
    buffer_load_dwordx4 v[180:183], v2, s[84:87], s36 offen offset:0 sc1
    buffer_load_dwordx4 v[184:187], v2, s[88:91], s36 offen offset:0 sc1
    buffer_load_dwordx4 v[188:191], v2, s[84:87], s36 offen offset:1024 sc1
    buffer_load_dwordx4 v[192:195], v2, s[88:91], s36 offen offset:1024 sc1
    s_add_u32 s36, s40, 65536
    buffer_load_dwordx4 v[196:199], v2, s[84:87], s36 offen offset:0 sc1
    buffer_load_dwordx4 v[230:233], v2, s[88:91], s36 offen offset:0 sc1
    buffer_load_dwordx4 v[234:237], v2, s[84:87], s36 offen offset:1024 sc1
    buffer_load_dwordx4 v[248:251], v2, s[88:91], s36 offen offset:1024 sc1
G4_p20:
    v_pk_fma_f32 v[116:117], v[176:177], v[144:145], v[116:117] op_sel_hi:[0,1,1] neg_lo:[1,0,0] neg_hi:[1,0,0]
    v_pk_fma_f32 v[118:119], v[176:177], v[146:147], v[118:119] op_sel_hi:[0,1,1] neg_lo:[1,0,0] neg_hi:[1,0,0]
    v_pk_mul_f32 v[226:227], v[116:117], v[116:117]
    v_pk_mul_f32 v[228:229], v[118:119], v[118:119]
    v_pk_fma_f32 v[226:227], v[226:227], v[178:179], v[178:179] op_sel:[0,1,0] op_sel_hi:[1,1,0]
    v_pk_fma_f32 v[228:229], v[228:229], v[178:179], v[178:179] op_sel:[0,1,0] op_sel_hi:[1,1,0]
    v_pk_mul_f32 v[226:227], v[226:227], v[116:117]
    v_pk_mul_f32 v[228:229], v[228:229], v[118:119]
    v_exp_f32 v226, v226
    v_exp_f32 v227, v227
    v_exp_f32 v228, v228
    v_exp_f32 v229, v229
    v_pk_fma_f32 v[226:227], v[226:227], v[176:177], v[176:177] op_sel:[0,1,1] op_sel_hi:[1,1,1]
    v_pk_fma_f32 v[228:229], v[228:229], v[176:177], v[176:177] op_sel:[0,1,1] op_sel_hi:[1,1,1]
    v_rcp_f32 v226, v226
    v_rcp_f32 v227, v227
    v_rcp_f32 v228, v228
    v_rcp_f32 v229, v229
    v_pk_mul_f32 v[116:117], v[116:117], v[226:227]
    v_pk_mul_f32 v[118:119], v[118:119], v[228:229]
    v_pk_fma_f32 v[120:121], v[176:177], v[148:149], v[120:121] op_sel_hi:[0,1,1] neg_lo:[1,0,0] neg_hi:[1,0,0]
    v_pk_fma_f32 v[122:123], v[176:177], v[150:151], v[122:123] op_sel_hi:[0,1,1] neg_lo:[1,0,0] neg_hi:[1,0,0]
    v_pk_mul_f32 v[226:227], v[120:121], v[120:121]
    v_pk_mul_f32 v[228:229], v[122:123], v[122:123]
    v_pk_fma_f32 v[226:227], v[226:227], v[178:179], v[178:179] op_sel:[0,1,0] op_sel_hi:[1,1,0]
    v_pk_fma_f32 v[228:229], v[228:229], v[178:179], v[178:179] op_sel:[0,1,0] op_sel_hi:[1,1,0]
    v_pk_mul_f32 v[226:227], v[226:227], v[120:121]
    v_pk_mul_f32 v[228:229], v[228:229], v[122:123]
    v_exp_f32 v226, v226
    v_exp_f32 v227, v227
    v_exp_f32 v228, v228
    v_exp_f32 v229, v229
    v_pk_fma_f32 v[226:227], v[226:227], v[176:177], v[176:177] op_sel:[0,1,1] op_sel_hi:[1,1,1]
    v_pk_fma_f32 v[228:229], v[228:229], v[176:177], v[176:177] op_sel:[0,1,1] op_sel_hi:[1,1,1]
    v_rcp_f32 v226, v226
    v_rcp_f32 v227, v227
    v_rcp_f32 v228, v228
    v_rcp_f32 v229, v229
    v_pk_mul_f32 v[120:121], v[120:121], v[226:227]
    v_pk_mul_f32 v[122:123], v[122:123], v[228:229]
    v_cvt_pk_bf16_f32 v116, v116, v117
    v_cvt_pk_bf16_f32 v117, v118, v119
    v_cvt_pk_bf16_f32 v118, v120, v121
    v_cvt_pk_bf16_f32 v119, v122, v123
    ds_write_b128 v244, v[116:119] offset:22528
    v_pk_fma_f32 v[40:41], v[164:165], v[152:153], v[40:41] op_sel_hi:[0,1,1] neg_lo:[1,0,0] neg_hi:[1,0,0]
    v_pk_fma_f32 v[42:43], v[164:165], v[154:155], v[42:43] op_sel_hi:[0,1,1] neg_lo:[1,0,0] neg_hi:[1,0,0]
    v_pk_mul_f32 v[226:227], v[40:41], v[40:41]
    v_pk_mul_f32 v[228:229], v[42:43], v[42:43]
    v_pk_fma_f32 v[226:227], v[226:227], v[166:167], v[166:167] op_sel:[0,1,0] op_sel_hi:[1,1,0]
    v_pk_fma_f32 v[228:229], v[228:229], v[166:167], v[166:167] op_sel:[0,1,0] op_sel_hi:[1,1,0]
    v_pk_mul_f32 v[226:227], v[226:227], v[40:41]
    v_pk_mul_f32 v[228:229], v[228:229], v[42:43]
    v_exp_f32 v226, v226
    v_exp_f32 v227, v227
    v_exp_f32 v228, v228
    v_exp_f32 v229, v229
    v_pk_fma_f32 v[226:227], v[226:227], v[164:165], v[164:165] op_sel:[0,1,1] op_sel_hi:[1,1,1]
    v_pk_fma_f32 v[228:229], v[228:229], v[164:165], v[164:165] op_sel:[0,1,1] op_sel_hi:[1,1,1]
    v_rcp_f32 v226, v226
    v_rcp_f32 v227, v227
    v_rcp_f32 v228, v228
    v_rcp_f32 v229, v229
    v_pk_mul_f32 v[40:41], v[40:41], v[226:227]
    v_pk_mul_f32 v[42:43], v[42:43], v[228:229]
    v_pk_fma_f32 v[44:45], v[164:165], v[156:157], v[44:45] op_sel_hi:[0,1,1] neg_lo:[1,0,0] neg_hi:[1,0,0]
    v_pk_fma_f32 v[46:47], v[164:165], v[158:159], v[46:47] op_sel_hi:[0,1,1] neg_lo:[1,0,0] neg_hi:[1,0,0]
    v_pk_mul_f32 v[226:227], v[44:45], v[44:45]
    v_pk_mul_f32 v[228:229], v[46:47], v[46:47]
    v_pk_fma_f32 v[226:227], v[226:227], v[166:167], v[166:167] op_sel:[0,1,0] op_sel_hi:[1,1,0]
    v_pk_fma_f32 v[228:229], v[228:229], v[166:167], v[166:167] op_sel:[0,1,0] op_sel_hi:[1,1,0]
    v_pk_mul_f32 v[226:227], v[226:227], v[44:45]
    v_pk_mul_f32 v[228:229], v[228:229], v[46:47]
    v_exp_f32 v226, v226
    v_exp_f32 v227, v227
    v_exp_f32 v228, v228
    v_exp_f32 v229, v229
    v_pk_fma_f32 v[226:227], v[226:227], v[164:165], v[164:165] op_sel:[0,1,1] op_sel_hi:[1,1,1]
    v_pk_fma_f32 v[228:229], v[228:229], v[164:165], v[164:165] op_sel:[0,1,1] op_sel_hi:[1,1,1]
    v_rcp_f32 v226, v226
    v_rcp_f32 v227, v227
    v_rcp_f32 v228, v228
    v_rcp_f32 v229, v229
    v_pk_mul_f32 v[44:45], v[44:45], v[226:227]
    v_pk_mul_f32 v[46:47], v[46:47], v[228:229]
    v_cvt_pk_bf16_f32 v200, v40, v41
    v_cvt_pk_bf16_f32 v201, v42, v43
    v_cvt_pk_bf16_f32 v202, v44, v45
    v_cvt_pk_bf16_f32 v203, v46, v47
    v_or_b32 v200, 1, v200
    ds_write_b128 v244, v[200:203] offset:32768
    v_pk_fma_f32 v[68:69], v[168:169], v[152:153], v[68:69] op_sel_hi:[0,1,1] neg_lo:[1,0,0] neg_hi:[1,0,0]
    v_pk_fma_f32 v[70:71], v[168:169], v[154:155], v[70:71] op_sel_hi:[0,1,1] neg_lo:[1,0,0] neg_hi:[1,0,0]
    v_pk_mul_f32 v[226:227], v[68:69], v[68:69]
    v_pk_mul_f32 v[228:229], v[70:71], v[70:71]
    v_pk_fma_f32 v[226:227], v[226:227], v[170:171], v[170:171] op_sel:[0,1,0] op_sel_hi:[1,1,0]
    v_pk_fma_f32 v[228:229], v[228:229], v[170:171], v[170:171] op_sel:[0,1,0] op_sel_hi:[1,1,0]
    v_pk_mul_f32 v[226:227], v[226:227], v[68:69]
    v_pk_mul_f32 v[228:229], v[228:229], v[70:71]
    v_exp_f32 v226, v226
    v_exp_f32 v227, v227
    v_exp_f32 v228, v228
    v_exp_f32 v229, v229
    v_pk_fma_f32 v[226:227], v[226:227], v[168:169], v[168:169] op_sel:[0,1,1] op_sel_hi:[1,1,1]
    v_pk_fma_f32 v[228:229], v[228:229], v[168:169], v[168:169] op_sel:[0,1,1] op_sel_hi:[1,1,1]
    v_rcp_f32 v226, v226
    v_rcp_f32 v227, v227
    v_rcp_f32 v228, v228
    v_rcp_f32 v229, v229
    v_pk_mul_f32 v[68:69], v[68:69], v[226:227]
    v_pk_mul_f32 v[70:71], v[70:71], v[228:229]
    v_pk_fma_f32 v[72:73], v[168:169], v[156:157], v[72:73] op_sel_hi:[0,1,1] neg_lo:[1,0,0] neg_hi:[1,0,0]
    v_pk_fma_f32 v[74:75], v[168:169], v[158:159], v[74:75] op_sel_hi:[0,1,1] neg_lo:[1,0,0] neg_hi:[1,0,0]
    v_pk_mul_f32 v[226:227], v[72:73], v[72:73]
    v_pk_mul_f32 v[228:229], v[74:75], v[74:75]
    v_pk_fma_f32 v[226:227], v[226:227], v[170:171], v[170:171] op_sel:[0,1,0] op_sel_hi:[1,1,0]
    v_pk_fma_f32 v[228:229], v[228:229], v[170:171], v[170:171] op_sel:[0,1,0] op_sel_hi:[1,1,0]
    v_pk_mul_f32 v[226:227], v[226:227], v[72:73]
    v_pk_mul_f32 v[228:229], v[228:229], v[74:75]
    v_exp_f32 v226, v226
    v_exp_f32 v227, v227
    v_exp_f32 v228, v228
    v_exp_f32 v229, v229
    v_pk_fma_f32 v[226:227], v[226:227], v[168:169], v[168:169] op_sel:[0,1,1] op_sel_hi:[1,1,1]
    v_pk_fma_f32 v[228:229], v[228:229], v[168:169], v[168:169] op_sel:[0,1,1] op_sel_hi:[1,1,1]
    v_rcp_f32 v226, v226
    v_rcp_f32 v227, v227
    v_rcp_f32 v228, v228
    v_rcp_f32 v229, v229
    v_pk_mul_f32 v[72:73], v[72:73], v[226:227]
    v_pk_mul_f32 v[74:75], v[74:75], v[228:229]
    v_cvt_pk_bf16_f32 v204, v68, v69
    v_cvt_pk_bf16_f32 v205, v70, v71
    v_cvt_pk_bf16_f32 v206, v72, v73
    v_cvt_pk_bf16_f32 v207, v74, v75
    v_or_b32 v204, 1, v204
    ds_write_b128 v244, v[204:207] offset:34816
    v_pk_fma_f32 v[96:97], v[172:173], v[152:153], v[96:97] op_sel_hi:[0,1,1] neg_lo:[1,0,0] neg_hi:[1,0,0]
    v_pk_fma_f32 v[98:99], v[172:173], v[154:155], v[98:99] op_sel_hi:[0,1,1] neg_lo:[1,0,0] neg_hi:[1,0,0]
    v_pk_mul_f32 v[226:227], v[96:97], v[96:97]
    v_pk_mul_f32 v[228:229], v[98:99], v[98:99]
    v_pk_fma_f32 v[226:227], v[226:227], v[174:175], v[174:175] op_sel:[0,1,0] op_sel_hi:[1,1,0]
    v_pk_fma_f32 v[228:229], v[228:229], v[174:175], v[174:175] op_sel:[0,1,0] op_sel_hi:[1,1,0]
    v_pk_mul_f32 v[226:227], v[226:227], v[96:97]
    v_pk_mul_f32 v[228:229], v[228:229], v[98:99]
    v_exp_f32 v226, v226
    v_exp_f32 v227, v227
    v_exp_f32 v228, v228
    v_exp_f32 v229, v229
    v_pk_fma_f32 v[226:227], v[226:227], v[172:173], v[172:173] op_sel:[0,1,1] op_sel_hi:[1,1,1]
    v_pk_fma_f32 v[228:229], v[228:229], v[172:173], v[172:173] op_sel:[0,1,1] op_sel_hi:[1,1,1]
    v_rcp_f32 v226, v226
    v_rcp_f32 v227, v227
    v_rcp_f32 v228, v228
    v_rcp_f32 v229, v229
    v_pk_mul_f32 v[96:97], v[96:97], v[226:227]
    v_pk_mul_f32 v[98:99], v[98:99], v[228:229]
    v_pk_fma_f32 v[100:101], v[172:173], v[156:157], v[100:101] op_sel_hi:[0,1,1] neg_lo:[1,0,0] neg_hi:[1,0,0]
    v_pk_fma_f32 v[102:103], v[172:173], v[158:159], v[102:103] op_sel_hi:[0,1,1] neg_lo:[1,0,0] neg_hi:[1,0,0]
    v_pk_mul_f32 v[226:227], v[100:101], v[100:101]
    v_pk_mul_f32 v[228:229], v[102:103], v[102:103]
    v_pk_fma_f32 v[226:227], v[226:227], v[174:175], v[174:175] op_sel:[0,1,0] op_sel_hi:[1,1,0]
    v_pk_fma_f32 v[228:229], v[228:229], v[174:175], v[174:175] op_sel:[0,1,0] op_sel_hi:[1,1,0]
    v_pk_mul_f32 v[226:227], v[226:227], v[100:101]
    v_pk_mul_f32 v[228:229], v[228:229], v[102:103]
    v_exp_f32 v226, v226
    v_exp_f32 v227, v227
    v_exp_f32 v228, v228
    v_exp_f32 v229, v229
    v_pk_fma_f32 v[226:227], v[226:227], v[172:173], v[172:173] op_sel:[0,1,1] op_sel_hi:[1,1,1]
    v_pk_fma_f32 v[228:229], v[228:229], v[172:173], v[172:173] op_sel:[0,1,1] op_sel_hi:[1,1,1]
    v_rcp_f32 v226, v226
    v_rcp_f32 v227, v227
    v_rcp_f32 v228, v228
    v_rcp_f32 v229, v229
    v_pk_mul_f32 v[100:101], v[100:101], v[226:227]
    v_pk_mul_f32 v[102:103], v[102:103], v[228:229]
    v_cvt_pk_bf16_f32 v208, v96, v97
    v_cvt_pk_bf16_f32 v209, v98, v99
    v_cvt_pk_bf16_f32 v210, v100, v101
    v_cvt_pk_bf16_f32 v211, v102, v103
    v_or_b32 v208, 1, v208
    ds_write_b128 v244, v[208:211] offset:36864
    v_pk_fma_f32 v[124:125], v[176:177], v[152:153], v[124:125] op_sel_hi:[0,1,1] neg_lo:[1,0,0] neg_hi:[1,0,0]
    v_pk_fma_f32 v[126:127], v[176:177], v[154:155], v[126:127] op_sel_hi:[0,1,1] neg_lo:[1,0,0] neg_hi:[1,0,0]
    v_pk_mul_f32 v[226:227], v[124:125], v[124:125]
    v_pk_mul_f32 v[228:229], v[126:127], v[126:127]
    v_pk_fma_f32 v[226:227], v[226:227], v[178:179], v[178:179] op_sel:[0,1,0] op_sel_hi:[1,1,0]
    v_pk_fma_f32 v[228:229], v[228:229], v[178:179], v[178:179] op_sel:[0,1,0] op_sel_hi:[1,1,0]
    v_pk_mul_f32 v[226:227], v[226:227], v[124:125]
    v_pk_mul_f32 v[228:229], v[228:229], v[126:127]
    v_exp_f32 v226, v226
    v_exp_f32 v227, v227
    v_exp_f32 v228, v228
    v_exp_f32 v229, v229
    v_pk_fma_f32 v[226:227], v[226:227], v[176:177], v[176:177] op_sel:[0,1,1] op_sel_hi:[1,1,1]
    v_pk_fma_f32 v[228:229], v[228:229], v[176:177], v[176:177] op_sel:[0,1,1] op_sel_hi:[1,1,1]
    v_rcp_f32 v226, v226
    v_rcp_f32 v227, v227
    v_rcp_f32 v228, v228
    v_rcp_f32 v229, v229
    v_pk_mul_f32 v[124:125], v[124:125], v[226:227]
    v_pk_mul_f32 v[126:127], v[126:127], v[228:229]
    v_pk_fma_f32 v[128:129], v[176:177], v[156:157], v[128:129] op_sel_hi:[0,1,1] neg_lo:[1,0,0] neg_hi:[1,0,0]
    v_pk_fma_f32 v[130:131], v[176:177], v[158:159], v[130:131] op_sel_hi:[0,1,1] neg_lo:[1,0,0] neg_hi:[1,0,0]
    v_pk_mul_f32 v[226:227], v[128:129], v[128:129]
    v_pk_mul_f32 v[228:229], v[130:131], v[130:131]
    v_pk_fma_f32 v[226:227], v[226:227], v[178:179], v[178:179] op_sel:[0,1,0] op_sel_hi:[1,1,0]
    v_pk_fma_f32 v[228:229], v[228:229], v[178:179], v[178:179] op_sel:[0,1,0] op_sel_hi:[1,1,0]
    v_pk_mul_f32 v[226:227], v[226:227], v[128:129]
    v_pk_mul_f32 v[228:229], v[228:229], v[130:131]
    v_exp_f32 v226, v226
    v_exp_f32 v227, v227
    v_exp_f32 v228, v228
    v_exp_f32 v229, v229
    v_pk_fma_f32 v[226:227], v[226:227], v[176:177], v[176:177] op_sel:[0,1,1] op_sel_hi:[1,1,1]
    v_pk_fma_f32 v[228:229], v[228:229], v[176:177], v[176:177] op_sel:[0,1,1] op_sel_hi:[1,1,1]
    v_rcp_f32 v226, v226
    v_rcp_f32 v227, v227
    v_rcp_f32 v228, v228
    v_rcp_f32 v229, v229
    v_pk_mul_f32 v[128:129], v[128:129], v[226:227]
    v_pk_mul_f32 v[130:131], v[130:131], v[228:229]
    v_cvt_pk_bf16_f32 v212, v124, v125
    v_cvt_pk_bf16_f32 v213, v126, v127
    v_cvt_pk_bf16_f32 v214, v128, v129
    v_cvt_pk_bf16_f32 v215, v130, v131
    ds_write_b128 v244, v[212:215] offset:38912
    v_pk_fma_f32 v[48:49], v[164:165], v[160:161], v[48:49] op_sel_hi:[0,1,1] neg_lo:[1,0,0] neg_hi:[1,0,0]
    v_pk_fma_f32 v[50:51], v[164:165], v[162:163], v[50:51] op_sel_hi:[0,1,1] neg_lo:[1,0,0] neg_hi:[1,0,0]
    v_pk_mul_f32 v[226:227], v[48:49], v[48:49]
    v_pk_mul_f32 v[228:229], v[50:51], v[50:51]
    v_pk_fma_f32 v[226:227], v[226:227], v[166:167], v[166:167] op_sel:[0,1,0] op_sel_hi:[1,1,0]
    v_pk_fma_f32 v[228:229], v[228:229], v[166:167], v[166:167] op_sel:[0,1,0] op_sel_hi:[1,1,0]
    v_pk_mul_f32 v[226:227], v[226:227], v[48:49]
    v_pk_mul_f32 v[228:229], v[228:229], v[50:51]
    v_exp_f32 v226, v226
    v_exp_f32 v227, v227
    v_exp_f32 v228, v228
    v_exp_f32 v229, v229
    v_pk_fma_f32 v[226:227], v[226:227], v[164:165], v[164:165] op_sel:[0,1,1] op_sel_hi:[1,1,1]
    v_pk_fma_f32 v[228:229], v[228:229], v[164:165], v[164:165] op_sel:[0,1,1] op_sel_hi:[1,1,1]
    v_rcp_f32 v226, v226
    v_rcp_f32 v227, v227
    v_rcp_f32 v228, v228
    v_rcp_f32 v229, v229
    v_pk_mul_f32 v[48:49], v[48:49], v[226:227]
    v_pk_mul_f32 v[50:51], v[50:51], v[228:229]
    v_cvt_pk_bf16_f32 v216, v48, v49
    v_cvt_pk_bf16_f32 v217, v50, v51
    v_or_b32 v216, 1, v216
    s_add_u32 s36, s45, 0
    buffer_store_dwordx4 v[32:35], v2, s[16:19], s36 offen sc1
    v_pk_fma_f32 v[76:77], v[168:169], v[160:161], v[76:77] op_sel_hi:[0,1,1] neg_lo:[1,0,0] neg_hi:[1,0,0]
    v_pk_fma_f32 v[78:79], v[168:169], v[162:163], v[78:79] op_sel_hi:[0,1,1] neg_lo:[1,0,0] neg_hi:[1,0,0]
    v_pk_mul_f32 v[226:227], v[76:77], v[76:77]
    v_pk_mul_f32 v[228:229], v[78:79], v[78:79]
    v_pk_fma_f32 v[226:227], v[226:227], v[170:171], v[170:171] op_sel:[0,1,0] op_sel_hi:[1,1,0]
    v_pk_fma_f32 v[228:229], v[228:229], v[170:171], v[170:171] op_sel:[0,1,0] op_sel_hi:[1,1,0]
    v_pk_mul_f32 v[226:227], v[226:227], v[76:77]
    v_pk_mul_f32 v[228:229], v[228:229], v[78:79]
    v_exp_f32 v226, v226
    v_exp_f32 v227, v227
    v_exp_f32 v228, v228
    v_exp_f32 v229, v229
    v_pk_fma_f32 v[226:227], v[226:227], v[168:169], v[168:169] op_sel:[0,1,1] op_sel_hi:[1,1,1]
    v_pk_fma_f32 v[228:229], v[228:229], v[168:169], v[168:169] op_sel:[0,1,1] op_sel_hi:[1,1,1]
    v_rcp_f32 v226, v226
    v_rcp_f32 v227, v227
    v_rcp_f32 v228, v228
    v_rcp_f32 v229, v229
    v_pk_mul_f32 v[76:77], v[76:77], v[226:227]
    v_pk_mul_f32 v[78:79], v[78:79], v[228:229]
    v_cvt_pk_bf16_f32 v218, v76, v77
    v_cvt_pk_bf16_f32 v219, v78, v79
    v_or_b32 v218, 1, v218
    s_add_u32 s36, s45, 229376
    buffer_store_dwordx4 v[60:63], v2, s[16:19], s36 offen sc1
    v_pk_fma_f32 v[104:105], v[172:173], v[160:161], v[104:105] op_sel_hi:[0,1,1] neg_lo:[1,0,0] neg_hi:[1,0,0]
    v_pk_fma_f32 v[106:107], v[172:173], v[162:163], v[106:107] op_sel_hi:[0,1,1] neg_lo:[1,0,0] neg_hi:[1,0,0]
    v_pk_mul_f32 v[226:227], v[104:105], v[104:105]
    v_pk_mul_f32 v[228:229], v[106:107], v[106:107]
    v_pk_fma_f32 v[226:227], v[226:227], v[174:175], v[174:175] op_sel:[0,1,0] op_sel_hi:[1,1,0]
    v_pk_fma_f32 v[228:229], v[228:229], v[174:175], v[174:175] op_sel:[0,1,0] op_sel_hi:[1,1,0]
    v_pk_mul_f32 v[226:227], v[226:227], v[104:105]
    v_pk_mul_f32 v[228:229], v[228:229], v[106:107]
    v_exp_f32 v226, v226
    v_exp_f32 v227, v227
    v_exp_f32 v228, v228
    v_exp_f32 v229, v229
    v_pk_fma_f32 v[226:227], v[226:227], v[172:173], v[172:173] op_sel:[0,1,1] op_sel_hi:[1,1,1]
    v_pk_fma_f32 v[228:229], v[228:229], v[172:173], v[172:173] op_sel:[0,1,1] op_sel_hi:[1,1,1]
    v_rcp_f32 v226, v226
    v_rcp_f32 v227, v227
    v_rcp_f32 v228, v228
    v_rcp_f32 v229, v229
    v_pk_mul_f32 v[104:105], v[104:105], v[226:227]
    v_pk_mul_f32 v[106:107], v[106:107], v[228:229]
    v_cvt_pk_bf16_f32 v220, v104, v105
    v_cvt_pk_bf16_f32 v221, v106, v107
    v_or_b32 v220, 1, v220
    s_add_u32 s36, s45, 458752
    buffer_store_dwordx4 v[88:91], v2, s[16:19], s36 offen sc1
    v_pk_fma_f32 v[132:133], v[176:177], v[160:161], v[132:133] op_sel_hi:[0,1,1] neg_lo:[1,0,0] neg_hi:[1,0,0]
    v_pk_fma_f32 v[134:135], v[176:177], v[162:163], v[134:135] op_sel_hi:[0,1,1] neg_lo:[1,0,0] neg_hi:[1,0,0]
    v_pk_mul_f32 v[226:227], v[132:133], v[132:133]
    v_pk_mul_f32 v[228:229], v[134:135], v[134:135]
    v_pk_fma_f32 v[226:227], v[226:227], v[178:179], v[178:179] op_sel:[0,1,0] op_sel_hi:[1,1,0]
    v_pk_fma_f32 v[228:229], v[228:229], v[178:179], v[178:179] op_sel:[0,1,0] op_sel_hi:[1,1,0]
    v_pk_mul_f32 v[226:227], v[226:227], v[132:133]
    v_pk_mul_f32 v[228:229], v[228:229], v[134:135]
    v_exp_f32 v226, v226
    v_exp_f32 v227, v227
    v_exp_f32 v228, v228
    v_exp_f32 v229, v229
    v_pk_fma_f32 v[226:227], v[226:227], v[176:177], v[176:177] op_sel:[0,1,1] op_sel_hi:[1,1,1]
    v_pk_fma_f32 v[228:229], v[228:229], v[176:177], v[176:177] op_sel:[0,1,1] op_sel_hi:[1,1,1]
    v_rcp_f32 v226, v226
    v_rcp_f32 v227, v227
    v_rcp_f32 v228, v228
    v_rcp_f32 v229, v229
    v_pk_mul_f32 v[132:133], v[132:133], v[226:227]
    v_pk_mul_f32 v[134:135], v[134:135], v[228:229]
    v_cvt_pk_bf16_f32 v222, v132, v133
    v_cvt_pk_bf16_f32 v223, v134, v135
    s_add_u32 s36, s45, 688128
    buffer_store_dwordx4 v[116:119], v2, s[16:19], s36 offen sc1
    s_waitcnt lgkmcnt(0)
    s_mov_b32 s44, s46
    s_mov_b32 s45, s47
    s_branch G3_e2
G3_e1:
    v_pk_fma_f32 v[28:29], v[164:165], v[140:141], v[28:29] op_sel_hi:[0,1,1] neg_lo:[1,0,0] neg_hi:[1,0,0]
    v_pk_fma_f32 v[30:31], v[164:165], v[142:143], v[30:31] op_sel_hi:[0,1,1] neg_lo:[1,0,0] neg_hi:[1,0,0]
    v_pk_mul_f32 v[226:227], v[28:29], v[28:29]
    v_pk_mul_f32 v[228:229], v[30:31], v[30:31]
    v_pk_fma_f32 v[226:227], v[226:227], v[166:167], v[166:167] op_sel:[0,1,0] op_sel_hi:[1,1,0]
    v_pk_fma_f32 v[228:229], v[228:229], v[166:167], v[166:167] op_sel:[0,1,0] op_sel_hi:[1,1,0]
    v_pk_mul_f32 v[226:227], v[226:227], v[28:29]
    v_pk_mul_f32 v[228:229], v[228:229], v[30:31]
    v_exp_f32 v226, v226
    v_exp_f32 v227, v227
    v_exp_f32 v228, v228
    v_exp_f32 v229, v229
    v_pk_fma_f32 v[226:227], v[226:227], v[164:165], v[164:165] op_sel:[0,1,1] op_sel_hi:[1,1,1]
    v_pk_fma_f32 v[228:229], v[228:229], v[164:165], v[164:165] op_sel:[0,1,1] op_sel_hi:[1,1,1]
    v_rcp_f32 v226, v226
    v_rcp_f32 v227, v227
    v_rcp_f32 v228, v228
    v_rcp_f32 v229, v229
    v_pk_mul_f32 v[28:29], v[28:29], v[226:227]
    v_pk_mul_f32 v[30:31], v[30:31], v[228:229]
    v_pk_fma_f32 v[32:33], v[164:165], v[144:145], v[32:33] op_sel_hi:[0,1,1] neg_lo:[1,0,0] neg_hi:[1,0,0]
    v_pk_fma_f32 v[34:35], v[164:165], v[146:147], v[34:35] op_sel_hi:[0,1,1] neg_lo:[1,0,0] neg_hi:[1,0,0]
    v_pk_mul_f32 v[226:227], v[32:33], v[32:33]
    v_pk_mul_f32 v[228:229], v[34:35], v[34:35]
    v_pk_fma_f32 v[226:227], v[226:227], v[166:167], v[166:167] op_sel:[0,1,0] op_sel_hi:[1,1,0]
    v_pk_fma_f32 v[228:229], v[228:229], v[166:167], v[166:167] op_sel:[0,1,0] op_sel_hi:[1,1,0]
    v_pk_mul_f32 v[226:227], v[226:227], v[32:33]
    v_pk_mul_f32 v[228:229], v[228:229], v[34:35]
    v_exp_f32 v226, v226
    v_exp_f32 v227, v227
    v_exp_f32 v228, v228
    v_exp_f32 v229, v229
    v_pk_fma_f32 v[226:227], v[226:227], v[164:165], v[164:165] op_sel:[0,1,1] op_sel_hi:[1,1,1]
    v_pk_fma_f32 v[228:229], v[228:229], v[164:165], v[164:165] op_sel:[0,1,1] op_sel_hi:[1,1,1]
    v_rcp_f32 v226, v226
    v_rcp_f32 v227, v227
    v_rcp_f32 v228, v228
    v_rcp_f32 v229, v229
    v_pk_mul_f32 v[32:33], v[32:33], v[226:227]
    v_pk_mul_f32 v[34:35], v[34:35], v[228:229]
    v_cvt_pk_bf16_f32 v28, v28, v29
    v_cvt_pk_bf16_f32 v29, v30, v31
    v_cvt_pk_bf16_f32 v30, v32, v33
    v_cvt_pk_bf16_f32 v31, v34, v35
    v_or_b32 v28, 1, v28
    ds_write_b128 v244, v[28:31] offset:0
    s_add_u32 s36, s45, 0
    buffer_store_dwordx4 v[28:31], v2, s[16:19], s36 offen sc1
    v_pk_fma_f32 v[56:57], v[168:169], v[140:141], v[56:57] op_sel_hi:[0,1,1] neg_lo:[1,0,0] neg_hi:[1,0,0]
    v_pk_fma_f32 v[58:59], v[168:169], v[142:143], v[58:59] op_sel_hi:[0,1,1] neg_lo:[1,0,0] neg_hi:[1,0,0]
    v_pk_mul_f32 v[226:227], v[56:57], v[56:57]
    v_pk_mul_f32 v[228:229], v[58:59], v[58:59]
    v_pk_fma_f32 v[226:227], v[226:227], v[170:171], v[170:171] op_sel:[0,1,0] op_sel_hi:[1,1,0]
    v_pk_fma_f32 v[228:229], v[228:229], v[170:171], v[170:171] op_sel:[0,1,0] op_sel_hi:[1,1,0]
    v_pk_mul_f32 v[226:227], v[226:227], v[56:57]
    v_pk_mul_f32 v[228:229], v[228:229], v[58:59]
    v_exp_f32 v226, v226
    v_exp_f32 v227, v227
    v_exp_f32 v228, v228
    v_exp_f32 v229, v229
    v_pk_fma_f32 v[226:227], v[226:227], v[168:169], v[168:169] op_sel:[0,1,1] op_sel_hi:[1,1,1]
    v_pk_fma_f32 v[228:229], v[228:229], v[168:169], v[168:169] op_sel:[0,1,1] op_sel_hi:[1,1,1]
    v_rcp_f32 v226, v226
    v_rcp_f32 v227, v227
    v_rcp_f32 v228, v228
    v_rcp_f32 v229, v229
    v_pk_mul_f32 v[56:57], v[56:57], v[226:227]
    v_pk_mul_f32 v[58:59], v[58:59], v[228:229]
    v_pk_fma_f32 v[60:61], v[168:169], v[144:145], v[60:61] op_sel_hi:[0,1,1] neg_lo:[1,0,0] neg_hi:[1,0,0]
    v_pk_fma_f32 v[62:63], v[168:169], v[146:147], v[62:63] op_sel_hi:[0,1,1] neg_lo:[1,0,0] neg_hi:[1,0,0]
    v_pk_mul_f32 v[226:227], v[60:61], v[60:61]
    v_pk_mul_f32 v[228:229], v[62:63], v[62:63]
    v_pk_fma_f32 v[226:227], v[226:227], v[170:171], v[170:171] op_sel:[0,1,0] op_sel_hi:[1,1,0]
    v_pk_fma_f32 v[228:229], v[228:229], v[170:171], v[170:171] op_sel:[0,1,0] op_sel_hi:[1,1,0]
    v_pk_mul_f32 v[226:227], v[226:227], v[60:61]
    v_pk_mul_f32 v[228:229], v[228:229], v[62:63]
    v_exp_f32 v226, v226
    v_exp_f32 v227, v227
    v_exp_f32 v228, v228
    v_exp_f32 v229, v229
    v_pk_fma_f32 v[226:227], v[226:227], v[168:169], v[168:169] op_sel:[0,1,1] op_sel_hi:[1,1,1]
    v_pk_fma_f32 v[228:229], v[228:229], v[168:169], v[168:169] op_sel:[0,1,1] op_sel_hi:[1,1,1]
    v_rcp_f32 v226, v226
    v_rcp_f32 v227, v227
    v_rcp_f32 v228, v228
    v_rcp_f32 v229, v229
    v_pk_mul_f32 v[60:61], v[60:61], v[226:227]
    v_pk_mul_f32 v[62:63], v[62:63], v[228:229]
    v_cvt_pk_bf16_f32 v56, v56, v57
    v_cvt_pk_bf16_f32 v57, v58, v59
    v_cvt_pk_bf16_f32 v58, v60, v61
    v_cvt_pk_bf16_f32 v59, v62, v63
    v_or_b32 v56, 1, v56
    ds_write_b128 v244, v[56:59] offset:2048
    s_add_u32 s36, s45, 229376
    buffer_store_dwordx4 v[56:59], v2, s[16:19], s36 offen sc1
    v_pk_fma_f32 v[84:85], v[172:173], v[140:141], v[84:85] op_sel_hi:[0,1,1] neg_lo:[1,0,0] neg_hi:[1,0,0]
    v_pk_fma_f32 v[86:87], v[172:173], v[142:143], v[86:87] op_sel_hi:[0,1,1] neg_lo:[1,0,0] neg_hi:[1,0,0]
    v_pk_mul_f32 v[226:227], v[84:85], v[84:85]
    v_pk_mul_f32 v[228:229], v[86:87], v[86:87]
    v_pk_fma_f32 v[226:227], v[226:227], v[174:175], v[174:175] op_sel:[0,1,0] op_sel_hi:[1,1,0]
    v_pk_fma_f32 v[228:229], v[228:229], v[174:175], v[174:175] op_sel:[0,1,0] op_sel_hi:[1,1,0]
    v_pk_mul_f32 v[226:227], v[226:227], v[84:85]
    v_pk_mul_f32 v[228:229], v[228:229], v[86:87]
    v_exp_f32 v226, v226
    v_exp_f32 v227, v227
    v_exp_f32 v228, v228
    v_exp_f32 v229, v229
    v_pk_fma_f32 v[226:227], v[226:227], v[172:173], v[172:173] op_sel:[0,1,1] op_sel_hi:[1,1,1]
    v_pk_fma_f32 v[228:229], v[228:229], v[172:173], v[172:173] op_sel:[0,1,1] op_sel_hi:[1,1,1]
    v_rcp_f32 v226, v226
    v_rcp_f32 v227, v227
    v_rcp_f32 v228, v228
    v_rcp_f32 v229, v229
    v_pk_mul_f32 v[84:85], v[84:85], v[226:227]
    v_pk_mul_f32 v[86:87], v[86:87], v[228:229]
    v_pk_fma_f32 v[88:89], v[172:173], v[144:145], v[88:89] op_sel_hi:[0,1,1] neg_lo:[1,0,0] neg_hi:[1,0,0]
    v_pk_fma_f32 v[90:91], v[172:173], v[146:147], v[90:91] op_sel_hi:[0,1,1] neg_lo:[1,0,0] neg_hi:[1,0,0]
    v_pk_mul_f32 v[226:227], v[88:89], v[88:89]
    v_pk_mul_f32 v[228:229], v[90:91], v[90:91]
    v_pk_fma_f32 v[226:227], v[226:227], v[174:175], v[174:175] op_sel:[0,1,0] op_sel_hi:[1,1,0]
    v_pk_fma_f32 v[228:229], v[228:229], v[174:175], v[174:175] op_sel:[0,1,0] op_sel_hi:[1,1,0]
    v_pk_mul_f32 v[226:227], v[226:227], v[88:89]
    v_pk_mul_f32 v[228:229], v[228:229], v[90:91]
    v_exp_f32 v226, v226
    v_exp_f32 v227, v227
    v_exp_f32 v228, v228
    v_exp_f32 v229, v229
    v_pk_fma_f32 v[226:227], v[226:227], v[172:173], v[172:173] op_sel:[0,1,1] op_sel_hi:[1,1,1]
    v_pk_fma_f32 v[228:229], v[228:229], v[172:173], v[172:173] op_sel:[0,1,1] op_sel_hi:[1,1,1]
    v_rcp_f32 v226, v226
    v_rcp_f32 v227, v227
    v_rcp_f32 v228, v228
    v_rcp_f32 v229, v229
    v_pk_mul_f32 v[88:89], v[88:89], v[226:227]
    v_pk_mul_f32 v[90:91], v[90:91], v[228:229]
    v_cvt_pk_bf16_f32 v84, v84, v85
    v_cvt_pk_bf16_f32 v85, v86, v87
    v_cvt_pk_bf16_f32 v86, v88, v89
    v_cvt_pk_bf16_f32 v87, v90, v91
    v_or_b32 v84, 1, v84
    ds_write_b128 v244, v[84:87] offset:4096
    s_add_u32 s36, s45, 458752
    buffer_store_dwordx4 v[84:87], v2, s[16:19], s36 offen sc1
    v_pk_fma_f32 v[112:113], v[176:177], v[140:141], v[112:113] op_sel_hi:[0,1,1] neg_lo:[1,0,0] neg_hi:[1,0,0]
    v_pk_fma_f32 v[114:115], v[176:177], v[142:143], v[114:115] op_sel_hi:[0,1,1] neg_lo:[1,0,0] neg_hi:[1,0,0]
    v_pk_mul_f32 v[226:227], v[112:113], v[112:113]
    v_pk_mul_f32 v[228:229], v[114:115], v[114:115]
    v_pk_fma_f32 v[226:227], v[226:227], v[178:179], v[178:179] op_sel:[0,1,0] op_sel_hi:[1,1,0]
    v_pk_fma_f32 v[228:229], v[228:229], v[178:179], v[178:179] op_sel:[0,1,0] op_sel_hi:[1,1,0]
    v_pk_mul_f32 v[226:227], v[226:227], v[112:113]
    v_pk_mul_f32 v[228:229], v[228:229], v[114:115]
    v_exp_f32 v226, v226
    v_exp_f32 v227, v227
    v_exp_f32 v228, v228
    v_exp_f32 v229, v229
    v_pk_fma_f32 v[226:227], v[226:227], v[176:177], v[176:177] op_sel:[0,1,1] op_sel_hi:[1,1,1]
    v_pk_fma_f32 v[228:229], v[228:229], v[176:177], v[176:177] op_sel:[0,1,1] op_sel_hi:[1,1,1]
    v_rcp_f32 v226, v226
    v_rcp_f32 v227, v227
    v_rcp_f32 v228, v228
    v_rcp_f32 v229, v229
    v_pk_mul_f32 v[112:113], v[112:113], v[226:227]
    v_pk_mul_f32 v[114:115], v[114:115], v[228:229]
    v_pk_fma_f32 v[116:117], v[176:177], v[144:145], v[116:117] op_sel_hi:[0,1,1] neg_lo:[1,0,0] neg_hi:[1,0,0]
    v_pk_fma_f32 v[118:119], v[176:177], v[146:147], v[118:119] op_sel_hi:[0,1,1] neg_lo:[1,0,0] neg_hi:[1,0,0]
    v_pk_mul_f32 v[226:227], v[116:117], v[116:117]
    v_pk_mul_f32 v[228:229], v[118:119], v[118:119]
    v_pk_fma_f32 v[226:227], v[226:227], v[178:179], v[178:179] op_sel:[0,1,0] op_sel_hi:[1,1,0]
    v_pk_fma_f32 v[228:229], v[228:229], v[178:179], v[178:179] op_sel:[0,1,0] op_sel_hi:[1,1,0]
    v_pk_mul_f32 v[226:227], v[226:227], v[116:117]
    v_pk_mul_f32 v[228:229], v[228:229], v[118:119]
    v_exp_f32 v226, v226
    v_exp_f32 v227, v227
    v_exp_f32 v228, v228
    v_exp_f32 v229, v229
    v_pk_fma_f32 v[226:227], v[226:227], v[176:177], v[176:177] op_sel:[0,1,1] op_sel_hi:[1,1,1]
    v_pk_fma_f32 v[228:229], v[228:229], v[176:177], v[176:177] op_sel:[0,1,1] op_sel_hi:[1,1,1]
    v_rcp_f32 v226, v226
    v_rcp_f32 v227, v227
    v_rcp_f32 v228, v228
    v_rcp_f32 v229, v229
    v_pk_mul_f32 v[116:117], v[116:117], v[226:227]
    v_pk_mul_f32 v[118:119], v[118:119], v[228:229]
    v_cvt_pk_bf16_f32 v112, v112, v113
    v_cvt_pk_bf16_f32 v113, v114, v115
    v_cvt_pk_bf16_f32 v114, v116, v117
    v_cvt_pk_bf16_f32 v115, v118, v119
    ds_write_b128 v244, v[112:115] offset:6144
    s_add_u32 s36, s45, 688128
    buffer_store_dwordx4 v[112:115], v2, s[16:19], s36 offen sc1
    v_pk_fma_f32 v[36:37], v[164:165], v[148:149], v[36:37] op_sel_hi:[0,1,1] neg_lo:[1,0,0] neg_hi:[1,0,0]
    v_pk_fma_f32 v[38:39], v[164:165], v[150:151], v[38:39] op_sel_hi:[0,1,1] neg_lo:[1,0,0] neg_hi:[1,0,0]
    v_pk_mul_f32 v[226:227], v[36:37], v[36:37]
    v_pk_mul_f32 v[228:229], v[38:39], v[38:39]
    v_pk_fma_f32 v[226:227], v[226:227], v[166:167], v[166:167] op_sel:[0,1,0] op_sel_hi:[1,1,0]
    v_pk_fma_f32 v[228:229], v[228:229], v[166:167], v[166:167] op_sel:[0,1,0] op_sel_hi:[1,1,0]
    v_pk_mul_f32 v[226:227], v[226:227], v[36:37]
    v_pk_mul_f32 v[228:229], v[228:229], v[38:39]
    v_exp_f32 v226, v226
    v_exp_f32 v227, v227
    v_exp_f32 v228, v228
    v_exp_f32 v229, v229
    v_pk_fma_f32 v[226:227], v[226:227], v[164:165], v[164:165] op_sel:[0,1,1] op_sel_hi:[1,1,1]
    v_pk_fma_f32 v[228:229], v[228:229], v[164:165], v[164:165] op_sel:[0,1,1] op_sel_hi:[1,1,1]
    v_rcp_f32 v226, v226
    v_rcp_f32 v227, v227
    v_rcp_f32 v228, v228
    v_rcp_f32 v229, v229
    v_pk_mul_f32 v[36:37], v[36:37], v[226:227]
    v_pk_mul_f32 v[38:39], v[38:39], v[228:229]
    v_pk_fma_f32 v[40:41], v[164:165], v[152:153], v[40:41] op_sel_hi:[0,1,1] neg_lo:[1,0,0] neg_hi:[1,0,0]
    v_pk_fma_f32 v[42:43], v[164:165], v[154:155], v[42:43] op_sel_hi:[0,1,1] neg_lo:[1,0,0] neg_hi:[1,0,0]
    v_pk_mul_f32 v[226:227], v[40:41], v[40:41]
    v_pk_mul_f32 v[228:229], v[42:43], v[42:43]
    v_pk_fma_f32 v[226:227], v[226:227], v[166:167], v[166:167] op_sel:[0,1,0] op_sel_hi:[1,1,0]
    v_pk_fma_f32 v[228:229], v[228:229], v[166:167], v[166:167] op_sel:[0,1,0] op_sel_hi:[1,1,0]
    v_pk_mul_f32 v[226:227], v[226:227], v[40:41]
    v_pk_mul_f32 v[228:229], v[228:229], v[42:43]
    v_exp_f32 v226, v226
    v_exp_f32 v227, v227
    v_exp_f32 v228, v228
    v_exp_f32 v229, v229
    v_pk_fma_f32 v[226:227], v[226:227], v[164:165], v[164:165] op_sel:[0,1,1] op_sel_hi:[1,1,1]
    v_pk_fma_f32 v[228:229], v[228:229], v[164:165], v[164:165] op_sel:[0,1,1] op_sel_hi:[1,1,1]
    v_rcp_f32 v226, v226
    v_rcp_f32 v227, v227
    v_rcp_f32 v228, v228
    v_rcp_f32 v229, v229
    v_pk_mul_f32 v[40:41], v[40:41], v[226:227]
    v_pk_mul_f32 v[42:43], v[42:43], v[228:229]
    v_cvt_pk_bf16_f32 v36, v36, v37
    v_cvt_pk_bf16_f32 v37, v38, v39
    v_cvt_pk_bf16_f32 v38, v40, v41
    v_cvt_pk_bf16_f32 v39, v42, v43
    v_or_b32 v36, 1, v36
    ds_write_b128 v244, v[36:39] offset:16384
    v_pk_fma_f32 v[64:65], v[168:169], v[148:149], v[64:65] op_sel_hi:[0,1,1] neg_lo:[1,0,0] neg_hi:[1,0,0]
    v_pk_fma_f32 v[66:67], v[168:169], v[150:151], v[66:67] op_sel_hi:[0,1,1] neg_lo:[1,0,0] neg_hi:[1,0,0]
    v_pk_mul_f32 v[226:227], v[64:65], v[64:65]
    v_pk_mul_f32 v[228:229], v[66:67], v[66:67]
    v_pk_fma_f32 v[226:227], v[226:227], v[170:171], v[170:171] op_sel:[0,1,0] op_sel_hi:[1,1,0]
    v_pk_fma_f32 v[228:229], v[228:229], v[170:171], v[170:171] op_sel:[0,1,0] op_sel_hi:[1,1,0]
    v_pk_mul_f32 v[226:227], v[226:227], v[64:65]
    v_pk_mul_f32 v[228:229], v[228:229], v[66:67]
    v_exp_f32 v226, v226
    v_exp_f32 v227, v227
    v_exp_f32 v228, v228
    v_exp_f32 v229, v229
    v_pk_fma_f32 v[226:227], v[226:227], v[168:169], v[168:169] op_sel:[0,1,1] op_sel_hi:[1,1,1]
    v_pk_fma_f32 v[228:229], v[228:229], v[168:169], v[168:169] op_sel:[0,1,1] op_sel_hi:[1,1,1]
    v_rcp_f32 v226, v226
    v_rcp_f32 v227, v227
    v_rcp_f32 v228, v228
    v_rcp_f32 v229, v229
    v_pk_mul_f32 v[64:65], v[64:65], v[226:227]
    v_pk_mul_f32 v[66:67], v[66:67], v[228:229]
    v_pk_fma_f32 v[68:69], v[168:169], v[152:153], v[68:69] op_sel_hi:[0,1,1] neg_lo:[1,0,0] neg_hi:[1,0,0]
    v_pk_fma_f32 v[70:71], v[168:169], v[154:155], v[70:71] op_sel_hi:[0,1,1] neg_lo:[1,0,0] neg_hi:[1,0,0]
    v_pk_mul_f32 v[226:227], v[68:69], v[68:69]
    v_pk_mul_f32 v[228:229], v[70:71], v[70:71]
    v_pk_fma_f32 v[226:227], v[226:227], v[170:171], v[170:171] op_sel:[0,1,0] op_sel_hi:[1,1,0]
    v_pk_fma_f32 v[228:229], v[228:229], v[170:171], v[170:171] op_sel:[0,1,0] op_sel_hi:[1,1,0]
    v_pk_mul_f32 v[226:227], v[226:227], v[68:69]
    v_pk_mul_f32 v[228:229], v[228:229], v[70:71]
    v_exp_f32 v226, v226
    v_exp_f32 v227, v227
    v_exp_f32 v228, v228
    v_exp_f32 v229, v229
    v_pk_fma_f32 v[226:227], v[226:227], v[168:169], v[168:169] op_sel:[0,1,1] op_sel_hi:[1,1,1]
    v_pk_fma_f32 v[228:229], v[228:229], v[168:169], v[168:169] op_sel:[0,1,1] op_sel_hi:[1,1,1]
    v_rcp_f32 v226, v226
    v_rcp_f32 v227, v227
    v_rcp_f32 v228, v228
    v_rcp_f32 v229, v229
    v_pk_mul_f32 v[68:69], v[68:69], v[226:227]
    v_pk_mul_f32 v[70:71], v[70:71], v[228:229]
    v_cvt_pk_bf16_f32 v64, v64, v65
    v_cvt_pk_bf16_f32 v65, v66, v67
    v_cvt_pk_bf16_f32 v66, v68, v69
    v_cvt_pk_bf16_f32 v67, v70, v71
    v_or_b32 v64, 1, v64
    ds_write_b128 v244, v[64:67] offset:18432
    s_waitcnt vmcnt(0)
    s_mov_b64 exec, 1
    ds_add_u32 v246, v245
    s_mov_b64 exec, -1
    v_pk_fma_f32 v[92:93], v[172:173], v[148:149], v[92:93] op_sel_hi:[0,1,1] neg_lo:[1,0,0] neg_hi:[1,0,0]
    v_pk_fma_f32 v[94:95], v[172:173], v[150:151], v[94:95] op_sel_hi:[0,1,1] neg_lo:[1,0,0] neg_hi:[1,0,0]
    v_pk_mul_f32 v[226:227], v[92:93], v[92:93]
    v_pk_mul_f32 v[228:229], v[94:95], v[94:95]
    v_pk_fma_f32 v[226:227], v[226:227], v[174:175], v[174:175] op_sel:[0,1,0] op_sel_hi:[1,1,0]
    v_pk_fma_f32 v[228:229], v[228:229], v[174:175], v[174:175] op_sel:[0,1,0] op_sel_hi:[1,1,0]
    v_pk_mul_f32 v[226:227], v[226:227], v[92:93]
    v_pk_mul_f32 v[228:229], v[228:229], v[94:95]
    v_exp_f32 v226, v226
    v_exp_f32 v227, v227
    v_exp_f32 v228, v228
    v_exp_f32 v229, v229
    v_pk_fma_f32 v[226:227], v[226:227], v[172:173], v[172:173] op_sel:[0,1,1] op_sel_hi:[1,1,1]
    v_pk_fma_f32 v[228:229], v[228:229], v[172:173], v[172:173] op_sel:[0,1,1] op_sel_hi:[1,1,1]
    v_rcp_f32 v226, v226
    v_rcp_f32 v227, v227
    v_rcp_f32 v228, v228
    v_rcp_f32 v229, v229
    v_pk_mul_f32 v[92:93], v[92:93], v[226:227]
    v_pk_mul_f32 v[94:95], v[94:95], v[228:229]
    v_pk_fma_f32 v[96:97], v[172:173], v[152:153], v[96:97] op_sel_hi:[0,1,1] neg_lo:[1,0,0] neg_hi:[1,0,0]
    v_pk_fma_f32 v[98:99], v[172:173], v[154:155], v[98:99] op_sel_hi:[0,1,1] neg_lo:[1,0,0] neg_hi:[1,0,0]
    v_pk_mul_f32 v[226:227], v[96:97], v[96:97]
    v_pk_mul_f32 v[228:229], v[98:99], v[98:99]
    v_pk_fma_f32 v[226:227], v[226:227], v[174:175], v[174:175] op_sel:[0,1,0] op_sel_hi:[1,1,0]
    v_pk_fma_f32 v[228:229], v[228:229], v[174:175], v[174:175] op_sel:[0,1,0] op_sel_hi:[1,1,0]
    v_pk_mul_f32 v[226:227], v[226:227], v[96:97]
    v_pk_mul_f32 v[228:229], v[228:229], v[98:99]
    v_exp_f32 v226, v226
    v_exp_f32 v227, v227
    v_exp_f32 v228, v228
    v_exp_f32 v229, v229
    v_pk_fma_f32 v[226:227], v[226:227], v[172:173], v[172:173] op_sel:[0,1,1] op_sel_hi:[1,1,1]
    v_pk_fma_f32 v[228:229], v[228:229], v[172:173], v[172:173] op_sel:[0,1,1] op_sel_hi:[1,1,1]
    v_rcp_f32 v226, v226
    v_rcp_f32 v227, v227
    v_rcp_f32 v228, v228
    v_rcp_f32 v229, v229
    v_pk_mul_f32 v[96:97], v[96:97], v[226:227]
    v_pk_mul_f32 v[98:99], v[98:99], v[228:229]
    v_cvt_pk_bf16_f32 v92, v92, v93
    v_cvt_pk_bf16_f32 v93, v94, v95
    v_cvt_pk_bf16_f32 v94, v96, v97
    v_cvt_pk_bf16_f32 v95, v98, v99
    v_or_b32 v92, 1, v92
    ds_write_b128 v244, v[92:95] offset:20480
    s_cmp_eq_u32 s60, 1
    s_cbranch_scc1 G4_p11
    buffer_load_dwordx4 v[180:183], v196, s[84:87], 0 offen offset:0 sc1
    buffer_load_dwordx4 v[188:191], v196, s[88:91], 0 offen offset:0 sc1
    buffer_load_dwordx4 v[184:187], v196, s[84:87], 0 offen offset:2048 sc1
    buffer_load_dwordx4 v[192:195], v196, s[88:91], 0 offen offset:2048 sc1
    s_branch G4_p21
G4_p11:
    s_add_u32 s36, s40, 0
    buffer_load_dwordx4 v[180:183], v2, s[84:87], s36 offen offset:0 sc1
    buffer_load_dwordx4 v[184:187], v2, s[88:91], s36 offen offset:0 sc1
    buffer_load_dwordx4 v[188:191], v2, s[84:87], s36 offen offset:1024 sc1
    buffer_load_dwordx4 v[192:195], v2, s[88:91], s36 offen offset:1024 sc1
    s_add_u32 s36, s40, 65536
    buffer_load_dwordx4 v[196:199], v2, s[84:87], s36 offen offset:0 sc1
    buffer_load_dwordx4 v[230:233], v2, s[88:91], s36 offen offset:0 sc1
    buffer_load_dwordx4 v[234:237], v2, s[84:87], s36 offen offset:1024 sc1
    buffer_load_dwordx4 v[248:251], v2, s[88:91], s36 offen offset:1024 sc1
G4_p21:
    v_pk_fma_f32 v[120:121], v[176:177], v[148:149], v[120:121] op_sel_hi:[0,1,1] neg_lo:[1,0,0] neg_hi:[1,0,0]
    v_pk_fma_f32 v[122:123], v[176:177], v[150:151], v[122:123] op_sel_hi:[0,1,1] neg_lo:[1,0,0] neg_hi:[1,0,0]
    v_pk_mul_f32 v[226:227], v[120:121], v[120:121]
    v_pk_mul_f32 v[228:229], v[122:123], v[122:123]
    v_pk_fma_f32 v[226:227], v[226:227], v[178:179], v[178:179] op_sel:[0,1,0] op_sel_hi:[1,1,0]
    v_pk_fma_f32 v[228:229], v[228:229], v[178:179], v[178:179] op_sel:[0,1,0] op_sel_hi:[1,1,0]
    v_pk_mul_f32 v[226:227], v[226:227], v[120:121]
    v_pk_mul_f32 v[228:229], v[228:229], v[122:123]
    v_exp_f32 v226, v226
    v_exp_f32 v227, v227
    v_exp_f32 v228, v228
    v_exp_f32 v229, v229
    v_pk_fma_f32 v[226:227], v[226:227], v[176:177], v[176:177] op_sel:[0,1,1] op_sel_hi:[1,1,1]
    v_pk_fma_f32 v[228:229], v[228:229], v[176:177], v[176:177] op_sel:[0,1,1] op_sel_hi:[1,1,1]
    v_rcp_f32 v226, v226
    v_rcp_f32 v227, v227
    v_rcp_f32 v228, v228
    v_rcp_f32 v229, v229
    v_pk_mul_f32 v[120:121], v[120:121], v[226:227]
    v_pk_mul_f32 v[122:123], v[122:123], v[228:229]
    v_pk_fma_f32 v[124:125], v[176:177], v[152:153], v[124:125] op_sel_hi:[0,1,1] neg_lo:[1,0,0] neg_hi:[1,0,0]
    v_pk_fma_f32 v[126:127], v[176:177], v[154:155], v[126:127] op_sel_hi:[0,1,1] neg_lo:[1,0,0] neg_hi:[1,0,0]
    v_pk_mul_f32 v[226:227], v[124:125], v[124:125]
    v_pk_mul_f32 v[228:229], v[126:127], v[126:127]
    v_pk_fma_f32 v[226:227], v[226:227], v[178:179], v[178:179] op_sel:[0,1,0] op_sel_hi:[1,1,0]
    v_pk_fma_f32 v[228:229], v[228:229], v[178:179], v[178:179] op_sel:[0,1,0] op_sel_hi:[1,1,0]
    v_pk_mul_f32 v[226:227], v[226:227], v[124:125]
    v_pk_mul_f32 v[228:229], v[228:229], v[126:127]
    v_exp_f32 v226, v226
    v_exp_f32 v227, v227
    v_exp_f32 v228, v228
    v_exp_f32 v229, v229
    v_pk_fma_f32 v[226:227], v[226:227], v[176:177], v[176:177] op_sel:[0,1,1] op_sel_hi:[1,1,1]
    v_pk_fma_f32 v[228:229], v[228:229], v[176:177], v[176:177] op_sel:[0,1,1] op_sel_hi:[1,1,1]
    v_rcp_f32 v226, v226
    v_rcp_f32 v227, v227
    v_rcp_f32 v228, v228
    v_rcp_f32 v229, v229
    v_pk_mul_f32 v[124:125], v[124:125], v[226:227]
    v_pk_mul_f32 v[126:127], v[126:127], v[228:229]
    v_cvt_pk_bf16_f32 v120, v120, v121
    v_cvt_pk_bf16_f32 v121, v122, v123
    v_cvt_pk_bf16_f32 v122, v124, v125
    v_cvt_pk_bf16_f32 v123, v126, v127
    ds_write_b128 v244, v[120:123] offset:22528
    v_pk_fma_f32 v[44:45], v[164:165], v[156:157], v[44:45] op_sel_hi:[0,1,1] neg_lo:[1,0,0] neg_hi:[1,0,0]
    v_pk_fma_f32 v[46:47], v[164:165], v[158:159], v[46:47] op_sel_hi:[0,1,1] neg_lo:[1,0,0] neg_hi:[1,0,0]
    v_pk_mul_f32 v[226:227], v[44:45], v[44:45]
    v_pk_mul_f32 v[228:229], v[46:47], v[46:47]
    v_pk_fma_f32 v[226:227], v[226:227], v[166:167], v[166:167] op_sel:[0,1,0] op_sel_hi:[1,1,0]
    v_pk_fma_f32 v[228:229], v[228:229], v[166:167], v[166:167] op_sel:[0,1,0] op_sel_hi:[1,1,0]
    v_pk_mul_f32 v[226:227], v[226:227], v[44:45]
    v_pk_mul_f32 v[228:229], v[228:229], v[46:47]
    v_exp_f32 v226, v226
    v_exp_f32 v227, v227
    v_exp_f32 v228, v228
    v_exp_f32 v229, v229
    v_pk_fma_f32 v[226:227], v[226:227], v[164:165], v[164:165] op_sel:[0,1,1] op_sel_hi:[1,1,1]
    v_pk_fma_f32 v[228:229], v[228:229], v[164:165], v[164:165] op_sel:[0,1,1] op_sel_hi:[1,1,1]
    v_rcp_f32 v226, v226
    v_rcp_f32 v227, v227
    v_rcp_f32 v228, v228
    v_rcp_f32 v229, v229
    v_pk_mul_f32 v[44:45], v[44:45], v[226:227]
    v_pk_mul_f32 v[46:47], v[46:47], v[228:229]
    v_pk_fma_f32 v[48:49], v[164:165], v[160:161], v[48:49] op_sel_hi:[0,1,1] neg_lo:[1,0,0] neg_hi:[1,0,0]
    v_pk_fma_f32 v[50:51], v[164:165], v[162:163], v[50:51] op_sel_hi:[0,1,1] neg_lo:[1,0,0] neg_hi:[1,0,0]
    v_pk_mul_f32 v[226:227], v[48:49], v[48:49]
    v_pk_mul_f32 v[228:229], v[50:51], v[50:51]
    v_pk_fma_f32 v[226:227], v[226:227], v[166:167], v[166:167] op_sel:[0,1,0] op_sel_hi:[1,1,0]
    v_pk_fma_f32 v[228:229], v[228:229], v[166:167], v[166:167] op_sel:[0,1,0] op_sel_hi:[1,1,0]
    v_pk_mul_f32 v[226:227], v[226:227], v[48:49]
    v_pk_mul_f32 v[228:229], v[228:229], v[50:51]
    v_exp_f32 v226, v226
    v_exp_f32 v227, v227
    v_exp_f32 v228, v228
    v_exp_f32 v229, v229
    v_pk_fma_f32 v[226:227], v[226:227], v[164:165], v[164:165] op_sel:[0,1,1] op_sel_hi:[1,1,1]
    v_pk_fma_f32 v[228:229], v[228:229], v[164:165], v[164:165] op_sel:[0,1,1] op_sel_hi:[1,1,1]
    v_rcp_f32 v226, v226
    v_rcp_f32 v227, v227
    v_rcp_f32 v228, v228
    v_rcp_f32 v229, v229
    v_pk_mul_f32 v[48:49], v[48:49], v[226:227]
    v_pk_mul_f32 v[50:51], v[50:51], v[228:229]
    v_cvt_pk_bf16_f32 v200, v44, v45
    v_cvt_pk_bf16_f32 v201, v46, v47
    v_cvt_pk_bf16_f32 v202, v48, v49
    v_cvt_pk_bf16_f32 v203, v50, v51
    v_or_b32 v200, 1, v200
    ds_write_b128 v244, v[200:203] offset:32768
    v_pk_fma_f32 v[72:73], v[168:169], v[156:157], v[72:73] op_sel_hi:[0,1,1] neg_lo:[1,0,0] neg_hi:[1,0,0]
    v_pk_fma_f32 v[74:75], v[168:169], v[158:159], v[74:75] op_sel_hi:[0,1,1] neg_lo:[1,0,0] neg_hi:[1,0,0]
    v_pk_mul_f32 v[226:227], v[72:73], v[72:73]
    v_pk_mul_f32 v[228:229], v[74:75], v[74:75]
    v_pk_fma_f32 v[226:227], v[226:227], v[170:171], v[170:171] op_sel:[0,1,0] op_sel_hi:[1,1,0]
    v_pk_fma_f32 v[228:229], v[228:229], v[170:171], v[170:171] op_sel:[0,1,0] op_sel_hi:[1,1,0]
    v_pk_mul_f32 v[226:227], v[226:227], v[72:73]
    v_pk_mul_f32 v[228:229], v[228:229], v[74:75]
    v_exp_f32 v226, v226
    v_exp_f32 v227, v227
    v_exp_f32 v228, v228
    v_exp_f32 v229, v229
    v_pk_fma_f32 v[226:227], v[226:227], v[168:169], v[168:169] op_sel:[0,1,1] op_sel_hi:[1,1,1]
    v_pk_fma_f32 v[228:229], v[228:229], v[168:169], v[168:169] op_sel:[0,1,1] op_sel_hi:[1,1,1]
    v_rcp_f32 v226, v226
    v_rcp_f32 v227, v227
    v_rcp_f32 v228, v228
    v_rcp_f32 v229, v229
    v_pk_mul_f32 v[72:73], v[72:73], v[226:227]
    v_pk_mul_f32 v[74:75], v[74:75], v[228:229]
    v_pk_fma_f32 v[76:77], v[168:169], v[160:161], v[76:77] op_sel_hi:[0,1,1] neg_lo:[1,0,0] neg_hi:[1,0,0]
    v_pk_fma_f32 v[78:79], v[168:169], v[162:163], v[78:79] op_sel_hi:[0,1,1] neg_lo:[1,0,0] neg_hi:[1,0,0]
    v_pk_mul_f32 v[226:227], v[76:77], v[76:77]
    v_pk_mul_f32 v[228:229], v[78:79], v[78:79]
    v_pk_fma_f32 v[226:227], v[226:227], v[170:171], v[170:171] op_sel:[0,1,0] op_sel_hi:[1,1,0]
    v_pk_fma_f32 v[228:229], v[228:229], v[170:171], v[170:171] op_sel:[0,1,0] op_sel_hi:[1,1,0]
    v_pk_mul_f32 v[226:227], v[226:227], v[76:77]
    v_pk_mul_f32 v[228:229], v[228:229], v[78:79]
    v_exp_f32 v226, v226
    v_exp_f32 v227, v227
    v_exp_f32 v228, v228
    v_exp_f32 v229, v229
    v_pk_fma_f32 v[226:227], v[226:227], v[168:169], v[168:169] op_sel:[0,1,1] op_sel_hi:[1,1,1]
    v_pk_fma_f32 v[228:229], v[228:229], v[168:169], v[168:169] op_sel:[0,1,1] op_sel_hi:[1,1,1]
    v_rcp_f32 v226, v226
    v_rcp_f32 v227, v227
    v_rcp_f32 v228, v228
    v_rcp_f32 v229, v229
    v_pk_mul_f32 v[76:77], v[76:77], v[226:227]
    v_pk_mul_f32 v[78:79], v[78:79], v[228:229]
    v_cvt_pk_bf16_f32 v204, v72, v73
    v_cvt_pk_bf16_f32 v205, v74, v75
    v_cvt_pk_bf16_f32 v206, v76, v77
    v_cvt_pk_bf16_f32 v207, v78, v79
    v_or_b32 v204, 1, v204
    ds_write_b128 v244, v[204:207] offset:34816
    v_pk_fma_f32 v[100:101], v[172:173], v[156:157], v[100:101] op_sel_hi:[0,1,1] neg_lo:[1,0,0] neg_hi:[1,0,0]
    v_pk_fma_f32 v[102:103], v[172:173], v[158:159], v[102:103] op_sel_hi:[0,1,1] neg_lo:[1,0,0] neg_hi:[1,0,0]
    v_pk_mul_f32 v[226:227], v[100:101], v[100:101]
    v_pk_mul_f32 v[228:229], v[102:103], v[102:103]
    v_pk_fma_f32 v[226:227], v[226:227], v[174:175], v[174:175] op_sel:[0,1,0] op_sel_hi:[1,1,0]
    v_pk_fma_f32 v[228:229], v[228:229], v[174:175], v[174:175] op_sel:[0,1,0] op_sel_hi:[1,1,0]
    v_pk_mul_f32 v[226:227], v[226:227], v[100:101]
    v_pk_mul_f32 v[228:229], v[228:229], v[102:103]
    v_exp_f32 v226, v226
    v_exp_f32 v227, v227
    v_exp_f32 v228, v228
    v_exp_f32 v229, v229
    v_pk_fma_f32 v[226:227], v[226:227], v[172:173], v[172:173] op_sel:[0,1,1] op_sel_hi:[1,1,1]
    v_pk_fma_f32 v[228:229], v[228:229], v[172:173], v[172:173] op_sel:[0,1,1] op_sel_hi:[1,1,1]
    v_rcp_f32 v226, v226
    v_rcp_f32 v227, v227
    v_rcp_f32 v228, v228
    v_rcp_f32 v229, v229
    v_pk_mul_f32 v[100:101], v[100:101], v[226:227]
    v_pk_mul_f32 v[102:103], v[102:103], v[228:229]
    v_pk_fma_f32 v[104:105], v[172:173], v[160:161], v[104:105] op_sel_hi:[0,1,1] neg_lo:[1,0,0] neg_hi:[1,0,0]
    v_pk_fma_f32 v[106:107], v[172:173], v[162:163], v[106:107] op_sel_hi:[0,1,1] neg_lo:[1,0,0] neg_hi:[1,0,0]
    v_pk_mul_f32 v[226:227], v[104:105], v[104:105]
    v_pk_mul_f32 v[228:229], v[106:107], v[106:107]
    v_pk_fma_f32 v[226:227], v[226:227], v[174:175], v[174:175] op_sel:[0,1,0] op_sel_hi:[1,1,0]
    v_pk_fma_f32 v[228:229], v[228:229], v[174:175], v[174:175] op_sel:[0,1,0] op_sel_hi:[1,1,0]
    v_pk_mul_f32 v[226:227], v[226:227], v[104:105]
    v_pk_mul_f32 v[228:229], v[228:229], v[106:107]
    v_exp_f32 v226, v226
    v_exp_f32 v227, v227
    v_exp_f32 v228, v228
    v_exp_f32 v229, v229
    v_pk_fma_f32 v[226:227], v[226:227], v[172:173], v[172:173] op_sel:[0,1,1] op_sel_hi:[1,1,1]
    v_pk_fma_f32 v[228:229], v[228:229], v[172:173], v[172:173] op_sel:[0,1,1] op_sel_hi:[1,1,1]
    v_rcp_f32 v226, v226
    v_rcp_f32 v227, v227
    v_rcp_f32 v228, v228
    v_rcp_f32 v229, v229
    v_pk_mul_f32 v[104:105], v[104:105], v[226:227]
    v_pk_mul_f32 v[106:107], v[106:107], v[228:229]
    v_cvt_pk_bf16_f32 v208, v100, v101
    v_cvt_pk_bf16_f32 v209, v102, v103
    v_cvt_pk_bf16_f32 v210, v104, v105
    v_cvt_pk_bf16_f32 v211, v106, v107
    v_or_b32 v208, 1, v208
    ds_write_b128 v244, v[208:211] offset:36864
    v_pk_fma_f32 v[128:129], v[176:177], v[156:157], v[128:129] op_sel_hi:[0,1,1] neg_lo:[1,0,0] neg_hi:[1,0,0]
    v_pk_fma_f32 v[130:131], v[176:177], v[158:159], v[130:131] op_sel_hi:[0,1,1] neg_lo:[1,0,0] neg_hi:[1,0,0]
    v_pk_mul_f32 v[226:227], v[128:129], v[128:129]
    v_pk_mul_f32 v[228:229], v[130:131], v[130:131]
    v_pk_fma_f32 v[226:227], v[226:227], v[178:179], v[178:179] op_sel:[0,1,0] op_sel_hi:[1,1,0]
    v_pk_fma_f32 v[228:229], v[228:229], v[178:179], v[178:179] op_sel:[0,1,0] op_sel_hi:[1,1,0]
    v_pk_mul_f32 v[226:227], v[226:227], v[128:129]
    v_pk_mul_f32 v[228:229], v[228:229], v[130:131]
    v_exp_f32 v226, v226
    v_exp_f32 v227, v227
    v_exp_f32 v228, v228
    v_exp_f32 v229, v229
    v_pk_fma_f32 v[226:227], v[226:227], v[176:177], v[176:177] op_sel:[0,1,1] op_sel_hi:[1,1,1]
    v_pk_fma_f32 v[228:229], v[228:229], v[176:177], v[176:177] op_sel:[0,1,1] op_sel_hi:[1,1,1]
    v_rcp_f32 v226, v226
    v_rcp_f32 v227, v227
    v_rcp_f32 v228, v228
    v_rcp_f32 v229, v229
    v_pk_mul_f32 v[128:129], v[128:129], v[226:227]
    v_pk_mul_f32 v[130:131], v[130:131], v[228:229]
    v_pk_fma_f32 v[132:133], v[176:177], v[160:161], v[132:133] op_sel_hi:[0,1,1] neg_lo:[1,0,0] neg_hi:[1,0,0]
    v_pk_fma_f32 v[134:135], v[176:177], v[162:163], v[134:135] op_sel_hi:[0,1,1] neg_lo:[1,0,0] neg_hi:[1,0,0]
    v_pk_mul_f32 v[226:227], v[132:133], v[132:133]
    v_pk_mul_f32 v[228:229], v[134:135], v[134:135]
    v_pk_fma_f32 v[226:227], v[226:227], v[178:179], v[178:179] op_sel:[0,1,0] op_sel_hi:[1,1,0]
    v_pk_fma_f32 v[228:229], v[228:229], v[178:179], v[178:179] op_sel:[0,1,0] op_sel_hi:[1,1,0]
    v_pk_mul_f32 v[226:227], v[226:227], v[132:133]
    v_pk_mul_f32 v[228:229], v[228:229], v[134:135]
    v_exp_f32 v226, v226
    v_exp_f32 v227, v227
    v_exp_f32 v228, v228
    v_exp_f32 v229, v229
    v_pk_fma_f32 v[226:227], v[226:227], v[176:177], v[176:177] op_sel:[0,1,1] op_sel_hi:[1,1,1]
    v_pk_fma_f32 v[228:229], v[228:229], v[176:177], v[176:177] op_sel:[0,1,1] op_sel_hi:[1,1,1]
    v_rcp_f32 v226, v226
    v_rcp_f32 v227, v227
    v_rcp_f32 v228, v228
    v_rcp_f32 v229, v229
    v_pk_mul_f32 v[132:133], v[132:133], v[226:227]
    v_pk_mul_f32 v[134:135], v[134:135], v[228:229]
    v_cvt_pk_bf16_f32 v212, v128, v129
    v_cvt_pk_bf16_f32 v213, v130, v131
    v_cvt_pk_bf16_f32 v214, v132, v133
    v_cvt_pk_bf16_f32 v215, v134, v135
    ds_write_b128 v244, v[212:215] offset:38912
    v_pk_fma_f32 v[24:25], v[164:165], v[136:137], v[24:25] op_sel_hi:[0,1,1] neg_lo:[1,0,0] neg_hi:[1,0,0]
    v_pk_fma_f32 v[26:27], v[164:165], v[138:139], v[26:27] op_sel_hi:[0,1,1] neg_lo:[1,0,0] neg_hi:[1,0,0]
    v_pk_mul_f32 v[226:227], v[24:25], v[24:25]
    v_pk_mul_f32 v[228:229], v[26:27], v[26:27]
    v_pk_fma_f32 v[226:227], v[226:227], v[166:167], v[166:167] op_sel:[0,1,0] op_sel_hi:[1,1,0]
    v_pk_fma_f32 v[228:229], v[228:229], v[166:167], v[166:167] op_sel:[0,1,0] op_sel_hi:[1,1,0]
    v_pk_mul_f32 v[226:227], v[226:227], v[24:25]
    v_pk_mul_f32 v[228:229], v[228:229], v[26:27]
    v_exp_f32 v226, v226
    v_exp_f32 v227, v227
    v_exp_f32 v228, v228
    v_exp_f32 v229, v229
    v_pk_fma_f32 v[226:227], v[226:227], v[164:165], v[164:165] op_sel:[0,1,1] op_sel_hi:[1,1,1]
    v_pk_fma_f32 v[228:229], v[228:229], v[164:165], v[164:165] op_sel:[0,1,1] op_sel_hi:[1,1,1]
    v_rcp_f32 v226, v226
    v_rcp_f32 v227, v227
    v_rcp_f32 v228, v228
    v_rcp_f32 v229, v229
    v_pk_mul_f32 v[24:25], v[24:25], v[226:227]
    v_pk_mul_f32 v[26:27], v[26:27], v[228:229]
    v_cvt_pk_bf16_f32 v216, v24, v25
    v_cvt_pk_bf16_f32 v217, v26, v27
    v_or_b32 v216, 1, v216
    s_add_u32 s36, s46, 0
    buffer_store_dwordx4 v[36:39], v2, s[16:19], s36 offen sc1
    v_pk_fma_f32 v[52:53], v[168:169], v[136:137], v[52:53] op_sel_hi:[0,1,1] neg_lo:[1,0,0] neg_hi:[1,0,0]
    v_pk_fma_f32 v[54:55], v[168:169], v[138:139], v[54:55] op_sel_hi:[0,1,1] neg_lo:[1,0,0] neg_hi:[1,0,0]
    v_pk_mul_f32 v[226:227], v[52:53], v[52:53]
    v_pk_mul_f32 v[228:229], v[54:55], v[54:55]
    v_pk_fma_f32 v[226:227], v[226:227], v[170:171], v[170:171] op_sel:[0,1,0] op_sel_hi:[1,1,0]
    v_pk_fma_f32 v[228:229], v[228:229], v[170:171], v[170:171] op_sel:[0,1,0] op_sel_hi:[1,1,0]
    v_pk_mul_f32 v[226:227], v[226:227], v[52:53]
    v_pk_mul_f32 v[228:229], v[228:229], v[54:55]
    v_exp_f32 v226, v226
    v_exp_f32 v227, v227
    v_exp_f32 v228, v228
    v_exp_f32 v229, v229
    v_pk_fma_f32 v[226:227], v[226:227], v[168:169], v[168:169] op_sel:[0,1,1] op_sel_hi:[1,1,1]
    v_pk_fma_f32 v[228:229], v[228:229], v[168:169], v[168:169] op_sel:[0,1,1] op_sel_hi:[1,1,1]
    v_rcp_f32 v226, v226
    v_rcp_f32 v227, v227
    v_rcp_f32 v228, v228
    v_rcp_f32 v229, v229
    v_pk_mul_f32 v[52:53], v[52:53], v[226:227]
    v_pk_mul_f32 v[54:55], v[54:55], v[228:229]
    v_cvt_pk_bf16_f32 v218, v52, v53
    v_cvt_pk_bf16_f32 v219, v54, v55
    v_or_b32 v218, 1, v218
    s_add_u32 s36, s46, 229376
    buffer_store_dwordx4 v[64:67], v2, s[16:19], s36 offen sc1
    v_pk_fma_f32 v[80:81], v[172:173], v[136:137], v[80:81] op_sel_hi:[0,1,1] neg_lo:[1,0,0] neg_hi:[1,0,0]
    v_pk_fma_f32 v[82:83], v[172:173], v[138:139], v[82:83] op_sel_hi:[0,1,1] neg_lo:[1,0,0] neg_hi:[1,0,0]
    v_pk_mul_f32 v[226:227], v[80:81], v[80:81]
    v_pk_mul_f32 v[228:229], v[82:83], v[82:83]
    v_pk_fma_f32 v[226:227], v[226:227], v[174:175], v[174:175] op_sel:[0,1,0] op_sel_hi:[1,1,0]
    v_pk_fma_f32 v[228:229], v[228:229], v[174:175], v[174:175] op_sel:[0,1,0] op_sel_hi:[1,1,0]
    v_pk_mul_f32 v[226:227], v[226:227], v[80:81]
    v_pk_mul_f32 v[228:229], v[228:229], v[82:83]
    v_exp_f32 v226, v226
    v_exp_f32 v227, v227
    v_exp_f32 v228, v228
    v_exp_f32 v229, v229
    v_pk_fma_f32 v[226:227], v[226:227], v[172:173], v[172:173] op_sel:[0,1,1] op_sel_hi:[1,1,1]
    v_pk_fma_f32 v[228:229], v[228:229], v[172:173], v[172:173] op_sel:[0,1,1] op_sel_hi:[1,1,1]
    v_rcp_f32 v226, v226
    v_rcp_f32 v227, v227
    v_rcp_f32 v228, v228
    v_rcp_f32 v229, v229
    v_pk_mul_f32 v[80:81], v[80:81], v[226:227]
    v_pk_mul_f32 v[82:83], v[82:83], v[228:229]
    v_cvt_pk_bf16_f32 v220, v80, v81
    v_cvt_pk_bf16_f32 v221, v82, v83
    v_or_b32 v220, 1, v220
    s_add_u32 s36, s46, 458752
    buffer_store_dwordx4 v[92:95], v2, s[16:19], s36 offen sc1
    v_pk_fma_f32 v[108:109], v[176:177], v[136:137], v[108:109] op_sel_hi:[0,1,1] neg_lo:[1,0,0] neg_hi:[1,0,0]
    v_pk_fma_f32 v[110:111], v[176:177], v[138:139], v[110:111] op_sel_hi:[0,1,1] neg_lo:[1,0,0] neg_hi:[1,0,0]
    v_pk_mul_f32 v[226:227], v[108:109], v[108:109]
    v_pk_mul_f32 v[228:229], v[110:111], v[110:111]
    v_pk_fma_f32 v[226:227], v[226:227], v[178:179], v[178:179] op_sel:[0,1,0] op_sel_hi:[1,1,0]
    v_pk_fma_f32 v[228:229], v[228:229], v[178:179], v[178:179] op_sel:[0,1,0] op_sel_hi:[1,1,0]
    v_pk_mul_f32 v[226:227], v[226:227], v[108:109]
    v_pk_mul_f32 v[228:229], v[228:229], v[110:111]
    v_exp_f32 v226, v226
    v_exp_f32 v227, v227
    v_exp_f32 v228, v228
    v_exp_f32 v229, v229
    v_pk_fma_f32 v[226:227], v[226:227], v[176:177], v[176:177] op_sel:[0,1,1] op_sel_hi:[1,1,1]
    v_pk_fma_f32 v[228:229], v[228:229], v[176:177], v[176:177] op_sel:[0,1,1] op_sel_hi:[1,1,1]
    v_rcp_f32 v226, v226
    v_rcp_f32 v227, v227
    v_rcp_f32 v228, v228
    v_rcp_f32 v229, v229
    v_pk_mul_f32 v[108:109], v[108:109], v[226:227]
    v_pk_mul_f32 v[110:111], v[110:111], v[228:229]
    v_cvt_pk_bf16_f32 v222, v108, v109
    v_cvt_pk_bf16_f32 v223, v110, v111
    s_add_u32 s36, s46, 688128
    buffer_store_dwordx4 v[120:123], v2, s[16:19], s36 offen sc1
    s_waitcnt lgkmcnt(0)
    s_add_u32 s45, s44, 512
    s_mov_b32 s44, s47
G3_e2:
    s_waitcnt lgkmcnt(0)
    s_barrier
    ds_read_b128 v[88:91], v17 offset:0
    ds_read_b128 v[92:95], v17 offset:2048
    ds_read_b128 v[96:99], v17 offset:4096
    ds_read_b128 v[100:103], v17 offset:6144
    ds_read_b64_tr_b16 v[104:105], v18 offset:0
    ds_read_b64_tr_b16 v[106:107], v18 offset:4096
    ds_read_b64_tr_b16 v[108:109], v19 offset:0
    ds_read_b64_tr_b16 v[110:111], v19 offset:4096
    ds_read_b64_tr_b16 v[112:113], v20 offset:0
    ds_read_b64_tr_b16 v[114:115], v20 offset:4096
    ds_read_b64_tr_b16 v[116:117], v21 offset:0
    ds_read_b64_tr_b16 v[118:119], v21 offset:4096
    s_waitcnt lgkmcnt(6)
    v_mfma_f32_16x16x32_bf16 v[24:27], v[104:107], v[88:91], 0
    ds_read_b128 v[120:123], v17 offset:1024
    s_add_u32 s42, s42, 16384
    v_mfma_f32_16x16x32_bf16 v[40:43], v[104:107], v[92:95], 0
    ds_read_b128 v[124:127], v17 offset:3072
    s_cmp_eq_u32 s42, 49152
    v_mfma_f32_16x16x32_bf16 v[56:59], v[104:107], v[96:99], 0
    ds_read_b128 v[128:131], v17 offset:5120
    s_cselect_b32 s42, 0, s42
    v_mfma_f32_16x16x32_bf16 v[72:75], v[104:107], v[100:103], 0
    ds_read_b128 v[132:135], v17 offset:7168
    s_waitcnt lgkmcnt(8)
    v_mfma_f32_16x16x32_bf16 v[76:79], v[108:111], v[100:103], 0
    ds_read_b64_tr_b16 v[136:137], v18 offset:8192
    s_add_u32 s48, s48, 16384
    v_mfma_f32_16x16x32_bf16 v[60:63], v[108:111], v[96:99], 0
    ds_read_b64_tr_b16 v[138:139], v18 offset:12288
    s_cmp_eq_u32 s48, 98304
    v_mfma_f32_16x16x32_bf16 v[44:47], v[108:111], v[92:95], 0
    ds_read_b64_tr_b16 v[140:141], v19 offset:8192
    s_cselect_b32 s48, 0, s48
    v_mfma_f32_16x16x32_bf16 v[28:31], v[108:111], v[88:91], 0
    ds_read_b64_tr_b16 v[142:143], v19 offset:12288
    s_waitcnt lgkmcnt(8)
    v_mfma_f32_16x16x32_bf16 v[32:35], v[112:115], v[88:91], 0
    ds_read_b64_tr_b16 v[144:145], v20 offset:8192
    v_add_u32 v17, s42, v12
    v_mfma_f32_16x16x32_bf16 v[48:51], v[112:115], v[92:95], 0
    ds_read_b64_tr_b16 v[146:147], v20 offset:12288
    s_add_u32 s36, s44, 0
    v_mfma_f32_16x16x32_bf16 v[64:67], v[112:115], v[96:99], 0
    ds_read_b64_tr_b16 v[148:149], v21 offset:8192
    buffer_store_dwordx4 v[200:203], v2, s[16:19], s36 offen sc1
    v_mfma_f32_16x16x32_bf16 v[80:83], v[112:115], v[100:103], 0
    ds_read_b64_tr_b16 v[150:151], v21 offset:12288
    s_add_u32 s36, s45, 0
    v_mfma_f32_16x16x32_bf16 v[84:87], v[116:119], v[100:103], 0
    buffer_store_dwordx2 v[216:217], v238, s[16:19], s36 offen sc1
    v_add_u32 v18, s48, v13
    v_mfma_f32_16x16x32_bf16 v[68:71], v[116:119], v[96:99], 0
    v_add_u32 v19, s48, v14
    v_mfma_f32_16x16x32_bf16 v[52:55], v[116:119], v[92:95], 0
    v_add_u32 v20, s48, v15
    v_mfma_f32_16x16x32_bf16 v[36:39], v[116:119], v[88:91], 0
    v_add_u32 v21, s48, v16
    s_waitcnt lgkmcnt(6)
    v_mfma_f32_16x16x32_bf16 v[24:27], v[136:139], v[120:123], v[24:27]
    v_mfma_f32_16x16x32_bf16 v[40:43], v[136:139], v[124:127], v[40:43]
    v_mfma_f32_16x16x32_bf16 v[56:59], v[136:139], v[128:131], v[56:59]
    s_waitcnt lgkmcnt(0)
    s_barrier
    v_mfma_f32_16x16x32_bf16 v[72:75], v[136:139], v[132:135], v[72:75]
    ds_read_b128 v[88:91], v17 offset:0
    s_add_u32 s36, s44, 229376
    v_mfma_f32_16x16x32_bf16 v[76:79], v[140:143], v[132:135], v[76:79]
    ds_read_b128 v[92:95], v17 offset:2048
    buffer_store_dwordx4 v[204:207], v2, s[16:19], s36 offen sc1
    v_mfma_f32_16x16x32_bf16 v[60:63], v[140:143], v[128:131], v[60:63]
    ds_read_b128 v[96:99], v17 offset:4096
    s_add_u32 s36, s45, 229376
    v_mfma_f32_16x16x32_bf16 v[44:47], v[140:143], v[124:127], v[44:47]
    ds_read_b128 v[100:103], v17 offset:6144
    buffer_store_dwordx2 v[218:219], v238, s[16:19], s36 offen sc1
    v_mfma_f32_16x16x32_bf16 v[28:31], v[140:143], v[120:123], v[28:31]
    ds_read_b64_tr_b16 v[104:105], v18 offset:0
    s_add_u32 s43, s43, 1
    v_mfma_f32_16x16x32_bf16 v[32:35], v[144:147], v[120:123], v[32:35]
    ds_read_b64_tr_b16 v[106:107], v18 offset:4096
    s_cmp_lt_u32 s43, 27
    v_mfma_f32_16x16x32_bf16 v[48:51], v[144:147], v[124:127], v[48:51]
    ds_read_b64_tr_b16 v[108:109], v19 offset:0
    v_mfma_f32_16x16x32_bf16 v[64:67], v[144:147], v[128:131], v[64:67]
    ds_read_b64_tr_b16 v[110:111], v19 offset:4096
    v_mfma_f32_16x16x32_bf16 v[80:83], v[144:147], v[132:135], v[80:83]
    ds_read_b64_tr_b16 v[112:113], v20 offset:0
    v_mfma_f32_16x16x32_bf16 v[84:87], v[148:151], v[132:135], v[84:87]
    ds_read_b64_tr_b16 v[114:115], v20 offset:4096
    v_mfma_f32_16x16x32_bf16 v[68:71], v[148:151], v[128:131], v[68:71]
    ds_read_b64_tr_b16 v[116:117], v21 offset:0
    v_mfma_f32_16x16x32_bf16 v[52:55], v[148:151], v[124:127], v[52:55]
    ds_read_b64_tr_b16 v[118:119], v21 offset:4096
    v_mfma_f32_16x16x32_bf16 v[36:39], v[148:151], v[120:123], v[36:39]
    s_waitcnt lgkmcnt(6)
    v_mfma_f32_16x16x32_bf16 v[24:27], v[104:107], v[88:91], v[24:27]
    ds_read_b128 v[120:123], v17 offset:1024
    s_add_u32 s42, s42, 16384
    v_mfma_f32_16x16x32_bf16 v[40:43], v[104:107], v[92:95], v[40:43]
    ds_read_b128 v[124:127], v17 offset:3072
    s_cmp_eq_u32 s42, 49152
    v_mfma_f32_16x16x32_bf16 v[56:59], v[104:107], v[96:99], v[56:59]
    ds_read_b128 v[128:131], v17 offset:5120
    s_cselect_b32 s42, 0, s42
    v_mfma_f32_16x16x32_bf16 v[72:75], v[104:107], v[100:103], v[72:75]
    ds_read_b128 v[132:135], v17 offset:7168
    s_waitcnt lgkmcnt(8)
    v_mfma_f32_16x16x32_bf16 v[76:79], v[108:111], v[100:103], v[76:79]
    ds_read_b64_tr_b16 v[136:137], v18 offset:8192
    s_add_u32 s48, s48, 16384
    v_mfma_f32_16x16x32_bf16 v[60:63], v[108:111], v[96:99], v[60:63]
    ds_read_b64_tr_b16 v[138:139], v18 offset:12288
    s_cmp_eq_u32 s48, 98304
    v_mfma_f32_16x16x32_bf16 v[44:47], v[108:111], v[92:95], v[44:47]
    ds_read_b64_tr_b16 v[140:141], v19 offset:8192
    s_cselect_b32 s48, 0, s48
    v_mfma_f32_16x16x32_bf16 v[28:31], v[108:111], v[88:91], v[28:31]
    ds_read_b64_tr_b16 v[142:143], v19 offset:12288
    s_waitcnt lgkmcnt(8)
    v_mfma_f32_16x16x32_bf16 v[32:35], v[112:115], v[88:91], v[32:35]
    ds_read_b64_tr_b16 v[144:145], v20 offset:8192
    v_add_u32 v17, s42, v12
    v_mfma_f32_16x16x32_bf16 v[48:51], v[112:115], v[92:95], v[48:51]
    ds_read_b64_tr_b16 v[146:147], v20 offset:12288
    s_add_u32 s36, s44, 458752
    v_mfma_f32_16x16x32_bf16 v[64:67], v[112:115], v[96:99], v[64:67]
    ds_read_b64_tr_b16 v[148:149], v21 offset:8192
    buffer_store_dwordx4 v[208:211], v2, s[16:19], s36 offen sc1
    v_mfma_f32_16x16x32_bf16 v[80:83], v[112:115], v[100:103], v[80:83]
    ds_read_b64_tr_b16 v[150:151], v21 offset:12288
    s_add_u32 s36, s45, 458752
    v_mfma_f32_16x16x32_bf16 v[84:87], v[116:119], v[100:103], v[84:87]
    buffer_store_dwordx2 v[220:221], v238, s[16:19], s36 offen sc1
    v_add_u32 v18, s48, v13
    v_mfma_f32_16x16x32_bf16 v[68:71], v[116:119], v[96:99], v[68:71]
    v_add_u32 v19, s48, v14
    v_mfma_f32_16x16x32_bf16 v[52:55], v[116:119], v[92:95], v[52:55]
    v_add_u32 v20, s48, v15
    v_mfma_f32_16x16x32_bf16 v[36:39], v[116:119], v[88:91], v[36:39]
    v_add_u32 v21, s48, v16
    s_waitcnt lgkmcnt(6)
    v_mfma_f32_16x16x32_bf16 v[24:27], v[136:139], v[120:123], v[24:27]
    v_mfma_f32_16x16x32_bf16 v[40:43], v[136:139], v[124:127], v[40:43]
    s_waitcnt vmcnt(6)
    v_mfma_f32_16x16x32_bf16 v[56:59], v[136:139], v[128:131], v[56:59]
    s_waitcnt lgkmcnt(0)
    s_barrier
    v_mfma_f32_16x16x32_bf16 v[72:75], v[136:139], v[132:135], v[72:75]
    ds_read_b128 v[88:91], v17 offset:0
    s_add_u32 s36, s44, 688128
    v_mfma_f32_16x16x32_bf16 v[76:79], v[140:143], v[132:135], v[76:79]
    ds_read_b128 v[92:95], v17 offset:2048
    buffer_store_dwordx4 v[212:215], v2, s[16:19], s36 offen sc1
    v_mfma_f32_16x16x32_bf16 v[60:63], v[140:143], v[128:131], v[60:63]
    ds_read_b128 v[96:99], v17 offset:4096
    s_add_u32 s36, s45, 688128
    v_mfma_f32_16x16x32_bf16 v[44:47], v[140:143], v[124:127], v[44:47]
    ds_read_b128 v[100:103], v17 offset:6144
    buffer_store_dwordx2 v[222:223], v238, s[16:19], s36 offen sc1
    v_mfma_f32_16x16x32_bf16 v[28:31], v[140:143], v[120:123], v[28:31]
    ds_read_b64_tr_b16 v[104:105], v18 offset:0
    s_add_u32 s43, s43, 1
    v_mfma_f32_16x16x32_bf16 v[32:35], v[144:147], v[120:123], v[32:35]
    ds_read_b64_tr_b16 v[106:107], v18 offset:4096
    s_cmp_lt_u32 s43, 27
    v_mfma_f32_16x16x32_bf16 v[48:51], v[144:147], v[124:127], v[48:51]
    ds_read_b64_tr_b16 v[108:109], v19 offset:0
    v_mfma_f32_16x16x32_bf16 v[64:67], v[144:147], v[128:131], v[64:67]
    ds_read_b64_tr_b16 v[110:111], v19 offset:4096
    v_mfma_f32_16x16x32_bf16 v[80:83], v[144:147], v[132:135], v[80:83]
    ds_read_b64_tr_b16 v[112:113], v20 offset:0
    v_mfma_f32_16x16x32_bf16 v[84:87], v[148:151], v[132:135], v[84:87]
    ds_read_b64_tr_b16 v[114:115], v20 offset:4096
    v_mfma_f32_16x16x32_bf16 v[68:71], v[148:151], v[128:131], v[68:71]
    ds_read_b64_tr_b16 v[116:117], v21 offset:0
    v_mfma_f32_16x16x32_bf16 v[52:55], v[148:151], v[124:127], v[52:55]
    ds_read_b64_tr_b16 v[118:119], v21 offset:4096
    v_mfma_f32_16x16x32_bf16 v[36:39], v[148:151], v[120:123], v[36:39]
    s_waitcnt lgkmcnt(6)
mm_27:
    v_mfma_f32_16x16x32_bf16 v[24:27], v[104:107], v[88:91], v[24:27]
    ds_read_b128 v[120:123], v17 offset:1024
    s_add_u32 s42, s42, 16384
    v_mfma_f32_16x16x32_bf16 v[40:43], v[104:107], v[92:95], v[40:43]
    ds_read_b128 v[124:127], v17 offset:3072
    s_cmp_eq_u32 s42, 49152
    v_mfma_f32_16x16x32_bf16 v[56:59], v[104:107], v[96:99], v[56:59]
    ds_read_b128 v[128:131], v17 offset:5120
    s_cselect_b32 s42, 0, s42
    v_mfma_f32_16x16x32_bf16 v[72:75], v[104:107], v[100:103], v[72:75]
    ds_read_b128 v[132:135], v17 offset:7168
    s_waitcnt lgkmcnt(8)
    v_mfma_f32_16x16x32_bf16 v[76:79], v[108:111], v[100:103], v[76:79]
    ds_read_b64_tr_b16 v[136:137], v18 offset:8192
    s_add_u32 s48, s48, 16384
    v_mfma_f32_16x16x32_bf16 v[60:63], v[108:111], v[96:99], v[60:63]
    ds_read_b64_tr_b16 v[138:139], v18 offset:12288
    s_cmp_eq_u32 s48, 98304
    v_mfma_f32_16x16x32_bf16 v[44:47], v[108:111], v[92:95], v[44:47]
    ds_read_b64_tr_b16 v[140:141], v19 offset:8192
    s_cselect_b32 s48, 0, s48
    v_mfma_f32_16x16x32_bf16 v[28:31], v[108:111], v[88:91], v[28:31]
    ds_read_b64_tr_b16 v[142:143], v19 offset:12288
    s_waitcnt lgkmcnt(8)
    v_mfma_f32_16x16x32_bf16 v[32:35], v[112:115], v[88:91], v[32:35]
    ds_read_b64_tr_b16 v[144:145], v20 offset:8192
    v_add_u32 v17, s42, v12
    v_mfma_f32_16x16x32_bf16 v[48:51], v[112:115], v[92:95], v[48:51]
    ds_read_b64_tr_b16 v[146:147], v20 offset:12288
    v_add_u32 v18, s48, v13
    v_mfma_f32_16x16x32_bf16 v[64:67], v[112:115], v[96:99], v[64:67]
    ds_read_b64_tr_b16 v[148:149], v21 offset:8192
    v_add_u32 v19, s48, v14
    v_mfma_f32_16x16x32_bf16 v[80:83], v[112:115], v[100:103], v[80:83]
    ds_read_b64_tr_b16 v[150:151], v21 offset:12288
    v_add_u32 v20, s48, v15
    v_mfma_f32_16x16x32_bf16 v[84:87], v[116:119], v[100:103], v[84:87]
    v_add_u32 v21, s48, v16
    v_mfma_f32_16x16x32_bf16 v[68:71], v[116:119], v[96:99], v[68:71]
    v_mfma_f32_16x16x32_bf16 v[52:55], v[116:119], v[92:95], v[52:55]
    v_mfma_f32_16x16x32_bf16 v[36:39], v[116:119], v[88:91], v[36:39]
    s_waitcnt lgkmcnt(6)
    v_mfma_f32_16x16x32_bf16 v[24:27], v[136:139], v[120:123], v[24:27]
    s_add_u32 s43, s43, 1
    s_cmp_lt_u32 s43, 4
    v_mfma_f32_16x16x32_bf16 v[40:43], v[136:139], v[124:127], v[40:43]
    v_mfma_f32_16x16x32_bf16 v[56:59], v[136:139], v[128:131], v[56:59]
    s_waitcnt lgkmcnt(0)
    s_barrier
    v_mfma_f32_16x16x32_bf16 v[72:75], v[136:139], v[132:135], v[72:75]
    ds_read_b128 v[88:91], v17 offset:0
    v_mfma_f32_16x16x32_bf16 v[76:79], v[140:143], v[132:135], v[76:79]
    ds_read_b128 v[92:95], v17 offset:2048
    v_mfma_f32_16x16x32_bf16 v[60:63], v[140:143], v[128:131], v[60:63]
    ds_read_b128 v[96:99], v17 offset:4096
    v_mfma_f32_16x16x32_bf16 v[44:47], v[140:143], v[124:127], v[44:47]
    ds_read_b128 v[100:103], v17 offset:6144
    v_mfma_f32_16x16x32_bf16 v[28:31], v[140:143], v[120:123], v[28:31]
    ds_read_b64_tr_b16 v[104:105], v18 offset:0
    v_mfma_f32_16x16x32_bf16 v[32:35], v[144:147], v[120:123], v[32:35]
    ds_read_b64_tr_b16 v[106:107], v18 offset:4096
    v_mfma_f32_16x16x32_bf16 v[48:51], v[144:147], v[124:127], v[48:51]
    ds_read_b64_tr_b16 v[108:109], v19 offset:0
    v_mfma_f32_16x16x32_bf16 v[64:67], v[144:147], v[128:131], v[64:67]
    ds_read_b64_tr_b16 v[110:111], v19 offset:4096
    v_mfma_f32_16x16x32_bf16 v[80:83], v[144:147], v[132:135], v[80:83]
    ds_read_b64_tr_b16 v[112:113], v20 offset:0
    v_mfma_f32_16x16x32_bf16 v[84:87], v[148:151], v[132:135], v[84:87]
    ds_read_b64_tr_b16 v[114:115], v20 offset:4096
    v_mfma_f32_16x16x32_bf16 v[68:71], v[148:151], v[128:131], v[68:71]
    ds_read_b64_tr_b16 v[116:117], v21 offset:0
    v_mfma_f32_16x16x32_bf16 v[52:55], v[148:151], v[124:127], v[52:55]
    ds_read_b64_tr_b16 v[118:119], v21 offset:4096
    v_mfma_f32_16x16x32_bf16 v[36:39], v[148:151], v[120:123], v[36:39]
    s_waitcnt lgkmcnt(6)
    s_cbranch_scc1 mm_27
mm_28:
    v_mfma_f32_16x16x32_bf16 v[24:27], v[104:107], v[88:91], v[24:27]
    ds_read_b128 v[120:123], v17 offset:1024
    s_add_u32 s42, s42, 16384
    v_mfma_f32_16x16x32_bf16 v[40:43], v[104:107], v[92:95], v[40:43]
    ds_read_b128 v[124:127], v17 offset:3072
    s_cmp_eq_u32 s42, 49152
    v_mfma_f32_16x16x32_bf16 v[56:59], v[104:107], v[96:99], v[56:59]
    ds_read_b128 v[128:131], v17 offset:5120
    s_cselect_b32 s42, 0, s42
    v_mfma_f32_16x16x32_bf16 v[72:75], v[104:107], v[100:103], v[72:75]
    ds_read_b128 v[132:135], v17 offset:7168
    s_waitcnt lgkmcnt(8)
    v_mfma_f32_16x16x32_bf16 v[76:79], v[108:111], v[100:103], v[76:79]
    ds_read_b64_tr_b16 v[136:137], v18 offset:8192
    s_add_u32 s48, s48, 16384
    v_mfma_f32_16x16x32_bf16 v[60:63], v[108:111], v[96:99], v[60:63]
    ds_read_b64_tr_b16 v[138:139], v18 offset:12288
    s_cmp_eq_u32 s48, 98304
    v_mfma_f32_16x16x32_bf16 v[44:47], v[108:111], v[92:95], v[44:47]
    ds_read_b64_tr_b16 v[140:141], v19 offset:8192
    s_cselect_b32 s48, 0, s48
    v_mfma_f32_16x16x32_bf16 v[28:31], v[108:111], v[88:91], v[28:31]
    ds_read_b64_tr_b16 v[142:143], v19 offset:12288
    s_waitcnt lgkmcnt(8)
    v_mfma_f32_16x16x32_bf16 v[32:35], v[112:115], v[88:91], v[32:35]
    ds_read_b64_tr_b16 v[144:145], v20 offset:8192
    v_add_u32 v17, s42, v12
    v_mfma_f32_16x16x32_bf16 v[48:51], v[112:115], v[92:95], v[48:51]
    ds_read_b64_tr_b16 v[146:147], v20 offset:12288
    v_add_u32 v18, s48, v13
    v_mfma_f32_16x16x32_bf16 v[64:67], v[112:115], v[96:99], v[64:67]
    ds_read_b64_tr_b16 v[148:149], v21 offset:8192
    v_add_u32 v19, s48, v14
    v_mfma_f32_16x16x32_bf16 v[80:83], v[112:115], v[100:103], v[80:83]
    ds_read_b64_tr_b16 v[150:151], v21 offset:12288
    v_add_u32 v20, s48, v15
    v_mfma_f32_16x16x32_bf16 v[84:87], v[116:119], v[100:103], v[84:87]
    v_add_u32 v21, s48, v16
    v_mfma_f32_16x16x32_bf16 v[68:71], v[116:119], v[96:99], v[68:71]
    v_mfma_f32_16x16x32_bf16 v[52:55], v[116:119], v[92:95], v[52:55]
    v_mfma_f32_16x16x32_bf16 v[36:39], v[116:119], v[88:91], v[36:39]
    s_waitcnt lgkmcnt(6)
    v_mfma_f32_16x16x32_bf16 v[24:27], v[136:139], v[120:123], v[24:27]
    s_add_u32 s43, s43, 1
    s_cmp_lt_u32 s43, 27
    v_mfma_f32_16x16x32_bf16 v[40:43], v[136:139], v[124:127], v[40:43]
    s_waitcnt vmcnt(0)
    v_mfma_f32_16x16x32_bf16 v[56:59], v[136:139], v[128:131], v[56:59]
    s_waitcnt lgkmcnt(0)
    s_barrier
    v_mfma_f32_16x16x32_bf16 v[72:75], v[136:139], v[132:135], v[72:75]
    ds_read_b128 v[88:91], v17 offset:0
    v_mfma_f32_16x16x32_bf16 v[76:79], v[140:143], v[132:135], v[76:79]
    ds_read_b128 v[92:95], v17 offset:2048
    v_mfma_f32_16x16x32_bf16 v[60:63], v[140:143], v[128:131], v[60:63]
    ds_read_b128 v[96:99], v17 offset:4096
    v_mfma_f32_16x16x32_bf16 v[44:47], v[140:143], v[124:127], v[44:47]
    ds_read_b128 v[100:103], v17 offset:6144
    v_mfma_f32_16x16x32_bf16 v[28:31], v[140:143], v[120:123], v[28:31]
    ds_read_b64_tr_b16 v[104:105], v18 offset:0
    v_mfma_f32_16x16x32_bf16 v[32:35], v[144:147], v[120:123], v[32:35]
    ds_read_b64_tr_b16 v[106:107], v18 offset:4096
    v_mfma_f32_16x16x32_bf16 v[48:51], v[144:147], v[124:127], v[48:51]
    ds_read_b64_tr_b16 v[108:109], v19 offset:0
    v_mfma_f32_16x16x32_bf16 v[64:67], v[144:147], v[128:131], v[64:67]
    ds_read_b64_tr_b16 v[110:111], v19 offset:4096
    v_mfma_f32_16x16x32_bf16 v[80:83], v[144:147], v[132:135], v[80:83]
    ds_read_b64_tr_b16 v[112:113], v20 offset:0
    v_mfma_f32_16x16x32_bf16 v[84:87], v[148:151], v[132:135], v[84:87]
    ds_read_b64_tr_b16 v[114:115], v20 offset:4096
    v_mfma_f32_16x16x32_bf16 v[68:71], v[148:151], v[128:131], v[68:71]
    ds_read_b64_tr_b16 v[116:117], v21 offset:0
    v_mfma_f32_16x16x32_bf16 v[52:55], v[148:151], v[124:127], v[52:55]
    ds_read_b64_tr_b16 v[118:119], v21 offset:4096
    v_mfma_f32_16x16x32_bf16 v[36:39], v[148:151], v[120:123], v[36:39]
    s_waitcnt lgkmcnt(6)
    s_cbranch_scc1 mm_28
    s_cmp_eq_u32 s60, 1
    s_cbranch_scc1 G4_last
    v_mfma_f32_16x16x32_bf16 v[24:27], v[104:107], v[88:91], v[24:27]
    ds_read_b128 v[120:123], v17 offset:1024
    v_mfma_f32_16x16x32_bf16 v[40:43], v[104:107], v[92:95], v[40:43]
    ds_read_b128 v[124:127], v17 offset:3072
    v_mfma_f32_16x16x32_bf16 v[56:59], v[104:107], v[96:99], v[56:59]
    ds_read_b128 v[128:131], v17 offset:5120
    v_mfma_f32_16x16x32_bf16 v[72:75], v[104:107], v[100:103], v[72:75]
    ds_read_b128 v[132:135], v17 offset:7168
    s_waitcnt lgkmcnt(8)
    v_mfma_f32_16x16x32_bf16 v[76:79], v[108:111], v[100:103], v[76:79]
    ds_read_b64_tr_b16 v[136:137], v18 offset:8192
    v_mfma_f32_16x16x32_bf16 v[60:63], v[108:111], v[96:99], v[60:63]
    ds_read_b64_tr_b16 v[138:139], v18 offset:12288
    v_mfma_f32_16x16x32_bf16 v[44:47], v[108:111], v[92:95], v[44:47]
    ds_read_b64_tr_b16 v[140:141], v19 offset:8192
    v_mfma_f32_16x16x32_bf16 v[28:31], v[108:111], v[88:91], v[28:31]
    ds_read_b64_tr_b16 v[142:143], v19 offset:12288
    s_waitcnt lgkmcnt(8)
    v_mfma_f32_16x16x32_bf16 v[32:35], v[112:115], v[88:91], v[32:35]
    ds_read_b64_tr_b16 v[144:145], v20 offset:8192
    v_mfma_f32_16x16x32_bf16 v[48:51], v[112:115], v[92:95], v[48:51]
    ds_read_b64_tr_b16 v[146:147], v20 offset:12288
    v_mfma_f32_16x16x32_bf16 v[64:67], v[112:115], v[96:99], v[64:67]
    ds_read_b64_tr_b16 v[148:149], v21 offset:8192
    v_mfma_f32_16x16x32_bf16 v[80:83], v[112:115], v[100:103], v[80:83]
    ds_read_b64_tr_b16 v[150:151], v21 offset:12288
    v_mfma_f32_16x16x32_bf16 v[84:87], v[116:119], v[100:103], v[84:87]
    v_mfma_f32_16x16x32_bf16 v[68:71], v[116:119], v[96:99], v[68:71]
    v_mfma_f32_16x16x32_bf16 v[52:55], v[116:119], v[92:95], v[52:55]
    v_mfma_f32_16x16x32_bf16 v[36:39], v[116:119], v[88:91], v[36:39]
    s_waitcnt lgkmcnt(0)
    v_mfma_f32_16x16x32_bf16 v[24:27], v[136:139], v[120:123], v[24:27]
    s_mul_i32 s36, s31, 524288
    s_add_u32 s36, s36, 0
    s_add_u32 s16, s62, s36
    v_mfma_f32_16x16x32_bf16 v[40:43], v[136:139], v[124:127], v[40:43]
    s_addc_u32 s17, s63, 0
    s_mov_b32 s18, 516096
    s_mov_b32 s19, 0x20000
    v_mfma_f32_16x16x32_bf16 v[56:59], v[136:139], v[128:131], v[56:59]
    v_mfma_f32_16x16x32_bf16 v[72:75], v[136:139], v[132:135], v[72:75]
    v_mfma_f32_16x16x32_bf16 v[76:79], v[140:143], v[132:135], v[76:79]
    v_mfma_f32_16x16x32_bf16 v[60:63], v[140:143], v[128:131], v[60:63]
    v_mfma_f32_16x16x32_bf16 v[44:47], v[140:143], v[124:127], v[44:47]
    v_mfma_f32_16x16x32_bf16 v[28:31], v[140:143], v[120:123], v[28:31]
    v_mfma_f32_16x16x32_bf16 v[32:35], v[144:147], v[120:123], v[32:35]
    v_mfma_f32_16x16x32_bf16 v[48:51], v[144:147], v[124:127], v[48:51]
    v_mfma_f32_16x16x32_bf16 v[64:67], v[144:147], v[128:131], v[64:67]
    v_mfma_f32_16x16x32_bf16 v[80:83], v[144:147], v[132:135], v[80:83]
    v_mfma_f32_16x16x32_bf16 v[84:87], v[148:151], v[132:135], v[84:87]
    v_mfma_f32_16x16x32_bf16 v[68:71], v[148:151], v[128:131], v[68:71]
    v_mfma_f32_16x16x32_bf16 v[52:55], v[148:151], v[124:127], v[52:55]
    v_mfma_f32_16x16x32_bf16 v[36:39], v[148:151], v[120:123], v[36:39]
    s_add_u32 s36, s39, 0
    v_cvt_pk_bf16_f32 v24, v24, v25
    v_cvt_pk_bf16_f32 v25, v26, v27
    v_cvt_pk_bf16_f32 v26, v28, v29
    v_cvt_pk_bf16_f32 v27, v30, v31
    v_or_b32 v24, 1, v24
    buffer_store_dwordx4 v[24:27], v2, s[16:19], s36 offen offset:0 sc1
    v_cvt_pk_bf16_f32 v32, v32, v33
    v_cvt_pk_bf16_f32 v33, v34, v35
    v_cvt_pk_bf16_f32 v34, v36, v37
    v_cvt_pk_bf16_f32 v35, v38, v39
    v_or_b32 v32, 1, v32
    buffer_store_dwordx4 v[32:35], v2, s[16:19], s36 offen offset:1024 sc1
    s_add_u32 s36, s39, 65536
    v_cvt_pk_bf16_f32 v40, v40, v41
    v_cvt_pk_bf16_f32 v41, v42, v43
    v_cvt_pk_bf16_f32 v42, v44, v45
    v_cvt_pk_bf16_f32 v43, v46, v47
    v_or_b32 v40, 1, v40
    buffer_store_dwordx4 v[40:43], v2, s[16:19], s36 offen offset:0 sc1
    v_cvt_pk_bf16_f32 v48, v48, v49
    v_cvt_pk_bf16_f32 v49, v50, v51
    v_cvt_pk_bf16_f32 v50, v52, v53
    v_cvt_pk_bf16_f32 v51, v54, v55
    v_or_b32 v48, 1, v48
    buffer_store_dwordx4 v[48:51], v2, s[16:19], s36 offen offset:1024 sc1
    s_add_u32 s36, s39, 131072
    v_cvt_pk_bf16_f32 v56, v56, v57
    v_cvt_pk_bf16_f32 v57, v58, v59
    v_cvt_pk_bf16_f32 v58, v60, v61
    v_cvt_pk_bf16_f32 v59, v62, v63
    v_or_b32 v56, 1, v56
    buffer_store_dwordx4 v[56:59], v2, s[16:19], s36 offen offset:0 sc1
    v_cvt_pk_bf16_f32 v64, v64, v65
    v_cvt_pk_bf16_f32 v65, v66, v67
    v_cvt_pk_bf16_f32 v66, v68, v69
    v_cvt_pk_bf16_f32 v67, v70, v71
    v_or_b32 v64, 1, v64
    buffer_store_dwordx4 v[64:67], v2, s[16:19], s36 offen offset:1024 sc1
    s_add_u32 s36, s39, 196608
    v_cvt_pk_bf16_f32 v72, v72, v73
    v_cvt_pk_bf16_f32 v73, v74, v75
    v_cvt_pk_bf16_f32 v74, v76, v77
    v_cvt_pk_bf16_f32 v75, v78, v79
    v_or_b32 v72, 1, v72
    buffer_store_dwordx4 v[72:75], v2, s[16:19], s36 offen offset:0 sc1
    v_cvt_pk_bf16_f32 v80, v80, v81
    v_cvt_pk_bf16_f32 v81, v82, v83
    v_cvt_pk_bf16_f32 v82, v84, v85
    v_cvt_pk_bf16_f32 v83, v86, v87
    v_or_b32 v80, 1, v80
    buffer_store_dwordx4 v[80:83], v2, s[16:19], s36 offen offset:1024 sc1
    s_barrier
    s_branch NEXT
G4_last:
    v_mfma_f32_16x16x32_bf16 v[24:27], v[104:107], v[88:91], v[24:27]
    ds_read_b128 v[120:123], v17 offset:1024
    v_mfma_f32_16x16x32_bf16 v[40:43], v[104:107], v[92:95], v[40:43]
    ds_read_b128 v[124:127], v17 offset:3072
    v_mfma_f32_16x16x32_bf16 v[56:59], v[104:107], v[96:99], v[56:59]
    ds_read_b128 v[128:131], v17 offset:5120
    v_mfma_f32_16x16x32_bf16 v[72:75], v[104:107], v[100:103], v[72:75]
    ds_read_b128 v[132:135], v17 offset:7168
    s_waitcnt lgkmcnt(8)
    v_mfma_f32_16x16x32_bf16 v[76:79], v[108:111], v[100:103], v[76:79]
    ds_read_b64_tr_b16 v[136:137], v18 offset:8192
    v_mfma_f32_16x16x32_bf16 v[60:63], v[108:111], v[96:99], v[60:63]
    ds_read_b64_tr_b16 v[138:139], v18 offset:12288
    v_mfma_f32_16x16x32_bf16 v[44:47], v[108:111], v[92:95], v[44:47]
    ds_read_b64_tr_b16 v[140:141], v19 offset:8192
    v_mfma_f32_16x16x32_bf16 v[28:31], v[108:111], v[88:91], v[28:31]
    ds_read_b64_tr_b16 v[142:143], v19 offset:12288
    s_waitcnt lgkmcnt(8)
    v_mfma_f32_16x16x32_bf16 v[32:35], v[112:115], v[88:91], v[32:35]
    ds_read_b64_tr_b16 v[144:145], v20 offset:8192
    v_mfma_f32_16x16x32_bf16 v[48:51], v[112:115], v[92:95], v[48:51]
    ds_read_b64_tr_b16 v[146:147], v20 offset:12288
    s_load_dwordx2 s[6:7], s[0:1], 88
    v_mfma_f32_16x16x32_bf16 v[64:67], v[112:115], v[96:99], v[64:67]
    ds_read_b64_tr_b16 v[148:149], v21 offset:8192
    v_mfma_f32_16x16x32_bf16 v[80:83], v[112:115], v[100:103], v[80:83]
    ds_read_b64_tr_b16 v[150:151], v21 offset:12288
    v_mfma_f32_16x16x32_bf16 v[84:87], v[116:119], v[100:103], v[84:87]
    v_mfma_f32_16x16x32_bf16 v[68:71], v[116:119], v[96:99], v[68:71]
    v_mfma_f32_16x16x32_bf16 v[52:55], v[116:119], v[92:95], v[52:55]
    v_mfma_f32_16x16x32_bf16 v[36:39], v[116:119], v[88:91], v[36:39]
    s_waitcnt lgkmcnt(0)
    v_mfma_f32_16x16x32_bf16 v[24:27], v[136:139], v[120:123], v[24:27]
    s_add_u32 s16, s62, 0x80000
    s_addc_u32 s17, s63, 0
    s_mov_b32 s18, 0x7e000
    v_mfma_f32_16x16x32_bf16 v[40:43], v[136:139], v[124:127], v[40:43]
    s_mov_b32 s19, 0x20000
    s_mov_b32 s20, s6
    s_mov_b32 s21, s7
    v_mfma_f32_16x16x32_bf16 v[56:59], v[136:139], v[128:131], v[56:59]
    s_mov_b32 s22, 0x400000
    s_mov_b32 s23, 0x20000
    s_add_u32 s44, s40, 65536
    v_mfma_f32_16x16x32_bf16 v[72:75], v[136:139], v[132:135], v[72:75]
    s_lshl_b32 s46, s28, 3
    s_add_u32 s46, s46, s37
    s_lshl_b32 s47, s31, 1
    v_mfma_f32_16x16x32_bf16 v[76:79], v[140:143], v[132:135], v[76:79]
    s_add_u32 s46, s46, s47
    s_lshl_b32 s46, s46, 15
    s_lshl_b32 s47, s38, 5
    v_mfma_f32_16x16x32_bf16 v[60:63], v[140:143], v[128:131], v[60:63]
    s_add_u32 s46, s46, s47
    s_add_u32 s47, s46, 32768
    v_and_b32 v225, 1, v23
    v_mfma_f32_16x16x32_bf16 v[44:47], v[140:143], v[124:127], v[44:47]
    v_lshlrev_b32 v224, 11, v22
    v_lshl_add_u32 v224, v225, 5, v224
    v_mfma_f32_16x16x32_bf16 v[28:31], v[140:143], v[120:123], v[28:31]
    v_lshrrev_b32 v225, 1, v23
    v_lshl_add_u32 v224, v225, 4, v224
    v_mfma_f32_16x16x32_bf16 v[32:35], v[144:147], v[120:123], v[32:35]
    v_lshrrev_b32 v225, 3, v22
    v_mul_u32_u24 v225, 16320, v225
    v_mfma_f32_16x16x32_bf16 v[48:51], v[144:147], v[124:127], v[48:51]
    v_sub_u32 v224, v224, v225
    v_add_u32 v225, 16384, v224
    v_mfma_f32_16x16x32_bf16 v[64:67], v[144:147], v[128:131], v[64:67]
    v_mfma_f32_16x16x32_bf16 v[80:83], v[144:147], v[132:135], v[80:83]
    v_mfma_f32_16x16x32_bf16 v[84:87], v[148:151], v[132:135], v[84:87]
    v_mfma_f32_16x16x32_bf16 v[68:71], v[148:151], v[128:131], v[68:71]
    v_mfma_f32_16x16x32_bf16 v[52:55], v[148:151], v[124:127], v[52:55]
    v_mfma_f32_16x16x32_bf16 v[36:39], v[148:151], v[120:123], v[36:39]
    s_cmp_eq_u32 s31, 0
    s_cbranch_scc1 G4_k0
    s_add_u32 s36, s41, 0
    v_cvt_pk_bf16_f32 v24, v24, v25
    v_cvt_pk_bf16_f32 v25, v26, v27
    v_cvt_pk_bf16_f32 v26, v28, v29
    v_cvt_pk_bf16_f32 v27, v30, v31
    v_or_b32 v24, 1, v24
    buffer_store_dwordx4 v[24:27], v2, s[16:19], s36 offen offset:0 sc1
    v_cvt_pk_bf16_f32 v32, v32, v33
    v_cvt_pk_bf16_f32 v33, v34, v35
    v_cvt_pk_bf16_f32 v34, v36, v37
    v_cvt_pk_bf16_f32 v35, v38, v39
    v_or_b32 v32, 1, v32
    buffer_store_dwordx4 v[32:35], v2, s[16:19], s36 offen offset:1024 sc1
    s_add_u32 s36, s41, 65536
    v_cvt_pk_bf16_f32 v40, v40, v41
    v_cvt_pk_bf16_f32 v41, v42, v43
    v_cvt_pk_bf16_f32 v42, v44, v45
    v_cvt_pk_bf16_f32 v43, v46, v47
    v_or_b32 v40, 1, v40
    buffer_store_dwordx4 v[40:43], v2, s[16:19], s36 offen offset:0 sc1
    v_cvt_pk_bf16_f32 v48, v48, v49
    v_cvt_pk_bf16_f32 v49, v50, v51
    v_cvt_pk_bf16_f32 v50, v52, v53
    v_cvt_pk_bf16_f32 v51, v54, v55
    v_or_b32 v48, 1, v48
    buffer_store_dwordx4 v[48:51], v2, s[16:19], s36 offen offset:1024 sc1
    v_pk_mov_b32 v[24:25], v[56:57], v[56:57] op_sel:[0,1]
    v_pk_mov_b32 v[26:27], v[58:59], v[58:59] op_sel:[0,1]
    v_pk_mov_b32 v[28:29], v[60:61], v[60:61] op_sel:[0,1]
    v_pk_mov_b32 v[30:31], v[62:63], v[62:63] op_sel:[0,1]
    v_pk_mov_b32 v[32:33], v[64:65], v[64:65] op_sel:[0,1]
    v_pk_mov_b32 v[34:35], v[66:67], v[66:67] op_sel:[0,1]
    v_pk_mov_b32 v[36:37], v[68:69], v[68:69] op_sel:[0,1]
    v_pk_mov_b32 v[38:39], v[70:71], v[70:71] op_sel:[0,1]
    v_pk_mov_b32 v[40:41], v[72:73], v[72:73] op_sel:[0,1]
    v_pk_mov_b32 v[42:43], v[74:75], v[74:75] op_sel:[0,1]
    v_pk_mov_b32 v[44:45], v[76:77], v[76:77] op_sel:[0,1]
    v_pk_mov_b32 v[46:47], v[78:79], v[78:79] op_sel:[0,1]
    v_pk_mov_b32 v[48:49], v[80:81], v[80:81] op_sel:[0,1]
    v_pk_mov_b32 v[50:51], v[82:83], v[82:83] op_sel:[0,1]
    v_pk_mov_b32 v[52:53], v[84:85], v[84:85] op_sel:[0,1]
    v_pk_mov_b32 v[54:55], v[86:87], v[86:87] op_sel:[0,1]
    s_branch G4_k1
G4_k0:
    s_add_u32 s36, s41, 0
    v_cvt_pk_bf16_f32 v56, v56, v57
    v_cvt_pk_bf16_f32 v57, v58, v59
    v_cvt_pk_bf16_f32 v58, v60, v61
    v_cvt_pk_bf16_f32 v59, v62, v63
    v_or_b32 v56, 1, v56
    buffer_store_dwordx4 v[56:59], v2, s[16:19], s36 offen offset:0 sc1
    v_cvt_pk_bf16_f32 v64, v64, v65
    v_cvt_pk_bf16_f32 v65, v66, v67
    v_cvt_pk_bf16_f32 v66, v68, v69
    v_cvt_pk_bf16_f32 v67, v70, v71
    v_or_b32 v64, 1, v64
    buffer_store_dwordx4 v[64:67], v2, s[16:19], s36 offen offset:1024 sc1
    s_add_u32 s36, s41, 65536
    v_cvt_pk_bf16_f32 v72, v72, v73
    v_cvt_pk_bf16_f32 v73, v74, v75
    v_cvt_pk_bf16_f32 v74, v76, v77
    v_cvt_pk_bf16_f32 v75, v78, v79
    v_or_b32 v72, 1, v72
    buffer_store_dwordx4 v[72:75], v2, s[16:19], s36 offen offset:0 sc1
    v_cvt_pk_bf16_f32 v80, v80, v81
    v_cvt_pk_bf16_f32 v81, v82, v83
    v_cvt_pk_bf16_f32 v82, v84, v85
    v_cvt_pk_bf16_f32 v83, v86, v87
    v_or_b32 v80, 1, v80
    buffer_store_dwordx4 v[80:83], v2, s[16:19], s36 offen offset:1024 sc1
G4_k1:
    s_mov_b32 s78, 0x3f80
    s_mov_b32 s79, 0x3f800000
    v_dot2_f32_bf16 v24, v180, s78, v24
    v_dot2_f32_bf16 v25, v180, s79, v25
    v_dot2_f32_bf16 v26, v181, s78, v26
    v_dot2_f32_bf16 v27, v181, s79, v27
    v_dot2_f32_bf16 v28, v182, s78, v28
    v_dot2_f32_bf16 v29, v182, s79, v29
    v_dot2_f32_bf16 v30, v183, s78, v30
    v_dot2_f32_bf16 v31, v183, s79, v31
    v_dot2_f32_bf16 v32, v188, s78, v32
    v_dot2_f32_bf16 v33, v188, s79, v33
    v_dot2_f32_bf16 v34, v189, s78, v34
    v_dot2_f32_bf16 v35, v189, s79, v35
    v_dot2_f32_bf16 v36, v190, s78, v36
    v_dot2_f32_bf16 v37, v190, s79, v37
    v_dot2_f32_bf16 v38, v191, s78, v38
    v_dot2_f32_bf16 v39, v191, s79, v39
    v_dot2_f32_bf16 v40, v196, s78, v40
    v_dot2_f32_bf16 v41, v196, s79, v41
    v_dot2_f32_bf16 v42, v197, s78, v42
    v_dot2_f32_bf16 v43, v197, s79, v43
    v_dot2_f32_bf16 v44, v198, s78, v44
    v_dot2_f32_bf16 v45, v198, s79, v45
    v_dot2_f32_bf16 v46, v199, s78, v46
    v_dot2_f32_bf16 v47, v199, s79, v47
    v_dot2_f32_bf16 v48, v234, s78, v48
    v_dot2_f32_bf16 v49, v234, s79, v49
    v_dot2_f32_bf16 v50, v235, s78, v50
    v_dot2_f32_bf16 v51, v235, s79, v51
    v_dot2_f32_bf16 v52, v236, s78, v52
    v_dot2_f32_bf16 v53, v236, s79, v53
    v_dot2_f32_bf16 v54, v237, s78, v54
    v_dot2_f32_bf16 v55, v237, s79, v55
    v_dot2_f32_bf16 v24, v184, s78, v24
    v_dot2_f32_bf16 v25, v184, s79, v25
    v_dot2_f32_bf16 v26, v185, s78, v26
    v_dot2_f32_bf16 v27, v185, s79, v27
    v_dot2_f32_bf16 v28, v186, s78, v28
    v_dot2_f32_bf16 v29, v186, s79, v29
    v_dot2_f32_bf16 v30, v187, s78, v30
    v_dot2_f32_bf16 v31, v187, s79, v31
    v_dot2_f32_bf16 v32, v192, s78, v32
    v_dot2_f32_bf16 v33, v192, s79, v33
    v_dot2_f32_bf16 v34, v193, s78, v34
    v_dot2_f32_bf16 v35, v193, s79, v35
    v_dot2_f32_bf16 v36, v194, s78, v36
    v_dot2_f32_bf16 v37, v194, s79, v37
    v_dot2_f32_bf16 v38, v195, s78, v38
    v_dot2_f32_bf16 v39, v195, s79, v39
    v_dot2_f32_bf16 v40, v230, s78, v40
    v_dot2_f32_bf16 v41, v230, s79, v41
    v_dot2_f32_bf16 v42, v231, s78, v42
    v_dot2_f32_bf16 v43, v231, s79, v43
    v_dot2_f32_bf16 v44, v232, s78, v44
    v_dot2_f32_bf16 v45, v232, s79, v45
    v_dot2_f32_bf16 v46, v233, s78, v46
    v_dot2_f32_bf16 v47, v233, s79, v47
    v_dot2_f32_bf16 v48, v248, s78, v48
    v_dot2_f32_bf16 v49, v248, s79, v49
    v_dot2_f32_bf16 v50, v249, s78, v50
    v_dot2_f32_bf16 v51, v249, s79, v51
    v_dot2_f32_bf16 v52, v250, s78, v52
    v_dot2_f32_bf16 v53, v250, s79, v53
    v_dot2_f32_bf16 v54, v251, s78, v54
    v_dot2_f32_bf16 v55, v251, s79, v55
    s_mov_b32 s53, 0
dp_29:
    buffer_load_dwordx4 v[208:211], v2, s[16:19], s40 offen offset:0 sc1
    buffer_load_dwordx4 v[212:215], v2, s[16:19], s40 offen offset:1024 sc1
    buffer_load_dwordx4 v[216:219], v2, s[16:19], s44 offen offset:0 sc1
    buffer_load_dwordx4 v[220:223], v2, s[16:19], s44 offen offset:1024 sc1
    s_waitcnt vmcnt(0)
    v_bitop3_b32 v6, v208, v212, v216 bitop3:0x80
    v_bitop3_b32 v6, v6, v220, 1 bitop3:0x80
    v_cmp_eq_u32 vcc, 0, v6
    s_cbranch_vccz dq_30
    s_sleep 2
    s_add_u32 s53, s53, 1
    s_cmp_lt_u32 s53, s61
    s_cbranch_scc1 dp_29
    s_mov_b32 s61, 0
dq_30:
    v_dot2_f32_bf16 v24, v208, s78, v24
    v_dot2_f32_bf16 v25, v208, s79, v25
    v_dot2_f32_bf16 v26, v209, s78, v26
    v_dot2_f32_bf16 v27, v209, s79, v27
    v_dot2_f32_bf16 v28, v210, s78, v28
    v_dot2_f32_bf16 v29, v210, s79, v29
    v_dot2_f32_bf16 v30, v211, s78, v30
    v_dot2_f32_bf16 v31, v211, s79, v31
    v_cvt_pk_bf16_f32 v24, v24, v25
    v_cvt_pk_bf16_f32 v25, v26, v27
    v_cvt_pk_bf16_f32 v26, v28, v29
    v_cvt_pk_bf16_f32 v27, v30, v31
    s_nop 0
    v_permlane16_swap_b32 v24, v26
    v_permlane16_swap_b32 v25, v27
    v_dot2_f32_bf16 v32, v212, s78, v32
    v_dot2_f32_bf16 v33, v212, s79, v33
    v_dot2_f32_bf16 v34, v213, s78, v34
    v_dot2_f32_bf16 v35, v213, s79, v35
    v_dot2_f32_bf16 v36, v214, s78, v36
    v_dot2_f32_bf16 v37, v214, s79, v37
    v_dot2_f32_bf16 v38, v215, s78, v38
    v_dot2_f32_bf16 v39, v215, s79, v39
    v_cvt_pk_bf16_f32 v32, v32, v33
    v_cvt_pk_bf16_f32 v33, v34, v35
    v_cvt_pk_bf16_f32 v34, v36, v37
    v_cvt_pk_bf16_f32 v35, v38, v39
    s_nop 0
    v_permlane16_swap_b32 v32, v34
    v_permlane16_swap_b32 v33, v35
    v_mov_b32 v36, v24
    v_mov_b32 v37, v25
    v_mov_b32 v38, v26
    v_mov_b32 v39, v27
    v_mov_b32_dpp v24, v32 row_ror:8 row_mask:0xf bank_mask:0xc
    v_mov_b32_dpp v25, v33 row_ror:8 row_mask:0xf bank_mask:0xc
    v_mov_b32_dpp v26, v34 row_ror:8 row_mask:0xf bank_mask:0xc
    v_mov_b32_dpp v27, v35 row_ror:8 row_mask:0xf bank_mask:0xc
    v_mov_b32_dpp v32, v36 row_ror:8 row_mask:0xf bank_mask:0x3
    v_mov_b32_dpp v33, v37 row_ror:8 row_mask:0xf bank_mask:0x3
    v_mov_b32_dpp v34, v38 row_ror:8 row_mask:0xf bank_mask:0x3
    v_mov_b32_dpp v35, v39 row_ror:8 row_mask:0xf bank_mask:0x3
    buffer_store_dwordx4 v[24:27], v224, s[20:23], s46 offen sc1
    buffer_store_dwordx4 v[32:35], v225, s[20:23], s46 offen sc1
    v_dot2_f32_bf16 v40, v216, s78, v40
    v_dot2_f32_bf16 v41, v216, s79, v41
    v_dot2_f32_bf16 v42, v217, s78, v42
    v_dot2_f32_bf16 v43, v217, s79, v43
    v_dot2_f32_bf16 v44, v218, s78, v44
    v_dot2_f32_bf16 v45, v218, s79, v45
    v_dot2_f32_bf16 v46, v219, s78, v46
    v_dot2_f32_bf16 v47, v219, s79, v47
    v_cvt_pk_bf16_f32 v40, v40, v41
    v_cvt_pk_bf16_f32 v41, v42, v43
    v_cvt_pk_bf16_f32 v42, v44, v45
    v_cvt_pk_bf16_f32 v43, v46, v47
    s_nop 0
    v_permlane16_swap_b32 v40, v42
    v_permlane16_swap_b32 v41, v43
    v_dot2_f32_bf16 v48, v220, s78, v48
    v_dot2_f32_bf16 v49, v220, s79, v49
    v_dot2_f32_bf16 v50, v221, s78, v50
    v_dot2_f32_bf16 v51, v221, s79, v51
    v_dot2_f32_bf16 v52, v222, s78, v52
    v_dot2_f32_bf16 v53, v222, s79, v53
    v_dot2_f32_bf16 v54, v223, s78, v54
    v_dot2_f32_bf16 v55, v223, s79, v55
    v_cvt_pk_bf16_f32 v48, v48, v49
    v_cvt_pk_bf16_f32 v49, v50, v51
    v_cvt_pk_bf16_f32 v50, v52, v53
    v_cvt_pk_bf16_f32 v51, v54, v55
    s_nop 0
    v_permlane16_swap_b32 v48, v50
    v_permlane16_swap_b32 v49, v51
    v_mov_b32 v52, v40
    v_mov_b32 v53, v41
    v_mov_b32 v54, v42
    v_mov_b32 v55, v43
    v_mov_b32_dpp v40, v48 row_ror:8 row_mask:0xf bank_mask:0xc
    v_mov_b32_dpp v41, v49 row_ror:8 row_mask:0xf bank_mask:0xc
    v_mov_b32_dpp v42, v50 row_ror:8 row_mask:0xf bank_mask:0xc
    v_mov_b32_dpp v43, v51 row_ror:8 row_mask:0xf bank_mask:0xc
    v_mov_b32_dpp v48, v52 row_ror:8 row_mask:0xf bank_mask:0x3
    v_mov_b32_dpp v49, v53 row_ror:8 row_mask:0xf bank_mask:0x3
    v_mov_b32_dpp v50, v54 row_ror:8 row_mask:0xf bank_mask:0x3
    v_mov_b32_dpp v51, v55 row_ror:8 row_mask:0xf bank_mask:0x3
    buffer_store_dwordx4 v[40:43], v224, s[20:23], s47 offen sc1
    buffer_store_dwordx4 v[48:51], v225, s[20:23], s47 offen sc1
    s_branch K_fin
LOADERS:
    s_cmp_lg_u32 s60, 0
    s_cbranch_scc1 pr_31
    s_and_b32 s36, s29, 6
    s_cmp_eq_u32 s36, 2
    s_cbranch_scc0 pr_31
    s_call_b64 s[76:77], SUB_park2
pr_31:
    s_cmp_ge_u32 s30, 6
    s_cbranch_scc1 WLOAD
    s_add_u32 s54, s55, 0x500
    v_mov_b32 v222, s54
    s_lshl_b32 s53, s29, 7
    s_add_u32 s53, s53, 23121920
    v_mov_b32 v226, s53
    s_sleep 30
    s_mov_b64 exec, 1
    buffer_load_dword v227, v226, s[56:59], 0 offen sc1
    s_mov_b64 exec, -1
    s_waitcnt vmcnt(0)
    v_readfirstlane_b32 s53, v227
    s_add_u32 s54, s52, 16
    s_cmp_eq_u32 s53, s54
    s_cbranch_scc1 fok_32
    s_mov_b32 s53, 0
    s_add_u32 s54, s52, 16
    s_bfm_b64 exec, 1, 0
poll_33:
    buffer_load_dword v227, v226, s[56:59], 0 offen sc1
    s_waitcnt vmcnt(0)
    v_xor_b32 v227, s54, v227
    v_cmp_eq_u32 vcc, 0, v227
    s_nop 0
    s_cmp_eq_u64 vcc, exec
    s_cbranch_scc1 pok_34
    s_sleep 5
    s_add_u32 s53, s53, 1
    s_cmp_lt_u32 s53, s61
    s_cbranch_scc1 poll_33
    s_mov_b32 s61, 0
pok_34:
    s_mov_b64 exec, -1
fok_32:
    s_add_u32 s24, s4, 0x1400000
    s_addc_u32 s25, s5, 0
    s_mov_b32 s26, 0x20000
    s_mov_b32 s27, 0x20000
    s_cmp_eq_u32 s60, 0
    s_cselect_b32 s26, s26, 0
    s_and_b32 s36, s30, 1
    s_mul_i32 s36, s36, 128
    s_mul_i32 s37, s29, 256
    s_add_u32 s37, s36, s37
    v_lshrrev_b32 v224, 3, v1
    v_mul_u32_u24 v224, 4096, v224
    v_and_b32 v23, 112, v2
    v_add_u32 v224, v224, v23
    s_cmp_eq_u32 s60, 0
    s_cselect_b64 exec, -1, 0
    buffer_load_dwordx4 v[24:27], v224, s[24:27], s37 offen sc1
    s_add_u32 s37, s37, 32768
    buffer_load_dwordx4 v[28:31], v224, s[24:27], s37 offen sc1
    s_add_u32 s37, s37, 32768
    buffer_load_dwordx4 v[32:35], v224, s[24:27], s37 offen sc1
    s_add_u32 s37, s37, 32768
    buffer_load_dwordx4 v[36:39], v224, s[24:27], s37 offen sc1
    s_add_u32 s37, s37, 32768
    s_mov_b64 exec, -1
    s_mov_b64 exec, 1
    buffer_load_dword v223, v222, s[56:59], 0 offen sc1
    s_mov_b64 exec, -1
    s_waitcnt vmcnt(0)
    v_readfirstlane_b32 s53, v223
    s_add_u32 s54, s52, 16
    s_cmp_eq_u32 s53, s54
    s_cbranch_scc1 fok_35
    s_mov_b32 s53, 0
    s_add_u32 s54, s52, 16
    s_bfm_b64 exec, 1, 0
poll_36:
    buffer_load_dword v223, v222, s[56:59], 0 offen sc1
    s_waitcnt vmcnt(0)
    v_xor_b32 v223, s54, v223
    v_cmp_eq_u32 vcc, 0, v223
    s_nop 0
    s_cmp_eq_u64 vcc, exec
    s_cbranch_scc1 pok_37
    s_sleep 5
    s_add_u32 s53, s53, 1
    s_cmp_lt_u32 s53, s61
    s_cbranch_scc1 poll_36
    s_mov_b32 s61, 0
pok_37:
    s_mov_b64 exec, -1
fok_35:
    s_add_u32 s20, s62, 0x5d0000
    s_addc_u32 s21, s63, 0
    s_mov_b32 s22, 0x800
    s_mov_b32 s23, 0x20000
    s_and_b32 s35, s30, 1
    s_lshl_b32 s35, s35, 10
    buffer_load_dwordx4 v[16:19], v2, s[20:23], s35 offen sc1
    s_cmp_lg_u32 s60, 0
    s_cbranch_scc1 pc_38
    v_add_f32 v24, v24, v28
    v_add_f32 v25, v25, v29
    v_add_f32 v26, v26, v30
    v_add_f32 v27, v27, v31
    v_add_f32 v24, v24, v32
    v_add_f32 v25, v25, v33
    v_add_f32 v26, v26, v34
    v_add_f32 v27, v27, v35
    v_add_f32 v24, v24, v36
    v_add_f32 v25, v25, v37
    v_add_f32 v26, v26, v38
    v_add_f32 v27, v27, v39
    v_add_f32_dpp v24, v24, v24 row_ror:8 row_mask:0xf bank_mask:0xf
    v_add_f32_dpp v25, v25, v25 row_ror:8 row_mask:0xf bank_mask:0xf
    v_add_f32_dpp v26, v26, v26 row_ror:8 row_mask:0xf bank_mask:0xf
    v_add_f32_dpp v27, v27, v27 row_ror:8 row_mask:0xf bank_mask:0xf
    v_mov_b32 v28, v24
    v_mov_b32 v29, v25
    v_mov_b32 v30, v26
    v_mov_b32 v31, v27
    v_permlane16_swap_b32 v24, v28
    v_permlane16_swap_b32 v25, v29
    v_permlane16_swap_b32 v26, v30
    v_permlane16_swap_b32 v27, v31
    v_add_f32 v24, v24, v28
    v_add_f32 v25, v25, v29
    v_add_f32 v26, v26, v30
    v_add_f32 v27, v27, v31
    v_mov_b32 v28, v24
    v_mov_b32 v29, v25
    v_mov_b32 v30, v26
    v_mov_b32 v31, v27
    v_permlane32_swap_b32 v24, v28
    v_permlane32_swap_b32 v25, v29
    v_permlane32_swap_b32 v26, v30
    v_permlane32_swap_b32 v27, v31
    v_add_f32 v24, v24, v28
    v_add_f32 v25, v25, v29
    v_add_f32 v26, v26, v30
    v_add_f32 v27, v27, v31
pc_38:
    s_cmp_lg_u32 s60, 0
    s_cbranch_scc1 pc_39
    s_and_b32 s36, s30, 1
    s_mul_i32 s36, s36, 128
    s_add_u32 s36, s36, 163328
    v_add_u32 v23, s36, v2
    s_bfm_b64 exec, 8, 0
    ds_write_b128 v23, v[24:27]
    s_mov_b64 exec, -1
    s_waitcnt lgkmcnt(0)
pc_39:
    s_waitcnt vmcnt(0)
    s_and_b32 s36, s30, 1
    s_lshl_b32 s36, s36, 10
    s_add_u32 s36, s36, 160768
    v_add_u32 v221, s36, v2
    ds_write_b128 v221, v[16:19]
    s_waitcnt lgkmcnt(0)
    s_cmp_lg_u32 s30, 4
    s_cbranch_scc1 AL_nw
    s_cmp_eq_u32 s60, 0
    s_cbranch_scc1 AL_nw
    s_add_u32 s54, s55, 0xffc00300
    s_add_u32 s53, s54, s92
    v_mov_b32 v9, s53
    s_add_u32 s53, s53, 128
    v_writelane_b32 v9, s53, 1
    s_add_u32 s53, s54, s93
    v_writelane_b32 v9, s53, 2
    s_add_u32 s53, s53, 128
    v_writelane_b32 v9, s53, 3
    s_mov_b32 s53, 0
    s_add_u32 s54, s52, 8
    s_bfm_b64 exec, 4, 0
poll_41:
    buffer_load_dword v8, v9, s[56:59], 0 offen sc1
    s_waitcnt vmcnt(0)
    v_xor_b32 v8, s54, v8
    v_cmp_eq_u32 vcc, 0, v8
    s_nop 0
    s_cmp_eq_u64 vcc, exec
    s_cbranch_scc1 pok_42
    s_sleep 5
    s_add_u32 s53, s53, 1
    s_cmp_lt_u32 s53, s61
    s_cbranch_scc1 poll_41
    s_mov_b32 s61, 0
pok_42:
    s_mov_b64 exec, -1
AL_nw:
    s_and_b32 s36, s30, 1
    s_lshl_b32 s36, s36, 12
    s_add_u32 s36, s36, 32768
    v_add_u32 v6, s36, v2
    ds_read_b128 v[16:19], v6 offset:0
    ds_read_b128 v[20:23], v6 offset:1024
    ds_read_b128 v[24:27], v6 offset:2048
    ds_read_b128 v[28:31], v6 offset:3072
    ds_read_b128 v[32:35], v6 offset:8192
    ds_read_b128 v[36:39], v6 offset:9216
    ds_read_b128 v[40:43], v6 offset:10240
    ds_read_b128 v[44:47], v6 offset:11264
    s_waitcnt lgkmcnt(0)
    s_barrier
    s_call_b64 s[76:77], SUB_after_g1
    s_barrier
    s_waitcnt vmcnt(0)
    s_barrier
    s_call_b64 s[76:77], SUB_after_g2
    s_and_b32 s35, s30, 1
    s_add_u32 s12, s62, 0x80000
    s_addc_u32 s13, s63, 0
    s_mov_b32 s14, 0x7e000
    s_mov_b32 s15, 0x20000
    s_mul_i32 s38, s35, 262144
    s_lshl_b32 s41, s35, 13
    s_mov_b32 s42, 0
    s_mov_b32 s44, 0
    s_add_u32 s54, s55, 0x200
    v_mov_b32 v9, s54
    s_mov_b32 s44, 1
    s_mov_b32 s42, 16384
    s_add_u32 s54, s55, 0x580
    v_mov_b32 v222, s54
    v_lshlrev_b32 v221, 3, v1
    s_add_u32 s19, s41, s42
    v_readlane_b32 s16, v248, s44
    s_nop 0
    s_add_u32 s16, s16, s38
    s_add_u32 s44, s44, 1
    s_and_b32 s44, s44, 15
    s_add_u32 s42, s42, 16384
    s_cmp_eq_u32 s42, 49152
    s_cselect_b32 s42, 0, s42
    s_mov_b32 m0, s19
    s_mov_b32 s39, s16
    s_waitcnt vmcnt(63)
    s_barrier
    s_sleep 6
    s_mov_b32 s53, 0
    s_add_u32 s54, s52, 16
    s_bfm_b64 exec, 1, 0
poll_43:
    buffer_load_dword v8, v9, s[56:59], 0 offen sc1
    s_waitcnt vmcnt(0)
    v_xor_b32 v8, s54, v8
    v_cmp_eq_u32 vcc, 0, v8
    s_nop 0
    s_cmp_eq_u64 vcc, exec
    s_cbranch_scc1 pok_44
    s_sleep 5
    s_add_u32 s53, s53, 1
    s_cmp_lt_u32 s53, s61
    s_cbranch_scc1 poll_43
    s_mov_b32 s61, 0
pok_44:
    s_mov_b64 exec, -1
    buffer_load_dwordx4 v2, s[12:15], s39 offen sc1 lds
    buffer_load_dwordx4 v2, s[12:15], s39 offen offset:1024 sc1 lds
    s_add_u32 m0, m0, 2048
    s_add_u32 s39, s39, 65536
    buffer_load_dwordx4 v2, s[12:15], s39 offen sc1 lds
    buffer_load_dwordx4 v2, s[12:15], s39 offen offset:1024 sc1 lds
    s_add_u32 s19, s41, s42
    v_readlane_b32 s16, v248, s44
    s_nop 0
    s_add_u32 s16, s16, s38
    s_add_u32 s44, s44, 1
    s_and_b32 s44, s44, 15
    s_add_u32 s42, s42, 16384
    s_cmp_eq_u32 s42, 49152
    s_cselect_b32 s42, 0, s42
    s_add_u32 m0, m0, 2048
    s_add_u32 s39, s39, 65536
    buffer_load_dwordx4 v2, s[12:15], s39 offen sc1 lds
    buffer_load_dwordx4 v2, s[12:15], s39 offen offset:1024 sc1 lds
    s_add_u32 m0, m0, 2048
    s_add_u32 s39, s39, 65536
    buffer_load_dwordx4 v2, s[12:15], s39 offen sc1 lds
    buffer_load_dwordx4 v2, s[12:15], s39 offen offset:1024 sc1 lds
    s_mov_b32 m0, s19
    s_mov_b32 s39, s16
    buffer_load_dwordx4 v2, s[12:15], s39 offen sc1 lds
    buffer_load_dwordx4 v2, s[12:15], s39 offen offset:1024 sc1 lds
    s_add_u32 m0, m0, 2048
    s_add_u32 s39, s39, 65536
    buffer_load_dwordx4 v2, s[12:15], s39 offen sc1 lds
    buffer_load_dwordx4 v2, s[12:15], s39 offen offset:1024 sc1 lds
    s_add_u32 s19, s41, s42
    v_readlane_b32 s16, v248, s44
    s_nop 0
    s_add_u32 s16, s16, s38
    s_add_u32 s44, s44, 1
    s_and_b32 s44, s44, 15
    s_add_u32 s42, s42, 16384
    s_cmp_eq_u32 s42, 49152
    s_cselect_b32 s42, 0, s42
    s_add_u32 m0, m0, 2048
    s_add_u32 s39, s39, 65536
    buffer_load_dwordx4 v2, s[12:15], s39 offen sc1 lds
    buffer_load_dwordx4 v2, s[12:15], s39 offen offset:1024 sc1 lds
    s_add_u32 m0, m0, 2048
    s_add_u32 s39, s39, 65536
    buffer_load_dwordx4 v2, s[12:15], s39 offen sc1 lds
    buffer_load_dwordx4 v2, s[12:15], s39 offen offset:1024 sc1 lds
    s_mov_b32 m0, s19
    s_mov_b32 s39, s16
    s_waitcnt vmcnt(8)
    s_barrier
    buffer_load_dwordx4 v2, s[12:15], s39 offen sc1 lds
    buffer_load_dwordx4 v2, s[12:15], s39 offen offset:1024 sc1 lds
    s_add_u32 m0, m0, 2048
    s_add_u32 s39, s39, 65536
    buffer_load_dwordx4 v2, s[12:15], s39 offen sc1 lds
    buffer_load_dwordx4 v2, s[12:15], s39 offen offset:1024 sc1 lds
    s_add_u32 s19, s41, s42
    v_readlane_b32 s16, v248, s44
    s_nop 0
    s_add_u32 s16, s16, s38
    s_add_u32 s44, s44, 1
    s_and_b32 s44, s44, 15
    s_add_u32 s42, s42, 16384
    s_cmp_eq_u32 s42, 49152
    s_cselect_b32 s42, 0, s42
    s_add_u32 m0, m0, 2048
    s_add_u32 s39, s39, 65536
    buffer_load_dwordx4 v2, s[12:15], s39 offen sc1 lds
    buffer_load_dwordx4 v2, s[12:15], s39 offen offset:1024 sc1 lds
    s_add_u32 m0, m0, 2048
    s_add_u32 s39, s39, 65536
    buffer_load_dwordx4 v2, s[12:15], s39 offen sc1 lds
    buffer_load_dwordx4 v2, s[12:15], s39 offen offset:1024 sc1 lds
    s_mov_b32 m0, s19
    s_mov_b32 s39, s16
    s_add_u32 s24, s4, 0x1420000
    s_addc_u32 s25, s5, 0
    s_mov_b32 s26, 0x70000
    s_mov_b32 s27, 0x20000
    s_cmp_eq_u32 s60, 0
    s_cselect_b32 s26, s26, 0
    s_and_b32 s36, s30, 1
    s_mul_i32 s36, s36, 448
    s_mul_i32 s37, s29, 896
    s_add_u32 s37, s36, s37
    v_lshrrev_b32 v224, 5, v1
    v_mul_u32_u24 v224, 14336, v224
    v_and_b32 v179, 496, v2
    v_add_u32 v224, v224, v179
    s_cmp_eq_u32 s60, 0
    s_cselect_b64 exec, -1, 0
    buffer_load_dwordx4 v[180:183], v224, s[24:27], s37 offen sc1
    s_add_u32 s37, s37, 28672
    buffer_load_dwordx4 v[184:187], v224, s[24:27], s37 offen sc1
    s_add_u32 s37, s37, 28672
    buffer_load_dwordx4 v[188:191], v224, s[24:27], s37 offen sc1
    s_add_u32 s37, s37, 28672
    buffer_load_dwordx4 v[192:195], v224, s[24:27], s37 offen sc1
    s_add_u32 s37, s37, 28672
    buffer_load_dwordx4 v[196:199], v224, s[24:27], s37 offen sc1
    s_add_u32 s37, s37, 28672
    s_mov_b64 exec, -1
    s_waitcnt vmcnt(13)
    s_barrier
    buffer_load_dwordx4 v2, s[12:15], s39 offen sc1 lds
    buffer_load_dwordx4 v2, s[12:15], s39 offen offset:1024 sc1 lds
    s_add_u32 m0, m0, 2048
    s_add_u32 s39, s39, 65536
    buffer_load_dwordx4 v2, s[12:15], s39 offen sc1 lds
    buffer_load_dwordx4 v2, s[12:15], s39 offen offset:1024 sc1 lds
    s_add_u32 s19, s41, s42
    v_readlane_b32 s16, v248, s44
    s_nop 0
    s_add_u32 s16, s16, s38
    s_add_u32 s44, s44, 1
    s_and_b32 s44, s44, 15
    s_add_u32 s42, s42, 16384
    s_cmp_eq_u32 s42, 49152
    s_cselect_b32 s42, 0, s42
    s_add_u32 m0, m0, 2048
    s_add_u32 s39, s39, 65536
    buffer_load_dwordx4 v2, s[12:15], s39 offen sc1 lds
    buffer_load_dwordx4 v2, s[12:15], s39 offen offset:1024 sc1 lds
    s_add_u32 m0, m0, 2048
    s_add_u32 s39, s39, 65536
    buffer_load_dwordx4 v2, s[12:15], s39 offen sc1 lds
    buffer_load_dwordx4 v2, s[12:15], s39 offen offset:1024 sc1 lds
    s_mov_b32 m0, s19
    s_mov_b32 s39, s16
    s_cmp_eq_u32 s60, 0
    s_cselect_b64 exec, -1, 0
    buffer_load_dwordx4 v[200:203], v224, s[24:27], s37 offen sc1
    s_add_u32 s37, s37, 28672
    buffer_load_dwordx4 v[204:207], v224, s[24:27], s37 offen sc1
    s_add_u32 s37, s37, 28672
    buffer_load_dwordx4 v[208:211], v224, s[24:27], s37 offen sc1
    s_add_u32 s37, s37, 28672
    buffer_load_dwordx4 v[212:215], v224, s[24:27], s37 offen sc1
    s_add_u32 s37, s37, 28672
    s_mov_b64 exec, -1
    s_waitcnt vmcnt(17)
    s_barrier
    buffer_load_dwordx4 v2, s[12:15], s39 offen sc1 lds
    buffer_load_dwordx4 v2, s[12:15], s39 offen offset:1024 sc1 lds
    s_add_u32 m0, m0, 2048
    s_add_u32 s39, s39, 65536
    buffer_load_dwordx4 v2, s[12:15], s39 offen sc1 lds
    buffer_load_dwordx4 v2, s[12:15], s39 offen offset:1024 sc1 lds
    s_add_u32 s19, s41, s42
    v_readlane_b32 s16, v248, s44
    s_nop 0
    s_add_u32 s16, s16, s38
    s_add_u32 s44, s44, 1
    s_and_b32 s44, s44, 15
    s_add_u32 s42, s42, 16384
    s_cmp_eq_u32 s42, 49152
    s_cselect_b32 s42, 0, s42
    s_add_u32 m0, m0, 2048
    s_add_u32 s39, s39, 65536
    buffer_load_dwordx4 v2, s[12:15], s39 offen sc1 lds
    buffer_load_dwordx4 v2, s[12:15], s39 offen offset:1024 sc1 lds
    s_add_u32 m0, m0, 2048
    s_add_u32 s39, s39, 65536
    buffer_load_dwordx4 v2, s[12:15], s39 offen sc1 lds
    buffer_load_dwordx4 v2, s[12:15], s39 offen offset:1024 sc1 lds
    s_mov_b32 m0, s19
    s_mov_b32 s39, s16
    s_waitcnt vmcnt(12)
    s_barrier
    buffer_load_dwordx4 v2, s[12:15], s39 offen sc1 lds
    buffer_load_dwordx4 v2, s[12:15], s39 offen offset:1024 sc1 lds
    s_add_u32 m0, m0, 2048
    s_add_u32 s39, s39, 65536
    buffer_load_dwordx4 v2, s[12:15], s39 offen sc1 lds
    buffer_load_dwordx4 v2, s[12:15], s39 offen offset:1024 sc1 lds
    s_add_u32 s19, s41, s42
    v_readlane_b32 s16, v248, s44
    s_nop 0
    s_add_u32 s16, s16, s38
    s_add_u32 s44, s44, 1
    s_and_b32 s44, s44, 15
    s_add_u32 s42, s42, 16384
    s_cmp_eq_u32 s42, 49152
    s_cselect_b32 s42, 0, s42
    s_add_u32 m0, m0, 2048
    s_add_u32 s39, s39, 65536
    buffer_load_dwordx4 v2, s[12:15], s39 offen sc1 lds
    buffer_load_dwordx4 v2, s[12:15], s39 offen offset:1024 sc1 lds
    s_add_u32 m0, m0, 2048
    s_add_u32 s39, s39, 65536
    buffer_load_dwordx4 v2, s[12:15], s39 offen sc1 lds
    buffer_load_dwordx4 v2, s[12:15], s39 offen offset:1024 sc1 lds
    s_mov_b32 m0, s19
    s_mov_b32 s39, s16
    s_waitcnt vmcnt(16)
    s_cmp_lg_u32 s60, 0
    s_cbranch_scc1 pc_45
    v_add_f32 v180, v180, v184
    v_add_f32 v181, v181, v185
    v_add_f32 v182, v182, v186
    v_add_f32 v183, v183, v187
    v_add_f32 v180, v180, v188
    v_add_f32 v181, v181, v189
    v_add_f32 v182, v182, v190
    v_add_f32 v183, v183, v191
    v_add_f32 v180, v180, v192
    v_add_f32 v181, v181, v193
    v_add_f32 v182, v182, v194
    v_add_f32 v183, v183, v195
    v_add_f32 v180, v180, v196
    v_add_f32 v181, v181, v197
    v_add_f32 v182, v182, v198
    v_add_f32 v183, v183, v199
    v_add_f32 v180, v180, v200
    v_add_f32 v181, v181, v201
    v_add_f32 v182, v182, v202
    v_add_f32 v183, v183, v203
    v_add_f32 v180, v180, v204
    v_add_f32 v181, v181, v205
    v_add_f32 v182, v182, v206
    v_add_f32 v183, v183, v207
    v_add_f32 v180, v180, v208
    v_add_f32 v181, v181, v209
    v_add_f32 v182, v182, v210
    v_add_f32 v183, v183, v211
    v_add_f32 v180, v180, v212
    v_add_f32 v181, v181, v213
    v_add_f32 v182, v182, v214
    v_add_f32 v183, v183, v215
pc_45:
    s_cmp_eq_u32 s60, 0
    s_cselect_b64 exec, -1, 0
    buffer_load_dwordx4 v[184:187], v224, s[24:27], s37 offen sc1
    s_add_u32 s37, s37, 28672
    buffer_load_dwordx4 v[188:191], v224, s[24:27], s37 offen sc1
    s_add_u32 s37, s37, 28672
    buffer_load_dwordx4 v[192:195], v224, s[24:27], s37 offen sc1
    s_add_u32 s37, s37, 28672
    buffer_load_dwordx4 v[196:199], v224, s[24:27], s37 offen sc1
    s_add_u32 s37, s37, 28672
    buffer_load_dwordx4 v[200:203], v224, s[24:27], s37 offen sc1
    s_add_u32 s37, s37, 28672
    buffer_load_dwordx4 v[204:207], v224, s[24:27], s37 offen sc1
    s_add_u32 s37, s37, 28672
    buffer_load_dwordx4 v[208:211], v224, s[24:27], s37 offen sc1
    s_add_u32 s37, s37, 28672
    s_mov_b64 exec, -1
    s_waitcnt vmcnt(15)
    s_barrier
    buffer_load_dwordx4 v2, s[12:15], s39 offen sc1 lds
    buffer_load_dwordx4 v2, s[12:15], s39 offen offset:1024 sc1 lds
    s_add_u32 m0, m0, 2048
    s_add_u32 s39, s39, 65536
    buffer_load_dwordx4 v2, s[12:15], s39 offen sc1 lds
    buffer_load_dwordx4 v2, s[12:15], s39 offen offset:1024 sc1 lds
    s_add_u32 s19, s41, s42
    v_readlane_b32 s16, v248, s44
    s_nop 0
    s_add_u32 s16, s16, s38
    s_add_u32 s44, s44, 1
    s_and_b32 s44, s44, 15
    s_add_u32 s42, s42, 16384
    s_cmp_eq_u32 s42, 49152
    s_cselect_b32 s42, 0, s42
    s_add_u32 m0, m0, 2048
    s_add_u32 s39, s39, 65536
    buffer_load_dwordx4 v2, s[12:15], s39 offen sc1 lds
    buffer_load_dwordx4 v2, s[12:15], s39 offen offset:1024 sc1 lds
    s_add_u32 m0, m0, 2048
    s_add_u32 s39, s39, 65536
    buffer_load_dwordx4 v2, s[12:15], s39 offen sc1 lds
    buffer_load_dwordx4 v2, s[12:15], s39 offen offset:1024 sc1 lds
    s_mov_b32 m0, s19
    s_mov_b32 s39, s16
    s_mov_b64 exec, 1
    buffer_load_dword v223, v222, s[56:59], 0 offen sc1
    s_mov_b64 exec, -1
    s_waitcnt vmcnt(16)
    s_barrier
    buffer_load_dwordx4 v2, s[12:15], s39 offen sc1 lds
    buffer_load_dwordx4 v2, s[12:15], s39 offen offset:1024 sc1 lds
    s_add_u32 m0, m0, 2048
    s_add_u32 s39, s39, 65536
    buffer_load_dwordx4 v2, s[12:15], s39 offen sc1 lds
    buffer_load_dwordx4 v2, s[12:15], s39 offen offset:1024 sc1 lds
    s_add_u32 s19, s41, s42
    v_readlane_b32 s16, v248, s44
    s_nop 0
    s_add_u32 s16, s16, s38
    s_add_u32 s44, s44, 1
    s_and_b32 s44, s44, 15
    s_add_u32 s42, s42, 16384
    s_cmp_eq_u32 s42, 49152
    s_cselect_b32 s42, 0, s42
    s_add_u32 m0, m0, 2048
    s_add_u32 s39, s39, 65536
    buffer_load_dwordx4 v2, s[12:15], s39 offen sc1 lds
    buffer_load_dwordx4 v2, s[12:15], s39 offen offset:1024 sc1 lds
    s_add_u32 m0, m0, 2048
    s_add_u32 s39, s39, 65536
    buffer_load_dwordx4 v2, s[12:15], s39 offen sc1 lds
    buffer_load_dwordx4 v2, s[12:15], s39 offen offset:1024 sc1 lds
    s_mov_b32 m0, s19
    s_mov_b32 s39, s16
    s_waitcnt vmcnt(17)
    s_cmp_lg_u32 s60, 0
    s_cbranch_scc1 pc_46
    v_add_f32 v180, v180, v184
    v_add_f32 v181, v181, v185
    v_add_f32 v182, v182, v186
    v_add_f32 v183, v183, v187
    v_add_f32 v180, v180, v188
    v_add_f32 v181, v181, v189
    v_add_f32 v182, v182, v190
    v_add_f32 v183, v183, v191
    v_add_f32 v180, v180, v192
    v_add_f32 v181, v181, v193
    v_add_f32 v182, v182, v194
    v_add_f32 v183, v183, v195
    v_add_f32 v180, v180, v196
    v_add_f32 v181, v181, v197
    v_add_f32 v182, v182, v198
    v_add_f32 v183, v183, v199
    v_add_f32 v180, v180, v200
    v_add_f32 v181, v181, v201
    v_add_f32 v182, v182, v202
    v_add_f32 v183, v183, v203
    v_add_f32 v180, v180, v204
    v_add_f32 v181, v181, v205
    v_add_f32 v182, v182, v206
    v_add_f32 v183, v183, v207
    v_add_f32 v180, v180, v208
    v_add_f32 v181, v181, v209
    v_add_f32 v182, v182, v210
    v_add_f32 v183, v183, v211
pc_46:
    s_waitcnt vmcnt(9)
    s_barrier
    buffer_load_dwordx4 v2, s[12:15], s39 offen sc1 lds
    buffer_load_dwordx4 v2, s[12:15], s39 offen offset:1024 sc1 lds
    s_add_u32 m0, m0, 2048
    s_add_u32 s39, s39, 65536
    buffer_load_dwordx4 v2, s[12:15], s39 offen sc1 lds
    buffer_load_dwordx4 v2, s[12:15], s39 offen offset:1024 sc1 lds
    s_add_u32 s19, s41, s42
    v_readlane_b32 s16, v248, s44
    s_nop 0
    s_add_u32 s16, s16, s38
    s_add_u32 s44, s44, 1
    s_and_b32 s44, s44, 15
    s_add_u32 s42, s42, 16384
    s_cmp_eq_u32 s42, 49152
    s_cselect_b32 s42, 0, s42
    s_add_u32 m0, m0, 2048
    s_add_u32 s39, s39, 65536
    buffer_load_dwordx4 v2, s[12:15], s39 offen sc1 lds
    buffer_load_dwordx4 v2, s[12:15], s39 offen offset:1024 sc1 lds
    s_add_u32 m0, m0, 2048
    s_add_u32 s39, s39, 65536
    buffer_load_dwordx4 v2, s[12:15], s39 offen sc1 lds
    buffer_load_dwordx4 v2, s[12:15], s39 offen offset:1024 sc1 lds
    s_mov_b32 m0, s19
    s_mov_b32 s39, s16
    s_cmp_lg_u32 s60, 0
    s_cbranch_scc1 pc_47
    v_mov_b32 v184, v180
    v_mov_b32 v185, v181
    v_mov_b32 v186, v182
    v_mov_b32 v187, v183
    v_permlane32_swap_b32 v180, v184
    v_permlane32_swap_b32 v181, v185
    v_permlane32_swap_b32 v182, v186
    v_permlane32_swap_b32 v183, v187
    v_add_f32 v180, v180, v184
    v_add_f32 v181, v181, v185
    v_add_f32 v182, v182, v186
    v_add_f32 v183, v183, v187
    s_and_b32 s36, s30, 1
    s_mul_i32 s36, s36, 448
    s_add_u32 s36, s36, 159744
    v_add_u32 v179, s36, v2
    s_bfm_b64 exec, 28, 0
    ds_write_b128 v179, v[180:183]
    s_mov_b64 exec, -1
    s_waitcnt lgkmcnt(0)
pc_47:
    s_waitcnt vmcnt(16)
    v_readfirstlane_b32 s53, v223
    s_add_u32 s54, s52, 16
    s_cmp_eq_u32 s53, s54
    s_cbranch_scc1 fok_48
    s_mov_b32 s53, 0
    s_add_u32 s54, s52, 16
    s_bfm_b64 exec, 1, 0
poll_49:
    buffer_load_dword v223, v222, s[56:59], 0 offen sc1
    s_waitcnt vmcnt(0)
    v_xor_b32 v223, s54, v223
    v_cmp_eq_u32 vcc, 0, v223
    s_nop 0
    s_cmp_eq_u64 vcc, exec
    s_cbranch_scc1 pok_50
    s_sleep 5
    s_add_u32 s53, s53, 1
    s_cmp_lt_u32 s53, s61
    s_cbranch_scc1 poll_49
    s_mov_b32 s61, 0
pok_50:
    s_mov_b64 exec, -1
fok_48:
    s_add_u32 s20, s62, 0x5c8000
    s_addc_u32 s21, s63, 0
    s_mov_b32 s22, 0x6000
    s_mov_b32 s23, 0x20000
    s_and_b32 s35, s30, 1
    s_lshl_b32 s35, s35, 9
    s_add_u32 s36, s35, 0
    buffer_load_dwordx2 v[184:185], v221, s[20:23], s36 offen offset:0 sc1
    buffer_load_dwordx2 v[186:187], v221, s[20:23], s36 offen offset:1024 sc1
    buffer_load_dwordx2 v[188:189], v221, s[20:23], s36 offen offset:2048 sc1
    buffer_load_dwordx2 v[190:191], v221, s[20:23], s36 offen offset:3072 sc1
    s_waitcnt vmcnt(12)
    s_barrier
    buffer_load_dwordx4 v2, s[12:15], s39 offen sc1 lds
    buffer_load_dwordx4 v2, s[12:15], s39 offen offset:1024 sc1 lds
    s_add_u32 m0, m0, 2048
    s_add_u32 s39, s39, 65536
    buffer_load_dwordx4 v2, s[12:15], s39 offen sc1 lds
    buffer_load_dwordx4 v2, s[12:15], s39 offen offset:1024 sc1 lds
    s_add_u32 s19, s41, s42
    v_readlane_b32 s16, v248, s44
    s_nop 0
    s_add_u32 s16, s16, s38
    s_add_u32 s44, s44, 1
    s_and_b32 s44, s44, 15
    s_add_u32 s42, s42, 16384
    s_cmp_eq_u32 s42, 49152
    s_cselect_b32 s42, 0, s42
    s_add_u32 m0, m0, 2048
    s_add_u32 s39, s39, 65536
    buffer_load_dwordx4 v2, s[12:15], s39 offen sc1 lds
    buffer_load_dwordx4 v2, s[12:15], s39 offen offset:1024 sc1 lds
    s_add_u32 m0, m0, 2048
    s_add_u32 s39, s39, 65536
    buffer_load_dwordx4 v2, s[12:15], s39 offen sc1 lds
    buffer_load_dwordx4 v2, s[12:15], s39 offen offset:1024 sc1 lds
    s_mov_b32 m0, s19
    s_mov_b32 s39, s16
    s_add_u32 s36, s35, 4096
    buffer_load_dwordx2 v[192:193], v221, s[20:23], s36 offen offset:0 sc1
    buffer_load_dwordx2 v[194:195], v221, s[20:23], s36 offen offset:1024 sc1
    buffer_load_dwordx2 v[196:197], v221, s[20:23], s36 offen offset:2048 sc1
    buffer_load_dwordx2 v[198:199], v221, s[20:23], s36 offen offset:3072 sc1
    s_add_u32 s36, s35, 16384
    buffer_load_dwordx2 v[200:201], v221, s[20:23], s36 offen offset:0 sc1
    buffer_load_dwordx2 v[202:203], v221, s[20:23], s36 offen offset:1024 sc1
    s_waitcnt vmcnt(18)
    s_barrier
    buffer_load_dwordx4 v2, s[12:15], s39 offen sc1 lds
    buffer_load_dwordx4 v2, s[12:15], s39 offen offset:1024 sc1 lds
    s_add_u32 m0, m0, 2048
    s_add_u32 s39, s39, 65536
    buffer_load_dwordx4 v2, s[12:15], s39 offen sc1 lds
    buffer_load_dwordx4 v2, s[12:15], s39 offen offset:1024 sc1 lds
    s_add_u32 s19, s41, s42
    v_readlane_b32 s16, v248, s44
    s_nop 0
    s_add_u32 s16, s16, s38
    s_add_u32 s44, s44, 1
    s_and_b32 s44, s44, 15
    s_add_u32 s42, s42, 16384
    s_cmp_eq_u32 s42, 49152
    s_cselect_b32 s42, 0, s42
    s_add_u32 m0, m0, 2048
    s_add_u32 s39, s39, 65536
    buffer_load_dwordx4 v2, s[12:15], s39 offen sc1 lds
    buffer_load_dwordx4 v2, s[12:15], s39 offen offset:1024 sc1 lds
    s_add_u32 m0, m0, 2048
    s_add_u32 s39, s39, 65536
    buffer_load_dwordx4 v2, s[12:15], s39 offen sc1 lds
    buffer_load_dwordx4 v2, s[12:15], s39 offen offset:1024 sc1 lds
    s_mov_b32 m0, s19
    s_mov_b32 s39, s16
    s_add_u32 s36, s35, 16384
    buffer_load_dwordx2 v[204:205], v221, s[20:23], s36 offen offset:2048 sc1
    buffer_load_dwordx2 v[206:207], v221, s[20:23], s36 offen offset:3072 sc1
    s_add_u32 s36, s35, 20480
    buffer_load_dwordx2 v[208:209], v221, s[20:23], s36 offen offset:0 sc1
    buffer_load_dwordx2 v[210:211], v221, s[20:23], s36 offen offset:1024 sc1
    buffer_load_dwordx2 v[212:213], v221, s[20:23], s36 offen offset:2048 sc1
    buffer_load_dwordx2 v[214:215], v221, s[20:23], s36 offen offset:3072 sc1
    s_waitcnt vmcnt(20)
    s_barrier
    buffer_load_dwordx4 v2, s[12:15], s39 offen sc1 lds
    buffer_load_dwordx4 v2, s[12:15], s39 offen offset:1024 sc1 lds
    s_add_u32 m0, m0, 2048
    s_add_u32 s39, s39, 65536
    buffer_load_dwordx4 v2, s[12:15], s39 offen sc1 lds
    buffer_load_dwordx4 v2, s[12:15], s39 offen offset:1024 sc1 lds
    s_add_u32 s19, s41, s42
    v_readlane_b32 s16, v248, s44
    s_nop 0
    s_add_u32 s16, s16, s38
    s_add_u32 s44, s44, 1
    s_and_b32 s44, s44, 15
    s_add_u32 s42, s42, 16384
    s_cmp_eq_u32 s42, 49152
    s_cselect_b32 s42, 0, s42
    s_add_u32 m0, m0, 2048
    s_add_u32 s39, s39, 65536
    buffer_load_dwordx4 v2, s[12:15], s39 offen sc1 lds
    buffer_load_dwordx4 v2, s[12:15], s39 offen offset:1024 sc1 lds
    s_add_u32 m0, m0, 2048
    s_add_u32 s39, s39, 65536
    buffer_load_dwordx4 v2, s[12:15], s39 offen sc1 lds
    buffer_load_dwordx4 v2, s[12:15], s39 offen offset:1024 sc1 lds
    s_mov_b32 m0, s19
    s_mov_b32 s39, s16
    s_waitcnt vmcnt(14)
    s_barrier
    buffer_load_dwordx4 v2, s[12:15], s39 offen sc1 lds
    buffer_load_dwordx4 v2, s[12:15], s39 offen offset:1024 sc1 lds
    s_add_u32 m0, m0, 2048
    s_add_u32 s39, s39, 65536
    buffer_load_dwordx4 v2, s[12:15], s39 offen sc1 lds
    buffer_load_dwordx4 v2, s[12:15], s39 offen offset:1024 sc1 lds
    s_add_u32 s19, s41, s42
    v_readlane_b32 s16, v248, s44
    s_nop 0
    s_add_u32 s16, s16, s38
    s_add_u32 s44, s44, 1
    s_and_b32 s44, s44, 15
    s_add_u32 s42, s42, 16384
    s_cmp_eq_u32 s42, 49152
    s_cselect_b32 s42, 0, s42
    s_add_u32 m0, m0, 2048
    s_add_u32 s39, s39, 65536
    buffer_load_dwordx4 v2, s[12:15], s39 offen sc1 lds
    buffer_load_dwordx4 v2, s[12:15], s39 offen offset:1024 sc1 lds
    s_add_u32 m0, m0, 2048
    s_add_u32 s39, s39, 65536
    buffer_load_dwordx4 v2, s[12:15], s39 offen sc1 lds
    buffer_load_dwordx4 v2, s[12:15], s39 offen offset:1024 sc1 lds
    s_mov_b32 m0, s19
    s_mov_b32 s39, s16
    s_waitcnt vmcnt(16)
    v_add_f32 v184, v184, v200
    v_add_f32 v185, v185, v201
    v_add_f32 v186, v186, v202
    v_add_f32 v187, v187, v203
    v_add_f32 v188, v188, v204
    v_add_f32 v189, v189, v205
    v_add_f32 v190, v190, v206
    v_add_f32 v191, v191, v207
    v_add_f32 v192, v192, v208
    v_add_f32 v193, v193, v209
    v_add_f32 v194, v194, v210
    v_add_f32 v195, v195, v211
    v_add_f32 v196, v196, v212
    v_add_f32 v197, v197, v213
    v_add_f32 v198, v198, v214
    v_add_f32 v199, v199, v215
    s_waitcnt vmcnt(8)
    s_barrier
    buffer_load_dwordx4 v2, s[12:15], s39 offen sc1 lds
    buffer_load_dwordx4 v2, s[12:15], s39 offen offset:1024 sc1 lds
    s_add_u32 m0, m0, 2048
    s_add_u32 s39, s39, 65536
    buffer_load_dwordx4 v2, s[12:15], s39 offen sc1 lds
    buffer_load_dwordx4 v2, s[12:15], s39 offen offset:1024 sc1 lds
    s_add_u32 s19, s41, s42
    v_readlane_b32 s16, v248, s44
    s_nop 0
    s_add_u32 s16, s16, s38
    s_add_u32 s44, s44, 1
    s_and_b32 s44, s44, 15
    s_add_u32 s42, s42, 16384
    s_cmp_eq_u32 s42, 49152
    s_cselect_b32 s42, 0, s42
    s_add_u32 m0, m0, 2048
    s_add_u32 s39, s39, 65536
    buffer_load_dwordx4 v2, s[12:15], s39 offen sc1 lds
    buffer_load_dwordx4 v2, s[12:15], s39 offen offset:1024 sc1 lds
    s_add_u32 m0, m0, 2048
    s_add_u32 s39, s39, 65536
    buffer_load_dwordx4 v2, s[12:15], s39 offen sc1 lds
    buffer_load_dwordx4 v2, s[12:15], s39 offen offset:1024 sc1 lds
    s_mov_b32 m0, s19
    s_mov_b32 s39, s16
    v_add_f32 v184, v184, v192
    v_add_f32 v185, v185, v193
    v_add_f32 v186, v186, v194
    v_add_f32 v187, v187, v195
    v_add_f32 v188, v188, v196
    v_add_f32 v189, v189, v197
    v_add_f32 v190, v190, v198
    v_add_f32 v191, v191, v199
    v_add_f32 v184, v184, v188
    v_add_f32 v185, v185, v189
    v_add_f32 v186, v186, v190
    v_add_f32 v187, v187, v191
    v_add_f32 v184, v184, v186
    v_add_f32 v185, v185, v187
    v_mul_f32 v188, 0x3a800000, v184
    v_mul_f32 v217, 0x3a800000, v185
    s_waitcnt vmcnt(8)
    s_barrier
    buffer_load_dwordx4 v2, s[12:15], s39 offen sc1 lds
    buffer_load_dwordx4 v2, s[12:15], s39 offen offset:1024 sc1 lds
    s_add_u32 m0, m0, 2048
    s_add_u32 s39, s39, 65536
    buffer_load_dwordx4 v2, s[12:15], s39 offen sc1 lds
    buffer_load_dwordx4 v2, s[12:15], s39 offen offset:1024 sc1 lds
    s_add_u32 m0, m0, 2048
    s_add_u32 s39, s39, 65536
    buffer_load_dwordx4 v2, s[12:15], s39 offen sc1 lds
    buffer_load_dwordx4 v2, s[12:15], s39 offen offset:1024 sc1 lds
    s_add_u32 m0, m0, 2048
    s_add_u32 s39, s39, 65536
    buffer_load_dwordx4 v2, s[12:15], s39 offen sc1 lds
    buffer_load_dwordx4 v2, s[12:15], s39 offen offset:1024 sc1 lds
    v_fma_f32 v217, -v188, v188, v217
    v_max_f32 v217, 0, v217
    v_add_f32 v217, 0x3727c5ac, v217
    v_sqrt_f32 v217, v217
    s_nop 0
    v_mov_b32 v189, v217
    v_rcp_f32 v219, v217
    s_nop 0
    v_mul_f32 v190, 0xc0135761, v219
    v_mul_f32 v191, v219, v219
    v_mul_f32 v191, v191, v190
    v_mul_f32 v191, 0x3d372713, v191
    s_lshl_b32 s35, s35, 1
    s_add_u32 s35, s35, 160768
    v_add_u32 v220, s35, v2
    ds_write_b128 v220, v[188:191]
    s_waitcnt lgkmcnt(0)
    s_waitcnt vmcnt(8)
    s_barrier
    s_mov_b64 s[48:49], s[74:75]
    s_mov_b32 s50, 7340032
    s_mov_b32 s51, 0x20000
    s_lshl_b32 s45, s2, 1
    s_and_b32 s46, s30, 1
    s_add_u32 s45, s45, s46
    s_mul_i32 s45, s45, 14336
    s_cmp_eq_u32 s60, 0
    s_cselect_b64 exec, -1, 0
    s_add_u32 s46, s45, 0
    buffer_load_dwordx4 v[176:179], v2, s[48:51], s46 offen
    s_add_u32 s46, s45, 1024
    buffer_load_dwordx4 v[176:179], v2, s[48:51], s46 offen
    s_add_u32 s46, s45, 2048
    buffer_load_dwordx4 v[176:179], v2, s[48:51], s46 offen
    s_add_u32 s46, s45, 3072
    buffer_load_dwordx4 v[176:179], v2, s[48:51], s46 offen
    s_add_u32 s46, s45, 4096
    buffer_load_dwordx4 v[176:179], v2, s[48:51], s46 offen
    s_add_u32 s46, s45, 5120
    buffer_load_dwordx4 v[176:179], v2, s[48:51], s46 offen
    s_add_u32 s46, s45, 6144
    buffer_load_dwordx4 v[176:179], v2, s[48:51], s46 offen
    s_add_u32 s46, s45, 7168
    buffer_load_dwordx4 v[176:179], v2, s[48:51], s46 offen
    s_add_u32 s46, s45, 8192
    buffer_load_dwordx4 v[176:179], v2, s[48:51], s46 offen
    s_add_u32 s46, s45, 9216
    buffer_load_dwordx4 v[176:179], v2, s[48:51], s46 offen
    s_add_u32 s46, s45, 10240
    buffer_load_dwordx4 v[176:179], v2, s[48:51], s46 offen
    s_add_u32 s46, s45, 11264
    buffer_load_dwordx4 v[176:179], v2, s[48:51], s46 offen
    s_add_u32 s46, s45, 12288
    buffer_load_dwordx4 v[176:179], v2, s[48:51], s46 offen
    s_add_u32 s46, s45, 13312
    buffer_load_dwordx4 v[176:179], v2, s[48:51], s46 offen
    s_mov_b64 exec, -1
    s_waitcnt vmcnt(14)
    s_barrier
    s_barrier
    s_cmp_lg_u32 s60, 0
    s_cbranch_scc1 rp_54
    s_call_b64 s[76:77], SUB_r_pre
rp_54:
    s_and_b32 s35, s30, 1
    s_add_u32 s12, s62, 0x400000
    s_addc_u32 s13, s63, 0
    s_mov_b32 s14, 0x1be000
    s_mov_b32 s15, 0x20000
    s_mul_i32 s38, s35, 917504
    s_mul_i32 s36, s31, 114688
    s_add_u32 s38, s38, s36
    s_lshl_b32 s41, s35, 13
    s_mov_b32 s42, 0
    s_mov_b32 s44, 0
    s_add_u32 s54, s55, 0x700
    s_lshl_b32 s53, s31, 7
    s_add_u32 s54, s54, s53
    v_mov_b32 v9, s54
    s_add_u32 s54, s55, 0x600
    s_lshl_b32 s53, s31, 7
    s_add_u32 s54, s54, s53
    v_mov_b32 v10, s54
    s_add_u32 s54, s55, 0x300
    s_lshl_b32 s53, s31, 7
    s_add_u32 s54, s54, s53
    v_mov_b32 v12, s54
    v_mov_b32 v13, 1
    s_and_b32 s51, s30, 1
    s_lshl_b32 s51, s51, 30
    s_lshl_b32 s54, s60, 2
    s_add_u32 s54, s54, 4
    v_mov_b32 v14, 162880
spin_55:
    s_sleep 2
    ds_read_b32 v15, v14
    s_waitcnt lgkmcnt(0)
    v_readfirstlane_b32 s53, v15
    s_nop 0
    s_cmp_ge_u32 s53, s54
    s_cbranch_scc0 spin_55
    s_mov_b64 exec, 1
    buffer_atomic_add v13, v9, s[56:59], s51 offen sc1
    s_mov_b64 exec, -1
    v_xor_b32 v15, 128, v12
    s_mov_b32 s44, 3
    s_call_b64 s[76:77], PREP_a_issue_4
    s_mov_b32 m0, s19
    s_mov_b32 s39, s16
    s_mov_b32 s40, s17
    s_waitcnt vmcnt(16)
    s_barrier
    s_mov_b64 exec, 1
    buffer_load_dword v8, v9, s[56:59], 0 offen sc1
    s_mov_b64 exec, -1
    s_waitcnt vmcnt(9)
    s_barrier
    s_waitcnt vmcnt(0)
    v_readfirstlane_b32 s53, v8
    s_add_u32 s54, s52, 8
    s_cmp_eq_u32 s53, s54
    s_cbranch_scc1 fok_56
    s_mov_b32 s53, 0
    s_add_u32 s54, s52, 8
    s_bfm_b64 exec, 1, 0
poll_57:
    buffer_load_dword v8, v9, s[56:59], 0 offen sc1
    s_waitcnt vmcnt(0)
    v_xor_b32 v8, s54, v8
    v_cmp_eq_u32 vcc, 0, v8
    s_nop 0
    s_cmp_eq_u64 vcc, exec
    s_cbranch_scc1 pok_58
    s_sleep 5
    s_add_u32 s53, s53, 1
    s_cmp_lt_u32 s53, s61
    s_cbranch_scc1 poll_57
    s_mov_b32 s61, 0
pok_58:
    s_mov_b64 exec, -1
fok_56:
    buffer_load_dwordx4 v2, s[12:15], s39 offen sc1 lds
    s_add_u32 m0, m0, 1024
    s_nop 0
    buffer_load_dwordx4 v2, s[12:15], s40 offen sc1 lds
    s_add_u32 m0, m0, 1024
    s_add_u32 s39, s39, 229376
    buffer_load_dwordx4 v2, s[12:15], s39 offen sc1 lds
    s_add_u32 m0, m0, 1024
    s_add_u32 s40, s40, 229376
    buffer_load_dwordx4 v2, s[12:15], s40 offen sc1 lds
    s_call_b64 s[76:77], PREP_a_issue_4
    s_add_u32 m0, m0, 1024
    s_add_u32 s39, s39, 229376
    buffer_load_dwordx4 v2, s[12:15], s39 offen sc1 lds
    s_add_u32 m0, m0, 1024
    s_add_u32 s40, s40, 229376
    buffer_load_dwordx4 v2, s[12:15], s40 offen sc1 lds
    s_add_u32 m0, m0, 1024
    s_add_u32 s39, s39, 229376
    buffer_load_dwordx4 v2, s[12:15], s39 offen sc1 lds
    s_add_u32 m0, m0, 1024
    s_add_u32 s40, s40, 229376
    buffer_load_dwordx4 v2, s[12:15], s40 offen sc1 lds
    s_mov_b32 m0, s19
    s_mov_b32 s39, s16
    s_mov_b32 s40, s17
    s_waitcnt vmcnt(9)
    s_barrier
    s_mov_b64 exec, 1
    buffer_atomic_add v13, v10, s[56:59], s51 offen sc1
    s_mov_b64 exec, -1
    buffer_load_dwordx4 v2, s[12:15], s39 offen sc1 lds
    s_add_u32 m0, m0, 1024
    s_nop 0
    buffer_load_dwordx4 v2, s[12:15], s40 offen sc1 lds
    s_add_u32 m0, m0, 1024
    s_add_u32 s39, s39, 229376
    buffer_load_dwordx4 v2, s[12:15], s39 offen sc1 lds
    s_add_u32 m0, m0, 1024
    s_add_u32 s40, s40, 229376
    buffer_load_dwordx4 v2, s[12:15], s40 offen sc1 lds
    s_call_b64 s[76:77], PREP_a_issue_4
    s_add_u32 m0, m0, 1024
    s_add_u32 s39, s39, 229376
    buffer_load_dwordx4 v2, s[12:15], s39 offen sc1 lds
    s_add_u32 m0, m0, 1024
    s_add_u32 s40, s40, 229376
    buffer_load_dwordx4 v2, s[12:15], s40 offen sc1 lds
    s_add_u32 m0, m0, 1024
    s_add_u32 s39, s39, 229376
    buffer_load_dwordx4 v2, s[12:15], s39 offen sc1 lds
    s_add_u32 m0, m0, 1024
    s_add_u32 s40, s40, 229376
    buffer_load_dwordx4 v2, s[12:15], s40 offen sc1 lds
    s_mov_b32 m0, s19
    s_mov_b32 s39, s16
    s_mov_b32 s40, s17
    s_waitcnt vmcnt(9)
    s_barrier
    buffer_load_dwordx4 v2, s[12:15], s39 offen sc1 lds
    s_add_u32 m0, m0, 1024
    s_nop 0
    buffer_load_dwordx4 v2, s[12:15], s40 offen sc1 lds
    s_add_u32 m0, m0, 1024
    s_add_u32 s39, s39, 229376
    buffer_load_dwordx4 v2, s[12:15], s39 offen sc1 lds
    s_add_u32 m0, m0, 1024
    s_add_u32 s40, s40, 229376
    buffer_load_dwordx4 v2, s[12:15], s40 offen sc1 lds
    s_call_b64 s[76:77], PREP_a_issue_4
    s_add_u32 m0, m0, 1024
    s_add_u32 s39, s39, 229376
    buffer_load_dwordx4 v2, s[12:15], s39 offen sc1 lds
    s_add_u32 m0, m0, 1024
    s_add_u32 s40, s40, 229376
    buffer_load_dwordx4 v2, s[12:15], s40 offen sc1 lds
    s_add_u32 m0, m0, 1024
    s_add_u32 s39, s39, 229376
    buffer_load_dwordx4 v2, s[12:15], s39 offen sc1 lds
    s_add_u32 m0, m0, 1024
    s_add_u32 s40, s40, 229376
    buffer_load_dwordx4 v2, s[12:15], s40 offen sc1 lds
    s_mov_b32 m0, s19
    s_mov_b32 s39, s16
    s_mov_b32 s40, s17
    s_waitcnt vmcnt(8)
    s_barrier
    buffer_load_dwordx4 v2, s[12:15], s39 offen sc1 lds
    s_add_u32 m0, m0, 1024
    s_nop 0
    buffer_load_dwordx4 v2, s[12:15], s40 offen sc1 lds
    s_add_u32 m0, m0, 1024
    s_add_u32 s39, s39, 229376
    buffer_load_dwordx4 v2, s[12:15], s39 offen sc1 lds
    s_add_u32 m0, m0, 1024
    s_add_u32 s40, s40, 229376
    buffer_load_dwordx4 v2, s[12:15], s40 offen sc1 lds
    s_mov_b64 exec, 1
    buffer_load_dword v11, v10, s[56:59], 0 offen sc1
    s_mov_b64 exec, -1
    s_call_b64 s[76:77], PREP_a_issue_4
    s_add_u32 m0, m0, 1024
    s_add_u32 s39, s39, 229376
    buffer_load_dwordx4 v2, s[12:15], s39 offen sc1 lds
    s_add_u32 m0, m0, 1024
    s_add_u32 s40, s40, 229376
    buffer_load_dwordx4 v2, s[12:15], s40 offen sc1 lds
    s_add_u32 m0, m0, 1024
    s_add_u32 s39, s39, 229376
    buffer_load_dwordx4 v2, s[12:15], s39 offen sc1 lds
    s_add_u32 m0, m0, 1024
    s_add_u32 s40, s40, 229376
    buffer_load_dwordx4 v2, s[12:15], s40 offen sc1 lds
    s_mov_b32 m0, s19
    s_mov_b32 s39, s16
    s_mov_b32 s40, s17
    s_waitcnt vmcnt(9)
    s_barrier
    s_mov_b64 exec, 1
    buffer_atomic_add v13, v12, s[56:59], s51 offen sc1
    s_mov_b64 exec, -1
    buffer_load_dwordx4 v2, s[12:15], s39 offen sc1 lds
    s_add_u32 m0, m0, 1024
    s_nop 0
    buffer_load_dwordx4 v2, s[12:15], s40 offen sc1 lds
    s_add_u32 m0, m0, 1024
    s_add_u32 s39, s39, 229376
    buffer_load_dwordx4 v2, s[12:15], s39 offen sc1 lds
    s_add_u32 m0, m0, 1024
    s_add_u32 s40, s40, 229376
    buffer_load_dwordx4 v2, s[12:15], s40 offen sc1 lds
    s_call_b64 s[76:77], PREP_a_issue_4
    s_add_u32 m0, m0, 1024
    s_add_u32 s39, s39, 229376
    buffer_load_dwordx4 v2, s[12:15], s39 offen sc1 lds
    s_add_u32 m0, m0, 1024
    s_add_u32 s40, s40, 229376
    buffer_load_dwordx4 v2, s[12:15], s40 offen sc1 lds
    s_add_u32 m0, m0, 1024
    s_add_u32 s39, s39, 229376
    buffer_load_dwordx4 v2, s[12:15], s39 offen sc1 lds
    s_add_u32 m0, m0, 1024
    s_add_u32 s40, s40, 229376
    buffer_load_dwordx4 v2, s[12:15], s40 offen sc1 lds
    s_mov_b32 m0, s19
    s_mov_b32 s39, s16
    s_mov_b32 s40, s17
    s_waitcnt vmcnt(9)
    s_barrier
    buffer_load_dwordx4 v2, s[12:15], s39 offen sc1 lds
    s_add_u32 m0, m0, 1024
    s_nop 0
    buffer_load_dwordx4 v2, s[12:15], s40 offen sc1 lds
    s_add_u32 m0, m0, 1024
    s_add_u32 s39, s39, 229376
    buffer_load_dwordx4 v2, s[12:15], s39 offen sc1 lds
    s_add_u32 m0, m0, 1024
    s_add_u32 s40, s40, 229376
    buffer_load_dwordx4 v2, s[12:15], s40 offen sc1 lds
    s_waitcnt vmcnt(17)
    v_readfirstlane_b32 s53, v11
    s_add_u32 s54, s52, 8
    s_cmp_eq_u32 s53, s54
    s_cbranch_scc1 fok_59
    s_mov_b32 s53, 0
    s_add_u32 s54, s52, 8
    s_bfm_b64 exec, 1, 0
poll_60:
    buffer_load_dword v11, v10, s[56:59], 0 offen sc1
    s_waitcnt vmcnt(0)
    v_xor_b32 v11, s54, v11
    v_cmp_eq_u32 vcc, 0, v11
    s_nop 0
    s_cmp_eq_u64 vcc, exec
    s_cbranch_scc1 pok_61
    s_sleep 5
    s_add_u32 s53, s53, 1
    s_cmp_lt_u32 s53, s61
    s_cbranch_scc1 poll_60
    s_mov_b32 s61, 0
pok_61:
    s_mov_b64 exec, -1
fok_59:
    s_call_b64 s[76:77], PREP_a_issue_4
    s_add_u32 m0, m0, 1024
    s_add_u32 s39, s39, 229376
    buffer_load_dwordx4 v2, s[12:15], s39 offen sc1 lds
    s_add_u32 m0, m0, 1024
    s_add_u32 s40, s40, 229376
    buffer_load_dwordx4 v2, s[12:15], s40 offen sc1 lds
    s_add_u32 m0, m0, 1024
    s_add_u32 s39, s39, 229376
    buffer_load_dwordx4 v2, s[12:15], s39 offen sc1 lds
    s_add_u32 m0, m0, 1024
    s_add_u32 s40, s40, 229376
    buffer_load_dwordx4 v2, s[12:15], s40 offen sc1 lds
    s_mov_b32 m0, s19
    s_mov_b32 s39, s16
    s_mov_b32 s40, s17
    s_waitcnt vmcnt(8)
    s_barrier
    buffer_load_dwordx4 v2, s[12:15], s39 offen sc1 lds
    s_add_u32 m0, m0, 1024
    s_nop 0
    buffer_load_dwordx4 v2, s[12:15], s40 offen sc1 lds
    s_add_u32 m0, m0, 1024
    s_add_u32 s39, s39, 229376
    buffer_load_dwordx4 v2, s[12:15], s39 offen sc1 lds
    s_add_u32 m0, m0, 1024
    s_add_u32 s40, s40, 229376
    buffer_load_dwordx4 v2, s[12:15], s40 offen sc1 lds
    s_mov_b32 s43, 1
ld_62:
    s_add_u32 s19, s41, s42
    v_readlane_b32 s16, v249, s44
    v_readlane_b32 s17, v250, s44
    s_add_u32 s16, s16, s38
    s_add_u32 s17, s17, s38
    s_add_u32 s44, s44, 1
    s_add_u32 s42, s42, 16384
    s_cmp_eq_u32 s42, 49152
    s_cselect_b32 s42, 0, s42
    s_add_u32 m0, m0, 1024
    s_add_u32 s39, s39, 229376
    buffer_load_dwordx4 v2, s[12:15], s39 offen sc1 lds
    s_add_u32 m0, m0, 1024
    s_add_u32 s40, s40, 229376
    buffer_load_dwordx4 v2, s[12:15], s40 offen sc1 lds
    s_add_u32 m0, m0, 1024
    s_add_u32 s39, s39, 229376
    buffer_load_dwordx4 v2, s[12:15], s39 offen sc1 lds
    s_add_u32 m0, m0, 1024
    s_add_u32 s40, s40, 229376
    buffer_load_dwordx4 v2, s[12:15], s40 offen sc1 lds
    s_mov_b32 m0, s19
    s_mov_b32 s39, s16
    s_mov_b32 s40, s17
    s_waitcnt vmcnt(8)
    s_barrier
    buffer_load_dwordx4 v2, s[12:15], s39 offen sc1 lds
    s_add_u32 m0, m0, 1024
    s_nop 0
    buffer_load_dwordx4 v2, s[12:15], s40 offen sc1 lds
    s_add_u32 m0, m0, 1024
    s_add_u32 s39, s39, 229376
    buffer_load_dwordx4 v2, s[12:15], s39 offen sc1 lds
    s_add_u32 m0, m0, 1024
    s_add_u32 s40, s40, 229376
    buffer_load_dwordx4 v2, s[12:15], s40 offen sc1 lds
    s_add_u32 s43, s43, 1
    s_cmp_lt_u32 s43, 4
    s_cbranch_scc1 ld_62
    s_call_b64 s[76:77], PREP_a_issue_4
    s_add_u32 m0, m0, 1024
    s_add_u32 s39, s39, 229376
    buffer_load_dwordx4 v2, s[12:15], s39 offen sc1 lds
    s_add_u32 m0, m0, 1024
    s_add_u32 s40, s40, 229376
    buffer_load_dwordx4 v2, s[12:15], s40 offen sc1 lds
    s_add_u32 m0, m0, 1024
    s_add_u32 s39, s39, 229376
    buffer_load_dwordx4 v2, s[12:15], s39 offen sc1 lds
    s_add_u32 m0, m0, 1024
    s_add_u32 s40, s40, 229376
    buffer_load_dwordx4 v2, s[12:15], s40 offen sc1 lds
    s_mov_b32 m0, s19
    s_mov_b32 s39, s16
    s_mov_b32 s40, s17
    s_waitcnt vmcnt(8)
    s_barrier
    buffer_load_dwordx4 v2, s[12:15], s39 offen sc1 lds
    s_add_u32 m0, m0, 1024
    s_nop 0
    buffer_load_dwordx4 v2, s[12:15], s40 offen sc1 lds
    s_add_u32 m0, m0, 1024
    s_add_u32 s39, s39, 229376
    buffer_load_dwordx4 v2, s[12:15], s39 offen sc1 lds
    s_add_u32 m0, m0, 1024
    s_add_u32 s40, s40, 229376
    buffer_load_dwordx4 v2, s[12:15], s40 offen sc1 lds
    s_mov_b64 exec, 1
    buffer_load_dword v11, v12, s[56:59], 0 offen sc1
    s_mov_b64 exec, -1
    s_call_b64 s[76:77], PREP_a_issue_4
    s_add_u32 m0, m0, 1024
    s_add_u32 s39, s39, 229376
    buffer_load_dwordx4 v2, s[12:15], s39 offen sc1 lds
    s_add_u32 m0, m0, 1024
    s_add_u32 s40, s40, 229376
    buffer_load_dwordx4 v2, s[12:15], s40 offen sc1 lds
    s_add_u32 m0, m0, 1024
    s_add_u32 s39, s39, 229376
    buffer_load_dwordx4 v2, s[12:15], s39 offen sc1 lds
    s_add_u32 m0, m0, 1024
    s_add_u32 s40, s40, 229376
    buffer_load_dwordx4 v2, s[12:15], s40 offen sc1 lds
    s_mov_b32 m0, s19
    s_mov_b32 s39, s16
    s_mov_b32 s40, s17
    s_waitcnt vmcnt(9)
    s_barrier
    buffer_load_dwordx4 v2, s[12:15], s39 offen sc1 lds
    s_add_u32 m0, m0, 1024
    s_nop 0
    buffer_load_dwordx4 v2, s[12:15], s40 offen sc1 lds
    s_add_u32 m0, m0, 1024
    s_add_u32 s39, s39, 229376
    buffer_load_dwordx4 v2, s[12:15], s39 offen sc1 lds
    s_add_u32 m0, m0, 1024
    s_add_u32 s40, s40, 229376
    buffer_load_dwordx4 v2, s[12:15], s40 offen sc1 lds
    s_call_b64 s[76:77], PREP_a_issue_4
    s_add_u32 m0, m0, 1024
    s_add_u32 s39, s39, 229376
    buffer_load_dwordx4 v2, s[12:15], s39 offen sc1 lds
    s_add_u32 m0, m0, 1024
    s_add_u32 s40, s40, 229376
    buffer_load_dwordx4 v2, s[12:15], s40 offen sc1 lds
    s_add_u32 m0, m0, 1024
    s_add_u32 s39, s39, 229376
    buffer_load_dwordx4 v2, s[12:15], s39 offen sc1 lds
    s_add_u32 m0, m0, 1024
    s_add_u32 s40, s40, 229376
    buffer_load_dwordx4 v2, s[12:15], s40 offen sc1 lds
    s_mov_b32 m0, s19
    s_mov_b32 s39, s16
    s_mov_b32 s40, s17
    s_waitcnt vmcnt(8)
    s_barrier
    buffer_load_dwordx4 v2, s[12:15], s39 offen sc1 lds
    s_add_u32 m0, m0, 1024
    s_nop 0
    buffer_load_dwordx4 v2, s[12:15], s40 offen sc1 lds
    s_add_u32 m0, m0, 1024
    s_add_u32 s39, s39, 229376
    buffer_load_dwordx4 v2, s[12:15], s39 offen sc1 lds
    s_add_u32 m0, m0, 1024
    s_add_u32 s40, s40, 229376
    buffer_load_dwordx4 v2, s[12:15], s40 offen sc1 lds
    s_waitcnt vmcnt(16)
    v_readfirstlane_b32 s53, v11
    s_add_u32 s54, s52, 8
    s_cmp_eq_u32 s53, s54
    s_cbranch_scc1 fok_63
    s_mov_b32 s53, 0
    s_add_u32 s54, s52, 8
    s_bfm_b64 exec, 1, 0
poll_64:
    buffer_load_dword v11, v12, s[56:59], 0 offen sc1
    s_waitcnt vmcnt(0)
    v_xor_b32 v11, s54, v11
    v_cmp_eq_u32 vcc, 0, v11
    s_nop 0
    s_cmp_eq_u64 vcc, exec
    s_cbranch_scc1 pok_65
    s_sleep 5
    s_add_u32 s53, s53, 1
    s_cmp_lt_u32 s53, s61
    s_cbranch_scc1 poll_64
    s_mov_b32 s61, 0
pok_65:
    s_mov_b64 exec, -1
fok_63:
    s_call_b64 s[76:77], PREP_a_issue_4
    s_add_u32 m0, m0, 1024
    s_add_u32 s39, s39, 229376
    buffer_load_dwordx4 v2, s[12:15], s39 offen sc1 lds
    s_add_u32 m0, m0, 1024
    s_add_u32 s40, s40, 229376
    buffer_load_dwordx4 v2, s[12:15], s40 offen sc1 lds
    s_add_u32 m0, m0, 1024
    s_add_u32 s39, s39, 229376
    buffer_load_dwordx4 v2, s[12:15], s39 offen sc1 lds
    s_add_u32 m0, m0, 1024
    s_add_u32 s40, s40, 229376
    buffer_load_dwordx4 v2, s[12:15], s40 offen sc1 lds
    s_mov_b32 m0, s19
    s_mov_b32 s39, s16
    s_mov_b32 s40, s17
    s_waitcnt vmcnt(8)
    s_barrier
    buffer_load_dwordx4 v2, s[12:15], s39 offen sc1 lds
    s_add_u32 m0, m0, 1024
    s_nop 0
    buffer_load_dwordx4 v2, s[12:15], s40 offen sc1 lds
    s_add_u32 m0, m0, 1024
    s_add_u32 s39, s39, 229376
    buffer_load_dwordx4 v2, s[12:15], s39 offen sc1 lds
    s_add_u32 m0, m0, 1024
    s_add_u32 s40, s40, 229376
    buffer_load_dwordx4 v2, s[12:15], s40 offen sc1 lds
    s_mov_b32 s43, 1
ld_66:
    s_add_u32 s19, s41, s42
    v_readlane_b32 s16, v249, s44
    v_readlane_b32 s17, v250, s44
    s_add_u32 s16, s16, s38
    s_add_u32 s17, s17, s38
    s_add_u32 s44, s44, 1
    s_add_u32 s42, s42, 16384
    s_cmp_eq_u32 s42, 49152
    s_cselect_b32 s42, 0, s42
    s_add_u32 m0, m0, 1024
    s_add_u32 s39, s39, 229376
    buffer_load_dwordx4 v2, s[12:15], s39 offen sc1 lds
    s_add_u32 m0, m0, 1024
    s_add_u32 s40, s40, 229376
    buffer_load_dwordx4 v2, s[12:15], s40 offen sc1 lds
    s_add_u32 m0, m0, 1024
    s_add_u32 s39, s39, 229376
    buffer_load_dwordx4 v2, s[12:15], s39 offen sc1 lds
    s_add_u32 m0, m0, 1024
    s_add_u32 s40, s40, 229376
    buffer_load_dwordx4 v2, s[12:15], s40 offen sc1 lds
    s_mov_b32 m0, s19
    s_mov_b32 s39, s16
    s_mov_b32 s40, s17
    s_waitcnt vmcnt(8)
    s_barrier
    buffer_load_dwordx4 v2, s[12:15], s39 offen sc1 lds
    s_add_u32 m0, m0, 1024
    s_nop 0
    buffer_load_dwordx4 v2, s[12:15], s40 offen sc1 lds
    s_add_u32 m0, m0, 1024
    s_add_u32 s39, s39, 229376
    buffer_load_dwordx4 v2, s[12:15], s39 offen sc1 lds
    s_add_u32 m0, m0, 1024
    s_add_u32 s40, s40, 229376
    buffer_load_dwordx4 v2, s[12:15], s40 offen sc1 lds
    s_add_u32 s43, s43, 1
    s_cmp_lt_u32 s43, 5
    s_cbranch_scc1 ld_66
    s_call_b64 s[76:77], PREP_a_issue_4
    s_add_u32 m0, m0, 1024
    s_add_u32 s39, s39, 229376
    buffer_load_dwordx4 v2, s[12:15], s39 offen sc1 lds
    s_add_u32 m0, m0, 1024
    s_add_u32 s40, s40, 229376
    buffer_load_dwordx4 v2, s[12:15], s40 offen sc1 lds
    s_add_u32 m0, m0, 1024
    s_add_u32 s39, s39, 229376
    buffer_load_dwordx4 v2, s[12:15], s39 offen sc1 lds
    s_add_u32 m0, m0, 1024
    s_add_u32 s40, s40, 229376
    buffer_load_dwordx4 v2, s[12:15], s40 offen sc1 lds
    s_mov_b32 m0, s19
    s_mov_b32 s39, s16
    s_mov_b32 s40, s17
    s_waitcnt vmcnt(8)
    s_barrier
    buffer_load_dwordx4 v2, s[12:15], s39 offen sc1 lds
    s_add_u32 m0, m0, 1024
    s_nop 0
    buffer_load_dwordx4 v2, s[12:15], s40 offen sc1 lds
    s_add_u32 m0, m0, 1024
    s_add_u32 s39, s39, 229376
    buffer_load_dwordx4 v2, s[12:15], s39 offen sc1 lds
    s_add_u32 m0, m0, 1024
    s_add_u32 s40, s40, 229376
    buffer_load_dwordx4 v2, s[12:15], s40 offen sc1 lds
    s_mov_b64 exec, 1
    buffer_load_dword v11, v15, s[56:59], 0 offen sc1
    s_mov_b64 exec, -1
    s_call_b64 s[76:77], PREP_a_issue_4
    s_add_u32 m0, m0, 1024
    s_add_u32 s39, s39, 229376
    buffer_load_dwordx4 v2, s[12:15], s39 offen sc1 lds
    s_add_u32 m0, m0, 1024
    s_add_u32 s40, s40, 229376
    buffer_load_dwordx4 v2, s[12:15], s40 offen sc1 lds
    s_add_u32 m0, m0, 1024
    s_add_u32 s39, s39, 229376
    buffer_load_dwordx4 v2, s[12:15], s39 offen sc1 lds
    s_add_u32 m0, m0, 1024
    s_add_u32 s40, s40, 229376
    buffer_load_dwordx4 v2, s[12:15], s40 offen sc1 lds
    s_mov_b32 m0, s19
    s_mov_b32 s39, s16
    s_mov_b32 s40, s17
    s_waitcnt vmcnt(9)
    s_barrier
    buffer_load_dwordx4 v2, s[12:15], s39 offen sc1 lds
    s_add_u32 m0, m0, 1024
    s_nop 0
    buffer_load_dwordx4 v2, s[12:15], s40 offen sc1 lds
    s_add_u32 m0, m0, 1024
    s_add_u32 s39, s39, 229376
    buffer_load_dwordx4 v2, s[12:15], s39 offen sc1 lds
    s_add_u32 m0, m0, 1024
    s_add_u32 s40, s40, 229376
    buffer_load_dwordx4 v2, s[12:15], s40 offen sc1 lds
    s_call_b64 s[76:77], PREP_a_issue_4
    s_add_u32 m0, m0, 1024
    s_add_u32 s39, s39, 229376
    buffer_load_dwordx4 v2, s[12:15], s39 offen sc1 lds
    s_add_u32 m0, m0, 1024
    s_add_u32 s40, s40, 229376
    buffer_load_dwordx4 v2, s[12:15], s40 offen sc1 lds
    s_add_u32 m0, m0, 1024
    s_add_u32 s39, s39, 229376
    buffer_load_dwordx4 v2, s[12:15], s39 offen sc1 lds
    s_add_u32 m0, m0, 1024
    s_add_u32 s40, s40, 229376
    buffer_load_dwordx4 v2, s[12:15], s40 offen sc1 lds
    s_mov_b32 m0, s19
    s_mov_b32 s39, s16
    s_mov_b32 s40, s17
    s_waitcnt vmcnt(8)
    s_barrier
    buffer_load_dwordx4 v2, s[12:15], s39 offen sc1 lds
    s_add_u32 m0, m0, 1024
    s_nop 0
    buffer_load_dwordx4 v2, s[12:15], s40 offen sc1 lds
    s_add_u32 m0, m0, 1024
    s_add_u32 s39, s39, 229376
    buffer_load_dwordx4 v2, s[12:15], s39 offen sc1 lds
    s_add_u32 m0, m0, 1024
    s_add_u32 s40, s40, 229376
    buffer_load_dwordx4 v2, s[12:15], s40 offen sc1 lds
    s_waitcnt vmcnt(16)
    v_readfirstlane_b32 s53, v11
    s_add_u32 s54, s52, 8
    s_cmp_eq_u32 s53, s54
    s_cbranch_scc1 fok_67
    s_mov_b32 s53, 0
    s_add_u32 s54, s52, 8
    s_bfm_b64 exec, 1, 0
poll_68:
    buffer_load_dword v11, v15, s[56:59], 0 offen sc1
    s_waitcnt vmcnt(0)
    v_xor_b32 v11, s54, v11
    v_cmp_eq_u32 vcc, 0, v11
    s_nop 0
    s_cmp_eq_u64 vcc, exec
    s_cbranch_scc1 pok_69
    s_sleep 5
    s_add_u32 s53, s53, 1
    s_cmp_lt_u32 s53, s61
    s_cbranch_scc1 poll_68
    s_mov_b32 s61, 0
pok_69:
    s_mov_b64 exec, -1
fok_67:
    s_call_b64 s[76:77], PREP_a_issue_4
    s_add_u32 m0, m0, 1024
    s_add_u32 s39, s39, 229376
    buffer_load_dwordx4 v2, s[12:15], s39 offen sc1 lds
    s_add_u32 m0, m0, 1024
    s_add_u32 s40, s40, 229376
    buffer_load_dwordx4 v2, s[12:15], s40 offen sc1 lds
    s_add_u32 m0, m0, 1024
    s_add_u32 s39, s39, 229376
    buffer_load_dwordx4 v2, s[12:15], s39 offen sc1 lds
    s_add_u32 m0, m0, 1024
    s_add_u32 s40, s40, 229376
    buffer_load_dwordx4 v2, s[12:15], s40 offen sc1 lds
    s_mov_b32 m0, s19
    s_mov_b32 s39, s16
    s_mov_b32 s40, s17
    s_waitcnt vmcnt(8)
    s_barrier
    buffer_load_dwordx4 v2, s[12:15], s39 offen sc1 lds
    s_add_u32 m0, m0, 1024
    s_nop 0
    buffer_load_dwordx4 v2, s[12:15], s40 offen sc1 lds
    s_add_u32 m0, m0, 1024
    s_add_u32 s39, s39, 229376
    buffer_load_dwordx4 v2, s[12:15], s39 offen sc1 lds
    s_add_u32 m0, m0, 1024
    s_add_u32 s40, s40, 229376
    buffer_load_dwordx4 v2, s[12:15], s40 offen sc1 lds
    s_mov_b32 s43, 1
ld_70:
    s_add_u32 s19, s41, s42
    v_readlane_b32 s16, v249, s44
    v_readlane_b32 s17, v250, s44
    s_add_u32 s16, s16, s38
    s_add_u32 s17, s17, s38
    s_add_u32 s44, s44, 1
    s_add_u32 s42, s42, 16384
    s_cmp_eq_u32 s42, 49152
    s_cselect_b32 s42, 0, s42
    s_add_u32 m0, m0, 1024
    s_add_u32 s39, s39, 229376
    buffer_load_dwordx4 v2, s[12:15], s39 offen sc1 lds
    s_add_u32 m0, m0, 1024
    s_add_u32 s40, s40, 229376
    buffer_load_dwordx4 v2, s[12:15], s40 offen sc1 lds
    s_add_u32 m0, m0, 1024
    s_add_u32 s39, s39, 229376
    buffer_load_dwordx4 v2, s[12:15], s39 offen sc1 lds
    s_add_u32 m0, m0, 1024
    s_add_u32 s40, s40, 229376
    buffer_load_dwordx4 v2, s[12:15], s40 offen sc1 lds
    s_mov_b32 m0, s19
    s_mov_b32 s39, s16
    s_mov_b32 s40, s17
    s_waitcnt vmcnt(8)
    s_barrier
    buffer_load_dwordx4 v2, s[12:15], s39 offen sc1 lds
    s_add_u32 m0, m0, 1024
    s_nop 0
    buffer_load_dwordx4 v2, s[12:15], s40 offen sc1 lds
    s_add_u32 m0, m0, 1024
    s_add_u32 s39, s39, 229376
    buffer_load_dwordx4 v2, s[12:15], s39 offen sc1 lds
    s_add_u32 m0, m0, 1024
    s_add_u32 s40, s40, 229376
    buffer_load_dwordx4 v2, s[12:15], s40 offen sc1 lds
    s_add_u32 s43, s43, 1
    s_cmp_lt_u32 s43, 3
    s_cbranch_scc1 ld_70
    s_call_b64 s[76:77], PREP_a_issue_4
    s_add_u32 m0, m0, 1024
    s_add_u32 s39, s39, 229376
    buffer_load_dwordx4 v2, s[12:15], s39 offen sc1 lds
    s_add_u32 m0, m0, 1024
    s_add_u32 s40, s40, 229376
    buffer_load_dwordx4 v2, s[12:15], s40 offen sc1 lds
    s_add_u32 m0, m0, 1024
    s_add_u32 s39, s39, 229376
    buffer_load_dwordx4 v2, s[12:15], s39 offen sc1 lds
    s_add_u32 m0, m0, 1024
    s_add_u32 s40, s40, 229376
    buffer_load_dwordx4 v2, s[12:15], s40 offen sc1 lds
    s_mov_b32 m0, s19
    s_mov_b32 s39, s16
    s_mov_b32 s40, s17
    s_waitcnt vmcnt(8)
    s_barrier
    buffer_load_dwordx4 v2, s[12:15], s39 offen sc1 lds
    s_add_u32 m0, m0, 1024
    s_nop 0
    buffer_load_dwordx4 v2, s[12:15], s40 offen sc1 lds
    s_add_u32 m0, m0, 1024
    s_add_u32 s39, s39, 229376
    buffer_load_dwordx4 v2, s[12:15], s39 offen sc1 lds
    s_add_u32 m0, m0, 1024
    s_add_u32 s40, s40, 229376
    buffer_load_dwordx4 v2, s[12:15], s40 offen sc1 lds
    s_add_u32 m0, m0, 1024
    s_add_u32 s39, s39, 229376
    buffer_load_dwordx4 v2, s[12:15], s39 offen sc1 lds
    s_add_u32 m0, m0, 1024
    s_add_u32 s40, s40, 229376
    buffer_load_dwordx4 v2, s[12:15], s40 offen sc1 lds
    s_add_u32 m0, m0, 1024
    s_add_u32 s39, s39, 229376
    buffer_load_dwordx4 v2, s[12:15], s39 offen sc1 lds
    s_add_u32 m0, m0, 1024
    s_add_u32 s40, s40, 229376
    buffer_load_dwordx4 v2, s[12:15], s40 offen sc1 lds
    s_waitcnt vmcnt(8)
    s_barrier
    s_waitcnt vmcnt(0)
    s_barrier
    s_cmp_eq_u32 s60, 1
    s_cbranch_scc1 K_fin
    s_barrier
    s_and_b32 s36, s30, 1
    s_lshl_b32 s36, s36, 12
    s_add_u32 s36, s36, 32768
    v_add_u32 v6, s36, v2
    ds_write_b128 v6, v[16:19] offset:0
    ds_write_b128 v6, v[20:23] offset:1024
    ds_write_b128 v6, v[24:27] offset:2048
    ds_write_b128 v6, v[28:31] offset:3072
    ds_write_b128 v6, v[32:35] offset:8192
    ds_write_b128 v6, v[36:39] offset:9216
    ds_write_b128 v6, v[40:43] offset:10240
    ds_write_b128 v6, v[44:47] offset:11264
    s_waitcnt lgkmcnt(0)
    s_branch NEXT
WLOAD:
    s_cmp_eq_u32 s60, 1
    s_cbranch_scc1 WL_1
    s_mov_b64 s[12:13], s[68:69]
    s_mov_b32 s14, 2097152
    s_mov_b32 s15, 0x20000
    s_and_b32 s35, s30, 1
    s_mul_i32 s38, s99, 128
    s_mul_i32 s41, s35, 65536
    s_add_u32 s38, s38, s41
    s_mul_i32 s41, s35, 4096
    s_add_u32 s41, s41, 24576
    s_mov_b32 s42, 0
    s_mov_b32 s44, s67
    s_branch WL_2
WL_1:
    s_mov_b64 s[12:13], s[68:69]
    s_mov_b32 s14, 2097152
    s_mov_b32 s15, 0x20000
    s_and_b32 s35, s30, 1
    s_mul_i32 s38, s99, 128
    s_mul_i32 s41, s35, 65536
    s_add_u32 s38, s38, s41
    s_mul_i32 s41, s35, 4096
    s_add_u32 s41, s41, 24576
    s_mov_b32 s42, 0
    s_mov_b32 s44, s67
WL_2:
    s_waitcnt vmcnt(0)
    s_and_b32 s36, s30, 1
    s_lshl_b32 s36, s36, 12
    s_add_u32 s36, s36, 81920
    v_add_u32 v6, s36, v2
    ds_read_b128 v[16:19], v6 offset:16384
    ds_read_b128 v[20:23], v6 offset:17408
    ds_read_b128 v[24:27], v6 offset:18432
    ds_read_b128 v[28:31], v6 offset:19456
    ds_read_b128 v[32:35], v6 offset:24576
    ds_read_b128 v[36:39], v6 offset:25600
    ds_read_b128 v[40:43], v6 offset:26624
    ds_read_b128 v[44:47], v6 offset:27648
    ds_read_b128 v[204:207], v6 offset:0
    ds_read_b128 v[208:211], v6 offset:1024
    ds_read_b128 v[212:215], v6 offset:2048
    ds_read_b128 v[216:219], v6 offset:3072
    s_waitcnt lgkmcnt(0)
    s_barrier
    s_call_b64 s[76:77], SUB_after_g1
    s_barrier
    s_waitcnt vmcnt(0)
    s_barrier
    s_call_b64 s[76:77], SUB_after_g2
    s_mov_b64 s[12:13], s[72:73]
    s_mov_b32 s14, 7340032
    s_mov_b32 s15, 0x20000
    s_and_b32 s35, s30, 1
    s_mul_i32 s38, s29, 448
    s_mul_i32 s41, s35, 229376
    s_add_u32 s38, s38, s41
    s_mul_i32 s41, s35, 14336
    s_add_u32 s41, s41, 73728
    s_mov_b32 s42, 0
    s_mov_b32 s44, 0
    s_mov_b32 s42, 28672
    s_mov_b32 s44, 2
    s_add_u32 s19, s41, s42
    v_readlane_b32 s16, v248, s44
    s_nop 0
    s_add_u32 s16, s16, s38
    s_add_u32 s44, s44, 1
    s_and_b32 s44, s44, 15
    s_add_u32 s42, s42, 28672
    s_cmp_eq_u32 s42, 86016
    s_cselect_b32 s42, 0, s42
    s_mov_b32 m0, s19
    s_mov_b32 s39, s16
    s_waitcnt vmcnt(63)
    s_barrier
    buffer_load_dwordx4 v241, s[12:15], s39 offen lds
    s_add_u32 m0, m0, 1024
    s_nop 0
    buffer_load_dwordx4 v242, s[12:15], s39 offen lds
    s_add_u32 m0, m0, 1024
    s_nop 0
    buffer_load_dwordx4 v243, s[12:15], s39 offen lds
    s_add_u32 m0, m0, 1024
    s_nop 0
    buffer_load_dwordx4 v244, s[12:15], s39 offen lds
    s_add_u32 m0, m0, 1024
    s_nop 0
    buffer_load_dwordx4 v245, s[12:15], s39 offen lds
    s_add_u32 m0, m0, 1024
    s_nop 0
    buffer_load_dwordx4 v246, s[12:15], s39 offen lds
    s_add_u32 m0, m0, 1024
    s_nop 0
    buffer_load_dwordx4 v247, s[12:15], s39 offen lds
    s_mov_b32 s43, 1
ld_71:
    s_add_u32 s19, s41, s42
    v_readlane_b32 s16, v248, s44
    s_nop 0
    s_add_u32 s16, s16, s38
    s_add_u32 s44, s44, 1
    s_and_b32 s44, s44, 15
    s_add_u32 s42, s42, 28672
    s_cmp_eq_u32 s42, 86016
    s_cselect_b32 s42, 0, s42
    s_add_u32 m0, m0, 1024
    s_add_u32 s39, s39, 114688
    buffer_load_dwordx4 v241, s[12:15], s39 offen lds
    s_add_u32 m0, m0, 1024
    s_nop 0
    buffer_load_dwordx4 v242, s[12:15], s39 offen lds
    s_add_u32 m0, m0, 1024
    s_nop 0
    buffer_load_dwordx4 v243, s[12:15], s39 offen lds
    s_add_u32 m0, m0, 1024
    s_nop 0
    buffer_load_dwordx4 v244, s[12:15], s39 offen lds
    s_add_u32 m0, m0, 1024
    s_nop 0
    buffer_load_dwordx4 v245, s[12:15], s39 offen lds
    s_add_u32 m0, m0, 1024
    s_nop 0
    buffer_load_dwordx4 v246, s[12:15], s39 offen lds
    s_add_u32 m0, m0, 1024
    s_nop 0
    buffer_load_dwordx4 v247, s[12:15], s39 offen lds
    s_mov_b32 m0, s19
    s_mov_b32 s39, s16
    s_waitcnt vmcnt(14)
    s_barrier
    buffer_load_dwordx4 v241, s[12:15], s39 offen lds
    s_add_u32 m0, m0, 1024
    s_nop 0
    buffer_load_dwordx4 v242, s[12:15], s39 offen lds
    s_add_u32 m0, m0, 1024
    s_nop 0
    buffer_load_dwordx4 v243, s[12:15], s39 offen lds
    s_add_u32 m0, m0, 1024
    s_nop 0
    buffer_load_dwordx4 v244, s[12:15], s39 offen lds
    s_add_u32 m0, m0, 1024
    s_nop 0
    buffer_load_dwordx4 v245, s[12:15], s39 offen lds
    s_add_u32 m0, m0, 1024
    s_nop 0
    buffer_load_dwordx4 v246, s[12:15], s39 offen lds
    s_add_u32 m0, m0, 1024
    s_nop 0
    buffer_load_dwordx4 v247, s[12:15], s39 offen lds
    s_add_u32 s43, s43, 1
    s_cmp_lt_u32 s43, 13
    s_cbranch_scc1 ld_71
    s_add_u32 s19, s41, s42
    v_readlane_b32 s16, v248, s44
    s_nop 0
    s_add_u32 s16, s16, s38
    s_add_u32 s44, s44, 1
    s_and_b32 s44, s44, 15
    s_add_u32 s42, s42, 28672
    s_cmp_eq_u32 s42, 86016
    s_cselect_b32 s42, 0, s42
    s_add_u32 m0, m0, 1024
    s_add_u32 s39, s39, 114688
    buffer_load_dwordx4 v241, s[12:15], s39 offen lds
    s_add_u32 m0, m0, 1024
    s_nop 0
    buffer_load_dwordx4 v242, s[12:15], s39 offen lds
    s_add_u32 m0, m0, 1024
    s_nop 0
    buffer_load_dwordx4 v243, s[12:15], s39 offen lds
    s_add_u32 m0, m0, 1024
    s_nop 0
    buffer_load_dwordx4 v244, s[12:15], s39 offen lds
    s_add_u32 m0, m0, 1024
    s_nop 0
    buffer_load_dwordx4 v245, s[12:15], s39 offen lds
    s_add_u32 m0, m0, 1024
    s_nop 0
    buffer_load_dwordx4 v246, s[12:15], s39 offen lds
    s_add_u32 m0, m0, 1024
    s_nop 0
    buffer_load_dwordx4 v247, s[12:15], s39 offen lds
    s_mov_b32 m0, s19
    s_mov_b32 s39, s16
    s_waitcnt vmcnt(14)
    s_barrier
    buffer_load_dwordx4 v241, s[12:15], s39 offen lds
    s_add_u32 m0, m0, 1024
    s_nop 0
    buffer_load_dwordx4 v242, s[12:15], s39 offen lds
    s_add_u32 m0, m0, 1024
    s_nop 0
    buffer_load_dwordx4 v243, s[12:15], s39 offen lds
    s_add_u32 m0, m0, 1024
    s_nop 0
    buffer_load_dwordx4 v244, s[12:15], s39 offen lds
    s_add_u32 m0, m0, 1024
    s_nop 0
    buffer_load_dwordx4 v245, s[12:15], s39 offen lds
    s_add_u32 m0, m0, 1024
    s_nop 0
    buffer_load_dwordx4 v246, s[12:15], s39 offen lds
    s_add_u32 m0, m0, 1024
    s_nop 0
    buffer_load_dwordx4 v247, s[12:15], s39 offen lds
    s_add_u32 m0, m0, 1024
    s_add_u32 s39, s39, 114688
    buffer_load_dwordx4 v241, s[12:15], s39 offen lds
    s_add_u32 m0, m0, 1024
    s_nop 0
    buffer_load_dwordx4 v242, s[12:15], s39 offen lds
    s_add_u32 m0, m0, 1024
    s_nop 0
    buffer_load_dwordx4 v243, s[12:15], s39 offen lds
    s_add_u32 m0, m0, 1024
    s_nop 0
    buffer_load_dwordx4 v244, s[12:15], s39 offen lds
    s_add_u32 m0, m0, 1024
    s_nop 0
    buffer_load_dwordx4 v245, s[12:15], s39 offen lds
    s_add_u32 m0, m0, 1024
    s_nop 0
    buffer_load_dwordx4 v246, s[12:15], s39 offen lds
    s_add_u32 m0, m0, 1024
    s_nop 0
    buffer_load_dwordx4 v247, s[12:15], s39 offen lds
    s_waitcnt vmcnt(14)
    s_barrier
    s_waitcnt vmcnt(0)
    s_barrier
    s_cmp_lg_u32 s60, 0
    s_cbranch_scc1 rp_72
    s_call_b64 s[76:77], SUB_r_pre
rp_72:
    s_barrier
    s_mov_b64 s[12:13], s[74:75]
    s_mov_b32 s14, 7340032
    s_mov_b32 s15, 0x20000
    s_and_b32 s35, s30, 1
    s_mul_i32 s38, s33, 256
    s_mul_i32 s41, s31, 3670016
    s_add_u32 s38, s38, s41
    s_mul_i32 s41, s35, 8192
    s_add_u32 s41, s41, 49152
    s_mov_b32 s42, 0
    s_mov_b32 s44, 0
    s_mov_b32 s49, s44
    s_and_b32 s43, s28, 3
    s_mul_i32 s43, s43, 6
    s_lshr_b32 s43, s43, 2
    s_mov_b32 s50, 0
wpre_73:
    s_mul_i32 s42, s43, 16384
    s_add_u32 s44, s49, s43
    s_mov_b32 s45, 8192
    s_add_u32 s19, s41, s42
    v_readlane_b32 s16, v249, s44
    s_nop 0
    s_bitcmp1_b32 s16, 0
    s_cselect_b32 s17, 16384, s45
    s_cselect_b32 s18, -40960, s45
    s_andn2_b32 s16, s16, 1
    s_add_u32 s16, s16, s38
    s_add_u32 s44, s44, 1
    s_add_u32 s42, s42, 16384
    s_cmp_eq_u32 s42, 98304
    s_cselect_b32 s42, 0, s42
    s_mov_b32 m0, s19
    s_mov_b32 s39, s16
    s_mov_b32 s32, s17
    s_mov_b32 s3, s18
    buffer_load_dwordx4 v239, s[12:15], s39 offen lds
    s_add_u32 m0, m0, 1024
    s_add_u32 s39, s39, s32
    buffer_load_dwordx4 v240, s[12:15], s39 offen lds
    s_add_u32 m0, m0, 1024
    s_add_u32 s39, s39, s32
    buffer_load_dwordx4 v239, s[12:15], s39 offen lds
    s_add_u32 m0, m0, 1024
    s_add_u32 s39, s39, s32
    buffer_load_dwordx4 v240, s[12:15], s39 offen lds
    s_waitcnt vmcnt(8)
    s_add_u32 m0, m0, 1024
    s_add_u32 s39, s39, s3
    buffer_load_dwordx4 v239, s[12:15], s39 offen lds
    s_add_u32 m0, m0, 1024
    s_add_u32 s39, s39, s32
    buffer_load_dwordx4 v240, s[12:15], s39 offen lds
    s_add_u32 m0, m0, 1024
    s_add_u32 s39, s39, s32
    buffer_load_dwordx4 v239, s[12:15], s39 offen lds
    s_add_u32 m0, m0, 1024
    s_add_u32 s39, s39, s32
    buffer_load_dwordx4 v240, s[12:15], s39 offen lds
    s_waitcnt vmcnt(8)
    s_add_u32 s43, s43, 1
    s_cmp_eq_u32 s43, 6
    s_cselect_b32 s43, 0, s43
    s_add_u32 s50, s50, 1
    s_cmp_lt_u32 s50, 6
    s_cbranch_scc1 wpre_73
    s_mov_b32 s42, 0
    s_add_u32 s44, s49, 6
    s_cmp_eq_u32 s60, 1
    s_cbranch_scc1 WL_t1
    s_call_b64 s[76:77], PREP_w_issue_4
    s_mov_b32 m0, s19
    s_mov_b32 s39, s16
    s_mov_b32 s32, s17
    s_mov_b32 s3, s18
    s_waitcnt vmcnt(0)
    s_barrier
    s_waitcnt vmcnt(0)
    s_barrier
    buffer_load_dwordx4 v239, s[12:15], s39 offen lds
    s_add_u32 m0, m0, 1024
    s_add_u32 s39, s39, s32
    buffer_load_dwordx4 v240, s[12:15], s39 offen lds
    s_add_u32 m0, m0, 1024
    s_add_u32 s39, s39, s32
    buffer_load_dwordx4 v239, s[12:15], s39 offen lds
    s_add_u32 m0, m0, 1024
    s_add_u32 s39, s39, s32
    buffer_load_dwordx4 v240, s[12:15], s39 offen lds
    s_call_b64 s[76:77], PREP_w_issue_4
    s_add_u32 m0, m0, 1024
    s_add_u32 s39, s39, s3
    buffer_load_dwordx4 v239, s[12:15], s39 offen lds
    s_add_u32 m0, m0, 1024
    s_add_u32 s39, s39, s32
    buffer_load_dwordx4 v240, s[12:15], s39 offen lds
    s_add_u32 m0, m0, 1024
    s_add_u32 s39, s39, s32
    buffer_load_dwordx4 v239, s[12:15], s39 offen lds
    s_add_u32 m0, m0, 1024
    s_add_u32 s39, s39, s32
    buffer_load_dwordx4 v240, s[12:15], s39 offen lds
    s_mov_b32 m0, s19
    s_mov_b32 s39, s16
    s_mov_b32 s32, s17
    s_mov_b32 s3, s18
    s_waitcnt vmcnt(8)
    s_barrier
    buffer_load_dwordx4 v239, s[12:15], s39 offen lds
    s_add_u32 m0, m0, 1024
    s_add_u32 s39, s39, s32
    buffer_load_dwordx4 v240, s[12:15], s39 offen lds
    s_add_u32 m0, m0, 1024
    s_add_u32 s39, s39, s32
    buffer_load_dwordx4 v239, s[12:15], s39 offen lds
    s_add_u32 m0, m0, 1024
    s_add_u32 s39, s39, s32
    buffer_load_dwordx4 v240, s[12:15], s39 offen lds
    s_call_b64 s[76:77], PREP_w_issue_4
    s_add_u32 m0, m0, 1024
    s_add_u32 s39, s39, s3
    buffer_load_dwordx4 v239, s[12:15], s39 offen lds
    s_add_u32 m0, m0, 1024
    s_add_u32 s39, s39, s32
    buffer_load_dwordx4 v240, s[12:15], s39 offen lds
    s_add_u32 m0, m0, 1024
    s_add_u32 s39, s39, s32
    buffer_load_dwordx4 v239, s[12:15], s39 offen lds
    s_add_u32 m0, m0, 1024
    s_add_u32 s39, s39, s32
    buffer_load_dwordx4 v240, s[12:15], s39 offen lds
    s_mov_b32 m0, s19
    s_mov_b32 s39, s16
    s_mov_b32 s32, s17
    s_mov_b32 s3, s18
    s_waitcnt vmcnt(16)
    s_barrier
    buffer_load_dwordx4 v239, s[12:15], s39 offen lds
    s_add_u32 m0, m0, 1024
    s_add_u32 s39, s39, s32
    buffer_load_dwordx4 v240, s[12:15], s39 offen lds
    s_add_u32 m0, m0, 1024
    s_add_u32 s39, s39, s32
    buffer_load_dwordx4 v239, s[12:15], s39 offen lds
    s_add_u32 m0, m0, 1024
    s_add_u32 s39, s39, s32
    buffer_load_dwordx4 v240, s[12:15], s39 offen lds
    s_call_b64 s[76:77], PREP_w_issue_4
    s_add_u32 m0, m0, 1024
    s_add_u32 s39, s39, s3
    buffer_load_dwordx4 v239, s[12:15], s39 offen lds
    s_add_u32 m0, m0, 1024
    s_add_u32 s39, s39, s32
    buffer_load_dwordx4 v240, s[12:15], s39 offen lds
    s_add_u32 m0, m0, 1024
    s_add_u32 s39, s39, s32
    buffer_load_dwordx4 v239, s[12:15], s39 offen lds
    s_add_u32 m0, m0, 1024
    s_add_u32 s39, s39, s32
    buffer_load_dwordx4 v240, s[12:15], s39 offen lds
    s_mov_b32 m0, s19
    s_mov_b32 s39, s16
    s_mov_b32 s32, s17
    s_mov_b32 s3, s18
    s_waitcnt vmcnt(24)
    s_barrier
    buffer_load_dwordx4 v239, s[12:15], s39 offen lds
    s_add_u32 m0, m0, 1024
    s_add_u32 s39, s39, s32
    buffer_load_dwordx4 v240, s[12:15], s39 offen lds
    s_add_u32 m0, m0, 1024
    s_add_u32 s39, s39, s32
    buffer_load_dwordx4 v239, s[12:15], s39 offen lds
    s_add_u32 m0, m0, 1024
    s_add_u32 s39, s39, s32
    buffer_load_dwordx4 v240, s[12:15], s39 offen lds
    s_mov_b32 s43, 1
ld_74:
    s_mov_b32 s45, 8192
    s_add_u32 s19, s41, s42
    v_readlane_b32 s16, v249, s44
    s_nop 0
    s_bitcmp1_b32 s16, 0
    s_cselect_b32 s17, 16384, s45
    s_cselect_b32 s18, -40960, s45
    s_andn2_b32 s16, s16, 1
    s_add_u32 s16, s16, s38
    s_add_u32 s44, s44, 1
    s_add_u32 s42, s42, 16384
    s_cmp_eq_u32 s42, 98304
    s_cselect_b32 s42, 0, s42
    s_add_u32 m0, m0, 1024
    s_add_u32 s39, s39, s3
    buffer_load_dwordx4 v239, s[12:15], s39 offen lds
    s_add_u32 m0, m0, 1024
    s_add_u32 s39, s39, s32
    buffer_load_dwordx4 v240, s[12:15], s39 offen lds
    s_add_u32 m0, m0, 1024
    s_add_u32 s39, s39, s32
    buffer_load_dwordx4 v239, s[12:15], s39 offen lds
    s_add_u32 m0, m0, 1024
    s_add_u32 s39, s39, s32
    buffer_load_dwordx4 v240, s[12:15], s39 offen lds
    s_mov_b32 m0, s19
    s_mov_b32 s39, s16
    s_mov_b32 s32, s17
    s_mov_b32 s3, s18
    s_waitcnt vmcnt(32)
    s_barrier
    buffer_load_dwordx4 v239, s[12:15], s39 offen lds
    s_add_u32 m0, m0, 1024
    s_add_u32 s39, s39, s32
    buffer_load_dwordx4 v240, s[12:15], s39 offen lds
    s_add_u32 m0, m0, 1024
    s_add_u32 s39, s39, s32
    buffer_load_dwordx4 v239, s[12:15], s39 offen lds
    s_add_u32 m0, m0, 1024
    s_add_u32 s39, s39, s32
    buffer_load_dwordx4 v240, s[12:15], s39 offen lds
    s_add_u32 s43, s43, 1
    s_cmp_lt_u32 s43, 18
    s_cbranch_scc1 ld_74
    s_call_b64 s[76:77], PREP_w_issue_4
    s_add_u32 m0, m0, 1024
    s_add_u32 s39, s39, s3
    buffer_load_dwordx4 v239, s[12:15], s39 offen lds
    s_add_u32 m0, m0, 1024
    s_add_u32 s39, s39, s32
    buffer_load_dwordx4 v240, s[12:15], s39 offen lds
    s_add_u32 m0, m0, 1024
    s_add_u32 s39, s39, s32
    buffer_load_dwordx4 v239, s[12:15], s39 offen lds
    s_add_u32 m0, m0, 1024
    s_add_u32 s39, s39, s32
    buffer_load_dwordx4 v240, s[12:15], s39 offen lds
    s_mov_b32 m0, s19
    s_mov_b32 s39, s16
    s_mov_b32 s32, s17
    s_mov_b32 s3, s18
    s_waitcnt vmcnt(32)
    s_barrier
    buffer_load_dwordx4 v239, s[12:15], s39 offen lds
    s_add_u32 m0, m0, 1024
    s_add_u32 s39, s39, s32
    buffer_load_dwordx4 v240, s[12:15], s39 offen lds
    s_add_u32 m0, m0, 1024
    s_add_u32 s39, s39, s32
    buffer_load_dwordx4 v239, s[12:15], s39 offen lds
    s_add_u32 m0, m0, 1024
    s_add_u32 s39, s39, s32
    buffer_load_dwordx4 v240, s[12:15], s39 offen lds
    s_add_u32 m0, m0, 1024
    s_add_u32 s39, s39, s3
    buffer_load_dwordx4 v239, s[12:15], s39 offen lds
    s_add_u32 m0, m0, 1024
    s_add_u32 s39, s39, s32
    buffer_load_dwordx4 v240, s[12:15], s39 offen lds
    s_add_u32 m0, m0, 1024
    s_add_u32 s39, s39, s32
    buffer_load_dwordx4 v239, s[12:15], s39 offen lds
    s_add_u32 m0, m0, 1024
    s_add_u32 s39, s39, s32
    buffer_load_dwordx4 v240, s[12:15], s39 offen lds
    s_waitcnt vmcnt(32)
    s_barrier
    s_mov_b64 s[12:13], s[68:69]
    s_mov_b32 s14, 2097152
    s_mov_b32 s15, 0x20000
    s_and_b32 s35, s30, 1
    s_mul_i32 s38, s99, 128
    s_mul_i32 s41, s35, 65536
    s_add_u32 s38, s38, s41
    s_mul_i32 s41, s35, 4096
    s_add_u32 s41, s41, 24576
    s_mov_b32 s42, 0
    s_mov_b32 s44, s67
    s_and_b32 s36, s99, 7
    s_cmp_eq_u32 s36, 3
    s_cselect_b64 s[50:51], 0, -1
    s_mov_b32 s42, 90112
    s_mov_b32 s44, s67
    s_add_u32 s44, s44, 11
    s_and_b32 s44, s44, 15
    s_call_b64 s[76:77], SUB_w_issue_1
    s_mov_b32 s42, 98304
    s_mov_b32 s44, s67
    s_add_u32 s44, s44, 12
    s_and_b32 s44, s44, 15
    s_call_b64 s[76:77], SUB_w_issue_1
    s_waitcnt vmcnt(32)
    s_barrier
    s_mov_b32 s42, 106496
    s_mov_b32 s44, s67
    s_add_u32 s44, s44, 13
    s_and_b32 s44, s44, 15
    s_call_b64 s[76:77], SUB_w_issue_1
    s_mov_b32 s42, 114688
    s_mov_b32 s44, s67
    s_add_u32 s44, s44, 14
    s_and_b32 s44, s44, 15
    s_call_b64 s[76:77], SUB_w_issue_1
    s_waitcnt vmcnt(32)
    s_barrier
    s_mov_b32 s42, 24576
    s_mov_b32 s44, s67
    s_add_u32 s44, s44, 3
    s_and_b32 s44, s44, 15
    s_call_b64 s[76:77], SUB_w_issue_1
    s_mov_b32 s42, 32768
    s_mov_b32 s44, s67
    s_add_u32 s44, s44, 4
    s_and_b32 s44, s44, 15
    s_call_b64 s[76:77], SUB_w_issue_1
    s_waitcnt vmcnt(32)
    s_barrier
    s_mov_b32 s42, 40960
    s_mov_b32 s44, s67
    s_add_u32 s44, s44, 5
    s_and_b32 s44, s44, 15
    s_call_b64 s[76:77], SUB_w_issue_1
    s_mov_b32 s42, 49152
    s_mov_b32 s44, s67
    s_add_u32 s44, s44, 6
    s_and_b32 s44, s44, 15
    s_call_b64 s[76:77], SUB_w_issue_1
    s_mov_b32 s42, 0
    s_mov_b32 s44, s67
    s_add_u32 s44, s44, 0
    s_and_b32 s44, s44, 15
    s_call_b64 s[76:77], SUB_w_issue_1
    s_waitcnt vmcnt(36)
    s_barrier
    s_mov_b32 s42, 65536
    s_mov_b32 s44, s67
    s_add_u32 s44, s44, 8
    s_and_b32 s44, s44, 15
    s_call_b64 s[76:77], SUB_w_issue_1
    s_mov_b32 s42, 122880
    s_mov_b32 s44, s67
    s_add_u32 s44, s44, 15
    s_and_b32 s44, s44, 15
    s_call_b64 s[76:77], SUB_w_issue_1
    s_add_u32 s36, s41, 57344
    v_add_u32 v6, s36, v2
    s_barrier
    s_add_u32 s36, s41, 57344
    v_add_u32 v6, s36, v2
    ds_write_b128 v6, v[16:19] offset:16384
    ds_write_b128 v6, v[20:23] offset:17408
    ds_write_b128 v6, v[24:27] offset:18432
    ds_write_b128 v6, v[28:31] offset:19456
    ds_write_b128 v6, v[32:35] offset:24576
    ds_write_b128 v6, v[36:39] offset:25600
    ds_write_b128 v6, v[40:43] offset:26624
    ds_write_b128 v6, v[44:47] offset:27648
    ds_write_b128 v6, v[204:207] offset:0
    ds_write_b128 v6, v[208:211] offset:1024
    ds_write_b128 v6, v[212:215] offset:2048
    ds_write_b128 v6, v[216:219] offset:3072
    s_waitcnt lgkmcnt(0)
    s_branch NEXT
WL_t1:
    s_call_b64 s[76:77], PREP_w_issue_4
    s_mov_b32 m0, s19
    s_mov_b32 s39, s16
    s_mov_b32 s32, s17
    s_mov_b32 s3, s18
    s_waitcnt vmcnt(0)
    s_barrier
    s_waitcnt vmcnt(0)
    s_barrier
    s_waitcnt vmcnt(0)
    s_barrier
    s_waitcnt vmcnt(0)
    s_barrier
    s_waitcnt vmcnt(0)
    s_barrier
    buffer_load_dwordx4 v239, s[12:15], s39 offen lds
    s_add_u32 m0, m0, 1024
    s_add_u32 s39, s39, s32
    buffer_load_dwordx4 v240, s[12:15], s39 offen lds
    s_add_u32 m0, m0, 1024
    s_add_u32 s39, s39, s32
    buffer_load_dwordx4 v239, s[12:15], s39 offen lds
    s_add_u32 m0, m0, 1024
    s_add_u32 s39, s39, s32
    buffer_load_dwordx4 v240, s[12:15], s39 offen lds
    s_mov_b32 s43, 1
ld_75:
    s_mov_b32 s45, 8192
    s_add_u32 s19, s41, s42
    v_readlane_b32 s16, v249, s44
    s_nop 0
    s_bitcmp1_b32 s16, 0
    s_cselect_b32 s17, 16384, s45
    s_cselect_b32 s18, -40960, s45
    s_andn2_b32 s16, s16, 1
    s_add_u32 s16, s16, s38
    s_add_u32 s44, s44, 1
    s_add_u32 s42, s42, 16384
    s_cmp_eq_u32 s42, 98304
    s_cselect_b32 s42, 0, s42
    s_add_u32 m0, m0, 1024
    s_add_u32 s39, s39, s3
    buffer_load_dwordx4 v239, s[12:15], s39 offen lds
    s_add_u32 m0, m0, 1024
    s_add_u32 s39, s39, s32
    buffer_load_dwordx4 v240, s[12:15], s39 offen lds
    s_add_u32 m0, m0, 1024
    s_add_u32 s39, s39, s32
    buffer_load_dwordx4 v239, s[12:15], s39 offen lds
    s_add_u32 m0, m0, 1024
    s_add_u32 s39, s39, s32
    buffer_load_dwordx4 v240, s[12:15], s39 offen lds
    s_mov_b32 m0, s19
    s_mov_b32 s39, s16
    s_mov_b32 s32, s17
    s_mov_b32 s3, s18
    s_waitcnt vmcnt(8)
    s_barrier
    buffer_load_dwordx4 v239, s[12:15], s39 offen lds
    s_add_u32 m0, m0, 1024
    s_add_u32 s39, s39, s32
    buffer_load_dwordx4 v240, s[12:15], s39 offen lds
    s_add_u32 m0, m0, 1024
    s_add_u32 s39, s39, s32
    buffer_load_dwordx4 v239, s[12:15], s39 offen lds
    s_add_u32 m0, m0, 1024
    s_add_u32 s39, s39, s32
    buffer_load_dwordx4 v240, s[12:15], s39 offen lds
    s_add_u32 s43, s43, 1
    s_cmp_lt_u32 s43, 21
    s_cbranch_scc1 ld_75
    s_call_b64 s[76:77], PREP_w_issue_4
    s_add_u32 m0, m0, 1024
    s_add_u32 s39, s39, s3
    buffer_load_dwordx4 v239, s[12:15], s39 offen lds
    s_add_u32 m0, m0, 1024
    s_add_u32 s39, s39, s32
    buffer_load_dwordx4 v240, s[12:15], s39 offen lds
    s_add_u32 m0, m0, 1024
    s_add_u32 s39, s39, s32
    buffer_load_dwordx4 v239, s[12:15], s39 offen lds
    s_add_u32 m0, m0, 1024
    s_add_u32 s39, s39, s32
    buffer_load_dwordx4 v240, s[12:15], s39 offen lds
    s_mov_b32 m0, s19
    s_mov_b32 s39, s16
    s_mov_b32 s32, s17
    s_mov_b32 s3, s18
    s_waitcnt vmcnt(8)
    s_barrier
    buffer_load_dwordx4 v239, s[12:15], s39 offen lds
    s_add_u32 m0, m0, 1024
    s_add_u32 s39, s39, s32
    buffer_load_dwordx4 v240, s[12:15], s39 offen lds
    s_add_u32 m0, m0, 1024
    s_add_u32 s39, s39, s32
    buffer_load_dwordx4 v239, s[12:15], s39 offen lds
    s_add_u32 m0, m0, 1024
    s_add_u32 s39, s39, s32
    buffer_load_dwordx4 v240, s[12:15], s39 offen lds
    s_add_u32 m0, m0, 1024
    s_add_u32 s39, s39, s3
    buffer_load_dwordx4 v239, s[12:15], s39 offen lds
    s_add_u32 m0, m0, 1024
    s_add_u32 s39, s39, s32
    buffer_load_dwordx4 v240, s[12:15], s39 offen lds
    s_add_u32 m0, m0, 1024
    s_add_u32 s39, s39, s32
    buffer_load_dwordx4 v239, s[12:15], s39 offen lds
    s_add_u32 m0, m0, 1024
    s_add_u32 s39, s39, s32
    buffer_load_dwordx4 v240, s[12:15], s39 offen lds
    s_waitcnt vmcnt(8)
    s_barrier
    s_waitcnt vmcnt(0)
    s_barrier
    s_branch K_fin
NEXT:
    s_setprio 0
    s_add_u32 s60, s60, 1
    s_add_u32 s55, s55, 4194304
    s_add_u32 s62, s62, 4194304
    s_addc_u32 s63, s63, 0
    s_branch LAYER
K_fin:
    s_endpgm
SUB_w1_regs:
    s_mov_b64 s[12:13], s[68:69]
    s_mov_b32 s14, 2097152
    s_mov_b32 s15, 0x20000
    s_and_b32 s35, s30, 3
    s_mul_i32 s35, s35, 294912
    s_lshl_b32 s39, s99, 7
    s_add_u32 s39, s39, s35
    buffer_load_dwordx4 v[176:179], v238, s[12:15], s39 offen
    s_add_u32 s39, s39, 16384
    buffer_load_dwordx4 v[188:191], v238, s[12:15], s39 offen
    s_add_u32 s39, s39, 16384
    buffer_load_dwordx4 v[192:195], v238, s[12:15], s39 offen
    s_add_u32 s39, s39, 16384
    buffer_load_dwordx4 v[200:203], v238, s[12:15], s39 offen
    s_add_u32 s39, s39, 16384
    s_waitcnt vmcnt(8)
    buffer_load_dwordx4 v[204:207], v238, s[12:15], s39 offen
    s_add_u32 s39, s39, 16384
    buffer_load_dwordx4 v[208:211], v238, s[12:15], s39 offen
    s_add_u32 s39, s39, 16384
    buffer_load_dwordx4 v[212:215], v238, s[12:15], s39 offen
    s_add_u32 s39, s39, 16384
    buffer_load_dwordx4 v[216:219], v238, s[12:15], s39 offen
    s_add_u32 s39, s39, 16384
    s_waitcnt vmcnt(8)
    buffer_load_dwordx4 v[220:223], v238, s[12:15], s39 offen
    s_add_u32 s39, s39, 16384
    buffer_load_dwordx4 v[224:227], v238, s[12:15], s39 offen
    s_add_u32 s39, s39, 16384
    buffer_load_dwordx4 v[16:19], v238, s[12:15], s39 offen
    s_add_u32 s39, s39, 16384
    buffer_load_dwordx4 v[20:23], v238, s[12:15], s39 offen
    s_add_u32 s39, s39, 16384
    s_waitcnt vmcnt(8)
    buffer_load_dwordx4 v[24:27], v238, s[12:15], s39 offen
    s_add_u32 s39, s39, 16384
    buffer_load_dwordx4 v[28:31], v238, s[12:15], s39 offen
    s_add_u32 s39, s39, 16384
    buffer_load_dwordx4 v[32:35], v238, s[12:15], s39 offen
    s_add_u32 s39, s39, 16384
    buffer_load_dwordx4 v[36:39], v238, s[12:15], s39 offen
    s_add_u32 s39, s39, 16384
    s_waitcnt vmcnt(8)
    buffer_load_dwordx4 v[40:43], v238, s[12:15], s39 offen
    s_add_u32 s39, s39, 16384
    buffer_load_dwordx4 v[44:47], v238, s[12:15], s39 offen
    s_add_u32 s39, s39, 16384
    s_setpc_b64 s[76:77]
SUB_park:
    s_mov_b64 s[12:13], s[70:71]
    s_mov_b32 s14, 2097152
    s_mov_b32 s15, 0x20000
    s_and_b32 s35, s30, 3
    s_lshl_b32 s35, s35, 19
    s_lshl_b32 s39, s29, 7
    s_add_u32 s39, s39, s35
    buffer_load_dwordx4 v[48:51], v238, s[12:15], s39 offen
    s_add_u32 s39, s39, 16384
    buffer_load_dwordx4 v[52:55], v238, s[12:15], s39 offen
    s_add_u32 s39, s39, 16384
    buffer_load_dwordx4 v[56:59], v238, s[12:15], s39 offen
    s_add_u32 s39, s39, 16384
    buffer_load_dwordx4 v[60:63], v238, s[12:15], s39 offen
    s_add_u32 s39, s39, 16384
    s_waitcnt vmcnt(8)
    buffer_load_dwordx4 v[64:67], v238, s[12:15], s39 offen
    s_add_u32 s39, s39, 16384
    buffer_load_dwordx4 v[68:71], v238, s[12:15], s39 offen
    s_add_u32 s39, s39, 16384
    buffer_load_dwordx4 v[72:75], v238, s[12:15], s39 offen
    s_add_u32 s39, s39, 16384
    buffer_load_dwordx4 v[76:79], v238, s[12:15], s39 offen
    s_add_u32 s39, s39, 16384
    s_waitcnt vmcnt(8)
    buffer_load_dwordx4 v[80:83], v238, s[12:15], s39 offen
    s_add_u32 s39, s39, 16384
    buffer_load_dwordx4 v[84:87], v238, s[12:15], s39 offen
    s_add_u32 s39, s39, 16384
    buffer_load_dwordx4 v[88:91], v238, s[12:15], s39 offen
    s_add_u32 s39, s39, 16384
    buffer_load_dwordx4 v[92:95], v238, s[12:15], s39 offen
    s_add_u32 s39, s39, 16384
    s_waitcnt vmcnt(8)
    buffer_load_dwordx4 v[96:99], v238, s[12:15], s39 offen
    s_add_u32 s39, s39, 16384
    buffer_load_dwordx4 v[100:103], v238, s[12:15], s39 offen
    s_add_u32 s39, s39, 16384
    buffer_load_dwordx4 v[104:107], v238, s[12:15], s39 offen
    s_add_u32 s39, s39, 16384
    buffer_load_dwordx4 v[108:111], v238, s[12:15], s39 offen
    s_add_u32 s39, s39, 16384
    s_waitcnt vmcnt(8)
    buffer_load_dwordx4 v[112:115], v238, s[12:15], s39 offen
    s_add_u32 s39, s39, 16384
    buffer_load_dwordx4 v[116:119], v238, s[12:15], s39 offen
    s_add_u32 s39, s39, 16384
    buffer_load_dwordx4 v[120:123], v238, s[12:15], s39 offen
    s_add_u32 s39, s39, 16384
    buffer_load_dwordx4 v[124:127], v238, s[12:15], s39 offen
    s_add_u32 s39, s39, 16384
    s_waitcnt vmcnt(8)
    buffer_load_dwordx4 v[128:131], v238, s[12:15], s39 offen
    s_add_u32 s39, s39, 16384
    buffer_load_dwordx4 v[132:135], v238, s[12:15], s39 offen
    s_add_u32 s39, s39, 16384
    buffer_load_dwordx4 v[136:139], v238, s[12:15], s39 offen
    s_add_u32 s39, s39, 16384
    buffer_load_dwordx4 v[140:143], v238, s[12:15], s39 offen
    s_add_u32 s39, s39, 16384
    s_waitcnt vmcnt(8)
    s_setpc_b64 s[76:77]
SUB_park2:
    s_mov_b64 s[12:13], s[70:71]
    s_mov_b32 s14, 2097152
    s_mov_b32 s15, 0x20000
    s_and_b32 s35, s30, 3
    s_lshl_b32 s35, s35, 19
    s_lshl_b32 s39, s29, 7
    s_add_u32 s39, s39, s35
    s_add_u32 s39, s39, 393216
    buffer_load_dwordx4 v[144:147], v238, s[12:15], s39 offen
    s_add_u32 s39, s39, 16384
    buffer_load_dwordx4 v[148:151], v238, s[12:15], s39 offen
    s_add_u32 s39, s39, 16384
    buffer_load_dwordx4 v[152:155], v238, s[12:15], s39 offen
    s_add_u32 s39, s39, 16384
    buffer_load_dwordx4 v[156:159], v238, s[12:15], s39 offen
    s_add_u32 s39, s39, 16384
    s_waitcnt vmcnt(8)
    buffer_load_dwordx4 v[160:163], v238, s[12:15], s39 offen
    s_add_u32 s39, s39, 16384
    buffer_load_dwordx4 v[164:167], v238, s[12:15], s39 offen
    s_add_u32 s39, s39, 16384
    buffer_load_dwordx4 v[168:171], v238, s[12:15], s39 offen
    s_add_u32 s39, s39, 16384
    buffer_load_dwordx4 v[172:175], v238, s[12:15], s39 offen
    s_add_u32 s39, s39, 16384
    s_waitcnt vmcnt(8)
    s_setpc_b64 s[76:77]
SUB_w1_put:
    s_and_b32 s35, s30, 3
    s_mul_i32 s35, s35, 18432
    v_add_u32 v8, s35, v2
    v_mov_b32 v6, 162836
spin_76:
    s_sleep 2
    ds_read_b32 v7, v6
    s_waitcnt lgkmcnt(0)
    v_readfirstlane_b32 s53, v7
    s_nop 0
    s_cmp_ge_u32 s53, 8
    s_cbranch_scc0 spin_76
    s_waitcnt vmcnt(24)
    ds_write_b128 v8, v[176:179] offset:24576
    ds_write_b128 v8, v[188:191] offset:25600
    ds_write_b128 v8, v[192:195] offset:26624
    ds_write_b128 v8, v[200:203] offset:27648
    ds_write_b128 v8, v[204:207] offset:28672
    ds_write_b128 v8, v[208:211] offset:29696
    ds_write_b128 v8, v[212:215] offset:30720
    ds_write_b128 v8, v[216:219] offset:31744
    ds_write_b128 v8, v[220:223] offset:32768
    ds_write_b128 v8, v[224:227] offset:33792
    ds_write_b128 v8, v[16:19] offset:34816
    ds_write_b128 v8, v[20:23] offset:35840
    ds_write_b128 v8, v[24:27] offset:36864
    ds_write_b128 v8, v[28:31] offset:37888
    ds_write_b128 v8, v[32:35] offset:38912
    ds_write_b128 v8, v[36:39] offset:39936
    ds_write_b128 v8, v[40:43] offset:40960
    ds_write_b128 v8, v[44:47] offset:41984
    s_waitcnt lgkmcnt(0)
    s_setpc_b64 s[76:77]
SUB_after_g1:
    s_mov_b64 s[12:13], s[72:73]
    s_mov_b32 s14, 7340032
    s_mov_b32 s15, 0x20000
    v_readlane_b32 s36, v251, 0
    v_readlane_b32 s37, v251, 1
    v_readlane_b32 s34, v251, 2
    s_and_b32 s35, s30, 3
    s_mul_i32 s38, s35, 114688
    s_mul_i32 s39, s29, 448
    s_add_u32 s38, s38, s39
    s_and_b32 s36, s36, 15
    s_mul_i32 s36, s36, 458752
    s_add_u32 s36, s36, s38
    s_and_b32 s37, s37, 15
    s_mul_i32 s37, s37, 458752
    s_add_u32 s37, s37, s38
    s_and_b32 s34, s34, 15
    s_mul_i32 s34, s34, 458752
    s_add_u32 s34, s34, s38
    s_mul_i32 s39, s35, 7168
    s_add_u32 m0, s39, 131072
    s_nop 0
    buffer_load_dwordx4 v241, s[12:15], s36 offen lds
    s_add_u32 m0, m0, 1024
    s_nop 0
    buffer_load_dwordx4 v242, s[12:15], s36 offen lds
    s_add_u32 m0, m0, 1024
    s_nop 0
    buffer_load_dwordx4 v243, s[12:15], s36 offen lds
    s_add_u32 m0, m0, 1024
    s_nop 0
    buffer_load_dwordx4 v244, s[12:15], s36 offen lds
    s_add_u32 m0, m0, 1024
    s_nop 0
    buffer_load_dwordx4 v245, s[12:15], s36 offen lds
    s_add_u32 m0, m0, 1024
    s_nop 0
    buffer_load_dwordx4 v246, s[12:15], s36 offen lds
    s_add_u32 m0, m0, 1024
    s_nop 0
    buffer_load_dwordx4 v247, s[12:15], s36 offen lds
    buffer_load_dwordx4 v[176:179], v241, s[12:15], s37 offen
    buffer_load_dwordx4 v[180:183], v242, s[12:15], s37 offen
    buffer_load_dwordx4 v[184:187], v243, s[12:15], s37 offen
    buffer_load_dwordx4 v[188:191], v244, s[12:15], s37 offen
    buffer_load_dwordx4 v[192:195], v245, s[12:15], s37 offen
    buffer_load_dwordx4 v[196:199], v246, s[12:15], s37 offen
    buffer_load_dwordx4 v[200:203], v247, s[12:15], s37 offen
    s_lshr_b32 s36, s67, 2
    s_sub_u32 s36, s35, s36
    s_and_b32 s36, s36, 3
    s_lshl_b32 s36, s36, 15
    v_add_u32 v6, s36, v2
    s_waitcnt vmcnt(14)
    ds_write_b128 v6, v[48:51] offset:0
    ds_write_b128 v6, v[52:55] offset:1024
    ds_write_b128 v6, v[56:59] offset:2048
    ds_write_b128 v6, v[60:63] offset:3072
    ds_write_b128 v6, v[64:67] offset:4096
    ds_write_b128 v6, v[68:71] offset:5120
    ds_write_b128 v6, v[72:75] offset:6144
    ds_write_b128 v6, v[76:79] offset:7168
    ds_write_b128 v6, v[80:83] offset:8192
    ds_write_b128 v6, v[84:87] offset:9216
    ds_write_b128 v6, v[88:91] offset:10240
    ds_write_b128 v6, v[92:95] offset:11264
    ds_write_b128 v6, v[96:99] offset:12288
    ds_write_b128 v6, v[100:103] offset:13312
    ds_write_b128 v6, v[104:107] offset:14336
    ds_write_b128 v6, v[108:111] offset:15360
    ds_write_b128 v6, v[112:115] offset:16384
    ds_write_b128 v6, v[116:119] offset:17408
    ds_write_b128 v6, v[120:123] offset:18432
    ds_write_b128 v6, v[124:127] offset:19456
    ds_write_b128 v6, v[128:131] offset:20480
    ds_write_b128 v6, v[132:135] offset:21504
    ds_write_b128 v6, v[136:139] offset:22528
    ds_write_b128 v6, v[140:143] offset:23552
    ds_write_b128 v6, v[144:147] offset:24576
    ds_write_b128 v6, v[148:151] offset:25600
    ds_write_b128 v6, v[152:155] offset:26624
    ds_write_b128 v6, v[156:159] offset:27648
    ds_write_b128 v6, v[160:163] offset:28672
    ds_write_b128 v6, v[164:167] offset:29696
    ds_write_b128 v6, v[168:171] offset:30720
    ds_write_b128 v6, v[172:175] offset:31744
    s_waitcnt lgkmcnt(0)
    s_setpc_b64 s[76:77]
SUB_after_g2:
    s_and_b32 s35, s30, 3
    s_mul_i32 s39, s35, 7168
    s_add_u32 s39, s39, 73728
    v_add_u32 v7, s39, v2
    ds_write_b128 v7, v[176:179] offset:0
    ds_write_b128 v7, v[180:183] offset:1024
    ds_write_b128 v7, v[184:187] offset:2048
    ds_write_b128 v7, v[188:191] offset:3072
    ds_write_b128 v7, v[192:195] offset:4096
    ds_write_b128 v7, v[196:199] offset:5120
    ds_write_b128 v7, v[200:203] offset:6144
    s_waitcnt lgkmcnt(0)
    s_setpc_b64 s[76:77]
SUB_r_pre:
    v_and_b32 v199, 7, v0
    v_lshrrev_b32 v228, 6, v0
    v_lshlrev_b32 v228, 4, v228
    v_bfe_u32 v229, v0, 3, 3
    v_add_u32 v228, v228, v229
    s_lshr_b32 s78, s29, 1
    s_lshl_b32 s78, s78, 16
    s_and_b32 s79, s29, 1
    s_lshl_b32 s79, s79, 7
    s_add_u32 s78, s78, s79
    s_lshr_b32 s79, s30, 1
    s_lshl_b32 s79, s79, 13
    s_add_u32 s78, s78, s79
    v_lshlrev_b32 v196, 8, v228
    v_lshl_add_u32 v196, v199, 4, v196
    v_add_u32 v196, s78, v196
    s_mov_b32 s84, s62
    s_mov_b32 s85, s63
    s_mov_b32 s86, 0x7e000
    s_mov_b32 s87, 0x20000
    s_add_u32 s88, s62, 0x80000
    s_addc_u32 s89, s63, 0
    s_mov_b32 s90, 0x7e000
    s_mov_b32 s91, 0x20000
    buffer_load_dwordx4 v[180:183], v196, s[84:87], 0 offen offset:0 sc1
    buffer_load_dwordx4 v[188:191], v196, s[88:91], 0 offen offset:0 sc1
    buffer_load_dwordx4 v[184:187], v196, s[84:87], 0 offen offset:2048 sc1
    buffer_load_dwordx4 v[192:195], v196, s[88:91], 0 offen offset:2048 sc1
    s_setpc_b64 s[76:77]
SUB_w_issue_1:
    s_add_u32 s19, s41, s42
    s_mul_i32 s16, s44, 131072
    s_add_u32 s16, s16, s38
    s_add_u32 s44, s44, 1
    s_and_b32 s44, s44, 15
    s_add_u32 s42, s42, 8192
    s_cmp_eq_u32 s42, 131072
    s_cselect_b32 s42, 0, s42
    s_mov_b32 m0, s19
    s_mov_b32 s39, s16
    buffer_load_dwordx4 v238, s[12:15], s39 offen lds
    s_add_u32 m0, m0, 1024
    s_add_u32 s39, s39, 16384
    buffer_load_dwordx4 v238, s[12:15], s39 offen lds
    s_add_u32 m0, m0, 1024
    s_add_u32 s39, s39, 16384
    buffer_load_dwordx4 v238, s[12:15], s39 offen lds
    s_add_u32 m0, m0, 1024
    s_add_u32 s39, s39, 16384
    buffer_load_dwordx4 v238, s[12:15], s39 offen lds
    s_setpc_b64 s[76:77]
PREP_a_issue_4:
    s_add_u32 s19, s41, s42
    v_readlane_b32 s16, v249, s44
    v_readlane_b32 s17, v250, s44
    s_add_u32 s16, s16, s38
    s_add_u32 s17, s17, s38
    s_add_u32 s44, s44, 1
    s_add_u32 s42, s42, 16384
    s_cmp_eq_u32 s42, 49152
    s_cselect_b32 s42, 0, s42
    s_setpc_b64 s[76:77]
PREP_w_issue_4:
    s_mov_b32 s45, 8192
    s_add_u32 s19, s41, s42
    v_readlane_b32 s16, v249, s44
    s_nop 0
    s_bitcmp1_b32 s16, 0
    s_cselect_b32 s17, 16384, s45
    s_cselect_b32 s18, -40960, s45
    s_andn2_b32 s16, s16, 1
    s_add_u32 s16, s16, s38
    s_add_u32 s44, s44, 1
    s_add_u32 s42, s42, 16384
    s_cmp_eq_u32 s42, 98304
    s_cselect_b32 s42, 0, s42
    s_setpc_b64 s[76:77]
K_end:
    s_endpgm
.p2align 6
K_tab:
.short 4096,5137,6178,11379,18660,25941,40502,33223,47784,55065,19706,12427,26988,34269,48830,41551,56096,9264,20736,10448,23824,25008,38384,35296,39568,49856,54128,52944,0,0,0,0
.short 4096,5137,6178,18659,11380,25941,33222,47783,40504,55065,12426,26987,19708,34269,41550,56111,48816,9264,10448,23824,20736,25008,35296,39568,38384,49856,52944,54128,0,0,0,0
.short 4096,5137,6178,11379,25940,18661,33222,40503,55064,47785,12426,19707,34268,26989,41550,48831,9264,56096,10448,20736,25008,23824,35296,38384,49856,39568,52944,54128,0,0,0,0
.short 4096,5137,6178,11379,18660,33221,25942,40503,47784,12425,55066,19707,26988,41549,34270,48831,56096,10448,9264,20736,23824,35296,25008,38384,39568,52944,49856,54128,0,0,0,0
.short 11377,12418,13459,18660,4101,25942,33223,47784,40505,55066,5147,26988,19709,34270,41551,56096,48816,6176,10288,23824,20736,25008,35296,39568,38384,49856,52944,54128,0,0,0,0
.short 11377,12418,13459,4100,25941,18662,33223,40504,55065,47786,5147,19708,34269,26990,41551,48816,6176,56096,10288,20736,25008,23824,35296,38384,49856,39568,52944,54128,0,0,0,0
.short 11377,12418,13459,4100,18661,33222,25943,40504,47785,5146,55067,19708,26989,41550,34271,48816,56096,10288,6176,20736,23824,35296,25008,38384,39568,52944,49856,54128,0,0,0,0
.short 11377,12418,13459,4100,18661,25942,40503,33224,47785,55066,19707,5148,26989,34270,48831,41536,56096,6176,20736,10288,23824,25008,38384,35296,39568,49856,54128,52944,0,0,0,0
.short 18658,19699,20740,4101,25942,11383,33224,40505,55066,47787,5148,12429,34270,26991,41536,48817,6176,56096,9264,10448,25008,23824,35296,38384,49856,39568,52944,54128,0,0,0,0
.short 18658,19699,20740,4101,11382,33223,25944,40505,47786,5147,55068,12429,26990,41551,34256,48817,56096,9264,6176,10448,23824,35296,25008,38384,39568,52944,49856,54128,0,0,0,0
.short 18658,19699,20740,4101,11382,25943,40504,33225,47786,55067,12428,5149,26990,34271,48816,41537,56096,6176,10448,9264,23824,25008,38384,35296,39568,49856,54128,52944,0,0,0,0
.short 18658,19699,20740,11381,4102,25943,33224,47785,40506,55067,5148,26989,12430,34271,41536,56097,48816,6176,9264,23824,10448,25008,35296,39568,38384,49856,52944,54128,0,0,0,0
.short 25939,26980,28021,4102,11383,33224,18665,40506,47787,5148,55069,12430,19711,41536,34257,48818,56096,9264,6176,10448,20736,35296,24848,38384,39568,52944,49856,54128,0,0,0,0
.short 25939,26980,28021,4102,11383,18664,40505,33226,47787,55068,12429,5150,19711,34256,48817,41538,56096,6176,10448,9264,20736,24848,38384,35296,39568,49856,54128,52944,0,0,0,0
.short 25939,26980,28021,11382,4103,18664,33225,47786,40507,55068,5149,19710,12431,34256,41537,56098,48816,6176,9264,20736,10448,24848,35296,39568,38384,49856,52944,54128,0,0,0,0
.short 25939,26980,28021,4102,18663,11384,33225,40506,55067,47788,5149,12430,34271,19696,41537,48818,6176,56096,9264,10448,24848,20736,35296,38384,49856,39568,52944,54128,0,0,0,0
.short 33220,34261,35302,4103,11384,18665,40506,25947,47788,55069,12430,5151,19696,26977,48818,41539,56096,6176,10448,9264,20736,23824,38384,25008,39568,49856,54128,52944,0,0,0,0
.short 33220,34261,35302,11383,4104,18665,25946,47787,40508,55069,5150,19711,12416,26977,41538,56099,48816,6176,9264,20736,10448,23824,25008,39568,38384,49856,52944,54128,0,0,0,0
.short 33220,34261,35302,4103,18664,11385,25946,40507,55068,47789,5150,12431,26976,19697,41538,48819,6176,56096,9264,10448,23824,20736,25008,38384,49856,39568,52944,54128,0,0,0,0
.short 33220,34261,35302,4103,11384,25945,18666,40507,47788,5149,55070,12431,19696,41537,26978,48819,56096,9264,6176,10448,20736,25008,23824,38384,39568,52944,49856,54128,0,0,0,0
.short 40501,41542,42583,11384,4105,18666,25947,47788,33229,55070,5151,19696,12417,26978,34259,56100,48816,6176,9264,20736,10448,23824,25008,39408,35296,49856,52944,54128,0,0,0,0
.short 40501,41542,42583,4104,18665,11386,25947,33228,55069,47790,5151,12416,26977,19698,34259,48820,6176,56096,9264,10448,23824,20736,25008,35296,49856,39408,52944,54128,0,0,0,0
.short 40501,41542,42583,4104,11385,25946,18667,33228,47789,5150,55071,12416,19697,34258,26979,48820,56096,9264,6176,10448,20736,25008,23824,35296,39408,52944,49856,54128,0,0,0,0
.short 40501,41542,42583,4104,11385,18666,33227,25948,47789,55070,12431,5136,19697,26978,48819,34260,56096,6176,10448,9264,20736,23824,35296,25008,39408,49856,54128,52944,0,0,0,0
.short 47782,48823,49864,4105,18666,11387,25948,33229,55070,40511,5136,12417,26978,19699,34260,41541,6176,56096,9264,10448,23824,20736,25008,35296,39568,38384,52944,54128,0,0,0,0
.short 47782,48823,49864,4105,11386,25947,18668,33229,40510,5151,55056,12417,19698,34259,26980,41541,56096,9264,6176,10448,20736,25008,23824,35296,38384,52944,39568,54128,0,0,0,0
.short 47782,48823,49864,4105,11386,18667,33228,25949,40510,55071,12416,5137,19698,26979,41540,34261,56096,6176,10448,9264,20736,23824,35296,25008,38384,39568,54128,52944,0,0,0,0
.short 47782,48823,49864,11385,4106,18667,25948,40509,33230,55071,5136,19697,12418,26979,34260,56101,41536,6176,9264,20736,10448,23824,25008,38384,35296,39568,52944,54128,0,0,0,0
.short 55063,56104,57145,4106,11387,25948,18669,33230,40511,5136,47777,12418,19699,34260,26981,41542,48816,9264,6176,10448,20736,25008,23824,35296,38384,49856,39568,53968,0,0,0,0
.short 55063,56104,57145,4106,11387,18668,33229,25950,40511,47776,12417,5138,19699,26980,41541,34262,48816,6176,10448,9264,20736,23824,35296,25008,38384,39568,53968,49856,0,0,0,0
.short 55063,56104,57145,11386,4107,18668,25949,40510,33231,47776,5137,19698,12419,26980,34261,48822,41536,6176,9264,20736,10448,23824,25008,38384,35296,39568,49856,53968,0,0,0,0
.short 55063,56104,57145,4106,18667,11388,25949,33230,47791,40496,5137,12418,26979,19700,34261,41542,6176,48816,9264,10448,23824,20736,25008,35296,39568,38384,49856,53968,0,0,0,0
.short 4104,5145,6186,11387,18668,25949,40510,33231,47776,55057,19698,12419,26980,34261,48822,41543,56096,9264,20736,10448,23824,25008,38384,35296,39568,49856,54128,52944,0,0,0,0
.short 4104,5145,6186,18667,11388,25949,33230,47791,40496,55057,12418,26979,19700,34261,41542,56103,48816,9264,10448,23824,20736,25008,35296,39568,38384,49856,52944,54128,0,0,0,0
.short 4104,5145,6186,11387,25948,18669,33230,40511,55056,47777,12418,19699,34260,26981,41542,48823,9264,56096,10448,20736,25008,23824,35296,38384,49856,39568,52944,54128,0,0,0,0
.short 4104,5145,6186,11387,18668,33229,25950,40511,47776,12417,55058,19699,26980,41541,34262,48823,56096,10448,9264,20736,23824,35296,25008,38384,39568,52944,49856,54128,0,0,0,0
.short 11385,12426,13467,18668,4109,25950,33231,47776,40497,55058,5139,26980,19701,34262,41543,56104,48816,6176,10288,23824,20736,25008,35296,39568,38384,49856,52944,54128,0,0,0,0
.short 11385,12426,13467,4108,25949,18670,33231,40496,55057,47778,5139,19700,34261,26982,41543,48824,6176,56096,10288,20736,25008,23824,35296,38384,49856,39568,52944,54128,0,0,0,0
.short 11385,12426,13467,4108,18669,33230,25951,40496,47777,5138,55059,19700,26981,41542,34263,48824,56096,10288,6176,20736,23824,35296,25008,38384,39568,52944,49856,54128,0,0,0,0
.short 11385,12426,13467,4108,18669,25950,40511,33216,47777,55058,19699,5140,26981,34262,48823,41544,56096,6176,20736,10288,23824,25008,38384,35296,39568,49856,54128,52944,0,0,0,0
.short 18666,19707,20748,4109,25950,11391,33216,40497,55058,47779,5140,12421,34262,26983,41544,48825,6176,56096,9264,10448,25008,23824,35296,38384,49856,39568,52944,54128,0,0,0,0
.short 18666,19707,20748,4109,11390,33231,25936,40497,47778,5139,55060,12421,26982,41543,34264,48825,56096,9264,6176,10448,23824,35296,25008,38384,39568,52944,49856,54128,0,0,0,0
.short 18666,19707,20748,4109,11390,25951,40496,33217,47778,55059,12420,5141,26982,34263,48824,41545,56096,6176,10448,9264,23824,25008,38384,35296,39568,49856,54128,52944,0,0,0,0
.short 18666,19707,20748,11389,4110,25951,33216,47777,40498,55059,5140,26981,12422,34263,41544,56105,48816,6176,9264,23824,10448,25008,35296,39568,38384,49856,52944,54128,0,0,0,0
.short 25947,26988,28029,4110,11391,33216,18657,40498,47779,5140,55061,12422,19703,41544,34265,48826,56096,9264,6176,10448,20736,35296,24848,38384,39568,52944,49856,54128,0,0,0,0
.short 25947,26988,28029,4110,11391,18656,40497,33218,47779,55060,12421,5142,19703,34264,48825,41546,56096,6176,10448,9264,20736,24848,38384,35296,39568,49856,54128,52944,0,0,0,0
.short 25947,26988,28029,11390,4111,18656,33217,47778,40499,55060,5141,19702,12423,34264,41545,56106,48816,6176,9264,20736,10448,24848,35296,39568,38384,49856,52944,54128,0,0,0,0
.short 25947,26988,28029,4110,18671,11376,33217,40498,55059,47780,5141,12422,34263,19704,41545,48826,6176,56096,9264,10448,24848,20736,35296,38384,49856,39568,52944,54128,0,0,0,0
.short 33228,34269,35310,4111,11376,18657,40498,25939,47780,55061,12422,5143,19704,26985,48826,41547,56096,6176,10448,9264,20736,23824,38384,25008,39568,49856,54128,52944,0,0,0,0
.short 33228,34269,35310,11391,4096,18657,25938,47779,40500,55061,5142,19703,12424,26985,41546,56107,48816,6176,9264,20736,10448,23824,25008,39568,38384,49856,52944,54128,0,0,0,0
.short 33228,34269,35310,4111,18656,11377,25938,40499,55060,47781,5142,12423,26984,19705,41546,48827,6176,56096,9264,10448,23824,20736,25008,38384,49856,39568,52944,54128,0,0,0,0
.short 33228,34269,35310,4111,11376,25937,18658,40499,47780,5141,55062,12423,19704,41545,26986,48827,56096,9264,6176,10448,20736,25008,23824,38384,39568,52944,49856,54128,0,0,0,0
.short 40509,41550,42591,11376,4097,18658,25939,47780,33221,55062,5143,19704,12425,26986,34267,56108,48816,6176,9264,20736,10448,23824,25008,39408,35296,49856,52944,54128,0,0,0,0
.short 40509,41550,42591,4096,18657,11378,25939,33220,55061,47782,5143,12424,26985,19706,34267,48828,6176,56096,9264,10448,23824,20736,25008,35296,49856,39408,52944,54128,0,0,0,0
.short 40509,41550,42591,4096,11377,25938,18659,33220,47781,5142,55063,12424,19705,34266,26987,48828,56096,9264,6176,10448,20736,25008,23824,35296,39408,52944,49856,54128,0,0,0,0
.short 40509,41550,42591,4096,11377,18658,33219,25940,47781,55062,12423,5144,19705,26986,48827,34268,56096,6176,10448,9264,20736,23824,35296,25008,39408,49856,54128,52944,0,0,0,0
.short 47790,48831,49856,4097,18658,11379,25940,33221,55062,40503,5144,12425,26986,19707,34268,41549,6176,56096,9264,10448,23824,20736,25008,35296,39568,38384,52944,54128,0,0,0,0
.short 47790,48831,49856,4097,11378,25939,18660,33221,40502,5143,55064,12425,19706,34267,26988,41549,56096,9264,6176,10448,20736,25008,23824,35296,38384,52944,39568,54128,0,0,0,0
.short 47790,48831,49856,4097,11378,18659,33220,25941,40502,55063,12424,5145,19706,26987,41548,34269,56096,6176,10448,9264,20736,23824,35296,25008,38384,39568,54128,52944,0,0,0,0
.short 47790,48831,49856,11377,4098,18659,25940,40501,33222,55063,5144,19705,12426,26987,34268,56109,41536,6176,9264,20736,10448,23824,25008,38384,35296,39568,52944,54128,0,0,0,0
.short 55071,56096,57137,4098,11379,25940,18661,33222,40503,5144,47785,12426,19707,34268,26989,41550,48816,9264,6176,10448,20736,25008,23824,35296,38384,49856,39568,53968,0,0,0,0
.short 55071,56096,57137,4098,11379,18660,33221,25942,40503,47784,12425,5146,19707,26988,41549,34270,48816,6176,10448,9264,20736,23824,35296,25008,38384,39568,53968,49856,0,0,0,0
.short 55071,56096,57137,11378,4099,18660,25941,40502,33223,47784,5145,19706,12427,26988,34269,48830,41536,6176,9264,20736,10448,23824,25008,38384,35296,39568,49856,53968,0,0,0,0
.short 55071,56096,57137,4098,18659,11380,25941,33222,47783,40504,5145,12426,26987,19708,34269,41550,6176,48816,9264,10448,23824,20736,25008,35296,39568,38384,49856,53968,0,0,0,0
.section .rodata,"a"
.p2align 6
.amdhsa_kernel interleave_layers__ssm_conv_h3__mixer_s_mlp__prompt_kernel
  .amdhsa_next_free_vgpr 256
  .amdhsa_next_free_sgpr 102
  .amdhsa_accum_offset 256
  .amdhsa_group_segment_fixed_size 0
  .amdhsa_kernarg_size 112
  .amdhsa_user_sgpr_count 2
  .amdhsa_user_sgpr_kernarg_segment_ptr 1
  .amdhsa_system_sgpr_workgroup_id_x 1
  .amdhsa_float_denorm_mode_32 3
.end_amdhsa_kernel
```

```asm
; @launch grid=(256,1,1) block=(512,1,1) lds=163840
.amdgcn_target "amdgcn-amd-amdhsa--gfx950"
.text
.globl interleave_layers__ssm_conv_h3__mixer_s_mlp__prompt_kernel
.p2align 8
.type interleave_layers__ssm_conv_h3__mixer_s_mlp__prompt_kernel,@function
interleave_layers__ssm_conv_h3__mixer_s_mlp__prompt_kernel:
    s_cmp_ge_u32 s2, 256
    s_cbranch_scc1 K_end
    s_load_dwordx8 s[8:15], s[0:1], 8
    s_load_dwordx2 s[6:7], s[0:1], 0
    s_load_dwordx8 s[68:75], s[0:1], 56
    s_load_dwordx2 s[4:5], s[0:1], 104
    s_load_dwordx2 s[84:85], s[0:1], 96
    s_memrealtime s[46:47]
    s_load_dwordx2 s[96:97], s[0:1], 40
    v_lshrrev_b32 v1, 6, v0
    s_nop 0
    v_readfirstlane_b32 s30, v1
    s_getpc_b64 s[48:49]
K_pc:
    s_lshr_b32 s36, s2, 3
    s_lshl_b32 s36, s36, 11
    v_lshlrev_b32 v4, 2, v0
    v_add_u32 v4, s36, v4
    v_cmp_gt_u32 vcc, K_end-K_pc-8, v4
    s_nop 0
    s_and_saveexec_b64 s[36:37], vcc
    s_cbranch_execz K_3
    v_mov_b32 v5, s49
    v_add_co_u32 v4, vcc, s48, v4
    s_nop 1
    v_addc_co_u32 v5, vcc, 0, v5, vcc
    global_load_dword v250, v[4:5], off
K_3:
    s_mov_b64 exec, -1
    v_and_b32 v6, 31, v0
    v_lshrrev_b32 v7, 5, v0
    s_and_b32 s34, s2, 7
    s_lshr_b32 s35, s2, 3
    s_lshl_b32 s36, s35, 17
    s_lshl_b32 s37, s34, 8
    s_add_u32 s36, s36, s37
    v_lshlrev_b32 v8, 13, v7
    v_lshl_add_u32 v8, v6, 3, v8
    v_add_u32 v12, s36, v8
    v_add_u32 v14, 4096, v12
    s_mov_b32 s18, 4194304
    s_mov_b32 s19, 0x20000
    s_mov_b32 s22, s18
    s_mov_b32 s23, s19
    s_waitcnt lgkmcnt(0)
    s_mov_b32 s86, 256
    s_mov_b32 s87, 0x20000
    v_mov_b32 v78, 0
    s_lshl_b32 s45, s2, 3
    s_add_u32 s45, s45, s30
    s_cmp_lg_u32 s45, 4
    s_cbranch_scc1 KV_t0
    s_getreg_b32 s45, hwreg(HW_REG_XCC_ID, 0, 3)
    s_lshl_b32 s45, s45, 1
    s_lshl_b32 s44, s46, 6
    s_or_b32 s44, s44, s45
    s_or_b32 s44, s44, 1
    v_mov_b32 v76, s44
    v_mov_b32 v77, 0
    s_mov_b64 exec, 1
    buffer_store_dwordx2 v[76:77], v78, s[84:87], 0 offen sc1
    s_mov_b64 exec, -1
KV_t0:
    s_mov_b64 s[16:17], s[8:9]
    s_mov_b64 s[20:21], s[10:11]
    buffer_load_dwordx2 v[28:29], v12, s[16:19], 0 offen offset:0 nt
    buffer_load_dwordx2 v[30:31], v12, s[16:19], 0 offen offset:2048 nt
    buffer_load_dwordx2 v[32:33], v14, s[16:19], 0 offen offset:0 nt
    buffer_load_dwordx2 v[34:35], v14, s[16:19], 0 offen offset:2048 nt
    buffer_load_dwordx2 v[36:37], v12, s[20:23], 0 offen offset:0 nt
    buffer_load_dwordx2 v[38:39], v12, s[20:23], 0 offen offset:2048 nt
    buffer_load_dwordx2 v[40:41], v14, s[20:23], 0 offen offset:0 nt
    buffer_load_dwordx2 v[42:43], v14, s[20:23], 0 offen offset:2048 nt
    v_subrev_u32 v9, 6144, v12
    v_subrev_u32 v10, 4096, v12
    v_subrev_u32 v11, 2048, v12
    s_lshl_b32 s37, s34, 10
    v_lshlrev_b32 v16, 5, v6
    v_add_u32 v16, s37, v16
    s_mov_b32 s24, s12
    s_mov_b32 s25, s13
    s_mov_b32 s26, 0x2000
    s_mov_b32 s27, 0x20000
    v_and_b32 v8, 1, v7
    v_lshl_add_u32 v16, v8, 4, v16
    buffer_load_dwordx4 v[44:47], v16, s[24:27], 0 offen
    s_cmp_lg_u32 s30, 4
    s_cbranch_scc1 KV_t2
    buffer_load_dword v76, v78, s[84:87], 0 offen sc1
KV_t2:
    s_bfm_b64 exec, 32, 0
    buffer_load_dwordx2 v[22:23], v9, s[16:19], 0 offen nt
    buffer_load_dwordx2 v[24:25], v10, s[16:19], 0 offen nt
    buffer_load_dwordx2 v[26:27], v11, s[16:19], 0 offen nt
    s_mov_b64 exec, -1
    v_and_b32 v1, 63, v0
    v_lshlrev_b32 v2, 4, v1
    v_lshlrev_b32 v3, 2, v1
    s_mov_b32 s67, 0
    s_mov_b32 s60, 0
    s_mov_b32 s61, 40000
    s_mov_b32 s52, 0
    s_mov_b32 s55, 0
    s_mov_b32 s92, 0
    s_mov_b32 s93, 0
    s_mov_b32 s94, 0
    s_mov_b32 s56, s4
    s_mov_b32 s57, s5
    s_mov_b32 s58, 0xa000000
    s_mov_b32 s59, 0x20000
    s_add_u32 s62, s4, 33554432
    s_addc_u32 s63, s5, 0
    s_and_b32 s41, s30, 3
    s_and_b32 s38, s2, 7
    s_lshl_b32 s38, s38, 5
    s_lshr_b32 s39, s2, 3
    s_add_u32 s38, s38, s39
    s_lshl_b32 s39, s38, 2
    s_add_u32 s39, s39, s41
    s_mul_i32 s40, s41, 24576
    s_lshr_b32 s36, s39, 1
    s_lshl_b32 s36, s36, 2
    s_load_dword s98, s[96:97], s36
    s_lshl_b32 s36, s39, 12
    s_add_u32 s12, s14, s36
    s_addc_u32 s13, s15, 0
    s_mov_b32 s14, 4096
    s_mov_b32 s15, 0x20000
    s_lshr_b32 s45, s30, 2
    s_lshl_b32 s45, s45, 11
    s_add_u32 s36, s45, 0xffffffc0
    v_add_u32 v70, s36, v2
    v_add_u32 v71, 16, v70
    s_add_u32 s36, s45, 0x3c0
    v_add_u32 v72, s36, v2
    v_add_u32 v73, 16, v72
    s_mov_b32 s36, 4032
    v_add_u32 v74, s36, v2
    v_add_u32 v75, 16, v74
    s_and_b32 s34, s2, 7
    s_lshr_b32 s35, s2, 3
    v_mov_b32 v80, 0
    v_mov_b32 v81, 0
    v_mov_b32 v82, 0
    v_mov_b32 v83, 0
    v_add_u32 v86, s40, v2
    ds_write_b128 v86, v[80:83] offset:22784
    s_bfm_b64 exec, 26, 0
    ds_write_b128 v86, v[80:83] offset:23808
    s_mov_b64 exec, -1
    v_lshlrev_b32 v8, 2, v7
    v_sub_u32 v8, 60, v8
    v_lshrrev_b32 v85, 3, v8
    v_bfe_u32 v84, v6, 1, 3
    v_xor_b32 v85, v85, v84
    v_lshlrev_b32 v85, 4, v85
    v_and_b32 v8, 7, v8
    v_lshl_add_u32 v85, v8, 1, v85
    v_lshl_add_u32 v84, v6, 9, v85
    v_add_u32 v84, 98304, v84
    s_waitcnt vmcnt(0)
    s_cmp_lg_u32 s30, 4
    s_cbranch_scc1 KV_t1
KV_t1:
    buffer_load_dwordx4 v[52:55], v70, s[12:15], 0 offen nt
    buffer_load_dwordx2 v[56:57], v71, s[12:15], 0 offen nt
    buffer_load_dwordx4 v[58:61], v72, s[12:15], 0 offen nt
    buffer_load_dwordx2 v[62:63], v73, s[12:15], 0 offen nt
    buffer_load_dwordx4 v[64:67], v74, s[12:15], 0 offen nt
    buffer_load_dwordx2 v[68:69], v75, s[12:15], 0 offen nt
    v_mov_b32 v48, v44
    v_mov_b32 v49, v45
    v_mov_b32 v50, v46
    v_mov_b32 v51, v47
    v_mov_b32 v126, v30
    v_mov_b32 v127, v31
    v_mov_b32 v128, v32
    v_mov_b32 v129, v33
    v_mov_b32 v130, v34
    v_mov_b32 v131, v35
    v_permlane32_swap_b32 v44, v48
    v_permlane32_swap_b32 v45, v49
    v_permlane32_swap_b32 v46, v50
    v_permlane32_swap_b32 v47, v51
    v_permlane32_swap_b32 v22, v126
    v_permlane32_swap_b32 v23, v127
    v_permlane32_swap_b32 v24, v128
    v_permlane32_swap_b32 v25, v129
    v_permlane32_swap_b32 v26, v130
    v_permlane32_swap_b32 v27, v131
    v_lshlrev_b32 v88, 16, v44
    v_and_b32 v90, 0xffff0000, v44
    v_lshlrev_b32 v92, 16, v45
    v_and_b32 v94, 0xffff0000, v45
    v_lshlrev_b32 v89, 16, v46
    v_and_b32 v91, 0xffff0000, v46
    v_lshlrev_b32 v93, 16, v47
    v_and_b32 v95, 0xffff0000, v47
    v_lshlrev_b32 v96, 16, v22
    v_and_b32 v97, 0xffff0000, v22
    v_lshlrev_b32 v98, 16, v24
    v_and_b32 v99, 0xffff0000, v24
    v_lshlrev_b32 v100, 16, v26
    v_and_b32 v101, 0xffff0000, v26
    v_lshlrev_b32 v102, 16, v28
    v_and_b32 v103, 0xffff0000, v28
    v_lshlrev_b32 v104, 16, v30
    v_and_b32 v105, 0xffff0000, v30
    v_lshlrev_b32 v106, 16, v32
    v_and_b32 v107, 0xffff0000, v32
    v_lshlrev_b32 v108, 16, v34
    v_and_b32 v109, 0xffff0000, v34
    v_lshlrev_b32 v110, 16, v36
    v_and_b32 v111, 0xffff0000, v36
    v_lshlrev_b32 v112, 16, v38
    v_and_b32 v113, 0xffff0000, v38
    v_lshlrev_b32 v114, 16, v40
    v_and_b32 v115, 0xffff0000, v40
    v_lshlrev_b32 v116, 16, v42
    v_and_b32 v117, 0xffff0000, v42
    v_pk_mul_f32 v[118:119], v[96:97], v[94:95]
    v_pk_mul_f32 v[120:121], v[98:99], v[94:95]
    v_pk_mul_f32 v[122:123], v[100:101], v[94:95]
    v_pk_mul_f32 v[124:125], v[102:103], v[94:95]
    v_pk_fma_f32 v[118:119], v[98:99], v[92:93], v[118:119]
    v_pk_fma_f32 v[120:121], v[100:101], v[92:93], v[120:121]
    v_pk_fma_f32 v[122:123], v[102:103], v[92:93], v[122:123]
    v_pk_fma_f32 v[124:125], v[104:105], v[92:93], v[124:125]
    v_pk_fma_f32 v[118:119], v[100:101], v[90:91], v[118:119]
    v_pk_fma_f32 v[120:121], v[102:103], v[90:91], v[120:121]
    v_pk_fma_f32 v[122:123], v[104:105], v[90:91], v[122:123]
    v_pk_fma_f32 v[124:125], v[106:107], v[90:91], v[124:125]
    v_pk_fma_f32 v[118:119], v[102:103], v[88:89], v[118:119]
    v_pk_fma_f32 v[120:121], v[104:105], v[88:89], v[120:121]
    v_pk_fma_f32 v[122:123], v[106:107], v[88:89], v[122:123]
    v_pk_fma_f32 v[124:125], v[108:109], v[88:89], v[124:125]
    v_pk_mul_f32 v[118:119], v[118:119], v[110:111]
    v_pk_mul_f32 v[120:121], v[120:121], v[112:113]
    v_pk_mul_f32 v[122:123], v[122:123], v[114:115]
    v_pk_mul_f32 v[124:125], v[124:125], v[116:117]
    v_cvt_pk_bf16_f32 v136, v124, v122
    v_cvt_pk_bf16_f32 v137, v120, v118
    ds_write_b64 v84, v[136:137] offset:0
    v_cvt_pk_bf16_f32 v138, v125, v123
    v_cvt_pk_bf16_f32 v139, v121, v119
    ds_write_b64 v84, v[138:139] offset:128
    v_lshlrev_b32 v88, 16, v48
    v_and_b32 v90, 0xffff0000, v48
    v_lshlrev_b32 v92, 16, v49
    v_and_b32 v94, 0xffff0000, v49
    v_lshlrev_b32 v89, 16, v50
    v_and_b32 v91, 0xffff0000, v50
    v_lshlrev_b32 v93, 16, v51
    v_and_b32 v95, 0xffff0000, v51
    v_lshlrev_b32 v96, 16, v23
    v_and_b32 v97, 0xffff0000, v23
    v_lshlrev_b32 v98, 16, v25
    v_and_b32 v99, 0xffff0000, v25
    v_lshlrev_b32 v100, 16, v27
    v_and_b32 v101, 0xffff0000, v27
    v_lshlrev_b32 v102, 16, v29
    v_and_b32 v103, 0xffff0000, v29
    v_lshlrev_b32 v104, 16, v31
    v_and_b32 v105, 0xffff0000, v31
    v_lshlrev_b32 v106, 16, v33
    v_and_b32 v107, 0xffff0000, v33
    v_lshlrev_b32 v108, 16, v35
    v_and_b32 v109, 0xffff0000, v35
    v_lshlrev_b32 v110, 16, v37
    v_and_b32 v111, 0xffff0000, v37
    v_lshlrev_b32 v112, 16, v39
    v_and_b32 v113, 0xffff0000, v39
    v_lshlrev_b32 v114, 16, v41
    v_and_b32 v115, 0xffff0000, v41
    v_lshlrev_b32 v116, 16, v43
    v_and_b32 v117, 0xffff0000, v43
    v_pk_mul_f32 v[118:119], v[96:97], v[94:95]
    v_pk_mul_f32 v[120:121], v[98:99], v[94:95]
    v_pk_mul_f32 v[122:123], v[100:101], v[94:95]
    v_pk_mul_f32 v[124:125], v[102:103], v[94:95]
    v_pk_fma_f32 v[118:119], v[98:99], v[92:93], v[118:119]
    v_pk_fma_f32 v[120:121], v[100:101], v[92:93], v[120:121]
    v_pk_fma_f32 v[122:123], v[102:103], v[92:93], v[122:123]
    v_pk_fma_f32 v[124:125], v[104:105], v[92:93], v[124:125]
    v_pk_fma_f32 v[118:119], v[100:101], v[90:91], v[118:119]
    v_pk_fma_f32 v[120:121], v[102:103], v[90:91], v[120:121]
    v_pk_fma_f32 v[122:123], v[104:105], v[90:91], v[122:123]
    v_pk_fma_f32 v[124:125], v[106:107], v[90:91], v[124:125]
    v_pk_fma_f32 v[118:119], v[102:103], v[88:89], v[118:119]
    v_pk_fma_f32 v[120:121], v[104:105], v[88:89], v[120:121]
    v_pk_fma_f32 v[122:123], v[106:107], v[88:89], v[122:123]
    v_pk_fma_f32 v[124:125], v[108:109], v[88:89], v[124:125]
    v_pk_mul_f32 v[118:119], v[118:119], v[110:111]
    v_pk_mul_f32 v[120:121], v[120:121], v[112:113]
    v_pk_mul_f32 v[122:123], v[122:123], v[114:115]
    v_pk_mul_f32 v[124:125], v[124:125], v[116:117]
    v_cvt_pk_bf16_f32 v140, v124, v122
    v_cvt_pk_bf16_f32 v141, v120, v118
    ds_write_b64 v84, v[140:141] offset:256
    v_cvt_pk_bf16_f32 v142, v125, v123
    v_cvt_pk_bf16_f32 v143, v121, v119
    ds_write_b64 v84, v[142:143] offset:384
    s_cmp_lg_u32 s30, 4
    s_cbranch_scc1 HB_2
    v_add_u32 v18, 162816, v3
    ds_write_b32 v18, v78
    s_mov_b32 s53, 0
    s_waitcnt vmcnt(6)
HB_p:
    v_readfirstlane_b32 s52, v76
    s_nop 0
    s_cmp_eq_u32 s52, 0
    s_cbranch_scc1 HB_r
    s_cmp_ge_u32 s53, 60
    s_cbranch_scc1 HB_q
    s_add_u32 s54, s46, 8192
    s_lshl_b32 s54, s54, 6
    s_sub_u32 s54, s54, s52
    s_cmp_lt_u32 s54, 786432
    s_cbranch_scc1 HB_q
HB_r:
    buffer_load_dword v76, v78, s[84:87], 0 offen sc1
    s_waitcnt vmcnt(0)
    s_add_u32 s53, s53, 1
    s_cmp_lt_u32 s53, s61
    s_cbranch_scc1 HB_p
    s_mov_b32 s52, 1
    s_mov_b32 s61, 0
HB_q:
    v_mov_b32 v18, 162828
    v_mov_b32 v19, s52
    s_waitcnt lgkmcnt(0)
    ds_write_b32 v18, v19
HB_2:
    s_add_u32 s16, s4, 0x2000000
    s_addc_u32 s17, s5, 0
    s_mov_b32 s18, 0x8000000
    s_mov_b32 s19, 0x20000
    v_lshrrev_b32 v8, 3, v0
    v_and_b32 v85, 7, v0
    v_lshlrev_b32 v149, 12, v8
    v_lshl_add_u32 v149, v85, 4, v149
    s_lshl_b32 s36, s34, 24
    s_sub_u32 s37, 31, s35
    s_lshl_b32 s37, s37, 7
    s_add_u32 s36, s36, s37
    s_add_u32 s37, s36, 262144
    v_lshrrev_b32 v148, 3, v8
    v_xor_b32 v148, v148, v85
    v_lshlrev_b32 v148, 4, v148
    v_lshl_add_u32 v148, v8, 7, v148
    v_add_u32 v148, 98304, v148
    v_mov_b32 v18, 162828
    s_waitcnt lgkmcnt(0)
    s_barrier
    ds_read_b128 v[152:155], v148 offset:0
    ds_read_b128 v[156:159], v148 offset:8192
    ds_read_b32 v19, v18
    s_waitcnt lgkmcnt(2)
    v_or_b32 v152, 1, v152
    buffer_store_dwordx4 v[152:155], v149, s[16:19], s36 offen sc1
    s_waitcnt lgkmcnt(1)
    v_or_b32 v156, 1, v156
    buffer_store_dwordx4 v[156:159], v149, s[16:19], s37 offen sc1
    s_waitcnt lgkmcnt(0)
    v_readfirstlane_b32 s52, v19
    s_cmp_lg_u32 s30, 0
    s_cbranch_scc1 KV_ni
    s_cmp_ge_u32 s35, 16
    s_cbranch_scc1 KV_ni
    v_mov_b32 v8, s52
    s_lshl_b32 s37, s34, 7
    s_lshl_b32 s53, s35, 10
    s_add_u32 s37, s37, s53
    s_add_u32 s37, s37, 23101440
    s_mov_b64 exec, 1
    buffer_store_dword v8, v78, s[56:59], s37 offen sc1
    s_mov_b64 exec, -1
KV_ni:
    s_cmp_ge_u32 s2, 32
    s_cbranch_scc1 KV_n3
    s_cmp_lg_u32 s30, 5
    s_cbranch_scc1 KV_n3
    s_and_b32 s42, s2, 7
    s_lshl_b32 s42, s42, 10
    s_lshr_b32 s43, s2, 3
    s_lshl_b32 s43, s43, 14
    s_add_u32 s42, s42, s43
    s_add_u32 s42, s42, 39714816
    v_lshrrev_b32 v8, 5, v1
    v_mul_u32_u24 v8, 7680, v8
    v_add_u32 v8, v8, v2
    buffer_store_dwordx4 v[80:83], v8, s[56:59], s42 offen sc1
KV_n3:
    s_bfe_u32 s32, s52, 0x30001
    s_add_u32 s32, s32, s2
    s_and_b32 s32, s32, 7
    s_lshr_b32 s33, s2, 3
    s_and_b32 s28, s32, 2
    s_lshr_b32 s53, s32, 2
    s_or_b32 s28, s28, s53
    s_lshl_b32 s28, s28, 2
    s_and_b32 s53, s33, 3
    s_add_u32 s28, s28, s53
    s_and_b32 s31, s32, 1
    s_lshr_b32 s33, s33, 2
    s_lshl_b32 s29, s31, 3
    s_add_u32 s29, s29, s33
    s_xor_b32 s99, s29, 1
    v_and_b32 v199, 7, v0
    v_lshrrev_b32 v228, 6, v0
    v_lshlrev_b32 v228, 4, v228
    v_bfe_u32 v229, v0, 3, 3
    v_add_u32 v228, v228, v229
    s_lshr_b32 s78, s29, 1
    s_lshl_b32 s78, s78, 16
    s_and_b32 s79, s29, 1
    s_lshl_b32 s79, s79, 7
    s_add_u32 s78, s78, s79
    s_lshr_b32 s79, s30, 1
    s_lshl_b32 s79, s79, 13
    s_add_u32 s78, s78, s79
    v_lshlrev_b32 v196, 8, v228
    v_lshl_add_u32 v196, v199, 4, v196
    v_add_u32 v196, s78, v196
    s_lshl_b32 s78, s28, 7
    s_lshl_b32 s79, s29, 3
    s_add_u32 s78, s78, s79
    v_add_u32 v197, s78, v199
    v_lshlrev_b32 v198, 11, v197
    v_lshrrev_b32 v229, 2, v228
    v_lshlrev_b32 v229, 3, v229
    v_and_b32 v228, 3, v228
    v_add_u32 v228, v228, v229
    v_lshl_add_u32 v198, v228, 3, v198
    v_and_b32 v197, 15, v197
    v_lshlrev_b32 v197, 4, v197
    v_and_b32 v229, 15, v228
    v_lshl_add_u32 v197, v229, 9, v197
    v_lshrrev_b32 v229, 4, v228
    v_lshl_add_u32 v197, v229, 14, v197
    s_lshr_b32 s78, s28, 3
    s_lshl_b32 s78, s78, 2
    s_and_b32 s79, s28, 3
    s_add_u32 s78, s78, s79
    s_lshl_b32 s78, s78, 24
    s_and_b32 s79, s28, 4
    s_lshl_b32 s79, s79, 11
    s_add_u32 s78, s78, s79
    s_and_b32 s79, s29, 4
    s_lshl_b32 s79, s79, 6
    s_add_u32 s78, s78, s79
    s_and_b32 s79, s29, 2
    s_lshl_b32 s79, s79, 2
    s_add_u32 s78, s78, s79
    s_lshl_b32 s79, s31, 18
    s_add_u32 s78, s78, s79
    v_add_u32 v197, s78, v197
    s_lshl_b32 s36, s34, 5
    s_add_u32 s36, s36, s35
    s_lshl_b32 s36, s36, 7
    s_add_u32 s36, s36, 23068672
    v_mov_b32 v18, 1
    v_mov_b32 v19, 162820
    v_mov_b32 v21, 0
    s_mov_b64 exec, 1
    s_waitcnt vmcnt(0)
    ds_add_rtn_u32 v20, v19, v18
    v_mov_b32 v19, s52
    s_waitcnt lgkmcnt(0)
    v_readfirstlane_b32 s54, v20
    s_nop 0
    s_and_b32 s54, s54, 7
    s_cmp_lg_u32 s54, 7
    s_cbranch_scc1 pub_1
    buffer_store_dword v19, v21, s[56:59], s36 offen sc1
pub_1:
    s_mov_b64 exec, -1
    s_mov_b32 s8, s6
    s_mov_b32 s9, s7
    s_mov_b32 s10, 0x400000
    s_mov_b32 s11, 0x20000
    buffer_load_dwordx2 v[180:181], v198, s[8:11], 0 offen offset:0 nt
    buffer_load_dwordx2 v[182:183], v198, s[8:11], 0 offen offset:32 nt
    buffer_load_dwordx2 v[184:185], v198, s[8:11], 0 offen offset:128 nt
    buffer_load_dwordx2 v[186:187], v198, s[8:11], 0 offen offset:160 nt
    v_add_u32 v160, s45, v86
    v_alignbit_b32 v88, v53, v52, 16
    v_mov_b32 v92, v53
    v_alignbit_b32 v96, v54, v53, 16
    v_alignbit_b32 v89, v54, v53, 16
    v_mov_b32 v93, v54
    v_alignbit_b32 v97, v55, v54, 16
    v_alignbit_b32 v90, v55, v54, 16
    v_mov_b32 v94, v55
    v_alignbit_b32 v98, v56, v55, 16
    v_alignbit_b32 v91, v56, v55, 16
    v_mov_b32 v95, v56
    v_alignbit_b32 v99, v57, v56, 16
    ds_write_b128 v160, v[88:91] offset:0
    ds_write_b128 v160, v[92:95] offset:4160
    ds_write_b128 v160, v[96:99] offset:8320
    ds_write_b128 v160, v[54:57] offset:12480
    v_alignbit_b32 v100, v59, v58, 16
    v_mov_b32 v104, v59
    v_alignbit_b32 v108, v60, v59, 16
    v_alignbit_b32 v101, v60, v59, 16
    v_mov_b32 v105, v60
    v_alignbit_b32 v109, v61, v60, 16
    v_alignbit_b32 v102, v61, v60, 16
    v_mov_b32 v106, v61
    v_alignbit_b32 v110, v62, v61, 16
    v_alignbit_b32 v103, v62, v61, 16
    v_mov_b32 v107, v62
    v_alignbit_b32 v111, v63, v62, 16
    ds_write_b128 v160, v[100:103] offset:1024
    ds_write_b128 v160, v[104:107] offset:5184
    ds_write_b128 v160, v[108:111] offset:9344
    ds_write_b128 v160, v[60:63] offset:13504
    v_alignbit_b32 v112, v65, v64, 16
    v_mov_b32 v116, v65
    v_alignbit_b32 v120, v66, v65, 16
    v_alignbit_b32 v113, v66, v65, 16
    v_mov_b32 v117, v66
    v_alignbit_b32 v121, v67, v66, 16
    v_alignbit_b32 v114, v67, v66, 16
    v_mov_b32 v118, v67
    v_alignbit_b32 v122, v68, v67, 16
    v_alignbit_b32 v115, v68, v67, 16
    v_mov_b32 v119, v68
    v_alignbit_b32 v123, v69, v68, 16
    s_mov_b64 exec, 0xf
    ds_write_b128 v86, v[112:115] offset:4096
    ds_write_b128 v86, v[116:119] offset:8256
    ds_write_b128 v86, v[120:123] offset:12416
    ds_write_b128 v86, v[66:69] offset:16576
    s_mov_b64 exec, -1
    s_waitcnt lgkmcnt(0)
    s_barrier
    v_mov_b32 v238, 0
    v_mov_b32 v239, 0
    v_mov_b32 v240, 0
    v_mov_b32 v241, 0
    v_mov_b32 v242, 0
    v_mov_b32 v243, 0
    v_mov_b32 v244, 0
    v_mov_b32 v245, 0
    v_mov_b32 v246, 0
    v_mov_b32 v247, 0
    s_cmp_ge_u32 s30, 4
    s_cbranch_scc1 FR_b
    s_and_b32 s38, s2, 7
    s_lshl_b32 s38, s38, 5
    s_lshr_b32 s39, s2, 3
    s_add_u32 s38, s38, s39
    s_lshl_b32 s39, s38, 2
    s_add_u32 s39, s39, s30
    s_mul_i32 s40, s30, 24576
    s_and_b32 s36, s39, 127
    s_lshl_b32 s36, s36, 12
    s_lshr_b32 s37, s39, 7
    s_lshl_b32 s37, s37, 24
    s_add_u32 s36, s36, s37
    s_add_u32 s36, s36, 33554432
    s_add_u32 s16, s4, s36
    s_addc_u32 s17, s5, 0
    s_mov_b32 s18, 4096
    s_mov_b32 s19, 0x20000
    v_lshrrev_b32 v6, 2, v1
    v_mul_u32_u24 v12, 96, v6
    v_and_b32 v6, 3, v1
    v_lshl_add_u32 v12, v6, 4, v12
    v_add_u32 v12, s40, v12
    v_and_b32 v35, 15, v1
    v_lshrrev_b32 v36, 4, v1
    v_and_b32 v6, 3, v35
    v_mul_u32_u24 v32, 4160, v6
    v_lshl_add_u32 v32, v36, 4, v32
    v_lshrrev_b32 v6, 2, v35
    v_lshl_add_u32 v32, v6, 3, v32
    v_add_u32 v32, s40, v32
    v_sub_u32 v6, 15, v35
    v_mul_u32_u24 v34, 96, v6
    v_add_u32 v34, s40, v34
    v_lshl_add_u32 v33, v36, 4, v34
    ds_read_b64 v[72:73], v32 offset:0
    ds_read_b64 v[74:75], v32 offset:8
    ds_read_b64 v[76:77], v32 offset:32
    ds_read_b64 v[78:79], v32 offset:40
    ds_read_b64 v[80:81], v32 offset:1024
    ds_read_b64 v[82:83], v32 offset:1032
    ds_read_b64 v[84:85], v32 offset:1056
    ds_read_b64 v[86:87], v32 offset:1064
    ds_read_b64 v[88:89], v32 offset:2048
    ds_read_b64 v[90:91], v32 offset:2056
    ds_read_b64 v[92:93], v32 offset:2080
    ds_read_b64 v[94:95], v32 offset:2088
    ds_read_b64 v[96:97], v32 offset:3072
    ds_read_b64 v[98:99], v32 offset:3080
    ds_read_b64 v[100:101], v32 offset:3104
    ds_read_b64 v[102:103], v32 offset:3112
    s_bitcmp1_b32 s39, 0
    s_cselect_b32 s36, 0, 16
    s_lshl_b32 s41, s98, s36
    s_and_b32 s41, s41, 0xffff0000
    s_lshr_b32 s36, s41, 16
    v_lshl_add_u32 v6, v36, 3, v35
    v_sub_u32 v6, 31, v6
    v_mov_b32 v10, s36
    v_mov_b32 v11, s41
    v_and_b32 v8, 1, v6
    v_cmp_eq_u32 vcc, 1, v8
    s_nop 1
    v_cndmask_b32 v10, v10, v11, vcc
    v_ashrrev_i32 v6, 1, v6
    v_cmp_eq_u32 vcc, 0, v6
    s_nop 1
    v_cndmask_b32 v152, 0, v10, vcc
    v_cmp_eq_u32 vcc, 1, v6
    s_nop 1
    v_cndmask_b32 v153, 0, v10, vcc
    v_cmp_eq_u32 vcc, 2, v6
    s_nop 1
    v_cndmask_b32 v154, 0, v10, vcc
    v_cmp_eq_u32 vcc, 3, v6
    s_nop 1
    v_cndmask_b32 v155, 0, v10, vcc
    v_cmp_eq_u32 vcc, 8, v6
    s_nop 1
    v_cndmask_b32 v156, 0, v10, vcc
    v_cmp_eq_u32 vcc, 9, v6
    s_nop 1
    v_cndmask_b32 v157, 0, v10, vcc
    v_cmp_eq_u32 vcc, 10, v6
    s_nop 1
    v_cndmask_b32 v158, 0, v10, vcc
    v_cmp_eq_u32 vcc, 11, v6
    s_nop 1
    v_cndmask_b32 v159, 0, v10, vcc
    s_add_u32 s12, s4, 0x2100000
    s_addc_u32 s13, s5, 0
    s_mov_b32 s14, 0x7f00000
    s_mov_b32 s15, 0x20000
    v_bfe_u32 v6, v1, 2, 2
    v_mul_u32_u24 v168, 24640, v6
    v_mul_u32_u24 v6, 72, v36
    v_add_u32 v168, v168, v6
    v_and_b32 v6, 3, v1
    v_lshl_add_u32 v168, v6, 3, v168
    s_mul_i32 s36, s30, 1152
    v_add_u32 v168, s36, v168
    v_lshrrev_b32 v6, 5, v1
    v_mul_u32_u24 v169, 261632, v6
    v_add_u32 v169, v169, v2
    s_lshr_b32 s44, s38, 4
    s_lshl_b32 s44, s44, 14
    s_and_b32 s37, s38, 15
    s_lshl_b32 s37, s37, 9
    s_add_u32 s44, s44, s37
    s_and_b32 s37, s30, 1
    s_lshl_b32 s37, s37, 13
    s_add_u32 s44, s44, s37
    s_lshr_b32 s37, s30, 1
    s_lshl_b32 s37, s37, 26
    s_add_u32 s44, s44, s37
    s_and_b32 s47, s44, 0x2000
    s_xor_b32 s47, s47, 8192
    s_lshr_b32 s37, s30, 1
    s_lshl_b32 s37, s37, 12
    s_add_u32 s47, s47, s37
    s_and_b32 s37, s2, 7
    s_lshl_b32 s37, s37, 7
    s_add_u32 s47, s47, s37
    v_mov_b32 v34, 162824
    v_mov_b32 v7, 1
    s_mul_i32 s36, s30, 24640
    v_mul_u32_u24 v170, 72, v35
    v_lshl_add_u32 v170, v36, 3, v170
    v_add_u32 v170, s36, v170
    v_lshlrev_b32 v6, 10, v1
    v_mov_b32 v35, 0
    s_and_b32 s45, s2, 31
    s_lshl_b32 s45, s45, 7
    s_add_u32 s45, s45, 23117824
    s_cmp_lg_u32 s30, 0
    s_cbranch_scc1 CV_w
    s_and_b32 s36, s2, 7
    s_lshl_b32 s36, s36, 12
    s_add_u32 s36, s36, 23068672
    v_lshlrev_b32 v9, 7, v1
    v_add_u32 v9, s36, v9
    s_mov_b32 s53, 0
    s_add_u32 s54, s52, 0
    s_bfm_b64 exec, 32, 0
poll_2:
    buffer_load_dword v8, v9, s[56:59], 0 offen sc1
    s_waitcnt vmcnt(0)
    v_xor_b32 v8, s54, v8
    v_cmp_eq_u32 vcc, 0, v8
    s_nop 0
    s_cmp_eq_u64 vcc, exec
    s_cbranch_scc1 pok_3
    s_sleep 5
    s_add_u32 s53, s53, 1
    s_cmp_lt_u32 s53, s61
    s_cbranch_scc1 poll_2
    s_mov_b32 s61, 0
pok_3:
    s_mov_b64 exec, -1
    v_mov_b32 v8, 162832
    v_mov_b32 v9, 1
    s_waitcnt lgkmcnt(0)
    ds_write_b32 v8, v9
CV_w:
    v_mov_b32 v8, 162832
spin_4:
    ds_read_b32 v9, v8
    s_waitcnt lgkmcnt(0)
    v_readfirstlane_b32 s53, v9
    s_nop 0
    s_cmp_ge_u32 s53, 1
    s_cbranch_scc0 spin_4
    buffer_load_dwordx4 v[16:19], v2, s[16:19], 0 offen offset:0 sc1 nt
    buffer_load_dwordx4 v[20:23], v2, s[16:19], 0 offen offset:1024 sc1 nt
    buffer_load_dwordx4 v[24:27], v2, s[16:19], 0 offen offset:2048 sc1 nt
    buffer_load_dwordx4 v[28:31], v2, s[16:19], 0 offen offset:3072 sc1 nt
    s_waitcnt vmcnt(3)
    ds_write_b128 v12, v[16:19] offset:16640
    s_waitcnt vmcnt(2)
    ds_write_b128 v12, v[20:23] offset:18176
    s_waitcnt vmcnt(1)
    ds_write_b128 v12, v[24:27] offset:19712
    s_waitcnt vmcnt(0)
    ds_write_b128 v12, v[28:31] offset:21248
    v_mov_b32 v8, 162836
    v_mov_b32 v9, 1
    s_mov_b64 exec, 1
    ds_add_u32 v8, v9
    s_mov_b64 exec, -1
    s_waitcnt lgkmcnt(0)
    ds_read_b128 v[136:139], v33 offset:21248
    ds_read_b128 v[140:143], v33 offset:19712
    ds_read_b128 v[144:147], v33 offset:18176
    ds_read_b128 v[148:151], v33 offset:16640
    s_waitcnt lgkmcnt(3)
    v_mfma_f32_16x16x32_bf16 v[40:43], v[152:155], v[136:139], 0
    v_mfma_f32_16x16x32_bf16 v[44:47], v[156:159], v[136:139], 0
    s_waitcnt lgkmcnt(2)
    v_mfma_f32_16x16x32_bf16 v[48:51], v[152:155], v[140:143], 0
    v_mfma_f32_16x16x32_bf16 v[52:55], v[156:159], v[140:143], 0
    s_waitcnt lgkmcnt(1)
    v_mfma_f32_16x16x32_bf16 v[56:59], v[152:155], v[144:147], 0
    v_mfma_f32_16x16x32_bf16 v[60:63], v[156:159], v[144:147], 0
    s_waitcnt lgkmcnt(0)
    v_mfma_f32_16x16x32_bf16 v[64:67], v[152:155], v[148:151], 0
    v_mfma_f32_16x16x32_bf16 v[68:71], v[156:159], v[148:151], 0
    s_mov_b32 s43, 0
CV_r:
    s_waitcnt lgkmcnt(0)
    v_mfma_f32_16x16x32_bf16 v[40:43], v[72:75], v[136:139], v[40:43]
    v_mfma_f32_16x16x32_bf16 v[48:51], v[72:75], v[140:143], v[48:51]
    v_mfma_f32_16x16x32_bf16 v[56:59], v[72:75], v[144:147], v[56:59]
    v_mfma_f32_16x16x32_bf16 v[64:67], v[72:75], v[148:151], v[64:67]
    v_mfma_f32_16x16x32_bf16 v[44:47], v[76:79], v[136:139], v[44:47]
    v_mfma_f32_16x16x32_bf16 v[52:55], v[76:79], v[140:143], v[52:55]
    v_mfma_f32_16x16x32_bf16 v[60:63], v[76:79], v[144:147], v[60:63]
    v_mfma_f32_16x16x32_bf16 v[68:71], v[76:79], v[148:151], v[68:71]
    v_mfma_f32_16x16x32_bf16 v[48:51], v[80:83], v[136:139], v[48:51]
    v_mfma_f32_16x16x32_bf16 v[56:59], v[80:83], v[140:143], v[56:59]
    v_mfma_f32_16x16x32_bf16 v[64:67], v[80:83], v[144:147], v[64:67]
    v_mfma_f32_16x16x32_bf16 v[52:55], v[84:87], v[136:139], v[52:55]
    v_mfma_f32_16x16x32_bf16 v[60:63], v[84:87], v[140:143], v[60:63]
    v_mfma_f32_16x16x32_bf16 v[68:71], v[84:87], v[144:147], v[68:71]
    v_mfma_f32_16x16x32_bf16 v[56:59], v[88:91], v[136:139], v[56:59]
    v_mfma_f32_16x16x32_bf16 v[64:67], v[88:91], v[140:143], v[64:67]
    v_mfma_f32_16x16x32_bf16 v[60:63], v[92:95], v[136:139], v[60:63]
    v_mfma_f32_16x16x32_bf16 v[68:71], v[92:95], v[140:143], v[68:71]
    v_mfma_f32_16x16x32_bf16 v[64:67], v[96:99], v[136:139], v[64:67]
    v_mfma_f32_16x16x32_bf16 v[68:71], v[100:103], v[136:139], v[68:71]
    ds_read_b128 v[152:155], v33 offset:21344
    ds_read_b128 v[156:159], v33 offset:19808
    ds_read_b128 v[160:163], v33 offset:18272
    ds_read_b128 v[164:167], v33 offset:16736
    ds_read_b64 v[104:105], v32 offset:64
    ds_read_b64 v[106:107], v32 offset:72
    ds_read_b64 v[108:109], v32 offset:96
    ds_read_b64 v[110:111], v32 offset:104
    ds_read_b64 v[112:113], v32 offset:1088
    ds_read_b64 v[114:115], v32 offset:1096
    ds_read_b64 v[116:117], v32 offset:1120
    ds_read_b64 v[118:119], v32 offset:1128
    ds_read_b64 v[120:121], v32 offset:2112
    ds_read_b64 v[122:123], v32 offset:2120
    ds_read_b64 v[124:125], v32 offset:2144
    ds_read_b64 v[126:127], v32 offset:2152
    ds_read_b64 v[128:129], v32 offset:3136
    ds_read_b64 v[130:131], v32 offset:3144
    ds_read_b64 v[132:133], v32 offset:3168
    ds_read_b64 v[134:135], v32 offset:3176
    s_waitcnt lgkmcnt(0)
    v_mfma_f32_16x16x32_bf16 v[40:43], v[104:107], v[152:155], v[40:43]
    v_mfma_f32_16x16x32_bf16 v[48:51], v[104:107], v[156:159], v[48:51]
    v_mfma_f32_16x16x32_bf16 v[56:59], v[104:107], v[160:163], v[56:59]
    v_mfma_f32_16x16x32_bf16 v[64:67], v[104:107], v[164:167], v[64:67]
    v_mfma_f32_16x16x32_bf16 v[44:47], v[108:111], v[152:155], v[44:47]
    v_mfma_f32_16x16x32_bf16 v[52:55], v[108:111], v[156:159], v[52:55]
    v_mfma_f32_16x16x32_bf16 v[60:63], v[108:111], v[160:163], v[60:63]
    v_mfma_f32_16x16x32_bf16 v[68:71], v[108:111], v[164:167], v[68:71]
    v_mfma_f32_16x16x32_bf16 v[48:51], v[112:115], v[152:155], v[48:51]
    v_mfma_f32_16x16x32_bf16 v[56:59], v[112:115], v[156:159], v[56:59]
    v_mfma_f32_16x16x32_bf16 v[64:67], v[112:115], v[160:163], v[64:67]
    v_mfma_f32_16x16x32_bf16 v[52:55], v[116:119], v[152:155], v[52:55]
    v_mfma_f32_16x16x32_bf16 v[60:63], v[116:119], v[156:159], v[60:63]
    v_mfma_f32_16x16x32_bf16 v[68:71], v[116:119], v[160:163], v[68:71]
    v_mfma_f32_16x16x32_bf16 v[56:59], v[120:123], v[152:155], v[56:59]
    v_mfma_f32_16x16x32_bf16 v[64:67], v[120:123], v[156:159], v[64:67]
    v_mfma_f32_16x16x32_bf16 v[60:63], v[124:127], v[152:155], v[60:63]
    v_mfma_f32_16x16x32_bf16 v[68:71], v[124:127], v[156:159], v[68:71]
    v_mfma_f32_16x16x32_bf16 v[64:67], v[128:131], v[152:155], v[64:67]
    v_mfma_f32_16x16x32_bf16 v[68:71], v[132:135], v[152:155], v[68:71]
    ds_read_b128 v[136:139], v33 offset:21440
    ds_read_b128 v[140:143], v33 offset:19904
    ds_read_b128 v[144:147], v33 offset:18368
    ds_read_b128 v[148:151], v33 offset:16832
    ds_read_b64 v[72:73], v32 offset:128
    ds_read_b64 v[74:75], v32 offset:136
    ds_read_b64 v[76:77], v32 offset:160
    ds_read_b64 v[78:79], v32 offset:168
    ds_read_b64 v[80:81], v32 offset:1152
    ds_read_b64 v[82:83], v32 offset:1160
    ds_read_b64 v[84:85], v32 offset:1184
    ds_read_b64 v[86:87], v32 offset:1192
    ds_read_b64 v[88:89], v32 offset:2176
    ds_read_b64 v[90:91], v32 offset:2184
    ds_read_b64 v[92:93], v32 offset:2208
    ds_read_b64 v[94:95], v32 offset:2216
    ds_read_b64 v[96:97], v32 offset:3200
    ds_read_b64 v[98:99], v32 offset:3208
    ds_read_b64 v[100:101], v32 offset:3232
    ds_read_b64 v[102:103], v32 offset:3240
    v_add_u32 v32, 128, v32
    v_add_u32 v33, 192, v33
    s_add_u32 s43, s43, 1
    s_cmp_lt_u32 s43, 4
    s_cbranch_scc1 CV_r
CV_l:
    s_waitcnt lgkmcnt(10)
    v_mfma_f32_16x16x32_bf16 v[40:43], v[72:75], v[136:139], v[40:43]
    ds_read_b128 v[152:155], v33 offset:21344
    v_mfma_f32_16x16x32_bf16 v[48:51], v[72:75], v[140:143], v[48:51]
    ds_read_b128 v[156:159], v33 offset:19808
    s_cmp_eq_u32 s43, 5
    v_mfma_f32_16x16x32_bf16 v[56:59], v[72:75], v[144:147], v[56:59]
    ds_read_b128 v[160:163], v33 offset:18272
    s_cselect_b64 exec, 1, 0
    buffer_load_dword v12, v35, s[56:59], s45 offen sc1
    s_mov_b64 exec, -1
    v_mfma_f32_16x16x32_bf16 v[64:67], v[72:75], v[148:151], v[64:67]
    ds_read_b128 v[164:167], v33 offset:16736
    v_mfma_f32_16x16x32_bf16 v[44:47], v[76:79], v[136:139], v[44:47]
    ds_read_b64 v[104:105], v32 offset:64
    v_mfma_f32_16x16x32_bf16 v[52:55], v[76:79], v[140:143], v[52:55]
    ds_read_b64 v[106:107], v32 offset:72
    v_mfma_f32_16x16x32_bf16 v[60:63], v[76:79], v[144:147], v[60:63]
    ds_read_b64 v[108:109], v32 offset:96
    v_mfma_f32_16x16x32_bf16 v[68:71], v[76:79], v[148:151], v[68:71]
    ds_read_b64 v[110:111], v32 offset:104
    v_mfma_f32_16x16x32_bf16 v[48:51], v[80:83], v[136:139], v[48:51]
    ds_read_b64 v[112:113], v32 offset:1088
    v_mfma_f32_16x16x32_bf16 v[56:59], v[80:83], v[140:143], v[56:59]
    ds_read_b64 v[114:115], v32 offset:1096
    s_waitcnt lgkmcnt(10)
    v_mfma_f32_16x16x32_bf16 v[64:67], v[80:83], v[144:147], v[64:67]
    ds_read_b64 v[116:117], v32 offset:1120
    v_mfma_f32_16x16x32_bf16 v[52:55], v[84:87], v[136:139], v[52:55]
    ds_read_b64 v[118:119], v32 offset:1128
    v_mfma_f32_16x16x32_bf16 v[60:63], v[84:87], v[140:143], v[60:63]
    ds_read_b64 v[120:121], v32 offset:2112
    v_mfma_f32_16x16x32_bf16 v[68:71], v[84:87], v[144:147], v[68:71]
    ds_read_b64 v[122:123], v32 offset:2120
    v_mfma_f32_16x16x32_bf16 v[56:59], v[88:91], v[136:139], v[56:59]
    ds_read_b64 v[124:125], v32 offset:2144
    v_mfma_f32_16x16x32_bf16 v[64:67], v[88:91], v[140:143], v[64:67]
    ds_read_b64 v[126:127], v32 offset:2152
    v_mfma_f32_16x16x32_bf16 v[60:63], v[92:95], v[136:139], v[60:63]
    ds_read_b64 v[128:129], v32 offset:3136
    v_mfma_f32_16x16x32_bf16 v[68:71], v[92:95], v[140:143], v[68:71]
    ds_read_b64 v[130:131], v32 offset:3144
    v_mfma_f32_16x16x32_bf16 v[64:67], v[96:99], v[136:139], v[64:67]
    ds_read_b64 v[132:133], v32 offset:3168
    v_mfma_f32_16x16x32_bf16 v[68:71], v[100:103], v[136:139], v[68:71]
    ds_read_b64 v[134:135], v32 offset:3176
    s_waitcnt lgkmcnt(10)
    v_mfma_f32_16x16x32_bf16 v[40:43], v[104:107], v[152:155], v[40:43]
    ds_read_b128 v[136:139], v33 offset:21440
    v_mfma_f32_16x16x32_bf16 v[48:51], v[104:107], v[156:159], v[48:51]
    ds_read_b128 v[140:143], v33 offset:19904
    v_mfma_f32_16x16x32_bf16 v[56:59], v[104:107], v[160:163], v[56:59]
    ds_read_b128 v[144:147], v33 offset:18368
    v_mfma_f32_16x16x32_bf16 v[64:67], v[104:107], v[164:167], v[64:67]
    ds_read_b128 v[148:151], v33 offset:16832
    v_mfma_f32_16x16x32_bf16 v[44:47], v[108:111], v[152:155], v[44:47]
    ds_read_b64 v[72:73], v32 offset:128
    v_mfma_f32_16x16x32_bf16 v[52:55], v[108:111], v[156:159], v[52:55]
    ds_read_b64 v[74:75], v32 offset:136
    v_add_u32 v33, 192, v33
    v_mfma_f32_16x16x32_bf16 v[60:63], v[108:111], v[160:163], v[60:63]
    ds_read_b64 v[76:77], v32 offset:160
    s_add_u32 s43, s43, 1
    v_mfma_f32_16x16x32_bf16 v[68:71], v[108:111], v[164:167], v[68:71]
    ds_read_b64 v[78:79], v32 offset:168
    s_cmp_lt_u32 s43, 8
    v_mfma_f32_16x16x32_bf16 v[48:51], v[112:115], v[152:155], v[48:51]
    ds_read_b64 v[80:81], v32 offset:1152
    v_mfma_f32_16x16x32_bf16 v[56:59], v[112:115], v[156:159], v[56:59]
    ds_read_b64 v[82:83], v32 offset:1160
    s_waitcnt lgkmcnt(10)
    v_mfma_f32_16x16x32_bf16 v[64:67], v[112:115], v[160:163], v[64:67]
    ds_read_b64 v[84:85], v32 offset:1184
    v_mfma_f32_16x16x32_bf16 v[52:55], v[116:119], v[152:155], v[52:55]
    ds_read_b64 v[86:87], v32 offset:1192
    v_mfma_f32_16x16x32_bf16 v[60:63], v[116:119], v[156:159], v[60:63]
    ds_read_b64 v[88:89], v32 offset:2176
    v_mfma_f32_16x16x32_bf16 v[68:71], v[116:119], v[160:163], v[68:71]
    ds_read_b64 v[90:91], v32 offset:2184
    v_mfma_f32_16x16x32_bf16 v[56:59], v[120:123], v[152:155], v[56:59]
    ds_read_b64 v[92:93], v32 offset:2208
    v_mfma_f32_16x16x32_bf16 v[64:67], v[120:123], v[156:159], v[64:67]
    ds_read_b64 v[94:95], v32 offset:2216
    v_mfma_f32_16x16x32_bf16 v[60:63], v[124:127], v[152:155], v[60:63]
    ds_read_b64 v[96:97], v32 offset:3200
    v_mfma_f32_16x16x32_bf16 v[68:71], v[124:127], v[156:159], v[68:71]
    ds_read_b64 v[98:99], v32 offset:3208
    v_mfma_f32_16x16x32_bf16 v[64:67], v[128:131], v[152:155], v[64:67]
    ds_read_b64 v[100:101], v32 offset:3232
    v_mfma_f32_16x16x32_bf16 v[68:71], v[132:135], v[152:155], v[68:71]
    ds_read_b64 v[102:103], v32 offset:3240
    v_add_u32 v32, 128, v32
    s_cbranch_scc1 CV_l
    v_cvt_pk_bf16_f32 v16, v40, v41
    v_cvt_pk_bf16_f32 v17, v42, v43
    ds_write_b64 v170, v[16:17] offset:0
    v_cvt_pk_bf16_f32 v18, v44, v45
    v_cvt_pk_bf16_f32 v19, v46, v47
    ds_write_b64 v170, v[18:19] offset:32
    v_cvt_pk_bf16_f32 v20, v48, v49
    v_cvt_pk_bf16_f32 v21, v50, v51
    ds_write_b64 v170, v[20:21] offset:1152
    v_cvt_pk_bf16_f32 v22, v52, v53
    v_cvt_pk_bf16_f32 v23, v54, v55
    ds_write_b64 v170, v[22:23] offset:1184
    v_cvt_pk_bf16_f32 v24, v56, v57
    v_cvt_pk_bf16_f32 v25, v58, v59
    ds_write_b64 v170, v[24:25] offset:2304
    v_cvt_pk_bf16_f32 v26, v60, v61
    v_cvt_pk_bf16_f32 v27, v62, v63
    ds_write_b64 v170, v[26:27] offset:2336
    v_cvt_pk_bf16_f32 v28, v64, v65
    v_cvt_pk_bf16_f32 v29, v66, v67
    ds_write_b64 v170, v[28:29] offset:3456
    v_cvt_pk_bf16_f32 v30, v68, v69
    v_cvt_pk_bf16_f32 v31, v70, v71
    ds_write_b64 v170, v[30:31] offset:3488
    s_mov_b64 exec, 1
    ds_add_u32 v34, v7
    s_mov_b64 exec, -1
    s_mov_b32 s53, 0
    s_waitcnt vmcnt(0)
CV_v:
    v_readfirstlane_b32 s94, v12
    s_nop 0
    s_sub_u32 s94, s94, s52
    s_and_b32 s37, s94, 0xfffffe01
    s_cbranch_scc0 CV_k
    buffer_load_dword v12, v35, s[56:59], s45 offen sc1
    s_waitcnt vmcnt(0)
    s_add_u32 s53, s53, 1
    s_cmp_lt_u32 s53, s61
    s_cbranch_scc1 CV_v
    s_mov_b32 s61, 0
    s_mov_b32 s94, 0
CV_k:
    s_lshr_b32 s94, s94, 1
    s_add_u32 s37, s94, 65536
    v_mov_b32 v8, 162844
    v_mov_b32 v9, s37
    ds_write_b32 v8, v9
    s_cmp_gt_u32 s94, 10
    s_cselect_b32 s37, 0x2000, 0
    s_xor_b32 s44, s44, s37
    s_xor_b32 s45, s47, s37
    s_add_u32 s45, s45, 23101440
    v_mov_b32 v8, 162824
spin_5:
    ds_read_b32 v9, v8
    s_waitcnt lgkmcnt(0)
    v_readfirstlane_b32 s53, v9
    s_nop 0
    s_cmp_ge_u32 s53, 6
    s_cbranch_scc0 spin_5
    ds_read_b64_tr_b16 v[104:105], v168 offset:0
    ds_read_b64_tr_b16 v[106:107], v168 offset:32
    ds_read_b64_tr_b16 v[108:109], v168 offset:288
    ds_read_b64_tr_b16 v[110:111], v168 offset:320
    ds_read_b64_tr_b16 v[112:113], v168 offset:576
    ds_read_b64_tr_b16 v[114:115], v168 offset:608
    ds_read_b64_tr_b16 v[116:117], v168 offset:864
    ds_read_b64_tr_b16 v[118:119], v168 offset:896
    s_waitcnt lgkmcnt(6)
    v_or_b32 v104, 1, v104
    buffer_store_dwordx4 v[104:107], v169, s[12:15], s44 offen sc1
    s_add_u32 s44, s44, 16777216
    s_waitcnt lgkmcnt(4)
    v_or_b32 v108, 1, v108
    buffer_store_dwordx4 v[108:111], v169, s[12:15], s44 offen sc1
    s_add_u32 s44, s44, 16777216
    s_waitcnt lgkmcnt(2)
    v_or_b32 v112, 1, v112
    buffer_store_dwordx4 v[112:115], v169, s[12:15], s44 offen sc1
    s_add_u32 s44, s44, 16777216
    s_waitcnt lgkmcnt(0)
    v_or_b32 v116, 1, v116
    buffer_store_dwordx4 v[116:119], v169, s[12:15], s44 offen sc1
    s_add_u32 s44, s44, 16777216
    v_mov_b32 v8, 162836
    v_mov_b32 v9, 1
    s_mov_b64 exec, 1
    ds_add_u32 v8, v9
    s_mov_b64 exec, -1
    s_mov_b64 exec, 0xf
    s_waitcnt vmcnt(0)
    buffer_atomic_add v7, v6, s[56:59], s45 offen sc1
    s_mov_b64 exec, -1
    s_branch FR_end
FR_b:
    s_cmp_ge_u32 s2, 32
    s_cbranch_scc1 FB_np
    s_cmp_lg_u32 s30, 5
    s_cbranch_scc1 FB_np
    s_and_b32 s42, s2, 7
    s_lshl_b32 s42, s42, 10
    s_lshr_b32 s43, s2, 3
    s_lshl_b32 s43, s43, 14
    s_add_u32 s42, s42, s43
    s_add_u32 s42, s42, 39714816
    v_mov_b32 v14, 0
    s_mov_b64 exec, 1
    s_mov_b32 s46, -1
    s_mov_b32 s47, -1
    s_add_u32 s48, s4, s42
    s_addc_u32 s49, s5, 0
    s_load_dword s101, s[48:49], 384
    s_waitcnt lgkmcnt(0)
    s_memtime s[34:35]
    s_waitcnt lgkmcnt(0)
    s_load_dword s101, s[48:49], 0
    s_waitcnt lgkmcnt(0)
    s_memtime s[36:37]
    s_waitcnt lgkmcnt(0)
    s_sub_u32 s43, s36, s34
    s_min_u32 s46, s46, s43
    s_load_dword s101, s[48:49], 8192
    s_waitcnt lgkmcnt(0)
    s_memtime s[34:35]
    s_waitcnt lgkmcnt(0)
    s_sub_u32 s43, s34, s36
    s_min_u32 s47, s47, s43
    s_load_dword s101, s[48:49], 128
    s_waitcnt lgkmcnt(0)
    s_memtime s[36:37]
    s_waitcnt lgkmcnt(0)
    s_sub_u32 s43, s36, s34
    s_min_u32 s46, s46, s43
    s_load_dword s101, s[48:49], 8320
    s_waitcnt lgkmcnt(0)
    s_memtime s[34:35]
    s_waitcnt lgkmcnt(0)
    s_sub_u32 s43, s34, s36
    s_min_u32 s47, s47, s43
    s_cmp_lt_u32 s47, s46
    s_cselect_b32 s45, 1, 0
    s_lshr_b32 s46, s28, 2
    s_xor_b32 s45, s45, s46
    s_and_b32 s45, s45, 1
    s_lshl_b32 s45, s45, 8
    s_or_b32 s43, s45, 1
    v_mov_b32 v12, s43
    buffer_atomic_add v12, v14, s[84:87], 0 offen offset:4 sc0 sc1
    s_waitcnt vmcnt(0)
    v_readfirstlane_b32 s36, v12
    s_nop 0
    s_add_u32 s36, s36, s43
    s_and_b32 s37, s36, 255
    s_cmp_lg_u32 s37, 21
    s_cbranch_scc1 FB_np
    s_lshr_b32 s36, s36, 8
    s_lshl_b32 s36, s36, 1
    s_add_u32 s36, s36, s52
    s_bfm_b64 exec, 32, 0
    v_mov_b32 v12, s36
    v_lshlrev_b32 v13, 7, v1
    s_mov_b32 s36, 23117824
    buffer_store_dword v12, v13, s[56:59], s36 offen sc1
FB_np:
    s_mov_b64 exec, -1
    s_getpc_b64 s[34:35]
K_tpc:
    s_lshl_b32 s36, s29, 2
    s_and_b32 s37, s28, 3
    s_add_u32 s36, s36, s37
    s_lshl_b32 s36, s36, 6
    s_add_u32 s36, s36, K_tab-K_tpc
    s_add_u32 s34, s34, s36
    s_addc_u32 s35, s35, 0
    v_and_b32 v248, 31, v1
    v_lshlrev_b32 v248, 1, v248
    global_load_ushort v251, v248, s[34:35]
    v_lshrrev_b32 v253, 3, v1
    v_lshlrev_b32 v238, 11, v253
    v_and_b32 v253, 6, v253
    v_and_b32 v254, 7, v1
    v_xor_b32 v253, v253, v254
    v_lshl_add_u32 v238, v253, 4, v238
    v_lshrrev_b32 v253, 4, v1
    v_lshlrev_b32 v239, 11, v253
    v_add_u32 v253, 0, v253
    v_lshlrev_b32 v253, 1, v253
    v_and_b32 v254, 15, v1
    v_xor_b32 v253, v253, v254
    v_lshl_add_u32 v239, v253, 4, v239
    v_lshrrev_b32 v253, 4, v1
    v_lshlrev_b32 v240, 11, v253
    v_add_u32 v253, 4, v253
    v_lshlrev_b32 v253, 1, v253
    v_and_b32 v254, 15, v1
    v_xor_b32 v253, v253, v254
    v_lshl_add_u32 v240, v253, 4, v240
    v_add_u32 v254, 0, v1
    v_mul_u32_u24 v253, 2341, v254
    v_lshrrev_b32 v253, 16, v253
    v_mul_u32_u24 v241, 28, v253
    v_sub_u32 v254, v254, v241
    v_mul_u32_u24 v241, 7168, v253
    v_lshrrev_b32 v253, 1, v253
    v_and_b32 v253, 2, v253
    v_xor_b32 v254, v254, v253
    v_lshl_add_u32 v241, v254, 4, v241
    v_add_u32 v254, 64, v1
    v_mul_u32_u24 v253, 2341, v254
    v_lshrrev_b32 v253, 16, v253
    v_mul_u32_u24 v242, 28, v253
    v_sub_u32 v254, v254, v242
    v_mul_u32_u24 v242, 7168, v253
    v_lshrrev_b32 v253, 1, v253
    v_and_b32 v253, 2, v253
    v_xor_b32 v254, v254, v253
    v_lshl_add_u32 v242, v254, 4, v242
    v_add_u32 v254, 128, v1
    v_mul_u32_u24 v253, 2341, v254
    v_lshrrev_b32 v253, 16, v253
    v_mul_u32_u24 v243, 28, v253
    v_sub_u32 v254, v254, v243
    v_mul_u32_u24 v243, 7168, v253
    v_lshrrev_b32 v253, 1, v253
    v_and_b32 v253, 2, v253
    v_xor_b32 v254, v254, v253
    v_lshl_add_u32 v243, v254, 4, v243
    v_add_u32 v254, 192, v1
    v_mul_u32_u24 v253, 2341, v254
    v_lshrrev_b32 v253, 16, v253
    v_mul_u32_u24 v244, 28, v253
    v_sub_u32 v254, v254, v244
    v_mul_u32_u24 v244, 7168, v253
    v_lshrrev_b32 v253, 1, v253
    v_and_b32 v253, 2, v253
    v_xor_b32 v254, v254, v253
    v_lshl_add_u32 v244, v254, 4, v244
    v_add_u32 v254, 256, v1
    v_mul_u32_u24 v253, 2341, v254
    v_lshrrev_b32 v253, 16, v253
    v_mul_u32_u24 v245, 28, v253
    v_sub_u32 v254, v254, v245
    v_mul_u32_u24 v245, 7168, v253
    v_lshrrev_b32 v253, 1, v253
    v_and_b32 v253, 2, v253
    v_xor_b32 v254, v254, v253
    v_lshl_add_u32 v245, v254, 4, v245
    v_add_u32 v254, 320, v1
    v_mul_u32_u24 v253, 2341, v254
    v_lshrrev_b32 v253, 16, v253
    v_mul_u32_u24 v246, 28, v253
    v_sub_u32 v254, v254, v246
    v_mul_u32_u24 v246, 7168, v253
    v_lshrrev_b32 v253, 1, v253
    v_and_b32 v253, 2, v253
    v_xor_b32 v254, v254, v253
    v_lshl_add_u32 v246, v254, 4, v246
    v_add_u32 v254, 384, v1
    v_mul_u32_u24 v253, 2341, v254
    v_lshrrev_b32 v253, 16, v253
    v_mul_u32_u24 v247, 28, v253
    v_sub_u32 v254, v254, v247
    v_mul_u32_u24 v247, 7168, v253
    v_lshrrev_b32 v253, 1, v253
    v_and_b32 v253, 2, v253
    v_xor_b32 v254, v254, v253
    v_lshl_add_u32 v247, v254, 4, v247
    s_cmp_ge_u32 s30, 6
    s_cbranch_scc1 FB_cs
    s_cmp_lg_u32 s30, 4
    s_cbranch_scc1 FB_ni
    v_mov_b32 v12, s52
    s_lshr_b32 s53, s28, 3
    s_lshl_b32 s53, s53, 2
    s_and_b32 s54, s28, 3
    s_add_u32 s53, s53, s54
    s_lshl_b32 s53, s53, 24
    s_lshr_b32 s54, s28, 2
    s_xor_b32 s54, s54, s94
    s_and_b32 s54, s54, 1
    s_lshl_b32 s54, s54, 13
    s_add_u32 s37, s53, s54
    s_add_u32 s37, s37, 33554432
    s_andn2_b32 s37, s37, 0x2000
    s_lshl_b32 s53, s29, 7
    s_add_u32 s37, s37, s53
    s_add_u32 s37, s37, 6029312
    v_and_b32 v13, 1, v1
    v_lshlrev_b32 v13, 13, v13
    v_lshrrev_b32 v14, 1, v1
    v_lshl_add_u32 v13, v14, 22, v13
    s_mov_b64 exec, 0xf
    buffer_store_dword v12, v13, s[56:59], s37 offen sc1
    s_cmp_lg_u32 s28, 0
    s_cbranch_scc1 FB_n2
    s_add_u32 s37, s53, 23121920
    s_mov_b64 exec, 1
    buffer_store_dword v12, v13, s[56:59], s37 offen sc1
FB_n2:
    s_mov_b64 exec, -1
FB_ni:
    s_waitcnt vmcnt(0)
    v_bfe_u32 v252, v251, 2, 2
    v_lshlrev_b32 v248, 14, v252
    v_and_b32 v252, 3, v251
    v_lshl_add_u32 v248, v252, 11, v248
    v_bfe_u32 v252, v251, 7, 3
    v_lshlrev_b32 v249, 14, v252
    v_bfe_u32 v252, v251, 4, 3
    v_lshl_add_u32 v249, v252, 10, v249
    v_bfe_u32 v252, v251, 13, 3
    v_lshlrev_b32 v250, 14, v252
    v_bfe_u32 v252, v251, 10, 3
    v_lshl_add_u32 v250, v252, 10, v250
    v_mov_b32 v6, 162836
spin_7:
    s_sleep 2
    ds_read_b32 v7, v6
    s_waitcnt lgkmcnt(0)
    v_readfirstlane_b32 s53, v7
    s_nop 0
    s_cmp_ge_u32 s53, 4
    s_cbranch_scc0 spin_7
    s_load_dwordx2 s[48:49], s[0:1], 64
    s_lshl_b32 s45, s2, 1
    s_and_b32 s50, s30, 1
    s_add_u32 s45, s45, s50
    s_mul_i32 s45, s45, 4096
    s_mov_b32 s50, 2097152
    s_mov_b32 s51, 0x20000
    s_waitcnt lgkmcnt(0)
    buffer_load_dwordx4 v[20:23], v2, s[48:51], s45 offen offset:0
    buffer_load_dwordx4 v[20:23], v2, s[48:51], s45 offen offset:1024
    buffer_load_dwordx4 v[20:23], v2, s[48:51], s45 offen offset:2048
    buffer_load_dwordx4 v[20:23], v2, s[48:51], s45 offen offset:3072
    v_mov_b32 v6, 1
    v_mov_b32 v7, 162824
    s_mov_b64 exec, 1
    s_waitcnt vmcnt(0)
    ds_add_u32 v7, v6
    s_mov_b64 exec, -1
    v_mov_b32 v6, 162840
spin_9:
    s_sleep 4
    ds_read_b32 v7, v6
    s_waitcnt lgkmcnt(0)
    v_readfirstlane_b32 s53, v7
    s_nop 0
    s_cmp_ge_u32 s53, 2
    s_cbranch_scc0 spin_9
    s_call_b64 s[76:77], SUB_w1_regs
    s_call_b64 s[76:77], SUB_park
    v_mov_b32 v6, 162840
spin_10:
    s_sleep 3
    ds_read_b32 v7, v6
    s_waitcnt lgkmcnt(0)
    v_readfirstlane_b32 s53, v7
    s_nop 0
    s_cmp_ge_u32 s53, 4
    s_cbranch_scc0 spin_10
    s_mov_b64 s[12:13], s[68:69]
    s_mov_b32 s14, 2097152
    s_mov_b32 s15, 0x20000
    s_and_b32 s35, s30, 1
    s_mul_i32 s38, s99, 128
    s_mul_i32 s41, s35, 65536
    s_add_u32 s38, s38, s41
    s_mul_i32 s41, s35, 4096
    s_add_u32 s41, s41, 24576
    s_mov_b32 s42, 0
    s_mov_b32 s44, s67
    s_mov_b32 s42, 73728
    s_mov_b32 s44, s67
    s_add_u32 s44, s44, 9
    s_and_b32 s44, s44, 15
    s_call_b64 s[76:77], SUB_w_issue_1
    s_waitcnt vmcnt(8)
    s_mov_b32 s42, 81920
    s_mov_b32 s44, s67
    s_add_u32 s44, s44, 10
    s_and_b32 s44, s44, 15
    s_call_b64 s[76:77], SUB_w_issue_1
    s_waitcnt vmcnt(8)
    s_mov_b32 s42, 90112
    s_mov_b32 s44, s67
    s_add_u32 s44, s44, 11
    s_and_b32 s44, s44, 15
    s_call_b64 s[76:77], SUB_w_issue_1
    s_waitcnt vmcnt(8)
    s_and_b32 s36, s29, 6
    s_cmp_eq_u32 s36, 2
    s_cbranch_scc1 pr_11
    s_call_b64 s[76:77], SUB_park2
pr_11:
    s_call_b64 s[76:77], SUB_w1_put
    s_branch FR_end
FB_cs:
    v_and_b32 v164, 15, v1
    v_mov_b32 v165, 0x3f803f80
    v_cmp_eq_u32 vcc, 0, v164
    s_nop 1
    v_cndmask_b32 v16, 0, v165, vcc
    v_cndmask_b32 v17, 0, v165, vcc
    v_cndmask_b32 v18, 0, v165, vcc
    v_cndmask_b32 v19, 0, v165, vcc
    v_cmp_eq_u32 vcc, 1, v164
    s_nop 1
    v_cndmask_b32 v20, 0, v165, vcc
    v_cndmask_b32 v21, 0, v165, vcc
    v_cndmask_b32 v22, 0, v165, vcc
    v_cndmask_b32 v23, 0, v165, vcc
    v_cmp_eq_u32 vcc, 2, v164
    s_nop 1
    v_cndmask_b32 v24, 0, v165, vcc
    v_cndmask_b32 v25, 0, v165, vcc
    v_cndmask_b32 v26, 0, v165, vcc
    v_cndmask_b32 v27, 0, v165, vcc
    v_cmp_eq_u32 vcc, 3, v164
    s_nop 1
    v_cndmask_b32 v28, 0, v165, vcc
    v_cndmask_b32 v29, 0, v165, vcc
    v_cndmask_b32 v30, 0, v165, vcc
    v_cndmask_b32 v31, 0, v165, vcc
    v_cmp_eq_u32 vcc, 4, v164
    s_nop 1
    v_cndmask_b32 v32, 0, v165, vcc
    v_cndmask_b32 v33, 0, v165, vcc
    v_cndmask_b32 v34, 0, v165, vcc
    v_cndmask_b32 v35, 0, v165, vcc
    v_cmp_eq_u32 vcc, 5, v164
    s_nop 1
    v_cndmask_b32 v36, 0, v165, vcc
    v_cndmask_b32 v37, 0, v165, vcc
    v_cndmask_b32 v38, 0, v165, vcc
    v_cndmask_b32 v39, 0, v165, vcc
    v_cmp_eq_u32 vcc, 6, v164
    s_nop 1
    v_cndmask_b32 v40, 0, v165, vcc
    v_cndmask_b32 v41, 0, v165, vcc
    v_cndmask_b32 v42, 0, v165, vcc
    v_cndmask_b32 v43, 0, v165, vcc
    v_cmp_eq_u32 vcc, 7, v164
    s_nop 1
    v_cndmask_b32 v44, 0, v165, vcc
    v_cndmask_b32 v45, 0, v165, vcc
    v_cndmask_b32 v46, 0, v165, vcc
    v_cndmask_b32 v47, 0, v165, vcc
    v_cmp_eq_u32 vcc, 8, v164
    s_nop 1
    v_cndmask_b32 v48, 0, v165, vcc
    v_cndmask_b32 v49, 0, v165, vcc
    v_cndmask_b32 v50, 0, v165, vcc
    v_cndmask_b32 v51, 0, v165, vcc
    v_cmp_eq_u32 vcc, 9, v164
    s_nop 1
    v_cndmask_b32 v52, 0, v165, vcc
    v_cndmask_b32 v53, 0, v165, vcc
    v_cndmask_b32 v54, 0, v165, vcc
    v_cndmask_b32 v55, 0, v165, vcc
    v_cmp_eq_u32 vcc, 10, v164
    s_nop 1
    v_cndmask_b32 v56, 0, v165, vcc
    v_cndmask_b32 v57, 0, v165, vcc
    v_cndmask_b32 v58, 0, v165, vcc
    v_cndmask_b32 v59, 0, v165, vcc
    v_cmp_eq_u32 vcc, 11, v164
    s_nop 1
    v_cndmask_b32 v60, 0, v165, vcc
    v_cndmask_b32 v61, 0, v165, vcc
    v_cndmask_b32 v62, 0, v165, vcc
    v_cndmask_b32 v63, 0, v165, vcc
    v_cmp_eq_u32 vcc, 12, v164
    s_nop 1
    v_cndmask_b32 v64, 0, v165, vcc
    v_cndmask_b32 v65, 0, v165, vcc
    v_cndmask_b32 v66, 0, v165, vcc
    v_cndmask_b32 v67, 0, v165, vcc
    v_cmp_eq_u32 vcc, 13, v164
    s_nop 1
    v_cndmask_b32 v68, 0, v165, vcc
    v_cndmask_b32 v69, 0, v165, vcc
    v_cndmask_b32 v70, 0, v165, vcc
    v_cndmask_b32 v71, 0, v165, vcc
    s_mov_b32 s35, 0
    v_lshrrev_b32 v253, 2, v1
    v_mul_u32_u24 v144, 128, v253
    v_and_b32 v254, 3, v1
    v_lshl_add_u32 v144, v254, 3, v144
    v_add_u32 v144, 24576, v144
    v_bfe_u32 v253, v253, 1, 2
    s_mul_i32 s36, s35, 4
    s_add_u32 s36, s36, 3
    v_xor_b32 v254, s36, v253
    v_lshl_add_u32 v147, v254, 5, v144
    s_mul_i32 s36, s35, 4
    s_add_u32 s36, s36, 2
    v_xor_b32 v254, s36, v253
    v_lshl_add_u32 v146, v254, 5, v144
    s_mul_i32 s36, s35, 4
    s_add_u32 s36, s36, 1
    v_xor_b32 v254, s36, v253
    v_lshl_add_u32 v145, v254, 5, v144
    s_mul_i32 s36, s35, 4
    s_add_u32 s36, s36, 0
    v_xor_b32 v254, s36, v253
    v_lshl_add_u32 v144, v254, 5, v144
    s_and_b32 s35, s30, 1
    s_mul_i32 s35, s35, 4096
    s_add_u32 s35, s35, 73728
    v_add_u32 v144, s35, v144
    v_add_u32 v145, s35, v145
    v_add_u32 v146, s35, v146
    v_add_u32 v147, s35, v147
    s_mov_b32 s35, 0
    v_lshrrev_b32 v253, 2, v1
    v_mul_u32_u24 v148, 448, v253
    v_and_b32 v254, 3, v1
    v_lshl_add_u32 v148, v254, 3, v148
    v_add_u32 v148, 73728, v148
    s_mul_i32 s36, s35, 224
    v_add_u32 v148, s36, v148
    v_bfe_u32 v253, v1, 4, 1
    v_lshlrev_b32 v253, 5, v253
    s_cmp_eq_u32 s35, 0
    s_cselect_b32 s36, 1, -1
    v_mul_lo_u32 v253, v253, s36
    v_sub_u32 v149, v148, v253
    v_add_u32 v148, v148, v253
    s_and_b32 s35, s30, 1
    s_mul_i32 s35, s35, 14336
    s_add_u32 s35, s35, 32768
    v_add_u32 v148, s35, v148
    v_add_u32 v149, s35, v149
    s_mov_b32 s35, 1
    v_lshrrev_b32 v253, 2, v1
    v_mul_u32_u24 v150, 448, v253
    v_and_b32 v254, 3, v1
    v_lshl_add_u32 v150, v254, 3, v150
    v_add_u32 v150, 73728, v150
    s_mul_i32 s36, s35, 224
    v_add_u32 v150, s36, v150
    v_bfe_u32 v253, v1, 4, 1
    v_lshlrev_b32 v253, 5, v253
    s_cmp_eq_u32 s35, 0
    s_cselect_b32 s36, 1, -1
    v_mul_lo_u32 v253, v253, s36
    v_sub_u32 v151, v150, v253
    v_add_u32 v150, v150, v253
    s_and_b32 s35, s30, 1
    s_mul_i32 s35, s35, 14336
    s_add_u32 s35, s35, 32768
    v_add_u32 v150, s35, v150
    v_add_u32 v151, s35, v151
    v_mov_b32 v156, 0
    v_mov_b32 v157, 0
    v_mov_b32 v158, 0
    v_mov_b32 v159, 0
    v_mov_b32 v160, 0
    v_mov_b32 v161, 0
    v_mov_b32 v162, 0
    v_mov_b32 v163, 0
    v_lshrrev_b32 v166, 4, v1
    v_lshlrev_b32 v166, 4, v166
    v_lshl_add_u32 v166, v164, 6, v166
    v_mov_b32 v165, 0x7f000000
    v_cmp_gt_u32 vcc, 4, v164
    s_nop 1
    v_cndmask_b32 v167, v165, v166, vcc
    v_cmp_gt_u32 vcc, 14, v164
    s_nop 1
    v_cndmask_b32 v168, v165, v166, vcc
    s_waitcnt vmcnt(0)
    v_and_b32 v252, 15, v251
    v_mul_u32_u24 v248, 458752, v252
    s_and_b32 s36, s30, 1
    s_mul_i32 s36, s36, 6
    s_add_u32 s36, s36, 4
    v_bfe_u32 v252, v251, s36, 6
    v_mul_u32_u24 v250, 37, v252
    v_lshrrev_b32 v250, 8, v250
    v_mul_u32_u24 v250, 7, v250
    v_sub_u32 v250, v252, v250
    v_cmp_eq_u32 vcc, 3, v250
    s_nop 1
    v_cndmask_b32 v250, 0, 1, vcc
    v_lshl_add_u32 v249, v252, 16, v250
    v_mov_b32 v6, 162836
spin_12:
    s_sleep 2
    ds_read_b32 v7, v6
    s_waitcnt lgkmcnt(0)
    v_readfirstlane_b32 s53, v7
    s_nop 0
    s_cmp_ge_u32 s53, 4
    s_cbranch_scc0 spin_12
    s_mov_b64 s[12:13], s[68:69]
    s_mov_b32 s14, 2097152
    s_mov_b32 s15, 0x20000
    s_and_b32 s35, s30, 1
    s_mul_i32 s38, s99, 128
    s_mul_i32 s41, s35, 65536
    s_add_u32 s38, s38, s41
    s_mul_i32 s41, s35, 4096
    s_add_u32 s41, s41, 24576
    s_mov_b32 s42, 0
    s_mov_b32 s44, s67
    s_mov_b32 s42, 73728
    s_mov_b32 s44, s28
    s_add_u32 s19, s41, s42
    s_mul_i32 s16, s44, 131072
    s_add_u32 s16, s16, s38
    s_add_u32 s44, s44, 1
    s_and_b32 s44, s44, 15
    s_add_u32 s42, s42, 8192
    s_cmp_eq_u32 s42, 131072
    s_cselect_b32 s42, 0, s42
    s_mov_b32 m0, s19
    s_mov_b32 s39, s16
    buffer_load_dwordx4 v238, s[12:15], s39 offen lds
    s_add_u32 m0, m0, 1024
    s_add_u32 s39, s39, 16384
    buffer_load_dwordx4 v238, s[12:15], s39 offen lds
    s_add_u32 m0, m0, 1024
    s_add_u32 s39, s39, 16384
    buffer_load_dwordx4 v238, s[12:15], s39 offen lds
    s_add_u32 m0, m0, 1024
    s_add_u32 s39, s39, 16384
    buffer_load_dwordx4 v238, s[12:15], s39 offen lds
    s_mov_b64 s[12:13], s[72:73]
    s_mov_b32 s14, 7340032
    s_mov_b32 s15, 0x20000
    s_and_b32 s35, s30, 1
    s_mul_i32 s38, s29, 448
    s_mul_i32 s41, s35, 229376
    s_add_u32 s38, s38, s41
    s_mul_i32 s41, s35, 14336
    s_add_u32 s41, s41, 73728
    s_mov_b32 s42, 0
    s_mov_b32 s44, 0
    s_mov_b32 s42, 32768
    s_mov_b32 s44, s28
    s_add_u32 s19, s41, s42
    s_mul_i32 s16, s44, 458752
    s_add_u32 s16, s16, s38
    s_add_u32 s44, s44, 1
    s_and_b32 s44, s44, 15
    s_add_u32 s42, s42, 28672
    s_cmp_eq_u32 s42, 86016
    s_cselect_b32 s42, 0, s42
    s_mov_b32 m0, s19
    s_mov_b32 s39, s16
    buffer_load_dwordx4 v241, s[12:15], s39 offen lds
    s_add_u32 m0, m0, 1024
    s_nop 0
    buffer_load_dwordx4 v242, s[12:15], s39 offen lds
    s_add_u32 m0, m0, 1024
    s_nop 0
    buffer_load_dwordx4 v243, s[12:15], s39 offen lds
    s_add_u32 m0, m0, 1024
    s_nop 0
    buffer_load_dwordx4 v244, s[12:15], s39 offen lds
    s_add_u32 m0, m0, 1024
    s_nop 0
    buffer_load_dwordx4 v245, s[12:15], s39 offen lds
    s_add_u32 m0, m0, 1024
    s_nop 0
    buffer_load_dwordx4 v246, s[12:15], s39 offen lds
    s_add_u32 m0, m0, 1024
    s_nop 0
    buffer_load_dwordx4 v247, s[12:15], s39 offen lds
    s_add_u32 m0, m0, 1024
    s_add_u32 s39, s39, 114688
    buffer_load_dwordx4 v241, s[12:15], s39 offen lds
    s_add_u32 m0, m0, 1024
    s_nop 0
    buffer_load_dwordx4 v242, s[12:15], s39 offen lds
    s_add_u32 m0, m0, 1024
    s_nop 0
    buffer_load_dwordx4 v243, s[12:15], s39 offen lds
    s_add_u32 m0, m0, 1024
    s_nop 0
    buffer_load_dwordx4 v244, s[12:15], s39 offen lds
    s_add_u32 m0, m0, 1024
    s_nop 0
    buffer_load_dwordx4 v245, s[12:15], s39 offen lds
    s_add_u32 m0, m0, 1024
    s_nop 0
    buffer_load_dwordx4 v246, s[12:15], s39 offen lds
    s_add_u32 m0, m0, 1024
    s_nop 0
    buffer_load_dwordx4 v247, s[12:15], s39 offen lds
    s_waitcnt vmcnt(14)
    s_setprio 1
    ds_read_b64_tr_b16 v[128:129], v144 offset:0
    ds_read_b64_tr_b16 v[130:131], v144 offset:2048
    ds_read_b64_tr_b16 v[132:133], v145 offset:0
    ds_read_b64_tr_b16 v[134:135], v145 offset:2048
    ds_read_b64_tr_b16 v[136:137], v146 offset:0
    ds_read_b64_tr_b16 v[138:139], v146 offset:2048
    ds_read_b64_tr_b16 v[140:141], v147 offset:0
    ds_read_b64_tr_b16 v[142:143], v147 offset:2048
    s_add_u32 s20, s4, 0x1400000
    s_addc_u32 s21, s5, 0
    s_mov_b32 s22, 0x20000
    s_mov_b32 s23, 0x20000
    s_lshl_b32 s35, s28, 1
    s_and_b32 s36, s30, 1
    s_add_u32 s35, s35, s36
    s_mul_i32 s35, s35, 4096
    s_mul_i32 s36, s29, 256
    s_add_u32 s35, s35, s36
    s_waitcnt lgkmcnt(0)
    v_mfma_f32_16x16x32_bf16 v[160:163], v[128:131], v[16:19], v[160:163]
    v_mfma_f32_16x16x32_bf16 v[160:163], v[132:135], v[20:23], v[160:163]
    v_mfma_f32_16x16x32_bf16 v[160:163], v[136:139], v[24:27], v[160:163]
    v_mfma_f32_16x16x32_bf16 v[160:163], v[140:143], v[28:31], v[160:163]
    s_nop 7
    buffer_store_dwordx4 v[160:163], v167, s[20:23], s35 offen sc1
    s_waitcnt vmcnt(1)
    v_mov_b32 v6, 162840
    v_mov_b32 v7, 1
    s_mov_b64 exec, 1
    ds_add_u32 v6, v7
    s_mov_b64 exec, -1
    ds_read_b64_tr_b16 v[72:73], v148 offset:0
    ds_read_b64_tr_b16 v[74:75], v148 offset:7168
    ds_read_b64_tr_b16 v[76:77], v149 offset:32
    ds_read_b64_tr_b16 v[78:79], v149 offset:7200
    ds_read_b64_tr_b16 v[80:81], v148 offset:64
    ds_read_b64_tr_b16 v[82:83], v148 offset:7232
    ds_read_b64_tr_b16 v[84:85], v149 offset:96
    ds_read_b64_tr_b16 v[86:87], v149 offset:7264
    ds_read_b64_tr_b16 v[88:89], v148 offset:128
    ds_read_b64_tr_b16 v[90:91], v148 offset:7296
    ds_read_b64_tr_b16 v[92:93], v149 offset:160
    ds_read_b64_tr_b16 v[94:95], v149 offset:7328
    ds_read_b64_tr_b16 v[96:97], v148 offset:192
    ds_read_b64_tr_b16 v[98:99], v148 offset:7360
    ds_read_b64_tr_b16 v[100:101], v150 offset:0
    ds_read_b64_tr_b16 v[102:103], v150 offset:7168
    ds_read_b64_tr_b16 v[104:105], v151 offset:32
    ds_read_b64_tr_b16 v[106:107], v151 offset:7200
    ds_read_b64_tr_b16 v[108:109], v150 offset:64
    ds_read_b64_tr_b16 v[110:111], v150 offset:7232
    ds_read_b64_tr_b16 v[112:113], v151 offset:96
    ds_read_b64_tr_b16 v[114:115], v151 offset:7264
    ds_read_b64_tr_b16 v[116:117], v150 offset:128
    ds_read_b64_tr_b16 v[118:119], v150 offset:7296
    ds_read_b64_tr_b16 v[120:121], v151 offset:160
    ds_read_b64_tr_b16 v[122:123], v151 offset:7328
    ds_read_b64_tr_b16 v[124:125], v150 offset:192
    ds_read_b64_tr_b16 v[126:127], v150 offset:7360
    s_add_u32 s20, s4, 0x1420000
    s_addc_u32 s21, s5, 0
    s_mov_b32 s22, 0x70000
    s_mov_b32 s23, 0x20000
    s_lshl_b32 s35, s28, 1
    s_and_b32 s36, s30, 1
    s_add_u32 s35, s35, s36
    s_mul_i32 s35, s35, 14336
    s_mul_i32 s36, s29, 896
    s_add_u32 s35, s35, s36
    s_waitcnt lgkmcnt(0)
    v_mfma_f32_16x16x32_bf16 v[156:159], v[72:75], v[16:19], v[156:159]
    v_mfma_f32_16x16x32_bf16 v[156:159], v[76:79], v[20:23], v[156:159]
    v_mfma_f32_16x16x32_bf16 v[156:159], v[80:83], v[24:27], v[156:159]
    v_mfma_f32_16x16x32_bf16 v[156:159], v[84:87], v[28:31], v[156:159]
    v_mfma_f32_16x16x32_bf16 v[156:159], v[88:91], v[32:35], v[156:159]
    v_mfma_f32_16x16x32_bf16 v[156:159], v[92:95], v[36:39], v[156:159]
    v_mfma_f32_16x16x32_bf16 v[156:159], v[96:99], v[40:43], v[156:159]
    v_mfma_f32_16x16x32_bf16 v[156:159], v[100:103], v[44:47], v[156:159]
    v_mfma_f32_16x16x32_bf16 v[156:159], v[104:107], v[48:51], v[156:159]
    v_mfma_f32_16x16x32_bf16 v[156:159], v[108:111], v[52:55], v[156:159]
    v_mfma_f32_16x16x32_bf16 v[156:159], v[112:115], v[56:59], v[156:159]
    v_mfma_f32_16x16x32_bf16 v[156:159], v[116:119], v[60:63], v[156:159]
    v_mfma_f32_16x16x32_bf16 v[156:159], v[120:123], v[64:67], v[156:159]
    v_mfma_f32_16x16x32_bf16 v[156:159], v[124:127], v[68:71], v[156:159]
    s_nop 7
    buffer_store_dwordx4 v[156:159], v168, s[20:23], s35 offen sc1
    v_mov_b32 v6, 162840
    v_mov_b32 v7, 1
    s_mov_b64 exec, 1
    ds_add_u32 v6, v7
    s_mov_b64 exec, -1
    s_setprio 0
    s_call_b64 s[76:77], SUB_w1_regs
    s_call_b64 s[76:77], SUB_park
    v_mov_b32 v6, 162840
spin_14:
    s_sleep 3
    ds_read_b32 v7, v6
    s_waitcnt lgkmcnt(0)
    v_readfirstlane_b32 s53, v7
    s_nop 0
    s_cmp_ge_u32 s53, 4
    s_cbranch_scc0 spin_14
    s_mov_b64 s[12:13], s[68:69]
    s_mov_b32 s14, 2097152
    s_mov_b32 s15, 0x20000
    s_and_b32 s35, s30, 1
    s_mul_i32 s38, s99, 128
    s_mul_i32 s41, s35, 65536
    s_add_u32 s38, s38, s41
    s_mul_i32 s41, s35, 4096
    s_add_u32 s41, s41, 24576
    s_mov_b32 s42, 0
    s_mov_b32 s44, s67
    s_mov_b32 s42, 98304
    s_mov_b32 s44, s67
    s_add_u32 s44, s44, 12
    s_and_b32 s44, s44, 15
    s_call_b64 s[76:77], SUB_w_issue_1
    s_waitcnt vmcnt(8)
    s_mov_b32 s42, 106496
    s_mov_b32 s44, s67
    s_add_u32 s44, s44, 13
    s_and_b32 s44, s44, 15
    s_call_b64 s[76:77], SUB_w_issue_1
    s_waitcnt vmcnt(8)
    s_mov_b32 s42, 114688
    s_mov_b32 s44, s67
    s_add_u32 s44, s44, 14
    s_and_b32 s44, s44, 15
    s_call_b64 s[76:77], SUB_w_issue_1
    s_waitcnt vmcnt(8)
    s_mov_b32 s42, 122880
    s_mov_b32 s44, s67
    s_add_u32 s44, s44, 15
    s_and_b32 s44, s44, 15
    s_call_b64 s[76:77], SUB_w_issue_1
    s_waitcnt vmcnt(8)
    s_and_b32 s36, s29, 6
    s_cmp_eq_u32 s36, 2
    s_cbranch_scc1 pr_15
    s_call_b64 s[76:77], SUB_park2
pr_15:
    s_call_b64 s[76:77], SUB_w1_put
FR_end:
LAYER:
    v_lshlrev_b32 v40, 6, v199
    v_add_u32 v40, 161792, v40
    s_lshl_b32 s35, s30, 3
    v_add_u32 v39, s35, v40
    s_cmp_eq_u32 s60, 0
    s_cbranch_scc1 R_l0
    s_sub_u32 s8, s62, 0x400000
    s_subb_u32 s9, s63, 0
    s_mov_b32 s10, 0x7e000
    s_mov_b32 s11, 0x20000
    s_sub_u32 s12, s62, 0x380000
    s_subb_u32 s13, s63, 0
    s_mov_b32 s14, 0x7e000
    s_mov_b32 s15, 0x20000
    s_mov_b32 s20, s62
    s_mov_b32 s21, s63
    s_mov_b32 s22, 0x7e000
    s_mov_b32 s23, 0x20000
    s_mov_b32 s78, 0x3f80
    s_mov_b32 s79, 0x3f800000
    v_lshlrev_b32 v222, 16, v230
    v_and_b32 v223, 0xffff0000, v230
    v_lshlrev_b32 v206, 16, v180
    v_and_b32 v207, 0xffff0000, v180
    v_lshlrev_b32 v12, 16, v188
    v_and_b32 v13, 0xffff0000, v188
    v_pk_add_f32 v[206:207], v[206:207], v[12:13]
    v_lshlrev_b32 v224, 16, v231
    v_and_b32 v225, 0xffff0000, v231
    v_lshlrev_b32 v208, 16, v181
    v_and_b32 v209, 0xffff0000, v181
    v_lshlrev_b32 v14, 16, v189
    v_and_b32 v15, 0xffff0000, v189
    v_pk_add_f32 v[208:209], v[208:209], v[14:15]
    v_lshlrev_b32 v226, 16, v232
    v_and_b32 v227, 0xffff0000, v232
    v_lshlrev_b32 v210, 16, v182
    v_and_b32 v211, 0xffff0000, v182
    v_lshlrev_b32 v16, 16, v190
    v_and_b32 v17, 0xffff0000, v190
    v_pk_add_f32 v[210:211], v[210:211], v[16:17]
    v_lshlrev_b32 v228, 16, v233
    v_and_b32 v229, 0xffff0000, v233
    v_lshlrev_b32 v212, 16, v183
    v_and_b32 v213, 0xffff0000, v183
    v_lshlrev_b32 v18, 16, v191
    v_and_b32 v19, 0xffff0000, v191
    v_pk_add_f32 v[212:213], v[212:213], v[18:19]
    v_lshlrev_b32 v230, 16, v234
    v_and_b32 v231, 0xffff0000, v234
    v_lshlrev_b32 v214, 16, v184
    v_and_b32 v215, 0xffff0000, v184
    v_lshlrev_b32 v20, 16, v192
    v_and_b32 v21, 0xffff0000, v192
    v_pk_add_f32 v[214:215], v[214:215], v[20:21]
    v_lshlrev_b32 v232, 16, v235
    v_and_b32 v233, 0xffff0000, v235
    v_lshlrev_b32 v216, 16, v185
    v_and_b32 v217, 0xffff0000, v185
    v_lshlrev_b32 v22, 16, v193
    v_and_b32 v23, 0xffff0000, v193
    v_pk_add_f32 v[216:217], v[216:217], v[22:23]
    v_lshlrev_b32 v234, 16, v236
    v_and_b32 v235, 0xffff0000, v236
    v_lshlrev_b32 v218, 16, v186
    v_and_b32 v219, 0xffff0000, v186
    v_lshlrev_b32 v24, 16, v194
    v_and_b32 v25, 0xffff0000, v194
    v_pk_add_f32 v[218:219], v[218:219], v[24:25]
    v_lshlrev_b32 v236, 16, v237
    v_and_b32 v237, 0xffff0000, v237
    v_lshlrev_b32 v220, 16, v187
    v_and_b32 v221, 0xffff0000, v187
    v_lshlrev_b32 v26, 16, v195
    v_and_b32 v27, 0xffff0000, v195
    v_pk_add_f32 v[220:221], v[220:221], v[26:27]
    s_mov_b32 s53, 0
    s_sleep 10
    s_cmp_ge_u32 s30, 6
    s_cbranch_scc1 dp_16
    s_sleep 14
dp_16:
    buffer_load_dwordx4 v[180:183], v196, s[8:11], 0 offen offset:0 sc1
    buffer_load_dwordx4 v[188:191], v196, s[12:15], 0 offen offset:0 sc1
    buffer_load_dwordx4 v[184:187], v196, s[8:11], 0 offen offset:2048 sc1
    buffer_load_dwordx4 v[192:195], v196, s[12:15], 0 offen offset:2048 sc1
    s_waitcnt vmcnt(0)
    v_bitop3_b32 v6, v180, v184, v188 bitop3:0x80
    v_bitop3_b32 v6, v6, v192, 1 bitop3:0x80
    v_cmp_eq_u32 vcc, 0, v6
    s_cbranch_vccz dq_17
    s_sleep 4
    s_add_u32 s53, s53, 1
    s_cmp_lt_u32 s53, s61
    s_cbranch_scc1 dp_16
    s_mov_b32 s61, 0
dq_17:
    v_dot2_f32_bf16 v206, v180, s78, v206
    v_dot2_f32_bf16 v207, v180, s79, v207
    v_dot2_f32_bf16 v208, v181, s78, v208
    v_dot2_f32_bf16 v209, v181, s79, v209
    v_dot2_f32_bf16 v210, v182, s78, v210
    v_dot2_f32_bf16 v211, v182, s79, v211
    v_dot2_f32_bf16 v212, v183, s78, v212
    v_dot2_f32_bf16 v213, v183, s79, v213
    v_dot2_f32_bf16 v214, v184, s78, v214
    v_dot2_f32_bf16 v215, v184, s79, v215
    v_dot2_f32_bf16 v216, v185, s78, v216
    v_dot2_f32_bf16 v217, v185, s79, v217
    v_dot2_f32_bf16 v218, v186, s78, v218
    v_dot2_f32_bf16 v219, v186, s79, v219
    v_dot2_f32_bf16 v220, v187, s78, v220
    v_dot2_f32_bf16 v221, v187, s79, v221
    v_dot2_f32_bf16 v206, v188, s78, v206
    v_dot2_f32_bf16 v207, v188, s79, v207
    v_dot2_f32_bf16 v208, v189, s78, v208
    v_dot2_f32_bf16 v209, v189, s79, v209
    v_dot2_f32_bf16 v210, v190, s78, v210
    v_dot2_f32_bf16 v211, v190, s79, v211
    v_dot2_f32_bf16 v212, v191, s78, v212
    v_dot2_f32_bf16 v213, v191, s79, v213
    v_dot2_f32_bf16 v214, v192, s78, v214
    v_dot2_f32_bf16 v215, v192, s79, v215
    v_dot2_f32_bf16 v216, v193, s78, v216
    v_dot2_f32_bf16 v217, v193, s79, v217
    v_dot2_f32_bf16 v218, v194, s78, v218
    v_dot2_f32_bf16 v219, v194, s79, v219
    v_dot2_f32_bf16 v220, v195, s78, v220
    v_dot2_f32_bf16 v221, v195, s79, v221
    s_nop 2
    v_pk_add_f32 v[32:33], v[206:207], v[208:209]
    v_pk_mul_f32 v[34:35], v[206:207], v[206:207]
    v_pk_fma_f32 v[34:35], v[208:209], v[208:209], v[34:35]
    v_pk_add_f32 v[32:33], v[32:33], v[210:211]
    v_pk_fma_f32 v[34:35], v[210:211], v[210:211], v[34:35]
    v_pk_add_f32 v[32:33], v[32:33], v[212:213]
    v_pk_fma_f32 v[34:35], v[212:213], v[212:213], v[34:35]
    v_pk_add_f32 v[32:33], v[32:33], v[214:215]
    v_pk_fma_f32 v[34:35], v[214:215], v[214:215], v[34:35]
    v_pk_add_f32 v[32:33], v[32:33], v[216:217]
    v_pk_fma_f32 v[34:35], v[216:217], v[216:217], v[34:35]
    v_pk_add_f32 v[32:33], v[32:33], v[218:219]
    v_pk_fma_f32 v[34:35], v[218:219], v[218:219], v[34:35]
    v_pk_add_f32 v[32:33], v[32:33], v[220:221]
    v_pk_fma_f32 v[34:35], v[220:221], v[220:221], v[34:35]
    v_add_f32 v30, v32, v33
    v_add_f32 v31, v34, v35
    s_nop 0
    v_add_f32_dpp v30, v30, v30 row_ror:8 row_mask:0xf bank_mask:0xf
    v_add_f32_dpp v31, v31, v31 row_ror:8 row_mask:0xf bank_mask:0xf
    v_mov_b32 v32, v30
    v_mov_b32 v33, v31
    s_nop 0
    v_permlane16_swap_b32 v30, v32
    v_permlane16_swap_b32 v31, v33
    v_pk_add_f32 v[30:31], v[30:31], v[32:33]
    v_mov_b32 v32, v30
    v_mov_b32 v33, v31
    s_nop 0
    v_permlane32_swap_b32 v30, v32
    v_permlane32_swap_b32 v31, v33
    v_pk_add_f32 v[30:31], v[30:31], v[32:33]
    ds_write_b64 v39, v[30:31] offset:0
    s_waitcnt lgkmcnt(0)
    s_barrier
    ds_read_b128 v[12:15], v40 offset:0
    ds_read_b128 v[16:19], v40 offset:16
    ds_read_b128 v[20:23], v40 offset:32
    ds_read_b128 v[24:27], v40 offset:48
    s_waitcnt lgkmcnt(0)
    v_pk_add_f32 v[12:13], v[12:13], v[14:15]
    v_pk_add_f32 v[16:17], v[16:17], v[18:19]
    v_pk_add_f32 v[20:21], v[20:21], v[22:23]
    v_pk_add_f32 v[24:25], v[24:25], v[26:27]
    v_pk_add_f32 v[12:13], v[12:13], v[16:17]
    v_pk_add_f32 v[20:21], v[20:21], v[24:25]
    v_pk_add_f32 v[12:13], v[12:13], v[20:21]
    v_mul_f32 v36, 0x3a800000, v12
    v_mul_f32 v38, 0x3a800000, v13
    v_fma_f32 v38, -v36, v36, v38
    v_max_f32 v38, 0, v38
    v_add_f32 v38, 0x3727c5ac, v38
    v_rsq_f32 v37, v38
    s_nop 0
    v_mul_f32 v36, v36, v37
    v_pk_fma_f32 v[12:13], v[206:207], v[36:37], v[36:37] op_sel:[0,1,0] op_sel_hi:[1,1,0] neg_lo:[0,0,1] neg_hi:[0,0,1]
    v_pk_fma_f32 v[14:15], v[208:209], v[36:37], v[36:37] op_sel:[0,1,0] op_sel_hi:[1,1,0] neg_lo:[0,0,1] neg_hi:[0,0,1]
    v_pk_fma_f32 v[16:17], v[210:211], v[36:37], v[36:37] op_sel:[0,1,0] op_sel_hi:[1,1,0] neg_lo:[0,0,1] neg_hi:[0,0,1]
    v_pk_fma_f32 v[18:19], v[212:213], v[36:37], v[36:37] op_sel:[0,1,0] op_sel_hi:[1,1,0] neg_lo:[0,0,1] neg_hi:[0,0,1]
    v_pk_fma_f32 v[20:21], v[214:215], v[36:37], v[36:37] op_sel:[0,1,0] op_sel_hi:[1,1,0] neg_lo:[0,0,1] neg_hi:[0,0,1]
    v_pk_fma_f32 v[22:23], v[216:217], v[36:37], v[36:37] op_sel:[0,1,0] op_sel_hi:[1,1,0] neg_lo:[0,0,1] neg_hi:[0,0,1]
    v_pk_fma_f32 v[24:25], v[218:219], v[36:37], v[36:37] op_sel:[0,1,0] op_sel_hi:[1,1,0] neg_lo:[0,0,1] neg_hi:[0,0,1]
    v_pk_fma_f32 v[26:27], v[220:221], v[36:37], v[36:37] op_sel:[0,1,0] op_sel_hi:[1,1,0] neg_lo:[0,0,1] neg_hi:[0,0,1]
    v_pk_fma_f32 v[206:207], v[12:13], v[222:223], v[206:207]
    v_cvt_pk_bf16_f32 v180, v206, v207
    v_pk_fma_f32 v[208:209], v[14:15], v[224:225], v[208:209]
    v_cvt_pk_bf16_f32 v181, v208, v209
    v_and_b32 v180, -2, v180
    v_pk_fma_f32 v[210:211], v[16:17], v[226:227], v[210:211]
    v_cvt_pk_bf16_f32 v182, v210, v211
    v_pk_fma_f32 v[212:213], v[18:19], v[228:229], v[212:213]
    v_cvt_pk_bf16_f32 v183, v212, v213
    buffer_store_dwordx4 v[180:183], v196, s[20:23], 0 offen offset:0 sc1
    v_pk_fma_f32 v[214:215], v[20:21], v[230:231], v[214:215]
    v_cvt_pk_bf16_f32 v184, v214, v215
    v_pk_fma_f32 v[216:217], v[22:23], v[232:233], v[216:217]
    v_cvt_pk_bf16_f32 v185, v216, v217
    v_and_b32 v184, -2, v184
    v_pk_fma_f32 v[218:219], v[24:25], v[234:235], v[218:219]
    v_cvt_pk_bf16_f32 v186, v218, v219
    v_pk_fma_f32 v[220:221], v[26:27], v[236:237], v[220:221]
    v_cvt_pk_bf16_f32 v187, v220, v221
    buffer_store_dwordx4 v[184:187], v196, s[20:23], 0 offen offset:2048 sc1
    s_branch R_s2
R_l0:
    v_lshlrev_b32 v206, 16, v180
    v_and_b32 v207, 0xffff0000, v180
    v_lshlrev_b32 v208, 16, v181
    v_and_b32 v209, 0xffff0000, v181
    v_lshlrev_b32 v210, 16, v182
    v_and_b32 v211, 0xffff0000, v182
    v_lshlrev_b32 v212, 16, v183
    v_and_b32 v213, 0xffff0000, v183
    v_lshlrev_b32 v214, 16, v184
    v_and_b32 v215, 0xffff0000, v184
    v_lshlrev_b32 v216, 16, v185
    v_and_b32 v217, 0xffff0000, v185
    v_lshlrev_b32 v218, 16, v186
    v_and_b32 v219, 0xffff0000, v186
    v_lshlrev_b32 v220, 16, v187
    v_and_b32 v221, 0xffff0000, v187
    v_pk_add_f32 v[32:33], v[206:207], v[208:209]
    v_pk_mul_f32 v[34:35], v[206:207], v[206:207]
    v_pk_fma_f32 v[34:35], v[208:209], v[208:209], v[34:35]
    v_pk_add_f32 v[32:33], v[32:33], v[210:211]
    v_pk_fma_f32 v[34:35], v[210:211], v[210:211], v[34:35]
    v_pk_add_f32 v[32:33], v[32:33], v[212:213]
    v_pk_fma_f32 v[34:35], v[212:213], v[212:213], v[34:35]
    v_pk_add_f32 v[32:33], v[32:33], v[214:215]
    v_pk_fma_f32 v[34:35], v[214:215], v[214:215], v[34:35]
    v_pk_add_f32 v[32:33], v[32:33], v[216:217]
    v_pk_fma_f32 v[34:35], v[216:217], v[216:217], v[34:35]
    v_pk_add_f32 v[32:33], v[32:33], v[218:219]
    v_pk_fma_f32 v[34:35], v[218:219], v[218:219], v[34:35]
    v_pk_add_f32 v[32:33], v[32:33], v[220:221]
    v_pk_fma_f32 v[34:35], v[220:221], v[220:221], v[34:35]
    v_add_f32 v30, v32, v33
    v_add_f32 v31, v34, v35
    s_nop 0
    v_add_f32_dpp v30, v30, v30 row_ror:8 row_mask:0xf bank_mask:0xf
    v_add_f32_dpp v31, v31, v31 row_ror:8 row_mask:0xf bank_mask:0xf
    v_mov_b32 v32, v30
    v_mov_b32 v33, v31
    s_nop 0
    v_permlane16_swap_b32 v30, v32
    v_permlane16_swap_b32 v31, v33
    v_pk_add_f32 v[30:31], v[30:31], v[32:33]
    v_mov_b32 v32, v30
    v_mov_b32 v33, v31
    s_nop 0
    v_permlane32_swap_b32 v30, v32
    v_permlane32_swap_b32 v31, v33
    v_pk_add_f32 v[30:31], v[30:31], v[32:33]
    ds_write_b64 v39, v[30:31] offset:0
    s_waitcnt lgkmcnt(0)
    v_mov_b32 v222, 162844
spin_18:
    ds_read_b32 v223, v222
    s_waitcnt lgkmcnt(0)
    v_readfirstlane_b32 s94, v223
    s_nop 0
    s_cmp_ge_u32 s94, 65536
    s_cbranch_scc0 spin_18
    s_cmp_gt_u32 s94, 65546
    s_cselect_b32 s94, 1, 0
    s_lshl_b32 s53, s94, 13
    v_xor_b32 v197, s53, v197
    s_lshr_b32 s53, s28, 3
    s_lshl_b32 s53, s53, 2
    s_and_b32 s54, s28, 3
    s_add_u32 s53, s53, s54
    s_lshl_b32 s53, s53, 24
    s_lshr_b32 s54, s28, 2
    s_xor_b32 s54, s54, s94
    s_and_b32 s54, s54, 1
    s_lshl_b32 s54, s54, 13
    s_add_u32 s36, s53, s54
    s_add_u32 s36, s36, 33554432
    s_lshr_b32 s53, s53, 14
    s_add_u32 s36, s53, s54
    s_xor_b32 s36, s36, 8192
    s_add_u32 s36, s36, 23101440
    s_lshl_b32 s53, s30, 7
    s_add_u32 s36, s36, s53
    v_mov_b32 v226, s36
    s_waitcnt vmcnt(0)
    s_barrier
    s_mov_b32 s53, 0
    s_add_u32 s54, s52, 32
    s_bfm_b64 exec, 1, 0
poll_19:
    buffer_load_dword v222, v226, s[56:59], 0 offen sc1
    s_waitcnt vmcnt(0)
    v_xor_b32 v222, s54, v222
    v_cmp_eq_u32 vcc, 0, v222
    s_nop 0
    s_cmp_eq_u64 vcc, exec
    s_cbranch_scc1 pok_20
    s_sleep 6
    s_add_u32 s53, s53, 1
    s_cmp_lt_u32 s53, s61
    s_cbranch_scc1 poll_19
    s_mov_b32 s61, 0
pok_20:
    s_mov_b64 exec, -1
    s_add_u32 s80, s4, 0x2100000
    s_addc_u32 s81, s5, 0
    s_mov_b32 s82, 0x7f00000
    s_mov_b32 s83, 0x20000
    s_mov_b32 s78, 0
    buffer_load_dwordx2 v[230:231], v197, s[80:83], s78 offen sc1
    s_mov_b32 s78, 2048
    buffer_load_dwordx2 v[232:233], v197, s[80:83], s78 offen sc1
    s_mov_b32 s78, 16384
    buffer_load_dwordx2 v[234:235], v197, s[80:83], s78 offen sc1
    s_mov_b32 s78, 18432
    buffer_load_dwordx2 v[236:237], v197, s[80:83], s78 offen sc1
    s_lshr_b32 s53, s28, 3
    s_lshl_b32 s53, s53, 2
    s_and_b32 s54, s28, 3
    s_add_u32 s53, s53, s54
    s_lshl_b32 s53, s53, 24
    s_lshr_b32 s54, s28, 2
    s_xor_b32 s54, s54, s94
    s_and_b32 s54, s54, 1
    s_lshl_b32 s54, s54, 13
    s_add_u32 s55, s53, s54
    s_add_u32 s55, s55, 33554432
    s_add_u32 s62, s4, s55
    s_addc_u32 s63, s5, 0
    s_sub_u32 s36, s28, 1
    s_max_i32 s36, s36, 0
    s_lshr_b32 s53, s36, 3
    s_lshl_b32 s53, s53, 2
    s_and_b32 s54, s36, 3
    s_add_u32 s53, s53, s54
    s_lshl_b32 s53, s53, 24
    s_lshr_b32 s54, s36, 2
    s_xor_b32 s54, s54, s94
    s_and_b32 s54, s54, 1
    s_lshl_b32 s54, s54, 13
    s_add_u32 s92, s53, s54
    s_add_u32 s92, s92, 33554432
    s_sub_u32 s92, s92, s55
    s_add_u32 s36, s28, 1
    s_min_u32 s36, s36, 15
    s_lshr_b32 s53, s36, 3
    s_lshl_b32 s53, s53, 2
    s_and_b32 s54, s36, 3
    s_add_u32 s53, s53, s54
    s_lshl_b32 s53, s53, 24
    s_lshr_b32 s54, s36, 2
    s_xor_b32 s54, s54, s94
    s_and_b32 s54, s54, 1
    s_lshl_b32 s54, s54, 13
    s_add_u32 s93, s53, s54
    s_add_u32 s93, s93, 33554432
    s_sub_u32 s93, s93, s55
    s_add_u32 s55, s55, 6029312
    s_mov_b32 s20, s62
    s_mov_b32 s21, s63
    s_mov_b32 s22, 0x7e000
    s_mov_b32 s23, 0x20000
    ds_read_b128 v[12:15], v40 offset:0
    ds_read_b128 v[16:19], v40 offset:16
    ds_read_b128 v[20:23], v40 offset:32
    ds_read_b128 v[24:27], v40 offset:48
    s_waitcnt lgkmcnt(0)
    v_pk_add_f32 v[12:13], v[12:13], v[14:15]
    v_pk_add_f32 v[16:17], v[16:17], v[18:19]
    v_pk_add_f32 v[20:21], v[20:21], v[22:23]
    v_pk_add_f32 v[24:25], v[24:25], v[26:27]
    v_pk_add_f32 v[12:13], v[12:13], v[16:17]
    v_pk_add_f32 v[20:21], v[20:21], v[24:25]
    v_pk_add_f32 v[12:13], v[12:13], v[20:21]
    v_mul_f32 v36, 0x3a800000, v12
    v_mul_f32 v38, 0x3a800000, v13
    v_fma_f32 v38, -v36, v36, v38
    v_max_f32 v38, 0, v38
    v_add_f32 v38, 0x3727c5ac, v38
    v_rsq_f32 v37, v38
    s_nop 0
    v_pk_add_f32 v[12:13], v[206:207], v[36:37] op_sel_hi:[1,0] neg_lo:[0,1] neg_hi:[0,1]
    v_pk_mul_f32 v[12:13], v[12:13], v[36:37] op_sel:[0,1] op_sel_hi:[1,1]
    v_pk_add_f32 v[14:15], v[208:209], v[36:37] op_sel_hi:[1,0] neg_lo:[0,1] neg_hi:[0,1]
    v_pk_mul_f32 v[14:15], v[14:15], v[36:37] op_sel:[0,1] op_sel_hi:[1,1]
    v_pk_add_f32 v[16:17], v[210:211], v[36:37] op_sel_hi:[1,0] neg_lo:[0,1] neg_hi:[0,1]
    v_pk_mul_f32 v[16:17], v[16:17], v[36:37] op_sel:[0,1] op_sel_hi:[1,1]
    v_pk_add_f32 v[18:19], v[212:213], v[36:37] op_sel_hi:[1,0] neg_lo:[0,1] neg_hi:[0,1]
    v_pk_mul_f32 v[18:19], v[18:19], v[36:37] op_sel:[0,1] op_sel_hi:[1,1]
    v_pk_add_f32 v[20:21], v[214:215], v[36:37] op_sel_hi:[1,0] neg_lo:[0,1] neg_hi:[0,1]
    v_pk_mul_f32 v[20:21], v[20:21], v[36:37] op_sel:[0,1] op_sel_hi:[1,1]
    v_pk_add_f32 v[22:23], v[216:217], v[36:37] op_sel_hi:[1,0] neg_lo:[0,1] neg_hi:[0,1]
    v_pk_mul_f32 v[22:23], v[22:23], v[36:37] op_sel:[0,1] op_sel_hi:[1,1]
    v_pk_add_f32 v[24:25], v[218:219], v[36:37] op_sel_hi:[1,0] neg_lo:[0,1] neg_hi:[0,1]
    v_pk_mul_f32 v[24:25], v[24:25], v[36:37] op_sel:[0,1] op_sel_hi:[1,1]
    v_pk_add_f32 v[26:27], v[220:221], v[36:37] op_sel_hi:[1,0] neg_lo:[0,1] neg_hi:[0,1]
    v_pk_mul_f32 v[26:27], v[26:27], v[36:37] op_sel:[0,1] op_sel_hi:[1,1]
    s_barrier
    s_waitcnt vmcnt(0)
    v_lshlrev_b32 v222, 16, v230
    v_and_b32 v223, 0xffff0000, v230
    v_pk_fma_f32 v[206:207], v[12:13], v[222:223], v[206:207]
    v_cvt_pk_bf16_f32 v180, v206, v207
    v_lshlrev_b32 v222, 16, v231
    v_and_b32 v223, 0xffff0000, v231
    v_pk_fma_f32 v[208:209], v[14:15], v[222:223], v[208:209]
    v_cvt_pk_bf16_f32 v181, v208, v209
    v_and_b32 v180, -2, v180
    v_lshlrev_b32 v222, 16, v232
    v_and_b32 v223, 0xffff0000, v232
    v_pk_fma_f32 v[210:211], v[16:17], v[222:223], v[210:211]
    v_cvt_pk_bf16_f32 v182, v210, v211
    v_lshlrev_b32 v222, 16, v233
    v_and_b32 v223, 0xffff0000, v233
    v_pk_fma_f32 v[212:213], v[18:19], v[222:223], v[212:213]
    v_cvt_pk_bf16_f32 v183, v212, v213
    buffer_store_dwordx4 v[180:183], v196, s[20:23], 0 offen offset:0 sc1
    v_lshlrev_b32 v222, 16, v234
    v_and_b32 v223, 0xffff0000, v234
    v_pk_fma_f32 v[214:215], v[20:21], v[222:223], v[214:215]
    v_cvt_pk_bf16_f32 v184, v214, v215
    v_lshlrev_b32 v222, 16, v235
    v_and_b32 v223, 0xffff0000, v235
    v_pk_fma_f32 v[216:217], v[22:23], v[222:223], v[216:217]
    v_cvt_pk_bf16_f32 v185, v216, v217
    v_and_b32 v184, -2, v184
    v_lshlrev_b32 v222, 16, v236
    v_and_b32 v223, 0xffff0000, v236
    v_pk_fma_f32 v[218:219], v[24:25], v[222:223], v[218:219]
    v_cvt_pk_bf16_f32 v186, v218, v219
    v_lshlrev_b32 v222, 16, v237
    v_and_b32 v223, 0xffff0000, v237
    v_pk_fma_f32 v[220:221], v[26:27], v[222:223], v[220:221]
    v_cvt_pk_bf16_f32 v187, v220, v221
    buffer_store_dwordx4 v[184:187], v196, s[20:23], 0 offen offset:2048 sc1
R_s2:
    v_lshlrev_b32 v206, 16, v180
    v_and_b32 v207, 0xffff0000, v180
    v_lshlrev_b32 v208, 16, v181
    v_and_b32 v209, 0xffff0000, v181
    v_lshlrev_b32 v210, 16, v182
    v_and_b32 v211, 0xffff0000, v182
    v_lshlrev_b32 v212, 16, v183
    v_and_b32 v213, 0xffff0000, v183
    v_lshlrev_b32 v214, 16, v184
    v_and_b32 v215, 0xffff0000, v184
    v_lshlrev_b32 v216, 16, v185
    v_and_b32 v217, 0xffff0000, v185
    v_lshlrev_b32 v218, 16, v186
    v_and_b32 v219, 0xffff0000, v186
    v_lshlrev_b32 v220, 16, v187
    v_and_b32 v221, 0xffff0000, v187
    v_pk_add_f32 v[32:33], v[206:207], v[208:209]
    v_pk_mul_f32 v[34:35], v[206:207], v[206:207]
    v_pk_fma_f32 v[34:35], v[208:209], v[208:209], v[34:35]
    v_pk_add_f32 v[32:33], v[32:33], v[210:211]
    v_pk_fma_f32 v[34:35], v[210:211], v[210:211], v[34:35]
    v_pk_add_f32 v[32:33], v[32:33], v[212:213]
    v_pk_fma_f32 v[34:35], v[212:213], v[212:213], v[34:35]
    v_pk_add_f32 v[32:33], v[32:33], v[214:215]
    v_pk_fma_f32 v[34:35], v[214:215], v[214:215], v[34:35]
    v_pk_add_f32 v[32:33], v[32:33], v[216:217]
    v_pk_fma_f32 v[34:35], v[216:217], v[216:217], v[34:35]
    v_pk_add_f32 v[32:33], v[32:33], v[218:219]
    v_pk_fma_f32 v[34:35], v[218:219], v[218:219], v[34:35]
    v_pk_add_f32 v[32:33], v[32:33], v[220:221]
    v_pk_fma_f32 v[34:35], v[220:221], v[220:221], v[34:35]
    v_add_f32 v30, v32, v33
    v_add_f32 v31, v34, v35
    s_nop 0
    v_add_f32_dpp v30, v30, v30 row_ror:8 row_mask:0xf bank_mask:0xf
    v_add_f32_dpp v31, v31, v31 row_ror:8 row_mask:0xf bank_mask:0xf
    v_mov_b32 v32, v30
    v_mov_b32 v33, v31
    s_nop 0
    v_permlane16_swap_b32 v30, v32
    v_permlane16_swap_b32 v31, v33
    v_pk_add_f32 v[30:31], v[30:31], v[32:33]
    v_mov_b32 v32, v30
    v_mov_b32 v33, v31
    s_nop 0
    v_permlane32_swap_b32 v30, v32
    v_permlane32_swap_b32 v31, v33
    v_pk_add_f32 v[30:31], v[30:31], v[32:33]
    ds_write_b64 v39, v[30:31] offset:512
    s_waitcnt lgkmcnt(0)
    s_barrier
    s_cmp_lg_u32 s30, 6
    s_cbranch_scc1 R_n6
    s_cmp_lg_u32 s60, 0
    s_cbranch_scc1 R_n6
    s_lshl_b32 s53, s29, 7
    s_add_u32 s53, s53, 23121920
    v_mov_b32 v8, 1
    v_mov_b32 v9, 0
    s_mov_b64 exec, 1
    buffer_atomic_add v8, v9, s[56:59], s53 offen sc1
    s_mov_b64 exec, -1
R_n6:
    s_cmp_lg_u32 s30, 7
    s_cbranch_scc1 R_nl
    ds_read_b128 v[12:15], v40 offset:512
    ds_read_b128 v[16:19], v40 offset:528
    ds_read_b128 v[20:23], v40 offset:544
    ds_read_b128 v[24:27], v40 offset:560
    s_waitcnt lgkmcnt(0)
    v_pk_add_f32 v[12:13], v[12:13], v[14:15]
    v_pk_add_f32 v[16:17], v[16:17], v[18:19]
    v_pk_add_f32 v[20:21], v[20:21], v[22:23]
    v_pk_add_f32 v[24:25], v[24:25], v[26:27]
    v_pk_add_f32 v[12:13], v[12:13], v[16:17]
    v_pk_add_f32 v[20:21], v[20:21], v[24:25]
    v_pk_add_f32 v[12:13], v[12:13], v[20:21]
    v_mul_f32 v36, 0x3a800000, v12
    v_mul_f32 v38, 0x3a800000, v13
    v_fma_f32 v38, -v36, v36, v38
    v_max_f32 v38, 0, v38
    v_mov_b32 v42, v36
    v_mov_b32 v43, v38
    v_add_f32 v38, 0x3727c5ac, v38
    v_sqrt_f32 v38, v38
    s_nop 0
    v_mov_b32 v41, v38
    v_rcp_f32 v37, v38
    v_sub_f32 v42, v42, v36
    v_mul_f32 v42, v42, v37
    v_mul_f32 v43, v43, v37
    v_mul_f32 v43, v43, v37
    v_add_f32 v43, 0x3727c5ac, v43
    v_rsq_f32 v44, v43
    v_mov_b32 v224, v36
    v_mov_b32 v225, v37
    v_fma_f32 v226, v42, v41, v36
    v_mul_f32 v227, v37, v44
    s_add_u32 s24, s62, 0x5d0000
    s_addc_u32 s25, s63, 0
    s_mov_b32 s26, 0x800
    s_mov_b32 s27, 0x20000
    s_lshl_b32 s36, s29, 3
    v_add_u32 v6, s36, v199
    v_lshlrev_b32 v6, 4, v6
    s_mov_b64 exec, 0xff
    buffer_store_dwordx4 v[224:227], v6, s[24:27], 0 offen sc1
    s_mov_b64 exec, -1
    s_add_u32 s53, s55, 1280
    v_mov_b32 v8, 1
    v_mov_b32 v9, 162816
    v_mov_b32 v11, 0
    s_mov_b64 exec, 1
    s_waitcnt vmcnt(0)
    buffer_atomic_add v8, v11, s[56:59], s53 offen sc1
pub_21:
    s_mov_b64 exec, -1
R_nl:
    s_cmp_ge_u32 s30, 4
    s_cbranch_scc1 LOADERS
    s_setprio 1
    s_mov_b32 s8, s62
    s_mov_b32 s9, s63
    s_mov_b32 s10, 0x7e000
    s_mov_b32 s11, 0x20000
    v_add_u32 v126, 0, v2
    v_add_u32 v127, 65536, v2
    s_lshl_b32 s44, s30, 17
    s_mov_b32 s34, s30
    s_mov_b32 s35, 0
    v_and_b32 v22, 15, v1
    v_lshrrev_b32 v23, 4, v1
    s_mul_i32 s37, s34, 2
    s_mul_i32 s38, s99, 4
    s_mul_i32 s36, s35, 4
    s_add_u32 s38, s38, s36
    v_add_u32 v128, 4096, v2
    v_add_u32 v129, 69632, v2
    s_add_u32 s45, s44, 16384
    s_add_u32 s46, s44, 32768
    s_add_u32 s47, s44, 49152
    v_min_u32 v18, 1, v1
    v_lshlrev_b32 v18, 16, v18
    v_add_u32 v18, 162896, v18
    v_mov_b32 v19, 1
    v_lshrrev_b32 v6, 2, v1
    v_mul_u32_u24 v13, 128, v6
    v_and_b32 v7, 3, v1
    v_lshl_add_u32 v13, v7, 3, v13
    v_add_u32 v13, 24576, v13
    v_bfe_u32 v6, v6, 1, 2
    s_mul_i32 s36, s35, 4
    s_add_u32 s36, s36, 3
    v_xor_b32 v7, s36, v6
    v_lshl_add_u32 v16, v7, 5, v13
    s_mul_i32 s36, s35, 4
    s_add_u32 s36, s36, 2
    v_xor_b32 v7, s36, v6
    v_lshl_add_u32 v15, v7, 5, v13
    s_mul_i32 s36, s35, 4
    s_add_u32 s36, s36, 1
    v_xor_b32 v7, s36, v6
    v_lshl_add_u32 v14, v7, 5, v13
    s_mul_i32 s36, s35, 4
    s_add_u32 s36, s36, 0
    v_xor_b32 v7, s36, v6
    v_lshl_add_u32 v13, v7, 5, v13
    v_pk_mov_b32 v[24:25], 0, 0
    v_pk_mov_b32 v[26:27], 0, 0
    v_pk_mov_b32 v[28:29], 0, 0
    v_pk_mov_b32 v[30:31], 0, 0
    v_pk_mov_b32 v[32:33], 0, 0
    v_pk_mov_b32 v[34:35], 0, 0
    v_pk_mov_b32 v[36:37], 0, 0
    v_pk_mov_b32 v[38:39], 0, 0
    v_pk_mov_b32 v[40:41], 0, 0
    v_pk_mov_b32 v[42:43], 0, 0
    v_pk_mov_b32 v[44:45], 0, 0
    v_pk_mov_b32 v[46:47], 0, 0
    v_pk_mov_b32 v[48:49], 0, 0
    v_pk_mov_b32 v[50:51], 0, 0
    v_pk_mov_b32 v[52:53], 0, 0
    v_pk_mov_b32 v[54:55], 0, 0
    s_mov_b32 s43, 0
    s_mul_i32 s36, s35, 256
    s_add_u32 s36, s36, 163328
    v_lshlrev_b32 v6, 4, v23
    v_add_u32 v6, s36, v6
    s_lshl_b32 s36, s37, 8
    s_add_u32 s36, s36, 160776
    v_lshlrev_b32 v7, 4, v22
    v_add_u32 v7, s36, v7
    s_add_u32 s16, s62, 0x100000
    s_addc_u32 s17, s63, 0
    s_mov_b32 s18, 0x7e000
    s_mov_b32 s19, 0x20000
    v_lshlrev_b32 v12, 11, v23
    v_lshl_add_u32 v12, v22, 4, v12
    s_lshl_b32 s39, s38, 13
    s_lshl_b32 s36, s37, 8
    s_add_u32 s39, s39, s36
    s_add_u32 s40, s39, 16384
    s_lshl_b32 s36, s29, 1
    s_lshr_b32 s53, s36, 3
    s_lshl_b32 s53, s53, 14
    s_and_b32 s41, s36, 7
    s_lshl_b32 s41, s41, 10
    s_add_u32 s41, s41, s53
    s_lshl_b32 s36, s37, 16
    s_add_u32 s41, s41, s36
    s_mov_b32 s53, 0
    s_mov_b32 s49, s44
    ds_read_b64_tr_b16 v[56:57], v13 offset:0
    ds_read_b64_tr_b16 v[58:59], v13 offset:2048
    ds_read_b64_tr_b16 v[60:61], v14 offset:0
    ds_read_b64_tr_b16 v[62:63], v14 offset:2048
    ds_read_b64_tr_b16 v[64:65], v15 offset:0
    ds_read_b64_tr_b16 v[66:67], v15 offset:2048
    ds_read_b64_tr_b16 v[68:69], v16 offset:0
    ds_read_b64_tr_b16 v[70:71], v16 offset:2048
    ds_read_b64_tr_b16 v[72:73], v13 offset:4096
    ds_read_b64_tr_b16 v[74:75], v13 offset:6144
    ds_read_b64_tr_b16 v[76:77], v14 offset:4096
    ds_read_b64_tr_b16 v[78:79], v14 offset:6144
    ds_read_b64_tr_b16 v[80:81], v15 offset:4096
    ds_read_b64_tr_b16 v[82:83], v15 offset:6144
    ds_read_b64_tr_b16 v[84:85], v16 offset:4096
    ds_read_b64_tr_b16 v[86:87], v16 offset:6144
dm_22p:
    buffer_load_dwordx4 v[164:167], v126, s[8:11], s44 offen offset:0 sc1
    buffer_load_dwordx4 v[168:171], v127, s[8:11], s44 offen offset:0 sc1
    buffer_load_dwordx4 v[172:175], v126, s[8:11], s44 offen offset:1024 sc1
    buffer_load_dwordx4 v[176:179], v127, s[8:11], s44 offen offset:1024 sc1
    buffer_load_dwordx4 v[180:183], v126, s[8:11], s44 offen offset:2048 sc1
    buffer_load_dwordx4 v[184:187], v127, s[8:11], s44 offen offset:2048 sc1
    buffer_load_dwordx4 v[188:191], v126, s[8:11], s44 offen offset:3072 sc1
    buffer_load_dwordx4 v[192:195], v127, s[8:11], s44 offen offset:3072 sc1
dm_22w:
    s_waitcnt vmcnt(4)
    v_or3_b32 v17, v164, v168, v172
    v_bitop3_b32 v17, v17, v176, 1 bitop3:0xa8
    v_cmp_ne_u32 vcc, 0, v17
    s_cbranch_vccz dm_22q
dm_22r:
    s_sleep 2
    buffer_load_dwordx4 v[164:167], v126, s[8:11], s44 offen offset:0 sc1
    buffer_load_dwordx4 v[168:171], v127, s[8:11], s44 offen offset:0 sc1
    buffer_load_dwordx4 v[172:175], v126, s[8:11], s44 offen offset:1024 sc1
    buffer_load_dwordx4 v[176:179], v127, s[8:11], s44 offen offset:1024 sc1
    buffer_load_dwordx4 v[180:183], v126, s[8:11], s44 offen offset:2048 sc1
    buffer_load_dwordx4 v[184:187], v127, s[8:11], s44 offen offset:2048 sc1
    buffer_load_dwordx4 v[188:191], v126, s[8:11], s44 offen offset:3072 sc1
    buffer_load_dwordx4 v[192:195], v127, s[8:11], s44 offen offset:3072 sc1
    s_waitcnt vmcnt(4)
    v_or3_b32 v17, v164, v168, v172
    v_bitop3_b32 v17, v17, v176, 1 bitop3:0xa8
    v_cmp_ne_u32 vcc, 0, v17
    s_cbranch_vccz dm_22t
    s_add_u32 s53, s53, 1
    s_cmp_lt_u32 s53, s61
    s_cbranch_scc1 dm_22r
    s_mov_b32 s61, 0
    s_branch dm_22t
dm_22q:
dm_22t:
    buffer_load_dwordx4 v[196:199], v128, s[8:11], s44 offen offset:0 sc1
    buffer_load_dwordx4 v[200:203], v129, s[8:11], s44 offen offset:0 sc1
    buffer_load_dwordx4 v[204:207], v128, s[8:11], s44 offen offset:1024 sc1
    buffer_load_dwordx4 v[208:211], v129, s[8:11], s44 offen offset:1024 sc1
    buffer_load_dwordx4 v[212:215], v128, s[8:11], s44 offen offset:2048 sc1
    buffer_load_dwordx4 v[216:219], v129, s[8:11], s44 offen offset:2048 sc1
    s_waitcnt lgkmcnt(0)
dm_22:
    v_mfma_f32_16x16x32_bf16 v[24:27], v[56:59], v[164:167], v[24:27]
    ds_read_b64_tr_b16 v[88:89], v13 offset:8192
    buffer_load_dwordx4 v[220:223], v128, s[8:11], s44 offen offset:3072 sc1
    v_mfma_f32_16x16x32_bf16 v[40:43], v[56:59], v[168:171], v[40:43]
    ds_read_b64_tr_b16 v[90:91], v13 offset:10240
    buffer_load_dwordx4 v[224:227], v129, s[8:11], s44 offen offset:3072 sc1
    v_mfma_f32_16x16x32_bf16 v[44:47], v[60:63], v[168:171], v[44:47]
    ds_read_b64_tr_b16 v[92:93], v14 offset:8192
    s_mov_b32 s44, s45
    v_mfma_f32_16x16x32_bf16 v[28:31], v[60:63], v[164:167], v[28:31]
    ds_read_b64_tr_b16 v[94:95], v14 offset:10240
    s_mov_b32 s45, s46
    v_mfma_f32_16x16x32_bf16 v[32:35], v[64:67], v[164:167], v[32:35]
    ds_read_b64_tr_b16 v[96:97], v15 offset:8192
    s_mov_b32 s46, s47
    v_mfma_f32_16x16x32_bf16 v[48:51], v[64:67], v[168:171], v[48:51]
    ds_read_b64_tr_b16 v[98:99], v15 offset:10240
    s_mov_b32 s47, 1048576
    v_mfma_f32_16x16x32_bf16 v[52:55], v[68:71], v[168:171], v[52:55]
    ds_read_b64_tr_b16 v[100:101], v16 offset:8192
    v_mfma_f32_16x16x32_bf16 v[36:39], v[68:71], v[164:167], v[36:39]
    ds_read_b64_tr_b16 v[102:103], v16 offset:10240
    s_waitcnt lgkmcnt(8)
    v_mfma_f32_16x16x32_bf16 v[24:27], v[72:75], v[172:175], v[24:27]
    ds_read_b64_tr_b16 v[104:105], v13 offset:12288
    buffer_load_dwordx4 v[164:167], v126, s[8:11], s44 offen offset:0 sc1
    v_mfma_f32_16x16x32_bf16 v[40:43], v[72:75], v[176:179], v[40:43]
    ds_read_b64_tr_b16 v[106:107], v13 offset:14336
    buffer_load_dwordx4 v[168:171], v127, s[8:11], s44 offen offset:0 sc1
    v_mfma_f32_16x16x32_bf16 v[44:47], v[76:79], v[176:179], v[44:47]
    ds_read_b64_tr_b16 v[108:109], v14 offset:12288
    s_waitcnt vmcnt(10)
    v_mfma_f32_16x16x32_bf16 v[28:31], v[76:79], v[172:175], v[28:31]
    ds_read_b64_tr_b16 v[110:111], v14 offset:14336
    v_or3_b32 v17, v180, v184, v188
    v_mfma_f32_16x16x32_bf16 v[32:35], v[80:83], v[172:175], v[32:35]
    ds_read_b64_tr_b16 v[112:113], v15 offset:12288
    v_bitop3_b32 v17, v17, v192, 1 bitop3:0xa8
    v_mfma_f32_16x16x32_bf16 v[48:51], v[80:83], v[176:179], v[48:51]
    ds_read_b64_tr_b16 v[114:115], v15 offset:14336
    v_cmp_ne_u32 vcc, 0, v17
    v_mfma_f32_16x16x32_bf16 v[52:55], v[84:87], v[176:179], v[52:55]
    ds_read_b64_tr_b16 v[116:117], v16 offset:12288
    ds_read_b64_tr_b16 v[118:119], v16 offset:14336
    v_mfma_f32_16x16x32_bf16 v[36:39], v[84:87], v[172:175], v[36:39]
    s_waitcnt lgkmcnt(8)
    s_cbranch_vccnz dm_22f0
dm_22g0:
    v_mfma_f32_16x16x32_bf16 v[24:27], v[88:91], v[180:183], v[24:27]
    ds_read_b64_tr_b16 v[56:57], v13 offset:16384
    buffer_load_dwordx4 v[172:175], v126, s[8:11], s44 offen offset:1024 sc1
    v_mfma_f32_16x16x32_bf16 v[40:43], v[88:91], v[184:187], v[40:43]
    ds_read_b64_tr_b16 v[58:59], v13 offset:18432
    buffer_load_dwordx4 v[176:179], v127, s[8:11], s44 offen offset:1024 sc1
    v_mfma_f32_16x16x32_bf16 v[44:47], v[92:95], v[184:187], v[44:47]
    ds_read_b64_tr_b16 v[60:61], v14 offset:16384
    v_mfma_f32_16x16x32_bf16 v[28:31], v[92:95], v[180:183], v[28:31]
    ds_read_b64_tr_b16 v[62:63], v14 offset:18432
    v_mfma_f32_16x16x32_bf16 v[32:35], v[96:99], v[180:183], v[32:35]
    ds_read_b64_tr_b16 v[64:65], v15 offset:16384
    v_mfma_f32_16x16x32_bf16 v[48:51], v[96:99], v[184:187], v[48:51]
    ds_read_b64_tr_b16 v[66:67], v15 offset:18432
    v_mfma_f32_16x16x32_bf16 v[52:55], v[100:103], v[184:187], v[52:55]
    ds_read_b64_tr_b16 v[68:69], v16 offset:16384
    v_mfma_f32_16x16x32_bf16 v[36:39], v[100:103], v[180:183], v[36:39]
    ds_read_b64_tr_b16 v[70:71], v16 offset:18432
    s_waitcnt lgkmcnt(8)
    v_mfma_f32_16x16x32_bf16 v[24:27], v[104:107], v[188:191], v[24:27]
    ds_read_b64_tr_b16 v[72:73], v13 offset:20480
    buffer_load_dwordx4 v[180:183], v126, s[8:11], s44 offen offset:2048 sc1
    v_mfma_f32_16x16x32_bf16 v[40:43], v[104:107], v[192:195], v[40:43]
    ds_read_b64_tr_b16 v[74:75], v13 offset:22528
    buffer_load_dwordx4 v[184:187], v127, s[8:11], s44 offen offset:2048 sc1
    v_mfma_f32_16x16x32_bf16 v[44:47], v[108:111], v[192:195], v[44:47]
    ds_read_b64_tr_b16 v[76:77], v14 offset:20480
    s_waitcnt vmcnt(10)
    v_mfma_f32_16x16x32_bf16 v[28:31], v[108:111], v[188:191], v[28:31]
    ds_read_b64_tr_b16 v[78:79], v14 offset:22528
    v_or3_b32 v17, v196, v200, v204
    v_mfma_f32_16x16x32_bf16 v[32:35], v[112:115], v[188:191], v[32:35]
    ds_read_b64_tr_b16 v[80:81], v15 offset:20480
    v_bitop3_b32 v17, v17, v208, 1 bitop3:0xa8
    v_mfma_f32_16x16x32_bf16 v[48:51], v[112:115], v[192:195], v[48:51]
    ds_read_b64_tr_b16 v[82:83], v15 offset:22528
    v_cmp_ne_u32 vcc, 0, v17
    v_mfma_f32_16x16x32_bf16 v[52:55], v[116:119], v[192:195], v[52:55]
    ds_read_b64_tr_b16 v[84:85], v16 offset:20480
    ds_read_b64_tr_b16 v[86:87], v16 offset:22528
    v_mfma_f32_16x16x32_bf16 v[36:39], v[116:119], v[188:191], v[36:39]
    s_waitcnt lgkmcnt(8)
    s_cbranch_vccnz dm_22f1
dm_22g1:
    v_mfma_f32_16x16x32_bf16 v[24:27], v[56:59], v[196:199], v[24:27]
    ds_read_b64_tr_b16 v[88:89], v13 offset:24576
    buffer_load_dwordx4 v[188:191], v126, s[8:11], s44 offen offset:3072 sc1
    v_mfma_f32_16x16x32_bf16 v[40:43], v[56:59], v[200:203], v[40:43]
    ds_read_b64_tr_b16 v[90:91], v13 offset:26624
    buffer_load_dwordx4 v[192:195], v127, s[8:11], s44 offen offset:3072 sc1
    v_mfma_f32_16x16x32_bf16 v[44:47], v[60:63], v[200:203], v[44:47]
    ds_read_b64_tr_b16 v[92:93], v14 offset:24576
    v_mfma_f32_16x16x32_bf16 v[28:31], v[60:63], v[196:199], v[28:31]
    ds_read_b64_tr_b16 v[94:95], v14 offset:26624
    v_mfma_f32_16x16x32_bf16 v[32:35], v[64:67], v[196:199], v[32:35]
    ds_read_b64_tr_b16 v[96:97], v15 offset:24576
    s_add_u32 s43, s43, 1
    v_mfma_f32_16x16x32_bf16 v[48:51], v[64:67], v[200:203], v[48:51]
    ds_read_b64_tr_b16 v[98:99], v15 offset:26624
    v_mfma_f32_16x16x32_bf16 v[52:55], v[68:71], v[200:203], v[52:55]
    ds_read_b64_tr_b16 v[100:101], v16 offset:24576
    v_mfma_f32_16x16x32_bf16 v[36:39], v[68:71], v[196:199], v[36:39]
    ds_read_b64_tr_b16 v[102:103], v16 offset:26624
    s_waitcnt lgkmcnt(8)
    v_mfma_f32_16x16x32_bf16 v[24:27], v[72:75], v[204:207], v[24:27]
    ds_read_b64_tr_b16 v[104:105], v13 offset:28672
    buffer_load_dwordx4 v[196:199], v128, s[8:11], s44 offen offset:0 sc1
    v_mfma_f32_16x16x32_bf16 v[40:43], v[72:75], v[208:211], v[40:43]
    ds_read_b64_tr_b16 v[106:107], v13 offset:30720
    buffer_load_dwordx4 v[200:203], v129, s[8:11], s44 offen offset:0 sc1
    v_mfma_f32_16x16x32_bf16 v[44:47], v[76:79], v[208:211], v[44:47]
    ds_read_b64_tr_b16 v[108:109], v14 offset:28672
    s_waitcnt vmcnt(10)
    v_mfma_f32_16x16x32_bf16 v[28:31], v[76:79], v[204:207], v[28:31]
    ds_read_b64_tr_b16 v[110:111], v14 offset:30720
    v_add_u32 v13, 32768, v13
    v_or3_b32 v17, v212, v216, v220
    v_mfma_f32_16x16x32_bf16 v[32:35], v[80:83], v[204:207], v[32:35]
    ds_read_b64_tr_b16 v[112:113], v15 offset:28672
    v_add_u32 v14, 32768, v14
    v_bitop3_b32 v17, v17, v224, 1 bitop3:0xa8
    v_mfma_f32_16x16x32_bf16 v[48:51], v[80:83], v[208:211], v[48:51]
    ds_read_b64_tr_b16 v[114:115], v15 offset:30720
    v_add_u32 v15, 32768, v15
    v_cmp_ne_u32 vcc, 0, v17
    v_mfma_f32_16x16x32_bf16 v[52:55], v[84:87], v[208:211], v[52:55]
    ds_read_b64_tr_b16 v[116:117], v16 offset:28672
    ds_read_b64_tr_b16 v[118:119], v16 offset:30720
    v_mfma_f32_16x16x32_bf16 v[36:39], v[84:87], v[204:207], v[36:39]
    v_add_u32 v16, 32768, v16
    s_waitcnt lgkmcnt(8)
    s_cbranch_vccnz dm_22f2
dm_22g2:
    v_mfma_f32_16x16x32_bf16 v[24:27], v[88:91], v[212:215], v[24:27]
    ds_read_b64_tr_b16 v[56:57], v13 offset:0
    buffer_load_dwordx4 v[204:207], v128, s[8:11], s44 offen offset:1024 sc1
    v_mfma_f32_16x16x32_bf16 v[40:43], v[88:91], v[216:219], v[40:43]
    ds_read_b64_tr_b16 v[58:59], v13 offset:2048
    buffer_load_dwordx4 v[208:211], v129, s[8:11], s44 offen offset:1024 sc1
    v_mfma_f32_16x16x32_bf16 v[44:47], v[92:95], v[216:219], v[44:47]
    ds_read_b64_tr_b16 v[60:61], v14 offset:0
    s_mov_b32 s49, s44
    v_mfma_f32_16x16x32_bf16 v[28:31], v[92:95], v[212:215], v[28:31]
    ds_read_b64_tr_b16 v[62:63], v14 offset:2048
    v_mfma_f32_16x16x32_bf16 v[32:35], v[96:99], v[212:215], v[32:35]
    ds_read_b64_tr_b16 v[64:65], v15 offset:0
    v_mfma_f32_16x16x32_bf16 v[48:51], v[96:99], v[216:219], v[48:51]
    ds_read_b64_tr_b16 v[66:67], v15 offset:2048
    v_mfma_f32_16x16x32_bf16 v[52:55], v[100:103], v[216:219], v[52:55]
    ds_read_b64_tr_b16 v[68:69], v16 offset:0
    v_mfma_f32_16x16x32_bf16 v[36:39], v[100:103], v[212:215], v[36:39]
    ds_read_b64_tr_b16 v[70:71], v16 offset:2048
    s_waitcnt lgkmcnt(8)
    v_mfma_f32_16x16x32_bf16 v[24:27], v[104:107], v[220:223], v[24:27]
    ds_read_b64_tr_b16 v[72:73], v13 offset:4096
    buffer_load_dwordx4 v[212:215], v128, s[8:11], s44 offen offset:2048 sc1
    v_mfma_f32_16x16x32_bf16 v[40:43], v[104:107], v[224:227], v[40:43]
    ds_read_b64_tr_b16 v[74:75], v13 offset:6144
    buffer_load_dwordx4 v[216:219], v129, s[8:11], s44 offen offset:2048 sc1
    v_mfma_f32_16x16x32_bf16 v[44:47], v[108:111], v[224:227], v[44:47]
    ds_read_b64_tr_b16 v[76:77], v14 offset:4096
    s_waitcnt vmcnt(10)
    v_mfma_f32_16x16x32_bf16 v[28:31], v[108:111], v[220:223], v[28:31]
    ds_read_b64_tr_b16 v[78:79], v14 offset:6144
    v_or3_b32 v17, v164, v168, v172
    v_mfma_f32_16x16x32_bf16 v[32:35], v[112:115], v[220:223], v[32:35]
    ds_read_b64_tr_b16 v[80:81], v15 offset:4096
    v_bitop3_b32 v17, v17, v176, 1 bitop3:0xa8
    v_mfma_f32_16x16x32_bf16 v[48:51], v[112:115], v[224:227], v[48:51]
    ds_read_b64_tr_b16 v[82:83], v15 offset:6144
    v_cmp_ne_u32 vcc, 0, v17
    v_mfma_f32_16x16x32_bf16 v[52:55], v[116:119], v[224:227], v[52:55]
    ds_read_b64_tr_b16 v[84:85], v16 offset:4096
    ds_read_b64_tr_b16 v[86:87], v16 offset:6144
    s_cmp_lt_u32 s43, 3
    v_mfma_f32_16x16x32_bf16 v[36:39], v[116:119], v[220:223], v[36:39]
    s_waitcnt lgkmcnt(8)
    s_cbranch_vccnz dm_22f3
dm_22g3:
    s_cbranch_scc1 dm_22
    v_mfma_f32_16x16x32_bf16 v[24:27], v[56:59], v[164:167], v[24:27]
    ds_read_b64_tr_b16 v[88:89], v13 offset:8192
    buffer_load_dwordx4 v[220:223], v128, s[8:11], s44 offen offset:3072 sc1
    v_mfma_f32_16x16x32_bf16 v[40:43], v[56:59], v[168:171], v[40:43]
    ds_read_b64_tr_b16 v[90:91], v13 offset:10240
    buffer_load_dwordx4 v[224:227], v129, s[8:11], s44 offen offset:3072 sc1
    v_mfma_f32_16x16x32_bf16 v[44:47], v[60:63], v[168:171], v[44:47]
    ds_read_b64_tr_b16 v[92:93], v14 offset:8192
    v_mfma_f32_16x16x32_bf16 v[28:31], v[60:63], v[164:167], v[28:31]
    ds_read_b64_tr_b16 v[94:95], v14 offset:10240
    ds_add_u32 v18, v19
    v_mfma_f32_16x16x32_bf16 v[32:35], v[64:67], v[164:167], v[32:35]
    ds_read_b64_tr_b16 v[96:97], v15 offset:8192
    v_mfma_f32_16x16x32_bf16 v[48:51], v[64:67], v[168:171], v[48:51]
    ds_read_b64_tr_b16 v[98:99], v15 offset:10240
    v_mfma_f32_16x16x32_bf16 v[52:55], v[68:71], v[168:171], v[52:55]
    ds_read_b64_tr_b16 v[100:101], v16 offset:8192
    v_mfma_f32_16x16x32_bf16 v[36:39], v[68:71], v[164:167], v[36:39]
    ds_read_b64_tr_b16 v[102:103], v16 offset:10240
    s_waitcnt lgkmcnt(9)
    v_mfma_f32_16x16x32_bf16 v[24:27], v[72:75], v[172:175], v[24:27]
    ds_read_b64_tr_b16 v[104:105], v13 offset:12288
    v_mfma_f32_16x16x32_bf16 v[40:43], v[72:75], v[176:179], v[40:43]
    ds_read_b64_tr_b16 v[106:107], v13 offset:14336
    v_mfma_f32_16x16x32_bf16 v[44:47], v[76:79], v[176:179], v[44:47]
    ds_read_b64_tr_b16 v[108:109], v14 offset:12288
    s_waitcnt vmcnt(8)
    v_mfma_f32_16x16x32_bf16 v[28:31], v[76:79], v[172:175], v[28:31]
    ds_read_b64_tr_b16 v[110:111], v14 offset:14336
    v_or3_b32 v17, v180, v184, v188
    v_mfma_f32_16x16x32_bf16 v[32:35], v[80:83], v[172:175], v[32:35]
    ds_read_b64_tr_b16 v[112:113], v15 offset:12288
    v_bitop3_b32 v17, v17, v192, 1 bitop3:0xa8
    v_mfma_f32_16x16x32_bf16 v[48:51], v[80:83], v[176:179], v[48:51]
    ds_read_b64_tr_b16 v[114:115], v15 offset:14336
    v_cmp_ne_u32 vcc, 0, v17
    v_mfma_f32_16x16x32_bf16 v[52:55], v[84:87], v[176:179], v[52:55]
    ds_read_b64_tr_b16 v[116:117], v16 offset:12288
    ds_read_b64_tr_b16 v[118:119], v16 offset:14336
    v_mfma_f32_16x16x32_bf16 v[36:39], v[84:87], v[172:175], v[36:39]
    s_waitcnt lgkmcnt(8)
    s_cbranch_vccnz dm_22m0
dm_22n0:
    v_mfma_f32_16x16x32_bf16 v[24:27], v[88:91], v[180:183], v[24:27]
    ds_read_b64_tr_b16 v[56:57], v13 offset:16384
    v_mfma_f32_16x16x32_bf16 v[40:43], v[88:91], v[184:187], v[40:43]
    ds_read_b64_tr_b16 v[58:59], v13 offset:18432
    v_mfma_f32_16x16x32_bf16 v[44:47], v[92:95], v[184:187], v[44:47]
    ds_read_b64_tr_b16 v[60:61], v14 offset:16384
    v_mfma_f32_16x16x32_bf16 v[28:31], v[92:95], v[180:183], v[28:31]
    ds_read_b64_tr_b16 v[62:63], v14 offset:18432
    v_mfma_f32_16x16x32_bf16 v[32:35], v[96:99], v[180:183], v[32:35]
    ds_read_b64_tr_b16 v[64:65], v15 offset:16384
    v_mfma_f32_16x16x32_bf16 v[48:51], v[96:99], v[184:187], v[48:51]
    ds_read_b64_tr_b16 v[66:67], v15 offset:18432
    v_mfma_f32_16x16x32_bf16 v[52:55], v[100:103], v[184:187], v[52:55]
    ds_read_b64_tr_b16 v[68:69], v16 offset:16384
    v_mfma_f32_16x16x32_bf16 v[36:39], v[100:103], v[180:183], v[36:39]
    ds_read_b64_tr_b16 v[70:71], v16 offset:18432
    s_waitcnt lgkmcnt(8)
    v_mfma_f32_16x16x32_bf16 v[24:27], v[104:107], v[188:191], v[24:27]
    ds_read_b64_tr_b16 v[72:73], v13 offset:20480
    v_mfma_f32_16x16x32_bf16 v[40:43], v[104:107], v[192:195], v[40:43]
    ds_read_b64_tr_b16 v[74:75], v13 offset:22528
    v_mfma_f32_16x16x32_bf16 v[44:47], v[108:111], v[192:195], v[44:47]
    ds_read_b64_tr_b16 v[76:77], v14 offset:20480
    s_waitcnt vmcnt(4)
    v_mfma_f32_16x16x32_bf16 v[28:31], v[108:111], v[188:191], v[28:31]
    ds_read_b64_tr_b16 v[78:79], v14 offset:22528
    v_or3_b32 v17, v196, v200, v204
    v_mfma_f32_16x16x32_bf16 v[32:35], v[112:115], v[188:191], v[32:35]
    ds_read_b64_tr_b16 v[80:81], v15 offset:20480
    v_bitop3_b32 v17, v17, v208, 1 bitop3:0xa8
    v_mfma_f32_16x16x32_bf16 v[48:51], v[112:115], v[192:195], v[48:51]
    ds_read_b64_tr_b16 v[82:83], v15 offset:22528
    v_cmp_ne_u32 vcc, 0, v17
    v_mfma_f32_16x16x32_bf16 v[52:55], v[116:119], v[192:195], v[52:55]
    ds_read_b64_tr_b16 v[84:85], v16 offset:20480
    ds_read_b64_tr_b16 v[86:87], v16 offset:22528
    v_mfma_f32_16x16x32_bf16 v[36:39], v[116:119], v[188:191], v[36:39]
    s_waitcnt lgkmcnt(8)
    s_cbranch_vccnz dm_22m1
dm_22n1:
    v_mfma_f32_16x16x32_bf16 v[24:27], v[56:59], v[196:199], v[24:27]
    ds_read_b64_tr_b16 v[88:89], v13 offset:24576
    v_mfma_f32_16x16x32_bf16 v[40:43], v[56:59], v[200:203], v[40:43]
    ds_read_b64_tr_b16 v[90:91], v13 offset:26624
    v_mfma_f32_16x16x32_bf16 v[44:47], v[60:63], v[200:203], v[44:47]
    ds_read_b64_tr_b16 v[92:93], v14 offset:24576
    v_mfma_f32_16x16x32_bf16 v[28:31], v[60:63], v[196:199], v[28:31]
    ds_read_b64_tr_b16 v[94:95], v14 offset:26624
    v_mfma_f32_16x16x32_bf16 v[32:35], v[64:67], v[196:199], v[32:35]
    ds_read_b64_tr_b16 v[96:97], v15 offset:24576
    v_mfma_f32_16x16x32_bf16 v[48:51], v[64:67], v[200:203], v[48:51]
    ds_read_b64_tr_b16 v[98:99], v15 offset:26624
    v_mfma_f32_16x16x32_bf16 v[52:55], v[68:71], v[200:203], v[52:55]
    ds_read_b64_tr_b16 v[100:101], v16 offset:24576
    v_mfma_f32_16x16x32_bf16 v[36:39], v[68:71], v[196:199], v[36:39]
    ds_read_b64_tr_b16 v[102:103], v16 offset:26624
    s_waitcnt lgkmcnt(8)
    v_mfma_f32_16x16x32_bf16 v[24:27], v[72:75], v[204:207], v[24:27]
    ds_read_b64_tr_b16 v[104:105], v13 offset:28672
    v_mfma_f32_16x16x32_bf16 v[40:43], v[72:75], v[208:211], v[40:43]
    ds_read_b64_tr_b16 v[106:107], v13 offset:30720
    v_mfma_f32_16x16x32_bf16 v[44:47], v[76:79], v[208:211], v[44:47]
    ds_read_b64_tr_b16 v[108:109], v14 offset:28672
    s_waitcnt vmcnt(0)
    v_mfma_f32_16x16x32_bf16 v[28:31], v[76:79], v[204:207], v[28:31]
    ds_read_b64_tr_b16 v[110:111], v14 offset:30720
    v_or3_b32 v17, v212, v216, v220
    v_mfma_f32_16x16x32_bf16 v[32:35], v[80:83], v[204:207], v[32:35]
    ds_read_b64_tr_b16 v[112:113], v15 offset:28672
    v_bitop3_b32 v17, v17, v224, 1 bitop3:0xa8
    v_mfma_f32_16x16x32_bf16 v[48:51], v[80:83], v[208:211], v[48:51]
    ds_read_b64_tr_b16 v[114:115], v15 offset:30720
    v_cmp_ne_u32 vcc, 0, v17
    v_mfma_f32_16x16x32_bf16 v[52:55], v[84:87], v[208:211], v[52:55]
    ds_read_b64_tr_b16 v[116:117], v16 offset:28672
    ds_read_b64_tr_b16 v[118:119], v16 offset:30720
    v_mfma_f32_16x16x32_bf16 v[36:39], v[84:87], v[204:207], v[36:39]
    s_waitcnt lgkmcnt(8)
    s_cbranch_vccnz dm_22m2
dm_22n2:
dm_22x:
    v_mfma_f32_16x16x32_bf16 v[24:27], v[88:91], v[212:215], v[24:27]
    v_mfma_f32_16x16x32_bf16 v[40:43], v[88:91], v[216:219], v[40:43]
    v_mfma_f32_16x16x32_bf16 v[44:47], v[92:95], v[216:219], v[44:47]
    v_mfma_f32_16x16x32_bf16 v[28:31], v[92:95], v[212:215], v[28:31]
    v_mfma_f32_16x16x32_bf16 v[32:35], v[96:99], v[212:215], v[32:35]
    v_mfma_f32_16x16x32_bf16 v[48:51], v[96:99], v[216:219], v[48:51]
    v_mfma_f32_16x16x32_bf16 v[52:55], v[100:103], v[216:219], v[52:55]
    v_mfma_f32_16x16x32_bf16 v[36:39], v[100:103], v[212:215], v[36:39]
    s_waitcnt lgkmcnt(0)
    s_barrier
    v_mfma_f32_16x16x32_bf16 v[24:27], v[104:107], v[220:223], v[24:27]
    ds_read_b128 v[56:59], v6 offset:0
    v_mfma_f32_16x16x32_bf16 v[40:43], v[104:107], v[224:227], v[40:43]
    ds_read_b128 v[60:63], v6 offset:64
    v_mfma_f32_16x16x32_bf16 v[44:47], v[108:111], v[224:227], v[44:47]
    ds_read_b128 v[64:67], v6 offset:128
    v_mfma_f32_16x16x32_bf16 v[28:31], v[108:111], v[220:223], v[28:31]
    ds_read_b128 v[68:71], v6 offset:192
    v_mfma_f32_16x16x32_bf16 v[32:35], v[112:115], v[220:223], v[32:35]
    ds_read_b64 v[72:73], v7 offset:0
    v_mfma_f32_16x16x32_bf16 v[48:51], v[112:115], v[224:227], v[48:51]
    ds_read_b64 v[74:75], v7 offset:256
    v_mfma_f32_16x16x32_bf16 v[52:55], v[116:119], v[224:227], v[52:55]
    v_mfma_f32_16x16x32_bf16 v[36:39], v[116:119], v[220:223], v[36:39]
    s_waitcnt lgkmcnt(0)
    v_mul_f32 v134, 0xc0135761, v73
    v_mul_f32 v135, v73, v73
    v_mul_f32 v135, v135, v134
    v_mul_f32 v135, 0x3d372713, v135
    v_rcp_f32 v73, v73
    v_mul_f32 v136, 0xc0135761, v75
    v_mul_f32 v137, v75, v75
    v_mul_f32 v137, v137, v136
    v_mul_f32 v137, 0x3d372713, v137
    v_rcp_f32 v75, v75
    v_pk_fma_f32 v[24:25], v[72:73], v[56:57], v[24:25] op_sel_hi:[0,1,1] neg_lo:[1,0,0] neg_hi:[1,0,0]
    v_pk_fma_f32 v[26:27], v[72:73], v[58:59], v[26:27] op_sel_hi:[0,1,1] neg_lo:[1,0,0] neg_hi:[1,0,0]
    v_pk_mul_f32 v[122:123], v[24:25], v[24:25]
    v_pk_mul_f32 v[124:125], v[26:27], v[26:27]
    v_pk_fma_f32 v[122:123], v[122:123], v[134:135], v[134:135] op_sel:[0,1,0] op_sel_hi:[1,1,0]
    v_pk_fma_f32 v[124:125], v[124:125], v[134:135], v[134:135] op_sel:[0,1,0] op_sel_hi:[1,1,0]
    v_pk_mul_f32 v[122:123], v[122:123], v[24:25]
    v_pk_mul_f32 v[124:125], v[124:125], v[26:27]
    v_exp_f32 v122, v122
    v_exp_f32 v123, v123
    v_exp_f32 v124, v124
    v_exp_f32 v125, v125
    v_pk_fma_f32 v[122:123], v[122:123], v[72:73], v[72:73] op_sel:[0,1,1] op_sel_hi:[1,1,1]
    v_pk_fma_f32 v[124:125], v[124:125], v[72:73], v[72:73] op_sel:[0,1,1] op_sel_hi:[1,1,1]
    v_rcp_f32 v122, v122
    v_rcp_f32 v123, v123
    v_rcp_f32 v124, v124
    v_rcp_f32 v125, v125
    v_pk_mul_f32 v[24:25], v[24:25], v[122:123]
    v_pk_mul_f32 v[26:27], v[26:27], v[124:125]
    v_pk_fma_f32 v[28:29], v[72:73], v[60:61], v[28:29] op_sel_hi:[0,1,1] neg_lo:[1,0,0] neg_hi:[1,0,0]
    v_pk_fma_f32 v[30:31], v[72:73], v[62:63], v[30:31] op_sel_hi:[0,1,1] neg_lo:[1,0,0] neg_hi:[1,0,0]
    v_pk_mul_f32 v[122:123], v[28:29], v[28:29]
    v_pk_mul_f32 v[124:125], v[30:31], v[30:31]
    v_pk_fma_f32 v[122:123], v[122:123], v[134:135], v[134:135] op_sel:[0,1,0] op_sel_hi:[1,1,0]
    v_pk_fma_f32 v[124:125], v[124:125], v[134:135], v[134:135] op_sel:[0,1,0] op_sel_hi:[1,1,0]
    v_pk_mul_f32 v[122:123], v[122:123], v[28:29]
    v_pk_mul_f32 v[124:125], v[124:125], v[30:31]
    v_exp_f32 v122, v122
    v_exp_f32 v123, v123
    v_exp_f32 v124, v124
    v_exp_f32 v125, v125
    v_pk_fma_f32 v[122:123], v[122:123], v[72:73], v[72:73] op_sel:[0,1,1] op_sel_hi:[1,1,1]
    v_pk_fma_f32 v[124:125], v[124:125], v[72:73], v[72:73] op_sel:[0,1,1] op_sel_hi:[1,1,1]
    v_rcp_f32 v122, v122
    v_rcp_f32 v123, v123
    v_rcp_f32 v124, v124
    v_rcp_f32 v125, v125
    v_pk_mul_f32 v[28:29], v[28:29], v[122:123]
    v_pk_mul_f32 v[30:31], v[30:31], v[124:125]
    v_cvt_pk_bf16_f32 v24, v24, v25
    v_cvt_pk_bf16_f32 v25, v26, v27
    v_cvt_pk_bf16_f32 v26, v28, v29
    v_cvt_pk_bf16_f32 v27, v30, v31
    v_and_b32 v24, -2, v24
    buffer_store_dwordx4 v[24:27], v12, s[16:19], s39 offen offset:0 sc1
    v_pk_fma_f32 v[40:41], v[74:75], v[56:57], v[40:41] op_sel_hi:[0,1,1] neg_lo:[1,0,0] neg_hi:[1,0,0]
    v_pk_fma_f32 v[42:43], v[74:75], v[58:59], v[42:43] op_sel_hi:[0,1,1] neg_lo:[1,0,0] neg_hi:[1,0,0]
    v_pk_mul_f32 v[122:123], v[40:41], v[40:41]
    v_pk_mul_f32 v[124:125], v[42:43], v[42:43]
    v_pk_fma_f32 v[122:123], v[122:123], v[136:137], v[136:137] op_sel:[0,1,0] op_sel_hi:[1,1,0]
    v_pk_fma_f32 v[124:125], v[124:125], v[136:137], v[136:137] op_sel:[0,1,0] op_sel_hi:[1,1,0]
    v_pk_mul_f32 v[122:123], v[122:123], v[40:41]
    v_pk_mul_f32 v[124:125], v[124:125], v[42:43]
    v_exp_f32 v122, v122
    v_exp_f32 v123, v123
    v_exp_f32 v124, v124
    v_exp_f32 v125, v125
    v_pk_fma_f32 v[122:123], v[122:123], v[74:75], v[74:75] op_sel:[0,1,1] op_sel_hi:[1,1,1]
    v_pk_fma_f32 v[124:125], v[124:125], v[74:75], v[74:75] op_sel:[0,1,1] op_sel_hi:[1,1,1]
    v_rcp_f32 v122, v122
    v_rcp_f32 v123, v123
    v_rcp_f32 v124, v124
    v_rcp_f32 v125, v125
    v_pk_mul_f32 v[40:41], v[40:41], v[122:123]
    v_pk_mul_f32 v[42:43], v[42:43], v[124:125]
    v_pk_fma_f32 v[44:45], v[74:75], v[60:61], v[44:45] op_sel_hi:[0,1,1] neg_lo:[1,0,0] neg_hi:[1,0,0]
    v_pk_fma_f32 v[46:47], v[74:75], v[62:63], v[46:47] op_sel_hi:[0,1,1] neg_lo:[1,0,0] neg_hi:[1,0,0]
    v_pk_mul_f32 v[122:123], v[44:45], v[44:45]
    v_pk_mul_f32 v[124:125], v[46:47], v[46:47]
    v_pk_fma_f32 v[122:123], v[122:123], v[136:137], v[136:137] op_sel:[0,1,0] op_sel_hi:[1,1,0]
    v_pk_fma_f32 v[124:125], v[124:125], v[136:137], v[136:137] op_sel:[0,1,0] op_sel_hi:[1,1,0]
    v_pk_mul_f32 v[122:123], v[122:123], v[44:45]
    v_pk_mul_f32 v[124:125], v[124:125], v[46:47]
    v_exp_f32 v122, v122
    v_exp_f32 v123, v123
    v_exp_f32 v124, v124
    v_exp_f32 v125, v125
    v_pk_fma_f32 v[122:123], v[122:123], v[74:75], v[74:75] op_sel:[0,1,1] op_sel_hi:[1,1,1]
    v_pk_fma_f32 v[124:125], v[124:125], v[74:75], v[74:75] op_sel:[0,1,1] op_sel_hi:[1,1,1]
    v_rcp_f32 v122, v122
    v_rcp_f32 v123, v123
    v_rcp_f32 v124, v124
    v_rcp_f32 v125, v125
    v_pk_mul_f32 v[44:45], v[44:45], v[122:123]
    v_pk_mul_f32 v[46:47], v[46:47], v[124:125]
    v_cvt_pk_bf16_f32 v40, v40, v41
    v_cvt_pk_bf16_f32 v41, v42, v43
    v_cvt_pk_bf16_f32 v42, v44, v45
    v_cvt_pk_bf16_f32 v43, v46, v47
    v_and_b32 v40, -2, v40
    buffer_store_dwordx4 v[40:43], v12, s[16:19], s39 offen offset:256 sc1
    v_pk_fma_f32 v[32:33], v[72:73], v[64:65], v[32:33] op_sel_hi:[0,1,1] neg_lo:[1,0,0] neg_hi:[1,0,0]
    v_pk_fma_f32 v[34:35], v[72:73], v[66:67], v[34:35] op_sel_hi:[0,1,1] neg_lo:[1,0,0] neg_hi:[1,0,0]
    v_pk_mul_f32 v[122:123], v[32:33], v[32:33]
    v_pk_mul_f32 v[124:125], v[34:35], v[34:35]
    v_pk_fma_f32 v[122:123], v[122:123], v[134:135], v[134:135] op_sel:[0,1,0] op_sel_hi:[1,1,0]
    v_pk_fma_f32 v[124:125], v[124:125], v[134:135], v[134:135] op_sel:[0,1,0] op_sel_hi:[1,1,0]
    v_pk_mul_f32 v[122:123], v[122:123], v[32:33]
    v_pk_mul_f32 v[124:125], v[124:125], v[34:35]
    v_exp_f32 v122, v122
    v_exp_f32 v123, v123
    v_exp_f32 v124, v124
    v_exp_f32 v125, v125
    v_pk_fma_f32 v[122:123], v[122:123], v[72:73], v[72:73] op_sel:[0,1,1] op_sel_hi:[1,1,1]
    v_pk_fma_f32 v[124:125], v[124:125], v[72:73], v[72:73] op_sel:[0,1,1] op_sel_hi:[1,1,1]
    v_rcp_f32 v122, v122
    v_rcp_f32 v123, v123
    v_rcp_f32 v124, v124
    v_rcp_f32 v125, v125
    v_pk_mul_f32 v[32:33], v[32:33], v[122:123]
    v_pk_mul_f32 v[34:35], v[34:35], v[124:125]
    v_pk_fma_f32 v[36:37], v[72:73], v[68:69], v[36:37] op_sel_hi:[0,1,1] neg_lo:[1,0,0] neg_hi:[1,0,0]
    v_pk_fma_f32 v[38:39], v[72:73], v[70:71], v[38:39] op_sel_hi:[0,1,1] neg_lo:[1,0,0] neg_hi:[1,0,0]
    v_pk_mul_f32 v[122:123], v[36:37], v[36:37]
    v_pk_mul_f32 v[124:125], v[38:39], v[38:39]
    v_pk_fma_f32 v[122:123], v[122:123], v[134:135], v[134:135] op_sel:[0,1,0] op_sel_hi:[1,1,0]
    v_pk_fma_f32 v[124:125], v[124:125], v[134:135], v[134:135] op_sel:[0,1,0] op_sel_hi:[1,1,0]
    v_pk_mul_f32 v[122:123], v[122:123], v[36:37]
    v_pk_mul_f32 v[124:125], v[124:125], v[38:39]
    v_exp_f32 v122, v122
    v_exp_f32 v123, v123
    v_exp_f32 v124, v124
    v_exp_f32 v125, v125
    v_pk_fma_f32 v[122:123], v[122:123], v[72:73], v[72:73] op_sel:[0,1,1] op_sel_hi:[1,1,1]
    v_pk_fma_f32 v[124:125], v[124:125], v[72:73], v[72:73] op_sel:[0,1,1] op_sel_hi:[1,1,1]
    v_rcp_f32 v122, v122
    v_rcp_f32 v123, v123
    v_rcp_f32 v124, v124
    v_rcp_f32 v125, v125
    v_pk_mul_f32 v[36:37], v[36:37], v[122:123]
    v_pk_mul_f32 v[38:39], v[38:39], v[124:125]
    v_cvt_pk_bf16_f32 v32, v32, v33
    v_cvt_pk_bf16_f32 v33, v34, v35
    v_cvt_pk_bf16_f32 v34, v36, v37
    v_cvt_pk_bf16_f32 v35, v38, v39
    v_and_b32 v32, -2, v32
    buffer_store_dwordx4 v[32:35], v12, s[16:19], s40 offen offset:0 sc1
    buffer_load_dwordx4 v[148:151], v126, s[8:11], s41 offen offset:0 sc1
    buffer_load_dwordx4 v[152:155], v126, s[8:11], s41 offen offset:1024 sc1
    buffer_load_dwordx4 v[156:159], v127, s[8:11], s41 offen offset:0 sc1
    buffer_load_dwordx4 v[160:163], v127, s[8:11], s41 offen offset:1024 sc1
    v_pk_fma_f32 v[48:49], v[74:75], v[64:65], v[48:49] op_sel_hi:[0,1,1] neg_lo:[1,0,0] neg_hi:[1,0,0]
    v_pk_fma_f32 v[50:51], v[74:75], v[66:67], v[50:51] op_sel_hi:[0,1,1] neg_lo:[1,0,0] neg_hi:[1,0,0]
    v_pk_mul_f32 v[122:123], v[48:49], v[48:49]
    v_pk_mul_f32 v[124:125], v[50:51], v[50:51]
    v_pk_fma_f32 v[122:123], v[122:123], v[136:137], v[136:137] op_sel:[0,1,0] op_sel_hi:[1,1,0]
    v_pk_fma_f32 v[124:125], v[124:125], v[136:137], v[136:137] op_sel:[0,1,0] op_sel_hi:[1,1,0]
    v_pk_mul_f32 v[122:123], v[122:123], v[48:49]
    v_pk_mul_f32 v[124:125], v[124:125], v[50:51]
    v_exp_f32 v122, v122
    v_exp_f32 v123, v123
    v_exp_f32 v124, v124
    v_exp_f32 v125, v125
    v_pk_fma_f32 v[122:123], v[122:123], v[74:75], v[74:75] op_sel:[0,1,1] op_sel_hi:[1,1,1]
    v_pk_fma_f32 v[124:125], v[124:125], v[74:75], v[74:75] op_sel:[0,1,1] op_sel_hi:[1,1,1]
    v_rcp_f32 v122, v122
    v_rcp_f32 v123, v123
    v_rcp_f32 v124, v124
    v_rcp_f32 v125, v125
    v_pk_mul_f32 v[48:49], v[48:49], v[122:123]
    v_pk_mul_f32 v[50:51], v[50:51], v[124:125]
    v_pk_fma_f32 v[52:53], v[74:75], v[68:69], v[52:53] op_sel_hi:[0,1,1] neg_lo:[1,0,0] neg_hi:[1,0,0]
    v_pk_fma_f32 v[54:55], v[74:75], v[70:71], v[54:55] op_sel_hi:[0,1,1] neg_lo:[1,0,0] neg_hi:[1,0,0]
    v_pk_mul_f32 v[122:123], v[52:53], v[52:53]
    v_pk_mul_f32 v[124:125], v[54:55], v[54:55]
    v_pk_fma_f32 v[122:123], v[122:123], v[136:137], v[136:137] op_sel:[0,1,0] op_sel_hi:[1,1,0]
    v_pk_fma_f32 v[124:125], v[124:125], v[136:137], v[136:137] op_sel:[0,1,0] op_sel_hi:[1,1,0]
    v_pk_mul_f32 v[122:123], v[122:123], v[52:53]
    v_pk_mul_f32 v[124:125], v[124:125], v[54:55]
    v_exp_f32 v122, v122
    v_exp_f32 v123, v123
    v_exp_f32 v124, v124
    v_exp_f32 v125, v125
    v_pk_fma_f32 v[122:123], v[122:123], v[74:75], v[74:75] op_sel:[0,1,1] op_sel_hi:[1,1,1]
    v_pk_fma_f32 v[124:125], v[124:125], v[74:75], v[74:75] op_sel:[0,1,1] op_sel_hi:[1,1,1]
    v_rcp_f32 v122, v122
    v_rcp_f32 v123, v123
    v_rcp_f32 v124, v124
    v_rcp_f32 v125, v125
    v_pk_mul_f32 v[52:53], v[52:53], v[122:123]
    v_pk_mul_f32 v[54:55], v[54:55], v[124:125]
    v_cvt_pk_bf16_f32 v48, v48, v49
    v_cvt_pk_bf16_f32 v49, v50, v51
    v_cvt_pk_bf16_f32 v50, v52, v53
    v_cvt_pk_bf16_f32 v51, v54, v55
    v_and_b32 v48, -2, v48
    buffer_store_dwordx4 v[48:51], v12, s[16:19], s40 offen offset:256 sc1
    s_add_u32 s8, s4, 0x2100000
    s_addc_u32 s9, s5, 0
    s_mov_b32 s10, 0x8400000
    s_mov_b32 s11, 0x20000
    s_sub_u32 s47, s55, 39583744
    s_lshl_b32 s46, s30, 9
    s_add_u32 s47, s47, s46
    s_add_u32 s45, s92, 2048
    s_cmp_eq_u32 s28, 0
    s_cselect_b32 s45, 1073741824, s45
    s_cmp_eq_u32 s30, 0
    s_cselect_b32 s45, s45, 0
    s_add_u32 s53, s47, 0xfffffff0
    v_add_u32 v126, s53, v12
    v_add_u32 v127, 256, v126
    v_add_u32 v134, s45, v126
    v_cmp_gt_u32 vcc, 1, v22
    s_nop 1
    v_cndmask_b32 v126, v126, v134, vcc
    s_mov_b32 s34, s30
    s_mov_b32 s35, 0
    v_and_b32 v22, 15, v1
    v_lshrrev_b32 v23, 4, v1
    s_mul_i32 s37, s34, 2
    s_mul_i32 s38, s29, 4
    s_mul_i32 s36, s35, 4
    s_add_u32 s38, s38, s36
    s_lshr_b32 s36, s38, 1
    s_lshr_b32 s53, s36, 3
    s_lshl_b32 s53, s53, 14
    s_and_b32 s39, s36, 7
    s_lshl_b32 s39, s39, 10
    s_add_u32 s39, s39, s53
    s_lshl_b32 s36, s37, 16
    s_add_u32 s39, s39, s36
    s_sub_u32 s46, s93, 2048
    s_cmp_eq_u32 s28, 15
    s_cselect_b32 s46, 1073741824, s46
    s_cmp_eq_u32 s30, 3
    s_cselect_b32 s46, s46, 0
    s_add_u32 s53, s47, 0x10
    v_add_u32 v128, s53, v12
    v_add_u32 v129, 256, v128
    v_add_u32 v134, s46, v129
    v_cmp_le_u32 vcc, 15, v22
    s_nop 1
    v_cndmask_b32 v129, v129, v134, vcc
    s_add_u32 s53, s47, 0xffffffe0
    v_add_u32 v130, s53, v12
    v_add_u32 v131, 256, v130
    v_add_u32 v134, s45, v130
    v_cmp_gt_u32 vcc, 2, v22
    s_nop 1
    v_cndmask_b32 v130, v130, v134, vcc
    s_add_u32 s53, s47, 0x20
    v_add_u32 v132, s53, v12
    v_add_u32 v133, 256, v132
    v_add_u32 v134, s46, v133
    v_cmp_le_u32 vcc, 14, v22
    s_nop 1
    v_cndmask_b32 v133, v133, v134, vcc
    v_mov_b32 v134, v126
    v_mov_b32 v135, v127
    v_lshrrev_b32 v6, 2, v1
    v_mul_u32_u24 v13, 128, v6
    v_and_b32 v7, 3, v1
    v_lshl_add_u32 v13, v7, 3, v13
    v_add_u32 v13, 0, v13
    v_bfe_u32 v6, v6, 1, 2
    s_mul_i32 s36, s35, 4
    s_add_u32 s36, s36, 3
    v_xor_b32 v7, s36, v6
    v_lshl_add_u32 v16, v7, 5, v13
    s_mul_i32 s36, s35, 4
    s_add_u32 s36, s36, 2
    v_xor_b32 v7, s36, v6
    v_lshl_add_u32 v15, v7, 5, v13
    s_mul_i32 s36, s35, 4
    s_add_u32 s36, s36, 1
    v_xor_b32 v7, s36, v6
    v_lshl_add_u32 v14, v7, 5, v13
    s_mul_i32 s36, s35, 4
    s_add_u32 s36, s36, 0
    v_xor_b32 v7, s36, v6
    v_lshl_add_u32 v13, v7, 5, v13
    s_lshl_b32 s36, s37, 8
    s_add_u32 s36, s36, 160768
    v_lshlrev_b32 v7, 4, v22
    v_add_u32 v7, s36, v7
    ds_read_b64 v[56:57], v7 offset:0
    ds_read_b64 v[58:59], v7 offset:256
    s_waitcnt vmcnt(1) lgkmcnt(0)
    s_sleep 6
    s_cmp_lg_u32 s60, 0
    s_cbranch_scc1 G2_nd
    s_sleep 2
G2_nd:
    s_mov_b32 s44, 0
    buffer_load_dwordx4 v[164:167], v126, s[8:11], s44 offen sc1
    buffer_load_dwordx4 v[168:171], v127, s[8:11], s44 offen sc1
    s_add_u32 s44, s44, 16384
    buffer_load_dwordx4 v[172:175], v126, s[8:11], s44 offen sc1
    buffer_load_dwordx4 v[176:179], v127, s[8:11], s44 offen sc1
    s_add_u32 s44, s44, 16384
    buffer_load_dwordx4 v[180:183], v126, s[8:11], s44 offen
    buffer_load_dwordx4 v[184:187], v127, s[8:11], s44 offen
    s_add_u32 s44, s44, 16384
    buffer_load_dwordx4 v[188:191], v126, s[8:11], s44 offen
    buffer_load_dwordx4 v[192:195], v127, s[8:11], s44 offen
    s_add_u32 s44, s44, 16384
    v_lshlrev_b32 v24, 16, v148
    v_and_b32 v25, 0xffff0000, v148
    v_pk_add_f32 v[24:25], v[24:25], v[56:57] op_sel_hi:[1,0] neg_lo:[0,1] neg_hi:[0,1]
    v_pk_mul_f32 v[24:25], v[24:25], v[56:57] op_sel:[0,1] op_sel_hi:[1,1]
    v_lshlrev_b32 v26, 16, v149
    v_and_b32 v27, 0xffff0000, v149
    v_pk_add_f32 v[26:27], v[26:27], v[56:57] op_sel_hi:[1,0] neg_lo:[0,1] neg_hi:[0,1]
    v_pk_mul_f32 v[26:27], v[26:27], v[56:57] op_sel:[0,1] op_sel_hi:[1,1]
    v_lshlrev_b32 v28, 16, v150
    v_and_b32 v29, 0xffff0000, v150
    v_pk_add_f32 v[28:29], v[28:29], v[56:57] op_sel_hi:[1,0] neg_lo:[0,1] neg_hi:[0,1]
    v_pk_mul_f32 v[28:29], v[28:29], v[56:57] op_sel:[0,1] op_sel_hi:[1,1]
    v_lshlrev_b32 v30, 16, v151
    v_and_b32 v31, 0xffff0000, v151
    v_pk_add_f32 v[30:31], v[30:31], v[56:57] op_sel_hi:[1,0] neg_lo:[0,1] neg_hi:[0,1]
    v_pk_mul_f32 v[30:31], v[30:31], v[56:57] op_sel:[0,1] op_sel_hi:[1,1]
    v_lshlrev_b32 v32, 16, v152
    v_and_b32 v33, 0xffff0000, v152
    v_pk_add_f32 v[32:33], v[32:33], v[56:57] op_sel_hi:[1,0] neg_lo:[0,1] neg_hi:[0,1]
    v_pk_mul_f32 v[32:33], v[32:33], v[56:57] op_sel:[0,1] op_sel_hi:[1,1]
    v_lshlrev_b32 v34, 16, v153
    v_and_b32 v35, 0xffff0000, v153
    v_pk_add_f32 v[34:35], v[34:35], v[56:57] op_sel_hi:[1,0] neg_lo:[0,1] neg_hi:[0,1]
    v_pk_mul_f32 v[34:35], v[34:35], v[56:57] op_sel:[0,1] op_sel_hi:[1,1]
    v_lshlrev_b32 v36, 16, v154
    v_and_b32 v37, 0xffff0000, v154
    v_pk_add_f32 v[36:37], v[36:37], v[56:57] op_sel_hi:[1,0] neg_lo:[0,1] neg_hi:[0,1]
    v_pk_mul_f32 v[36:37], v[36:37], v[56:57] op_sel:[0,1] op_sel_hi:[1,1]
    v_lshlrev_b32 v38, 16, v155
    v_and_b32 v39, 0xffff0000, v155
    v_pk_add_f32 v[38:39], v[38:39], v[56:57] op_sel_hi:[1,0] neg_lo:[0,1] neg_hi:[0,1]
    v_pk_mul_f32 v[38:39], v[38:39], v[56:57] op_sel:[0,1] op_sel_hi:[1,1]
    v_lshlrev_b32 v40, 16, v156
    v_and_b32 v41, 0xffff0000, v156
    v_pk_add_f32 v[40:41], v[40:41], v[58:59] op_sel_hi:[1,0] neg_lo:[0,1] neg_hi:[0,1]
    v_pk_mul_f32 v[40:41], v[40:41], v[58:59] op_sel:[0,1] op_sel_hi:[1,1]
    v_lshlrev_b32 v42, 16, v157
    v_and_b32 v43, 0xffff0000, v157
    v_pk_add_f32 v[42:43], v[42:43], v[58:59] op_sel_hi:[1,0] neg_lo:[0,1] neg_hi:[0,1]
    v_pk_mul_f32 v[42:43], v[42:43], v[58:59] op_sel:[0,1] op_sel_hi:[1,1]
    v_lshlrev_b32 v44, 16, v158
    v_and_b32 v45, 0xffff0000, v158
    v_pk_add_f32 v[44:45], v[44:45], v[58:59] op_sel_hi:[1,0] neg_lo:[0,1] neg_hi:[0,1]
    v_pk_mul_f32 v[44:45], v[44:45], v[58:59] op_sel:[0,1] op_sel_hi:[1,1]
    v_lshlrev_b32 v46, 16, v159
    v_and_b32 v47, 0xffff0000, v159
    v_pk_add_f32 v[46:47], v[46:47], v[58:59] op_sel_hi:[1,0] neg_lo:[0,1] neg_hi:[0,1]
    v_pk_mul_f32 v[46:47], v[46:47], v[58:59] op_sel:[0,1] op_sel_hi:[1,1]
    v_lshlrev_b32 v48, 16, v160
    v_and_b32 v49, 0xffff0000, v160
    v_pk_add_f32 v[48:49], v[48:49], v[58:59] op_sel_hi:[1,0] neg_lo:[0,1] neg_hi:[0,1]
    v_pk_mul_f32 v[48:49], v[48:49], v[58:59] op_sel:[0,1] op_sel_hi:[1,1]
    v_lshlrev_b32 v50, 16, v161
    v_and_b32 v51, 0xffff0000, v161
    v_pk_add_f32 v[50:51], v[50:51], v[58:59] op_sel_hi:[1,0] neg_lo:[0,1] neg_hi:[0,1]
    v_pk_mul_f32 v[50:51], v[50:51], v[58:59] op_sel:[0,1] op_sel_hi:[1,1]
    v_lshlrev_b32 v52, 16, v162
    v_and_b32 v53, 0xffff0000, v162
    v_pk_add_f32 v[52:53], v[52:53], v[58:59] op_sel_hi:[1,0] neg_lo:[0,1] neg_hi:[0,1]
    v_pk_mul_f32 v[52:53], v[52:53], v[58:59] op_sel:[0,1] op_sel_hi:[1,1]
    v_lshlrev_b32 v54, 16, v163
    v_and_b32 v55, 0xffff0000, v163
    v_pk_add_f32 v[54:55], v[54:55], v[58:59] op_sel_hi:[1,0] neg_lo:[0,1] neg_hi:[0,1]
    v_pk_mul_f32 v[54:55], v[54:55], v[58:59] op_sel:[0,1] op_sel_hi:[1,1]
    s_mov_b32 s43, 0
    s_add_u32 s16, s62, 0x80000
    s_addc_u32 s17, s63, 0
    s_mov_b32 s18, 0x7e000
    s_mov_b32 s19, 0x20000
    s_mov_b32 s53, 0
    s_mov_b32 s49, s44
    s_barrier
    ds_read_b64_tr_b16 v[56:57], v13 offset:0
    ds_read_b64_tr_b16 v[58:59], v13 offset:2048
    ds_read_b64_tr_b16 v[60:61], v14 offset:0
    ds_read_b64_tr_b16 v[62:63], v14 offset:2048
    ds_read_b64_tr_b16 v[64:65], v15 offset:0
    ds_read_b64_tr_b16 v[66:67], v15 offset:2048
    ds_read_b64_tr_b16 v[68:69], v16 offset:0
    ds_read_b64_tr_b16 v[70:71], v16 offset:2048
    ds_read_b64_tr_b16 v[72:73], v13 offset:4096
    ds_read_b64_tr_b16 v[74:75], v13 offset:6144
    ds_read_b64_tr_b16 v[76:77], v14 offset:4096
    ds_read_b64_tr_b16 v[78:79], v14 offset:6144
    ds_read_b64_tr_b16 v[80:81], v15 offset:4096
    ds_read_b64_tr_b16 v[82:83], v15 offset:6144
    ds_read_b64_tr_b16 v[84:85], v16 offset:4096
    ds_read_b64_tr_b16 v[86:87], v16 offset:6144
    s_branch dm_23w
dm_23p:
    s_mov_b32 s44, 0
    buffer_load_dwordx4 v[164:167], v126, s[8:11], s44 offen sc1
    buffer_load_dwordx4 v[168:171], v127, s[8:11], s44 offen sc1
    s_add_u32 s44, s44, 16384
    buffer_load_dwordx4 v[172:175], v126, s[8:11], s44 offen sc1
    buffer_load_dwordx4 v[176:179], v127, s[8:11], s44 offen sc1
    s_add_u32 s44, s44, 16384
    buffer_load_dwordx4 v[180:183], v126, s[8:11], s44 offen
    buffer_load_dwordx4 v[184:187], v127, s[8:11], s44 offen
    s_add_u32 s44, s44, 16384
    buffer_load_dwordx4 v[188:191], v126, s[8:11], s44 offen
    buffer_load_dwordx4 v[192:195], v127, s[8:11], s44 offen
    s_add_u32 s44, s44, 16384
dm_23w:
    s_waitcnt vmcnt(4)
    v_or3_b32 v17, v164, v168, v172
    v_bitop3_b32 v17, v17, v176, 1 bitop3:0xa8
    v_cmp_ne_u32 vcc, 0, v17
    s_cbranch_vccz dm_23q
dm_23r:
    s_sleep 2
    s_mov_b32 s44, 0
    buffer_load_dwordx4 v[164:167], v126, s[8:11], s44 offen sc1
    buffer_load_dwordx4 v[168:171], v127, s[8:11], s44 offen sc1
    s_add_u32 s44, s44, 16384
    buffer_load_dwordx4 v[172:175], v126, s[8:11], s44 offen sc1
    buffer_load_dwordx4 v[176:179], v127, s[8:11], s44 offen sc1
    s_add_u32 s44, s44, 16384
    buffer_load_dwordx4 v[180:183], v126, s[8:11], s44 offen sc1
    buffer_load_dwordx4 v[184:187], v127, s[8:11], s44 offen sc1
    s_add_u32 s44, s44, 16384
    buffer_load_dwordx4 v[188:191], v126, s[8:11], s44 offen sc1
    buffer_load_dwordx4 v[192:195], v127, s[8:11], s44 offen sc1
    s_add_u32 s44, s44, 16384
    s_waitcnt vmcnt(4)
    v_or3_b32 v17, v164, v168, v172
    v_bitop3_b32 v17, v17, v176, 1 bitop3:0xa8
    v_cmp_ne_u32 vcc, 0, v17
    s_cbranch_vccz dm_23t
    s_add_u32 s53, s53, 1
    s_cmp_lt_u32 s53, s61
    s_cbranch_scc1 dm_23r
    s_mov_b32 s61, 0
    s_branch dm_23t
dm_23q:
dm_23t:
    buffer_load_dwordx4 v[196:199], v126, s[8:11], s44 offen
    buffer_load_dwordx4 v[200:203], v127, s[8:11], s44 offen
    s_add_u32 s44, s44, 16384
    buffer_load_dwordx4 v[204:207], v126, s[8:11], s44 offen
    buffer_load_dwordx4 v[208:211], v127, s[8:11], s44 offen
    s_add_u32 s44, s44, 16384
    buffer_load_dwordx4 v[212:215], v126, s[8:11], s44 offen
    buffer_load_dwordx4 v[216:219], v127, s[8:11], s44 offen
    s_add_u32 s44, s44, 16384
    s_waitcnt lgkmcnt(0)
dm_23:
    v_mfma_f32_16x16x32_bf16 v[24:27], v[56:59], v[164:167], v[24:27]
    ds_read_b64_tr_b16 v[88:89], v13 offset:8192
    buffer_load_dwordx4 v[220:223], v126, s[8:11], s44 offen
    v_mfma_f32_16x16x32_bf16 v[40:43], v[56:59], v[168:171], v[40:43]
    ds_read_b64_tr_b16 v[90:91], v13 offset:10240
    buffer_load_dwordx4 v[224:227], v127, s[8:11], s44 offen
    v_mfma_f32_16x16x32_bf16 v[44:47], v[60:63], v[168:171], v[44:47]
    ds_read_b64_tr_b16 v[92:93], v14 offset:8192
    s_add_u32 s44, s44, 16384
    v_mfma_f32_16x16x32_bf16 v[28:31], v[60:63], v[164:167], v[28:31]
    ds_read_b64_tr_b16 v[94:95], v14 offset:10240
    v_mov_b32 v126, v128
    v_mfma_f32_16x16x32_bf16 v[32:35], v[64:67], v[164:167], v[32:35]
    ds_read_b64_tr_b16 v[96:97], v15 offset:8192
    v_mov_b32 v127, v129
    v_mfma_f32_16x16x32_bf16 v[48:51], v[64:67], v[168:171], v[48:51]
    ds_read_b64_tr_b16 v[98:99], v15 offset:10240
    v_mov_b32 v128, v130
    v_mfma_f32_16x16x32_bf16 v[52:55], v[68:71], v[168:171], v[52:55]
    ds_read_b64_tr_b16 v[100:101], v16 offset:8192
    v_mov_b32 v129, v131
    v_mfma_f32_16x16x32_bf16 v[36:39], v[68:71], v[164:167], v[36:39]
    ds_read_b64_tr_b16 v[102:103], v16 offset:10240
    s_waitcnt lgkmcnt(8)
    v_mfma_f32_16x16x32_bf16 v[24:27], v[72:75], v[172:175], v[24:27]
    ds_read_b64_tr_b16 v[104:105], v13 offset:12288
    buffer_load_dwordx4 v[164:167], v126, s[8:11], s44 offen
    v_mfma_f32_16x16x32_bf16 v[40:43], v[72:75], v[176:179], v[40:43]
    ds_read_b64_tr_b16 v[106:107], v13 offset:14336
    buffer_load_dwordx4 v[168:171], v127, s[8:11], s44 offen
    v_mfma_f32_16x16x32_bf16 v[44:47], v[76:79], v[176:179], v[44:47]
    ds_read_b64_tr_b16 v[108:109], v14 offset:12288
    s_add_u32 s44, s44, 16384
    s_waitcnt vmcnt(10)
    v_mfma_f32_16x16x32_bf16 v[28:31], v[76:79], v[172:175], v[28:31]
    ds_read_b64_tr_b16 v[110:111], v14 offset:14336
    v_or3_b32 v17, v180, v184, v188
    v_mfma_f32_16x16x32_bf16 v[32:35], v[80:83], v[172:175], v[32:35]
    ds_read_b64_tr_b16 v[112:113], v15 offset:12288
    v_bitop3_b32 v17, v17, v192, 1 bitop3:0xa8
    v_mfma_f32_16x16x32_bf16 v[48:51], v[80:83], v[176:179], v[48:51]
    ds_read_b64_tr_b16 v[114:115], v15 offset:14336
    v_cmp_ne_u32 vcc, 0, v17
    v_mfma_f32_16x16x32_bf16 v[52:55], v[84:87], v[176:179], v[52:55]
    ds_read_b64_tr_b16 v[116:117], v16 offset:12288
    ds_read_b64_tr_b16 v[118:119], v16 offset:14336
    v_mfma_f32_16x16x32_bf16 v[36:39], v[84:87], v[172:175], v[36:39]
    s_waitcnt lgkmcnt(8)
    s_cbranch_vccnz dm_23f0
dm_23g0:
    v_mfma_f32_16x16x32_bf16 v[24:27], v[88:91], v[180:183], v[24:27]
    ds_read_b64_tr_b16 v[56:57], v13 offset:16384
    buffer_load_dwordx4 v[172:175], v126, s[8:11], s44 offen
    v_mfma_f32_16x16x32_bf16 v[40:43], v[88:91], v[184:187], v[40:43]
    ds_read_b64_tr_b16 v[58:59], v13 offset:18432
    buffer_load_dwordx4 v[176:179], v127, s[8:11], s44 offen
    v_mfma_f32_16x16x32_bf16 v[44:47], v[92:95], v[184:187], v[44:47]
    ds_read_b64_tr_b16 v[60:61], v14 offset:16384
    s_add_u32 s44, s44, 16384
    v_mfma_f32_16x16x32_bf16 v[28:31], v[92:95], v[180:183], v[28:31]
    ds_read_b64_tr_b16 v[62:63], v14 offset:18432
    v_mov_b32 v130, v132
    v_mfma_f32_16x16x32_bf16 v[32:35], v[96:99], v[180:183], v[32:35]
    ds_read_b64_tr_b16 v[64:65], v15 offset:16384
    v_mov_b32 v131, v133
    v_mfma_f32_16x16x32_bf16 v[48:51], v[96:99], v[184:187], v[48:51]
    ds_read_b64_tr_b16 v[66:67], v15 offset:18432
    v_mov_b32 v132, 1073741824
    v_mfma_f32_16x16x32_bf16 v[52:55], v[100:103], v[184:187], v[52:55]
    ds_read_b64_tr_b16 v[68:69], v16 offset:16384
    v_mov_b32 v133, 1073741824
    v_mfma_f32_16x16x32_bf16 v[36:39], v[100:103], v[180:183], v[36:39]
    ds_read_b64_tr_b16 v[70:71], v16 offset:18432
    s_waitcnt lgkmcnt(8)
    v_mfma_f32_16x16x32_bf16 v[24:27], v[104:107], v[188:191], v[24:27]
    ds_read_b64_tr_b16 v[72:73], v13 offset:20480
    buffer_load_dwordx4 v[180:183], v126, s[8:11], s44 offen
    v_mfma_f32_16x16x32_bf16 v[40:43], v[104:107], v[192:195], v[40:43]
    ds_read_b64_tr_b16 v[74:75], v13 offset:22528
    buffer_load_dwordx4 v[184:187], v127, s[8:11], s44 offen
    v_mfma_f32_16x16x32_bf16 v[44:47], v[108:111], v[192:195], v[44:47]
    ds_read_b64_tr_b16 v[76:77], v14 offset:20480
    s_add_u32 s44, s44, 16384
    s_waitcnt vmcnt(10)
    v_mfma_f32_16x16x32_bf16 v[28:31], v[108:111], v[188:191], v[28:31]
    ds_read_b64_tr_b16 v[78:79], v14 offset:22528
    v_or3_b32 v17, v196, v200, v204
    v_mfma_f32_16x16x32_bf16 v[32:35], v[112:115], v[188:191], v[32:35]
    ds_read_b64_tr_b16 v[80:81], v15 offset:20480
    v_bitop3_b32 v17, v17, v208, 1 bitop3:0xa8
    v_mfma_f32_16x16x32_bf16 v[48:51], v[112:115], v[192:195], v[48:51]
    ds_read_b64_tr_b16 v[82:83], v15 offset:22528
    v_cmp_ne_u32 vcc, 0, v17
    v_mfma_f32_16x16x32_bf16 v[52:55], v[116:119], v[192:195], v[52:55]
    ds_read_b64_tr_b16 v[84:85], v16 offset:20480
    ds_read_b64_tr_b16 v[86:87], v16 offset:22528
    v_mfma_f32_16x16x32_bf16 v[36:39], v[116:119], v[188:191], v[36:39]
    s_waitcnt lgkmcnt(8)
    s_cbranch_vccnz dm_23f1
dm_23g1:
    v_mfma_f32_16x16x32_bf16 v[24:27], v[56:59], v[196:199], v[24:27]
    ds_read_b64_tr_b16 v[88:89], v13 offset:24576
    buffer_load_dwordx4 v[188:191], v126, s[8:11], s44 offen
    v_mfma_f32_16x16x32_bf16 v[40:43], v[56:59], v[200:203], v[40:43]
    ds_read_b64_tr_b16 v[90:91], v13 offset:26624
    buffer_load_dwordx4 v[192:195], v127, s[8:11], s44 offen
    v_mfma_f32_16x16x32_bf16 v[44:47], v[60:63], v[200:203], v[44:47]
    ds_read_b64_tr_b16 v[92:93], v14 offset:24576
    s_add_u32 s44, s44, 16384
    v_mfma_f32_16x16x32_bf16 v[28:31], v[60:63], v[196:199], v[28:31]
    ds_read_b64_tr_b16 v[94:95], v14 offset:26624
    v_mfma_f32_16x16x32_bf16 v[32:35], v[64:67], v[196:199], v[32:35]
    ds_read_b64_tr_b16 v[96:97], v15 offset:24576
    s_add_u32 s43, s43, 1
    v_mfma_f32_16x16x32_bf16 v[48:51], v[64:67], v[200:203], v[48:51]
    ds_read_b64_tr_b16 v[98:99], v15 offset:26624
    v_mfma_f32_16x16x32_bf16 v[52:55], v[68:71], v[200:203], v[52:55]
    ds_read_b64_tr_b16 v[100:101], v16 offset:24576
    v_mfma_f32_16x16x32_bf16 v[36:39], v[68:71], v[196:199], v[36:39]
    ds_read_b64_tr_b16 v[102:103], v16 offset:26624
    s_waitcnt lgkmcnt(8)
    v_mfma_f32_16x16x32_bf16 v[24:27], v[72:75], v[204:207], v[24:27]
    ds_read_b64_tr_b16 v[104:105], v13 offset:28672
    buffer_load_dwordx4 v[196:199], v126, s[8:11], s44 offen
    v_mfma_f32_16x16x32_bf16 v[40:43], v[72:75], v[208:211], v[40:43]
    ds_read_b64_tr_b16 v[106:107], v13 offset:30720
    buffer_load_dwordx4 v[200:203], v127, s[8:11], s44 offen
    v_mfma_f32_16x16x32_bf16 v[44:47], v[76:79], v[208:211], v[44:47]
    ds_read_b64_tr_b16 v[108:109], v14 offset:28672
    s_add_u32 s44, s44, 16384
    s_waitcnt vmcnt(10)
    v_mfma_f32_16x16x32_bf16 v[28:31], v[76:79], v[204:207], v[28:31]
    ds_read_b64_tr_b16 v[110:111], v14 offset:30720
    v_add_u32 v13, 32768, v13
    v_or3_b32 v17, v212, v216, v220
    v_mfma_f32_16x16x32_bf16 v[32:35], v[80:83], v[204:207], v[32:35]
    ds_read_b64_tr_b16 v[112:113], v15 offset:28672
    v_add_u32 v14, 32768, v14
    v_bitop3_b32 v17, v17, v224, 1 bitop3:0xa8
    v_mfma_f32_16x16x32_bf16 v[48:51], v[80:83], v[208:211], v[48:51]
    ds_read_b64_tr_b16 v[114:115], v15 offset:30720
    v_add_u32 v15, 32768, v15
    v_cmp_ne_u32 vcc, 0, v17
    v_mfma_f32_16x16x32_bf16 v[52:55], v[84:87], v[208:211], v[52:55]
    ds_read_b64_tr_b16 v[116:117], v16 offset:28672
    ds_read_b64_tr_b16 v[118:119], v16 offset:30720
    v_mfma_f32_16x16x32_bf16 v[36:39], v[84:87], v[204:207], v[36:39]
    v_add_u32 v16, 32768, v16
    s_waitcnt lgkmcnt(8)
    s_cbranch_vccnz dm_23f2
dm_23g2:
    v_mfma_f32_16x16x32_bf16 v[24:27], v[88:91], v[212:215], v[24:27]
    ds_read_b64_tr_b16 v[56:57], v13 offset:0
    buffer_load_dwordx4 v[204:207], v126, s[8:11], s44 offen
    v_mfma_f32_16x16x32_bf16 v[40:43], v[88:91], v[216:219], v[40:43]
    ds_read_b64_tr_b16 v[58:59], v13 offset:2048
    buffer_load_dwordx4 v[208:211], v127, s[8:11], s44 offen
    v_mfma_f32_16x16x32_bf16 v[44:47], v[92:95], v[216:219], v[44:47]
    ds_read_b64_tr_b16 v[60:61], v14 offset:0
    s_add_u32 s44, s44, 16384
    v_mfma_f32_16x16x32_bf16 v[28:31], v[92:95], v[212:215], v[28:31]
    ds_read_b64_tr_b16 v[62:63], v14 offset:2048
    v_mov_b32 v134, v126
    v_mfma_f32_16x16x32_bf16 v[32:35], v[96:99], v[212:215], v[32:35]
    ds_read_b64_tr_b16 v[64:65], v15 offset:0
    v_mov_b32 v135, v127
    v_mfma_f32_16x16x32_bf16 v[48:51], v[96:99], v[216:219], v[48:51]
    ds_read_b64_tr_b16 v[66:67], v15 offset:2048
    v_mfma_f32_16x16x32_bf16 v[52:55], v[100:103], v[216:219], v[52:55]
    ds_read_b64_tr_b16 v[68:69], v16 offset:0
    v_mfma_f32_16x16x32_bf16 v[36:39], v[100:103], v[212:215], v[36:39]
    ds_read_b64_tr_b16 v[70:71], v16 offset:2048
    s_waitcnt lgkmcnt(8)
    v_mfma_f32_16x16x32_bf16 v[24:27], v[104:107], v[220:223], v[24:27]
    ds_read_b64_tr_b16 v[72:73], v13 offset:4096
    buffer_load_dwordx4 v[212:215], v126, s[8:11], s44 offen
    v_mfma_f32_16x16x32_bf16 v[40:43], v[104:107], v[224:227], v[40:43]
    ds_read_b64_tr_b16 v[74:75], v13 offset:6144
    buffer_load_dwordx4 v[216:219], v127, s[8:11], s44 offen
    v_mfma_f32_16x16x32_bf16 v[44:47], v[108:111], v[224:227], v[44:47]
    ds_read_b64_tr_b16 v[76:77], v14 offset:4096
    s_add_u32 s44, s44, 16384
    s_waitcnt vmcnt(10)
    v_mfma_f32_16x16x32_bf16 v[28:31], v[108:111], v[220:223], v[28:31]
    ds_read_b64_tr_b16 v[78:79], v14 offset:6144
    v_or3_b32 v17, v164, v168, v172
    v_mfma_f32_16x16x32_bf16 v[32:35], v[112:115], v[220:223], v[32:35]
    ds_read_b64_tr_b16 v[80:81], v15 offset:4096
    v_bitop3_b32 v17, v17, v176, 1 bitop3:0xa8
    v_mfma_f32_16x16x32_bf16 v[48:51], v[112:115], v[224:227], v[48:51]
    ds_read_b64_tr_b16 v[82:83], v15 offset:6144
    v_cmp_ne_u32 vcc, 0, v17
    v_mfma_f32_16x16x32_bf16 v[52:55], v[116:119], v[224:227], v[52:55]
    ds_read_b64_tr_b16 v[84:85], v16 offset:4096
    ds_read_b64_tr_b16 v[86:87], v16 offset:6144
    s_cmp_lt_u32 s43, 3
    v_mfma_f32_16x16x32_bf16 v[36:39], v[116:119], v[220:223], v[36:39]
    s_waitcnt lgkmcnt(8)
    s_cbranch_vccnz dm_23f3
dm_23g3:
    s_cbranch_scc1 dm_23
    v_mfma_f32_16x16x32_bf16 v[24:27], v[56:59], v[164:167], v[24:27]
    ds_read_b64_tr_b16 v[88:89], v13 offset:8192
    buffer_load_dwordx4 v[220:223], v126, s[8:11], s44 offen
    v_mfma_f32_16x16x32_bf16 v[40:43], v[56:59], v[168:171], v[40:43]
    ds_read_b64_tr_b16 v[90:91], v13 offset:10240
    buffer_load_dwordx4 v[224:227], v127, s[8:11], s44 offen
    v_mfma_f32_16x16x32_bf16 v[44:47], v[60:63], v[168:171], v[44:47]
    ds_read_b64_tr_b16 v[92:93], v14 offset:8192
    v_mfma_f32_16x16x32_bf16 v[28:31], v[60:63], v[164:167], v[28:31]
    ds_read_b64_tr_b16 v[94:95], v14 offset:10240
    v_mfma_f32_16x16x32_bf16 v[32:35], v[64:67], v[164:167], v[32:35]
    ds_read_b64_tr_b16 v[96:97], v15 offset:8192
    v_mfma_f32_16x16x32_bf16 v[48:51], v[64:67], v[168:171], v[48:51]
    ds_read_b64_tr_b16 v[98:99], v15 offset:10240
    v_mfma_f32_16x16x32_bf16 v[52:55], v[68:71], v[168:171], v[52:55]
    ds_read_b64_tr_b16 v[100:101], v16 offset:8192
    v_mfma_f32_16x16x32_bf16 v[36:39], v[68:71], v[164:167], v[36:39]
    ds_read_b64_tr_b16 v[102:103], v16 offset:10240
    s_waitcnt lgkmcnt(8)
    v_mfma_f32_16x16x32_bf16 v[24:27], v[72:75], v[172:175], v[24:27]
    ds_read_b64_tr_b16 v[104:105], v13 offset:12288
    v_mfma_f32_16x16x32_bf16 v[40:43], v[72:75], v[176:179], v[40:43]
    ds_read_b64_tr_b16 v[106:107], v13 offset:14336
    v_mfma_f32_16x16x32_bf16 v[44:47], v[76:79], v[176:179], v[44:47]
    ds_read_b64_tr_b16 v[108:109], v14 offset:12288
    s_waitcnt vmcnt(8)
    v_mfma_f32_16x16x32_bf16 v[28:31], v[76:79], v[172:175], v[28:31]
    ds_read_b64_tr_b16 v[110:111], v14 offset:14336
    v_or3_b32 v17, v180, v184, v188
    v_mfma_f32_16x16x32_bf16 v[32:35], v[80:83], v[172:175], v[32:35]
    ds_read_b64_tr_b16 v[112:113], v15 offset:12288
    v_bitop3_b32 v17, v17, v192, 1 bitop3:0xa8
    v_mfma_f32_16x16x32_bf16 v[48:51], v[80:83], v[176:179], v[48:51]
    ds_read_b64_tr_b16 v[114:115], v15 offset:14336
    v_cmp_ne_u32 vcc, 0, v17
    v_mfma_f32_16x16x32_bf16 v[52:55], v[84:87], v[176:179], v[52:55]
    ds_read_b64_tr_b16 v[116:117], v16 offset:12288
    ds_read_b64_tr_b16 v[118:119], v16 offset:14336
    v_mfma_f32_16x16x32_bf16 v[36:39], v[84:87], v[172:175], v[36:39]
    s_waitcnt lgkmcnt(8)
    s_cbranch_vccnz dm_23m0
dm_23n0:
    v_mfma_f32_16x16x32_bf16 v[24:27], v[88:91], v[180:183], v[24:27]
    ds_read_b64_tr_b16 v[56:57], v13 offset:16384
    v_mfma_f32_16x16x32_bf16 v[40:43], v[88:91], v[184:187], v[40:43]
    ds_read_b64_tr_b16 v[58:59], v13 offset:18432
    v_mfma_f32_16x16x32_bf16 v[44:47], v[92:95], v[184:187], v[44:47]
    ds_read_b64_tr_b16 v[60:61], v14 offset:16384
    v_mfma_f32_16x16x32_bf16 v[28:31], v[92:95], v[180:183], v[28:31]
    ds_read_b64_tr_b16 v[62:63], v14 offset:18432
    v_mfma_f32_16x16x32_bf16 v[32:35], v[96:99], v[180:183], v[32:35]
    ds_read_b64_tr_b16 v[64:65], v15 offset:16384
    v_mfma_f32_16x16x32_bf16 v[48:51], v[96:99], v[184:187], v[48:51]
    ds_read_b64_tr_b16 v[66:67], v15 offset:18432
    v_mfma_f32_16x16x32_bf16 v[52:55], v[100:103], v[184:187], v[52:55]
    ds_read_b64_tr_b16 v[68:69], v16 offset:16384
    v_mfma_f32_16x16x32_bf16 v[36:39], v[100:103], v[180:183], v[36:39]
    ds_read_b64_tr_b16 v[70:71], v16 offset:18432
    s_waitcnt lgkmcnt(8)
    v_mfma_f32_16x16x32_bf16 v[24:27], v[104:107], v[188:191], v[24:27]
    ds_read_b64_tr_b16 v[72:73], v13 offset:20480
    v_mfma_f32_16x16x32_bf16 v[40:43], v[104:107], v[192:195], v[40:43]
    ds_read_b64_tr_b16 v[74:75], v13 offset:22528
    v_mfma_f32_16x16x32_bf16 v[44:47], v[108:111], v[192:195], v[44:47]
    ds_read_b64_tr_b16 v[76:77], v14 offset:20480
    s_waitcnt vmcnt(4)
    v_mfma_f32_16x16x32_bf16 v[28:31], v[108:111], v[188:191], v[28:31]
    ds_read_b64_tr_b16 v[78:79], v14 offset:22528
    v_or3_b32 v17, v196, v200, v204
    v_mfma_f32_16x16x32_bf16 v[32:35], v[112:115], v[188:191], v[32:35]
    ds_read_b64_tr_b16 v[80:81], v15 offset:20480
    v_bitop3_b32 v17, v17, v208, 1 bitop3:0xa8
    v_mfma_f32_16x16x32_bf16 v[48:51], v[112:115], v[192:195], v[48:51]
    ds_read_b64_tr_b16 v[82:83], v15 offset:22528
    v_cmp_ne_u32 vcc, 0, v17
    v_mfma_f32_16x16x32_bf16 v[52:55], v[116:119], v[192:195], v[52:55]
    ds_read_b64_tr_b16 v[84:85], v16 offset:20480
    ds_read_b64_tr_b16 v[86:87], v16 offset:22528
    v_mfma_f32_16x16x32_bf16 v[36:39], v[116:119], v[188:191], v[36:39]
    s_waitcnt lgkmcnt(8)
    s_cbranch_vccnz dm_23m1
dm_23n1:
    v_mfma_f32_16x16x32_bf16 v[24:27], v[56:59], v[196:199], v[24:27]
    ds_read_b64_tr_b16 v[88:89], v13 offset:24576
    v_mfma_f32_16x16x32_bf16 v[40:43], v[56:59], v[200:203], v[40:43]
    ds_read_b64_tr_b16 v[90:91], v13 offset:26624
    v_mfma_f32_16x16x32_bf16 v[44:47], v[60:63], v[200:203], v[44:47]
    ds_read_b64_tr_b16 v[92:93], v14 offset:24576
    v_mfma_f32_16x16x32_bf16 v[28:31], v[60:63], v[196:199], v[28:31]
    ds_read_b64_tr_b16 v[94:95], v14 offset:26624
    v_mfma_f32_16x16x32_bf16 v[32:35], v[64:67], v[196:199], v[32:35]
    ds_read_b64_tr_b16 v[96:97], v15 offset:24576
    v_mfma_f32_16x16x32_bf16 v[48:51], v[64:67], v[200:203], v[48:51]
    ds_read_b64_tr_b16 v[98:99], v15 offset:26624
    v_mfma_f32_16x16x32_bf16 v[52:55], v[68:71], v[200:203], v[52:55]
    ds_read_b64_tr_b16 v[100:101], v16 offset:24576
    v_mfma_f32_16x16x32_bf16 v[36:39], v[68:71], v[196:199], v[36:39]
    ds_read_b64_tr_b16 v[102:103], v16 offset:26624
    s_waitcnt lgkmcnt(8)
    v_mfma_f32_16x16x32_bf16 v[24:27], v[72:75], v[204:207], v[24:27]
    ds_read_b64_tr_b16 v[104:105], v13 offset:28672
    v_mfma_f32_16x16x32_bf16 v[40:43], v[72:75], v[208:211], v[40:43]
    ds_read_b64_tr_b16 v[106:107], v13 offset:30720
    v_mfma_f32_16x16x32_bf16 v[44:47], v[76:79], v[208:211], v[44:47]
    ds_read_b64_tr_b16 v[108:109], v14 offset:28672
    s_waitcnt vmcnt(0)
    v_mfma_f32_16x16x32_bf16 v[28:31], v[76:79], v[204:207], v[28:31]
    ds_read_b64_tr_b16 v[110:111], v14 offset:30720
    v_or3_b32 v17, v212, v216, v220
    v_mfma_f32_16x16x32_bf16 v[32:35], v[80:83], v[204:207], v[32:35]
    ds_read_b64_tr_b16 v[112:113], v15 offset:28672
    v_bitop3_b32 v17, v17, v224, 1 bitop3:0xa8
    v_mfma_f32_16x16x32_bf16 v[48:51], v[80:83], v[208:211], v[48:51]
    ds_read_b64_tr_b16 v[114:115], v15 offset:30720
    v_cmp_ne_u32 vcc, 0, v17
    v_mfma_f32_16x16x32_bf16 v[52:55], v[84:87], v[208:211], v[52:55]
    ds_read_b64_tr_b16 v[116:117], v16 offset:28672
    ds_read_b64_tr_b16 v[118:119], v16 offset:30720
    v_mfma_f32_16x16x32_bf16 v[36:39], v[84:87], v[204:207], v[36:39]
    s_waitcnt lgkmcnt(8)
    s_cbranch_vccnz dm_23m2
dm_23n2:
dm_23x:
    v_mfma_f32_16x16x32_bf16 v[24:27], v[88:91], v[212:215], v[24:27]
    v_mfma_f32_16x16x32_bf16 v[40:43], v[88:91], v[216:219], v[40:43]
    v_mfma_f32_16x16x32_bf16 v[44:47], v[92:95], v[216:219], v[44:47]
    v_mfma_f32_16x16x32_bf16 v[28:31], v[92:95], v[212:215], v[28:31]
    v_mfma_f32_16x16x32_bf16 v[32:35], v[96:99], v[212:215], v[32:35]
    v_mfma_f32_16x16x32_bf16 v[48:51], v[96:99], v[216:219], v[48:51]
    v_mfma_f32_16x16x32_bf16 v[52:55], v[100:103], v[216:219], v[52:55]
    v_mfma_f32_16x16x32_bf16 v[36:39], v[100:103], v[212:215], v[36:39]
    s_waitcnt lgkmcnt(0)
    v_mfma_f32_16x16x32_bf16 v[24:27], v[104:107], v[220:223], v[24:27]
    s_add_u32 s44, s62, 0x5c8000
    v_mfma_f32_16x16x32_bf16 v[40:43], v[104:107], v[224:227], v[40:43]
    s_addc_u32 s45, s63, 0
    v_mfma_f32_16x16x32_bf16 v[44:47], v[108:111], v[224:227], v[44:47]
    v_mfma_f32_16x16x32_bf16 v[28:31], v[108:111], v[220:223], v[28:31]
    s_mov_b32 s46, 0x6000
    v_mfma_f32_16x16x32_bf16 v[32:35], v[112:115], v[220:223], v[32:35]
    v_mfma_f32_16x16x32_bf16 v[48:51], v[112:115], v[224:227], v[48:51]
    s_mov_b32 s47, 0x20000
    v_mfma_f32_16x16x32_bf16 v[52:55], v[116:119], v[224:227], v[52:55]
    v_mfma_f32_16x16x32_bf16 v[36:39], v[116:119], v[220:223], v[36:39]
    s_add_u32 s36, s39, 0
    v_cvt_pk_bf16_f32 v148, v24, v25
    v_cvt_pk_bf16_f32 v149, v26, v27
    v_cvt_pk_bf16_f32 v150, v28, v29
    v_cvt_pk_bf16_f32 v151, v30, v31
    v_and_b32 v148, -2, v148
    buffer_store_dwordx4 v[148:151], v2, s[16:19], s36 offen offset:0 sc1
    v_cvt_pk_bf16_f32 v152, v32, v33
    v_cvt_pk_bf16_f32 v153, v34, v35
    v_cvt_pk_bf16_f32 v154, v36, v37
    v_cvt_pk_bf16_f32 v155, v38, v39
    v_and_b32 v152, -2, v152
    buffer_store_dwordx4 v[152:155], v2, s[16:19], s36 offen offset:1024 sc1
    s_add_u32 s36, s39, 65536
    v_cvt_pk_bf16_f32 v156, v40, v41
    v_cvt_pk_bf16_f32 v157, v42, v43
    v_cvt_pk_bf16_f32 v158, v44, v45
    v_cvt_pk_bf16_f32 v159, v46, v47
    v_and_b32 v156, -2, v156
    buffer_store_dwordx4 v[156:159], v2, s[16:19], s36 offen offset:0 sc1
    v_cvt_pk_bf16_f32 v160, v48, v49
    v_cvt_pk_bf16_f32 v161, v50, v51
    v_cvt_pk_bf16_f32 v162, v52, v53
    v_cvt_pk_bf16_f32 v163, v54, v55
    v_and_b32 v160, -2, v160
    buffer_store_dwordx4 v[160:163], v2, s[16:19], s36 offen offset:1024 sc1
    s_barrier
    s_lshl_b32 s36, s37, 11
    v_add_u32 v7, s36, v2
    ds_write_b128 v7, v[148:151] offset:0
    ds_write_b128 v7, v[152:155] offset:1024
    ds_write_b128 v7, v[156:159] offset:2048
    ds_write_b128 v7, v[160:163] offset:3072
    v_lshlrev_b32 v24, 16, v148
    v_and_b32 v25, 0xffff0000, v148
    v_lshlrev_b32 v26, 16, v149
    v_and_b32 v27, 0xffff0000, v149
    v_lshlrev_b32 v28, 16, v150
    v_and_b32 v29, 0xffff0000, v150
    v_lshlrev_b32 v30, 16, v151
    v_and_b32 v31, 0xffff0000, v151
    v_lshlrev_b32 v32, 16, v152
    v_and_b32 v33, 0xffff0000, v152
    v_lshlrev_b32 v34, 16, v153
    v_and_b32 v35, 0xffff0000, v153
    v_lshlrev_b32 v36, 16, v154
    v_and_b32 v37, 0xffff0000, v154
    v_lshlrev_b32 v38, 16, v155
    v_and_b32 v39, 0xffff0000, v155
    v_lshlrev_b32 v40, 16, v156
    v_and_b32 v41, 0xffff0000, v156
    v_lshlrev_b32 v42, 16, v157
    v_and_b32 v43, 0xffff0000, v157
    v_lshlrev_b32 v44, 16, v158
    v_and_b32 v45, 0xffff0000, v158
    v_lshlrev_b32 v46, 16, v159
    v_and_b32 v47, 0xffff0000, v159
    v_lshlrev_b32 v48, 16, v160
    v_and_b32 v49, 0xffff0000, v160
    v_lshlrev_b32 v50, 16, v161
    v_and_b32 v51, 0xffff0000, v161
    v_lshlrev_b32 v52, 16, v162
    v_and_b32 v53, 0xffff0000, v162
    v_lshlrev_b32 v54, 16, v163
    v_and_b32 v55, 0xffff0000, v163
    s_add_u32 s53, s55, 512
    v_mov_b32 v8, 1
    v_mov_b32 v9, 162816
    v_mov_b32 v11, 0
    s_mov_b64 exec, 1
    s_waitcnt vmcnt(0)
    ds_add_rtn_u32 v10, v9, v8
    s_waitcnt lgkmcnt(0)
    v_readfirstlane_b32 s54, v10
    s_nop 0
    s_and_b32 s54, s54, 3
    s_cmp_lg_u32 s54, 3
    s_cbranch_scc1 pub_24
    buffer_atomic_add v8, v11, s[56:59], s53 offen sc1
    v_mov_b32 v9, 162872
    ds_add_u32 v9, v8
pub_24:
    s_mov_b64 exec, -1
    s_waitcnt lgkmcnt(0)
    s_barrier
    v_pk_add_f32 v[142:143], v[24:25], v[26:27]
    v_pk_mul_f32 v[136:137], v[24:25], v[24:25]
    v_pk_fma_f32 v[136:137], v[26:27], v[26:27], v[136:137]
    v_pk_add_f32 v[142:143], v[142:143], v[28:29]
    v_pk_fma_f32 v[136:137], v[28:29], v[28:29], v[136:137]
    v_pk_add_f32 v[142:143], v[142:143], v[30:31]
    v_pk_fma_f32 v[136:137], v[30:31], v[30:31], v[136:137]
    v_pk_add_f32 v[142:143], v[142:143], v[32:33]
    v_pk_fma_f32 v[136:137], v[32:33], v[32:33], v[136:137]
    v_pk_add_f32 v[142:143], v[142:143], v[34:35]
    v_pk_fma_f32 v[136:137], v[34:35], v[34:35], v[136:137]
    v_pk_add_f32 v[142:143], v[142:143], v[36:37]
    v_pk_fma_f32 v[136:137], v[36:37], v[36:37], v[136:137]
    v_pk_add_f32 v[142:143], v[142:143], v[38:39]
    v_pk_fma_f32 v[136:137], v[38:39], v[38:39], v[136:137]
    v_add_f32 v138, v142, v143
    v_add_f32 v139, v136, v137
    v_mov_b32 v142, v138
    v_mov_b32 v143, v139
    s_nop 0
    v_permlane16_swap_b32 v138, v142
    v_permlane16_swap_b32 v139, v143
    v_pk_add_f32 v[138:139], v[138:139], v[142:143]
    v_mov_b32 v142, v138
    v_mov_b32 v143, v139
    s_nop 0
    v_permlane32_swap_b32 v138, v142
    v_permlane32_swap_b32 v139, v143
    v_pk_add_f32 v[138:139], v[138:139], v[142:143]
    v_pk_add_f32 v[142:143], v[40:41], v[42:43]
    v_pk_mul_f32 v[136:137], v[40:41], v[40:41]
    v_pk_fma_f32 v[136:137], v[42:43], v[42:43], v[136:137]
    v_pk_add_f32 v[142:143], v[142:143], v[44:45]
    v_pk_fma_f32 v[136:137], v[44:45], v[44:45], v[136:137]
    v_pk_add_f32 v[142:143], v[142:143], v[46:47]
    v_pk_fma_f32 v[136:137], v[46:47], v[46:47], v[136:137]
    v_pk_add_f32 v[142:143], v[142:143], v[48:49]
    v_pk_fma_f32 v[136:137], v[48:49], v[48:49], v[136:137]
    v_pk_add_f32 v[142:143], v[142:143], v[50:51]
    v_pk_fma_f32 v[136:137], v[50:51], v[50:51], v[136:137]
    v_pk_add_f32 v[142:143], v[142:143], v[52:53]
    v_pk_fma_f32 v[136:137], v[52:53], v[52:53], v[136:137]
    v_pk_add_f32 v[142:143], v[142:143], v[54:55]
    v_pk_fma_f32 v[136:137], v[54:55], v[54:55], v[136:137]
    v_add_f32 v140, v142, v143
    v_add_f32 v141, v136, v137
    v_mov_b32 v142, v140
    v_mov_b32 v143, v141
    s_nop 0
    v_permlane16_swap_b32 v140, v142
    v_permlane16_swap_b32 v141, v143
    v_pk_add_f32 v[140:141], v[140:141], v[142:143]
    v_mov_b32 v142, v140
    v_mov_b32 v143, v141
    s_nop 0
    v_permlane32_swap_b32 v140, v142
    v_permlane32_swap_b32 v141, v143
    v_pk_add_f32 v[140:141], v[140:141], v[142:143]
    v_cmp_eq_u32 vcc, 0, v23
    s_nop 1
    v_cndmask_b32 v138, v140, v138, vcc
    v_cndmask_b32 v139, v141, v139, vcc
    s_lshr_b32 s53, s29, 3
    s_lshl_b32 s53, s53, 14
    s_and_b32 s40, s29, 7
    s_lshl_b32 s40, s40, 10
    s_add_u32 s40, s40, s53
    s_lshl_b32 s36, s34, 8
    s_add_u32 s40, s40, s36
    v_lshlrev_b32 v7, 3, v1
    s_bfm_b64 exec, 32, 0
    buffer_store_dwordx2 v[138:139], v7, s[44:47], s40 offen sc1
    s_mov_b64 exec, -1
    s_lshr_b32 s34, s30, 1
    s_and_b32 s35, s30, 1
    v_and_b32 v22, 15, v1
    v_lshrrev_b32 v23, 4, v1
    s_mul_i32 s37, s34, 4
    s_mul_i32 s38, s29, 14
    s_mul_i32 s36, s35, 7
    s_add_u32 s38, s38, s36
    s_mul_i32 s36, s34, 8192
    v_add_u32 v12, s36, v2
    v_lshrrev_b32 v6, 2, v1
    v_mul_u32_u24 v13, 448, v6
    v_and_b32 v7, 3, v1
    v_lshl_add_u32 v13, v7, 3, v13
    v_add_u32 v13, 73728, v13
    s_mul_i32 s36, s35, 224
    v_add_u32 v13, s36, v13
    v_bfe_u32 v6, v1, 4, 1
    v_lshlrev_b32 v6, 5, v6
    s_cmp_eq_u32 s35, 0
    s_cselect_b32 s36, 1, -1
    v_mul_lo_u32 v6, v6, s36
    v_sub_u32 v14, v13, v6
    v_add_u32 v13, v13, v6
    v_mov_b32 v17, v12
    s_mov_b32 s42, 0
    s_mov_b32 s43, 0
    s_mov_b32 s48, 57344
    v_add_u32 v18, 57344, v13
    v_add_u32 v19, 57344, v14
    ds_read_b128 v[136:139], v17 offset:0
    ds_read_b128 v[140:143], v17 offset:2048
    ds_read_b128 v[144:147], v17 offset:4096
    ds_read_b128 v[148:151], v17 offset:6144
    ds_read_b64_tr_b16 v[152:153], v18 offset:0
    ds_read_b64_tr_b16 v[154:155], v18 offset:7168
    ds_read_b64_tr_b16 v[156:157], v19 offset:32
    ds_read_b64_tr_b16 v[158:159], v19 offset:7200
    ds_read_b64_tr_b16 v[160:161], v18 offset:64
    ds_read_b64_tr_b16 v[162:163], v18 offset:7232
    ds_read_b64_tr_b16 v[164:165], v19 offset:96
    ds_read_b64_tr_b16 v[166:167], v19 offset:7264
    ds_read_b64_tr_b16 v[168:169], v18 offset:128
    ds_read_b64_tr_b16 v[170:171], v18 offset:7296
    ds_read_b64_tr_b16 v[172:173], v19 offset:160
    ds_read_b64_tr_b16 v[174:175], v19 offset:7328
    ds_read_b64_tr_b16 v[176:177], v18 offset:192
    ds_read_b64_tr_b16 v[178:179], v18 offset:7360
    s_waitcnt lgkmcnt(12)
    v_mfma_f32_16x16x32_bf16 v[24:27], v[152:155], v[136:139], 0
    ds_read_b128 v[180:183], v17 offset:1024
    s_add_u32 s42, s42, 16384
    v_mfma_f32_16x16x32_bf16 v[52:55], v[152:155], v[140:143], 0
    ds_read_b128 v[184:187], v17 offset:3072
    s_cmp_eq_u32 s42, 49152
    v_mfma_f32_16x16x32_bf16 v[80:83], v[152:155], v[144:147], 0
    ds_read_b128 v[188:191], v17 offset:5120
    s_cselect_b32 s42, 0, s42
    v_mfma_f32_16x16x32_bf16 v[108:111], v[152:155], v[148:151], 0
    ds_read_b128 v[192:195], v17 offset:7168
    s_waitcnt lgkmcnt(14)
    v_mfma_f32_16x16x32_bf16 v[112:115], v[156:159], v[148:151], 0
    ds_read_b64_tr_b16 v[196:197], v18 offset:14336
    s_add_u32 s48, s48, 28672
    v_mfma_f32_16x16x32_bf16 v[84:87], v[156:159], v[144:147], 0
    ds_read_b64_tr_b16 v[198:199], v18 offset:21504
    s_cmp_eq_u32 s48, 86016
    v_mfma_f32_16x16x32_bf16 v[56:59], v[156:159], v[140:143], 0
    ds_read_b64_tr_b16 v[200:201], v19 offset:14368
    s_cselect_b32 s48, 0, s48
    v_mfma_f32_16x16x32_bf16 v[28:31], v[156:159], v[136:139], 0
    ds_read_b64_tr_b16 v[202:203], v19 offset:21536
    s_waitcnt lgkmcnt(8)
    v_mfma_f32_16x16x32_bf16 v[32:35], v[160:163], v[136:139], 0
    ds_read_b64_tr_b16 v[204:205], v18 offset:14400
    v_add_u32 v17, s42, v12
    v_mfma_f32_16x16x32_bf16 v[60:63], v[160:163], v[140:143], 0
    ds_read_b64_tr_b16 v[206:207], v18 offset:21568
    v_mfma_f32_16x16x32_bf16 v[88:91], v[160:163], v[144:147], 0
    ds_read_b64_tr_b16 v[208:209], v19 offset:14432
    v_mfma_f32_16x16x32_bf16 v[116:119], v[160:163], v[148:151], 0
    ds_read_b64_tr_b16 v[210:211], v19 offset:21600
    v_mfma_f32_16x16x32_bf16 v[120:123], v[164:167], v[148:151], 0
    ds_read_b64_tr_b16 v[212:213], v18 offset:14464
    v_mfma_f32_16x16x32_bf16 v[92:95], v[164:167], v[144:147], 0
    ds_read_b64_tr_b16 v[214:215], v18 offset:21632
    v_mfma_f32_16x16x32_bf16 v[64:67], v[164:167], v[140:143], 0
    ds_read_b64_tr_b16 v[216:217], v19 offset:14496
    v_mfma_f32_16x16x32_bf16 v[36:39], v[164:167], v[136:139], 0
    ds_read_b64_tr_b16 v[218:219], v19 offset:21664
    v_add_u32 v19, s48, v14
    v_mfma_f32_16x16x32_bf16 v[40:43], v[168:171], v[136:139], 0
    ds_read_b64_tr_b16 v[220:221], v18 offset:14528
    v_mfma_f32_16x16x32_bf16 v[68:71], v[168:171], v[140:143], 0
    ds_read_b64_tr_b16 v[222:223], v18 offset:21696
    v_add_u32 v18, s48, v13
    v_mfma_f32_16x16x32_bf16 v[96:99], v[168:171], v[144:147], 0
    v_mfma_f32_16x16x32_bf16 v[124:127], v[168:171], v[148:151], 0
    v_mfma_f32_16x16x32_bf16 v[128:131], v[172:175], v[148:151], 0
    v_mfma_f32_16x16x32_bf16 v[100:103], v[172:175], v[144:147], 0
    v_mfma_f32_16x16x32_bf16 v[72:75], v[172:175], v[140:143], 0
    v_mfma_f32_16x16x32_bf16 v[44:47], v[172:175], v[136:139], 0
    v_mfma_f32_16x16x32_bf16 v[48:51], v[176:179], v[136:139], 0
    v_mfma_f32_16x16x32_bf16 v[76:79], v[176:179], v[140:143], 0
    v_mfma_f32_16x16x32_bf16 v[104:107], v[176:179], v[144:147], 0
    v_mfma_f32_16x16x32_bf16 v[132:135], v[176:179], v[148:151], 0
    s_waitcnt lgkmcnt(12)
    v_mfma_f32_16x16x32_bf16 v[24:27], v[196:199], v[180:183], v[24:27]
    s_add_u32 s43, s43, 1
    s_mul_i32 s36, s35, 448
    s_add_u32 s36, s36, 159744
    v_lshlrev_b32 v6, 4, v23
    v_mfma_f32_16x16x32_bf16 v[52:55], v[196:199], v[184:187], v[52:55]
    v_add_u32 v6, s36, v6
    s_lshl_b32 s36, s37, 8
    s_add_u32 s36, s36, 160768
    v_lshlrev_b32 v7, 4, v22
    v_mfma_f32_16x16x32_bf16 v[80:83], v[196:199], v[188:191], v[80:83]
    v_add_u32 v7, s36, v7
    s_add_u32 s16, s62, 0x400000
    s_addc_u32 s17, s63, 0
    s_mov_b32 s18, 0x1be000
    v_mfma_f32_16x16x32_bf16 v[108:111], v[196:199], v[192:195], v[108:111]
    s_mov_b32 s19, 0x20000
    s_mul_i32 s39, s37, 229376
    s_lshr_b32 s36, s38, 1
    s_waitcnt lgkmcnt(0)
    v_mfma_f32_16x16x32_bf16 v[112:115], v[200:203], v[192:195], v[112:115]
    s_add_u32 s36, s36, 0
    s_lshr_b32 s53, s36, 3
    s_lshl_b32 s53, s53, 14
    s_and_b32 s44, s36, 7
    v_mfma_f32_16x16x32_bf16 v[84:87], v[200:203], v[188:191], v[84:87]
    s_lshl_b32 s44, s44, 10
    s_add_u32 s44, s44, s53
    s_add_u32 s44, s44, s39
    s_lshr_b32 s36, s38, 1
    v_mfma_f32_16x16x32_bf16 v[56:59], v[200:203], v[184:187], v[56:59]
    s_add_u32 s36, s36, 1
    s_lshr_b32 s53, s36, 3
    s_lshl_b32 s53, s53, 14
    s_and_b32 s45, s36, 7
    v_mfma_f32_16x16x32_bf16 v[28:31], v[200:203], v[180:183], v[28:31]
    s_lshl_b32 s45, s45, 10
    s_add_u32 s45, s45, s53
    s_add_u32 s45, s45, s39
    s_lshr_b32 s36, s38, 1
    v_mfma_f32_16x16x32_bf16 v[32:35], v[204:207], v[180:183], v[32:35]
    s_add_u32 s36, s36, 2
    s_lshr_b32 s53, s36, 3
    s_lshl_b32 s53, s53, 14
    s_and_b32 s46, s36, 7
    v_mfma_f32_16x16x32_bf16 v[60:63], v[204:207], v[184:187], v[60:63]
    s_lshl_b32 s46, s46, 10
    s_add_u32 s46, s46, s53
    s_add_u32 s46, s46, s39
    s_lshr_b32 s36, s38, 1
    v_mfma_f32_16x16x32_bf16 v[88:91], v[204:207], v[188:191], v[88:91]
    s_add_u32 s36, s36, 3
    s_lshr_b32 s53, s36, 3
    s_lshl_b32 s53, s53, 14
    s_and_b32 s47, s36, 7
    v_mfma_f32_16x16x32_bf16 v[116:119], v[204:207], v[192:195], v[116:119]
    s_lshl_b32 s47, s47, 10
    s_add_u32 s47, s47, s53
    s_add_u32 s47, s47, s39
    v_lshrrev_b32 v226, 2, v1
    v_mfma_f32_16x16x32_bf16 v[120:123], v[208:211], v[192:195], v[120:123]
    v_mul_u32_u24 v240, 256, v226
    v_and_b32 v227, 3, v1
    v_lshl_add_u32 v240, v227, 3, v240
    v_add_u32 v240, 49152, v240
    v_mfma_f32_16x16x32_bf16 v[92:95], v[208:211], v[188:191], v[92:95]
    v_and_b32 v226, 7, v226
    s_mul_i32 s36, s35, 4
    s_add_u32 s36, s36, 3
    v_xor_b32 v227, s36, v226
    v_mfma_f32_16x16x32_bf16 v[64:67], v[208:211], v[184:187], v[64:67]
    v_lshl_add_u32 v243, v227, 5, v240
    s_mul_i32 s36, s35, 4
    s_add_u32 s36, s36, 2
    v_xor_b32 v227, s36, v226
    v_mfma_f32_16x16x32_bf16 v[36:39], v[208:211], v[180:183], v[36:39]
    v_lshl_add_u32 v242, v227, 5, v240
    s_mul_i32 s36, s35, 4
    s_add_u32 s36, s36, 1
    v_xor_b32 v227, s36, v226
    v_mfma_f32_16x16x32_bf16 v[40:43], v[212:215], v[180:183], v[40:43]
    v_lshl_add_u32 v241, v227, 5, v240
    s_mul_i32 s36, s35, 4
    s_add_u32 s36, s36, 0
    v_xor_b32 v227, s36, v226
    v_mfma_f32_16x16x32_bf16 v[68:71], v[212:215], v[184:187], v[68:71]
    v_lshl_add_u32 v240, v227, 5, v240
    s_lshl_b32 s38, s33, 3
    s_lshl_b32 s36, s35, 2
    s_add_u32 s38, s38, s36
    v_mfma_f32_16x16x32_bf16 v[96:99], v[212:215], v[188:191], v[96:99]
    s_lshr_b32 s36, s38, 1
    s_lshr_b32 s53, s36, 3
    s_lshl_b32 s53, s53, 14
    s_and_b32 s39, s36, 7
    v_mfma_f32_16x16x32_bf16 v[124:127], v[212:215], v[192:195], v[124:127]
    s_lshl_b32 s39, s39, 10
    s_add_u32 s39, s39, s53
    s_lshl_b32 s36, s37, 16
    s_add_u32 s39, s39, s36
    v_mfma_f32_16x16x32_bf16 v[128:131], v[216:219], v[192:195], v[128:131]
    s_lshl_b32 s40, s31, 17
    s_add_u32 s40, s40, s39
    s_xor_b32 s41, s31, 1
    s_lshl_b32 s41, s41, 17
    v_mfma_f32_16x16x32_bf16 v[100:103], v[216:219], v[188:191], v[100:103]
    s_add_u32 s41, s41, s39
    s_mov_b32 s84, s62
    s_mov_b32 s85, s63
    s_mov_b32 s86, 0x7e000
    v_mfma_f32_16x16x32_bf16 v[72:75], v[216:219], v[184:187], v[72:75]
    s_mov_b32 s87, 0x20000
    s_add_u32 s88, s62, 0x80000
    s_addc_u32 s89, s63, 0
    s_mov_b32 s90, 0x7e000
    v_mfma_f32_16x16x32_bf16 v[44:47], v[216:219], v[180:183], v[44:47]
    s_mov_b32 s91, 0x20000
    s_lshl_b32 s36, s37, 1
    s_add_u32 s36, s36, s35
    s_lshl_b32 s36, s36, 10
    v_mfma_f32_16x16x32_bf16 v[48:51], v[220:223], v[180:183], v[48:51]
    v_add_u32 v244, s36, v2
    v_mov_b32 v245, 1
    v_mov_b32 v246, 162880
    v_lshrrev_b32 v238, 1, v23
    v_mfma_f32_16x16x32_bf16 v[76:79], v[220:223], v[184:187], v[76:79]
    v_lshlrev_b32 v238, 8, v238
    v_lshl_add_u32 v238, v22, 4, v238
    v_and_b32 v224, 1, v23
    v_lshl_add_u32 v238, v224, 3, v238
    v_mfma_f32_16x16x32_bf16 v[104:107], v[220:223], v[188:191], v[104:107]
    v_mfma_f32_16x16x32_bf16 v[132:135], v[220:223], v[192:195], v[132:135]
    s_add_u32 s53, s55, 1408
    v_mov_b32 v8, 1
    v_mov_b32 v9, 162864
    v_mov_b32 v11, 0
    s_mov_b64 exec, 1
    s_waitcnt vmcnt(0)
    ds_add_rtn_u32 v10, v9, v8
    s_waitcnt lgkmcnt(0)
    v_readfirstlane_b32 s54, v10
    s_nop 0
    s_and_b32 s54, s54, 3
    s_cmp_lg_u32 s54, 3
    s_cbranch_scc1 pub_25
    buffer_atomic_add v8, v11, s[56:59], s53 offen sc1
pub_25:
    s_mov_b64 exec, -1
    s_barrier
    ds_read_b128 v[136:139], v17 offset:0
    ds_read_b128 v[140:143], v17 offset:2048
    ds_read_b128 v[144:147], v17 offset:4096
    ds_read_b128 v[148:151], v17 offset:6144
    ds_read_b64_tr_b16 v[152:153], v18 offset:0
    ds_read_b64_tr_b16 v[154:155], v18 offset:7168
    ds_read_b64_tr_b16 v[156:157], v19 offset:32
    ds_read_b64_tr_b16 v[158:159], v19 offset:7200
    ds_read_b64_tr_b16 v[160:161], v18 offset:64
    ds_read_b64_tr_b16 v[162:163], v18 offset:7232
    ds_read_b64_tr_b16 v[164:165], v19 offset:96
    ds_read_b64_tr_b16 v[166:167], v19 offset:7264
    ds_read_b64_tr_b16 v[168:169], v18 offset:128
    ds_read_b64_tr_b16 v[170:171], v18 offset:7296
    ds_read_b64_tr_b16 v[172:173], v19 offset:160
    ds_read_b64_tr_b16 v[174:175], v19 offset:7328
    ds_read_b64_tr_b16 v[176:177], v18 offset:192
    ds_read_b64_tr_b16 v[178:179], v18 offset:7360
    s_waitcnt lgkmcnt(12)
mm_26:
    v_mfma_f32_16x16x32_bf16 v[24:27], v[152:155], v[136:139], v[24:27]
    ds_read_b128 v[180:183], v17 offset:1024
    s_add_u32 s42, s42, 16384
    v_mfma_f32_16x16x32_bf16 v[52:55], v[152:155], v[140:143], v[52:55]
    ds_read_b128 v[184:187], v17 offset:3072
    s_cmp_eq_u32 s42, 49152
    v_mfma_f32_16x16x32_bf16 v[80:83], v[152:155], v[144:147], v[80:83]
    ds_read_b128 v[188:191], v17 offset:5120
    s_cselect_b32 s42, 0, s42
    v_mfma_f32_16x16x32_bf16 v[108:111], v[152:155], v[148:151], v[108:111]
    ds_read_b128 v[192:195], v17 offset:7168
    s_waitcnt lgkmcnt(14)
    v_mfma_f32_16x16x32_bf16 v[112:115], v[156:159], v[148:151], v[112:115]
    ds_read_b64_tr_b16 v[196:197], v18 offset:14336
    s_add_u32 s48, s48, 28672
    v_mfma_f32_16x16x32_bf16 v[84:87], v[156:159], v[144:147], v[84:87]
    ds_read_b64_tr_b16 v[198:199], v18 offset:21504
    s_cmp_eq_u32 s48, 86016
    v_mfma_f32_16x16x32_bf16 v[56:59], v[156:159], v[140:143], v[56:59]
    ds_read_b64_tr_b16 v[200:201], v19 offset:14368
    s_cselect_b32 s48, 0, s48
    v_mfma_f32_16x16x32_bf16 v[28:31], v[156:159], v[136:139], v[28:31]
    ds_read_b64_tr_b16 v[202:203], v19 offset:21536
    s_waitcnt lgkmcnt(8)
    v_mfma_f32_16x16x32_bf16 v[32:35], v[160:163], v[136:139], v[32:35]
    ds_read_b64_tr_b16 v[204:205], v18 offset:14400
    v_add_u32 v17, s42, v12
    v_mfma_f32_16x16x32_bf16 v[60:63], v[160:163], v[140:143], v[60:63]
    ds_read_b64_tr_b16 v[206:207], v18 offset:21568
    v_mfma_f32_16x16x32_bf16 v[88:91], v[160:163], v[144:147], v[88:91]
    ds_read_b64_tr_b16 v[208:209], v19 offset:14432
    v_mfma_f32_16x16x32_bf16 v[116:119], v[160:163], v[148:151], v[116:119]
    ds_read_b64_tr_b16 v[210:211], v19 offset:21600
    v_mfma_f32_16x16x32_bf16 v[120:123], v[164:167], v[148:151], v[120:123]
    ds_read_b64_tr_b16 v[212:213], v18 offset:14464
    v_mfma_f32_16x16x32_bf16 v[92:95], v[164:167], v[144:147], v[92:95]
    ds_read_b64_tr_b16 v[214:215], v18 offset:21632
    v_mfma_f32_16x16x32_bf16 v[64:67], v[164:167], v[140:143], v[64:67]
    ds_read_b64_tr_b16 v[216:217], v19 offset:14496
    v_mfma_f32_16x16x32_bf16 v[36:39], v[164:167], v[136:139], v[36:39]
    ds_read_b64_tr_b16 v[218:219], v19 offset:21664
    v_add_u32 v19, s48, v14
    v_mfma_f32_16x16x32_bf16 v[40:43], v[168:171], v[136:139], v[40:43]
    ds_read_b64_tr_b16 v[220:221], v18 offset:14528
    v_mfma_f32_16x16x32_bf16 v[68:71], v[168:171], v[140:143], v[68:71]
    ds_read_b64_tr_b16 v[222:223], v18 offset:21696
    v_add_u32 v18, s48, v13
    v_mfma_f32_16x16x32_bf16 v[96:99], v[168:171], v[144:147], v[96:99]
    v_mfma_f32_16x16x32_bf16 v[124:127], v[168:171], v[148:151], v[124:127]
    v_mfma_f32_16x16x32_bf16 v[128:131], v[172:175], v[148:151], v[128:131]
    v_mfma_f32_16x16x32_bf16 v[100:103], v[172:175], v[144:147], v[100:103]
    v_mfma_f32_16x16x32_bf16 v[72:75], v[172:175], v[140:143], v[72:75]
    v_mfma_f32_16x16x32_bf16 v[44:47], v[172:175], v[136:139], v[44:47]
    v_mfma_f32_16x16x32_bf16 v[48:51], v[176:179], v[136:139], v[48:51]
    v_mfma_f32_16x16x32_bf16 v[76:79], v[176:179], v[140:143], v[76:79]
    v_mfma_f32_16x16x32_bf16 v[104:107], v[176:179], v[144:147], v[104:107]
    v_mfma_f32_16x16x32_bf16 v[132:135], v[176:179], v[148:151], v[132:135]
    s_waitcnt lgkmcnt(12)
    v_mfma_f32_16x16x32_bf16 v[24:27], v[196:199], v[180:183], v[24:27]
    s_add_u32 s43, s43, 1
    s_cmp_lt_u32 s43, 15
    v_mfma_f32_16x16x32_bf16 v[52:55], v[196:199], v[184:187], v[52:55]
    v_mfma_f32_16x16x32_bf16 v[80:83], v[196:199], v[188:191], v[80:83]
    v_mfma_f32_16x16x32_bf16 v[108:111], v[196:199], v[192:195], v[108:111]
    s_waitcnt lgkmcnt(0)
    s_barrier
    v_mfma_f32_16x16x32_bf16 v[112:115], v[200:203], v[192:195], v[112:115]
    ds_read_b128 v[136:139], v17 offset:0
    v_mfma_f32_16x16x32_bf16 v[84:87], v[200:203], v[188:191], v[84:87]
    ds_read_b128 v[140:143], v17 offset:2048
    v_mfma_f32_16x16x32_bf16 v[56:59], v[200:203], v[184:187], v[56:59]
    ds_read_b128 v[144:147], v17 offset:4096
    v_mfma_f32_16x16x32_bf16 v[28:31], v[200:203], v[180:183], v[28:31]
    ds_read_b128 v[148:151], v17 offset:6144
    v_mfma_f32_16x16x32_bf16 v[32:35], v[204:207], v[180:183], v[32:35]
    ds_read_b64_tr_b16 v[152:153], v18 offset:0
    v_mfma_f32_16x16x32_bf16 v[60:63], v[204:207], v[184:187], v[60:63]
    ds_read_b64_tr_b16 v[154:155], v18 offset:7168
    v_mfma_f32_16x16x32_bf16 v[88:91], v[204:207], v[188:191], v[88:91]
    ds_read_b64_tr_b16 v[156:157], v19 offset:32
    v_mfma_f32_16x16x32_bf16 v[116:119], v[204:207], v[192:195], v[116:119]
    ds_read_b64_tr_b16 v[158:159], v19 offset:7200
    v_mfma_f32_16x16x32_bf16 v[120:123], v[208:211], v[192:195], v[120:123]
    ds_read_b64_tr_b16 v[160:161], v18 offset:64
    v_mfma_f32_16x16x32_bf16 v[92:95], v[208:211], v[188:191], v[92:95]
    ds_read_b64_tr_b16 v[162:163], v18 offset:7232
    v_mfma_f32_16x16x32_bf16 v[64:67], v[208:211], v[184:187], v[64:67]
    ds_read_b64_tr_b16 v[164:165], v19 offset:96
    v_mfma_f32_16x16x32_bf16 v[36:39], v[208:211], v[180:183], v[36:39]
    ds_read_b64_tr_b16 v[166:167], v19 offset:7264
    v_mfma_f32_16x16x32_bf16 v[40:43], v[212:215], v[180:183], v[40:43]
    ds_read_b64_tr_b16 v[168:169], v18 offset:128
    v_mfma_f32_16x16x32_bf16 v[68:71], v[212:215], v[184:187], v[68:71]
    ds_read_b64_tr_b16 v[170:171], v18 offset:7296
    v_mfma_f32_16x16x32_bf16 v[96:99], v[212:215], v[188:191], v[96:99]
    ds_read_b64_tr_b16 v[172:173], v19 offset:160
    v_mfma_f32_16x16x32_bf16 v[124:127], v[212:215], v[192:195], v[124:127]
    ds_read_b64_tr_b16 v[174:175], v19 offset:7328
    v_mfma_f32_16x16x32_bf16 v[128:131], v[216:219], v[192:195], v[128:131]
    ds_read_b64_tr_b16 v[176:177], v18 offset:192
    v_mfma_f32_16x16x32_bf16 v[100:103], v[216:219], v[188:191], v[100:103]
    ds_read_b64_tr_b16 v[178:179], v18 offset:7360
    v_mfma_f32_16x16x32_bf16 v[72:75], v[216:219], v[184:187], v[72:75]
    v_mfma_f32_16x16x32_bf16 v[44:47], v[216:219], v[180:183], v[44:47]
    v_mfma_f32_16x16x32_bf16 v[48:51], v[220:223], v[180:183], v[48:51]
    v_mfma_f32_16x16x32_bf16 v[76:79], v[220:223], v[184:187], v[76:79]
    v_mfma_f32_16x16x32_bf16 v[104:107], v[220:223], v[188:191], v[104:107]
    v_mfma_f32_16x16x32_bf16 v[132:135], v[220:223], v[192:195], v[132:135]
    s_waitcnt lgkmcnt(12)
    s_cbranch_scc1 mm_26
    v_mfma_f32_16x16x32_bf16 v[24:27], v[152:155], v[136:139], v[24:27]
    ds_read_b128 v[180:183], v17 offset:1024
    v_mfma_f32_16x16x32_bf16 v[52:55], v[152:155], v[140:143], v[52:55]
    ds_read_b128 v[184:187], v17 offset:3072
    v_mfma_f32_16x16x32_bf16 v[80:83], v[152:155], v[144:147], v[80:83]
    ds_read_b128 v[188:191], v17 offset:5120
    v_mfma_f32_16x16x32_bf16 v[108:111], v[152:155], v[148:151], v[108:111]
    ds_read_b128 v[192:195], v17 offset:7168
    s_waitcnt lgkmcnt(14)
    v_mfma_f32_16x16x32_bf16 v[112:115], v[156:159], v[148:151], v[112:115]
    ds_read_b64_tr_b16 v[196:197], v18 offset:14336
    v_mfma_f32_16x16x32_bf16 v[84:87], v[156:159], v[144:147], v[84:87]
    ds_read_b64_tr_b16 v[198:199], v18 offset:21504
    v_mfma_f32_16x16x32_bf16 v[56:59], v[156:159], v[140:143], v[56:59]
    ds_read_b64_tr_b16 v[200:201], v19 offset:14368
    v_mfma_f32_16x16x32_bf16 v[28:31], v[156:159], v[136:139], v[28:31]
    ds_read_b64_tr_b16 v[202:203], v19 offset:21536
    s_waitcnt lgkmcnt(8)
    v_mfma_f32_16x16x32_bf16 v[32:35], v[160:163], v[136:139], v[32:35]
    ds_read_b64_tr_b16 v[204:205], v18 offset:14400
    v_mfma_f32_16x16x32_bf16 v[60:63], v[160:163], v[140:143], v[60:63]
    ds_read_b64_tr_b16 v[206:207], v18 offset:21568
    v_mfma_f32_16x16x32_bf16 v[88:91], v[160:163], v[144:147], v[88:91]
    ds_read_b64_tr_b16 v[208:209], v19 offset:14432
    v_mfma_f32_16x16x32_bf16 v[116:119], v[160:163], v[148:151], v[116:119]
    ds_read_b64_tr_b16 v[210:211], v19 offset:21600
    v_mfma_f32_16x16x32_bf16 v[120:123], v[164:167], v[148:151], v[120:123]
    ds_read_b64_tr_b16 v[212:213], v18 offset:14464
    v_mfma_f32_16x16x32_bf16 v[92:95], v[164:167], v[144:147], v[92:95]
    ds_read_b64_tr_b16 v[214:215], v18 offset:21632
    v_mfma_f32_16x16x32_bf16 v[64:67], v[164:167], v[140:143], v[64:67]
    ds_read_b64_tr_b16 v[216:217], v19 offset:14496
    v_mfma_f32_16x16x32_bf16 v[36:39], v[164:167], v[136:139], v[36:39]
    ds_read_b64_tr_b16 v[218:219], v19 offset:21664
    v_mfma_f32_16x16x32_bf16 v[40:43], v[168:171], v[136:139], v[40:43]
    ds_read_b64_tr_b16 v[220:221], v18 offset:14528
    v_mfma_f32_16x16x32_bf16 v[68:71], v[168:171], v[140:143], v[68:71]
    ds_read_b64_tr_b16 v[222:223], v18 offset:21696
    v_mfma_f32_16x16x32_bf16 v[96:99], v[168:171], v[144:147], v[96:99]
    v_mfma_f32_16x16x32_bf16 v[124:127], v[168:171], v[148:151], v[124:127]
    v_mfma_f32_16x16x32_bf16 v[128:131], v[172:175], v[148:151], v[128:131]
    v_mfma_f32_16x16x32_bf16 v[100:103], v[172:175], v[144:147], v[100:103]
    v_mfma_f32_16x16x32_bf16 v[72:75], v[172:175], v[140:143], v[72:75]
    v_mfma_f32_16x16x32_bf16 v[44:47], v[172:175], v[136:139], v[44:47]
    v_mfma_f32_16x16x32_bf16 v[48:51], v[176:179], v[136:139], v[48:51]
    v_mfma_f32_16x16x32_bf16 v[76:79], v[176:179], v[140:143], v[76:79]
    v_mfma_f32_16x16x32_bf16 v[104:107], v[176:179], v[144:147], v[104:107]
    v_mfma_f32_16x16x32_bf16 v[132:135], v[176:179], v[148:151], v[132:135]
    s_waitcnt lgkmcnt(0)
    s_barrier
    v_mfma_f32_16x16x32_bf16 v[24:27], v[196:199], v[180:183], v[24:27]
    ds_read_b128 v[136:139], v6 offset:0
    v_mfma_f32_16x16x32_bf16 v[52:55], v[196:199], v[184:187], v[52:55]
    ds_read_b128 v[140:143], v6 offset:64
    v_mfma_f32_16x16x32_bf16 v[80:83], v[196:199], v[188:191], v[80:83]
    ds_read_b128 v[144:147], v6 offset:128
    v_mfma_f32_16x16x32_bf16 v[108:111], v[196:199], v[192:195], v[108:111]
    ds_read_b128 v[148:151], v6 offset:192
    v_mfma_f32_16x16x32_bf16 v[112:115], v[200:203], v[192:195], v[112:115]
    ds_read_b128 v[152:155], v6 offset:256
    v_mfma_f32_16x16x32_bf16 v[84:87], v[200:203], v[188:191], v[84:87]
    ds_read_b128 v[156:159], v6 offset:320
    v_mfma_f32_16x16x32_bf16 v[56:59], v[200:203], v[184:187], v[56:59]
    ds_read_b128 v[160:163], v6 offset:384
    v_mfma_f32_16x16x32_bf16 v[28:31], v[200:203], v[180:183], v[28:31]
    ds_read_b128 v[164:167], v7 offset:0
    v_mfma_f32_16x16x32_bf16 v[32:35], v[204:207], v[180:183], v[32:35]
    ds_read_b128 v[168:171], v7 offset:256
    v_mfma_f32_16x16x32_bf16 v[60:63], v[204:207], v[184:187], v[60:63]
    ds_read_b128 v[172:175], v7 offset:512
    v_mfma_f32_16x16x32_bf16 v[88:91], v[204:207], v[188:191], v[88:91]
    ds_read_b128 v[176:179], v7 offset:768
    v_mov_b32 v13, v240
    v_mfma_f32_16x16x32_bf16 v[116:119], v[204:207], v[192:195], v[116:119]
    v_add_u32 v18, 0, v240
    v_mov_b32 v14, v241
    v_mfma_f32_16x16x32_bf16 v[120:123], v[208:211], v[192:195], v[120:123]
    v_add_u32 v19, 0, v241
    v_mov_b32 v15, v242
    v_mfma_f32_16x16x32_bf16 v[92:95], v[208:211], v[188:191], v[92:95]
    v_add_u32 v20, 0, v242
    v_mov_b32 v16, v243
    v_mfma_f32_16x16x32_bf16 v[64:67], v[208:211], v[184:187], v[64:67]
    v_add_u32 v21, 0, v243
    s_mov_b32 s42, 0
    s_mov_b32 s43, 0
    v_mfma_f32_16x16x32_bf16 v[36:39], v[208:211], v[180:183], v[36:39]
    s_mov_b32 s48, 0
    v_mov_b32 v17, v12
    v_and_b32 v199, 7, v0
    v_mfma_f32_16x16x32_bf16 v[40:43], v[212:215], v[180:183], v[40:43]
    v_lshrrev_b32 v228, 6, v0
    v_lshlrev_b32 v228, 4, v228
    v_mfma_f32_16x16x32_bf16 v[68:71], v[212:215], v[184:187], v[68:71]
    v_bfe_u32 v229, v0, 3, 3
    v_add_u32 v228, v228, v229
    s_lshr_b32 s78, s29, 1
    v_mfma_f32_16x16x32_bf16 v[96:99], v[212:215], v[188:191], v[96:99]
    s_lshl_b32 s78, s78, 16
    s_and_b32 s79, s29, 1
    s_lshl_b32 s79, s79, 7
    v_mfma_f32_16x16x32_bf16 v[124:127], v[212:215], v[192:195], v[124:127]
    s_add_u32 s78, s78, s79
    s_lshr_b32 s79, s30, 1
    s_lshl_b32 s79, s79, 13
    v_mfma_f32_16x16x32_bf16 v[128:131], v[216:219], v[192:195], v[128:131]
    s_add_u32 s78, s78, s79
    v_lshlrev_b32 v196, 8, v228
    v_lshl_add_u32 v196, v199, 4, v196
    v_mfma_f32_16x16x32_bf16 v[100:103], v[216:219], v[188:191], v[100:103]
    v_add_u32 v196, s78, v196
    v_mfma_f32_16x16x32_bf16 v[72:75], v[216:219], v[184:187], v[72:75]
    v_mfma_f32_16x16x32_bf16 v[44:47], v[216:219], v[180:183], v[44:47]
    v_mfma_f32_16x16x32_bf16 v[48:51], v[220:223], v[180:183], v[48:51]
    v_mfma_f32_16x16x32_bf16 v[76:79], v[220:223], v[184:187], v[76:79]
    v_mfma_f32_16x16x32_bf16 v[104:107], v[220:223], v[188:191], v[104:107]
    v_mfma_f32_16x16x32_bf16 v[132:135], v[220:223], v[192:195], v[132:135]
    s_waitcnt lgkmcnt(0)
    s_cmp_eq_u32 s35, 1
    s_cbranch_scc1 G3_e1
    v_pk_fma_f32 v[24:25], v[164:165], v[136:137], v[24:25] op_sel_hi:[0,1,1] neg_lo:[1,0,0] neg_hi:[1,0,0]
    v_pk_fma_f32 v[26:27], v[164:165], v[138:139], v[26:27] op_sel_hi:[0,1,1] neg_lo:[1,0,0] neg_hi:[1,0,0]
    v_pk_mul_f32 v[226:227], v[24:25], v[24:25]
    v_pk_mul_f32 v[228:229], v[26:27], v[26:27]
    v_pk_fma_f32 v[226:227], v[226:227], v[166:167], v[166:167] op_sel:[0,1,0] op_sel_hi:[1,1,0]
    v_pk_fma_f32 v[228:229], v[228:229], v[166:167], v[166:167] op_sel:[0,1,0] op_sel_hi:[1,1,0]
    v_pk_mul_f32 v[226:227], v[226:227], v[24:25]
    v_pk_mul_f32 v[228:229], v[228:229], v[26:27]
    v_exp_f32 v226, v226
    v_exp_f32 v227, v227
    v_exp_f32 v228, v228
    v_exp_f32 v229, v229
    v_pk_fma_f32 v[226:227], v[226:227], v[164:165], v[164:165] op_sel:[0,1,1] op_sel_hi:[1,1,1]
    v_pk_fma_f32 v[228:229], v[228:229], v[164:165], v[164:165] op_sel:[0,1,1] op_sel_hi:[1,1,1]
    v_rcp_f32 v226, v226
    v_rcp_f32 v227, v227
    v_rcp_f32 v228, v228
    v_rcp_f32 v229, v229
    v_pk_mul_f32 v[24:25], v[24:25], v[226:227]
    v_pk_mul_f32 v[26:27], v[26:27], v[228:229]
    v_pk_fma_f32 v[28:29], v[164:165], v[140:141], v[28:29] op_sel_hi:[0,1,1] neg_lo:[1,0,0] neg_hi:[1,0,0]
    v_pk_fma_f32 v[30:31], v[164:165], v[142:143], v[30:31] op_sel_hi:[0,1,1] neg_lo:[1,0,0] neg_hi:[1,0,0]
    v_pk_mul_f32 v[226:227], v[28:29], v[28:29]
    v_pk_mul_f32 v[228:229], v[30:31], v[30:31]
    v_pk_fma_f32 v[226:227], v[226:227], v[166:167], v[166:167] op_sel:[0,1,0] op_sel_hi:[1,1,0]
    v_pk_fma_f32 v[228:229], v[228:229], v[166:167], v[166:167] op_sel:[0,1,0] op_sel_hi:[1,1,0]
    v_pk_mul_f32 v[226:227], v[226:227], v[28:29]
    v_pk_mul_f32 v[228:229], v[228:229], v[30:31]
    v_exp_f32 v226, v226
    v_exp_f32 v227, v227
    v_exp_f32 v228, v228
    v_exp_f32 v229, v229
    v_pk_fma_f32 v[226:227], v[226:227], v[164:165], v[164:165] op_sel:[0,1,1] op_sel_hi:[1,1,1]
    v_pk_fma_f32 v[228:229], v[228:229], v[164:165], v[164:165] op_sel:[0,1,1] op_sel_hi:[1,1,1]
    v_rcp_f32 v226, v226
    v_rcp_f32 v227, v227
    v_rcp_f32 v228, v228
    v_rcp_f32 v229, v229
    v_pk_mul_f32 v[28:29], v[28:29], v[226:227]
    v_pk_mul_f32 v[30:31], v[30:31], v[228:229]
    v_cvt_pk_bf16_f32 v24, v24, v25
    v_cvt_pk_bf16_f32 v25, v26, v27
    v_cvt_pk_bf16_f32 v26, v28, v29
    v_cvt_pk_bf16_f32 v27, v30, v31
    v_or_b32 v24, 1, v24
    ds_write_b128 v244, v[24:27] offset:0
    s_add_u32 s36, s44, 0
    buffer_store_dwordx4 v[24:27], v2, s[16:19], s36 offen sc1
    v_pk_fma_f32 v[52:53], v[168:169], v[136:137], v[52:53] op_sel_hi:[0,1,1] neg_lo:[1,0,0] neg_hi:[1,0,0]
    v_pk_fma_f32 v[54:55], v[168:169], v[138:139], v[54:55] op_sel_hi:[0,1,1] neg_lo:[1,0,0] neg_hi:[1,0,0]
    v_pk_mul_f32 v[226:227], v[52:53], v[52:53]
    v_pk_mul_f32 v[228:229], v[54:55], v[54:55]
    v_pk_fma_f32 v[226:227], v[226:227], v[170:171], v[170:171] op_sel:[0,1,0] op_sel_hi:[1,1,0]
    v_pk_fma_f32 v[228:229], v[228:229], v[170:171], v[170:171] op_sel:[0,1,0] op_sel_hi:[1,1,0]
    v_pk_mul_f32 v[226:227], v[226:227], v[52:53]
    v_pk_mul_f32 v[228:229], v[228:229], v[54:55]
    v_exp_f32 v226, v226
    v_exp_f32 v227, v227
    v_exp_f32 v228, v228
    v_exp_f32 v229, v229
    v_pk_fma_f32 v[226:227], v[226:227], v[168:169], v[168:169] op_sel:[0,1,1] op_sel_hi:[1,1,1]
    v_pk_fma_f32 v[228:229], v[228:229], v[168:169], v[168:169] op_sel:[0,1,1] op_sel_hi:[1,1,1]
    v_rcp_f32 v226, v226
    v_rcp_f32 v227, v227
    v_rcp_f32 v228, v228
    v_rcp_f32 v229, v229
    v_pk_mul_f32 v[52:53], v[52:53], v[226:227]
    v_pk_mul_f32 v[54:55], v[54:55], v[228:229]
    v_pk_fma_f32 v[56:57], v[168:169], v[140:141], v[56:57] op_sel_hi:[0,1,1] neg_lo:[1,0,0] neg_hi:[1,0,0]
    v_pk_fma_f32 v[58:59], v[168:169], v[142:143], v[58:59] op_sel_hi:[0,1,1] neg_lo:[1,0,0] neg_hi:[1,0,0]
    v_pk_mul_f32 v[226:227], v[56:57], v[56:57]
    v_pk_mul_f32 v[228:229], v[58:59], v[58:59]
    v_pk_fma_f32 v[226:227], v[226:227], v[170:171], v[170:171] op_sel:[0,1,0] op_sel_hi:[1,1,0]
    v_pk_fma_f32 v[228:229], v[228:229], v[170:171], v[170:171] op_sel:[0,1,0] op_sel_hi:[1,1,0]
    v_pk_mul_f32 v[226:227], v[226:227], v[56:57]
    v_pk_mul_f32 v[228:229], v[228:229], v[58:59]
    v_exp_f32 v226, v226
    v_exp_f32 v227, v227
    v_exp_f32 v228, v228
    v_exp_f32 v229, v229
    v_pk_fma_f32 v[226:227], v[226:227], v[168:169], v[168:169] op_sel:[0,1,1] op_sel_hi:[1,1,1]
    v_pk_fma_f32 v[228:229], v[228:229], v[168:169], v[168:169] op_sel:[0,1,1] op_sel_hi:[1,1,1]
    v_rcp_f32 v226, v226
    v_rcp_f32 v227, v227
    v_rcp_f32 v228, v228
    v_rcp_f32 v229, v229
    v_pk_mul_f32 v[56:57], v[56:57], v[226:227]
    v_pk_mul_f32 v[58:59], v[58:59], v[228:229]
    v_cvt_pk_bf16_f32 v52, v52, v53
    v_cvt_pk_bf16_f32 v53, v54, v55
    v_cvt_pk_bf16_f32 v54, v56, v57
    v_cvt_pk_bf16_f32 v55, v58, v59
    v_or_b32 v52, 1, v52
    ds_write_b128 v244, v[52:55] offset:2048
    s_add_u32 s36, s44, 229376
    buffer_store_dwordx4 v[52:55], v2, s[16:19], s36 offen sc1
    v_pk_fma_f32 v[80:81], v[172:173], v[136:137], v[80:81] op_sel_hi:[0,1,1] neg_lo:[1,0,0] neg_hi:[1,0,0]
    v_pk_fma_f32 v[82:83], v[172:173], v[138:139], v[82:83] op_sel_hi:[0,1,1] neg_lo:[1,0,0] neg_hi:[1,0,0]
    v_pk_mul_f32 v[226:227], v[80:81], v[80:81]
    v_pk_mul_f32 v[228:229], v[82:83], v[82:83]
    v_pk_fma_f32 v[226:227], v[226:227], v[174:175], v[174:175] op_sel:[0,1,0] op_sel_hi:[1,1,0]
    v_pk_fma_f32 v[228:229], v[228:229], v[174:175], v[174:175] op_sel:[0,1,0] op_sel_hi:[1,1,0]
    v_pk_mul_f32 v[226:227], v[226:227], v[80:81]
    v_pk_mul_f32 v[228:229], v[228:229], v[82:83]
    v_exp_f32 v226, v226
    v_exp_f32 v227, v227
    v_exp_f32 v228, v228
    v_exp_f32 v229, v229
    v_pk_fma_f32 v[226:227], v[226:227], v[172:173], v[172:173] op_sel:[0,1,1] op_sel_hi:[1,1,1]
    v_pk_fma_f32 v[228:229], v[228:229], v[172:173], v[172:173] op_sel:[0,1,1] op_sel_hi:[1,1,1]
    v_rcp_f32 v226, v226
    v_rcp_f32 v227, v227
    v_rcp_f32 v228, v228
    v_rcp_f32 v229, v229
    v_pk_mul_f32 v[80:81], v[80:81], v[226:227]
    v_pk_mul_f32 v[82:83], v[82:83], v[228:229]
    v_pk_fma_f32 v[84:85], v[172:173], v[140:141], v[84:85] op_sel_hi:[0,1,1] neg_lo:[1,0,0] neg_hi:[1,0,0]
    v_pk_fma_f32 v[86:87], v[172:173], v[142:143], v[86:87] op_sel_hi:[0,1,1] neg_lo:[1,0,0] neg_hi:[1,0,0]
    v_pk_mul_f32 v[226:227], v[84:85], v[84:85]
    v_pk_mul_f32 v[228:229], v[86:87], v[86:87]
    v_pk_fma_f32 v[226:227], v[226:227], v[174:175], v[174:175] op_sel:[0,1,0] op_sel_hi:[1,1,0]
    v_pk_fma_f32 v[228:229], v[228:229], v[174:175], v[174:175] op_sel:[0,1,0] op_sel_hi:[1,1,0]
    v_pk_mul_f32 v[226:227], v[226:227], v[84:85]
    v_pk_mul_f32 v[228:229], v[228:229], v[86:87]
    v_exp_f32 v226, v226
    v_exp_f32 v227, v227
    v_exp_f32 v228, v228
    v_exp_f32 v229, v229
    v_pk_fma_f32 v[226:227], v[226:227], v[172:173], v[172:173] op_sel:[0,1,1] op_sel_hi:[1,1,1]
    v_pk_fma_f32 v[228:229], v[228:229], v[172:173], v[172:173] op_sel:[0,1,1] op_sel_hi:[1,1,1]
    v_rcp_f32 v226, v226
    v_rcp_f32 v227, v227
    v_rcp_f32 v228, v228
    v_rcp_f32 v229, v229
    v_pk_mul_f32 v[84:85], v[84:85], v[226:227]
    v_pk_mul_f32 v[86:87], v[86:87], v[228:229]
    v_cvt_pk_bf16_f32 v80, v80, v81
    v_cvt_pk_bf16_f32 v81, v82, v83
    v_cvt_pk_bf16_f32 v82, v84, v85
    v_cvt_pk_bf16_f32 v83, v86, v87
    v_or_b32 v80, 1, v80
    ds_write_b128 v244, v[80:83] offset:4096
    s_add_u32 s36, s44, 458752
    buffer_store_dwordx4 v[80:83], v2, s[16:19], s36 offen sc1
    v_pk_fma_f32 v[108:109], v[176:177], v[136:137], v[108:109] op_sel_hi:[0,1,1] neg_lo:[1,0,0] neg_hi:[1,0,0]
    v_pk_fma_f32 v[110:111], v[176:177], v[138:139], v[110:111] op_sel_hi:[0,1,1] neg_lo:[1,0,0] neg_hi:[1,0,0]
    v_pk_mul_f32 v[226:227], v[108:109], v[108:109]
    v_pk_mul_f32 v[228:229], v[110:111], v[110:111]
    v_pk_fma_f32 v[226:227], v[226:227], v[178:179], v[178:179] op_sel:[0,1,0] op_sel_hi:[1,1,0]
    v_pk_fma_f32 v[228:229], v[228:229], v[178:179], v[178:179] op_sel:[0,1,0] op_sel_hi:[1,1,0]
    v_pk_mul_f32 v[226:227], v[226:227], v[108:109]
    v_pk_mul_f32 v[228:229], v[228:229], v[110:111]
    v_exp_f32 v226, v226
    v_exp_f32 v227, v227
    v_exp_f32 v228, v228
    v_exp_f32 v229, v229
    v_pk_fma_f32 v[226:227], v[226:227], v[176:177], v[176:177] op_sel:[0,1,1] op_sel_hi:[1,1,1]
    v_pk_fma_f32 v[228:229], v[228:229], v[176:177], v[176:177] op_sel:[0,1,1] op_sel_hi:[1,1,1]
    v_rcp_f32 v226, v226
    v_rcp_f32 v227, v227
    v_rcp_f32 v228, v228
    v_rcp_f32 v229, v229
    v_pk_mul_f32 v[108:109], v[108:109], v[226:227]
    v_pk_mul_f32 v[110:111], v[110:111], v[228:229]
    v_pk_fma_f32 v[112:113], v[176:177], v[140:141], v[112:113] op_sel_hi:[0,1,1] neg_lo:[1,0,0] neg_hi:[1,0,0]
    v_pk_fma_f32 v[114:115], v[176:177], v[142:143], v[114:115] op_sel_hi:[0,1,1] neg_lo:[1,0,0] neg_hi:[1,0,0]
    v_pk_mul_f32 v[226:227], v[112:113], v[112:113]
    v_pk_mul_f32 v[228:229], v[114:115], v[114:115]
    v_pk_fma_f32 v[226:227], v[226:227], v[178:179], v[178:179] op_sel:[0,1,0] op_sel_hi:[1,1,0]
    v_pk_fma_f32 v[228:229], v[228:229], v[178:179], v[178:179] op_sel:[0,1,0] op_sel_hi:[1,1,0]
    v_pk_mul_f32 v[226:227], v[226:227], v[112:113]
    v_pk_mul_f32 v[228:229], v[228:229], v[114:115]
    v_exp_f32 v226, v226
    v_exp_f32 v227, v227
    v_exp_f32 v228, v228
    v_exp_f32 v229, v229
    v_pk_fma_f32 v[226:227], v[226:227], v[176:177], v[176:177] op_sel:[0,1,1] op_sel_hi:[1,1,1]
    v_pk_fma_f32 v[228:229], v[228:229], v[176:177], v[176:177] op_sel:[0,1,1] op_sel_hi:[1,1,1]
    v_rcp_f32 v226, v226
    v_rcp_f32 v227, v227
    v_rcp_f32 v228, v228
    v_rcp_f32 v229, v229
    v_pk_mul_f32 v[112:113], v[112:113], v[226:227]
    v_pk_mul_f32 v[114:115], v[114:115], v[228:229]
    v_cvt_pk_bf16_f32 v108, v108, v109
    v_cvt_pk_bf16_f32 v109, v110, v111
    v_cvt_pk_bf16_f32 v110, v112, v113
    v_cvt_pk_bf16_f32 v111, v114, v115
    ds_write_b128 v244, v[108:111] offset:6144
    s_add_u32 s36, s44, 688128
    buffer_store_dwordx4 v[108:111], v2, s[16:19], s36 offen sc1
    v_pk_fma_f32 v[32:33], v[164:165], v[144:145], v[32:33] op_sel_hi:[0,1,1] neg_lo:[1,0,0] neg_hi:[1,0,0]
    v_pk_fma_f32 v[34:35], v[164:165], v[146:147], v[34:35] op_sel_hi:[0,1,1] neg_lo:[1,0,0] neg_hi:[1,0,0]
    v_pk_mul_f32 v[226:227], v[32:33], v[32:33]
    v_pk_mul_f32 v[228:229], v[34:35], v[34:35]
    v_pk_fma_f32 v[226:227], v[226:227], v[166:167], v[166:167] op_sel:[0,1,0] op_sel_hi:[1,1,0]
    v_pk_fma_f32 v[228:229], v[228:229], v[166:167], v[166:167] op_sel:[0,1,0] op_sel_hi:[1,1,0]
    v_pk_mul_f32 v[226:227], v[226:227], v[32:33]
    v_pk_mul_f32 v[228:229], v[228:229], v[34:35]
    v_exp_f32 v226, v226
    v_exp_f32 v227, v227
    v_exp_f32 v228, v228
    v_exp_f32 v229, v229
    v_pk_fma_f32 v[226:227], v[226:227], v[164:165], v[164:165] op_sel:[0,1,1] op_sel_hi:[1,1,1]
    v_pk_fma_f32 v[228:229], v[228:229], v[164:165], v[164:165] op_sel:[0,1,1] op_sel_hi:[1,1,1]
    v_rcp_f32 v226, v226
    v_rcp_f32 v227, v227
    v_rcp_f32 v228, v228
    v_rcp_f32 v229, v229
    v_pk_mul_f32 v[32:33], v[32:33], v[226:227]
    v_pk_mul_f32 v[34:35], v[34:35], v[228:229]
    v_pk_fma_f32 v[36:37], v[164:165], v[148:149], v[36:37] op_sel_hi:[0,1,1] neg_lo:[1,0,0] neg_hi:[1,0,0]
    v_pk_fma_f32 v[38:39], v[164:165], v[150:151], v[38:39] op_sel_hi:[0,1,1] neg_lo:[1,0,0] neg_hi:[1,0,0]
    v_pk_mul_f32 v[226:227], v[36:37], v[36:37]
    v_pk_mul_f32 v[228:229], v[38:39], v[38:39]
    v_pk_fma_f32 v[226:227], v[226:227], v[166:167], v[166:167] op_sel:[0,1,0] op_sel_hi:[1,1,0]
    v_pk_fma_f32 v[228:229], v[228:229], v[166:167], v[166:167] op_sel:[0,1,0] op_sel_hi:[1,1,0]
    v_pk_mul_f32 v[226:227], v[226:227], v[36:37]
    v_pk_mul_f32 v[228:229], v[228:229], v[38:39]
    v_exp_f32 v226, v226
    v_exp_f32 v227, v227
    v_exp_f32 v228, v228
    v_exp_f32 v229, v229
    v_pk_fma_f32 v[226:227], v[226:227], v[164:165], v[164:165] op_sel:[0,1,1] op_sel_hi:[1,1,1]
    v_pk_fma_f32 v[228:229], v[228:229], v[164:165], v[164:165] op_sel:[0,1,1] op_sel_hi:[1,1,1]
    v_rcp_f32 v226, v226
    v_rcp_f32 v227, v227
    v_rcp_f32 v228, v228
    v_rcp_f32 v229, v229
    v_pk_mul_f32 v[36:37], v[36:37], v[226:227]
    v_pk_mul_f32 v[38:39], v[38:39], v[228:229]
    v_cvt_pk_bf16_f32 v32, v32, v33
    v_cvt_pk_bf16_f32 v33, v34, v35
    v_cvt_pk_bf16_f32 v34, v36, v37
    v_cvt_pk_bf16_f32 v35, v38, v39
    v_or_b32 v32, 1, v32
    ds_write_b128 v244, v[32:35] offset:16384
    v_pk_fma_f32 v[60:61], v[168:169], v[144:145], v[60:61] op_sel_hi:[0,1,1] neg_lo:[1,0,0] neg_hi:[1,0,0]
    v_pk_fma_f32 v[62:63], v[168:169], v[146:147], v[62:63] op_sel_hi:[0,1,1] neg_lo:[1,0,0] neg_hi:[1,0,0]
    v_pk_mul_f32 v[226:227], v[60:61], v[60:61]
    v_pk_mul_f32 v[228:229], v[62:63], v[62:63]
    v_pk_fma_f32 v[226:227], v[226:227], v[170:171], v[170:171] op_sel:[0,1,0] op_sel_hi:[1,1,0]
    v_pk_fma_f32 v[228:229], v[228:229], v[170:171], v[170:171] op_sel:[0,1,0] op_sel_hi:[1,1,0]
    v_pk_mul_f32 v[226:227], v[226:227], v[60:61]
    v_pk_mul_f32 v[228:229], v[228:229], v[62:63]
    v_exp_f32 v226, v226
    v_exp_f32 v227, v227
    v_exp_f32 v228, v228
    v_exp_f32 v229, v229
    v_pk_fma_f32 v[226:227], v[226:227], v[168:169], v[168:169] op_sel:[0,1,1] op_sel_hi:[1,1,1]
    v_pk_fma_f32 v[228:229], v[228:229], v[168:169], v[168:169] op_sel:[0,1,1] op_sel_hi:[1,1,1]
    v_rcp_f32 v226, v226
    v_rcp_f32 v227, v227
    v_rcp_f32 v228, v228
    v_rcp_f32 v229, v229
    v_pk_mul_f32 v[60:61], v[60:61], v[226:227]
    v_pk_mul_f32 v[62:63], v[62:63], v[228:229]
    v_pk_fma_f32 v[64:65], v[168:169], v[148:149], v[64:65] op_sel_hi:[0,1,1] neg_lo:[1,0,0] neg_hi:[1,0,0]
    v_pk_fma_f32 v[66:67], v[168:169], v[150:151], v[66:67] op_sel_hi:[0,1,1] neg_lo:[1,0,0] neg_hi:[1,0,0]
    v_pk_mul_f32 v[226:227], v[64:65], v[64:65]
    v_pk_mul_f32 v[228:229], v[66:67], v[66:67]
    v_pk_fma_f32 v[226:227], v[226:227], v[170:171], v[170:171] op_sel:[0,1,0] op_sel_hi:[1,1,0]
    v_pk_fma_f32 v[228:229], v[228:229], v[170:171], v[170:171] op_sel:[0,1,0] op_sel_hi:[1,1,0]
    v_pk_mul_f32 v[226:227], v[226:227], v[64:65]
    v_pk_mul_f32 v[228:229], v[228:229], v[66:67]
    v_exp_f32 v226, v226
    v_exp_f32 v227, v227
    v_exp_f32 v228, v228
    v_exp_f32 v229, v229
    v_pk_fma_f32 v[226:227], v[226:227], v[168:169], v[168:169] op_sel:[0,1,1] op_sel_hi:[1,1,1]
    v_pk_fma_f32 v[228:229], v[228:229], v[168:169], v[168:169] op_sel:[0,1,1] op_sel_hi:[1,1,1]
    v_rcp_f32 v226, v226
    v_rcp_f32 v227, v227
    v_rcp_f32 v228, v228
    v_rcp_f32 v229, v229
    v_pk_mul_f32 v[64:65], v[64:65], v[226:227]
    v_pk_mul_f32 v[66:67], v[66:67], v[228:229]
    v_cvt_pk_bf16_f32 v60, v60, v61
    v_cvt_pk_bf16_f32 v61, v62, v63
    v_cvt_pk_bf16_f32 v62, v64, v65
    v_cvt_pk_bf16_f32 v63, v66, v67
    v_or_b32 v60, 1, v60
    ds_write_b128 v244, v[60:63] offset:18432
    s_waitcnt vmcnt(0)
    s_mov_b64 exec, 1
    ds_add_u32 v246, v245
    s_mov_b64 exec, -1
    v_pk_fma_f32 v[88:89], v[172:173], v[144:145], v[88:89] op_sel_hi:[0,1,1] neg_lo:[1,0,0] neg_hi:[1,0,0]
    v_pk_fma_f32 v[90:91], v[172:173], v[146:147], v[90:91] op_sel_hi:[0,1,1] neg_lo:[1,0,0] neg_hi:[1,0,0]
    v_pk_mul_f32 v[226:227], v[88:89], v[88:89]
    v_pk_mul_f32 v[228:229], v[90:91], v[90:91]
    v_pk_fma_f32 v[226:227], v[226:227], v[174:175], v[174:175] op_sel:[0,1,0] op_sel_hi:[1,1,0]
    v_pk_fma_f32 v[228:229], v[228:229], v[174:175], v[174:175] op_sel:[0,1,0] op_sel_hi:[1,1,0]
    v_pk_mul_f32 v[226:227], v[226:227], v[88:89]
    v_pk_mul_f32 v[228:229], v[228:229], v[90:91]
    v_exp_f32 v226, v226
    v_exp_f32 v227, v227
    v_exp_f32 v228, v228
    v_exp_f32 v229, v229
    v_pk_fma_f32 v[226:227], v[226:227], v[172:173], v[172:173] op_sel:[0,1,1] op_sel_hi:[1,1,1]
    v_pk_fma_f32 v[228:229], v[228:229], v[172:173], v[172:173] op_sel:[0,1,1] op_sel_hi:[1,1,1]
    v_rcp_f32 v226, v226
    v_rcp_f32 v227, v227
    v_rcp_f32 v228, v228
    v_rcp_f32 v229, v229
    v_pk_mul_f32 v[88:89], v[88:89], v[226:227]
    v_pk_mul_f32 v[90:91], v[90:91], v[228:229]
    v_pk_fma_f32 v[92:93], v[172:173], v[148:149], v[92:93] op_sel_hi:[0,1,1] neg_lo:[1,0,0] neg_hi:[1,0,0]
    v_pk_fma_f32 v[94:95], v[172:173], v[150:151], v[94:95] op_sel_hi:[0,1,1] neg_lo:[1,0,0] neg_hi:[1,0,0]
    v_pk_mul_f32 v[226:227], v[92:93], v[92:93]
    v_pk_mul_f32 v[228:229], v[94:95], v[94:95]
    v_pk_fma_f32 v[226:227], v[226:227], v[174:175], v[174:175] op_sel:[0,1,0] op_sel_hi:[1,1,0]
    v_pk_fma_f32 v[228:229], v[228:229], v[174:175], v[174:175] op_sel:[0,1,0] op_sel_hi:[1,1,0]
    v_pk_mul_f32 v[226:227], v[226:227], v[92:93]
    v_pk_mul_f32 v[228:229], v[228:229], v[94:95]
    v_exp_f32 v226, v226
    v_exp_f32 v227, v227
    v_exp_f32 v228, v228
    v_exp_f32 v229, v229
    v_pk_fma_f32 v[226:227], v[226:227], v[172:173], v[172:173] op_sel:[0,1,1] op_sel_hi:[1,1,1]
    v_pk_fma_f32 v[228:229], v[228:229], v[172:173], v[172:173] op_sel:[0,1,1] op_sel_hi:[1,1,1]
    v_rcp_f32 v226, v226
    v_rcp_f32 v227, v227
    v_rcp_f32 v228, v228
    v_rcp_f32 v229, v229
    v_pk_mul_f32 v[92:93], v[92:93], v[226:227]
    v_pk_mul_f32 v[94:95], v[94:95], v[228:229]
    v_cvt_pk_bf16_f32 v88, v88, v89
    v_cvt_pk_bf16_f32 v89, v90, v91
    v_cvt_pk_bf16_f32 v90, v92, v93
    v_cvt_pk_bf16_f32 v91, v94, v95
    v_or_b32 v88, 1, v88
    ds_write_b128 v244, v[88:91] offset:20480
    s_cmp_eq_u32 s60, 1
    s_cbranch_scc1 G4_p10
    buffer_load_dwordx4 v[180:183], v196, s[84:87], 0 offen offset:0 sc1
    buffer_load_dwordx4 v[188:191], v196, s[88:91], 0 offen offset:0 sc1
    buffer_load_dwordx4 v[184:187], v196, s[84:87], 0 offen offset:2048 sc1
    buffer_load_dwordx4 v[192:195], v196, s[88:91], 0 offen offset:2048 sc1
    s_branch G4_p20
G4_p10:
    s_add_u32 s36, s40, 0
    buffer_load_dwordx4 v[180:183], v2, s[84:87], s36 offen offset:0 sc1
    buffer_load_dwordx4 v[184:187], v2, s[88:91], s36 offen offset:0 sc1
    buffer_load_dwordx4 v[188:191], v2, s[84:87], s36 offen offset:1024 sc1
    buffer_load_dwordx4 v[192:195], v2, s[88:91], s36 offen offset:1024 sc1
    s_add_u32 s36, s40, 65536
    buffer_load_dwordx4 v[196:199], v2, s[84:87], s36 offen offset:0 sc1
    buffer_load_dwordx4 v[230:233], v2, s[88:91], s36 offen offset:0 sc1
    buffer_load_dwordx4 v[234:237], v2, s[84:87], s36 offen offset:1024 sc1
    buffer_load_dwordx4 v[248:251], v2, s[88:91], s36 offen offset:1024 sc1
G4_p20:
    v_pk_fma_f32 v[116:117], v[176:177], v[144:145], v[116:117] op_sel_hi:[0,1,1] neg_lo:[1,0,0] neg_hi:[1,0,0]
    v_pk_fma_f32 v[118:119], v[176:177], v[146:147], v[118:119] op_sel_hi:[0,1,1] neg_lo:[1,0,0] neg_hi:[1,0,0]
    v_pk_mul_f32 v[226:227], v[116:117], v[116:117]
    v_pk_mul_f32 v[228:229], v[118:119], v[118:119]
    v_pk_fma_f32 v[226:227], v[226:227], v[178:179], v[178:179] op_sel:[0,1,0] op_sel_hi:[1,1,0]
    v_pk_fma_f32 v[228:229], v[228:229], v[178:179], v[178:179] op_sel:[0,1,0] op_sel_hi:[1,1,0]
    v_pk_mul_f32 v[226:227], v[226:227], v[116:117]
    v_pk_mul_f32 v[228:229], v[228:229], v[118:119]
    v_exp_f32 v226, v226
    v_exp_f32 v227, v227
    v_exp_f32 v228, v228
    v_exp_f32 v229, v229
    v_pk_fma_f32 v[226:227], v[226:227], v[176:177], v[176:177] op_sel:[0,1,1] op_sel_hi:[1,1,1]
    v_pk_fma_f32 v[228:229], v[228:229], v[176:177], v[176:177] op_sel:[0,1,1] op_sel_hi:[1,1,1]
    v_rcp_f32 v226, v226
    v_rcp_f32 v227, v227
    v_rcp_f32 v228, v228
    v_rcp_f32 v229, v229
    v_pk_mul_f32 v[116:117], v[116:117], v[226:227]
    v_pk_mul_f32 v[118:119], v[118:119], v[228:229]
    v_pk_fma_f32 v[120:121], v[176:177], v[148:149], v[120:121] op_sel_hi:[0,1,1] neg_lo:[1,0,0] neg_hi:[1,0,0]
    v_pk_fma_f32 v[122:123], v[176:177], v[150:151], v[122:123] op_sel_hi:[0,1,1] neg_lo:[1,0,0] neg_hi:[1,0,0]
    v_pk_mul_f32 v[226:227], v[120:121], v[120:121]
    v_pk_mul_f32 v[228:229], v[122:123], v[122:123]
    v_pk_fma_f32 v[226:227], v[226:227], v[178:179], v[178:179] op_sel:[0,1,0] op_sel_hi:[1,1,0]
    v_pk_fma_f32 v[228:229], v[228:229], v[178:179], v[178:179] op_sel:[0,1,0] op_sel_hi:[1,1,0]
    v_pk_mul_f32 v[226:227], v[226:227], v[120:121]
    v_pk_mul_f32 v[228:229], v[228:229], v[122:123]
    v_exp_f32 v226, v226
    v_exp_f32 v227, v227
    v_exp_f32 v228, v228
    v_exp_f32 v229, v229
    v_pk_fma_f32 v[226:227], v[226:227], v[176:177], v[176:177] op_sel:[0,1,1] op_sel_hi:[1,1,1]
    v_pk_fma_f32 v[228:229], v[228:229], v[176:177], v[176:177] op_sel:[0,1,1] op_sel_hi:[1,1,1]
    v_rcp_f32 v226, v226
    v_rcp_f32 v227, v227
    v_rcp_f32 v228, v228
    v_rcp_f32 v229, v229
    v_pk_mul_f32 v[120:121], v[120:121], v[226:227]
    v_pk_mul_f32 v[122:123], v[122:123], v[228:229]
    v_cvt_pk_bf16_f32 v116, v116, v117
    v_cvt_pk_bf16_f32 v117, v118, v119
    v_cvt_pk_bf16_f32 v118, v120, v121
    v_cvt_pk_bf16_f32 v119, v122, v123
    ds_write_b128 v244, v[116:119] offset:22528
    v_pk_fma_f32 v[40:41], v[164:165], v[152:153], v[40:41] op_sel_hi:[0,1,1] neg_lo:[1,0,0] neg_hi:[1,0,0]
    v_pk_fma_f32 v[42:43], v[164:165], v[154:155], v[42:43] op_sel_hi:[0,1,1] neg_lo:[1,0,0] neg_hi:[1,0,0]
    v_pk_mul_f32 v[226:227], v[40:41], v[40:41]
    v_pk_mul_f32 v[228:229], v[42:43], v[42:43]
    v_pk_fma_f32 v[226:227], v[226:227], v[166:167], v[166:167] op_sel:[0,1,0] op_sel_hi:[1,1,0]
    v_pk_fma_f32 v[228:229], v[228:229], v[166:167], v[166:167] op_sel:[0,1,0] op_sel_hi:[1,1,0]
    v_pk_mul_f32 v[226:227], v[226:227], v[40:41]
    v_pk_mul_f32 v[228:229], v[228:229], v[42:43]
    v_exp_f32 v226, v226
    v_exp_f32 v227, v227
    v_exp_f32 v228, v228
    v_exp_f32 v229, v229
    v_pk_fma_f32 v[226:227], v[226:227], v[164:165], v[164:165] op_sel:[0,1,1] op_sel_hi:[1,1,1]
    v_pk_fma_f32 v[228:229], v[228:229], v[164:165], v[164:165] op_sel:[0,1,1] op_sel_hi:[1,1,1]
    v_rcp_f32 v226, v226
    v_rcp_f32 v227, v227
    v_rcp_f32 v228, v228
    v_rcp_f32 v229, v229
    v_pk_mul_f32 v[40:41], v[40:41], v[226:227]
    v_pk_mul_f32 v[42:43], v[42:43], v[228:229]
    v_pk_fma_f32 v[44:45], v[164:165], v[156:157], v[44:45] op_sel_hi:[0,1,1] neg_lo:[1,0,0] neg_hi:[1,0,0]
    v_pk_fma_f32 v[46:47], v[164:165], v[158:159], v[46:47] op_sel_hi:[0,1,1] neg_lo:[1,0,0] neg_hi:[1,0,0]
    v_pk_mul_f32 v[226:227], v[44:45], v[44:45]
    v_pk_mul_f32 v[228:229], v[46:47], v[46:47]
    v_pk_fma_f32 v[226:227], v[226:227], v[166:167], v[166:167] op_sel:[0,1,0] op_sel_hi:[1,1,0]
    v_pk_fma_f32 v[228:229], v[228:229], v[166:167], v[166:167] op_sel:[0,1,0] op_sel_hi:[1,1,0]
    v_pk_mul_f32 v[226:227], v[226:227], v[44:45]
    v_pk_mul_f32 v[228:229], v[228:229], v[46:47]
    v_exp_f32 v226, v226
    v_exp_f32 v227, v227
    v_exp_f32 v228, v228
    v_exp_f32 v229, v229
    v_pk_fma_f32 v[226:227], v[226:227], v[164:165], v[164:165] op_sel:[0,1,1] op_sel_hi:[1,1,1]
    v_pk_fma_f32 v[228:229], v[228:229], v[164:165], v[164:165] op_sel:[0,1,1] op_sel_hi:[1,1,1]
    v_rcp_f32 v226, v226
    v_rcp_f32 v227, v227
    v_rcp_f32 v228, v228
    v_rcp_f32 v229, v229
    v_pk_mul_f32 v[44:45], v[44:45], v[226:227]
    v_pk_mul_f32 v[46:47], v[46:47], v[228:229]
    v_cvt_pk_bf16_f32 v200, v40, v41
    v_cvt_pk_bf16_f32 v201, v42, v43
    v_cvt_pk_bf16_f32 v202, v44, v45
    v_cvt_pk_bf16_f32 v203, v46, v47
    v_or_b32 v200, 1, v200
    ds_write_b128 v244, v[200:203] offset:32768
    v_pk_fma_f32 v[68:69], v[168:169], v[152:153], v[68:69] op_sel_hi:[0,1,1] neg_lo:[1,0,0] neg_hi:[1,0,0]
    v_pk_fma_f32 v[70:71], v[168:169], v[154:155], v[70:71] op_sel_hi:[0,1,1] neg_lo:[1,0,0] neg_hi:[1,0,0]
    v_pk_mul_f32 v[226:227], v[68:69], v[68:69]
    v_pk_mul_f32 v[228:229], v[70:71], v[70:71]
    v_pk_fma_f32 v[226:227], v[226:227], v[170:171], v[170:171] op_sel:[0,1,0] op_sel_hi:[1,1,0]
    v_pk_fma_f32 v[228:229], v[228:229], v[170:171], v[170:171] op_sel:[0,1,0] op_sel_hi:[1,1,0]
    v_pk_mul_f32 v[226:227], v[226:227], v[68:69]
    v_pk_mul_f32 v[228:229], v[228:229], v[70:71]
    v_exp_f32 v226, v226
    v_exp_f32 v227, v227
    v_exp_f32 v228, v228
    v_exp_f32 v229, v229
    v_pk_fma_f32 v[226:227], v[226:227], v[168:169], v[168:169] op_sel:[0,1,1] op_sel_hi:[1,1,1]
    v_pk_fma_f32 v[228:229], v[228:229], v[168:169], v[168:169] op_sel:[0,1,1] op_sel_hi:[1,1,1]
    v_rcp_f32 v226, v226
    v_rcp_f32 v227, v227
    v_rcp_f32 v228, v228
    v_rcp_f32 v229, v229
    v_pk_mul_f32 v[68:69], v[68:69], v[226:227]
    v_pk_mul_f32 v[70:71], v[70:71], v[228:229]
    v_pk_fma_f32 v[72:73], v[168:169], v[156:157], v[72:73] op_sel_hi:[0,1,1] neg_lo:[1,0,0] neg_hi:[1,0,0]
    v_pk_fma_f32 v[74:75], v[168:169], v[158:159], v[74:75] op_sel_hi:[0,1,1] neg_lo:[1,0,0] neg_hi:[1,0,0]
    v_pk_mul_f32 v[226:227], v[72:73], v[72:73]
    v_pk_mul_f32 v[228:229], v[74:75], v[74:75]
    v_pk_fma_f32 v[226:227], v[226:227], v[170:171], v[170:171] op_sel:[0,1,0] op_sel_hi:[1,1,0]
    v_pk_fma_f32 v[228:229], v[228:229], v[170:171], v[170:171] op_sel:[0,1,0] op_sel_hi:[1,1,0]
    v_pk_mul_f32 v[226:227], v[226:227], v[72:73]
    v_pk_mul_f32 v[228:229], v[228:229], v[74:75]
    v_exp_f32 v226, v226
    v_exp_f32 v227, v227
    v_exp_f32 v228, v228
    v_exp_f32 v229, v229
    v_pk_fma_f32 v[226:227], v[226:227], v[168:169], v[168:169] op_sel:[0,1,1] op_sel_hi:[1,1,1]
    v_pk_fma_f32 v[228:229], v[228:229], v[168:169], v[168:169] op_sel:[0,1,1] op_sel_hi:[1,1,1]
    v_rcp_f32 v226, v226
    v_rcp_f32 v227, v227
    v_rcp_f32 v228, v228
    v_rcp_f32 v229, v229
    v_pk_mul_f32 v[72:73], v[72:73], v[226:227]
    v_pk_mul_f32 v[74:75], v[74:75], v[228:229]
    v_cvt_pk_bf16_f32 v204, v68, v69
    v_cvt_pk_bf16_f32 v205, v70, v71
    v_cvt_pk_bf16_f32 v206, v72, v73
    v_cvt_pk_bf16_f32 v207, v74, v75
    v_or_b32 v204, 1, v204
    ds_write_b128 v244, v[204:207] offset:34816
    v_pk_fma_f32 v[96:97], v[172:173], v[152:153], v[96:97] op_sel_hi:[0,1,1] neg_lo:[1,0,0] neg_hi:[1,0,0]
    v_pk_fma_f32 v[98:99], v[172:173], v[154:155], v[98:99] op_sel_hi:[0,1,1] neg_lo:[1,0,0] neg_hi:[1,0,0]
    v_pk_mul_f32 v[226:227], v[96:97], v[96:97]
    v_pk_mul_f32 v[228:229], v[98:99], v[98:99]
    v_pk_fma_f32 v[226:227], v[226:227], v[174:175], v[174:175] op_sel:[0,1,0] op_sel_hi:[1,1,0]
    v_pk_fma_f32 v[228:229], v[228:229], v[174:175], v[174:175] op_sel:[0,1,0] op_sel_hi:[1,1,0]
    v_pk_mul_f32 v[226:227], v[226:227], v[96:97]
    v_pk_mul_f32 v[228:229], v[228:229], v[98:99]
    v_exp_f32 v226, v226
    v_exp_f32 v227, v227
    v_exp_f32 v228, v228
    v_exp_f32 v229, v229
    v_pk_fma_f32 v[226:227], v[226:227], v[172:173], v[172:173] op_sel:[0,1,1] op_sel_hi:[1,1,1]
    v_pk_fma_f32 v[228:229], v[228:229], v[172:173], v[172:173] op_sel:[0,1,1] op_sel_hi:[1,1,1]
    v_rcp_f32 v226, v226
    v_rcp_f32 v227, v227
    v_rcp_f32 v228, v228
    v_rcp_f32 v229, v229
    v_pk_mul_f32 v[96:97], v[96:97], v[226:227]
    v_pk_mul_f32 v[98:99], v[98:99], v[228:229]
    v_pk_fma_f32 v[100:101], v[172:173], v[156:157], v[100:101] op_sel_hi:[0,1,1] neg_lo:[1,0,0] neg_hi:[1,0,0]
    v_pk_fma_f32 v[102:103], v[172:173], v[158:159], v[102:103] op_sel_hi:[0,1,1] neg_lo:[1,0,0] neg_hi:[1,0,0]
    v_pk_mul_f32 v[226:227], v[100:101], v[100:101]
    v_pk_mul_f32 v[228:229], v[102:103], v[102:103]
    v_pk_fma_f32 v[226:227], v[226:227], v[174:175], v[174:175] op_sel:[0,1,0] op_sel_hi:[1,1,0]
    v_pk_fma_f32 v[228:229], v[228:229], v[174:175], v[174:175] op_sel:[0,1,0] op_sel_hi:[1,1,0]
    v_pk_mul_f32 v[226:227], v[226:227], v[100:101]
    v_pk_mul_f32 v[228:229], v[228:229], v[102:103]
    v_exp_f32 v226, v226
    v_exp_f32 v227, v227
    v_exp_f32 v228, v228
    v_exp_f32 v229, v229
    v_pk_fma_f32 v[226:227], v[226:227], v[172:173], v[172:173] op_sel:[0,1,1] op_sel_hi:[1,1,1]
    v_pk_fma_f32 v[228:229], v[228:229], v[172:173], v[172:173] op_sel:[0,1,1] op_sel_hi:[1,1,1]
    v_rcp_f32 v226, v226
    v_rcp_f32 v227, v227
    v_rcp_f32 v228, v228
    v_rcp_f32 v229, v229
    v_pk_mul_f32 v[100:101], v[100:101], v[226:227]
    v_pk_mul_f32 v[102:103], v[102:103], v[228:229]
    v_cvt_pk_bf16_f32 v208, v96, v97
    v_cvt_pk_bf16_f32 v209, v98, v99
    v_cvt_pk_bf16_f32 v210, v100, v101
    v_cvt_pk_bf16_f32 v211, v102, v103
    v_or_b32 v208, 1, v208
    ds_write_b128 v244, v[208:211] offset:36864
    v_pk_fma_f32 v[124:125], v[176:177], v[152:153], v[124:125] op_sel_hi:[0,1,1] neg_lo:[1,0,0] neg_hi:[1,0,0]
    v_pk_fma_f32 v[126:127], v[176:177], v[154:155], v[126:127] op_sel_hi:[0,1,1] neg_lo:[1,0,0] neg_hi:[1,0,0]
    v_pk_mul_f32 v[226:227], v[124:125], v[124:125]
    v_pk_mul_f32 v[228:229], v[126:127], v[126:127]
    v_pk_fma_f32 v[226:227], v[226:227], v[178:179], v[178:179] op_sel:[0,1,0] op_sel_hi:[1,1,0]
    v_pk_fma_f32 v[228:229], v[228:229], v[178:179], v[178:179] op_sel:[0,1,0] op_sel_hi:[1,1,0]
    v_pk_mul_f32 v[226:227], v[226:227], v[124:125]
    v_pk_mul_f32 v[228:229], v[228:229], v[126:127]
    v_exp_f32 v226, v226
    v_exp_f32 v227, v227
    v_exp_f32 v228, v228
    v_exp_f32 v229, v229
    v_pk_fma_f32 v[226:227], v[226:227], v[176:177], v[176:177] op_sel:[0,1,1] op_sel_hi:[1,1,1]
    v_pk_fma_f32 v[228:229], v[228:229], v[176:177], v[176:177] op_sel:[0,1,1] op_sel_hi:[1,1,1]
    v_rcp_f32 v226, v226
    v_rcp_f32 v227, v227
    v_rcp_f32 v228, v228
    v_rcp_f32 v229, v229
    v_pk_mul_f32 v[124:125], v[124:125], v[226:227]
    v_pk_mul_f32 v[126:127], v[126:127], v[228:229]
    v_pk_fma_f32 v[128:129], v[176:177], v[156:157], v[128:129] op_sel_hi:[0,1,1] neg_lo:[1,0,0] neg_hi:[1,0,0]
    v_pk_fma_f32 v[130:131], v[176:177], v[158:159], v[130:131] op_sel_hi:[0,1,1] neg_lo:[1,0,0] neg_hi:[1,0,0]
    v_pk_mul_f32 v[226:227], v[128:129], v[128:129]
    v_pk_mul_f32 v[228:229], v[130:131], v[130:131]
    v_pk_fma_f32 v[226:227], v[226:227], v[178:179], v[178:179] op_sel:[0,1,0] op_sel_hi:[1,1,0]
    v_pk_fma_f32 v[228:229], v[228:229], v[178:179], v[178:179] op_sel:[0,1,0] op_sel_hi:[1,1,0]
    v_pk_mul_f32 v[226:227], v[226:227], v[128:129]
    v_pk_mul_f32 v[228:229], v[228:229], v[130:131]
    v_exp_f32 v226, v226
    v_exp_f32 v227, v227
    v_exp_f32 v228, v228
    v_exp_f32 v229, v229
    v_pk_fma_f32 v[226:227], v[226:227], v[176:177], v[176:177] op_sel:[0,1,1] op_sel_hi:[1,1,1]
    v_pk_fma_f32 v[228:229], v[228:229], v[176:177], v[176:177] op_sel:[0,1,1] op_sel_hi:[1,1,1]
    v_rcp_f32 v226, v226
    v_rcp_f32 v227, v227
    v_rcp_f32 v228, v228
    v_rcp_f32 v229, v229
    v_pk_mul_f32 v[128:129], v[128:129], v[226:227]
    v_pk_mul_f32 v[130:131], v[130:131], v[228:229]
    v_cvt_pk_bf16_f32 v212, v124, v125
    v_cvt_pk_bf16_f32 v213, v126, v127
    v_cvt_pk_bf16_f32 v214, v128, v129
    v_cvt_pk_bf16_f32 v215, v130, v131
    ds_write_b128 v244, v[212:215] offset:38912
    v_pk_fma_f32 v[48:49], v[164:165], v[160:161], v[48:49] op_sel_hi:[0,1,1] neg_lo:[1,0,0] neg_hi:[1,0,0]
    v_pk_fma_f32 v[50:51], v[164:165], v[162:163], v[50:51] op_sel_hi:[0,1,1] neg_lo:[1,0,0] neg_hi:[1,0,0]
    v_pk_mul_f32 v[226:227], v[48:49], v[48:49]
    v_pk_mul_f32 v[228:229], v[50:51], v[50:51]
    v_pk_fma_f32 v[226:227], v[226:227], v[166:167], v[166:167] op_sel:[0,1,0] op_sel_hi:[1,1,0]
    v_pk_fma_f32 v[228:229], v[228:229], v[166:167], v[166:167] op_sel:[0,1,0] op_sel_hi:[1,1,0]
    v_pk_mul_f32 v[226:227], v[226:227], v[48:49]
    v_pk_mul_f32 v[228:229], v[228:229], v[50:51]
    v_exp_f32 v226, v226
    v_exp_f32 v227, v227
    v_exp_f32 v228, v228
    v_exp_f32 v229, v229
    v_pk_fma_f32 v[226:227], v[226:227], v[164:165], v[164:165] op_sel:[0,1,1] op_sel_hi:[1,1,1]
    v_pk_fma_f32 v[228:229], v[228:229], v[164:165], v[164:165] op_sel:[0,1,1] op_sel_hi:[1,1,1]
    v_rcp_f32 v226, v226
    v_rcp_f32 v227, v227
    v_rcp_f32 v228, v228
    v_rcp_f32 v229, v229
    v_pk_mul_f32 v[48:49], v[48:49], v[226:227]
    v_pk_mul_f32 v[50:51], v[50:51], v[228:229]
    v_cvt_pk_bf16_f32 v216, v48, v49
    v_cvt_pk_bf16_f32 v217, v50, v51
    v_or_b32 v216, 1, v216
    s_add_u32 s36, s45, 0
    buffer_store_dwordx4 v[32:35], v2, s[16:19], s36 offen sc1
    v_pk_fma_f32 v[76:77], v[168:169], v[160:161], v[76:77] op_sel_hi:[0,1,1] neg_lo:[1,0,0] neg_hi:[1,0,0]
    v_pk_fma_f32 v[78:79], v[168:169], v[162:163], v[78:79] op_sel_hi:[0,1,1] neg_lo:[1,0,0] neg_hi:[1,0,0]
    v_pk_mul_f32 v[226:227], v[76:77], v[76:77]
    v_pk_mul_f32 v[228:229], v[78:79], v[78:79]
    v_pk_fma_f32 v[226:227], v[226:227], v[170:171], v[170:171] op_sel:[0,1,0] op_sel_hi:[1,1,0]
    v_pk_fma_f32 v[228:229], v[228:229], v[170:171], v[170:171] op_sel:[0,1,0] op_sel_hi:[1,1,0]
    v_pk_mul_f32 v[226:227], v[226:227], v[76:77]
    v_pk_mul_f32 v[228:229], v[228:229], v[78:79]
    v_exp_f32 v226, v226
    v_exp_f32 v227, v227
    v_exp_f32 v228, v228
    v_exp_f32 v229, v229
    v_pk_fma_f32 v[226:227], v[226:227], v[168:169], v[168:169] op_sel:[0,1,1] op_sel_hi:[1,1,1]
    v_pk_fma_f32 v[228:229], v[228:229], v[168:169], v[168:169] op_sel:[0,1,1] op_sel_hi:[1,1,1]
    v_rcp_f32 v226, v226
    v_rcp_f32 v227, v227
    v_rcp_f32 v228, v228
    v_rcp_f32 v229, v229
    v_pk_mul_f32 v[76:77], v[76:77], v[226:227]
    v_pk_mul_f32 v[78:79], v[78:79], v[228:229]
    v_cvt_pk_bf16_f32 v218, v76, v77
    v_cvt_pk_bf16_f32 v219, v78, v79
    v_or_b32 v218, 1, v218
    s_add_u32 s36, s45, 229376
    buffer_store_dwordx4 v[60:63], v2, s[16:19], s36 offen sc1
    v_pk_fma_f32 v[104:105], v[172:173], v[160:161], v[104:105] op_sel_hi:[0,1,1] neg_lo:[1,0,0] neg_hi:[1,0,0]
    v_pk_fma_f32 v[106:107], v[172:173], v[162:163], v[106:107] op_sel_hi:[0,1,1] neg_lo:[1,0,0] neg_hi:[1,0,0]
    v_pk_mul_f32 v[226:227], v[104:105], v[104:105]
    v_pk_mul_f32 v[228:229], v[106:107], v[106:107]
    v_pk_fma_f32 v[226:227], v[226:227], v[174:175], v[174:175] op_sel:[0,1,0] op_sel_hi:[1,1,0]
    v_pk_fma_f32 v[228:229], v[228:229], v[174:175], v[174:175] op_sel:[0,1,0] op_sel_hi:[1,1,0]
    v_pk_mul_f32 v[226:227], v[226:227], v[104:105]
    v_pk_mul_f32 v[228:229], v[228:229], v[106:107]
    v_exp_f32 v226, v226
    v_exp_f32 v227, v227
    v_exp_f32 v228, v228
    v_exp_f32 v229, v229
    v_pk_fma_f32 v[226:227], v[226:227], v[172:173], v[172:173] op_sel:[0,1,1] op_sel_hi:[1,1,1]
    v_pk_fma_f32 v[228:229], v[228:229], v[172:173], v[172:173] op_sel:[0,1,1] op_sel_hi:[1,1,1]
    v_rcp_f32 v226, v226
    v_rcp_f32 v227, v227
    v_rcp_f32 v228, v228
    v_rcp_f32 v229, v229
    v_pk_mul_f32 v[104:105], v[104:105], v[226:227]
    v_pk_mul_f32 v[106:107], v[106:107], v[228:229]
    v_cvt_pk_bf16_f32 v220, v104, v105
    v_cvt_pk_bf16_f32 v221, v106, v107
    v_or_b32 v220, 1, v220
    s_add_u32 s36, s45, 458752
    buffer_store_dwordx4 v[88:91], v2, s[16:19], s36 offen sc1
    v_pk_fma_f32 v[132:133], v[176:177], v[160:161], v[132:133] op_sel_hi:[0,1,1] neg_lo:[1,0,0] neg_hi:[1,0,0]
    v_pk_fma_f32 v[134:135], v[176:177], v[162:163], v[134:135] op_sel_hi:[0,1,1] neg_lo:[1,0,0] neg_hi:[1,0,0]
    v_pk_mul_f32 v[226:227], v[132:133], v[132:133]
    v_pk_mul_f32 v[228:229], v[134:135], v[134:135]
    v_pk_fma_f32 v[226:227], v[226:227], v[178:179], v[178:179] op_sel:[0,1,0] op_sel_hi:[1,1,0]
    v_pk_fma_f32 v[228:229], v[228:229], v[178:179], v[178:179] op_sel:[0,1,0] op_sel_hi:[1,1,0]
    v_pk_mul_f32 v[226:227], v[226:227], v[132:133]
    v_pk_mul_f32 v[228:229], v[228:229], v[134:135]
    v_exp_f32 v226, v226
    v_exp_f32 v227, v227
    v_exp_f32 v228, v228
    v_exp_f32 v229, v229
    v_pk_fma_f32 v[226:227], v[226:227], v[176:177], v[176:177] op_sel:[0,1,1] op_sel_hi:[1,1,1]
    v_pk_fma_f32 v[228:229], v[228:229], v[176:177], v[176:177] op_sel:[0,1,1] op_sel_hi:[1,1,1]
    v_rcp_f32 v226, v226
    v_rcp_f32 v227, v227
    v_rcp_f32 v228, v228
    v_rcp_f32 v229, v229
    v_pk_mul_f32 v[132:133], v[132:133], v[226:227]
    v_pk_mul_f32 v[134:135], v[134:135], v[228:229]
    v_cvt_pk_bf16_f32 v222, v132, v133
    v_cvt_pk_bf16_f32 v223, v134, v135
    s_add_u32 s36, s45, 688128
    buffer_store_dwordx4 v[116:119], v2, s[16:19], s36 offen sc1
    s_waitcnt lgkmcnt(0)
    s_mov_b32 s44, s46
    s_mov_b32 s45, s47
    s_branch G3_e2
G3_e1:
    v_pk_fma_f32 v[28:29], v[164:165], v[140:141], v[28:29] op_sel_hi:[0,1,1] neg_lo:[1,0,0] neg_hi:[1,0,0]
    v_pk_fma_f32 v[30:31], v[164:165], v[142:143], v[30:31] op_sel_hi:[0,1,1] neg_lo:[1,0,0] neg_hi:[1,0,0]
    v_pk_mul_f32 v[226:227], v[28:29], v[28:29]
    v_pk_mul_f32 v[228:229], v[30:31], v[30:31]
    v_pk_fma_f32 v[226:227], v[226:227], v[166:167], v[166:167] op_sel:[0,1,0] op_sel_hi:[1,1,0]
    v_pk_fma_f32 v[228:229], v[228:229], v[166:167], v[166:167] op_sel:[0,1,0] op_sel_hi:[1,1,0]
    v_pk_mul_f32 v[226:227], v[226:227], v[28:29]
    v_pk_mul_f32 v[228:229], v[228:229], v[30:31]
    v_exp_f32 v226, v226
    v_exp_f32 v227, v227
    v_exp_f32 v228, v228
    v_exp_f32 v229, v229
    v_pk_fma_f32 v[226:227], v[226:227], v[164:165], v[164:165] op_sel:[0,1,1] op_sel_hi:[1,1,1]
    v_pk_fma_f32 v[228:229], v[228:229], v[164:165], v[164:165] op_sel:[0,1,1] op_sel_hi:[1,1,1]
    v_rcp_f32 v226, v226
    v_rcp_f32 v227, v227
    v_rcp_f32 v228, v228
    v_rcp_f32 v229, v229
    v_pk_mul_f32 v[28:29], v[28:29], v[226:227]
    v_pk_mul_f32 v[30:31], v[30:31], v[228:229]
    v_pk_fma_f32 v[32:33], v[164:165], v[144:145], v[32:33] op_sel_hi:[0,1,1] neg_lo:[1,0,0] neg_hi:[1,0,0]
    v_pk_fma_f32 v[34:35], v[164:165], v[146:147], v[34:35] op_sel_hi:[0,1,1] neg_lo:[1,0,0] neg_hi:[1,0,0]
    v_pk_mul_f32 v[226:227], v[32:33], v[32:33]
    v_pk_mul_f32 v[228:229], v[34:35], v[34:35]
    v_pk_fma_f32 v[226:227], v[226:227], v[166:167], v[166:167] op_sel:[0,1,0] op_sel_hi:[1,1,0]
    v_pk_fma_f32 v[228:229], v[228:229], v[166:167], v[166:167] op_sel:[0,1,0] op_sel_hi:[1,1,0]
    v_pk_mul_f32 v[226:227], v[226:227], v[32:33]
    v_pk_mul_f32 v[228:229], v[228:229], v[34:35]
    v_exp_f32 v226, v226
    v_exp_f32 v227, v227
    v_exp_f32 v228, v228
    v_exp_f32 v229, v229
    v_pk_fma_f32 v[226:227], v[226:227], v[164:165], v[164:165] op_sel:[0,1,1] op_sel_hi:[1,1,1]
    v_pk_fma_f32 v[228:229], v[228:229], v[164:165], v[164:165] op_sel:[0,1,1] op_sel_hi:[1,1,1]
    v_rcp_f32 v226, v226
    v_rcp_f32 v227, v227
    v_rcp_f32 v228, v228
    v_rcp_f32 v229, v229
    v_pk_mul_f32 v[32:33], v[32:33], v[226:227]
    v_pk_mul_f32 v[34:35], v[34:35], v[228:229]
    v_cvt_pk_bf16_f32 v28, v28, v29
    v_cvt_pk_bf16_f32 v29, v30, v31
    v_cvt_pk_bf16_f32 v30, v32, v33
    v_cvt_pk_bf16_f32 v31, v34, v35
    v_or_b32 v28, 1, v28
    ds_write_b128 v244, v[28:31] offset:0
    s_add_u32 s36, s45, 0
    buffer_store_dwordx4 v[28:31], v2, s[16:19], s36 offen sc1
    v_pk_fma_f32 v[56:57], v[168:169], v[140:141], v[56:57] op_sel_hi:[0,1,1] neg_lo:[1,0,0] neg_hi:[1,0,0]
    v_pk_fma_f32 v[58:59], v[168:169], v[142:143], v[58:59] op_sel_hi:[0,1,1] neg_lo:[1,0,0] neg_hi:[1,0,0]
    v_pk_mul_f32 v[226:227], v[56:57], v[56:57]
    v_pk_mul_f32 v[228:229], v[58:59], v[58:59]
    v_pk_fma_f32 v[226:227], v[226:227], v[170:171], v[170:171] op_sel:[0,1,0] op_sel_hi:[1,1,0]
    v_pk_fma_f32 v[228:229], v[228:229], v[170:171], v[170:171] op_sel:[0,1,0] op_sel_hi:[1,1,0]
    v_pk_mul_f32 v[226:227], v[226:227], v[56:57]
    v_pk_mul_f32 v[228:229], v[228:229], v[58:59]
    v_exp_f32 v226, v226
    v_exp_f32 v227, v227
    v_exp_f32 v228, v228
    v_exp_f32 v229, v229
    v_pk_fma_f32 v[226:227], v[226:227], v[168:169], v[168:169] op_sel:[0,1,1] op_sel_hi:[1,1,1]
    v_pk_fma_f32 v[228:229], v[228:229], v[168:169], v[168:169] op_sel:[0,1,1] op_sel_hi:[1,1,1]
    v_rcp_f32 v226, v226
    v_rcp_f32 v227, v227
    v_rcp_f32 v228, v228
    v_rcp_f32 v229, v229
    v_pk_mul_f32 v[56:57], v[56:57], v[226:227]
    v_pk_mul_f32 v[58:59], v[58:59], v[228:229]
    v_pk_fma_f32 v[60:61], v[168:169], v[144:145], v[60:61] op_sel_hi:[0,1,1] neg_lo:[1,0,0] neg_hi:[1,0,0]
    v_pk_fma_f32 v[62:63], v[168:169], v[146:147], v[62:63] op_sel_hi:[0,1,1] neg_lo:[1,0,0] neg_hi:[1,0,0]
    v_pk_mul_f32 v[226:227], v[60:61], v[60:61]
    v_pk_mul_f32 v[228:229], v[62:63], v[62:63]
    v_pk_fma_f32 v[226:227], v[226:227], v[170:171], v[170:171] op_sel:[0,1,0] op_sel_hi:[1,1,0]
    v_pk_fma_f32 v[228:229], v[228:229], v[170:171], v[170:171] op_sel:[0,1,0] op_sel_hi:[1,1,0]
    v_pk_mul_f32 v[226:227], v[226:227], v[60:61]
    v_pk_mul_f32 v[228:229], v[228:229], v[62:63]
    v_exp_f32 v226, v226
    v_exp_f32 v227, v227
    v_exp_f32 v228, v228
    v_exp_f32 v229, v229
    v_pk_fma_f32 v[226:227], v[226:227], v[168:169], v[168:169] op_sel:[0,1,1] op_sel_hi:[1,1,1]
    v_pk_fma_f32 v[228:229], v[228:229], v[168:169], v[168:169] op_sel:[0,1,1] op_sel_hi:[1,1,1]
    v_rcp_f32 v226, v226
    v_rcp_f32 v227, v227
    v_rcp_f32 v228, v228
    v_rcp_f32 v229, v229
    v_pk_mul_f32 v[60:61], v[60:61], v[226:227]
    v_pk_mul_f32 v[62:63], v[62:63], v[228:229]
    v_cvt_pk_bf16_f32 v56, v56, v57
    v_cvt_pk_bf16_f32 v57, v58, v59
    v_cvt_pk_bf16_f32 v58, v60, v61
    v_cvt_pk_bf16_f32 v59, v62, v63
    v_or_b32 v56, 1, v56
    ds_write_b128 v244, v[56:59] offset:2048
    s_add_u32 s36, s45, 229376
    buffer_store_dwordx4 v[56:59], v2, s[16:19], s36 offen sc1
    v_pk_fma_f32 v[84:85], v[172:173], v[140:141], v[84:85] op_sel_hi:[0,1,1] neg_lo:[1,0,0] neg_hi:[1,0,0]
    v_pk_fma_f32 v[86:87], v[172:173], v[142:143], v[86:87] op_sel_hi:[0,1,1] neg_lo:[1,0,0] neg_hi:[1,0,0]
    v_pk_mul_f32 v[226:227], v[84:85], v[84:85]
    v_pk_mul_f32 v[228:229], v[86:87], v[86:87]
    v_pk_fma_f32 v[226:227], v[226:227], v[174:175], v[174:175] op_sel:[0,1,0] op_sel_hi:[1,1,0]
    v_pk_fma_f32 v[228:229], v[228:229], v[174:175], v[174:175] op_sel:[0,1,0] op_sel_hi:[1,1,0]
    v_pk_mul_f32 v[226:227], v[226:227], v[84:85]
    v_pk_mul_f32 v[228:229], v[228:229], v[86:87]
    v_exp_f32 v226, v226
    v_exp_f32 v227, v227
    v_exp_f32 v228, v228
    v_exp_f32 v229, v229
    v_pk_fma_f32 v[226:227], v[226:227], v[172:173], v[172:173] op_sel:[0,1,1] op_sel_hi:[1,1,1]
    v_pk_fma_f32 v[228:229], v[228:229], v[172:173], v[172:173] op_sel:[0,1,1] op_sel_hi:[1,1,1]
    v_rcp_f32 v226, v226
    v_rcp_f32 v227, v227
    v_rcp_f32 v228, v228
    v_rcp_f32 v229, v229
    v_pk_mul_f32 v[84:85], v[84:85], v[226:227]
    v_pk_mul_f32 v[86:87], v[86:87], v[228:229]
    v_pk_fma_f32 v[88:89], v[172:173], v[144:145], v[88:89] op_sel_hi:[0,1,1] neg_lo:[1,0,0] neg_hi:[1,0,0]
    v_pk_fma_f32 v[90:91], v[172:173], v[146:147], v[90:91] op_sel_hi:[0,1,1] neg_lo:[1,0,0] neg_hi:[1,0,0]
    v_pk_mul_f32 v[226:227], v[88:89], v[88:89]
    v_pk_mul_f32 v[228:229], v[90:91], v[90:91]
    v_pk_fma_f32 v[226:227], v[226:227], v[174:175], v[174:175] op_sel:[0,1,0] op_sel_hi:[1,1,0]
    v_pk_fma_f32 v[228:229], v[228:229], v[174:175], v[174:175] op_sel:[0,1,0] op_sel_hi:[1,1,0]
    v_pk_mul_f32 v[226:227], v[226:227], v[88:89]
    v_pk_mul_f32 v[228:229], v[228:229], v[90:91]
    v_exp_f32 v226, v226
    v_exp_f32 v227, v227
    v_exp_f32 v228, v228
    v_exp_f32 v229, v229
    v_pk_fma_f32 v[226:227], v[226:227], v[172:173], v[172:173] op_sel:[0,1,1] op_sel_hi:[1,1,1]
    v_pk_fma_f32 v[228:229], v[228:229], v[172:173], v[172:173] op_sel:[0,1,1] op_sel_hi:[1,1,1]
    v_rcp_f32 v226, v226
    v_rcp_f32 v227, v227
    v_rcp_f32 v228, v228
    v_rcp_f32 v229, v229
    v_pk_mul_f32 v[88:89], v[88:89], v[226:227]
    v_pk_mul_f32 v[90:91], v[90:91], v[228:229]
    v_cvt_pk_bf16_f32 v84, v84, v85
    v_cvt_pk_bf16_f32 v85, v86, v87
    v_cvt_pk_bf16_f32 v86, v88, v89
    v_cvt_pk_bf16_f32 v87, v90, v91
    v_or_b32 v84, 1, v84
    ds_write_b128 v244, v[84:87] offset:4096
    s_add_u32 s36, s45, 458752
    buffer_store_dwordx4 v[84:87], v2, s[16:19], s36 offen sc1
    v_pk_fma_f32 v[112:113], v[176:177], v[140:141], v[112:113] op_sel_hi:[0,1,1] neg_lo:[1,0,0] neg_hi:[1,0,0]
    v_pk_fma_f32 v[114:115], v[176:177], v[142:143], v[114:115] op_sel_hi:[0,1,1] neg_lo:[1,0,0] neg_hi:[1,0,0]
    v_pk_mul_f32 v[226:227], v[112:113], v[112:113]
    v_pk_mul_f32 v[228:229], v[114:115], v[114:115]
    v_pk_fma_f32 v[226:227], v[226:227], v[178:179], v[178:179] op_sel:[0,1,0] op_sel_hi:[1,1,0]
    v_pk_fma_f32 v[228:229], v[228:229], v[178:179], v[178:179] op_sel:[0,1,0] op_sel_hi:[1,1,0]
    v_pk_mul_f32 v[226:227], v[226:227], v[112:113]
    v_pk_mul_f32 v[228:229], v[228:229], v[114:115]
    v_exp_f32 v226, v226
    v_exp_f32 v227, v227
    v_exp_f32 v228, v228
    v_exp_f32 v229, v229
    v_pk_fma_f32 v[226:227], v[226:227], v[176:177], v[176:177] op_sel:[0,1,1] op_sel_hi:[1,1,1]
    v_pk_fma_f32 v[228:229], v[228:229], v[176:177], v[176:177] op_sel:[0,1,1] op_sel_hi:[1,1,1]
    v_rcp_f32 v226, v226
    v_rcp_f32 v227, v227
    v_rcp_f32 v228, v228
    v_rcp_f32 v229, v229
    v_pk_mul_f32 v[112:113], v[112:113], v[226:227]
    v_pk_mul_f32 v[114:115], v[114:115], v[228:229]
    v_pk_fma_f32 v[116:117], v[176:177], v[144:145], v[116:117] op_sel_hi:[0,1,1] neg_lo:[1,0,0] neg_hi:[1,0,0]
    v_pk_fma_f32 v[118:119], v[176:177], v[146:147], v[118:119] op_sel_hi:[0,1,1] neg_lo:[1,0,0] neg_hi:[1,0,0]
    v_pk_mul_f32 v[226:227], v[116:117], v[116:117]
    v_pk_mul_f32 v[228:229], v[118:119], v[118:119]
    v_pk_fma_f32 v[226:227], v[226:227], v[178:179], v[178:179] op_sel:[0,1,0] op_sel_hi:[1,1,0]
    v_pk_fma_f32 v[228:229], v[228:229], v[178:179], v[178:179] op_sel:[0,1,0] op_sel_hi:[1,1,0]
    v_pk_mul_f32 v[226:227], v[226:227], v[116:117]
    v_pk_mul_f32 v[228:229], v[228:229], v[118:119]
    v_exp_f32 v226, v226
    v_exp_f32 v227, v227
    v_exp_f32 v228, v228
    v_exp_f32 v229, v229
    v_pk_fma_f32 v[226:227], v[226:227], v[176:177], v[176:177] op_sel:[0,1,1] op_sel_hi:[1,1,1]
    v_pk_fma_f32 v[228:229], v[228:229], v[176:177], v[176:177] op_sel:[0,1,1] op_sel_hi:[1,1,1]
    v_rcp_f32 v226, v226
    v_rcp_f32 v227, v227
    v_rcp_f32 v228, v228
    v_rcp_f32 v229, v229
    v_pk_mul_f32 v[116:117], v[116:117], v[226:227]
    v_pk_mul_f32 v[118:119], v[118:119], v[228:229]
    v_cvt_pk_bf16_f32 v112, v112, v113
    v_cvt_pk_bf16_f32 v113, v114, v115
    v_cvt_pk_bf16_f32 v114, v116, v117
    v_cvt_pk_bf16_f32 v115, v118, v119
    ds_write_b128 v244, v[112:115] offset:6144
    s_add_u32 s36, s45, 688128
    buffer_store_dwordx4 v[112:115], v2, s[16:19], s36 offen sc1
    v_pk_fma_f32 v[36:37], v[164:165], v[148:149], v[36:37] op_sel_hi:[0,1,1] neg_lo:[1,0,0] neg_hi:[1,0,0]
    v_pk_fma_f32 v[38:39], v[164:165], v[150:151], v[38:39] op_sel_hi:[0,1,1] neg_lo:[1,0,0] neg_hi:[1,0,0]
    v_pk_mul_f32 v[226:227], v[36:37], v[36:37]
    v_pk_mul_f32 v[228:229], v[38:39], v[38:39]
    v_pk_fma_f32 v[226:227], v[226:227], v[166:167], v[166:167] op_sel:[0,1,0] op_sel_hi:[1,1,0]
    v_pk_fma_f32 v[228:229], v[228:229], v[166:167], v[166:167] op_sel:[0,1,0] op_sel_hi:[1,1,0]
    v_pk_mul_f32 v[226:227], v[226:227], v[36:37]
    v_pk_mul_f32 v[228:229], v[228:229], v[38:39]
    v_exp_f32 v226, v226
    v_exp_f32 v227, v227
    v_exp_f32 v228, v228
    v_exp_f32 v229, v229
    v_pk_fma_f32 v[226:227], v[226:227], v[164:165], v[164:165] op_sel:[0,1,1] op_sel_hi:[1,1,1]
    v_pk_fma_f32 v[228:229], v[228:229], v[164:165], v[164:165] op_sel:[0,1,1] op_sel_hi:[1,1,1]
    v_rcp_f32 v226, v226
    v_rcp_f32 v227, v227
    v_rcp_f32 v228, v228
    v_rcp_f32 v229, v229
    v_pk_mul_f32 v[36:37], v[36:37], v[226:227]
    v_pk_mul_f32 v[38:39], v[38:39], v[228:229]
    v_pk_fma_f32 v[40:41], v[164:165], v[152:153], v[40:41] op_sel_hi:[0,1,1] neg_lo:[1,0,0] neg_hi:[1,0,0]
    v_pk_fma_f32 v[42:43], v[164:165], v[154:155], v[42:43] op_sel_hi:[0,1,1] neg_lo:[1,0,0] neg_hi:[1,0,0]
    v_pk_mul_f32 v[226:227], v[40:41], v[40:41]
    v_pk_mul_f32 v[228:229], v[42:43], v[42:43]
    v_pk_fma_f32 v[226:227], v[226:227], v[166:167], v[166:167] op_sel:[0,1,0] op_sel_hi:[1,1,0]
    v_pk_fma_f32 v[228:229], v[228:229], v[166:167], v[166:167] op_sel:[0,1,0] op_sel_hi:[1,1,0]
    v_pk_mul_f32 v[226:227], v[226:227], v[40:41]
    v_pk_mul_f32 v[228:229], v[228:229], v[42:43]
    v_exp_f32 v226, v226
    v_exp_f32 v227, v227
    v_exp_f32 v228, v228
    v_exp_f32 v229, v229
    v_pk_fma_f32 v[226:227], v[226:227], v[164:165], v[164:165] op_sel:[0,1,1] op_sel_hi:[1,1,1]
    v_pk_fma_f32 v[228:229], v[228:229], v[164:165], v[164:165] op_sel:[0,1,1] op_sel_hi:[1,1,1]
    v_rcp_f32 v226, v226
    v_rcp_f32 v227, v227
    v_rcp_f32 v228, v228
    v_rcp_f32 v229, v229
    v_pk_mul_f32 v[40:41], v[40:41], v[226:227]
    v_pk_mul_f32 v[42:43], v[42:43], v[228:229]
    v_cvt_pk_bf16_f32 v36, v36, v37
    v_cvt_pk_bf16_f32 v37, v38, v39
    v_cvt_pk_bf16_f32 v38, v40, v41
    v_cvt_pk_bf16_f32 v39, v42, v43
    v_or_b32 v36, 1, v36
    ds_write_b128 v244, v[36:39] offset:16384
    v_pk_fma_f32 v[64:65], v[168:169], v[148:149], v[64:65] op_sel_hi:[0,1,1] neg_lo:[1,0,0] neg_hi:[1,0,0]
    v_pk_fma_f32 v[66:67], v[168:169], v[150:151], v[66:67] op_sel_hi:[0,1,1] neg_lo:[1,0,0] neg_hi:[1,0,0]
    v_pk_mul_f32 v[226:227], v[64:65], v[64:65]
    v_pk_mul_f32 v[228:229], v[66:67], v[66:67]
    v_pk_fma_f32 v[226:227], v[226:227], v[170:171], v[170:171] op_sel:[0,1,0] op_sel_hi:[1,1,0]
    v_pk_fma_f32 v[228:229], v[228:229], v[170:171], v[170:171] op_sel:[0,1,0] op_sel_hi:[1,1,0]
    v_pk_mul_f32 v[226:227], v[226:227], v[64:65]
    v_pk_mul_f32 v[228:229], v[228:229], v[66:67]
    v_exp_f32 v226, v226
    v_exp_f32 v227, v227
    v_exp_f32 v228, v228
    v_exp_f32 v229, v229
    v_pk_fma_f32 v[226:227], v[226:227], v[168:169], v[168:169] op_sel:[0,1,1] op_sel_hi:[1,1,1]
    v_pk_fma_f32 v[228:229], v[228:229], v[168:169], v[168:169] op_sel:[0,1,1] op_sel_hi:[1,1,1]
    v_rcp_f32 v226, v226
    v_rcp_f32 v227, v227
    v_rcp_f32 v228, v228
    v_rcp_f32 v229, v229
    v_pk_mul_f32 v[64:65], v[64:65], v[226:227]
    v_pk_mul_f32 v[66:67], v[66:67], v[228:229]
    v_pk_fma_f32 v[68:69], v[168:169], v[152:153], v[68:69] op_sel_hi:[0,1,1] neg_lo:[1,0,0] neg_hi:[1,0,0]
    v_pk_fma_f32 v[70:71], v[168:169], v[154:155], v[70:71] op_sel_hi:[0,1,1] neg_lo:[1,0,0] neg_hi:[1,0,0]
    v_pk_mul_f32 v[226:227], v[68:69], v[68:69]
    v_pk_mul_f32 v[228:229], v[70:71], v[70:71]
    v_pk_fma_f32 v[226:227], v[226:227], v[170:171], v[170:171] op_sel:[0,1,0] op_sel_hi:[1,1,0]
    v_pk_fma_f32 v[228:229], v[228:229], v[170:171], v[170:171] op_sel:[0,1,0] op_sel_hi:[1,1,0]
    v_pk_mul_f32 v[226:227], v[226:227], v[68:69]
    v_pk_mul_f32 v[228:229], v[228:229], v[70:71]
    v_exp_f32 v226, v226
    v_exp_f32 v227, v227
    v_exp_f32 v228, v228
    v_exp_f32 v229, v229
    v_pk_fma_f32 v[226:227], v[226:227], v[168:169], v[168:169] op_sel:[0,1,1] op_sel_hi:[1,1,1]
    v_pk_fma_f32 v[228:229], v[228:229], v[168:169], v[168:169] op_sel:[0,1,1] op_sel_hi:[1,1,1]
    v_rcp_f32 v226, v226
    v_rcp_f32 v227, v227
    v_rcp_f32 v228, v228
    v_rcp_f32 v229, v229
    v_pk_mul_f32 v[68:69], v[68:69], v[226:227]
    v_pk_mul_f32 v[70:71], v[70:71], v[228:229]
    v_cvt_pk_bf16_f32 v64, v64, v65
    v_cvt_pk_bf16_f32 v65, v66, v67
    v_cvt_pk_bf16_f32 v66, v68, v69
    v_cvt_pk_bf16_f32 v67, v70, v71
    v_or_b32 v64, 1, v64
    ds_write_b128 v244, v[64:67] offset:18432
    s_waitcnt vmcnt(0)
    s_mov_b64 exec, 1
    ds_add_u32 v246, v245
    s_mov_b64 exec, -1
    v_pk_fma_f32 v[92:93], v[172:173], v[148:149], v[92:93] op_sel_hi:[0,1,1] neg_lo:[1,0,0] neg_hi:[1,0,0]
    v_pk_fma_f32 v[94:95], v[172:173], v[150:151], v[94:95] op_sel_hi:[0,1,1] neg_lo:[1,0,0] neg_hi:[1,0,0]
    v_pk_mul_f32 v[226:227], v[92:93], v[92:93]
    v_pk_mul_f32 v[228:229], v[94:95], v[94:95]
    v_pk_fma_f32 v[226:227], v[226:227], v[174:175], v[174:175] op_sel:[0,1,0] op_sel_hi:[1,1,0]
    v_pk_fma_f32 v[228:229], v[228:229], v[174:175], v[174:175] op_sel:[0,1,0] op_sel_hi:[1,1,0]
    v_pk_mul_f32 v[226:227], v[226:227], v[92:93]
    v_pk_mul_f32 v[228:229], v[228:229], v[94:95]
    v_exp_f32 v226, v226
    v_exp_f32 v227, v227
    v_exp_f32 v228, v228
    v_exp_f32 v229, v229
    v_pk_fma_f32 v[226:227], v[226:227], v[172:173], v[172:173] op_sel:[0,1,1] op_sel_hi:[1,1,1]
    v_pk_fma_f32 v[228:229], v[228:229], v[172:173], v[172:173] op_sel:[0,1,1] op_sel_hi:[1,1,1]
    v_rcp_f32 v226, v226
    v_rcp_f32 v227, v227
    v_rcp_f32 v228, v228
    v_rcp_f32 v229, v229
    v_pk_mul_f32 v[92:93], v[92:93], v[226:227]
    v_pk_mul_f32 v[94:95], v[94:95], v[228:229]
    v_pk_fma_f32 v[96:97], v[172:173], v[152:153], v[96:97] op_sel_hi:[0,1,1] neg_lo:[1,0,0] neg_hi:[1,0,0]
    v_pk_fma_f32 v[98:99], v[172:173], v[154:155], v[98:99] op_sel_hi:[0,1,1] neg_lo:[1,0,0] neg_hi:[1,0,0]
    v_pk_mul_f32 v[226:227], v[96:97], v[96:97]
    v_pk_mul_f32 v[228:229], v[98:99], v[98:99]
    v_pk_fma_f32 v[226:227], v[226:227], v[174:175], v[174:175] op_sel:[0,1,0] op_sel_hi:[1,1,0]
    v_pk_fma_f32 v[228:229], v[228:229], v[174:175], v[174:175] op_sel:[0,1,0] op_sel_hi:[1,1,0]
    v_pk_mul_f32 v[226:227], v[226:227], v[96:97]
    v_pk_mul_f32 v[228:229], v[228:229], v[98:99]
    v_exp_f32 v226, v226
    v_exp_f32 v227, v227
    v_exp_f32 v228, v228
    v_exp_f32 v229, v229
    v_pk_fma_f32 v[226:227], v[226:227], v[172:173], v[172:173] op_sel:[0,1,1] op_sel_hi:[1,1,1]
    v_pk_fma_f32 v[228:229], v[228:229], v[172:173], v[172:173] op_sel:[0,1,1] op_sel_hi:[1,1,1]
    v_rcp_f32 v226, v226
    v_rcp_f32 v227, v227
    v_rcp_f32 v228, v228
    v_rcp_f32 v229, v229
    v_pk_mul_f32 v[96:97], v[96:97], v[226:227]
    v_pk_mul_f32 v[98:99], v[98:99], v[228:229]
    v_cvt_pk_bf16_f32 v92, v92, v93
    v_cvt_pk_bf16_f32 v93, v94, v95
    v_cvt_pk_bf16_f32 v94, v96, v97
    v_cvt_pk_bf16_f32 v95, v98, v99
    v_or_b32 v92, 1, v92
    ds_write_b128 v244, v[92:95] offset:20480
    s_cmp_eq_u32 s60, 1
    s_cbranch_scc1 G4_p11
    buffer_load_dwordx4 v[180:183], v196, s[84:87], 0 offen offset:0 sc1
    buffer_load_dwordx4 v[188:191], v196, s[88:91], 0 offen offset:0 sc1
    buffer_load_dwordx4 v[184:187], v196, s[84:87], 0 offen offset:2048 sc1
    buffer_load_dwordx4 v[192:195], v196, s[88:91], 0 offen offset:2048 sc1
    s_branch G4_p21
G4_p11:
    s_add_u32 s36, s40, 0
    buffer_load_dwordx4 v[180:183], v2, s[84:87], s36 offen offset:0 sc1
    buffer_load_dwordx4 v[184:187], v2, s[88:91], s36 offen offset:0 sc1
    buffer_load_dwordx4 v[188:191], v2, s[84:87], s36 offen offset:1024 sc1
    buffer_load_dwordx4 v[192:195], v2, s[88:91], s36 offen offset:1024 sc1
    s_add_u32 s36, s40, 65536
    buffer_load_dwordx4 v[196:199], v2, s[84:87], s36 offen offset:0 sc1
    buffer_load_dwordx4 v[230:233], v2, s[88:91], s36 offen offset:0 sc1
    buffer_load_dwordx4 v[234:237], v2, s[84:87], s36 offen offset:1024 sc1
    buffer_load_dwordx4 v[248:251], v2, s[88:91], s36 offen offset:1024 sc1
G4_p21:
    v_pk_fma_f32 v[120:121], v[176:177], v[148:149], v[120:121] op_sel_hi:[0,1,1] neg_lo:[1,0,0] neg_hi:[1,0,0]
    v_pk_fma_f32 v[122:123], v[176:177], v[150:151], v[122:123] op_sel_hi:[0,1,1] neg_lo:[1,0,0] neg_hi:[1,0,0]
    v_pk_mul_f32 v[226:227], v[120:121], v[120:121]
    v_pk_mul_f32 v[228:229], v[122:123], v[122:123]
    v_pk_fma_f32 v[226:227], v[226:227], v[178:179], v[178:179] op_sel:[0,1,0] op_sel_hi:[1,1,0]
    v_pk_fma_f32 v[228:229], v[228:229], v[178:179], v[178:179] op_sel:[0,1,0] op_sel_hi:[1,1,0]
    v_pk_mul_f32 v[226:227], v[226:227], v[120:121]
    v_pk_mul_f32 v[228:229], v[228:229], v[122:123]
    v_exp_f32 v226, v226
    v_exp_f32 v227, v227
    v_exp_f32 v228, v228
    v_exp_f32 v229, v229
    v_pk_fma_f32 v[226:227], v[226:227], v[176:177], v[176:177] op_sel:[0,1,1] op_sel_hi:[1,1,1]
    v_pk_fma_f32 v[228:229], v[228:229], v[176:177], v[176:177] op_sel:[0,1,1] op_sel_hi:[1,1,1]
    v_rcp_f32 v226, v226
    v_rcp_f32 v227, v227
    v_rcp_f32 v228, v228
    v_rcp_f32 v229, v229
    v_pk_mul_f32 v[120:121], v[120:121], v[226:227]
    v_pk_mul_f32 v[122:123], v[122:123], v[228:229]
    v_pk_fma_f32 v[124:125], v[176:177], v[152:153], v[124:125] op_sel_hi:[0,1,1] neg_lo:[1,0,0] neg_hi:[1,0,0]
    v_pk_fma_f32 v[126:127], v[176:177], v[154:155], v[126:127] op_sel_hi:[0,1,1] neg_lo:[1,0,0] neg_hi:[1,0,0]
    v_pk_mul_f32 v[226:227], v[124:125], v[124:125]
    v_pk_mul_f32 v[228:229], v[126:127], v[126:127]
    v_pk_fma_f32 v[226:227], v[226:227], v[178:179], v[178:179] op_sel:[0,1,0] op_sel_hi:[1,1,0]
    v_pk_fma_f32 v[228:229], v[228:229], v[178:179], v[178:179] op_sel:[0,1,0] op_sel_hi:[1,1,0]
    v_pk_mul_f32 v[226:227], v[226:227], v[124:125]
    v_pk_mul_f32 v[228:229], v[228:229], v[126:127]
    v_exp_f32 v226, v226
    v_exp_f32 v227, v227
    v_exp_f32 v228, v228
    v_exp_f32 v229, v229
    v_pk_fma_f32 v[226:227], v[226:227], v[176:177], v[176:177] op_sel:[0,1,1] op_sel_hi:[1,1,1]
    v_pk_fma_f32 v[228:229], v[228:229], v[176:177], v[176:177] op_sel:[0,1,1] op_sel_hi:[1,1,1]
    v_rcp_f32 v226, v226
    v_rcp_f32 v227, v227
    v_rcp_f32 v228, v228
    v_rcp_f32 v229, v229
    v_pk_mul_f32 v[124:125], v[124:125], v[226:227]
    v_pk_mul_f32 v[126:127], v[126:127], v[228:229]
    v_cvt_pk_bf16_f32 v120, v120, v121
    v_cvt_pk_bf16_f32 v121, v122, v123
    v_cvt_pk_bf16_f32 v122, v124, v125
    v_cvt_pk_bf16_f32 v123, v126, v127
    ds_write_b128 v244, v[120:123] offset:22528
    v_pk_fma_f32 v[44:45], v[164:165], v[156:157], v[44:45] op_sel_hi:[0,1,1] neg_lo:[1,0,0] neg_hi:[1,0,0]
    v_pk_fma_f32 v[46:47], v[164:165], v[158:159], v[46:47] op_sel_hi:[0,1,1] neg_lo:[1,0,0] neg_hi:[1,0,0]
    v_pk_mul_f32 v[226:227], v[44:45], v[44:45]
    v_pk_mul_f32 v[228:229], v[46:47], v[46:47]
    v_pk_fma_f32 v[226:227], v[226:227], v[166:167], v[166:167] op_sel:[0,1,0] op_sel_hi:[1,1,0]
    v_pk_fma_f32 v[228:229], v[228:229], v[166:167], v[166:167] op_sel:[0,1,0] op_sel_hi:[1,1,0]
    v_pk_mul_f32 v[226:227], v[226:227], v[44:45]
    v_pk_mul_f32 v[228:229], v[228:229], v[46:47]
    v_exp_f32 v226, v226
    v_exp_f32 v227, v227
    v_exp_f32 v228, v228
    v_exp_f32 v229, v229
    v_pk_fma_f32 v[226:227], v[226:227], v[164:165], v[164:165] op_sel:[0,1,1] op_sel_hi:[1,1,1]
    v_pk_fma_f32 v[228:229], v[228:229], v[164:165], v[164:165] op_sel:[0,1,1] op_sel_hi:[1,1,1]
    v_rcp_f32 v226, v226
    v_rcp_f32 v227, v227
    v_rcp_f32 v228, v228
    v_rcp_f32 v229, v229
    v_pk_mul_f32 v[44:45], v[44:45], v[226:227]
    v_pk_mul_f32 v[46:47], v[46:47], v[228:229]
    v_pk_fma_f32 v[48:49], v[164:165], v[160:161], v[48:49] op_sel_hi:[0,1,1] neg_lo:[1,0,0] neg_hi:[1,0,0]
    v_pk_fma_f32 v[50:51], v[164:165], v[162:163], v[50:51] op_sel_hi:[0,1,1] neg_lo:[1,0,0] neg_hi:[1,0,0]
    v_pk_mul_f32 v[226:227], v[48:49], v[48:49]
    v_pk_mul_f32 v[228:229], v[50:51], v[50:51]
    v_pk_fma_f32 v[226:227], v[226:227], v[166:167], v[166:167] op_sel:[0,1,0] op_sel_hi:[1,1,0]
    v_pk_fma_f32 v[228:229], v[228:229], v[166:167], v[166:167] op_sel:[0,1,0] op_sel_hi:[1,1,0]
    v_pk_mul_f32 v[226:227], v[226:227], v[48:49]
    v_pk_mul_f32 v[228:229], v[228:229], v[50:51]
    v_exp_f32 v226, v226
    v_exp_f32 v227, v227
    v_exp_f32 v228, v228
    v_exp_f32 v229, v229
    v_pk_fma_f32 v[226:227], v[226:227], v[164:165], v[164:165] op_sel:[0,1,1] op_sel_hi:[1,1,1]
    v_pk_fma_f32 v[228:229], v[228:229], v[164:165], v[164:165] op_sel:[0,1,1] op_sel_hi:[1,1,1]
    v_rcp_f32 v226, v226
    v_rcp_f32 v227, v227
    v_rcp_f32 v228, v228
    v_rcp_f32 v229, v229
    v_pk_mul_f32 v[48:49], v[48:49], v[226:227]
    v_pk_mul_f32 v[50:51], v[50:51], v[228:229]
    v_cvt_pk_bf16_f32 v200, v44, v45
    v_cvt_pk_bf16_f32 v201, v46, v47
    v_cvt_pk_bf16_f32 v202, v48, v49
    v_cvt_pk_bf16_f32 v203, v50, v51
    v_or_b32 v200, 1, v200
    ds_write_b128 v244, v[200:203] offset:32768
    v_pk_fma_f32 v[72:73], v[168:169], v[156:157], v[72:73] op_sel_hi:[0,1,1] neg_lo:[1,0,0] neg_hi:[1,0,0]
    v_pk_fma_f32 v[74:75], v[168:169], v[158:159], v[74:75] op_sel_hi:[0,1,1] neg_lo:[1,0,0] neg_hi:[1,0,0]
    v_pk_mul_f32 v[226:227], v[72:73], v[72:73]
    v_pk_mul_f32 v[228:229], v[74:75], v[74:75]
    v_pk_fma_f32 v[226:227], v[226:227], v[170:171], v[170:171] op_sel:[0,1,0] op_sel_hi:[1,1,0]
    v_pk_fma_f32 v[228:229], v[228:229], v[170:171], v[170:171] op_sel:[0,1,0] op_sel_hi:[1,1,0]
    v_pk_mul_f32 v[226:227], v[226:227], v[72:73]
    v_pk_mul_f32 v[228:229], v[228:229], v[74:75]
    v_exp_f32 v226, v226
    v_exp_f32 v227, v227
    v_exp_f32 v228, v228
    v_exp_f32 v229, v229
    v_pk_fma_f32 v[226:227], v[226:227], v[168:169], v[168:169] op_sel:[0,1,1] op_sel_hi:[1,1,1]
    v_pk_fma_f32 v[228:229], v[228:229], v[168:169], v[168:169] op_sel:[0,1,1] op_sel_hi:[1,1,1]
    v_rcp_f32 v226, v226
    v_rcp_f32 v227, v227
    v_rcp_f32 v228, v228
    v_rcp_f32 v229, v229
    v_pk_mul_f32 v[72:73], v[72:73], v[226:227]
    v_pk_mul_f32 v[74:75], v[74:75], v[228:229]
    v_pk_fma_f32 v[76:77], v[168:169], v[160:161], v[76:77] op_sel_hi:[0,1,1] neg_lo:[1,0,0] neg_hi:[1,0,0]
    v_pk_fma_f32 v[78:79], v[168:169], v[162:163], v[78:79] op_sel_hi:[0,1,1] neg_lo:[1,0,0] neg_hi:[1,0,0]
    v_pk_mul_f32 v[226:227], v[76:77], v[76:77]
    v_pk_mul_f32 v[228:229], v[78:79], v[78:79]
    v_pk_fma_f32 v[226:227], v[226:227], v[170:171], v[170:171] op_sel:[0,1,0] op_sel_hi:[1,1,0]
    v_pk_fma_f32 v[228:229], v[228:229], v[170:171], v[170:171] op_sel:[0,1,0] op_sel_hi:[1,1,0]
    v_pk_mul_f32 v[226:227], v[226:227], v[76:77]
    v_pk_mul_f32 v[228:229], v[228:229], v[78:79]
    v_exp_f32 v226, v226
    v_exp_f32 v227, v227
    v_exp_f32 v228, v228
    v_exp_f32 v229, v229
    v_pk_fma_f32 v[226:227], v[226:227], v[168:169], v[168:169] op_sel:[0,1,1] op_sel_hi:[1,1,1]
    v_pk_fma_f32 v[228:229], v[228:229], v[168:169], v[168:169] op_sel:[0,1,1] op_sel_hi:[1,1,1]
    v_rcp_f32 v226, v226
    v_rcp_f32 v227, v227
    v_rcp_f32 v228, v228
    v_rcp_f32 v229, v229
    v_pk_mul_f32 v[76:77], v[76:77], v[226:227]
    v_pk_mul_f32 v[78:79], v[78:79], v[228:229]
    v_cvt_pk_bf16_f32 v204, v72, v73
    v_cvt_pk_bf16_f32 v205, v74, v75
    v_cvt_pk_bf16_f32 v206, v76, v77
    v_cvt_pk_bf16_f32 v207, v78, v79
    v_or_b32 v204, 1, v204
    ds_write_b128 v244, v[204:207] offset:34816
    v_pk_fma_f32 v[100:101], v[172:173], v[156:157], v[100:101] op_sel_hi:[0,1,1] neg_lo:[1,0,0] neg_hi:[1,0,0]
    v_pk_fma_f32 v[102:103], v[172:173], v[158:159], v[102:103] op_sel_hi:[0,1,1] neg_lo:[1,0,0] neg_hi:[1,0,0]
    v_pk_mul_f32 v[226:227], v[100:101], v[100:101]
    v_pk_mul_f32 v[228:229], v[102:103], v[102:103]
    v_pk_fma_f32 v[226:227], v[226:227], v[174:175], v[174:175] op_sel:[0,1,0] op_sel_hi:[1,1,0]
    v_pk_fma_f32 v[228:229], v[228:229], v[174:175], v[174:175] op_sel:[0,1,0] op_sel_hi:[1,1,0]
    v_pk_mul_f32 v[226:227], v[226:227], v[100:101]
    v_pk_mul_f32 v[228:229], v[228:229], v[102:103]
    v_exp_f32 v226, v226
    v_exp_f32 v227, v227
    v_exp_f32 v228, v228
    v_exp_f32 v229, v229
    v_pk_fma_f32 v[226:227], v[226:227], v[172:173], v[172:173] op_sel:[0,1,1] op_sel_hi:[1,1,1]
    v_pk_fma_f32 v[228:229], v[228:229], v[172:173], v[172:173] op_sel:[0,1,1] op_sel_hi:[1,1,1]
    v_rcp_f32 v226, v226
    v_rcp_f32 v227, v227
    v_rcp_f32 v228, v228
    v_rcp_f32 v229, v229
    v_pk_mul_f32 v[100:101], v[100:101], v[226:227]
    v_pk_mul_f32 v[102:103], v[102:103], v[228:229]
    v_pk_fma_f32 v[104:105], v[172:173], v[160:161], v[104:105] op_sel_hi:[0,1,1] neg_lo:[1,0,0] neg_hi:[1,0,0]
    v_pk_fma_f32 v[106:107], v[172:173], v[162:163], v[106:107] op_sel_hi:[0,1,1] neg_lo:[1,0,0] neg_hi:[1,0,0]
    v_pk_mul_f32 v[226:227], v[104:105], v[104:105]
    v_pk_mul_f32 v[228:229], v[106:107], v[106:107]
    v_pk_fma_f32 v[226:227], v[226:227], v[174:175], v[174:175] op_sel:[0,1,0] op_sel_hi:[1,1,0]
    v_pk_fma_f32 v[228:229], v[228:229], v[174:175], v[174:175] op_sel:[0,1,0] op_sel_hi:[1,1,0]
    v_pk_mul_f32 v[226:227], v[226:227], v[104:105]
    v_pk_mul_f32 v[228:229], v[228:229], v[106:107]
    v_exp_f32 v226, v226
    v_exp_f32 v227, v227
    v_exp_f32 v228, v228
    v_exp_f32 v229, v229
    v_pk_fma_f32 v[226:227], v[226:227], v[172:173], v[172:173] op_sel:[0,1,1] op_sel_hi:[1,1,1]
    v_pk_fma_f32 v[228:229], v[228:229], v[172:173], v[172:173] op_sel:[0,1,1] op_sel_hi:[1,1,1]
    v_rcp_f32 v226, v226
    v_rcp_f32 v227, v227
    v_rcp_f32 v228, v228
    v_rcp_f32 v229, v229
    v_pk_mul_f32 v[104:105], v[104:105], v[226:227]
    v_pk_mul_f32 v[106:107], v[106:107], v[228:229]
    v_cvt_pk_bf16_f32 v208, v100, v101
    v_cvt_pk_bf16_f32 v209, v102, v103
    v_cvt_pk_bf16_f32 v210, v104, v105
    v_cvt_pk_bf16_f32 v211, v106, v107
    v_or_b32 v208, 1, v208
    ds_write_b128 v244, v[208:211] offset:36864
    v_pk_fma_f32 v[128:129], v[176:177], v[156:157], v[128:129] op_sel_hi:[0,1,1] neg_lo:[1,0,0] neg_hi:[1,0,0]
    v_pk_fma_f32 v[130:131], v[176:177], v[158:159], v[130:131] op_sel_hi:[0,1,1] neg_lo:[1,0,0] neg_hi:[1,0,0]
    v_pk_mul_f32 v[226:227], v[128:129], v[128:129]
    v_pk_mul_f32 v[228:229], v[130:131], v[130:131]
    v_pk_fma_f32 v[226:227], v[226:227], v[178:179], v[178:179] op_sel:[0,1,0] op_sel_hi:[1,1,0]
    v_pk_fma_f32 v[228:229], v[228:229], v[178:179], v[178:179] op_sel:[0,1,0] op_sel_hi:[1,1,0]
    v_pk_mul_f32 v[226:227], v[226:227], v[128:129]
    v_pk_mul_f32 v[228:229], v[228:229], v[130:131]
    v_exp_f32 v226, v226
    v_exp_f32 v227, v227
    v_exp_f32 v228, v228
    v_exp_f32 v229, v229
    v_pk_fma_f32 v[226:227], v[226:227], v[176:177], v[176:177] op_sel:[0,1,1] op_sel_hi:[1,1,1]
    v_pk_fma_f32 v[228:229], v[228:229], v[176:177], v[176:177] op_sel:[0,1,1] op_sel_hi:[1,1,1]
    v_rcp_f32 v226, v226
    v_rcp_f32 v227, v227
    v_rcp_f32 v228, v228
    v_rcp_f32 v229, v229
    v_pk_mul_f32 v[128:129], v[128:129], v[226:227]
    v_pk_mul_f32 v[130:131], v[130:131], v[228:229]
    v_pk_fma_f32 v[132:133], v[176:177], v[160:161], v[132:133] op_sel_hi:[0,1,1] neg_lo:[1,0,0] neg_hi:[1,0,0]
    v_pk_fma_f32 v[134:135], v[176:177], v[162:163], v[134:135] op_sel_hi:[0,1,1] neg_lo:[1,0,0] neg_hi:[1,0,0]
    v_pk_mul_f32 v[226:227], v[132:133], v[132:133]
    v_pk_mul_f32 v[228:229], v[134:135], v[134:135]
    v_pk_fma_f32 v[226:227], v[226:227], v[178:179], v[178:179] op_sel:[0,1,0] op_sel_hi:[1,1,0]
    v_pk_fma_f32 v[228:229], v[228:229], v[178:179], v[178:179] op_sel:[0,1,0] op_sel_hi:[1,1,0]
    v_pk_mul_f32 v[226:227], v[226:227], v[132:133]
    v_pk_mul_f32 v[228:229], v[228:229], v[134:135]
    v_exp_f32 v226, v226
    v_exp_f32 v227, v227
    v_exp_f32 v228, v228
    v_exp_f32 v229, v229
    v_pk_fma_f32 v[226:227], v[226:227], v[176:177], v[176:177] op_sel:[0,1,1] op_sel_hi:[1,1,1]
    v_pk_fma_f32 v[228:229], v[228:229], v[176:177], v[176:177] op_sel:[0,1,1] op_sel_hi:[1,1,1]
    v_rcp_f32 v226, v226
    v_rcp_f32 v227, v227
    v_rcp_f32 v228, v228
    v_rcp_f32 v229, v229
    v_pk_mul_f32 v[132:133], v[132:133], v[226:227]
    v_pk_mul_f32 v[134:135], v[134:135], v[228:229]
    v_cvt_pk_bf16_f32 v212, v128, v129
    v_cvt_pk_bf16_f32 v213, v130, v131
    v_cvt_pk_bf16_f32 v214, v132, v133
    v_cvt_pk_bf16_f32 v215, v134, v135
    ds_write_b128 v244, v[212:215] offset:38912
    v_pk_fma_f32 v[24:25], v[164:165], v[136:137], v[24:25] op_sel_hi:[0,1,1] neg_lo:[1,0,0] neg_hi:[1,0,0]
    v_pk_fma_f32 v[26:27], v[164:165], v[138:139], v[26:27] op_sel_hi:[0,1,1] neg_lo:[1,0,0] neg_hi:[1,0,0]
    v_pk_mul_f32 v[226:227], v[24:25], v[24:25]
    v_pk_mul_f32 v[228:229], v[26:27], v[26:27]
    v_pk_fma_f32 v[226:227], v[226:227], v[166:167], v[166:167] op_sel:[0,1,0] op_sel_hi:[1,1,0]
    v_pk_fma_f32 v[228:229], v[228:229], v[166:167], v[166:167] op_sel:[0,1,0] op_sel_hi:[1,1,0]
    v_pk_mul_f32 v[226:227], v[226:227], v[24:25]
    v_pk_mul_f32 v[228:229], v[228:229], v[26:27]
    v_exp_f32 v226, v226
    v_exp_f32 v227, v227
    v_exp_f32 v228, v228
    v_exp_f32 v229, v229
    v_pk_fma_f32 v[226:227], v[226:227], v[164:165], v[164:165] op_sel:[0,1,1] op_sel_hi:[1,1,1]
    v_pk_fma_f32 v[228:229], v[228:229], v[164:165], v[164:165] op_sel:[0,1,1] op_sel_hi:[1,1,1]
    v_rcp_f32 v226, v226
    v_rcp_f32 v227, v227
    v_rcp_f32 v228, v228
    v_rcp_f32 v229, v229
    v_pk_mul_f32 v[24:25], v[24:25], v[226:227]
    v_pk_mul_f32 v[26:27], v[26:27], v[228:229]
    v_cvt_pk_bf16_f32 v216, v24, v25
    v_cvt_pk_bf16_f32 v217, v26, v27
    v_or_b32 v216, 1, v216
    s_add_u32 s36, s46, 0
    buffer_store_dwordx4 v[36:39], v2, s[16:19], s36 offen sc1
    v_pk_fma_f32 v[52:53], v[168:169], v[136:137], v[52:53] op_sel_hi:[0,1,1] neg_lo:[1,0,0] neg_hi:[1,0,0]
    v_pk_fma_f32 v[54:55], v[168:169], v[138:139], v[54:55] op_sel_hi:[0,1,1] neg_lo:[1,0,0] neg_hi:[1,0,0]
    v_pk_mul_f32 v[226:227], v[52:53], v[52:53]
    v_pk_mul_f32 v[228:229], v[54:55], v[54:55]
    v_pk_fma_f32 v[226:227], v[226:227], v[170:171], v[170:171] op_sel:[0,1,0] op_sel_hi:[1,1,0]
    v_pk_fma_f32 v[228:229], v[228:229], v[170:171], v[170:171] op_sel:[0,1,0] op_sel_hi:[1,1,0]
    v_pk_mul_f32 v[226:227], v[226:227], v[52:53]
    v_pk_mul_f32 v[228:229], v[228:229], v[54:55]
    v_exp_f32 v226, v226
    v_exp_f32 v227, v227
    v_exp_f32 v228, v228
    v_exp_f32 v229, v229
    v_pk_fma_f32 v[226:227], v[226:227], v[168:169], v[168:169] op_sel:[0,1,1] op_sel_hi:[1,1,1]
    v_pk_fma_f32 v[228:229], v[228:229], v[168:169], v[168:169] op_sel:[0,1,1] op_sel_hi:[1,1,1]
    v_rcp_f32 v226, v226
    v_rcp_f32 v227, v227
    v_rcp_f32 v228, v228
    v_rcp_f32 v229, v229
    v_pk_mul_f32 v[52:53], v[52:53], v[226:227]
    v_pk_mul_f32 v[54:55], v[54:55], v[228:229]
    v_cvt_pk_bf16_f32 v218, v52, v53
    v_cvt_pk_bf16_f32 v219, v54, v55
    v_or_b32 v218, 1, v218
    s_add_u32 s36, s46, 229376
    buffer_store_dwordx4 v[64:67], v2, s[16:19], s36 offen sc1
    v_pk_fma_f32 v[80:81], v[172:173], v[136:137], v[80:81] op_sel_hi:[0,1,1] neg_lo:[1,0,0] neg_hi:[1,0,0]
    v_pk_fma_f32 v[82:83], v[172:173], v[138:139], v[82:83] op_sel_hi:[0,1,1] neg_lo:[1,0,0] neg_hi:[1,0,0]
    v_pk_mul_f32 v[226:227], v[80:81], v[80:81]
    v_pk_mul_f32 v[228:229], v[82:83], v[82:83]
    v_pk_fma_f32 v[226:227], v[226:227], v[174:175], v[174:175] op_sel:[0,1,0] op_sel_hi:[1,1,0]
    v_pk_fma_f32 v[228:229], v[228:229], v[174:175], v[174:175] op_sel:[0,1,0] op_sel_hi:[1,1,0]
    v_pk_mul_f32 v[226:227], v[226:227], v[80:81]
    v_pk_mul_f32 v[228:229], v[228:229], v[82:83]
    v_exp_f32 v226, v226
    v_exp_f32 v227, v227
    v_exp_f32 v228, v228
    v_exp_f32 v229, v229
    v_pk_fma_f32 v[226:227], v[226:227], v[172:173], v[172:173] op_sel:[0,1,1] op_sel_hi:[1,1,1]
    v_pk_fma_f32 v[228:229], v[228:229], v[172:173], v[172:173] op_sel:[0,1,1] op_sel_hi:[1,1,1]
    v_rcp_f32 v226, v226
    v_rcp_f32 v227, v227
    v_rcp_f32 v228, v228
    v_rcp_f32 v229, v229
    v_pk_mul_f32 v[80:81], v[80:81], v[226:227]
    v_pk_mul_f32 v[82:83], v[82:83], v[228:229]
    v_cvt_pk_bf16_f32 v220, v80, v81
    v_cvt_pk_bf16_f32 v221, v82, v83
    v_or_b32 v220, 1, v220
    s_add_u32 s36, s46, 458752
    buffer_store_dwordx4 v[92:95], v2, s[16:19], s36 offen sc1
    v_pk_fma_f32 v[108:109], v[176:177], v[136:137], v[108:109] op_sel_hi:[0,1,1] neg_lo:[1,0,0] neg_hi:[1,0,0]
    v_pk_fma_f32 v[110:111], v[176:177], v[138:139], v[110:111] op_sel_hi:[0,1,1] neg_lo:[1,0,0] neg_hi:[1,0,0]
    v_pk_mul_f32 v[226:227], v[108:109], v[108:109]
    v_pk_mul_f32 v[228:229], v[110:111], v[110:111]
    v_pk_fma_f32 v[226:227], v[226:227], v[178:179], v[178:179] op_sel:[0,1,0] op_sel_hi:[1,1,0]
    v_pk_fma_f32 v[228:229], v[228:229], v[178:179], v[178:179] op_sel:[0,1,0] op_sel_hi:[1,1,0]
    v_pk_mul_f32 v[226:227], v[226:227], v[108:109]
    v_pk_mul_f32 v[228:229], v[228:229], v[110:111]
    v_exp_f32 v226, v226
    v_exp_f32 v227, v227
    v_exp_f32 v228, v228
    v_exp_f32 v229, v229
    v_pk_fma_f32 v[226:227], v[226:227], v[176:177], v[176:177] op_sel:[0,1,1] op_sel_hi:[1,1,1]
    v_pk_fma_f32 v[228:229], v[228:229], v[176:177], v[176:177] op_sel:[0,1,1] op_sel_hi:[1,1,1]
    v_rcp_f32 v226, v226
    v_rcp_f32 v227, v227
    v_rcp_f32 v228, v228
    v_rcp_f32 v229, v229
    v_pk_mul_f32 v[108:109], v[108:109], v[226:227]
    v_pk_mul_f32 v[110:111], v[110:111], v[228:229]
    v_cvt_pk_bf16_f32 v222, v108, v109
    v_cvt_pk_bf16_f32 v223, v110, v111
    s_add_u32 s36, s46, 688128
    buffer_store_dwordx4 v[120:123], v2, s[16:19], s36 offen sc1
    s_waitcnt lgkmcnt(0)
    s_add_u32 s45, s44, 512
    s_mov_b32 s44, s47
G3_e2:
    s_waitcnt lgkmcnt(0)
    s_barrier
    ds_read_b128 v[88:91], v17 offset:0
    ds_read_b128 v[92:95], v17 offset:2048
    ds_read_b128 v[96:99], v17 offset:4096
    ds_read_b128 v[100:103], v17 offset:6144
    ds_read_b64_tr_b16 v[104:105], v18 offset:0
    ds_read_b64_tr_b16 v[106:107], v18 offset:4096
    ds_read_b64_tr_b16 v[108:109], v19 offset:0
    ds_read_b64_tr_b16 v[110:111], v19 offset:4096
    ds_read_b64_tr_b16 v[112:113], v20 offset:0
    ds_read_b64_tr_b16 v[114:115], v20 offset:4096
    ds_read_b64_tr_b16 v[116:117], v21 offset:0
    ds_read_b64_tr_b16 v[118:119], v21 offset:4096
    s_waitcnt lgkmcnt(6)
    v_mfma_f32_16x16x32_bf16 v[24:27], v[104:107], v[88:91], 0
    ds_read_b128 v[120:123], v17 offset:1024
    s_add_u32 s42, s42, 16384
    v_mfma_f32_16x16x32_bf16 v[40:43], v[104:107], v[92:95], 0
    ds_read_b128 v[124:127], v17 offset:3072
    s_cmp_eq_u32 s42, 49152
    v_mfma_f32_16x16x32_bf16 v[56:59], v[104:107], v[96:99], 0
    ds_read_b128 v[128:131], v17 offset:5120
    s_cselect_b32 s42, 0, s42
    v_mfma_f32_16x16x32_bf16 v[72:75], v[104:107], v[100:103], 0
    ds_read_b128 v[132:135], v17 offset:7168
    s_waitcnt lgkmcnt(8)
    v_mfma_f32_16x16x32_bf16 v[76:79], v[108:111], v[100:103], 0
    ds_read_b64_tr_b16 v[136:137], v18 offset:8192
    s_add_u32 s48, s48, 16384
    v_mfma_f32_16x16x32_bf16 v[60:63], v[108:111], v[96:99], 0
    ds_read_b64_tr_b16 v[138:139], v18 offset:12288
    s_cmp_eq_u32 s48, 98304
    v_mfma_f32_16x16x32_bf16 v[44:47], v[108:111], v[92:95], 0
    ds_read_b64_tr_b16 v[140:141], v19 offset:8192
    s_cselect_b32 s48, 0, s48
    v_mfma_f32_16x16x32_bf16 v[28:31], v[108:111], v[88:91], 0
    ds_read_b64_tr_b16 v[142:143], v19 offset:12288
    s_waitcnt lgkmcnt(8)
    v_mfma_f32_16x16x32_bf16 v[32:35], v[112:115], v[88:91], 0
    ds_read_b64_tr_b16 v[144:145], v20 offset:8192
    v_add_u32 v17, s42, v12
    v_mfma_f32_16x16x32_bf16 v[48:51], v[112:115], v[92:95], 0
    ds_read_b64_tr_b16 v[146:147], v20 offset:12288
    s_add_u32 s36, s44, 0
    v_mfma_f32_16x16x32_bf16 v[64:67], v[112:115], v[96:99], 0
    ds_read_b64_tr_b16 v[148:149], v21 offset:8192
    buffer_store_dwordx4 v[200:203], v2, s[16:19], s36 offen sc1
    v_mfma_f32_16x16x32_bf16 v[80:83], v[112:115], v[100:103], 0
    ds_read_b64_tr_b16 v[150:151], v21 offset:12288
    s_add_u32 s36, s45, 0
    v_mfma_f32_16x16x32_bf16 v[84:87], v[116:119], v[100:103], 0
    buffer_store_dwordx2 v[216:217], v238, s[16:19], s36 offen sc1
    v_add_u32 v18, s48, v13
    v_mfma_f32_16x16x32_bf16 v[68:71], v[116:119], v[96:99], 0
    v_add_u32 v19, s48, v14
    v_mfma_f32_16x16x32_bf16 v[52:55], v[116:119], v[92:95], 0
    v_add_u32 v20, s48, v15
    v_mfma_f32_16x16x32_bf16 v[36:39], v[116:119], v[88:91], 0
    v_add_u32 v21, s48, v16
    s_waitcnt lgkmcnt(6)
    v_mfma_f32_16x16x32_bf16 v[24:27], v[136:139], v[120:123], v[24:27]
    v_mfma_f32_16x16x32_bf16 v[40:43], v[136:139], v[124:127], v[40:43]
    v_mfma_f32_16x16x32_bf16 v[56:59], v[136:139], v[128:131], v[56:59]
    s_waitcnt lgkmcnt(0)
    s_barrier
    v_mfma_f32_16x16x32_bf16 v[72:75], v[136:139], v[132:135], v[72:75]
    ds_read_b128 v[88:91], v17 offset:0
    s_add_u32 s36, s44, 229376
    v_mfma_f32_16x16x32_bf16 v[76:79], v[140:143], v[132:135], v[76:79]
    ds_read_b128 v[92:95], v17 offset:2048
    buffer_store_dwordx4 v[204:207], v2, s[16:19], s36 offen sc1
    v_mfma_f32_16x16x32_bf16 v[60:63], v[140:143], v[128:131], v[60:63]
    ds_read_b128 v[96:99], v17 offset:4096
    s_add_u32 s36, s45, 229376
    v_mfma_f32_16x16x32_bf16 v[44:47], v[140:143], v[124:127], v[44:47]
    ds_read_b128 v[100:103], v17 offset:6144
    buffer_store_dwordx2 v[218:219], v238, s[16:19], s36 offen sc1
    v_mfma_f32_16x16x32_bf16 v[28:31], v[140:143], v[120:123], v[28:31]
    ds_read_b64_tr_b16 v[104:105], v18 offset:0
    s_add_u32 s43, s43, 1
    v_mfma_f32_16x16x32_bf16 v[32:35], v[144:147], v[120:123], v[32:35]
    ds_read_b64_tr_b16 v[106:107], v18 offset:4096
    s_cmp_lt_u32 s43, 27
    v_mfma_f32_16x16x32_bf16 v[48:51], v[144:147], v[124:127], v[48:51]
    ds_read_b64_tr_b16 v[108:109], v19 offset:0
    v_mfma_f32_16x16x32_bf16 v[64:67], v[144:147], v[128:131], v[64:67]
    ds_read_b64_tr_b16 v[110:111], v19 offset:4096
    v_mfma_f32_16x16x32_bf16 v[80:83], v[144:147], v[132:135], v[80:83]
    ds_read_b64_tr_b16 v[112:113], v20 offset:0
    v_mfma_f32_16x16x32_bf16 v[84:87], v[148:151], v[132:135], v[84:87]
    ds_read_b64_tr_b16 v[114:115], v20 offset:4096
    v_mfma_f32_16x16x32_bf16 v[68:71], v[148:151], v[128:131], v[68:71]
    ds_read_b64_tr_b16 v[116:117], v21 offset:0
    v_mfma_f32_16x16x32_bf16 v[52:55], v[148:151], v[124:127], v[52:55]
    ds_read_b64_tr_b16 v[118:119], v21 offset:4096
    v_mfma_f32_16x16x32_bf16 v[36:39], v[148:151], v[120:123], v[36:39]
    s_waitcnt lgkmcnt(6)
    v_mfma_f32_16x16x32_bf16 v[24:27], v[104:107], v[88:91], v[24:27]
    ds_read_b128 v[120:123], v17 offset:1024
    s_add_u32 s42, s42, 16384
    v_mfma_f32_16x16x32_bf16 v[40:43], v[104:107], v[92:95], v[40:43]
    ds_read_b128 v[124:127], v17 offset:3072
    s_cmp_eq_u32 s42, 49152
    v_mfma_f32_16x16x32_bf16 v[56:59], v[104:107], v[96:99], v[56:59]
    ds_read_b128 v[128:131], v17 offset:5120
    s_cselect_b32 s42, 0, s42
    v_mfma_f32_16x16x32_bf16 v[72:75], v[104:107], v[100:103], v[72:75]
    ds_read_b128 v[132:135], v17 offset:7168
    s_waitcnt lgkmcnt(8)
    v_mfma_f32_16x16x32_bf16 v[76:79], v[108:111], v[100:103], v[76:79]
    ds_read_b64_tr_b16 v[136:137], v18 offset:8192
    s_add_u32 s48, s48, 16384
    v_mfma_f32_16x16x32_bf16 v[60:63], v[108:111], v[96:99], v[60:63]
    ds_read_b64_tr_b16 v[138:139], v18 offset:12288
    s_cmp_eq_u32 s48, 98304
    v_mfma_f32_16x16x32_bf16 v[44:47], v[108:111], v[92:95], v[44:47]
    ds_read_b64_tr_b16 v[140:141], v19 offset:8192
    s_cselect_b32 s48, 0, s48
    v_mfma_f32_16x16x32_bf16 v[28:31], v[108:111], v[88:91], v[28:31]
    ds_read_b64_tr_b16 v[142:143], v19 offset:12288
    s_waitcnt lgkmcnt(8)
    v_mfma_f32_16x16x32_bf16 v[32:35], v[112:115], v[88:91], v[32:35]
    ds_read_b64_tr_b16 v[144:145], v20 offset:8192
    v_add_u32 v17, s42, v12
    v_mfma_f32_16x16x32_bf16 v[48:51], v[112:115], v[92:95], v[48:51]
    ds_read_b64_tr_b16 v[146:147], v20 offset:12288
    s_add_u32 s36, s44, 458752
    v_mfma_f32_16x16x32_bf16 v[64:67], v[112:115], v[96:99], v[64:67]
    ds_read_b64_tr_b16 v[148:149], v21 offset:8192
    buffer_store_dwordx4 v[208:211], v2, s[16:19], s36 offen sc1
    v_mfma_f32_16x16x32_bf16 v[80:83], v[112:115], v[100:103], v[80:83]
    ds_read_b64_tr_b16 v[150:151], v21 offset:12288
    s_add_u32 s36, s45, 458752
    v_mfma_f32_16x16x32_bf16 v[84:87], v[116:119], v[100:103], v[84:87]
    buffer_store_dwordx2 v[220:221], v238, s[16:19], s36 offen sc1
    v_add_u32 v18, s48, v13
    v_mfma_f32_16x16x32_bf16 v[68:71], v[116:119], v[96:99], v[68:71]
    v_add_u32 v19, s48, v14
    v_mfma_f32_16x16x32_bf16 v[52:55], v[116:119], v[92:95], v[52:55]
    v_add_u32 v20, s48, v15
    v_mfma_f32_16x16x32_bf16 v[36:39], v[116:119], v[88:91], v[36:39]
    v_add_u32 v21, s48, v16
    s_waitcnt lgkmcnt(6)
    v_mfma_f32_16x16x32_bf16 v[24:27], v[136:139], v[120:123], v[24:27]
    v_mfma_f32_16x16x32_bf16 v[40:43], v[136:139], v[124:127], v[40:43]
    s_waitcnt vmcnt(6)
    v_mfma_f32_16x16x32_bf16 v[56:59], v[136:139], v[128:131], v[56:59]
    s_waitcnt lgkmcnt(0)
    s_barrier
    v_mfma_f32_16x16x32_bf16 v[72:75], v[136:139], v[132:135], v[72:75]
    ds_read_b128 v[88:91], v17 offset:0
    s_add_u32 s36, s44, 688128
    v_mfma_f32_16x16x32_bf16 v[76:79], v[140:143], v[132:135], v[76:79]
    ds_read_b128 v[92:95], v17 offset:2048
    buffer_store_dwordx4 v[212:215], v2, s[16:19], s36 offen sc1
    v_mfma_f32_16x16x32_bf16 v[60:63], v[140:143], v[128:131], v[60:63]
    ds_read_b128 v[96:99], v17 offset:4096
    s_add_u32 s36, s45, 688128
    v_mfma_f32_16x16x32_bf16 v[44:47], v[140:143], v[124:127], v[44:47]
    ds_read_b128 v[100:103], v17 offset:6144
    buffer_store_dwordx2 v[222:223], v238, s[16:19], s36 offen sc1
    v_mfma_f32_16x16x32_bf16 v[28:31], v[140:143], v[120:123], v[28:31]
    ds_read_b64_tr_b16 v[104:105], v18 offset:0
    s_add_u32 s43, s43, 1
    v_mfma_f32_16x16x32_bf16 v[32:35], v[144:147], v[120:123], v[32:35]
    ds_read_b64_tr_b16 v[106:107], v18 offset:4096
    s_cmp_lt_u32 s43, 27
    v_mfma_f32_16x16x32_bf16 v[48:51], v[144:147], v[124:127], v[48:51]
    ds_read_b64_tr_b16 v[108:109], v19 offset:0
    v_mfma_f32_16x16x32_bf16 v[64:67], v[144:147], v[128:131], v[64:67]
    ds_read_b64_tr_b16 v[110:111], v19 offset:4096
    v_mfma_f32_16x16x32_bf16 v[80:83], v[144:147], v[132:135], v[80:83]
    ds_read_b64_tr_b16 v[112:113], v20 offset:0
    v_mfma_f32_16x16x32_bf16 v[84:87], v[148:151], v[132:135], v[84:87]
    ds_read_b64_tr_b16 v[114:115], v20 offset:4096
    v_mfma_f32_16x16x32_bf16 v[68:71], v[148:151], v[128:131], v[68:71]
    ds_read_b64_tr_b16 v[116:117], v21 offset:0
    v_mfma_f32_16x16x32_bf16 v[52:55], v[148:151], v[124:127], v[52:55]
    ds_read_b64_tr_b16 v[118:119], v21 offset:4096
    v_mfma_f32_16x16x32_bf16 v[36:39], v[148:151], v[120:123], v[36:39]
    s_waitcnt lgkmcnt(6)
mm_27:
    v_mfma_f32_16x16x32_bf16 v[24:27], v[104:107], v[88:91], v[24:27]
    ds_read_b128 v[120:123], v17 offset:1024
    s_add_u32 s42, s42, 16384
    v_mfma_f32_16x16x32_bf16 v[40:43], v[104:107], v[92:95], v[40:43]
    ds_read_b128 v[124:127], v17 offset:3072
    s_cmp_eq_u32 s42, 49152
    v_mfma_f32_16x16x32_bf16 v[56:59], v[104:107], v[96:99], v[56:59]
    ds_read_b128 v[128:131], v17 offset:5120
    s_cselect_b32 s42, 0, s42
    v_mfma_f32_16x16x32_bf16 v[72:75], v[104:107], v[100:103], v[72:75]
    ds_read_b128 v[132:135], v17 offset:7168
    s_waitcnt lgkmcnt(8)
    v_mfma_f32_16x16x32_bf16 v[76:79], v[108:111], v[100:103], v[76:79]
    ds_read_b64_tr_b16 v[136:137], v18 offset:8192
    s_add_u32 s48, s48, 16384
    v_mfma_f32_16x16x32_bf16 v[60:63], v[108:111], v[96:99], v[60:63]
    ds_read_b64_tr_b16 v[138:139], v18 offset:12288
    s_cmp_eq_u32 s48, 98304
    v_mfma_f32_16x16x32_bf16 v[44:47], v[108:111], v[92:95], v[44:47]
    ds_read_b64_tr_b16 v[140:141], v19 offset:8192
    s_cselect_b32 s48, 0, s48
    v_mfma_f32_16x16x32_bf16 v[28:31], v[108:111], v[88:91], v[28:31]
    ds_read_b64_tr_b16 v[142:143], v19 offset:12288
    s_waitcnt lgkmcnt(8)
    v_mfma_f32_16x16x32_bf16 v[32:35], v[112:115], v[88:91], v[32:35]
    ds_read_b64_tr_b16 v[144:145], v20 offset:8192
    v_add_u32 v17, s42, v12
    v_mfma_f32_16x16x32_bf16 v[48:51], v[112:115], v[92:95], v[48:51]
    ds_read_b64_tr_b16 v[146:147], v20 offset:12288
    v_add_u32 v18, s48, v13
    v_mfma_f32_16x16x32_bf16 v[64:67], v[112:115], v[96:99], v[64:67]
    ds_read_b64_tr_b16 v[148:149], v21 offset:8192
    v_add_u32 v19, s48, v14
    v_mfma_f32_16x16x32_bf16 v[80:83], v[112:115], v[100:103], v[80:83]
    ds_read_b64_tr_b16 v[150:151], v21 offset:12288
    v_add_u32 v20, s48, v15
    v_mfma_f32_16x16x32_bf16 v[84:87], v[116:119], v[100:103], v[84:87]
    v_add_u32 v21, s48, v16
    v_mfma_f32_16x16x32_bf16 v[68:71], v[116:119], v[96:99], v[68:71]
    v_mfma_f32_16x16x32_bf16 v[52:55], v[116:119], v[92:95], v[52:55]
    v_mfma_f32_16x16x32_bf16 v[36:39], v[116:119], v[88:91], v[36:39]
    s_waitcnt lgkmcnt(6)
    v_mfma_f32_16x16x32_bf16 v[24:27], v[136:139], v[120:123], v[24:27]
    s_add_u32 s43, s43, 1
    s_cmp_lt_u32 s43, 4
    v_mfma_f32_16x16x32_bf16 v[40:43], v[136:139], v[124:127], v[40:43]
    v_mfma_f32_16x16x32_bf16 v[56:59], v[136:139], v[128:131], v[56:59]
    s_waitcnt lgkmcnt(0)
    s_barrier
    v_mfma_f32_16x16x32_bf16 v[72:75], v[136:139], v[132:135], v[72:75]
    ds_read_b128 v[88:91], v17 offset:0
    v_mfma_f32_16x16x32_bf16 v[76:79], v[140:143], v[132:135], v[76:79]
    ds_read_b128 v[92:95], v17 offset:2048
    v_mfma_f32_16x16x32_bf16 v[60:63], v[140:143], v[128:131], v[60:63]
    ds_read_b128 v[96:99], v17 offset:4096
    v_mfma_f32_16x16x32_bf16 v[44:47], v[140:143], v[124:127], v[44:47]
    ds_read_b128 v[100:103], v17 offset:6144
    v_mfma_f32_16x16x32_bf16 v[28:31], v[140:143], v[120:123], v[28:31]
    ds_read_b64_tr_b16 v[104:105], v18 offset:0
    v_mfma_f32_16x16x32_bf16 v[32:35], v[144:147], v[120:123], v[32:35]
    ds_read_b64_tr_b16 v[106:107], v18 offset:4096
    v_mfma_f32_16x16x32_bf16 v[48:51], v[144:147], v[124:127], v[48:51]
    ds_read_b64_tr_b16 v[108:109], v19 offset:0
    v_mfma_f32_16x16x32_bf16 v[64:67], v[144:147], v[128:131], v[64:67]
    ds_read_b64_tr_b16 v[110:111], v19 offset:4096
    v_mfma_f32_16x16x32_bf16 v[80:83], v[144:147], v[132:135], v[80:83]
    ds_read_b64_tr_b16 v[112:113], v20 offset:0
    v_mfma_f32_16x16x32_bf16 v[84:87], v[148:151], v[132:135], v[84:87]
    ds_read_b64_tr_b16 v[114:115], v20 offset:4096
    v_mfma_f32_16x16x32_bf16 v[68:71], v[148:151], v[128:131], v[68:71]
    ds_read_b64_tr_b16 v[116:117], v21 offset:0
    v_mfma_f32_16x16x32_bf16 v[52:55], v[148:151], v[124:127], v[52:55]
    ds_read_b64_tr_b16 v[118:119], v21 offset:4096
    v_mfma_f32_16x16x32_bf16 v[36:39], v[148:151], v[120:123], v[36:39]
    s_waitcnt lgkmcnt(6)
    s_cbranch_scc1 mm_27
mm_28:
    v_mfma_f32_16x16x32_bf16 v[24:27], v[104:107], v[88:91], v[24:27]
    ds_read_b128 v[120:123], v17 offset:1024
    s_add_u32 s42, s42, 16384
    v_mfma_f32_16x16x32_bf16 v[40:43], v[104:107], v[92:95], v[40:43]
    ds_read_b128 v[124:127], v17 offset:3072
    s_cmp_eq_u32 s42, 49152
    v_mfma_f32_16x16x32_bf16 v[56:59], v[104:107], v[96:99], v[56:59]
    ds_read_b128 v[128:131], v17 offset:5120
    s_cselect_b32 s42, 0, s42
    v_mfma_f32_16x16x32_bf16 v[72:75], v[104:107], v[100:103], v[72:75]
    ds_read_b128 v[132:135], v17 offset:7168
    s_waitcnt lgkmcnt(8)
    v_mfma_f32_16x16x32_bf16 v[76:79], v[108:111], v[100:103], v[76:79]
    ds_read_b64_tr_b16 v[136:137], v18 offset:8192
    s_add_u32 s48, s48, 16384
    v_mfma_f32_16x16x32_bf16 v[60:63], v[108:111], v[96:99], v[60:63]
    ds_read_b64_tr_b16 v[138:139], v18 offset:12288
    s_cmp_eq_u32 s48, 98304
    v_mfma_f32_16x16x32_bf16 v[44:47], v[108:111], v[92:95], v[44:47]
    ds_read_b64_tr_b16 v[140:141], v19 offset:8192
    s_cselect_b32 s48, 0, s48
    v_mfma_f32_16x16x32_bf16 v[28:31], v[108:111], v[88:91], v[28:31]
    ds_read_b64_tr_b16 v[142:143], v19 offset:12288
    s_waitcnt lgkmcnt(8)
    v_mfma_f32_16x16x32_bf16 v[32:35], v[112:115], v[88:91], v[32:35]
    ds_read_b64_tr_b16 v[144:145], v20 offset:8192
    v_add_u32 v17, s42, v12
    v_mfma_f32_16x16x32_bf16 v[48:51], v[112:115], v[92:95], v[48:51]
    ds_read_b64_tr_b16 v[146:147], v20 offset:12288
    v_add_u32 v18, s48, v13
    v_mfma_f32_16x16x32_bf16 v[64:67], v[112:115], v[96:99], v[64:67]
    ds_read_b64_tr_b16 v[148:149], v21 offset:8192
    v_add_u32 v19, s48, v14
    v_mfma_f32_16x16x32_bf16 v[80:83], v[112:115], v[100:103], v[80:83]
    ds_read_b64_tr_b16 v[150:151], v21 offset:12288
    v_add_u32 v20, s48, v15
    v_mfma_f32_16x16x32_bf16 v[84:87], v[116:119], v[100:103], v[84:87]
    v_add_u32 v21, s48, v16
    v_mfma_f32_16x16x32_bf16 v[68:71], v[116:119], v[96:99], v[68:71]
    v_mfma_f32_16x16x32_bf16 v[52:55], v[116:119], v[92:95], v[52:55]
    v_mfma_f32_16x16x32_bf16 v[36:39], v[116:119], v[88:91], v[36:39]
    s_waitcnt lgkmcnt(6)
    v_mfma_f32_16x16x32_bf16 v[24:27], v[136:139], v[120:123], v[24:27]
    s_add_u32 s43, s43, 1
    s_cmp_lt_u32 s43, 27
    v_mfma_f32_16x16x32_bf16 v[40:43], v[136:139], v[124:127], v[40:43]
    s_waitcnt vmcnt(0)
    v_mfma_f32_16x16x32_bf16 v[56:59], v[136:139], v[128:131], v[56:59]
    s_waitcnt lgkmcnt(0)
    s_barrier
    v_mfma_f32_16x16x32_bf16 v[72:75], v[136:139], v[132:135], v[72:75]
    ds_read_b128 v[88:91], v17 offset:0
    v_mfma_f32_16x16x32_bf16 v[76:79], v[140:143], v[132:135], v[76:79]
    ds_read_b128 v[92:95], v17 offset:2048
    v_mfma_f32_16x16x32_bf16 v[60:63], v[140:143], v[128:131], v[60:63]
    ds_read_b128 v[96:99], v17 offset:4096
    v_mfma_f32_16x16x32_bf16 v[44:47], v[140:143], v[124:127], v[44:47]
    ds_read_b128 v[100:103], v17 offset:6144
    v_mfma_f32_16x16x32_bf16 v[28:31], v[140:143], v[120:123], v[28:31]
    ds_read_b64_tr_b16 v[104:105], v18 offset:0
    v_mfma_f32_16x16x32_bf16 v[32:35], v[144:147], v[120:123], v[32:35]
    ds_read_b64_tr_b16 v[106:107], v18 offset:4096
    v_mfma_f32_16x16x32_bf16 v[48:51], v[144:147], v[124:127], v[48:51]
    ds_read_b64_tr_b16 v[108:109], v19 offset:0
    v_mfma_f32_16x16x32_bf16 v[64:67], v[144:147], v[128:131], v[64:67]
    ds_read_b64_tr_b16 v[110:111], v19 offset:4096
    v_mfma_f32_16x16x32_bf16 v[80:83], v[144:147], v[132:135], v[80:83]
    ds_read_b64_tr_b16 v[112:113], v20 offset:0
    v_mfma_f32_16x16x32_bf16 v[84:87], v[148:151], v[132:135], v[84:87]
    ds_read_b64_tr_b16 v[114:115], v20 offset:4096
    v_mfma_f32_16x16x32_bf16 v[68:71], v[148:151], v[128:131], v[68:71]
    ds_read_b64_tr_b16 v[116:117], v21 offset:0
    v_mfma_f32_16x16x32_bf16 v[52:55], v[148:151], v[124:127], v[52:55]
    ds_read_b64_tr_b16 v[118:119], v21 offset:4096
    v_mfma_f32_16x16x32_bf16 v[36:39], v[148:151], v[120:123], v[36:39]
    s_waitcnt lgkmcnt(6)
    s_cbranch_scc1 mm_28
    s_cmp_eq_u32 s60, 1
    s_cbranch_scc1 G4_last
    v_mfma_f32_16x16x32_bf16 v[24:27], v[104:107], v[88:91], v[24:27]
    ds_read_b128 v[120:123], v17 offset:1024
    v_mfma_f32_16x16x32_bf16 v[40:43], v[104:107], v[92:95], v[40:43]
    ds_read_b128 v[124:127], v17 offset:3072
    v_mfma_f32_16x16x32_bf16 v[56:59], v[104:107], v[96:99], v[56:59]
    ds_read_b128 v[128:131], v17 offset:5120
    v_mfma_f32_16x16x32_bf16 v[72:75], v[104:107], v[100:103], v[72:75]
    ds_read_b128 v[132:135], v17 offset:7168
    s_waitcnt lgkmcnt(8)
    v_mfma_f32_16x16x32_bf16 v[76:79], v[108:111], v[100:103], v[76:79]
    ds_read_b64_tr_b16 v[136:137], v18 offset:8192
    v_mfma_f32_16x16x32_bf16 v[60:63], v[108:111], v[96:99], v[60:63]
    ds_read_b64_tr_b16 v[138:139], v18 offset:12288
    v_mfma_f32_16x16x32_bf16 v[44:47], v[108:111], v[92:95], v[44:47]
    ds_read_b64_tr_b16 v[140:141], v19 offset:8192
    v_mfma_f32_16x16x32_bf16 v[28:31], v[108:111], v[88:91], v[28:31]
    ds_read_b64_tr_b16 v[142:143], v19 offset:12288
    s_waitcnt lgkmcnt(8)
    v_mfma_f32_16x16x32_bf16 v[32:35], v[112:115], v[88:91], v[32:35]
    ds_read_b64_tr_b16 v[144:145], v20 offset:8192
    v_mfma_f32_16x16x32_bf16 v[48:51], v[112:115], v[92:95], v[48:51]
    ds_read_b64_tr_b16 v[146:147], v20 offset:12288
    v_mfma_f32_16x16x32_bf16 v[64:67], v[112:115], v[96:99], v[64:67]
    ds_read_b64_tr_b16 v[148:149], v21 offset:8192
    v_mfma_f32_16x16x32_bf16 v[80:83], v[112:115], v[100:103], v[80:83]
    ds_read_b64_tr_b16 v[150:151], v21 offset:12288
    v_mfma_f32_16x16x32_bf16 v[84:87], v[116:119], v[100:103], v[84:87]
    v_mfma_f32_16x16x32_bf16 v[68:71], v[116:119], v[96:99], v[68:71]
    v_mfma_f32_16x16x32_bf16 v[52:55], v[116:119], v[92:95], v[52:55]
    v_mfma_f32_16x16x32_bf16 v[36:39], v[116:119], v[88:91], v[36:39]
    s_waitcnt lgkmcnt(0)
    v_mfma_f32_16x16x32_bf16 v[24:27], v[136:139], v[120:123], v[24:27]
    s_mul_i32 s36, s31, 524288
    s_add_u32 s36, s36, 0
    s_add_u32 s16, s62, s36
    v_mfma_f32_16x16x32_bf16 v[40:43], v[136:139], v[124:127], v[40:43]
    s_addc_u32 s17, s63, 0
    s_mov_b32 s18, 516096
    s_mov_b32 s19, 0x20000
    v_mfma_f32_16x16x32_bf16 v[56:59], v[136:139], v[128:131], v[56:59]
    v_mfma_f32_16x16x32_bf16 v[72:75], v[136:139], v[132:135], v[72:75]
    v_mfma_f32_16x16x32_bf16 v[76:79], v[140:143], v[132:135], v[76:79]
    v_mfma_f32_16x16x32_bf16 v[60:63], v[140:143], v[128:131], v[60:63]
    v_mfma_f32_16x16x32_bf16 v[44:47], v[140:143], v[124:127], v[44:47]
    v_mfma_f32_16x16x32_bf16 v[28:31], v[140:143], v[120:123], v[28:31]
    v_mfma_f32_16x16x32_bf16 v[32:35], v[144:147], v[120:123], v[32:35]
    v_mfma_f32_16x16x32_bf16 v[48:51], v[144:147], v[124:127], v[48:51]
    v_mfma_f32_16x16x32_bf16 v[64:67], v[144:147], v[128:131], v[64:67]
    v_mfma_f32_16x16x32_bf16 v[80:83], v[144:147], v[132:135], v[80:83]
    v_mfma_f32_16x16x32_bf16 v[84:87], v[148:151], v[132:135], v[84:87]
    v_mfma_f32_16x16x32_bf16 v[68:71], v[148:151], v[128:131], v[68:71]
    v_mfma_f32_16x16x32_bf16 v[52:55], v[148:151], v[124:127], v[52:55]
    v_mfma_f32_16x16x32_bf16 v[36:39], v[148:151], v[120:123], v[36:39]
    s_add_u32 s36, s39, 0
    v_cvt_pk_bf16_f32 v24, v24, v25
    v_cvt_pk_bf16_f32 v25, v26, v27
    v_cvt_pk_bf16_f32 v26, v28, v29
    v_cvt_pk_bf16_f32 v27, v30, v31
    v_or_b32 v24, 1, v24
    buffer_store_dwordx4 v[24:27], v2, s[16:19], s36 offen offset:0 sc1
    v_cvt_pk_bf16_f32 v32, v32, v33
    v_cvt_pk_bf16_f32 v33, v34, v35
    v_cvt_pk_bf16_f32 v34, v36, v37
    v_cvt_pk_bf16_f32 v35, v38, v39
    v_or_b32 v32, 1, v32
    buffer_store_dwordx4 v[32:35], v2, s[16:19], s36 offen offset:1024 sc1
    s_add_u32 s36, s39, 65536
    v_cvt_pk_bf16_f32 v40, v40, v41
    v_cvt_pk_bf16_f32 v41, v42, v43
    v_cvt_pk_bf16_f32 v42, v44, v45
    v_cvt_pk_bf16_f32 v43, v46, v47
    v_or_b32 v40, 1, v40
    buffer_store_dwordx4 v[40:43], v2, s[16:19], s36 offen offset:0 sc1
    v_cvt_pk_bf16_f32 v48, v48, v49
    v_cvt_pk_bf16_f32 v49, v50, v51
    v_cvt_pk_bf16_f32 v50, v52, v53
    v_cvt_pk_bf16_f32 v51, v54, v55
    v_or_b32 v48, 1, v48
    buffer_store_dwordx4 v[48:51], v2, s[16:19], s36 offen offset:1024 sc1
    s_add_u32 s36, s39, 131072
    v_cvt_pk_bf16_f32 v56, v56, v57
    v_cvt_pk_bf16_f32 v57, v58, v59
    v_cvt_pk_bf16_f32 v58, v60, v61
    v_cvt_pk_bf16_f32 v59, v62, v63
    v_or_b32 v56, 1, v56
    buffer_store_dwordx4 v[56:59], v2, s[16:19], s36 offen offset:0 sc1
    v_cvt_pk_bf16_f32 v64, v64, v65
    v_cvt_pk_bf16_f32 v65, v66, v67
    v_cvt_pk_bf16_f32 v66, v68, v69
    v_cvt_pk_bf16_f32 v67, v70, v71
    v_or_b32 v64, 1, v64
    buffer_store_dwordx4 v[64:67], v2, s[16:19], s36 offen offset:1024 sc1
    s_add_u32 s36, s39, 196608
    v_cvt_pk_bf16_f32 v72, v72, v73
    v_cvt_pk_bf16_f32 v73, v74, v75
    v_cvt_pk_bf16_f32 v74, v76, v77
    v_cvt_pk_bf16_f32 v75, v78, v79
    v_or_b32 v72, 1, v72
    buffer_store_dwordx4 v[72:75], v2, s[16:19], s36 offen offset:0 sc1
    v_cvt_pk_bf16_f32 v80, v80, v81
    v_cvt_pk_bf16_f32 v81, v82, v83
    v_cvt_pk_bf16_f32 v82, v84, v85
    v_cvt_pk_bf16_f32 v83, v86, v87
    v_or_b32 v80, 1, v80
    buffer_store_dwordx4 v[80:83], v2, s[16:19], s36 offen offset:1024 sc1
    s_barrier
    s_branch NEXT
G4_last:
    v_mfma_f32_16x16x32_bf16 v[24:27], v[104:107], v[88:91], v[24:27]
    ds_read_b128 v[120:123], v17 offset:1024
    v_mfma_f32_16x16x32_bf16 v[40:43], v[104:107], v[92:95], v[40:43]
    ds_read_b128 v[124:127], v17 offset:3072
    v_mfma_f32_16x16x32_bf16 v[56:59], v[104:107], v[96:99], v[56:59]
    ds_read_b128 v[128:131], v17 offset:5120
    v_mfma_f32_16x16x32_bf16 v[72:75], v[104:107], v[100:103], v[72:75]
    ds_read_b128 v[132:135], v17 offset:7168
    s_waitcnt lgkmcnt(8)
    v_mfma_f32_16x16x32_bf16 v[76:79], v[108:111], v[100:103], v[76:79]
    ds_read_b64_tr_b16 v[136:137], v18 offset:8192
    v_mfma_f32_16x16x32_bf16 v[60:63], v[108:111], v[96:99], v[60:63]
    ds_read_b64_tr_b16 v[138:139], v18 offset:12288
    v_mfma_f32_16x16x32_bf16 v[44:47], v[108:111], v[92:95], v[44:47]
    ds_read_b64_tr_b16 v[140:141], v19 offset:8192
    v_mfma_f32_16x16x32_bf16 v[28:31], v[108:111], v[88:91], v[28:31]
    ds_read_b64_tr_b16 v[142:143], v19 offset:12288
    s_waitcnt lgkmcnt(8)
    v_mfma_f32_16x16x32_bf16 v[32:35], v[112:115], v[88:91], v[32:35]
    ds_read_b64_tr_b16 v[144:145], v20 offset:8192
    v_mfma_f32_16x16x32_bf16 v[48:51], v[112:115], v[92:95], v[48:51]
    ds_read_b64_tr_b16 v[146:147], v20 offset:12288
    s_load_dwordx2 s[6:7], s[0:1], 88
    v_mfma_f32_16x16x32_bf16 v[64:67], v[112:115], v[96:99], v[64:67]
    ds_read_b64_tr_b16 v[148:149], v21 offset:8192
    v_mfma_f32_16x16x32_bf16 v[80:83], v[112:115], v[100:103], v[80:83]
    ds_read_b64_tr_b16 v[150:151], v21 offset:12288
    v_mfma_f32_16x16x32_bf16 v[84:87], v[116:119], v[100:103], v[84:87]
    v_mfma_f32_16x16x32_bf16 v[68:71], v[116:119], v[96:99], v[68:71]
    v_mfma_f32_16x16x32_bf16 v[52:55], v[116:119], v[92:95], v[52:55]
    v_mfma_f32_16x16x32_bf16 v[36:39], v[116:119], v[88:91], v[36:39]
    s_waitcnt lgkmcnt(0)
    v_mfma_f32_16x16x32_bf16 v[24:27], v[136:139], v[120:123], v[24:27]
    s_add_u32 s16, s62, 0x80000
    s_addc_u32 s17, s63, 0
    s_mov_b32 s18, 0x7e000
    v_mfma_f32_16x16x32_bf16 v[40:43], v[136:139], v[124:127], v[40:43]
    s_mov_b32 s19, 0x20000
    s_mov_b32 s20, s6
    s_mov_b32 s21, s7
    v_mfma_f32_16x16x32_bf16 v[56:59], v[136:139], v[128:131], v[56:59]
    s_mov_b32 s22, 0x400000
    s_mov_b32 s23, 0x20000
    s_add_u32 s44, s40, 65536
    v_mfma_f32_16x16x32_bf16 v[72:75], v[136:139], v[132:135], v[72:75]
    s_lshl_b32 s46, s28, 3
    s_add_u32 s46, s46, s37
    s_lshl_b32 s47, s31, 1
    v_mfma_f32_16x16x32_bf16 v[76:79], v[140:143], v[132:135], v[76:79]
    s_add_u32 s46, s46, s47
    s_lshl_b32 s46, s46, 15
    s_lshl_b32 s47, s38, 5
    v_mfma_f32_16x16x32_bf16 v[60:63], v[140:143], v[128:131], v[60:63]
    s_add_u32 s46, s46, s47
    s_add_u32 s47, s46, 32768
    v_and_b32 v225, 1, v23
    v_mfma_f32_16x16x32_bf16 v[44:47], v[140:143], v[124:127], v[44:47]
    v_lshlrev_b32 v224, 11, v22
    v_lshl_add_u32 v224, v225, 5, v224
    v_mfma_f32_16x16x32_bf16 v[28:31], v[140:143], v[120:123], v[28:31]
    v_lshrrev_b32 v225, 1, v23
    v_lshl_add_u32 v224, v225, 4, v224
    v_mfma_f32_16x16x32_bf16 v[32:35], v[144:147], v[120:123], v[32:35]
    v_lshrrev_b32 v225, 3, v22
    v_mul_u32_u24 v225, 16320, v225
    v_mfma_f32_16x16x32_bf16 v[48:51], v[144:147], v[124:127], v[48:51]
    v_sub_u32 v224, v224, v225
    v_add_u32 v225, 16384, v224
    v_mfma_f32_16x16x32_bf16 v[64:67], v[144:147], v[128:131], v[64:67]
    v_mfma_f32_16x16x32_bf16 v[80:83], v[144:147], v[132:135], v[80:83]
    v_mfma_f32_16x16x32_bf16 v[84:87], v[148:151], v[132:135], v[84:87]
    v_mfma_f32_16x16x32_bf16 v[68:71], v[148:151], v[128:131], v[68:71]
    v_mfma_f32_16x16x32_bf16 v[52:55], v[148:151], v[124:127], v[52:55]
    v_mfma_f32_16x16x32_bf16 v[36:39], v[148:151], v[120:123], v[36:39]
    s_cmp_eq_u32 s31, 0
    s_cbranch_scc1 G4_k0
    s_add_u32 s36, s41, 0
    v_cvt_pk_bf16_f32 v24, v24, v25
    v_cvt_pk_bf16_f32 v25, v26, v27
    v_cvt_pk_bf16_f32 v26, v28, v29
    v_cvt_pk_bf16_f32 v27, v30, v31
    v_or_b32 v24, 1, v24
    buffer_store_dwordx4 v[24:27], v2, s[16:19], s36 offen offset:0 sc1
    v_cvt_pk_bf16_f32 v32, v32, v33
    v_cvt_pk_bf16_f32 v33, v34, v35
    v_cvt_pk_bf16_f32 v34, v36, v37
    v_cvt_pk_bf16_f32 v35, v38, v39
    v_or_b32 v32, 1, v32
    buffer_store_dwordx4 v[32:35], v2, s[16:19], s36 offen offset:1024 sc1
    s_add_u32 s36, s41, 65536
    v_cvt_pk_bf16_f32 v40, v40, v41
    v_cvt_pk_bf16_f32 v41, v42, v43
    v_cvt_pk_bf16_f32 v42, v44, v45
    v_cvt_pk_bf16_f32 v43, v46, v47
    v_or_b32 v40, 1, v40
    buffer_store_dwordx4 v[40:43], v2, s[16:19], s36 offen offset:0 sc1
    v_cvt_pk_bf16_f32 v48, v48, v49
    v_cvt_pk_bf16_f32 v49, v50, v51
    v_cvt_pk_bf16_f32 v50, v52, v53
    v_cvt_pk_bf16_f32 v51, v54, v55
    v_or_b32 v48, 1, v48
    buffer_store_dwordx4 v[48:51], v2, s[16:19], s36 offen offset:1024 sc1
    v_pk_mov_b32 v[24:25], v[56:57], v[56:57] op_sel:[0,1]
    v_pk_mov_b32 v[26:27], v[58:59], v[58:59] op_sel:[0,1]
    v_pk_mov_b32 v[28:29], v[60:61], v[60:61] op_sel:[0,1]
    v_pk_mov_b32 v[30:31], v[62:63], v[62:63] op_sel:[0,1]
    v_pk_mov_b32 v[32:33], v[64:65], v[64:65] op_sel:[0,1]
    v_pk_mov_b32 v[34:35], v[66:67], v[66:67] op_sel:[0,1]
    v_pk_mov_b32 v[36:37], v[68:69], v[68:69] op_sel:[0,1]
    v_pk_mov_b32 v[38:39], v[70:71], v[70:71] op_sel:[0,1]
    v_pk_mov_b32 v[40:41], v[72:73], v[72:73] op_sel:[0,1]
    v_pk_mov_b32 v[42:43], v[74:75], v[74:75] op_sel:[0,1]
    v_pk_mov_b32 v[44:45], v[76:77], v[76:77] op_sel:[0,1]
    v_pk_mov_b32 v[46:47], v[78:79], v[78:79] op_sel:[0,1]
    v_pk_mov_b32 v[48:49], v[80:81], v[80:81] op_sel:[0,1]
    v_pk_mov_b32 v[50:51], v[82:83], v[82:83] op_sel:[0,1]
    v_pk_mov_b32 v[52:53], v[84:85], v[84:85] op_sel:[0,1]
    v_pk_mov_b32 v[54:55], v[86:87], v[86:87] op_sel:[0,1]
    s_branch G4_k1
G4_k0:
    s_add_u32 s36, s41, 0
    v_cvt_pk_bf16_f32 v56, v56, v57
    v_cvt_pk_bf16_f32 v57, v58, v59
    v_cvt_pk_bf16_f32 v58, v60, v61
    v_cvt_pk_bf16_f32 v59, v62, v63
    v_or_b32 v56, 1, v56
    buffer_store_dwordx4 v[56:59], v2, s[16:19], s36 offen offset:0 sc1
    v_cvt_pk_bf16_f32 v64, v64, v65
    v_cvt_pk_bf16_f32 v65, v66, v67
    v_cvt_pk_bf16_f32 v66, v68, v69
    v_cvt_pk_bf16_f32 v67, v70, v71
    v_or_b32 v64, 1, v64
    buffer_store_dwordx4 v[64:67], v2, s[16:19], s36 offen offset:1024 sc1
    s_add_u32 s36, s41, 65536
    v_cvt_pk_bf16_f32 v72, v72, v73
    v_cvt_pk_bf16_f32 v73, v74, v75
    v_cvt_pk_bf16_f32 v74, v76, v77
    v_cvt_pk_bf16_f32 v75, v78, v79
    v_or_b32 v72, 1, v72
    buffer_store_dwordx4 v[72:75], v2, s[16:19], s36 offen offset:0 sc1
    v_cvt_pk_bf16_f32 v80, v80, v81
    v_cvt_pk_bf16_f32 v81, v82, v83
    v_cvt_pk_bf16_f32 v82, v84, v85
    v_cvt_pk_bf16_f32 v83, v86, v87
    v_or_b32 v80, 1, v80
    buffer_store_dwordx4 v[80:83], v2, s[16:19], s36 offen offset:1024 sc1
G4_k1:
    s_mov_b32 s78, 0x3f80
    s_mov_b32 s79, 0x3f800000
    v_dot2_f32_bf16 v24, v180, s78, v24
    v_dot2_f32_bf16 v25, v180, s79, v25
    v_dot2_f32_bf16 v26, v181, s78, v26
    v_dot2_f32_bf16 v27, v181, s79, v27
    v_dot2_f32_bf16 v28, v182, s78, v28
    v_dot2_f32_bf16 v29, v182, s79, v29
    v_dot2_f32_bf16 v30, v183, s78, v30
    v_dot2_f32_bf16 v31, v183, s79, v31
    v_dot2_f32_bf16 v32, v188, s78, v32
    v_dot2_f32_bf16 v33, v188, s79, v33
    v_dot2_f32_bf16 v34, v189, s78, v34
    v_dot2_f32_bf16 v35, v189, s79, v35
    v_dot2_f32_bf16 v36, v190, s78, v36
    v_dot2_f32_bf16 v37, v190, s79, v37
    v_dot2_f32_bf16 v38, v191, s78, v38
    v_dot2_f32_bf16 v39, v191, s79, v39
    v_dot2_f32_bf16 v40, v196, s78, v40
    v_dot2_f32_bf16 v41, v196, s79, v41
    v_dot2_f32_bf16 v42, v197, s78, v42
    v_dot2_f32_bf16 v43, v197, s79, v43
    v_dot2_f32_bf16 v44, v198, s78, v44
    v_dot2_f32_bf16 v45, v198, s79, v45
    v_dot2_f32_bf16 v46, v199, s78, v46
    v_dot2_f32_bf16 v47, v199, s79, v47
    v_dot2_f32_bf16 v48, v234, s78, v48
    v_dot2_f32_bf16 v49, v234, s79, v49
    v_dot2_f32_bf16 v50, v235, s78, v50
    v_dot2_f32_bf16 v51, v235, s79, v51
    v_dot2_f32_bf16 v52, v236, s78, v52
    v_dot2_f32_bf16 v53, v236, s79, v53
    v_dot2_f32_bf16 v54, v237, s78, v54
    v_dot2_f32_bf16 v55, v237, s79, v55
    v_dot2_f32_bf16 v24, v184, s78, v24
    v_dot2_f32_bf16 v25, v184, s79, v25
    v_dot2_f32_bf16 v26, v185, s78, v26
    v_dot2_f32_bf16 v27, v185, s79, v27
    v_dot2_f32_bf16 v28, v186, s78, v28
    v_dot2_f32_bf16 v29, v186, s79, v29
    v_dot2_f32_bf16 v30, v187, s78, v30
    v_dot2_f32_bf16 v31, v187, s79, v31
    v_dot2_f32_bf16 v32, v192, s78, v32
    v_dot2_f32_bf16 v33, v192, s79, v33
    v_dot2_f32_bf16 v34, v193, s78, v34
    v_dot2_f32_bf16 v35, v193, s79, v35
    v_dot2_f32_bf16 v36, v194, s78, v36
    v_dot2_f32_bf16 v37, v194, s79, v37
    v_dot2_f32_bf16 v38, v195, s78, v38
    v_dot2_f32_bf16 v39, v195, s79, v39
    v_dot2_f32_bf16 v40, v230, s78, v40
    v_dot2_f32_bf16 v41, v230, s79, v41
    v_dot2_f32_bf16 v42, v231, s78, v42
    v_dot2_f32_bf16 v43, v231, s79, v43
    v_dot2_f32_bf16 v44, v232, s78, v44
    v_dot2_f32_bf16 v45, v232, s79, v45
    v_dot2_f32_bf16 v46, v233, s78, v46
    v_dot2_f32_bf16 v47, v233, s79, v47
    v_dot2_f32_bf16 v48, v248, s78, v48
    v_dot2_f32_bf16 v49, v248, s79, v49
    v_dot2_f32_bf16 v50, v249, s78, v50
    v_dot2_f32_bf16 v51, v249, s79, v51
    v_dot2_f32_bf16 v52, v250, s78, v52
    v_dot2_f32_bf16 v53, v250, s79, v53
    v_dot2_f32_bf16 v54, v251, s78, v54
    v_dot2_f32_bf16 v55, v251, s79, v55
    s_mov_b32 s53, 0
dp_29:
    buffer_load_dwordx4 v[208:211], v2, s[16:19], s40 offen offset:0 sc1
    buffer_load_dwordx4 v[212:215], v2, s[16:19], s40 offen offset:1024 sc1
    buffer_load_dwordx4 v[216:219], v2, s[16:19], s44 offen offset:0 sc1
    buffer_load_dwordx4 v[220:223], v2, s[16:19], s44 offen offset:1024 sc1
    s_waitcnt vmcnt(0)
    v_bitop3_b32 v6, v208, v212, v216 bitop3:0x80
    v_bitop3_b32 v6, v6, v220, 1 bitop3:0x80
    v_cmp_eq_u32 vcc, 0, v6
    s_cbranch_vccz dq_30
    s_sleep 2
    s_add_u32 s53, s53, 1
    s_cmp_lt_u32 s53, s61
    s_cbranch_scc1 dp_29
    s_mov_b32 s61, 0
dq_30:
    v_dot2_f32_bf16 v24, v208, s78, v24
    v_dot2_f32_bf16 v25, v208, s79, v25
    v_dot2_f32_bf16 v26, v209, s78, v26
    v_dot2_f32_bf16 v27, v209, s79, v27
    v_dot2_f32_bf16 v28, v210, s78, v28
    v_dot2_f32_bf16 v29, v210, s79, v29
    v_dot2_f32_bf16 v30, v211, s78, v30
    v_dot2_f32_bf16 v31, v211, s79, v31
    v_cvt_pk_bf16_f32 v24, v24, v25
    v_cvt_pk_bf16_f32 v25, v26, v27
    v_cvt_pk_bf16_f32 v26, v28, v29
    v_cvt_pk_bf16_f32 v27, v30, v31
    s_nop 0
    v_permlane16_swap_b32 v24, v26
    v_permlane16_swap_b32 v25, v27
    v_dot2_f32_bf16 v32, v212, s78, v32
    v_dot2_f32_bf16 v33, v212, s79, v33
    v_dot2_f32_bf16 v34, v213, s78, v34
    v_dot2_f32_bf16 v35, v213, s79, v35
    v_dot2_f32_bf16 v36, v214, s78, v36
    v_dot2_f32_bf16 v37, v214, s79, v37
    v_dot2_f32_bf16 v38, v215, s78, v38
    v_dot2_f32_bf16 v39, v215, s79, v39
    v_cvt_pk_bf16_f32 v32, v32, v33
    v_cvt_pk_bf16_f32 v33, v34, v35
    v_cvt_pk_bf16_f32 v34, v36, v37
    v_cvt_pk_bf16_f32 v35, v38, v39
    s_nop 0
    v_permlane16_swap_b32 v32, v34
    v_permlane16_swap_b32 v33, v35
    v_mov_b32 v36, v24
    v_mov_b32 v37, v25
    v_mov_b32 v38, v26
    v_mov_b32 v39, v27
    v_mov_b32_dpp v24, v32 row_ror:8 row_mask:0xf bank_mask:0xc
    v_mov_b32_dpp v25, v33 row_ror:8 row_mask:0xf bank_mask:0xc
    v_mov_b32_dpp v26, v34 row_ror:8 row_mask:0xf bank_mask:0xc
    v_mov_b32_dpp v27, v35 row_ror:8 row_mask:0xf bank_mask:0xc
    v_mov_b32_dpp v32, v36 row_ror:8 row_mask:0xf bank_mask:0x3
    v_mov_b32_dpp v33, v37 row_ror:8 row_mask:0xf bank_mask:0x3
    v_mov_b32_dpp v34, v38 row_ror:8 row_mask:0xf bank_mask:0x3
    v_mov_b32_dpp v35, v39 row_ror:8 row_mask:0xf bank_mask:0x3
    buffer_store_dwordx4 v[24:27], v224, s[20:23], s46 offen sc1
    buffer_store_dwordx4 v[32:35], v225, s[20:23], s46 offen sc1
    v_dot2_f32_bf16 v40, v216, s78, v40
    v_dot2_f32_bf16 v41, v216, s79, v41
    v_dot2_f32_bf16 v42, v217, s78, v42
    v_dot2_f32_bf16 v43, v217, s79, v43
    v_dot2_f32_bf16 v44, v218, s78, v44
    v_dot2_f32_bf16 v45, v218, s79, v45
    v_dot2_f32_bf16 v46, v219, s78, v46
    v_dot2_f32_bf16 v47, v219, s79, v47
    v_cvt_pk_bf16_f32 v40, v40, v41
    v_cvt_pk_bf16_f32 v41, v42, v43
    v_cvt_pk_bf16_f32 v42, v44, v45
    v_cvt_pk_bf16_f32 v43, v46, v47
    s_nop 0
    v_permlane16_swap_b32 v40, v42
    v_permlane16_swap_b32 v41, v43
    v_dot2_f32_bf16 v48, v220, s78, v48
    v_dot2_f32_bf16 v49, v220, s79, v49
    v_dot2_f32_bf16 v50, v221, s78, v50
    v_dot2_f32_bf16 v51, v221, s79, v51
    v_dot2_f32_bf16 v52, v222, s78, v52
    v_dot2_f32_bf16 v53, v222, s79, v53
    v_dot2_f32_bf16 v54, v223, s78, v54
    v_dot2_f32_bf16 v55, v223, s79, v55
    v_cvt_pk_bf16_f32 v48, v48, v49
    v_cvt_pk_bf16_f32 v49, v50, v51
    v_cvt_pk_bf16_f32 v50, v52, v53
    v_cvt_pk_bf16_f32 v51, v54, v55
    s_nop 0
    v_permlane16_swap_b32 v48, v50
    v_permlane16_swap_b32 v49, v51
    v_mov_b32 v52, v40
    v_mov_b32 v53, v41
    v_mov_b32 v54, v42
    v_mov_b32 v55, v43
    v_mov_b32_dpp v40, v48 row_ror:8 row_mask:0xf bank_mask:0xc
    v_mov_b32_dpp v41, v49 row_ror:8 row_mask:0xf bank_mask:0xc
    v_mov_b32_dpp v42, v50 row_ror:8 row_mask:0xf bank_mask:0xc
    v_mov_b32_dpp v43, v51 row_ror:8 row_mask:0xf bank_mask:0xc
    v_mov_b32_dpp v48, v52 row_ror:8 row_mask:0xf bank_mask:0x3
    v_mov_b32_dpp v49, v53 row_ror:8 row_mask:0xf bank_mask:0x3
    v_mov_b32_dpp v50, v54 row_ror:8 row_mask:0xf bank_mask:0x3
    v_mov_b32_dpp v51, v55 row_ror:8 row_mask:0xf bank_mask:0x3
    buffer_store_dwordx4 v[40:43], v224, s[20:23], s47 offen sc1
    buffer_store_dwordx4 v[48:51], v225, s[20:23], s47 offen sc1
    s_branch K_fin
LOADERS:
    s_cmp_lg_u32 s60, 0
    s_cbranch_scc1 pr_31
    s_and_b32 s36, s29, 6
    s_cmp_eq_u32 s36, 2
    s_cbranch_scc0 pr_31
    s_call_b64 s[76:77], SUB_park2
pr_31:
    s_cmp_ge_u32 s30, 6
    s_cbranch_scc1 WLOAD
    s_add_u32 s54, s55, 0x500
    v_mov_b32 v222, s54
    s_lshl_b32 s53, s29, 7
    s_add_u32 s53, s53, 23121920
    v_mov_b32 v226, s53
    s_sleep 30
    s_mov_b64 exec, 1
    buffer_load_dword v227, v226, s[56:59], 0 offen sc1
    s_mov_b64 exec, -1
    s_waitcnt vmcnt(0)
    v_readfirstlane_b32 s53, v227
    s_add_u32 s54, s52, 16
    s_cmp_eq_u32 s53, s54
    s_cbranch_scc1 fok_32
    s_mov_b32 s53, 0
    s_add_u32 s54, s52, 16
    s_bfm_b64 exec, 1, 0
poll_33:
    buffer_load_dword v227, v226, s[56:59], 0 offen sc1
    s_waitcnt vmcnt(0)
    v_xor_b32 v227, s54, v227
    v_cmp_eq_u32 vcc, 0, v227
    s_nop 0
    s_cmp_eq_u64 vcc, exec
    s_cbranch_scc1 pok_34
    s_sleep 5
    s_add_u32 s53, s53, 1
    s_cmp_lt_u32 s53, s61
    s_cbranch_scc1 poll_33
    s_mov_b32 s61, 0
pok_34:
    s_mov_b64 exec, -1
fok_32:
    s_add_u32 s24, s4, 0x1400000
    s_addc_u32 s25, s5, 0
    s_mov_b32 s26, 0x20000
    s_mov_b32 s27, 0x20000
    s_cmp_eq_u32 s60, 0
    s_cselect_b32 s26, s26, 0
    s_and_b32 s36, s30, 1
    s_mul_i32 s36, s36, 128
    s_mul_i32 s37, s29, 256
    s_add_u32 s37, s36, s37
    v_lshrrev_b32 v224, 3, v1
    v_mul_u32_u24 v224, 4096, v224
    v_and_b32 v23, 112, v2
    v_add_u32 v224, v224, v23
    s_cmp_eq_u32 s60, 0
    s_cselect_b64 exec, -1, 0
    buffer_load_dwordx4 v[24:27], v224, s[24:27], s37 offen sc1
    s_add_u32 s37, s37, 32768
    buffer_load_dwordx4 v[28:31], v224, s[24:27], s37 offen sc1
    s_add_u32 s37, s37, 32768
    buffer_load_dwordx4 v[32:35], v224, s[24:27], s37 offen sc1
    s_add_u32 s37, s37, 32768
    buffer_load_dwordx4 v[36:39], v224, s[24:27], s37 offen sc1
    s_add_u32 s37, s37, 32768
    s_mov_b64 exec, -1
    s_mov_b64 exec, 1
    buffer_load_dword v223, v222, s[56:59], 0 offen sc1
    s_mov_b64 exec, -1
    s_waitcnt vmcnt(0)
    v_readfirstlane_b32 s53, v223
    s_add_u32 s54, s52, 16
    s_cmp_eq_u32 s53, s54
    s_cbranch_scc1 fok_35
    s_mov_b32 s53, 0
    s_add_u32 s54, s52, 16
    s_bfm_b64 exec, 1, 0
poll_36:
    buffer_load_dword v223, v222, s[56:59], 0 offen sc1
    s_waitcnt vmcnt(0)
    v_xor_b32 v223, s54, v223
    v_cmp_eq_u32 vcc, 0, v223
    s_nop 0
    s_cmp_eq_u64 vcc, exec
    s_cbranch_scc1 pok_37
    s_sleep 5
    s_add_u32 s53, s53, 1
    s_cmp_lt_u32 s53, s61
    s_cbranch_scc1 poll_36
    s_mov_b32 s61, 0
pok_37:
    s_mov_b64 exec, -1
fok_35:
    s_add_u32 s20, s62, 0x5d0000
    s_addc_u32 s21, s63, 0
    s_mov_b32 s22, 0x800
    s_mov_b32 s23, 0x20000
    s_and_b32 s35, s30, 1
    s_lshl_b32 s35, s35, 10
    buffer_load_dwordx4 v[16:19], v2, s[20:23], s35 offen sc1
    s_cmp_lg_u32 s60, 0
    s_cbranch_scc1 pc_38
    v_add_f32 v24, v24, v28
    v_add_f32 v25, v25, v29
    v_add_f32 v26, v26, v30
    v_add_f32 v27, v27, v31
    v_add_f32 v24, v24, v32
    v_add_f32 v25, v25, v33
    v_add_f32 v26, v26, v34
    v_add_f32 v27, v27, v35
    v_add_f32 v24, v24, v36
    v_add_f32 v25, v25, v37
    v_add_f32 v26, v26, v38
    v_add_f32 v27, v27, v39
    v_add_f32_dpp v24, v24, v24 row_ror:8 row_mask:0xf bank_mask:0xf
    v_add_f32_dpp v25, v25, v25 row_ror:8 row_mask:0xf bank_mask:0xf
    v_add_f32_dpp v26, v26, v26 row_ror:8 row_mask:0xf bank_mask:0xf
    v_add_f32_dpp v27, v27, v27 row_ror:8 row_mask:0xf bank_mask:0xf
    v_mov_b32 v28, v24
    v_mov_b32 v29, v25
    v_mov_b32 v30, v26
    v_mov_b32 v31, v27
    v_permlane16_swap_b32 v24, v28
    v_permlane16_swap_b32 v25, v29
    v_permlane16_swap_b32 v26, v30
    v_permlane16_swap_b32 v27, v31
    v_add_f32 v24, v24, v28
    v_add_f32 v25, v25, v29
    v_add_f32 v26, v26, v30
    v_add_f32 v27, v27, v31
    v_mov_b32 v28, v24
    v_mov_b32 v29, v25
    v_mov_b32 v30, v26
    v_mov_b32 v31, v27
    v_permlane32_swap_b32 v24, v28
    v_permlane32_swap_b32 v25, v29
    v_permlane32_swap_b32 v26, v30
    v_permlane32_swap_b32 v27, v31
    v_add_f32 v24, v24, v28
    v_add_f32 v25, v25, v29
    v_add_f32 v26, v26, v30
    v_add_f32 v27, v27, v31
pc_38:
    s_cmp_lg_u32 s60, 0
    s_cbranch_scc1 pc_39
    s_and_b32 s36, s30, 1
    s_mul_i32 s36, s36, 128
    s_add_u32 s36, s36, 163328
    v_add_u32 v23, s36, v2
    s_bfm_b64 exec, 8, 0
    ds_write_b128 v23, v[24:27]
    s_mov_b64 exec, -1
    s_waitcnt lgkmcnt(0)
pc_39:
    s_waitcnt vmcnt(0)
    s_and_b32 s36, s30, 1
    s_lshl_b32 s36, s36, 10
    s_add_u32 s36, s36, 160768
    v_add_u32 v221, s36, v2
    ds_write_b128 v221, v[16:19]
    s_waitcnt lgkmcnt(0)
    s_cmp_lg_u32 s30, 4
    s_cbranch_scc1 AL_nw
    s_cmp_eq_u32 s60, 0
    s_cbranch_scc1 AL_nw
    s_add_u32 s54, s55, 0xffc00300
    s_add_u32 s53, s54, s92
    v_mov_b32 v9, s53
    s_add_u32 s53, s53, 128
    v_writelane_b32 v9, s53, 1
    s_add_u32 s53, s54, s93
    v_writelane_b32 v9, s53, 2
    s_add_u32 s53, s53, 128
    v_writelane_b32 v9, s53, 3
    s_mov_b32 s53, 0
    s_add_u32 s54, s52, 8
    s_bfm_b64 exec, 4, 0
poll_41:
    buffer_load_dword v8, v9, s[56:59], 0 offen sc1
    s_waitcnt vmcnt(0)
    v_xor_b32 v8, s54, v8
    v_cmp_eq_u32 vcc, 0, v8
    s_nop 0
    s_cmp_eq_u64 vcc, exec
    s_cbranch_scc1 pok_42
    s_sleep 5
    s_add_u32 s53, s53, 1
    s_cmp_lt_u32 s53, s61
    s_cbranch_scc1 poll_41
    s_mov_b32 s61, 0
pok_42:
    s_mov_b64 exec, -1
AL_nw:
    s_and_b32 s36, s30, 1
    s_lshl_b32 s36, s36, 12
    s_add_u32 s36, s36, 32768
    v_add_u32 v6, s36, v2
    ds_read_b128 v[16:19], v6 offset:0
    ds_read_b128 v[20:23], v6 offset:1024
    ds_read_b128 v[24:27], v6 offset:2048
    ds_read_b128 v[28:31], v6 offset:3072
    ds_read_b128 v[32:35], v6 offset:8192
    ds_read_b128 v[36:39], v6 offset:9216
    ds_read_b128 v[40:43], v6 offset:10240
    ds_read_b128 v[44:47], v6 offset:11264
    s_waitcnt lgkmcnt(0)
    s_call_b64 s[76:77], SUB_before_d1
    s_barrier
    s_call_b64 s[76:77], SUB_after_g1
    s_barrier
    s_waitcnt vmcnt(0)
    s_barrier
    s_call_b64 s[76:77], SUB_after_g2
    s_and_b32 s35, s30, 1
    s_add_u32 s12, s62, 0x80000
    s_addc_u32 s13, s63, 0
    s_mov_b32 s14, 0x7e000
    s_mov_b32 s15, 0x20000
    s_mul_i32 s38, s35, 262144
    s_lshl_b32 s41, s35, 13
    s_mov_b32 s42, 0
    s_mov_b32 s44, 0
    s_add_u32 s54, s55, 0x200
    v_mov_b32 v9, s54
    s_mov_b32 s44, 1
    s_mov_b32 s42, 16384
    s_add_u32 s54, s55, 0x580
    v_mov_b32 v222, s54
    v_lshlrev_b32 v221, 3, v1
    s_add_u32 s19, s41, s42
    v_readlane_b32 s16, v248, s44
    s_nop 0
    s_add_u32 s16, s16, s38
    s_add_u32 s44, s44, 1
    s_and_b32 s44, s44, 15
    s_add_u32 s42, s42, 16384
    s_cmp_eq_u32 s42, 49152
    s_cselect_b32 s42, 0, s42
    s_mov_b32 m0, s19
    s_mov_b32 s39, s16
    s_waitcnt vmcnt(63)
    s_barrier
    s_sleep 6
    s_mov_b32 s53, 0
    s_add_u32 s54, s52, 16
    s_bfm_b64 exec, 1, 0
poll_43:
    buffer_load_dword v8, v9, s[56:59], 0 offen sc1
    s_waitcnt vmcnt(0)
    v_xor_b32 v8, s54, v8
    v_cmp_eq_u32 vcc, 0, v8
    s_nop 0
    s_cmp_eq_u64 vcc, exec
    s_cbranch_scc1 pok_44
    s_sleep 5
    s_add_u32 s53, s53, 1
    s_cmp_lt_u32 s53, s61
    s_cbranch_scc1 poll_43
    s_mov_b32 s61, 0
pok_44:
    s_mov_b64 exec, -1
    buffer_load_dwordx4 v2, s[12:15], s39 offen sc1 lds
    buffer_load_dwordx4 v2, s[12:15], s39 offen offset:1024 sc1 lds
    s_add_u32 m0, m0, 2048
    s_add_u32 s39, s39, 65536
    buffer_load_dwordx4 v2, s[12:15], s39 offen sc1 lds
    buffer_load_dwordx4 v2, s[12:15], s39 offen offset:1024 sc1 lds
    s_add_u32 s19, s41, s42
    v_readlane_b32 s16, v248, s44
    s_nop 0
    s_add_u32 s16, s16, s38
    s_add_u32 s44, s44, 1
    s_and_b32 s44, s44, 15
    s_add_u32 s42, s42, 16384
    s_cmp_eq_u32 s42, 49152
    s_cselect_b32 s42, 0, s42
    s_add_u32 m0, m0, 2048
    s_add_u32 s39, s39, 65536
    buffer_load_dwordx4 v2, s[12:15], s39 offen sc1 lds
    buffer_load_dwordx4 v2, s[12:15], s39 offen offset:1024 sc1 lds
    s_add_u32 m0, m0, 2048
    s_add_u32 s39, s39, 65536
    buffer_load_dwordx4 v2, s[12:15], s39 offen sc1 lds
    buffer_load_dwordx4 v2, s[12:15], s39 offen offset:1024 sc1 lds
    s_mov_b32 m0, s19
    s_mov_b32 s39, s16
    buffer_load_dwordx4 v2, s[12:15], s39 offen sc1 lds
    buffer_load_dwordx4 v2, s[12:15], s39 offen offset:1024 sc1 lds
    s_add_u32 m0, m0, 2048
    s_add_u32 s39, s39, 65536
    buffer_load_dwordx4 v2, s[12:15], s39 offen sc1 lds
    buffer_load_dwordx4 v2, s[12:15], s39 offen offset:1024 sc1 lds
    s_add_u32 s19, s41, s42
    v_readlane_b32 s16, v248, s44
    s_nop 0
    s_add_u32 s16, s16, s38
    s_add_u32 s44, s44, 1
    s_and_b32 s44, s44, 15
    s_add_u32 s42, s42, 16384
    s_cmp_eq_u32 s42, 49152
    s_cselect_b32 s42, 0, s42
    s_add_u32 m0, m0, 2048
    s_add_u32 s39, s39, 65536
    buffer_load_dwordx4 v2, s[12:15], s39 offen sc1 lds
    buffer_load_dwordx4 v2, s[12:15], s39 offen offset:1024 sc1 lds
    s_add_u32 m0, m0, 2048
    s_add_u32 s39, s39, 65536
    buffer_load_dwordx4 v2, s[12:15], s39 offen sc1 lds
    buffer_load_dwordx4 v2, s[12:15], s39 offen offset:1024 sc1 lds
    s_mov_b32 m0, s19
    s_mov_b32 s39, s16
    s_waitcnt vmcnt(8)
    s_barrier
    buffer_load_dwordx4 v2, s[12:15], s39 offen sc1 lds
    buffer_load_dwordx4 v2, s[12:15], s39 offen offset:1024 sc1 lds
    s_add_u32 m0, m0, 2048
    s_add_u32 s39, s39, 65536
    buffer_load_dwordx4 v2, s[12:15], s39 offen sc1 lds
    buffer_load_dwordx4 v2, s[12:15], s39 offen offset:1024 sc1 lds
    s_add_u32 s19, s41, s42
    v_readlane_b32 s16, v248, s44
    s_nop 0
    s_add_u32 s16, s16, s38
    s_add_u32 s44, s44, 1
    s_and_b32 s44, s44, 15
    s_add_u32 s42, s42, 16384
    s_cmp_eq_u32 s42, 49152
    s_cselect_b32 s42, 0, s42
    s_add_u32 m0, m0, 2048
    s_add_u32 s39, s39, 65536
    buffer_load_dwordx4 v2, s[12:15], s39 offen sc1 lds
    buffer_load_dwordx4 v2, s[12:15], s39 offen offset:1024 sc1 lds
    s_add_u32 m0, m0, 2048
    s_add_u32 s39, s39, 65536
    buffer_load_dwordx4 v2, s[12:15], s39 offen sc1 lds
    buffer_load_dwordx4 v2, s[12:15], s39 offen offset:1024 sc1 lds
    s_mov_b32 m0, s19
    s_mov_b32 s39, s16
    s_add_u32 s24, s4, 0x1420000
    s_addc_u32 s25, s5, 0
    s_mov_b32 s26, 0x70000
    s_mov_b32 s27, 0x20000
    s_cmp_eq_u32 s60, 0
    s_cselect_b32 s26, s26, 0
    s_and_b32 s36, s30, 1
    s_mul_i32 s36, s36, 448
    s_mul_i32 s37, s29, 896
    s_add_u32 s37, s36, s37
    v_lshrrev_b32 v224, 5, v1
    v_mul_u32_u24 v224, 14336, v224
    v_and_b32 v179, 496, v2
    v_add_u32 v224, v224, v179
    s_cmp_eq_u32 s60, 0
    s_cselect_b64 exec, -1, 0
    buffer_load_dwordx4 v[180:183], v224, s[24:27], s37 offen sc1
    s_add_u32 s37, s37, 28672
    buffer_load_dwordx4 v[184:187], v224, s[24:27], s37 offen sc1
    s_add_u32 s37, s37, 28672
    buffer_load_dwordx4 v[188:191], v224, s[24:27], s37 offen sc1
    s_add_u32 s37, s37, 28672
    buffer_load_dwordx4 v[192:195], v224, s[24:27], s37 offen sc1
    s_add_u32 s37, s37, 28672
    buffer_load_dwordx4 v[196:199], v224, s[24:27], s37 offen sc1
    s_add_u32 s37, s37, 28672
    s_mov_b64 exec, -1
    s_waitcnt vmcnt(13)
    s_barrier
    buffer_load_dwordx4 v2, s[12:15], s39 offen sc1 lds
    buffer_load_dwordx4 v2, s[12:15], s39 offen offset:1024 sc1 lds
    s_add_u32 m0, m0, 2048
    s_add_u32 s39, s39, 65536
    buffer_load_dwordx4 v2, s[12:15], s39 offen sc1 lds
    buffer_load_dwordx4 v2, s[12:15], s39 offen offset:1024 sc1 lds
    s_add_u32 s19, s41, s42
    v_readlane_b32 s16, v248, s44
    s_nop 0
    s_add_u32 s16, s16, s38
    s_add_u32 s44, s44, 1
    s_and_b32 s44, s44, 15
    s_add_u32 s42, s42, 16384
    s_cmp_eq_u32 s42, 49152
    s_cselect_b32 s42, 0, s42
    s_add_u32 m0, m0, 2048
    s_add_u32 s39, s39, 65536
    buffer_load_dwordx4 v2, s[12:15], s39 offen sc1 lds
    buffer_load_dwordx4 v2, s[12:15], s39 offen offset:1024 sc1 lds
    s_add_u32 m0, m0, 2048
    s_add_u32 s39, s39, 65536
    buffer_load_dwordx4 v2, s[12:15], s39 offen sc1 lds
    buffer_load_dwordx4 v2, s[12:15], s39 offen offset:1024 sc1 lds
    s_mov_b32 m0, s19
    s_mov_b32 s39, s16
    s_cmp_eq_u32 s60, 0
    s_cselect_b64 exec, -1, 0
    buffer_load_dwordx4 v[200:203], v224, s[24:27], s37 offen sc1
    s_add_u32 s37, s37, 28672
    buffer_load_dwordx4 v[204:207], v224, s[24:27], s37 offen sc1
    s_add_u32 s37, s37, 28672
    buffer_load_dwordx4 v[208:211], v224, s[24:27], s37 offen sc1
    s_add_u32 s37, s37, 28672
    buffer_load_dwordx4 v[212:215], v224, s[24:27], s37 offen sc1
    s_add_u32 s37, s37, 28672
    s_mov_b64 exec, -1
    s_waitcnt vmcnt(17)
    s_barrier
    buffer_load_dwordx4 v2, s[12:15], s39 offen sc1 lds
    buffer_load_dwordx4 v2, s[12:15], s39 offen offset:1024 sc1 lds
    s_add_u32 m0, m0, 2048
    s_add_u32 s39, s39, 65536
    buffer_load_dwordx4 v2, s[12:15], s39 offen sc1 lds
    buffer_load_dwordx4 v2, s[12:15], s39 offen offset:1024 sc1 lds
    s_add_u32 s19, s41, s42
    v_readlane_b32 s16, v248, s44
    s_nop 0
    s_add_u32 s16, s16, s38
    s_add_u32 s44, s44, 1
    s_and_b32 s44, s44, 15
    s_add_u32 s42, s42, 16384
    s_cmp_eq_u32 s42, 49152
    s_cselect_b32 s42, 0, s42
    s_add_u32 m0, m0, 2048
    s_add_u32 s39, s39, 65536
    buffer_load_dwordx4 v2, s[12:15], s39 offen sc1 lds
    buffer_load_dwordx4 v2, s[12:15], s39 offen offset:1024 sc1 lds
    s_add_u32 m0, m0, 2048
    s_add_u32 s39, s39, 65536
    buffer_load_dwordx4 v2, s[12:15], s39 offen sc1 lds
    buffer_load_dwordx4 v2, s[12:15], s39 offen offset:1024 sc1 lds
    s_mov_b32 m0, s19
    s_mov_b32 s39, s16
    s_waitcnt vmcnt(12)
    s_barrier
    buffer_load_dwordx4 v2, s[12:15], s39 offen sc1 lds
    buffer_load_dwordx4 v2, s[12:15], s39 offen offset:1024 sc1 lds
    s_add_u32 m0, m0, 2048
    s_add_u32 s39, s39, 65536
    buffer_load_dwordx4 v2, s[12:15], s39 offen sc1 lds
    buffer_load_dwordx4 v2, s[12:15], s39 offen offset:1024 sc1 lds
    s_add_u32 s19, s41, s42
    v_readlane_b32 s16, v248, s44
    s_nop 0
    s_add_u32 s16, s16, s38
    s_add_u32 s44, s44, 1
    s_and_b32 s44, s44, 15
    s_add_u32 s42, s42, 16384
    s_cmp_eq_u32 s42, 49152
    s_cselect_b32 s42, 0, s42
    s_add_u32 m0, m0, 2048
    s_add_u32 s39, s39, 65536
    buffer_load_dwordx4 v2, s[12:15], s39 offen sc1 lds
    buffer_load_dwordx4 v2, s[12:15], s39 offen offset:1024 sc1 lds
    s_add_u32 m0, m0, 2048
    s_add_u32 s39, s39, 65536
    buffer_load_dwordx4 v2, s[12:15], s39 offen sc1 lds
    buffer_load_dwordx4 v2, s[12:15], s39 offen offset:1024 sc1 lds
    s_mov_b32 m0, s19
    s_mov_b32 s39, s16
    s_waitcnt vmcnt(16)
    s_cmp_lg_u32 s60, 0
    s_cbranch_scc1 pc_45
    v_add_f32 v180, v180, v184
    v_add_f32 v181, v181, v185
    v_add_f32 v182, v182, v186
    v_add_f32 v183, v183, v187
    v_add_f32 v180, v180, v188
    v_add_f32 v181, v181, v189
    v_add_f32 v182, v182, v190
    v_add_f32 v183, v183, v191
    v_add_f32 v180, v180, v192
    v_add_f32 v181, v181, v193
    v_add_f32 v182, v182, v194
    v_add_f32 v183, v183, v195
    v_add_f32 v180, v180, v196
    v_add_f32 v181, v181, v197
    v_add_f32 v182, v182, v198
    v_add_f32 v183, v183, v199
    v_add_f32 v180, v180, v200
    v_add_f32 v181, v181, v201
    v_add_f32 v182, v182, v202
    v_add_f32 v183, v183, v203
    v_add_f32 v180, v180, v204
    v_add_f32 v181, v181, v205
    v_add_f32 v182, v182, v206
    v_add_f32 v183, v183, v207
    v_add_f32 v180, v180, v208
    v_add_f32 v181, v181, v209
    v_add_f32 v182, v182, v210
    v_add_f32 v183, v183, v211
    v_add_f32 v180, v180, v212
    v_add_f32 v181, v181, v213
    v_add_f32 v182, v182, v214
    v_add_f32 v183, v183, v215
pc_45:
    s_cmp_eq_u32 s60, 0
    s_cselect_b64 exec, -1, 0
    buffer_load_dwordx4 v[184:187], v224, s[24:27], s37 offen sc1
    s_add_u32 s37, s37, 28672
    buffer_load_dwordx4 v[188:191], v224, s[24:27], s37 offen sc1
    s_add_u32 s37, s37, 28672
    buffer_load_dwordx4 v[192:195], v224, s[24:27], s37 offen sc1
    s_add_u32 s37, s37, 28672
    buffer_load_dwordx4 v[196:199], v224, s[24:27], s37 offen sc1
    s_add_u32 s37, s37, 28672
    buffer_load_dwordx4 v[200:203], v224, s[24:27], s37 offen sc1
    s_add_u32 s37, s37, 28672
    buffer_load_dwordx4 v[204:207], v224, s[24:27], s37 offen sc1
    s_add_u32 s37, s37, 28672
    buffer_load_dwordx4 v[208:211], v224, s[24:27], s37 offen sc1
    s_add_u32 s37, s37, 28672
    s_mov_b64 exec, -1
    s_waitcnt vmcnt(15)
    s_barrier
    buffer_load_dwordx4 v2, s[12:15], s39 offen sc1 lds
    buffer_load_dwordx4 v2, s[12:15], s39 offen offset:1024 sc1 lds
    s_add_u32 m0, m0, 2048
    s_add_u32 s39, s39, 65536
    buffer_load_dwordx4 v2, s[12:15], s39 offen sc1 lds
    buffer_load_dwordx4 v2, s[12:15], s39 offen offset:1024 sc1 lds
    s_add_u32 s19, s41, s42
    v_readlane_b32 s16, v248, s44
    s_nop 0
    s_add_u32 s16, s16, s38
    s_add_u32 s44, s44, 1
    s_and_b32 s44, s44, 15
    s_add_u32 s42, s42, 16384
    s_cmp_eq_u32 s42, 49152
    s_cselect_b32 s42, 0, s42
    s_add_u32 m0, m0, 2048
    s_add_u32 s39, s39, 65536
    buffer_load_dwordx4 v2, s[12:15], s39 offen sc1 lds
    buffer_load_dwordx4 v2, s[12:15], s39 offen offset:1024 sc1 lds
    s_add_u32 m0, m0, 2048
    s_add_u32 s39, s39, 65536
    buffer_load_dwordx4 v2, s[12:15], s39 offen sc1 lds
    buffer_load_dwordx4 v2, s[12:15], s39 offen offset:1024 sc1 lds
    s_mov_b32 m0, s19
    s_mov_b32 s39, s16
    s_mov_b64 exec, 1
    buffer_load_dword v223, v222, s[56:59], 0 offen sc1
    s_mov_b64 exec, -1
    s_waitcnt vmcnt(16)
    s_barrier
    buffer_load_dwordx4 v2, s[12:15], s39 offen sc1 lds
    buffer_load_dwordx4 v2, s[12:15], s39 offen offset:1024 sc1 lds
    s_add_u32 m0, m0, 2048
    s_add_u32 s39, s39, 65536
    buffer_load_dwordx4 v2, s[12:15], s39 offen sc1 lds
    buffer_load_dwordx4 v2, s[12:15], s39 offen offset:1024 sc1 lds
    s_add_u32 s19, s41, s42
    v_readlane_b32 s16, v248, s44
    s_nop 0
    s_add_u32 s16, s16, s38
    s_add_u32 s44, s44, 1
    s_and_b32 s44, s44, 15
    s_add_u32 s42, s42, 16384
    s_cmp_eq_u32 s42, 49152
    s_cselect_b32 s42, 0, s42
    s_add_u32 m0, m0, 2048
    s_add_u32 s39, s39, 65536
    buffer_load_dwordx4 v2, s[12:15], s39 offen sc1 lds
    buffer_load_dwordx4 v2, s[12:15], s39 offen offset:1024 sc1 lds
    s_add_u32 m0, m0, 2048
    s_add_u32 s39, s39, 65536
    buffer_load_dwordx4 v2, s[12:15], s39 offen sc1 lds
    buffer_load_dwordx4 v2, s[12:15], s39 offen offset:1024 sc1 lds
    s_mov_b32 m0, s19
    s_mov_b32 s39, s16
    s_waitcnt vmcnt(17)
    s_cmp_lg_u32 s60, 0
    s_cbranch_scc1 pc_46
    v_add_f32 v180, v180, v184
    v_add_f32 v181, v181, v185
    v_add_f32 v182, v182, v186
    v_add_f32 v183, v183, v187
    v_add_f32 v180, v180, v188
    v_add_f32 v181, v181, v189
    v_add_f32 v182, v182, v190
    v_add_f32 v183, v183, v191
    v_add_f32 v180, v180, v192
    v_add_f32 v181, v181, v193
    v_add_f32 v182, v182, v194
    v_add_f32 v183, v183, v195
    v_add_f32 v180, v180, v196
    v_add_f32 v181, v181, v197
    v_add_f32 v182, v182, v198
    v_add_f32 v183, v183, v199
    v_add_f32 v180, v180, v200
    v_add_f32 v181, v181, v201
    v_add_f32 v182, v182, v202
    v_add_f32 v183, v183, v203
    v_add_f32 v180, v180, v204
    v_add_f32 v181, v181, v205
    v_add_f32 v182, v182, v206
    v_add_f32 v183, v183, v207
    v_add_f32 v180, v180, v208
    v_add_f32 v181, v181, v209
    v_add_f32 v182, v182, v210
    v_add_f32 v183, v183, v211
pc_46:
    s_waitcnt vmcnt(9)
    s_barrier
    buffer_load_dwordx4 v2, s[12:15], s39 offen sc1 lds
    buffer_load_dwordx4 v2, s[12:15], s39 offen offset:1024 sc1 lds
    s_add_u32 m0, m0, 2048
    s_add_u32 s39, s39, 65536
    buffer_load_dwordx4 v2, s[12:15], s39 offen sc1 lds
    buffer_load_dwordx4 v2, s[12:15], s39 offen offset:1024 sc1 lds
    s_add_u32 s19, s41, s42
    v_readlane_b32 s16, v248, s44
    s_nop 0
    s_add_u32 s16, s16, s38
    s_add_u32 s44, s44, 1
    s_and_b32 s44, s44, 15
    s_add_u32 s42, s42, 16384
    s_cmp_eq_u32 s42, 49152
    s_cselect_b32 s42, 0, s42
    s_add_u32 m0, m0, 2048
    s_add_u32 s39, s39, 65536
    buffer_load_dwordx4 v2, s[12:15], s39 offen sc1 lds
    buffer_load_dwordx4 v2, s[12:15], s39 offen offset:1024 sc1 lds
    s_add_u32 m0, m0, 2048
    s_add_u32 s39, s39, 65536
    buffer_load_dwordx4 v2, s[12:15], s39 offen sc1 lds
    buffer_load_dwordx4 v2, s[12:15], s39 offen offset:1024 sc1 lds
    s_mov_b32 m0, s19
    s_mov_b32 s39, s16
    s_cmp_lg_u32 s60, 0
    s_cbranch_scc1 pc_47
    v_mov_b32 v184, v180
    v_mov_b32 v185, v181
    v_mov_b32 v186, v182
    v_mov_b32 v187, v183
    v_permlane32_swap_b32 v180, v184
    v_permlane32_swap_b32 v181, v185
    v_permlane32_swap_b32 v182, v186
    v_permlane32_swap_b32 v183, v187
    v_add_f32 v180, v180, v184
    v_add_f32 v181, v181, v185
    v_add_f32 v182, v182, v186
    v_add_f32 v183, v183, v187
    s_and_b32 s36, s30, 1
    s_mul_i32 s36, s36, 448
    s_add_u32 s36, s36, 159744
    v_add_u32 v179, s36, v2
    s_bfm_b64 exec, 28, 0
    ds_write_b128 v179, v[180:183]
    s_mov_b64 exec, -1
    s_waitcnt lgkmcnt(0)
pc_47:
    s_waitcnt vmcnt(16)
    v_readfirstlane_b32 s53, v223
    s_add_u32 s54, s52, 16
    s_cmp_eq_u32 s53, s54
    s_cbranch_scc1 fok_48
    s_mov_b32 s53, 0
    s_add_u32 s54, s52, 16
    s_bfm_b64 exec, 1, 0
poll_49:
    buffer_load_dword v223, v222, s[56:59], 0 offen sc1
    s_waitcnt vmcnt(0)
    v_xor_b32 v223, s54, v223
    v_cmp_eq_u32 vcc, 0, v223
    s_nop 0
    s_cmp_eq_u64 vcc, exec
    s_cbranch_scc1 pok_50
    s_sleep 5
    s_add_u32 s53, s53, 1
    s_cmp_lt_u32 s53, s61
    s_cbranch_scc1 poll_49
    s_mov_b32 s61, 0
pok_50:
    s_mov_b64 exec, -1
fok_48:
    s_add_u32 s20, s62, 0x5c8000
    s_addc_u32 s21, s63, 0
    s_mov_b32 s22, 0x6000
    s_mov_b32 s23, 0x20000
    s_and_b32 s35, s30, 1
    s_lshl_b32 s35, s35, 9
    s_add_u32 s36, s35, 0
    buffer_load_dwordx2 v[184:185], v221, s[20:23], s36 offen offset:0 sc1
    buffer_load_dwordx2 v[186:187], v221, s[20:23], s36 offen offset:1024 sc1
    buffer_load_dwordx2 v[188:189], v221, s[20:23], s36 offen offset:2048 sc1
    buffer_load_dwordx2 v[190:191], v221, s[20:23], s36 offen offset:3072 sc1
    s_waitcnt vmcnt(12)
    s_barrier
    buffer_load_dwordx4 v2, s[12:15], s39 offen sc1 lds
    buffer_load_dwordx4 v2, s[12:15], s39 offen offset:1024 sc1 lds
    s_add_u32 m0, m0, 2048
    s_add_u32 s39, s39, 65536
    buffer_load_dwordx4 v2, s[12:15], s39 offen sc1 lds
    buffer_load_dwordx4 v2, s[12:15], s39 offen offset:1024 sc1 lds
    s_add_u32 s19, s41, s42
    v_readlane_b32 s16, v248, s44
    s_nop 0
    s_add_u32 s16, s16, s38
    s_add_u32 s44, s44, 1
    s_and_b32 s44, s44, 15
    s_add_u32 s42, s42, 16384
    s_cmp_eq_u32 s42, 49152
    s_cselect_b32 s42, 0, s42
    s_add_u32 m0, m0, 2048
    s_add_u32 s39, s39, 65536
    buffer_load_dwordx4 v2, s[12:15], s39 offen sc1 lds
    buffer_load_dwordx4 v2, s[12:15], s39 offen offset:1024 sc1 lds
    s_add_u32 m0, m0, 2048
    s_add_u32 s39, s39, 65536
    buffer_load_dwordx4 v2, s[12:15], s39 offen sc1 lds
    buffer_load_dwordx4 v2, s[12:15], s39 offen offset:1024 sc1 lds
    s_mov_b32 m0, s19
    s_mov_b32 s39, s16
    s_add_u32 s36, s35, 4096
    buffer_load_dwordx2 v[192:193], v221, s[20:23], s36 offen offset:0 sc1
    buffer_load_dwordx2 v[194:195], v221, s[20:23], s36 offen offset:1024 sc1
    buffer_load_dwordx2 v[196:197], v221, s[20:23], s36 offen offset:2048 sc1
    buffer_load_dwordx2 v[198:199], v221, s[20:23], s36 offen offset:3072 sc1
    s_add_u32 s36, s35, 16384
    buffer_load_dwordx2 v[200:201], v221, s[20:23], s36 offen offset:0 sc1
    buffer_load_dwordx2 v[202:203], v221, s[20:23], s36 offen offset:1024 sc1
    s_waitcnt vmcnt(18)
    s_barrier
    buffer_load_dwordx4 v2, s[12:15], s39 offen sc1 lds
    buffer_load_dwordx4 v2, s[12:15], s39 offen offset:1024 sc1 lds
    s_add_u32 m0, m0, 2048
    s_add_u32 s39, s39, 65536
    buffer_load_dwordx4 v2, s[12:15], s39 offen sc1 lds
    buffer_load_dwordx4 v2, s[12:15], s39 offen offset:1024 sc1 lds
    s_add_u32 s19, s41, s42
    v_readlane_b32 s16, v248, s44
    s_nop 0
    s_add_u32 s16, s16, s38
    s_add_u32 s44, s44, 1
    s_and_b32 s44, s44, 15
    s_add_u32 s42, s42, 16384
    s_cmp_eq_u32 s42, 49152
    s_cselect_b32 s42, 0, s42
    s_add_u32 m0, m0, 2048
    s_add_u32 s39, s39, 65536
    buffer_load_dwordx4 v2, s[12:15], s39 offen sc1 lds
    buffer_load_dwordx4 v2, s[12:15], s39 offen offset:1024 sc1 lds
    s_add_u32 m0, m0, 2048
    s_add_u32 s39, s39, 65536
    buffer_load_dwordx4 v2, s[12:15], s39 offen sc1 lds
    buffer_load_dwordx4 v2, s[12:15], s39 offen offset:1024 sc1 lds
    s_mov_b32 m0, s19
    s_mov_b32 s39, s16
    s_add_u32 s36, s35, 16384
    buffer_load_dwordx2 v[204:205], v221, s[20:23], s36 offen offset:2048 sc1
    buffer_load_dwordx2 v[206:207], v221, s[20:23], s36 offen offset:3072 sc1
    s_add_u32 s36, s35, 20480
    buffer_load_dwordx2 v[208:209], v221, s[20:23], s36 offen offset:0 sc1
    buffer_load_dwordx2 v[210:211], v221, s[20:23], s36 offen offset:1024 sc1
    buffer_load_dwordx2 v[212:213], v221, s[20:23], s36 offen offset:2048 sc1
    buffer_load_dwordx2 v[214:215], v221, s[20:23], s36 offen offset:3072 sc1
    s_waitcnt vmcnt(20)
    s_barrier
    buffer_load_dwordx4 v2, s[12:15], s39 offen sc1 lds
    buffer_load_dwordx4 v2, s[12:15], s39 offen offset:1024 sc1 lds
    s_add_u32 m0, m0, 2048
    s_add_u32 s39, s39, 65536
    buffer_load_dwordx4 v2, s[12:15], s39 offen sc1 lds
    buffer_load_dwordx4 v2, s[12:15], s39 offen offset:1024 sc1 lds
    s_add_u32 s19, s41, s42
    v_readlane_b32 s16, v248, s44
    s_nop 0
    s_add_u32 s16, s16, s38
    s_add_u32 s44, s44, 1
    s_and_b32 s44, s44, 15
    s_add_u32 s42, s42, 16384
    s_cmp_eq_u32 s42, 49152
    s_cselect_b32 s42, 0, s42
    s_add_u32 m0, m0, 2048
    s_add_u32 s39, s39, 65536
    buffer_load_dwordx4 v2, s[12:15], s39 offen sc1 lds
    buffer_load_dwordx4 v2, s[12:15], s39 offen offset:1024 sc1 lds
    s_add_u32 m0, m0, 2048
    s_add_u32 s39, s39, 65536
    buffer_load_dwordx4 v2, s[12:15], s39 offen sc1 lds
    buffer_load_dwordx4 v2, s[12:15], s39 offen offset:1024 sc1 lds
    s_mov_b32 m0, s19
    s_mov_b32 s39, s16
    s_waitcnt vmcnt(14)
    s_barrier
    buffer_load_dwordx4 v2, s[12:15], s39 offen sc1 lds
    buffer_load_dwordx4 v2, s[12:15], s39 offen offset:1024 sc1 lds
    s_add_u32 m0, m0, 2048
    s_add_u32 s39, s39, 65536
    buffer_load_dwordx4 v2, s[12:15], s39 offen sc1 lds
    buffer_load_dwordx4 v2, s[12:15], s39 offen offset:1024 sc1 lds
    s_add_u32 s19, s41, s42
    v_readlane_b32 s16, v248, s44
    s_nop 0
    s_add_u32 s16, s16, s38
    s_add_u32 s44, s44, 1
    s_and_b32 s44, s44, 15
    s_add_u32 s42, s42, 16384
    s_cmp_eq_u32 s42, 49152
    s_cselect_b32 s42, 0, s42
    s_add_u32 m0, m0, 2048
    s_add_u32 s39, s39, 65536
    buffer_load_dwordx4 v2, s[12:15], s39 offen sc1 lds
    buffer_load_dwordx4 v2, s[12:15], s39 offen offset:1024 sc1 lds
    s_add_u32 m0, m0, 2048
    s_add_u32 s39, s39, 65536
    buffer_load_dwordx4 v2, s[12:15], s39 offen sc1 lds
    buffer_load_dwordx4 v2, s[12:15], s39 offen offset:1024 sc1 lds
    s_mov_b32 m0, s19
    s_mov_b32 s39, s16
    s_waitcnt vmcnt(16)
    v_add_f32 v184, v184, v200
    v_add_f32 v185, v185, v201
    v_add_f32 v186, v186, v202
    v_add_f32 v187, v187, v203
    v_add_f32 v188, v188, v204
    v_add_f32 v189, v189, v205
    v_add_f32 v190, v190, v206
    v_add_f32 v191, v191, v207
    v_add_f32 v192, v192, v208
    v_add_f32 v193, v193, v209
    v_add_f32 v194, v194, v210
    v_add_f32 v195, v195, v211
    v_add_f32 v196, v196, v212
    v_add_f32 v197, v197, v213
    v_add_f32 v198, v198, v214
    v_add_f32 v199, v199, v215
    s_waitcnt vmcnt(8)
    s_barrier
    buffer_load_dwordx4 v2, s[12:15], s39 offen sc1 lds
    buffer_load_dwordx4 v2, s[12:15], s39 offen offset:1024 sc1 lds
    s_add_u32 m0, m0, 2048
    s_add_u32 s39, s39, 65536
    buffer_load_dwordx4 v2, s[12:15], s39 offen sc1 lds
    buffer_load_dwordx4 v2, s[12:15], s39 offen offset:1024 sc1 lds
    s_add_u32 s19, s41, s42
    v_readlane_b32 s16, v248, s44
    s_nop 0
    s_add_u32 s16, s16, s38
    s_add_u32 s44, s44, 1
    s_and_b32 s44, s44, 15
    s_add_u32 s42, s42, 16384
    s_cmp_eq_u32 s42, 49152
    s_cselect_b32 s42, 0, s42
    s_add_u32 m0, m0, 2048
    s_add_u32 s39, s39, 65536
    buffer_load_dwordx4 v2, s[12:15], s39 offen sc1 lds
    buffer_load_dwordx4 v2, s[12:15], s39 offen offset:1024 sc1 lds
    s_add_u32 m0, m0, 2048
    s_add_u32 s39, s39, 65536
    buffer_load_dwordx4 v2, s[12:15], s39 offen sc1 lds
    buffer_load_dwordx4 v2, s[12:15], s39 offen offset:1024 sc1 lds
    s_mov_b32 m0, s19
    s_mov_b32 s39, s16
    v_add_f32 v184, v184, v192
    v_add_f32 v185, v185, v193
    v_add_f32 v186, v186, v194
    v_add_f32 v187, v187, v195
    v_add_f32 v188, v188, v196
    v_add_f32 v189, v189, v197
    v_add_f32 v190, v190, v198
    v_add_f32 v191, v191, v199
    v_add_f32 v184, v184, v188
    v_add_f32 v185, v185, v189
    v_add_f32 v186, v186, v190
    v_add_f32 v187, v187, v191
    v_add_f32 v184, v184, v186
    v_add_f32 v185, v185, v187
    v_mul_f32 v188, 0x3a800000, v184
    v_mul_f32 v217, 0x3a800000, v185
    s_waitcnt vmcnt(8)
    s_barrier
    buffer_load_dwordx4 v2, s[12:15], s39 offen sc1 lds
    buffer_load_dwordx4 v2, s[12:15], s39 offen offset:1024 sc1 lds
    s_add_u32 m0, m0, 2048
    s_add_u32 s39, s39, 65536
    buffer_load_dwordx4 v2, s[12:15], s39 offen sc1 lds
    buffer_load_dwordx4 v2, s[12:15], s39 offen offset:1024 sc1 lds
    s_add_u32 m0, m0, 2048
    s_add_u32 s39, s39, 65536
    buffer_load_dwordx4 v2, s[12:15], s39 offen sc1 lds
    buffer_load_dwordx4 v2, s[12:15], s39 offen offset:1024 sc1 lds
    s_add_u32 m0, m0, 2048
    s_add_u32 s39, s39, 65536
    buffer_load_dwordx4 v2, s[12:15], s39 offen sc1 lds
    buffer_load_dwordx4 v2, s[12:15], s39 offen offset:1024 sc1 lds
    v_fma_f32 v217, -v188, v188, v217
    v_max_f32 v217, 0, v217
    v_add_f32 v217, 0x3727c5ac, v217
    v_sqrt_f32 v217, v217
    s_nop 0
    v_mov_b32 v189, v217
    v_rcp_f32 v219, v217
    s_nop 0
    v_mul_f32 v190, 0xc0135761, v219
    v_mul_f32 v191, v219, v219
    v_mul_f32 v191, v191, v190
    v_mul_f32 v191, 0x3d372713, v191
    s_lshl_b32 s35, s35, 1
    s_add_u32 s35, s35, 160768
    v_add_u32 v220, s35, v2
    ds_write_b128 v220, v[188:191]
    s_waitcnt lgkmcnt(0)
    s_waitcnt vmcnt(8)
    s_barrier
    s_mov_b64 s[48:49], s[74:75]
    s_mov_b32 s50, 7340032
    s_mov_b32 s51, 0x20000
    s_lshl_b32 s45, s2, 1
    s_and_b32 s46, s30, 1
    s_add_u32 s45, s45, s46
    s_mul_i32 s45, s45, 14336
    s_cmp_eq_u32 s60, 0
    s_cselect_b64 exec, -1, 0
    s_add_u32 s46, s45, 0
    buffer_load_dwordx4 v[176:179], v2, s[48:51], s46 offen
    s_add_u32 s46, s45, 1024
    buffer_load_dwordx4 v[176:179], v2, s[48:51], s46 offen
    s_add_u32 s46, s45, 2048
    buffer_load_dwordx4 v[176:179], v2, s[48:51], s46 offen
    s_add_u32 s46, s45, 3072
    buffer_load_dwordx4 v[176:179], v2, s[48:51], s46 offen
    s_add_u32 s46, s45, 4096
    buffer_load_dwordx4 v[176:179], v2, s[48:51], s46 offen
    s_add_u32 s46, s45, 5120
    buffer_load_dwordx4 v[176:179], v2, s[48:51], s46 offen
    s_add_u32 s46, s45, 6144
    buffer_load_dwordx4 v[176:179], v2, s[48:51], s46 offen
    s_add_u32 s46, s45, 7168
    buffer_load_dwordx4 v[176:179], v2, s[48:51], s46 offen
    s_add_u32 s46, s45, 8192
    buffer_load_dwordx4 v[176:179], v2, s[48:51], s46 offen
    s_add_u32 s46, s45, 9216
    buffer_load_dwordx4 v[176:179], v2, s[48:51], s46 offen
    s_add_u32 s46, s45, 10240
    buffer_load_dwordx4 v[176:179], v2, s[48:51], s46 offen
    s_add_u32 s46, s45, 11264
    buffer_load_dwordx4 v[176:179], v2, s[48:51], s46 offen
    s_add_u32 s46, s45, 12288
    buffer_load_dwordx4 v[176:179], v2, s[48:51], s46 offen
    s_add_u32 s46, s45, 13312
    buffer_load_dwordx4 v[176:179], v2, s[48:51], s46 offen
    s_mov_b64 exec, -1
    s_waitcnt vmcnt(14)
    s_barrier
    s_barrier
    s_cmp_lg_u32 s60, 0
    s_cbranch_scc1 rp_54
    s_call_b64 s[76:77], SUB_r_pre
rp_54:
    s_and_b32 s35, s30, 1
    s_add_u32 s12, s62, 0x400000
    s_addc_u32 s13, s63, 0
    s_mov_b32 s14, 0x1be000
    s_mov_b32 s15, 0x20000
    s_mul_i32 s38, s35, 917504
    s_mul_i32 s36, s31, 114688
    s_add_u32 s38, s38, s36
    s_lshl_b32 s41, s35, 13
    s_mov_b32 s42, 0
    s_mov_b32 s44, 0
    s_add_u32 s54, s55, 0x700
    s_lshl_b32 s53, s31, 7
    s_add_u32 s54, s54, s53
    v_mov_b32 v9, s54
    s_add_u32 s54, s55, 0x600
    s_lshl_b32 s53, s31, 7
    s_add_u32 s54, s54, s53
    v_mov_b32 v10, s54
    s_add_u32 s54, s55, 0x300
    s_lshl_b32 s53, s31, 7
    s_add_u32 s54, s54, s53
    v_mov_b32 v12, s54
    v_mov_b32 v13, 1
    s_and_b32 s51, s30, 1
    s_lshl_b32 s51, s51, 30
    s_lshl_b32 s54, s60, 2
    s_add_u32 s54, s54, 4
    v_mov_b32 v14, 162880
spin_55:
    s_sleep 2
    ds_read_b32 v15, v14
    s_waitcnt lgkmcnt(0)
    v_readfirstlane_b32 s53, v15
    s_nop 0
    s_cmp_ge_u32 s53, s54
    s_cbranch_scc0 spin_55
    s_mov_b64 exec, 1
    buffer_atomic_add v13, v9, s[56:59], s51 offen sc1
    s_mov_b64 exec, -1
    v_xor_b32 v15, 128, v12
    s_mov_b32 s44, 3
    s_call_b64 s[76:77], PREP_a_issue_4
    s_mov_b32 m0, s19
    s_mov_b32 s39, s16
    s_mov_b32 s40, s17
    s_waitcnt vmcnt(16)
    s_barrier
    s_mov_b64 exec, 1
    buffer_load_dword v8, v9, s[56:59], 0 offen sc1
    s_mov_b64 exec, -1
    s_waitcnt vmcnt(9)
    s_barrier
    s_waitcnt vmcnt(0)
    v_readfirstlane_b32 s53, v8
    s_add_u32 s54, s52, 8
    s_cmp_eq_u32 s53, s54
    s_cbranch_scc1 fok_56
    s_mov_b32 s53, 0
    s_add_u32 s54, s52, 8
    s_bfm_b64 exec, 1, 0
poll_57:
    buffer_load_dword v8, v9, s[56:59], 0 offen sc1
    s_waitcnt vmcnt(0)
    v_xor_b32 v8, s54, v8
    v_cmp_eq_u32 vcc, 0, v8
    s_nop 0
    s_cmp_eq_u64 vcc, exec
    s_cbranch_scc1 pok_58
    s_sleep 5
    s_add_u32 s53, s53, 1
    s_cmp_lt_u32 s53, s61
    s_cbranch_scc1 poll_57
    s_mov_b32 s61, 0
pok_58:
    s_mov_b64 exec, -1
fok_56:
    buffer_load_dwordx4 v2, s[12:15], s39 offen sc1 lds
    s_add_u32 m0, m0, 1024
    s_nop 0
    buffer_load_dwordx4 v2, s[12:15], s40 offen sc1 lds
    s_add_u32 m0, m0, 1024
    s_add_u32 s39, s39, 229376
    buffer_load_dwordx4 v2, s[12:15], s39 offen sc1 lds
    s_add_u32 m0, m0, 1024
    s_add_u32 s40, s40, 229376
    buffer_load_dwordx4 v2, s[12:15], s40 offen sc1 lds
    s_call_b64 s[76:77], PREP_a_issue_4
    s_add_u32 m0, m0, 1024
    s_add_u32 s39, s39, 229376
    buffer_load_dwordx4 v2, s[12:15], s39 offen sc1 lds
    s_add_u32 m0, m0, 1024
    s_add_u32 s40, s40, 229376
    buffer_load_dwordx4 v2, s[12:15], s40 offen sc1 lds
    s_add_u32 m0, m0, 1024
    s_add_u32 s39, s39, 229376
    buffer_load_dwordx4 v2, s[12:15], s39 offen sc1 lds
    s_add_u32 m0, m0, 1024
    s_add_u32 s40, s40, 229376
    buffer_load_dwordx4 v2, s[12:15], s40 offen sc1 lds
    s_mov_b32 m0, s19
    s_mov_b32 s39, s16
    s_mov_b32 s40, s17
    s_waitcnt vmcnt(9)
    s_barrier
    s_mov_b64 exec, 1
    buffer_atomic_add v13, v10, s[56:59], s51 offen sc1
    s_mov_b64 exec, -1
    buffer_load_dwordx4 v2, s[12:15], s39 offen sc1 lds
    s_add_u32 m0, m0, 1024
    s_nop 0
    buffer_load_dwordx4 v2, s[12:15], s40 offen sc1 lds
    s_add_u32 m0, m0, 1024
    s_add_u32 s39, s39, 229376
    buffer_load_dwordx4 v2, s[12:15], s39 offen sc1 lds
    s_add_u32 m0, m0, 1024
    s_add_u32 s40, s40, 229376
    buffer_load_dwordx4 v2, s[12:15], s40 offen sc1 lds
    s_call_b64 s[76:77], PREP_a_issue_4
    s_add_u32 m0, m0, 1024
    s_add_u32 s39, s39, 229376
    buffer_load_dwordx4 v2, s[12:15], s39 offen sc1 lds
    s_add_u32 m0, m0, 1024
    s_add_u32 s40, s40, 229376
    buffer_load_dwordx4 v2, s[12:15], s40 offen sc1 lds
    s_add_u32 m0, m0, 1024
    s_add_u32 s39, s39, 229376
    buffer_load_dwordx4 v2, s[12:15], s39 offen sc1 lds
    s_add_u32 m0, m0, 1024
    s_add_u32 s40, s40, 229376
    buffer_load_dwordx4 v2, s[12:15], s40 offen sc1 lds
    s_mov_b32 m0, s19
    s_mov_b32 s39, s16
    s_mov_b32 s40, s17
    s_waitcnt vmcnt(9)
    s_barrier
    buffer_load_dwordx4 v2, s[12:15], s39 offen sc1 lds
    s_add_u32 m0, m0, 1024
    s_nop 0
    buffer_load_dwordx4 v2, s[12:15], s40 offen sc1 lds
    s_add_u32 m0, m0, 1024
    s_add_u32 s39, s39, 229376
    buffer_load_dwordx4 v2, s[12:15], s39 offen sc1 lds
    s_add_u32 m0, m0, 1024
    s_add_u32 s40, s40, 229376
    buffer_load_dwordx4 v2, s[12:15], s40 offen sc1 lds
    s_call_b64 s[76:77], PREP_a_issue_4
    s_add_u32 m0, m0, 1024
    s_add_u32 s39, s39, 229376
    buffer_load_dwordx4 v2, s[12:15], s39 offen sc1 lds
    s_add_u32 m0, m0, 1024
    s_add_u32 s40, s40, 229376
    buffer_load_dwordx4 v2, s[12:15], s40 offen sc1 lds
    s_add_u32 m0, m0, 1024
    s_add_u32 s39, s39, 229376
    buffer_load_dwordx4 v2, s[12:15], s39 offen sc1 lds
    s_add_u32 m0, m0, 1024
    s_add_u32 s40, s40, 229376
    buffer_load_dwordx4 v2, s[12:15], s40 offen sc1 lds
    s_mov_b32 m0, s19
    s_mov_b32 s39, s16
    s_mov_b32 s40, s17
    s_waitcnt vmcnt(8)
    s_barrier
    buffer_load_dwordx4 v2, s[12:15], s39 offen sc1 lds
    s_add_u32 m0, m0, 1024
    s_nop 0
    buffer_load_dwordx4 v2, s[12:15], s40 offen sc1 lds
    s_add_u32 m0, m0, 1024
    s_add_u32 s39, s39, 229376
    buffer_load_dwordx4 v2, s[12:15], s39 offen sc1 lds
    s_add_u32 m0, m0, 1024
    s_add_u32 s40, s40, 229376
    buffer_load_dwordx4 v2, s[12:15], s40 offen sc1 lds
    s_mov_b64 exec, 1
    buffer_load_dword v11, v10, s[56:59], 0 offen sc1
    s_mov_b64 exec, -1
    s_call_b64 s[76:77], PREP_a_issue_4
    s_add_u32 m0, m0, 1024
    s_add_u32 s39, s39, 229376
    buffer_load_dwordx4 v2, s[12:15], s39 offen sc1 lds
    s_add_u32 m0, m0, 1024
    s_add_u32 s40, s40, 229376
    buffer_load_dwordx4 v2, s[12:15], s40 offen sc1 lds
    s_add_u32 m0, m0, 1024
    s_add_u32 s39, s39, 229376
    buffer_load_dwordx4 v2, s[12:15], s39 offen sc1 lds
    s_add_u32 m0, m0, 1024
    s_add_u32 s40, s40, 229376
    buffer_load_dwordx4 v2, s[12:15], s40 offen sc1 lds
    s_mov_b32 m0, s19
    s_mov_b32 s39, s16
    s_mov_b32 s40, s17
    s_waitcnt vmcnt(9)
    s_barrier
    s_mov_b64 exec, 1
    buffer_atomic_add v13, v12, s[56:59], s51 offen sc1
    s_mov_b64 exec, -1
    buffer_load_dwordx4 v2, s[12:15], s39 offen sc1 lds
    s_add_u32 m0, m0, 1024
    s_nop 0
    buffer_load_dwordx4 v2, s[12:15], s40 offen sc1 lds
    s_add_u32 m0, m0, 1024
    s_add_u32 s39, s39, 229376
    buffer_load_dwordx4 v2, s[12:15], s39 offen sc1 lds
    s_add_u32 m0, m0, 1024
    s_add_u32 s40, s40, 229376
    buffer_load_dwordx4 v2, s[12:15], s40 offen sc1 lds
    s_call_b64 s[76:77], PREP_a_issue_4
    s_add_u32 m0, m0, 1024
    s_add_u32 s39, s39, 229376
    buffer_load_dwordx4 v2, s[12:15], s39 offen sc1 lds
    s_add_u32 m0, m0, 1024
    s_add_u32 s40, s40, 229376
    buffer_load_dwordx4 v2, s[12:15], s40 offen sc1 lds
    s_add_u32 m0, m0, 1024
    s_add_u32 s39, s39, 229376
    buffer_load_dwordx4 v2, s[12:15], s39 offen sc1 lds
    s_add_u32 m0, m0, 1024
    s_add_u32 s40, s40, 229376
    buffer_load_dwordx4 v2, s[12:15], s40 offen sc1 lds
    s_mov_b32 m0, s19
    s_mov_b32 s39, s16
    s_mov_b32 s40, s17
    s_waitcnt vmcnt(9)
    s_barrier
    buffer_load_dwordx4 v2, s[12:15], s39 offen sc1 lds
    s_add_u32 m0, m0, 1024
    s_nop 0
    buffer_load_dwordx4 v2, s[12:15], s40 offen sc1 lds
    s_add_u32 m0, m0, 1024
    s_add_u32 s39, s39, 229376
    buffer_load_dwordx4 v2, s[12:15], s39 offen sc1 lds
    s_add_u32 m0, m0, 1024
    s_add_u32 s40, s40, 229376
    buffer_load_dwordx4 v2, s[12:15], s40 offen sc1 lds
    s_waitcnt vmcnt(17)
    v_readfirstlane_b32 s53, v11
    s_add_u32 s54, s52, 8
    s_cmp_eq_u32 s53, s54
    s_cbranch_scc1 fok_59
    s_mov_b32 s53, 0
    s_add_u32 s54, s52, 8
    s_bfm_b64 exec, 1, 0
poll_60:
    buffer_load_dword v11, v10, s[56:59], 0 offen sc1
    s_waitcnt vmcnt(0)
    v_xor_b32 v11, s54, v11
    v_cmp_eq_u32 vcc, 0, v11
    s_nop 0
    s_cmp_eq_u64 vcc, exec
    s_cbranch_scc1 pok_61
    s_sleep 5
    s_add_u32 s53, s53, 1
    s_cmp_lt_u32 s53, s61
    s_cbranch_scc1 poll_60
    s_mov_b32 s61, 0
pok_61:
    s_mov_b64 exec, -1
fok_59:
    s_call_b64 s[76:77], PREP_a_issue_4
    s_add_u32 m0, m0, 1024
    s_add_u32 s39, s39, 229376
    buffer_load_dwordx4 v2, s[12:15], s39 offen sc1 lds
    s_add_u32 m0, m0, 1024
    s_add_u32 s40, s40, 229376
    buffer_load_dwordx4 v2, s[12:15], s40 offen sc1 lds
    s_add_u32 m0, m0, 1024
    s_add_u32 s39, s39, 229376
    buffer_load_dwordx4 v2, s[12:15], s39 offen sc1 lds
    s_add_u32 m0, m0, 1024
    s_add_u32 s40, s40, 229376
    buffer_load_dwordx4 v2, s[12:15], s40 offen sc1 lds
    s_mov_b32 m0, s19
    s_mov_b32 s39, s16
    s_mov_b32 s40, s17
    s_waitcnt vmcnt(8)
    s_barrier
    buffer_load_dwordx4 v2, s[12:15], s39 offen sc1 lds
    s_add_u32 m0, m0, 1024
    s_nop 0
    buffer_load_dwordx4 v2, s[12:15], s40 offen sc1 lds
    s_add_u32 m0, m0, 1024
    s_add_u32 s39, s39, 229376
    buffer_load_dwordx4 v2, s[12:15], s39 offen sc1 lds
    s_add_u32 m0, m0, 1024
    s_add_u32 s40, s40, 229376
    buffer_load_dwordx4 v2, s[12:15], s40 offen sc1 lds
    s_mov_b32 s43, 1
ld_62:
    s_add_u32 s19, s41, s42
    v_readlane_b32 s16, v249, s44
    v_readlane_b32 s17, v250, s44
    s_add_u32 s16, s16, s38
    s_add_u32 s17, s17, s38
    s_add_u32 s44, s44, 1
    s_add_u32 s42, s42, 16384
    s_cmp_eq_u32 s42, 49152
    s_cselect_b32 s42, 0, s42
    s_add_u32 m0, m0, 1024
    s_add_u32 s39, s39, 229376
    buffer_load_dwordx4 v2, s[12:15], s39 offen sc1 lds
    s_add_u32 m0, m0, 1024
    s_add_u32 s40, s40, 229376
    buffer_load_dwordx4 v2, s[12:15], s40 offen sc1 lds
    s_add_u32 m0, m0, 1024
    s_add_u32 s39, s39, 229376
    buffer_load_dwordx4 v2, s[12:15], s39 offen sc1 lds
    s_add_u32 m0, m0, 1024
    s_add_u32 s40, s40, 229376
    buffer_load_dwordx4 v2, s[12:15], s40 offen sc1 lds
    s_mov_b32 m0, s19
    s_mov_b32 s39, s16
    s_mov_b32 s40, s17
    s_waitcnt vmcnt(8)
    s_barrier
    buffer_load_dwordx4 v2, s[12:15], s39 offen sc1 lds
    s_add_u32 m0, m0, 1024
    s_nop 0
    buffer_load_dwordx4 v2, s[12:15], s40 offen sc1 lds
    s_add_u32 m0, m0, 1024
    s_add_u32 s39, s39, 229376
    buffer_load_dwordx4 v2, s[12:15], s39 offen sc1 lds
    s_add_u32 m0, m0, 1024
    s_add_u32 s40, s40, 229376
    buffer_load_dwordx4 v2, s[12:15], s40 offen sc1 lds
    s_add_u32 s43, s43, 1
    s_cmp_lt_u32 s43, 4
    s_cbranch_scc1 ld_62
    s_call_b64 s[76:77], PREP_a_issue_4
    s_add_u32 m0, m0, 1024
    s_add_u32 s39, s39, 229376
    buffer_load_dwordx4 v2, s[12:15], s39 offen sc1 lds
    s_add_u32 m0, m0, 1024
    s_add_u32 s40, s40, 229376
    buffer_load_dwordx4 v2, s[12:15], s40 offen sc1 lds
    s_add_u32 m0, m0, 1024
    s_add_u32 s39, s39, 229376
    buffer_load_dwordx4 v2, s[12:15], s39 offen sc1 lds
    s_add_u32 m0, m0, 1024
    s_add_u32 s40, s40, 229376
    buffer_load_dwordx4 v2, s[12:15], s40 offen sc1 lds
    s_mov_b32 m0, s19
    s_mov_b32 s39, s16
    s_mov_b32 s40, s17
    s_waitcnt vmcnt(8)
    s_barrier
    buffer_load_dwordx4 v2, s[12:15], s39 offen sc1 lds
    s_add_u32 m0, m0, 1024
    s_nop 0
    buffer_load_dwordx4 v2, s[12:15], s40 offen sc1 lds
    s_add_u32 m0, m0, 1024
    s_add_u32 s39, s39, 229376
    buffer_load_dwordx4 v2, s[12:15], s39 offen sc1 lds
    s_add_u32 m0, m0, 1024
    s_add_u32 s40, s40, 229376
    buffer_load_dwordx4 v2, s[12:15], s40 offen sc1 lds
    s_mov_b64 exec, 1
    buffer_load_dword v11, v12, s[56:59], 0 offen sc1
    s_mov_b64 exec, -1
    s_call_b64 s[76:77], PREP_a_issue_4
    s_add_u32 m0, m0, 1024
    s_add_u32 s39, s39, 229376
    buffer_load_dwordx4 v2, s[12:15], s39 offen sc1 lds
    s_add_u32 m0, m0, 1024
    s_add_u32 s40, s40, 229376
    buffer_load_dwordx4 v2, s[12:15], s40 offen sc1 lds
    s_add_u32 m0, m0, 1024
    s_add_u32 s39, s39, 229376
    buffer_load_dwordx4 v2, s[12:15], s39 offen sc1 lds
    s_add_u32 m0, m0, 1024
    s_add_u32 s40, s40, 229376
    buffer_load_dwordx4 v2, s[12:15], s40 offen sc1 lds
    s_mov_b32 m0, s19
    s_mov_b32 s39, s16
    s_mov_b32 s40, s17
    s_waitcnt vmcnt(9)
    s_barrier
    buffer_load_dwordx4 v2, s[12:15], s39 offen sc1 lds
    s_add_u32 m0, m0, 1024
    s_nop 0
    buffer_load_dwordx4 v2, s[12:15], s40 offen sc1 lds
    s_add_u32 m0, m0, 1024
    s_add_u32 s39, s39, 229376
    buffer_load_dwordx4 v2, s[12:15], s39 offen sc1 lds
    s_add_u32 m0, m0, 1024
    s_add_u32 s40, s40, 229376
    buffer_load_dwordx4 v2, s[12:15], s40 offen sc1 lds
    s_call_b64 s[76:77], PREP_a_issue_4
    s_add_u32 m0, m0, 1024
    s_add_u32 s39, s39, 229376
    buffer_load_dwordx4 v2, s[12:15], s39 offen sc1 lds
    s_add_u32 m0, m0, 1024
    s_add_u32 s40, s40, 229376
    buffer_load_dwordx4 v2, s[12:15], s40 offen sc1 lds
    s_add_u32 m0, m0, 1024
    s_add_u32 s39, s39, 229376
    buffer_load_dwordx4 v2, s[12:15], s39 offen sc1 lds
    s_add_u32 m0, m0, 1024
    s_add_u32 s40, s40, 229376
    buffer_load_dwordx4 v2, s[12:15], s40 offen sc1 lds
    s_mov_b32 m0, s19
    s_mov_b32 s39, s16
    s_mov_b32 s40, s17
    s_waitcnt vmcnt(8)
    s_barrier
    buffer_load_dwordx4 v2, s[12:15], s39 offen sc1 lds
    s_add_u32 m0, m0, 1024
    s_nop 0
    buffer_load_dwordx4 v2, s[12:15], s40 offen sc1 lds
    s_add_u32 m0, m0, 1024
    s_add_u32 s39, s39, 229376
    buffer_load_dwordx4 v2, s[12:15], s39 offen sc1 lds
    s_add_u32 m0, m0, 1024
    s_add_u32 s40, s40, 229376
    buffer_load_dwordx4 v2, s[12:15], s40 offen sc1 lds
    s_waitcnt vmcnt(16)
    v_readfirstlane_b32 s53, v11
    s_add_u32 s54, s52, 8
    s_cmp_eq_u32 s53, s54
    s_cbranch_scc1 fok_63
    s_mov_b32 s53, 0
    s_add_u32 s54, s52, 8
    s_bfm_b64 exec, 1, 0
poll_64:
    buffer_load_dword v11, v12, s[56:59], 0 offen sc1
    s_waitcnt vmcnt(0)
    v_xor_b32 v11, s54, v11
    v_cmp_eq_u32 vcc, 0, v11
    s_nop 0
    s_cmp_eq_u64 vcc, exec
    s_cbranch_scc1 pok_65
    s_sleep 5
    s_add_u32 s53, s53, 1
    s_cmp_lt_u32 s53, s61
    s_cbranch_scc1 poll_64
    s_mov_b32 s61, 0
pok_65:
    s_mov_b64 exec, -1
fok_63:
    s_call_b64 s[76:77], PREP_a_issue_4
    s_add_u32 m0, m0, 1024
    s_add_u32 s39, s39, 229376
    buffer_load_dwordx4 v2, s[12:15], s39 offen sc1 lds
    s_add_u32 m0, m0, 1024
    s_add_u32 s40, s40, 229376
    buffer_load_dwordx4 v2, s[12:15], s40 offen sc1 lds
    s_add_u32 m0, m0, 1024
    s_add_u32 s39, s39, 229376
    buffer_load_dwordx4 v2, s[12:15], s39 offen sc1 lds
    s_add_u32 m0, m0, 1024
    s_add_u32 s40, s40, 229376
    buffer_load_dwordx4 v2, s[12:15], s40 offen sc1 lds
    s_mov_b32 m0, s19
    s_mov_b32 s39, s16
    s_mov_b32 s40, s17
    s_waitcnt vmcnt(8)
    s_barrier
    buffer_load_dwordx4 v2, s[12:15], s39 offen sc1 lds
    s_add_u32 m0, m0, 1024
    s_nop 0
    buffer_load_dwordx4 v2, s[12:15], s40 offen sc1 lds
    s_add_u32 m0, m0, 1024
    s_add_u32 s39, s39, 229376
    buffer_load_dwordx4 v2, s[12:15], s39 offen sc1 lds
    s_add_u32 m0, m0, 1024
    s_add_u32 s40, s40, 229376
    buffer_load_dwordx4 v2, s[12:15], s40 offen sc1 lds
    s_mov_b32 s43, 1
ld_66:
    s_add_u32 s19, s41, s42
    v_readlane_b32 s16, v249, s44
    v_readlane_b32 s17, v250, s44
    s_add_u32 s16, s16, s38
    s_add_u32 s17, s17, s38
    s_add_u32 s44, s44, 1
    s_add_u32 s42, s42, 16384
    s_cmp_eq_u32 s42, 49152
    s_cselect_b32 s42, 0, s42
    s_add_u32 m0, m0, 1024
    s_add_u32 s39, s39, 229376
    buffer_load_dwordx4 v2, s[12:15], s39 offen sc1 lds
    s_add_u32 m0, m0, 1024
    s_add_u32 s40, s40, 229376
    buffer_load_dwordx4 v2, s[12:15], s40 offen sc1 lds
    s_add_u32 m0, m0, 1024
    s_add_u32 s39, s39, 229376
    buffer_load_dwordx4 v2, s[12:15], s39 offen sc1 lds
    s_add_u32 m0, m0, 1024
    s_add_u32 s40, s40, 229376
    buffer_load_dwordx4 v2, s[12:15], s40 offen sc1 lds
    s_mov_b32 m0, s19
    s_mov_b32 s39, s16
    s_mov_b32 s40, s17
    s_waitcnt vmcnt(8)
    s_barrier
    buffer_load_dwordx4 v2, s[12:15], s39 offen sc1 lds
    s_add_u32 m0, m0, 1024
    s_nop 0
    buffer_load_dwordx4 v2, s[12:15], s40 offen sc1 lds
    s_add_u32 m0, m0, 1024
    s_add_u32 s39, s39, 229376
    buffer_load_dwordx4 v2, s[12:15], s39 offen sc1 lds
    s_add_u32 m0, m0, 1024
    s_add_u32 s40, s40, 229376
    buffer_load_dwordx4 v2, s[12:15], s40 offen sc1 lds
    s_add_u32 s43, s43, 1
    s_cmp_lt_u32 s43, 5
    s_cbranch_scc1 ld_66
    s_call_b64 s[76:77], PREP_a_issue_4
    s_add_u32 m0, m0, 1024
    s_add_u32 s39, s39, 229376
    buffer_load_dwordx4 v2, s[12:15], s39 offen sc1 lds
    s_add_u32 m0, m0, 1024
    s_add_u32 s40, s40, 229376
    buffer_load_dwordx4 v2, s[12:15], s40 offen sc1 lds
    s_add_u32 m0, m0, 1024
    s_add_u32 s39, s39, 229376
    buffer_load_dwordx4 v2, s[12:15], s39 offen sc1 lds
    s_add_u32 m0, m0, 1024
    s_add_u32 s40, s40, 229376
    buffer_load_dwordx4 v2, s[12:15], s40 offen sc1 lds
    s_mov_b32 m0, s19
    s_mov_b32 s39, s16
    s_mov_b32 s40, s17
    s_waitcnt vmcnt(8)
    s_barrier
    buffer_load_dwordx4 v2, s[12:15], s39 offen sc1 lds
    s_add_u32 m0, m0, 1024
    s_nop 0
    buffer_load_dwordx4 v2, s[12:15], s40 offen sc1 lds
    s_add_u32 m0, m0, 1024
    s_add_u32 s39, s39, 229376
    buffer_load_dwordx4 v2, s[12:15], s39 offen sc1 lds
    s_add_u32 m0, m0, 1024
    s_add_u32 s40, s40, 229376
    buffer_load_dwordx4 v2, s[12:15], s40 offen sc1 lds
    s_mov_b64 exec, 1
    buffer_load_dword v11, v15, s[56:59], 0 offen sc1
    s_mov_b64 exec, -1
    s_call_b64 s[76:77], PREP_a_issue_4
    s_add_u32 m0, m0, 1024
    s_add_u32 s39, s39, 229376
    buffer_load_dwordx4 v2, s[12:15], s39 offen sc1 lds
    s_add_u32 m0, m0, 1024
    s_add_u32 s40, s40, 229376
    buffer_load_dwordx4 v2, s[12:15], s40 offen sc1 lds
    s_add_u32 m0, m0, 1024
    s_add_u32 s39, s39, 229376
    buffer_load_dwordx4 v2, s[12:15], s39 offen sc1 lds
    s_add_u32 m0, m0, 1024
    s_add_u32 s40, s40, 229376
    buffer_load_dwordx4 v2, s[12:15], s40 offen sc1 lds
    s_mov_b32 m0, s19
    s_mov_b32 s39, s16
    s_mov_b32 s40, s17
    s_waitcnt vmcnt(9)
    s_barrier
    buffer_load_dwordx4 v2, s[12:15], s39 offen sc1 lds
    s_add_u32 m0, m0, 1024
    s_nop 0
    buffer_load_dwordx4 v2, s[12:15], s40 offen sc1 lds
    s_add_u32 m0, m0, 1024
    s_add_u32 s39, s39, 229376
    buffer_load_dwordx4 v2, s[12:15], s39 offen sc1 lds
    s_add_u32 m0, m0, 1024
    s_add_u32 s40, s40, 229376
    buffer_load_dwordx4 v2, s[12:15], s40 offen sc1 lds
    s_call_b64 s[76:77], PREP_a_issue_4
    s_add_u32 m0, m0, 1024
    s_add_u32 s39, s39, 229376
    buffer_load_dwordx4 v2, s[12:15], s39 offen sc1 lds
    s_add_u32 m0, m0, 1024
    s_add_u32 s40, s40, 229376
    buffer_load_dwordx4 v2, s[12:15], s40 offen sc1 lds
    s_add_u32 m0, m0, 1024
    s_add_u32 s39, s39, 229376
    buffer_load_dwordx4 v2, s[12:15], s39 offen sc1 lds
    s_add_u32 m0, m0, 1024
    s_add_u32 s40, s40, 229376
    buffer_load_dwordx4 v2, s[12:15], s40 offen sc1 lds
    s_mov_b32 m0, s19
    s_mov_b32 s39, s16
    s_mov_b32 s40, s17
    s_waitcnt vmcnt(8)
    s_barrier
    buffer_load_dwordx4 v2, s[12:15], s39 offen sc1 lds
    s_add_u32 m0, m0, 1024
    s_nop 0
    buffer_load_dwordx4 v2, s[12:15], s40 offen sc1 lds
    s_add_u32 m0, m0, 1024
    s_add_u32 s39, s39, 229376
    buffer_load_dwordx4 v2, s[12:15], s39 offen sc1 lds
    s_add_u32 m0, m0, 1024
    s_add_u32 s40, s40, 229376
    buffer_load_dwordx4 v2, s[12:15], s40 offen sc1 lds
    s_waitcnt vmcnt(16)
    v_readfirstlane_b32 s53, v11
    s_add_u32 s54, s52, 8
    s_cmp_eq_u32 s53, s54
    s_cbranch_scc1 fok_67
    s_mov_b32 s53, 0
    s_add_u32 s54, s52, 8
    s_bfm_b64 exec, 1, 0
poll_68:
    buffer_load_dword v11, v15, s[56:59], 0 offen sc1
    s_waitcnt vmcnt(0)
    v_xor_b32 v11, s54, v11
    v_cmp_eq_u32 vcc, 0, v11
    s_nop 0
    s_cmp_eq_u64 vcc, exec
    s_cbranch_scc1 pok_69
    s_sleep 5
    s_add_u32 s53, s53, 1
    s_cmp_lt_u32 s53, s61
    s_cbranch_scc1 poll_68
    s_mov_b32 s61, 0
pok_69:
    s_mov_b64 exec, -1
fok_67:
    s_call_b64 s[76:77], PREP_a_issue_4
    s_add_u32 m0, m0, 1024
    s_add_u32 s39, s39, 229376
    buffer_load_dwordx4 v2, s[12:15], s39 offen sc1 lds
    s_add_u32 m0, m0, 1024
    s_add_u32 s40, s40, 229376
    buffer_load_dwordx4 v2, s[12:15], s40 offen sc1 lds
    s_add_u32 m0, m0, 1024
    s_add_u32 s39, s39, 229376
    buffer_load_dwordx4 v2, s[12:15], s39 offen sc1 lds
    s_add_u32 m0, m0, 1024
    s_add_u32 s40, s40, 229376
    buffer_load_dwordx4 v2, s[12:15], s40 offen sc1 lds
    s_mov_b32 m0, s19
    s_mov_b32 s39, s16
    s_mov_b32 s40, s17
    s_waitcnt vmcnt(8)
    s_barrier
    buffer_load_dwordx4 v2, s[12:15], s39 offen sc1 lds
    s_add_u32 m0, m0, 1024
    s_nop 0
    buffer_load_dwordx4 v2, s[12:15], s40 offen sc1 lds
    s_add_u32 m0, m0, 1024
    s_add_u32 s39, s39, 229376
    buffer_load_dwordx4 v2, s[12:15], s39 offen sc1 lds
    s_add_u32 m0, m0, 1024
    s_add_u32 s40, s40, 229376
    buffer_load_dwordx4 v2, s[12:15], s40 offen sc1 lds
    s_mov_b32 s43, 1
ld_70:
    s_add_u32 s19, s41, s42
    v_readlane_b32 s16, v249, s44
    v_readlane_b32 s17, v250, s44
    s_add_u32 s16, s16, s38
    s_add_u32 s17, s17, s38
    s_add_u32 s44, s44, 1
    s_add_u32 s42, s42, 16384
    s_cmp_eq_u32 s42, 49152
    s_cselect_b32 s42, 0, s42
    s_add_u32 m0, m0, 1024
    s_add_u32 s39, s39, 229376
    buffer_load_dwordx4 v2, s[12:15], s39 offen sc1 lds
    s_add_u32 m0, m0, 1024
    s_add_u32 s40, s40, 229376
    buffer_load_dwordx4 v2, s[12:15], s40 offen sc1 lds
    s_add_u32 m0, m0, 1024
    s_add_u32 s39, s39, 229376
    buffer_load_dwordx4 v2, s[12:15], s39 offen sc1 lds
    s_add_u32 m0, m0, 1024
    s_add_u32 s40, s40, 229376
    buffer_load_dwordx4 v2, s[12:15], s40 offen sc1 lds
    s_mov_b32 m0, s19
    s_mov_b32 s39, s16
    s_mov_b32 s40, s17
    s_waitcnt vmcnt(8)
    s_barrier
    buffer_load_dwordx4 v2, s[12:15], s39 offen sc1 lds
    s_add_u32 m0, m0, 1024
    s_nop 0
    buffer_load_dwordx4 v2, s[12:15], s40 offen sc1 lds
    s_add_u32 m0, m0, 1024
    s_add_u32 s39, s39, 229376
    buffer_load_dwordx4 v2, s[12:15], s39 offen sc1 lds
    s_add_u32 m0, m0, 1024
    s_add_u32 s40, s40, 229376
    buffer_load_dwordx4 v2, s[12:15], s40 offen sc1 lds
    s_add_u32 s43, s43, 1
    s_cmp_lt_u32 s43, 3
    s_cbranch_scc1 ld_70
    s_call_b64 s[76:77], PREP_a_issue_4
    s_add_u32 m0, m0, 1024
    s_add_u32 s39, s39, 229376
    buffer_load_dwordx4 v2, s[12:15], s39 offen sc1 lds
    s_add_u32 m0, m0, 1024
    s_add_u32 s40, s40, 229376
    buffer_load_dwordx4 v2, s[12:15], s40 offen sc1 lds
    s_add_u32 m0, m0, 1024
    s_add_u32 s39, s39, 229376
    buffer_load_dwordx4 v2, s[12:15], s39 offen sc1 lds
    s_add_u32 m0, m0, 1024
    s_add_u32 s40, s40, 229376
    buffer_load_dwordx4 v2, s[12:15], s40 offen sc1 lds
    s_mov_b32 m0, s19
    s_mov_b32 s39, s16
    s_mov_b32 s40, s17
    s_waitcnt vmcnt(8)
    s_barrier
    buffer_load_dwordx4 v2, s[12:15], s39 offen sc1 lds
    s_add_u32 m0, m0, 1024
    s_nop 0
    buffer_load_dwordx4 v2, s[12:15], s40 offen sc1 lds
    s_add_u32 m0, m0, 1024
    s_add_u32 s39, s39, 229376
    buffer_load_dwordx4 v2, s[12:15], s39 offen sc1 lds
    s_add_u32 m0, m0, 1024
    s_add_u32 s40, s40, 229376
    buffer_load_dwordx4 v2, s[12:15], s40 offen sc1 lds
    s_add_u32 m0, m0, 1024
    s_add_u32 s39, s39, 229376
    buffer_load_dwordx4 v2, s[12:15], s39 offen sc1 lds
    s_add_u32 m0, m0, 1024
    s_add_u32 s40, s40, 229376
    buffer_load_dwordx4 v2, s[12:15], s40 offen sc1 lds
    s_add_u32 m0, m0, 1024
    s_add_u32 s39, s39, 229376
    buffer_load_dwordx4 v2, s[12:15], s39 offen sc1 lds
    s_add_u32 m0, m0, 1024
    s_add_u32 s40, s40, 229376
    buffer_load_dwordx4 v2, s[12:15], s40 offen sc1 lds
    s_waitcnt vmcnt(8)
    s_barrier
    s_waitcnt vmcnt(0)
    s_barrier
    s_cmp_eq_u32 s60, 1
    s_cbranch_scc1 K_fin
    s_barrier
    s_and_b32 s36, s30, 1
    s_lshl_b32 s36, s36, 12
    s_add_u32 s36, s36, 32768
    v_add_u32 v6, s36, v2
    ds_write_b128 v6, v[16:19] offset:0
    ds_write_b128 v6, v[20:23] offset:1024
    ds_write_b128 v6, v[24:27] offset:2048
    ds_write_b128 v6, v[28:31] offset:3072
    ds_write_b128 v6, v[32:35] offset:8192
    ds_write_b128 v6, v[36:39] offset:9216
    ds_write_b128 v6, v[40:43] offset:10240
    ds_write_b128 v6, v[44:47] offset:11264
    s_waitcnt lgkmcnt(0)
    s_branch NEXT
WLOAD:
    s_cmp_eq_u32 s60, 1
    s_cbranch_scc1 WL_1
    s_mov_b64 s[12:13], s[68:69]
    s_mov_b32 s14, 2097152
    s_mov_b32 s15, 0x20000
    s_and_b32 s35, s30, 1
    s_mul_i32 s38, s99, 128
    s_mul_i32 s41, s35, 65536
    s_add_u32 s38, s38, s41
    s_mul_i32 s41, s35, 4096
    s_add_u32 s41, s41, 24576
    s_mov_b32 s42, 0
    s_mov_b32 s44, s67
    s_branch WL_2
WL_1:
    s_mov_b64 s[12:13], s[68:69]
    s_mov_b32 s14, 2097152
    s_mov_b32 s15, 0x20000
    s_and_b32 s35, s30, 1
    s_mul_i32 s38, s99, 128
    s_mul_i32 s41, s35, 65536
    s_add_u32 s38, s38, s41
    s_mul_i32 s41, s35, 4096
    s_add_u32 s41, s41, 24576
    s_mov_b32 s42, 0
    s_mov_b32 s44, s67
WL_2:
    s_waitcnt vmcnt(0)
    s_and_b32 s36, s30, 1
    s_lshl_b32 s36, s36, 12
    s_add_u32 s36, s36, 81920
    v_add_u32 v6, s36, v2
    ds_read_b128 v[16:19], v6 offset:16384
    ds_read_b128 v[20:23], v6 offset:17408
    ds_read_b128 v[24:27], v6 offset:18432
    ds_read_b128 v[28:31], v6 offset:19456
    ds_read_b128 v[32:35], v6 offset:24576
    ds_read_b128 v[36:39], v6 offset:25600
    ds_read_b128 v[40:43], v6 offset:26624
    ds_read_b128 v[44:47], v6 offset:27648
    ds_read_b128 v[204:207], v6 offset:0
    ds_read_b128 v[208:211], v6 offset:1024
    ds_read_b128 v[212:215], v6 offset:2048
    ds_read_b128 v[216:219], v6 offset:3072
    s_waitcnt lgkmcnt(0)
    s_call_b64 s[76:77], SUB_before_d1
    s_barrier
    s_call_b64 s[76:77], SUB_after_g1
    s_barrier
    s_waitcnt vmcnt(0)
    s_barrier
    s_call_b64 s[76:77], SUB_after_g2
    s_mov_b64 s[12:13], s[72:73]
    s_mov_b32 s14, 7340032
    s_mov_b32 s15, 0x20000
    s_and_b32 s35, s30, 1
    s_mul_i32 s38, s29, 448
    s_mul_i32 s41, s35, 229376
    s_add_u32 s38, s38, s41
    s_mul_i32 s41, s35, 14336
    s_add_u32 s41, s41, 73728
    s_mov_b32 s42, 0
    s_mov_b32 s44, 0
    s_mov_b32 s42, 28672
    s_mov_b32 s44, 2
    s_add_u32 s19, s41, s42
    v_readlane_b32 s16, v248, s44
    s_nop 0
    s_add_u32 s16, s16, s38
    s_add_u32 s44, s44, 1
    s_and_b32 s44, s44, 15
    s_add_u32 s42, s42, 28672
    s_cmp_eq_u32 s42, 86016
    s_cselect_b32 s42, 0, s42
    s_mov_b32 m0, s19
    s_mov_b32 s39, s16
    s_waitcnt vmcnt(63)
    s_barrier
    buffer_load_dwordx4 v241, s[12:15], s39 offen lds
    s_add_u32 m0, m0, 1024
    s_nop 0
    buffer_load_dwordx4 v242, s[12:15], s39 offen lds
    s_add_u32 m0, m0, 1024
    s_nop 0
    buffer_load_dwordx4 v243, s[12:15], s39 offen lds
    s_add_u32 m0, m0, 1024
    s_nop 0
    buffer_load_dwordx4 v244, s[12:15], s39 offen lds
    s_add_u32 m0, m0, 1024
    s_nop 0
    buffer_load_dwordx4 v245, s[12:15], s39 offen lds
    s_add_u32 m0, m0, 1024
    s_nop 0
    buffer_load_dwordx4 v246, s[12:15], s39 offen lds
    s_add_u32 m0, m0, 1024
    s_nop 0
    buffer_load_dwordx4 v247, s[12:15], s39 offen lds
    s_mov_b32 s43, 1
ld_71:
    s_add_u32 s19, s41, s42
    v_readlane_b32 s16, v248, s44
    s_nop 0
    s_add_u32 s16, s16, s38
    s_add_u32 s44, s44, 1
    s_and_b32 s44, s44, 15
    s_add_u32 s42, s42, 28672
    s_cmp_eq_u32 s42, 86016
    s_cselect_b32 s42, 0, s42
    s_add_u32 m0, m0, 1024
    s_add_u32 s39, s39, 114688
    buffer_load_dwordx4 v241, s[12:15], s39 offen lds
    s_add_u32 m0, m0, 1024
    s_nop 0
    buffer_load_dwordx4 v242, s[12:15], s39 offen lds
    s_add_u32 m0, m0, 1024
    s_nop 0
    buffer_load_dwordx4 v243, s[12:15], s39 offen lds
    s_add_u32 m0, m0, 1024
    s_nop 0
    buffer_load_dwordx4 v244, s[12:15], s39 offen lds
    s_add_u32 m0, m0, 1024
    s_nop 0
    buffer_load_dwordx4 v245, s[12:15], s39 offen lds
    s_add_u32 m0, m0, 1024
    s_nop 0
    buffer_load_dwordx4 v246, s[12:15], s39 offen lds
    s_add_u32 m0, m0, 1024
    s_nop 0
    buffer_load_dwordx4 v247, s[12:15], s39 offen lds
    s_mov_b32 m0, s19
    s_mov_b32 s39, s16
    s_waitcnt vmcnt(14)
    s_barrier
    buffer_load_dwordx4 v241, s[12:15], s39 offen lds
    s_add_u32 m0, m0, 1024
    s_nop 0
    buffer_load_dwordx4 v242, s[12:15], s39 offen lds
    s_add_u32 m0, m0, 1024
    s_nop 0
    buffer_load_dwordx4 v243, s[12:15], s39 offen lds
    s_add_u32 m0, m0, 1024
    s_nop 0
    buffer_load_dwordx4 v244, s[12:15], s39 offen lds
    s_add_u32 m0, m0, 1024
    s_nop 0
    buffer_load_dwordx4 v245, s[12:15], s39 offen lds
    s_add_u32 m0, m0, 1024
    s_nop 0
    buffer_load_dwordx4 v246, s[12:15], s39 offen lds
    s_add_u32 m0, m0, 1024
    s_nop 0
    buffer_load_dwordx4 v247, s[12:15], s39 offen lds
    s_add_u32 s43, s43, 1
    s_cmp_lt_u32 s43, 13
    s_cbranch_scc1 ld_71
    s_add_u32 s19, s41, s42
    v_readlane_b32 s16, v248, s44
    s_nop 0
    s_add_u32 s16, s16, s38
    s_add_u32 s44, s44, 1
    s_and_b32 s44, s44, 15
    s_add_u32 s42, s42, 28672
    s_cmp_eq_u32 s42, 86016
    s_cselect_b32 s42, 0, s42
    s_add_u32 m0, m0, 1024
    s_add_u32 s39, s39, 114688
    buffer_load_dwordx4 v241, s[12:15], s39 offen lds
    s_add_u32 m0, m0, 1024
    s_nop 0
    buffer_load_dwordx4 v242, s[12:15], s39 offen lds
    s_add_u32 m0, m0, 1024
    s_nop 0
    buffer_load_dwordx4 v243, s[12:15], s39 offen lds
    s_add_u32 m0, m0, 1024
    s_nop 0
    buffer_load_dwordx4 v244, s[12:15], s39 offen lds
    s_add_u32 m0, m0, 1024
    s_nop 0
    buffer_load_dwordx4 v245, s[12:15], s39 offen lds
    s_add_u32 m0, m0, 1024
    s_nop 0
    buffer_load_dwordx4 v246, s[12:15], s39 offen lds
    s_add_u32 m0, m0, 1024
    s_nop 0
    buffer_load_dwordx4 v247, s[12:15], s39 offen lds
    s_mov_b32 m0, s19
    s_mov_b32 s39, s16
    s_waitcnt vmcnt(14)
    s_barrier
    buffer_load_dwordx4 v241, s[12:15], s39 offen lds
    s_add_u32 m0, m0, 1024
    s_nop 0
    buffer_load_dwordx4 v242, s[12:15], s39 offen lds
    s_add_u32 m0, m0, 1024
    s_nop 0
    buffer_load_dwordx4 v243, s[12:15], s39 offen lds
    s_add_u32 m0, m0, 1024
    s_nop 0
    buffer_load_dwordx4 v244, s[12:15], s39 offen lds
    s_add_u32 m0, m0, 1024
    s_nop 0
    buffer_load_dwordx4 v245, s[12:15], s39 offen lds
    s_add_u32 m0, m0, 1024
    s_nop 0
    buffer_load_dwordx4 v246, s[12:15], s39 offen lds
    s_add_u32 m0, m0, 1024
    s_nop 0
    buffer_load_dwordx4 v247, s[12:15], s39 offen lds
    s_add_u32 m0, m0, 1024
    s_add_u32 s39, s39, 114688
    buffer_load_dwordx4 v241, s[12:15], s39 offen lds
    s_add_u32 m0, m0, 1024
    s_nop 0
    buffer_load_dwordx4 v242, s[12:15], s39 offen lds
    s_add_u32 m0, m0, 1024
    s_nop 0
    buffer_load_dwordx4 v243, s[12:15], s39 offen lds
    s_add_u32 m0, m0, 1024
    s_nop 0
    buffer_load_dwordx4 v244, s[12:15], s39 offen lds
    s_add_u32 m0, m0, 1024
    s_nop 0
    buffer_load_dwordx4 v245, s[12:15], s39 offen lds
    s_add_u32 m0, m0, 1024
    s_nop 0
    buffer_load_dwordx4 v246, s[12:15], s39 offen lds
    s_add_u32 m0, m0, 1024
    s_nop 0
    buffer_load_dwordx4 v247, s[12:15], s39 offen lds
    s_waitcnt vmcnt(14)
    s_barrier
    s_waitcnt vmcnt(0)
    s_barrier
    s_cmp_lg_u32 s60, 0
    s_cbranch_scc1 rp_72
    s_call_b64 s[76:77], SUB_r_pre
rp_72:
    s_barrier
    s_mov_b64 s[12:13], s[74:75]
    s_mov_b32 s14, 7340032
    s_mov_b32 s15, 0x20000
    s_and_b32 s35, s30, 1
    s_mul_i32 s38, s33, 256
    s_mul_i32 s41, s31, 3670016
    s_add_u32 s38, s38, s41
    s_mul_i32 s41, s35, 8192
    s_add_u32 s41, s41, 49152
    s_mov_b32 s42, 0
    s_mov_b32 s44, 0
    s_mov_b32 s49, s44
    s_and_b32 s43, s28, 3
    s_mul_i32 s43, s43, 6
    s_lshr_b32 s43, s43, 2
    s_mov_b32 s50, 0
wpre_73:
    s_mul_i32 s42, s43, 16384
    s_add_u32 s44, s49, s43
    s_mov_b32 s45, 8192
    s_add_u32 s19, s41, s42
    v_readlane_b32 s16, v249, s44
    s_nop 0
    s_bitcmp1_b32 s16, 0
    s_cselect_b32 s17, 16384, s45
    s_cselect_b32 s18, -40960, s45
    s_andn2_b32 s16, s16, 1
    s_add_u32 s16, s16, s38
    s_add_u32 s44, s44, 1
    s_add_u32 s42, s42, 16384
    s_cmp_eq_u32 s42, 98304
    s_cselect_b32 s42, 0, s42
    s_mov_b32 m0, s19
    s_mov_b32 s39, s16
    s_mov_b32 s32, s17
    s_mov_b32 s3, s18
    buffer_load_dwordx4 v239, s[12:15], s39 offen lds
    s_add_u32 m0, m0, 1024
    s_add_u32 s39, s39, s32
    buffer_load_dwordx4 v240, s[12:15], s39 offen lds
    s_add_u32 m0, m0, 1024
    s_add_u32 s39, s39, s32
    buffer_load_dwordx4 v239, s[12:15], s39 offen lds
    s_add_u32 m0, m0, 1024
    s_add_u32 s39, s39, s32
    buffer_load_dwordx4 v240, s[12:15], s39 offen lds
    s_waitcnt vmcnt(8)
    s_add_u32 m0, m0, 1024
    s_add_u32 s39, s39, s3
    buffer_load_dwordx4 v239, s[12:15], s39 offen lds
    s_add_u32 m0, m0, 1024
    s_add_u32 s39, s39, s32
    buffer_load_dwordx4 v240, s[12:15], s39 offen lds
    s_add_u32 m0, m0, 1024
    s_add_u32 s39, s39, s32
    buffer_load_dwordx4 v239, s[12:15], s39 offen lds
    s_add_u32 m0, m0, 1024
    s_add_u32 s39, s39, s32
    buffer_load_dwordx4 v240, s[12:15], s39 offen lds
    s_waitcnt vmcnt(8)
    s_add_u32 s43, s43, 1
    s_cmp_eq_u32 s43, 6
    s_cselect_b32 s43, 0, s43
    s_add_u32 s50, s50, 1
    s_cmp_lt_u32 s50, 6
    s_cbranch_scc1 wpre_73
    s_mov_b32 s42, 0
    s_add_u32 s44, s49, 6
    s_cmp_eq_u32 s60, 1
    s_cbranch_scc1 WL_t1
    s_call_b64 s[76:77], PREP_w_issue_4
    s_mov_b32 m0, s19
    s_mov_b32 s39, s16
    s_mov_b32 s32, s17
    s_mov_b32 s3, s18
    s_waitcnt vmcnt(0)
    s_barrier
    s_waitcnt vmcnt(0)
    s_barrier
    buffer_load_dwordx4 v239, s[12:15], s39 offen lds
    s_add_u32 m0, m0, 1024
    s_add_u32 s39, s39, s32
    buffer_load_dwordx4 v240, s[12:15], s39 offen lds
    s_add_u32 m0, m0, 1024
    s_add_u32 s39, s39, s32
    buffer_load_dwordx4 v239, s[12:15], s39 offen lds
    s_add_u32 m0, m0, 1024
    s_add_u32 s39, s39, s32
    buffer_load_dwordx4 v240, s[12:15], s39 offen lds
    s_call_b64 s[76:77], PREP_w_issue_4
    s_add_u32 m0, m0, 1024
    s_add_u32 s39, s39, s3
    buffer_load_dwordx4 v239, s[12:15], s39 offen lds
    s_add_u32 m0, m0, 1024
    s_add_u32 s39, s39, s32
    buffer_load_dwordx4 v240, s[12:15], s39 offen lds
    s_add_u32 m0, m0, 1024
    s_add_u32 s39, s39, s32
    buffer_load_dwordx4 v239, s[12:15], s39 offen lds
    s_add_u32 m0, m0, 1024
    s_add_u32 s39, s39, s32
    buffer_load_dwordx4 v240, s[12:15], s39 offen lds
    s_mov_b32 m0, s19
    s_mov_b32 s39, s16
    s_mov_b32 s32, s17
    s_mov_b32 s3, s18
    s_waitcnt vmcnt(8)
    s_barrier
    buffer_load_dwordx4 v239, s[12:15], s39 offen lds
    s_add_u32 m0, m0, 1024
    s_add_u32 s39, s39, s32
    buffer_load_dwordx4 v240, s[12:15], s39 offen lds
    s_add_u32 m0, m0, 1024
    s_add_u32 s39, s39, s32
    buffer_load_dwordx4 v239, s[12:15], s39 offen lds
    s_add_u32 m0, m0, 1024
    s_add_u32 s39, s39, s32
    buffer_load_dwordx4 v240, s[12:15], s39 offen lds
    s_call_b64 s[76:77], PREP_w_issue_4
    s_add_u32 m0, m0, 1024
    s_add_u32 s39, s39, s3
    buffer_load_dwordx4 v239, s[12:15], s39 offen lds
    s_add_u32 m0, m0, 1024
    s_add_u32 s39, s39, s32
    buffer_load_dwordx4 v240, s[12:15], s39 offen lds
    s_add_u32 m0, m0, 1024
    s_add_u32 s39, s39, s32
    buffer_load_dwordx4 v239, s[12:15], s39 offen lds
    s_add_u32 m0, m0, 1024
    s_add_u32 s39, s39, s32
    buffer_load_dwordx4 v240, s[12:15], s39 offen lds
    s_mov_b32 m0, s19
    s_mov_b32 s39, s16
    s_mov_b32 s32, s17
    s_mov_b32 s3, s18
    s_waitcnt vmcnt(16)
    s_barrier
    buffer_load_dwordx4 v239, s[12:15], s39 offen lds
    s_add_u32 m0, m0, 1024
    s_add_u32 s39, s39, s32
    buffer_load_dwordx4 v240, s[12:15], s39 offen lds
    s_add_u32 m0, m0, 1024
    s_add_u32 s39, s39, s32
    buffer_load_dwordx4 v239, s[12:15], s39 offen lds
    s_add_u32 m0, m0, 1024
    s_add_u32 s39, s39, s32
    buffer_load_dwordx4 v240, s[12:15], s39 offen lds
    s_call_b64 s[76:77], PREP_w_issue_4
    s_add_u32 m0, m0, 1024
    s_add_u32 s39, s39, s3
    buffer_load_dwordx4 v239, s[12:15], s39 offen lds
    s_add_u32 m0, m0, 1024
    s_add_u32 s39, s39, s32
    buffer_load_dwordx4 v240, s[12:15], s39 offen lds
    s_add_u32 m0, m0, 1024
    s_add_u32 s39, s39, s32
    buffer_load_dwordx4 v239, s[12:15], s39 offen lds
    s_add_u32 m0, m0, 1024
    s_add_u32 s39, s39, s32
    buffer_load_dwordx4 v240, s[12:15], s39 offen lds
    s_mov_b32 m0, s19
    s_mov_b32 s39, s16
    s_mov_b32 s32, s17
    s_mov_b32 s3, s18
    s_waitcnt vmcnt(24)
    s_barrier
    buffer_load_dwordx4 v239, s[12:15], s39 offen lds
    s_add_u32 m0, m0, 1024
    s_add_u32 s39, s39, s32
    buffer_load_dwordx4 v240, s[12:15], s39 offen lds
    s_add_u32 m0, m0, 1024
    s_add_u32 s39, s39, s32
    buffer_load_dwordx4 v239, s[12:15], s39 offen lds
    s_add_u32 m0, m0, 1024
    s_add_u32 s39, s39, s32
    buffer_load_dwordx4 v240, s[12:15], s39 offen lds
    s_mov_b32 s43, 1
ld_74:
    s_mov_b32 s45, 8192
    s_add_u32 s19, s41, s42
    v_readlane_b32 s16, v249, s44
    s_nop 0
    s_bitcmp1_b32 s16, 0
    s_cselect_b32 s17, 16384, s45
    s_cselect_b32 s18, -40960, s45
    s_andn2_b32 s16, s16, 1
    s_add_u32 s16, s16, s38
    s_add_u32 s44, s44, 1
    s_add_u32 s42, s42, 16384
    s_cmp_eq_u32 s42, 98304
    s_cselect_b32 s42, 0, s42
    s_add_u32 m0, m0, 1024
    s_add_u32 s39, s39, s3
    buffer_load_dwordx4 v239, s[12:15], s39 offen lds
    s_add_u32 m0, m0, 1024
    s_add_u32 s39, s39, s32
    buffer_load_dwordx4 v240, s[12:15], s39 offen lds
    s_add_u32 m0, m0, 1024
    s_add_u32 s39, s39, s32
    buffer_load_dwordx4 v239, s[12:15], s39 offen lds
    s_add_u32 m0, m0, 1024
    s_add_u32 s39, s39, s32
    buffer_load_dwordx4 v240, s[12:15], s39 offen lds
    s_mov_b32 m0, s19
    s_mov_b32 s39, s16
    s_mov_b32 s32, s17
    s_mov_b32 s3, s18
    s_waitcnt vmcnt(32)
    s_barrier
    buffer_load_dwordx4 v239, s[12:15], s39 offen lds
    s_add_u32 m0, m0, 1024
    s_add_u32 s39, s39, s32
    buffer_load_dwordx4 v240, s[12:15], s39 offen lds
    s_add_u32 m0, m0, 1024
    s_add_u32 s39, s39, s32
    buffer_load_dwordx4 v239, s[12:15], s39 offen lds
    s_add_u32 m0, m0, 1024
    s_add_u32 s39, s39, s32
    buffer_load_dwordx4 v240, s[12:15], s39 offen lds
    s_add_u32 s43, s43, 1
    s_cmp_lt_u32 s43, 18
    s_cbranch_scc1 ld_74
    s_call_b64 s[76:77], PREP_w_issue_4
    s_add_u32 m0, m0, 1024
    s_add_u32 s39, s39, s3
    buffer_load_dwordx4 v239, s[12:15], s39 offen lds
    s_add_u32 m0, m0, 1024
    s_add_u32 s39, s39, s32
    buffer_load_dwordx4 v240, s[12:15], s39 offen lds
    s_add_u32 m0, m0, 1024
    s_add_u32 s39, s39, s32
    buffer_load_dwordx4 v239, s[12:15], s39 offen lds
    s_add_u32 m0, m0, 1024
    s_add_u32 s39, s39, s32
    buffer_load_dwordx4 v240, s[12:15], s39 offen lds
    s_mov_b32 m0, s19
    s_mov_b32 s39, s16
    s_mov_b32 s32, s17
    s_mov_b32 s3, s18
    s_waitcnt vmcnt(32)
    s_barrier
    buffer_load_dwordx4 v239, s[12:15], s39 offen lds
    s_add_u32 m0, m0, 1024
    s_add_u32 s39, s39, s32
    buffer_load_dwordx4 v240, s[12:15], s39 offen lds
    s_add_u32 m0, m0, 1024
    s_add_u32 s39, s39, s32
    buffer_load_dwordx4 v239, s[12:15], s39 offen lds
    s_add_u32 m0, m0, 1024
    s_add_u32 s39, s39, s32
    buffer_load_dwordx4 v240, s[12:15], s39 offen lds
    s_add_u32 m0, m0, 1024
    s_add_u32 s39, s39, s3
    buffer_load_dwordx4 v239, s[12:15], s39 offen lds
    s_add_u32 m0, m0, 1024
    s_add_u32 s39, s39, s32
    buffer_load_dwordx4 v240, s[12:15], s39 offen lds
    s_add_u32 m0, m0, 1024
    s_add_u32 s39, s39, s32
    buffer_load_dwordx4 v239, s[12:15], s39 offen lds
    s_add_u32 m0, m0, 1024
    s_add_u32 s39, s39, s32
    buffer_load_dwordx4 v240, s[12:15], s39 offen lds
    s_waitcnt vmcnt(32)
    s_barrier
    s_mov_b64 s[12:13], s[68:69]
    s_mov_b32 s14, 2097152
    s_mov_b32 s15, 0x20000
    s_and_b32 s35, s30, 1
    s_mul_i32 s38, s99, 128
    s_mul_i32 s41, s35, 65536
    s_add_u32 s38, s38, s41
    s_mul_i32 s41, s35, 4096
    s_add_u32 s41, s41, 24576
    s_mov_b32 s42, 0
    s_mov_b32 s44, s67
    s_and_b32 s36, s99, 7
    s_cmp_eq_u32 s36, 3
    s_cselect_b64 s[50:51], 0, -1
    s_mov_b32 s42, 90112
    s_mov_b32 s44, s67
    s_add_u32 s44, s44, 11
    s_and_b32 s44, s44, 15
    s_call_b64 s[76:77], SUB_w_issue_1
    s_mov_b32 s42, 98304
    s_mov_b32 s44, s67
    s_add_u32 s44, s44, 12
    s_and_b32 s44, s44, 15
    s_call_b64 s[76:77], SUB_w_issue_1
    s_waitcnt vmcnt(32)
    s_barrier
    s_mov_b32 s42, 106496
    s_mov_b32 s44, s67
    s_add_u32 s44, s44, 13
    s_and_b32 s44, s44, 15
    s_call_b64 s[76:77], SUB_w_issue_1
    s_mov_b32 s42, 114688
    s_mov_b32 s44, s67
    s_add_u32 s44, s44, 14
    s_and_b32 s44, s44, 15
    s_call_b64 s[76:77], SUB_w_issue_1
    s_waitcnt vmcnt(32)
    s_barrier
    s_mov_b32 s42, 24576
    s_mov_b32 s44, s67
    s_add_u32 s44, s44, 3
    s_and_b32 s44, s44, 15
    s_call_b64 s[76:77], SUB_w_issue_1
    s_mov_b32 s42, 32768
    s_mov_b32 s44, s67
    s_add_u32 s44, s44, 4
    s_and_b32 s44, s44, 15
    s_call_b64 s[76:77], SUB_w_issue_1
    s_waitcnt vmcnt(32)
    s_barrier
    s_mov_b32 s42, 40960
    s_mov_b32 s44, s67
    s_add_u32 s44, s44, 5
    s_and_b32 s44, s44, 15
    s_call_b64 s[76:77], SUB_w_issue_1
    s_mov_b32 s42, 49152
    s_mov_b32 s44, s67
    s_add_u32 s44, s44, 6
    s_and_b32 s44, s44, 15
    s_call_b64 s[76:77], SUB_w_issue_1
    s_mov_b32 s42, 0
    s_mov_b32 s44, s67
    s_add_u32 s44, s44, 0
    s_and_b32 s44, s44, 15
    s_call_b64 s[76:77], SUB_w_issue_1
    s_waitcnt vmcnt(36)
    s_barrier
    s_mov_b32 s42, 65536
    s_mov_b32 s44, s67
    s_add_u32 s44, s44, 8
    s_and_b32 s44, s44, 15
    s_call_b64 s[76:77], SUB_w_issue_1
    s_mov_b32 s42, 122880
    s_mov_b32 s44, s67
    s_add_u32 s44, s44, 15
    s_and_b32 s44, s44, 15
    s_call_b64 s[76:77], SUB_w_issue_1
    s_add_u32 s36, s41, 57344
    v_add_u32 v6, s36, v2
    s_barrier
    s_add_u32 s36, s41, 57344
    v_add_u32 v6, s36, v2
    ds_write_b128 v6, v[16:19] offset:16384
    ds_write_b128 v6, v[20:23] offset:17408
    ds_write_b128 v6, v[24:27] offset:18432
    ds_write_b128 v6, v[28:31] offset:19456
    ds_write_b128 v6, v[32:35] offset:24576
    ds_write_b128 v6, v[36:39] offset:25600
    ds_write_b128 v6, v[40:43] offset:26624
    ds_write_b128 v6, v[44:47] offset:27648
    ds_write_b128 v6, v[204:207] offset:0
    ds_write_b128 v6, v[208:211] offset:1024
    ds_write_b128 v6, v[212:215] offset:2048
    ds_write_b128 v6, v[216:219] offset:3072
    s_waitcnt lgkmcnt(0)
    s_branch NEXT
WL_t1:
    s_call_b64 s[76:77], PREP_w_issue_4
    s_mov_b32 m0, s19
    s_mov_b32 s39, s16
    s_mov_b32 s32, s17
    s_mov_b32 s3, s18
    s_waitcnt vmcnt(0)
    s_barrier
    s_waitcnt vmcnt(0)
    s_barrier
    s_waitcnt vmcnt(0)
    s_barrier
    s_waitcnt vmcnt(0)
    s_barrier
    s_waitcnt vmcnt(0)
    s_barrier
    buffer_load_dwordx4 v239, s[12:15], s39 offen lds
    s_add_u32 m0, m0, 1024
    s_add_u32 s39, s39, s32
    buffer_load_dwordx4 v240, s[12:15], s39 offen lds
    s_add_u32 m0, m0, 1024
    s_add_u32 s39, s39, s32
    buffer_load_dwordx4 v239, s[12:15], s39 offen lds
    s_add_u32 m0, m0, 1024
    s_add_u32 s39, s39, s32
    buffer_load_dwordx4 v240, s[12:15], s39 offen lds
    s_mov_b32 s43, 1
ld_75:
    s_mov_b32 s45, 8192
    s_add_u32 s19, s41, s42
    v_readlane_b32 s16, v249, s44
    s_nop 0
    s_bitcmp1_b32 s16, 0
    s_cselect_b32 s17, 16384, s45
    s_cselect_b32 s18, -40960, s45
    s_andn2_b32 s16, s16, 1
    s_add_u32 s16, s16, s38
    s_add_u32 s44, s44, 1
    s_add_u32 s42, s42, 16384
    s_cmp_eq_u32 s42, 98304
    s_cselect_b32 s42, 0, s42
    s_add_u32 m0, m0, 1024
    s_add_u32 s39, s39, s3
    buffer_load_dwordx4 v239, s[12:15], s39 offen lds
    s_add_u32 m0, m0, 1024
    s_add_u32 s39, s39, s32
    buffer_load_dwordx4 v240, s[12:15], s39 offen lds
    s_add_u32 m0, m0, 1024
    s_add_u32 s39, s39, s32
    buffer_load_dwordx4 v239, s[12:15], s39 offen lds
    s_add_u32 m0, m0, 1024
    s_add_u32 s39, s39, s32
    buffer_load_dwordx4 v240, s[12:15], s39 offen lds
    s_mov_b32 m0, s19
    s_mov_b32 s39, s16
    s_mov_b32 s32, s17
    s_mov_b32 s3, s18
    s_waitcnt vmcnt(8)
    s_barrier
    buffer_load_dwordx4 v239, s[12:15], s39 offen lds
    s_add_u32 m0, m0, 1024
    s_add_u32 s39, s39, s32
    buffer_load_dwordx4 v240, s[12:15], s39 offen lds
    s_add_u32 m0, m0, 1024
    s_add_u32 s39, s39, s32
    buffer_load_dwordx4 v239, s[12:15], s39 offen lds
    s_add_u32 m0, m0, 1024
    s_add_u32 s39, s39, s32
    buffer_load_dwordx4 v240, s[12:15], s39 offen lds
    s_add_u32 s43, s43, 1
    s_cmp_lt_u32 s43, 21
    s_cbranch_scc1 ld_75
    s_call_b64 s[76:77], PREP_w_issue_4
    s_add_u32 m0, m0, 1024
    s_add_u32 s39, s39, s3
    buffer_load_dwordx4 v239, s[12:15], s39 offen lds
    s_add_u32 m0, m0, 1024
    s_add_u32 s39, s39, s32
    buffer_load_dwordx4 v240, s[12:15], s39 offen lds
    s_add_u32 m0, m0, 1024
    s_add_u32 s39, s39, s32
    buffer_load_dwordx4 v239, s[12:15], s39 offen lds
    s_add_u32 m0, m0, 1024
    s_add_u32 s39, s39, s32
    buffer_load_dwordx4 v240, s[12:15], s39 offen lds
    s_mov_b32 m0, s19
    s_mov_b32 s39, s16
    s_mov_b32 s32, s17
    s_mov_b32 s3, s18
    s_waitcnt vmcnt(8)
    s_barrier
    buffer_load_dwordx4 v239, s[12:15], s39 offen lds
    s_add_u32 m0, m0, 1024
    s_add_u32 s39, s39, s32
    buffer_load_dwordx4 v240, s[12:15], s39 offen lds
    s_add_u32 m0, m0, 1024
    s_add_u32 s39, s39, s32
    buffer_load_dwordx4 v239, s[12:15], s39 offen lds
    s_add_u32 m0, m0, 1024
    s_add_u32 s39, s39, s32
    buffer_load_dwordx4 v240, s[12:15], s39 offen lds
    s_add_u32 m0, m0, 1024
    s_add_u32 s39, s39, s3
    buffer_load_dwordx4 v239, s[12:15], s39 offen lds
    s_add_u32 m0, m0, 1024
    s_add_u32 s39, s39, s32
    buffer_load_dwordx4 v240, s[12:15], s39 offen lds
    s_add_u32 m0, m0, 1024
    s_add_u32 s39, s39, s32
    buffer_load_dwordx4 v239, s[12:15], s39 offen lds
    s_add_u32 m0, m0, 1024
    s_add_u32 s39, s39, s32
    buffer_load_dwordx4 v240, s[12:15], s39 offen lds
    s_waitcnt vmcnt(8)
    s_barrier
    s_waitcnt vmcnt(0)
    s_barrier
    s_branch K_fin
NEXT:
    s_setprio 0
    s_add_u32 s60, s60, 1
    s_add_u32 s55, s55, 4194304
    s_add_u32 s62, s62, 4194304
    s_addc_u32 s63, s63, 0
    s_branch LAYER
K_fin:
    s_endpgm
dm_22m0:
    s_sleep 2
    buffer_load_dwordx4 v[180:183], v126, s[8:11], s44 offen offset:2048 sc1
    buffer_load_dwordx4 v[184:187], v127, s[8:11], s44 offen offset:2048 sc1
    buffer_load_dwordx4 v[188:191], v126, s[8:11], s44 offen offset:3072 sc1
    buffer_load_dwordx4 v[192:195], v127, s[8:11], s44 offen offset:3072 sc1
    buffer_load_dwordx4 v[196:199], v128, s[8:11], s44 offen offset:0 sc1
    buffer_load_dwordx4 v[200:203], v129, s[8:11], s44 offen offset:0 sc1
    buffer_load_dwordx4 v[204:207], v128, s[8:11], s44 offen offset:1024 sc1
    buffer_load_dwordx4 v[208:211], v129, s[8:11], s44 offen offset:1024 sc1
    buffer_load_dwordx4 v[212:215], v128, s[8:11], s44 offen offset:2048 sc1
    buffer_load_dwordx4 v[216:219], v129, s[8:11], s44 offen offset:2048 sc1
    buffer_load_dwordx4 v[220:223], v128, s[8:11], s44 offen offset:3072 sc1
    buffer_load_dwordx4 v[224:227], v129, s[8:11], s44 offen offset:3072 sc1
    s_waitcnt vmcnt(8)
    v_or3_b32 v17, v180, v184, v188
    v_bitop3_b32 v17, v17, v192, 1 bitop3:0xa8
    v_cmp_ne_u32 vcc, 0, v17
    s_add_u32 s53, s53, 1
    s_cmp_ge_u32 s53, s61
    s_cselect_b32 s61, 0, s61
    s_cbranch_scc1 dm_22n0
    s_cbranch_vccnz dm_22m0
    s_branch dm_22n0
dm_22m1:
    s_sleep 2
    buffer_load_dwordx4 v[196:199], v128, s[8:11], s44 offen offset:0 sc1
    buffer_load_dwordx4 v[200:203], v129, s[8:11], s44 offen offset:0 sc1
    buffer_load_dwordx4 v[204:207], v128, s[8:11], s44 offen offset:1024 sc1
    buffer_load_dwordx4 v[208:211], v129, s[8:11], s44 offen offset:1024 sc1
    buffer_load_dwordx4 v[212:215], v128, s[8:11], s44 offen offset:2048 sc1
    buffer_load_dwordx4 v[216:219], v129, s[8:11], s44 offen offset:2048 sc1
    buffer_load_dwordx4 v[220:223], v128, s[8:11], s44 offen offset:3072 sc1
    buffer_load_dwordx4 v[224:227], v129, s[8:11], s44 offen offset:3072 sc1
    s_waitcnt vmcnt(4)
    v_or3_b32 v17, v196, v200, v204
    v_bitop3_b32 v17, v17, v208, 1 bitop3:0xa8
    v_cmp_ne_u32 vcc, 0, v17
    s_add_u32 s53, s53, 1
    s_cmp_ge_u32 s53, s61
    s_cselect_b32 s61, 0, s61
    s_cbranch_scc1 dm_22n1
    s_cbranch_vccnz dm_22m1
    s_branch dm_22n1
dm_22m2:
    s_sleep 2
    buffer_load_dwordx4 v[212:215], v128, s[8:11], s44 offen offset:2048 sc1
    buffer_load_dwordx4 v[216:219], v129, s[8:11], s44 offen offset:2048 sc1
    buffer_load_dwordx4 v[220:223], v128, s[8:11], s44 offen offset:3072 sc1
    buffer_load_dwordx4 v[224:227], v129, s[8:11], s44 offen offset:3072 sc1
    s_waitcnt vmcnt(0)
    v_or3_b32 v17, v212, v216, v220
    v_bitop3_b32 v17, v17, v224, 1 bitop3:0xa8
    v_cmp_ne_u32 vcc, 0, v17
    s_add_u32 s53, s53, 1
    s_cmp_ge_u32 s53, s61
    s_cselect_b32 s61, 0, s61
    s_cbranch_scc1 dm_22n2
    s_cbranch_vccnz dm_22m2
    s_branch dm_22n2
dm_22f0:
    s_cselect_b32 s50, 1, 0
dm_22h0:
    s_sleep 2
    buffer_load_dwordx4 v[180:183], v126, s[8:11], s49 offen offset:2048 sc1
    buffer_load_dwordx4 v[184:187], v127, s[8:11], s49 offen offset:2048 sc1
    buffer_load_dwordx4 v[188:191], v126, s[8:11], s49 offen offset:3072 sc1
    buffer_load_dwordx4 v[192:195], v127, s[8:11], s49 offen offset:3072 sc1
    buffer_load_dwordx4 v[196:199], v128, s[8:11], s49 offen offset:0 sc1
    buffer_load_dwordx4 v[200:203], v129, s[8:11], s49 offen offset:0 sc1
    buffer_load_dwordx4 v[204:207], v128, s[8:11], s49 offen offset:1024 sc1
    buffer_load_dwordx4 v[208:211], v129, s[8:11], s49 offen offset:1024 sc1
    buffer_load_dwordx4 v[212:215], v128, s[8:11], s49 offen offset:2048 sc1
    buffer_load_dwordx4 v[216:219], v129, s[8:11], s49 offen offset:2048 sc1
    buffer_load_dwordx4 v[220:223], v128, s[8:11], s49 offen offset:3072 sc1
    buffer_load_dwordx4 v[224:227], v129, s[8:11], s49 offen offset:3072 sc1
    buffer_load_dwordx4 v[164:167], v126, s[8:11], s44 offen offset:0 sc1
    buffer_load_dwordx4 v[168:171], v127, s[8:11], s44 offen offset:0 sc1
    s_waitcnt vmcnt(10)
    v_or3_b32 v17, v180, v184, v188
    v_bitop3_b32 v17, v17, v192, 1 bitop3:0xa8
    v_cmp_ne_u32 vcc, 0, v17
    s_add_u32 s53, s53, 1
    s_cmp_ge_u32 s53, s61
    s_cselect_b32 s61, 0, s61
    s_cbranch_scc1 dm_22k0
    s_cbranch_vccnz dm_22h0
dm_22k0:
    s_cmp_eq_u32 s50, 1
    s_branch dm_22g0
dm_22f1:
    s_cselect_b32 s50, 1, 0
dm_22h1:
    s_sleep 2
    buffer_load_dwordx4 v[196:199], v128, s[8:11], s49 offen offset:0 sc1
    buffer_load_dwordx4 v[200:203], v129, s[8:11], s49 offen offset:0 sc1
    buffer_load_dwordx4 v[204:207], v128, s[8:11], s49 offen offset:1024 sc1
    buffer_load_dwordx4 v[208:211], v129, s[8:11], s49 offen offset:1024 sc1
    buffer_load_dwordx4 v[212:215], v128, s[8:11], s49 offen offset:2048 sc1
    buffer_load_dwordx4 v[216:219], v129, s[8:11], s49 offen offset:2048 sc1
    buffer_load_dwordx4 v[220:223], v128, s[8:11], s49 offen offset:3072 sc1
    buffer_load_dwordx4 v[224:227], v129, s[8:11], s49 offen offset:3072 sc1
    buffer_load_dwordx4 v[164:167], v126, s[8:11], s44 offen offset:0 sc1
    buffer_load_dwordx4 v[168:171], v127, s[8:11], s44 offen offset:0 sc1
    buffer_load_dwordx4 v[172:175], v126, s[8:11], s44 offen offset:1024 sc1
    buffer_load_dwordx4 v[176:179], v127, s[8:11], s44 offen offset:1024 sc1
    buffer_load_dwordx4 v[180:183], v126, s[8:11], s44 offen offset:2048 sc1
    buffer_load_dwordx4 v[184:187], v127, s[8:11], s44 offen offset:2048 sc1
    s_waitcnt vmcnt(10)
    v_or3_b32 v17, v196, v200, v204
    v_bitop3_b32 v17, v17, v208, 1 bitop3:0xa8
    v_cmp_ne_u32 vcc, 0, v17
    s_add_u32 s53, s53, 1
    s_cmp_ge_u32 s53, s61
    s_cselect_b32 s61, 0, s61
    s_cbranch_scc1 dm_22k1
    s_cbranch_vccnz dm_22h1
dm_22k1:
    s_cmp_eq_u32 s50, 1
    s_branch dm_22g1
dm_22f2:
    s_cselect_b32 s50, 1, 0
dm_22h2:
    s_sleep 2
    buffer_load_dwordx4 v[212:215], v128, s[8:11], s49 offen offset:2048 sc1
    buffer_load_dwordx4 v[216:219], v129, s[8:11], s49 offen offset:2048 sc1
    buffer_load_dwordx4 v[220:223], v128, s[8:11], s49 offen offset:3072 sc1
    buffer_load_dwordx4 v[224:227], v129, s[8:11], s49 offen offset:3072 sc1
    buffer_load_dwordx4 v[164:167], v126, s[8:11], s44 offen offset:0 sc1
    buffer_load_dwordx4 v[168:171], v127, s[8:11], s44 offen offset:0 sc1
    buffer_load_dwordx4 v[172:175], v126, s[8:11], s44 offen offset:1024 sc1
    buffer_load_dwordx4 v[176:179], v127, s[8:11], s44 offen offset:1024 sc1
    buffer_load_dwordx4 v[180:183], v126, s[8:11], s44 offen offset:2048 sc1
    buffer_load_dwordx4 v[184:187], v127, s[8:11], s44 offen offset:2048 sc1
    buffer_load_dwordx4 v[188:191], v126, s[8:11], s44 offen offset:3072 sc1
    buffer_load_dwordx4 v[192:195], v127, s[8:11], s44 offen offset:3072 sc1
    buffer_load_dwordx4 v[196:199], v128, s[8:11], s44 offen offset:0 sc1
    buffer_load_dwordx4 v[200:203], v129, s[8:11], s44 offen offset:0 sc1
    s_waitcnt vmcnt(10)
    v_or3_b32 v17, v212, v216, v220
    v_bitop3_b32 v17, v17, v224, 1 bitop3:0xa8
    v_cmp_ne_u32 vcc, 0, v17
    s_add_u32 s53, s53, 1
    s_cmp_ge_u32 s53, s61
    s_cselect_b32 s61, 0, s61
    s_cbranch_scc1 dm_22k2
    s_cbranch_vccnz dm_22h2
dm_22k2:
    s_cmp_eq_u32 s50, 1
    s_branch dm_22g2
dm_22f3:
    s_cselect_b32 s50, 1, 0
dm_22h3:
    s_sleep 2
    buffer_load_dwordx4 v[164:167], v126, s[8:11], s49 offen offset:0 sc1
    buffer_load_dwordx4 v[168:171], v127, s[8:11], s49 offen offset:0 sc1
    buffer_load_dwordx4 v[172:175], v126, s[8:11], s49 offen offset:1024 sc1
    buffer_load_dwordx4 v[176:179], v127, s[8:11], s49 offen offset:1024 sc1
    buffer_load_dwordx4 v[180:183], v126, s[8:11], s49 offen offset:2048 sc1
    buffer_load_dwordx4 v[184:187], v127, s[8:11], s49 offen offset:2048 sc1
    buffer_load_dwordx4 v[188:191], v126, s[8:11], s49 offen offset:3072 sc1
    buffer_load_dwordx4 v[192:195], v127, s[8:11], s49 offen offset:3072 sc1
    buffer_load_dwordx4 v[196:199], v128, s[8:11], s49 offen offset:0 sc1
    buffer_load_dwordx4 v[200:203], v129, s[8:11], s49 offen offset:0 sc1
    buffer_load_dwordx4 v[204:207], v128, s[8:11], s49 offen offset:1024 sc1
    buffer_load_dwordx4 v[208:211], v129, s[8:11], s49 offen offset:1024 sc1
    buffer_load_dwordx4 v[212:215], v128, s[8:11], s49 offen offset:2048 sc1
    buffer_load_dwordx4 v[216:219], v129, s[8:11], s49 offen offset:2048 sc1
    s_waitcnt vmcnt(10)
    v_or3_b32 v17, v164, v168, v172
    v_bitop3_b32 v17, v17, v176, 1 bitop3:0xa8
    v_cmp_ne_u32 vcc, 0, v17
    s_add_u32 s53, s53, 1
    s_cmp_ge_u32 s53, s61
    s_cselect_b32 s61, 0, s61
    s_cbranch_scc1 dm_22k3
    s_cbranch_vccnz dm_22h3
dm_22k3:
    s_cmp_eq_u32 s50, 1
    s_branch dm_22g3
dm_23m0:
    s_sleep 2
    s_mov_b32 s44, 425984
    buffer_load_dwordx4 v[180:183], v126, s[8:11], s44 offen sc1
    buffer_load_dwordx4 v[184:187], v127, s[8:11], s44 offen sc1
    s_add_u32 s44, s44, 16384
    buffer_load_dwordx4 v[188:191], v126, s[8:11], s44 offen sc1
    buffer_load_dwordx4 v[192:195], v127, s[8:11], s44 offen sc1
    s_add_u32 s44, s44, 16384
    buffer_load_dwordx4 v[196:199], v126, s[8:11], s44 offen sc1
    buffer_load_dwordx4 v[200:203], v127, s[8:11], s44 offen sc1
    s_add_u32 s44, s44, 16384
    buffer_load_dwordx4 v[204:207], v126, s[8:11], s44 offen sc1
    buffer_load_dwordx4 v[208:211], v127, s[8:11], s44 offen sc1
    s_add_u32 s44, s44, 16384
    buffer_load_dwordx4 v[212:215], v126, s[8:11], s44 offen sc1
    buffer_load_dwordx4 v[216:219], v127, s[8:11], s44 offen sc1
    s_add_u32 s44, s44, 16384
    buffer_load_dwordx4 v[220:223], v126, s[8:11], s44 offen sc1
    buffer_load_dwordx4 v[224:227], v127, s[8:11], s44 offen sc1
    s_add_u32 s44, s44, 16384
    s_waitcnt vmcnt(8)
    v_or3_b32 v17, v180, v184, v188
    v_bitop3_b32 v17, v17, v192, 1 bitop3:0xa8
    v_cmp_ne_u32 vcc, 0, v17
    s_add_u32 s53, s53, 1
    s_cmp_ge_u32 s53, s61
    s_cselect_b32 s61, 0, s61
    s_cbranch_scc1 dm_23n0
    s_cbranch_vccnz dm_23m0
    s_branch dm_23n0
dm_23m1:
    s_sleep 2
    s_mov_b32 s44, 458752
    buffer_load_dwordx4 v[196:199], v126, s[8:11], s44 offen sc1
    buffer_load_dwordx4 v[200:203], v127, s[8:11], s44 offen sc1
    s_add_u32 s44, s44, 16384
    buffer_load_dwordx4 v[204:207], v126, s[8:11], s44 offen sc1
    buffer_load_dwordx4 v[208:211], v127, s[8:11], s44 offen sc1
    s_add_u32 s44, s44, 16384
    buffer_load_dwordx4 v[212:215], v126, s[8:11], s44 offen sc1
    buffer_load_dwordx4 v[216:219], v127, s[8:11], s44 offen sc1
    s_add_u32 s44, s44, 16384
    buffer_load_dwordx4 v[220:223], v126, s[8:11], s44 offen sc1
    buffer_load_dwordx4 v[224:227], v127, s[8:11], s44 offen sc1
    s_add_u32 s44, s44, 16384
    s_waitcnt vmcnt(4)
    v_or3_b32 v17, v196, v200, v204
    v_bitop3_b32 v17, v17, v208, 1 bitop3:0xa8
    v_cmp_ne_u32 vcc, 0, v17
    s_add_u32 s53, s53, 1
    s_cmp_ge_u32 s53, s61
    s_cselect_b32 s61, 0, s61
    s_cbranch_scc1 dm_23n1
    s_cbranch_vccnz dm_23m1
    s_branch dm_23n1
dm_23m2:
    s_sleep 2
    s_mov_b32 s44, 491520
    buffer_load_dwordx4 v[212:215], v126, s[8:11], s44 offen sc1
    buffer_load_dwordx4 v[216:219], v127, s[8:11], s44 offen sc1
    s_add_u32 s44, s44, 16384
    buffer_load_dwordx4 v[220:223], v126, s[8:11], s44 offen sc1
    buffer_load_dwordx4 v[224:227], v127, s[8:11], s44 offen sc1
    s_add_u32 s44, s44, 16384
    s_waitcnt vmcnt(0)
    v_or3_b32 v17, v212, v216, v220
    v_bitop3_b32 v17, v17, v224, 1 bitop3:0xa8
    v_cmp_ne_u32 vcc, 0, v17
    s_add_u32 s53, s53, 1
    s_cmp_ge_u32 s53, s61
    s_cselect_b32 s61, 0, s61
    s_cbranch_scc1 dm_23n2
    s_cbranch_vccnz dm_23m2
    s_branch dm_23n2
dm_23f0:
    s_cselect_b32 s50, 1, 0
dm_23h0:
    s_sleep 2
    s_sub_u32 s44, s44, 114688
    buffer_load_dwordx4 v[180:183], v134, s[8:11], s44 offen sc1
    buffer_load_dwordx4 v[184:187], v135, s[8:11], s44 offen sc1
    s_add_u32 s44, s44, 16384
    buffer_load_dwordx4 v[188:191], v134, s[8:11], s44 offen sc1
    buffer_load_dwordx4 v[192:195], v135, s[8:11], s44 offen sc1
    s_add_u32 s44, s44, 16384
    buffer_load_dwordx4 v[196:199], v134, s[8:11], s44 offen sc1
    buffer_load_dwordx4 v[200:203], v135, s[8:11], s44 offen sc1
    s_add_u32 s44, s44, 16384
    buffer_load_dwordx4 v[204:207], v134, s[8:11], s44 offen sc1
    buffer_load_dwordx4 v[208:211], v135, s[8:11], s44 offen sc1
    s_add_u32 s44, s44, 16384
    buffer_load_dwordx4 v[212:215], v134, s[8:11], s44 offen sc1
    buffer_load_dwordx4 v[216:219], v135, s[8:11], s44 offen sc1
    s_add_u32 s44, s44, 16384
    buffer_load_dwordx4 v[220:223], v134, s[8:11], s44 offen sc1
    buffer_load_dwordx4 v[224:227], v135, s[8:11], s44 offen sc1
    s_add_u32 s44, s44, 16384
    buffer_load_dwordx4 v[164:167], v126, s[8:11], s44 offen sc1
    buffer_load_dwordx4 v[168:171], v127, s[8:11], s44 offen sc1
    s_add_u32 s44, s44, 16384
    s_waitcnt vmcnt(10)
    v_or3_b32 v17, v180, v184, v188
    v_bitop3_b32 v17, v17, v192, 1 bitop3:0xa8
    v_cmp_ne_u32 vcc, 0, v17
    s_add_u32 s53, s53, 1
    s_cmp_ge_u32 s53, s61
    s_cselect_b32 s61, 0, s61
    s_cbranch_scc1 dm_23k0
    s_cbranch_vccnz dm_23h0
dm_23k0:
    s_cmp_eq_u32 s50, 1
    s_branch dm_23g0
dm_23f1:
    s_cselect_b32 s50, 1, 0
dm_23h1:
    s_sleep 2
    s_sub_u32 s44, s44, 114688
    buffer_load_dwordx4 v[196:199], v134, s[8:11], s44 offen sc1
    buffer_load_dwordx4 v[200:203], v135, s[8:11], s44 offen sc1
    s_add_u32 s44, s44, 16384
    buffer_load_dwordx4 v[204:207], v134, s[8:11], s44 offen sc1
    buffer_load_dwordx4 v[208:211], v135, s[8:11], s44 offen sc1
    s_add_u32 s44, s44, 16384
    buffer_load_dwordx4 v[212:215], v134, s[8:11], s44 offen sc1
    buffer_load_dwordx4 v[216:219], v135, s[8:11], s44 offen sc1
    s_add_u32 s44, s44, 16384
    buffer_load_dwordx4 v[220:223], v134, s[8:11], s44 offen sc1
    buffer_load_dwordx4 v[224:227], v135, s[8:11], s44 offen sc1
    s_add_u32 s44, s44, 16384
    buffer_load_dwordx4 v[164:167], v126, s[8:11], s44 offen sc1
    buffer_load_dwordx4 v[168:171], v127, s[8:11], s44 offen sc1
    s_add_u32 s44, s44, 16384
    buffer_load_dwordx4 v[172:175], v126, s[8:11], s44 offen sc1
    buffer_load_dwordx4 v[176:179], v127, s[8:11], s44 offen sc1
    s_add_u32 s44, s44, 16384
    buffer_load_dwordx4 v[180:183], v126, s[8:11], s44 offen sc1
    buffer_load_dwordx4 v[184:187], v127, s[8:11], s44 offen sc1
    s_add_u32 s44, s44, 16384
    s_waitcnt vmcnt(10)
    v_or3_b32 v17, v196, v200, v204
    v_bitop3_b32 v17, v17, v208, 1 bitop3:0xa8
    v_cmp_ne_u32 vcc, 0, v17
    s_add_u32 s53, s53, 1
    s_cmp_ge_u32 s53, s61
    s_cselect_b32 s61, 0, s61
    s_cbranch_scc1 dm_23k1
    s_cbranch_vccnz dm_23h1
dm_23k1:
    s_cmp_eq_u32 s50, 1
    s_branch dm_23g1
dm_23f2:
    s_cselect_b32 s50, 1, 0
dm_23h2:
    s_sleep 2
    s_sub_u32 s44, s44, 114688
    buffer_load_dwordx4 v[212:215], v134, s[8:11], s44 offen sc1
    buffer_load_dwordx4 v[216:219], v135, s[8:11], s44 offen sc1
    s_add_u32 s44, s44, 16384
    buffer_load_dwordx4 v[220:223], v134, s[8:11], s44 offen sc1
    buffer_load_dwordx4 v[224:227], v135, s[8:11], s44 offen sc1
    s_add_u32 s44, s44, 16384
    buffer_load_dwordx4 v[164:167], v126, s[8:11], s44 offen sc1
    buffer_load_dwordx4 v[168:171], v127, s[8:11], s44 offen sc1
    s_add_u32 s44, s44, 16384
    buffer_load_dwordx4 v[172:175], v126, s[8:11], s44 offen sc1
    buffer_load_dwordx4 v[176:179], v127, s[8:11], s44 offen sc1
    s_add_u32 s44, s44, 16384
    buffer_load_dwordx4 v[180:183], v126, s[8:11], s44 offen sc1
    buffer_load_dwordx4 v[184:187], v127, s[8:11], s44 offen sc1
    s_add_u32 s44, s44, 16384
    buffer_load_dwordx4 v[188:191], v126, s[8:11], s44 offen sc1
    buffer_load_dwordx4 v[192:195], v127, s[8:11], s44 offen sc1
    s_add_u32 s44, s44, 16384
    buffer_load_dwordx4 v[196:199], v126, s[8:11], s44 offen sc1
    buffer_load_dwordx4 v[200:203], v127, s[8:11], s44 offen sc1
    s_add_u32 s44, s44, 16384
    s_waitcnt vmcnt(10)
    v_or3_b32 v17, v212, v216, v220
    v_bitop3_b32 v17, v17, v224, 1 bitop3:0xa8
    v_cmp_ne_u32 vcc, 0, v17
    s_add_u32 s53, s53, 1
    s_cmp_ge_u32 s53, s61
    s_cselect_b32 s61, 0, s61
    s_cbranch_scc1 dm_23k2
    s_cbranch_vccnz dm_23h2
dm_23k2:
    s_cmp_eq_u32 s50, 1
    s_branch dm_23g2
dm_23f3:
    s_cselect_b32 s50, 1, 0
dm_23h3:
    s_sleep 2
    s_sub_u32 s44, s44, 114688
    buffer_load_dwordx4 v[164:167], v134, s[8:11], s44 offen sc1
    buffer_load_dwordx4 v[168:171], v135, s[8:11], s44 offen sc1
    s_add_u32 s44, s44, 16384
    buffer_load_dwordx4 v[172:175], v134, s[8:11], s44 offen sc1
    buffer_load_dwordx4 v[176:179], v135, s[8:11], s44 offen sc1
    s_add_u32 s44, s44, 16384
    buffer_load_dwordx4 v[180:183], v134, s[8:11], s44 offen sc1
    buffer_load_dwordx4 v[184:187], v135, s[8:11], s44 offen sc1
    s_add_u32 s44, s44, 16384
    buffer_load_dwordx4 v[188:191], v134, s[8:11], s44 offen sc1
    buffer_load_dwordx4 v[192:195], v135, s[8:11], s44 offen sc1
    s_add_u32 s44, s44, 16384
    buffer_load_dwordx4 v[196:199], v134, s[8:11], s44 offen sc1
    buffer_load_dwordx4 v[200:203], v135, s[8:11], s44 offen sc1
    s_add_u32 s44, s44, 16384
    buffer_load_dwordx4 v[204:207], v134, s[8:11], s44 offen sc1
    buffer_load_dwordx4 v[208:211], v135, s[8:11], s44 offen sc1
    s_add_u32 s44, s44, 16384
    buffer_load_dwordx4 v[212:215], v134, s[8:11], s44 offen sc1
    buffer_load_dwordx4 v[216:219], v135, s[8:11], s44 offen sc1
    s_add_u32 s44, s44, 16384
    s_waitcnt vmcnt(10)
    v_or3_b32 v17, v164, v168, v172
    v_bitop3_b32 v17, v17, v176, 1 bitop3:0xa8
    v_cmp_ne_u32 vcc, 0, v17
    s_add_u32 s53, s53, 1
    s_cmp_ge_u32 s53, s61
    s_cselect_b32 s61, 0, s61
    s_cbranch_scc1 dm_23k3
    s_cbranch_vccnz dm_23h3
dm_23k3:
    s_cmp_eq_u32 s50, 1
    s_branch dm_23g3
SUB_w1_regs:
    s_mov_b64 s[12:13], s[68:69]
    s_mov_b32 s14, 2097152
    s_mov_b32 s15, 0x20000
    s_and_b32 s35, s30, 3
    s_mul_i32 s35, s35, 294912
    s_lshl_b32 s39, s99, 7
    s_add_u32 s39, s39, s35
    buffer_load_dwordx4 v[176:179], v238, s[12:15], s39 offen
    s_add_u32 s39, s39, 16384
    buffer_load_dwordx4 v[188:191], v238, s[12:15], s39 offen
    s_add_u32 s39, s39, 16384
    buffer_load_dwordx4 v[192:195], v238, s[12:15], s39 offen
    s_add_u32 s39, s39, 16384
    buffer_load_dwordx4 v[200:203], v238, s[12:15], s39 offen
    s_add_u32 s39, s39, 16384
    s_waitcnt vmcnt(8)
    buffer_load_dwordx4 v[204:207], v238, s[12:15], s39 offen
    s_add_u32 s39, s39, 16384
    buffer_load_dwordx4 v[208:211], v238, s[12:15], s39 offen
    s_add_u32 s39, s39, 16384
    buffer_load_dwordx4 v[212:215], v238, s[12:15], s39 offen
    s_add_u32 s39, s39, 16384
    buffer_load_dwordx4 v[216:219], v238, s[12:15], s39 offen
    s_add_u32 s39, s39, 16384
    s_waitcnt vmcnt(8)
    buffer_load_dwordx4 v[220:223], v238, s[12:15], s39 offen
    s_add_u32 s39, s39, 16384
    buffer_load_dwordx4 v[224:227], v238, s[12:15], s39 offen
    s_add_u32 s39, s39, 16384
    buffer_load_dwordx4 v[16:19], v238, s[12:15], s39 offen
    s_add_u32 s39, s39, 16384
    buffer_load_dwordx4 v[20:23], v238, s[12:15], s39 offen
    s_add_u32 s39, s39, 16384
    s_waitcnt vmcnt(8)
    buffer_load_dwordx4 v[24:27], v238, s[12:15], s39 offen
    s_add_u32 s39, s39, 16384
    buffer_load_dwordx4 v[28:31], v238, s[12:15], s39 offen
    s_add_u32 s39, s39, 16384
    buffer_load_dwordx4 v[32:35], v238, s[12:15], s39 offen
    s_add_u32 s39, s39, 16384
    buffer_load_dwordx4 v[36:39], v238, s[12:15], s39 offen
    s_add_u32 s39, s39, 16384
    s_waitcnt vmcnt(8)
    buffer_load_dwordx4 v[40:43], v238, s[12:15], s39 offen
    s_add_u32 s39, s39, 16384
    buffer_load_dwordx4 v[44:47], v238, s[12:15], s39 offen
    s_add_u32 s39, s39, 16384
    s_setpc_b64 s[76:77]
SUB_park:
    s_mov_b64 s[12:13], s[70:71]
    s_mov_b32 s14, 2097152
    s_mov_b32 s15, 0x20000
    s_and_b32 s35, s30, 3
    s_lshl_b32 s35, s35, 19
    s_lshl_b32 s39, s29, 7
    s_add_u32 s39, s39, s35
    buffer_load_dwordx4 v[48:51], v238, s[12:15], s39 offen
    s_add_u32 s39, s39, 16384
    buffer_load_dwordx4 v[52:55], v238, s[12:15], s39 offen
    s_add_u32 s39, s39, 16384
    buffer_load_dwordx4 v[56:59], v238, s[12:15], s39 offen
    s_add_u32 s39, s39, 16384
    buffer_load_dwordx4 v[60:63], v238, s[12:15], s39 offen
    s_add_u32 s39, s39, 16384
    s_waitcnt vmcnt(8)
    buffer_load_dwordx4 v[64:67], v238, s[12:15], s39 offen
    s_add_u32 s39, s39, 16384
    buffer_load_dwordx4 v[68:71], v238, s[12:15], s39 offen
    s_add_u32 s39, s39, 16384
    buffer_load_dwordx4 v[72:75], v238, s[12:15], s39 offen
    s_add_u32 s39, s39, 16384
    buffer_load_dwordx4 v[76:79], v238, s[12:15], s39 offen
    s_add_u32 s39, s39, 16384
    s_waitcnt vmcnt(8)
    buffer_load_dwordx4 v[80:83], v238, s[12:15], s39 offen
    s_add_u32 s39, s39, 16384
    buffer_load_dwordx4 v[84:87], v238, s[12:15], s39 offen
    s_add_u32 s39, s39, 16384
    buffer_load_dwordx4 v[88:91], v238, s[12:15], s39 offen
    s_add_u32 s39, s39, 16384
    buffer_load_dwordx4 v[92:95], v238, s[12:15], s39 offen
    s_add_u32 s39, s39, 16384
    s_waitcnt vmcnt(8)
    buffer_load_dwordx4 v[96:99], v238, s[12:15], s39 offen
    s_add_u32 s39, s39, 16384
    buffer_load_dwordx4 v[100:103], v238, s[12:15], s39 offen
    s_add_u32 s39, s39, 16384
    buffer_load_dwordx4 v[104:107], v238, s[12:15], s39 offen
    s_add_u32 s39, s39, 16384
    buffer_load_dwordx4 v[108:111], v238, s[12:15], s39 offen
    s_add_u32 s39, s39, 16384
    s_waitcnt vmcnt(8)
    buffer_load_dwordx4 v[112:115], v238, s[12:15], s39 offen
    s_add_u32 s39, s39, 16384
    buffer_load_dwordx4 v[116:119], v238, s[12:15], s39 offen
    s_add_u32 s39, s39, 16384
    buffer_load_dwordx4 v[120:123], v238, s[12:15], s39 offen
    s_add_u32 s39, s39, 16384
    buffer_load_dwordx4 v[124:127], v238, s[12:15], s39 offen
    s_add_u32 s39, s39, 16384
    s_waitcnt vmcnt(8)
    buffer_load_dwordx4 v[128:131], v238, s[12:15], s39 offen
    s_add_u32 s39, s39, 16384
    buffer_load_dwordx4 v[132:135], v238, s[12:15], s39 offen
    s_add_u32 s39, s39, 16384
    buffer_load_dwordx4 v[136:139], v238, s[12:15], s39 offen
    s_add_u32 s39, s39, 16384
    buffer_load_dwordx4 v[140:143], v238, s[12:15], s39 offen
    s_add_u32 s39, s39, 16384
    s_waitcnt vmcnt(8)
    s_setpc_b64 s[76:77]
SUB_park2:
    s_mov_b64 s[12:13], s[70:71]
    s_mov_b32 s14, 2097152
    s_mov_b32 s15, 0x20000
    s_and_b32 s35, s30, 3
    s_lshl_b32 s35, s35, 19
    s_lshl_b32 s39, s29, 7
    s_add_u32 s39, s39, s35
    s_add_u32 s39, s39, 393216
    buffer_load_dwordx4 v[144:147], v238, s[12:15], s39 offen
    s_add_u32 s39, s39, 16384
    buffer_load_dwordx4 v[148:151], v238, s[12:15], s39 offen
    s_add_u32 s39, s39, 16384
    buffer_load_dwordx4 v[152:155], v238, s[12:15], s39 offen
    s_add_u32 s39, s39, 16384
    buffer_load_dwordx4 v[156:159], v238, s[12:15], s39 offen
    s_add_u32 s39, s39, 16384
    s_waitcnt vmcnt(8)
    buffer_load_dwordx4 v[160:163], v238, s[12:15], s39 offen
    s_add_u32 s39, s39, 16384
    buffer_load_dwordx4 v[164:167], v238, s[12:15], s39 offen
    s_add_u32 s39, s39, 16384
    buffer_load_dwordx4 v[168:171], v238, s[12:15], s39 offen
    s_add_u32 s39, s39, 16384
    buffer_load_dwordx4 v[172:175], v238, s[12:15], s39 offen
    s_add_u32 s39, s39, 16384
    s_waitcnt vmcnt(8)
    s_setpc_b64 s[76:77]
SUB_w1_put:
    s_and_b32 s35, s30, 3
    s_mul_i32 s35, s35, 18432
    v_add_u32 v8, s35, v2
    v_mov_b32 v6, 162836
spin_76:
    s_sleep 2
    ds_read_b32 v7, v6
    s_waitcnt lgkmcnt(0)
    v_readfirstlane_b32 s53, v7
    s_nop 0
    s_cmp_ge_u32 s53, 8
    s_cbranch_scc0 spin_76
    s_waitcnt vmcnt(24)
    ds_write_b128 v8, v[176:179] offset:24576
    ds_write_b128 v8, v[188:191] offset:25600
    ds_write_b128 v8, v[192:195] offset:26624
    ds_write_b128 v8, v[200:203] offset:27648
    ds_write_b128 v8, v[204:207] offset:28672
    ds_write_b128 v8, v[208:211] offset:29696
    ds_write_b128 v8, v[212:215] offset:30720
    ds_write_b128 v8, v[216:219] offset:31744
    ds_write_b128 v8, v[220:223] offset:32768
    ds_write_b128 v8, v[224:227] offset:33792
    ds_write_b128 v8, v[16:19] offset:34816
    ds_write_b128 v8, v[20:23] offset:35840
    ds_write_b128 v8, v[24:27] offset:36864
    ds_write_b128 v8, v[28:31] offset:37888
    ds_write_b128 v8, v[32:35] offset:38912
    ds_write_b128 v8, v[36:39] offset:39936
    ds_write_b128 v8, v[40:43] offset:40960
    ds_write_b128 v8, v[44:47] offset:41984
    s_waitcnt lgkmcnt(0)
    s_setpc_b64 s[76:77]
SUB_before_d1:
    s_mov_b64 s[12:13], s[72:73]
    s_mov_b32 s14, 7340032
    s_mov_b32 s15, 0x20000
    v_readlane_b32 s36, v251, 0
    v_readlane_b32 s37, v251, 1
    v_readlane_b32 s34, v251, 2
    s_and_b32 s35, s30, 3
    s_mul_i32 s38, s35, 114688
    s_mul_i32 s39, s29, 448
    s_add_u32 s38, s38, s39
    s_and_b32 s36, s36, 15
    s_mul_i32 s36, s36, 458752
    s_add_u32 s36, s36, s38
    s_and_b32 s37, s37, 15
    s_mul_i32 s37, s37, 458752
    s_add_u32 s37, s37, s38
    s_and_b32 s34, s34, 15
    s_mul_i32 s34, s34, 458752
    s_add_u32 s34, s34, s38
    s_lshl_b32 s54, s60, 2
    s_add_u32 s54, s54, 4
    v_mov_b32 v8, 162896
spin_77:
    s_sleep 2
    ds_read_b32 v9, v8
    s_waitcnt lgkmcnt(0)
    v_readfirstlane_b32 s53, v9
    s_nop 0
    s_cmp_ge_u32 s53, s54
    s_cbranch_scc0 spin_77
    buffer_load_dwordx4 v[176:179], v241, s[12:15], s37 offen
    buffer_load_dwordx4 v[180:183], v242, s[12:15], s37 offen
    buffer_load_dwordx4 v[184:187], v243, s[12:15], s37 offen
    buffer_load_dwordx4 v[188:191], v244, s[12:15], s37 offen
    buffer_load_dwordx4 v[192:195], v245, s[12:15], s37 offen
    buffer_load_dwordx4 v[196:199], v246, s[12:15], s37 offen
    buffer_load_dwordx4 v[200:203], v247, s[12:15], s37 offen
    s_setpc_b64 s[76:77]
SUB_after_g1:
    s_mov_b64 s[12:13], s[72:73]
    s_mov_b32 s14, 7340032
    s_mov_b32 s15, 0x20000
    v_readlane_b32 s36, v251, 0
    v_readlane_b32 s37, v251, 1
    v_readlane_b32 s34, v251, 2
    s_and_b32 s35, s30, 3
    s_mul_i32 s38, s35, 114688
    s_mul_i32 s39, s29, 448
    s_add_u32 s38, s38, s39
    s_and_b32 s36, s36, 15
    s_mul_i32 s36, s36, 458752
    s_add_u32 s36, s36, s38
    s_and_b32 s37, s37, 15
    s_mul_i32 s37, s37, 458752
    s_add_u32 s37, s37, s38
    s_and_b32 s34, s34, 15
    s_mul_i32 s34, s34, 458752
    s_add_u32 s34, s34, s38
    s_mul_i32 s39, s35, 7168
    s_add_u32 m0, s39, 131072
    s_nop 0
    buffer_load_dwordx4 v241, s[12:15], s36 offen lds
    s_add_u32 m0, m0, 1024
    s_nop 0
    buffer_load_dwordx4 v242, s[12:15], s36 offen lds
    s_add_u32 m0, m0, 1024
    s_nop 0
    buffer_load_dwordx4 v243, s[12:15], s36 offen lds
    s_add_u32 m0, m0, 1024
    s_nop 0
    buffer_load_dwordx4 v244, s[12:15], s36 offen lds
    s_add_u32 m0, m0, 1024
    s_nop 0
    buffer_load_dwordx4 v245, s[12:15], s36 offen lds
    s_add_u32 m0, m0, 1024
    s_nop 0
    buffer_load_dwordx4 v246, s[12:15], s36 offen lds
    s_add_u32 m0, m0, 1024
    s_nop 0
    buffer_load_dwordx4 v247, s[12:15], s36 offen lds
    s_lshr_b32 s36, s67, 2
    s_sub_u32 s36, s35, s36
    s_and_b32 s36, s36, 3
    s_lshl_b32 s36, s36, 15
    v_add_u32 v6, s36, v2
    s_waitcnt vmcnt(14)
    ds_write_b128 v6, v[48:51] offset:0
    ds_write_b128 v6, v[52:55] offset:1024
    ds_write_b128 v6, v[56:59] offset:2048
    ds_write_b128 v6, v[60:63] offset:3072
    ds_write_b128 v6, v[64:67] offset:4096
    ds_write_b128 v6, v[68:71] offset:5120
    ds_write_b128 v6, v[72:75] offset:6144
    ds_write_b128 v6, v[76:79] offset:7168
    ds_write_b128 v6, v[80:83] offset:8192
    ds_write_b128 v6, v[84:87] offset:9216
    ds_write_b128 v6, v[88:91] offset:10240
    ds_write_b128 v6, v[92:95] offset:11264
    ds_write_b128 v6, v[96:99] offset:12288
    ds_write_b128 v6, v[100:103] offset:13312
    ds_write_b128 v6, v[104:107] offset:14336
    ds_write_b128 v6, v[108:111] offset:15360
    ds_write_b128 v6, v[112:115] offset:16384
    ds_write_b128 v6, v[116:119] offset:17408
    ds_write_b128 v6, v[120:123] offset:18432
    ds_write_b128 v6, v[124:127] offset:19456
    ds_write_b128 v6, v[128:131] offset:20480
    ds_write_b128 v6, v[132:135] offset:21504
    ds_write_b128 v6, v[136:139] offset:22528
    ds_write_b128 v6, v[140:143] offset:23552
    ds_write_b128 v6, v[144:147] offset:24576
    ds_write_b128 v6, v[148:151] offset:25600
    ds_write_b128 v6, v[152:155] offset:26624
    ds_write_b128 v6, v[156:159] offset:27648
    ds_write_b128 v6, v[160:163] offset:28672
    ds_write_b128 v6, v[164:167] offset:29696
    ds_write_b128 v6, v[168:171] offset:30720
    ds_write_b128 v6, v[172:175] offset:31744
    s_waitcnt lgkmcnt(0)
    s_setpc_b64 s[76:77]
SUB_after_g2:
    s_and_b32 s35, s30, 3
    s_mul_i32 s39, s35, 7168
    s_add_u32 s39, s39, 73728
    v_add_u32 v7, s39, v2
    ds_write_b128 v7, v[176:179] offset:0
    ds_write_b128 v7, v[180:183] offset:1024
    ds_write_b128 v7, v[184:187] offset:2048
    ds_write_b128 v7, v[188:191] offset:3072
    ds_write_b128 v7, v[192:195] offset:4096
    ds_write_b128 v7, v[196:199] offset:5120
    ds_write_b128 v7, v[200:203] offset:6144
    s_waitcnt vmcnt(0) lgkmcnt(0)
    s_setpc_b64 s[76:77]
SUB_r_pre:
    v_and_b32 v199, 7, v0
    v_lshrrev_b32 v228, 6, v0
    v_lshlrev_b32 v228, 4, v228
    v_bfe_u32 v229, v0, 3, 3
    v_add_u32 v228, v228, v229
    s_lshr_b32 s78, s29, 1
    s_lshl_b32 s78, s78, 16
    s_and_b32 s79, s29, 1
    s_lshl_b32 s79, s79, 7
    s_add_u32 s78, s78, s79
    s_lshr_b32 s79, s30, 1
    s_lshl_b32 s79, s79, 13
    s_add_u32 s78, s78, s79
    v_lshlrev_b32 v196, 8, v228
    v_lshl_add_u32 v196, v199, 4, v196
    v_add_u32 v196, s78, v196
    s_mov_b32 s84, s62
    s_mov_b32 s85, s63
    s_mov_b32 s86, 0x7e000
    s_mov_b32 s87, 0x20000
    s_add_u32 s88, s62, 0x80000
    s_addc_u32 s89, s63, 0
    s_mov_b32 s90, 0x7e000
    s_mov_b32 s91, 0x20000
    buffer_load_dwordx4 v[180:183], v196, s[84:87], 0 offen offset:0 sc1
    buffer_load_dwordx4 v[188:191], v196, s[88:91], 0 offen offset:0 sc1
    buffer_load_dwordx4 v[184:187], v196, s[84:87], 0 offen offset:2048 sc1
    buffer_load_dwordx4 v[192:195], v196, s[88:91], 0 offen offset:2048 sc1
    s_setpc_b64 s[76:77]
SUB_w_issue_1:
    s_add_u32 s19, s41, s42
    s_mul_i32 s16, s44, 131072
    s_add_u32 s16, s16, s38
    s_add_u32 s44, s44, 1
    s_and_b32 s44, s44, 15
    s_add_u32 s42, s42, 8192
    s_cmp_eq_u32 s42, 131072
    s_cselect_b32 s42, 0, s42
    s_mov_b32 m0, s19
    s_mov_b32 s39, s16
    buffer_load_dwordx4 v238, s[12:15], s39 offen lds
    s_add_u32 m0, m0, 1024
    s_add_u32 s39, s39, 16384
    buffer_load_dwordx4 v238, s[12:15], s39 offen lds
    s_add_u32 m0, m0, 1024
    s_add_u32 s39, s39, 16384
    buffer_load_dwordx4 v238, s[12:15], s39 offen lds
    s_add_u32 m0, m0, 1024
    s_add_u32 s39, s39, 16384
    buffer_load_dwordx4 v238, s[12:15], s39 offen lds
    s_setpc_b64 s[76:77]
PREP_a_issue_4:
    s_add_u32 s19, s41, s42
    v_readlane_b32 s16, v249, s44
    v_readlane_b32 s17, v250, s44
    s_add_u32 s16, s16, s38
    s_add_u32 s17, s17, s38
    s_add_u32 s44, s44, 1
    s_add_u32 s42, s42, 16384
    s_cmp_eq_u32 s42, 49152
    s_cselect_b32 s42, 0, s42
    s_setpc_b64 s[76:77]
PREP_w_issue_4:
    s_mov_b32 s45, 8192
    s_add_u32 s19, s41, s42
    v_readlane_b32 s16, v249, s44
    s_nop 0
    s_bitcmp1_b32 s16, 0
    s_cselect_b32 s17, 16384, s45
    s_cselect_b32 s18, -40960, s45
    s_andn2_b32 s16, s16, 1
    s_add_u32 s16, s16, s38
    s_add_u32 s44, s44, 1
    s_add_u32 s42, s42, 16384
    s_cmp_eq_u32 s42, 98304
    s_cselect_b32 s42, 0, s42
    s_setpc_b64 s[76:77]
K_end:
    s_endpgm
.p2align 6
K_tab:
.short 4096,5137,6178,11379,18660,25941,40502,33223,47784,55065,19706,12427,26988,34269,48830,41551,56096,9264,20736,10448,23824,25008,38384,35296,39568,49856,54128,52944,0,0,0,0
.short 4096,5137,6178,18659,11380,25941,33222,47783,40504,55065,12426,26987,19708,34269,41550,56111,48816,9264,10448,23824,20736,25008,35296,39568,38384,49856,52944,54128,0,0,0,0
.short 4096,5137,6178,11379,25940,18661,33222,40503,55064,47785,12426,19707,34268,26989,41550,48831,9264,56096,10448,20736,25008,23824,35296,38384,49856,39568,52944,54128,0,0,0,0
.short 4096,5137,6178,11379,18660,33221,25942,40503,47784,12425,55066,19707,26988,41549,34270,48831,56096,10448,9264,20736,23824,35296,25008,38384,39568,52944,49856,54128,0,0,0,0
.short 11377,12418,13459,18660,4101,25942,33223,47784,40505,55066,5147,26988,19709,34270,41551,56096,48816,6176,10288,23824,20736,25008,35296,39568,38384,49856,52944,54128,0,0,0,0
.short 11377,12418,13459,4100,25941,18662,33223,40504,55065,47786,5147,19708,34269,26990,41551,48816,6176,56096,10288,20736,25008,23824,35296,38384,49856,39568,52944,54128,0,0,0,0
.short 11377,12418,13459,4100,18661,33222,25943,40504,47785,5146,55067,19708,26989,41550,34271,48816,56096,10288,6176,20736,23824,35296,25008,38384,39568,52944,49856,54128,0,0,0,0
.short 11377,12418,13459,4100,18661,25942,40503,33224,47785,55066,19707,5148,26989,34270,48831,41536,56096,6176,20736,10288,23824,25008,38384,35296,39568,49856,54128,52944,0,0,0,0
.short 18658,19699,20740,4101,25942,11383,33224,40505,55066,47787,5148,12429,34270,26991,41536,48817,6176,56096,9264,10448,25008,23824,35296,38384,49856,39568,52944,54128,0,0,0,0
.short 18658,19699,20740,4101,11382,33223,25944,40505,47786,5147,55068,12429,26990,41551,34256,48817,56096,9264,6176,10448,23824,35296,25008,38384,39568,52944,49856,54128,0,0,0,0
.short 18658,19699,20740,4101,11382,25943,40504,33225,47786,55067,12428,5149,26990,34271,48816,41537,56096,6176,10448,9264,23824,25008,38384,35296,39568,49856,54128,52944,0,0,0,0
.short 18658,19699,20740,11381,4102,25943,33224,47785,40506,55067,5148,26989,12430,34271,41536,56097,48816,6176,9264,23824,10448,25008,35296,39568,38384,49856,52944,54128,0,0,0,0
.short 25939,26980,28021,4102,11383,33224,18665,40506,47787,5148,55069,12430,19711,41536,34257,48818,56096,9264,6176,10448,20736,35296,24848,38384,39568,52944,49856,54128,0,0,0,0
.short 25939,26980,28021,4102,11383,18664,40505,33226,47787,55068,12429,5150,19711,34256,48817,41538,56096,6176,10448,9264,20736,24848,38384,35296,39568,49856,54128,52944,0,0,0,0
.short 25939,26980,28021,11382,4103,18664,33225,47786,40507,55068,5149,19710,12431,34256,41537,56098,48816,6176,9264,20736,10448,24848,35296,39568,38384,49856,52944,54128,0,0,0,0
.short 25939,26980,28021,4102,18663,11384,33225,40506,55067,47788,5149,12430,34271,19696,41537,48818,6176,56096,9264,10448,24848,20736,35296,38384,49856,39568,52944,54128,0,0,0,0
.short 33220,34261,35302,4103,11384,18665,40506,25947,47788,55069,12430,5151,19696,26977,48818,41539,56096,6176,10448,9264,20736,23824,38384,25008,39568,49856,54128,52944,0,0,0,0
.short 33220,34261,35302,11383,4104,18665,25946,47787,40508,55069,5150,19711,12416,26977,41538,56099,48816,6176,9264,20736,10448,23824,25008,39568,38384,49856,52944,54128,0,0,0,0
.short 33220,34261,35302,4103,18664,11385,25946,40507,55068,47789,5150,12431,26976,19697,41538,48819,6176,56096,9264,10448,23824,20736,25008,38384,49856,39568,52944,54128,0,0,0,0
.short 33220,34261,35302,4103,11384,25945,18666,40507,47788,5149,55070,12431,19696,41537,26978,48819,56096,9264,6176,10448,20736,25008,23824,38384,39568,52944,49856,54128,0,0,0,0
.short 40501,41542,42583,11384,4105,18666,25947,47788,33229,55070,5151,19696,12417,26978,34259,56100,48816,6176,9264,20736,10448,23824,25008,39408,35296,49856,52944,54128,0,0,0,0
.short 40501,41542,42583,4104,18665,11386,25947,33228,55069,47790,5151,12416,26977,19698,34259,48820,6176,56096,9264,10448,23824,20736,25008,35296,49856,39408,52944,54128,0,0,0,0
.short 40501,41542,42583,4104,11385,25946,18667,33228,47789,5150,55071,12416,19697,34258,26979,48820,56096,9264,6176,10448,20736,25008,23824,35296,39408,52944,49856,54128,0,0,0,0
.short 40501,41542,42583,4104,11385,18666,33227,25948,47789,55070,12431,5136,19697,26978,48819,34260,56096,6176,10448,9264,20736,23824,35296,25008,39408,49856,54128,52944,0,0,0,0
.short 47782,48823,49864,4105,18666,11387,25948,33229,55070,40511,5136,12417,26978,19699,34260,41541,6176,56096,9264,10448,23824,20736,25008,35296,39568,38384,52944,54128,0,0,0,0
.short 47782,48823,49864,4105,11386,25947,18668,33229,40510,5151,55056,12417,19698,34259,26980,41541,56096,9264,6176,10448,20736,25008,23824,35296,38384,52944,39568,54128,0,0,0,0
.short 47782,48823,49864,4105,11386,18667,33228,25949,40510,55071,12416,5137,19698,26979,41540,34261,56096,6176,10448,9264,20736,23824,35296,25008,38384,39568,54128,52944,0,0,0,0
.short 47782,48823,49864,11385,4106,18667,25948,40509,33230,55071,5136,19697,12418,26979,34260,56101,41536,6176,9264,20736,10448,23824,25008,38384,35296,39568,52944,54128,0,0,0,0
.short 55063,56104,57145,4106,11387,25948,18669,33230,40511,5136,47777,12418,19699,34260,26981,41542,48816,9264,6176,10448,20736,25008,23824,35296,38384,49856,39568,53968,0,0,0,0
.short 55063,56104,57145,4106,11387,18668,33229,25950,40511,47776,12417,5138,19699,26980,41541,34262,48816,6176,10448,9264,20736,23824,35296,25008,38384,39568,53968,49856,0,0,0,0
.short 55063,56104,57145,11386,4107,18668,25949,40510,33231,47776,5137,19698,12419,26980,34261,48822,41536,6176,9264,20736,10448,23824,25008,38384,35296,39568,49856,53968,0,0,0,0
.short 55063,56104,57145,4106,18667,11388,25949,33230,47791,40496,5137,12418,26979,19700,34261,41542,6176,48816,9264,10448,23824,20736,25008,35296,39568,38384,49856,53968,0,0,0,0
.short 4104,5145,6186,11387,18668,25949,40510,33231,47776,55057,19698,12419,26980,34261,48822,41543,56096,9264,20736,10448,23824,25008,38384,35296,39568,49856,54128,52944,0,0,0,0
.short 4104,5145,6186,18667,11388,25949,33230,47791,40496,55057,12418,26979,19700,34261,41542,56103,48816,9264,10448,23824,20736,25008,35296,39568,38384,49856,52944,54128,0,0,0,0
.short 4104,5145,6186,11387,25948,18669,33230,40511,55056,47777,12418,19699,34260,26981,41542,48823,9264,56096,10448,20736,25008,23824,35296,38384,49856,39568,52944,54128,0,0,0,0
.short 4104,5145,6186,11387,18668,33229,25950,40511,47776,12417,55058,19699,26980,41541,34262,48823,56096,10448,9264,20736,23824,35296,25008,38384,39568,52944,49856,54128,0,0,0,0
.short 11385,12426,13467,18668,4109,25950,33231,47776,40497,55058,5139,26980,19701,34262,41543,56104,48816,6176,10288,23824,20736,25008,35296,39568,38384,49856,52944,54128,0,0,0,0
.short 11385,12426,13467,4108,25949,18670,33231,40496,55057,47778,5139,19700,34261,26982,41543,48824,6176,56096,10288,20736,25008,23824,35296,38384,49856,39568,52944,54128,0,0,0,0
.short 11385,12426,13467,4108,18669,33230,25951,40496,47777,5138,55059,19700,26981,41542,34263,48824,56096,10288,6176,20736,23824,35296,25008,38384,39568,52944,49856,54128,0,0,0,0
.short 11385,12426,13467,4108,18669,25950,40511,33216,47777,55058,19699,5140,26981,34262,48823,41544,56096,6176,20736,10288,23824,25008,38384,35296,39568,49856,54128,52944,0,0,0,0
.short 18666,19707,20748,4109,25950,11391,33216,40497,55058,47779,5140,12421,34262,26983,41544,48825,6176,56096,9264,10448,25008,23824,35296,38384,49856,39568,52944,54128,0,0,0,0
.short 18666,19707,20748,4109,11390,33231,25936,40497,47778,5139,55060,12421,26982,41543,34264,48825,56096,9264,6176,10448,23824,35296,25008,38384,39568,52944,49856,54128,0,0,0,0
.short 18666,19707,20748,4109,11390,25951,40496,33217,47778,55059,12420,5141,26982,34263,48824,41545,56096,6176,10448,9264,23824,25008,38384,35296,39568,49856,54128,52944,0,0,0,0
.short 18666,19707,20748,11389,4110,25951,33216,47777,40498,55059,5140,26981,12422,34263,41544,56105,48816,6176,9264,23824,10448,25008,35296,39568,38384,49856,52944,54128,0,0,0,0
.short 25947,26988,28029,4110,11391,33216,18657,40498,47779,5140,55061,12422,19703,41544,34265,48826,56096,9264,6176,10448,20736,35296,24848,38384,39568,52944,49856,54128,0,0,0,0
.short 25947,26988,28029,4110,11391,18656,40497,33218,47779,55060,12421,5142,19703,34264,48825,41546,56096,6176,10448,9264,20736,24848,38384,35296,39568,49856,54128,52944,0,0,0,0
.short 25947,26988,28029,11390,4111,18656,33217,47778,40499,55060,5141,19702,12423,34264,41545,56106,48816,6176,9264,20736,10448,24848,35296,39568,38384,49856,52944,54128,0,0,0,0
.short 25947,26988,28029,4110,18671,11376,33217,40498,55059,47780,5141,12422,34263,19704,41545,48826,6176,56096,9264,10448,24848,20736,35296,38384,49856,39568,52944,54128,0,0,0,0
.short 33228,34269,35310,4111,11376,18657,40498,25939,47780,55061,12422,5143,19704,26985,48826,41547,56096,6176,10448,9264,20736,23824,38384,25008,39568,49856,54128,52944,0,0,0,0
.short 33228,34269,35310,11391,4096,18657,25938,47779,40500,55061,5142,19703,12424,26985,41546,56107,48816,6176,9264,20736,10448,23824,25008,39568,38384,49856,52944,54128,0,0,0,0
.short 33228,34269,35310,4111,18656,11377,25938,40499,55060,47781,5142,12423,26984,19705,41546,48827,6176,56096,9264,10448,23824,20736,25008,38384,49856,39568,52944,54128,0,0,0,0
.short 33228,34269,35310,4111,11376,25937,18658,40499,47780,5141,55062,12423,19704,41545,26986,48827,56096,9264,6176,10448,20736,25008,23824,38384,39568,52944,49856,54128,0,0,0,0
.short 40509,41550,42591,11376,4097,18658,25939,47780,33221,55062,5143,19704,12425,26986,34267,56108,48816,6176,9264,20736,10448,23824,25008,39408,35296,49856,52944,54128,0,0,0,0
.short 40509,41550,42591,4096,18657,11378,25939,33220,55061,47782,5143,12424,26985,19706,34267,48828,6176,56096,9264,10448,23824,20736,25008,35296,49856,39408,52944,54128,0,0,0,0
.short 40509,41550,42591,4096,11377,25938,18659,33220,47781,5142,55063,12424,19705,34266,26987,48828,56096,9264,6176,10448,20736,25008,23824,35296,39408,52944,49856,54128,0,0,0,0
.short 40509,41550,42591,4096,11377,18658,33219,25940,47781,55062,12423,5144,19705,26986,48827,34268,56096,6176,10448,9264,20736,23824,35296,25008,39408,49856,54128,52944,0,0,0,0
.short 47790,48831,49856,4097,18658,11379,25940,33221,55062,40503,5144,12425,26986,19707,34268,41549,6176,56096,9264,10448,23824,20736,25008,35296,39568,38384,52944,54128,0,0,0,0
.short 47790,48831,49856,4097,11378,25939,18660,33221,40502,5143,55064,12425,19706,34267,26988,41549,56096,9264,6176,10448,20736,25008,23824,35296,38384,52944,39568,54128,0,0,0,0
.short 47790,48831,49856,4097,11378,18659,33220,25941,40502,55063,12424,5145,19706,26987,41548,34269,56096,6176,10448,9264,20736,23824,35296,25008,38384,39568,54128,52944,0,0,0,0
.short 47790,48831,49856,11377,4098,18659,25940,40501,33222,55063,5144,19705,12426,26987,34268,56109,41536,6176,9264,20736,10448,23824,25008,38384,35296,39568,52944,54128,0,0,0,0
.short 55071,56096,57137,4098,11379,25940,18661,33222,40503,5144,47785,12426,19707,34268,26989,41550,48816,9264,6176,10448,20736,25008,23824,35296,38384,49856,39568,53968,0,0,0,0
.short 55071,56096,57137,4098,11379,18660,33221,25942,40503,47784,12425,5146,19707,26988,41549,34270,48816,6176,10448,9264,20736,23824,35296,25008,38384,39568,53968,49856,0,0,0,0
.short 55071,56096,57137,11378,4099,18660,25941,40502,33223,47784,5145,19706,12427,26988,34269,48830,41536,6176,9264,20736,10448,23824,25008,38384,35296,39568,49856,53968,0,0,0,0
.short 55071,56096,57137,4098,18659,11380,25941,33222,47783,40504,5145,12426,26987,19708,34269,41550,6176,48816,9264,10448,23824,20736,25008,35296,39568,38384,49856,53968,0,0,0,0
.section .rodata,"a"
.p2align 6
.amdhsa_kernel interleave_layers__ssm_conv_h3__mixer_s_mlp__prompt_kernel
  .amdhsa_next_free_vgpr 256
  .amdhsa_next_free_sgpr 102
  .amdhsa_accum_offset 256
  .amdhsa_group_segment_fixed_size 0
  .amdhsa_kernarg_size 112
  .amdhsa_user_sgpr_count 2
  .amdhsa_user_sgpr_kernarg_segment_ptr 1
  .amdhsa_system_sgpr_workgroup_id_x 1
  .amdhsa_float_denorm_mode_32 3
.end_amdhsa_kernel
```

```asm
; @launch grid=(256,1,1) block=(512,1,1) lds=163840
.amdgcn_target "amdgcn-amd-amdhsa--gfx950"
.text
.globl interleave_layers__ssm_conv_h3__mixer_s_mlp__prompt_kernel
.p2align 8
.type interleave_layers__ssm_conv_h3__mixer_s_mlp__prompt_kernel,@function
interleave_layers__ssm_conv_h3__mixer_s_mlp__prompt_kernel:
    s_cmp_ge_u32 s2, 256
    s_cbranch_scc1 K_end
    s_load_dwordx8 s[8:15], s[0:1], 8
    s_load_dwordx2 s[6:7], s[0:1], 0
    s_load_dwordx8 s[68:75], s[0:1], 56
    s_load_dwordx2 s[4:5], s[0:1], 104
    s_load_dwordx2 s[84:85], s[0:1], 96
    s_memrealtime s[46:47]
    s_load_dwordx2 s[96:97], s[0:1], 40
    v_lshrrev_b32 v1, 6, v0
    s_nop 0
    v_readfirstlane_b32 s30, v1
    s_getpc_b64 s[48:49]
K_pc:
    s_lshr_b32 s36, s2, 3
    s_lshl_b32 s36, s36, 11
    v_lshlrev_b32 v4, 2, v0
    v_add_u32 v4, s36, v4
    v_cmp_gt_u32 vcc, K_end-K_pc-8, v4
    s_nop 0
    s_and_saveexec_b64 s[36:37], vcc
    s_cbranch_execz K_3
    v_mov_b32 v5, s49
    v_add_co_u32 v4, vcc, s48, v4
    s_nop 1
    v_addc_co_u32 v5, vcc, 0, v5, vcc
    global_load_dword v250, v[4:5], off
K_3:
    s_mov_b64 exec, -1
    v_and_b32 v6, 31, v0
    v_lshrrev_b32 v7, 5, v0
    s_and_b32 s34, s2, 7
    s_lshr_b32 s35, s2, 3
    s_lshl_b32 s36, s35, 17
    s_lshl_b32 s37, s34, 8
    s_add_u32 s36, s36, s37
    v_lshlrev_b32 v8, 13, v7
    v_lshl_add_u32 v8, v6, 3, v8
    v_add_u32 v12, s36, v8
    v_add_u32 v14, 4096, v12
    s_mov_b32 s18, 4194304
    s_mov_b32 s19, 0x20000
    s_mov_b32 s22, s18
    s_mov_b32 s23, s19
    s_waitcnt lgkmcnt(0)
    s_mov_b32 s86, 256
    s_mov_b32 s87, 0x20000
    v_mov_b32 v78, 0
    s_lshl_b32 s45, s2, 3
    s_add_u32 s45, s45, s30
    s_cmp_lg_u32 s45, 4
    s_cbranch_scc1 KV_t0
    s_getreg_b32 s45, hwreg(HW_REG_XCC_ID, 0, 3)
    s_lshl_b32 s45, s45, 1
    s_lshl_b32 s44, s46, 6
    s_or_b32 s44, s44, s45
    s_or_b32 s44, s44, 1
    v_mov_b32 v76, s44
    v_mov_b32 v77, 0
    s_mov_b64 exec, 1
    buffer_store_dwordx2 v[76:77], v78, s[84:87], 0 offen sc1
    s_mov_b64 exec, -1
KV_t0:
    s_mov_b64 s[16:17], s[8:9]
    s_mov_b64 s[20:21], s[10:11]
    buffer_load_dwordx2 v[28:29], v12, s[16:19], 0 offen offset:0 nt
    buffer_load_dwordx2 v[30:31], v12, s[16:19], 0 offen offset:2048 nt
    buffer_load_dwordx2 v[32:33], v14, s[16:19], 0 offen offset:0 nt
    buffer_load_dwordx2 v[34:35], v14, s[16:19], 0 offen offset:2048 nt
    buffer_load_dwordx2 v[36:37], v12, s[20:23], 0 offen offset:0 nt
    buffer_load_dwordx2 v[38:39], v12, s[20:23], 0 offen offset:2048 nt
    buffer_load_dwordx2 v[40:41], v14, s[20:23], 0 offen offset:0 nt
    buffer_load_dwordx2 v[42:43], v14, s[20:23], 0 offen offset:2048 nt
    v_subrev_u32 v9, 6144, v12
    v_subrev_u32 v10, 4096, v12
    v_subrev_u32 v11, 2048, v12
    s_lshl_b32 s37, s34, 10
    v_lshlrev_b32 v16, 5, v6
    v_add_u32 v16, s37, v16
    s_mov_b32 s24, s12
    s_mov_b32 s25, s13
    s_mov_b32 s26, 0x2000
    s_mov_b32 s27, 0x20000
    v_and_b32 v8, 1, v7
    v_lshl_add_u32 v16, v8, 4, v16
    buffer_load_dwordx4 v[44:47], v16, s[24:27], 0 offen
    s_cmp_lg_u32 s30, 4
    s_cbranch_scc1 KV_t2
    buffer_load_dword v76, v78, s[84:87], 0 offen sc1
KV_t2:
    s_bfm_b64 exec, 32, 0
    buffer_load_dwordx2 v[22:23], v9, s[16:19], 0 offen nt
    buffer_load_dwordx2 v[24:25], v10, s[16:19], 0 offen nt
    buffer_load_dwordx2 v[26:27], v11, s[16:19], 0 offen nt
    s_mov_b64 exec, -1
    v_and_b32 v1, 63, v0
    v_lshlrev_b32 v2, 4, v1
    v_lshlrev_b32 v3, 2, v1
    s_mov_b32 s67, 0
    s_mov_b32 s60, 0
    s_mov_b32 s61, 40000
    s_mov_b32 s52, 0
    s_mov_b32 s55, 0
    s_mov_b32 s92, 0
    s_mov_b32 s93, 0
    s_mov_b32 s94, 0
    s_mov_b32 s56, s4
    s_mov_b32 s57, s5
    s_mov_b32 s58, 0xa000000
    s_mov_b32 s59, 0x20000
    s_add_u32 s62, s4, 33554432
    s_addc_u32 s63, s5, 0
    s_and_b32 s41, s30, 3
    s_and_b32 s38, s2, 7
    s_lshl_b32 s38, s38, 5
    s_lshr_b32 s39, s2, 3
    s_add_u32 s38, s38, s39
    s_lshl_b32 s39, s38, 2
    s_add_u32 s39, s39, s41
    s_mul_i32 s40, s41, 24576
    s_lshr_b32 s36, s39, 1
    s_lshl_b32 s36, s36, 2
    s_load_dword s98, s[96:97], s36
    s_lshl_b32 s36, s39, 12
    s_add_u32 s12, s14, s36
    s_addc_u32 s13, s15, 0
    s_mov_b32 s14, 4096
    s_mov_b32 s15, 0x20000
    s_lshr_b32 s45, s30, 2
    s_lshl_b32 s45, s45, 11
    s_add_u32 s36, s45, 0xffffffc0
    v_add_u32 v70, s36, v2
    v_add_u32 v71, 16, v70
    s_add_u32 s36, s45, 0x3c0
    v_add_u32 v72, s36, v2
    v_add_u32 v73, 16, v72
    s_mov_b32 s36, 4032
    v_add_u32 v74, s36, v2
    v_add_u32 v75, 16, v74
    s_and_b32 s34, s2, 7
    s_lshr_b32 s35, s2, 3
    v_mov_b32 v80, 0
    v_mov_b32 v81, 0
    v_mov_b32 v82, 0
    v_mov_b32 v83, 0
    v_add_u32 v86, s40, v2
    ds_write_b128 v86, v[80:83] offset:22784
    s_bfm_b64 exec, 26, 0
    ds_write_b128 v86, v[80:83] offset:23808
    s_mov_b64 exec, -1
    v_lshlrev_b32 v8, 2, v7
    v_sub_u32 v8, 60, v8
    v_lshrrev_b32 v85, 3, v8
    v_bfe_u32 v84, v6, 1, 3
    v_xor_b32 v85, v85, v84
    v_lshlrev_b32 v85, 4, v85
    v_and_b32 v8, 7, v8
    v_lshl_add_u32 v85, v8, 1, v85
    v_lshl_add_u32 v84, v6, 9, v85
    v_add_u32 v84, 98304, v84
    s_waitcnt vmcnt(0)
    s_cmp_lg_u32 s30, 4
    s_cbranch_scc1 KV_t1
KV_t1:
    buffer_load_dwordx4 v[52:55], v70, s[12:15], 0 offen nt
    buffer_load_dwordx2 v[56:57], v71, s[12:15], 0 offen nt
    buffer_load_dwordx4 v[58:61], v72, s[12:15], 0 offen nt
    buffer_load_dwordx2 v[62:63], v73, s[12:15], 0 offen nt
    buffer_load_dwordx4 v[64:67], v74, s[12:15], 0 offen nt
    buffer_load_dwordx2 v[68:69], v75, s[12:15], 0 offen nt
    v_mov_b32 v48, v44
    v_mov_b32 v49, v45
    v_mov_b32 v50, v46
    v_mov_b32 v51, v47
    v_mov_b32 v126, v30
    v_mov_b32 v127, v31
    v_mov_b32 v128, v32
    v_mov_b32 v129, v33
    v_mov_b32 v130, v34
    v_mov_b32 v131, v35
    v_permlane32_swap_b32 v44, v48
    v_permlane32_swap_b32 v45, v49
    v_permlane32_swap_b32 v46, v50
    v_permlane32_swap_b32 v47, v51
    v_permlane32_swap_b32 v22, v126
    v_permlane32_swap_b32 v23, v127
    v_permlane32_swap_b32 v24, v128
    v_permlane32_swap_b32 v25, v129
    v_permlane32_swap_b32 v26, v130
    v_permlane32_swap_b32 v27, v131
    v_lshlrev_b32 v88, 16, v44
    v_and_b32 v90, 0xffff0000, v44
    v_lshlrev_b32 v92, 16, v45
    v_and_b32 v94, 0xffff0000, v45
    v_lshlrev_b32 v89, 16, v46
    v_and_b32 v91, 0xffff0000, v46
    v_lshlrev_b32 v93, 16, v47
    v_and_b32 v95, 0xffff0000, v47
    v_lshlrev_b32 v96, 16, v22
    v_and_b32 v97, 0xffff0000, v22
    v_lshlrev_b32 v98, 16, v24
    v_and_b32 v99, 0xffff0000, v24
    v_lshlrev_b32 v100, 16, v26
    v_and_b32 v101, 0xffff0000, v26
    v_lshlrev_b32 v102, 16, v28
    v_and_b32 v103, 0xffff0000, v28
    v_lshlrev_b32 v104, 16, v30
    v_and_b32 v105, 0xffff0000, v30
    v_lshlrev_b32 v106, 16, v32
    v_and_b32 v107, 0xffff0000, v32
    v_lshlrev_b32 v108, 16, v34
    v_and_b32 v109, 0xffff0000, v34
    v_lshlrev_b32 v110, 16, v36
    v_and_b32 v111, 0xffff0000, v36
    v_lshlrev_b32 v112, 16, v38
    v_and_b32 v113, 0xffff0000, v38
    v_lshlrev_b32 v114, 16, v40
    v_and_b32 v115, 0xffff0000, v40
    v_lshlrev_b32 v116, 16, v42
    v_and_b32 v117, 0xffff0000, v42
    v_pk_mul_f32 v[118:119], v[96:97], v[94:95]
    v_pk_mul_f32 v[120:121], v[98:99], v[94:95]
    v_pk_mul_f32 v[122:123], v[100:101], v[94:95]
    v_pk_mul_f32 v[124:125], v[102:103], v[94:95]
    v_pk_fma_f32 v[118:119], v[98:99], v[92:93], v[118:119]
    v_pk_fma_f32 v[120:121], v[100:101], v[92:93], v[120:121]
    v_pk_fma_f32 v[122:123], v[102:103], v[92:93], v[122:123]
    v_pk_fma_f32 v[124:125], v[104:105], v[92:93], v[124:125]
    v_pk_fma_f32 v[118:119], v[100:101], v[90:91], v[118:119]
    v_pk_fma_f32 v[120:121], v[102:103], v[90:91], v[120:121]
    v_pk_fma_f32 v[122:123], v[104:105], v[90:91], v[122:123]
    v_pk_fma_f32 v[124:125], v[106:107], v[90:91], v[124:125]
    v_pk_fma_f32 v[118:119], v[102:103], v[88:89], v[118:119]
    v_pk_fma_f32 v[120:121], v[104:105], v[88:89], v[120:121]
    v_pk_fma_f32 v[122:123], v[106:107], v[88:89], v[122:123]
    v_pk_fma_f32 v[124:125], v[108:109], v[88:89], v[124:125]
    v_pk_mul_f32 v[118:119], v[118:119], v[110:111]
    v_pk_mul_f32 v[120:121], v[120:121], v[112:113]
    v_pk_mul_f32 v[122:123], v[122:123], v[114:115]
    v_pk_mul_f32 v[124:125], v[124:125], v[116:117]
    v_cvt_pk_bf16_f32 v136, v124, v122
    v_cvt_pk_bf16_f32 v137, v120, v118
    ds_write_b64 v84, v[136:137] offset:0
    v_cvt_pk_bf16_f32 v138, v125, v123
    v_cvt_pk_bf16_f32 v139, v121, v119
    ds_write_b64 v84, v[138:139] offset:128
    v_lshlrev_b32 v88, 16, v48
    v_and_b32 v90, 0xffff0000, v48
    v_lshlrev_b32 v92, 16, v49
    v_and_b32 v94, 0xffff0000, v49
    v_lshlrev_b32 v89, 16, v50
    v_and_b32 v91, 0xffff0000, v50
    v_lshlrev_b32 v93, 16, v51
    v_and_b32 v95, 0xffff0000, v51
    v_lshlrev_b32 v96, 16, v23
    v_and_b32 v97, 0xffff0000, v23
    v_lshlrev_b32 v98, 16, v25
    v_and_b32 v99, 0xffff0000, v25
    v_lshlrev_b32 v100, 16, v27
    v_and_b32 v101, 0xffff0000, v27
    v_lshlrev_b32 v102, 16, v29
    v_and_b32 v103, 0xffff0000, v29
    v_lshlrev_b32 v104, 16, v31
    v_and_b32 v105, 0xffff0000, v31
    v_lshlrev_b32 v106, 16, v33
    v_and_b32 v107, 0xffff0000, v33
    v_lshlrev_b32 v108, 16, v35
    v_and_b32 v109, 0xffff0000, v35
    v_lshlrev_b32 v110, 16, v37
    v_and_b32 v111, 0xffff0000, v37
    v_lshlrev_b32 v112, 16, v39
    v_and_b32 v113, 0xffff0000, v39
    v_lshlrev_b32 v114, 16, v41
    v_and_b32 v115, 0xffff0000, v41
    v_lshlrev_b32 v116, 16, v43
    v_and_b32 v117, 0xffff0000, v43
    v_pk_mul_f32 v[118:119], v[96:97], v[94:95]
    v_pk_mul_f32 v[120:121], v[98:99], v[94:95]
    v_pk_mul_f32 v[122:123], v[100:101], v[94:95]
    v_pk_mul_f32 v[124:125], v[102:103], v[94:95]
    v_pk_fma_f32 v[118:119], v[98:99], v[92:93], v[118:119]
    v_pk_fma_f32 v[120:121], v[100:101], v[92:93], v[120:121]
    v_pk_fma_f32 v[122:123], v[102:103], v[92:93], v[122:123]
    v_pk_fma_f32 v[124:125], v[104:105], v[92:93], v[124:125]
    v_pk_fma_f32 v[118:119], v[100:101], v[90:91], v[118:119]
    v_pk_fma_f32 v[120:121], v[102:103], v[90:91], v[120:121]
    v_pk_fma_f32 v[122:123], v[104:105], v[90:91], v[122:123]
    v_pk_fma_f32 v[124:125], v[106:107], v[90:91], v[124:125]
    v_pk_fma_f32 v[118:119], v[102:103], v[88:89], v[118:119]
    v_pk_fma_f32 v[120:121], v[104:105], v[88:89], v[120:121]
    v_pk_fma_f32 v[122:123], v[106:107], v[88:89], v[122:123]
    v_pk_fma_f32 v[124:125], v[108:109], v[88:89], v[124:125]
    v_pk_mul_f32 v[118:119], v[118:119], v[110:111]
    v_pk_mul_f32 v[120:121], v[120:121], v[112:113]
    v_pk_mul_f32 v[122:123], v[122:123], v[114:115]
    v_pk_mul_f32 v[124:125], v[124:125], v[116:117]
    v_cvt_pk_bf16_f32 v140, v124, v122
    v_cvt_pk_bf16_f32 v141, v120, v118
    ds_write_b64 v84, v[140:141] offset:256
    v_cvt_pk_bf16_f32 v142, v125, v123
    v_cvt_pk_bf16_f32 v143, v121, v119
    ds_write_b64 v84, v[142:143] offset:384
    s_cmp_lg_u32 s30, 4
    s_cbranch_scc1 HB_2
    v_add_u32 v18, 162816, v3
    ds_write_b32 v18, v78
    s_mov_b32 s53, 0
    s_waitcnt vmcnt(6)
HB_p:
    v_readfirstlane_b32 s52, v76
    s_nop 0
    s_cmp_eq_u32 s52, 0
    s_cbranch_scc1 HB_r
    s_cmp_ge_u32 s53, 60
    s_cbranch_scc1 HB_q
    s_add_u32 s54, s46, 8192
    s_lshl_b32 s54, s54, 6
    s_sub_u32 s54, s54, s52
    s_cmp_lt_u32 s54, 786432
    s_cbranch_scc1 HB_q
HB_r:
    buffer_load_dword v76, v78, s[84:87], 0 offen sc1
    s_waitcnt vmcnt(0)
    s_add_u32 s53, s53, 1
    s_cmp_lt_u32 s53, s61
    s_cbranch_scc1 HB_p
    s_mov_b32 s52, 1
    s_mov_b32 s61, 0
HB_q:
    v_mov_b32 v18, 162828
    v_mov_b32 v19, s52
    s_waitcnt lgkmcnt(0)
    ds_write_b32 v18, v19
HB_2:
    s_add_u32 s16, s4, 0x2000000
    s_addc_u32 s17, s5, 0
    s_mov_b32 s18, 0x8000000
    s_mov_b32 s19, 0x20000
    v_lshrrev_b32 v8, 3, v0
    v_and_b32 v85, 7, v0
    v_lshlrev_b32 v149, 12, v8
    v_lshl_add_u32 v149, v85, 4, v149
    s_lshl_b32 s36, s34, 24
    s_sub_u32 s37, 31, s35
    s_lshl_b32 s37, s37, 7
    s_add_u32 s36, s36, s37
    s_add_u32 s37, s36, 262144
    v_lshrrev_b32 v148, 3, v8
    v_xor_b32 v148, v148, v85
    v_lshlrev_b32 v148, 4, v148
    v_lshl_add_u32 v148, v8, 7, v148
    v_add_u32 v148, 98304, v148
    v_mov_b32 v18, 162828
    s_waitcnt lgkmcnt(0)
    s_barrier
    ds_read_b128 v[152:155], v148 offset:0
    ds_read_b128 v[156:159], v148 offset:8192
    ds_read_b32 v19, v18
    s_waitcnt lgkmcnt(2)
    v_or_b32 v152, 1, v152
    buffer_store_dwordx4 v[152:155], v149, s[16:19], s36 offen sc1
    s_waitcnt lgkmcnt(1)
    v_or_b32 v156, 1, v156
    buffer_store_dwordx4 v[156:159], v149, s[16:19], s37 offen sc1
    s_waitcnt lgkmcnt(0)
    v_readfirstlane_b32 s52, v19
    s_cmp_lg_u32 s30, 0
    s_cbranch_scc1 KV_ni
    s_cmp_ge_u32 s35, 16
    s_cbranch_scc1 KV_ni
    v_mov_b32 v8, s52
    s_lshl_b32 s37, s34, 7
    s_lshl_b32 s53, s35, 10
    s_add_u32 s37, s37, s53
    s_add_u32 s37, s37, 23101440
    s_mov_b64 exec, 1
    buffer_store_dword v8, v78, s[56:59], s37 offen sc1
    s_mov_b64 exec, -1
KV_ni:
    s_cmp_ge_u32 s2, 32
    s_cbranch_scc1 KV_n3
    s_cmp_lg_u32 s30, 5
    s_cbranch_scc1 KV_n3
    s_and_b32 s42, s2, 7
    s_lshl_b32 s42, s42, 10
    s_lshr_b32 s43, s2, 3
    s_lshl_b32 s43, s43, 14
    s_add_u32 s42, s42, s43
    s_add_u32 s42, s42, 39714816
    v_lshrrev_b32 v8, 5, v1
    v_mul_u32_u24 v8, 7680, v8
    v_add_u32 v8, v8, v2
    buffer_store_dwordx4 v[80:83], v8, s[56:59], s42 offen sc1
KV_n3:
    s_bfe_u32 s32, s52, 0x30001
    s_add_u32 s32, s32, s2
    s_and_b32 s32, s32, 7
    s_lshr_b32 s33, s2, 3
    s_and_b32 s28, s32, 2
    s_lshr_b32 s53, s32, 2
    s_or_b32 s28, s28, s53
    s_lshl_b32 s28, s28, 2
    s_and_b32 s53, s33, 3
    s_add_u32 s28, s28, s53
    s_and_b32 s31, s32, 1
    s_lshr_b32 s33, s33, 2
    s_lshl_b32 s29, s31, 3
    s_add_u32 s29, s29, s33
    s_xor_b32 s99, s29, 1
    v_and_b32 v199, 7, v0
    v_lshrrev_b32 v228, 6, v0
    v_lshlrev_b32 v228, 4, v228
    v_bfe_u32 v229, v0, 3, 3
    v_add_u32 v228, v228, v229
    s_lshr_b32 s78, s29, 1
    s_lshl_b32 s78, s78, 16
    s_and_b32 s79, s29, 1
    s_lshl_b32 s79, s79, 7
    s_add_u32 s78, s78, s79
    s_lshr_b32 s79, s30, 1
    s_lshl_b32 s79, s79, 13
    s_add_u32 s78, s78, s79
    v_lshlrev_b32 v196, 8, v228
    v_lshl_add_u32 v196, v199, 4, v196
    v_add_u32 v196, s78, v196
    s_lshl_b32 s78, s28, 7
    s_lshl_b32 s79, s29, 3
    s_add_u32 s78, s78, s79
    v_add_u32 v197, s78, v199
    v_lshlrev_b32 v198, 11, v197
    v_lshrrev_b32 v229, 2, v228
    v_lshlrev_b32 v229, 3, v229
    v_and_b32 v228, 3, v228
    v_add_u32 v228, v228, v229
    v_lshl_add_u32 v198, v228, 3, v198
    v_and_b32 v197, 15, v197
    v_lshlrev_b32 v197, 4, v197
    v_and_b32 v229, 15, v228
    v_lshl_add_u32 v197, v229, 9, v197
    v_lshrrev_b32 v229, 4, v228
    v_lshl_add_u32 v197, v229, 14, v197
    s_lshr_b32 s78, s28, 3
    s_lshl_b32 s78, s78, 2
    s_and_b32 s79, s28, 3
    s_add_u32 s78, s78, s79
    s_lshl_b32 s78, s78, 24
    s_and_b32 s79, s28, 4
    s_lshl_b32 s79, s79, 11
    s_add_u32 s78, s78, s79
    s_and_b32 s79, s29, 4
    s_lshl_b32 s79, s79, 6
    s_add_u32 s78, s78, s79
    s_and_b32 s79, s29, 2
    s_lshl_b32 s79, s79, 2
    s_add_u32 s78, s78, s79
    s_lshl_b32 s79, s31, 18
    s_add_u32 s78, s78, s79
    v_add_u32 v197, s78, v197
    s_lshl_b32 s36, s34, 5
    s_add_u32 s36, s36, s35
    s_lshl_b32 s36, s36, 7
    s_add_u32 s36, s36, 23068672
    v_mov_b32 v18, 1
    v_mov_b32 v19, 162820
    v_mov_b32 v21, 0
    s_mov_b64 exec, 1
    s_waitcnt vmcnt(0)
    ds_add_rtn_u32 v20, v19, v18
    v_mov_b32 v19, s52
    s_waitcnt lgkmcnt(0)
    v_readfirstlane_b32 s54, v20
    s_nop 0
    s_and_b32 s54, s54, 7
    s_cmp_lg_u32 s54, 7
    s_cbranch_scc1 pub_1
    buffer_store_dword v19, v21, s[56:59], s36 offen sc1
pub_1:
    s_mov_b64 exec, -1
    s_mov_b32 s8, s6
    s_mov_b32 s9, s7
    s_mov_b32 s10, 0x400000
    s_mov_b32 s11, 0x20000
    buffer_load_dwordx2 v[180:181], v198, s[8:11], 0 offen offset:0 nt
    buffer_load_dwordx2 v[182:183], v198, s[8:11], 0 offen offset:32 nt
    buffer_load_dwordx2 v[184:185], v198, s[8:11], 0 offen offset:128 nt
    buffer_load_dwordx2 v[186:187], v198, s[8:11], 0 offen offset:160 nt
    v_add_u32 v160, s45, v86
    v_alignbit_b32 v88, v53, v52, 16
    v_mov_b32 v92, v53
    v_alignbit_b32 v96, v54, v53, 16
    v_alignbit_b32 v89, v54, v53, 16
    v_mov_b32 v93, v54
    v_alignbit_b32 v97, v55, v54, 16
    v_alignbit_b32 v90, v55, v54, 16
    v_mov_b32 v94, v55
    v_alignbit_b32 v98, v56, v55, 16
    v_alignbit_b32 v91, v56, v55, 16
    v_mov_b32 v95, v56
    v_alignbit_b32 v99, v57, v56, 16
    ds_write_b128 v160, v[88:91] offset:0
    ds_write_b128 v160, v[92:95] offset:4160
    ds_write_b128 v160, v[96:99] offset:8320
    ds_write_b128 v160, v[54:57] offset:12480
    v_alignbit_b32 v100, v59, v58, 16
    v_mov_b32 v104, v59
    v_alignbit_b32 v108, v60, v59, 16
    v_alignbit_b32 v101, v60, v59, 16
    v_mov_b32 v105, v60
    v_alignbit_b32 v109, v61, v60, 16
    v_alignbit_b32 v102, v61, v60, 16
    v_mov_b32 v106, v61
    v_alignbit_b32 v110, v62, v61, 16
    v_alignbit_b32 v103, v62, v61, 16
    v_mov_b32 v107, v62
    v_alignbit_b32 v111, v63, v62, 16
    ds_write_b128 v160, v[100:103] offset:1024
    ds_write_b128 v160, v[104:107] offset:5184
    ds_write_b128 v160, v[108:111] offset:9344
    ds_write_b128 v160, v[60:63] offset:13504
    v_alignbit_b32 v112, v65, v64, 16
    v_mov_b32 v116, v65
    v_alignbit_b32 v120, v66, v65, 16
    v_alignbit_b32 v113, v66, v65, 16
    v_mov_b32 v117, v66
    v_alignbit_b32 v121, v67, v66, 16
    v_alignbit_b32 v114, v67, v66, 16
    v_mov_b32 v118, v67
    v_alignbit_b32 v122, v68, v67, 16
    v_alignbit_b32 v115, v68, v67, 16
    v_mov_b32 v119, v68
    v_alignbit_b32 v123, v69, v68, 16
    s_mov_b64 exec, 0xf
    ds_write_b128 v86, v[112:115] offset:4096
    ds_write_b128 v86, v[116:119] offset:8256
    ds_write_b128 v86, v[120:123] offset:12416
    ds_write_b128 v86, v[66:69] offset:16576
    s_mov_b64 exec, -1
    s_waitcnt lgkmcnt(0)
    s_barrier
    v_mov_b32 v238, 0
    v_mov_b32 v239, 0
    v_mov_b32 v240, 0
    v_mov_b32 v241, 0
    v_mov_b32 v242, 0
    v_mov_b32 v243, 0
    v_mov_b32 v244, 0
    v_mov_b32 v245, 0
    v_mov_b32 v246, 0
    v_mov_b32 v247, 0
    s_cmp_ge_u32 s30, 4
    s_cbranch_scc1 FR_b
    s_and_b32 s38, s2, 7
    s_lshl_b32 s38, s38, 5
    s_lshr_b32 s39, s2, 3
    s_add_u32 s38, s38, s39
    s_lshl_b32 s39, s38, 2
    s_add_u32 s39, s39, s30
    s_mul_i32 s40, s30, 24576
    s_and_b32 s36, s39, 127
    s_lshl_b32 s36, s36, 12
    s_lshr_b32 s37, s39, 7
    s_lshl_b32 s37, s37, 24
    s_add_u32 s36, s36, s37
    s_add_u32 s36, s36, 33554432
    s_add_u32 s16, s4, s36
    s_addc_u32 s17, s5, 0
    s_mov_b32 s18, 4096
    s_mov_b32 s19, 0x20000
    v_lshrrev_b32 v6, 2, v1
    v_mul_u32_u24 v12, 96, v6
    v_and_b32 v6, 3, v1
    v_lshl_add_u32 v12, v6, 4, v12
    v_add_u32 v12, s40, v12
    v_and_b32 v35, 15, v1
    v_lshrrev_b32 v36, 4, v1
    v_and_b32 v6, 3, v35
    v_mul_u32_u24 v32, 4160, v6
    v_lshl_add_u32 v32, v36, 4, v32
    v_lshrrev_b32 v6, 2, v35
    v_lshl_add_u32 v32, v6, 3, v32
    v_add_u32 v32, s40, v32
    v_sub_u32 v6, 15, v35
    v_mul_u32_u24 v34, 96, v6
    v_add_u32 v34, s40, v34
    v_lshl_add_u32 v33, v36, 4, v34
    ds_read_b64 v[72:73], v32 offset:0
    ds_read_b64 v[74:75], v32 offset:8
    ds_read_b64 v[76:77], v32 offset:32
    ds_read_b64 v[78:79], v32 offset:40
    ds_read_b64 v[80:81], v32 offset:1024
    ds_read_b64 v[82:83], v32 offset:1032
    ds_read_b64 v[84:85], v32 offset:1056
    ds_read_b64 v[86:87], v32 offset:1064
    ds_read_b64 v[88:89], v32 offset:2048
    ds_read_b64 v[90:91], v32 offset:2056
    ds_read_b64 v[92:93], v32 offset:2080
    ds_read_b64 v[94:95], v32 offset:2088
    ds_read_b64 v[96:97], v32 offset:3072
    ds_read_b64 v[98:99], v32 offset:3080
    ds_read_b64 v[100:101], v32 offset:3104
    ds_read_b64 v[102:103], v32 offset:3112
    s_bitcmp1_b32 s39, 0
    s_cselect_b32 s36, 0, 16
    s_lshl_b32 s41, s98, s36
    s_and_b32 s41, s41, 0xffff0000
    s_lshr_b32 s36, s41, 16
    v_lshl_add_u32 v6, v36, 3, v35
    v_sub_u32 v6, 31, v6
    v_mov_b32 v10, s36
    v_mov_b32 v11, s41
    v_and_b32 v8, 1, v6
    v_cmp_eq_u32 vcc, 1, v8
    s_nop 1
    v_cndmask_b32 v10, v10, v11, vcc
    v_ashrrev_i32 v6, 1, v6
    v_cmp_eq_u32 vcc, 0, v6
    s_nop 1
    v_cndmask_b32 v152, 0, v10, vcc
    v_cmp_eq_u32 vcc, 1, v6
    s_nop 1
    v_cndmask_b32 v153, 0, v10, vcc
    v_cmp_eq_u32 vcc, 2, v6
    s_nop 1
    v_cndmask_b32 v154, 0, v10, vcc
    v_cmp_eq_u32 vcc, 3, v6
    s_nop 1
    v_cndmask_b32 v155, 0, v10, vcc
    v_cmp_eq_u32 vcc, 8, v6
    s_nop 1
    v_cndmask_b32 v156, 0, v10, vcc
    v_cmp_eq_u32 vcc, 9, v6
    s_nop 1
    v_cndmask_b32 v157, 0, v10, vcc
    v_cmp_eq_u32 vcc, 10, v6
    s_nop 1
    v_cndmask_b32 v158, 0, v10, vcc
    v_cmp_eq_u32 vcc, 11, v6
    s_nop 1
    v_cndmask_b32 v159, 0, v10, vcc
    s_add_u32 s12, s4, 0x2100000
    s_addc_u32 s13, s5, 0
    s_mov_b32 s14, 0x7f00000
    s_mov_b32 s15, 0x20000
    v_bfe_u32 v6, v1, 2, 2
    v_mul_u32_u24 v168, 24640, v6
    v_mul_u32_u24 v6, 72, v36
    v_add_u32 v168, v168, v6
    v_and_b32 v6, 3, v1
    v_lshl_add_u32 v168, v6, 3, v168
    s_mul_i32 s36, s30, 1152
    v_add_u32 v168, s36, v168
    v_lshrrev_b32 v6, 5, v1
    v_mul_u32_u24 v169, 261632, v6
    v_add_u32 v169, v169, v2
    s_lshr_b32 s44, s38, 4
    s_lshl_b32 s44, s44, 14
    s_and_b32 s37, s38, 15
    s_lshl_b32 s37, s37, 9
    s_add_u32 s44, s44, s37
    s_and_b32 s37, s30, 1
    s_lshl_b32 s37, s37, 13
    s_add_u32 s44, s44, s37
    s_lshr_b32 s37, s30, 1
    s_lshl_b32 s37, s37, 26
    s_add_u32 s44, s44, s37
    s_and_b32 s47, s44, 0x2000
    s_xor_b32 s47, s47, 8192
    s_lshr_b32 s37, s30, 1
    s_lshl_b32 s37, s37, 12
    s_add_u32 s47, s47, s37
    s_and_b32 s37, s2, 7
    s_lshl_b32 s37, s37, 7
    s_add_u32 s47, s47, s37
    v_mov_b32 v34, 162824
    v_mov_b32 v7, 1
    s_mul_i32 s36, s30, 24640
    v_mul_u32_u24 v170, 72, v35
    v_lshl_add_u32 v170, v36, 3, v170
    v_add_u32 v170, s36, v170
    v_lshlrev_b32 v6, 10, v1
    v_mov_b32 v35, 0
    s_and_b32 s45, s2, 31
    s_lshl_b32 s45, s45, 7
    s_add_u32 s45, s45, 23117824
    s_cmp_lg_u32 s30, 0
    s_cbranch_scc1 CV_w
    s_and_b32 s36, s2, 7
    s_lshl_b32 s36, s36, 12
    s_add_u32 s36, s36, 23068672
    v_lshlrev_b32 v9, 7, v1
    v_add_u32 v9, s36, v9
    s_mov_b32 s53, 0
    s_add_u32 s54, s52, 0
    s_bfm_b64 exec, 32, 0
poll_2:
    buffer_load_dword v8, v9, s[56:59], 0 offen sc1
    s_waitcnt vmcnt(0)
    v_xor_b32 v8, s54, v8
    v_cmp_eq_u32 vcc, 0, v8
    s_nop 0
    s_cmp_eq_u64 vcc, exec
    s_cbranch_scc1 pok_3
    s_sleep 5
    s_add_u32 s53, s53, 1
    s_cmp_lt_u32 s53, s61
    s_cbranch_scc1 poll_2
    s_mov_b32 s61, 0
pok_3:
    s_mov_b64 exec, -1
    v_mov_b32 v8, 162832
    v_mov_b32 v9, 1
    s_waitcnt lgkmcnt(0)
    ds_write_b32 v8, v9
CV_w:
    v_mov_b32 v8, 162832
spin_4:
    ds_read_b32 v9, v8
    s_waitcnt lgkmcnt(0)
    v_readfirstlane_b32 s53, v9
    s_nop 0
    s_cmp_ge_u32 s53, 1
    s_cbranch_scc0 spin_4
    buffer_load_dwordx4 v[16:19], v2, s[16:19], 0 offen offset:0 sc1 nt
    buffer_load_dwordx4 v[20:23], v2, s[16:19], 0 offen offset:1024 sc1 nt
    buffer_load_dwordx4 v[24:27], v2, s[16:19], 0 offen offset:2048 sc1 nt
    buffer_load_dwordx4 v[28:31], v2, s[16:19], 0 offen offset:3072 sc1 nt
    s_waitcnt vmcnt(3)
    ds_write_b128 v12, v[16:19] offset:16640
    s_waitcnt vmcnt(2)
    ds_write_b128 v12, v[20:23] offset:18176
    s_waitcnt vmcnt(1)
    ds_write_b128 v12, v[24:27] offset:19712
    s_waitcnt vmcnt(0)
    ds_write_b128 v12, v[28:31] offset:21248
    v_mov_b32 v8, 162836
    v_mov_b32 v9, 1
    s_mov_b64 exec, 1
    ds_add_u32 v8, v9
    s_mov_b64 exec, -1
    s_waitcnt lgkmcnt(0)
    ds_read_b128 v[136:139], v33 offset:21248
    ds_read_b128 v[140:143], v33 offset:19712
    ds_read_b128 v[144:147], v33 offset:18176
    ds_read_b128 v[148:151], v33 offset:16640
    s_waitcnt lgkmcnt(3)
    v_mfma_f32_16x16x32_bf16 v[40:43], v[152:155], v[136:139], 0
    v_mfma_f32_16x16x32_bf16 v[44:47], v[156:159], v[136:139], 0
    s_waitcnt lgkmcnt(2)
    v_mfma_f32_16x16x32_bf16 v[48:51], v[152:155], v[140:143], 0
    v_mfma_f32_16x16x32_bf16 v[52:55], v[156:159], v[140:143], 0
    s_waitcnt lgkmcnt(1)
    v_mfma_f32_16x16x32_bf16 v[56:59], v[152:155], v[144:147], 0
    v_mfma_f32_16x16x32_bf16 v[60:63], v[156:159], v[144:147], 0
    s_waitcnt lgkmcnt(0)
    v_mfma_f32_16x16x32_bf16 v[64:67], v[152:155], v[148:151], 0
    v_mfma_f32_16x16x32_bf16 v[68:71], v[156:159], v[148:151], 0
    s_mov_b32 s43, 0
CV_r:
    s_waitcnt lgkmcnt(0)
    v_mfma_f32_16x16x32_bf16 v[40:43], v[72:75], v[136:139], v[40:43]
    v_mfma_f32_16x16x32_bf16 v[48:51], v[72:75], v[140:143], v[48:51]
    v_mfma_f32_16x16x32_bf16 v[56:59], v[72:75], v[144:147], v[56:59]
    v_mfma_f32_16x16x32_bf16 v[64:67], v[72:75], v[148:151], v[64:67]
    v_mfma_f32_16x16x32_bf16 v[44:47], v[76:79], v[136:139], v[44:47]
    v_mfma_f32_16x16x32_bf16 v[52:55], v[76:79], v[140:143], v[52:55]
    v_mfma_f32_16x16x32_bf16 v[60:63], v[76:79], v[144:147], v[60:63]
    v_mfma_f32_16x16x32_bf16 v[68:71], v[76:79], v[148:151], v[68:71]
    v_mfma_f32_16x16x32_bf16 v[48:51], v[80:83], v[136:139], v[48:51]
    v_mfma_f32_16x16x32_bf16 v[56:59], v[80:83], v[140:143], v[56:59]
    v_mfma_f32_16x16x32_bf16 v[64:67], v[80:83], v[144:147], v[64:67]
    v_mfma_f32_16x16x32_bf16 v[52:55], v[84:87], v[136:139], v[52:55]
    v_mfma_f32_16x16x32_bf16 v[60:63], v[84:87], v[140:143], v[60:63]
    v_mfma_f32_16x16x32_bf16 v[68:71], v[84:87], v[144:147], v[68:71]
    v_mfma_f32_16x16x32_bf16 v[56:59], v[88:91], v[136:139], v[56:59]
    v_mfma_f32_16x16x32_bf16 v[64:67], v[88:91], v[140:143], v[64:67]
    v_mfma_f32_16x16x32_bf16 v[60:63], v[92:95], v[136:139], v[60:63]
    v_mfma_f32_16x16x32_bf16 v[68:71], v[92:95], v[140:143], v[68:71]
    v_mfma_f32_16x16x32_bf16 v[64:67], v[96:99], v[136:139], v[64:67]
    v_mfma_f32_16x16x32_bf16 v[68:71], v[100:103], v[136:139], v[68:71]
    ds_read_b128 v[152:155], v33 offset:21344
    ds_read_b128 v[156:159], v33 offset:19808
    ds_read_b128 v[160:163], v33 offset:18272
    ds_read_b128 v[164:167], v33 offset:16736
    ds_read_b64 v[104:105], v32 offset:64
    ds_read_b64 v[106:107], v32 offset:72
    ds_read_b64 v[108:109], v32 offset:96
    ds_read_b64 v[110:111], v32 offset:104
    ds_read_b64 v[112:113], v32 offset:1088
    ds_read_b64 v[114:115], v32 offset:1096
    ds_read_b64 v[116:117], v32 offset:1120
    ds_read_b64 v[118:119], v32 offset:1128
    ds_read_b64 v[120:121], v32 offset:2112
    ds_read_b64 v[122:123], v32 offset:2120
    ds_read_b64 v[124:125], v32 offset:2144
    ds_read_b64 v[126:127], v32 offset:2152
    ds_read_b64 v[128:129], v32 offset:3136
    ds_read_b64 v[130:131], v32 offset:3144
    ds_read_b64 v[132:133], v32 offset:3168
    ds_read_b64 v[134:135], v32 offset:3176
    s_waitcnt lgkmcnt(0)
    v_mfma_f32_16x16x32_bf16 v[40:43], v[104:107], v[152:155], v[40:43]
    v_mfma_f32_16x16x32_bf16 v[48:51], v[104:107], v[156:159], v[48:51]
    v_mfma_f32_16x16x32_bf16 v[56:59], v[104:107], v[160:163], v[56:59]
    v_mfma_f32_16x16x32_bf16 v[64:67], v[104:107], v[164:167], v[64:67]
    v_mfma_f32_16x16x32_bf16 v[44:47], v[108:111], v[152:155], v[44:47]
    v_mfma_f32_16x16x32_bf16 v[52:55], v[108:111], v[156:159], v[52:55]
    v_mfma_f32_16x16x32_bf16 v[60:63], v[108:111], v[160:163], v[60:63]
    v_mfma_f32_16x16x32_bf16 v[68:71], v[108:111], v[164:167], v[68:71]
    v_mfma_f32_16x16x32_bf16 v[48:51], v[112:115], v[152:155], v[48:51]
    v_mfma_f32_16x16x32_bf16 v[56:59], v[112:115], v[156:159], v[56:59]
    v_mfma_f32_16x16x32_bf16 v[64:67], v[112:115], v[160:163], v[64:67]
    v_mfma_f32_16x16x32_bf16 v[52:55], v[116:119], v[152:155], v[52:55]
    v_mfma_f32_16x16x32_bf16 v[60:63], v[116:119], v[156:159], v[60:63]
    v_mfma_f32_16x16x32_bf16 v[68:71], v[116:119], v[160:163], v[68:71]
    v_mfma_f32_16x16x32_bf16 v[56:59], v[120:123], v[152:155], v[56:59]
    v_mfma_f32_16x16x32_bf16 v[64:67], v[120:123], v[156:159], v[64:67]
    v_mfma_f32_16x16x32_bf16 v[60:63], v[124:127], v[152:155], v[60:63]
    v_mfma_f32_16x16x32_bf16 v[68:71], v[124:127], v[156:159], v[68:71]
    v_mfma_f32_16x16x32_bf16 v[64:67], v[128:131], v[152:155], v[64:67]
    v_mfma_f32_16x16x32_bf16 v[68:71], v[132:135], v[152:155], v[68:71]
    ds_read_b128 v[136:139], v33 offset:21440
    ds_read_b128 v[140:143], v33 offset:19904
    ds_read_b128 v[144:147], v33 offset:18368
    ds_read_b128 v[148:151], v33 offset:16832
    ds_read_b64 v[72:73], v32 offset:128
    ds_read_b64 v[74:75], v32 offset:136
    ds_read_b64 v[76:77], v32 offset:160
    ds_read_b64 v[78:79], v32 offset:168
    ds_read_b64 v[80:81], v32 offset:1152
    ds_read_b64 v[82:83], v32 offset:1160
    ds_read_b64 v[84:85], v32 offset:1184
    ds_read_b64 v[86:87], v32 offset:1192
    ds_read_b64 v[88:89], v32 offset:2176
    ds_read_b64 v[90:91], v32 offset:2184
    ds_read_b64 v[92:93], v32 offset:2208
    ds_read_b64 v[94:95], v32 offset:2216
    ds_read_b64 v[96:97], v32 offset:3200
    ds_read_b64 v[98:99], v32 offset:3208
    ds_read_b64 v[100:101], v32 offset:3232
    ds_read_b64 v[102:103], v32 offset:3240
    v_add_u32 v32, 128, v32
    v_add_u32 v33, 192, v33
    s_add_u32 s43, s43, 1
    s_cmp_lt_u32 s43, 4
    s_cbranch_scc1 CV_r
CV_l:
    s_waitcnt lgkmcnt(10)
    v_mfma_f32_16x16x32_bf16 v[40:43], v[72:75], v[136:139], v[40:43]
    ds_read_b128 v[152:155], v33 offset:21344
    v_mfma_f32_16x16x32_bf16 v[48:51], v[72:75], v[140:143], v[48:51]
    ds_read_b128 v[156:159], v33 offset:19808
    s_cmp_eq_u32 s43, 5
    v_mfma_f32_16x16x32_bf16 v[56:59], v[72:75], v[144:147], v[56:59]
    ds_read_b128 v[160:163], v33 offset:18272
    s_cselect_b64 exec, 1, 0
    buffer_load_dword v12, v35, s[56:59], s45 offen sc1
    s_mov_b64 exec, -1
    v_mfma_f32_16x16x32_bf16 v[64:67], v[72:75], v[148:151], v[64:67]
    ds_read_b128 v[164:167], v33 offset:16736
    v_mfma_f32_16x16x32_bf16 v[44:47], v[76:79], v[136:139], v[44:47]
    ds_read_b64 v[104:105], v32 offset:64
    v_mfma_f32_16x16x32_bf16 v[52:55], v[76:79], v[140:143], v[52:55]
    ds_read_b64 v[106:107], v32 offset:72
    v_mfma_f32_16x16x32_bf16 v[60:63], v[76:79], v[144:147], v[60:63]
    ds_read_b64 v[108:109], v32 offset:96
    v_mfma_f32_16x16x32_bf16 v[68:71], v[76:79], v[148:151], v[68:71]
    ds_read_b64 v[110:111], v32 offset:104
    v_mfma_f32_16x16x32_bf16 v[48:51], v[80:83], v[136:139], v[48:51]
    ds_read_b64 v[112:113], v32 offset:1088
    v_mfma_f32_16x16x32_bf16 v[56:59], v[80:83], v[140:143], v[56:59]
    ds_read_b64 v[114:115], v32 offset:1096
    s_waitcnt lgkmcnt(10)
    v_mfma_f32_16x16x32_bf16 v[64:67], v[80:83], v[144:147], v[64:67]
    ds_read_b64 v[116:117], v32 offset:1120
    v_mfma_f32_16x16x32_bf16 v[52:55], v[84:87], v[136:139], v[52:55]
    ds_read_b64 v[118:119], v32 offset:1128
    v_mfma_f32_16x16x32_bf16 v[60:63], v[84:87], v[140:143], v[60:63]
    ds_read_b64 v[120:121], v32 offset:2112
    v_mfma_f32_16x16x32_bf16 v[68:71], v[84:87], v[144:147], v[68:71]
    ds_read_b64 v[122:123], v32 offset:2120
    v_mfma_f32_16x16x32_bf16 v[56:59], v[88:91], v[136:139], v[56:59]
    ds_read_b64 v[124:125], v32 offset:2144
    v_mfma_f32_16x16x32_bf16 v[64:67], v[88:91], v[140:143], v[64:67]
    ds_read_b64 v[126:127], v32 offset:2152
    v_mfma_f32_16x16x32_bf16 v[60:63], v[92:95], v[136:139], v[60:63]
    ds_read_b64 v[128:129], v32 offset:3136
    v_mfma_f32_16x16x32_bf16 v[68:71], v[92:95], v[140:143], v[68:71]
    ds_read_b64 v[130:131], v32 offset:3144
    v_mfma_f32_16x16x32_bf16 v[64:67], v[96:99], v[136:139], v[64:67]
    ds_read_b64 v[132:133], v32 offset:3168
    v_mfma_f32_16x16x32_bf16 v[68:71], v[100:103], v[136:139], v[68:71]
    ds_read_b64 v[134:135], v32 offset:3176
    s_waitcnt lgkmcnt(10)
    v_mfma_f32_16x16x32_bf16 v[40:43], v[104:107], v[152:155], v[40:43]
    ds_read_b128 v[136:139], v33 offset:21440
    v_mfma_f32_16x16x32_bf16 v[48:51], v[104:107], v[156:159], v[48:51]
    ds_read_b128 v[140:143], v33 offset:19904
    v_mfma_f32_16x16x32_bf16 v[56:59], v[104:107], v[160:163], v[56:59]
    ds_read_b128 v[144:147], v33 offset:18368
    v_mfma_f32_16x16x32_bf16 v[64:67], v[104:107], v[164:167], v[64:67]
    ds_read_b128 v[148:151], v33 offset:16832
    v_mfma_f32_16x16x32_bf16 v[44:47], v[108:111], v[152:155], v[44:47]
    ds_read_b64 v[72:73], v32 offset:128
    v_mfma_f32_16x16x32_bf16 v[52:55], v[108:111], v[156:159], v[52:55]
    ds_read_b64 v[74:75], v32 offset:136
    v_add_u32 v33, 192, v33
    v_mfma_f32_16x16x32_bf16 v[60:63], v[108:111], v[160:163], v[60:63]
    ds_read_b64 v[76:77], v32 offset:160
    s_add_u32 s43, s43, 1
    v_mfma_f32_16x16x32_bf16 v[68:71], v[108:111], v[164:167], v[68:71]
    ds_read_b64 v[78:79], v32 offset:168
    s_cmp_lt_u32 s43, 8
    v_mfma_f32_16x16x32_bf16 v[48:51], v[112:115], v[152:155], v[48:51]
    ds_read_b64 v[80:81], v32 offset:1152
    v_mfma_f32_16x16x32_bf16 v[56:59], v[112:115], v[156:159], v[56:59]
    ds_read_b64 v[82:83], v32 offset:1160
    s_waitcnt lgkmcnt(10)
    v_mfma_f32_16x16x32_bf16 v[64:67], v[112:115], v[160:163], v[64:67]
    ds_read_b64 v[84:85], v32 offset:1184
    v_mfma_f32_16x16x32_bf16 v[52:55], v[116:119], v[152:155], v[52:55]
    ds_read_b64 v[86:87], v32 offset:1192
    v_mfma_f32_16x16x32_bf16 v[60:63], v[116:119], v[156:159], v[60:63]
    ds_read_b64 v[88:89], v32 offset:2176
    v_mfma_f32_16x16x32_bf16 v[68:71], v[116:119], v[160:163], v[68:71]
    ds_read_b64 v[90:91], v32 offset:2184
    v_mfma_f32_16x16x32_bf16 v[56:59], v[120:123], v[152:155], v[56:59]
    ds_read_b64 v[92:93], v32 offset:2208
    v_mfma_f32_16x16x32_bf16 v[64:67], v[120:123], v[156:159], v[64:67]
    ds_read_b64 v[94:95], v32 offset:2216
    v_mfma_f32_16x16x32_bf16 v[60:63], v[124:127], v[152:155], v[60:63]
    ds_read_b64 v[96:97], v32 offset:3200
    v_mfma_f32_16x16x32_bf16 v[68:71], v[124:127], v[156:159], v[68:71]
    ds_read_b64 v[98:99], v32 offset:3208
    v_mfma_f32_16x16x32_bf16 v[64:67], v[128:131], v[152:155], v[64:67]
    ds_read_b64 v[100:101], v32 offset:3232
    v_mfma_f32_16x16x32_bf16 v[68:71], v[132:135], v[152:155], v[68:71]
    ds_read_b64 v[102:103], v32 offset:3240
    v_add_u32 v32, 128, v32
    s_cbranch_scc1 CV_l
    v_cvt_pk_bf16_f32 v16, v40, v41
    v_cvt_pk_bf16_f32 v17, v42, v43
    ds_write_b64 v170, v[16:17] offset:0
    v_cvt_pk_bf16_f32 v18, v44, v45
    v_cvt_pk_bf16_f32 v19, v46, v47
    ds_write_b64 v170, v[18:19] offset:32
    v_cvt_pk_bf16_f32 v20, v48, v49
    v_cvt_pk_bf16_f32 v21, v50, v51
    ds_write_b64 v170, v[20:21] offset:1152
    v_cvt_pk_bf16_f32 v22, v52, v53
    v_cvt_pk_bf16_f32 v23, v54, v55
    ds_write_b64 v170, v[22:23] offset:1184
    v_cvt_pk_bf16_f32 v24, v56, v57
    v_cvt_pk_bf16_f32 v25, v58, v59
    ds_write_b64 v170, v[24:25] offset:2304
    v_cvt_pk_bf16_f32 v26, v60, v61
    v_cvt_pk_bf16_f32 v27, v62, v63
    ds_write_b64 v170, v[26:27] offset:2336
    v_cvt_pk_bf16_f32 v28, v64, v65
    v_cvt_pk_bf16_f32 v29, v66, v67
    ds_write_b64 v170, v[28:29] offset:3456
    v_cvt_pk_bf16_f32 v30, v68, v69
    v_cvt_pk_bf16_f32 v31, v70, v71
    ds_write_b64 v170, v[30:31] offset:3488
    s_mov_b64 exec, 1
    ds_add_u32 v34, v7
    s_mov_b64 exec, -1
    s_mov_b32 s53, 0
    s_waitcnt vmcnt(0)
CV_v:
    v_readfirstlane_b32 s94, v12
    s_nop 0
    s_sub_u32 s94, s94, s52
    s_and_b32 s37, s94, 0xfffffe01
    s_cbranch_scc0 CV_k
    buffer_load_dword v12, v35, s[56:59], s45 offen sc1
    s_waitcnt vmcnt(0)
    s_add_u32 s53, s53, 1
    s_cmp_lt_u32 s53, s61
    s_cbranch_scc1 CV_v
    s_mov_b32 s61, 0
    s_mov_b32 s94, 0
CV_k:
    s_lshr_b32 s94, s94, 1
    s_add_u32 s37, s94, 65536
    v_mov_b32 v8, 162844
    v_mov_b32 v9, s37
    ds_write_b32 v8, v9
    s_cmp_gt_u32 s94, 10
    s_cselect_b32 s37, 0x2000, 0
    s_xor_b32 s44, s44, s37
    s_xor_b32 s45, s47, s37
    s_add_u32 s45, s45, 23101440
    v_mov_b32 v8, 162824
spin_5:
    ds_read_b32 v9, v8
    s_waitcnt lgkmcnt(0)
    v_readfirstlane_b32 s53, v9
    s_nop 0
    s_cmp_ge_u32 s53, 6
    s_cbranch_scc0 spin_5
    ds_read_b64_tr_b16 v[104:105], v168 offset:0
    ds_read_b64_tr_b16 v[106:107], v168 offset:32
    ds_read_b64_tr_b16 v[108:109], v168 offset:288
    ds_read_b64_tr_b16 v[110:111], v168 offset:320
    ds_read_b64_tr_b16 v[112:113], v168 offset:576
    ds_read_b64_tr_b16 v[114:115], v168 offset:608
    ds_read_b64_tr_b16 v[116:117], v168 offset:864
    ds_read_b64_tr_b16 v[118:119], v168 offset:896
    s_waitcnt lgkmcnt(6)
    v_or_b32 v104, 1, v104
    buffer_store_dwordx4 v[104:107], v169, s[12:15], s44 offen sc1
    s_add_u32 s44, s44, 16777216
    s_waitcnt lgkmcnt(4)
    v_or_b32 v108, 1, v108
    buffer_store_dwordx4 v[108:111], v169, s[12:15], s44 offen sc1
    s_add_u32 s44, s44, 16777216
    s_waitcnt lgkmcnt(2)
    v_or_b32 v112, 1, v112
    buffer_store_dwordx4 v[112:115], v169, s[12:15], s44 offen sc1
    s_add_u32 s44, s44, 16777216
    s_waitcnt lgkmcnt(0)
    v_or_b32 v116, 1, v116
    buffer_store_dwordx4 v[116:119], v169, s[12:15], s44 offen sc1
    s_add_u32 s44, s44, 16777216
    v_mov_b32 v8, 162836
    v_mov_b32 v9, 1
    s_mov_b64 exec, 1
    ds_add_u32 v8, v9
    s_mov_b64 exec, -1
    s_mov_b64 exec, 0xf
    s_waitcnt vmcnt(0)
    buffer_atomic_add v7, v6, s[56:59], s45 offen sc1
    s_mov_b64 exec, -1
    s_branch FR_end
FR_b:
    s_cmp_ge_u32 s2, 32
    s_cbranch_scc1 FB_np
    s_cmp_lg_u32 s30, 5
    s_cbranch_scc1 FB_np
    s_and_b32 s42, s2, 7
    s_lshl_b32 s42, s42, 10
    s_lshr_b32 s43, s2, 3
    s_lshl_b32 s43, s43, 14
    s_add_u32 s42, s42, s43
    s_add_u32 s42, s42, 39714816
    v_mov_b32 v14, 0
    s_mov_b64 exec, 1
    s_mov_b32 s46, -1
    s_mov_b32 s47, -1
    s_add_u32 s48, s4, s42
    s_addc_u32 s49, s5, 0
    s_load_dword s101, s[48:49], 384
    s_waitcnt lgkmcnt(0)
    s_memtime s[34:35]
    s_waitcnt lgkmcnt(0)
    s_load_dword s101, s[48:49], 0
    s_waitcnt lgkmcnt(0)
    s_memtime s[36:37]
    s_waitcnt lgkmcnt(0)
    s_sub_u32 s43, s36, s34
    s_min_u32 s46, s46, s43
    s_load_dword s101, s[48:49], 8192
    s_waitcnt lgkmcnt(0)
    s_memtime s[34:35]
    s_waitcnt lgkmcnt(0)
    s_sub_u32 s43, s34, s36
    s_min_u32 s47, s47, s43
    s_load_dword s101, s[48:49], 128
    s_waitcnt lgkmcnt(0)
    s_memtime s[36:37]
    s_waitcnt lgkmcnt(0)
    s_sub_u32 s43, s36, s34
    s_min_u32 s46, s46, s43
    s_load_dword s101, s[48:49], 8320
    s_waitcnt lgkmcnt(0)
    s_memtime s[34:35]
    s_waitcnt lgkmcnt(0)
    s_sub_u32 s43, s34, s36
    s_min_u32 s47, s47, s43
    s_cmp_lt_u32 s47, s46
    s_cselect_b32 s45, 1, 0
    s_lshr_b32 s46, s28, 2
    s_xor_b32 s45, s45, s46
    s_and_b32 s45, s45, 1
    s_lshl_b32 s45, s45, 8
    s_or_b32 s43, s45, 1
    v_mov_b32 v12, s43
    buffer_atomic_add v12, v14, s[84:87], 0 offen offset:4 sc0 sc1
    s_waitcnt vmcnt(0)
    v_readfirstlane_b32 s36, v12
    s_nop 0
    s_add_u32 s36, s36, s43
    s_and_b32 s37, s36, 255
    s_cmp_lg_u32 s37, 21
    s_cbranch_scc1 FB_np
    s_lshr_b32 s36, s36, 8
    s_lshl_b32 s36, s36, 1
    s_add_u32 s36, s36, s52
    s_bfm_b64 exec, 32, 0
    v_mov_b32 v12, s36
    v_lshlrev_b32 v13, 7, v1
    s_mov_b32 s36, 23117824
    buffer_store_dword v12, v13, s[56:59], s36 offen sc1
FB_np:
    s_mov_b64 exec, -1
    s_getpc_b64 s[34:35]
K_tpc:
    s_lshl_b32 s36, s29, 2
    s_and_b32 s37, s28, 3
    s_add_u32 s36, s36, s37
    s_lshl_b32 s36, s36, 6
    s_add_u32 s36, s36, K_tab-K_tpc
    s_add_u32 s34, s34, s36
    s_addc_u32 s35, s35, 0
    v_and_b32 v248, 31, v1
    v_lshlrev_b32 v248, 1, v248
    global_load_ushort v251, v248, s[34:35]
    v_lshrrev_b32 v253, 3, v1
    v_lshlrev_b32 v238, 11, v253
    v_and_b32 v253, 6, v253
    v_and_b32 v254, 7, v1
    v_xor_b32 v253, v253, v254
    v_lshl_add_u32 v238, v253, 4, v238
    v_lshrrev_b32 v253, 4, v1
    v_lshlrev_b32 v239, 11, v253
    v_add_u32 v253, 0, v253
    v_lshlrev_b32 v253, 1, v253
    v_and_b32 v254, 15, v1
    v_xor_b32 v253, v253, v254
    v_lshl_add_u32 v239, v253, 4, v239
    v_lshrrev_b32 v253, 4, v1
    v_lshlrev_b32 v240, 11, v253
    v_add_u32 v253, 4, v253
    v_lshlrev_b32 v253, 1, v253
    v_and_b32 v254, 15, v1
    v_xor_b32 v253, v253, v254
    v_lshl_add_u32 v240, v253, 4, v240
    v_add_u32 v254, 0, v1
    v_mul_u32_u24 v253, 2341, v254
    v_lshrrev_b32 v253, 16, v253
    v_mul_u32_u24 v241, 28, v253
    v_sub_u32 v254, v254, v241
    v_mul_u32_u24 v241, 7168, v253
    v_lshrrev_b32 v253, 1, v253
    v_and_b32 v253, 2, v253
    v_xor_b32 v254, v254, v253
    v_lshl_add_u32 v241, v254, 4, v241
    v_add_u32 v254, 64, v1
    v_mul_u32_u24 v253, 2341, v254
    v_lshrrev_b32 v253, 16, v253
    v_mul_u32_u24 v242, 28, v253
    v_sub_u32 v254, v254, v242
    v_mul_u32_u24 v242, 7168, v253
    v_lshrrev_b32 v253, 1, v253
    v_and_b32 v253, 2, v253
    v_xor_b32 v254, v254, v253
    v_lshl_add_u32 v242, v254, 4, v242
    v_add_u32 v254, 128, v1
    v_mul_u32_u24 v253, 2341, v254
    v_lshrrev_b32 v253, 16, v253
    v_mul_u32_u24 v243, 28, v253
    v_sub_u32 v254, v254, v243
    v_mul_u32_u24 v243, 7168, v253
    v_lshrrev_b32 v253, 1, v253
    v_and_b32 v253, 2, v253
    v_xor_b32 v254, v254, v253
    v_lshl_add_u32 v243, v254, 4, v243
    v_add_u32 v254, 192, v1
    v_mul_u32_u24 v253, 2341, v254
    v_lshrrev_b32 v253, 16, v253
    v_mul_u32_u24 v244, 28, v253
    v_sub_u32 v254, v254, v244
    v_mul_u32_u24 v244, 7168, v253
    v_lshrrev_b32 v253, 1, v253
    v_and_b32 v253, 2, v253
    v_xor_b32 v254, v254, v253
    v_lshl_add_u32 v244, v254, 4, v244
    v_add_u32 v254, 256, v1
    v_mul_u32_u24 v253, 2341, v254
    v_lshrrev_b32 v253, 16, v253
    v_mul_u32_u24 v245, 28, v253
    v_sub_u32 v254, v254, v245
    v_mul_u32_u24 v245, 7168, v253
    v_lshrrev_b32 v253, 1, v253
    v_and_b32 v253, 2, v253
    v_xor_b32 v254, v254, v253
    v_lshl_add_u32 v245, v254, 4, v245
    v_add_u32 v254, 320, v1
    v_mul_u32_u24 v253, 2341, v254
    v_lshrrev_b32 v253, 16, v253
    v_mul_u32_u24 v246, 28, v253
    v_sub_u32 v254, v254, v246
    v_mul_u32_u24 v246, 7168, v253
    v_lshrrev_b32 v253, 1, v253
    v_and_b32 v253, 2, v253
    v_xor_b32 v254, v254, v253
    v_lshl_add_u32 v246, v254, 4, v246
    v_add_u32 v254, 384, v1
    v_mul_u32_u24 v253, 2341, v254
    v_lshrrev_b32 v253, 16, v253
    v_mul_u32_u24 v247, 28, v253
    v_sub_u32 v254, v254, v247
    v_mul_u32_u24 v247, 7168, v253
    v_lshrrev_b32 v253, 1, v253
    v_and_b32 v253, 2, v253
    v_xor_b32 v254, v254, v253
    v_lshl_add_u32 v247, v254, 4, v247
    s_cmp_ge_u32 s30, 6
    s_cbranch_scc1 FB_cs
    s_cmp_lg_u32 s30, 4
    s_cbranch_scc1 FB_ni
    v_mov_b32 v12, s52
    s_lshr_b32 s53, s28, 3
    s_lshl_b32 s53, s53, 2
    s_and_b32 s54, s28, 3
    s_add_u32 s53, s53, s54
    s_lshl_b32 s53, s53, 24
    s_lshr_b32 s54, s28, 2
    s_xor_b32 s54, s54, s94
    s_and_b32 s54, s54, 1
    s_lshl_b32 s54, s54, 13
    s_add_u32 s37, s53, s54
    s_add_u32 s37, s37, 33554432
    s_andn2_b32 s37, s37, 0x2000
    s_lshl_b32 s53, s29, 7
    s_add_u32 s37, s37, s53
    s_add_u32 s37, s37, 6029312
    v_and_b32 v13, 1, v1
    v_lshlrev_b32 v13, 13, v13
    v_lshrrev_b32 v14, 1, v1
    v_lshl_add_u32 v13, v14, 22, v13
    s_mov_b64 exec, 0xf
    buffer_store_dword v12, v13, s[56:59], s37 offen sc1
    s_cmp_lg_u32 s28, 0
    s_cbranch_scc1 FB_n2
    s_add_u32 s37, s53, 23121920
    s_mov_b64 exec, 1
    buffer_store_dword v12, v13, s[56:59], s37 offen sc1
FB_n2:
    s_mov_b64 exec, -1
FB_ni:
    s_waitcnt vmcnt(0)
    v_bfe_u32 v252, v251, 2, 2
    v_lshlrev_b32 v248, 14, v252
    v_and_b32 v252, 3, v251
    v_lshl_add_u32 v248, v252, 11, v248
    v_bfe_u32 v252, v251, 7, 3
    v_lshlrev_b32 v249, 14, v252
    v_bfe_u32 v252, v251, 4, 3
    v_lshl_add_u32 v249, v252, 10, v249
    v_bfe_u32 v252, v251, 13, 3
    v_lshlrev_b32 v250, 14, v252
    v_bfe_u32 v252, v251, 10, 3
    v_lshl_add_u32 v250, v252, 10, v250
    v_mov_b32 v6, 162836
spin_7:
    s_sleep 2
    ds_read_b32 v7, v6
    s_waitcnt lgkmcnt(0)
    v_readfirstlane_b32 s53, v7
    s_nop 0
    s_cmp_ge_u32 s53, 4
    s_cbranch_scc0 spin_7
    s_load_dwordx2 s[48:49], s[0:1], 64
    s_lshl_b32 s45, s2, 1
    s_and_b32 s50, s30, 1
    s_add_u32 s45, s45, s50
    s_mul_i32 s45, s45, 4096
    s_mov_b32 s50, 2097152
    s_mov_b32 s51, 0x20000
    s_waitcnt lgkmcnt(0)
    buffer_load_dwordx4 v[20:23], v2, s[48:51], s45 offen offset:0
    buffer_load_dwordx4 v[20:23], v2, s[48:51], s45 offen offset:1024
    buffer_load_dwordx4 v[20:23], v2, s[48:51], s45 offen offset:2048
    buffer_load_dwordx4 v[20:23], v2, s[48:51], s45 offen offset:3072
    v_mov_b32 v6, 1
    v_mov_b32 v7, 162824
    s_mov_b64 exec, 1
    s_waitcnt vmcnt(0)
    ds_add_u32 v7, v6
    s_mov_b64 exec, -1
    v_mov_b32 v6, 162840
spin_9:
    s_sleep 4
    ds_read_b32 v7, v6
    s_waitcnt lgkmcnt(0)
    v_readfirstlane_b32 s53, v7
    s_nop 0
    s_cmp_ge_u32 s53, 2
    s_cbranch_scc0 spin_9
    s_call_b64 s[76:77], SUB_w1_regs
    s_call_b64 s[76:77], SUB_park
    v_mov_b32 v6, 162840
spin_10:
    s_sleep 3
    ds_read_b32 v7, v6
    s_waitcnt lgkmcnt(0)
    v_readfirstlane_b32 s53, v7
    s_nop 0
    s_cmp_ge_u32 s53, 4
    s_cbranch_scc0 spin_10
    s_mov_b64 s[12:13], s[68:69]
    s_mov_b32 s14, 2097152
    s_mov_b32 s15, 0x20000
    s_and_b32 s35, s30, 1
    s_mul_i32 s38, s99, 128
    s_mul_i32 s41, s35, 65536
    s_add_u32 s38, s38, s41
    s_mul_i32 s41, s35, 4096
    s_add_u32 s41, s41, 24576
    s_mov_b32 s42, 0
    s_mov_b32 s44, s67
    s_mov_b32 s42, 73728
    s_mov_b32 s44, s67
    s_add_u32 s44, s44, 9
    s_and_b32 s44, s44, 15
    s_call_b64 s[76:77], SUB_w_issue_1
    s_waitcnt vmcnt(8)
    s_mov_b32 s42, 81920
    s_mov_b32 s44, s67
    s_add_u32 s44, s44, 10
    s_and_b32 s44, s44, 15
    s_call_b64 s[76:77], SUB_w_issue_1
    s_waitcnt vmcnt(8)
    s_mov_b32 s42, 90112
    s_mov_b32 s44, s67
    s_add_u32 s44, s44, 11
    s_and_b32 s44, s44, 15
    s_call_b64 s[76:77], SUB_w_issue_1
    s_waitcnt vmcnt(8)
    s_and_b32 s36, s29, 6
    s_cmp_eq_u32 s36, 2
    s_cbranch_scc1 pr_11
    s_call_b64 s[76:77], SUB_park2
pr_11:
    s_call_b64 s[76:77], SUB_w1_put
    s_branch FR_end
FB_cs:
    v_and_b32 v164, 15, v1
    v_mov_b32 v165, 0x3f803f80
    v_cmp_eq_u32 vcc, 0, v164
    s_nop 1
    v_cndmask_b32 v16, 0, v165, vcc
    v_cndmask_b32 v17, 0, v165, vcc
    v_cndmask_b32 v18, 0, v165, vcc
    v_cndmask_b32 v19, 0, v165, vcc
    v_cmp_eq_u32 vcc, 1, v164
    s_nop 1
    v_cndmask_b32 v20, 0, v165, vcc
    v_cndmask_b32 v21, 0, v165, vcc
    v_cndmask_b32 v22, 0, v165, vcc
    v_cndmask_b32 v23, 0, v165, vcc
    v_cmp_eq_u32 vcc, 2, v164
    s_nop 1
    v_cndmask_b32 v24, 0, v165, vcc
    v_cndmask_b32 v25, 0, v165, vcc
    v_cndmask_b32 v26, 0, v165, vcc
    v_cndmask_b32 v27, 0, v165, vcc
    v_cmp_eq_u32 vcc, 3, v164
    s_nop 1
    v_cndmask_b32 v28, 0, v165, vcc
    v_cndmask_b32 v29, 0, v165, vcc
    v_cndmask_b32 v30, 0, v165, vcc
    v_cndmask_b32 v31, 0, v165, vcc
    v_cmp_eq_u32 vcc, 4, v164
    s_nop 1
    v_cndmask_b32 v32, 0, v165, vcc
    v_cndmask_b32 v33, 0, v165, vcc
    v_cndmask_b32 v34, 0, v165, vcc
    v_cndmask_b32 v35, 0, v165, vcc
    v_cmp_eq_u32 vcc, 5, v164
    s_nop 1
    v_cndmask_b32 v36, 0, v165, vcc
    v_cndmask_b32 v37, 0, v165, vcc
    v_cndmask_b32 v38, 0, v165, vcc
    v_cndmask_b32 v39, 0, v165, vcc
    v_cmp_eq_u32 vcc, 6, v164
    s_nop 1
    v_cndmask_b32 v40, 0, v165, vcc
    v_cndmask_b32 v41, 0, v165, vcc
    v_cndmask_b32 v42, 0, v165, vcc
    v_cndmask_b32 v43, 0, v165, vcc
    v_cmp_eq_u32 vcc, 7, v164
    s_nop 1
    v_cndmask_b32 v44, 0, v165, vcc
    v_cndmask_b32 v45, 0, v165, vcc
    v_cndmask_b32 v46, 0, v165, vcc
    v_cndmask_b32 v47, 0, v165, vcc
    v_cmp_eq_u32 vcc, 8, v164
    s_nop 1
    v_cndmask_b32 v48, 0, v165, vcc
    v_cndmask_b32 v49, 0, v165, vcc
    v_cndmask_b32 v50, 0, v165, vcc
    v_cndmask_b32 v51, 0, v165, vcc
    v_cmp_eq_u32 vcc, 9, v164
    s_nop 1
    v_cndmask_b32 v52, 0, v165, vcc
    v_cndmask_b32 v53, 0, v165, vcc
    v_cndmask_b32 v54, 0, v165, vcc
    v_cndmask_b32 v55, 0, v165, vcc
    v_cmp_eq_u32 vcc, 10, v164
    s_nop 1
    v_cndmask_b32 v56, 0, v165, vcc
    v_cndmask_b32 v57, 0, v165, vcc
    v_cndmask_b32 v58, 0, v165, vcc
    v_cndmask_b32 v59, 0, v165, vcc
    v_cmp_eq_u32 vcc, 11, v164
    s_nop 1
    v_cndmask_b32 v60, 0, v165, vcc
    v_cndmask_b32 v61, 0, v165, vcc
    v_cndmask_b32 v62, 0, v165, vcc
    v_cndmask_b32 v63, 0, v165, vcc
    v_cmp_eq_u32 vcc, 12, v164
    s_nop 1
    v_cndmask_b32 v64, 0, v165, vcc
    v_cndmask_b32 v65, 0, v165, vcc
    v_cndmask_b32 v66, 0, v165, vcc
    v_cndmask_b32 v67, 0, v165, vcc
    v_cmp_eq_u32 vcc, 13, v164
    s_nop 1
    v_cndmask_b32 v68, 0, v165, vcc
    v_cndmask_b32 v69, 0, v165, vcc
    v_cndmask_b32 v70, 0, v165, vcc
    v_cndmask_b32 v71, 0, v165, vcc
    s_mov_b32 s35, 0
    v_lshrrev_b32 v253, 2, v1
    v_mul_u32_u24 v144, 128, v253
    v_and_b32 v254, 3, v1
    v_lshl_add_u32 v144, v254, 3, v144
    v_add_u32 v144, 24576, v144
    v_bfe_u32 v253, v253, 1, 2
    s_mul_i32 s36, s35, 4
    s_add_u32 s36, s36, 3
    v_xor_b32 v254, s36, v253
    v_lshl_add_u32 v147, v254, 5, v144
    s_mul_i32 s36, s35, 4
    s_add_u32 s36, s36, 2
    v_xor_b32 v254, s36, v253
    v_lshl_add_u32 v146, v254, 5, v144
    s_mul_i32 s36, s35, 4
    s_add_u32 s36, s36, 1
    v_xor_b32 v254, s36, v253
    v_lshl_add_u32 v145, v254, 5, v144
    s_mul_i32 s36, s35, 4
    s_add_u32 s36, s36, 0
    v_xor_b32 v254, s36, v253
    v_lshl_add_u32 v144, v254, 5, v144
    s_and_b32 s35, s30, 1
    s_mul_i32 s35, s35, 4096
    s_add_u32 s35, s35, 73728
    v_add_u32 v144, s35, v144
    v_add_u32 v145, s35, v145
    v_add_u32 v146, s35, v146
    v_add_u32 v147, s35, v147
    s_mov_b32 s35, 0
    v_lshrrev_b32 v253, 2, v1
    v_mul_u32_u24 v148, 448, v253
    v_and_b32 v254, 3, v1
    v_lshl_add_u32 v148, v254, 3, v148
    v_add_u32 v148, 73728, v148
    s_mul_i32 s36, s35, 224
    v_add_u32 v148, s36, v148
    v_bfe_u32 v253, v1, 4, 1
    v_lshlrev_b32 v253, 5, v253
    s_cmp_eq_u32 s35, 0
    s_cselect_b32 s36, 1, -1
    v_mul_lo_u32 v253, v253, s36
    v_sub_u32 v149, v148, v253
    v_add_u32 v148, v148, v253
    s_and_b32 s35, s30, 1
    s_mul_i32 s35, s35, 14336
    s_add_u32 s35, s35, 32768
    v_add_u32 v148, s35, v148
    v_add_u32 v149, s35, v149
    s_mov_b32 s35, 1
    v_lshrrev_b32 v253, 2, v1
    v_mul_u32_u24 v150, 448, v253
    v_and_b32 v254, 3, v1
    v_lshl_add_u32 v150, v254, 3, v150
    v_add_u32 v150, 73728, v150
    s_mul_i32 s36, s35, 224
    v_add_u32 v150, s36, v150
    v_bfe_u32 v253, v1, 4, 1
    v_lshlrev_b32 v253, 5, v253
    s_cmp_eq_u32 s35, 0
    s_cselect_b32 s36, 1, -1
    v_mul_lo_u32 v253, v253, s36
    v_sub_u32 v151, v150, v253
    v_add_u32 v150, v150, v253
    s_and_b32 s35, s30, 1
    s_mul_i32 s35, s35, 14336
    s_add_u32 s35, s35, 32768
    v_add_u32 v150, s35, v150
    v_add_u32 v151, s35, v151
    v_mov_b32 v156, 0
    v_mov_b32 v157, 0
    v_mov_b32 v158, 0
    v_mov_b32 v159, 0
    v_mov_b32 v160, 0
    v_mov_b32 v161, 0
    v_mov_b32 v162, 0
    v_mov_b32 v163, 0
    v_lshrrev_b32 v166, 4, v1
    v_lshlrev_b32 v166, 4, v166
    v_lshl_add_u32 v166, v164, 6, v166
    v_mov_b32 v165, 0x7f000000
    v_cmp_gt_u32 vcc, 4, v164
    s_nop 1
    v_cndmask_b32 v167, v165, v166, vcc
    v_cmp_gt_u32 vcc, 14, v164
    s_nop 1
    v_cndmask_b32 v168, v165, v166, vcc
    s_waitcnt vmcnt(0)
    v_and_b32 v252, 15, v251
    v_mul_u32_u24 v248, 458752, v252
    s_and_b32 s36, s30, 1
    s_mul_i32 s36, s36, 6
    s_add_u32 s36, s36, 4
    v_bfe_u32 v252, v251, s36, 6
    v_mul_u32_u24 v250, 37, v252
    v_lshrrev_b32 v250, 8, v250
    v_mul_u32_u24 v250, 7, v250
    v_sub_u32 v250, v252, v250
    v_cmp_eq_u32 vcc, 3, v250
    s_nop 1
    v_cndmask_b32 v250, 0, 1, vcc
    v_lshl_add_u32 v249, v252, 16, v250
    v_mov_b32 v6, 162836
spin_12:
    s_sleep 2
    ds_read_b32 v7, v6
    s_waitcnt lgkmcnt(0)
    v_readfirstlane_b32 s53, v7
    s_nop 0
    s_cmp_ge_u32 s53, 4
    s_cbranch_scc0 spin_12
    s_mov_b64 s[12:13], s[68:69]
    s_mov_b32 s14, 2097152
    s_mov_b32 s15, 0x20000
    s_and_b32 s35, s30, 1
    s_mul_i32 s38, s99, 128
    s_mul_i32 s41, s35, 65536
    s_add_u32 s38, s38, s41
    s_mul_i32 s41, s35, 4096
    s_add_u32 s41, s41, 24576
    s_mov_b32 s42, 0
    s_mov_b32 s44, s67
    s_mov_b32 s42, 73728
    s_mov_b32 s44, s28
    s_add_u32 s19, s41, s42
    s_mul_i32 s16, s44, 131072
    s_add_u32 s16, s16, s38
    s_add_u32 s44, s44, 1
    s_and_b32 s44, s44, 15
    s_add_u32 s42, s42, 8192
    s_cmp_eq_u32 s42, 131072
    s_cselect_b32 s42, 0, s42
    s_mov_b32 m0, s19
    s_mov_b32 s39, s16
    buffer_load_dwordx4 v238, s[12:15], s39 offen lds
    s_add_u32 m0, m0, 1024
    s_add_u32 s39, s39, 16384
    buffer_load_dwordx4 v238, s[12:15], s39 offen lds
    s_add_u32 m0, m0, 1024
    s_add_u32 s39, s39, 16384
    buffer_load_dwordx4 v238, s[12:15], s39 offen lds
    s_add_u32 m0, m0, 1024
    s_add_u32 s39, s39, 16384
    buffer_load_dwordx4 v238, s[12:15], s39 offen lds
    s_mov_b64 s[12:13], s[72:73]
    s_mov_b32 s14, 7340032
    s_mov_b32 s15, 0x20000
    s_and_b32 s35, s30, 1
    s_mul_i32 s38, s29, 448
    s_mul_i32 s41, s35, 229376
    s_add_u32 s38, s38, s41
    s_mul_i32 s41, s35, 14336
    s_add_u32 s41, s41, 73728
    s_mov_b32 s42, 0
    s_mov_b32 s44, 0
    s_mov_b32 s42, 32768
    s_mov_b32 s44, s28
    s_add_u32 s19, s41, s42
    s_mul_i32 s16, s44, 458752
    s_add_u32 s16, s16, s38
    s_add_u32 s44, s44, 1
    s_and_b32 s44, s44, 15
    s_add_u32 s42, s42, 28672
    s_cmp_eq_u32 s42, 86016
    s_cselect_b32 s42, 0, s42
    s_mov_b32 m0, s19
    s_mov_b32 s39, s16
    buffer_load_dwordx4 v241, s[12:15], s39 offen lds
    s_add_u32 m0, m0, 1024
    s_nop 0
    buffer_load_dwordx4 v242, s[12:15], s39 offen lds
    s_add_u32 m0, m0, 1024
    s_nop 0
    buffer_load_dwordx4 v243, s[12:15], s39 offen lds
    s_add_u32 m0, m0, 1024
    s_nop 0
    buffer_load_dwordx4 v244, s[12:15], s39 offen lds
    s_add_u32 m0, m0, 1024
    s_nop 0
    buffer_load_dwordx4 v245, s[12:15], s39 offen lds
    s_add_u32 m0, m0, 1024
    s_nop 0
    buffer_load_dwordx4 v246, s[12:15], s39 offen lds
    s_add_u32 m0, m0, 1024
    s_nop 0
    buffer_load_dwordx4 v247, s[12:15], s39 offen lds
    s_add_u32 m0, m0, 1024
    s_add_u32 s39, s39, 114688
    buffer_load_dwordx4 v241, s[12:15], s39 offen lds
    s_add_u32 m0, m0, 1024
    s_nop 0
    buffer_load_dwordx4 v242, s[12:15], s39 offen lds
    s_add_u32 m0, m0, 1024
    s_nop 0
    buffer_load_dwordx4 v243, s[12:15], s39 offen lds
    s_add_u32 m0, m0, 1024
    s_nop 0
    buffer_load_dwordx4 v244, s[12:15], s39 offen lds
    s_add_u32 m0, m0, 1024
    s_nop 0
    buffer_load_dwordx4 v245, s[12:15], s39 offen lds
    s_add_u32 m0, m0, 1024
    s_nop 0
    buffer_load_dwordx4 v246, s[12:15], s39 offen lds
    s_add_u32 m0, m0, 1024
    s_nop 0
    buffer_load_dwordx4 v247, s[12:15], s39 offen lds
    s_waitcnt vmcnt(14)
    s_setprio 1
    ds_read_b64_tr_b16 v[128:129], v144 offset:0
    ds_read_b64_tr_b16 v[130:131], v144 offset:2048
    ds_read_b64_tr_b16 v[132:133], v145 offset:0
    ds_read_b64_tr_b16 v[134:135], v145 offset:2048
    ds_read_b64_tr_b16 v[136:137], v146 offset:0
    ds_read_b64_tr_b16 v[138:139], v146 offset:2048
    ds_read_b64_tr_b16 v[140:141], v147 offset:0
    ds_read_b64_tr_b16 v[142:143], v147 offset:2048
    s_add_u32 s20, s4, 0x1400000
    s_addc_u32 s21, s5, 0
    s_mov_b32 s22, 0x20000
    s_mov_b32 s23, 0x20000
    s_lshl_b32 s35, s28, 1
    s_and_b32 s36, s30, 1
    s_add_u32 s35, s35, s36
    s_mul_i32 s35, s35, 4096
    s_mul_i32 s36, s29, 256
    s_add_u32 s35, s35, s36
    s_waitcnt lgkmcnt(0)
    v_mfma_f32_16x16x32_bf16 v[160:163], v[128:131], v[16:19], v[160:163]
    v_mfma_f32_16x16x32_bf16 v[160:163], v[132:135], v[20:23], v[160:163]
    v_mfma_f32_16x16x32_bf16 v[160:163], v[136:139], v[24:27], v[160:163]
    v_mfma_f32_16x16x32_bf16 v[160:163], v[140:143], v[28:31], v[160:163]
    s_nop 7
    buffer_store_dwordx4 v[160:163], v167, s[20:23], s35 offen sc1
    s_waitcnt vmcnt(1)
    v_mov_b32 v6, 162840
    v_mov_b32 v7, 1
    s_mov_b64 exec, 1
    ds_add_u32 v6, v7
    s_mov_b64 exec, -1
    ds_read_b64_tr_b16 v[72:73], v148 offset:0
    ds_read_b64_tr_b16 v[74:75], v148 offset:7168
    ds_read_b64_tr_b16 v[76:77], v149 offset:32
    ds_read_b64_tr_b16 v[78:79], v149 offset:7200
    ds_read_b64_tr_b16 v[80:81], v148 offset:64
    ds_read_b64_tr_b16 v[82:83], v148 offset:7232
    ds_read_b64_tr_b16 v[84:85], v149 offset:96
    ds_read_b64_tr_b16 v[86:87], v149 offset:7264
    ds_read_b64_tr_b16 v[88:89], v148 offset:128
    ds_read_b64_tr_b16 v[90:91], v148 offset:7296
    ds_read_b64_tr_b16 v[92:93], v149 offset:160
    ds_read_b64_tr_b16 v[94:95], v149 offset:7328
    ds_read_b64_tr_b16 v[96:97], v148 offset:192
    ds_read_b64_tr_b16 v[98:99], v148 offset:7360
    ds_read_b64_tr_b16 v[100:101], v150 offset:0
    ds_read_b64_tr_b16 v[102:103], v150 offset:7168
    ds_read_b64_tr_b16 v[104:105], v151 offset:32
    ds_read_b64_tr_b16 v[106:107], v151 offset:7200
    ds_read_b64_tr_b16 v[108:109], v150 offset:64
    ds_read_b64_tr_b16 v[110:111], v150 offset:7232
    ds_read_b64_tr_b16 v[112:113], v151 offset:96
    ds_read_b64_tr_b16 v[114:115], v151 offset:7264
    ds_read_b64_tr_b16 v[116:117], v150 offset:128
    ds_read_b64_tr_b16 v[118:119], v150 offset:7296
    ds_read_b64_tr_b16 v[120:121], v151 offset:160
    ds_read_b64_tr_b16 v[122:123], v151 offset:7328
    ds_read_b64_tr_b16 v[124:125], v150 offset:192
    ds_read_b64_tr_b16 v[126:127], v150 offset:7360
    s_add_u32 s20, s4, 0x1420000
    s_addc_u32 s21, s5, 0
    s_mov_b32 s22, 0x70000
    s_mov_b32 s23, 0x20000
    s_lshl_b32 s35, s28, 1
    s_and_b32 s36, s30, 1
    s_add_u32 s35, s35, s36
    s_mul_i32 s35, s35, 14336
    s_mul_i32 s36, s29, 896
    s_add_u32 s35, s35, s36
    s_waitcnt lgkmcnt(0)
    v_mfma_f32_16x16x32_bf16 v[156:159], v[72:75], v[16:19], v[156:159]
    v_mfma_f32_16x16x32_bf16 v[156:159], v[76:79], v[20:23], v[156:159]
    v_mfma_f32_16x16x32_bf16 v[156:159], v[80:83], v[24:27], v[156:159]
    v_mfma_f32_16x16x32_bf16 v[156:159], v[84:87], v[28:31], v[156:159]
    v_mfma_f32_16x16x32_bf16 v[156:159], v[88:91], v[32:35], v[156:159]
    v_mfma_f32_16x16x32_bf16 v[156:159], v[92:95], v[36:39], v[156:159]
    v_mfma_f32_16x16x32_bf16 v[156:159], v[96:99], v[40:43], v[156:159]
    v_mfma_f32_16x16x32_bf16 v[156:159], v[100:103], v[44:47], v[156:159]
    v_mfma_f32_16x16x32_bf16 v[156:159], v[104:107], v[48:51], v[156:159]
    v_mfma_f32_16x16x32_bf16 v[156:159], v[108:111], v[52:55], v[156:159]
    v_mfma_f32_16x16x32_bf16 v[156:159], v[112:115], v[56:59], v[156:159]
    v_mfma_f32_16x16x32_bf16 v[156:159], v[116:119], v[60:63], v[156:159]
    v_mfma_f32_16x16x32_bf16 v[156:159], v[120:123], v[64:67], v[156:159]
    v_mfma_f32_16x16x32_bf16 v[156:159], v[124:127], v[68:71], v[156:159]
    s_nop 7
    buffer_store_dwordx4 v[156:159], v168, s[20:23], s35 offen sc1
    v_mov_b32 v6, 162840
    v_mov_b32 v7, 1
    s_mov_b64 exec, 1
    ds_add_u32 v6, v7
    s_mov_b64 exec, -1
    s_setprio 0
    s_call_b64 s[76:77], SUB_w1_regs
    s_call_b64 s[76:77], SUB_park
    v_mov_b32 v6, 162840
spin_14:
    s_sleep 3
    ds_read_b32 v7, v6
    s_waitcnt lgkmcnt(0)
    v_readfirstlane_b32 s53, v7
    s_nop 0
    s_cmp_ge_u32 s53, 4
    s_cbranch_scc0 spin_14
    s_mov_b64 s[12:13], s[68:69]
    s_mov_b32 s14, 2097152
    s_mov_b32 s15, 0x20000
    s_and_b32 s35, s30, 1
    s_mul_i32 s38, s99, 128
    s_mul_i32 s41, s35, 65536
    s_add_u32 s38, s38, s41
    s_mul_i32 s41, s35, 4096
    s_add_u32 s41, s41, 24576
    s_mov_b32 s42, 0
    s_mov_b32 s44, s67
    s_mov_b32 s42, 98304
    s_mov_b32 s44, s67
    s_add_u32 s44, s44, 12
    s_and_b32 s44, s44, 15
    s_call_b64 s[76:77], SUB_w_issue_1
    s_waitcnt vmcnt(8)
    s_mov_b32 s42, 106496
    s_mov_b32 s44, s67
    s_add_u32 s44, s44, 13
    s_and_b32 s44, s44, 15
    s_call_b64 s[76:77], SUB_w_issue_1
    s_waitcnt vmcnt(8)
    s_mov_b32 s42, 114688
    s_mov_b32 s44, s67
    s_add_u32 s44, s44, 14
    s_and_b32 s44, s44, 15
    s_call_b64 s[76:77], SUB_w_issue_1
    s_waitcnt vmcnt(8)
    s_mov_b32 s42, 122880
    s_mov_b32 s44, s67
    s_add_u32 s44, s44, 15
    s_and_b32 s44, s44, 15
    s_call_b64 s[76:77], SUB_w_issue_1
    s_waitcnt vmcnt(8)
    s_and_b32 s36, s29, 6
    s_cmp_eq_u32 s36, 2
    s_cbranch_scc1 pr_15
    s_call_b64 s[76:77], SUB_park2
pr_15:
    s_call_b64 s[76:77], SUB_w1_put
FR_end:
LAYER:
    v_lshlrev_b32 v40, 6, v199
    v_add_u32 v40, 161792, v40
    s_lshl_b32 s35, s30, 3
    v_add_u32 v39, s35, v40
    s_cmp_eq_u32 s60, 0
    s_cbranch_scc1 R_l0
    s_sub_u32 s8, s62, 0x400000
    s_subb_u32 s9, s63, 0
    s_mov_b32 s10, 0x7e000
    s_mov_b32 s11, 0x20000
    s_sub_u32 s12, s62, 0x380000
    s_subb_u32 s13, s63, 0
    s_mov_b32 s14, 0x7e000
    s_mov_b32 s15, 0x20000
    s_mov_b32 s20, s62
    s_mov_b32 s21, s63
    s_mov_b32 s22, 0x7e000
    s_mov_b32 s23, 0x20000
    s_mov_b32 s78, 0x3f80
    s_mov_b32 s79, 0x3f800000
    v_lshlrev_b32 v222, 16, v230
    v_and_b32 v223, 0xffff0000, v230
    v_lshlrev_b32 v206, 16, v180
    v_and_b32 v207, 0xffff0000, v180
    v_lshlrev_b32 v12, 16, v188
    v_and_b32 v13, 0xffff0000, v188
    v_pk_add_f32 v[206:207], v[206:207], v[12:13]
    v_lshlrev_b32 v224, 16, v231
    v_and_b32 v225, 0xffff0000, v231
    v_lshlrev_b32 v208, 16, v181
    v_and_b32 v209, 0xffff0000, v181
    v_lshlrev_b32 v14, 16, v189
    v_and_b32 v15, 0xffff0000, v189
    v_pk_add_f32 v[208:209], v[208:209], v[14:15]
    v_lshlrev_b32 v226, 16, v232
    v_and_b32 v227, 0xffff0000, v232
    v_lshlrev_b32 v210, 16, v182
    v_and_b32 v211, 0xffff0000, v182
    v_lshlrev_b32 v16, 16, v190
    v_and_b32 v17, 0xffff0000, v190
    v_pk_add_f32 v[210:211], v[210:211], v[16:17]
    v_lshlrev_b32 v228, 16, v233
    v_and_b32 v229, 0xffff0000, v233
    v_lshlrev_b32 v212, 16, v183
    v_and_b32 v213, 0xffff0000, v183
    v_lshlrev_b32 v18, 16, v191
    v_and_b32 v19, 0xffff0000, v191
    v_pk_add_f32 v[212:213], v[212:213], v[18:19]
    v_lshlrev_b32 v230, 16, v234
    v_and_b32 v231, 0xffff0000, v234
    v_lshlrev_b32 v214, 16, v184
    v_and_b32 v215, 0xffff0000, v184
    v_lshlrev_b32 v20, 16, v192
    v_and_b32 v21, 0xffff0000, v192
    v_pk_add_f32 v[214:215], v[214:215], v[20:21]
    v_lshlrev_b32 v232, 16, v235
    v_and_b32 v233, 0xffff0000, v235
    v_lshlrev_b32 v216, 16, v185
    v_and_b32 v217, 0xffff0000, v185
    v_lshlrev_b32 v22, 16, v193
    v_and_b32 v23, 0xffff0000, v193
    v_pk_add_f32 v[216:217], v[216:217], v[22:23]
    v_lshlrev_b32 v234, 16, v236
    v_and_b32 v235, 0xffff0000, v236
    v_lshlrev_b32 v218, 16, v186
    v_and_b32 v219, 0xffff0000, v186
    v_lshlrev_b32 v24, 16, v194
    v_and_b32 v25, 0xffff0000, v194
    v_pk_add_f32 v[218:219], v[218:219], v[24:25]
    v_lshlrev_b32 v236, 16, v237
    v_and_b32 v237, 0xffff0000, v237
    v_lshlrev_b32 v220, 16, v187
    v_and_b32 v221, 0xffff0000, v187
    v_lshlrev_b32 v26, 16, v195
    v_and_b32 v27, 0xffff0000, v195
    v_pk_add_f32 v[220:221], v[220:221], v[26:27]
    s_mov_b32 s53, 0
    s_sleep 10
    s_cmp_ge_u32 s30, 6
    s_cbranch_scc1 dp_16
    s_sleep 14
dp_16:
    buffer_load_dwordx4 v[180:183], v196, s[8:11], 0 offen offset:0 sc1
    buffer_load_dwordx4 v[188:191], v196, s[12:15], 0 offen offset:0 sc1
    buffer_load_dwordx4 v[184:187], v196, s[8:11], 0 offen offset:2048 sc1
    buffer_load_dwordx4 v[192:195], v196, s[12:15], 0 offen offset:2048 sc1
    s_waitcnt vmcnt(0)
    v_bitop3_b32 v6, v180, v184, v188 bitop3:0x80
    v_bitop3_b32 v6, v6, v192, 1 bitop3:0x80
    v_cmp_eq_u32 vcc, 0, v6
    s_cbranch_vccz dq_17
    s_sleep 4
    s_add_u32 s53, s53, 1
    s_cmp_lt_u32 s53, s61
    s_cbranch_scc1 dp_16
    s_mov_b32 s61, 0
dq_17:
    v_dot2_f32_bf16 v206, v180, s78, v206
    v_dot2_f32_bf16 v207, v180, s79, v207
    v_dot2_f32_bf16 v208, v181, s78, v208
    v_dot2_f32_bf16 v209, v181, s79, v209
    v_dot2_f32_bf16 v210, v182, s78, v210
    v_dot2_f32_bf16 v211, v182, s79, v211
    v_dot2_f32_bf16 v212, v183, s78, v212
    v_dot2_f32_bf16 v213, v183, s79, v213
    v_dot2_f32_bf16 v214, v184, s78, v214
    v_dot2_f32_bf16 v215, v184, s79, v215
    v_dot2_f32_bf16 v216, v185, s78, v216
    v_dot2_f32_bf16 v217, v185, s79, v217
    v_dot2_f32_bf16 v218, v186, s78, v218
    v_dot2_f32_bf16 v219, v186, s79, v219
    v_dot2_f32_bf16 v220, v187, s78, v220
    v_dot2_f32_bf16 v221, v187, s79, v221
    v_dot2_f32_bf16 v206, v188, s78, v206
    v_dot2_f32_bf16 v207, v188, s79, v207
    v_dot2_f32_bf16 v208, v189, s78, v208
    v_dot2_f32_bf16 v209, v189, s79, v209
    v_dot2_f32_bf16 v210, v190, s78, v210
    v_dot2_f32_bf16 v211, v190, s79, v211
    v_dot2_f32_bf16 v212, v191, s78, v212
    v_dot2_f32_bf16 v213, v191, s79, v213
    v_dot2_f32_bf16 v214, v192, s78, v214
    v_dot2_f32_bf16 v215, v192, s79, v215
    v_dot2_f32_bf16 v216, v193, s78, v216
    v_dot2_f32_bf16 v217, v193, s79, v217
    v_dot2_f32_bf16 v218, v194, s78, v218
    v_dot2_f32_bf16 v219, v194, s79, v219
    v_dot2_f32_bf16 v220, v195, s78, v220
    v_dot2_f32_bf16 v221, v195, s79, v221
    s_nop 2
    v_pk_add_f32 v[32:33], v[206:207], v[208:209]
    v_pk_mul_f32 v[34:35], v[206:207], v[206:207]
    v_pk_fma_f32 v[34:35], v[208:209], v[208:209], v[34:35]
    v_pk_add_f32 v[32:33], v[32:33], v[210:211]
    v_pk_fma_f32 v[34:35], v[210:211], v[210:211], v[34:35]
    v_pk_add_f32 v[32:33], v[32:33], v[212:213]
    v_pk_fma_f32 v[34:35], v[212:213], v[212:213], v[34:35]
    v_pk_add_f32 v[32:33], v[32:33], v[214:215]
    v_pk_fma_f32 v[34:35], v[214:215], v[214:215], v[34:35]
    v_pk_add_f32 v[32:33], v[32:33], v[216:217]
    v_pk_fma_f32 v[34:35], v[216:217], v[216:217], v[34:35]
    v_pk_add_f32 v[32:33], v[32:33], v[218:219]
    v_pk_fma_f32 v[34:35], v[218:219], v[218:219], v[34:35]
    v_pk_add_f32 v[32:33], v[32:33], v[220:221]
    v_pk_fma_f32 v[34:35], v[220:221], v[220:221], v[34:35]
    v_add_f32 v30, v32, v33
    v_add_f32 v31, v34, v35
    s_nop 0
    v_add_f32_dpp v30, v30, v30 row_ror:8 row_mask:0xf bank_mask:0xf
    v_add_f32_dpp v31, v31, v31 row_ror:8 row_mask:0xf bank_mask:0xf
    v_mov_b32 v32, v30
    v_mov_b32 v33, v31
    s_nop 0
    v_permlane16_swap_b32 v30, v32
    v_permlane16_swap_b32 v31, v33
    v_pk_add_f32 v[30:31], v[30:31], v[32:33]
    v_mov_b32 v32, v30
    v_mov_b32 v33, v31
    s_nop 0
    v_permlane32_swap_b32 v30, v32
    v_permlane32_swap_b32 v31, v33
    v_pk_add_f32 v[30:31], v[30:31], v[32:33]
    ds_write_b64 v39, v[30:31] offset:0
    s_waitcnt lgkmcnt(0)
    s_barrier
    ds_read_b128 v[12:15], v40 offset:0
    ds_read_b128 v[16:19], v40 offset:16
    ds_read_b128 v[20:23], v40 offset:32
    ds_read_b128 v[24:27], v40 offset:48
    s_waitcnt lgkmcnt(0)
    v_pk_add_f32 v[12:13], v[12:13], v[14:15]
    v_pk_add_f32 v[16:17], v[16:17], v[18:19]
    v_pk_add_f32 v[20:21], v[20:21], v[22:23]
    v_pk_add_f32 v[24:25], v[24:25], v[26:27]
    v_pk_add_f32 v[12:13], v[12:13], v[16:17]
    v_pk_add_f32 v[20:21], v[20:21], v[24:25]
    v_pk_add_f32 v[12:13], v[12:13], v[20:21]
    v_mul_f32 v36, 0x3a800000, v12
    v_mul_f32 v38, 0x3a800000, v13
    v_fma_f32 v38, -v36, v36, v38
    v_max_f32 v38, 0, v38
    v_add_f32 v38, 0x3727c5ac, v38
    v_rsq_f32 v37, v38
    s_nop 0
    v_mul_f32 v36, v36, v37
    v_pk_fma_f32 v[12:13], v[206:207], v[36:37], v[36:37] op_sel:[0,1,0] op_sel_hi:[1,1,0] neg_lo:[0,0,1] neg_hi:[0,0,1]
    v_pk_fma_f32 v[14:15], v[208:209], v[36:37], v[36:37] op_sel:[0,1,0] op_sel_hi:[1,1,0] neg_lo:[0,0,1] neg_hi:[0,0,1]
    v_pk_fma_f32 v[16:17], v[210:211], v[36:37], v[36:37] op_sel:[0,1,0] op_sel_hi:[1,1,0] neg_lo:[0,0,1] neg_hi:[0,0,1]
    v_pk_fma_f32 v[18:19], v[212:213], v[36:37], v[36:37] op_sel:[0,1,0] op_sel_hi:[1,1,0] neg_lo:[0,0,1] neg_hi:[0,0,1]
    v_pk_fma_f32 v[20:21], v[214:215], v[36:37], v[36:37] op_sel:[0,1,0] op_sel_hi:[1,1,0] neg_lo:[0,0,1] neg_hi:[0,0,1]
    v_pk_fma_f32 v[22:23], v[216:217], v[36:37], v[36:37] op_sel:[0,1,0] op_sel_hi:[1,1,0] neg_lo:[0,0,1] neg_hi:[0,0,1]
    v_pk_fma_f32 v[24:25], v[218:219], v[36:37], v[36:37] op_sel:[0,1,0] op_sel_hi:[1,1,0] neg_lo:[0,0,1] neg_hi:[0,0,1]
    v_pk_fma_f32 v[26:27], v[220:221], v[36:37], v[36:37] op_sel:[0,1,0] op_sel_hi:[1,1,0] neg_lo:[0,0,1] neg_hi:[0,0,1]
    v_pk_fma_f32 v[206:207], v[12:13], v[222:223], v[206:207]
    v_cvt_pk_bf16_f32 v180, v206, v207
    v_pk_fma_f32 v[208:209], v[14:15], v[224:225], v[208:209]
    v_cvt_pk_bf16_f32 v181, v208, v209
    v_and_b32 v180, -2, v180
    v_pk_fma_f32 v[210:211], v[16:17], v[226:227], v[210:211]
    v_cvt_pk_bf16_f32 v182, v210, v211
    v_pk_fma_f32 v[212:213], v[18:19], v[228:229], v[212:213]
    v_cvt_pk_bf16_f32 v183, v212, v213
    buffer_store_dwordx4 v[180:183], v196, s[20:23], 0 offen offset:0 sc1
    v_pk_fma_f32 v[214:215], v[20:21], v[230:231], v[214:215]
    v_cvt_pk_bf16_f32 v184, v214, v215
    v_pk_fma_f32 v[216:217], v[22:23], v[232:233], v[216:217]
    v_cvt_pk_bf16_f32 v185, v216, v217
    v_and_b32 v184, -2, v184
    v_pk_fma_f32 v[218:219], v[24:25], v[234:235], v[218:219]
    v_cvt_pk_bf16_f32 v186, v218, v219
    v_pk_fma_f32 v[220:221], v[26:27], v[236:237], v[220:221]
    v_cvt_pk_bf16_f32 v187, v220, v221
    buffer_store_dwordx4 v[184:187], v196, s[20:23], 0 offen offset:2048 sc1
    s_branch R_s2
R_l0:
    v_lshlrev_b32 v206, 16, v180
    v_and_b32 v207, 0xffff0000, v180
    v_lshlrev_b32 v208, 16, v181
    v_and_b32 v209, 0xffff0000, v181
    v_lshlrev_b32 v210, 16, v182
    v_and_b32 v211, 0xffff0000, v182
    v_lshlrev_b32 v212, 16, v183
    v_and_b32 v213, 0xffff0000, v183
    v_lshlrev_b32 v214, 16, v184
    v_and_b32 v215, 0xffff0000, v184
    v_lshlrev_b32 v216, 16, v185
    v_and_b32 v217, 0xffff0000, v185
    v_lshlrev_b32 v218, 16, v186
    v_and_b32 v219, 0xffff0000, v186
    v_lshlrev_b32 v220, 16, v187
    v_and_b32 v221, 0xffff0000, v187
    v_pk_add_f32 v[32:33], v[206:207], v[208:209]
    v_pk_mul_f32 v[34:35], v[206:207], v[206:207]
    v_pk_fma_f32 v[34:35], v[208:209], v[208:209], v[34:35]
    v_pk_add_f32 v[32:33], v[32:33], v[210:211]
    v_pk_fma_f32 v[34:35], v[210:211], v[210:211], v[34:35]
    v_pk_add_f32 v[32:33], v[32:33], v[212:213]
    v_pk_fma_f32 v[34:35], v[212:213], v[212:213], v[34:35]
    v_pk_add_f32 v[32:33], v[32:33], v[214:215]
    v_pk_fma_f32 v[34:35], v[214:215], v[214:215], v[34:35]
    v_pk_add_f32 v[32:33], v[32:33], v[216:217]
    v_pk_fma_f32 v[34:35], v[216:217], v[216:217], v[34:35]
    v_pk_add_f32 v[32:33], v[32:33], v[218:219]
    v_pk_fma_f32 v[34:35], v[218:219], v[218:219], v[34:35]
    v_pk_add_f32 v[32:33], v[32:33], v[220:221]
    v_pk_fma_f32 v[34:35], v[220:221], v[220:221], v[34:35]
    v_add_f32 v30, v32, v33
    v_add_f32 v31, v34, v35
    s_nop 0
    v_add_f32_dpp v30, v30, v30 row_ror:8 row_mask:0xf bank_mask:0xf
    v_add_f32_dpp v31, v31, v31 row_ror:8 row_mask:0xf bank_mask:0xf
    v_mov_b32 v32, v30
    v_mov_b32 v33, v31
    s_nop 0
    v_permlane16_swap_b32 v30, v32
    v_permlane16_swap_b32 v31, v33
    v_pk_add_f32 v[30:31], v[30:31], v[32:33]
    v_mov_b32 v32, v30
    v_mov_b32 v33, v31
    s_nop 0
    v_permlane32_swap_b32 v30, v32
    v_permlane32_swap_b32 v31, v33
    v_pk_add_f32 v[30:31], v[30:31], v[32:33]
    ds_write_b64 v39, v[30:31] offset:0
    s_waitcnt lgkmcnt(0)
    v_mov_b32 v222, 162844
spin_18:
    ds_read_b32 v223, v222
    s_waitcnt lgkmcnt(0)
    v_readfirstlane_b32 s94, v223
    s_nop 0
    s_cmp_ge_u32 s94, 65536
    s_cbranch_scc0 spin_18
    s_cmp_gt_u32 s94, 65546
    s_cselect_b32 s94, 1, 0
    s_lshl_b32 s53, s94, 13
    v_xor_b32 v197, s53, v197
    s_lshr_b32 s53, s28, 3
    s_lshl_b32 s53, s53, 2
    s_and_b32 s54, s28, 3
    s_add_u32 s53, s53, s54
    s_lshl_b32 s53, s53, 24
    s_lshr_b32 s54, s28, 2
    s_xor_b32 s54, s54, s94
    s_and_b32 s54, s54, 1
    s_lshl_b32 s54, s54, 13
    s_add_u32 s36, s53, s54
    s_add_u32 s36, s36, 33554432
    s_lshr_b32 s53, s53, 14
    s_add_u32 s36, s53, s54
    s_xor_b32 s36, s36, 8192
    s_add_u32 s36, s36, 23101440
    s_lshl_b32 s53, s30, 7
    s_add_u32 s36, s36, s53
    v_mov_b32 v226, s36
    s_waitcnt vmcnt(0)
    s_barrier
    s_mov_b32 s53, 0
    s_add_u32 s54, s52, 32
    s_bfm_b64 exec, 1, 0
poll_19:
    buffer_load_dword v222, v226, s[56:59], 0 offen sc1
    s_waitcnt vmcnt(0)
    v_xor_b32 v222, s54, v222
    v_cmp_eq_u32 vcc, 0, v222
    s_nop 0
    s_cmp_eq_u64 vcc, exec
    s_cbranch_scc1 pok_20
    s_sleep 6
    s_add_u32 s53, s53, 1
    s_cmp_lt_u32 s53, s61
    s_cbranch_scc1 poll_19
    s_mov_b32 s61, 0
pok_20:
    s_mov_b64 exec, -1
    s_add_u32 s80, s4, 0x2100000
    s_addc_u32 s81, s5, 0
    s_mov_b32 s82, 0x7f00000
    s_mov_b32 s83, 0x20000
    s_mov_b32 s78, 0
    buffer_load_dwordx2 v[230:231], v197, s[80:83], s78 offen sc1
    s_mov_b32 s78, 2048
    buffer_load_dwordx2 v[232:233], v197, s[80:83], s78 offen sc1
    s_mov_b32 s78, 16384
    buffer_load_dwordx2 v[234:235], v197, s[80:83], s78 offen sc1
    s_mov_b32 s78, 18432
    buffer_load_dwordx2 v[236:237], v197, s[80:83], s78 offen sc1
    s_lshr_b32 s53, s28, 3
    s_lshl_b32 s53, s53, 2
    s_and_b32 s54, s28, 3
    s_add_u32 s53, s53, s54
    s_lshl_b32 s53, s53, 24
    s_lshr_b32 s54, s28, 2
    s_xor_b32 s54, s54, s94
    s_and_b32 s54, s54, 1
    s_lshl_b32 s54, s54, 13
    s_add_u32 s55, s53, s54
    s_add_u32 s55, s55, 33554432
    s_add_u32 s62, s4, s55
    s_addc_u32 s63, s5, 0
    s_sub_u32 s36, s28, 1
    s_max_i32 s36, s36, 0
    s_lshr_b32 s53, s36, 3
    s_lshl_b32 s53, s53, 2
    s_and_b32 s54, s36, 3
    s_add_u32 s53, s53, s54
    s_lshl_b32 s53, s53, 24
    s_lshr_b32 s54, s36, 2
    s_xor_b32 s54, s54, s94
    s_and_b32 s54, s54, 1
    s_lshl_b32 s54, s54, 13
    s_add_u32 s92, s53, s54
    s_add_u32 s92, s92, 33554432
    s_sub_u32 s92, s92, s55
    s_add_u32 s36, s28, 1
    s_min_u32 s36, s36, 15
    s_lshr_b32 s53, s36, 3
    s_lshl_b32 s53, s53, 2
    s_and_b32 s54, s36, 3
    s_add_u32 s53, s53, s54
    s_lshl_b32 s53, s53, 24
    s_lshr_b32 s54, s36, 2
    s_xor_b32 s54, s54, s94
    s_and_b32 s54, s54, 1
    s_lshl_b32 s54, s54, 13
    s_add_u32 s93, s53, s54
    s_add_u32 s93, s93, 33554432
    s_sub_u32 s93, s93, s55
    s_add_u32 s55, s55, 6029312
    s_mov_b32 s20, s62
    s_mov_b32 s21, s63
    s_mov_b32 s22, 0x7e000
    s_mov_b32 s23, 0x20000
    ds_read_b128 v[12:15], v40 offset:0
    ds_read_b128 v[16:19], v40 offset:16
    ds_read_b128 v[20:23], v40 offset:32
    ds_read_b128 v[24:27], v40 offset:48
    s_waitcnt lgkmcnt(0)
    v_pk_add_f32 v[12:13], v[12:13], v[14:15]
    v_pk_add_f32 v[16:17], v[16:17], v[18:19]
    v_pk_add_f32 v[20:21], v[20:21], v[22:23]
    v_pk_add_f32 v[24:25], v[24:25], v[26:27]
    v_pk_add_f32 v[12:13], v[12:13], v[16:17]
    v_pk_add_f32 v[20:21], v[20:21], v[24:25]
    v_pk_add_f32 v[12:13], v[12:13], v[20:21]
    v_mul_f32 v36, 0x3a800000, v12
    v_mul_f32 v38, 0x3a800000, v13
    v_fma_f32 v38, -v36, v36, v38
    v_max_f32 v38, 0, v38
    v_add_f32 v38, 0x3727c5ac, v38
    v_rsq_f32 v37, v38
    s_nop 0
    v_pk_add_f32 v[12:13], v[206:207], v[36:37] op_sel_hi:[1,0] neg_lo:[0,1] neg_hi:[0,1]
    v_pk_mul_f32 v[12:13], v[12:13], v[36:37] op_sel:[0,1] op_sel_hi:[1,1]
    v_pk_add_f32 v[14:15], v[208:209], v[36:37] op_sel_hi:[1,0] neg_lo:[0,1] neg_hi:[0,1]
    v_pk_mul_f32 v[14:15], v[14:15], v[36:37] op_sel:[0,1] op_sel_hi:[1,1]
    v_pk_add_f32 v[16:17], v[210:211], v[36:37] op_sel_hi:[1,0] neg_lo:[0,1] neg_hi:[0,1]
    v_pk_mul_f32 v[16:17], v[16:17], v[36:37] op_sel:[0,1] op_sel_hi:[1,1]
    v_pk_add_f32 v[18:19], v[212:213], v[36:37] op_sel_hi:[1,0] neg_lo:[0,1] neg_hi:[0,1]
    v_pk_mul_f32 v[18:19], v[18:19], v[36:37] op_sel:[0,1] op_sel_hi:[1,1]
    v_pk_add_f32 v[20:21], v[214:215], v[36:37] op_sel_hi:[1,0] neg_lo:[0,1] neg_hi:[0,1]
    v_pk_mul_f32 v[20:21], v[20:21], v[36:37] op_sel:[0,1] op_sel_hi:[1,1]
    v_pk_add_f32 v[22:23], v[216:217], v[36:37] op_sel_hi:[1,0] neg_lo:[0,1] neg_hi:[0,1]
    v_pk_mul_f32 v[22:23], v[22:23], v[36:37] op_sel:[0,1] op_sel_hi:[1,1]
    v_pk_add_f32 v[24:25], v[218:219], v[36:37] op_sel_hi:[1,0] neg_lo:[0,1] neg_hi:[0,1]
    v_pk_mul_f32 v[24:25], v[24:25], v[36:37] op_sel:[0,1] op_sel_hi:[1,1]
    v_pk_add_f32 v[26:27], v[220:221], v[36:37] op_sel_hi:[1,0] neg_lo:[0,1] neg_hi:[0,1]
    v_pk_mul_f32 v[26:27], v[26:27], v[36:37] op_sel:[0,1] op_sel_hi:[1,1]
    s_barrier
    s_waitcnt vmcnt(0)
    v_lshlrev_b32 v222, 16, v230
    v_and_b32 v223, 0xffff0000, v230
    v_pk_fma_f32 v[206:207], v[12:13], v[222:223], v[206:207]
    v_cvt_pk_bf16_f32 v180, v206, v207
    v_lshlrev_b32 v222, 16, v231
    v_and_b32 v223, 0xffff0000, v231
    v_pk_fma_f32 v[208:209], v[14:15], v[222:223], v[208:209]
    v_cvt_pk_bf16_f32 v181, v208, v209
    v_and_b32 v180, -2, v180
    v_lshlrev_b32 v222, 16, v232
    v_and_b32 v223, 0xffff0000, v232
    v_pk_fma_f32 v[210:211], v[16:17], v[222:223], v[210:211]
    v_cvt_pk_bf16_f32 v182, v210, v211
    v_lshlrev_b32 v222, 16, v233
    v_and_b32 v223, 0xffff0000, v233
    v_pk_fma_f32 v[212:213], v[18:19], v[222:223], v[212:213]
    v_cvt_pk_bf16_f32 v183, v212, v213
    buffer_store_dwordx4 v[180:183], v196, s[20:23], 0 offen offset:0 sc1
    v_lshlrev_b32 v222, 16, v234
    v_and_b32 v223, 0xffff0000, v234
    v_pk_fma_f32 v[214:215], v[20:21], v[222:223], v[214:215]
    v_cvt_pk_bf16_f32 v184, v214, v215
    v_lshlrev_b32 v222, 16, v235
    v_and_b32 v223, 0xffff0000, v235
    v_pk_fma_f32 v[216:217], v[22:23], v[222:223], v[216:217]
    v_cvt_pk_bf16_f32 v185, v216, v217
    v_and_b32 v184, -2, v184
    v_lshlrev_b32 v222, 16, v236
    v_and_b32 v223, 0xffff0000, v236
    v_pk_fma_f32 v[218:219], v[24:25], v[222:223], v[218:219]
    v_cvt_pk_bf16_f32 v186, v218, v219
    v_lshlrev_b32 v222, 16, v237
    v_and_b32 v223, 0xffff0000, v237
    v_pk_fma_f32 v[220:221], v[26:27], v[222:223], v[220:221]
    v_cvt_pk_bf16_f32 v187, v220, v221
    buffer_store_dwordx4 v[184:187], v196, s[20:23], 0 offen offset:2048 sc1
R_s2:
    v_lshlrev_b32 v206, 16, v180
    v_and_b32 v207, 0xffff0000, v180
    v_lshlrev_b32 v208, 16, v181
    v_and_b32 v209, 0xffff0000, v181
    v_lshlrev_b32 v210, 16, v182
    v_and_b32 v211, 0xffff0000, v182
    v_lshlrev_b32 v212, 16, v183
    v_and_b32 v213, 0xffff0000, v183
    v_lshlrev_b32 v214, 16, v184
    v_and_b32 v215, 0xffff0000, v184
    v_lshlrev_b32 v216, 16, v185
    v_and_b32 v217, 0xffff0000, v185
    v_lshlrev_b32 v218, 16, v186
    v_and_b32 v219, 0xffff0000, v186
    v_lshlrev_b32 v220, 16, v187
    v_and_b32 v221, 0xffff0000, v187
    v_pk_add_f32 v[32:33], v[206:207], v[208:209]
    v_pk_mul_f32 v[34:35], v[206:207], v[206:207]
    v_pk_fma_f32 v[34:35], v[208:209], v[208:209], v[34:35]
    v_pk_add_f32 v[32:33], v[32:33], v[210:211]
    v_pk_fma_f32 v[34:35], v[210:211], v[210:211], v[34:35]
    v_pk_add_f32 v[32:33], v[32:33], v[212:213]
    v_pk_fma_f32 v[34:35], v[212:213], v[212:213], v[34:35]
    v_pk_add_f32 v[32:33], v[32:33], v[214:215]
    v_pk_fma_f32 v[34:35], v[214:215], v[214:215], v[34:35]
    v_pk_add_f32 v[32:33], v[32:33], v[216:217]
    v_pk_fma_f32 v[34:35], v[216:217], v[216:217], v[34:35]
    v_pk_add_f32 v[32:33], v[32:33], v[218:219]
    v_pk_fma_f32 v[34:35], v[218:219], v[218:219], v[34:35]
    v_pk_add_f32 v[32:33], v[32:33], v[220:221]
    v_pk_fma_f32 v[34:35], v[220:221], v[220:221], v[34:35]
    v_add_f32 v30, v32, v33
    v_add_f32 v31, v34, v35
    s_nop 0
    v_add_f32_dpp v30, v30, v30 row_ror:8 row_mask:0xf bank_mask:0xf
    v_add_f32_dpp v31, v31, v31 row_ror:8 row_mask:0xf bank_mask:0xf
    v_mov_b32 v32, v30
    v_mov_b32 v33, v31
    s_nop 0
    v_permlane16_swap_b32 v30, v32
    v_permlane16_swap_b32 v31, v33
    v_pk_add_f32 v[30:31], v[30:31], v[32:33]
    v_mov_b32 v32, v30
    v_mov_b32 v33, v31
    s_nop 0
    v_permlane32_swap_b32 v30, v32
    v_permlane32_swap_b32 v31, v33
    v_pk_add_f32 v[30:31], v[30:31], v[32:33]
    ds_write_b64 v39, v[30:31] offset:512
    s_waitcnt lgkmcnt(0)
    s_barrier
    s_cmp_lg_u32 s30, 6
    s_cbranch_scc1 R_n6
    s_cmp_lg_u32 s60, 0
    s_cbranch_scc1 R_n6
    s_lshl_b32 s53, s29, 7
    s_add_u32 s53, s53, 23121920
    v_mov_b32 v8, 1
    v_mov_b32 v9, 0
    s_mov_b64 exec, 1
    buffer_atomic_add v8, v9, s[56:59], s53 offen sc1
    s_mov_b64 exec, -1
R_n6:
    s_cmp_lg_u32 s30, 7
    s_cbranch_scc1 R_nl
    ds_read_b128 v[12:15], v40 offset:512
    ds_read_b128 v[16:19], v40 offset:528
    ds_read_b128 v[20:23], v40 offset:544
    ds_read_b128 v[24:27], v40 offset:560
    s_waitcnt lgkmcnt(0)
    v_pk_add_f32 v[12:13], v[12:13], v[14:15]
    v_pk_add_f32 v[16:17], v[16:17], v[18:19]
    v_pk_add_f32 v[20:21], v[20:21], v[22:23]
    v_pk_add_f32 v[24:25], v[24:25], v[26:27]
    v_pk_add_f32 v[12:13], v[12:13], v[16:17]
    v_pk_add_f32 v[20:21], v[20:21], v[24:25]
    v_pk_add_f32 v[12:13], v[12:13], v[20:21]
    v_mul_f32 v36, 0x3a800000, v12
    v_mul_f32 v38, 0x3a800000, v13
    v_fma_f32 v38, -v36, v36, v38
    v_max_f32 v38, 0, v38
    v_mov_b32 v42, v36
    v_mov_b32 v43, v38
    v_add_f32 v38, 0x3727c5ac, v38
    v_sqrt_f32 v38, v38
    s_nop 0
    v_mov_b32 v41, v38
    v_rcp_f32 v37, v38
    v_sub_f32 v42, v42, v36
    v_mul_f32 v42, v42, v37
    v_mul_f32 v43, v43, v37
    v_mul_f32 v43, v43, v37
    v_add_f32 v43, 0x3727c5ac, v43
    v_rsq_f32 v44, v43
    v_mov_b32 v224, v36
    v_mov_b32 v225, v37
    v_fma_f32 v226, v42, v41, v36
    v_mul_f32 v227, v37, v44
    s_add_u32 s24, s62, 0x5d0000
    s_addc_u32 s25, s63, 0
    s_mov_b32 s26, 0x800
    s_mov_b32 s27, 0x20000
    s_lshl_b32 s36, s29, 3
    v_add_u32 v6, s36, v199
    v_lshlrev_b32 v6, 4, v6
    s_mov_b64 exec, 0xff
    buffer_store_dwordx4 v[224:227], v6, s[24:27], 0 offen sc1
    s_mov_b64 exec, -1
    s_add_u32 s53, s55, 1280
    v_mov_b32 v8, 1
    v_mov_b32 v9, 162816
    v_mov_b32 v11, 0
    s_mov_b64 exec, 1
    s_waitcnt vmcnt(0)
    buffer_atomic_add v8, v11, s[56:59], s53 offen sc1
pub_21:
    s_mov_b64 exec, -1
R_nl:
    s_cmp_ge_u32 s30, 4
    s_cbranch_scc1 LOADERS
    s_setprio 1
    s_mov_b32 s8, s62
    s_mov_b32 s9, s63
    s_mov_b32 s10, 0x7e000
    s_mov_b32 s11, 0x20000
    v_add_u32 v126, 0, v2
    v_add_u32 v127, 65536, v2
    s_lshl_b32 s44, s30, 17
    s_mov_b32 s34, s30
    s_mov_b32 s35, 0
    v_and_b32 v22, 15, v1
    v_lshrrev_b32 v23, 4, v1
    s_mul_i32 s37, s34, 2
    s_mul_i32 s38, s99, 4
    s_mul_i32 s36, s35, 4
    s_add_u32 s38, s38, s36
    v_add_u32 v128, 4096, v2
    v_add_u32 v129, 69632, v2
    s_add_u32 s45, s44, 16384
    s_add_u32 s46, s44, 32768
    s_add_u32 s47, s44, 49152
    v_min_u32 v18, 1, v1
    v_lshlrev_b32 v18, 16, v18
    v_add_u32 v18, 162896, v18
    v_mov_b32 v19, 1
    v_lshrrev_b32 v6, 2, v1
    v_mul_u32_u24 v13, 128, v6
    v_and_b32 v7, 3, v1
    v_lshl_add_u32 v13, v7, 3, v13
    v_add_u32 v13, 24576, v13
    v_bfe_u32 v6, v6, 1, 2
    s_mul_i32 s36, s35, 4
    s_add_u32 s36, s36, 3
    v_xor_b32 v7, s36, v6
    v_lshl_add_u32 v16, v7, 5, v13
    s_mul_i32 s36, s35, 4
    s_add_u32 s36, s36, 2
    v_xor_b32 v7, s36, v6
    v_lshl_add_u32 v15, v7, 5, v13
    s_mul_i32 s36, s35, 4
    s_add_u32 s36, s36, 1
    v_xor_b32 v7, s36, v6
    v_lshl_add_u32 v14, v7, 5, v13
    s_mul_i32 s36, s35, 4
    s_add_u32 s36, s36, 0
    v_xor_b32 v7, s36, v6
    v_lshl_add_u32 v13, v7, 5, v13
    v_pk_mov_b32 v[24:25], 0, 0
    v_pk_mov_b32 v[26:27], 0, 0
    v_pk_mov_b32 v[28:29], 0, 0
    v_pk_mov_b32 v[30:31], 0, 0
    v_pk_mov_b32 v[32:33], 0, 0
    v_pk_mov_b32 v[34:35], 0, 0
    v_pk_mov_b32 v[36:37], 0, 0
    v_pk_mov_b32 v[38:39], 0, 0
    v_pk_mov_b32 v[40:41], 0, 0
    v_pk_mov_b32 v[42:43], 0, 0
    v_pk_mov_b32 v[44:45], 0, 0
    v_pk_mov_b32 v[46:47], 0, 0
    v_pk_mov_b32 v[48:49], 0, 0
    v_pk_mov_b32 v[50:51], 0, 0
    v_pk_mov_b32 v[52:53], 0, 0
    v_pk_mov_b32 v[54:55], 0, 0
    s_mov_b32 s43, 0
    s_mul_i32 s36, s35, 256
    s_add_u32 s36, s36, 163328
    v_lshlrev_b32 v6, 4, v23
    v_add_u32 v6, s36, v6
    s_lshl_b32 s36, s37, 8
    s_add_u32 s36, s36, 160776
    v_lshlrev_b32 v7, 4, v22
    v_add_u32 v7, s36, v7
    s_add_u32 s16, s62, 0x100000
    s_addc_u32 s17, s63, 0
    s_mov_b32 s18, 0x7e000
    s_mov_b32 s19, 0x20000
    v_lshlrev_b32 v12, 11, v23
    v_lshl_add_u32 v12, v22, 4, v12
    s_lshl_b32 s39, s38, 13
    s_lshl_b32 s36, s37, 8
    s_add_u32 s39, s39, s36
    s_add_u32 s40, s39, 16384
    s_lshl_b32 s36, s29, 1
    s_lshr_b32 s53, s36, 3
    s_lshl_b32 s53, s53, 14
    s_and_b32 s41, s36, 7
    s_lshl_b32 s41, s41, 10
    s_add_u32 s41, s41, s53
    s_lshl_b32 s36, s37, 16
    s_add_u32 s41, s41, s36
    s_mov_b32 s53, 0
    s_mov_b32 s49, s44
    ds_read_b64_tr_b16 v[56:57], v13 offset:0
    ds_read_b64_tr_b16 v[58:59], v13 offset:2048
    ds_read_b64_tr_b16 v[60:61], v14 offset:0
    ds_read_b64_tr_b16 v[62:63], v14 offset:2048
    ds_read_b64_tr_b16 v[64:65], v15 offset:0
    ds_read_b64_tr_b16 v[66:67], v15 offset:2048
    ds_read_b64_tr_b16 v[68:69], v16 offset:0
    ds_read_b64_tr_b16 v[70:71], v16 offset:2048
    ds_read_b64_tr_b16 v[72:73], v13 offset:4096
    ds_read_b64_tr_b16 v[74:75], v13 offset:6144
    ds_read_b64_tr_b16 v[76:77], v14 offset:4096
    ds_read_b64_tr_b16 v[78:79], v14 offset:6144
    ds_read_b64_tr_b16 v[80:81], v15 offset:4096
    ds_read_b64_tr_b16 v[82:83], v15 offset:6144
    ds_read_b64_tr_b16 v[84:85], v16 offset:4096
    ds_read_b64_tr_b16 v[86:87], v16 offset:6144
dm_22p:
    buffer_load_dwordx4 v[164:167], v126, s[8:11], s44 offen offset:0 sc1
    buffer_load_dwordx4 v[168:171], v127, s[8:11], s44 offen offset:0 sc1
    buffer_load_dwordx4 v[172:175], v126, s[8:11], s44 offen offset:1024 sc1
    buffer_load_dwordx4 v[176:179], v127, s[8:11], s44 offen offset:1024 sc1
    buffer_load_dwordx4 v[180:183], v126, s[8:11], s44 offen offset:2048 sc1
    buffer_load_dwordx4 v[184:187], v127, s[8:11], s44 offen offset:2048 sc1
    buffer_load_dwordx4 v[188:191], v126, s[8:11], s44 offen offset:3072 sc1
    buffer_load_dwordx4 v[192:195], v127, s[8:11], s44 offen offset:3072 sc1
dm_22w:
    s_waitcnt vmcnt(4)
    v_or3_b32 v17, v164, v168, v172
    v_bitop3_b32 v17, v17, v176, 1 bitop3:0xa8
    v_cmp_ne_u32 vcc, 0, v17
    s_cbranch_vccz dm_22q
dm_22r:
    s_sleep 2
    buffer_load_dwordx4 v[164:167], v126, s[8:11], s44 offen offset:0 sc1
    buffer_load_dwordx4 v[168:171], v127, s[8:11], s44 offen offset:0 sc1
    buffer_load_dwordx4 v[172:175], v126, s[8:11], s44 offen offset:1024 sc1
    buffer_load_dwordx4 v[176:179], v127, s[8:11], s44 offen offset:1024 sc1
    buffer_load_dwordx4 v[180:183], v126, s[8:11], s44 offen offset:2048 sc1
    buffer_load_dwordx4 v[184:187], v127, s[8:11], s44 offen offset:2048 sc1
    buffer_load_dwordx4 v[188:191], v126, s[8:11], s44 offen offset:3072 sc1
    buffer_load_dwordx4 v[192:195], v127, s[8:11], s44 offen offset:3072 sc1
    s_waitcnt vmcnt(4)
    v_or3_b32 v17, v164, v168, v172
    v_bitop3_b32 v17, v17, v176, 1 bitop3:0xa8
    v_cmp_ne_u32 vcc, 0, v17
    s_cbranch_vccz dm_22t
    s_add_u32 s53, s53, 1
    s_cmp_lt_u32 s53, s61
    s_cbranch_scc1 dm_22r
    s_mov_b32 s61, 0
    s_branch dm_22t
dm_22q:
dm_22t:
    buffer_load_dwordx4 v[196:199], v128, s[8:11], s44 offen offset:0 sc1
    buffer_load_dwordx4 v[200:203], v129, s[8:11], s44 offen offset:0 sc1
    buffer_load_dwordx4 v[204:207], v128, s[8:11], s44 offen offset:1024 sc1
    buffer_load_dwordx4 v[208:211], v129, s[8:11], s44 offen offset:1024 sc1
    buffer_load_dwordx4 v[212:215], v128, s[8:11], s44 offen offset:2048 sc1
    buffer_load_dwordx4 v[216:219], v129, s[8:11], s44 offen offset:2048 sc1
    s_waitcnt lgkmcnt(0)
dm_22:
    v_mfma_f32_16x16x32_bf16 v[24:27], v[56:59], v[164:167], v[24:27]
    ds_read_b64_tr_b16 v[88:89], v13 offset:8192
    buffer_load_dwordx4 v[220:223], v128, s[8:11], s44 offen offset:3072 sc1
    v_mfma_f32_16x16x32_bf16 v[40:43], v[56:59], v[168:171], v[40:43]
    ds_read_b64_tr_b16 v[90:91], v13 offset:10240
    buffer_load_dwordx4 v[224:227], v129, s[8:11], s44 offen offset:3072 sc1
    v_mfma_f32_16x16x32_bf16 v[44:47], v[60:63], v[168:171], v[44:47]
    ds_read_b64_tr_b16 v[92:93], v14 offset:8192
    s_mov_b32 s44, s45
    v_mfma_f32_16x16x32_bf16 v[28:31], v[60:63], v[164:167], v[28:31]
    ds_read_b64_tr_b16 v[94:95], v14 offset:10240
    s_mov_b32 s45, s46
    v_mfma_f32_16x16x32_bf16 v[32:35], v[64:67], v[164:167], v[32:35]
    ds_read_b64_tr_b16 v[96:97], v15 offset:8192
    s_mov_b32 s46, s47
    v_mfma_f32_16x16x32_bf16 v[48:51], v[64:67], v[168:171], v[48:51]
    ds_read_b64_tr_b16 v[98:99], v15 offset:10240
    s_mov_b32 s47, 1048576
    v_mfma_f32_16x16x32_bf16 v[52:55], v[68:71], v[168:171], v[52:55]
    ds_read_b64_tr_b16 v[100:101], v16 offset:8192
    v_mfma_f32_16x16x32_bf16 v[36:39], v[68:71], v[164:167], v[36:39]
    ds_read_b64_tr_b16 v[102:103], v16 offset:10240
    s_waitcnt lgkmcnt(8)
    v_mfma_f32_16x16x32_bf16 v[24:27], v[72:75], v[172:175], v[24:27]
    ds_read_b64_tr_b16 v[104:105], v13 offset:12288
    buffer_load_dwordx4 v[164:167], v126, s[8:11], s44 offen offset:0 sc1
    v_mfma_f32_16x16x32_bf16 v[40:43], v[72:75], v[176:179], v[40:43]
    ds_read_b64_tr_b16 v[106:107], v13 offset:14336
    buffer_load_dwordx4 v[168:171], v127, s[8:11], s44 offen offset:0 sc1
    v_mfma_f32_16x16x32_bf16 v[44:47], v[76:79], v[176:179], v[44:47]
    ds_read_b64_tr_b16 v[108:109], v14 offset:12288
    s_waitcnt vmcnt(10)
    v_mfma_f32_16x16x32_bf16 v[28:31], v[76:79], v[172:175], v[28:31]
    ds_read_b64_tr_b16 v[110:111], v14 offset:14336
    v_or3_b32 v17, v180, v184, v188
    v_mfma_f32_16x16x32_bf16 v[32:35], v[80:83], v[172:175], v[32:35]
    ds_read_b64_tr_b16 v[112:113], v15 offset:12288
    v_bitop3_b32 v17, v17, v192, 1 bitop3:0xa8
    v_mfma_f32_16x16x32_bf16 v[48:51], v[80:83], v[176:179], v[48:51]
    ds_read_b64_tr_b16 v[114:115], v15 offset:14336
    v_cmp_ne_u32 vcc, 0, v17
    v_mfma_f32_16x16x32_bf16 v[52:55], v[84:87], v[176:179], v[52:55]
    ds_read_b64_tr_b16 v[116:117], v16 offset:12288
    ds_read_b64_tr_b16 v[118:119], v16 offset:14336
    v_mfma_f32_16x16x32_bf16 v[36:39], v[84:87], v[172:175], v[36:39]
    s_waitcnt lgkmcnt(8)
    s_cbranch_vccnz dm_22f0
dm_22g0:
    v_mfma_f32_16x16x32_bf16 v[24:27], v[88:91], v[180:183], v[24:27]
    ds_read_b64_tr_b16 v[56:57], v13 offset:16384
    buffer_load_dwordx4 v[172:175], v126, s[8:11], s44 offen offset:1024 sc1
    v_mfma_f32_16x16x32_bf16 v[40:43], v[88:91], v[184:187], v[40:43]
    ds_read_b64_tr_b16 v[58:59], v13 offset:18432
    buffer_load_dwordx4 v[176:179], v127, s[8:11], s44 offen offset:1024 sc1
    v_mfma_f32_16x16x32_bf16 v[44:47], v[92:95], v[184:187], v[44:47]
    ds_read_b64_tr_b16 v[60:61], v14 offset:16384
    v_mfma_f32_16x16x32_bf16 v[28:31], v[92:95], v[180:183], v[28:31]
    ds_read_b64_tr_b16 v[62:63], v14 offset:18432
    v_mfma_f32_16x16x32_bf16 v[32:35], v[96:99], v[180:183], v[32:35]
    ds_read_b64_tr_b16 v[64:65], v15 offset:16384
    v_mfma_f32_16x16x32_bf16 v[48:51], v[96:99], v[184:187], v[48:51]
    ds_read_b64_tr_b16 v[66:67], v15 offset:18432
    v_mfma_f32_16x16x32_bf16 v[52:55], v[100:103], v[184:187], v[52:55]
    ds_read_b64_tr_b16 v[68:69], v16 offset:16384
    v_mfma_f32_16x16x32_bf16 v[36:39], v[100:103], v[180:183], v[36:39]
    ds_read_b64_tr_b16 v[70:71], v16 offset:18432
    s_waitcnt lgkmcnt(8)
    v_mfma_f32_16x16x32_bf16 v[24:27], v[104:107], v[188:191], v[24:27]
    ds_read_b64_tr_b16 v[72:73], v13 offset:20480
    buffer_load_dwordx4 v[180:183], v126, s[8:11], s44 offen offset:2048 sc1
    v_mfma_f32_16x16x32_bf16 v[40:43], v[104:107], v[192:195], v[40:43]
    ds_read_b64_tr_b16 v[74:75], v13 offset:22528
    buffer_load_dwordx4 v[184:187], v127, s[8:11], s44 offen offset:2048 sc1
    v_mfma_f32_16x16x32_bf16 v[44:47], v[108:111], v[192:195], v[44:47]
    ds_read_b64_tr_b16 v[76:77], v14 offset:20480
    s_waitcnt vmcnt(10)
    v_mfma_f32_16x16x32_bf16 v[28:31], v[108:111], v[188:191], v[28:31]
    ds_read_b64_tr_b16 v[78:79], v14 offset:22528
    v_or3_b32 v17, v196, v200, v204
    v_mfma_f32_16x16x32_bf16 v[32:35], v[112:115], v[188:191], v[32:35]
    ds_read_b64_tr_b16 v[80:81], v15 offset:20480
    v_bitop3_b32 v17, v17, v208, 1 bitop3:0xa8
    v_mfma_f32_16x16x32_bf16 v[48:51], v[112:115], v[192:195], v[48:51]
    ds_read_b64_tr_b16 v[82:83], v15 offset:22528
    v_cmp_ne_u32 vcc, 0, v17
    v_mfma_f32_16x16x32_bf16 v[52:55], v[116:119], v[192:195], v[52:55]
    ds_read_b64_tr_b16 v[84:85], v16 offset:20480
    ds_read_b64_tr_b16 v[86:87], v16 offset:22528
    v_mfma_f32_16x16x32_bf16 v[36:39], v[116:119], v[188:191], v[36:39]
    s_waitcnt lgkmcnt(8)
    s_cbranch_vccnz dm_22f1
dm_22g1:
    v_mfma_f32_16x16x32_bf16 v[24:27], v[56:59], v[196:199], v[24:27]
    ds_read_b64_tr_b16 v[88:89], v13 offset:24576
    buffer_load_dwordx4 v[188:191], v126, s[8:11], s44 offen offset:3072 sc1
    v_mfma_f32_16x16x32_bf16 v[40:43], v[56:59], v[200:203], v[40:43]
    ds_read_b64_tr_b16 v[90:91], v13 offset:26624
    buffer_load_dwordx4 v[192:195], v127, s[8:11], s44 offen offset:3072 sc1
    v_mfma_f32_16x16x32_bf16 v[44:47], v[60:63], v[200:203], v[44:47]
    ds_read_b64_tr_b16 v[92:93], v14 offset:24576
    v_mfma_f32_16x16x32_bf16 v[28:31], v[60:63], v[196:199], v[28:31]
    ds_read_b64_tr_b16 v[94:95], v14 offset:26624
    v_mfma_f32_16x16x32_bf16 v[32:35], v[64:67], v[196:199], v[32:35]
    ds_read_b64_tr_b16 v[96:97], v15 offset:24576
    s_add_u32 s43, s43, 1
    v_mfma_f32_16x16x32_bf16 v[48:51], v[64:67], v[200:203], v[48:51]
    ds_read_b64_tr_b16 v[98:99], v15 offset:26624
    v_mfma_f32_16x16x32_bf16 v[52:55], v[68:71], v[200:203], v[52:55]
    ds_read_b64_tr_b16 v[100:101], v16 offset:24576
    v_mfma_f32_16x16x32_bf16 v[36:39], v[68:71], v[196:199], v[36:39]
    ds_read_b64_tr_b16 v[102:103], v16 offset:26624
    s_waitcnt lgkmcnt(8)
    v_mfma_f32_16x16x32_bf16 v[24:27], v[72:75], v[204:207], v[24:27]
    ds_read_b64_tr_b16 v[104:105], v13 offset:28672
    buffer_load_dwordx4 v[196:199], v128, s[8:11], s44 offen offset:0 sc1
    v_mfma_f32_16x16x32_bf16 v[40:43], v[72:75], v[208:211], v[40:43]
    ds_read_b64_tr_b16 v[106:107], v13 offset:30720
    buffer_load_dwordx4 v[200:203], v129, s[8:11], s44 offen offset:0 sc1
    v_mfma_f32_16x16x32_bf16 v[44:47], v[76:79], v[208:211], v[44:47]
    ds_read_b64_tr_b16 v[108:109], v14 offset:28672
    s_waitcnt vmcnt(10)
    v_mfma_f32_16x16x32_bf16 v[28:31], v[76:79], v[204:207], v[28:31]
    ds_read_b64_tr_b16 v[110:111], v14 offset:30720
    v_add_u32 v13, 32768, v13
    v_or3_b32 v17, v212, v216, v220
    v_mfma_f32_16x16x32_bf16 v[32:35], v[80:83], v[204:207], v[32:35]
    ds_read_b64_tr_b16 v[112:113], v15 offset:28672
    v_add_u32 v14, 32768, v14
    v_bitop3_b32 v17, v17, v224, 1 bitop3:0xa8
    v_mfma_f32_16x16x32_bf16 v[48:51], v[80:83], v[208:211], v[48:51]
    ds_read_b64_tr_b16 v[114:115], v15 offset:30720
    v_add_u32 v15, 32768, v15
    v_cmp_ne_u32 vcc, 0, v17
    v_mfma_f32_16x16x32_bf16 v[52:55], v[84:87], v[208:211], v[52:55]
    ds_read_b64_tr_b16 v[116:117], v16 offset:28672
    ds_read_b64_tr_b16 v[118:119], v16 offset:30720
    v_mfma_f32_16x16x32_bf16 v[36:39], v[84:87], v[204:207], v[36:39]
    v_add_u32 v16, 32768, v16
    s_waitcnt lgkmcnt(8)
    s_cbranch_vccnz dm_22f2
dm_22g2:
    v_mfma_f32_16x16x32_bf16 v[24:27], v[88:91], v[212:215], v[24:27]
    ds_read_b64_tr_b16 v[56:57], v13 offset:0
    buffer_load_dwordx4 v[204:207], v128, s[8:11], s44 offen offset:1024 sc1
    v_mfma_f32_16x16x32_bf16 v[40:43], v[88:91], v[216:219], v[40:43]
    ds_read_b64_tr_b16 v[58:59], v13 offset:2048
    buffer_load_dwordx4 v[208:211], v129, s[8:11], s44 offen offset:1024 sc1
    v_mfma_f32_16x16x32_bf16 v[44:47], v[92:95], v[216:219], v[44:47]
    ds_read_b64_tr_b16 v[60:61], v14 offset:0
    s_mov_b32 s49, s44
    v_mfma_f32_16x16x32_bf16 v[28:31], v[92:95], v[212:215], v[28:31]
    ds_read_b64_tr_b16 v[62:63], v14 offset:2048
    v_mfma_f32_16x16x32_bf16 v[32:35], v[96:99], v[212:215], v[32:35]
    ds_read_b64_tr_b16 v[64:65], v15 offset:0
    v_mfma_f32_16x16x32_bf16 v[48:51], v[96:99], v[216:219], v[48:51]
    ds_read_b64_tr_b16 v[66:67], v15 offset:2048
    v_mfma_f32_16x16x32_bf16 v[52:55], v[100:103], v[216:219], v[52:55]
    ds_read_b64_tr_b16 v[68:69], v16 offset:0
    v_mfma_f32_16x16x32_bf16 v[36:39], v[100:103], v[212:215], v[36:39]
    ds_read_b64_tr_b16 v[70:71], v16 offset:2048
    s_waitcnt lgkmcnt(8)
    v_mfma_f32_16x16x32_bf16 v[24:27], v[104:107], v[220:223], v[24:27]
    ds_read_b64_tr_b16 v[72:73], v13 offset:4096
    buffer_load_dwordx4 v[212:215], v128, s[8:11], s44 offen offset:2048 sc1
    v_mfma_f32_16x16x32_bf16 v[40:43], v[104:107], v[224:227], v[40:43]
    ds_read_b64_tr_b16 v[74:75], v13 offset:6144
    buffer_load_dwordx4 v[216:219], v129, s[8:11], s44 offen offset:2048 sc1
    v_mfma_f32_16x16x32_bf16 v[44:47], v[108:111], v[224:227], v[44:47]
    ds_read_b64_tr_b16 v[76:77], v14 offset:4096
    s_waitcnt vmcnt(10)
    v_mfma_f32_16x16x32_bf16 v[28:31], v[108:111], v[220:223], v[28:31]
    ds_read_b64_tr_b16 v[78:79], v14 offset:6144
    v_or3_b32 v17, v164, v168, v172
    v_mfma_f32_16x16x32_bf16 v[32:35], v[112:115], v[220:223], v[32:35]
    ds_read_b64_tr_b16 v[80:81], v15 offset:4096
    v_bitop3_b32 v17, v17, v176, 1 bitop3:0xa8
    v_mfma_f32_16x16x32_bf16 v[48:51], v[112:115], v[224:227], v[48:51]
    ds_read_b64_tr_b16 v[82:83], v15 offset:6144
    v_cmp_ne_u32 vcc, 0, v17
    v_mfma_f32_16x16x32_bf16 v[52:55], v[116:119], v[224:227], v[52:55]
    ds_read_b64_tr_b16 v[84:85], v16 offset:4096
    ds_read_b64_tr_b16 v[86:87], v16 offset:6144
    s_cmp_lt_u32 s43, 3
    v_mfma_f32_16x16x32_bf16 v[36:39], v[116:119], v[220:223], v[36:39]
    s_waitcnt lgkmcnt(8)
    s_cbranch_vccnz dm_22f3
dm_22g3:
    s_cbranch_scc1 dm_22
    v_mfma_f32_16x16x32_bf16 v[24:27], v[56:59], v[164:167], v[24:27]
    ds_read_b64_tr_b16 v[88:89], v13 offset:8192
    buffer_load_dwordx4 v[220:223], v128, s[8:11], s44 offen offset:3072 sc1
    v_mfma_f32_16x16x32_bf16 v[40:43], v[56:59], v[168:171], v[40:43]
    ds_read_b64_tr_b16 v[90:91], v13 offset:10240
    buffer_load_dwordx4 v[224:227], v129, s[8:11], s44 offen offset:3072 sc1
    v_mfma_f32_16x16x32_bf16 v[44:47], v[60:63], v[168:171], v[44:47]
    ds_read_b64_tr_b16 v[92:93], v14 offset:8192
    v_mfma_f32_16x16x32_bf16 v[28:31], v[60:63], v[164:167], v[28:31]
    ds_read_b64_tr_b16 v[94:95], v14 offset:10240
    ds_add_u32 v18, v19
    v_mfma_f32_16x16x32_bf16 v[32:35], v[64:67], v[164:167], v[32:35]
    ds_read_b64_tr_b16 v[96:97], v15 offset:8192
    v_mfma_f32_16x16x32_bf16 v[48:51], v[64:67], v[168:171], v[48:51]
    ds_read_b64_tr_b16 v[98:99], v15 offset:10240
    v_mfma_f32_16x16x32_bf16 v[52:55], v[68:71], v[168:171], v[52:55]
    ds_read_b64_tr_b16 v[100:101], v16 offset:8192
    v_mfma_f32_16x16x32_bf16 v[36:39], v[68:71], v[164:167], v[36:39]
    ds_read_b64_tr_b16 v[102:103], v16 offset:10240
    s_waitcnt lgkmcnt(9)
    v_mfma_f32_16x16x32_bf16 v[24:27], v[72:75], v[172:175], v[24:27]
    ds_read_b64_tr_b16 v[104:105], v13 offset:12288
    v_mfma_f32_16x16x32_bf16 v[40:43], v[72:75], v[176:179], v[40:43]
    ds_read_b64_tr_b16 v[106:107], v13 offset:14336
    v_mfma_f32_16x16x32_bf16 v[44:47], v[76:79], v[176:179], v[44:47]
    ds_read_b64_tr_b16 v[108:109], v14 offset:12288
    s_waitcnt vmcnt(8)
    v_mfma_f32_16x16x32_bf16 v[28:31], v[76:79], v[172:175], v[28:31]
    ds_read_b64_tr_b16 v[110:111], v14 offset:14336
    v_or3_b32 v17, v180, v184, v188
    v_mfma_f32_16x16x32_bf16 v[32:35], v[80:83], v[172:175], v[32:35]
    ds_read_b64_tr_b16 v[112:113], v15 offset:12288
    v_bitop3_b32 v17, v17, v192, 1 bitop3:0xa8
    v_mfma_f32_16x16x32_bf16 v[48:51], v[80:83], v[176:179], v[48:51]
    ds_read_b64_tr_b16 v[114:115], v15 offset:14336
    v_cmp_ne_u32 vcc, 0, v17
    v_mfma_f32_16x16x32_bf16 v[52:55], v[84:87], v[176:179], v[52:55]
    ds_read_b64_tr_b16 v[116:117], v16 offset:12288
    ds_read_b64_tr_b16 v[118:119], v16 offset:14336
    v_mfma_f32_16x16x32_bf16 v[36:39], v[84:87], v[172:175], v[36:39]
    s_waitcnt lgkmcnt(8)
    s_cbranch_vccnz dm_22m0
dm_22n0:
    v_mfma_f32_16x16x32_bf16 v[24:27], v[88:91], v[180:183], v[24:27]
    ds_read_b64_tr_b16 v[56:57], v13 offset:16384
    v_mfma_f32_16x16x32_bf16 v[40:43], v[88:91], v[184:187], v[40:43]
    ds_read_b64_tr_b16 v[58:59], v13 offset:18432
    v_mfma_f32_16x16x32_bf16 v[44:47], v[92:95], v[184:187], v[44:47]
    ds_read_b64_tr_b16 v[60:61], v14 offset:16384
    v_mfma_f32_16x16x32_bf16 v[28:31], v[92:95], v[180:183], v[28:31]
    ds_read_b64_tr_b16 v[62:63], v14 offset:18432
    v_mfma_f32_16x16x32_bf16 v[32:35], v[96:99], v[180:183], v[32:35]
    ds_read_b64_tr_b16 v[64:65], v15 offset:16384
    v_mfma_f32_16x16x32_bf16 v[48:51], v[96:99], v[184:187], v[48:51]
    ds_read_b64_tr_b16 v[66:67], v15 offset:18432
    v_mfma_f32_16x16x32_bf16 v[52:55], v[100:103], v[184:187], v[52:55]
    ds_read_b64_tr_b16 v[68:69], v16 offset:16384
    v_mfma_f32_16x16x32_bf16 v[36:39], v[100:103], v[180:183], v[36:39]
    ds_read_b64_tr_b16 v[70:71], v16 offset:18432
    s_waitcnt lgkmcnt(8)
    v_mfma_f32_16x16x32_bf16 v[24:27], v[104:107], v[188:191], v[24:27]
    ds_read_b64_tr_b16 v[72:73], v13 offset:20480
    v_mfma_f32_16x16x32_bf16 v[40:43], v[104:107], v[192:195], v[40:43]
    ds_read_b64_tr_b16 v[74:75], v13 offset:22528
    v_mfma_f32_16x16x32_bf16 v[44:47], v[108:111], v[192:195], v[44:47]
    ds_read_b64_tr_b16 v[76:77], v14 offset:20480
    s_waitcnt vmcnt(4)
    v_mfma_f32_16x16x32_bf16 v[28:31], v[108:111], v[188:191], v[28:31]
    ds_read_b64_tr_b16 v[78:79], v14 offset:22528
    v_or3_b32 v17, v196, v200, v204
    v_mfma_f32_16x16x32_bf16 v[32:35], v[112:115], v[188:191], v[32:35]
    ds_read_b64_tr_b16 v[80:81], v15 offset:20480
    v_bitop3_b32 v17, v17, v208, 1 bitop3:0xa8
    v_mfma_f32_16x16x32_bf16 v[48:51], v[112:115], v[192:195], v[48:51]
    ds_read_b64_tr_b16 v[82:83], v15 offset:22528
    v_cmp_ne_u32 vcc, 0, v17
    v_mfma_f32_16x16x32_bf16 v[52:55], v[116:119], v[192:195], v[52:55]
    ds_read_b64_tr_b16 v[84:85], v16 offset:20480
    ds_read_b64_tr_b16 v[86:87], v16 offset:22528
    v_mfma_f32_16x16x32_bf16 v[36:39], v[116:119], v[188:191], v[36:39]
    s_waitcnt lgkmcnt(8)
    s_cbranch_vccnz dm_22m1
dm_22n1:
    v_mfma_f32_16x16x32_bf16 v[24:27], v[56:59], v[196:199], v[24:27]
    ds_read_b64_tr_b16 v[88:89], v13 offset:24576
    v_mfma_f32_16x16x32_bf16 v[40:43], v[56:59], v[200:203], v[40:43]
    ds_read_b64_tr_b16 v[90:91], v13 offset:26624
    v_mfma_f32_16x16x32_bf16 v[44:47], v[60:63], v[200:203], v[44:47]
    ds_read_b64_tr_b16 v[92:93], v14 offset:24576
    v_mfma_f32_16x16x32_bf16 v[28:31], v[60:63], v[196:199], v[28:31]
    ds_read_b64_tr_b16 v[94:95], v14 offset:26624
    v_mfma_f32_16x16x32_bf16 v[32:35], v[64:67], v[196:199], v[32:35]
    ds_read_b64_tr_b16 v[96:97], v15 offset:24576
    v_mfma_f32_16x16x32_bf16 v[48:51], v[64:67], v[200:203], v[48:51]
    ds_read_b64_tr_b16 v[98:99], v15 offset:26624
    v_mfma_f32_16x16x32_bf16 v[52:55], v[68:71], v[200:203], v[52:55]
    ds_read_b64_tr_b16 v[100:101], v16 offset:24576
    v_mfma_f32_16x16x32_bf16 v[36:39], v[68:71], v[196:199], v[36:39]
    ds_read_b64_tr_b16 v[102:103], v16 offset:26624
    s_waitcnt lgkmcnt(8)
    v_mfma_f32_16x16x32_bf16 v[24:27], v[72:75], v[204:207], v[24:27]
    ds_read_b64_tr_b16 v[104:105], v13 offset:28672
    v_mfma_f32_16x16x32_bf16 v[40:43], v[72:75], v[208:211], v[40:43]
    ds_read_b64_tr_b16 v[106:107], v13 offset:30720
    v_mfma_f32_16x16x32_bf16 v[44:47], v[76:79], v[208:211], v[44:47]
    ds_read_b64_tr_b16 v[108:109], v14 offset:28672
    s_waitcnt vmcnt(0)
    v_mfma_f32_16x16x32_bf16 v[28:31], v[76:79], v[204:207], v[28:31]
    ds_read_b64_tr_b16 v[110:111], v14 offset:30720
    v_or3_b32 v17, v212, v216, v220
    v_mfma_f32_16x16x32_bf16 v[32:35], v[80:83], v[204:207], v[32:35]
    ds_read_b64_tr_b16 v[112:113], v15 offset:28672
    v_bitop3_b32 v17, v17, v224, 1 bitop3:0xa8
    v_mfma_f32_16x16x32_bf16 v[48:51], v[80:83], v[208:211], v[48:51]
    ds_read_b64_tr_b16 v[114:115], v15 offset:30720
    v_cmp_ne_u32 vcc, 0, v17
    v_mfma_f32_16x16x32_bf16 v[52:55], v[84:87], v[208:211], v[52:55]
    ds_read_b64_tr_b16 v[116:117], v16 offset:28672
    ds_read_b64_tr_b16 v[118:119], v16 offset:30720
    v_mfma_f32_16x16x32_bf16 v[36:39], v[84:87], v[204:207], v[36:39]
    s_waitcnt lgkmcnt(8)
    s_cbranch_vccnz dm_22m2
dm_22n2:
dm_22x:
    v_mfma_f32_16x16x32_bf16 v[24:27], v[88:91], v[212:215], v[24:27]
    v_mfma_f32_16x16x32_bf16 v[40:43], v[88:91], v[216:219], v[40:43]
    v_mfma_f32_16x16x32_bf16 v[44:47], v[92:95], v[216:219], v[44:47]
    v_mfma_f32_16x16x32_bf16 v[28:31], v[92:95], v[212:215], v[28:31]
    v_mfma_f32_16x16x32_bf16 v[32:35], v[96:99], v[212:215], v[32:35]
    v_mfma_f32_16x16x32_bf16 v[48:51], v[96:99], v[216:219], v[48:51]
    v_mfma_f32_16x16x32_bf16 v[52:55], v[100:103], v[216:219], v[52:55]
    v_mfma_f32_16x16x32_bf16 v[36:39], v[100:103], v[212:215], v[36:39]
    s_waitcnt lgkmcnt(0)
    s_barrier
    v_mfma_f32_16x16x32_bf16 v[24:27], v[104:107], v[220:223], v[24:27]
    ds_read_b128 v[56:59], v6 offset:0
    v_mfma_f32_16x16x32_bf16 v[40:43], v[104:107], v[224:227], v[40:43]
    ds_read_b128 v[60:63], v6 offset:64
    v_mfma_f32_16x16x32_bf16 v[44:47], v[108:111], v[224:227], v[44:47]
    ds_read_b128 v[64:67], v6 offset:128
    v_mfma_f32_16x16x32_bf16 v[28:31], v[108:111], v[220:223], v[28:31]
    ds_read_b128 v[68:71], v6 offset:192
    v_mfma_f32_16x16x32_bf16 v[32:35], v[112:115], v[220:223], v[32:35]
    ds_read_b64 v[72:73], v7 offset:0
    v_mfma_f32_16x16x32_bf16 v[48:51], v[112:115], v[224:227], v[48:51]
    ds_read_b64 v[74:75], v7 offset:256
    v_mfma_f32_16x16x32_bf16 v[52:55], v[116:119], v[224:227], v[52:55]
    v_mfma_f32_16x16x32_bf16 v[36:39], v[116:119], v[220:223], v[36:39]
    s_waitcnt lgkmcnt(0)
    v_mul_f32 v134, 0xc0135761, v73
    v_mul_f32 v135, v73, v73
    v_mul_f32 v135, v135, v134
    v_mul_f32 v135, 0x3d372713, v135
    v_rcp_f32 v73, v73
    v_mul_f32 v136, 0xc0135761, v75
    v_mul_f32 v137, v75, v75
    v_mul_f32 v137, v137, v136
    v_mul_f32 v137, 0x3d372713, v137
    v_rcp_f32 v75, v75
    v_pk_fma_f32 v[24:25], v[72:73], v[56:57], v[24:25] op_sel_hi:[0,1,1] neg_lo:[1,0,0] neg_hi:[1,0,0]
    v_pk_fma_f32 v[26:27], v[72:73], v[58:59], v[26:27] op_sel_hi:[0,1,1] neg_lo:[1,0,0] neg_hi:[1,0,0]
    v_pk_mul_f32 v[122:123], v[24:25], v[24:25]
    v_pk_mul_f32 v[124:125], v[26:27], v[26:27]
    v_pk_fma_f32 v[122:123], v[122:123], v[134:135], v[134:135] op_sel:[0,1,0] op_sel_hi:[1,1,0]
    v_pk_fma_f32 v[124:125], v[124:125], v[134:135], v[134:135] op_sel:[0,1,0] op_sel_hi:[1,1,0]
    v_pk_mul_f32 v[122:123], v[122:123], v[24:25]
    v_pk_mul_f32 v[124:125], v[124:125], v[26:27]
    v_exp_f32 v122, v122
    v_exp_f32 v123, v123
    v_exp_f32 v124, v124
    v_exp_f32 v125, v125
    v_pk_fma_f32 v[122:123], v[122:123], v[72:73], v[72:73] op_sel:[0,1,1] op_sel_hi:[1,1,1]
    v_pk_fma_f32 v[124:125], v[124:125], v[72:73], v[72:73] op_sel:[0,1,1] op_sel_hi:[1,1,1]
    v_rcp_f32 v122, v122
    v_rcp_f32 v123, v123
    v_rcp_f32 v124, v124
    v_rcp_f32 v125, v125
    v_pk_mul_f32 v[24:25], v[24:25], v[122:123]
    v_pk_mul_f32 v[26:27], v[26:27], v[124:125]
    v_pk_fma_f32 v[28:29], v[72:73], v[60:61], v[28:29] op_sel_hi:[0,1,1] neg_lo:[1,0,0] neg_hi:[1,0,0]
    v_pk_fma_f32 v[30:31], v[72:73], v[62:63], v[30:31] op_sel_hi:[0,1,1] neg_lo:[1,0,0] neg_hi:[1,0,0]
    v_pk_mul_f32 v[122:123], v[28:29], v[28:29]
    v_pk_mul_f32 v[124:125], v[30:31], v[30:31]
    v_pk_fma_f32 v[122:123], v[122:123], v[134:135], v[134:135] op_sel:[0,1,0] op_sel_hi:[1,1,0]
    v_pk_fma_f32 v[124:125], v[124:125], v[134:135], v[134:135] op_sel:[0,1,0] op_sel_hi:[1,1,0]
    v_pk_mul_f32 v[122:123], v[122:123], v[28:29]
    v_pk_mul_f32 v[124:125], v[124:125], v[30:31]
    v_exp_f32 v122, v122
    v_exp_f32 v123, v123
    v_exp_f32 v124, v124
    v_exp_f32 v125, v125
    v_pk_fma_f32 v[122:123], v[122:123], v[72:73], v[72:73] op_sel:[0,1,1] op_sel_hi:[1,1,1]
    v_pk_fma_f32 v[124:125], v[124:125], v[72:73], v[72:73] op_sel:[0,1,1] op_sel_hi:[1,1,1]
    v_rcp_f32 v122, v122
    v_rcp_f32 v123, v123
    v_rcp_f32 v124, v124
    v_rcp_f32 v125, v125
    v_pk_mul_f32 v[28:29], v[28:29], v[122:123]
    v_pk_mul_f32 v[30:31], v[30:31], v[124:125]
    v_cvt_pk_bf16_f32 v24, v24, v25
    v_cvt_pk_bf16_f32 v25, v26, v27
    v_cvt_pk_bf16_f32 v26, v28, v29
    v_cvt_pk_bf16_f32 v27, v30, v31
    v_and_b32 v24, -2, v24
    buffer_store_dwordx4 v[24:27], v12, s[16:19], s39 offen offset:0 sc1
    v_pk_fma_f32 v[40:41], v[74:75], v[56:57], v[40:41] op_sel_hi:[0,1,1] neg_lo:[1,0,0] neg_hi:[1,0,0]
    v_pk_fma_f32 v[42:43], v[74:75], v[58:59], v[42:43] op_sel_hi:[0,1,1] neg_lo:[1,0,0] neg_hi:[1,0,0]
    v_pk_mul_f32 v[122:123], v[40:41], v[40:41]
    v_pk_mul_f32 v[124:125], v[42:43], v[42:43]
    v_pk_fma_f32 v[122:123], v[122:123], v[136:137], v[136:137] op_sel:[0,1,0] op_sel_hi:[1,1,0]
    v_pk_fma_f32 v[124:125], v[124:125], v[136:137], v[136:137] op_sel:[0,1,0] op_sel_hi:[1,1,0]
    v_pk_mul_f32 v[122:123], v[122:123], v[40:41]
    v_pk_mul_f32 v[124:125], v[124:125], v[42:43]
    v_exp_f32 v122, v122
    v_exp_f32 v123, v123
    v_exp_f32 v124, v124
    v_exp_f32 v125, v125
    v_pk_fma_f32 v[122:123], v[122:123], v[74:75], v[74:75] op_sel:[0,1,1] op_sel_hi:[1,1,1]
    v_pk_fma_f32 v[124:125], v[124:125], v[74:75], v[74:75] op_sel:[0,1,1] op_sel_hi:[1,1,1]
    v_rcp_f32 v122, v122
    v_rcp_f32 v123, v123
    v_rcp_f32 v124, v124
    v_rcp_f32 v125, v125
    v_pk_mul_f32 v[40:41], v[40:41], v[122:123]
    v_pk_mul_f32 v[42:43], v[42:43], v[124:125]
    v_pk_fma_f32 v[44:45], v[74:75], v[60:61], v[44:45] op_sel_hi:[0,1,1] neg_lo:[1,0,0] neg_hi:[1,0,0]
    v_pk_fma_f32 v[46:47], v[74:75], v[62:63], v[46:47] op_sel_hi:[0,1,1] neg_lo:[1,0,0] neg_hi:[1,0,0]
    v_pk_mul_f32 v[122:123], v[44:45], v[44:45]
    v_pk_mul_f32 v[124:125], v[46:47], v[46:47]
    v_pk_fma_f32 v[122:123], v[122:123], v[136:137], v[136:137] op_sel:[0,1,0] op_sel_hi:[1,1,0]
    v_pk_fma_f32 v[124:125], v[124:125], v[136:137], v[136:137] op_sel:[0,1,0] op_sel_hi:[1,1,0]
    v_pk_mul_f32 v[122:123], v[122:123], v[44:45]
    v_pk_mul_f32 v[124:125], v[124:125], v[46:47]
    v_exp_f32 v122, v122
    v_exp_f32 v123, v123
    v_exp_f32 v124, v124
    v_exp_f32 v125, v125
    v_pk_fma_f32 v[122:123], v[122:123], v[74:75], v[74:75] op_sel:[0,1,1] op_sel_hi:[1,1,1]
    v_pk_fma_f32 v[124:125], v[124:125], v[74:75], v[74:75] op_sel:[0,1,1] op_sel_hi:[1,1,1]
    v_rcp_f32 v122, v122
    v_rcp_f32 v123, v123
    v_rcp_f32 v124, v124
    v_rcp_f32 v125, v125
    v_pk_mul_f32 v[44:45], v[44:45], v[122:123]
    v_pk_mul_f32 v[46:47], v[46:47], v[124:125]
    v_cvt_pk_bf16_f32 v40, v40, v41
    v_cvt_pk_bf16_f32 v41, v42, v43
    v_cvt_pk_bf16_f32 v42, v44, v45
    v_cvt_pk_bf16_f32 v43, v46, v47
    v_and_b32 v40, -2, v40
    buffer_store_dwordx4 v[40:43], v12, s[16:19], s39 offen offset:256 sc1
    v_pk_fma_f32 v[32:33], v[72:73], v[64:65], v[32:33] op_sel_hi:[0,1,1] neg_lo:[1,0,0] neg_hi:[1,0,0]
    v_pk_fma_f32 v[34:35], v[72:73], v[66:67], v[34:35] op_sel_hi:[0,1,1] neg_lo:[1,0,0] neg_hi:[1,0,0]
    v_pk_mul_f32 v[122:123], v[32:33], v[32:33]
    v_pk_mul_f32 v[124:125], v[34:35], v[34:35]
    v_pk_fma_f32 v[122:123], v[122:123], v[134:135], v[134:135] op_sel:[0,1,0] op_sel_hi:[1,1,0]
    v_pk_fma_f32 v[124:125], v[124:125], v[134:135], v[134:135] op_sel:[0,1,0] op_sel_hi:[1,1,0]
    v_pk_mul_f32 v[122:123], v[122:123], v[32:33]
    v_pk_mul_f32 v[124:125], v[124:125], v[34:35]
    v_exp_f32 v122, v122
    v_exp_f32 v123, v123
    v_exp_f32 v124, v124
    v_exp_f32 v125, v125
    v_pk_fma_f32 v[122:123], v[122:123], v[72:73], v[72:73] op_sel:[0,1,1] op_sel_hi:[1,1,1]
    v_pk_fma_f32 v[124:125], v[124:125], v[72:73], v[72:73] op_sel:[0,1,1] op_sel_hi:[1,1,1]
    v_rcp_f32 v122, v122
    v_rcp_f32 v123, v123
    v_rcp_f32 v124, v124
    v_rcp_f32 v125, v125
    v_pk_mul_f32 v[32:33], v[32:33], v[122:123]
    v_pk_mul_f32 v[34:35], v[34:35], v[124:125]
    v_pk_fma_f32 v[36:37], v[72:73], v[68:69], v[36:37] op_sel_hi:[0,1,1] neg_lo:[1,0,0] neg_hi:[1,0,0]
    v_pk_fma_f32 v[38:39], v[72:73], v[70:71], v[38:39] op_sel_hi:[0,1,1] neg_lo:[1,0,0] neg_hi:[1,0,0]
    v_pk_mul_f32 v[122:123], v[36:37], v[36:37]
    v_pk_mul_f32 v[124:125], v[38:39], v[38:39]
    v_pk_fma_f32 v[122:123], v[122:123], v[134:135], v[134:135] op_sel:[0,1,0] op_sel_hi:[1,1,0]
    v_pk_fma_f32 v[124:125], v[124:125], v[134:135], v[134:135] op_sel:[0,1,0] op_sel_hi:[1,1,0]
    v_pk_mul_f32 v[122:123], v[122:123], v[36:37]
    v_pk_mul_f32 v[124:125], v[124:125], v[38:39]
    v_exp_f32 v122, v122
    v_exp_f32 v123, v123
    v_exp_f32 v124, v124
    v_exp_f32 v125, v125
    v_pk_fma_f32 v[122:123], v[122:123], v[72:73], v[72:73] op_sel:[0,1,1] op_sel_hi:[1,1,1]
    v_pk_fma_f32 v[124:125], v[124:125], v[72:73], v[72:73] op_sel:[0,1,1] op_sel_hi:[1,1,1]
    v_rcp_f32 v122, v122
    v_rcp_f32 v123, v123
    v_rcp_f32 v124, v124
    v_rcp_f32 v125, v125
    v_pk_mul_f32 v[36:37], v[36:37], v[122:123]
    v_pk_mul_f32 v[38:39], v[38:39], v[124:125]
    v_cvt_pk_bf16_f32 v32, v32, v33
    v_cvt_pk_bf16_f32 v33, v34, v35
    v_cvt_pk_bf16_f32 v34, v36, v37
    v_cvt_pk_bf16_f32 v35, v38, v39
    v_and_b32 v32, -2, v32
    buffer_store_dwordx4 v[32:35], v12, s[16:19], s40 offen offset:0 sc1
    buffer_load_dwordx4 v[148:151], v126, s[8:11], s41 offen offset:0 sc1
    buffer_load_dwordx4 v[152:155], v126, s[8:11], s41 offen offset:1024 sc1
    buffer_load_dwordx4 v[156:159], v127, s[8:11], s41 offen offset:0 sc1
    buffer_load_dwordx4 v[160:163], v127, s[8:11], s41 offen offset:1024 sc1
    v_pk_fma_f32 v[48:49], v[74:75], v[64:65], v[48:49] op_sel_hi:[0,1,1] neg_lo:[1,0,0] neg_hi:[1,0,0]
    v_pk_fma_f32 v[50:51], v[74:75], v[66:67], v[50:51] op_sel_hi:[0,1,1] neg_lo:[1,0,0] neg_hi:[1,0,0]
    v_pk_mul_f32 v[122:123], v[48:49], v[48:49]
    v_pk_mul_f32 v[124:125], v[50:51], v[50:51]
    v_pk_fma_f32 v[122:123], v[122:123], v[136:137], v[136:137] op_sel:[0,1,0] op_sel_hi:[1,1,0]
    v_pk_fma_f32 v[124:125], v[124:125], v[136:137], v[136:137] op_sel:[0,1,0] op_sel_hi:[1,1,0]
    v_pk_mul_f32 v[122:123], v[122:123], v[48:49]
    v_pk_mul_f32 v[124:125], v[124:125], v[50:51]
    v_exp_f32 v122, v122
    v_exp_f32 v123, v123
    v_exp_f32 v124, v124
    v_exp_f32 v125, v125
    v_pk_fma_f32 v[122:123], v[122:123], v[74:75], v[74:75] op_sel:[0,1,1] op_sel_hi:[1,1,1]
    v_pk_fma_f32 v[124:125], v[124:125], v[74:75], v[74:75] op_sel:[0,1,1] op_sel_hi:[1,1,1]
    v_rcp_f32 v122, v122
    v_rcp_f32 v123, v123
    v_rcp_f32 v124, v124
    v_rcp_f32 v125, v125
    v_pk_mul_f32 v[48:49], v[48:49], v[122:123]
    v_pk_mul_f32 v[50:51], v[50:51], v[124:125]
    v_pk_fma_f32 v[52:53], v[74:75], v[68:69], v[52:53] op_sel_hi:[0,1,1] neg_lo:[1,0,0] neg_hi:[1,0,0]
    v_pk_fma_f32 v[54:55], v[74:75], v[70:71], v[54:55] op_sel_hi:[0,1,1] neg_lo:[1,0,0] neg_hi:[1,0,0]
    v_pk_mul_f32 v[122:123], v[52:53], v[52:53]
    v_pk_mul_f32 v[124:125], v[54:55], v[54:55]
    v_pk_fma_f32 v[122:123], v[122:123], v[136:137], v[136:137] op_sel:[0,1,0] op_sel_hi:[1,1,0]
    v_pk_fma_f32 v[124:125], v[124:125], v[136:137], v[136:137] op_sel:[0,1,0] op_sel_hi:[1,1,0]
    v_pk_mul_f32 v[122:123], v[122:123], v[52:53]
    v_pk_mul_f32 v[124:125], v[124:125], v[54:55]
    v_exp_f32 v122, v122
    v_exp_f32 v123, v123
    v_exp_f32 v124, v124
    v_exp_f32 v125, v125
    v_pk_fma_f32 v[122:123], v[122:123], v[74:75], v[74:75] op_sel:[0,1,1] op_sel_hi:[1,1,1]
    v_pk_fma_f32 v[124:125], v[124:125], v[74:75], v[74:75] op_sel:[0,1,1] op_sel_hi:[1,1,1]
    v_rcp_f32 v122, v122
    v_rcp_f32 v123, v123
    v_rcp_f32 v124, v124
    v_rcp_f32 v125, v125
    v_pk_mul_f32 v[52:53], v[52:53], v[122:123]
    v_pk_mul_f32 v[54:55], v[54:55], v[124:125]
    v_cvt_pk_bf16_f32 v48, v48, v49
    v_cvt_pk_bf16_f32 v49, v50, v51
    v_cvt_pk_bf16_f32 v50, v52, v53
    v_cvt_pk_bf16_f32 v51, v54, v55
    v_and_b32 v48, -2, v48
    buffer_store_dwordx4 v[48:51], v12, s[16:19], s40 offen offset:256 sc1
    s_add_u32 s8, s4, 0x2100000
    s_addc_u32 s9, s5, 0
    s_mov_b32 s10, 0x8400000
    s_mov_b32 s11, 0x20000
    s_sub_u32 s47, s55, 39583744
    s_lshl_b32 s46, s30, 9
    s_add_u32 s47, s47, s46
    s_add_u32 s45, s92, 2048
    s_cmp_eq_u32 s28, 0
    s_cselect_b32 s45, 1073741824, s45
    s_cmp_eq_u32 s30, 0
    s_cselect_b32 s45, s45, 0
    s_add_u32 s53, s47, 0xfffffff0
    v_add_u32 v126, s53, v12
    v_add_u32 v127, 256, v126
    v_add_u32 v134, s45, v126
    v_cmp_gt_u32 vcc, 1, v22
    s_nop 1
    v_cndmask_b32 v126, v126, v134, vcc
    s_mov_b32 s34, s30
    s_mov_b32 s35, 0
    v_and_b32 v22, 15, v1
    v_lshrrev_b32 v23, 4, v1
    s_mul_i32 s37, s34, 2
    s_mul_i32 s38, s29, 4
    s_mul_i32 s36, s35, 4
    s_add_u32 s38, s38, s36
    s_lshr_b32 s36, s38, 1
    s_lshr_b32 s53, s36, 3
    s_lshl_b32 s53, s53, 14
    s_and_b32 s39, s36, 7
    s_lshl_b32 s39, s39, 10
    s_add_u32 s39, s39, s53
    s_lshl_b32 s36, s37, 16
    s_add_u32 s39, s39, s36
    s_sub_u32 s46, s93, 2048
    s_cmp_eq_u32 s28, 15
    s_cselect_b32 s46, 1073741824, s46
    s_cmp_eq_u32 s30, 3
    s_cselect_b32 s46, s46, 0
    s_add_u32 s53, s47, 0x10
    v_add_u32 v128, s53, v12
    v_add_u32 v129, 256, v128
    v_add_u32 v134, s46, v129
    v_cmp_le_u32 vcc, 15, v22
    s_nop 1
    v_cndmask_b32 v129, v129, v134, vcc
    s_add_u32 s53, s47, 0xffffffe0
    v_add_u32 v130, s53, v12
    v_add_u32 v131, 256, v130
    v_add_u32 v134, s45, v130
    v_cmp_gt_u32 vcc, 2, v22
    s_nop 1
    v_cndmask_b32 v130, v130, v134, vcc
    s_add_u32 s53, s47, 0x20
    v_add_u32 v132, s53, v12
    v_add_u32 v133, 256, v132
    v_add_u32 v134, s46, v133
    v_cmp_le_u32 vcc, 14, v22
    s_nop 1
    v_cndmask_b32 v133, v133, v134, vcc
    v_mov_b32 v134, v126
    v_mov_b32 v135, v127
    v_lshrrev_b32 v6, 2, v1
    v_mul_u32_u24 v13, 128, v6
    v_and_b32 v7, 3, v1
    v_lshl_add_u32 v13, v7, 3, v13
    v_add_u32 v13, 0, v13
    v_bfe_u32 v6, v6, 1, 2
    s_mul_i32 s36, s35, 4
    s_add_u32 s36, s36, 3
    v_xor_b32 v7, s36, v6
    v_lshl_add_u32 v16, v7, 5, v13
    s_mul_i32 s36, s35, 4
    s_add_u32 s36, s36, 2
    v_xor_b32 v7, s36, v6
    v_lshl_add_u32 v15, v7, 5, v13
    s_mul_i32 s36, s35, 4
    s_add_u32 s36, s36, 1
    v_xor_b32 v7, s36, v6
    v_lshl_add_u32 v14, v7, 5, v13
    s_mul_i32 s36, s35, 4
    s_add_u32 s36, s36, 0
    v_xor_b32 v7, s36, v6
    v_lshl_add_u32 v13, v7, 5, v13
    s_lshl_b32 s36, s37, 8
    s_add_u32 s36, s36, 160768
    v_lshlrev_b32 v7, 4, v22
    v_add_u32 v7, s36, v7
    ds_read_b64 v[56:57], v7 offset:0
    ds_read_b64 v[58:59], v7 offset:256
    s_waitcnt vmcnt(1) lgkmcnt(0)
    s_sleep 4
    s_cmp_lg_u32 s60, 0
    s_cbranch_scc1 G2_nd
    s_sleep 2
G2_nd:
    s_mov_b32 s44, 0
    buffer_load_dwordx4 v[164:167], v126, s[8:11], s44 offen sc1
    buffer_load_dwordx4 v[168:171], v127, s[8:11], s44 offen sc1
    s_add_u32 s44, s44, 16384
    buffer_load_dwordx4 v[172:175], v126, s[8:11], s44 offen sc1
    buffer_load_dwordx4 v[176:179], v127, s[8:11], s44 offen sc1
    s_add_u32 s44, s44, 16384
    buffer_load_dwordx4 v[180:183], v126, s[8:11], s44 offen
    buffer_load_dwordx4 v[184:187], v127, s[8:11], s44 offen
    s_add_u32 s44, s44, 16384
    buffer_load_dwordx4 v[188:191], v126, s[8:11], s44 offen
    buffer_load_dwordx4 v[192:195], v127, s[8:11], s44 offen
    s_add_u32 s44, s44, 16384
    v_lshlrev_b32 v24, 16, v148
    v_and_b32 v25, 0xffff0000, v148
    v_pk_add_f32 v[24:25], v[24:25], v[56:57] op_sel_hi:[1,0] neg_lo:[0,1] neg_hi:[0,1]
    v_pk_mul_f32 v[24:25], v[24:25], v[56:57] op_sel:[0,1] op_sel_hi:[1,1]
    v_lshlrev_b32 v26, 16, v149
    v_and_b32 v27, 0xffff0000, v149
    v_pk_add_f32 v[26:27], v[26:27], v[56:57] op_sel_hi:[1,0] neg_lo:[0,1] neg_hi:[0,1]
    v_pk_mul_f32 v[26:27], v[26:27], v[56:57] op_sel:[0,1] op_sel_hi:[1,1]
    v_lshlrev_b32 v28, 16, v150
    v_and_b32 v29, 0xffff0000, v150
    v_pk_add_f32 v[28:29], v[28:29], v[56:57] op_sel_hi:[1,0] neg_lo:[0,1] neg_hi:[0,1]
    v_pk_mul_f32 v[28:29], v[28:29], v[56:57] op_sel:[0,1] op_sel_hi:[1,1]
    v_lshlrev_b32 v30, 16, v151
    v_and_b32 v31, 0xffff0000, v151
    v_pk_add_f32 v[30:31], v[30:31], v[56:57] op_sel_hi:[1,0] neg_lo:[0,1] neg_hi:[0,1]
    v_pk_mul_f32 v[30:31], v[30:31], v[56:57] op_sel:[0,1] op_sel_hi:[1,1]
    v_lshlrev_b32 v32, 16, v152
    v_and_b32 v33, 0xffff0000, v152
    v_pk_add_f32 v[32:33], v[32:33], v[56:57] op_sel_hi:[1,0] neg_lo:[0,1] neg_hi:[0,1]
    v_pk_mul_f32 v[32:33], v[32:33], v[56:57] op_sel:[0,1] op_sel_hi:[1,1]
    v_lshlrev_b32 v34, 16, v153
    v_and_b32 v35, 0xffff0000, v153
    v_pk_add_f32 v[34:35], v[34:35], v[56:57] op_sel_hi:[1,0] neg_lo:[0,1] neg_hi:[0,1]
    v_pk_mul_f32 v[34:35], v[34:35], v[56:57] op_sel:[0,1] op_sel_hi:[1,1]
    v_lshlrev_b32 v36, 16, v154
    v_and_b32 v37, 0xffff0000, v154
    v_pk_add_f32 v[36:37], v[36:37], v[56:57] op_sel_hi:[1,0] neg_lo:[0,1] neg_hi:[0,1]
    v_pk_mul_f32 v[36:37], v[36:37], v[56:57] op_sel:[0,1] op_sel_hi:[1,1]
    v_lshlrev_b32 v38, 16, v155
    v_and_b32 v39, 0xffff0000, v155
    v_pk_add_f32 v[38:39], v[38:39], v[56:57] op_sel_hi:[1,0] neg_lo:[0,1] neg_hi:[0,1]
    v_pk_mul_f32 v[38:39], v[38:39], v[56:57] op_sel:[0,1] op_sel_hi:[1,1]
    v_lshlrev_b32 v40, 16, v156
    v_and_b32 v41, 0xffff0000, v156
    v_pk_add_f32 v[40:41], v[40:41], v[58:59] op_sel_hi:[1,0] neg_lo:[0,1] neg_hi:[0,1]
    v_pk_mul_f32 v[40:41], v[40:41], v[58:59] op_sel:[0,1] op_sel_hi:[1,1]
    v_lshlrev_b32 v42, 16, v157
    v_and_b32 v43, 0xffff0000, v157
    v_pk_add_f32 v[42:43], v[42:43], v[58:59] op_sel_hi:[1,0] neg_lo:[0,1] neg_hi:[0,1]
    v_pk_mul_f32 v[42:43], v[42:43], v[58:59] op_sel:[0,1] op_sel_hi:[1,1]
    v_lshlrev_b32 v44, 16, v158
    v_and_b32 v45, 0xffff0000, v158
    v_pk_add_f32 v[44:45], v[44:45], v[58:59] op_sel_hi:[1,0] neg_lo:[0,1] neg_hi:[0,1]
    v_pk_mul_f32 v[44:45], v[44:45], v[58:59] op_sel:[0,1] op_sel_hi:[1,1]
    v_lshlrev_b32 v46, 16, v159
    v_and_b32 v47, 0xffff0000, v159
    v_pk_add_f32 v[46:47], v[46:47], v[58:59] op_sel_hi:[1,0] neg_lo:[0,1] neg_hi:[0,1]
    v_pk_mul_f32 v[46:47], v[46:47], v[58:59] op_sel:[0,1] op_sel_hi:[1,1]
    v_lshlrev_b32 v48, 16, v160
    v_and_b32 v49, 0xffff0000, v160
    v_pk_add_f32 v[48:49], v[48:49], v[58:59] op_sel_hi:[1,0] neg_lo:[0,1] neg_hi:[0,1]
    v_pk_mul_f32 v[48:49], v[48:49], v[58:59] op_sel:[0,1] op_sel_hi:[1,1]
    v_lshlrev_b32 v50, 16, v161
    v_and_b32 v51, 0xffff0000, v161
    v_pk_add_f32 v[50:51], v[50:51], v[58:59] op_sel_hi:[1,0] neg_lo:[0,1] neg_hi:[0,1]
    v_pk_mul_f32 v[50:51], v[50:51], v[58:59] op_sel:[0,1] op_sel_hi:[1,1]
    v_lshlrev_b32 v52, 16, v162
    v_and_b32 v53, 0xffff0000, v162
    v_pk_add_f32 v[52:53], v[52:53], v[58:59] op_sel_hi:[1,0] neg_lo:[0,1] neg_hi:[0,1]
    v_pk_mul_f32 v[52:53], v[52:53], v[58:59] op_sel:[0,1] op_sel_hi:[1,1]
    v_lshlrev_b32 v54, 16, v163
    v_and_b32 v55, 0xffff0000, v163
    v_pk_add_f32 v[54:55], v[54:55], v[58:59] op_sel_hi:[1,0] neg_lo:[0,1] neg_hi:[0,1]
    v_pk_mul_f32 v[54:55], v[54:55], v[58:59] op_sel:[0,1] op_sel_hi:[1,1]
    s_mov_b32 s43, 0
    s_add_u32 s16, s62, 0x80000
    s_addc_u32 s17, s63, 0
    s_mov_b32 s18, 0x7e000
    s_mov_b32 s19, 0x20000
    s_mov_b32 s53, 0
    s_mov_b32 s49, s44
    buffer_load_dwordx4 v[196:199], v126, s[8:11], s44 offen
    buffer_load_dwordx4 v[200:203], v127, s[8:11], s44 offen
    s_add_u32 s44, s44, 16384
    buffer_load_dwordx4 v[204:207], v126, s[8:11], s44 offen
    buffer_load_dwordx4 v[208:211], v127, s[8:11], s44 offen
    s_add_u32 s44, s44, 16384
    buffer_load_dwordx4 v[212:215], v126, s[8:11], s44 offen
    buffer_load_dwordx4 v[216:219], v127, s[8:11], s44 offen
    s_add_u32 s44, s44, 16384
    s_barrier
    ds_read_b64_tr_b16 v[56:57], v13 offset:0
    ds_read_b64_tr_b16 v[58:59], v13 offset:2048
    ds_read_b64_tr_b16 v[60:61], v14 offset:0
    ds_read_b64_tr_b16 v[62:63], v14 offset:2048
    ds_read_b64_tr_b16 v[64:65], v15 offset:0
    ds_read_b64_tr_b16 v[66:67], v15 offset:2048
    ds_read_b64_tr_b16 v[68:69], v16 offset:0
    ds_read_b64_tr_b16 v[70:71], v16 offset:2048
    ds_read_b64_tr_b16 v[72:73], v13 offset:4096
    ds_read_b64_tr_b16 v[74:75], v13 offset:6144
    ds_read_b64_tr_b16 v[76:77], v14 offset:4096
    ds_read_b64_tr_b16 v[78:79], v14 offset:6144
    ds_read_b64_tr_b16 v[80:81], v15 offset:4096
    ds_read_b64_tr_b16 v[82:83], v15 offset:6144
    ds_read_b64_tr_b16 v[84:85], v16 offset:4096
    ds_read_b64_tr_b16 v[86:87], v16 offset:6144
    s_branch dm_23w
dm_23p:
    s_mov_b32 s44, 0
    buffer_load_dwordx4 v[164:167], v126, s[8:11], s44 offen sc1
    buffer_load_dwordx4 v[168:171], v127, s[8:11], s44 offen sc1
    s_add_u32 s44, s44, 16384
    buffer_load_dwordx4 v[172:175], v126, s[8:11], s44 offen sc1
    buffer_load_dwordx4 v[176:179], v127, s[8:11], s44 offen sc1
    s_add_u32 s44, s44, 16384
    buffer_load_dwordx4 v[180:183], v126, s[8:11], s44 offen
    buffer_load_dwordx4 v[184:187], v127, s[8:11], s44 offen
    s_add_u32 s44, s44, 16384
    buffer_load_dwordx4 v[188:191], v126, s[8:11], s44 offen
    buffer_load_dwordx4 v[192:195], v127, s[8:11], s44 offen
    s_add_u32 s44, s44, 16384
dm_23w:
    s_waitcnt vmcnt(10)
    v_or3_b32 v17, v164, v168, v172
    v_bitop3_b32 v17, v17, v176, 1 bitop3:0xa8
    v_cmp_ne_u32 vcc, 0, v17
    s_cbranch_vccz dm_23q
dm_23r:
    s_sleep 2
    s_mov_b32 s44, 0
    buffer_load_dwordx4 v[164:167], v126, s[8:11], s44 offen sc1
    buffer_load_dwordx4 v[168:171], v127, s[8:11], s44 offen sc1
    s_add_u32 s44, s44, 16384
    buffer_load_dwordx4 v[172:175], v126, s[8:11], s44 offen sc1
    buffer_load_dwordx4 v[176:179], v127, s[8:11], s44 offen sc1
    s_add_u32 s44, s44, 16384
    buffer_load_dwordx4 v[180:183], v126, s[8:11], s44 offen sc1
    buffer_load_dwordx4 v[184:187], v127, s[8:11], s44 offen sc1
    s_add_u32 s44, s44, 16384
    buffer_load_dwordx4 v[188:191], v126, s[8:11], s44 offen sc1
    buffer_load_dwordx4 v[192:195], v127, s[8:11], s44 offen sc1
    s_add_u32 s44, s44, 16384
    buffer_load_dwordx4 v[196:199], v126, s[8:11], s44 offen sc1
    buffer_load_dwordx4 v[200:203], v127, s[8:11], s44 offen sc1
    s_add_u32 s44, s44, 16384
    buffer_load_dwordx4 v[204:207], v126, s[8:11], s44 offen sc1
    buffer_load_dwordx4 v[208:211], v127, s[8:11], s44 offen sc1
    s_add_u32 s44, s44, 16384
    buffer_load_dwordx4 v[212:215], v126, s[8:11], s44 offen sc1
    buffer_load_dwordx4 v[216:219], v127, s[8:11], s44 offen sc1
    s_add_u32 s44, s44, 16384
    s_waitcnt vmcnt(10)
    v_or3_b32 v17, v164, v168, v172
    v_bitop3_b32 v17, v17, v176, 1 bitop3:0xa8
    v_cmp_ne_u32 vcc, 0, v17
    s_cbranch_vccz dm_23t
    s_add_u32 s53, s53, 1
    s_cmp_lt_u32 s53, s61
    s_cbranch_scc1 dm_23r
    s_mov_b32 s61, 0
    s_branch dm_23t
dm_23q:
dm_23t:
    s_waitcnt lgkmcnt(0)
dm_23:
    v_mfma_f32_16x16x32_bf16 v[24:27], v[56:59], v[164:167], v[24:27]
    ds_read_b64_tr_b16 v[88:89], v13 offset:8192
    buffer_load_dwordx4 v[220:223], v126, s[8:11], s44 offen
    v_mfma_f32_16x16x32_bf16 v[40:43], v[56:59], v[168:171], v[40:43]
    ds_read_b64_tr_b16 v[90:91], v13 offset:10240
    buffer_load_dwordx4 v[224:227], v127, s[8:11], s44 offen
    v_mfma_f32_16x16x32_bf16 v[44:47], v[60:63], v[168:171], v[44:47]
    ds_read_b64_tr_b16 v[92:93], v14 offset:8192
    s_add_u32 s44, s44, 16384
    v_mfma_f32_16x16x32_bf16 v[28:31], v[60:63], v[164:167], v[28:31]
    ds_read_b64_tr_b16 v[94:95], v14 offset:10240
    v_mov_b32 v126, v128
    v_mfma_f32_16x16x32_bf16 v[32:35], v[64:67], v[164:167], v[32:35]
    ds_read_b64_tr_b16 v[96:97], v15 offset:8192
    v_mov_b32 v127, v129
    v_mfma_f32_16x16x32_bf16 v[48:51], v[64:67], v[168:171], v[48:51]
    ds_read_b64_tr_b16 v[98:99], v15 offset:10240
    v_mov_b32 v128, v130
    v_mfma_f32_16x16x32_bf16 v[52:55], v[68:71], v[168:171], v[52:55]
    ds_read_b64_tr_b16 v[100:101], v16 offset:8192
    v_mov_b32 v129, v131
    v_mfma_f32_16x16x32_bf16 v[36:39], v[68:71], v[164:167], v[36:39]
    ds_read_b64_tr_b16 v[102:103], v16 offset:10240
    s_waitcnt lgkmcnt(8)
    v_mfma_f32_16x16x32_bf16 v[24:27], v[72:75], v[172:175], v[24:27]
    ds_read_b64_tr_b16 v[104:105], v13 offset:12288
    buffer_load_dwordx4 v[164:167], v126, s[8:11], s44 offen
    v_mfma_f32_16x16x32_bf16 v[40:43], v[72:75], v[176:179], v[40:43]
    ds_read_b64_tr_b16 v[106:107], v13 offset:14336
    buffer_load_dwordx4 v[168:171], v127, s[8:11], s44 offen
    v_mfma_f32_16x16x32_bf16 v[44:47], v[76:79], v[176:179], v[44:47]
    ds_read_b64_tr_b16 v[108:109], v14 offset:12288
    s_add_u32 s44, s44, 16384
    s_waitcnt vmcnt(10)
    v_mfma_f32_16x16x32_bf16 v[28:31], v[76:79], v[172:175], v[28:31]
    ds_read_b64_tr_b16 v[110:111], v14 offset:14336
    v_or3_b32 v17, v180, v184, v188
    v_mfma_f32_16x16x32_bf16 v[32:35], v[80:83], v[172:175], v[32:35]
    ds_read_b64_tr_b16 v[112:113], v15 offset:12288
    v_bitop3_b32 v17, v17, v192, 1 bitop3:0xa8
    v_mfma_f32_16x16x32_bf16 v[48:51], v[80:83], v[176:179], v[48:51]
    ds_read_b64_tr_b16 v[114:115], v15 offset:14336
    v_cmp_ne_u32 vcc, 0, v17
    v_mfma_f32_16x16x32_bf16 v[52:55], v[84:87], v[176:179], v[52:55]
    ds_read_b64_tr_b16 v[116:117], v16 offset:12288
    ds_read_b64_tr_b16 v[118:119], v16 offset:14336
    v_mfma_f32_16x16x32_bf16 v[36:39], v[84:87], v[172:175], v[36:39]
    s_waitcnt lgkmcnt(8)
    s_cbranch_vccnz dm_23f0
dm_23g0:
    v_mfma_f32_16x16x32_bf16 v[24:27], v[88:91], v[180:183], v[24:27]
    ds_read_b64_tr_b16 v[56:57], v13 offset:16384
    buffer_load_dwordx4 v[172:175], v126, s[8:11], s44 offen
    v_mfma_f32_16x16x32_bf16 v[40:43], v[88:91], v[184:187], v[40:43]
    ds_read_b64_tr_b16 v[58:59], v13 offset:18432
    buffer_load_dwordx4 v[176:179], v127, s[8:11], s44 offen
    v_mfma_f32_16x16x32_bf16 v[44:47], v[92:95], v[184:187], v[44:47]
    ds_read_b64_tr_b16 v[60:61], v14 offset:16384
    s_add_u32 s44, s44, 16384
    v_mfma_f32_16x16x32_bf16 v[28:31], v[92:95], v[180:183], v[28:31]
    ds_read_b64_tr_b16 v[62:63], v14 offset:18432
    v_mov_b32 v130, v132
    v_mfma_f32_16x16x32_bf16 v[32:35], v[96:99], v[180:183], v[32:35]
    ds_read_b64_tr_b16 v[64:65], v15 offset:16384
    v_mov_b32 v131, v133
    v_mfma_f32_16x16x32_bf16 v[48:51], v[96:99], v[184:187], v[48:51]
    ds_read_b64_tr_b16 v[66:67], v15 offset:18432
    v_mov_b32 v132, 1073741824
    v_mfma_f32_16x16x32_bf16 v[52:55], v[100:103], v[184:187], v[52:55]
    ds_read_b64_tr_b16 v[68:69], v16 offset:16384
    v_mov_b32 v133, 1073741824
    v_mfma_f32_16x16x32_bf16 v[36:39], v[100:103], v[180:183], v[36:39]
    ds_read_b64_tr_b16 v[70:71], v16 offset:18432
    s_waitcnt lgkmcnt(8)
    v_mfma_f32_16x16x32_bf16 v[24:27], v[104:107], v[188:191], v[24:27]
    ds_read_b64_tr_b16 v[72:73], v13 offset:20480
    buffer_load_dwordx4 v[180:183], v126, s[8:11], s44 offen
    v_mfma_f32_16x16x32_bf16 v[40:43], v[104:107], v[192:195], v[40:43]
    ds_read_b64_tr_b16 v[74:75], v13 offset:22528
    buffer_load_dwordx4 v[184:187], v127, s[8:11], s44 offen
    v_mfma_f32_16x16x32_bf16 v[44:47], v[108:111], v[192:195], v[44:47]
    ds_read_b64_tr_b16 v[76:77], v14 offset:20480
    s_add_u32 s44, s44, 16384
    s_waitcnt vmcnt(10)
    v_mfma_f32_16x16x32_bf16 v[28:31], v[108:111], v[188:191], v[28:31]
    ds_read_b64_tr_b16 v[78:79], v14 offset:22528
    v_or3_b32 v17, v196, v200, v204
    v_mfma_f32_16x16x32_bf16 v[32:35], v[112:115], v[188:191], v[32:35]
    ds_read_b64_tr_b16 v[80:81], v15 offset:20480
    v_bitop3_b32 v17, v17, v208, 1 bitop3:0xa8
    v_mfma_f32_16x16x32_bf16 v[48:51], v[112:115], v[192:195], v[48:51]
    ds_read_b64_tr_b16 v[82:83], v15 offset:22528
    v_cmp_ne_u32 vcc, 0, v17
    v_mfma_f32_16x16x32_bf16 v[52:55], v[116:119], v[192:195], v[52:55]
    ds_read_b64_tr_b16 v[84:85], v16 offset:20480
    ds_read_b64_tr_b16 v[86:87], v16 offset:22528
    v_mfma_f32_16x16x32_bf16 v[36:39], v[116:119], v[188:191], v[36:39]
    s_waitcnt lgkmcnt(8)
    s_cbranch_vccnz dm_23f1
dm_23g1:
    v_mfma_f32_16x16x32_bf16 v[24:27], v[56:59], v[196:199], v[24:27]
    ds_read_b64_tr_b16 v[88:89], v13 offset:24576
    buffer_load_dwordx4 v[188:191], v126, s[8:11], s44 offen
    v_mfma_f32_16x16x32_bf16 v[40:43], v[56:59], v[200:203], v[40:43]
    ds_read_b64_tr_b16 v[90:91], v13 offset:26624
    buffer_load_dwordx4 v[192:195], v127, s[8:11], s44 offen
    v_mfma_f32_16x16x32_bf16 v[44:47], v[60:63], v[200:203], v[44:47]
    ds_read_b64_tr_b16 v[92:93], v14 offset:24576
    s_add_u32 s44, s44, 16384
    v_mfma_f32_16x16x32_bf16 v[28:31], v[60:63], v[196:199], v[28:31]
    ds_read_b64_tr_b16 v[94:95], v14 offset:26624
    v_mfma_f32_16x16x32_bf16 v[32:35], v[64:67], v[196:199], v[32:35]
    ds_read_b64_tr_b16 v[96:97], v15 offset:24576
    s_add_u32 s43, s43, 1
    v_mfma_f32_16x16x32_bf16 v[48:51], v[64:67], v[200:203], v[48:51]
    ds_read_b64_tr_b16 v[98:99], v15 offset:26624
    v_mfma_f32_16x16x32_bf16 v[52:55], v[68:71], v[200:203], v[52:55]
    ds_read_b64_tr_b16 v[100:101], v16 offset:24576
    v_mfma_f32_16x16x32_bf16 v[36:39], v[68:71], v[196:199], v[36:39]
    ds_read_b64_tr_b16 v[102:103], v16 offset:26624
    s_waitcnt lgkmcnt(8)
    v_mfma_f32_16x16x32_bf16 v[24:27], v[72:75], v[204:207], v[24:27]
    ds_read_b64_tr_b16 v[104:105], v13 offset:28672
    buffer_load_dwordx4 v[196:199], v126, s[8:11], s44 offen
    v_mfma_f32_16x16x32_bf16 v[40:43], v[72:75], v[208:211], v[40:43]
    ds_read_b64_tr_b16 v[106:107], v13 offset:30720
    buffer_load_dwordx4 v[200:203], v127, s[8:11], s44 offen
    v_mfma_f32_16x16x32_bf16 v[44:47], v[76:79], v[208:211], v[44:47]
    ds_read_b64_tr_b16 v[108:109], v14 offset:28672
    s_add_u32 s44, s44, 16384
    s_waitcnt vmcnt(10)
    v_mfma_f32_16x16x32_bf16 v[28:31], v[76:79], v[204:207], v[28:31]
    ds_read_b64_tr_b16 v[110:111], v14 offset:30720
    v_add_u32 v13, 32768, v13
    v_or3_b32 v17, v212, v216, v220
    v_mfma_f32_16x16x32_bf16 v[32:35], v[80:83], v[204:207], v[32:35]
    ds_read_b64_tr_b16 v[112:113], v15 offset:28672
    v_add_u32 v14, 32768, v14
    v_bitop3_b32 v17, v17, v224, 1 bitop3:0xa8
    v_mfma_f32_16x16x32_bf16 v[48:51], v[80:83], v[208:211], v[48:51]
    ds_read_b64_tr_b16 v[114:115], v15 offset:30720
    v_add_u32 v15, 32768, v15
    v_cmp_ne_u32 vcc, 0, v17
    v_mfma_f32_16x16x32_bf16 v[52:55], v[84:87], v[208:211], v[52:55]
    ds_read_b64_tr_b16 v[116:117], v16 offset:28672
    ds_read_b64_tr_b16 v[118:119], v16 offset:30720
    v_mfma_f32_16x16x32_bf16 v[36:39], v[84:87], v[204:207], v[36:39]
    v_add_u32 v16, 32768, v16
    s_waitcnt lgkmcnt(8)
    s_cbranch_vccnz dm_23f2
dm_23g2:
    v_mfma_f32_16x16x32_bf16 v[24:27], v[88:91], v[212:215], v[24:27]
    ds_read_b64_tr_b16 v[56:57], v13 offset:0
    buffer_load_dwordx4 v[204:207], v126, s[8:11], s44 offen
    v_mfma_f32_16x16x32_bf16 v[40:43], v[88:91], v[216:219], v[40:43]
    ds_read_b64_tr_b16 v[58:59], v13 offset:2048
    buffer_load_dwordx4 v[208:211], v127, s[8:11], s44 offen
    v_mfma_f32_16x16x32_bf16 v[44:47], v[92:95], v[216:219], v[44:47]
    ds_read_b64_tr_b16 v[60:61], v14 offset:0
    s_add_u32 s44, s44, 16384
    v_mfma_f32_16x16x32_bf16 v[28:31], v[92:95], v[212:215], v[28:31]
    ds_read_b64_tr_b16 v[62:63], v14 offset:2048
    v_mov_b32 v134, v126
    v_mfma_f32_16x16x32_bf16 v[32:35], v[96:99], v[212:215], v[32:35]
    ds_read_b64_tr_b16 v[64:65], v15 offset:0
    v_mov_b32 v135, v127
    v_mfma_f32_16x16x32_bf16 v[48:51], v[96:99], v[216:219], v[48:51]
    ds_read_b64_tr_b16 v[66:67], v15 offset:2048
    v_mfma_f32_16x16x32_bf16 v[52:55], v[100:103], v[216:219], v[52:55]
    ds_read_b64_tr_b16 v[68:69], v16 offset:0
    v_mfma_f32_16x16x32_bf16 v[36:39], v[100:103], v[212:215], v[36:39]
    ds_read_b64_tr_b16 v[70:71], v16 offset:2048
    s_waitcnt lgkmcnt(8)
    v_mfma_f32_16x16x32_bf16 v[24:27], v[104:107], v[220:223], v[24:27]
    ds_read_b64_tr_b16 v[72:73], v13 offset:4096
    buffer_load_dwordx4 v[212:215], v126, s[8:11], s44 offen
    v_mfma_f32_16x16x32_bf16 v[40:43], v[104:107], v[224:227], v[40:43]
    ds_read_b64_tr_b16 v[74:75], v13 offset:6144
    buffer_load_dwordx4 v[216:219], v127, s[8:11], s44 offen
    v_mfma_f32_16x16x32_bf16 v[44:47], v[108:111], v[224:227], v[44:47]
    ds_read_b64_tr_b16 v[76:77], v14 offset:4096
    s_add_u32 s44, s44, 16384
    s_waitcnt vmcnt(10)
    v_mfma_f32_16x16x32_bf16 v[28:31], v[108:111], v[220:223], v[28:31]
    ds_read_b64_tr_b16 v[78:79], v14 offset:6144
    v_or3_b32 v17, v164, v168, v172
    v_mfma_f32_16x16x32_bf16 v[32:35], v[112:115], v[220:223], v[32:35]
    ds_read_b64_tr_b16 v[80:81], v15 offset:4096
    v_bitop3_b32 v17, v17, v176, 1 bitop3:0xa8
    v_mfma_f32_16x16x32_bf16 v[48:51], v[112:115], v[224:227], v[48:51]
    ds_read_b64_tr_b16 v[82:83], v15 offset:6144
    v_cmp_ne_u32 vcc, 0, v17
    v_mfma_f32_16x16x32_bf16 v[52:55], v[116:119], v[224:227], v[52:55]
    ds_read_b64_tr_b16 v[84:85], v16 offset:4096
    ds_read_b64_tr_b16 v[86:87], v16 offset:6144
    s_cmp_lt_u32 s43, 3
    v_mfma_f32_16x16x32_bf16 v[36:39], v[116:119], v[220:223], v[36:39]
    s_waitcnt lgkmcnt(8)
    s_cbranch_vccnz dm_23f3
dm_23g3:
    s_cbranch_scc1 dm_23
    v_mfma_f32_16x16x32_bf16 v[24:27], v[56:59], v[164:167], v[24:27]
    ds_read_b64_tr_b16 v[88:89], v13 offset:8192
    buffer_load_dwordx4 v[220:223], v126, s[8:11], s44 offen
    v_mfma_f32_16x16x32_bf16 v[40:43], v[56:59], v[168:171], v[40:43]
    ds_read_b64_tr_b16 v[90:91], v13 offset:10240
    buffer_load_dwordx4 v[224:227], v127, s[8:11], s44 offen
    v_mfma_f32_16x16x32_bf16 v[44:47], v[60:63], v[168:171], v[44:47]
    ds_read_b64_tr_b16 v[92:93], v14 offset:8192
    v_mfma_f32_16x16x32_bf16 v[28:31], v[60:63], v[164:167], v[28:31]
    ds_read_b64_tr_b16 v[94:95], v14 offset:10240
    v_mfma_f32_16x16x32_bf16 v[32:35], v[64:67], v[164:167], v[32:35]
    ds_read_b64_tr_b16 v[96:97], v15 offset:8192
    v_mfma_f32_16x16x32_bf16 v[48:51], v[64:67], v[168:171], v[48:51]
    ds_read_b64_tr_b16 v[98:99], v15 offset:10240
    v_mfma_f32_16x16x32_bf16 v[52:55], v[68:71], v[168:171], v[52:55]
    ds_read_b64_tr_b16 v[100:101], v16 offset:8192
    v_mfma_f32_16x16x32_bf16 v[36:39], v[68:71], v[164:167], v[36:39]
    ds_read_b64_tr_b16 v[102:103], v16 offset:10240
    s_waitcnt lgkmcnt(8)
    v_mfma_f32_16x16x32_bf16 v[24:27], v[72:75], v[172:175], v[24:27]
    ds_read_b64_tr_b16 v[104:105], v13 offset:12288
    v_mfma_f32_16x16x32_bf16 v[40:43], v[72:75], v[176:179], v[40:43]
    ds_read_b64_tr_b16 v[106:107], v13 offset:14336
    v_mfma_f32_16x16x32_bf16 v[44:47], v[76:79], v[176:179], v[44:47]
    ds_read_b64_tr_b16 v[108:109], v14 offset:12288
    s_waitcnt vmcnt(8)
    v_mfma_f32_16x16x32_bf16 v[28:31], v[76:79], v[172:175], v[28:31]
    ds_read_b64_tr_b16 v[110:111], v14 offset:14336
    v_or3_b32 v17, v180, v184, v188
    v_mfma_f32_16x16x32_bf16 v[32:35], v[80:83], v[172:175], v[32:35]
    ds_read_b64_tr_b16 v[112:113], v15 offset:12288
    v_bitop3_b32 v17, v17, v192, 1 bitop3:0xa8
    v_mfma_f32_16x16x32_bf16 v[48:51], v[80:83], v[176:179], v[48:51]
    ds_read_b64_tr_b16 v[114:115], v15 offset:14336
    v_cmp_ne_u32 vcc, 0, v17
    v_mfma_f32_16x16x32_bf16 v[52:55], v[84:87], v[176:179], v[52:55]
    ds_read_b64_tr_b16 v[116:117], v16 offset:12288
    ds_read_b64_tr_b16 v[118:119], v16 offset:14336
    v_mfma_f32_16x16x32_bf16 v[36:39], v[84:87], v[172:175], v[36:39]
    s_waitcnt lgkmcnt(8)
    s_cbranch_vccnz dm_23m0
dm_23n0:
    v_mfma_f32_16x16x32_bf16 v[24:27], v[88:91], v[180:183], v[24:27]
    ds_read_b64_tr_b16 v[56:57], v13 offset:16384
    v_mfma_f32_16x16x32_bf16 v[40:43], v[88:91], v[184:187], v[40:43]
    ds_read_b64_tr_b16 v[58:59], v13 offset:18432
    v_mfma_f32_16x16x32_bf16 v[44:47], v[92:95], v[184:187], v[44:47]
    ds_read_b64_tr_b16 v[60:61], v14 offset:16384
    v_mfma_f32_16x16x32_bf16 v[28:31], v[92:95], v[180:183], v[28:31]
    ds_read_b64_tr_b16 v[62:63], v14 offset:18432
    v_mfma_f32_16x16x32_bf16 v[32:35], v[96:99], v[180:183], v[32:35]
    ds_read_b64_tr_b16 v[64:65], v15 offset:16384
    v_mfma_f32_16x16x32_bf16 v[48:51], v[96:99], v[184:187], v[48:51]
    ds_read_b64_tr_b16 v[66:67], v15 offset:18432
    v_mfma_f32_16x16x32_bf16 v[52:55], v[100:103], v[184:187], v[52:55]
    ds_read_b64_tr_b16 v[68:69], v16 offset:16384
    v_mfma_f32_16x16x32_bf16 v[36:39], v[100:103], v[180:183], v[36:39]
    ds_read_b64_tr_b16 v[70:71], v16 offset:18432
    s_waitcnt lgkmcnt(8)
    v_mfma_f32_16x16x32_bf16 v[24:27], v[104:107], v[188:191], v[24:27]
    ds_read_b64_tr_b16 v[72:73], v13 offset:20480
    v_mfma_f32_16x16x32_bf16 v[40:43], v[104:107], v[192:195], v[40:43]
    ds_read_b64_tr_b16 v[74:75], v13 offset:22528
    v_mfma_f32_16x16x32_bf16 v[44:47], v[108:111], v[192:195], v[44:47]
    ds_read_b64_tr_b16 v[76:77], v14 offset:20480
    s_waitcnt vmcnt(4)
    v_mfma_f32_16x16x32_bf16 v[28:31], v[108:111], v[188:191], v[28:31]
    ds_read_b64_tr_b16 v[78:79], v14 offset:22528
    v_or3_b32 v17, v196, v200, v204
    v_mfma_f32_16x16x32_bf16 v[32:35], v[112:115], v[188:191], v[32:35]
    ds_read_b64_tr_b16 v[80:81], v15 offset:20480
    v_bitop3_b32 v17, v17, v208, 1 bitop3:0xa8
    v_mfma_f32_16x16x32_bf16 v[48:51], v[112:115], v[192:195], v[48:51]
    ds_read_b64_tr_b16 v[82:83], v15 offset:22528
    v_cmp_ne_u32 vcc, 0, v17
    v_mfma_f32_16x16x32_bf16 v[52:55], v[116:119], v[192:195], v[52:55]
    ds_read_b64_tr_b16 v[84:85], v16 offset:20480
    ds_read_b64_tr_b16 v[86:87], v16 offset:22528
    v_mfma_f32_16x16x32_bf16 v[36:39], v[116:119], v[188:191], v[36:39]
    s_waitcnt lgkmcnt(8)
    s_cbranch_vccnz dm_23m1
dm_23n1:
    v_mfma_f32_16x16x32_bf16 v[24:27], v[56:59], v[196:199], v[24:27]
    ds_read_b64_tr_b16 v[88:89], v13 offset:24576
    v_mfma_f32_16x16x32_bf16 v[40:43], v[56:59], v[200:203], v[40:43]
    ds_read_b64_tr_b16 v[90:91], v13 offset:26624
    v_mfma_f32_16x16x32_bf16 v[44:47], v[60:63], v[200:203], v[44:47]
    ds_read_b64_tr_b16 v[92:93], v14 offset:24576
    v_mfma_f32_16x16x32_bf16 v[28:31], v[60:63], v[196:199], v[28:31]
    ds_read_b64_tr_b16 v[94:95], v14 offset:26624
    v_mfma_f32_16x16x32_bf16 v[32:35], v[64:67], v[196:199], v[32:35]
    ds_read_b64_tr_b16 v[96:97], v15 offset:24576
    v_mfma_f32_16x16x32_bf16 v[48:51], v[64:67], v[200:203], v[48:51]
    ds_read_b64_tr_b16 v[98:99], v15 offset:26624
    v_mfma_f32_16x16x32_bf16 v[52:55], v[68:71], v[200:203], v[52:55]
    ds_read_b64_tr_b16 v[100:101], v16 offset:24576
    v_mfma_f32_16x16x32_bf16 v[36:39], v[68:71], v[196:199], v[36:39]
    ds_read_b64_tr_b16 v[102:103], v16 offset:26624
    s_waitcnt lgkmcnt(8)
    v_mfma_f32_16x16x32_bf16 v[24:27], v[72:75], v[204:207], v[24:27]
    ds_read_b64_tr_b16 v[104:105], v13 offset:28672
    v_mfma_f32_16x16x32_bf16 v[40:43], v[72:75], v[208:211], v[40:43]
    ds_read_b64_tr_b16 v[106:107], v13 offset:30720
    v_mfma_f32_16x16x32_bf16 v[44:47], v[76:79], v[208:211], v[44:47]
    ds_read_b64_tr_b16 v[108:109], v14 offset:28672
    s_waitcnt vmcnt(0)
    v_mfma_f32_16x16x32_bf16 v[28:31], v[76:79], v[204:207], v[28:31]
    ds_read_b64_tr_b16 v[110:111], v14 offset:30720
    v_or3_b32 v17, v212, v216, v220
    v_mfma_f32_16x16x32_bf16 v[32:35], v[80:83], v[204:207], v[32:35]
    ds_read_b64_tr_b16 v[112:113], v15 offset:28672
    v_bitop3_b32 v17, v17, v224, 1 bitop3:0xa8
    v_mfma_f32_16x16x32_bf16 v[48:51], v[80:83], v[208:211], v[48:51]
    ds_read_b64_tr_b16 v[114:115], v15 offset:30720
    v_cmp_ne_u32 vcc, 0, v17
    v_mfma_f32_16x16x32_bf16 v[52:55], v[84:87], v[208:211], v[52:55]
    ds_read_b64_tr_b16 v[116:117], v16 offset:28672
    ds_read_b64_tr_b16 v[118:119], v16 offset:30720
    v_mfma_f32_16x16x32_bf16 v[36:39], v[84:87], v[204:207], v[36:39]
    s_waitcnt lgkmcnt(8)
    s_cbranch_vccnz dm_23m2
dm_23n2:
dm_23x:
    v_mfma_f32_16x16x32_bf16 v[24:27], v[88:91], v[212:215], v[24:27]
    v_mfma_f32_16x16x32_bf16 v[40:43], v[88:91], v[216:219], v[40:43]
    v_mfma_f32_16x16x32_bf16 v[44:47], v[92:95], v[216:219], v[44:47]
    v_mfma_f32_16x16x32_bf16 v[28:31], v[92:95], v[212:215], v[28:31]
    v_mfma_f32_16x16x32_bf16 v[32:35], v[96:99], v[212:215], v[32:35]
    v_mfma_f32_16x16x32_bf16 v[48:51], v[96:99], v[216:219], v[48:51]
    v_mfma_f32_16x16x32_bf16 v[52:55], v[100:103], v[216:219], v[52:55]
    v_mfma_f32_16x16x32_bf16 v[36:39], v[100:103], v[212:215], v[36:39]
    s_waitcnt lgkmcnt(0)
    v_mfma_f32_16x16x32_bf16 v[24:27], v[104:107], v[220:223], v[24:27]
    s_add_u32 s44, s62, 0x5c8000
    v_mfma_f32_16x16x32_bf16 v[40:43], v[104:107], v[224:227], v[40:43]
    s_addc_u32 s45, s63, 0
    v_mfma_f32_16x16x32_bf16 v[44:47], v[108:111], v[224:227], v[44:47]
    v_mfma_f32_16x16x32_bf16 v[28:31], v[108:111], v[220:223], v[28:31]
    s_mov_b32 s46, 0x6000
    v_mfma_f32_16x16x32_bf16 v[32:35], v[112:115], v[220:223], v[32:35]
    v_mfma_f32_16x16x32_bf16 v[48:51], v[112:115], v[224:227], v[48:51]
    s_mov_b32 s47, 0x20000
    v_mfma_f32_16x16x32_bf16 v[52:55], v[116:119], v[224:227], v[52:55]
    v_mfma_f32_16x16x32_bf16 v[36:39], v[116:119], v[220:223], v[36:39]
    s_add_u32 s36, s39, 0
    v_cvt_pk_bf16_f32 v148, v24, v25
    v_cvt_pk_bf16_f32 v149, v26, v27
    v_cvt_pk_bf16_f32 v150, v28, v29
    v_cvt_pk_bf16_f32 v151, v30, v31
    v_and_b32 v148, -2, v148
    buffer_store_dwordx4 v[148:151], v2, s[16:19], s36 offen offset:0 sc1
    v_cvt_pk_bf16_f32 v152, v32, v33
    v_cvt_pk_bf16_f32 v153, v34, v35
    v_cvt_pk_bf16_f32 v154, v36, v37
    v_cvt_pk_bf16_f32 v155, v38, v39
    v_and_b32 v152, -2, v152
    buffer_store_dwordx4 v[152:155], v2, s[16:19], s36 offen offset:1024 sc1
    s_add_u32 s36, s39, 65536
    v_cvt_pk_bf16_f32 v156, v40, v41
    v_cvt_pk_bf16_f32 v157, v42, v43
    v_cvt_pk_bf16_f32 v158, v44, v45
    v_cvt_pk_bf16_f32 v159, v46, v47
    v_and_b32 v156, -2, v156
    buffer_store_dwordx4 v[156:159], v2, s[16:19], s36 offen offset:0 sc1
    v_cvt_pk_bf16_f32 v160, v48, v49
    v_cvt_pk_bf16_f32 v161, v50, v51
    v_cvt_pk_bf16_f32 v162, v52, v53
    v_cvt_pk_bf16_f32 v163, v54, v55
    v_and_b32 v160, -2, v160
    buffer_store_dwordx4 v[160:163], v2, s[16:19], s36 offen offset:1024 sc1
    s_barrier
    s_lshl_b32 s36, s37, 11
    v_add_u32 v7, s36, v2
    ds_write_b128 v7, v[148:151] offset:0
    ds_write_b128 v7, v[152:155] offset:1024
    ds_write_b128 v7, v[156:159] offset:2048
    ds_write_b128 v7, v[160:163] offset:3072
    v_lshlrev_b32 v24, 16, v148
    v_and_b32 v25, 0xffff0000, v148
    v_lshlrev_b32 v26, 16, v149
    v_and_b32 v27, 0xffff0000, v149
    v_lshlrev_b32 v28, 16, v150
    v_and_b32 v29, 0xffff0000, v150
    v_lshlrev_b32 v30, 16, v151
    v_and_b32 v31, 0xffff0000, v151
    v_lshlrev_b32 v32, 16, v152
    v_and_b32 v33, 0xffff0000, v152
    v_lshlrev_b32 v34, 16, v153
    v_and_b32 v35, 0xffff0000, v153
    v_lshlrev_b32 v36, 16, v154
    v_and_b32 v37, 0xffff0000, v154
    v_lshlrev_b32 v38, 16, v155
    v_and_b32 v39, 0xffff0000, v155
    v_lshlrev_b32 v40, 16, v156
    v_and_b32 v41, 0xffff0000, v156
    v_lshlrev_b32 v42, 16, v157
    v_and_b32 v43, 0xffff0000, v157
    v_lshlrev_b32 v44, 16, v158
    v_and_b32 v45, 0xffff0000, v158
    v_lshlrev_b32 v46, 16, v159
    v_and_b32 v47, 0xffff0000, v159
    v_lshlrev_b32 v48, 16, v160
    v_and_b32 v49, 0xffff0000, v160
    v_lshlrev_b32 v50, 16, v161
    v_and_b32 v51, 0xffff0000, v161
    v_lshlrev_b32 v52, 16, v162
    v_and_b32 v53, 0xffff0000, v162
    v_lshlrev_b32 v54, 16, v163
    v_and_b32 v55, 0xffff0000, v163
    s_add_u32 s53, s55, 512
    v_mov_b32 v8, 1
    v_mov_b32 v9, 162816
    v_mov_b32 v11, 0
    s_mov_b64 exec, 1
    s_waitcnt vmcnt(0)
    ds_add_rtn_u32 v10, v9, v8
    s_waitcnt lgkmcnt(0)
    v_readfirstlane_b32 s54, v10
    s_nop 0
    s_and_b32 s54, s54, 3
    s_cmp_lg_u32 s54, 3
    s_cbranch_scc1 pub_24
    buffer_atomic_add v8, v11, s[56:59], s53 offen sc1
    v_mov_b32 v9, 162872
    ds_add_u32 v9, v8
pub_24:
    s_mov_b64 exec, -1
    s_waitcnt lgkmcnt(0)
    s_barrier
    v_pk_add_f32 v[142:143], v[24:25], v[26:27]
    v_pk_mul_f32 v[136:137], v[24:25], v[24:25]
    v_pk_fma_f32 v[136:137], v[26:27], v[26:27], v[136:137]
    v_pk_add_f32 v[142:143], v[142:143], v[28:29]
    v_pk_fma_f32 v[136:137], v[28:29], v[28:29], v[136:137]
    v_pk_add_f32 v[142:143], v[142:143], v[30:31]
    v_pk_fma_f32 v[136:137], v[30:31], v[30:31], v[136:137]
    v_pk_add_f32 v[142:143], v[142:143], v[32:33]
    v_pk_fma_f32 v[136:137], v[32:33], v[32:33], v[136:137]
    v_pk_add_f32 v[142:143], v[142:143], v[34:35]
    v_pk_fma_f32 v[136:137], v[34:35], v[34:35], v[136:137]
    v_pk_add_f32 v[142:143], v[142:143], v[36:37]
    v_pk_fma_f32 v[136:137], v[36:37], v[36:37], v[136:137]
    v_pk_add_f32 v[142:143], v[142:143], v[38:39]
    v_pk_fma_f32 v[136:137], v[38:39], v[38:39], v[136:137]
    v_add_f32 v138, v142, v143
    v_add_f32 v139, v136, v137
    v_mov_b32 v142, v138
    v_mov_b32 v143, v139
    s_nop 0
    v_permlane16_swap_b32 v138, v142
    v_permlane16_swap_b32 v139, v143
    v_pk_add_f32 v[138:139], v[138:139], v[142:143]
    v_mov_b32 v142, v138
    v_mov_b32 v143, v139
    s_nop 0
    v_permlane32_swap_b32 v138, v142
    v_permlane32_swap_b32 v139, v143
    v_pk_add_f32 v[138:139], v[138:139], v[142:143]
    v_pk_add_f32 v[142:143], v[40:41], v[42:43]
    v_pk_mul_f32 v[136:137], v[40:41], v[40:41]
    v_pk_fma_f32 v[136:137], v[42:43], v[42:43], v[136:137]
    v_pk_add_f32 v[142:143], v[142:143], v[44:45]
    v_pk_fma_f32 v[136:137], v[44:45], v[44:45], v[136:137]
    v_pk_add_f32 v[142:143], v[142:143], v[46:47]
    v_pk_fma_f32 v[136:137], v[46:47], v[46:47], v[136:137]
    v_pk_add_f32 v[142:143], v[142:143], v[48:49]
    v_pk_fma_f32 v[136:137], v[48:49], v[48:49], v[136:137]
    v_pk_add_f32 v[142:143], v[142:143], v[50:51]
    v_pk_fma_f32 v[136:137], v[50:51], v[50:51], v[136:137]
    v_pk_add_f32 v[142:143], v[142:143], v[52:53]
    v_pk_fma_f32 v[136:137], v[52:53], v[52:53], v[136:137]
    v_pk_add_f32 v[142:143], v[142:143], v[54:55]
    v_pk_fma_f32 v[136:137], v[54:55], v[54:55], v[136:137]
    v_add_f32 v140, v142, v143
    v_add_f32 v141, v136, v137
    v_mov_b32 v142, v140
    v_mov_b32 v143, v141
    s_nop 0
    v_permlane16_swap_b32 v140, v142
    v_permlane16_swap_b32 v141, v143
    v_pk_add_f32 v[140:141], v[140:141], v[142:143]
    v_mov_b32 v142, v140
    v_mov_b32 v143, v141
    s_nop 0
    v_permlane32_swap_b32 v140, v142
    v_permlane32_swap_b32 v141, v143
    v_pk_add_f32 v[140:141], v[140:141], v[142:143]
    v_cmp_eq_u32 vcc, 0, v23
    s_nop 1
    v_cndmask_b32 v138, v140, v138, vcc
    v_cndmask_b32 v139, v141, v139, vcc
    s_lshr_b32 s53, s29, 3
    s_lshl_b32 s53, s53, 14
    s_and_b32 s40, s29, 7
    s_lshl_b32 s40, s40, 10
    s_add_u32 s40, s40, s53
    s_lshl_b32 s36, s34, 8
    s_add_u32 s40, s40, s36
    v_lshlrev_b32 v7, 3, v1
    s_bfm_b64 exec, 32, 0
    buffer_store_dwordx2 v[138:139], v7, s[44:47], s40 offen sc1
    s_mov_b64 exec, -1
    s_lshr_b32 s34, s30, 1
    s_and_b32 s35, s30, 1
    v_and_b32 v22, 15, v1
    v_lshrrev_b32 v23, 4, v1
    s_mul_i32 s37, s34, 4
    s_mul_i32 s38, s29, 14
    s_mul_i32 s36, s35, 7
    s_add_u32 s38, s38, s36
    s_mul_i32 s36, s34, 8192
    v_add_u32 v12, s36, v2
    v_lshrrev_b32 v6, 2, v1
    v_mul_u32_u24 v13, 448, v6
    v_and_b32 v7, 3, v1
    v_lshl_add_u32 v13, v7, 3, v13
    v_add_u32 v13, 73728, v13
    s_mul_i32 s36, s35, 224
    v_add_u32 v13, s36, v13
    v_bfe_u32 v6, v1, 4, 1
    v_lshlrev_b32 v6, 5, v6
    s_cmp_eq_u32 s35, 0
    s_cselect_b32 s36, 1, -1
    v_mul_lo_u32 v6, v6, s36
    v_sub_u32 v14, v13, v6
    v_add_u32 v13, v13, v6
    v_mov_b32 v17, v12
    s_mov_b32 s42, 0
    s_mov_b32 s43, 0
    s_mov_b32 s48, 57344
    v_add_u32 v18, 57344, v13
    v_add_u32 v19, 57344, v14
    ds_read_b128 v[136:139], v17 offset:0
    ds_read_b128 v[140:143], v17 offset:2048
    ds_read_b128 v[144:147], v17 offset:4096
    ds_read_b128 v[148:151], v17 offset:6144
    ds_read_b64_tr_b16 v[152:153], v18 offset:0
    ds_read_b64_tr_b16 v[154:155], v18 offset:7168
    ds_read_b64_tr_b16 v[156:157], v19 offset:32
    ds_read_b64_tr_b16 v[158:159], v19 offset:7200
    ds_read_b64_tr_b16 v[160:161], v18 offset:64
    ds_read_b64_tr_b16 v[162:163], v18 offset:7232
    ds_read_b64_tr_b16 v[164:165], v19 offset:96
    ds_read_b64_tr_b16 v[166:167], v19 offset:7264
    ds_read_b64_tr_b16 v[168:169], v18 offset:128
    ds_read_b64_tr_b16 v[170:171], v18 offset:7296
    ds_read_b64_tr_b16 v[172:173], v19 offset:160
    ds_read_b64_tr_b16 v[174:175], v19 offset:7328
    ds_read_b64_tr_b16 v[176:177], v18 offset:192
    ds_read_b64_tr_b16 v[178:179], v18 offset:7360
    s_waitcnt lgkmcnt(12)
    v_mfma_f32_16x16x32_bf16 v[24:27], v[152:155], v[136:139], 0
    ds_read_b128 v[180:183], v17 offset:1024
    s_add_u32 s42, s42, 16384
    v_mfma_f32_16x16x32_bf16 v[52:55], v[152:155], v[140:143], 0
    ds_read_b128 v[184:187], v17 offset:3072
    s_cmp_eq_u32 s42, 49152
    v_mfma_f32_16x16x32_bf16 v[80:83], v[152:155], v[144:147], 0
    ds_read_b128 v[188:191], v17 offset:5120
    s_cselect_b32 s42, 0, s42
    v_mfma_f32_16x16x32_bf16 v[108:111], v[152:155], v[148:151], 0
    ds_read_b128 v[192:195], v17 offset:7168
    s_waitcnt lgkmcnt(14)
    v_mfma_f32_16x16x32_bf16 v[112:115], v[156:159], v[148:151], 0
    ds_read_b64_tr_b16 v[196:197], v18 offset:14336
    s_add_u32 s48, s48, 28672
    v_mfma_f32_16x16x32_bf16 v[84:87], v[156:159], v[144:147], 0
    ds_read_b64_tr_b16 v[198:199], v18 offset:21504
    s_cmp_eq_u32 s48, 86016
    v_mfma_f32_16x16x32_bf16 v[56:59], v[156:159], v[140:143], 0
    ds_read_b64_tr_b16 v[200:201], v19 offset:14368
    s_cselect_b32 s48, 0, s48
    v_mfma_f32_16x16x32_bf16 v[28:31], v[156:159], v[136:139], 0
    ds_read_b64_tr_b16 v[202:203], v19 offset:21536
    s_waitcnt lgkmcnt(8)
    v_mfma_f32_16x16x32_bf16 v[32:35], v[160:163], v[136:139], 0
    ds_read_b64_tr_b16 v[204:205], v18 offset:14400
    v_add_u32 v17, s42, v12
    v_mfma_f32_16x16x32_bf16 v[60:63], v[160:163], v[140:143], 0
    ds_read_b64_tr_b16 v[206:207], v18 offset:21568
    v_mfma_f32_16x16x32_bf16 v[88:91], v[160:163], v[144:147], 0
    ds_read_b64_tr_b16 v[208:209], v19 offset:14432
    v_mfma_f32_16x16x32_bf16 v[116:119], v[160:163], v[148:151], 0
    ds_read_b64_tr_b16 v[210:211], v19 offset:21600
    v_mfma_f32_16x16x32_bf16 v[120:123], v[164:167], v[148:151], 0
    ds_read_b64_tr_b16 v[212:213], v18 offset:14464
    v_mfma_f32_16x16x32_bf16 v[92:95], v[164:167], v[144:147], 0
    ds_read_b64_tr_b16 v[214:215], v18 offset:21632
    v_mfma_f32_16x16x32_bf16 v[64:67], v[164:167], v[140:143], 0
    ds_read_b64_tr_b16 v[216:217], v19 offset:14496
    v_mfma_f32_16x16x32_bf16 v[36:39], v[164:167], v[136:139], 0
    ds_read_b64_tr_b16 v[218:219], v19 offset:21664
    v_add_u32 v19, s48, v14
    v_mfma_f32_16x16x32_bf16 v[40:43], v[168:171], v[136:139], 0
    ds_read_b64_tr_b16 v[220:221], v18 offset:14528
    v_mfma_f32_16x16x32_bf16 v[68:71], v[168:171], v[140:143], 0
    ds_read_b64_tr_b16 v[222:223], v18 offset:21696
    v_add_u32 v18, s48, v13
    v_mfma_f32_16x16x32_bf16 v[96:99], v[168:171], v[144:147], 0
    v_mfma_f32_16x16x32_bf16 v[124:127], v[168:171], v[148:151], 0
    v_mfma_f32_16x16x32_bf16 v[128:131], v[172:175], v[148:151], 0
    v_mfma_f32_16x16x32_bf16 v[100:103], v[172:175], v[144:147], 0
    v_mfma_f32_16x16x32_bf16 v[72:75], v[172:175], v[140:143], 0
    v_mfma_f32_16x16x32_bf16 v[44:47], v[172:175], v[136:139], 0
    v_mfma_f32_16x16x32_bf16 v[48:51], v[176:179], v[136:139], 0
    v_mfma_f32_16x16x32_bf16 v[76:79], v[176:179], v[140:143], 0
    v_mfma_f32_16x16x32_bf16 v[104:107], v[176:179], v[144:147], 0
    v_mfma_f32_16x16x32_bf16 v[132:135], v[176:179], v[148:151], 0
    s_waitcnt lgkmcnt(12)
    v_mfma_f32_16x16x32_bf16 v[24:27], v[196:199], v[180:183], v[24:27]
    s_add_u32 s43, s43, 1
    s_mul_i32 s36, s35, 448
    s_add_u32 s36, s36, 159744
    v_lshlrev_b32 v6, 4, v23
    v_mfma_f32_16x16x32_bf16 v[52:55], v[196:199], v[184:187], v[52:55]
    v_add_u32 v6, s36, v6
    s_lshl_b32 s36, s37, 8
    s_add_u32 s36, s36, 160768
    v_lshlrev_b32 v7, 4, v22
    v_mfma_f32_16x16x32_bf16 v[80:83], v[196:199], v[188:191], v[80:83]
    v_add_u32 v7, s36, v7
    s_add_u32 s16, s62, 0x400000
    s_addc_u32 s17, s63, 0
    s_mov_b32 s18, 0x1be000
    v_mfma_f32_16x16x32_bf16 v[108:111], v[196:199], v[192:195], v[108:111]
    s_mov_b32 s19, 0x20000
    s_mul_i32 s39, s37, 229376
    s_lshr_b32 s36, s38, 1
    s_waitcnt lgkmcnt(0)
    v_mfma_f32_16x16x32_bf16 v[112:115], v[200:203], v[192:195], v[112:115]
    s_add_u32 s36, s36, 0
    s_lshr_b32 s53, s36, 3
    s_lshl_b32 s53, s53, 14
    s_and_b32 s44, s36, 7
    v_mfma_f32_16x16x32_bf16 v[84:87], v[200:203], v[188:191], v[84:87]
    s_lshl_b32 s44, s44, 10
    s_add_u32 s44, s44, s53
    s_add_u32 s44, s44, s39
    s_lshr_b32 s36, s38, 1
    v_mfma_f32_16x16x32_bf16 v[56:59], v[200:203], v[184:187], v[56:59]
    s_add_u32 s36, s36, 1
    s_lshr_b32 s53, s36, 3
    s_lshl_b32 s53, s53, 14
    s_and_b32 s45, s36, 7
    v_mfma_f32_16x16x32_bf16 v[28:31], v[200:203], v[180:183], v[28:31]
    s_lshl_b32 s45, s45, 10
    s_add_u32 s45, s45, s53
    s_add_u32 s45, s45, s39
    s_lshr_b32 s36, s38, 1
    v_mfma_f32_16x16x32_bf16 v[32:35], v[204:207], v[180:183], v[32:35]
    s_add_u32 s36, s36, 2
    s_lshr_b32 s53, s36, 3
    s_lshl_b32 s53, s53, 14
    s_and_b32 s46, s36, 7
    v_mfma_f32_16x16x32_bf16 v[60:63], v[204:207], v[184:187], v[60:63]
    s_lshl_b32 s46, s46, 10
    s_add_u32 s46, s46, s53
    s_add_u32 s46, s46, s39
    s_lshr_b32 s36, s38, 1
    v_mfma_f32_16x16x32_bf16 v[88:91], v[204:207], v[188:191], v[88:91]
    s_add_u32 s36, s36, 3
    s_lshr_b32 s53, s36, 3
    s_lshl_b32 s53, s53, 14
    s_and_b32 s47, s36, 7
    v_mfma_f32_16x16x32_bf16 v[116:119], v[204:207], v[192:195], v[116:119]
    s_lshl_b32 s47, s47, 10
    s_add_u32 s47, s47, s53
    s_add_u32 s47, s47, s39
    v_lshrrev_b32 v226, 2, v1
    v_mfma_f32_16x16x32_bf16 v[120:123], v[208:211], v[192:195], v[120:123]
    v_mul_u32_u24 v240, 256, v226
    v_and_b32 v227, 3, v1
    v_lshl_add_u32 v240, v227, 3, v240
    v_add_u32 v240, 49152, v240
    v_mfma_f32_16x16x32_bf16 v[92:95], v[208:211], v[188:191], v[92:95]
    v_and_b32 v226, 7, v226
    s_mul_i32 s36, s35, 4
    s_add_u32 s36, s36, 3
    v_xor_b32 v227, s36, v226
    v_mfma_f32_16x16x32_bf16 v[64:67], v[208:211], v[184:187], v[64:67]
    v_lshl_add_u32 v243, v227, 5, v240
    s_mul_i32 s36, s35, 4
    s_add_u32 s36, s36, 2
    v_xor_b32 v227, s36, v226
    v_mfma_f32_16x16x32_bf16 v[36:39], v[208:211], v[180:183], v[36:39]
    v_lshl_add_u32 v242, v227, 5, v240
    s_mul_i32 s36, s35, 4
    s_add_u32 s36, s36, 1
    v_xor_b32 v227, s36, v226
    v_mfma_f32_16x16x32_bf16 v[40:43], v[212:215], v[180:183], v[40:43]
    v_lshl_add_u32 v241, v227, 5, v240
    s_mul_i32 s36, s35, 4
    s_add_u32 s36, s36, 0
    v_xor_b32 v227, s36, v226
    v_mfma_f32_16x16x32_bf16 v[68:71], v[212:215], v[184:187], v[68:71]
    v_lshl_add_u32 v240, v227, 5, v240
    s_lshl_b32 s38, s33, 3
    s_lshl_b32 s36, s35, 2
    s_add_u32 s38, s38, s36
    v_mfma_f32_16x16x32_bf16 v[96:99], v[212:215], v[188:191], v[96:99]
    s_lshr_b32 s36, s38, 1
    s_lshr_b32 s53, s36, 3
    s_lshl_b32 s53, s53, 14
    s_and_b32 s39, s36, 7
    v_mfma_f32_16x16x32_bf16 v[124:127], v[212:215], v[192:195], v[124:127]
    s_lshl_b32 s39, s39, 10
    s_add_u32 s39, s39, s53
    s_lshl_b32 s36, s37, 16
    s_add_u32 s39, s39, s36
    v_mfma_f32_16x16x32_bf16 v[128:131], v[216:219], v[192:195], v[128:131]
    s_lshl_b32 s40, s31, 17
    s_add_u32 s40, s40, s39
    s_xor_b32 s41, s31, 1
    s_lshl_b32 s41, s41, 17
    v_mfma_f32_16x16x32_bf16 v[100:103], v[216:219], v[188:191], v[100:103]
    s_add_u32 s41, s41, s39
    s_mov_b32 s84, s62
    s_mov_b32 s85, s63
    s_mov_b32 s86, 0x7e000
    v_mfma_f32_16x16x32_bf16 v[72:75], v[216:219], v[184:187], v[72:75]
    s_mov_b32 s87, 0x20000
    s_add_u32 s88, s62, 0x80000
    s_addc_u32 s89, s63, 0
    s_mov_b32 s90, 0x7e000
    v_mfma_f32_16x16x32_bf16 v[44:47], v[216:219], v[180:183], v[44:47]
    s_mov_b32 s91, 0x20000
    s_lshl_b32 s36, s37, 1
    s_add_u32 s36, s36, s35
    s_lshl_b32 s36, s36, 10
    v_mfma_f32_16x16x32_bf16 v[48:51], v[220:223], v[180:183], v[48:51]
    v_add_u32 v244, s36, v2
    v_mov_b32 v245, 1
    v_mov_b32 v246, 162880
    v_lshrrev_b32 v238, 1, v23
    v_mfma_f32_16x16x32_bf16 v[76:79], v[220:223], v[184:187], v[76:79]
    v_lshlrev_b32 v238, 8, v238
    v_lshl_add_u32 v238, v22, 4, v238
    v_and_b32 v224, 1, v23
    v_lshl_add_u32 v238, v224, 3, v238
    v_mfma_f32_16x16x32_bf16 v[104:107], v[220:223], v[188:191], v[104:107]
    v_mfma_f32_16x16x32_bf16 v[132:135], v[220:223], v[192:195], v[132:135]
    s_add_u32 s53, s55, 1408
    v_mov_b32 v8, 1
    v_mov_b32 v9, 162864
    v_mov_b32 v11, 0
    s_mov_b64 exec, 1
    s_waitcnt vmcnt(0)
    ds_add_rtn_u32 v10, v9, v8
    s_waitcnt lgkmcnt(0)
    v_readfirstlane_b32 s54, v10
    s_nop 0
    s_and_b32 s54, s54, 3
    s_cmp_lg_u32 s54, 3
    s_cbranch_scc1 pub_25
    buffer_atomic_add v8, v11, s[56:59], s53 offen sc1
pub_25:
    s_mov_b64 exec, -1
    s_barrier
    ds_read_b128 v[136:139], v17 offset:0
    ds_read_b128 v[140:143], v17 offset:2048
    ds_read_b128 v[144:147], v17 offset:4096
    ds_read_b128 v[148:151], v17 offset:6144
    ds_read_b64_tr_b16 v[152:153], v18 offset:0
    ds_read_b64_tr_b16 v[154:155], v18 offset:7168
    ds_read_b64_tr_b16 v[156:157], v19 offset:32
    ds_read_b64_tr_b16 v[158:159], v19 offset:7200
    ds_read_b64_tr_b16 v[160:161], v18 offset:64
    ds_read_b64_tr_b16 v[162:163], v18 offset:7232
    ds_read_b64_tr_b16 v[164:165], v19 offset:96
    ds_read_b64_tr_b16 v[166:167], v19 offset:7264
    ds_read_b64_tr_b16 v[168:169], v18 offset:128
    ds_read_b64_tr_b16 v[170:171], v18 offset:7296
    ds_read_b64_tr_b16 v[172:173], v19 offset:160
    ds_read_b64_tr_b16 v[174:175], v19 offset:7328
    ds_read_b64_tr_b16 v[176:177], v18 offset:192
    ds_read_b64_tr_b16 v[178:179], v18 offset:7360
    s_waitcnt lgkmcnt(12)
mm_26:
    v_mfma_f32_16x16x32_bf16 v[24:27], v[152:155], v[136:139], v[24:27]
    ds_read_b128 v[180:183], v17 offset:1024
    s_add_u32 s42, s42, 16384
    v_mfma_f32_16x16x32_bf16 v[52:55], v[152:155], v[140:143], v[52:55]
    ds_read_b128 v[184:187], v17 offset:3072
    s_cmp_eq_u32 s42, 49152
    v_mfma_f32_16x16x32_bf16 v[80:83], v[152:155], v[144:147], v[80:83]
    ds_read_b128 v[188:191], v17 offset:5120
    s_cselect_b32 s42, 0, s42
    v_mfma_f32_16x16x32_bf16 v[108:111], v[152:155], v[148:151], v[108:111]
    ds_read_b128 v[192:195], v17 offset:7168
    s_waitcnt lgkmcnt(14)
    v_mfma_f32_16x16x32_bf16 v[112:115], v[156:159], v[148:151], v[112:115]
    ds_read_b64_tr_b16 v[196:197], v18 offset:14336
    s_add_u32 s48, s48, 28672
    v_mfma_f32_16x16x32_bf16 v[84:87], v[156:159], v[144:147], v[84:87]
    ds_read_b64_tr_b16 v[198:199], v18 offset:21504
    s_cmp_eq_u32 s48, 86016
    v_mfma_f32_16x16x32_bf16 v[56:59], v[156:159], v[140:143], v[56:59]
    ds_read_b64_tr_b16 v[200:201], v19 offset:14368
    s_cselect_b32 s48, 0, s48
    v_mfma_f32_16x16x32_bf16 v[28:31], v[156:159], v[136:139], v[28:31]
    ds_read_b64_tr_b16 v[202:203], v19 offset:21536
    s_waitcnt lgkmcnt(8)
    v_mfma_f32_16x16x32_bf16 v[32:35], v[160:163], v[136:139], v[32:35]
    ds_read_b64_tr_b16 v[204:205], v18 offset:14400
    v_add_u32 v17, s42, v12
    v_mfma_f32_16x16x32_bf16 v[60:63], v[160:163], v[140:143], v[60:63]
    ds_read_b64_tr_b16 v[206:207], v18 offset:21568
    v_mfma_f32_16x16x32_bf16 v[88:91], v[160:163], v[144:147], v[88:91]
    ds_read_b64_tr_b16 v[208:209], v19 offset:14432
    v_mfma_f32_16x16x32_bf16 v[116:119], v[160:163], v[148:151], v[116:119]
    ds_read_b64_tr_b16 v[210:211], v19 offset:21600
    v_mfma_f32_16x16x32_bf16 v[120:123], v[164:167], v[148:151], v[120:123]
    ds_read_b64_tr_b16 v[212:213], v18 offset:14464
    v_mfma_f32_16x16x32_bf16 v[92:95], v[164:167], v[144:147], v[92:95]
    ds_read_b64_tr_b16 v[214:215], v18 offset:21632
    v_mfma_f32_16x16x32_bf16 v[64:67], v[164:167], v[140:143], v[64:67]
    ds_read_b64_tr_b16 v[216:217], v19 offset:14496
    v_mfma_f32_16x16x32_bf16 v[36:39], v[164:167], v[136:139], v[36:39]
    ds_read_b64_tr_b16 v[218:219], v19 offset:21664
    v_add_u32 v19, s48, v14
    v_mfma_f32_16x16x32_bf16 v[40:43], v[168:171], v[136:139], v[40:43]
    ds_read_b64_tr_b16 v[220:221], v18 offset:14528
    v_mfma_f32_16x16x32_bf16 v[68:71], v[168:171], v[140:143], v[68:71]
    ds_read_b64_tr_b16 v[222:223], v18 offset:21696
    v_add_u32 v18, s48, v13
    v_mfma_f32_16x16x32_bf16 v[96:99], v[168:171], v[144:147], v[96:99]
    v_mfma_f32_16x16x32_bf16 v[124:127], v[168:171], v[148:151], v[124:127]
    v_mfma_f32_16x16x32_bf16 v[128:131], v[172:175], v[148:151], v[128:131]
    v_mfma_f32_16x16x32_bf16 v[100:103], v[172:175], v[144:147], v[100:103]
    v_mfma_f32_16x16x32_bf16 v[72:75], v[172:175], v[140:143], v[72:75]
    v_mfma_f32_16x16x32_bf16 v[44:47], v[172:175], v[136:139], v[44:47]
    v_mfma_f32_16x16x32_bf16 v[48:51], v[176:179], v[136:139], v[48:51]
    v_mfma_f32_16x16x32_bf16 v[76:79], v[176:179], v[140:143], v[76:79]
    v_mfma_f32_16x16x32_bf16 v[104:107], v[176:179], v[144:147], v[104:107]
    v_mfma_f32_16x16x32_bf16 v[132:135], v[176:179], v[148:151], v[132:135]
    s_waitcnt lgkmcnt(12)
    v_mfma_f32_16x16x32_bf16 v[24:27], v[196:199], v[180:183], v[24:27]
    s_add_u32 s43, s43, 1
    s_cmp_lt_u32 s43, 15
    v_mfma_f32_16x16x32_bf16 v[52:55], v[196:199], v[184:187], v[52:55]
    v_mfma_f32_16x16x32_bf16 v[80:83], v[196:199], v[188:191], v[80:83]
    v_mfma_f32_16x16x32_bf16 v[108:111], v[196:199], v[192:195], v[108:111]
    s_waitcnt lgkmcnt(0)
    s_barrier
    v_mfma_f32_16x16x32_bf16 v[112:115], v[200:203], v[192:195], v[112:115]
    ds_read_b128 v[136:139], v17 offset:0
    v_mfma_f32_16x16x32_bf16 v[84:87], v[200:203], v[188:191], v[84:87]
    ds_read_b128 v[140:143], v17 offset:2048
    v_mfma_f32_16x16x32_bf16 v[56:59], v[200:203], v[184:187], v[56:59]
    ds_read_b128 v[144:147], v17 offset:4096
    v_mfma_f32_16x16x32_bf16 v[28:31], v[200:203], v[180:183], v[28:31]
    ds_read_b128 v[148:151], v17 offset:6144
    v_mfma_f32_16x16x32_bf16 v[32:35], v[204:207], v[180:183], v[32:35]
    ds_read_b64_tr_b16 v[152:153], v18 offset:0
    v_mfma_f32_16x16x32_bf16 v[60:63], v[204:207], v[184:187], v[60:63]
    ds_read_b64_tr_b16 v[154:155], v18 offset:7168
    v_mfma_f32_16x16x32_bf16 v[88:91], v[204:207], v[188:191], v[88:91]
    ds_read_b64_tr_b16 v[156:157], v19 offset:32
    v_mfma_f32_16x16x32_bf16 v[116:119], v[204:207], v[192:195], v[116:119]
    ds_read_b64_tr_b16 v[158:159], v19 offset:7200
    v_mfma_f32_16x16x32_bf16 v[120:123], v[208:211], v[192:195], v[120:123]
    ds_read_b64_tr_b16 v[160:161], v18 offset:64
    v_mfma_f32_16x16x32_bf16 v[92:95], v[208:211], v[188:191], v[92:95]
    ds_read_b64_tr_b16 v[162:163], v18 offset:7232
    v_mfma_f32_16x16x32_bf16 v[64:67], v[208:211], v[184:187], v[64:67]
    ds_read_b64_tr_b16 v[164:165], v19 offset:96
    v_mfma_f32_16x16x32_bf16 v[36:39], v[208:211], v[180:183], v[36:39]
    ds_read_b64_tr_b16 v[166:167], v19 offset:7264
    v_mfma_f32_16x16x32_bf16 v[40:43], v[212:215], v[180:183], v[40:43]
    ds_read_b64_tr_b16 v[168:169], v18 offset:128
    v_mfma_f32_16x16x32_bf16 v[68:71], v[212:215], v[184:187], v[68:71]
    ds_read_b64_tr_b16 v[170:171], v18 offset:7296
    v_mfma_f32_16x16x32_bf16 v[96:99], v[212:215], v[188:191], v[96:99]
    ds_read_b64_tr_b16 v[172:173], v19 offset:160
    v_mfma_f32_16x16x32_bf16 v[124:127], v[212:215], v[192:195], v[124:127]
    ds_read_b64_tr_b16 v[174:175], v19 offset:7328
    v_mfma_f32_16x16x32_bf16 v[128:131], v[216:219], v[192:195], v[128:131]
    ds_read_b64_tr_b16 v[176:177], v18 offset:192
    v_mfma_f32_16x16x32_bf16 v[100:103], v[216:219], v[188:191], v[100:103]
    ds_read_b64_tr_b16 v[178:179], v18 offset:7360
    v_mfma_f32_16x16x32_bf16 v[72:75], v[216:219], v[184:187], v[72:75]
    v_mfma_f32_16x16x32_bf16 v[44:47], v[216:219], v[180:183], v[44:47]
    v_mfma_f32_16x16x32_bf16 v[48:51], v[220:223], v[180:183], v[48:51]
    v_mfma_f32_16x16x32_bf16 v[76:79], v[220:223], v[184:187], v[76:79]
    v_mfma_f32_16x16x32_bf16 v[104:107], v[220:223], v[188:191], v[104:107]
    v_mfma_f32_16x16x32_bf16 v[132:135], v[220:223], v[192:195], v[132:135]
    s_waitcnt lgkmcnt(12)
    s_cbranch_scc1 mm_26
    v_mfma_f32_16x16x32_bf16 v[24:27], v[152:155], v[136:139], v[24:27]
    ds_read_b128 v[180:183], v17 offset:1024
    v_mfma_f32_16x16x32_bf16 v[52:55], v[152:155], v[140:143], v[52:55]
    ds_read_b128 v[184:187], v17 offset:3072
    v_mfma_f32_16x16x32_bf16 v[80:83], v[152:155], v[144:147], v[80:83]
    ds_read_b128 v[188:191], v17 offset:5120
    v_mfma_f32_16x16x32_bf16 v[108:111], v[152:155], v[148:151], v[108:111]
    ds_read_b128 v[192:195], v17 offset:7168
    s_waitcnt lgkmcnt(14)
    v_mfma_f32_16x16x32_bf16 v[112:115], v[156:159], v[148:151], v[112:115]
    ds_read_b64_tr_b16 v[196:197], v18 offset:14336
    v_mfma_f32_16x16x32_bf16 v[84:87], v[156:159], v[144:147], v[84:87]
    ds_read_b64_tr_b16 v[198:199], v18 offset:21504
    v_mfma_f32_16x16x32_bf16 v[56:59], v[156:159], v[140:143], v[56:59]
    ds_read_b64_tr_b16 v[200:201], v19 offset:14368
    v_mfma_f32_16x16x32_bf16 v[28:31], v[156:159], v[136:139], v[28:31]
    ds_read_b64_tr_b16 v[202:203], v19 offset:21536
    s_waitcnt lgkmcnt(8)
    v_mfma_f32_16x16x32_bf16 v[32:35], v[160:163], v[136:139], v[32:35]
    ds_read_b64_tr_b16 v[204:205], v18 offset:14400
    v_mfma_f32_16x16x32_bf16 v[60:63], v[160:163], v[140:143], v[60:63]
    ds_read_b64_tr_b16 v[206:207], v18 offset:21568
    v_mfma_f32_16x16x32_bf16 v[88:91], v[160:163], v[144:147], v[88:91]
    ds_read_b64_tr_b16 v[208:209], v19 offset:14432
    v_mfma_f32_16x16x32_bf16 v[116:119], v[160:163], v[148:151], v[116:119]
    ds_read_b64_tr_b16 v[210:211], v19 offset:21600
    v_mfma_f32_16x16x32_bf16 v[120:123], v[164:167], v[148:151], v[120:123]
    ds_read_b64_tr_b16 v[212:213], v18 offset:14464
    v_mfma_f32_16x16x32_bf16 v[92:95], v[164:167], v[144:147], v[92:95]
    ds_read_b64_tr_b16 v[214:215], v18 offset:21632
    v_mfma_f32_16x16x32_bf16 v[64:67], v[164:167], v[140:143], v[64:67]
    ds_read_b64_tr_b16 v[216:217], v19 offset:14496
    v_mfma_f32_16x16x32_bf16 v[36:39], v[164:167], v[136:139], v[36:39]
    ds_read_b64_tr_b16 v[218:219], v19 offset:21664
    v_mfma_f32_16x16x32_bf16 v[40:43], v[168:171], v[136:139], v[40:43]
    ds_read_b64_tr_b16 v[220:221], v18 offset:14528
    v_mfma_f32_16x16x32_bf16 v[68:71], v[168:171], v[140:143], v[68:71]
    ds_read_b64_tr_b16 v[222:223], v18 offset:21696
    v_mfma_f32_16x16x32_bf16 v[96:99], v[168:171], v[144:147], v[96:99]
    v_mfma_f32_16x16x32_bf16 v[124:127], v[168:171], v[148:151], v[124:127]
    v_mfma_f32_16x16x32_bf16 v[128:131], v[172:175], v[148:151], v[128:131]
    v_mfma_f32_16x16x32_bf16 v[100:103], v[172:175], v[144:147], v[100:103]
    v_mfma_f32_16x16x32_bf16 v[72:75], v[172:175], v[140:143], v[72:75]
    v_mfma_f32_16x16x32_bf16 v[44:47], v[172:175], v[136:139], v[44:47]
    v_mfma_f32_16x16x32_bf16 v[48:51], v[176:179], v[136:139], v[48:51]
    v_mfma_f32_16x16x32_bf16 v[76:79], v[176:179], v[140:143], v[76:79]
    v_mfma_f32_16x16x32_bf16 v[104:107], v[176:179], v[144:147], v[104:107]
    v_mfma_f32_16x16x32_bf16 v[132:135], v[176:179], v[148:151], v[132:135]
    s_waitcnt lgkmcnt(0)
    s_barrier
    v_mfma_f32_16x16x32_bf16 v[24:27], v[196:199], v[180:183], v[24:27]
    ds_read_b128 v[136:139], v6 offset:0
    v_mfma_f32_16x16x32_bf16 v[52:55], v[196:199], v[184:187], v[52:55]
    ds_read_b128 v[140:143], v6 offset:64
    v_mfma_f32_16x16x32_bf16 v[80:83], v[196:199], v[188:191], v[80:83]
    ds_read_b128 v[144:147], v6 offset:128
    v_mfma_f32_16x16x32_bf16 v[108:111], v[196:199], v[192:195], v[108:111]
    ds_read_b128 v[148:151], v6 offset:192
    v_mfma_f32_16x16x32_bf16 v[112:115], v[200:203], v[192:195], v[112:115]
    ds_read_b128 v[152:155], v6 offset:256
    v_mfma_f32_16x16x32_bf16 v[84:87], v[200:203], v[188:191], v[84:87]
    ds_read_b128 v[156:159], v6 offset:320
    v_mfma_f32_16x16x32_bf16 v[56:59], v[200:203], v[184:187], v[56:59]
    ds_read_b128 v[160:163], v6 offset:384
    v_mfma_f32_16x16x32_bf16 v[28:31], v[200:203], v[180:183], v[28:31]
    ds_read_b128 v[164:167], v7 offset:0
    v_mfma_f32_16x16x32_bf16 v[32:35], v[204:207], v[180:183], v[32:35]
    ds_read_b128 v[168:171], v7 offset:256
    v_mfma_f32_16x16x32_bf16 v[60:63], v[204:207], v[184:187], v[60:63]
    ds_read_b128 v[172:175], v7 offset:512
    v_mfma_f32_16x16x32_bf16 v[88:91], v[204:207], v[188:191], v[88:91]
    ds_read_b128 v[176:179], v7 offset:768
    v_mov_b32 v13, v240
    v_mfma_f32_16x16x32_bf16 v[116:119], v[204:207], v[192:195], v[116:119]
    v_add_u32 v18, 0, v240
    v_mov_b32 v14, v241
    v_mfma_f32_16x16x32_bf16 v[120:123], v[208:211], v[192:195], v[120:123]
    v_add_u32 v19, 0, v241
    v_mov_b32 v15, v242
    v_mfma_f32_16x16x32_bf16 v[92:95], v[208:211], v[188:191], v[92:95]
    v_add_u32 v20, 0, v242
    v_mov_b32 v16, v243
    v_mfma_f32_16x16x32_bf16 v[64:67], v[208:211], v[184:187], v[64:67]
    v_add_u32 v21, 0, v243
    s_mov_b32 s42, 0
    s_mov_b32 s43, 0
    v_mfma_f32_16x16x32_bf16 v[36:39], v[208:211], v[180:183], v[36:39]
    s_mov_b32 s48, 0
    v_mov_b32 v17, v12
    v_and_b32 v199, 7, v0
    v_mfma_f32_16x16x32_bf16 v[40:43], v[212:215], v[180:183], v[40:43]
    v_lshrrev_b32 v228, 6, v0
    v_lshlrev_b32 v228, 4, v228
    v_mfma_f32_16x16x32_bf16 v[68:71], v[212:215], v[184:187], v[68:71]
    v_bfe_u32 v229, v0, 3, 3
    v_add_u32 v228, v228, v229
    s_lshr_b32 s78, s29, 1
    v_mfma_f32_16x16x32_bf16 v[96:99], v[212:215], v[188:191], v[96:99]
    s_lshl_b32 s78, s78, 16
    s_and_b32 s79, s29, 1
    s_lshl_b32 s79, s79, 7
    v_mfma_f32_16x16x32_bf16 v[124:127], v[212:215], v[192:195], v[124:127]
    s_add_u32 s78, s78, s79
    s_lshr_b32 s79, s30, 1
    s_lshl_b32 s79, s79, 13
    v_mfma_f32_16x16x32_bf16 v[128:131], v[216:219], v[192:195], v[128:131]
    s_add_u32 s78, s78, s79
    v_lshlrev_b32 v196, 8, v228
    v_lshl_add_u32 v196, v199, 4, v196
    v_mfma_f32_16x16x32_bf16 v[100:103], v[216:219], v[188:191], v[100:103]
    v_add_u32 v196, s78, v196
    v_mfma_f32_16x16x32_bf16 v[72:75], v[216:219], v[184:187], v[72:75]
    v_mfma_f32_16x16x32_bf16 v[44:47], v[216:219], v[180:183], v[44:47]
    v_mfma_f32_16x16x32_bf16 v[48:51], v[220:223], v[180:183], v[48:51]
    v_mfma_f32_16x16x32_bf16 v[76:79], v[220:223], v[184:187], v[76:79]
    v_mfma_f32_16x16x32_bf16 v[104:107], v[220:223], v[188:191], v[104:107]
    v_mfma_f32_16x16x32_bf16 v[132:135], v[220:223], v[192:195], v[132:135]
    s_waitcnt lgkmcnt(0)
    s_cmp_eq_u32 s35, 1
    s_cbranch_scc1 G3_e1
    v_pk_fma_f32 v[24:25], v[164:165], v[136:137], v[24:25] op_sel_hi:[0,1,1] neg_lo:[1,0,0] neg_hi:[1,0,0]
    v_pk_fma_f32 v[26:27], v[164:165], v[138:139], v[26:27] op_sel_hi:[0,1,1] neg_lo:[1,0,0] neg_hi:[1,0,0]
    v_pk_mul_f32 v[226:227], v[24:25], v[24:25]
    v_pk_mul_f32 v[228:229], v[26:27], v[26:27]
    v_pk_fma_f32 v[226:227], v[226:227], v[166:167], v[166:167] op_sel:[0,1,0] op_sel_hi:[1,1,0]
    v_pk_fma_f32 v[228:229], v[228:229], v[166:167], v[166:167] op_sel:[0,1,0] op_sel_hi:[1,1,0]
    v_pk_mul_f32 v[226:227], v[226:227], v[24:25]
    v_pk_mul_f32 v[228:229], v[228:229], v[26:27]
    v_exp_f32 v226, v226
    v_exp_f32 v227, v227
    v_exp_f32 v228, v228
    v_exp_f32 v229, v229
    v_pk_fma_f32 v[226:227], v[226:227], v[164:165], v[164:165] op_sel:[0,1,1] op_sel_hi:[1,1,1]
    v_pk_fma_f32 v[228:229], v[228:229], v[164:165], v[164:165] op_sel:[0,1,1] op_sel_hi:[1,1,1]
    v_rcp_f32 v226, v226
    v_rcp_f32 v227, v227
    v_rcp_f32 v228, v228
    v_rcp_f32 v229, v229
    v_pk_mul_f32 v[24:25], v[24:25], v[226:227]
    v_pk_mul_f32 v[26:27], v[26:27], v[228:229]
    v_pk_fma_f32 v[28:29], v[164:165], v[140:141], v[28:29] op_sel_hi:[0,1,1] neg_lo:[1,0,0] neg_hi:[1,0,0]
    v_pk_fma_f32 v[30:31], v[164:165], v[142:143], v[30:31] op_sel_hi:[0,1,1] neg_lo:[1,0,0] neg_hi:[1,0,0]
    v_pk_mul_f32 v[226:227], v[28:29], v[28:29]
    v_pk_mul_f32 v[228:229], v[30:31], v[30:31]
    v_pk_fma_f32 v[226:227], v[226:227], v[166:167], v[166:167] op_sel:[0,1,0] op_sel_hi:[1,1,0]
    v_pk_fma_f32 v[228:229], v[228:229], v[166:167], v[166:167] op_sel:[0,1,0] op_sel_hi:[1,1,0]
    v_pk_mul_f32 v[226:227], v[226:227], v[28:29]
    v_pk_mul_f32 v[228:229], v[228:229], v[30:31]
    v_exp_f32 v226, v226
    v_exp_f32 v227, v227
    v_exp_f32 v228, v228
    v_exp_f32 v229, v229
    v_pk_fma_f32 v[226:227], v[226:227], v[164:165], v[164:165] op_sel:[0,1,1] op_sel_hi:[1,1,1]
    v_pk_fma_f32 v[228:229], v[228:229], v[164:165], v[164:165] op_sel:[0,1,1] op_sel_hi:[1,1,1]
    v_rcp_f32 v226, v226
    v_rcp_f32 v227, v227
    v_rcp_f32 v228, v228
    v_rcp_f32 v229, v229
    v_pk_mul_f32 v[28:29], v[28:29], v[226:227]
    v_pk_mul_f32 v[30:31], v[30:31], v[228:229]
    v_cvt_pk_bf16_f32 v24, v24, v25
    v_cvt_pk_bf16_f32 v25, v26, v27
    v_cvt_pk_bf16_f32 v26, v28, v29
    v_cvt_pk_bf16_f32 v27, v30, v31
    v_or_b32 v24, 1, v24
    ds_write_b128 v244, v[24:27] offset:0
    s_add_u32 s36, s44, 0
    buffer_store_dwordx4 v[24:27], v2, s[16:19], s36 offen sc1
    v_pk_fma_f32 v[52:53], v[168:169], v[136:137], v[52:53] op_sel_hi:[0,1,1] neg_lo:[1,0,0] neg_hi:[1,0,0]
    v_pk_fma_f32 v[54:55], v[168:169], v[138:139], v[54:55] op_sel_hi:[0,1,1] neg_lo:[1,0,0] neg_hi:[1,0,0]
    v_pk_mul_f32 v[226:227], v[52:53], v[52:53]
    v_pk_mul_f32 v[228:229], v[54:55], v[54:55]
    v_pk_fma_f32 v[226:227], v[226:227], v[170:171], v[170:171] op_sel:[0,1,0] op_sel_hi:[1,1,0]
    v_pk_fma_f32 v[228:229], v[228:229], v[170:171], v[170:171] op_sel:[0,1,0] op_sel_hi:[1,1,0]
    v_pk_mul_f32 v[226:227], v[226:227], v[52:53]
    v_pk_mul_f32 v[228:229], v[228:229], v[54:55]
    v_exp_f32 v226, v226
    v_exp_f32 v227, v227
    v_exp_f32 v228, v228
    v_exp_f32 v229, v229
    v_pk_fma_f32 v[226:227], v[226:227], v[168:169], v[168:169] op_sel:[0,1,1] op_sel_hi:[1,1,1]
    v_pk_fma_f32 v[228:229], v[228:229], v[168:169], v[168:169] op_sel:[0,1,1] op_sel_hi:[1,1,1]
    v_rcp_f32 v226, v226
    v_rcp_f32 v227, v227
    v_rcp_f32 v228, v228
    v_rcp_f32 v229, v229
    v_pk_mul_f32 v[52:53], v[52:53], v[226:227]
    v_pk_mul_f32 v[54:55], v[54:55], v[228:229]
    v_pk_fma_f32 v[56:57], v[168:169], v[140:141], v[56:57] op_sel_hi:[0,1,1] neg_lo:[1,0,0] neg_hi:[1,0,0]
    v_pk_fma_f32 v[58:59], v[168:169], v[142:143], v[58:59] op_sel_hi:[0,1,1] neg_lo:[1,0,0] neg_hi:[1,0,0]
    v_pk_mul_f32 v[226:227], v[56:57], v[56:57]
    v_pk_mul_f32 v[228:229], v[58:59], v[58:59]
    v_pk_fma_f32 v[226:227], v[226:227], v[170:171], v[170:171] op_sel:[0,1,0] op_sel_hi:[1,1,0]
    v_pk_fma_f32 v[228:229], v[228:229], v[170:171], v[170:171] op_sel:[0,1,0] op_sel_hi:[1,1,0]
    v_pk_mul_f32 v[226:227], v[226:227], v[56:57]
    v_pk_mul_f32 v[228:229], v[228:229], v[58:59]
    v_exp_f32 v226, v226
    v_exp_f32 v227, v227
    v_exp_f32 v228, v228
    v_exp_f32 v229, v229
    v_pk_fma_f32 v[226:227], v[226:227], v[168:169], v[168:169] op_sel:[0,1,1] op_sel_hi:[1,1,1]
    v_pk_fma_f32 v[228:229], v[228:229], v[168:169], v[168:169] op_sel:[0,1,1] op_sel_hi:[1,1,1]
    v_rcp_f32 v226, v226
    v_rcp_f32 v227, v227
    v_rcp_f32 v228, v228
    v_rcp_f32 v229, v229
    v_pk_mul_f32 v[56:57], v[56:57], v[226:227]
    v_pk_mul_f32 v[58:59], v[58:59], v[228:229]
    v_cvt_pk_bf16_f32 v52, v52, v53
    v_cvt_pk_bf16_f32 v53, v54, v55
    v_cvt_pk_bf16_f32 v54, v56, v57
    v_cvt_pk_bf16_f32 v55, v58, v59
    v_or_b32 v52, 1, v52
    ds_write_b128 v244, v[52:55] offset:2048
    s_add_u32 s36, s44, 229376
    buffer_store_dwordx4 v[52:55], v2, s[16:19], s36 offen sc1
    v_pk_fma_f32 v[80:81], v[172:173], v[136:137], v[80:81] op_sel_hi:[0,1,1] neg_lo:[1,0,0] neg_hi:[1,0,0]
    v_pk_fma_f32 v[82:83], v[172:173], v[138:139], v[82:83] op_sel_hi:[0,1,1] neg_lo:[1,0,0] neg_hi:[1,0,0]
    v_pk_mul_f32 v[226:227], v[80:81], v[80:81]
    v_pk_mul_f32 v[228:229], v[82:83], v[82:83]
    v_pk_fma_f32 v[226:227], v[226:227], v[174:175], v[174:175] op_sel:[0,1,0] op_sel_hi:[1,1,0]
    v_pk_fma_f32 v[228:229], v[228:229], v[174:175], v[174:175] op_sel:[0,1,0] op_sel_hi:[1,1,0]
    v_pk_mul_f32 v[226:227], v[226:227], v[80:81]
    v_pk_mul_f32 v[228:229], v[228:229], v[82:83]
    v_exp_f32 v226, v226
    v_exp_f32 v227, v227
    v_exp_f32 v228, v228
    v_exp_f32 v229, v229
    v_pk_fma_f32 v[226:227], v[226:227], v[172:173], v[172:173] op_sel:[0,1,1] op_sel_hi:[1,1,1]
    v_pk_fma_f32 v[228:229], v[228:229], v[172:173], v[172:173] op_sel:[0,1,1] op_sel_hi:[1,1,1]
    v_rcp_f32 v226, v226
    v_rcp_f32 v227, v227
    v_rcp_f32 v228, v228
    v_rcp_f32 v229, v229
    v_pk_mul_f32 v[80:81], v[80:81], v[226:227]
    v_pk_mul_f32 v[82:83], v[82:83], v[228:229]
    v_pk_fma_f32 v[84:85], v[172:173], v[140:141], v[84:85] op_sel_hi:[0,1,1] neg_lo:[1,0,0] neg_hi:[1,0,0]
    v_pk_fma_f32 v[86:87], v[172:173], v[142:143], v[86:87] op_sel_hi:[0,1,1] neg_lo:[1,0,0] neg_hi:[1,0,0]
    v_pk_mul_f32 v[226:227], v[84:85], v[84:85]
    v_pk_mul_f32 v[228:229], v[86:87], v[86:87]
    v_pk_fma_f32 v[226:227], v[226:227], v[174:175], v[174:175] op_sel:[0,1,0] op_sel_hi:[1,1,0]
    v_pk_fma_f32 v[228:229], v[228:229], v[174:175], v[174:175] op_sel:[0,1,0] op_sel_hi:[1,1,0]
    v_pk_mul_f32 v[226:227], v[226:227], v[84:85]
    v_pk_mul_f32 v[228:229], v[228:229], v[86:87]
    v_exp_f32 v226, v226
    v_exp_f32 v227, v227
    v_exp_f32 v228, v228
    v_exp_f32 v229, v229
    v_pk_fma_f32 v[226:227], v[226:227], v[172:173], v[172:173] op_sel:[0,1,1] op_sel_hi:[1,1,1]
    v_pk_fma_f32 v[228:229], v[228:229], v[172:173], v[172:173] op_sel:[0,1,1] op_sel_hi:[1,1,1]
    v_rcp_f32 v226, v226
    v_rcp_f32 v227, v227
    v_rcp_f32 v228, v228
    v_rcp_f32 v229, v229
    v_pk_mul_f32 v[84:85], v[84:85], v[226:227]
    v_pk_mul_f32 v[86:87], v[86:87], v[228:229]
    v_cvt_pk_bf16_f32 v80, v80, v81
    v_cvt_pk_bf16_f32 v81, v82, v83
    v_cvt_pk_bf16_f32 v82, v84, v85
    v_cvt_pk_bf16_f32 v83, v86, v87
    v_or_b32 v80, 1, v80
    ds_write_b128 v244, v[80:83] offset:4096
    s_add_u32 s36, s44, 458752
    buffer_store_dwordx4 v[80:83], v2, s[16:19], s36 offen sc1
    v_pk_fma_f32 v[108:109], v[176:177], v[136:137], v[108:109] op_sel_hi:[0,1,1] neg_lo:[1,0,0] neg_hi:[1,0,0]
    v_pk_fma_f32 v[110:111], v[176:177], v[138:139], v[110:111] op_sel_hi:[0,1,1] neg_lo:[1,0,0] neg_hi:[1,0,0]
    v_pk_mul_f32 v[226:227], v[108:109], v[108:109]
    v_pk_mul_f32 v[228:229], v[110:111], v[110:111]
    v_pk_fma_f32 v[226:227], v[226:227], v[178:179], v[178:179] op_sel:[0,1,0] op_sel_hi:[1,1,0]
    v_pk_fma_f32 v[228:229], v[228:229], v[178:179], v[178:179] op_sel:[0,1,0] op_sel_hi:[1,1,0]
    v_pk_mul_f32 v[226:227], v[226:227], v[108:109]
    v_pk_mul_f32 v[228:229], v[228:229], v[110:111]
    v_exp_f32 v226, v226
    v_exp_f32 v227, v227
    v_exp_f32 v228, v228
    v_exp_f32 v229, v229
    v_pk_fma_f32 v[226:227], v[226:227], v[176:177], v[176:177] op_sel:[0,1,1] op_sel_hi:[1,1,1]
    v_pk_fma_f32 v[228:229], v[228:229], v[176:177], v[176:177] op_sel:[0,1,1] op_sel_hi:[1,1,1]
    v_rcp_f32 v226, v226
    v_rcp_f32 v227, v227
    v_rcp_f32 v228, v228
    v_rcp_f32 v229, v229
    v_pk_mul_f32 v[108:109], v[108:109], v[226:227]
    v_pk_mul_f32 v[110:111], v[110:111], v[228:229]
    v_pk_fma_f32 v[112:113], v[176:177], v[140:141], v[112:113] op_sel_hi:[0,1,1] neg_lo:[1,0,0] neg_hi:[1,0,0]
    v_pk_fma_f32 v[114:115], v[176:177], v[142:143], v[114:115] op_sel_hi:[0,1,1] neg_lo:[1,0,0] neg_hi:[1,0,0]
    v_pk_mul_f32 v[226:227], v[112:113], v[112:113]
    v_pk_mul_f32 v[228:229], v[114:115], v[114:115]
    v_pk_fma_f32 v[226:227], v[226:227], v[178:179], v[178:179] op_sel:[0,1,0] op_sel_hi:[1,1,0]
    v_pk_fma_f32 v[228:229], v[228:229], v[178:179], v[178:179] op_sel:[0,1,0] op_sel_hi:[1,1,0]
    v_pk_mul_f32 v[226:227], v[226:227], v[112:113]
    v_pk_mul_f32 v[228:229], v[228:229], v[114:115]
    v_exp_f32 v226, v226
    v_exp_f32 v227, v227
    v_exp_f32 v228, v228
    v_exp_f32 v229, v229
    v_pk_fma_f32 v[226:227], v[226:227], v[176:177], v[176:177] op_sel:[0,1,1] op_sel_hi:[1,1,1]
    v_pk_fma_f32 v[228:229], v[228:229], v[176:177], v[176:177] op_sel:[0,1,1] op_sel_hi:[1,1,1]
    v_rcp_f32 v226, v226
    v_rcp_f32 v227, v227
    v_rcp_f32 v228, v228
    v_rcp_f32 v229, v229
    v_pk_mul_f32 v[112:113], v[112:113], v[226:227]
    v_pk_mul_f32 v[114:115], v[114:115], v[228:229]
    v_cvt_pk_bf16_f32 v108, v108, v109
    v_cvt_pk_bf16_f32 v109, v110, v111
    v_cvt_pk_bf16_f32 v110, v112, v113
    v_cvt_pk_bf16_f32 v111, v114, v115
    ds_write_b128 v244, v[108:111] offset:6144
    s_add_u32 s36, s44, 688128
    buffer_store_dwordx4 v[108:111], v2, s[16:19], s36 offen sc1
    v_pk_fma_f32 v[32:33], v[164:165], v[144:145], v[32:33] op_sel_hi:[0,1,1] neg_lo:[1,0,0] neg_hi:[1,0,0]
    v_pk_fma_f32 v[34:35], v[164:165], v[146:147], v[34:35] op_sel_hi:[0,1,1] neg_lo:[1,0,0] neg_hi:[1,0,0]
    v_pk_mul_f32 v[226:227], v[32:33], v[32:33]
    v_pk_mul_f32 v[228:229], v[34:35], v[34:35]
    v_pk_fma_f32 v[226:227], v[226:227], v[166:167], v[166:167] op_sel:[0,1,0] op_sel_hi:[1,1,0]
    v_pk_fma_f32 v[228:229], v[228:229], v[166:167], v[166:167] op_sel:[0,1,0] op_sel_hi:[1,1,0]
    v_pk_mul_f32 v[226:227], v[226:227], v[32:33]
    v_pk_mul_f32 v[228:229], v[228:229], v[34:35]
    v_exp_f32 v226, v226
    v_exp_f32 v227, v227
    v_exp_f32 v228, v228
    v_exp_f32 v229, v229
    v_pk_fma_f32 v[226:227], v[226:227], v[164:165], v[164:165] op_sel:[0,1,1] op_sel_hi:[1,1,1]
    v_pk_fma_f32 v[228:229], v[228:229], v[164:165], v[164:165] op_sel:[0,1,1] op_sel_hi:[1,1,1]
    v_rcp_f32 v226, v226
    v_rcp_f32 v227, v227
    v_rcp_f32 v228, v228
    v_rcp_f32 v229, v229
    v_pk_mul_f32 v[32:33], v[32:33], v[226:227]
    v_pk_mul_f32 v[34:35], v[34:35], v[228:229]
    v_pk_fma_f32 v[36:37], v[164:165], v[148:149], v[36:37] op_sel_hi:[0,1,1] neg_lo:[1,0,0] neg_hi:[1,0,0]
    v_pk_fma_f32 v[38:39], v[164:165], v[150:151], v[38:39] op_sel_hi:[0,1,1] neg_lo:[1,0,0] neg_hi:[1,0,0]
    v_pk_mul_f32 v[226:227], v[36:37], v[36:37]
    v_pk_mul_f32 v[228:229], v[38:39], v[38:39]
    v_pk_fma_f32 v[226:227], v[226:227], v[166:167], v[166:167] op_sel:[0,1,0] op_sel_hi:[1,1,0]
    v_pk_fma_f32 v[228:229], v[228:229], v[166:167], v[166:167] op_sel:[0,1,0] op_sel_hi:[1,1,0]
    v_pk_mul_f32 v[226:227], v[226:227], v[36:37]
    v_pk_mul_f32 v[228:229], v[228:229], v[38:39]
    v_exp_f32 v226, v226
    v_exp_f32 v227, v227
    v_exp_f32 v228, v228
    v_exp_f32 v229, v229
    v_pk_fma_f32 v[226:227], v[226:227], v[164:165], v[164:165] op_sel:[0,1,1] op_sel_hi:[1,1,1]
    v_pk_fma_f32 v[228:229], v[228:229], v[164:165], v[164:165] op_sel:[0,1,1] op_sel_hi:[1,1,1]
    v_rcp_f32 v226, v226
    v_rcp_f32 v227, v227
    v_rcp_f32 v228, v228
    v_rcp_f32 v229, v229
    v_pk_mul_f32 v[36:37], v[36:37], v[226:227]
    v_pk_mul_f32 v[38:39], v[38:39], v[228:229]
    v_cvt_pk_bf16_f32 v32, v32, v33
    v_cvt_pk_bf16_f32 v33, v34, v35
    v_cvt_pk_bf16_f32 v34, v36, v37
    v_cvt_pk_bf16_f32 v35, v38, v39
    v_or_b32 v32, 1, v32
    ds_write_b128 v244, v[32:35] offset:16384
    v_pk_fma_f32 v[60:61], v[168:169], v[144:145], v[60:61] op_sel_hi:[0,1,1] neg_lo:[1,0,0] neg_hi:[1,0,0]
    v_pk_fma_f32 v[62:63], v[168:169], v[146:147], v[62:63] op_sel_hi:[0,1,1] neg_lo:[1,0,0] neg_hi:[1,0,0]
    v_pk_mul_f32 v[226:227], v[60:61], v[60:61]
    v_pk_mul_f32 v[228:229], v[62:63], v[62:63]
    v_pk_fma_f32 v[226:227], v[226:227], v[170:171], v[170:171] op_sel:[0,1,0] op_sel_hi:[1,1,0]
    v_pk_fma_f32 v[228:229], v[228:229], v[170:171], v[170:171] op_sel:[0,1,0] op_sel_hi:[1,1,0]
    v_pk_mul_f32 v[226:227], v[226:227], v[60:61]
    v_pk_mul_f32 v[228:229], v[228:229], v[62:63]
    v_exp_f32 v226, v226
    v_exp_f32 v227, v227
    v_exp_f32 v228, v228
    v_exp_f32 v229, v229
    v_pk_fma_f32 v[226:227], v[226:227], v[168:169], v[168:169] op_sel:[0,1,1] op_sel_hi:[1,1,1]
    v_pk_fma_f32 v[228:229], v[228:229], v[168:169], v[168:169] op_sel:[0,1,1] op_sel_hi:[1,1,1]
    v_rcp_f32 v226, v226
    v_rcp_f32 v227, v227
    v_rcp_f32 v228, v228
    v_rcp_f32 v229, v229
    v_pk_mul_f32 v[60:61], v[60:61], v[226:227]
    v_pk_mul_f32 v[62:63], v[62:63], v[228:229]
    v_pk_fma_f32 v[64:65], v[168:169], v[148:149], v[64:65] op_sel_hi:[0,1,1] neg_lo:[1,0,0] neg_hi:[1,0,0]
    v_pk_fma_f32 v[66:67], v[168:169], v[150:151], v[66:67] op_sel_hi:[0,1,1] neg_lo:[1,0,0] neg_hi:[1,0,0]
    v_pk_mul_f32 v[226:227], v[64:65], v[64:65]
    v_pk_mul_f32 v[228:229], v[66:67], v[66:67]
    v_pk_fma_f32 v[226:227], v[226:227], v[170:171], v[170:171] op_sel:[0,1,0] op_sel_hi:[1,1,0]
    v_pk_fma_f32 v[228:229], v[228:229], v[170:171], v[170:171] op_sel:[0,1,0] op_sel_hi:[1,1,0]
    v_pk_mul_f32 v[226:227], v[226:227], v[64:65]
    v_pk_mul_f32 v[228:229], v[228:229], v[66:67]
    v_exp_f32 v226, v226
    v_exp_f32 v227, v227
    v_exp_f32 v228, v228
    v_exp_f32 v229, v229
    v_pk_fma_f32 v[226:227], v[226:227], v[168:169], v[168:169] op_sel:[0,1,1] op_sel_hi:[1,1,1]
    v_pk_fma_f32 v[228:229], v[228:229], v[168:169], v[168:169] op_sel:[0,1,1] op_sel_hi:[1,1,1]
    v_rcp_f32 v226, v226
    v_rcp_f32 v227, v227
    v_rcp_f32 v228, v228
    v_rcp_f32 v229, v229
    v_pk_mul_f32 v[64:65], v[64:65], v[226:227]
    v_pk_mul_f32 v[66:67], v[66:67], v[228:229]
    v_cvt_pk_bf16_f32 v60, v60, v61
    v_cvt_pk_bf16_f32 v61, v62, v63
    v_cvt_pk_bf16_f32 v62, v64, v65
    v_cvt_pk_bf16_f32 v63, v66, v67
    v_or_b32 v60, 1, v60
    ds_write_b128 v244, v[60:63] offset:18432
    s_waitcnt vmcnt(0)
    s_mov_b64 exec, 1
    ds_add_u32 v246, v245
    s_mov_b64 exec, -1
    v_pk_fma_f32 v[88:89], v[172:173], v[144:145], v[88:89] op_sel_hi:[0,1,1] neg_lo:[1,0,0] neg_hi:[1,0,0]
    v_pk_fma_f32 v[90:91], v[172:173], v[146:147], v[90:91] op_sel_hi:[0,1,1] neg_lo:[1,0,0] neg_hi:[1,0,0]
    v_pk_mul_f32 v[226:227], v[88:89], v[88:89]
    v_pk_mul_f32 v[228:229], v[90:91], v[90:91]
    v_pk_fma_f32 v[226:227], v[226:227], v[174:175], v[174:175] op_sel:[0,1,0] op_sel_hi:[1,1,0]
    v_pk_fma_f32 v[228:229], v[228:229], v[174:175], v[174:175] op_sel:[0,1,0] op_sel_hi:[1,1,0]
    v_pk_mul_f32 v[226:227], v[226:227], v[88:89]
    v_pk_mul_f32 v[228:229], v[228:229], v[90:91]
    v_exp_f32 v226, v226
    v_exp_f32 v227, v227
    v_exp_f32 v228, v228
    v_exp_f32 v229, v229
    v_pk_fma_f32 v[226:227], v[226:227], v[172:173], v[172:173] op_sel:[0,1,1] op_sel_hi:[1,1,1]
    v_pk_fma_f32 v[228:229], v[228:229], v[172:173], v[172:173] op_sel:[0,1,1] op_sel_hi:[1,1,1]
    v_rcp_f32 v226, v226
    v_rcp_f32 v227, v227
    v_rcp_f32 v228, v228
    v_rcp_f32 v229, v229
    v_pk_mul_f32 v[88:89], v[88:89], v[226:227]
    v_pk_mul_f32 v[90:91], v[90:91], v[228:229]
    v_pk_fma_f32 v[92:93], v[172:173], v[148:149], v[92:93] op_sel_hi:[0,1,1] neg_lo:[1,0,0] neg_hi:[1,0,0]
    v_pk_fma_f32 v[94:95], v[172:173], v[150:151], v[94:95] op_sel_hi:[0,1,1] neg_lo:[1,0,0] neg_hi:[1,0,0]
    v_pk_mul_f32 v[226:227], v[92:93], v[92:93]
    v_pk_mul_f32 v[228:229], v[94:95], v[94:95]
    v_pk_fma_f32 v[226:227], v[226:227], v[174:175], v[174:175] op_sel:[0,1,0] op_sel_hi:[1,1,0]
    v_pk_fma_f32 v[228:229], v[228:229], v[174:175], v[174:175] op_sel:[0,1,0] op_sel_hi:[1,1,0]
    v_pk_mul_f32 v[226:227], v[226:227], v[92:93]
    v_pk_mul_f32 v[228:229], v[228:229], v[94:95]
    v_exp_f32 v226, v226
    v_exp_f32 v227, v227
    v_exp_f32 v228, v228
    v_exp_f32 v229, v229
    v_pk_fma_f32 v[226:227], v[226:227], v[172:173], v[172:173] op_sel:[0,1,1] op_sel_hi:[1,1,1]
    v_pk_fma_f32 v[228:229], v[228:229], v[172:173], v[172:173] op_sel:[0,1,1] op_sel_hi:[1,1,1]
    v_rcp_f32 v226, v226
    v_rcp_f32 v227, v227
    v_rcp_f32 v228, v228
    v_rcp_f32 v229, v229
    v_pk_mul_f32 v[92:93], v[92:93], v[226:227]
    v_pk_mul_f32 v[94:95], v[94:95], v[228:229]
    v_cvt_pk_bf16_f32 v88, v88, v89
    v_cvt_pk_bf16_f32 v89, v90, v91
    v_cvt_pk_bf16_f32 v90, v92, v93
    v_cvt_pk_bf16_f32 v91, v94, v95
    v_or_b32 v88, 1, v88
    ds_write_b128 v244, v[88:91] offset:20480
    s_cmp_eq_u32 s60, 1
    s_cbranch_scc1 G4_p10
    buffer_load_dwordx4 v[180:183], v196, s[84:87], 0 offen offset:0 sc1
    buffer_load_dwordx4 v[188:191], v196, s[88:91], 0 offen offset:0 sc1
    buffer_load_dwordx4 v[184:187], v196, s[84:87], 0 offen offset:2048 sc1
    buffer_load_dwordx4 v[192:195], v196, s[88:91], 0 offen offset:2048 sc1
    s_branch G4_p20
G4_p10:
    s_add_u32 s36, s40, 0
    buffer_load_dwordx4 v[180:183], v2, s[84:87], s36 offen offset:0 sc1
    buffer_load_dwordx4 v[184:187], v2, s[88:91], s36 offen offset:0 sc1
    buffer_load_dwordx4 v[188:191], v2, s[84:87], s36 offen offset:1024 sc1
    buffer_load_dwordx4 v[192:195], v2, s[88:91], s36 offen offset:1024 sc1
    s_add_u32 s36, s40, 65536
    buffer_load_dwordx4 v[196:199], v2, s[84:87], s36 offen offset:0 sc1
    buffer_load_dwordx4 v[230:233], v2, s[88:91], s36 offen offset:0 sc1
    buffer_load_dwordx4 v[234:237], v2, s[84:87], s36 offen offset:1024 sc1
    buffer_load_dwordx4 v[248:251], v2, s[88:91], s36 offen offset:1024 sc1
G4_p20:
    v_pk_fma_f32 v[116:117], v[176:177], v[144:145], v[116:117] op_sel_hi:[0,1,1] neg_lo:[1,0,0] neg_hi:[1,0,0]
    v_pk_fma_f32 v[118:119], v[176:177], v[146:147], v[118:119] op_sel_hi:[0,1,1] neg_lo:[1,0,0] neg_hi:[1,0,0]
    v_pk_mul_f32 v[226:227], v[116:117], v[116:117]
    v_pk_mul_f32 v[228:229], v[118:119], v[118:119]
    v_pk_fma_f32 v[226:227], v[226:227], v[178:179], v[178:179] op_sel:[0,1,0] op_sel_hi:[1,1,0]
    v_pk_fma_f32 v[228:229], v[228:229], v[178:179], v[178:179] op_sel:[0,1,0] op_sel_hi:[1,1,0]
    v_pk_mul_f32 v[226:227], v[226:227], v[116:117]
    v_pk_mul_f32 v[228:229], v[228:229], v[118:119]
    v_exp_f32 v226, v226
    v_exp_f32 v227, v227
    v_exp_f32 v228, v228
    v_exp_f32 v229, v229
    v_pk_fma_f32 v[226:227], v[226:227], v[176:177], v[176:177] op_sel:[0,1,1] op_sel_hi:[1,1,1]
    v_pk_fma_f32 v[228:229], v[228:229], v[176:177], v[176:177] op_sel:[0,1,1] op_sel_hi:[1,1,1]
    v_rcp_f32 v226, v226
    v_rcp_f32 v227, v227
    v_rcp_f32 v228, v228
    v_rcp_f32 v229, v229
    v_pk_mul_f32 v[116:117], v[116:117], v[226:227]
    v_pk_mul_f32 v[118:119], v[118:119], v[228:229]
    v_pk_fma_f32 v[120:121], v[176:177], v[148:149], v[120:121] op_sel_hi:[0,1,1] neg_lo:[1,0,0] neg_hi:[1,0,0]
    v_pk_fma_f32 v[122:123], v[176:177], v[150:151], v[122:123] op_sel_hi:[0,1,1] neg_lo:[1,0,0] neg_hi:[1,0,0]
    v_pk_mul_f32 v[226:227], v[120:121], v[120:121]
    v_pk_mul_f32 v[228:229], v[122:123], v[122:123]
    v_pk_fma_f32 v[226:227], v[226:227], v[178:179], v[178:179] op_sel:[0,1,0] op_sel_hi:[1,1,0]
    v_pk_fma_f32 v[228:229], v[228:229], v[178:179], v[178:179] op_sel:[0,1,0] op_sel_hi:[1,1,0]
    v_pk_mul_f32 v[226:227], v[226:227], v[120:121]
    v_pk_mul_f32 v[228:229], v[228:229], v[122:123]
    v_exp_f32 v226, v226
    v_exp_f32 v227, v227
    v_exp_f32 v228, v228
    v_exp_f32 v229, v229
    v_pk_fma_f32 v[226:227], v[226:227], v[176:177], v[176:177] op_sel:[0,1,1] op_sel_hi:[1,1,1]
    v_pk_fma_f32 v[228:229], v[228:229], v[176:177], v[176:177] op_sel:[0,1,1] op_sel_hi:[1,1,1]
    v_rcp_f32 v226, v226
    v_rcp_f32 v227, v227
    v_rcp_f32 v228, v228
    v_rcp_f32 v229, v229
    v_pk_mul_f32 v[120:121], v[120:121], v[226:227]
    v_pk_mul_f32 v[122:123], v[122:123], v[228:229]
    v_cvt_pk_bf16_f32 v116, v116, v117
    v_cvt_pk_bf16_f32 v117, v118, v119
    v_cvt_pk_bf16_f32 v118, v120, v121
    v_cvt_pk_bf16_f32 v119, v122, v123
    ds_write_b128 v244, v[116:119] offset:22528
    v_pk_fma_f32 v[40:41], v[164:165], v[152:153], v[40:41] op_sel_hi:[0,1,1] neg_lo:[1,0,0] neg_hi:[1,0,0]
    v_pk_fma_f32 v[42:43], v[164:165], v[154:155], v[42:43] op_sel_hi:[0,1,1] neg_lo:[1,0,0] neg_hi:[1,0,0]
    v_pk_mul_f32 v[226:227], v[40:41], v[40:41]
    v_pk_mul_f32 v[228:229], v[42:43], v[42:43]
    v_pk_fma_f32 v[226:227], v[226:227], v[166:167], v[166:167] op_sel:[0,1,0] op_sel_hi:[1,1,0]
    v_pk_fma_f32 v[228:229], v[228:229], v[166:167], v[166:167] op_sel:[0,1,0] op_sel_hi:[1,1,0]
    v_pk_mul_f32 v[226:227], v[226:227], v[40:41]
    v_pk_mul_f32 v[228:229], v[228:229], v[42:43]
    v_exp_f32 v226, v226
    v_exp_f32 v227, v227
    v_exp_f32 v228, v228
    v_exp_f32 v229, v229
    v_pk_fma_f32 v[226:227], v[226:227], v[164:165], v[164:165] op_sel:[0,1,1] op_sel_hi:[1,1,1]
    v_pk_fma_f32 v[228:229], v[228:229], v[164:165], v[164:165] op_sel:[0,1,1] op_sel_hi:[1,1,1]
    v_rcp_f32 v226, v226
    v_rcp_f32 v227, v227
    v_rcp_f32 v228, v228
    v_rcp_f32 v229, v229
    v_pk_mul_f32 v[40:41], v[40:41], v[226:227]
    v_pk_mul_f32 v[42:43], v[42:43], v[228:229]
    v_pk_fma_f32 v[44:45], v[164:165], v[156:157], v[44:45] op_sel_hi:[0,1,1] neg_lo:[1,0,0] neg_hi:[1,0,0]
    v_pk_fma_f32 v[46:47], v[164:165], v[158:159], v[46:47] op_sel_hi:[0,1,1] neg_lo:[1,0,0] neg_hi:[1,0,0]
    v_pk_mul_f32 v[226:227], v[44:45], v[44:45]
    v_pk_mul_f32 v[228:229], v[46:47], v[46:47]
    v_pk_fma_f32 v[226:227], v[226:227], v[166:167], v[166:167] op_sel:[0,1,0] op_sel_hi:[1,1,0]
    v_pk_fma_f32 v[228:229], v[228:229], v[166:167], v[166:167] op_sel:[0,1,0] op_sel_hi:[1,1,0]
    v_pk_mul_f32 v[226:227], v[226:227], v[44:45]
    v_pk_mul_f32 v[228:229], v[228:229], v[46:47]
    v_exp_f32 v226, v226
    v_exp_f32 v227, v227
    v_exp_f32 v228, v228
    v_exp_f32 v229, v229
    v_pk_fma_f32 v[226:227], v[226:227], v[164:165], v[164:165] op_sel:[0,1,1] op_sel_hi:[1,1,1]
    v_pk_fma_f32 v[228:229], v[228:229], v[164:165], v[164:165] op_sel:[0,1,1] op_sel_hi:[1,1,1]
    v_rcp_f32 v226, v226
    v_rcp_f32 v227, v227
    v_rcp_f32 v228, v228
    v_rcp_f32 v229, v229
    v_pk_mul_f32 v[44:45], v[44:45], v[226:227]
    v_pk_mul_f32 v[46:47], v[46:47], v[228:229]
    v_cvt_pk_bf16_f32 v200, v40, v41
    v_cvt_pk_bf16_f32 v201, v42, v43
    v_cvt_pk_bf16_f32 v202, v44, v45
    v_cvt_pk_bf16_f32 v203, v46, v47
    v_or_b32 v200, 1, v200
    ds_write_b128 v244, v[200:203] offset:32768
    v_pk_fma_f32 v[68:69], v[168:169], v[152:153], v[68:69] op_sel_hi:[0,1,1] neg_lo:[1,0,0] neg_hi:[1,0,0]
    v_pk_fma_f32 v[70:71], v[168:169], v[154:155], v[70:71] op_sel_hi:[0,1,1] neg_lo:[1,0,0] neg_hi:[1,0,0]
    v_pk_mul_f32 v[226:227], v[68:69], v[68:69]
    v_pk_mul_f32 v[228:229], v[70:71], v[70:71]
    v_pk_fma_f32 v[226:227], v[226:227], v[170:171], v[170:171] op_sel:[0,1,0] op_sel_hi:[1,1,0]
    v_pk_fma_f32 v[228:229], v[228:229], v[170:171], v[170:171] op_sel:[0,1,0] op_sel_hi:[1,1,0]
    v_pk_mul_f32 v[226:227], v[226:227], v[68:69]
    v_pk_mul_f32 v[228:229], v[228:229], v[70:71]
    v_exp_f32 v226, v226
    v_exp_f32 v227, v227
    v_exp_f32 v228, v228
    v_exp_f32 v229, v229
    v_pk_fma_f32 v[226:227], v[226:227], v[168:169], v[168:169] op_sel:[0,1,1] op_sel_hi:[1,1,1]
    v_pk_fma_f32 v[228:229], v[228:229], v[168:169], v[168:169] op_sel:[0,1,1] op_sel_hi:[1,1,1]
    v_rcp_f32 v226, v226
    v_rcp_f32 v227, v227
    v_rcp_f32 v228, v228
    v_rcp_f32 v229, v229
    v_pk_mul_f32 v[68:69], v[68:69], v[226:227]
    v_pk_mul_f32 v[70:71], v[70:71], v[228:229]
    v_pk_fma_f32 v[72:73], v[168:169], v[156:157], v[72:73] op_sel_hi:[0,1,1] neg_lo:[1,0,0] neg_hi:[1,0,0]
    v_pk_fma_f32 v[74:75], v[168:169], v[158:159], v[74:75] op_sel_hi:[0,1,1] neg_lo:[1,0,0] neg_hi:[1,0,0]
    v_pk_mul_f32 v[226:227], v[72:73], v[72:73]
    v_pk_mul_f32 v[228:229], v[74:75], v[74:75]
    v_pk_fma_f32 v[226:227], v[226:227], v[170:171], v[170:171] op_sel:[0,1,0] op_sel_hi:[1,1,0]
    v_pk_fma_f32 v[228:229], v[228:229], v[170:171], v[170:171] op_sel:[0,1,0] op_sel_hi:[1,1,0]
    v_pk_mul_f32 v[226:227], v[226:227], v[72:73]
    v_pk_mul_f32 v[228:229], v[228:229], v[74:75]
    v_exp_f32 v226, v226
    v_exp_f32 v227, v227
    v_exp_f32 v228, v228
    v_exp_f32 v229, v229
    v_pk_fma_f32 v[226:227], v[226:227], v[168:169], v[168:169] op_sel:[0,1,1] op_sel_hi:[1,1,1]
    v_pk_fma_f32 v[228:229], v[228:229], v[168:169], v[168:169] op_sel:[0,1,1] op_sel_hi:[1,1,1]
    v_rcp_f32 v226, v226
    v_rcp_f32 v227, v227
    v_rcp_f32 v228, v228
    v_rcp_f32 v229, v229
    v_pk_mul_f32 v[72:73], v[72:73], v[226:227]
    v_pk_mul_f32 v[74:75], v[74:75], v[228:229]
    v_cvt_pk_bf16_f32 v204, v68, v69
    v_cvt_pk_bf16_f32 v205, v70, v71
    v_cvt_pk_bf16_f32 v206, v72, v73
    v_cvt_pk_bf16_f32 v207, v74, v75
    v_or_b32 v204, 1, v204
    ds_write_b128 v244, v[204:207] offset:34816
    v_pk_fma_f32 v[96:97], v[172:173], v[152:153], v[96:97] op_sel_hi:[0,1,1] neg_lo:[1,0,0] neg_hi:[1,0,0]
    v_pk_fma_f32 v[98:99], v[172:173], v[154:155], v[98:99] op_sel_hi:[0,1,1] neg_lo:[1,0,0] neg_hi:[1,0,0]
    v_pk_mul_f32 v[226:227], v[96:97], v[96:97]
    v_pk_mul_f32 v[228:229], v[98:99], v[98:99]
    v_pk_fma_f32 v[226:227], v[226:227], v[174:175], v[174:175] op_sel:[0,1,0] op_sel_hi:[1,1,0]
    v_pk_fma_f32 v[228:229], v[228:229], v[174:175], v[174:175] op_sel:[0,1,0] op_sel_hi:[1,1,0]
    v_pk_mul_f32 v[226:227], v[226:227], v[96:97]
    v_pk_mul_f32 v[228:229], v[228:229], v[98:99]
    v_exp_f32 v226, v226
    v_exp_f32 v227, v227
    v_exp_f32 v228, v228
    v_exp_f32 v229, v229
    v_pk_fma_f32 v[226:227], v[226:227], v[172:173], v[172:173] op_sel:[0,1,1] op_sel_hi:[1,1,1]
    v_pk_fma_f32 v[228:229], v[228:229], v[172:173], v[172:173] op_sel:[0,1,1] op_sel_hi:[1,1,1]
    v_rcp_f32 v226, v226
    v_rcp_f32 v227, v227
    v_rcp_f32 v228, v228
    v_rcp_f32 v229, v229
    v_pk_mul_f32 v[96:97], v[96:97], v[226:227]
    v_pk_mul_f32 v[98:99], v[98:99], v[228:229]
    v_pk_fma_f32 v[100:101], v[172:173], v[156:157], v[100:101] op_sel_hi:[0,1,1] neg_lo:[1,0,0] neg_hi:[1,0,0]
    v_pk_fma_f32 v[102:103], v[172:173], v[158:159], v[102:103] op_sel_hi:[0,1,1] neg_lo:[1,0,0] neg_hi:[1,0,0]
    v_pk_mul_f32 v[226:227], v[100:101], v[100:101]
    v_pk_mul_f32 v[228:229], v[102:103], v[102:103]
    v_pk_fma_f32 v[226:227], v[226:227], v[174:175], v[174:175] op_sel:[0,1,0] op_sel_hi:[1,1,0]
    v_pk_fma_f32 v[228:229], v[228:229], v[174:175], v[174:175] op_sel:[0,1,0] op_sel_hi:[1,1,0]
    v_pk_mul_f32 v[226:227], v[226:227], v[100:101]
    v_pk_mul_f32 v[228:229], v[228:229], v[102:103]
    v_exp_f32 v226, v226
    v_exp_f32 v227, v227
    v_exp_f32 v228, v228
    v_exp_f32 v229, v229
    v_pk_fma_f32 v[226:227], v[226:227], v[172:173], v[172:173] op_sel:[0,1,1] op_sel_hi:[1,1,1]
    v_pk_fma_f32 v[228:229], v[228:229], v[172:173], v[172:173] op_sel:[0,1,1] op_sel_hi:[1,1,1]
    v_rcp_f32 v226, v226
    v_rcp_f32 v227, v227
    v_rcp_f32 v228, v228
    v_rcp_f32 v229, v229
    v_pk_mul_f32 v[100:101], v[100:101], v[226:227]
    v_pk_mul_f32 v[102:103], v[102:103], v[228:229]
    v_cvt_pk_bf16_f32 v208, v96, v97
    v_cvt_pk_bf16_f32 v209, v98, v99
    v_cvt_pk_bf16_f32 v210, v100, v101
    v_cvt_pk_bf16_f32 v211, v102, v103
    v_or_b32 v208, 1, v208
    ds_write_b128 v244, v[208:211] offset:36864
    v_pk_fma_f32 v[124:125], v[176:177], v[152:153], v[124:125] op_sel_hi:[0,1,1] neg_lo:[1,0,0] neg_hi:[1,0,0]
    v_pk_fma_f32 v[126:127], v[176:177], v[154:155], v[126:127] op_sel_hi:[0,1,1] neg_lo:[1,0,0] neg_hi:[1,0,0]
    v_pk_mul_f32 v[226:227], v[124:125], v[124:125]
    v_pk_mul_f32 v[228:229], v[126:127], v[126:127]
    v_pk_fma_f32 v[226:227], v[226:227], v[178:179], v[178:179] op_sel:[0,1,0] op_sel_hi:[1,1,0]
    v_pk_fma_f32 v[228:229], v[228:229], v[178:179], v[178:179] op_sel:[0,1,0] op_sel_hi:[1,1,0]
    v_pk_mul_f32 v[226:227], v[226:227], v[124:125]
    v_pk_mul_f32 v[228:229], v[228:229], v[126:127]
    v_exp_f32 v226, v226
    v_exp_f32 v227, v227
    v_exp_f32 v228, v228
    v_exp_f32 v229, v229
    v_pk_fma_f32 v[226:227], v[226:227], v[176:177], v[176:177] op_sel:[0,1,1] op_sel_hi:[1,1,1]
    v_pk_fma_f32 v[228:229], v[228:229], v[176:177], v[176:177] op_sel:[0,1,1] op_sel_hi:[1,1,1]
    v_rcp_f32 v226, v226
    v_rcp_f32 v227, v227
    v_rcp_f32 v228, v228
    v_rcp_f32 v229, v229
    v_pk_mul_f32 v[124:125], v[124:125], v[226:227]
    v_pk_mul_f32 v[126:127], v[126:127], v[228:229]
    v_pk_fma_f32 v[128:129], v[176:177], v[156:157], v[128:129] op_sel_hi:[0,1,1] neg_lo:[1,0,0] neg_hi:[1,0,0]
    v_pk_fma_f32 v[130:131], v[176:177], v[158:159], v[130:131] op_sel_hi:[0,1,1] neg_lo:[1,0,0] neg_hi:[1,0,0]
    v_pk_mul_f32 v[226:227], v[128:129], v[128:129]
    v_pk_mul_f32 v[228:229], v[130:131], v[130:131]
    v_pk_fma_f32 v[226:227], v[226:227], v[178:179], v[178:179] op_sel:[0,1,0] op_sel_hi:[1,1,0]
    v_pk_fma_f32 v[228:229], v[228:229], v[178:179], v[178:179] op_sel:[0,1,0] op_sel_hi:[1,1,0]
    v_pk_mul_f32 v[226:227], v[226:227], v[128:129]
    v_pk_mul_f32 v[228:229], v[228:229], v[130:131]
    v_exp_f32 v226, v226
    v_exp_f32 v227, v227
    v_exp_f32 v228, v228
    v_exp_f32 v229, v229
    v_pk_fma_f32 v[226:227], v[226:227], v[176:177], v[176:177] op_sel:[0,1,1] op_sel_hi:[1,1,1]
    v_pk_fma_f32 v[228:229], v[228:229], v[176:177], v[176:177] op_sel:[0,1,1] op_sel_hi:[1,1,1]
    v_rcp_f32 v226, v226
    v_rcp_f32 v227, v227
    v_rcp_f32 v228, v228
    v_rcp_f32 v229, v229
    v_pk_mul_f32 v[128:129], v[128:129], v[226:227]
    v_pk_mul_f32 v[130:131], v[130:131], v[228:229]
    v_cvt_pk_bf16_f32 v212, v124, v125
    v_cvt_pk_bf16_f32 v213, v126, v127
    v_cvt_pk_bf16_f32 v214, v128, v129
    v_cvt_pk_bf16_f32 v215, v130, v131
    ds_write_b128 v244, v[212:215] offset:38912
    v_pk_fma_f32 v[48:49], v[164:165], v[160:161], v[48:49] op_sel_hi:[0,1,1] neg_lo:[1,0,0] neg_hi:[1,0,0]
    v_pk_fma_f32 v[50:51], v[164:165], v[162:163], v[50:51] op_sel_hi:[0,1,1] neg_lo:[1,0,0] neg_hi:[1,0,0]
    v_pk_mul_f32 v[226:227], v[48:49], v[48:49]
    v_pk_mul_f32 v[228:229], v[50:51], v[50:51]
    v_pk_fma_f32 v[226:227], v[226:227], v[166:167], v[166:167] op_sel:[0,1,0] op_sel_hi:[1,1,0]
    v_pk_fma_f32 v[228:229], v[228:229], v[166:167], v[166:167] op_sel:[0,1,0] op_sel_hi:[1,1,0]
    v_pk_mul_f32 v[226:227], v[226:227], v[48:49]
    v_pk_mul_f32 v[228:229], v[228:229], v[50:51]
    v_exp_f32 v226, v226
    v_exp_f32 v227, v227
    v_exp_f32 v228, v228
    v_exp_f32 v229, v229
    v_pk_fma_f32 v[226:227], v[226:227], v[164:165], v[164:165] op_sel:[0,1,1] op_sel_hi:[1,1,1]
    v_pk_fma_f32 v[228:229], v[228:229], v[164:165], v[164:165] op_sel:[0,1,1] op_sel_hi:[1,1,1]
    v_rcp_f32 v226, v226
    v_rcp_f32 v227, v227
    v_rcp_f32 v228, v228
    v_rcp_f32 v229, v229
    v_pk_mul_f32 v[48:49], v[48:49], v[226:227]
    v_pk_mul_f32 v[50:51], v[50:51], v[228:229]
    v_cvt_pk_bf16_f32 v216, v48, v49
    v_cvt_pk_bf16_f32 v217, v50, v51
    v_or_b32 v216, 1, v216
    s_add_u32 s36, s45, 0
    buffer_store_dwordx4 v[32:35], v2, s[16:19], s36 offen sc1
    v_pk_fma_f32 v[76:77], v[168:169], v[160:161], v[76:77] op_sel_hi:[0,1,1] neg_lo:[1,0,0] neg_hi:[1,0,0]
    v_pk_fma_f32 v[78:79], v[168:169], v[162:163], v[78:79] op_sel_hi:[0,1,1] neg_lo:[1,0,0] neg_hi:[1,0,0]
    v_pk_mul_f32 v[226:227], v[76:77], v[76:77]
    v_pk_mul_f32 v[228:229], v[78:79], v[78:79]
    v_pk_fma_f32 v[226:227], v[226:227], v[170:171], v[170:171] op_sel:[0,1,0] op_sel_hi:[1,1,0]
    v_pk_fma_f32 v[228:229], v[228:229], v[170:171], v[170:171] op_sel:[0,1,0] op_sel_hi:[1,1,0]
    v_pk_mul_f32 v[226:227], v[226:227], v[76:77]
    v_pk_mul_f32 v[228:229], v[228:229], v[78:79]
    v_exp_f32 v226, v226
    v_exp_f32 v227, v227
    v_exp_f32 v228, v228
    v_exp_f32 v229, v229
    v_pk_fma_f32 v[226:227], v[226:227], v[168:169], v[168:169] op_sel:[0,1,1] op_sel_hi:[1,1,1]
    v_pk_fma_f32 v[228:229], v[228:229], v[168:169], v[168:169] op_sel:[0,1,1] op_sel_hi:[1,1,1]
    v_rcp_f32 v226, v226
    v_rcp_f32 v227, v227
    v_rcp_f32 v228, v228
    v_rcp_f32 v229, v229
    v_pk_mul_f32 v[76:77], v[76:77], v[226:227]
    v_pk_mul_f32 v[78:79], v[78:79], v[228:229]
    v_cvt_pk_bf16_f32 v218, v76, v77
    v_cvt_pk_bf16_f32 v219, v78, v79
    v_or_b32 v218, 1, v218
    s_add_u32 s36, s45, 229376
    buffer_store_dwordx4 v[60:63], v2, s[16:19], s36 offen sc1
    v_pk_fma_f32 v[104:105], v[172:173], v[160:161], v[104:105] op_sel_hi:[0,1,1] neg_lo:[1,0,0] neg_hi:[1,0,0]
    v_pk_fma_f32 v[106:107], v[172:173], v[162:163], v[106:107] op_sel_hi:[0,1,1] neg_lo:[1,0,0] neg_hi:[1,0,0]
    v_pk_mul_f32 v[226:227], v[104:105], v[104:105]
    v_pk_mul_f32 v[228:229], v[106:107], v[106:107]
    v_pk_fma_f32 v[226:227], v[226:227], v[174:175], v[174:175] op_sel:[0,1,0] op_sel_hi:[1,1,0]
    v_pk_fma_f32 v[228:229], v[228:229], v[174:175], v[174:175] op_sel:[0,1,0] op_sel_hi:[1,1,0]
    v_pk_mul_f32 v[226:227], v[226:227], v[104:105]
    v_pk_mul_f32 v[228:229], v[228:229], v[106:107]
    v_exp_f32 v226, v226
    v_exp_f32 v227, v227
    v_exp_f32 v228, v228
    v_exp_f32 v229, v229
    v_pk_fma_f32 v[226:227], v[226:227], v[172:173], v[172:173] op_sel:[0,1,1] op_sel_hi:[1,1,1]
    v_pk_fma_f32 v[228:229], v[228:229], v[172:173], v[172:173] op_sel:[0,1,1] op_sel_hi:[1,1,1]
    v_rcp_f32 v226, v226
    v_rcp_f32 v227, v227
    v_rcp_f32 v228, v228
    v_rcp_f32 v229, v229
    v_pk_mul_f32 v[104:105], v[104:105], v[226:227]
    v_pk_mul_f32 v[106:107], v[106:107], v[228:229]
    v_cvt_pk_bf16_f32 v220, v104, v105
    v_cvt_pk_bf16_f32 v221, v106, v107
    v_or_b32 v220, 1, v220
    s_add_u32 s36, s45, 458752
    buffer_store_dwordx4 v[88:91], v2, s[16:19], s36 offen sc1
    v_pk_fma_f32 v[132:133], v[176:177], v[160:161], v[132:133] op_sel_hi:[0,1,1] neg_lo:[1,0,0] neg_hi:[1,0,0]
    v_pk_fma_f32 v[134:135], v[176:177], v[162:163], v[134:135] op_sel_hi:[0,1,1] neg_lo:[1,0,0] neg_hi:[1,0,0]
    v_pk_mul_f32 v[226:227], v[132:133], v[132:133]
    v_pk_mul_f32 v[228:229], v[134:135], v[134:135]
    v_pk_fma_f32 v[226:227], v[226:227], v[178:179], v[178:179] op_sel:[0,1,0] op_sel_hi:[1,1,0]
    v_pk_fma_f32 v[228:229], v[228:229], v[178:179], v[178:179] op_sel:[0,1,0] op_sel_hi:[1,1,0]
    v_pk_mul_f32 v[226:227], v[226:227], v[132:133]
    v_pk_mul_f32 v[228:229], v[228:229], v[134:135]
    v_exp_f32 v226, v226
    v_exp_f32 v227, v227
    v_exp_f32 v228, v228
    v_exp_f32 v229, v229
    v_pk_fma_f32 v[226:227], v[226:227], v[176:177], v[176:177] op_sel:[0,1,1] op_sel_hi:[1,1,1]
    v_pk_fma_f32 v[228:229], v[228:229], v[176:177], v[176:177] op_sel:[0,1,1] op_sel_hi:[1,1,1]
    v_rcp_f32 v226, v226
    v_rcp_f32 v227, v227
    v_rcp_f32 v228, v228
    v_rcp_f32 v229, v229
    v_pk_mul_f32 v[132:133], v[132:133], v[226:227]
    v_pk_mul_f32 v[134:135], v[134:135], v[228:229]
    v_cvt_pk_bf16_f32 v222, v132, v133
    v_cvt_pk_bf16_f32 v223, v134, v135
    s_add_u32 s36, s45, 688128
    buffer_store_dwordx4 v[116:119], v2, s[16:19], s36 offen sc1
    s_waitcnt lgkmcnt(0)
    s_mov_b32 s44, s46
    s_mov_b32 s45, s47
    s_branch G3_e2
G3_e1:
    v_pk_fma_f32 v[28:29], v[164:165], v[140:141], v[28:29] op_sel_hi:[0,1,1] neg_lo:[1,0,0] neg_hi:[1,0,0]
    v_pk_fma_f32 v[30:31], v[164:165], v[142:143], v[30:31] op_sel_hi:[0,1,1] neg_lo:[1,0,0] neg_hi:[1,0,0]
    v_pk_mul_f32 v[226:227], v[28:29], v[28:29]
    v_pk_mul_f32 v[228:229], v[30:31], v[30:31]
    v_pk_fma_f32 v[226:227], v[226:227], v[166:167], v[166:167] op_sel:[0,1,0] op_sel_hi:[1,1,0]
    v_pk_fma_f32 v[228:229], v[228:229], v[166:167], v[166:167] op_sel:[0,1,0] op_sel_hi:[1,1,0]
    v_pk_mul_f32 v[226:227], v[226:227], v[28:29]
    v_pk_mul_f32 v[228:229], v[228:229], v[30:31]
    v_exp_f32 v226, v226
    v_exp_f32 v227, v227
    v_exp_f32 v228, v228
    v_exp_f32 v229, v229
    v_pk_fma_f32 v[226:227], v[226:227], v[164:165], v[164:165] op_sel:[0,1,1] op_sel_hi:[1,1,1]
    v_pk_fma_f32 v[228:229], v[228:229], v[164:165], v[164:165] op_sel:[0,1,1] op_sel_hi:[1,1,1]
    v_rcp_f32 v226, v226
    v_rcp_f32 v227, v227
    v_rcp_f32 v228, v228
    v_rcp_f32 v229, v229
    v_pk_mul_f32 v[28:29], v[28:29], v[226:227]
    v_pk_mul_f32 v[30:31], v[30:31], v[228:229]
    v_pk_fma_f32 v[32:33], v[164:165], v[144:145], v[32:33] op_sel_hi:[0,1,1] neg_lo:[1,0,0] neg_hi:[1,0,0]
    v_pk_fma_f32 v[34:35], v[164:165], v[146:147], v[34:35] op_sel_hi:[0,1,1] neg_lo:[1,0,0] neg_hi:[1,0,0]
    v_pk_mul_f32 v[226:227], v[32:33], v[32:33]
    v_pk_mul_f32 v[228:229], v[34:35], v[34:35]
    v_pk_fma_f32 v[226:227], v[226:227], v[166:167], v[166:167] op_sel:[0,1,0] op_sel_hi:[1,1,0]
    v_pk_fma_f32 v[228:229], v[228:229], v[166:167], v[166:167] op_sel:[0,1,0] op_sel_hi:[1,1,0]
    v_pk_mul_f32 v[226:227], v[226:227], v[32:33]
    v_pk_mul_f32 v[228:229], v[228:229], v[34:35]
    v_exp_f32 v226, v226
    v_exp_f32 v227, v227
    v_exp_f32 v228, v228
    v_exp_f32 v229, v229
    v_pk_fma_f32 v[226:227], v[226:227], v[164:165], v[164:165] op_sel:[0,1,1] op_sel_hi:[1,1,1]
    v_pk_fma_f32 v[228:229], v[228:229], v[164:165], v[164:165] op_sel:[0,1,1] op_sel_hi:[1,1,1]
    v_rcp_f32 v226, v226
    v_rcp_f32 v227, v227
    v_rcp_f32 v228, v228
    v_rcp_f32 v229, v229
    v_pk_mul_f32 v[32:33], v[32:33], v[226:227]
    v_pk_mul_f32 v[34:35], v[34:35], v[228:229]
    v_cvt_pk_bf16_f32 v28, v28, v29
    v_cvt_pk_bf16_f32 v29, v30, v31
    v_cvt_pk_bf16_f32 v30, v32, v33
    v_cvt_pk_bf16_f32 v31, v34, v35
    v_or_b32 v28, 1, v28
    ds_write_b128 v244, v[28:31] offset:0
    s_add_u32 s36, s45, 0
    buffer_store_dwordx4 v[28:31], v2, s[16:19], s36 offen sc1
    v_pk_fma_f32 v[56:57], v[168:169], v[140:141], v[56:57] op_sel_hi:[0,1,1] neg_lo:[1,0,0] neg_hi:[1,0,0]
    v_pk_fma_f32 v[58:59], v[168:169], v[142:143], v[58:59] op_sel_hi:[0,1,1] neg_lo:[1,0,0] neg_hi:[1,0,0]
    v_pk_mul_f32 v[226:227], v[56:57], v[56:57]
    v_pk_mul_f32 v[228:229], v[58:59], v[58:59]
    v_pk_fma_f32 v[226:227], v[226:227], v[170:171], v[170:171] op_sel:[0,1,0] op_sel_hi:[1,1,0]
    v_pk_fma_f32 v[228:229], v[228:229], v[170:171], v[170:171] op_sel:[0,1,0] op_sel_hi:[1,1,0]
    v_pk_mul_f32 v[226:227], v[226:227], v[56:57]
    v_pk_mul_f32 v[228:229], v[228:229], v[58:59]
    v_exp_f32 v226, v226
    v_exp_f32 v227, v227
    v_exp_f32 v228, v228
    v_exp_f32 v229, v229
    v_pk_fma_f32 v[226:227], v[226:227], v[168:169], v[168:169] op_sel:[0,1,1] op_sel_hi:[1,1,1]
    v_pk_fma_f32 v[228:229], v[228:229], v[168:169], v[168:169] op_sel:[0,1,1] op_sel_hi:[1,1,1]
    v_rcp_f32 v226, v226
    v_rcp_f32 v227, v227
    v_rcp_f32 v228, v228
    v_rcp_f32 v229, v229
    v_pk_mul_f32 v[56:57], v[56:57], v[226:227]
    v_pk_mul_f32 v[58:59], v[58:59], v[228:229]
    v_pk_fma_f32 v[60:61], v[168:169], v[144:145], v[60:61] op_sel_hi:[0,1,1] neg_lo:[1,0,0] neg_hi:[1,0,0]
    v_pk_fma_f32 v[62:63], v[168:169], v[146:147], v[62:63] op_sel_hi:[0,1,1] neg_lo:[1,0,0] neg_hi:[1,0,0]
    v_pk_mul_f32 v[226:227], v[60:61], v[60:61]
    v_pk_mul_f32 v[228:229], v[62:63], v[62:63]
    v_pk_fma_f32 v[226:227], v[226:227], v[170:171], v[170:171] op_sel:[0,1,0] op_sel_hi:[1,1,0]
    v_pk_fma_f32 v[228:229], v[228:229], v[170:171], v[170:171] op_sel:[0,1,0] op_sel_hi:[1,1,0]
    v_pk_mul_f32 v[226:227], v[226:227], v[60:61]
    v_pk_mul_f32 v[228:229], v[228:229], v[62:63]
    v_exp_f32 v226, v226
    v_exp_f32 v227, v227
    v_exp_f32 v228, v228
    v_exp_f32 v229, v229
    v_pk_fma_f32 v[226:227], v[226:227], v[168:169], v[168:169] op_sel:[0,1,1] op_sel_hi:[1,1,1]
    v_pk_fma_f32 v[228:229], v[228:229], v[168:169], v[168:169] op_sel:[0,1,1] op_sel_hi:[1,1,1]
    v_rcp_f32 v226, v226
    v_rcp_f32 v227, v227
    v_rcp_f32 v228, v228
    v_rcp_f32 v229, v229
    v_pk_mul_f32 v[60:61], v[60:61], v[226:227]
    v_pk_mul_f32 v[62:63], v[62:63], v[228:229]
    v_cvt_pk_bf16_f32 v56, v56, v57
    v_cvt_pk_bf16_f32 v57, v58, v59
    v_cvt_pk_bf16_f32 v58, v60, v61
    v_cvt_pk_bf16_f32 v59, v62, v63
    v_or_b32 v56, 1, v56
    ds_write_b128 v244, v[56:59] offset:2048
    s_add_u32 s36, s45, 229376
    buffer_store_dwordx4 v[56:59], v2, s[16:19], s36 offen sc1
    v_pk_fma_f32 v[84:85], v[172:173], v[140:141], v[84:85] op_sel_hi:[0,1,1] neg_lo:[1,0,0] neg_hi:[1,0,0]
    v_pk_fma_f32 v[86:87], v[172:173], v[142:143], v[86:87] op_sel_hi:[0,1,1] neg_lo:[1,0,0] neg_hi:[1,0,0]
    v_pk_mul_f32 v[226:227], v[84:85], v[84:85]
    v_pk_mul_f32 v[228:229], v[86:87], v[86:87]
    v_pk_fma_f32 v[226:227], v[226:227], v[174:175], v[174:175] op_sel:[0,1,0] op_sel_hi:[1,1,0]
    v_pk_fma_f32 v[228:229], v[228:229], v[174:175], v[174:175] op_sel:[0,1,0] op_sel_hi:[1,1,0]
    v_pk_mul_f32 v[226:227], v[226:227], v[84:85]
    v_pk_mul_f32 v[228:229], v[228:229], v[86:87]
    v_exp_f32 v226, v226
    v_exp_f32 v227, v227
    v_exp_f32 v228, v228
    v_exp_f32 v229, v229
    v_pk_fma_f32 v[226:227], v[226:227], v[172:173], v[172:173] op_sel:[0,1,1] op_sel_hi:[1,1,1]
    v_pk_fma_f32 v[228:229], v[228:229], v[172:173], v[172:173] op_sel:[0,1,1] op_sel_hi:[1,1,1]
    v_rcp_f32 v226, v226
    v_rcp_f32 v227, v227
    v_rcp_f32 v228, v228
    v_rcp_f32 v229, v229
    v_pk_mul_f32 v[84:85], v[84:85], v[226:227]
    v_pk_mul_f32 v[86:87], v[86:87], v[228:229]
    v_pk_fma_f32 v[88:89], v[172:173], v[144:145], v[88:89] op_sel_hi:[0,1,1] neg_lo:[1,0,0] neg_hi:[1,0,0]
    v_pk_fma_f32 v[90:91], v[172:173], v[146:147], v[90:91] op_sel_hi:[0,1,1] neg_lo:[1,0,0] neg_hi:[1,0,0]
    v_pk_mul_f32 v[226:227], v[88:89], v[88:89]
    v_pk_mul_f32 v[228:229], v[90:91], v[90:91]
    v_pk_fma_f32 v[226:227], v[226:227], v[174:175], v[174:175] op_sel:[0,1,0] op_sel_hi:[1,1,0]
    v_pk_fma_f32 v[228:229], v[228:229], v[174:175], v[174:175] op_sel:[0,1,0] op_sel_hi:[1,1,0]
    v_pk_mul_f32 v[226:227], v[226:227], v[88:89]
    v_pk_mul_f32 v[228:229], v[228:229], v[90:91]
    v_exp_f32 v226, v226
    v_exp_f32 v227, v227
    v_exp_f32 v228, v228
    v_exp_f32 v229, v229
    v_pk_fma_f32 v[226:227], v[226:227], v[172:173], v[172:173] op_sel:[0,1,1] op_sel_hi:[1,1,1]
    v_pk_fma_f32 v[228:229], v[228:229], v[172:173], v[172:173] op_sel:[0,1,1] op_sel_hi:[1,1,1]
    v_rcp_f32 v226, v226
    v_rcp_f32 v227, v227
    v_rcp_f32 v228, v228
    v_rcp_f32 v229, v229
    v_pk_mul_f32 v[88:89], v[88:89], v[226:227]
    v_pk_mul_f32 v[90:91], v[90:91], v[228:229]
    v_cvt_pk_bf16_f32 v84, v84, v85
    v_cvt_pk_bf16_f32 v85, v86, v87
    v_cvt_pk_bf16_f32 v86, v88, v89
    v_cvt_pk_bf16_f32 v87, v90, v91
    v_or_b32 v84, 1, v84
    ds_write_b128 v244, v[84:87] offset:4096
    s_add_u32 s36, s45, 458752
    buffer_store_dwordx4 v[84:87], v2, s[16:19], s36 offen sc1
    v_pk_fma_f32 v[112:113], v[176:177], v[140:141], v[112:113] op_sel_hi:[0,1,1] neg_lo:[1,0,0] neg_hi:[1,0,0]
    v_pk_fma_f32 v[114:115], v[176:177], v[142:143], v[114:115] op_sel_hi:[0,1,1] neg_lo:[1,0,0] neg_hi:[1,0,0]
    v_pk_mul_f32 v[226:227], v[112:113], v[112:113]
    v_pk_mul_f32 v[228:229], v[114:115], v[114:115]
    v_pk_fma_f32 v[226:227], v[226:227], v[178:179], v[178:179] op_sel:[0,1,0] op_sel_hi:[1,1,0]
    v_pk_fma_f32 v[228:229], v[228:229], v[178:179], v[178:179] op_sel:[0,1,0] op_sel_hi:[1,1,0]
    v_pk_mul_f32 v[226:227], v[226:227], v[112:113]
    v_pk_mul_f32 v[228:229], v[228:229], v[114:115]
    v_exp_f32 v226, v226
    v_exp_f32 v227, v227
    v_exp_f32 v228, v228
    v_exp_f32 v229, v229
    v_pk_fma_f32 v[226:227], v[226:227], v[176:177], v[176:177] op_sel:[0,1,1] op_sel_hi:[1,1,1]
    v_pk_fma_f32 v[228:229], v[228:229], v[176:177], v[176:177] op_sel:[0,1,1] op_sel_hi:[1,1,1]
    v_rcp_f32 v226, v226
    v_rcp_f32 v227, v227
    v_rcp_f32 v228, v228
    v_rcp_f32 v229, v229
    v_pk_mul_f32 v[112:113], v[112:113], v[226:227]
    v_pk_mul_f32 v[114:115], v[114:115], v[228:229]
    v_pk_fma_f32 v[116:117], v[176:177], v[144:145], v[116:117] op_sel_hi:[0,1,1] neg_lo:[1,0,0] neg_hi:[1,0,0]
    v_pk_fma_f32 v[118:119], v[176:177], v[146:147], v[118:119] op_sel_hi:[0,1,1] neg_lo:[1,0,0] neg_hi:[1,0,0]
    v_pk_mul_f32 v[226:227], v[116:117], v[116:117]
    v_pk_mul_f32 v[228:229], v[118:119], v[118:119]
    v_pk_fma_f32 v[226:227], v[226:227], v[178:179], v[178:179] op_sel:[0,1,0] op_sel_hi:[1,1,0]
    v_pk_fma_f32 v[228:229], v[228:229], v[178:179], v[178:179] op_sel:[0,1,0] op_sel_hi:[1,1,0]
    v_pk_mul_f32 v[226:227], v[226:227], v[116:117]
    v_pk_mul_f32 v[228:229], v[228:229], v[118:119]
    v_exp_f32 v226, v226
    v_exp_f32 v227, v227
    v_exp_f32 v228, v228
    v_exp_f32 v229, v229
    v_pk_fma_f32 v[226:227], v[226:227], v[176:177], v[176:177] op_sel:[0,1,1] op_sel_hi:[1,1,1]
    v_pk_fma_f32 v[228:229], v[228:229], v[176:177], v[176:177] op_sel:[0,1,1] op_sel_hi:[1,1,1]
    v_rcp_f32 v226, v226
    v_rcp_f32 v227, v227
    v_rcp_f32 v228, v228
    v_rcp_f32 v229, v229
    v_pk_mul_f32 v[116:117], v[116:117], v[226:227]
    v_pk_mul_f32 v[118:119], v[118:119], v[228:229]
    v_cvt_pk_bf16_f32 v112, v112, v113
    v_cvt_pk_bf16_f32 v113, v114, v115
    v_cvt_pk_bf16_f32 v114, v116, v117
    v_cvt_pk_bf16_f32 v115, v118, v119
    ds_write_b128 v244, v[112:115] offset:6144
    s_add_u32 s36, s45, 688128
    buffer_store_dwordx4 v[112:115], v2, s[16:19], s36 offen sc1
    v_pk_fma_f32 v[36:37], v[164:165], v[148:149], v[36:37] op_sel_hi:[0,1,1] neg_lo:[1,0,0] neg_hi:[1,0,0]
    v_pk_fma_f32 v[38:39], v[164:165], v[150:151], v[38:39] op_sel_hi:[0,1,1] neg_lo:[1,0,0] neg_hi:[1,0,0]
    v_pk_mul_f32 v[226:227], v[36:37], v[36:37]
    v_pk_mul_f32 v[228:229], v[38:39], v[38:39]
    v_pk_fma_f32 v[226:227], v[226:227], v[166:167], v[166:167] op_sel:[0,1,0] op_sel_hi:[1,1,0]
    v_pk_fma_f32 v[228:229], v[228:229], v[166:167], v[166:167] op_sel:[0,1,0] op_sel_hi:[1,1,0]
    v_pk_mul_f32 v[226:227], v[226:227], v[36:37]
    v_pk_mul_f32 v[228:229], v[228:229], v[38:39]
    v_exp_f32 v226, v226
    v_exp_f32 v227, v227
    v_exp_f32 v228, v228
    v_exp_f32 v229, v229
    v_pk_fma_f32 v[226:227], v[226:227], v[164:165], v[164:165] op_sel:[0,1,1] op_sel_hi:[1,1,1]
    v_pk_fma_f32 v[228:229], v[228:229], v[164:165], v[164:165] op_sel:[0,1,1] op_sel_hi:[1,1,1]
    v_rcp_f32 v226, v226
    v_rcp_f32 v227, v227
    v_rcp_f32 v228, v228
    v_rcp_f32 v229, v229
    v_pk_mul_f32 v[36:37], v[36:37], v[226:227]
    v_pk_mul_f32 v[38:39], v[38:39], v[228:229]
    v_pk_fma_f32 v[40:41], v[164:165], v[152:153], v[40:41] op_sel_hi:[0,1,1] neg_lo:[1,0,0] neg_hi:[1,0,0]
    v_pk_fma_f32 v[42:43], v[164:165], v[154:155], v[42:43] op_sel_hi:[0,1,1] neg_lo:[1,0,0] neg_hi:[1,0,0]
    v_pk_mul_f32 v[226:227], v[40:41], v[40:41]
    v_pk_mul_f32 v[228:229], v[42:43], v[42:43]
    v_pk_fma_f32 v[226:227], v[226:227], v[166:167], v[166:167] op_sel:[0,1,0] op_sel_hi:[1,1,0]
    v_pk_fma_f32 v[228:229], v[228:229], v[166:167], v[166:167] op_sel:[0,1,0] op_sel_hi:[1,1,0]
    v_pk_mul_f32 v[226:227], v[226:227], v[40:41]
    v_pk_mul_f32 v[228:229], v[228:229], v[42:43]
    v_exp_f32 v226, v226
    v_exp_f32 v227, v227
    v_exp_f32 v228, v228
    v_exp_f32 v229, v229
    v_pk_fma_f32 v[226:227], v[226:227], v[164:165], v[164:165] op_sel:[0,1,1] op_sel_hi:[1,1,1]
    v_pk_fma_f32 v[228:229], v[228:229], v[164:165], v[164:165] op_sel:[0,1,1] op_sel_hi:[1,1,1]
    v_rcp_f32 v226, v226
    v_rcp_f32 v227, v227
    v_rcp_f32 v228, v228
    v_rcp_f32 v229, v229
    v_pk_mul_f32 v[40:41], v[40:41], v[226:227]
    v_pk_mul_f32 v[42:43], v[42:43], v[228:229]
    v_cvt_pk_bf16_f32 v36, v36, v37
    v_cvt_pk_bf16_f32 v37, v38, v39
    v_cvt_pk_bf16_f32 v38, v40, v41
    v_cvt_pk_bf16_f32 v39, v42, v43
    v_or_b32 v36, 1, v36
    ds_write_b128 v244, v[36:39] offset:16384
    v_pk_fma_f32 v[64:65], v[168:169], v[148:149], v[64:65] op_sel_hi:[0,1,1] neg_lo:[1,0,0] neg_hi:[1,0,0]
    v_pk_fma_f32 v[66:67], v[168:169], v[150:151], v[66:67] op_sel_hi:[0,1,1] neg_lo:[1,0,0] neg_hi:[1,0,0]
    v_pk_mul_f32 v[226:227], v[64:65], v[64:65]
    v_pk_mul_f32 v[228:229], v[66:67], v[66:67]
    v_pk_fma_f32 v[226:227], v[226:227], v[170:171], v[170:171] op_sel:[0,1,0] op_sel_hi:[1,1,0]
    v_pk_fma_f32 v[228:229], v[228:229], v[170:171], v[170:171] op_sel:[0,1,0] op_sel_hi:[1,1,0]
    v_pk_mul_f32 v[226:227], v[226:227], v[64:65]
    v_pk_mul_f32 v[228:229], v[228:229], v[66:67]
    v_exp_f32 v226, v226
    v_exp_f32 v227, v227
    v_exp_f32 v228, v228
    v_exp_f32 v229, v229
    v_pk_fma_f32 v[226:227], v[226:227], v[168:169], v[168:169] op_sel:[0,1,1] op_sel_hi:[1,1,1]
    v_pk_fma_f32 v[228:229], v[228:229], v[168:169], v[168:169] op_sel:[0,1,1] op_sel_hi:[1,1,1]
    v_rcp_f32 v226, v226
    v_rcp_f32 v227, v227
    v_rcp_f32 v228, v228
    v_rcp_f32 v229, v229
    v_pk_mul_f32 v[64:65], v[64:65], v[226:227]
    v_pk_mul_f32 v[66:67], v[66:67], v[228:229]
    v_pk_fma_f32 v[68:69], v[168:169], v[152:153], v[68:69] op_sel_hi:[0,1,1] neg_lo:[1,0,0] neg_hi:[1,0,0]
    v_pk_fma_f32 v[70:71], v[168:169], v[154:155], v[70:71] op_sel_hi:[0,1,1] neg_lo:[1,0,0] neg_hi:[1,0,0]
    v_pk_mul_f32 v[226:227], v[68:69], v[68:69]
    v_pk_mul_f32 v[228:229], v[70:71], v[70:71]
    v_pk_fma_f32 v[226:227], v[226:227], v[170:171], v[170:171] op_sel:[0,1,0] op_sel_hi:[1,1,0]
    v_pk_fma_f32 v[228:229], v[228:229], v[170:171], v[170:171] op_sel:[0,1,0] op_sel_hi:[1,1,0]
    v_pk_mul_f32 v[226:227], v[226:227], v[68:69]
    v_pk_mul_f32 v[228:229], v[228:229], v[70:71]
    v_exp_f32 v226, v226
    v_exp_f32 v227, v227
    v_exp_f32 v228, v228
    v_exp_f32 v229, v229
    v_pk_fma_f32 v[226:227], v[226:227], v[168:169], v[168:169] op_sel:[0,1,1] op_sel_hi:[1,1,1]
    v_pk_fma_f32 v[228:229], v[228:229], v[168:169], v[168:169] op_sel:[0,1,1] op_sel_hi:[1,1,1]
    v_rcp_f32 v226, v226
    v_rcp_f32 v227, v227
    v_rcp_f32 v228, v228
    v_rcp_f32 v229, v229
    v_pk_mul_f32 v[68:69], v[68:69], v[226:227]
    v_pk_mul_f32 v[70:71], v[70:71], v[228:229]
    v_cvt_pk_bf16_f32 v64, v64, v65
    v_cvt_pk_bf16_f32 v65, v66, v67
    v_cvt_pk_bf16_f32 v66, v68, v69
    v_cvt_pk_bf16_f32 v67, v70, v71
    v_or_b32 v64, 1, v64
    ds_write_b128 v244, v[64:67] offset:18432
    s_waitcnt vmcnt(0)
    s_mov_b64 exec, 1
    ds_add_u32 v246, v245
    s_mov_b64 exec, -1
    v_pk_fma_f32 v[92:93], v[172:173], v[148:149], v[92:93] op_sel_hi:[0,1,1] neg_lo:[1,0,0] neg_hi:[1,0,0]
    v_pk_fma_f32 v[94:95], v[172:173], v[150:151], v[94:95] op_sel_hi:[0,1,1] neg_lo:[1,0,0] neg_hi:[1,0,0]
    v_pk_mul_f32 v[226:227], v[92:93], v[92:93]
    v_pk_mul_f32 v[228:229], v[94:95], v[94:95]
    v_pk_fma_f32 v[226:227], v[226:227], v[174:175], v[174:175] op_sel:[0,1,0] op_sel_hi:[1,1,0]
    v_pk_fma_f32 v[228:229], v[228:229], v[174:175], v[174:175] op_sel:[0,1,0] op_sel_hi:[1,1,0]
    v_pk_mul_f32 v[226:227], v[226:227], v[92:93]
    v_pk_mul_f32 v[228:229], v[228:229], v[94:95]
    v_exp_f32 v226, v226
    v_exp_f32 v227, v227
    v_exp_f32 v228, v228
    v_exp_f32 v229, v229
    v_pk_fma_f32 v[226:227], v[226:227], v[172:173], v[172:173] op_sel:[0,1,1] op_sel_hi:[1,1,1]
    v_pk_fma_f32 v[228:229], v[228:229], v[172:173], v[172:173] op_sel:[0,1,1] op_sel_hi:[1,1,1]
    v_rcp_f32 v226, v226
    v_rcp_f32 v227, v227
    v_rcp_f32 v228, v228
    v_rcp_f32 v229, v229
    v_pk_mul_f32 v[92:93], v[92:93], v[226:227]
    v_pk_mul_f32 v[94:95], v[94:95], v[228:229]
    v_pk_fma_f32 v[96:97], v[172:173], v[152:153], v[96:97] op_sel_hi:[0,1,1] neg_lo:[1,0,0] neg_hi:[1,0,0]
    v_pk_fma_f32 v[98:99], v[172:173], v[154:155], v[98:99] op_sel_hi:[0,1,1] neg_lo:[1,0,0] neg_hi:[1,0,0]
    v_pk_mul_f32 v[226:227], v[96:97], v[96:97]
    v_pk_mul_f32 v[228:229], v[98:99], v[98:99]
    v_pk_fma_f32 v[226:227], v[226:227], v[174:175], v[174:175] op_sel:[0,1,0] op_sel_hi:[1,1,0]
    v_pk_fma_f32 v[228:229], v[228:229], v[174:175], v[174:175] op_sel:[0,1,0] op_sel_hi:[1,1,0]
    v_pk_mul_f32 v[226:227], v[226:227], v[96:97]
    v_pk_mul_f32 v[228:229], v[228:229], v[98:99]
    v_exp_f32 v226, v226
    v_exp_f32 v227, v227
    v_exp_f32 v228, v228
    v_exp_f32 v229, v229
    v_pk_fma_f32 v[226:227], v[226:227], v[172:173], v[172:173] op_sel:[0,1,1] op_sel_hi:[1,1,1]
    v_pk_fma_f32 v[228:229], v[228:229], v[172:173], v[172:173] op_sel:[0,1,1] op_sel_hi:[1,1,1]
    v_rcp_f32 v226, v226
    v_rcp_f32 v227, v227
    v_rcp_f32 v228, v228
    v_rcp_f32 v229, v229
    v_pk_mul_f32 v[96:97], v[96:97], v[226:227]
    v_pk_mul_f32 v[98:99], v[98:99], v[228:229]
    v_cvt_pk_bf16_f32 v92, v92, v93
    v_cvt_pk_bf16_f32 v93, v94, v95
    v_cvt_pk_bf16_f32 v94, v96, v97
    v_cvt_pk_bf16_f32 v95, v98, v99
    v_or_b32 v92, 1, v92
    ds_write_b128 v244, v[92:95] offset:20480
    s_cmp_eq_u32 s60, 1
    s_cbranch_scc1 G4_p11
    buffer_load_dwordx4 v[180:183], v196, s[84:87], 0 offen offset:0 sc1
    buffer_load_dwordx4 v[188:191], v196, s[88:91], 0 offen offset:0 sc1
    buffer_load_dwordx4 v[184:187], v196, s[84:87], 0 offen offset:2048 sc1
    buffer_load_dwordx4 v[192:195], v196, s[88:91], 0 offen offset:2048 sc1
    s_branch G4_p21
G4_p11:
    s_add_u32 s36, s40, 0
    buffer_load_dwordx4 v[180:183], v2, s[84:87], s36 offen offset:0 sc1
    buffer_load_dwordx4 v[184:187], v2, s[88:91], s36 offen offset:0 sc1
    buffer_load_dwordx4 v[188:191], v2, s[84:87], s36 offen offset:1024 sc1
    buffer_load_dwordx4 v[192:195], v2, s[88:91], s36 offen offset:1024 sc1
    s_add_u32 s36, s40, 65536
    buffer_load_dwordx4 v[196:199], v2, s[84:87], s36 offen offset:0 sc1
    buffer_load_dwordx4 v[230:233], v2, s[88:91], s36 offen offset:0 sc1
    buffer_load_dwordx4 v[234:237], v2, s[84:87], s36 offen offset:1024 sc1
    buffer_load_dwordx4 v[248:251], v2, s[88:91], s36 offen offset:1024 sc1
G4_p21:
    v_pk_fma_f32 v[120:121], v[176:177], v[148:149], v[120:121] op_sel_hi:[0,1,1] neg_lo:[1,0,0] neg_hi:[1,0,0]
    v_pk_fma_f32 v[122:123], v[176:177], v[150:151], v[122:123] op_sel_hi:[0,1,1] neg_lo:[1,0,0] neg_hi:[1,0,0]
    v_pk_mul_f32 v[226:227], v[120:121], v[120:121]
    v_pk_mul_f32 v[228:229], v[122:123], v[122:123]
    v_pk_fma_f32 v[226:227], v[226:227], v[178:179], v[178:179] op_sel:[0,1,0] op_sel_hi:[1,1,0]
    v_pk_fma_f32 v[228:229], v[228:229], v[178:179], v[178:179] op_sel:[0,1,0] op_sel_hi:[1,1,0]
    v_pk_mul_f32 v[226:227], v[226:227], v[120:121]
    v_pk_mul_f32 v[228:229], v[228:229], v[122:123]
    v_exp_f32 v226, v226
    v_exp_f32 v227, v227
    v_exp_f32 v228, v228
    v_exp_f32 v229, v229
    v_pk_fma_f32 v[226:227], v[226:227], v[176:177], v[176:177] op_sel:[0,1,1] op_sel_hi:[1,1,1]
    v_pk_fma_f32 v[228:229], v[228:229], v[176:177], v[176:177] op_sel:[0,1,1] op_sel_hi:[1,1,1]
    v_rcp_f32 v226, v226
    v_rcp_f32 v227, v227
    v_rcp_f32 v228, v228
    v_rcp_f32 v229, v229
    v_pk_mul_f32 v[120:121], v[120:121], v[226:227]
    v_pk_mul_f32 v[122:123], v[122:123], v[228:229]
    v_pk_fma_f32 v[124:125], v[176:177], v[152:153], v[124:125] op_sel_hi:[0,1,1] neg_lo:[1,0,0] neg_hi:[1,0,0]
    v_pk_fma_f32 v[126:127], v[176:177], v[154:155], v[126:127] op_sel_hi:[0,1,1] neg_lo:[1,0,0] neg_hi:[1,0,0]
    v_pk_mul_f32 v[226:227], v[124:125], v[124:125]
    v_pk_mul_f32 v[228:229], v[126:127], v[126:127]
    v_pk_fma_f32 v[226:227], v[226:227], v[178:179], v[178:179] op_sel:[0,1,0] op_sel_hi:[1,1,0]
    v_pk_fma_f32 v[228:229], v[228:229], v[178:179], v[178:179] op_sel:[0,1,0] op_sel_hi:[1,1,0]
    v_pk_mul_f32 v[226:227], v[226:227], v[124:125]
    v_pk_mul_f32 v[228:229], v[228:229], v[126:127]
    v_exp_f32 v226, v226
    v_exp_f32 v227, v227
    v_exp_f32 v228, v228
    v_exp_f32 v229, v229
    v_pk_fma_f32 v[226:227], v[226:227], v[176:177], v[176:177] op_sel:[0,1,1] op_sel_hi:[1,1,1]
    v_pk_fma_f32 v[228:229], v[228:229], v[176:177], v[176:177] op_sel:[0,1,1] op_sel_hi:[1,1,1]
    v_rcp_f32 v226, v226
    v_rcp_f32 v227, v227
    v_rcp_f32 v228, v228
    v_rcp_f32 v229, v229
    v_pk_mul_f32 v[124:125], v[124:125], v[226:227]
    v_pk_mul_f32 v[126:127], v[126:127], v[228:229]
    v_cvt_pk_bf16_f32 v120, v120, v121
    v_cvt_pk_bf16_f32 v121, v122, v123
    v_cvt_pk_bf16_f32 v122, v124, v125
    v_cvt_pk_bf16_f32 v123, v126, v127
    ds_write_b128 v244, v[120:123] offset:22528
    v_pk_fma_f32 v[44:45], v[164:165], v[156:157], v[44:45] op_sel_hi:[0,1,1] neg_lo:[1,0,0] neg_hi:[1,0,0]
    v_pk_fma_f32 v[46:47], v[164:165], v[158:159], v[46:47] op_sel_hi:[0,1,1] neg_lo:[1,0,0] neg_hi:[1,0,0]
    v_pk_mul_f32 v[226:227], v[44:45], v[44:45]
    v_pk_mul_f32 v[228:229], v[46:47], v[46:47]
    v_pk_fma_f32 v[226:227], v[226:227], v[166:167], v[166:167] op_sel:[0,1,0] op_sel_hi:[1,1,0]
    v_pk_fma_f32 v[228:229], v[228:229], v[166:167], v[166:167] op_sel:[0,1,0] op_sel_hi:[1,1,0]
    v_pk_mul_f32 v[226:227], v[226:227], v[44:45]
    v_pk_mul_f32 v[228:229], v[228:229], v[46:47]
    v_exp_f32 v226, v226
    v_exp_f32 v227, v227
    v_exp_f32 v228, v228
    v_exp_f32 v229, v229
    v_pk_fma_f32 v[226:227], v[226:227], v[164:165], v[164:165] op_sel:[0,1,1] op_sel_hi:[1,1,1]
    v_pk_fma_f32 v[228:229], v[228:229], v[164:165], v[164:165] op_sel:[0,1,1] op_sel_hi:[1,1,1]
    v_rcp_f32 v226, v226
    v_rcp_f32 v227, v227
    v_rcp_f32 v228, v228
    v_rcp_f32 v229, v229
    v_pk_mul_f32 v[44:45], v[44:45], v[226:227]
    v_pk_mul_f32 v[46:47], v[46:47], v[228:229]
    v_pk_fma_f32 v[48:49], v[164:165], v[160:161], v[48:49] op_sel_hi:[0,1,1] neg_lo:[1,0,0] neg_hi:[1,0,0]
    v_pk_fma_f32 v[50:51], v[164:165], v[162:163], v[50:51] op_sel_hi:[0,1,1] neg_lo:[1,0,0] neg_hi:[1,0,0]
    v_pk_mul_f32 v[226:227], v[48:49], v[48:49]
    v_pk_mul_f32 v[228:229], v[50:51], v[50:51]
    v_pk_fma_f32 v[226:227], v[226:227], v[166:167], v[166:167] op_sel:[0,1,0] op_sel_hi:[1,1,0]
    v_pk_fma_f32 v[228:229], v[228:229], v[166:167], v[166:167] op_sel:[0,1,0] op_sel_hi:[1,1,0]
    v_pk_mul_f32 v[226:227], v[226:227], v[48:49]
    v_pk_mul_f32 v[228:229], v[228:229], v[50:51]
    v_exp_f32 v226, v226
    v_exp_f32 v227, v227
    v_exp_f32 v228, v228
    v_exp_f32 v229, v229
    v_pk_fma_f32 v[226:227], v[226:227], v[164:165], v[164:165] op_sel:[0,1,1] op_sel_hi:[1,1,1]
    v_pk_fma_f32 v[228:229], v[228:229], v[164:165], v[164:165] op_sel:[0,1,1] op_sel_hi:[1,1,1]
    v_rcp_f32 v226, v226
    v_rcp_f32 v227, v227
    v_rcp_f32 v228, v228
    v_rcp_f32 v229, v229
    v_pk_mul_f32 v[48:49], v[48:49], v[226:227]
    v_pk_mul_f32 v[50:51], v[50:51], v[228:229]
    v_cvt_pk_bf16_f32 v200, v44, v45
    v_cvt_pk_bf16_f32 v201, v46, v47
    v_cvt_pk_bf16_f32 v202, v48, v49
    v_cvt_pk_bf16_f32 v203, v50, v51
    v_or_b32 v200, 1, v200
    ds_write_b128 v244, v[200:203] offset:32768
    v_pk_fma_f32 v[72:73], v[168:169], v[156:157], v[72:73] op_sel_hi:[0,1,1] neg_lo:[1,0,0] neg_hi:[1,0,0]
    v_pk_fma_f32 v[74:75], v[168:169], v[158:159], v[74:75] op_sel_hi:[0,1,1] neg_lo:[1,0,0] neg_hi:[1,0,0]
    v_pk_mul_f32 v[226:227], v[72:73], v[72:73]
    v_pk_mul_f32 v[228:229], v[74:75], v[74:75]
    v_pk_fma_f32 v[226:227], v[226:227], v[170:171], v[170:171] op_sel:[0,1,0] op_sel_hi:[1,1,0]
    v_pk_fma_f32 v[228:229], v[228:229], v[170:171], v[170:171] op_sel:[0,1,0] op_sel_hi:[1,1,0]
    v_pk_mul_f32 v[226:227], v[226:227], v[72:73]
    v_pk_mul_f32 v[228:229], v[228:229], v[74:75]
    v_exp_f32 v226, v226
    v_exp_f32 v227, v227
    v_exp_f32 v228, v228
    v_exp_f32 v229, v229
    v_pk_fma_f32 v[226:227], v[226:227], v[168:169], v[168:169] op_sel:[0,1,1] op_sel_hi:[1,1,1]
    v_pk_fma_f32 v[228:229], v[228:229], v[168:169], v[168:169] op_sel:[0,1,1] op_sel_hi:[1,1,1]
    v_rcp_f32 v226, v226
    v_rcp_f32 v227, v227
    v_rcp_f32 v228, v228
    v_rcp_f32 v229, v229
    v_pk_mul_f32 v[72:73], v[72:73], v[226:227]
    v_pk_mul_f32 v[74:75], v[74:75], v[228:229]
    v_pk_fma_f32 v[76:77], v[168:169], v[160:161], v[76:77] op_sel_hi:[0,1,1] neg_lo:[1,0,0] neg_hi:[1,0,0]
    v_pk_fma_f32 v[78:79], v[168:169], v[162:163], v[78:79] op_sel_hi:[0,1,1] neg_lo:[1,0,0] neg_hi:[1,0,0]
    v_pk_mul_f32 v[226:227], v[76:77], v[76:77]
    v_pk_mul_f32 v[228:229], v[78:79], v[78:79]
    v_pk_fma_f32 v[226:227], v[226:227], v[170:171], v[170:171] op_sel:[0,1,0] op_sel_hi:[1,1,0]
    v_pk_fma_f32 v[228:229], v[228:229], v[170:171], v[170:171] op_sel:[0,1,0] op_sel_hi:[1,1,0]
    v_pk_mul_f32 v[226:227], v[226:227], v[76:77]
    v_pk_mul_f32 v[228:229], v[228:229], v[78:79]
    v_exp_f32 v226, v226
    v_exp_f32 v227, v227
    v_exp_f32 v228, v228
    v_exp_f32 v229, v229
    v_pk_fma_f32 v[226:227], v[226:227], v[168:169], v[168:169] op_sel:[0,1,1] op_sel_hi:[1,1,1]
    v_pk_fma_f32 v[228:229], v[228:229], v[168:169], v[168:169] op_sel:[0,1,1] op_sel_hi:[1,1,1]
    v_rcp_f32 v226, v226
    v_rcp_f32 v227, v227
    v_rcp_f32 v228, v228
    v_rcp_f32 v229, v229
    v_pk_mul_f32 v[76:77], v[76:77], v[226:227]
    v_pk_mul_f32 v[78:79], v[78:79], v[228:229]
    v_cvt_pk_bf16_f32 v204, v72, v73
    v_cvt_pk_bf16_f32 v205, v74, v75
    v_cvt_pk_bf16_f32 v206, v76, v77
    v_cvt_pk_bf16_f32 v207, v78, v79
    v_or_b32 v204, 1, v204
    ds_write_b128 v244, v[204:207] offset:34816
    v_pk_fma_f32 v[100:101], v[172:173], v[156:157], v[100:101] op_sel_hi:[0,1,1] neg_lo:[1,0,0] neg_hi:[1,0,0]
    v_pk_fma_f32 v[102:103], v[172:173], v[158:159], v[102:103] op_sel_hi:[0,1,1] neg_lo:[1,0,0] neg_hi:[1,0,0]
    v_pk_mul_f32 v[226:227], v[100:101], v[100:101]
    v_pk_mul_f32 v[228:229], v[102:103], v[102:103]
    v_pk_fma_f32 v[226:227], v[226:227], v[174:175], v[174:175] op_sel:[0,1,0] op_sel_hi:[1,1,0]
    v_pk_fma_f32 v[228:229], v[228:229], v[174:175], v[174:175] op_sel:[0,1,0] op_sel_hi:[1,1,0]
    v_pk_mul_f32 v[226:227], v[226:227], v[100:101]
    v_pk_mul_f32 v[228:229], v[228:229], v[102:103]
    v_exp_f32 v226, v226
    v_exp_f32 v227, v227
    v_exp_f32 v228, v228
    v_exp_f32 v229, v229
    v_pk_fma_f32 v[226:227], v[226:227], v[172:173], v[172:173] op_sel:[0,1,1] op_sel_hi:[1,1,1]
    v_pk_fma_f32 v[228:229], v[228:229], v[172:173], v[172:173] op_sel:[0,1,1] op_sel_hi:[1,1,1]
    v_rcp_f32 v226, v226
    v_rcp_f32 v227, v227
    v_rcp_f32 v228, v228
    v_rcp_f32 v229, v229
    v_pk_mul_f32 v[100:101], v[100:101], v[226:227]
    v_pk_mul_f32 v[102:103], v[102:103], v[228:229]
    v_pk_fma_f32 v[104:105], v[172:173], v[160:161], v[104:105] op_sel_hi:[0,1,1] neg_lo:[1,0,0] neg_hi:[1,0,0]
    v_pk_fma_f32 v[106:107], v[172:173], v[162:163], v[106:107] op_sel_hi:[0,1,1] neg_lo:[1,0,0] neg_hi:[1,0,0]
    v_pk_mul_f32 v[226:227], v[104:105], v[104:105]
    v_pk_mul_f32 v[228:229], v[106:107], v[106:107]
    v_pk_fma_f32 v[226:227], v[226:227], v[174:175], v[174:175] op_sel:[0,1,0] op_sel_hi:[1,1,0]
    v_pk_fma_f32 v[228:229], v[228:229], v[174:175], v[174:175] op_sel:[0,1,0] op_sel_hi:[1,1,0]
    v_pk_mul_f32 v[226:227], v[226:227], v[104:105]
    v_pk_mul_f32 v[228:229], v[228:229], v[106:107]
    v_exp_f32 v226, v226
    v_exp_f32 v227, v227
    v_exp_f32 v228, v228
    v_exp_f32 v229, v229
    v_pk_fma_f32 v[226:227], v[226:227], v[172:173], v[172:173] op_sel:[0,1,1] op_sel_hi:[1,1,1]
    v_pk_fma_f32 v[228:229], v[228:229], v[172:173], v[172:173] op_sel:[0,1,1] op_sel_hi:[1,1,1]
    v_rcp_f32 v226, v226
    v_rcp_f32 v227, v227
    v_rcp_f32 v228, v228
    v_rcp_f32 v229, v229
    v_pk_mul_f32 v[104:105], v[104:105], v[226:227]
    v_pk_mul_f32 v[106:107], v[106:107], v[228:229]
    v_cvt_pk_bf16_f32 v208, v100, v101
    v_cvt_pk_bf16_f32 v209, v102, v103
    v_cvt_pk_bf16_f32 v210, v104, v105
    v_cvt_pk_bf16_f32 v211, v106, v107
    v_or_b32 v208, 1, v208
    ds_write_b128 v244, v[208:211] offset:36864
    v_pk_fma_f32 v[128:129], v[176:177], v[156:157], v[128:129] op_sel_hi:[0,1,1] neg_lo:[1,0,0] neg_hi:[1,0,0]
    v_pk_fma_f32 v[130:131], v[176:177], v[158:159], v[130:131] op_sel_hi:[0,1,1] neg_lo:[1,0,0] neg_hi:[1,0,0]
    v_pk_mul_f32 v[226:227], v[128:129], v[128:129]
    v_pk_mul_f32 v[228:229], v[130:131], v[130:131]
    v_pk_fma_f32 v[226:227], v[226:227], v[178:179], v[178:179] op_sel:[0,1,0] op_sel_hi:[1,1,0]
    v_pk_fma_f32 v[228:229], v[228:229], v[178:179], v[178:179] op_sel:[0,1,0] op_sel_hi:[1,1,0]
    v_pk_mul_f32 v[226:227], v[226:227], v[128:129]
    v_pk_mul_f32 v[228:229], v[228:229], v[130:131]
    v_exp_f32 v226, v226
    v_exp_f32 v227, v227
    v_exp_f32 v228, v228
    v_exp_f32 v229, v229
    v_pk_fma_f32 v[226:227], v[226:227], v[176:177], v[176:177] op_sel:[0,1,1] op_sel_hi:[1,1,1]
    v_pk_fma_f32 v[228:229], v[228:229], v[176:177], v[176:177] op_sel:[0,1,1] op_sel_hi:[1,1,1]
    v_rcp_f32 v226, v226
    v_rcp_f32 v227, v227
    v_rcp_f32 v228, v228
    v_rcp_f32 v229, v229
    v_pk_mul_f32 v[128:129], v[128:129], v[226:227]
    v_pk_mul_f32 v[130:131], v[130:131], v[228:229]
    v_pk_fma_f32 v[132:133], v[176:177], v[160:161], v[132:133] op_sel_hi:[0,1,1] neg_lo:[1,0,0] neg_hi:[1,0,0]
    v_pk_fma_f32 v[134:135], v[176:177], v[162:163], v[134:135] op_sel_hi:[0,1,1] neg_lo:[1,0,0] neg_hi:[1,0,0]
    v_pk_mul_f32 v[226:227], v[132:133], v[132:133]
    v_pk_mul_f32 v[228:229], v[134:135], v[134:135]
    v_pk_fma_f32 v[226:227], v[226:227], v[178:179], v[178:179] op_sel:[0,1,0] op_sel_hi:[1,1,0]
    v_pk_fma_f32 v[228:229], v[228:229], v[178:179], v[178:179] op_sel:[0,1,0] op_sel_hi:[1,1,0]
    v_pk_mul_f32 v[226:227], v[226:227], v[132:133]
    v_pk_mul_f32 v[228:229], v[228:229], v[134:135]
    v_exp_f32 v226, v226
    v_exp_f32 v227, v227
    v_exp_f32 v228, v228
    v_exp_f32 v229, v229
    v_pk_fma_f32 v[226:227], v[226:227], v[176:177], v[176:177] op_sel:[0,1,1] op_sel_hi:[1,1,1]
    v_pk_fma_f32 v[228:229], v[228:229], v[176:177], v[176:177] op_sel:[0,1,1] op_sel_hi:[1,1,1]
    v_rcp_f32 v226, v226
    v_rcp_f32 v227, v227
    v_rcp_f32 v228, v228
    v_rcp_f32 v229, v229
    v_pk_mul_f32 v[132:133], v[132:133], v[226:227]
    v_pk_mul_f32 v[134:135], v[134:135], v[228:229]
    v_cvt_pk_bf16_f32 v212, v128, v129
    v_cvt_pk_bf16_f32 v213, v130, v131
    v_cvt_pk_bf16_f32 v214, v132, v133
    v_cvt_pk_bf16_f32 v215, v134, v135
    ds_write_b128 v244, v[212:215] offset:38912
    v_pk_fma_f32 v[24:25], v[164:165], v[136:137], v[24:25] op_sel_hi:[0,1,1] neg_lo:[1,0,0] neg_hi:[1,0,0]
    v_pk_fma_f32 v[26:27], v[164:165], v[138:139], v[26:27] op_sel_hi:[0,1,1] neg_lo:[1,0,0] neg_hi:[1,0,0]
    v_pk_mul_f32 v[226:227], v[24:25], v[24:25]
    v_pk_mul_f32 v[228:229], v[26:27], v[26:27]
    v_pk_fma_f32 v[226:227], v[226:227], v[166:167], v[166:167] op_sel:[0,1,0] op_sel_hi:[1,1,0]
    v_pk_fma_f32 v[228:229], v[228:229], v[166:167], v[166:167] op_sel:[0,1,0] op_sel_hi:[1,1,0]
    v_pk_mul_f32 v[226:227], v[226:227], v[24:25]
    v_pk_mul_f32 v[228:229], v[228:229], v[26:27]
    v_exp_f32 v226, v226
    v_exp_f32 v227, v227
    v_exp_f32 v228, v228
    v_exp_f32 v229, v229
    v_pk_fma_f32 v[226:227], v[226:227], v[164:165], v[164:165] op_sel:[0,1,1] op_sel_hi:[1,1,1]
    v_pk_fma_f32 v[228:229], v[228:229], v[164:165], v[164:165] op_sel:[0,1,1] op_sel_hi:[1,1,1]
    v_rcp_f32 v226, v226
    v_rcp_f32 v227, v227
    v_rcp_f32 v228, v228
    v_rcp_f32 v229, v229
    v_pk_mul_f32 v[24:25], v[24:25], v[226:227]
    v_pk_mul_f32 v[26:27], v[26:27], v[228:229]
    v_cvt_pk_bf16_f32 v216, v24, v25
    v_cvt_pk_bf16_f32 v217, v26, v27
    v_or_b32 v216, 1, v216
    s_add_u32 s36, s46, 0
    buffer_store_dwordx4 v[36:39], v2, s[16:19], s36 offen sc1
    v_pk_fma_f32 v[52:53], v[168:169], v[136:137], v[52:53] op_sel_hi:[0,1,1] neg_lo:[1,0,0] neg_hi:[1,0,0]
    v_pk_fma_f32 v[54:55], v[168:169], v[138:139], v[54:55] op_sel_hi:[0,1,1] neg_lo:[1,0,0] neg_hi:[1,0,0]
    v_pk_mul_f32 v[226:227], v[52:53], v[52:53]
    v_pk_mul_f32 v[228:229], v[54:55], v[54:55]
    v_pk_fma_f32 v[226:227], v[226:227], v[170:171], v[170:171] op_sel:[0,1,0] op_sel_hi:[1,1,0]
    v_pk_fma_f32 v[228:229], v[228:229], v[170:171], v[170:171] op_sel:[0,1,0] op_sel_hi:[1,1,0]
    v_pk_mul_f32 v[226:227], v[226:227], v[52:53]
    v_pk_mul_f32 v[228:229], v[228:229], v[54:55]
    v_exp_f32 v226, v226
    v_exp_f32 v227, v227
    v_exp_f32 v228, v228
    v_exp_f32 v229, v229
    v_pk_fma_f32 v[226:227], v[226:227], v[168:169], v[168:169] op_sel:[0,1,1] op_sel_hi:[1,1,1]
    v_pk_fma_f32 v[228:229], v[228:229], v[168:169], v[168:169] op_sel:[0,1,1] op_sel_hi:[1,1,1]
    v_rcp_f32 v226, v226
    v_rcp_f32 v227, v227
    v_rcp_f32 v228, v228
    v_rcp_f32 v229, v229
    v_pk_mul_f32 v[52:53], v[52:53], v[226:227]
    v_pk_mul_f32 v[54:55], v[54:55], v[228:229]
    v_cvt_pk_bf16_f32 v218, v52, v53
    v_cvt_pk_bf16_f32 v219, v54, v55
    v_or_b32 v218, 1, v218
    s_add_u32 s36, s46, 229376
    buffer_store_dwordx4 v[64:67], v2, s[16:19], s36 offen sc1
    v_pk_fma_f32 v[80:81], v[172:173], v[136:137], v[80:81] op_sel_hi:[0,1,1] neg_lo:[1,0,0] neg_hi:[1,0,0]
    v_pk_fma_f32 v[82:83], v[172:173], v[138:139], v[82:83] op_sel_hi:[0,1,1] neg_lo:[1,0,0] neg_hi:[1,0,0]
    v_pk_mul_f32 v[226:227], v[80:81], v[80:81]
    v_pk_mul_f32 v[228:229], v[82:83], v[82:83]
    v_pk_fma_f32 v[226:227], v[226:227], v[174:175], v[174:175] op_sel:[0,1,0] op_sel_hi:[1,1,0]
    v_pk_fma_f32 v[228:229], v[228:229], v[174:175], v[174:175] op_sel:[0,1,0] op_sel_hi:[1,1,0]
    v_pk_mul_f32 v[226:227], v[226:227], v[80:81]
    v_pk_mul_f32 v[228:229], v[228:229], v[82:83]
    v_exp_f32 v226, v226
    v_exp_f32 v227, v227
    v_exp_f32 v228, v228
    v_exp_f32 v229, v229
    v_pk_fma_f32 v[226:227], v[226:227], v[172:173], v[172:173] op_sel:[0,1,1] op_sel_hi:[1,1,1]
    v_pk_fma_f32 v[228:229], v[228:229], v[172:173], v[172:173] op_sel:[0,1,1] op_sel_hi:[1,1,1]
    v_rcp_f32 v226, v226
    v_rcp_f32 v227, v227
    v_rcp_f32 v228, v228
    v_rcp_f32 v229, v229
    v_pk_mul_f32 v[80:81], v[80:81], v[226:227]
    v_pk_mul_f32 v[82:83], v[82:83], v[228:229]
    v_cvt_pk_bf16_f32 v220, v80, v81
    v_cvt_pk_bf16_f32 v221, v82, v83
    v_or_b32 v220, 1, v220
    s_add_u32 s36, s46, 458752
    buffer_store_dwordx4 v[92:95], v2, s[16:19], s36 offen sc1
    v_pk_fma_f32 v[108:109], v[176:177], v[136:137], v[108:109] op_sel_hi:[0,1,1] neg_lo:[1,0,0] neg_hi:[1,0,0]
    v_pk_fma_f32 v[110:111], v[176:177], v[138:139], v[110:111] op_sel_hi:[0,1,1] neg_lo:[1,0,0] neg_hi:[1,0,0]
    v_pk_mul_f32 v[226:227], v[108:109], v[108:109]
    v_pk_mul_f32 v[228:229], v[110:111], v[110:111]
    v_pk_fma_f32 v[226:227], v[226:227], v[178:179], v[178:179] op_sel:[0,1,0] op_sel_hi:[1,1,0]
    v_pk_fma_f32 v[228:229], v[228:229], v[178:179], v[178:179] op_sel:[0,1,0] op_sel_hi:[1,1,0]
    v_pk_mul_f32 v[226:227], v[226:227], v[108:109]
    v_pk_mul_f32 v[228:229], v[228:229], v[110:111]
    v_exp_f32 v226, v226
    v_exp_f32 v227, v227
    v_exp_f32 v228, v228
    v_exp_f32 v229, v229
    v_pk_fma_f32 v[226:227], v[226:227], v[176:177], v[176:177] op_sel:[0,1,1] op_sel_hi:[1,1,1]
    v_pk_fma_f32 v[228:229], v[228:229], v[176:177], v[176:177] op_sel:[0,1,1] op_sel_hi:[1,1,1]
    v_rcp_f32 v226, v226
    v_rcp_f32 v227, v227
    v_rcp_f32 v228, v228
    v_rcp_f32 v229, v229
    v_pk_mul_f32 v[108:109], v[108:109], v[226:227]
    v_pk_mul_f32 v[110:111], v[110:111], v[228:229]
    v_cvt_pk_bf16_f32 v222, v108, v109
    v_cvt_pk_bf16_f32 v223, v110, v111
    s_add_u32 s36, s46, 688128
    buffer_store_dwordx4 v[120:123], v2, s[16:19], s36 offen sc1
    s_waitcnt lgkmcnt(0)
    s_add_u32 s45, s44, 512
    s_mov_b32 s44, s47
G3_e2:
    s_waitcnt lgkmcnt(0)
    s_barrier
    ds_read_b128 v[88:91], v17 offset:0
    ds_read_b128 v[92:95], v17 offset:2048
    ds_read_b128 v[96:99], v17 offset:4096
    ds_read_b128 v[100:103], v17 offset:6144
    ds_read_b64_tr_b16 v[104:105], v18 offset:0
    ds_read_b64_tr_b16 v[106:107], v18 offset:4096
    ds_read_b64_tr_b16 v[108:109], v19 offset:0
    ds_read_b64_tr_b16 v[110:111], v19 offset:4096
    ds_read_b64_tr_b16 v[112:113], v20 offset:0
    ds_read_b64_tr_b16 v[114:115], v20 offset:4096
    ds_read_b64_tr_b16 v[116:117], v21 offset:0
    ds_read_b64_tr_b16 v[118:119], v21 offset:4096
    s_waitcnt lgkmcnt(6)
    v_mfma_f32_16x16x32_bf16 v[24:27], v[104:107], v[88:91], 0
    ds_read_b128 v[120:123], v17 offset:1024
    s_add_u32 s42, s42, 16384
    v_mfma_f32_16x16x32_bf16 v[40:43], v[104:107], v[92:95], 0
    ds_read_b128 v[124:127], v17 offset:3072
    s_cmp_eq_u32 s42, 49152
    v_mfma_f32_16x16x32_bf16 v[56:59], v[104:107], v[96:99], 0
    ds_read_b128 v[128:131], v17 offset:5120
    s_cselect_b32 s42, 0, s42
    v_mfma_f32_16x16x32_bf16 v[72:75], v[104:107], v[100:103], 0
    ds_read_b128 v[132:135], v17 offset:7168
    s_waitcnt lgkmcnt(8)
    v_mfma_f32_16x16x32_bf16 v[76:79], v[108:111], v[100:103], 0
    ds_read_b64_tr_b16 v[136:137], v18 offset:8192
    s_add_u32 s48, s48, 16384
    v_mfma_f32_16x16x32_bf16 v[60:63], v[108:111], v[96:99], 0
    ds_read_b64_tr_b16 v[138:139], v18 offset:12288
    s_cmp_eq_u32 s48, 98304
    v_mfma_f32_16x16x32_bf16 v[44:47], v[108:111], v[92:95], 0
    ds_read_b64_tr_b16 v[140:141], v19 offset:8192
    s_cselect_b32 s48, 0, s48
    v_mfma_f32_16x16x32_bf16 v[28:31], v[108:111], v[88:91], 0
    ds_read_b64_tr_b16 v[142:143], v19 offset:12288
    s_waitcnt lgkmcnt(8)
    v_mfma_f32_16x16x32_bf16 v[32:35], v[112:115], v[88:91], 0
    ds_read_b64_tr_b16 v[144:145], v20 offset:8192
    v_add_u32 v17, s42, v12
    v_mfma_f32_16x16x32_bf16 v[48:51], v[112:115], v[92:95], 0
    ds_read_b64_tr_b16 v[146:147], v20 offset:12288
    s_add_u32 s36, s44, 0
    v_mfma_f32_16x16x32_bf16 v[64:67], v[112:115], v[96:99], 0
    ds_read_b64_tr_b16 v[148:149], v21 offset:8192
    buffer_store_dwordx4 v[200:203], v2, s[16:19], s36 offen sc1
    v_mfma_f32_16x16x32_bf16 v[80:83], v[112:115], v[100:103], 0
    ds_read_b64_tr_b16 v[150:151], v21 offset:12288
    s_add_u32 s36, s45, 0
    v_mfma_f32_16x16x32_bf16 v[84:87], v[116:119], v[100:103], 0
    buffer_store_dwordx2 v[216:217], v238, s[16:19], s36 offen sc1
    v_add_u32 v18, s48, v13
    v_mfma_f32_16x16x32_bf16 v[68:71], v[116:119], v[96:99], 0
    v_add_u32 v19, s48, v14
    v_mfma_f32_16x16x32_bf16 v[52:55], v[116:119], v[92:95], 0
    v_add_u32 v20, s48, v15
    v_mfma_f32_16x16x32_bf16 v[36:39], v[116:119], v[88:91], 0
    v_add_u32 v21, s48, v16
    s_waitcnt lgkmcnt(6)
    v_mfma_f32_16x16x32_bf16 v[24:27], v[136:139], v[120:123], v[24:27]
    v_mfma_f32_16x16x32_bf16 v[40:43], v[136:139], v[124:127], v[40:43]
    v_mfma_f32_16x16x32_bf16 v[56:59], v[136:139], v[128:131], v[56:59]
    s_waitcnt lgkmcnt(0)
    s_barrier
    v_mfma_f32_16x16x32_bf16 v[72:75], v[136:139], v[132:135], v[72:75]
    ds_read_b128 v[88:91], v17 offset:0
    s_add_u32 s36, s44, 229376
    v_mfma_f32_16x16x32_bf16 v[76:79], v[140:143], v[132:135], v[76:79]
    ds_read_b128 v[92:95], v17 offset:2048
    buffer_store_dwordx4 v[204:207], v2, s[16:19], s36 offen sc1
    v_mfma_f32_16x16x32_bf16 v[60:63], v[140:143], v[128:131], v[60:63]
    ds_read_b128 v[96:99], v17 offset:4096
    s_add_u32 s36, s45, 229376
    v_mfma_f32_16x16x32_bf16 v[44:47], v[140:143], v[124:127], v[44:47]
    ds_read_b128 v[100:103], v17 offset:6144
    buffer_store_dwordx2 v[218:219], v238, s[16:19], s36 offen sc1
    v_mfma_f32_16x16x32_bf16 v[28:31], v[140:143], v[120:123], v[28:31]
    ds_read_b64_tr_b16 v[104:105], v18 offset:0
    s_add_u32 s43, s43, 1
    v_mfma_f32_16x16x32_bf16 v[32:35], v[144:147], v[120:123], v[32:35]
    ds_read_b64_tr_b16 v[106:107], v18 offset:4096
    s_cmp_lt_u32 s43, 27
    v_mfma_f32_16x16x32_bf16 v[48:51], v[144:147], v[124:127], v[48:51]
    ds_read_b64_tr_b16 v[108:109], v19 offset:0
    v_mfma_f32_16x16x32_bf16 v[64:67], v[144:147], v[128:131], v[64:67]
    ds_read_b64_tr_b16 v[110:111], v19 offset:4096
    v_mfma_f32_16x16x32_bf16 v[80:83], v[144:147], v[132:135], v[80:83]
    ds_read_b64_tr_b16 v[112:113], v20 offset:0
    v_mfma_f32_16x16x32_bf16 v[84:87], v[148:151], v[132:135], v[84:87]
    ds_read_b64_tr_b16 v[114:115], v20 offset:4096
    v_mfma_f32_16x16x32_bf16 v[68:71], v[148:151], v[128:131], v[68:71]
    ds_read_b64_tr_b16 v[116:117], v21 offset:0
    v_mfma_f32_16x16x32_bf16 v[52:55], v[148:151], v[124:127], v[52:55]
    ds_read_b64_tr_b16 v[118:119], v21 offset:4096
    v_mfma_f32_16x16x32_bf16 v[36:39], v[148:151], v[120:123], v[36:39]
    s_waitcnt lgkmcnt(6)
    v_mfma_f32_16x16x32_bf16 v[24:27], v[104:107], v[88:91], v[24:27]
    ds_read_b128 v[120:123], v17 offset:1024
    s_add_u32 s42, s42, 16384
    v_mfma_f32_16x16x32_bf16 v[40:43], v[104:107], v[92:95], v[40:43]
    ds_read_b128 v[124:127], v17 offset:3072
    s_cmp_eq_u32 s42, 49152
    v_mfma_f32_16x16x32_bf16 v[56:59], v[104:107], v[96:99], v[56:59]
    ds_read_b128 v[128:131], v17 offset:5120
    s_cselect_b32 s42, 0, s42
    v_mfma_f32_16x16x32_bf16 v[72:75], v[104:107], v[100:103], v[72:75]
    ds_read_b128 v[132:135], v17 offset:7168
    s_waitcnt lgkmcnt(8)
    v_mfma_f32_16x16x32_bf16 v[76:79], v[108:111], v[100:103], v[76:79]
    ds_read_b64_tr_b16 v[136:137], v18 offset:8192
    s_add_u32 s48, s48, 16384
    v_mfma_f32_16x16x32_bf16 v[60:63], v[108:111], v[96:99], v[60:63]
    ds_read_b64_tr_b16 v[138:139], v18 offset:12288
    s_cmp_eq_u32 s48, 98304
    v_mfma_f32_16x16x32_bf16 v[44:47], v[108:111], v[92:95], v[44:47]
    ds_read_b64_tr_b16 v[140:141], v19 offset:8192
    s_cselect_b32 s48, 0, s48
    v_mfma_f32_16x16x32_bf16 v[28:31], v[108:111], v[88:91], v[28:31]
    ds_read_b64_tr_b16 v[142:143], v19 offset:12288
    s_waitcnt lgkmcnt(8)
    v_mfma_f32_16x16x32_bf16 v[32:35], v[112:115], v[88:91], v[32:35]
    ds_read_b64_tr_b16 v[144:145], v20 offset:8192
    v_add_u32 v17, s42, v12
    v_mfma_f32_16x16x32_bf16 v[48:51], v[112:115], v[92:95], v[48:51]
    ds_read_b64_tr_b16 v[146:147], v20 offset:12288
    s_add_u32 s36, s44, 458752
    v_mfma_f32_16x16x32_bf16 v[64:67], v[112:115], v[96:99], v[64:67]
    ds_read_b64_tr_b16 v[148:149], v21 offset:8192
    buffer_store_dwordx4 v[208:211], v2, s[16:19], s36 offen sc1
    v_mfma_f32_16x16x32_bf16 v[80:83], v[112:115], v[100:103], v[80:83]
    ds_read_b64_tr_b16 v[150:151], v21 offset:12288
    s_add_u32 s36, s45, 458752
    v_mfma_f32_16x16x32_bf16 v[84:87], v[116:119], v[100:103], v[84:87]
    buffer_store_dwordx2 v[220:221], v238, s[16:19], s36 offen sc1
    v_add_u32 v18, s48, v13
    v_mfma_f32_16x16x32_bf16 v[68:71], v[116:119], v[96:99], v[68:71]
    v_add_u32 v19, s48, v14
    v_mfma_f32_16x16x32_bf16 v[52:55], v[116:119], v[92:95], v[52:55]
    v_add_u32 v20, s48, v15
    v_mfma_f32_16x16x32_bf16 v[36:39], v[116:119], v[88:91], v[36:39]
    v_add_u32 v21, s48, v16
    s_waitcnt lgkmcnt(6)
    v_mfma_f32_16x16x32_bf16 v[24:27], v[136:139], v[120:123], v[24:27]
    v_mfma_f32_16x16x32_bf16 v[40:43], v[136:139], v[124:127], v[40:43]
    s_waitcnt vmcnt(6)
    v_mfma_f32_16x16x32_bf16 v[56:59], v[136:139], v[128:131], v[56:59]
    s_waitcnt lgkmcnt(0)
    s_barrier
    v_mfma_f32_16x16x32_bf16 v[72:75], v[136:139], v[132:135], v[72:75]
    ds_read_b128 v[88:91], v17 offset:0
    s_add_u32 s36, s44, 688128
    v_mfma_f32_16x16x32_bf16 v[76:79], v[140:143], v[132:135], v[76:79]
    ds_read_b128 v[92:95], v17 offset:2048
    buffer_store_dwordx4 v[212:215], v2, s[16:19], s36 offen sc1
    v_mfma_f32_16x16x32_bf16 v[60:63], v[140:143], v[128:131], v[60:63]
    ds_read_b128 v[96:99], v17 offset:4096
    s_add_u32 s36, s45, 688128
    v_mfma_f32_16x16x32_bf16 v[44:47], v[140:143], v[124:127], v[44:47]
    ds_read_b128 v[100:103], v17 offset:6144
    buffer_store_dwordx2 v[222:223], v238, s[16:19], s36 offen sc1
    v_mfma_f32_16x16x32_bf16 v[28:31], v[140:143], v[120:123], v[28:31]
    ds_read_b64_tr_b16 v[104:105], v18 offset:0
    s_add_u32 s43, s43, 1
    v_mfma_f32_16x16x32_bf16 v[32:35], v[144:147], v[120:123], v[32:35]
    ds_read_b64_tr_b16 v[106:107], v18 offset:4096
    s_cmp_lt_u32 s43, 27
    v_mfma_f32_16x16x32_bf16 v[48:51], v[144:147], v[124:127], v[48:51]
    ds_read_b64_tr_b16 v[108:109], v19 offset:0
    v_mfma_f32_16x16x32_bf16 v[64:67], v[144:147], v[128:131], v[64:67]
    ds_read_b64_tr_b16 v[110:111], v19 offset:4096
    v_mfma_f32_16x16x32_bf16 v[80:83], v[144:147], v[132:135], v[80:83]
    ds_read_b64_tr_b16 v[112:113], v20 offset:0
    v_mfma_f32_16x16x32_bf16 v[84:87], v[148:151], v[132:135], v[84:87]
    ds_read_b64_tr_b16 v[114:115], v20 offset:4096
    v_mfma_f32_16x16x32_bf16 v[68:71], v[148:151], v[128:131], v[68:71]
    ds_read_b64_tr_b16 v[116:117], v21 offset:0
    v_mfma_f32_16x16x32_bf16 v[52:55], v[148:151], v[124:127], v[52:55]
    ds_read_b64_tr_b16 v[118:119], v21 offset:4096
    v_mfma_f32_16x16x32_bf16 v[36:39], v[148:151], v[120:123], v[36:39]
    s_waitcnt lgkmcnt(6)
mm_27:
    v_mfma_f32_16x16x32_bf16 v[24:27], v[104:107], v[88:91], v[24:27]
    ds_read_b128 v[120:123], v17 offset:1024
    s_add_u32 s42, s42, 16384
    v_mfma_f32_16x16x32_bf16 v[40:43], v[104:107], v[92:95], v[40:43]
    ds_read_b128 v[124:127], v17 offset:3072
    s_cmp_eq_u32 s42, 49152
    v_mfma_f32_16x16x32_bf16 v[56:59], v[104:107], v[96:99], v[56:59]
    ds_read_b128 v[128:131], v17 offset:5120
    s_cselect_b32 s42, 0, s42
    v_mfma_f32_16x16x32_bf16 v[72:75], v[104:107], v[100:103], v[72:75]
    ds_read_b128 v[132:135], v17 offset:7168
    s_waitcnt lgkmcnt(8)
    v_mfma_f32_16x16x32_bf16 v[76:79], v[108:111], v[100:103], v[76:79]
    ds_read_b64_tr_b16 v[136:137], v18 offset:8192
    s_add_u32 s48, s48, 16384
    v_mfma_f32_16x16x32_bf16 v[60:63], v[108:111], v[96:99], v[60:63]
    ds_read_b64_tr_b16 v[138:139], v18 offset:12288
    s_cmp_eq_u32 s48, 98304
    v_mfma_f32_16x16x32_bf16 v[44:47], v[108:111], v[92:95], v[44:47]
    ds_read_b64_tr_b16 v[140:141], v19 offset:8192
    s_cselect_b32 s48, 0, s48
    v_mfma_f32_16x16x32_bf16 v[28:31], v[108:111], v[88:91], v[28:31]
    ds_read_b64_tr_b16 v[142:143], v19 offset:12288
    s_waitcnt lgkmcnt(8)
    v_mfma_f32_16x16x32_bf16 v[32:35], v[112:115], v[88:91], v[32:35]
    ds_read_b64_tr_b16 v[144:145], v20 offset:8192
    v_add_u32 v17, s42, v12
    v_mfma_f32_16x16x32_bf16 v[48:51], v[112:115], v[92:95], v[48:51]
    ds_read_b64_tr_b16 v[146:147], v20 offset:12288
    v_add_u32 v18, s48, v13
    v_mfma_f32_16x16x32_bf16 v[64:67], v[112:115], v[96:99], v[64:67]
    ds_read_b64_tr_b16 v[148:149], v21 offset:8192
    v_add_u32 v19, s48, v14
    v_mfma_f32_16x16x32_bf16 v[80:83], v[112:115], v[100:103], v[80:83]
    ds_read_b64_tr_b16 v[150:151], v21 offset:12288
    v_add_u32 v20, s48, v15
    v_mfma_f32_16x16x32_bf16 v[84:87], v[116:119], v[100:103], v[84:87]
    v_add_u32 v21, s48, v16
    v_mfma_f32_16x16x32_bf16 v[68:71], v[116:119], v[96:99], v[68:71]
    v_mfma_f32_16x16x32_bf16 v[52:55], v[116:119], v[92:95], v[52:55]
    v_mfma_f32_16x16x32_bf16 v[36:39], v[116:119], v[88:91], v[36:39]
    s_waitcnt lgkmcnt(6)
    v_mfma_f32_16x16x32_bf16 v[24:27], v[136:139], v[120:123], v[24:27]
    s_add_u32 s43, s43, 1
    s_cmp_lt_u32 s43, 4
    v_mfma_f32_16x16x32_bf16 v[40:43], v[136:139], v[124:127], v[40:43]
    v_mfma_f32_16x16x32_bf16 v[56:59], v[136:139], v[128:131], v[56:59]
    s_waitcnt lgkmcnt(0)
    s_barrier
    v_mfma_f32_16x16x32_bf16 v[72:75], v[136:139], v[132:135], v[72:75]
    ds_read_b128 v[88:91], v17 offset:0
    v_mfma_f32_16x16x32_bf16 v[76:79], v[140:143], v[132:135], v[76:79]
    ds_read_b128 v[92:95], v17 offset:2048
    v_mfma_f32_16x16x32_bf16 v[60:63], v[140:143], v[128:131], v[60:63]
    ds_read_b128 v[96:99], v17 offset:4096
    v_mfma_f32_16x16x32_bf16 v[44:47], v[140:143], v[124:127], v[44:47]
    ds_read_b128 v[100:103], v17 offset:6144
    v_mfma_f32_16x16x32_bf16 v[28:31], v[140:143], v[120:123], v[28:31]
    ds_read_b64_tr_b16 v[104:105], v18 offset:0
    v_mfma_f32_16x16x32_bf16 v[32:35], v[144:147], v[120:123], v[32:35]
    ds_read_b64_tr_b16 v[106:107], v18 offset:4096
    v_mfma_f32_16x16x32_bf16 v[48:51], v[144:147], v[124:127], v[48:51]
    ds_read_b64_tr_b16 v[108:109], v19 offset:0
    v_mfma_f32_16x16x32_bf16 v[64:67], v[144:147], v[128:131], v[64:67]
    ds_read_b64_tr_b16 v[110:111], v19 offset:4096
    v_mfma_f32_16x16x32_bf16 v[80:83], v[144:147], v[132:135], v[80:83]
    ds_read_b64_tr_b16 v[112:113], v20 offset:0
    v_mfma_f32_16x16x32_bf16 v[84:87], v[148:151], v[132:135], v[84:87]
    ds_read_b64_tr_b16 v[114:115], v20 offset:4096
    v_mfma_f32_16x16x32_bf16 v[68:71], v[148:151], v[128:131], v[68:71]
    ds_read_b64_tr_b16 v[116:117], v21 offset:0
    v_mfma_f32_16x16x32_bf16 v[52:55], v[148:151], v[124:127], v[52:55]
    ds_read_b64_tr_b16 v[118:119], v21 offset:4096
    v_mfma_f32_16x16x32_bf16 v[36:39], v[148:151], v[120:123], v[36:39]
    s_waitcnt lgkmcnt(6)
    s_cbranch_scc1 mm_27
mm_28:
    v_mfma_f32_16x16x32_bf16 v[24:27], v[104:107], v[88:91], v[24:27]
    ds_read_b128 v[120:123], v17 offset:1024
    s_add_u32 s42, s42, 16384
    v_mfma_f32_16x16x32_bf16 v[40:43], v[104:107], v[92:95], v[40:43]
    ds_read_b128 v[124:127], v17 offset:3072
    s_cmp_eq_u32 s42, 49152
    v_mfma_f32_16x16x32_bf16 v[56:59], v[104:107], v[96:99], v[56:59]
    ds_read_b128 v[128:131], v17 offset:5120
    s_cselect_b32 s42, 0, s42
    v_mfma_f32_16x16x32_bf16 v[72:75], v[104:107], v[100:103], v[72:75]
    ds_read_b128 v[132:135], v17 offset:7168
    s_waitcnt lgkmcnt(8)
    v_mfma_f32_16x16x32_bf16 v[76:79], v[108:111], v[100:103], v[76:79]
    ds_read_b64_tr_b16 v[136:137], v18 offset:8192
    s_add_u32 s48, s48, 16384
    v_mfma_f32_16x16x32_bf16 v[60:63], v[108:111], v[96:99], v[60:63]
    ds_read_b64_tr_b16 v[138:139], v18 offset:12288
    s_cmp_eq_u32 s48, 98304
    v_mfma_f32_16x16x32_bf16 v[44:47], v[108:111], v[92:95], v[44:47]
    ds_read_b64_tr_b16 v[140:141], v19 offset:8192
    s_cselect_b32 s48, 0, s48
    v_mfma_f32_16x16x32_bf16 v[28:31], v[108:111], v[88:91], v[28:31]
    ds_read_b64_tr_b16 v[142:143], v19 offset:12288
    s_waitcnt lgkmcnt(8)
    v_mfma_f32_16x16x32_bf16 v[32:35], v[112:115], v[88:91], v[32:35]
    ds_read_b64_tr_b16 v[144:145], v20 offset:8192
    v_add_u32 v17, s42, v12
    v_mfma_f32_16x16x32_bf16 v[48:51], v[112:115], v[92:95], v[48:51]
    ds_read_b64_tr_b16 v[146:147], v20 offset:12288
    v_add_u32 v18, s48, v13
    v_mfma_f32_16x16x32_bf16 v[64:67], v[112:115], v[96:99], v[64:67]
    ds_read_b64_tr_b16 v[148:149], v21 offset:8192
    v_add_u32 v19, s48, v14
    v_mfma_f32_16x16x32_bf16 v[80:83], v[112:115], v[100:103], v[80:83]
    ds_read_b64_tr_b16 v[150:151], v21 offset:12288
    v_add_u32 v20, s48, v15
    v_mfma_f32_16x16x32_bf16 v[84:87], v[116:119], v[100:103], v[84:87]
    v_add_u32 v21, s48, v16
    v_mfma_f32_16x16x32_bf16 v[68:71], v[116:119], v[96:99], v[68:71]
    v_mfma_f32_16x16x32_bf16 v[52:55], v[116:119], v[92:95], v[52:55]
    v_mfma_f32_16x16x32_bf16 v[36:39], v[116:119], v[88:91], v[36:39]
    s_waitcnt lgkmcnt(6)
    v_mfma_f32_16x16x32_bf16 v[24:27], v[136:139], v[120:123], v[24:27]
    s_add_u32 s43, s43, 1
    s_cmp_lt_u32 s43, 27
    v_mfma_f32_16x16x32_bf16 v[40:43], v[136:139], v[124:127], v[40:43]
    s_waitcnt vmcnt(0)
    v_mfma_f32_16x16x32_bf16 v[56:59], v[136:139], v[128:131], v[56:59]
    s_waitcnt lgkmcnt(0)
    s_barrier
    v_mfma_f32_16x16x32_bf16 v[72:75], v[136:139], v[132:135], v[72:75]
    ds_read_b128 v[88:91], v17 offset:0
    v_mfma_f32_16x16x32_bf16 v[76:79], v[140:143], v[132:135], v[76:79]
    ds_read_b128 v[92:95], v17 offset:2048
    v_mfma_f32_16x16x32_bf16 v[60:63], v[140:143], v[128:131], v[60:63]
    ds_read_b128 v[96:99], v17 offset:4096
    v_mfma_f32_16x16x32_bf16 v[44:47], v[140:143], v[124:127], v[44:47]
    ds_read_b128 v[100:103], v17 offset:6144
    v_mfma_f32_16x16x32_bf16 v[28:31], v[140:143], v[120:123], v[28:31]
    ds_read_b64_tr_b16 v[104:105], v18 offset:0
    v_mfma_f32_16x16x32_bf16 v[32:35], v[144:147], v[120:123], v[32:35]
    ds_read_b64_tr_b16 v[106:107], v18 offset:4096
    v_mfma_f32_16x16x32_bf16 v[48:51], v[144:147], v[124:127], v[48:51]
    ds_read_b64_tr_b16 v[108:109], v19 offset:0
    v_mfma_f32_16x16x32_bf16 v[64:67], v[144:147], v[128:131], v[64:67]
    ds_read_b64_tr_b16 v[110:111], v19 offset:4096
    v_mfma_f32_16x16x32_bf16 v[80:83], v[144:147], v[132:135], v[80:83]
    ds_read_b64_tr_b16 v[112:113], v20 offset:0
    v_mfma_f32_16x16x32_bf16 v[84:87], v[148:151], v[132:135], v[84:87]
    ds_read_b64_tr_b16 v[114:115], v20 offset:4096
    v_mfma_f32_16x16x32_bf16 v[68:71], v[148:151], v[128:131], v[68:71]
    ds_read_b64_tr_b16 v[116:117], v21 offset:0
    v_mfma_f32_16x16x32_bf16 v[52:55], v[148:151], v[124:127], v[52:55]
    ds_read_b64_tr_b16 v[118:119], v21 offset:4096
    v_mfma_f32_16x16x32_bf16 v[36:39], v[148:151], v[120:123], v[36:39]
    s_waitcnt lgkmcnt(6)
    s_cbranch_scc1 mm_28
    s_cmp_eq_u32 s60, 1
    s_cbranch_scc1 G4_last
    v_mfma_f32_16x16x32_bf16 v[24:27], v[104:107], v[88:91], v[24:27]
    ds_read_b128 v[120:123], v17 offset:1024
    v_mfma_f32_16x16x32_bf16 v[40:43], v[104:107], v[92:95], v[40:43]
    ds_read_b128 v[124:127], v17 offset:3072
    v_mfma_f32_16x16x32_bf16 v[56:59], v[104:107], v[96:99], v[56:59]
    ds_read_b128 v[128:131], v17 offset:5120
    v_mfma_f32_16x16x32_bf16 v[72:75], v[104:107], v[100:103], v[72:75]
    ds_read_b128 v[132:135], v17 offset:7168
    s_waitcnt lgkmcnt(8)
    v_mfma_f32_16x16x32_bf16 v[76:79], v[108:111], v[100:103], v[76:79]
    ds_read_b64_tr_b16 v[136:137], v18 offset:8192
    v_mfma_f32_16x16x32_bf16 v[60:63], v[108:111], v[96:99], v[60:63]
    ds_read_b64_tr_b16 v[138:139], v18 offset:12288
    v_mfma_f32_16x16x32_bf16 v[44:47], v[108:111], v[92:95], v[44:47]
    ds_read_b64_tr_b16 v[140:141], v19 offset:8192
    v_mfma_f32_16x16x32_bf16 v[28:31], v[108:111], v[88:91], v[28:31]
    ds_read_b64_tr_b16 v[142:143], v19 offset:12288
    s_waitcnt lgkmcnt(8)
    v_mfma_f32_16x16x32_bf16 v[32:35], v[112:115], v[88:91], v[32:35]
    ds_read_b64_tr_b16 v[144:145], v20 offset:8192
    v_mfma_f32_16x16x32_bf16 v[48:51], v[112:115], v[92:95], v[48:51]
    ds_read_b64_tr_b16 v[146:147], v20 offset:12288
    v_mfma_f32_16x16x32_bf16 v[64:67], v[112:115], v[96:99], v[64:67]
    ds_read_b64_tr_b16 v[148:149], v21 offset:8192
    v_mfma_f32_16x16x32_bf16 v[80:83], v[112:115], v[100:103], v[80:83]
    ds_read_b64_tr_b16 v[150:151], v21 offset:12288
    v_mfma_f32_16x16x32_bf16 v[84:87], v[116:119], v[100:103], v[84:87]
    v_mfma_f32_16x16x32_bf16 v[68:71], v[116:119], v[96:99], v[68:71]
    v_mfma_f32_16x16x32_bf16 v[52:55], v[116:119], v[92:95], v[52:55]
    v_mfma_f32_16x16x32_bf16 v[36:39], v[116:119], v[88:91], v[36:39]
    s_waitcnt lgkmcnt(0)
    v_mfma_f32_16x16x32_bf16 v[24:27], v[136:139], v[120:123], v[24:27]
    s_mul_i32 s36, s31, 524288
    s_add_u32 s36, s36, 0
    s_add_u32 s16, s62, s36
    v_mfma_f32_16x16x32_bf16 v[40:43], v[136:139], v[124:127], v[40:43]
    s_addc_u32 s17, s63, 0
    s_mov_b32 s18, 516096
    s_mov_b32 s19, 0x20000
    v_mfma_f32_16x16x32_bf16 v[56:59], v[136:139], v[128:131], v[56:59]
    v_mfma_f32_16x16x32_bf16 v[72:75], v[136:139], v[132:135], v[72:75]
    v_mfma_f32_16x16x32_bf16 v[76:79], v[140:143], v[132:135], v[76:79]
    v_mfma_f32_16x16x32_bf16 v[60:63], v[140:143], v[128:131], v[60:63]
    v_mfma_f32_16x16x32_bf16 v[44:47], v[140:143], v[124:127], v[44:47]
    v_mfma_f32_16x16x32_bf16 v[28:31], v[140:143], v[120:123], v[28:31]
    v_mfma_f32_16x16x32_bf16 v[32:35], v[144:147], v[120:123], v[32:35]
    v_mfma_f32_16x16x32_bf16 v[48:51], v[144:147], v[124:127], v[48:51]
    v_mfma_f32_16x16x32_bf16 v[64:67], v[144:147], v[128:131], v[64:67]
    v_mfma_f32_16x16x32_bf16 v[80:83], v[144:147], v[132:135], v[80:83]
    v_mfma_f32_16x16x32_bf16 v[84:87], v[148:151], v[132:135], v[84:87]
    v_mfma_f32_16x16x32_bf16 v[68:71], v[148:151], v[128:131], v[68:71]
    v_mfma_f32_16x16x32_bf16 v[52:55], v[148:151], v[124:127], v[52:55]
    v_mfma_f32_16x16x32_bf16 v[36:39], v[148:151], v[120:123], v[36:39]
    s_add_u32 s36, s39, 0
    v_cvt_pk_bf16_f32 v24, v24, v25
    v_cvt_pk_bf16_f32 v25, v26, v27
    v_cvt_pk_bf16_f32 v26, v28, v29
    v_cvt_pk_bf16_f32 v27, v30, v31
    v_or_b32 v24, 1, v24
    buffer_store_dwordx4 v[24:27], v2, s[16:19], s36 offen offset:0 sc1
    v_cvt_pk_bf16_f32 v32, v32, v33
    v_cvt_pk_bf16_f32 v33, v34, v35
    v_cvt_pk_bf16_f32 v34, v36, v37
    v_cvt_pk_bf16_f32 v35, v38, v39
    v_or_b32 v32, 1, v32
    buffer_store_dwordx4 v[32:35], v2, s[16:19], s36 offen offset:1024 sc1
    s_add_u32 s36, s39, 65536
    v_cvt_pk_bf16_f32 v40, v40, v41
    v_cvt_pk_bf16_f32 v41, v42, v43
    v_cvt_pk_bf16_f32 v42, v44, v45
    v_cvt_pk_bf16_f32 v43, v46, v47
    v_or_b32 v40, 1, v40
    buffer_store_dwordx4 v[40:43], v2, s[16:19], s36 offen offset:0 sc1
    v_cvt_pk_bf16_f32 v48, v48, v49
    v_cvt_pk_bf16_f32 v49, v50, v51
    v_cvt_pk_bf16_f32 v50, v52, v53
    v_cvt_pk_bf16_f32 v51, v54, v55
    v_or_b32 v48, 1, v48
    buffer_store_dwordx4 v[48:51], v2, s[16:19], s36 offen offset:1024 sc1
    s_add_u32 s36, s39, 131072
    v_cvt_pk_bf16_f32 v56, v56, v57
    v_cvt_pk_bf16_f32 v57, v58, v59
    v_cvt_pk_bf16_f32 v58, v60, v61
    v_cvt_pk_bf16_f32 v59, v62, v63
    v_or_b32 v56, 1, v56
    buffer_store_dwordx4 v[56:59], v2, s[16:19], s36 offen offset:0 sc1
    v_cvt_pk_bf16_f32 v64, v64, v65
    v_cvt_pk_bf16_f32 v65, v66, v67
    v_cvt_pk_bf16_f32 v66, v68, v69
    v_cvt_pk_bf16_f32 v67, v70, v71
    v_or_b32 v64, 1, v64
    buffer_store_dwordx4 v[64:67], v2, s[16:19], s36 offen offset:1024 sc1
    s_add_u32 s36, s39, 196608
    v_cvt_pk_bf16_f32 v72, v72, v73
    v_cvt_pk_bf16_f32 v73, v74, v75
    v_cvt_pk_bf16_f32 v74, v76, v77
    v_cvt_pk_bf16_f32 v75, v78, v79
    v_or_b32 v72, 1, v72
    buffer_store_dwordx4 v[72:75], v2, s[16:19], s36 offen offset:0 sc1
    v_cvt_pk_bf16_f32 v80, v80, v81
    v_cvt_pk_bf16_f32 v81, v82, v83
    v_cvt_pk_bf16_f32 v82, v84, v85
    v_cvt_pk_bf16_f32 v83, v86, v87
    v_or_b32 v80, 1, v80
    buffer_store_dwordx4 v[80:83], v2, s[16:19], s36 offen offset:1024 sc1
    s_barrier
    s_branch NEXT
G4_last:
    v_mfma_f32_16x16x32_bf16 v[24:27], v[104:107], v[88:91], v[24:27]
    ds_read_b128 v[120:123], v17 offset:1024
    v_mfma_f32_16x16x32_bf16 v[40:43], v[104:107], v[92:95], v[40:43]
    ds_read_b128 v[124:127], v17 offset:3072
    v_mfma_f32_16x16x32_bf16 v[56:59], v[104:107], v[96:99], v[56:59]
    ds_read_b128 v[128:131], v17 offset:5120
    v_mfma_f32_16x16x32_bf16 v[72:75], v[104:107], v[100:103], v[72:75]
    ds_read_b128 v[132:135], v17 offset:7168
    s_waitcnt lgkmcnt(8)
    v_mfma_f32_16x16x32_bf16 v[76:79], v[108:111], v[100:103], v[76:79]
    ds_read_b64_tr_b16 v[136:137], v18 offset:8192
    v_mfma_f32_16x16x32_bf16 v[60:63], v[108:111], v[96:99], v[60:63]
    ds_read_b64_tr_b16 v[138:139], v18 offset:12288
    v_mfma_f32_16x16x32_bf16 v[44:47], v[108:111], v[92:95], v[44:47]
    ds_read_b64_tr_b16 v[140:141], v19 offset:8192
    v_mfma_f32_16x16x32_bf16 v[28:31], v[108:111], v[88:91], v[28:31]
    ds_read_b64_tr_b16 v[142:143], v19 offset:12288
    s_waitcnt lgkmcnt(8)
    v_mfma_f32_16x16x32_bf16 v[32:35], v[112:115], v[88:91], v[32:35]
    ds_read_b64_tr_b16 v[144:145], v20 offset:8192
    v_mfma_f32_16x16x32_bf16 v[48:51], v[112:115], v[92:95], v[48:51]
    ds_read_b64_tr_b16 v[146:147], v20 offset:12288
    s_load_dwordx2 s[6:7], s[0:1], 88
    v_mfma_f32_16x16x32_bf16 v[64:67], v[112:115], v[96:99], v[64:67]
    ds_read_b64_tr_b16 v[148:149], v21 offset:8192
    v_mfma_f32_16x16x32_bf16 v[80:83], v[112:115], v[100:103], v[80:83]
    ds_read_b64_tr_b16 v[150:151], v21 offset:12288
    v_mfma_f32_16x16x32_bf16 v[84:87], v[116:119], v[100:103], v[84:87]
    v_mfma_f32_16x16x32_bf16 v[68:71], v[116:119], v[96:99], v[68:71]
    v_mfma_f32_16x16x32_bf16 v[52:55], v[116:119], v[92:95], v[52:55]
    v_mfma_f32_16x16x32_bf16 v[36:39], v[116:119], v[88:91], v[36:39]
    s_waitcnt lgkmcnt(0)
    v_mfma_f32_16x16x32_bf16 v[24:27], v[136:139], v[120:123], v[24:27]
    s_add_u32 s16, s62, 0x80000
    s_addc_u32 s17, s63, 0
    s_mov_b32 s18, 0x7e000
    v_mfma_f32_16x16x32_bf16 v[40:43], v[136:139], v[124:127], v[40:43]
    s_mov_b32 s19, 0x20000
    s_mov_b32 s20, s6
    s_mov_b32 s21, s7
    v_mfma_f32_16x16x32_bf16 v[56:59], v[136:139], v[128:131], v[56:59]
    s_mov_b32 s22, 0x400000
    s_mov_b32 s23, 0x20000
    s_add_u32 s44, s40, 65536
    v_mfma_f32_16x16x32_bf16 v[72:75], v[136:139], v[132:135], v[72:75]
    s_lshl_b32 s46, s28, 3
    s_add_u32 s46, s46, s37
    s_lshl_b32 s47, s31, 1
    v_mfma_f32_16x16x32_bf16 v[76:79], v[140:143], v[132:135], v[76:79]
    s_add_u32 s46, s46, s47
    s_lshl_b32 s46, s46, 15
    s_lshl_b32 s47, s38, 5
    v_mfma_f32_16x16x32_bf16 v[60:63], v[140:143], v[128:131], v[60:63]
    s_add_u32 s46, s46, s47
    s_add_u32 s47, s46, 32768
    v_and_b32 v225, 1, v23
    v_mfma_f32_16x16x32_bf16 v[44:47], v[140:143], v[124:127], v[44:47]
    v_lshlrev_b32 v224, 11, v22
    v_lshl_add_u32 v224, v225, 5, v224
    v_mfma_f32_16x16x32_bf16 v[28:31], v[140:143], v[120:123], v[28:31]
    v_lshrrev_b32 v225, 1, v23
    v_lshl_add_u32 v224, v225, 4, v224
    v_mfma_f32_16x16x32_bf16 v[32:35], v[144:147], v[120:123], v[32:35]
    v_lshrrev_b32 v225, 3, v22
    v_mul_u32_u24 v225, 16320, v225
    v_mfma_f32_16x16x32_bf16 v[48:51], v[144:147], v[124:127], v[48:51]
    v_sub_u32 v224, v224, v225
    v_add_u32 v225, 16384, v224
    v_mfma_f32_16x16x32_bf16 v[64:67], v[144:147], v[128:131], v[64:67]
    v_mfma_f32_16x16x32_bf16 v[80:83], v[144:147], v[132:135], v[80:83]
    v_mfma_f32_16x16x32_bf16 v[84:87], v[148:151], v[132:135], v[84:87]
    v_mfma_f32_16x16x32_bf16 v[68:71], v[148:151], v[128:131], v[68:71]
    v_mfma_f32_16x16x32_bf16 v[52:55], v[148:151], v[124:127], v[52:55]
    v_mfma_f32_16x16x32_bf16 v[36:39], v[148:151], v[120:123], v[36:39]
    s_cmp_eq_u32 s31, 0
    s_cbranch_scc1 G4_k0
    s_add_u32 s36, s41, 0
    v_cvt_pk_bf16_f32 v24, v24, v25
    v_cvt_pk_bf16_f32 v25, v26, v27
    v_cvt_pk_bf16_f32 v26, v28, v29
    v_cvt_pk_bf16_f32 v27, v30, v31
    v_or_b32 v24, 1, v24
    buffer_store_dwordx4 v[24:27], v2, s[16:19], s36 offen offset:0 sc1
    v_cvt_pk_bf16_f32 v32, v32, v33
    v_cvt_pk_bf16_f32 v33, v34, v35
    v_cvt_pk_bf16_f32 v34, v36, v37
    v_cvt_pk_bf16_f32 v35, v38, v39
    v_or_b32 v32, 1, v32
    buffer_store_dwordx4 v[32:35], v2, s[16:19], s36 offen offset:1024 sc1
    s_add_u32 s36, s41, 65536
    v_cvt_pk_bf16_f32 v40, v40, v41
    v_cvt_pk_bf16_f32 v41, v42, v43
    v_cvt_pk_bf16_f32 v42, v44, v45
    v_cvt_pk_bf16_f32 v43, v46, v47
    v_or_b32 v40, 1, v40
    buffer_store_dwordx4 v[40:43], v2, s[16:19], s36 offen offset:0 sc1
    v_cvt_pk_bf16_f32 v48, v48, v49
    v_cvt_pk_bf16_f32 v49, v50, v51
    v_cvt_pk_bf16_f32 v50, v52, v53
    v_cvt_pk_bf16_f32 v51, v54, v55
    v_or_b32 v48, 1, v48
    buffer_store_dwordx4 v[48:51], v2, s[16:19], s36 offen offset:1024 sc1
    v_pk_mov_b32 v[24:25], v[56:57], v[56:57] op_sel:[0,1]
    v_pk_mov_b32 v[26:27], v[58:59], v[58:59] op_sel:[0,1]
    v_pk_mov_b32 v[28:29], v[60:61], v[60:61] op_sel:[0,1]
    v_pk_mov_b32 v[30:31], v[62:63], v[62:63] op_sel:[0,1]
    v_pk_mov_b32 v[32:33], v[64:65], v[64:65] op_sel:[0,1]
    v_pk_mov_b32 v[34:35], v[66:67], v[66:67] op_sel:[0,1]
    v_pk_mov_b32 v[36:37], v[68:69], v[68:69] op_sel:[0,1]
    v_pk_mov_b32 v[38:39], v[70:71], v[70:71] op_sel:[0,1]
    v_pk_mov_b32 v[40:41], v[72:73], v[72:73] op_sel:[0,1]
    v_pk_mov_b32 v[42:43], v[74:75], v[74:75] op_sel:[0,1]
    v_pk_mov_b32 v[44:45], v[76:77], v[76:77] op_sel:[0,1]
    v_pk_mov_b32 v[46:47], v[78:79], v[78:79] op_sel:[0,1]
    v_pk_mov_b32 v[48:49], v[80:81], v[80:81] op_sel:[0,1]
    v_pk_mov_b32 v[50:51], v[82:83], v[82:83] op_sel:[0,1]
    v_pk_mov_b32 v[52:53], v[84:85], v[84:85] op_sel:[0,1]
    v_pk_mov_b32 v[54:55], v[86:87], v[86:87] op_sel:[0,1]
    s_branch G4_k1
G4_k0:
    s_add_u32 s36, s41, 0
    v_cvt_pk_bf16_f32 v56, v56, v57
    v_cvt_pk_bf16_f32 v57, v58, v59
    v_cvt_pk_bf16_f32 v58, v60, v61
    v_cvt_pk_bf16_f32 v59, v62, v63
    v_or_b32 v56, 1, v56
    buffer_store_dwordx4 v[56:59], v2, s[16:19], s36 offen offset:0 sc1
    v_cvt_pk_bf16_f32 v64, v64, v65
    v_cvt_pk_bf16_f32 v65, v66, v67
    v_cvt_pk_bf16_f32 v66, v68, v69
    v_cvt_pk_bf16_f32 v67, v70, v71
    v_or_b32 v64, 1, v64
    buffer_store_dwordx4 v[64:67], v2, s[16:19], s36 offen offset:1024 sc1
    s_add_u32 s36, s41, 65536
    v_cvt_pk_bf16_f32 v72, v72, v73
    v_cvt_pk_bf16_f32 v73, v74, v75
    v_cvt_pk_bf16_f32 v74, v76, v77
    v_cvt_pk_bf16_f32 v75, v78, v79
    v_or_b32 v72, 1, v72
    buffer_store_dwordx4 v[72:75], v2, s[16:19], s36 offen offset:0 sc1
    v_cvt_pk_bf16_f32 v80, v80, v81
    v_cvt_pk_bf16_f32 v81, v82, v83
    v_cvt_pk_bf16_f32 v82, v84, v85
    v_cvt_pk_bf16_f32 v83, v86, v87
    v_or_b32 v80, 1, v80
    buffer_store_dwordx4 v[80:83], v2, s[16:19], s36 offen offset:1024 sc1
G4_k1:
    s_mov_b32 s78, 0x3f80
    s_mov_b32 s79, 0x3f800000
    v_dot2_f32_bf16 v24, v180, s78, v24
    v_dot2_f32_bf16 v25, v180, s79, v25
    v_dot2_f32_bf16 v26, v181, s78, v26
    v_dot2_f32_bf16 v27, v181, s79, v27
    v_dot2_f32_bf16 v28, v182, s78, v28
    v_dot2_f32_bf16 v29, v182, s79, v29
    v_dot2_f32_bf16 v30, v183, s78, v30
    v_dot2_f32_bf16 v31, v183, s79, v31
    v_dot2_f32_bf16 v32, v188, s78, v32
    v_dot2_f32_bf16 v33, v188, s79, v33
    v_dot2_f32_bf16 v34, v189, s78, v34
    v_dot2_f32_bf16 v35, v189, s79, v35
    v_dot2_f32_bf16 v36, v190, s78, v36
    v_dot2_f32_bf16 v37, v190, s79, v37
    v_dot2_f32_bf16 v38, v191, s78, v38
    v_dot2_f32_bf16 v39, v191, s79, v39
    v_dot2_f32_bf16 v40, v196, s78, v40
    v_dot2_f32_bf16 v41, v196, s79, v41
    v_dot2_f32_bf16 v42, v197, s78, v42
    v_dot2_f32_bf16 v43, v197, s79, v43
    v_dot2_f32_bf16 v44, v198, s78, v44
    v_dot2_f32_bf16 v45, v198, s79, v45
    v_dot2_f32_bf16 v46, v199, s78, v46
    v_dot2_f32_bf16 v47, v199, s79, v47
    v_dot2_f32_bf16 v48, v234, s78, v48
    v_dot2_f32_bf16 v49, v234, s79, v49
    v_dot2_f32_bf16 v50, v235, s78, v50
    v_dot2_f32_bf16 v51, v235, s79, v51
    v_dot2_f32_bf16 v52, v236, s78, v52
    v_dot2_f32_bf16 v53, v236, s79, v53
    v_dot2_f32_bf16 v54, v237, s78, v54
    v_dot2_f32_bf16 v55, v237, s79, v55
    v_dot2_f32_bf16 v24, v184, s78, v24
    v_dot2_f32_bf16 v25, v184, s79, v25
    v_dot2_f32_bf16 v26, v185, s78, v26
    v_dot2_f32_bf16 v27, v185, s79, v27
    v_dot2_f32_bf16 v28, v186, s78, v28
    v_dot2_f32_bf16 v29, v186, s79, v29
    v_dot2_f32_bf16 v30, v187, s78, v30
    v_dot2_f32_bf16 v31, v187, s79, v31
    v_dot2_f32_bf16 v32, v192, s78, v32
    v_dot2_f32_bf16 v33, v192, s79, v33
    v_dot2_f32_bf16 v34, v193, s78, v34
    v_dot2_f32_bf16 v35, v193, s79, v35
    v_dot2_f32_bf16 v36, v194, s78, v36
    v_dot2_f32_bf16 v37, v194, s79, v37
    v_dot2_f32_bf16 v38, v195, s78, v38
    v_dot2_f32_bf16 v39, v195, s79, v39
    v_dot2_f32_bf16 v40, v230, s78, v40
    v_dot2_f32_bf16 v41, v230, s79, v41
    v_dot2_f32_bf16 v42, v231, s78, v42
    v_dot2_f32_bf16 v43, v231, s79, v43
    v_dot2_f32_bf16 v44, v232, s78, v44
    v_dot2_f32_bf16 v45, v232, s79, v45
    v_dot2_f32_bf16 v46, v233, s78, v46
    v_dot2_f32_bf16 v47, v233, s79, v47
    v_dot2_f32_bf16 v48, v248, s78, v48
    v_dot2_f32_bf16 v49, v248, s79, v49
    v_dot2_f32_bf16 v50, v249, s78, v50
    v_dot2_f32_bf16 v51, v249, s79, v51
    v_dot2_f32_bf16 v52, v250, s78, v52
    v_dot2_f32_bf16 v53, v250, s79, v53
    v_dot2_f32_bf16 v54, v251, s78, v54
    v_dot2_f32_bf16 v55, v251, s79, v55
    s_mov_b32 s53, 0
dp_29:
    buffer_load_dwordx4 v[208:211], v2, s[16:19], s40 offen offset:0 sc1
    buffer_load_dwordx4 v[212:215], v2, s[16:19], s40 offen offset:1024 sc1
    buffer_load_dwordx4 v[216:219], v2, s[16:19], s44 offen offset:0 sc1
    buffer_load_dwordx4 v[220:223], v2, s[16:19], s44 offen offset:1024 sc1
    s_waitcnt vmcnt(0)
    v_bitop3_b32 v6, v208, v212, v216 bitop3:0x80
    v_bitop3_b32 v6, v6, v220, 1 bitop3:0x80
    v_cmp_eq_u32 vcc, 0, v6
    s_cbranch_vccz dq_30
    s_sleep 2
    s_add_u32 s53, s53, 1
    s_cmp_lt_u32 s53, s61
    s_cbranch_scc1 dp_29
    s_mov_b32 s61, 0
dq_30:
    v_dot2_f32_bf16 v24, v208, s78, v24
    v_dot2_f32_bf16 v25, v208, s79, v25
    v_dot2_f32_bf16 v26, v209, s78, v26
    v_dot2_f32_bf16 v27, v209, s79, v27
    v_dot2_f32_bf16 v28, v210, s78, v28
    v_dot2_f32_bf16 v29, v210, s79, v29
    v_dot2_f32_bf16 v30, v211, s78, v30
    v_dot2_f32_bf16 v31, v211, s79, v31
    v_cvt_pk_bf16_f32 v24, v24, v25
    v_cvt_pk_bf16_f32 v25, v26, v27
    v_cvt_pk_bf16_f32 v26, v28, v29
    v_cvt_pk_bf16_f32 v27, v30, v31
    s_nop 0
    v_permlane16_swap_b32 v24, v26
    v_permlane16_swap_b32 v25, v27
    v_dot2_f32_bf16 v32, v212, s78, v32
    v_dot2_f32_bf16 v33, v212, s79, v33
    v_dot2_f32_bf16 v34, v213, s78, v34
    v_dot2_f32_bf16 v35, v213, s79, v35
    v_dot2_f32_bf16 v36, v214, s78, v36
    v_dot2_f32_bf16 v37, v214, s79, v37
    v_dot2_f32_bf16 v38, v215, s78, v38
    v_dot2_f32_bf16 v39, v215, s79, v39
    v_cvt_pk_bf16_f32 v32, v32, v33
    v_cvt_pk_bf16_f32 v33, v34, v35
    v_cvt_pk_bf16_f32 v34, v36, v37
    v_cvt_pk_bf16_f32 v35, v38, v39
    s_nop 0
    v_permlane16_swap_b32 v32, v34
    v_permlane16_swap_b32 v33, v35
    v_mov_b32 v36, v24
    v_mov_b32 v37, v25
    v_mov_b32 v38, v26
    v_mov_b32 v39, v27
    v_mov_b32_dpp v24, v32 row_ror:8 row_mask:0xf bank_mask:0xc
    v_mov_b32_dpp v25, v33 row_ror:8 row_mask:0xf bank_mask:0xc
    v_mov_b32_dpp v26, v34 row_ror:8 row_mask:0xf bank_mask:0xc
    v_mov_b32_dpp v27, v35 row_ror:8 row_mask:0xf bank_mask:0xc
    v_mov_b32_dpp v32, v36 row_ror:8 row_mask:0xf bank_mask:0x3
    v_mov_b32_dpp v33, v37 row_ror:8 row_mask:0xf bank_mask:0x3
    v_mov_b32_dpp v34, v38 row_ror:8 row_mask:0xf bank_mask:0x3
    v_mov_b32_dpp v35, v39 row_ror:8 row_mask:0xf bank_mask:0x3
    buffer_store_dwordx4 v[24:27], v224, s[20:23], s46 offen sc1
    buffer_store_dwordx4 v[32:35], v225, s[20:23], s46 offen sc1
    v_dot2_f32_bf16 v40, v216, s78, v40
    v_dot2_f32_bf16 v41, v216, s79, v41
    v_dot2_f32_bf16 v42, v217, s78, v42
    v_dot2_f32_bf16 v43, v217, s79, v43
    v_dot2_f32_bf16 v44, v218, s78, v44
    v_dot2_f32_bf16 v45, v218, s79, v45
    v_dot2_f32_bf16 v46, v219, s78, v46
    v_dot2_f32_bf16 v47, v219, s79, v47
    v_cvt_pk_bf16_f32 v40, v40, v41
    v_cvt_pk_bf16_f32 v41, v42, v43
    v_cvt_pk_bf16_f32 v42, v44, v45
    v_cvt_pk_bf16_f32 v43, v46, v47
    s_nop 0
    v_permlane16_swap_b32 v40, v42
    v_permlane16_swap_b32 v41, v43
    v_dot2_f32_bf16 v48, v220, s78, v48
    v_dot2_f32_bf16 v49, v220, s79, v49
    v_dot2_f32_bf16 v50, v221, s78, v50
    v_dot2_f32_bf16 v51, v221, s79, v51
    v_dot2_f32_bf16 v52, v222, s78, v52
    v_dot2_f32_bf16 v53, v222, s79, v53
    v_dot2_f32_bf16 v54, v223, s78, v54
    v_dot2_f32_bf16 v55, v223, s79, v55
    v_cvt_pk_bf16_f32 v48, v48, v49
    v_cvt_pk_bf16_f32 v49, v50, v51
    v_cvt_pk_bf16_f32 v50, v52, v53
    v_cvt_pk_bf16_f32 v51, v54, v55
    s_nop 0
    v_permlane16_swap_b32 v48, v50
    v_permlane16_swap_b32 v49, v51
    v_mov_b32 v52, v40
    v_mov_b32 v53, v41
    v_mov_b32 v54, v42
    v_mov_b32 v55, v43
    v_mov_b32_dpp v40, v48 row_ror:8 row_mask:0xf bank_mask:0xc
    v_mov_b32_dpp v41, v49 row_ror:8 row_mask:0xf bank_mask:0xc
    v_mov_b32_dpp v42, v50 row_ror:8 row_mask:0xf bank_mask:0xc
    v_mov_b32_dpp v43, v51 row_ror:8 row_mask:0xf bank_mask:0xc
    v_mov_b32_dpp v48, v52 row_ror:8 row_mask:0xf bank_mask:0x3
    v_mov_b32_dpp v49, v53 row_ror:8 row_mask:0xf bank_mask:0x3
    v_mov_b32_dpp v50, v54 row_ror:8 row_mask:0xf bank_mask:0x3
    v_mov_b32_dpp v51, v55 row_ror:8 row_mask:0xf bank_mask:0x3
    buffer_store_dwordx4 v[40:43], v224, s[20:23], s47 offen sc1
    buffer_store_dwordx4 v[48:51], v225, s[20:23], s47 offen sc1
    s_branch K_fin
LOADERS:
    s_cmp_lg_u32 s60, 0
    s_cbranch_scc1 pr_31
    s_and_b32 s36, s29, 6
    s_cmp_eq_u32 s36, 2
    s_cbranch_scc0 pr_31
    s_call_b64 s[76:77], SUB_park2
pr_31:
    s_cmp_ge_u32 s30, 6
    s_cbranch_scc1 WLOAD
    s_add_u32 s54, s55, 0x500
    v_mov_b32 v222, s54
    s_lshl_b32 s53, s29, 7
    s_add_u32 s53, s53, 23121920
    v_mov_b32 v226, s53
    s_sleep 30
    s_mov_b64 exec, 1
    buffer_load_dword v227, v226, s[56:59], 0 offen sc1
    s_mov_b64 exec, -1
    s_waitcnt vmcnt(0)
    v_readfirstlane_b32 s53, v227
    s_add_u32 s54, s52, 16
    s_cmp_eq_u32 s53, s54
    s_cbranch_scc1 fok_32
    s_mov_b32 s53, 0
    s_add_u32 s54, s52, 16
    s_bfm_b64 exec, 1, 0
poll_33:
    buffer_load_dword v227, v226, s[56:59], 0 offen sc1
    s_waitcnt vmcnt(0)
    v_xor_b32 v227, s54, v227
    v_cmp_eq_u32 vcc, 0, v227
    s_nop 0
    s_cmp_eq_u64 vcc, exec
    s_cbranch_scc1 pok_34
    s_sleep 5
    s_add_u32 s53, s53, 1
    s_cmp_lt_u32 s53, s61
    s_cbranch_scc1 poll_33
    s_mov_b32 s61, 0
pok_34:
    s_mov_b64 exec, -1
fok_32:
    s_add_u32 s24, s4, 0x1400000
    s_addc_u32 s25, s5, 0
    s_mov_b32 s26, 0x20000
    s_mov_b32 s27, 0x20000
    s_cmp_eq_u32 s60, 0
    s_cselect_b32 s26, s26, 0
    s_and_b32 s36, s30, 1
    s_mul_i32 s36, s36, 128
    s_mul_i32 s37, s29, 256
    s_add_u32 s37, s36, s37
    v_lshrrev_b32 v224, 3, v1
    v_mul_u32_u24 v224, 4096, v224
    v_and_b32 v23, 112, v2
    v_add_u32 v224, v224, v23
    s_cmp_eq_u32 s60, 0
    s_cselect_b64 exec, -1, 0
    buffer_load_dwordx4 v[24:27], v224, s[24:27], s37 offen sc1
    s_add_u32 s37, s37, 32768
    buffer_load_dwordx4 v[28:31], v224, s[24:27], s37 offen sc1
    s_add_u32 s37, s37, 32768
    buffer_load_dwordx4 v[32:35], v224, s[24:27], s37 offen sc1
    s_add_u32 s37, s37, 32768
    buffer_load_dwordx4 v[36:39], v224, s[24:27], s37 offen sc1
    s_add_u32 s37, s37, 32768
    s_mov_b64 exec, -1
    s_mov_b64 exec, 1
    buffer_load_dword v223, v222, s[56:59], 0 offen sc1
    s_mov_b64 exec, -1
    s_waitcnt vmcnt(0)
    v_readfirstlane_b32 s53, v223
    s_add_u32 s54, s52, 16
    s_cmp_eq_u32 s53, s54
    s_cbranch_scc1 fok_35
    s_mov_b32 s53, 0
    s_add_u32 s54, s52, 16
    s_bfm_b64 exec, 1, 0
poll_36:
    buffer_load_dword v223, v222, s[56:59], 0 offen sc1
    s_waitcnt vmcnt(0)
    v_xor_b32 v223, s54, v223
    v_cmp_eq_u32 vcc, 0, v223
    s_nop 0
    s_cmp_eq_u64 vcc, exec
    s_cbranch_scc1 pok_37
    s_sleep 5
    s_add_u32 s53, s53, 1
    s_cmp_lt_u32 s53, s61
    s_cbranch_scc1 poll_36
    s_mov_b32 s61, 0
pok_37:
    s_mov_b64 exec, -1
fok_35:
    s_add_u32 s20, s62, 0x5d0000
    s_addc_u32 s21, s63, 0
    s_mov_b32 s22, 0x800
    s_mov_b32 s23, 0x20000
    s_and_b32 s35, s30, 1
    s_lshl_b32 s35, s35, 10
    buffer_load_dwordx4 v[16:19], v2, s[20:23], s35 offen sc1
    s_cmp_lg_u32 s60, 0
    s_cbranch_scc1 pc_38
    v_add_f32 v24, v24, v28
    v_add_f32 v25, v25, v29
    v_add_f32 v26, v26, v30
    v_add_f32 v27, v27, v31
    v_add_f32 v24, v24, v32
    v_add_f32 v25, v25, v33
    v_add_f32 v26, v26, v34
    v_add_f32 v27, v27, v35
    v_add_f32 v24, v24, v36
    v_add_f32 v25, v25, v37
    v_add_f32 v26, v26, v38
    v_add_f32 v27, v27, v39
    v_add_f32_dpp v24, v24, v24 row_ror:8 row_mask:0xf bank_mask:0xf
    v_add_f32_dpp v25, v25, v25 row_ror:8 row_mask:0xf bank_mask:0xf
    v_add_f32_dpp v26, v26, v26 row_ror:8 row_mask:0xf bank_mask:0xf
    v_add_f32_dpp v27, v27, v27 row_ror:8 row_mask:0xf bank_mask:0xf
    v_mov_b32 v28, v24
    v_mov_b32 v29, v25
    v_mov_b32 v30, v26
    v_mov_b32 v31, v27
    v_permlane16_swap_b32 v24, v28
    v_permlane16_swap_b32 v25, v29
    v_permlane16_swap_b32 v26, v30
    v_permlane16_swap_b32 v27, v31
    v_add_f32 v24, v24, v28
    v_add_f32 v25, v25, v29
    v_add_f32 v26, v26, v30
    v_add_f32 v27, v27, v31
    v_mov_b32 v28, v24
    v_mov_b32 v29, v25
    v_mov_b32 v30, v26
    v_mov_b32 v31, v27
    v_permlane32_swap_b32 v24, v28
    v_permlane32_swap_b32 v25, v29
    v_permlane32_swap_b32 v26, v30
    v_permlane32_swap_b32 v27, v31
    v_add_f32 v24, v24, v28
    v_add_f32 v25, v25, v29
    v_add_f32 v26, v26, v30
    v_add_f32 v27, v27, v31
pc_38:
    s_cmp_lg_u32 s60, 0
    s_cbranch_scc1 pc_39
    s_and_b32 s36, s30, 1
    s_mul_i32 s36, s36, 128
    s_add_u32 s36, s36, 163328
    v_add_u32 v23, s36, v2
    s_bfm_b64 exec, 8, 0
    ds_write_b128 v23, v[24:27]
    s_mov_b64 exec, -1
    s_waitcnt lgkmcnt(0)
pc_39:
    s_waitcnt vmcnt(0)
    s_and_b32 s36, s30, 1
    s_lshl_b32 s36, s36, 10
    s_add_u32 s36, s36, 160768
    v_add_u32 v221, s36, v2
    ds_write_b128 v221, v[16:19]
    s_waitcnt lgkmcnt(0)
    s_cmp_lg_u32 s30, 4
    s_cbranch_scc1 AL_nw
    s_cmp_eq_u32 s60, 0
    s_cbranch_scc1 AL_nw
    s_add_u32 s54, s55, 0xffc00300
    s_add_u32 s53, s54, s92
    v_mov_b32 v9, s53
    s_add_u32 s53, s53, 128
    v_writelane_b32 v9, s53, 1
    s_add_u32 s53, s54, s93
    v_writelane_b32 v9, s53, 2
    s_add_u32 s53, s53, 128
    v_writelane_b32 v9, s53, 3
    s_mov_b32 s53, 0
    s_add_u32 s54, s52, 8
    s_bfm_b64 exec, 4, 0
poll_41:
    buffer_load_dword v8, v9, s[56:59], 0 offen sc1
    s_waitcnt vmcnt(0)
    v_xor_b32 v8, s54, v8
    v_cmp_eq_u32 vcc, 0, v8
    s_nop 0
    s_cmp_eq_u64 vcc, exec
    s_cbranch_scc1 pok_42
    s_sleep 5
    s_add_u32 s53, s53, 1
    s_cmp_lt_u32 s53, s61
    s_cbranch_scc1 poll_41
    s_mov_b32 s61, 0
pok_42:
    s_mov_b64 exec, -1
AL_nw:
    s_and_b32 s36, s30, 1
    s_lshl_b32 s36, s36, 12
    s_add_u32 s36, s36, 32768
    v_add_u32 v6, s36, v2
    ds_read_b128 v[16:19], v6 offset:0
    ds_read_b128 v[20:23], v6 offset:1024
    ds_read_b128 v[24:27], v6 offset:2048
    ds_read_b128 v[28:31], v6 offset:3072
    ds_read_b128 v[32:35], v6 offset:8192
    ds_read_b128 v[36:39], v6 offset:9216
    ds_read_b128 v[40:43], v6 offset:10240
    ds_read_b128 v[44:47], v6 offset:11264
    s_waitcnt lgkmcnt(0)
    s_call_b64 s[76:77], SUB_before_d1
    s_barrier
    s_call_b64 s[76:77], SUB_after_g1
    s_barrier
    s_waitcnt vmcnt(0)
    s_barrier
    s_call_b64 s[76:77], SUB_after_g2
    s_and_b32 s35, s30, 1
    s_add_u32 s12, s62, 0x80000
    s_addc_u32 s13, s63, 0
    s_mov_b32 s14, 0x7e000
    s_mov_b32 s15, 0x20000
    s_mul_i32 s38, s35, 262144
    s_lshl_b32 s41, s35, 13
    s_mov_b32 s42, 0
    s_mov_b32 s44, 0
    s_add_u32 s54, s55, 0x200
    v_mov_b32 v9, s54
    s_mov_b32 s44, 1
    s_mov_b32 s42, 16384
    s_add_u32 s54, s55, 0x580
    v_mov_b32 v222, s54
    v_lshlrev_b32 v221, 3, v1
    s_add_u32 s19, s41, s42
    v_readlane_b32 s16, v248, s44
    s_nop 0
    s_add_u32 s16, s16, s38
    s_add_u32 s44, s44, 1
    s_and_b32 s44, s44, 15
    s_add_u32 s42, s42, 16384
    s_cmp_eq_u32 s42, 49152
    s_cselect_b32 s42, 0, s42
    s_mov_b32 m0, s19
    s_mov_b32 s39, s16
    s_waitcnt vmcnt(63)
    s_barrier
    s_sleep 6
    s_mov_b32 s53, 0
    s_add_u32 s54, s52, 16
    s_bfm_b64 exec, 1, 0
poll_43:
    buffer_load_dword v8, v9, s[56:59], 0 offen sc1
    s_waitcnt vmcnt(0)
    v_xor_b32 v8, s54, v8
    v_cmp_eq_u32 vcc, 0, v8
    s_nop 0
    s_cmp_eq_u64 vcc, exec
    s_cbranch_scc1 pok_44
    s_sleep 5
    s_add_u32 s53, s53, 1
    s_cmp_lt_u32 s53, s61
    s_cbranch_scc1 poll_43
    s_mov_b32 s61, 0
pok_44:
    s_mov_b64 exec, -1
    buffer_load_dwordx4 v2, s[12:15], s39 offen sc1 lds
    buffer_load_dwordx4 v2, s[12:15], s39 offen offset:1024 sc1 lds
    s_add_u32 m0, m0, 2048
    s_add_u32 s39, s39, 65536
    buffer_load_dwordx4 v2, s[12:15], s39 offen sc1 lds
    buffer_load_dwordx4 v2, s[12:15], s39 offen offset:1024 sc1 lds
    s_add_u32 s19, s41, s42
    v_readlane_b32 s16, v248, s44
    s_nop 0
    s_add_u32 s16, s16, s38
    s_add_u32 s44, s44, 1
    s_and_b32 s44, s44, 15
    s_add_u32 s42, s42, 16384
    s_cmp_eq_u32 s42, 49152
    s_cselect_b32 s42, 0, s42
    s_add_u32 m0, m0, 2048
    s_add_u32 s39, s39, 65536
    buffer_load_dwordx4 v2, s[12:15], s39 offen sc1 lds
    buffer_load_dwordx4 v2, s[12:15], s39 offen offset:1024 sc1 lds
    s_add_u32 m0, m0, 2048
    s_add_u32 s39, s39, 65536
    buffer_load_dwordx4 v2, s[12:15], s39 offen sc1 lds
    buffer_load_dwordx4 v2, s[12:15], s39 offen offset:1024 sc1 lds
    s_mov_b32 m0, s19
    s_mov_b32 s39, s16
    buffer_load_dwordx4 v2, s[12:15], s39 offen sc1 lds
    buffer_load_dwordx4 v2, s[12:15], s39 offen offset:1024 sc1 lds
    s_add_u32 m0, m0, 2048
    s_add_u32 s39, s39, 65536
    buffer_load_dwordx4 v2, s[12:15], s39 offen sc1 lds
    buffer_load_dwordx4 v2, s[12:15], s39 offen offset:1024 sc1 lds
    s_add_u32 s19, s41, s42
    v_readlane_b32 s16, v248, s44
    s_nop 0
    s_add_u32 s16, s16, s38
    s_add_u32 s44, s44, 1
    s_and_b32 s44, s44, 15
    s_add_u32 s42, s42, 16384
    s_cmp_eq_u32 s42, 49152
    s_cselect_b32 s42, 0, s42
    s_add_u32 m0, m0, 2048
    s_add_u32 s39, s39, 65536
    buffer_load_dwordx4 v2, s[12:15], s39 offen sc1 lds
    buffer_load_dwordx4 v2, s[12:15], s39 offen offset:1024 sc1 lds
    s_add_u32 m0, m0, 2048
    s_add_u32 s39, s39, 65536
    buffer_load_dwordx4 v2, s[12:15], s39 offen sc1 lds
    buffer_load_dwordx4 v2, s[12:15], s39 offen offset:1024 sc1 lds
    s_mov_b32 m0, s19
    s_mov_b32 s39, s16
    s_waitcnt vmcnt(8)
    s_barrier
    buffer_load_dwordx4 v2, s[12:15], s39 offen sc1 lds
    buffer_load_dwordx4 v2, s[12:15], s39 offen offset:1024 sc1 lds
    s_add_u32 m0, m0, 2048
    s_add_u32 s39, s39, 65536
    buffer_load_dwordx4 v2, s[12:15], s39 offen sc1 lds
    buffer_load_dwordx4 v2, s[12:15], s39 offen offset:1024 sc1 lds
    s_add_u32 s19, s41, s42
    v_readlane_b32 s16, v248, s44
    s_nop 0
    s_add_u32 s16, s16, s38
    s_add_u32 s44, s44, 1
    s_and_b32 s44, s44, 15
    s_add_u32 s42, s42, 16384
    s_cmp_eq_u32 s42, 49152
    s_cselect_b32 s42, 0, s42
    s_add_u32 m0, m0, 2048
    s_add_u32 s39, s39, 65536
    buffer_load_dwordx4 v2, s[12:15], s39 offen sc1 lds
    buffer_load_dwordx4 v2, s[12:15], s39 offen offset:1024 sc1 lds
    s_add_u32 m0, m0, 2048
    s_add_u32 s39, s39, 65536
    buffer_load_dwordx4 v2, s[12:15], s39 offen sc1 lds
    buffer_load_dwordx4 v2, s[12:15], s39 offen offset:1024 sc1 lds
    s_mov_b32 m0, s19
    s_mov_b32 s39, s16
    s_add_u32 s24, s4, 0x1420000
    s_addc_u32 s25, s5, 0
    s_mov_b32 s26, 0x70000
    s_mov_b32 s27, 0x20000
    s_cmp_eq_u32 s60, 0
    s_cselect_b32 s26, s26, 0
    s_and_b32 s36, s30, 1
    s_mul_i32 s36, s36, 448
    s_mul_i32 s37, s29, 896
    s_add_u32 s37, s36, s37
    v_lshrrev_b32 v224, 5, v1
    v_mul_u32_u24 v224, 14336, v224
    v_and_b32 v179, 496, v2
    v_add_u32 v224, v224, v179
    s_cmp_eq_u32 s60, 0
    s_cselect_b64 exec, -1, 0
    buffer_load_dwordx4 v[180:183], v224, s[24:27], s37 offen sc1
    s_add_u32 s37, s37, 28672
    buffer_load_dwordx4 v[184:187], v224, s[24:27], s37 offen sc1
    s_add_u32 s37, s37, 28672
    buffer_load_dwordx4 v[188:191], v224, s[24:27], s37 offen sc1
    s_add_u32 s37, s37, 28672
    buffer_load_dwordx4 v[192:195], v224, s[24:27], s37 offen sc1
    s_add_u32 s37, s37, 28672
    buffer_load_dwordx4 v[196:199], v224, s[24:27], s37 offen sc1
    s_add_u32 s37, s37, 28672
    s_mov_b64 exec, -1
    s_waitcnt vmcnt(13)
    s_barrier
    buffer_load_dwordx4 v2, s[12:15], s39 offen sc1 lds
    buffer_load_dwordx4 v2, s[12:15], s39 offen offset:1024 sc1 lds
    s_add_u32 m0, m0, 2048
    s_add_u32 s39, s39, 65536
    buffer_load_dwordx4 v2, s[12:15], s39 offen sc1 lds
    buffer_load_dwordx4 v2, s[12:15], s39 offen offset:1024 sc1 lds
    s_add_u32 s19, s41, s42
    v_readlane_b32 s16, v248, s44
    s_nop 0
    s_add_u32 s16, s16, s38
    s_add_u32 s44, s44, 1
    s_and_b32 s44, s44, 15
    s_add_u32 s42, s42, 16384
    s_cmp_eq_u32 s42, 49152
    s_cselect_b32 s42, 0, s42
    s_add_u32 m0, m0, 2048
    s_add_u32 s39, s39, 65536
    buffer_load_dwordx4 v2, s[12:15], s39 offen sc1 lds
    buffer_load_dwordx4 v2, s[12:15], s39 offen offset:1024 sc1 lds
    s_add_u32 m0, m0, 2048
    s_add_u32 s39, s39, 65536
    buffer_load_dwordx4 v2, s[12:15], s39 offen sc1 lds
    buffer_load_dwordx4 v2, s[12:15], s39 offen offset:1024 sc1 lds
    s_mov_b32 m0, s19
    s_mov_b32 s39, s16
    s_cmp_eq_u32 s60, 0
    s_cselect_b64 exec, -1, 0
    buffer_load_dwordx4 v[200:203], v224, s[24:27], s37 offen sc1
    s_add_u32 s37, s37, 28672
    buffer_load_dwordx4 v[204:207], v224, s[24:27], s37 offen sc1
    s_add_u32 s37, s37, 28672
    buffer_load_dwordx4 v[208:211], v224, s[24:27], s37 offen sc1
    s_add_u32 s37, s37, 28672
    buffer_load_dwordx4 v[212:215], v224, s[24:27], s37 offen sc1
    s_add_u32 s37, s37, 28672
    s_mov_b64 exec, -1
    s_waitcnt vmcnt(17)
    s_barrier
    buffer_load_dwordx4 v2, s[12:15], s39 offen sc1 lds
    buffer_load_dwordx4 v2, s[12:15], s39 offen offset:1024 sc1 lds
    s_add_u32 m0, m0, 2048
    s_add_u32 s39, s39, 65536
    buffer_load_dwordx4 v2, s[12:15], s39 offen sc1 lds
    buffer_load_dwordx4 v2, s[12:15], s39 offen offset:1024 sc1 lds
    s_add_u32 s19, s41, s42
    v_readlane_b32 s16, v248, s44
    s_nop 0
    s_add_u32 s16, s16, s38
    s_add_u32 s44, s44, 1
    s_and_b32 s44, s44, 15
    s_add_u32 s42, s42, 16384
    s_cmp_eq_u32 s42, 49152
    s_cselect_b32 s42, 0, s42
    s_add_u32 m0, m0, 2048
    s_add_u32 s39, s39, 65536
    buffer_load_dwordx4 v2, s[12:15], s39 offen sc1 lds
    buffer_load_dwordx4 v2, s[12:15], s39 offen offset:1024 sc1 lds
    s_add_u32 m0, m0, 2048
    s_add_u32 s39, s39, 65536
    buffer_load_dwordx4 v2, s[12:15], s39 offen sc1 lds
    buffer_load_dwordx4 v2, s[12:15], s39 offen offset:1024 sc1 lds
    s_mov_b32 m0, s19
    s_mov_b32 s39, s16
    s_waitcnt vmcnt(12)
    s_barrier
    buffer_load_dwordx4 v2, s[12:15], s39 offen sc1 lds
    buffer_load_dwordx4 v2, s[12:15], s39 offen offset:1024 sc1 lds
    s_add_u32 m0, m0, 2048
    s_add_u32 s39, s39, 65536
    buffer_load_dwordx4 v2, s[12:15], s39 offen sc1 lds
    buffer_load_dwordx4 v2, s[12:15], s39 offen offset:1024 sc1 lds
    s_add_u32 s19, s41, s42
    v_readlane_b32 s16, v248, s44
    s_nop 0
    s_add_u32 s16, s16, s38
    s_add_u32 s44, s44, 1
    s_and_b32 s44, s44, 15
    s_add_u32 s42, s42, 16384
    s_cmp_eq_u32 s42, 49152
    s_cselect_b32 s42, 0, s42
    s_add_u32 m0, m0, 2048
    s_add_u32 s39, s39, 65536
    buffer_load_dwordx4 v2, s[12:15], s39 offen sc1 lds
    buffer_load_dwordx4 v2, s[12:15], s39 offen offset:1024 sc1 lds
    s_add_u32 m0, m0, 2048
    s_add_u32 s39, s39, 65536
    buffer_load_dwordx4 v2, s[12:15], s39 offen sc1 lds
    buffer_load_dwordx4 v2, s[12:15], s39 offen offset:1024 sc1 lds
    s_mov_b32 m0, s19
    s_mov_b32 s39, s16
    s_waitcnt vmcnt(16)
    s_cmp_lg_u32 s60, 0
    s_cbranch_scc1 pc_45
    v_add_f32 v180, v180, v184
    v_add_f32 v181, v181, v185
    v_add_f32 v182, v182, v186
    v_add_f32 v183, v183, v187
    v_add_f32 v180, v180, v188
    v_add_f32 v181, v181, v189
    v_add_f32 v182, v182, v190
    v_add_f32 v183, v183, v191
    v_add_f32 v180, v180, v192
    v_add_f32 v181, v181, v193
    v_add_f32 v182, v182, v194
    v_add_f32 v183, v183, v195
    v_add_f32 v180, v180, v196
    v_add_f32 v181, v181, v197
    v_add_f32 v182, v182, v198
    v_add_f32 v183, v183, v199
    v_add_f32 v180, v180, v200
    v_add_f32 v181, v181, v201
    v_add_f32 v182, v182, v202
    v_add_f32 v183, v183, v203
    v_add_f32 v180, v180, v204
    v_add_f32 v181, v181, v205
    v_add_f32 v182, v182, v206
    v_add_f32 v183, v183, v207
    v_add_f32 v180, v180, v208
    v_add_f32 v181, v181, v209
    v_add_f32 v182, v182, v210
    v_add_f32 v183, v183, v211
    v_add_f32 v180, v180, v212
    v_add_f32 v181, v181, v213
    v_add_f32 v182, v182, v214
    v_add_f32 v183, v183, v215
pc_45:
    s_cmp_eq_u32 s60, 0
    s_cselect_b64 exec, -1, 0
    buffer_load_dwordx4 v[184:187], v224, s[24:27], s37 offen sc1
    s_add_u32 s37, s37, 28672
    buffer_load_dwordx4 v[188:191], v224, s[24:27], s37 offen sc1
    s_add_u32 s37, s37, 28672
    buffer_load_dwordx4 v[192:195], v224, s[24:27], s37 offen sc1
    s_add_u32 s37, s37, 28672
    buffer_load_dwordx4 v[196:199], v224, s[24:27], s37 offen sc1
    s_add_u32 s37, s37, 28672
    buffer_load_dwordx4 v[200:203], v224, s[24:27], s37 offen sc1
    s_add_u32 s37, s37, 28672
    buffer_load_dwordx4 v[204:207], v224, s[24:27], s37 offen sc1
    s_add_u32 s37, s37, 28672
    buffer_load_dwordx4 v[208:211], v224, s[24:27], s37 offen sc1
    s_add_u32 s37, s37, 28672
    s_mov_b64 exec, -1
    s_waitcnt vmcnt(15)
    s_barrier
    buffer_load_dwordx4 v2, s[12:15], s39 offen sc1 lds
    buffer_load_dwordx4 v2, s[12:15], s39 offen offset:1024 sc1 lds
    s_add_u32 m0, m0, 2048
    s_add_u32 s39, s39, 65536
    buffer_load_dwordx4 v2, s[12:15], s39 offen sc1 lds
    buffer_load_dwordx4 v2, s[12:15], s39 offen offset:1024 sc1 lds
    s_add_u32 s19, s41, s42
    v_readlane_b32 s16, v248, s44
    s_nop 0
    s_add_u32 s16, s16, s38
    s_add_u32 s44, s44, 1
    s_and_b32 s44, s44, 15
    s_add_u32 s42, s42, 16384
    s_cmp_eq_u32 s42, 49152
    s_cselect_b32 s42, 0, s42
    s_add_u32 m0, m0, 2048
    s_add_u32 s39, s39, 65536
    buffer_load_dwordx4 v2, s[12:15], s39 offen sc1 lds
    buffer_load_dwordx4 v2, s[12:15], s39 offen offset:1024 sc1 lds
    s_add_u32 m0, m0, 2048
    s_add_u32 s39, s39, 65536
    buffer_load_dwordx4 v2, s[12:15], s39 offen sc1 lds
    buffer_load_dwordx4 v2, s[12:15], s39 offen offset:1024 sc1 lds
    s_mov_b32 m0, s19
    s_mov_b32 s39, s16
    s_mov_b64 exec, 1
    buffer_load_dword v223, v222, s[56:59], 0 offen sc1
    s_mov_b64 exec, -1
    s_waitcnt vmcnt(16)
    s_barrier
    buffer_load_dwordx4 v2, s[12:15], s39 offen sc1 lds
    buffer_load_dwordx4 v2, s[12:15], s39 offen offset:1024 sc1 lds
    s_add_u32 m0, m0, 2048
    s_add_u32 s39, s39, 65536
    buffer_load_dwordx4 v2, s[12:15], s39 offen sc1 lds
    buffer_load_dwordx4 v2, s[12:15], s39 offen offset:1024 sc1 lds
    s_add_u32 s19, s41, s42
    v_readlane_b32 s16, v248, s44
    s_nop 0
    s_add_u32 s16, s16, s38
    s_add_u32 s44, s44, 1
    s_and_b32 s44, s44, 15
    s_add_u32 s42, s42, 16384
    s_cmp_eq_u32 s42, 49152
    s_cselect_b32 s42, 0, s42
    s_add_u32 m0, m0, 2048
    s_add_u32 s39, s39, 65536
    buffer_load_dwordx4 v2, s[12:15], s39 offen sc1 lds
    buffer_load_dwordx4 v2, s[12:15], s39 offen offset:1024 sc1 lds
    s_add_u32 m0, m0, 2048
    s_add_u32 s39, s39, 65536
    buffer_load_dwordx4 v2, s[12:15], s39 offen sc1 lds
    buffer_load_dwordx4 v2, s[12:15], s39 offen offset:1024 sc1 lds
    s_mov_b32 m0, s19
    s_mov_b32 s39, s16
    s_waitcnt vmcnt(17)
    s_cmp_lg_u32 s60, 0
    s_cbranch_scc1 pc_46
    v_add_f32 v180, v180, v184
    v_add_f32 v181, v181, v185
    v_add_f32 v182, v182, v186
    v_add_f32 v183, v183, v187
    v_add_f32 v180, v180, v188
    v_add_f32 v181, v181, v189
    v_add_f32 v182, v182, v190
    v_add_f32 v183, v183, v191
    v_add_f32 v180, v180, v192
    v_add_f32 v181, v181, v193
    v_add_f32 v182, v182, v194
    v_add_f32 v183, v183, v195
    v_add_f32 v180, v180, v196
    v_add_f32 v181, v181, v197
    v_add_f32 v182, v182, v198
    v_add_f32 v183, v183, v199
    v_add_f32 v180, v180, v200
    v_add_f32 v181, v181, v201
    v_add_f32 v182, v182, v202
    v_add_f32 v183, v183, v203
    v_add_f32 v180, v180, v204
    v_add_f32 v181, v181, v205
    v_add_f32 v182, v182, v206
    v_add_f32 v183, v183, v207
    v_add_f32 v180, v180, v208
    v_add_f32 v181, v181, v209
    v_add_f32 v182, v182, v210
    v_add_f32 v183, v183, v211
pc_46:
    s_waitcnt vmcnt(9)
    s_barrier
    buffer_load_dwordx4 v2, s[12:15], s39 offen sc1 lds
    buffer_load_dwordx4 v2, s[12:15], s39 offen offset:1024 sc1 lds
    s_add_u32 m0, m0, 2048
    s_add_u32 s39, s39, 65536
    buffer_load_dwordx4 v2, s[12:15], s39 offen sc1 lds
    buffer_load_dwordx4 v2, s[12:15], s39 offen offset:1024 sc1 lds
    s_add_u32 s19, s41, s42
    v_readlane_b32 s16, v248, s44
    s_nop 0
    s_add_u32 s16, s16, s38
    s_add_u32 s44, s44, 1
    s_and_b32 s44, s44, 15
    s_add_u32 s42, s42, 16384
    s_cmp_eq_u32 s42, 49152
    s_cselect_b32 s42, 0, s42
    s_add_u32 m0, m0, 2048
    s_add_u32 s39, s39, 65536
    buffer_load_dwordx4 v2, s[12:15], s39 offen sc1 lds
    buffer_load_dwordx4 v2, s[12:15], s39 offen offset:1024 sc1 lds
    s_add_u32 m0, m0, 2048
    s_add_u32 s39, s39, 65536
    buffer_load_dwordx4 v2, s[12:15], s39 offen sc1 lds
    buffer_load_dwordx4 v2, s[12:15], s39 offen offset:1024 sc1 lds
    s_mov_b32 m0, s19
    s_mov_b32 s39, s16
    s_cmp_lg_u32 s60, 0
    s_cbranch_scc1 pc_47
    v_mov_b32 v184, v180
    v_mov_b32 v185, v181
    v_mov_b32 v186, v182
    v_mov_b32 v187, v183
    v_permlane32_swap_b32 v180, v184
    v_permlane32_swap_b32 v181, v185
    v_permlane32_swap_b32 v182, v186
    v_permlane32_swap_b32 v183, v187
    v_add_f32 v180, v180, v184
    v_add_f32 v181, v181, v185
    v_add_f32 v182, v182, v186
    v_add_f32 v183, v183, v187
    s_and_b32 s36, s30, 1
    s_mul_i32 s36, s36, 448
    s_add_u32 s36, s36, 159744
    v_add_u32 v179, s36, v2
    s_bfm_b64 exec, 28, 0
    ds_write_b128 v179, v[180:183]
    s_mov_b64 exec, -1
    s_waitcnt lgkmcnt(0)
pc_47:
    s_waitcnt vmcnt(16)
    v_readfirstlane_b32 s53, v223
    s_add_u32 s54, s52, 16
    s_cmp_eq_u32 s53, s54
    s_cbranch_scc1 fok_48
    s_mov_b32 s53, 0
    s_add_u32 s54, s52, 16
    s_bfm_b64 exec, 1, 0
poll_49:
    buffer_load_dword v223, v222, s[56:59], 0 offen sc1
    s_waitcnt vmcnt(0)
    v_xor_b32 v223, s54, v223
    v_cmp_eq_u32 vcc, 0, v223
    s_nop 0
    s_cmp_eq_u64 vcc, exec
    s_cbranch_scc1 pok_50
    s_sleep 5
    s_add_u32 s53, s53, 1
    s_cmp_lt_u32 s53, s61
    s_cbranch_scc1 poll_49
    s_mov_b32 s61, 0
pok_50:
    s_mov_b64 exec, -1
fok_48:
    s_add_u32 s20, s62, 0x5c8000
    s_addc_u32 s21, s63, 0
    s_mov_b32 s22, 0x6000
    s_mov_b32 s23, 0x20000
    s_and_b32 s35, s30, 1
    s_lshl_b32 s35, s35, 9
    s_add_u32 s36, s35, 0
    buffer_load_dwordx2 v[184:185], v221, s[20:23], s36 offen offset:0 sc1
    buffer_load_dwordx2 v[186:187], v221, s[20:23], s36 offen offset:1024 sc1
    buffer_load_dwordx2 v[188:189], v221, s[20:23], s36 offen offset:2048 sc1
    buffer_load_dwordx2 v[190:191], v221, s[20:23], s36 offen offset:3072 sc1
    s_waitcnt vmcnt(12)
    s_barrier
    buffer_load_dwordx4 v2, s[12:15], s39 offen sc1 lds
    buffer_load_dwordx4 v2, s[12:15], s39 offen offset:1024 sc1 lds
    s_add_u32 m0, m0, 2048
    s_add_u32 s39, s39, 65536
    buffer_load_dwordx4 v2, s[12:15], s39 offen sc1 lds
    buffer_load_dwordx4 v2, s[12:15], s39 offen offset:1024 sc1 lds
    s_add_u32 s19, s41, s42
    v_readlane_b32 s16, v248, s44
    s_nop 0
    s_add_u32 s16, s16, s38
    s_add_u32 s44, s44, 1
    s_and_b32 s44, s44, 15
    s_add_u32 s42, s42, 16384
    s_cmp_eq_u32 s42, 49152
    s_cselect_b32 s42, 0, s42
    s_add_u32 m0, m0, 2048
    s_add_u32 s39, s39, 65536
    buffer_load_dwordx4 v2, s[12:15], s39 offen sc1 lds
    buffer_load_dwordx4 v2, s[12:15], s39 offen offset:1024 sc1 lds
    s_add_u32 m0, m0, 2048
    s_add_u32 s39, s39, 65536
    buffer_load_dwordx4 v2, s[12:15], s39 offen sc1 lds
    buffer_load_dwordx4 v2, s[12:15], s39 offen offset:1024 sc1 lds
    s_mov_b32 m0, s19
    s_mov_b32 s39, s16
    s_add_u32 s36, s35, 4096
    buffer_load_dwordx2 v[192:193], v221, s[20:23], s36 offen offset:0 sc1
    buffer_load_dwordx2 v[194:195], v221, s[20:23], s36 offen offset:1024 sc1
    buffer_load_dwordx2 v[196:197], v221, s[20:23], s36 offen offset:2048 sc1
    buffer_load_dwordx2 v[198:199], v221, s[20:23], s36 offen offset:3072 sc1
    s_add_u32 s36, s35, 16384
    buffer_load_dwordx2 v[200:201], v221, s[20:23], s36 offen offset:0 sc1
    buffer_load_dwordx2 v[202:203], v221, s[20:23], s36 offen offset:1024 sc1
    s_waitcnt vmcnt(18)
    s_barrier
    buffer_load_dwordx4 v2, s[12:15], s39 offen sc1 lds
    buffer_load_dwordx4 v2, s[12:15], s39 offen offset:1024 sc1 lds
    s_add_u32 m0, m0, 2048
    s_add_u32 s39, s39, 65536
    buffer_load_dwordx4 v2, s[12:15], s39 offen sc1 lds
    buffer_load_dwordx4 v2, s[12:15], s39 offen offset:1024 sc1 lds
    s_add_u32 s19, s41, s42
    v_readlane_b32 s16, v248, s44
    s_nop 0
    s_add_u32 s16, s16, s38
    s_add_u32 s44, s44, 1
    s_and_b32 s44, s44, 15
    s_add_u32 s42, s42, 16384
    s_cmp_eq_u32 s42, 49152
    s_cselect_b32 s42, 0, s42
    s_add_u32 m0, m0, 2048
    s_add_u32 s39, s39, 65536
    buffer_load_dwordx4 v2, s[12:15], s39 offen sc1 lds
    buffer_load_dwordx4 v2, s[12:15], s39 offen offset:1024 sc1 lds
    s_add_u32 m0, m0, 2048
    s_add_u32 s39, s39, 65536
    buffer_load_dwordx4 v2, s[12:15], s39 offen sc1 lds
    buffer_load_dwordx4 v2, s[12:15], s39 offen offset:1024 sc1 lds
    s_mov_b32 m0, s19
    s_mov_b32 s39, s16
    s_add_u32 s36, s35, 16384
    buffer_load_dwordx2 v[204:205], v221, s[20:23], s36 offen offset:2048 sc1
    buffer_load_dwordx2 v[206:207], v221, s[20:23], s36 offen offset:3072 sc1
    s_add_u32 s36, s35, 20480
    buffer_load_dwordx2 v[208:209], v221, s[20:23], s36 offen offset:0 sc1
    buffer_load_dwordx2 v[210:211], v221, s[20:23], s36 offen offset:1024 sc1
    buffer_load_dwordx2 v[212:213], v221, s[20:23], s36 offen offset:2048 sc1
    buffer_load_dwordx2 v[214:215], v221, s[20:23], s36 offen offset:3072 sc1
    s_waitcnt vmcnt(20)
    s_barrier
    buffer_load_dwordx4 v2, s[12:15], s39 offen sc1 lds
    buffer_load_dwordx4 v2, s[12:15], s39 offen offset:1024 sc1 lds
    s_add_u32 m0, m0, 2048
    s_add_u32 s39, s39, 65536
    buffer_load_dwordx4 v2, s[12:15], s39 offen sc1 lds
    buffer_load_dwordx4 v2, s[12:15], s39 offen offset:1024 sc1 lds
    s_add_u32 s19, s41, s42
    v_readlane_b32 s16, v248, s44
    s_nop 0
    s_add_u32 s16, s16, s38
    s_add_u32 s44, s44, 1
    s_and_b32 s44, s44, 15
    s_add_u32 s42, s42, 16384
    s_cmp_eq_u32 s42, 49152
    s_cselect_b32 s42, 0, s42
    s_add_u32 m0, m0, 2048
    s_add_u32 s39, s39, 65536
    buffer_load_dwordx4 v2, s[12:15], s39 offen sc1 lds
    buffer_load_dwordx4 v2, s[12:15], s39 offen offset:1024 sc1 lds
    s_add_u32 m0, m0, 2048
    s_add_u32 s39, s39, 65536
    buffer_load_dwordx4 v2, s[12:15], s39 offen sc1 lds
    buffer_load_dwordx4 v2, s[12:15], s39 offen offset:1024 sc1 lds
    s_mov_b32 m0, s19
    s_mov_b32 s39, s16
    s_waitcnt vmcnt(14)
    s_barrier
    buffer_load_dwordx4 v2, s[12:15], s39 offen sc1 lds
    buffer_load_dwordx4 v2, s[12:15], s39 offen offset:1024 sc1 lds
    s_add_u32 m0, m0, 2048
    s_add_u32 s39, s39, 65536
    buffer_load_dwordx4 v2, s[12:15], s39 offen sc1 lds
    buffer_load_dwordx4 v2, s[12:15], s39 offen offset:1024 sc1 lds
    s_add_u32 s19, s41, s42
    v_readlane_b32 s16, v248, s44
    s_nop 0
    s_add_u32 s16, s16, s38
    s_add_u32 s44, s44, 1
    s_and_b32 s44, s44, 15
    s_add_u32 s42, s42, 16384
    s_cmp_eq_u32 s42, 49152
    s_cselect_b32 s42, 0, s42
    s_add_u32 m0, m0, 2048
    s_add_u32 s39, s39, 65536
    buffer_load_dwordx4 v2, s[12:15], s39 offen sc1 lds
    buffer_load_dwordx4 v2, s[12:15], s39 offen offset:1024 sc1 lds
    s_add_u32 m0, m0, 2048
    s_add_u32 s39, s39, 65536
    buffer_load_dwordx4 v2, s[12:15], s39 offen sc1 lds
    buffer_load_dwordx4 v2, s[12:15], s39 offen offset:1024 sc1 lds
    s_mov_b32 m0, s19
    s_mov_b32 s39, s16
    s_waitcnt vmcnt(16)
    v_add_f32 v184, v184, v200
    v_add_f32 v185, v185, v201
    v_add_f32 v186, v186, v202
    v_add_f32 v187, v187, v203
    v_add_f32 v188, v188, v204
    v_add_f32 v189, v189, v205
    v_add_f32 v190, v190, v206
    v_add_f32 v191, v191, v207
    v_add_f32 v192, v192, v208
    v_add_f32 v193, v193, v209
    v_add_f32 v194, v194, v210
    v_add_f32 v195, v195, v211
    v_add_f32 v196, v196, v212
    v_add_f32 v197, v197, v213
    v_add_f32 v198, v198, v214
    v_add_f32 v199, v199, v215
    s_waitcnt vmcnt(8)
    s_barrier
    buffer_load_dwordx4 v2, s[12:15], s39 offen sc1 lds
    buffer_load_dwordx4 v2, s[12:15], s39 offen offset:1024 sc1 lds
    s_add_u32 m0, m0, 2048
    s_add_u32 s39, s39, 65536
    buffer_load_dwordx4 v2, s[12:15], s39 offen sc1 lds
    buffer_load_dwordx4 v2, s[12:15], s39 offen offset:1024 sc1 lds
    s_add_u32 s19, s41, s42
    v_readlane_b32 s16, v248, s44
    s_nop 0
    s_add_u32 s16, s16, s38
    s_add_u32 s44, s44, 1
    s_and_b32 s44, s44, 15
    s_add_u32 s42, s42, 16384
    s_cmp_eq_u32 s42, 49152
    s_cselect_b32 s42, 0, s42
    s_add_u32 m0, m0, 2048
    s_add_u32 s39, s39, 65536
    buffer_load_dwordx4 v2, s[12:15], s39 offen sc1 lds
    buffer_load_dwordx4 v2, s[12:15], s39 offen offset:1024 sc1 lds
    s_add_u32 m0, m0, 2048
    s_add_u32 s39, s39, 65536
    buffer_load_dwordx4 v2, s[12:15], s39 offen sc1 lds
    buffer_load_dwordx4 v2, s[12:15], s39 offen offset:1024 sc1 lds
    s_mov_b32 m0, s19
    s_mov_b32 s39, s16
    v_add_f32 v184, v184, v192
    v_add_f32 v185, v185, v193
    v_add_f32 v186, v186, v194
    v_add_f32 v187, v187, v195
    v_add_f32 v188, v188, v196
    v_add_f32 v189, v189, v197
    v_add_f32 v190, v190, v198
    v_add_f32 v191, v191, v199
    v_add_f32 v184, v184, v188
    v_add_f32 v185, v185, v189
    v_add_f32 v186, v186, v190
    v_add_f32 v187, v187, v191
    v_add_f32 v184, v184, v186
    v_add_f32 v185, v185, v187
    v_mul_f32 v188, 0x3a800000, v184
    v_mul_f32 v217, 0x3a800000, v185
    s_waitcnt vmcnt(8)
    s_barrier
    buffer_load_dwordx4 v2, s[12:15], s39 offen sc1 lds
    buffer_load_dwordx4 v2, s[12:15], s39 offen offset:1024 sc1 lds
    s_add_u32 m0, m0, 2048
    s_add_u32 s39, s39, 65536
    buffer_load_dwordx4 v2, s[12:15], s39 offen sc1 lds
    buffer_load_dwordx4 v2, s[12:15], s39 offen offset:1024 sc1 lds
    s_add_u32 m0, m0, 2048
    s_add_u32 s39, s39, 65536
    buffer_load_dwordx4 v2, s[12:15], s39 offen sc1 lds
    buffer_load_dwordx4 v2, s[12:15], s39 offen offset:1024 sc1 lds
    s_add_u32 m0, m0, 2048
    s_add_u32 s39, s39, 65536
    buffer_load_dwordx4 v2, s[12:15], s39 offen sc1 lds
    buffer_load_dwordx4 v2, s[12:15], s39 offen offset:1024 sc1 lds
    v_fma_f32 v217, -v188, v188, v217
    v_max_f32 v217, 0, v217
    v_add_f32 v217, 0x3727c5ac, v217
    v_sqrt_f32 v217, v217
    s_nop 0
    v_mov_b32 v189, v217
    v_rcp_f32 v219, v217
    s_nop 0
    v_mul_f32 v190, 0xc0135761, v219
    v_mul_f32 v191, v219, v219
    v_mul_f32 v191, v191, v190
    v_mul_f32 v191, 0x3d372713, v191
    s_lshl_b32 s35, s35, 1
    s_add_u32 s35, s35, 160768
    v_add_u32 v220, s35, v2
    ds_write_b128 v220, v[188:191]
    s_waitcnt lgkmcnt(0)
    s_waitcnt vmcnt(8)
    s_barrier
    s_mov_b64 s[48:49], s[74:75]
    s_mov_b32 s50, 7340032
    s_mov_b32 s51, 0x20000
    s_lshl_b32 s45, s2, 1
    s_and_b32 s46, s30, 1
    s_add_u32 s45, s45, s46
    s_mul_i32 s45, s45, 14336
    s_cmp_eq_u32 s60, 0
    s_cselect_b64 exec, -1, 0
    s_add_u32 s46, s45, 0
    buffer_load_dwordx4 v[176:179], v2, s[48:51], s46 offen
    s_add_u32 s46, s45, 1024
    buffer_load_dwordx4 v[176:179], v2, s[48:51], s46 offen
    s_add_u32 s46, s45, 2048
    buffer_load_dwordx4 v[176:179], v2, s[48:51], s46 offen
    s_add_u32 s46, s45, 3072
    buffer_load_dwordx4 v[176:179], v2, s[48:51], s46 offen
    s_add_u32 s46, s45, 4096
    buffer_load_dwordx4 v[176:179], v2, s[48:51], s46 offen
    s_add_u32 s46, s45, 5120
    buffer_load_dwordx4 v[176:179], v2, s[48:51], s46 offen
    s_add_u32 s46, s45, 6144
    buffer_load_dwordx4 v[176:179], v2, s[48:51], s46 offen
    s_add_u32 s46, s45, 7168
    buffer_load_dwordx4 v[176:179], v2, s[48:51], s46 offen
    s_add_u32 s46, s45, 8192
    buffer_load_dwordx4 v[176:179], v2, s[48:51], s46 offen
    s_add_u32 s46, s45, 9216
    buffer_load_dwordx4 v[176:179], v2, s[48:51], s46 offen
    s_add_u32 s46, s45, 10240
    buffer_load_dwordx4 v[176:179], v2, s[48:51], s46 offen
    s_add_u32 s46, s45, 11264
    buffer_load_dwordx4 v[176:179], v2, s[48:51], s46 offen
    s_add_u32 s46, s45, 12288
    buffer_load_dwordx4 v[176:179], v2, s[48:51], s46 offen
    s_add_u32 s46, s45, 13312
    buffer_load_dwordx4 v[176:179], v2, s[48:51], s46 offen
    s_mov_b64 exec, -1
    s_waitcnt vmcnt(14)
    s_barrier
    s_barrier
    s_cmp_lg_u32 s60, 0
    s_cbranch_scc1 rp_54
    s_call_b64 s[76:77], SUB_r_pre
rp_54:
    s_and_b32 s35, s30, 1
    s_add_u32 s12, s62, 0x400000
    s_addc_u32 s13, s63, 0
    s_mov_b32 s14, 0x1be000
    s_mov_b32 s15, 0x20000
    s_mul_i32 s38, s35, 917504
    s_mul_i32 s36, s31, 114688
    s_add_u32 s38, s38, s36
    s_lshl_b32 s41, s35, 13
    s_mov_b32 s42, 0
    s_mov_b32 s44, 0
    s_add_u32 s54, s55, 0x700
    s_lshl_b32 s53, s31, 7
    s_add_u32 s54, s54, s53
    v_mov_b32 v9, s54
    s_add_u32 s54, s55, 0x600
    s_lshl_b32 s53, s31, 7
    s_add_u32 s54, s54, s53
    v_mov_b32 v10, s54
    s_add_u32 s54, s55, 0x300
    s_lshl_b32 s53, s31, 7
    s_add_u32 s54, s54, s53
    v_mov_b32 v12, s54
    v_mov_b32 v13, 1
    s_and_b32 s51, s30, 1
    s_lshl_b32 s51, s51, 30
    s_lshl_b32 s54, s60, 2
    s_add_u32 s54, s54, 4
    v_mov_b32 v14, 162880
spin_55:
    s_sleep 2
    ds_read_b32 v15, v14
    s_waitcnt lgkmcnt(0)
    v_readfirstlane_b32 s53, v15
    s_nop 0
    s_cmp_ge_u32 s53, s54
    s_cbranch_scc0 spin_55
    s_mov_b64 exec, 1
    buffer_atomic_add v13, v9, s[56:59], s51 offen sc1
    s_mov_b64 exec, -1
    v_xor_b32 v15, 128, v12
    s_mov_b32 s44, 3
    s_call_b64 s[76:77], PREP_a_issue_4
    s_mov_b32 m0, s19
    s_mov_b32 s39, s16
    s_mov_b32 s40, s17
    s_waitcnt vmcnt(16)
    s_barrier
    s_mov_b64 exec, 1
    buffer_load_dword v8, v9, s[56:59], 0 offen sc1
    s_mov_b64 exec, -1
    s_waitcnt vmcnt(9)
    s_barrier
    s_waitcnt vmcnt(0)
    v_readfirstlane_b32 s53, v8
    s_add_u32 s54, s52, 8
    s_cmp_eq_u32 s53, s54
    s_cbranch_scc1 fok_56
    s_mov_b32 s53, 0
    s_add_u32 s54, s52, 8
    s_bfm_b64 exec, 1, 0
poll_57:
    buffer_load_dword v8, v9, s[56:59], 0 offen sc1
    s_waitcnt vmcnt(0)
    v_xor_b32 v8, s54, v8
    v_cmp_eq_u32 vcc, 0, v8
    s_nop 0
    s_cmp_eq_u64 vcc, exec
    s_cbranch_scc1 pok_58
    s_sleep 5
    s_add_u32 s53, s53, 1
    s_cmp_lt_u32 s53, s61
    s_cbranch_scc1 poll_57
    s_mov_b32 s61, 0
pok_58:
    s_mov_b64 exec, -1
fok_56:
    buffer_load_dwordx4 v2, s[12:15], s39 offen sc1 lds
    s_add_u32 m0, m0, 1024
    s_nop 0
    buffer_load_dwordx4 v2, s[12:15], s40 offen sc1 lds
    s_add_u32 m0, m0, 1024
    s_add_u32 s39, s39, 229376
    buffer_load_dwordx4 v2, s[12:15], s39 offen sc1 lds
    s_add_u32 m0, m0, 1024
    s_add_u32 s40, s40, 229376
    buffer_load_dwordx4 v2, s[12:15], s40 offen sc1 lds
    s_call_b64 s[76:77], PREP_a_issue_4
    s_add_u32 m0, m0, 1024
    s_add_u32 s39, s39, 229376
    buffer_load_dwordx4 v2, s[12:15], s39 offen sc1 lds
    s_add_u32 m0, m0, 1024
    s_add_u32 s40, s40, 229376
    buffer_load_dwordx4 v2, s[12:15], s40 offen sc1 lds
    s_add_u32 m0, m0, 1024
    s_add_u32 s39, s39, 229376
    buffer_load_dwordx4 v2, s[12:15], s39 offen sc1 lds
    s_add_u32 m0, m0, 1024
    s_add_u32 s40, s40, 229376
    buffer_load_dwordx4 v2, s[12:15], s40 offen sc1 lds
    s_mov_b32 m0, s19
    s_mov_b32 s39, s16
    s_mov_b32 s40, s17
    s_waitcnt vmcnt(9)
    s_barrier
    s_mov_b64 exec, 1
    buffer_atomic_add v13, v10, s[56:59], s51 offen sc1
    s_mov_b64 exec, -1
    buffer_load_dwordx4 v2, s[12:15], s39 offen sc1 lds
    s_add_u32 m0, m0, 1024
    s_nop 0
    buffer_load_dwordx4 v2, s[12:15], s40 offen sc1 lds
    s_add_u32 m0, m0, 1024
    s_add_u32 s39, s39, 229376
    buffer_load_dwordx4 v2, s[12:15], s39 offen sc1 lds
    s_add_u32 m0, m0, 1024
    s_add_u32 s40, s40, 229376
    buffer_load_dwordx4 v2, s[12:15], s40 offen sc1 lds
    s_call_b64 s[76:77], PREP_a_issue_4
    s_add_u32 m0, m0, 1024
    s_add_u32 s39, s39, 229376
    buffer_load_dwordx4 v2, s[12:15], s39 offen sc1 lds
    s_add_u32 m0, m0, 1024
    s_add_u32 s40, s40, 229376
    buffer_load_dwordx4 v2, s[12:15], s40 offen sc1 lds
    s_add_u32 m0, m0, 1024
    s_add_u32 s39, s39, 229376
    buffer_load_dwordx4 v2, s[12:15], s39 offen sc1 lds
    s_add_u32 m0, m0, 1024
    s_add_u32 s40, s40, 229376
    buffer_load_dwordx4 v2, s[12:15], s40 offen sc1 lds
    s_mov_b32 m0, s19
    s_mov_b32 s39, s16
    s_mov_b32 s40, s17
    s_waitcnt vmcnt(9)
    s_barrier
    buffer_load_dwordx4 v2, s[12:15], s39 offen sc1 lds
    s_add_u32 m0, m0, 1024
    s_nop 0
    buffer_load_dwordx4 v2, s[12:15], s40 offen sc1 lds
    s_add_u32 m0, m0, 1024
    s_add_u32 s39, s39, 229376
    buffer_load_dwordx4 v2, s[12:15], s39 offen sc1 lds
    s_add_u32 m0, m0, 1024
    s_add_u32 s40, s40, 229376
    buffer_load_dwordx4 v2, s[12:15], s40 offen sc1 lds
    s_call_b64 s[76:77], PREP_a_issue_4
    s_add_u32 m0, m0, 1024
    s_add_u32 s39, s39, 229376
    buffer_load_dwordx4 v2, s[12:15], s39 offen sc1 lds
    s_add_u32 m0, m0, 1024
    s_add_u32 s40, s40, 229376
    buffer_load_dwordx4 v2, s[12:15], s40 offen sc1 lds
    s_add_u32 m0, m0, 1024
    s_add_u32 s39, s39, 229376
    buffer_load_dwordx4 v2, s[12:15], s39 offen sc1 lds
    s_add_u32 m0, m0, 1024
    s_add_u32 s40, s40, 229376
    buffer_load_dwordx4 v2, s[12:15], s40 offen sc1 lds
    s_mov_b32 m0, s19
    s_mov_b32 s39, s16
    s_mov_b32 s40, s17
    s_waitcnt vmcnt(8)
    s_barrier
    buffer_load_dwordx4 v2, s[12:15], s39 offen sc1 lds
    s_add_u32 m0, m0, 1024
    s_nop 0
    buffer_load_dwordx4 v2, s[12:15], s40 offen sc1 lds
    s_add_u32 m0, m0, 1024
    s_add_u32 s39, s39, 229376
    buffer_load_dwordx4 v2, s[12:15], s39 offen sc1 lds
    s_add_u32 m0, m0, 1024
    s_add_u32 s40, s40, 229376
    buffer_load_dwordx4 v2, s[12:15], s40 offen sc1 lds
    s_mov_b64 exec, 1
    buffer_load_dword v11, v10, s[56:59], 0 offen sc1
    s_mov_b64 exec, -1
    s_call_b64 s[76:77], PREP_a_issue_4
    s_add_u32 m0, m0, 1024
    s_add_u32 s39, s39, 229376
    buffer_load_dwordx4 v2, s[12:15], s39 offen sc1 lds
    s_add_u32 m0, m0, 1024
    s_add_u32 s40, s40, 229376
    buffer_load_dwordx4 v2, s[12:15], s40 offen sc1 lds
    s_add_u32 m0, m0, 1024
    s_add_u32 s39, s39, 229376
    buffer_load_dwordx4 v2, s[12:15], s39 offen sc1 lds
    s_add_u32 m0, m0, 1024
    s_add_u32 s40, s40, 229376
    buffer_load_dwordx4 v2, s[12:15], s40 offen sc1 lds
    s_mov_b32 m0, s19
    s_mov_b32 s39, s16
    s_mov_b32 s40, s17
    s_waitcnt vmcnt(9)
    s_barrier
    s_mov_b64 exec, 1
    buffer_atomic_add v13, v12, s[56:59], s51 offen sc1
    s_mov_b64 exec, -1
    buffer_load_dwordx4 v2, s[12:15], s39 offen sc1 lds
    s_add_u32 m0, m0, 1024
    s_nop 0
    buffer_load_dwordx4 v2, s[12:15], s40 offen sc1 lds
    s_add_u32 m0, m0, 1024
    s_add_u32 s39, s39, 229376
    buffer_load_dwordx4 v2, s[12:15], s39 offen sc1 lds
    s_add_u32 m0, m0, 1024
    s_add_u32 s40, s40, 229376
    buffer_load_dwordx4 v2, s[12:15], s40 offen sc1 lds
    s_call_b64 s[76:77], PREP_a_issue_4
    s_add_u32 m0, m0, 1024
    s_add_u32 s39, s39, 229376
    buffer_load_dwordx4 v2, s[12:15], s39 offen sc1 lds
    s_add_u32 m0, m0, 1024
    s_add_u32 s40, s40, 229376
    buffer_load_dwordx4 v2, s[12:15], s40 offen sc1 lds
    s_add_u32 m0, m0, 1024
    s_add_u32 s39, s39, 229376
    buffer_load_dwordx4 v2, s[12:15], s39 offen sc1 lds
    s_add_u32 m0, m0, 1024
    s_add_u32 s40, s40, 229376
    buffer_load_dwordx4 v2, s[12:15], s40 offen sc1 lds
    s_mov_b32 m0, s19
    s_mov_b32 s39, s16
    s_mov_b32 s40, s17
    s_waitcnt vmcnt(9)
    s_barrier
    buffer_load_dwordx4 v2, s[12:15], s39 offen sc1 lds
    s_add_u32 m0, m0, 1024
    s_nop 0
    buffer_load_dwordx4 v2, s[12:15], s40 offen sc1 lds
    s_add_u32 m0, m0, 1024
    s_add_u32 s39, s39, 229376
    buffer_load_dwordx4 v2, s[12:15], s39 offen sc1 lds
    s_add_u32 m0, m0, 1024
    s_add_u32 s40, s40, 229376
    buffer_load_dwordx4 v2, s[12:15], s40 offen sc1 lds
    s_waitcnt vmcnt(17)
    v_readfirstlane_b32 s53, v11
    s_add_u32 s54, s52, 8
    s_cmp_eq_u32 s53, s54
    s_cbranch_scc1 fok_59
    s_mov_b32 s53, 0
    s_add_u32 s54, s52, 8
    s_bfm_b64 exec, 1, 0
poll_60:
    buffer_load_dword v11, v10, s[56:59], 0 offen sc1
    s_waitcnt vmcnt(0)
    v_xor_b32 v11, s54, v11
    v_cmp_eq_u32 vcc, 0, v11
    s_nop 0
    s_cmp_eq_u64 vcc, exec
    s_cbranch_scc1 pok_61
    s_sleep 5
    s_add_u32 s53, s53, 1
    s_cmp_lt_u32 s53, s61
    s_cbranch_scc1 poll_60
    s_mov_b32 s61, 0
pok_61:
    s_mov_b64 exec, -1
fok_59:
    s_call_b64 s[76:77], PREP_a_issue_4
    s_add_u32 m0, m0, 1024
    s_add_u32 s39, s39, 229376
    buffer_load_dwordx4 v2, s[12:15], s39 offen sc1 lds
    s_add_u32 m0, m0, 1024
    s_add_u32 s40, s40, 229376
    buffer_load_dwordx4 v2, s[12:15], s40 offen sc1 lds
    s_add_u32 m0, m0, 1024
    s_add_u32 s39, s39, 229376
    buffer_load_dwordx4 v2, s[12:15], s39 offen sc1 lds
    s_add_u32 m0, m0, 1024
    s_add_u32 s40, s40, 229376
    buffer_load_dwordx4 v2, s[12:15], s40 offen sc1 lds
    s_mov_b32 m0, s19
    s_mov_b32 s39, s16
    s_mov_b32 s40, s17
    s_waitcnt vmcnt(8)
    s_barrier
    buffer_load_dwordx4 v2, s[12:15], s39 offen sc1 lds
    s_add_u32 m0, m0, 1024
    s_nop 0
    buffer_load_dwordx4 v2, s[12:15], s40 offen sc1 lds
    s_add_u32 m0, m0, 1024
    s_add_u32 s39, s39, 229376
    buffer_load_dwordx4 v2, s[12:15], s39 offen sc1 lds
    s_add_u32 m0, m0, 1024
    s_add_u32 s40, s40, 229376
    buffer_load_dwordx4 v2, s[12:15], s40 offen sc1 lds
    s_mov_b32 s43, 1
ld_62:
    s_add_u32 s19, s41, s42
    v_readlane_b32 s16, v249, s44
    v_readlane_b32 s17, v250, s44
    s_add_u32 s16, s16, s38
    s_add_u32 s17, s17, s38
    s_add_u32 s44, s44, 1
    s_add_u32 s42, s42, 16384
    s_cmp_eq_u32 s42, 49152
    s_cselect_b32 s42, 0, s42
    s_add_u32 m0, m0, 1024
    s_add_u32 s39, s39, 229376
    buffer_load_dwordx4 v2, s[12:15], s39 offen sc1 lds
    s_add_u32 m0, m0, 1024
    s_add_u32 s40, s40, 229376
    buffer_load_dwordx4 v2, s[12:15], s40 offen sc1 lds
    s_add_u32 m0, m0, 1024
    s_add_u32 s39, s39, 229376
    buffer_load_dwordx4 v2, s[12:15], s39 offen sc1 lds
    s_add_u32 m0, m0, 1024
    s_add_u32 s40, s40, 229376
    buffer_load_dwordx4 v2, s[12:15], s40 offen sc1 lds
    s_mov_b32 m0, s19
    s_mov_b32 s39, s16
    s_mov_b32 s40, s17
    s_waitcnt vmcnt(8)
    s_barrier
    buffer_load_dwordx4 v2, s[12:15], s39 offen sc1 lds
    s_add_u32 m0, m0, 1024
    s_nop 0
    buffer_load_dwordx4 v2, s[12:15], s40 offen sc1 lds
    s_add_u32 m0, m0, 1024
    s_add_u32 s39, s39, 229376
    buffer_load_dwordx4 v2, s[12:15], s39 offen sc1 lds
    s_add_u32 m0, m0, 1024
    s_add_u32 s40, s40, 229376
    buffer_load_dwordx4 v2, s[12:15], s40 offen sc1 lds
    s_add_u32 s43, s43, 1
    s_cmp_lt_u32 s43, 4
    s_cbranch_scc1 ld_62
    s_call_b64 s[76:77], PREP_a_issue_4
    s_add_u32 m0, m0, 1024
    s_add_u32 s39, s39, 229376
    buffer_load_dwordx4 v2, s[12:15], s39 offen sc1 lds
    s_add_u32 m0, m0, 1024
    s_add_u32 s40, s40, 229376
    buffer_load_dwordx4 v2, s[12:15], s40 offen sc1 lds
    s_add_u32 m0, m0, 1024
    s_add_u32 s39, s39, 229376
    buffer_load_dwordx4 v2, s[12:15], s39 offen sc1 lds
    s_add_u32 m0, m0, 1024
    s_add_u32 s40, s40, 229376
    buffer_load_dwordx4 v2, s[12:15], s40 offen sc1 lds
    s_mov_b32 m0, s19
    s_mov_b32 s39, s16
    s_mov_b32 s40, s17
    s_waitcnt vmcnt(8)
    s_barrier
    buffer_load_dwordx4 v2, s[12:15], s39 offen sc1 lds
    s_add_u32 m0, m0, 1024
    s_nop 0
    buffer_load_dwordx4 v2, s[12:15], s40 offen sc1 lds
    s_add_u32 m0, m0, 1024
    s_add_u32 s39, s39, 229376
    buffer_load_dwordx4 v2, s[12:15], s39 offen sc1 lds
    s_add_u32 m0, m0, 1024
    s_add_u32 s40, s40, 229376
    buffer_load_dwordx4 v2, s[12:15], s40 offen sc1 lds
    s_mov_b64 exec, 1
    buffer_load_dword v11, v12, s[56:59], 0 offen sc1
    s_mov_b64 exec, -1
    s_call_b64 s[76:77], PREP_a_issue_4
    s_add_u32 m0, m0, 1024
    s_add_u32 s39, s39, 229376
    buffer_load_dwordx4 v2, s[12:15], s39 offen sc1 lds
    s_add_u32 m0, m0, 1024
    s_add_u32 s40, s40, 229376
    buffer_load_dwordx4 v2, s[12:15], s40 offen sc1 lds
    s_add_u32 m0, m0, 1024
    s_add_u32 s39, s39, 229376
    buffer_load_dwordx4 v2, s[12:15], s39 offen sc1 lds
    s_add_u32 m0, m0, 1024
    s_add_u32 s40, s40, 229376
    buffer_load_dwordx4 v2, s[12:15], s40 offen sc1 lds
    s_mov_b32 m0, s19
    s_mov_b32 s39, s16
    s_mov_b32 s40, s17
    s_waitcnt vmcnt(9)
    s_barrier
    buffer_load_dwordx4 v2, s[12:15], s39 offen sc1 lds
    s_add_u32 m0, m0, 1024
    s_nop 0
    buffer_load_dwordx4 v2, s[12:15], s40 offen sc1 lds
    s_add_u32 m0, m0, 1024
    s_add_u32 s39, s39, 229376
    buffer_load_dwordx4 v2, s[12:15], s39 offen sc1 lds
    s_add_u32 m0, m0, 1024
    s_add_u32 s40, s40, 229376
    buffer_load_dwordx4 v2, s[12:15], s40 offen sc1 lds
    s_call_b64 s[76:77], PREP_a_issue_4
    s_add_u32 m0, m0, 1024
    s_add_u32 s39, s39, 229376
    buffer_load_dwordx4 v2, s[12:15], s39 offen sc1 lds
    s_add_u32 m0, m0, 1024
    s_add_u32 s40, s40, 229376
    buffer_load_dwordx4 v2, s[12:15], s40 offen sc1 lds
    s_add_u32 m0, m0, 1024
    s_add_u32 s39, s39, 229376
    buffer_load_dwordx4 v2, s[12:15], s39 offen sc1 lds
    s_add_u32 m0, m0, 1024
    s_add_u32 s40, s40, 229376
    buffer_load_dwordx4 v2, s[12:15], s40 offen sc1 lds
    s_mov_b32 m0, s19
    s_mov_b32 s39, s16
    s_mov_b32 s40, s17
    s_waitcnt vmcnt(8)
    s_barrier
    buffer_load_dwordx4 v2, s[12:15], s39 offen sc1 lds
    s_add_u32 m0, m0, 1024
    s_nop 0
    buffer_load_dwordx4 v2, s[12:15], s40 offen sc1 lds
    s_add_u32 m0, m0, 1024
    s_add_u32 s39, s39, 229376
    buffer_load_dwordx4 v2, s[12:15], s39 offen sc1 lds
    s_add_u32 m0, m0, 1024
    s_add_u32 s40, s40, 229376
    buffer_load_dwordx4 v2, s[12:15], s40 offen sc1 lds
    s_waitcnt vmcnt(16)
    v_readfirstlane_b32 s53, v11
    s_add_u32 s54, s52, 8
    s_cmp_eq_u32 s53, s54
    s_cbranch_scc1 fok_63
    s_mov_b32 s53, 0
    s_add_u32 s54, s52, 8
    s_bfm_b64 exec, 1, 0
poll_64:
    buffer_load_dword v11, v12, s[56:59], 0 offen sc1
    s_waitcnt vmcnt(0)
    v_xor_b32 v11, s54, v11
    v_cmp_eq_u32 vcc, 0, v11
    s_nop 0
    s_cmp_eq_u64 vcc, exec
    s_cbranch_scc1 pok_65
    s_sleep 5
    s_add_u32 s53, s53, 1
    s_cmp_lt_u32 s53, s61
    s_cbranch_scc1 poll_64
    s_mov_b32 s61, 0
pok_65:
    s_mov_b64 exec, -1
fok_63:
    s_call_b64 s[76:77], PREP_a_issue_4
    s_add_u32 m0, m0, 1024
    s_add_u32 s39, s39, 229376
    buffer_load_dwordx4 v2, s[12:15], s39 offen sc1 lds
    s_add_u32 m0, m0, 1024
    s_add_u32 s40, s40, 229376
    buffer_load_dwordx4 v2, s[12:15], s40 offen sc1 lds
    s_add_u32 m0, m0, 1024
    s_add_u32 s39, s39, 229376
    buffer_load_dwordx4 v2, s[12:15], s39 offen sc1 lds
    s_add_u32 m0, m0, 1024
    s_add_u32 s40, s40, 229376
    buffer_load_dwordx4 v2, s[12:15], s40 offen sc1 lds
    s_mov_b32 m0, s19
    s_mov_b32 s39, s16
    s_mov_b32 s40, s17
    s_waitcnt vmcnt(8)
    s_barrier
    buffer_load_dwordx4 v2, s[12:15], s39 offen sc1 lds
    s_add_u32 m0, m0, 1024
    s_nop 0
    buffer_load_dwordx4 v2, s[12:15], s40 offen sc1 lds
    s_add_u32 m0, m0, 1024
    s_add_u32 s39, s39, 229376
    buffer_load_dwordx4 v2, s[12:15], s39 offen sc1 lds
    s_add_u32 m0, m0, 1024
    s_add_u32 s40, s40, 229376
    buffer_load_dwordx4 v2, s[12:15], s40 offen sc1 lds
    s_mov_b32 s43, 1
ld_66:
    s_add_u32 s19, s41, s42
    v_readlane_b32 s16, v249, s44
    v_readlane_b32 s17, v250, s44
    s_add_u32 s16, s16, s38
    s_add_u32 s17, s17, s38
    s_add_u32 s44, s44, 1
    s_add_u32 s42, s42, 16384
    s_cmp_eq_u32 s42, 49152
    s_cselect_b32 s42, 0, s42
    s_add_u32 m0, m0, 1024
    s_add_u32 s39, s39, 229376
    buffer_load_dwordx4 v2, s[12:15], s39 offen sc1 lds
    s_add_u32 m0, m0, 1024
    s_add_u32 s40, s40, 229376
    buffer_load_dwordx4 v2, s[12:15], s40 offen sc1 lds
    s_add_u32 m0, m0, 1024
    s_add_u32 s39, s39, 229376
    buffer_load_dwordx4 v2, s[12:15], s39 offen sc1 lds
    s_add_u32 m0, m0, 1024
    s_add_u32 s40, s40, 229376
    buffer_load_dwordx4 v2, s[12:15], s40 offen sc1 lds
    s_mov_b32 m0, s19
    s_mov_b32 s39, s16
    s_mov_b32 s40, s17
    s_waitcnt vmcnt(8)
    s_barrier
    buffer_load_dwordx4 v2, s[12:15], s39 offen sc1 lds
    s_add_u32 m0, m0, 1024
    s_nop 0
    buffer_load_dwordx4 v2, s[12:15], s40 offen sc1 lds
    s_add_u32 m0, m0, 1024
    s_add_u32 s39, s39, 229376
    buffer_load_dwordx4 v2, s[12:15], s39 offen sc1 lds
    s_add_u32 m0, m0, 1024
    s_add_u32 s40, s40, 229376
    buffer_load_dwordx4 v2, s[12:15], s40 offen sc1 lds
    s_add_u32 s43, s43, 1
    s_cmp_lt_u32 s43, 5
    s_cbranch_scc1 ld_66
    s_call_b64 s[76:77], PREP_a_issue_4
    s_add_u32 m0, m0, 1024
    s_add_u32 s39, s39, 229376
    buffer_load_dwordx4 v2, s[12:15], s39 offen sc1 lds
    s_add_u32 m0, m0, 1024
    s_add_u32 s40, s40, 229376
    buffer_load_dwordx4 v2, s[12:15], s40 offen sc1 lds
    s_add_u32 m0, m0, 1024
    s_add_u32 s39, s39, 229376
    buffer_load_dwordx4 v2, s[12:15], s39 offen sc1 lds
    s_add_u32 m0, m0, 1024
    s_add_u32 s40, s40, 229376
    buffer_load_dwordx4 v2, s[12:15], s40 offen sc1 lds
    s_mov_b32 m0, s19
    s_mov_b32 s39, s16
    s_mov_b32 s40, s17
    s_waitcnt vmcnt(8)
    s_barrier
    buffer_load_dwordx4 v2, s[12:15], s39 offen sc1 lds
    s_add_u32 m0, m0, 1024
    s_nop 0
    buffer_load_dwordx4 v2, s[12:15], s40 offen sc1 lds
    s_add_u32 m0, m0, 1024
    s_add_u32 s39, s39, 229376
    buffer_load_dwordx4 v2, s[12:15], s39 offen sc1 lds
    s_add_u32 m0, m0, 1024
    s_add_u32 s40, s40, 229376
    buffer_load_dwordx4 v2, s[12:15], s40 offen sc1 lds
    s_mov_b64 exec, 1
    buffer_load_dword v11, v15, s[56:59], 0 offen sc1
    s_mov_b64 exec, -1
    s_call_b64 s[76:77], PREP_a_issue_4
    s_add_u32 m0, m0, 1024
    s_add_u32 s39, s39, 229376
    buffer_load_dwordx4 v2, s[12:15], s39 offen sc1 lds
    s_add_u32 m0, m0, 1024
    s_add_u32 s40, s40, 229376
    buffer_load_dwordx4 v2, s[12:15], s40 offen sc1 lds
    s_add_u32 m0, m0, 1024
    s_add_u32 s39, s39, 229376
    buffer_load_dwordx4 v2, s[12:15], s39 offen sc1 lds
    s_add_u32 m0, m0, 1024
    s_add_u32 s40, s40, 229376
    buffer_load_dwordx4 v2, s[12:15], s40 offen sc1 lds
    s_mov_b32 m0, s19
    s_mov_b32 s39, s16
    s_mov_b32 s40, s17
    s_waitcnt vmcnt(9)
    s_barrier
    buffer_load_dwordx4 v2, s[12:15], s39 offen sc1 lds
    s_add_u32 m0, m0, 1024
    s_nop 0
    buffer_load_dwordx4 v2, s[12:15], s40 offen sc1 lds
    s_add_u32 m0, m0, 1024
    s_add_u32 s39, s39, 229376
    buffer_load_dwordx4 v2, s[12:15], s39 offen sc1 lds
    s_add_u32 m0, m0, 1024
    s_add_u32 s40, s40, 229376
    buffer_load_dwordx4 v2, s[12:15], s40 offen sc1 lds
    s_call_b64 s[76:77], PREP_a_issue_4
    s_add_u32 m0, m0, 1024
    s_add_u32 s39, s39, 229376
    buffer_load_dwordx4 v2, s[12:15], s39 offen sc1 lds
    s_add_u32 m0, m0, 1024
    s_add_u32 s40, s40, 229376
    buffer_load_dwordx4 v2, s[12:15], s40 offen sc1 lds
    s_add_u32 m0, m0, 1024
    s_add_u32 s39, s39, 229376
    buffer_load_dwordx4 v2, s[12:15], s39 offen sc1 lds
    s_add_u32 m0, m0, 1024
    s_add_u32 s40, s40, 229376
    buffer_load_dwordx4 v2, s[12:15], s40 offen sc1 lds
    s_mov_b32 m0, s19
    s_mov_b32 s39, s16
    s_mov_b32 s40, s17
    s_waitcnt vmcnt(8)
    s_barrier
    buffer_load_dwordx4 v2, s[12:15], s39 offen sc1 lds
    s_add_u32 m0, m0, 1024
    s_nop 0
    buffer_load_dwordx4 v2, s[12:15], s40 offen sc1 lds
    s_add_u32 m0, m0, 1024
    s_add_u32 s39, s39, 229376
    buffer_load_dwordx4 v2, s[12:15], s39 offen sc1 lds
    s_add_u32 m0, m0, 1024
    s_add_u32 s40, s40, 229376
    buffer_load_dwordx4 v2, s[12:15], s40 offen sc1 lds
    s_waitcnt vmcnt(16)
    v_readfirstlane_b32 s53, v11
    s_add_u32 s54, s52, 8
    s_cmp_eq_u32 s53, s54
    s_cbranch_scc1 fok_67
    s_mov_b32 s53, 0
    s_add_u32 s54, s52, 8
    s_bfm_b64 exec, 1, 0
poll_68:
    buffer_load_dword v11, v15, s[56:59], 0 offen sc1
    s_waitcnt vmcnt(0)
    v_xor_b32 v11, s54, v11
    v_cmp_eq_u32 vcc, 0, v11
    s_nop 0
    s_cmp_eq_u64 vcc, exec
    s_cbranch_scc1 pok_69
    s_sleep 5
    s_add_u32 s53, s53, 1
    s_cmp_lt_u32 s53, s61
    s_cbranch_scc1 poll_68
    s_mov_b32 s61, 0
pok_69:
    s_mov_b64 exec, -1
fok_67:
    s_call_b64 s[76:77], PREP_a_issue_4
    s_add_u32 m0, m0, 1024
    s_add_u32 s39, s39, 229376
    buffer_load_dwordx4 v2, s[12:15], s39 offen sc1 lds
    s_add_u32 m0, m0, 1024
    s_add_u32 s40, s40, 229376
    buffer_load_dwordx4 v2, s[12:15], s40 offen sc1 lds
    s_add_u32 m0, m0, 1024
    s_add_u32 s39, s39, 229376
    buffer_load_dwordx4 v2, s[12:15], s39 offen sc1 lds
    s_add_u32 m0, m0, 1024
    s_add_u32 s40, s40, 229376
    buffer_load_dwordx4 v2, s[12:15], s40 offen sc1 lds
    s_mov_b32 m0, s19
    s_mov_b32 s39, s16
    s_mov_b32 s40, s17
    s_waitcnt vmcnt(8)
    s_barrier
    buffer_load_dwordx4 v2, s[12:15], s39 offen sc1 lds
    s_add_u32 m0, m0, 1024
    s_nop 0
    buffer_load_dwordx4 v2, s[12:15], s40 offen sc1 lds
    s_add_u32 m0, m0, 1024
    s_add_u32 s39, s39, 229376
    buffer_load_dwordx4 v2, s[12:15], s39 offen sc1 lds
    s_add_u32 m0, m0, 1024
    s_add_u32 s40, s40, 229376
    buffer_load_dwordx4 v2, s[12:15], s40 offen sc1 lds
    s_mov_b32 s43, 1
ld_70:
    s_add_u32 s19, s41, s42
    v_readlane_b32 s16, v249, s44
    v_readlane_b32 s17, v250, s44
    s_add_u32 s16, s16, s38
    s_add_u32 s17, s17, s38
    s_add_u32 s44, s44, 1
    s_add_u32 s42, s42, 16384
    s_cmp_eq_u32 s42, 49152
    s_cselect_b32 s42, 0, s42
    s_add_u32 m0, m0, 1024
    s_add_u32 s39, s39, 229376
    buffer_load_dwordx4 v2, s[12:15], s39 offen sc1 lds
    s_add_u32 m0, m0, 1024
    s_add_u32 s40, s40, 229376
    buffer_load_dwordx4 v2, s[12:15], s40 offen sc1 lds
    s_add_u32 m0, m0, 1024
    s_add_u32 s39, s39, 229376
    buffer_load_dwordx4 v2, s[12:15], s39 offen sc1 lds
    s_add_u32 m0, m0, 1024
    s_add_u32 s40, s40, 229376
    buffer_load_dwordx4 v2, s[12:15], s40 offen sc1 lds
    s_mov_b32 m0, s19
    s_mov_b32 s39, s16
    s_mov_b32 s40, s17
    s_waitcnt vmcnt(8)
    s_barrier
    buffer_load_dwordx4 v2, s[12:15], s39 offen sc1 lds
    s_add_u32 m0, m0, 1024
    s_nop 0
    buffer_load_dwordx4 v2, s[12:15], s40 offen sc1 lds
    s_add_u32 m0, m0, 1024
    s_add_u32 s39, s39, 229376
    buffer_load_dwordx4 v2, s[12:15], s39 offen sc1 lds
    s_add_u32 m0, m0, 1024
    s_add_u32 s40, s40, 229376
    buffer_load_dwordx4 v2, s[12:15], s40 offen sc1 lds
    s_add_u32 s43, s43, 1
    s_cmp_lt_u32 s43, 3
    s_cbranch_scc1 ld_70
    s_call_b64 s[76:77], PREP_a_issue_4
    s_add_u32 m0, m0, 1024
    s_add_u32 s39, s39, 229376
    buffer_load_dwordx4 v2, s[12:15], s39 offen sc1 lds
    s_add_u32 m0, m0, 1024
    s_add_u32 s40, s40, 229376
    buffer_load_dwordx4 v2, s[12:15], s40 offen sc1 lds
    s_add_u32 m0, m0, 1024
    s_add_u32 s39, s39, 229376
    buffer_load_dwordx4 v2, s[12:15], s39 offen sc1 lds
    s_add_u32 m0, m0, 1024
    s_add_u32 s40, s40, 229376
    buffer_load_dwordx4 v2, s[12:15], s40 offen sc1 lds
    s_mov_b32 m0, s19
    s_mov_b32 s39, s16
    s_mov_b32 s40, s17
    s_waitcnt vmcnt(8)
    s_barrier
    buffer_load_dwordx4 v2, s[12:15], s39 offen sc1 lds
    s_add_u32 m0, m0, 1024
    s_nop 0
    buffer_load_dwordx4 v2, s[12:15], s40 offen sc1 lds
    s_add_u32 m0, m0, 1024
    s_add_u32 s39, s39, 229376
    buffer_load_dwordx4 v2, s[12:15], s39 offen sc1 lds
    s_add_u32 m0, m0, 1024
    s_add_u32 s40, s40, 229376
    buffer_load_dwordx4 v2, s[12:15], s40 offen sc1 lds
    s_add_u32 m0, m0, 1024
    s_add_u32 s39, s39, 229376
    buffer_load_dwordx4 v2, s[12:15], s39 offen sc1 lds
    s_add_u32 m0, m0, 1024
    s_add_u32 s40, s40, 229376
    buffer_load_dwordx4 v2, s[12:15], s40 offen sc1 lds
    s_add_u32 m0, m0, 1024
    s_add_u32 s39, s39, 229376
    buffer_load_dwordx4 v2, s[12:15], s39 offen sc1 lds
    s_add_u32 m0, m0, 1024
    s_add_u32 s40, s40, 229376
    buffer_load_dwordx4 v2, s[12:15], s40 offen sc1 lds
    s_waitcnt vmcnt(8)
    s_barrier
    s_waitcnt vmcnt(0)
    s_barrier
    s_cmp_eq_u32 s60, 1
    s_cbranch_scc1 K_fin
    s_barrier
    s_and_b32 s36, s30, 1
    s_lshl_b32 s36, s36, 12
    s_add_u32 s36, s36, 32768
    v_add_u32 v6, s36, v2
    ds_write_b128 v6, v[16:19] offset:0
    ds_write_b128 v6, v[20:23] offset:1024
    ds_write_b128 v6, v[24:27] offset:2048
    ds_write_b128 v6, v[28:31] offset:3072
    ds_write_b128 v6, v[32:35] offset:8192
    ds_write_b128 v6, v[36:39] offset:9216
    ds_write_b128 v6, v[40:43] offset:10240
    ds_write_b128 v6, v[44:47] offset:11264
    s_waitcnt lgkmcnt(0)
    s_branch NEXT
WLOAD:
    s_cmp_eq_u32 s60, 1
    s_cbranch_scc1 WL_1
    s_mov_b64 s[12:13], s[68:69]
    s_mov_b32 s14, 2097152
    s_mov_b32 s15, 0x20000
    s_and_b32 s35, s30, 1
    s_mul_i32 s38, s99, 128
    s_mul_i32 s41, s35, 65536
    s_add_u32 s38, s38, s41
    s_mul_i32 s41, s35, 4096
    s_add_u32 s41, s41, 24576
    s_mov_b32 s42, 0
    s_mov_b32 s44, s67
    s_branch WL_2
WL_1:
    s_mov_b64 s[12:13], s[68:69]
    s_mov_b32 s14, 2097152
    s_mov_b32 s15, 0x20000
    s_and_b32 s35, s30, 1
    s_mul_i32 s38, s99, 128
    s_mul_i32 s41, s35, 65536
    s_add_u32 s38, s38, s41
    s_mul_i32 s41, s35, 4096
    s_add_u32 s41, s41, 24576
    s_mov_b32 s42, 0
    s_mov_b32 s44, s67
WL_2:
    s_waitcnt vmcnt(0)
    s_and_b32 s36, s30, 1
    s_lshl_b32 s36, s36, 12
    s_add_u32 s36, s36, 81920
    v_add_u32 v6, s36, v2
    ds_read_b128 v[16:19], v6 offset:16384
    ds_read_b128 v[20:23], v6 offset:17408
    ds_read_b128 v[24:27], v6 offset:18432
    ds_read_b128 v[28:31], v6 offset:19456
    ds_read_b128 v[32:35], v6 offset:24576
    ds_read_b128 v[36:39], v6 offset:25600
    ds_read_b128 v[40:43], v6 offset:26624
    ds_read_b128 v[44:47], v6 offset:27648
    ds_read_b128 v[204:207], v6 offset:0
    ds_read_b128 v[208:211], v6 offset:1024
    ds_read_b128 v[212:215], v6 offset:2048
    ds_read_b128 v[216:219], v6 offset:3072
    s_waitcnt lgkmcnt(0)
    s_call_b64 s[76:77], SUB_before_d1
    s_barrier
    s_call_b64 s[76:77], SUB_after_g1
    s_barrier
    s_waitcnt vmcnt(0)
    s_barrier
    s_call_b64 s[76:77], SUB_after_g2
    s_mov_b64 s[12:13], s[72:73]
    s_mov_b32 s14, 7340032
    s_mov_b32 s15, 0x20000
    s_and_b32 s35, s30, 1
    s_mul_i32 s38, s29, 448
    s_mul_i32 s41, s35, 229376
    s_add_u32 s38, s38, s41
    s_mul_i32 s41, s35, 14336
    s_add_u32 s41, s41, 73728
    s_mov_b32 s42, 0
    s_mov_b32 s44, 0
    s_mov_b32 s42, 28672
    s_mov_b32 s44, 2
    s_add_u32 s19, s41, s42
    v_readlane_b32 s16, v248, s44
    s_nop 0
    s_add_u32 s16, s16, s38
    s_add_u32 s44, s44, 1
    s_and_b32 s44, s44, 15
    s_add_u32 s42, s42, 28672
    s_cmp_eq_u32 s42, 86016
    s_cselect_b32 s42, 0, s42
    s_mov_b32 m0, s19
    s_mov_b32 s39, s16
    s_waitcnt vmcnt(63)
    s_barrier
    buffer_load_dwordx4 v241, s[12:15], s39 offen lds
    s_add_u32 m0, m0, 1024
    s_nop 0
    buffer_load_dwordx4 v242, s[12:15], s39 offen lds
    s_add_u32 m0, m0, 1024
    s_nop 0
    buffer_load_dwordx4 v243, s[12:15], s39 offen lds
    s_add_u32 m0, m0, 1024
    s_nop 0
    buffer_load_dwordx4 v244, s[12:15], s39 offen lds
    s_add_u32 m0, m0, 1024
    s_nop 0
    buffer_load_dwordx4 v245, s[12:15], s39 offen lds
    s_add_u32 m0, m0, 1024
    s_nop 0
    buffer_load_dwordx4 v246, s[12:15], s39 offen lds
    s_add_u32 m0, m0, 1024
    s_nop 0
    buffer_load_dwordx4 v247, s[12:15], s39 offen lds
    s_mov_b32 s43, 1
ld_71:
    s_add_u32 s19, s41, s42
    v_readlane_b32 s16, v248, s44
    s_nop 0
    s_add_u32 s16, s16, s38
    s_add_u32 s44, s44, 1
    s_and_b32 s44, s44, 15
    s_add_u32 s42, s42, 28672
    s_cmp_eq_u32 s42, 86016
    s_cselect_b32 s42, 0, s42
    s_add_u32 m0, m0, 1024
    s_add_u32 s39, s39, 114688
    buffer_load_dwordx4 v241, s[12:15], s39 offen lds
    s_add_u32 m0, m0, 1024
    s_nop 0
    buffer_load_dwordx4 v242, s[12:15], s39 offen lds
    s_add_u32 m0, m0, 1024
    s_nop 0
    buffer_load_dwordx4 v243, s[12:15], s39 offen lds
    s_add_u32 m0, m0, 1024
    s_nop 0
    buffer_load_dwordx4 v244, s[12:15], s39 offen lds
    s_add_u32 m0, m0, 1024
    s_nop 0
    buffer_load_dwordx4 v245, s[12:15], s39 offen lds
    s_add_u32 m0, m0, 1024
    s_nop 0
    buffer_load_dwordx4 v246, s[12:15], s39 offen lds
    s_add_u32 m0, m0, 1024
    s_nop 0
    buffer_load_dwordx4 v247, s[12:15], s39 offen lds
    s_mov_b32 m0, s19
    s_mov_b32 s39, s16
    s_waitcnt vmcnt(14)
    s_barrier
    buffer_load_dwordx4 v241, s[12:15], s39 offen lds
    s_add_u32 m0, m0, 1024
    s_nop 0
    buffer_load_dwordx4 v242, s[12:15], s39 offen lds
    s_add_u32 m0, m0, 1024
    s_nop 0
    buffer_load_dwordx4 v243, s[12:15], s39 offen lds
    s_add_u32 m0, m0, 1024
    s_nop 0
    buffer_load_dwordx4 v244, s[12:15], s39 offen lds
    s_add_u32 m0, m0, 1024
    s_nop 0
    buffer_load_dwordx4 v245, s[12:15], s39 offen lds
    s_add_u32 m0, m0, 1024
    s_nop 0
    buffer_load_dwordx4 v246, s[12:15], s39 offen lds
    s_add_u32 m0, m0, 1024
    s_nop 0
    buffer_load_dwordx4 v247, s[12:15], s39 offen lds
    s_add_u32 s43, s43, 1
    s_cmp_lt_u32 s43, 13
    s_cbranch_scc1 ld_71
    s_add_u32 s19, s41, s42
    v_readlane_b32 s16, v248, s44
    s_nop 0
    s_add_u32 s16, s16, s38
    s_add_u32 s44, s44, 1
    s_and_b32 s44, s44, 15
    s_add_u32 s42, s42, 28672
    s_cmp_eq_u32 s42, 86016
    s_cselect_b32 s42, 0, s42
    s_add_u32 m0, m0, 1024
    s_add_u32 s39, s39, 114688
    buffer_load_dwordx4 v241, s[12:15], s39 offen lds
    s_add_u32 m0, m0, 1024
    s_nop 0
    buffer_load_dwordx4 v242, s[12:15], s39 offen lds
    s_add_u32 m0, m0, 1024
    s_nop 0
    buffer_load_dwordx4 v243, s[12:15], s39 offen lds
    s_add_u32 m0, m0, 1024
    s_nop 0
    buffer_load_dwordx4 v244, s[12:15], s39 offen lds
    s_add_u32 m0, m0, 1024
    s_nop 0
    buffer_load_dwordx4 v245, s[12:15], s39 offen lds
    s_add_u32 m0, m0, 1024
    s_nop 0
    buffer_load_dwordx4 v246, s[12:15], s39 offen lds
    s_add_u32 m0, m0, 1024
    s_nop 0
    buffer_load_dwordx4 v247, s[12:15], s39 offen lds
    s_mov_b32 m0, s19
    s_mov_b32 s39, s16
    s_waitcnt vmcnt(14)
    s_barrier
    buffer_load_dwordx4 v241, s[12:15], s39 offen lds
    s_add_u32 m0, m0, 1024
    s_nop 0
    buffer_load_dwordx4 v242, s[12:15], s39 offen lds
    s_add_u32 m0, m0, 1024
    s_nop 0
    buffer_load_dwordx4 v243, s[12:15], s39 offen lds
    s_add_u32 m0, m0, 1024
    s_nop 0
    buffer_load_dwordx4 v244, s[12:15], s39 offen lds
    s_add_u32 m0, m0, 1024
    s_nop 0
    buffer_load_dwordx4 v245, s[12:15], s39 offen lds
    s_add_u32 m0, m0, 1024
    s_nop 0
    buffer_load_dwordx4 v246, s[12:15], s39 offen lds
    s_add_u32 m0, m0, 1024
    s_nop 0
    buffer_load_dwordx4 v247, s[12:15], s39 offen lds
    s_add_u32 m0, m0, 1024
    s_add_u32 s39, s39, 114688
    buffer_load_dwordx4 v241, s[12:15], s39 offen lds
    s_add_u32 m0, m0, 1024
    s_nop 0
    buffer_load_dwordx4 v242, s[12:15], s39 offen lds
    s_add_u32 m0, m0, 1024
    s_nop 0
    buffer_load_dwordx4 v243, s[12:15], s39 offen lds
    s_add_u32 m0, m0, 1024
    s_nop 0
    buffer_load_dwordx4 v244, s[12:15], s39 offen lds
    s_add_u32 m0, m0, 1024
    s_nop 0
    buffer_load_dwordx4 v245, s[12:15], s39 offen lds
    s_add_u32 m0, m0, 1024
    s_nop 0
    buffer_load_dwordx4 v246, s[12:15], s39 offen lds
    s_add_u32 m0, m0, 1024
    s_nop 0
    buffer_load_dwordx4 v247, s[12:15], s39 offen lds
    s_waitcnt vmcnt(14)
    s_barrier
    s_waitcnt vmcnt(0)
    s_barrier
    s_cmp_lg_u32 s60, 0
    s_cbranch_scc1 rp_72
    s_call_b64 s[76:77], SUB_r_pre
rp_72:
    s_barrier
    s_mov_b64 s[12:13], s[74:75]
    s_mov_b32 s14, 7340032
    s_mov_b32 s15, 0x20000
    s_and_b32 s35, s30, 1
    s_mul_i32 s38, s33, 256
    s_mul_i32 s41, s31, 3670016
    s_add_u32 s38, s38, s41
    s_mul_i32 s41, s35, 8192
    s_add_u32 s41, s41, 49152
    s_mov_b32 s42, 0
    s_mov_b32 s44, 0
    s_mov_b32 s49, s44
    s_and_b32 s43, s28, 3
    s_mul_i32 s43, s43, 6
    s_lshr_b32 s43, s43, 2
    s_mov_b32 s50, 0
wpre_73:
    s_mul_i32 s42, s43, 16384
    s_add_u32 s44, s49, s43
    s_mov_b32 s45, 8192
    s_add_u32 s19, s41, s42
    v_readlane_b32 s16, v249, s44
    s_nop 0
    s_bitcmp1_b32 s16, 0
    s_cselect_b32 s17, 16384, s45
    s_cselect_b32 s18, -40960, s45
    s_andn2_b32 s16, s16, 1
    s_add_u32 s16, s16, s38
    s_add_u32 s44, s44, 1
    s_add_u32 s42, s42, 16384
    s_cmp_eq_u32 s42, 98304
    s_cselect_b32 s42, 0, s42
    s_mov_b32 m0, s19
    s_mov_b32 s39, s16
    s_mov_b32 s32, s17
    s_mov_b32 s3, s18
    buffer_load_dwordx4 v239, s[12:15], s39 offen lds
    s_add_u32 m0, m0, 1024
    s_add_u32 s39, s39, s32
    buffer_load_dwordx4 v240, s[12:15], s39 offen lds
    s_add_u32 m0, m0, 1024
    s_add_u32 s39, s39, s32
    buffer_load_dwordx4 v239, s[12:15], s39 offen lds
    s_add_u32 m0, m0, 1024
    s_add_u32 s39, s39, s32
    buffer_load_dwordx4 v240, s[12:15], s39 offen lds
    s_waitcnt vmcnt(8)
    s_add_u32 m0, m0, 1024
    s_add_u32 s39, s39, s3
    buffer_load_dwordx4 v239, s[12:15], s39 offen lds
    s_add_u32 m0, m0, 1024
    s_add_u32 s39, s39, s32
    buffer_load_dwordx4 v240, s[12:15], s39 offen lds
    s_add_u32 m0, m0, 1024
    s_add_u32 s39, s39, s32
    buffer_load_dwordx4 v239, s[12:15], s39 offen lds
    s_add_u32 m0, m0, 1024
    s_add_u32 s39, s39, s32
    buffer_load_dwordx4 v240, s[12:15], s39 offen lds
    s_waitcnt vmcnt(8)
    s_add_u32 s43, s43, 1
    s_cmp_eq_u32 s43, 6
    s_cselect_b32 s43, 0, s43
    s_add_u32 s50, s50, 1
    s_cmp_lt_u32 s50, 6
    s_cbranch_scc1 wpre_73
    s_mov_b32 s42, 0
    s_add_u32 s44, s49, 6
    s_cmp_eq_u32 s60, 1
    s_cbranch_scc1 WL_t1
    s_call_b64 s[76:77], PREP_w_issue_4
    s_mov_b32 m0, s19
    s_mov_b32 s39, s16
    s_mov_b32 s32, s17
    s_mov_b32 s3, s18
    s_waitcnt vmcnt(0)
    s_barrier
    s_waitcnt vmcnt(0)
    s_barrier
    buffer_load_dwordx4 v239, s[12:15], s39 offen lds
    s_add_u32 m0, m0, 1024
    s_add_u32 s39, s39, s32
    buffer_load_dwordx4 v240, s[12:15], s39 offen lds
    s_add_u32 m0, m0, 1024
    s_add_u32 s39, s39, s32
    buffer_load_dwordx4 v239, s[12:15], s39 offen lds
    s_add_u32 m0, m0, 1024
    s_add_u32 s39, s39, s32
    buffer_load_dwordx4 v240, s[12:15], s39 offen lds
    s_call_b64 s[76:77], PREP_w_issue_4
    s_add_u32 m0, m0, 1024
    s_add_u32 s39, s39, s3
    buffer_load_dwordx4 v239, s[12:15], s39 offen lds
    s_add_u32 m0, m0, 1024
    s_add_u32 s39, s39, s32
    buffer_load_dwordx4 v240, s[12:15], s39 offen lds
    s_add_u32 m0, m0, 1024
    s_add_u32 s39, s39, s32
    buffer_load_dwordx4 v239, s[12:15], s39 offen lds
    s_add_u32 m0, m0, 1024
    s_add_u32 s39, s39, s32
    buffer_load_dwordx4 v240, s[12:15], s39 offen lds
    s_mov_b32 m0, s19
    s_mov_b32 s39, s16
    s_mov_b32 s32, s17
    s_mov_b32 s3, s18
    s_waitcnt vmcnt(8)
    s_barrier
    buffer_load_dwordx4 v239, s[12:15], s39 offen lds
    s_add_u32 m0, m0, 1024
    s_add_u32 s39, s39, s32
    buffer_load_dwordx4 v240, s[12:15], s39 offen lds
    s_add_u32 m0, m0, 1024
    s_add_u32 s39, s39, s32
    buffer_load_dwordx4 v239, s[12:15], s39 offen lds
    s_add_u32 m0, m0, 1024
    s_add_u32 s39, s39, s32
    buffer_load_dwordx4 v240, s[12:15], s39 offen lds
    s_call_b64 s[76:77], PREP_w_issue_4
    s_add_u32 m0, m0, 1024
    s_add_u32 s39, s39, s3
    buffer_load_dwordx4 v239, s[12:15], s39 offen lds
    s_add_u32 m0, m0, 1024
    s_add_u32 s39, s39, s32
    buffer_load_dwordx4 v240, s[12:15], s39 offen lds
    s_add_u32 m0, m0, 1024
    s_add_u32 s39, s39, s32
    buffer_load_dwordx4 v239, s[12:15], s39 offen lds
    s_add_u32 m0, m0, 1024
    s_add_u32 s39, s39, s32
    buffer_load_dwordx4 v240, s[12:15], s39 offen lds
    s_mov_b32 m0, s19
    s_mov_b32 s39, s16
    s_mov_b32 s32, s17
    s_mov_b32 s3, s18
    s_waitcnt vmcnt(16)
    s_barrier
    buffer_load_dwordx4 v239, s[12:15], s39 offen lds
    s_add_u32 m0, m0, 1024
    s_add_u32 s39, s39, s32
    buffer_load_dwordx4 v240, s[12:15], s39 offen lds
    s_add_u32 m0, m0, 1024
    s_add_u32 s39, s39, s32
    buffer_load_dwordx4 v239, s[12:15], s39 offen lds
    s_add_u32 m0, m0, 1024
    s_add_u32 s39, s39, s32
    buffer_load_dwordx4 v240, s[12:15], s39 offen lds
    s_call_b64 s[76:77], PREP_w_issue_4
    s_add_u32 m0, m0, 1024
    s_add_u32 s39, s39, s3
    buffer_load_dwordx4 v239, s[12:15], s39 offen lds
    s_add_u32 m0, m0, 1024
    s_add_u32 s39, s39, s32
    buffer_load_dwordx4 v240, s[12:15], s39 offen lds
    s_add_u32 m0, m0, 1024
    s_add_u32 s39, s39, s32
    buffer_load_dwordx4 v239, s[12:15], s39 offen lds
    s_add_u32 m0, m0, 1024
    s_add_u32 s39, s39, s32
    buffer_load_dwordx4 v240, s[12:15], s39 offen lds
    s_mov_b32 m0, s19
    s_mov_b32 s39, s16
    s_mov_b32 s32, s17
    s_mov_b32 s3, s18
    s_waitcnt vmcnt(24)
    s_barrier
    buffer_load_dwordx4 v239, s[12:15], s39 offen lds
    s_add_u32 m0, m0, 1024
    s_add_u32 s39, s39, s32
    buffer_load_dwordx4 v240, s[12:15], s39 offen lds
    s_add_u32 m0, m0, 1024
    s_add_u32 s39, s39, s32
    buffer_load_dwordx4 v239, s[12:15], s39 offen lds
    s_add_u32 m0, m0, 1024
    s_add_u32 s39, s39, s32
    buffer_load_dwordx4 v240, s[12:15], s39 offen lds
    s_mov_b32 s43, 1
ld_74:
    s_mov_b32 s45, 8192
    s_add_u32 s19, s41, s42
    v_readlane_b32 s16, v249, s44
    s_nop 0
    s_bitcmp1_b32 s16, 0
    s_cselect_b32 s17, 16384, s45
    s_cselect_b32 s18, -40960, s45
    s_andn2_b32 s16, s16, 1
    s_add_u32 s16, s16, s38
    s_add_u32 s44, s44, 1
    s_add_u32 s42, s42, 16384
    s_cmp_eq_u32 s42, 98304
    s_cselect_b32 s42, 0, s42
    s_add_u32 m0, m0, 1024
    s_add_u32 s39, s39, s3
    buffer_load_dwordx4 v239, s[12:15], s39 offen lds
    s_add_u32 m0, m0, 1024
    s_add_u32 s39, s39, s32
    buffer_load_dwordx4 v240, s[12:15], s39 offen lds
    s_add_u32 m0, m0, 1024
    s_add_u32 s39, s39, s32
    buffer_load_dwordx4 v239, s[12:15], s39 offen lds
    s_add_u32 m0, m0, 1024
    s_add_u32 s39, s39, s32
    buffer_load_dwordx4 v240, s[12:15], s39 offen lds
    s_mov_b32 m0, s19
    s_mov_b32 s39, s16
    s_mov_b32 s32, s17
    s_mov_b32 s3, s18
    s_waitcnt vmcnt(32)
    s_barrier
    buffer_load_dwordx4 v239, s[12:15], s39 offen lds
    s_add_u32 m0, m0, 1024
    s_add_u32 s39, s39, s32
    buffer_load_dwordx4 v240, s[12:15], s39 offen lds
    s_add_u32 m0, m0, 1024
    s_add_u32 s39, s39, s32
    buffer_load_dwordx4 v239, s[12:15], s39 offen lds
    s_add_u32 m0, m0, 1024
    s_add_u32 s39, s39, s32
    buffer_load_dwordx4 v240, s[12:15], s39 offen lds
    s_add_u32 s43, s43, 1
    s_cmp_lt_u32 s43, 18
    s_cbranch_scc1 ld_74
    s_call_b64 s[76:77], PREP_w_issue_4
    s_add_u32 m0, m0, 1024
    s_add_u32 s39, s39, s3
    buffer_load_dwordx4 v239, s[12:15], s39 offen lds
    s_add_u32 m0, m0, 1024
    s_add_u32 s39, s39, s32
    buffer_load_dwordx4 v240, s[12:15], s39 offen lds
    s_add_u32 m0, m0, 1024
    s_add_u32 s39, s39, s32
    buffer_load_dwordx4 v239, s[12:15], s39 offen lds
    s_add_u32 m0, m0, 1024
    s_add_u32 s39, s39, s32
    buffer_load_dwordx4 v240, s[12:15], s39 offen lds
    s_mov_b32 m0, s19
    s_mov_b32 s39, s16
    s_mov_b32 s32, s17
    s_mov_b32 s3, s18
    s_waitcnt vmcnt(32)
    s_barrier
    buffer_load_dwordx4 v239, s[12:15], s39 offen lds
    s_add_u32 m0, m0, 1024
    s_add_u32 s39, s39, s32
    buffer_load_dwordx4 v240, s[12:15], s39 offen lds
    s_add_u32 m0, m0, 1024
    s_add_u32 s39, s39, s32
    buffer_load_dwordx4 v239, s[12:15], s39 offen lds
    s_add_u32 m0, m0, 1024
    s_add_u32 s39, s39, s32
    buffer_load_dwordx4 v240, s[12:15], s39 offen lds
    s_add_u32 m0, m0, 1024
    s_add_u32 s39, s39, s3
    buffer_load_dwordx4 v239, s[12:15], s39 offen lds
    s_add_u32 m0, m0, 1024
    s_add_u32 s39, s39, s32
    buffer_load_dwordx4 v240, s[12:15], s39 offen lds
    s_add_u32 m0, m0, 1024
    s_add_u32 s39, s39, s32
    buffer_load_dwordx4 v239, s[12:15], s39 offen lds
    s_add_u32 m0, m0, 1024
    s_add_u32 s39, s39, s32
    buffer_load_dwordx4 v240, s[12:15], s39 offen lds
    s_waitcnt vmcnt(32)
    s_barrier
    s_mov_b64 s[12:13], s[68:69]
    s_mov_b32 s14, 2097152
    s_mov_b32 s15, 0x20000
    s_and_b32 s35, s30, 1
    s_mul_i32 s38, s99, 128
    s_mul_i32 s41, s35, 65536
    s_add_u32 s38, s38, s41
    s_mul_i32 s41, s35, 4096
    s_add_u32 s41, s41, 24576
    s_mov_b32 s42, 0
    s_mov_b32 s44, s67
    s_and_b32 s36, s99, 7
    s_cmp_eq_u32 s36, 3
    s_cselect_b64 s[50:51], 0, -1
    s_mov_b32 s42, 90112
    s_mov_b32 s44, s67
    s_add_u32 s44, s44, 11
    s_and_b32 s44, s44, 15
    s_call_b64 s[76:77], SUB_w_issue_1
    s_mov_b32 s42, 98304
    s_mov_b32 s44, s67
    s_add_u32 s44, s44, 12
    s_and_b32 s44, s44, 15
    s_call_b64 s[76:77], SUB_w_issue_1
    s_waitcnt vmcnt(32)
    s_barrier
    s_mov_b32 s42, 106496
    s_mov_b32 s44, s67
    s_add_u32 s44, s44, 13
    s_and_b32 s44, s44, 15
    s_call_b64 s[76:77], SUB_w_issue_1
    s_mov_b32 s42, 114688
    s_mov_b32 s44, s67
    s_add_u32 s44, s44, 14
    s_and_b32 s44, s44, 15
    s_call_b64 s[76:77], SUB_w_issue_1
    s_waitcnt vmcnt(32)
    s_barrier
    s_mov_b32 s42, 24576
    s_mov_b32 s44, s67
    s_add_u32 s44, s44, 3
    s_and_b32 s44, s44, 15
    s_call_b64 s[76:77], SUB_w_issue_1
    s_mov_b32 s42, 32768
    s_mov_b32 s44, s67
    s_add_u32 s44, s44, 4
    s_and_b32 s44, s44, 15
    s_call_b64 s[76:77], SUB_w_issue_1
    s_waitcnt vmcnt(32)
    s_barrier
    s_mov_b32 s42, 40960
    s_mov_b32 s44, s67
    s_add_u32 s44, s44, 5
    s_and_b32 s44, s44, 15
    s_call_b64 s[76:77], SUB_w_issue_1
    s_mov_b32 s42, 49152
    s_mov_b32 s44, s67
    s_add_u32 s44, s44, 6
    s_and_b32 s44, s44, 15
    s_call_b64 s[76:77], SUB_w_issue_1
    s_mov_b32 s42, 0
    s_mov_b32 s44, s67
    s_add_u32 s44, s44, 0
    s_and_b32 s44, s44, 15
    s_call_b64 s[76:77], SUB_w_issue_1
    s_waitcnt vmcnt(36)
    s_barrier
    s_mov_b32 s42, 65536
    s_mov_b32 s44, s67
    s_add_u32 s44, s44, 8
    s_and_b32 s44, s44, 15
    s_call_b64 s[76:77], SUB_w_issue_1
    s_mov_b32 s42, 122880
    s_mov_b32 s44, s67
    s_add_u32 s44, s44, 15
    s_and_b32 s44, s44, 15
    s_call_b64 s[76:77], SUB_w_issue_1
    s_add_u32 s36, s41, 57344
    v_add_u32 v6, s36, v2
    s_barrier
    s_add_u32 s36, s41, 57344
    v_add_u32 v6, s36, v2
    ds_write_b128 v6, v[16:19] offset:16384
    ds_write_b128 v6, v[20:23] offset:17408
    ds_write_b128 v6, v[24:27] offset:18432
    ds_write_b128 v6, v[28:31] offset:19456
    ds_write_b128 v6, v[32:35] offset:24576
    ds_write_b128 v6, v[36:39] offset:25600
    ds_write_b128 v6, v[40:43] offset:26624
    ds_write_b128 v6, v[44:47] offset:27648
    ds_write_b128 v6, v[204:207] offset:0
    ds_write_b128 v6, v[208:211] offset:1024
    ds_write_b128 v6, v[212:215] offset:2048
    ds_write_b128 v6, v[216:219] offset:3072
    s_waitcnt lgkmcnt(0)
    s_branch NEXT
WL_t1:
    s_call_b64 s[76:77], PREP_w_issue_4
    s_mov_b32 m0, s19
    s_mov_b32 s39, s16
    s_mov_b32 s32, s17
    s_mov_b32 s3, s18
    s_waitcnt vmcnt(0)
    s_barrier
    s_waitcnt vmcnt(0)
    s_barrier
    s_waitcnt vmcnt(0)
    s_barrier
    s_waitcnt vmcnt(0)
    s_barrier
    s_waitcnt vmcnt(0)
    s_barrier
    buffer_load_dwordx4 v239, s[12:15], s39 offen lds
    s_add_u32 m0, m0, 1024
    s_add_u32 s39, s39, s32
    buffer_load_dwordx4 v240, s[12:15], s39 offen lds
    s_add_u32 m0, m0, 1024
    s_add_u32 s39, s39, s32
    buffer_load_dwordx4 v239, s[12:15], s39 offen lds
    s_add_u32 m0, m0, 1024
    s_add_u32 s39, s39, s32
    buffer_load_dwordx4 v240, s[12:15], s39 offen lds
    s_mov_b32 s43, 1
ld_75:
    s_mov_b32 s45, 8192
    s_add_u32 s19, s41, s42
    v_readlane_b32 s16, v249, s44
    s_nop 0
    s_bitcmp1_b32 s16, 0
    s_cselect_b32 s17, 16384, s45
    s_cselect_b32 s18, -40960, s45
    s_andn2_b32 s16, s16, 1
    s_add_u32 s16, s16, s38
    s_add_u32 s44, s44, 1
    s_add_u32 s42, s42, 16384
    s_cmp_eq_u32 s42, 98304
    s_cselect_b32 s42, 0, s42
    s_add_u32 m0, m0, 1024
    s_add_u32 s39, s39, s3
    buffer_load_dwordx4 v239, s[12:15], s39 offen lds
    s_add_u32 m0, m0, 1024
    s_add_u32 s39, s39, s32
    buffer_load_dwordx4 v240, s[12:15], s39 offen lds
    s_add_u32 m0, m0, 1024
    s_add_u32 s39, s39, s32
    buffer_load_dwordx4 v239, s[12:15], s39 offen lds
    s_add_u32 m0, m0, 1024
    s_add_u32 s39, s39, s32
    buffer_load_dwordx4 v240, s[12:15], s39 offen lds
    s_mov_b32 m0, s19
    s_mov_b32 s39, s16
    s_mov_b32 s32, s17
    s_mov_b32 s3, s18
    s_waitcnt vmcnt(8)
    s_barrier
    buffer_load_dwordx4 v239, s[12:15], s39 offen lds
    s_add_u32 m0, m0, 1024
    s_add_u32 s39, s39, s32
    buffer_load_dwordx4 v240, s[12:15], s39 offen lds
    s_add_u32 m0, m0, 1024
    s_add_u32 s39, s39, s32
    buffer_load_dwordx4 v239, s[12:15], s39 offen lds
    s_add_u32 m0, m0, 1024
    s_add_u32 s39, s39, s32
    buffer_load_dwordx4 v240, s[12:15], s39 offen lds
    s_add_u32 s43, s43, 1
    s_cmp_lt_u32 s43, 21
    s_cbranch_scc1 ld_75
    s_call_b64 s[76:77], PREP_w_issue_4
    s_add_u32 m0, m0, 1024
    s_add_u32 s39, s39, s3
    buffer_load_dwordx4 v239, s[12:15], s39 offen lds
    s_add_u32 m0, m0, 1024
    s_add_u32 s39, s39, s32
    buffer_load_dwordx4 v240, s[12:15], s39 offen lds
    s_add_u32 m0, m0, 1024
    s_add_u32 s39, s39, s32
    buffer_load_dwordx4 v239, s[12:15], s39 offen lds
    s_add_u32 m0, m0, 1024
    s_add_u32 s39, s39, s32
    buffer_load_dwordx4 v240, s[12:15], s39 offen lds
    s_mov_b32 m0, s19
    s_mov_b32 s39, s16
    s_mov_b32 s32, s17
    s_mov_b32 s3, s18
    s_waitcnt vmcnt(8)
    s_barrier
    buffer_load_dwordx4 v239, s[12:15], s39 offen lds
    s_add_u32 m0, m0, 1024
    s_add_u32 s39, s39, s32
    buffer_load_dwordx4 v240, s[12:15], s39 offen lds
    s_add_u32 m0, m0, 1024
    s_add_u32 s39, s39, s32
    buffer_load_dwordx4 v239, s[12:15], s39 offen lds
    s_add_u32 m0, m0, 1024
    s_add_u32 s39, s39, s32
    buffer_load_dwordx4 v240, s[12:15], s39 offen lds
    s_add_u32 m0, m0, 1024
    s_add_u32 s39, s39, s3
    buffer_load_dwordx4 v239, s[12:15], s39 offen lds
    s_add_u32 m0, m0, 1024
    s_add_u32 s39, s39, s32
    buffer_load_dwordx4 v240, s[12:15], s39 offen lds
    s_add_u32 m0, m0, 1024
    s_add_u32 s39, s39, s32
    buffer_load_dwordx4 v239, s[12:15], s39 offen lds
    s_add_u32 m0, m0, 1024
    s_add_u32 s39, s39, s32
    buffer_load_dwordx4 v240, s[12:15], s39 offen lds
    s_waitcnt vmcnt(8)
    s_barrier
    s_waitcnt vmcnt(0)
    s_barrier
    s_branch K_fin
NEXT:
    s_setprio 0
    s_add_u32 s60, s60, 1
    s_add_u32 s55, s55, 4194304
    s_add_u32 s62, s62, 4194304
    s_addc_u32 s63, s63, 0
    s_branch LAYER
K_fin:
    s_endpgm
dm_22m0:
    s_sleep 2
    buffer_load_dwordx4 v[180:183], v126, s[8:11], s44 offen offset:2048 sc1
    buffer_load_dwordx4 v[184:187], v127, s[8:11], s44 offen offset:2048 sc1
    buffer_load_dwordx4 v[188:191], v126, s[8:11], s44 offen offset:3072 sc1
    buffer_load_dwordx4 v[192:195], v127, s[8:11], s44 offen offset:3072 sc1
    buffer_load_dwordx4 v[196:199], v128, s[8:11], s44 offen offset:0 sc1
    buffer_load_dwordx4 v[200:203], v129, s[8:11], s44 offen offset:0 sc1
    buffer_load_dwordx4 v[204:207], v128, s[8:11], s44 offen offset:1024 sc1
    buffer_load_dwordx4 v[208:211], v129, s[8:11], s44 offen offset:1024 sc1
    buffer_load_dwordx4 v[212:215], v128, s[8:11], s44 offen offset:2048 sc1
    buffer_load_dwordx4 v[216:219], v129, s[8:11], s44 offen offset:2048 sc1
    buffer_load_dwordx4 v[220:223], v128, s[8:11], s44 offen offset:3072 sc1
    buffer_load_dwordx4 v[224:227], v129, s[8:11], s44 offen offset:3072 sc1
    s_waitcnt vmcnt(8)
    v_or3_b32 v17, v180, v184, v188
    v_bitop3_b32 v17, v17, v192, 1 bitop3:0xa8
    v_cmp_ne_u32 vcc, 0, v17
    s_add_u32 s53, s53, 1
    s_cmp_ge_u32 s53, s61
    s_cselect_b32 s61, 0, s61
    s_cbranch_scc1 dm_22n0
    s_cbranch_vccnz dm_22m0
    s_branch dm_22n0
dm_22m1:
    s_sleep 2
    buffer_load_dwordx4 v[196:199], v128, s[8:11], s44 offen offset:0 sc1
    buffer_load_dwordx4 v[200:203], v129, s[8:11], s44 offen offset:0 sc1
    buffer_load_dwordx4 v[204:207], v128, s[8:11], s44 offen offset:1024 sc1
    buffer_load_dwordx4 v[208:211], v129, s[8:11], s44 offen offset:1024 sc1
    buffer_load_dwordx4 v[212:215], v128, s[8:11], s44 offen offset:2048 sc1
    buffer_load_dwordx4 v[216:219], v129, s[8:11], s44 offen offset:2048 sc1
    buffer_load_dwordx4 v[220:223], v128, s[8:11], s44 offen offset:3072 sc1
    buffer_load_dwordx4 v[224:227], v129, s[8:11], s44 offen offset:3072 sc1
    s_waitcnt vmcnt(4)
    v_or3_b32 v17, v196, v200, v204
    v_bitop3_b32 v17, v17, v208, 1 bitop3:0xa8
    v_cmp_ne_u32 vcc, 0, v17
    s_add_u32 s53, s53, 1
    s_cmp_ge_u32 s53, s61
    s_cselect_b32 s61, 0, s61
    s_cbranch_scc1 dm_22n1
    s_cbranch_vccnz dm_22m1
    s_branch dm_22n1
dm_22m2:
    s_sleep 2
    buffer_load_dwordx4 v[212:215], v128, s[8:11], s44 offen offset:2048 sc1
    buffer_load_dwordx4 v[216:219], v129, s[8:11], s44 offen offset:2048 sc1
    buffer_load_dwordx4 v[220:223], v128, s[8:11], s44 offen offset:3072 sc1
    buffer_load_dwordx4 v[224:227], v129, s[8:11], s44 offen offset:3072 sc1
    s_waitcnt vmcnt(0)
    v_or3_b32 v17, v212, v216, v220
    v_bitop3_b32 v17, v17, v224, 1 bitop3:0xa8
    v_cmp_ne_u32 vcc, 0, v17
    s_add_u32 s53, s53, 1
    s_cmp_ge_u32 s53, s61
    s_cselect_b32 s61, 0, s61
    s_cbranch_scc1 dm_22n2
    s_cbranch_vccnz dm_22m2
    s_branch dm_22n2
dm_22f0:
    s_cselect_b32 s50, 1, 0
dm_22h0:
    s_sleep 2
    buffer_load_dwordx4 v[180:183], v126, s[8:11], s49 offen offset:2048 sc1
    buffer_load_dwordx4 v[184:187], v127, s[8:11], s49 offen offset:2048 sc1
    buffer_load_dwordx4 v[188:191], v126, s[8:11], s49 offen offset:3072 sc1
    buffer_load_dwordx4 v[192:195], v127, s[8:11], s49 offen offset:3072 sc1
    buffer_load_dwordx4 v[196:199], v128, s[8:11], s49 offen offset:0 sc1
    buffer_load_dwordx4 v[200:203], v129, s[8:11], s49 offen offset:0 sc1
    buffer_load_dwordx4 v[204:207], v128, s[8:11], s49 offen offset:1024 sc1
    buffer_load_dwordx4 v[208:211], v129, s[8:11], s49 offen offset:1024 sc1
    buffer_load_dwordx4 v[212:215], v128, s[8:11], s49 offen offset:2048 sc1
    buffer_load_dwordx4 v[216:219], v129, s[8:11], s49 offen offset:2048 sc1
    buffer_load_dwordx4 v[220:223], v128, s[8:11], s49 offen offset:3072 sc1
    buffer_load_dwordx4 v[224:227], v129, s[8:11], s49 offen offset:3072 sc1
    buffer_load_dwordx4 v[164:167], v126, s[8:11], s44 offen offset:0 sc1
    buffer_load_dwordx4 v[168:171], v127, s[8:11], s44 offen offset:0 sc1
    s_waitcnt vmcnt(10)
    v_or3_b32 v17, v180, v184, v188
    v_bitop3_b32 v17, v17, v192, 1 bitop3:0xa8
    v_cmp_ne_u32 vcc, 0, v17
    s_add_u32 s53, s53, 1
    s_cmp_ge_u32 s53, s61
    s_cselect_b32 s61, 0, s61
    s_cbranch_scc1 dm_22k0
    s_cbranch_vccnz dm_22h0
dm_22k0:
    s_cmp_eq_u32 s50, 1
    s_branch dm_22g0
dm_22f1:
    s_cselect_b32 s50, 1, 0
dm_22h1:
    s_sleep 2
    buffer_load_dwordx4 v[196:199], v128, s[8:11], s49 offen offset:0 sc1
    buffer_load_dwordx4 v[200:203], v129, s[8:11], s49 offen offset:0 sc1
    buffer_load_dwordx4 v[204:207], v128, s[8:11], s49 offen offset:1024 sc1
    buffer_load_dwordx4 v[208:211], v129, s[8:11], s49 offen offset:1024 sc1
    buffer_load_dwordx4 v[212:215], v128, s[8:11], s49 offen offset:2048 sc1
    buffer_load_dwordx4 v[216:219], v129, s[8:11], s49 offen offset:2048 sc1
    buffer_load_dwordx4 v[220:223], v128, s[8:11], s49 offen offset:3072 sc1
    buffer_load_dwordx4 v[224:227], v129, s[8:11], s49 offen offset:3072 sc1
    buffer_load_dwordx4 v[164:167], v126, s[8:11], s44 offen offset:0 sc1
    buffer_load_dwordx4 v[168:171], v127, s[8:11], s44 offen offset:0 sc1
    buffer_load_dwordx4 v[172:175], v126, s[8:11], s44 offen offset:1024 sc1
    buffer_load_dwordx4 v[176:179], v127, s[8:11], s44 offen offset:1024 sc1
    buffer_load_dwordx4 v[180:183], v126, s[8:11], s44 offen offset:2048 sc1
    buffer_load_dwordx4 v[184:187], v127, s[8:11], s44 offen offset:2048 sc1
    s_waitcnt vmcnt(10)
    v_or3_b32 v17, v196, v200, v204
    v_bitop3_b32 v17, v17, v208, 1 bitop3:0xa8
    v_cmp_ne_u32 vcc, 0, v17
    s_add_u32 s53, s53, 1
    s_cmp_ge_u32 s53, s61
    s_cselect_b32 s61, 0, s61
    s_cbranch_scc1 dm_22k1
    s_cbranch_vccnz dm_22h1
dm_22k1:
    s_cmp_eq_u32 s50, 1
    s_branch dm_22g1
dm_22f2:
    s_cselect_b32 s50, 1, 0
dm_22h2:
    s_sleep 2
    buffer_load_dwordx4 v[212:215], v128, s[8:11], s49 offen offset:2048 sc1
    buffer_load_dwordx4 v[216:219], v129, s[8:11], s49 offen offset:2048 sc1
    buffer_load_dwordx4 v[220:223], v128, s[8:11], s49 offen offset:3072 sc1
    buffer_load_dwordx4 v[224:227], v129, s[8:11], s49 offen offset:3072 sc1
    buffer_load_dwordx4 v[164:167], v126, s[8:11], s44 offen offset:0 sc1
    buffer_load_dwordx4 v[168:171], v127, s[8:11], s44 offen offset:0 sc1
    buffer_load_dwordx4 v[172:175], v126, s[8:11], s44 offen offset:1024 sc1
    buffer_load_dwordx4 v[176:179], v127, s[8:11], s44 offen offset:1024 sc1
    buffer_load_dwordx4 v[180:183], v126, s[8:11], s44 offen offset:2048 sc1
    buffer_load_dwordx4 v[184:187], v127, s[8:11], s44 offen offset:2048 sc1
    buffer_load_dwordx4 v[188:191], v126, s[8:11], s44 offen offset:3072 sc1
    buffer_load_dwordx4 v[192:195], v127, s[8:11], s44 offen offset:3072 sc1
    buffer_load_dwordx4 v[196:199], v128, s[8:11], s44 offen offset:0 sc1
    buffer_load_dwordx4 v[200:203], v129, s[8:11], s44 offen offset:0 sc1
    s_waitcnt vmcnt(10)
    v_or3_b32 v17, v212, v216, v220
    v_bitop3_b32 v17, v17, v224, 1 bitop3:0xa8
    v_cmp_ne_u32 vcc, 0, v17
    s_add_u32 s53, s53, 1
    s_cmp_ge_u32 s53, s61
    s_cselect_b32 s61, 0, s61
    s_cbranch_scc1 dm_22k2
    s_cbranch_vccnz dm_22h2
dm_22k2:
    s_cmp_eq_u32 s50, 1
    s_branch dm_22g2
dm_22f3:
    s_cselect_b32 s50, 1, 0
dm_22h3:
    s_sleep 2
    buffer_load_dwordx4 v[164:167], v126, s[8:11], s49 offen offset:0 sc1
    buffer_load_dwordx4 v[168:171], v127, s[8:11], s49 offen offset:0 sc1
    buffer_load_dwordx4 v[172:175], v126, s[8:11], s49 offen offset:1024 sc1
    buffer_load_dwordx4 v[176:179], v127, s[8:11], s49 offen offset:1024 sc1
    buffer_load_dwordx4 v[180:183], v126, s[8:11], s49 offen offset:2048 sc1
    buffer_load_dwordx4 v[184:187], v127, s[8:11], s49 offen offset:2048 sc1
    buffer_load_dwordx4 v[188:191], v126, s[8:11], s49 offen offset:3072 sc1
    buffer_load_dwordx4 v[192:195], v127, s[8:11], s49 offen offset:3072 sc1
    buffer_load_dwordx4 v[196:199], v128, s[8:11], s49 offen offset:0 sc1
    buffer_load_dwordx4 v[200:203], v129, s[8:11], s49 offen offset:0 sc1
    buffer_load_dwordx4 v[204:207], v128, s[8:11], s49 offen offset:1024 sc1
    buffer_load_dwordx4 v[208:211], v129, s[8:11], s49 offen offset:1024 sc1
    buffer_load_dwordx4 v[212:215], v128, s[8:11], s49 offen offset:2048 sc1
    buffer_load_dwordx4 v[216:219], v129, s[8:11], s49 offen offset:2048 sc1
    s_waitcnt vmcnt(10)
    v_or3_b32 v17, v164, v168, v172
    v_bitop3_b32 v17, v17, v176, 1 bitop3:0xa8
    v_cmp_ne_u32 vcc, 0, v17
    s_add_u32 s53, s53, 1
    s_cmp_ge_u32 s53, s61
    s_cselect_b32 s61, 0, s61
    s_cbranch_scc1 dm_22k3
    s_cbranch_vccnz dm_22h3
dm_22k3:
    s_cmp_eq_u32 s50, 1
    s_branch dm_22g3
dm_23m0:
    s_sleep 2
    s_mov_b32 s44, 425984
    buffer_load_dwordx4 v[180:183], v126, s[8:11], s44 offen sc1
    buffer_load_dwordx4 v[184:187], v127, s[8:11], s44 offen sc1
    s_add_u32 s44, s44, 16384
    buffer_load_dwordx4 v[188:191], v126, s[8:11], s44 offen sc1
    buffer_load_dwordx4 v[192:195], v127, s[8:11], s44 offen sc1
    s_add_u32 s44, s44, 16384
    buffer_load_dwordx4 v[196:199], v126, s[8:11], s44 offen sc1
    buffer_load_dwordx4 v[200:203], v127, s[8:11], s44 offen sc1
    s_add_u32 s44, s44, 16384
    buffer_load_dwordx4 v[204:207], v126, s[8:11], s44 offen sc1
    buffer_load_dwordx4 v[208:211], v127, s[8:11], s44 offen sc1
    s_add_u32 s44, s44, 16384
    buffer_load_dwordx4 v[212:215], v126, s[8:11], s44 offen sc1
    buffer_load_dwordx4 v[216:219], v127, s[8:11], s44 offen sc1
    s_add_u32 s44, s44, 16384
    buffer_load_dwordx4 v[220:223], v126, s[8:11], s44 offen sc1
    buffer_load_dwordx4 v[224:227], v127, s[8:11], s44 offen sc1
    s_add_u32 s44, s44, 16384
    s_waitcnt vmcnt(8)
    v_or3_b32 v17, v180, v184, v188
    v_bitop3_b32 v17, v17, v192, 1 bitop3:0xa8
    v_cmp_ne_u32 vcc, 0, v17
    s_add_u32 s53, s53, 1
    s_cmp_ge_u32 s53, s61
    s_cselect_b32 s61, 0, s61
    s_cbranch_scc1 dm_23n0
    s_cbranch_vccnz dm_23m0
    s_branch dm_23n0
dm_23m1:
    s_sleep 2
    s_mov_b32 s44, 458752
    buffer_load_dwordx4 v[196:199], v126, s[8:11], s44 offen sc1
    buffer_load_dwordx4 v[200:203], v127, s[8:11], s44 offen sc1
    s_add_u32 s44, s44, 16384
    buffer_load_dwordx4 v[204:207], v126, s[8:11], s44 offen sc1
    buffer_load_dwordx4 v[208:211], v127, s[8:11], s44 offen sc1
    s_add_u32 s44, s44, 16384
    buffer_load_dwordx4 v[212:215], v126, s[8:11], s44 offen sc1
    buffer_load_dwordx4 v[216:219], v127, s[8:11], s44 offen sc1
    s_add_u32 s44, s44, 16384
    buffer_load_dwordx4 v[220:223], v126, s[8:11], s44 offen sc1
    buffer_load_dwordx4 v[224:227], v127, s[8:11], s44 offen sc1
    s_add_u32 s44, s44, 16384
    s_waitcnt vmcnt(4)
    v_or3_b32 v17, v196, v200, v204
    v_bitop3_b32 v17, v17, v208, 1 bitop3:0xa8
    v_cmp_ne_u32 vcc, 0, v17
    s_add_u32 s53, s53, 1
    s_cmp_ge_u32 s53, s61
    s_cselect_b32 s61, 0, s61
    s_cbranch_scc1 dm_23n1
    s_cbranch_vccnz dm_23m1
    s_branch dm_23n1
dm_23m2:
    s_sleep 2
    s_mov_b32 s44, 491520
    buffer_load_dwordx4 v[212:215], v126, s[8:11], s44 offen sc1
    buffer_load_dwordx4 v[216:219], v127, s[8:11], s44 offen sc1
    s_add_u32 s44, s44, 16384
    buffer_load_dwordx4 v[220:223], v126, s[8:11], s44 offen sc1
    buffer_load_dwordx4 v[224:227], v127, s[8:11], s44 offen sc1
    s_add_u32 s44, s44, 16384
    s_waitcnt vmcnt(0)
    v_or3_b32 v17, v212, v216, v220
    v_bitop3_b32 v17, v17, v224, 1 bitop3:0xa8
    v_cmp_ne_u32 vcc, 0, v17
    s_add_u32 s53, s53, 1
    s_cmp_ge_u32 s53, s61
    s_cselect_b32 s61, 0, s61
    s_cbranch_scc1 dm_23n2
    s_cbranch_vccnz dm_23m2
    s_branch dm_23n2
dm_23f0:
    s_cselect_b32 s50, 1, 0
dm_23h0:
    s_sleep 2
    s_sub_u32 s44, s44, 114688
    buffer_load_dwordx4 v[180:183], v134, s[8:11], s44 offen sc1
    buffer_load_dwordx4 v[184:187], v135, s[8:11], s44 offen sc1
    s_add_u32 s44, s44, 16384
    buffer_load_dwordx4 v[188:191], v134, s[8:11], s44 offen sc1
    buffer_load_dwordx4 v[192:195], v135, s[8:11], s44 offen sc1
    s_add_u32 s44, s44, 16384
    buffer_load_dwordx4 v[196:199], v134, s[8:11], s44 offen sc1
    buffer_load_dwordx4 v[200:203], v135, s[8:11], s44 offen sc1
    s_add_u32 s44, s44, 16384
    buffer_load_dwordx4 v[204:207], v134, s[8:11], s44 offen sc1
    buffer_load_dwordx4 v[208:211], v135, s[8:11], s44 offen sc1
    s_add_u32 s44, s44, 16384
    buffer_load_dwordx4 v[212:215], v134, s[8:11], s44 offen sc1
    buffer_load_dwordx4 v[216:219], v135, s[8:11], s44 offen sc1
    s_add_u32 s44, s44, 16384
    buffer_load_dwordx4 v[220:223], v134, s[8:11], s44 offen sc1
    buffer_load_dwordx4 v[224:227], v135, s[8:11], s44 offen sc1
    s_add_u32 s44, s44, 16384
    buffer_load_dwordx4 v[164:167], v126, s[8:11], s44 offen sc1
    buffer_load_dwordx4 v[168:171], v127, s[8:11], s44 offen sc1
    s_add_u32 s44, s44, 16384
    s_waitcnt vmcnt(10)
    v_or3_b32 v17, v180, v184, v188
    v_bitop3_b32 v17, v17, v192, 1 bitop3:0xa8
    v_cmp_ne_u32 vcc, 0, v17
    s_add_u32 s53, s53, 1
    s_cmp_ge_u32 s53, s61
    s_cselect_b32 s61, 0, s61
    s_cbranch_scc1 dm_23k0
    s_cbranch_vccnz dm_23h0
dm_23k0:
    s_cmp_eq_u32 s50, 1
    s_branch dm_23g0
dm_23f1:
    s_cselect_b32 s50, 1, 0
dm_23h1:
    s_sleep 2
    s_sub_u32 s44, s44, 114688
    buffer_load_dwordx4 v[196:199], v134, s[8:11], s44 offen sc1
    buffer_load_dwordx4 v[200:203], v135, s[8:11], s44 offen sc1
    s_add_u32 s44, s44, 16384
    buffer_load_dwordx4 v[204:207], v134, s[8:11], s44 offen sc1
    buffer_load_dwordx4 v[208:211], v135, s[8:11], s44 offen sc1
    s_add_u32 s44, s44, 16384
    buffer_load_dwordx4 v[212:215], v134, s[8:11], s44 offen sc1
    buffer_load_dwordx4 v[216:219], v135, s[8:11], s44 offen sc1
    s_add_u32 s44, s44, 16384
    buffer_load_dwordx4 v[220:223], v134, s[8:11], s44 offen sc1
    buffer_load_dwordx4 v[224:227], v135, s[8:11], s44 offen sc1
    s_add_u32 s44, s44, 16384
    buffer_load_dwordx4 v[164:167], v126, s[8:11], s44 offen sc1
    buffer_load_dwordx4 v[168:171], v127, s[8:11], s44 offen sc1
    s_add_u32 s44, s44, 16384
    buffer_load_dwordx4 v[172:175], v126, s[8:11], s44 offen sc1
    buffer_load_dwordx4 v[176:179], v127, s[8:11], s44 offen sc1
    s_add_u32 s44, s44, 16384
    buffer_load_dwordx4 v[180:183], v126, s[8:11], s44 offen sc1
    buffer_load_dwordx4 v[184:187], v127, s[8:11], s44 offen sc1
    s_add_u32 s44, s44, 16384
    s_waitcnt vmcnt(10)
    v_or3_b32 v17, v196, v200, v204
    v_bitop3_b32 v17, v17, v208, 1 bitop3:0xa8
    v_cmp_ne_u32 vcc, 0, v17
    s_add_u32 s53, s53, 1
    s_cmp_ge_u32 s53, s61
    s_cselect_b32 s61, 0, s61
    s_cbranch_scc1 dm_23k1
    s_cbranch_vccnz dm_23h1
dm_23k1:
    s_cmp_eq_u32 s50, 1
    s_branch dm_23g1
dm_23f2:
    s_cselect_b32 s50, 1, 0
dm_23h2:
    s_sleep 2
    s_sub_u32 s44, s44, 114688
    buffer_load_dwordx4 v[212:215], v134, s[8:11], s44 offen sc1
    buffer_load_dwordx4 v[216:219], v135, s[8:11], s44 offen sc1
    s_add_u32 s44, s44, 16384
    buffer_load_dwordx4 v[220:223], v134, s[8:11], s44 offen sc1
    buffer_load_dwordx4 v[224:227], v135, s[8:11], s44 offen sc1
    s_add_u32 s44, s44, 16384
    buffer_load_dwordx4 v[164:167], v126, s[8:11], s44 offen sc1
    buffer_load_dwordx4 v[168:171], v127, s[8:11], s44 offen sc1
    s_add_u32 s44, s44, 16384
    buffer_load_dwordx4 v[172:175], v126, s[8:11], s44 offen sc1
    buffer_load_dwordx4 v[176:179], v127, s[8:11], s44 offen sc1
    s_add_u32 s44, s44, 16384
    buffer_load_dwordx4 v[180:183], v126, s[8:11], s44 offen sc1
    buffer_load_dwordx4 v[184:187], v127, s[8:11], s44 offen sc1
    s_add_u32 s44, s44, 16384
    buffer_load_dwordx4 v[188:191], v126, s[8:11], s44 offen sc1
    buffer_load_dwordx4 v[192:195], v127, s[8:11], s44 offen sc1
    s_add_u32 s44, s44, 16384
    buffer_load_dwordx4 v[196:199], v126, s[8:11], s44 offen sc1
    buffer_load_dwordx4 v[200:203], v127, s[8:11], s44 offen sc1
    s_add_u32 s44, s44, 16384
    s_waitcnt vmcnt(10)
    v_or3_b32 v17, v212, v216, v220
    v_bitop3_b32 v17, v17, v224, 1 bitop3:0xa8
    v_cmp_ne_u32 vcc, 0, v17
    s_add_u32 s53, s53, 1
    s_cmp_ge_u32 s53, s61
    s_cselect_b32 s61, 0, s61
    s_cbranch_scc1 dm_23k2
    s_cbranch_vccnz dm_23h2
dm_23k2:
    s_cmp_eq_u32 s50, 1
    s_branch dm_23g2
dm_23f3:
    s_cselect_b32 s50, 1, 0
dm_23h3:
    s_sleep 2
    s_sub_u32 s44, s44, 114688
    buffer_load_dwordx4 v[164:167], v134, s[8:11], s44 offen sc1
    buffer_load_dwordx4 v[168:171], v135, s[8:11], s44 offen sc1
    s_add_u32 s44, s44, 16384
    buffer_load_dwordx4 v[172:175], v134, s[8:11], s44 offen sc1
    buffer_load_dwordx4 v[176:179], v135, s[8:11], s44 offen sc1
    s_add_u32 s44, s44, 16384
    buffer_load_dwordx4 v[180:183], v134, s[8:11], s44 offen sc1
    buffer_load_dwordx4 v[184:187], v135, s[8:11], s44 offen sc1
    s_add_u32 s44, s44, 16384
    buffer_load_dwordx4 v[188:191], v134, s[8:11], s44 offen sc1
    buffer_load_dwordx4 v[192:195], v135, s[8:11], s44 offen sc1
    s_add_u32 s44, s44, 16384
    buffer_load_dwordx4 v[196:199], v134, s[8:11], s44 offen sc1
    buffer_load_dwordx4 v[200:203], v135, s[8:11], s44 offen sc1
    s_add_u32 s44, s44, 16384
    buffer_load_dwordx4 v[204:207], v134, s[8:11], s44 offen sc1
    buffer_load_dwordx4 v[208:211], v135, s[8:11], s44 offen sc1
    s_add_u32 s44, s44, 16384
    buffer_load_dwordx4 v[212:215], v134, s[8:11], s44 offen sc1
    buffer_load_dwordx4 v[216:219], v135, s[8:11], s44 offen sc1
    s_add_u32 s44, s44, 16384
    s_waitcnt vmcnt(10)
    v_or3_b32 v17, v164, v168, v172
    v_bitop3_b32 v17, v17, v176, 1 bitop3:0xa8
    v_cmp_ne_u32 vcc, 0, v17
    s_add_u32 s53, s53, 1
    s_cmp_ge_u32 s53, s61
    s_cselect_b32 s61, 0, s61
    s_cbranch_scc1 dm_23k3
    s_cbranch_vccnz dm_23h3
dm_23k3:
    s_cmp_eq_u32 s50, 1
    s_branch dm_23g3
SUB_w1_regs:
    s_mov_b64 s[12:13], s[68:69]
    s_mov_b32 s14, 2097152
    s_mov_b32 s15, 0x20000
    s_and_b32 s35, s30, 3
    s_mul_i32 s35, s35, 294912
    s_lshl_b32 s39, s99, 7
    s_add_u32 s39, s39, s35
    buffer_load_dwordx4 v[176:179], v238, s[12:15], s39 offen
    s_add_u32 s39, s39, 16384
    buffer_load_dwordx4 v[188:191], v238, s[12:15], s39 offen
    s_add_u32 s39, s39, 16384
    buffer_load_dwordx4 v[192:195], v238, s[12:15], s39 offen
    s_add_u32 s39, s39, 16384
    buffer_load_dwordx4 v[200:203], v238, s[12:15], s39 offen
    s_add_u32 s39, s39, 16384
    s_waitcnt vmcnt(8)
    buffer_load_dwordx4 v[204:207], v238, s[12:15], s39 offen
    s_add_u32 s39, s39, 16384
    buffer_load_dwordx4 v[208:211], v238, s[12:15], s39 offen
    s_add_u32 s39, s39, 16384
    buffer_load_dwordx4 v[212:215], v238, s[12:15], s39 offen
    s_add_u32 s39, s39, 16384
    buffer_load_dwordx4 v[216:219], v238, s[12:15], s39 offen
    s_add_u32 s39, s39, 16384
    s_waitcnt vmcnt(8)
    buffer_load_dwordx4 v[220:223], v238, s[12:15], s39 offen
    s_add_u32 s39, s39, 16384
    buffer_load_dwordx4 v[224:227], v238, s[12:15], s39 offen
    s_add_u32 s39, s39, 16384
    buffer_load_dwordx4 v[16:19], v238, s[12:15], s39 offen
    s_add_u32 s39, s39, 16384
    buffer_load_dwordx4 v[20:23], v238, s[12:15], s39 offen
    s_add_u32 s39, s39, 16384
    s_waitcnt vmcnt(8)
    buffer_load_dwordx4 v[24:27], v238, s[12:15], s39 offen
    s_add_u32 s39, s39, 16384
    buffer_load_dwordx4 v[28:31], v238, s[12:15], s39 offen
    s_add_u32 s39, s39, 16384
    buffer_load_dwordx4 v[32:35], v238, s[12:15], s39 offen
    s_add_u32 s39, s39, 16384
    buffer_load_dwordx4 v[36:39], v238, s[12:15], s39 offen
    s_add_u32 s39, s39, 16384
    s_waitcnt vmcnt(8)
    buffer_load_dwordx4 v[40:43], v238, s[12:15], s39 offen
    s_add_u32 s39, s39, 16384
    buffer_load_dwordx4 v[44:47], v238, s[12:15], s39 offen
    s_add_u32 s39, s39, 16384
    s_setpc_b64 s[76:77]
SUB_park:
    s_mov_b64 s[12:13], s[70:71]
    s_mov_b32 s14, 2097152
    s_mov_b32 s15, 0x20000
    s_and_b32 s35, s30, 3
    s_lshl_b32 s35, s35, 19
    s_lshl_b32 s39, s29, 7
    s_add_u32 s39, s39, s35
    buffer_load_dwordx4 v[48:51], v238, s[12:15], s39 offen
    s_add_u32 s39, s39, 16384
    buffer_load_dwordx4 v[52:55], v238, s[12:15], s39 offen
    s_add_u32 s39, s39, 16384
    buffer_load_dwordx4 v[56:59], v238, s[12:15], s39 offen
    s_add_u32 s39, s39, 16384
    buffer_load_dwordx4 v[60:63], v238, s[12:15], s39 offen
    s_add_u32 s39, s39, 16384
    s_waitcnt vmcnt(8)
    buffer_load_dwordx4 v[64:67], v238, s[12:15], s39 offen
    s_add_u32 s39, s39, 16384
    buffer_load_dwordx4 v[68:71], v238, s[12:15], s39 offen
    s_add_u32 s39, s39, 16384
    buffer_load_dwordx4 v[72:75], v238, s[12:15], s39 offen
    s_add_u32 s39, s39, 16384
    buffer_load_dwordx4 v[76:79], v238, s[12:15], s39 offen
    s_add_u32 s39, s39, 16384
    s_waitcnt vmcnt(8)
    buffer_load_dwordx4 v[80:83], v238, s[12:15], s39 offen
    s_add_u32 s39, s39, 16384
    buffer_load_dwordx4 v[84:87], v238, s[12:15], s39 offen
    s_add_u32 s39, s39, 16384
    buffer_load_dwordx4 v[88:91], v238, s[12:15], s39 offen
    s_add_u32 s39, s39, 16384
    buffer_load_dwordx4 v[92:95], v238, s[12:15], s39 offen
    s_add_u32 s39, s39, 16384
    s_waitcnt vmcnt(8)
    buffer_load_dwordx4 v[96:99], v238, s[12:15], s39 offen
    s_add_u32 s39, s39, 16384
    buffer_load_dwordx4 v[100:103], v238, s[12:15], s39 offen
    s_add_u32 s39, s39, 16384
    buffer_load_dwordx4 v[104:107], v238, s[12:15], s39 offen
    s_add_u32 s39, s39, 16384
    buffer_load_dwordx4 v[108:111], v238, s[12:15], s39 offen
    s_add_u32 s39, s39, 16384
    s_waitcnt vmcnt(8)
    buffer_load_dwordx4 v[112:115], v238, s[12:15], s39 offen
    s_add_u32 s39, s39, 16384
    buffer_load_dwordx4 v[116:119], v238, s[12:15], s39 offen
    s_add_u32 s39, s39, 16384
    buffer_load_dwordx4 v[120:123], v238, s[12:15], s39 offen
    s_add_u32 s39, s39, 16384
    buffer_load_dwordx4 v[124:127], v238, s[12:15], s39 offen
    s_add_u32 s39, s39, 16384
    s_waitcnt vmcnt(8)
    buffer_load_dwordx4 v[128:131], v238, s[12:15], s39 offen
    s_add_u32 s39, s39, 16384
    buffer_load_dwordx4 v[132:135], v238, s[12:15], s39 offen
    s_add_u32 s39, s39, 16384
    buffer_load_dwordx4 v[136:139], v238, s[12:15], s39 offen
    s_add_u32 s39, s39, 16384
    buffer_load_dwordx4 v[140:143], v238, s[12:15], s39 offen
    s_add_u32 s39, s39, 16384
    s_waitcnt vmcnt(8)
    s_setpc_b64 s[76:77]
SUB_park2:
    s_mov_b64 s[12:13], s[70:71]
    s_mov_b32 s14, 2097152
    s_mov_b32 s15, 0x20000
    s_and_b32 s35, s30, 3
    s_lshl_b32 s35, s35, 19
    s_lshl_b32 s39, s29, 7
    s_add_u32 s39, s39, s35
    s_add_u32 s39, s39, 393216
    buffer_load_dwordx4 v[144:147], v238, s[12:15], s39 offen
    s_add_u32 s39, s39, 16384
    buffer_load_dwordx4 v[148:151], v238, s[12:15], s39 offen
    s_add_u32 s39, s39, 16384
    buffer_load_dwordx4 v[152:155], v238, s[12:15], s39 offen
    s_add_u32 s39, s39, 16384
    buffer_load_dwordx4 v[156:159], v238, s[12:15], s39 offen
    s_add_u32 s39, s39, 16384
    s_waitcnt vmcnt(8)
    buffer_load_dwordx4 v[160:163], v238, s[12:15], s39 offen
    s_add_u32 s39, s39, 16384
    buffer_load_dwordx4 v[164:167], v238, s[12:15], s39 offen
    s_add_u32 s39, s39, 16384
    buffer_load_dwordx4 v[168:171], v238, s[12:15], s39 offen
    s_add_u32 s39, s39, 16384
    buffer_load_dwordx4 v[172:175], v238, s[12:15], s39 offen
    s_add_u32 s39, s39, 16384
    s_waitcnt vmcnt(8)
    s_setpc_b64 s[76:77]
SUB_w1_put:
    s_and_b32 s35, s30, 3
    s_mul_i32 s35, s35, 18432
    v_add_u32 v8, s35, v2
    v_mov_b32 v6, 162836
spin_76:
    s_sleep 2
    ds_read_b32 v7, v6
    s_waitcnt lgkmcnt(0)
    v_readfirstlane_b32 s53, v7
    s_nop 0
    s_cmp_ge_u32 s53, 8
    s_cbranch_scc0 spin_76
    s_waitcnt vmcnt(24)
    ds_write_b128 v8, v[176:179] offset:24576
    ds_write_b128 v8, v[188:191] offset:25600
    ds_write_b128 v8, v[192:195] offset:26624
    ds_write_b128 v8, v[200:203] offset:27648
    ds_write_b128 v8, v[204:207] offset:28672
    ds_write_b128 v8, v[208:211] offset:29696
    ds_write_b128 v8, v[212:215] offset:30720
    ds_write_b128 v8, v[216:219] offset:31744
    ds_write_b128 v8, v[220:223] offset:32768
    ds_write_b128 v8, v[224:227] offset:33792
    ds_write_b128 v8, v[16:19] offset:34816
    ds_write_b128 v8, v[20:23] offset:35840
    ds_write_b128 v8, v[24:27] offset:36864
    ds_write_b128 v8, v[28:31] offset:37888
    ds_write_b128 v8, v[32:35] offset:38912
    ds_write_b128 v8, v[36:39] offset:39936
    ds_write_b128 v8, v[40:43] offset:40960
    ds_write_b128 v8, v[44:47] offset:41984
    s_waitcnt lgkmcnt(0)
    s_setpc_b64 s[76:77]
SUB_before_d1:
    s_mov_b64 s[12:13], s[72:73]
    s_mov_b32 s14, 7340032
    s_mov_b32 s15, 0x20000
    v_readlane_b32 s36, v251, 0
    v_readlane_b32 s37, v251, 1
    v_readlane_b32 s34, v251, 2
    s_and_b32 s35, s30, 3
    s_mul_i32 s38, s35, 114688
    s_mul_i32 s39, s29, 448
    s_add_u32 s38, s38, s39
    s_and_b32 s36, s36, 15
    s_mul_i32 s36, s36, 458752
    s_add_u32 s36, s36, s38
    s_and_b32 s37, s37, 15
    s_mul_i32 s37, s37, 458752
    s_add_u32 s37, s37, s38
    s_and_b32 s34, s34, 15
    s_mul_i32 s34, s34, 458752
    s_add_u32 s34, s34, s38
    s_lshl_b32 s54, s60, 2
    s_add_u32 s54, s54, 4
    v_mov_b32 v8, 162896
spin_77:
    s_sleep 2
    ds_read_b32 v9, v8
    s_waitcnt lgkmcnt(0)
    v_readfirstlane_b32 s53, v9
    s_nop 0
    s_cmp_ge_u32 s53, s54
    s_cbranch_scc0 spin_77
    buffer_load_dwordx4 v[176:179], v241, s[12:15], s37 offen
    buffer_load_dwordx4 v[180:183], v242, s[12:15], s37 offen
    buffer_load_dwordx4 v[184:187], v243, s[12:15], s37 offen
    buffer_load_dwordx4 v[188:191], v244, s[12:15], s37 offen
    buffer_load_dwordx4 v[192:195], v245, s[12:15], s37 offen
    buffer_load_dwordx4 v[196:199], v246, s[12:15], s37 offen
    buffer_load_dwordx4 v[200:203], v247, s[12:15], s37 offen
    s_setpc_b64 s[76:77]
SUB_after_g1:
    s_mov_b64 s[12:13], s[72:73]
    s_mov_b32 s14, 7340032
    s_mov_b32 s15, 0x20000
    v_readlane_b32 s36, v251, 0
    v_readlane_b32 s37, v251, 1
    v_readlane_b32 s34, v251, 2
    s_and_b32 s35, s30, 3
    s_mul_i32 s38, s35, 114688
    s_mul_i32 s39, s29, 448
    s_add_u32 s38, s38, s39
    s_and_b32 s36, s36, 15
    s_mul_i32 s36, s36, 458752
    s_add_u32 s36, s36, s38
    s_and_b32 s37, s37, 15
    s_mul_i32 s37, s37, 458752
    s_add_u32 s37, s37, s38
    s_and_b32 s34, s34, 15
    s_mul_i32 s34, s34, 458752
    s_add_u32 s34, s34, s38
    s_mul_i32 s39, s35, 7168
    s_add_u32 m0, s39, 131072
    s_nop 0
    buffer_load_dwordx4 v241, s[12:15], s36 offen lds
    s_add_u32 m0, m0, 1024
    s_nop 0
    buffer_load_dwordx4 v242, s[12:15], s36 offen lds
    s_add_u32 m0, m0, 1024
    s_nop 0
    buffer_load_dwordx4 v243, s[12:15], s36 offen lds
    s_add_u32 m0, m0, 1024
    s_nop 0
    buffer_load_dwordx4 v244, s[12:15], s36 offen lds
    s_add_u32 m0, m0, 1024
    s_nop 0
    buffer_load_dwordx4 v245, s[12:15], s36 offen lds
    s_add_u32 m0, m0, 1024
    s_nop 0
    buffer_load_dwordx4 v246, s[12:15], s36 offen lds
    s_add_u32 m0, m0, 1024
    s_nop 0
    buffer_load_dwordx4 v247, s[12:15], s36 offen lds
    s_lshr_b32 s36, s67, 2
    s_sub_u32 s36, s35, s36
    s_and_b32 s36, s36, 3
    s_lshl_b32 s36, s36, 15
    v_add_u32 v6, s36, v2
    s_waitcnt vmcnt(14)
    ds_write_b128 v6, v[48:51] offset:0
    ds_write_b128 v6, v[52:55] offset:1024
    ds_write_b128 v6, v[56:59] offset:2048
    ds_write_b128 v6, v[60:63] offset:3072
    ds_write_b128 v6, v[64:67] offset:4096
    ds_write_b128 v6, v[68:71] offset:5120
    ds_write_b128 v6, v[72:75] offset:6144
    ds_write_b128 v6, v[76:79] offset:7168
    ds_write_b128 v6, v[80:83] offset:8192
    ds_write_b128 v6, v[84:87] offset:9216
    ds_write_b128 v6, v[88:91] offset:10240
    ds_write_b128 v6, v[92:95] offset:11264
    ds_write_b128 v6, v[96:99] offset:12288
    ds_write_b128 v6, v[100:103] offset:13312
    ds_write_b128 v6, v[104:107] offset:14336
    ds_write_b128 v6, v[108:111] offset:15360
    ds_write_b128 v6, v[112:115] offset:16384
    ds_write_b128 v6, v[116:119] offset:17408
    ds_write_b128 v6, v[120:123] offset:18432
    ds_write_b128 v6, v[124:127] offset:19456
    ds_write_b128 v6, v[128:131] offset:20480
    ds_write_b128 v6, v[132:135] offset:21504
    ds_write_b128 v6, v[136:139] offset:22528
    ds_write_b128 v6, v[140:143] offset:23552
    ds_write_b128 v6, v[144:147] offset:24576
    ds_write_b128 v6, v[148:151] offset:25600
    ds_write_b128 v6, v[152:155] offset:26624
    ds_write_b128 v6, v[156:159] offset:27648
    ds_write_b128 v6, v[160:163] offset:28672
    ds_write_b128 v6, v[164:167] offset:29696
    ds_write_b128 v6, v[168:171] offset:30720
    ds_write_b128 v6, v[172:175] offset:31744
    s_waitcnt lgkmcnt(0)
    s_setpc_b64 s[76:77]
SUB_after_g2:
    s_and_b32 s35, s30, 3
    s_mul_i32 s39, s35, 7168
    s_add_u32 s39, s39, 73728
    v_add_u32 v7, s39, v2
    ds_write_b128 v7, v[176:179] offset:0
    ds_write_b128 v7, v[180:183] offset:1024
    ds_write_b128 v7, v[184:187] offset:2048
    ds_write_b128 v7, v[188:191] offset:3072
    ds_write_b128 v7, v[192:195] offset:4096
    ds_write_b128 v7, v[196:199] offset:5120
    ds_write_b128 v7, v[200:203] offset:6144
    s_waitcnt vmcnt(0) lgkmcnt(0)
    s_setpc_b64 s[76:77]
SUB_r_pre:
    v_and_b32 v199, 7, v0
    v_lshrrev_b32 v228, 6, v0
    v_lshlrev_b32 v228, 4, v228
    v_bfe_u32 v229, v0, 3, 3
    v_add_u32 v228, v228, v229
    s_lshr_b32 s78, s29, 1
    s_lshl_b32 s78, s78, 16
    s_and_b32 s79, s29, 1
    s_lshl_b32 s79, s79, 7
    s_add_u32 s78, s78, s79
    s_lshr_b32 s79, s30, 1
    s_lshl_b32 s79, s79, 13
    s_add_u32 s78, s78, s79
    v_lshlrev_b32 v196, 8, v228
    v_lshl_add_u32 v196, v199, 4, v196
    v_add_u32 v196, s78, v196
    s_mov_b32 s84, s62
    s_mov_b32 s85, s63
    s_mov_b32 s86, 0x7e000
    s_mov_b32 s87, 0x20000
    s_add_u32 s88, s62, 0x80000
    s_addc_u32 s89, s63, 0
    s_mov_b32 s90, 0x7e000
    s_mov_b32 s91, 0x20000
    buffer_load_dwordx4 v[180:183], v196, s[84:87], 0 offen offset:0 sc1
    buffer_load_dwordx4 v[188:191], v196, s[88:91], 0 offen offset:0 sc1
    buffer_load_dwordx4 v[184:187], v196, s[84:87], 0 offen offset:2048 sc1
    buffer_load_dwordx4 v[192:195], v196, s[88:91], 0 offen offset:2048 sc1
    s_setpc_b64 s[76:77]
SUB_w_issue_1:
    s_add_u32 s19, s41, s42
    s_mul_i32 s16, s44, 131072
    s_add_u32 s16, s16, s38
    s_add_u32 s44, s44, 1
    s_and_b32 s44, s44, 15
    s_add_u32 s42, s42, 8192
    s_cmp_eq_u32 s42, 131072
    s_cselect_b32 s42, 0, s42
    s_mov_b32 m0, s19
    s_mov_b32 s39, s16
    buffer_load_dwordx4 v238, s[12:15], s39 offen lds
    s_add_u32 m0, m0, 1024
    s_add_u32 s39, s39, 16384
    buffer_load_dwordx4 v238, s[12:15], s39 offen lds
    s_add_u32 m0, m0, 1024
    s_add_u32 s39, s39, 16384
    buffer_load_dwordx4 v238, s[12:15], s39 offen lds
    s_add_u32 m0, m0, 1024
    s_add_u32 s39, s39, 16384
    buffer_load_dwordx4 v238, s[12:15], s39 offen lds
    s_setpc_b64 s[76:77]
PREP_a_issue_4:
    s_add_u32 s19, s41, s42
    v_readlane_b32 s16, v249, s44
    v_readlane_b32 s17, v250, s44
    s_add_u32 s16, s16, s38
    s_add_u32 s17, s17, s38
    s_add_u32 s44, s44, 1
    s_add_u32 s42, s42, 16384
    s_cmp_eq_u32 s42, 49152
    s_cselect_b32 s42, 0, s42
    s_setpc_b64 s[76:77]
PREP_w_issue_4:
    s_mov_b32 s45, 8192
    s_add_u32 s19, s41, s42
    v_readlane_b32 s16, v249, s44
    s_nop 0
    s_bitcmp1_b32 s16, 0
    s_cselect_b32 s17, 16384, s45
    s_cselect_b32 s18, -40960, s45
    s_andn2_b32 s16, s16, 1
    s_add_u32 s16, s16, s38
    s_add_u32 s44, s44, 1
    s_add_u32 s42, s42, 16384
    s_cmp_eq_u32 s42, 98304
    s_cselect_b32 s42, 0, s42
    s_setpc_b64 s[76:77]
K_end:
    s_endpgm
.p2align 6
K_tab:
.short 4096,5137,6178,11379,18660,25941,40502,33223,47784,55065,19706,12427,26988,34269,48830,41551,56096,9264,20736,10448,23824,25008,38384,35296,39568,49856,54128,52944,0,0,0,0
.short 4096,5137,6178,18659,11380,25941,33222,47783,40504,55065,12426,26987,19708,34269,41550,56111,48816,9264,10448,23824,20736,25008,35296,39568,38384,49856,52944,54128,0,0,0,0
.short 4096,5137,6178,11379,25940,18661,33222,40503,55064,47785,12426,19707,34268,26989,41550,48831,9264,56096,10448,20736,25008,23824,35296,38384,49856,39568,52944,54128,0,0,0,0
.short 4096,5137,6178,11379,18660,33221,25942,40503,47784,12425,55066,19707,26988,41549,34270,48831,56096,10448,9264,20736,23824,35296,25008,38384,39568,52944,49856,54128,0,0,0,0
.short 11377,12418,13459,18660,4101,25942,33223,47784,40505,55066,5147,26988,19709,34270,41551,56096,48816,6176,10288,23824,20736,25008,35296,39568,38384,49856,52944,54128,0,0,0,0
.short 11377,12418,13459,4100,25941,18662,33223,40504,55065,47786,5147,19708,34269,26990,41551,48816,6176,56096,10288,20736,25008,23824,35296,38384,49856,39568,52944,54128,0,0,0,0
.short 11377,12418,13459,4100,18661,33222,25943,40504,47785,5146,55067,19708,26989,41550,34271,48816,56096,10288,6176,20736,23824,35296,25008,38384,39568,52944,49856,54128,0,0,0,0
.short 11377,12418,13459,4100,18661,25942,40503,33224,47785,55066,19707,5148,26989,34270,48831,41536,56096,6176,20736,10288,23824,25008,38384,35296,39568,49856,54128,52944,0,0,0,0
.short 18658,19699,20740,4101,25942,11383,33224,40505,55066,47787,5148,12429,34270,26991,41536,48817,6176,56096,9264,10448,25008,23824,35296,38384,49856,39568,52944,54128,0,0,0,0
.short 18658,19699,20740,4101,11382,33223,25944,40505,47786,5147,55068,12429,26990,41551,34256,48817,56096,9264,6176,10448,23824,35296,25008,38384,39568,52944,49856,54128,0,0,0,0
.short 18658,19699,20740,4101,11382,25943,40504,33225,47786,55067,12428,5149,26990,34271,48816,41537,56096,6176,10448,9264,23824,25008,38384,35296,39568,49856,54128,52944,0,0,0,0
.short 18658,19699,20740,11381,4102,25943,33224,47785,40506,55067,5148,26989,12430,34271,41536,56097,48816,6176,9264,23824,10448,25008,35296,39568,38384,49856,52944,54128,0,0,0,0
.short 25939,26980,28021,4102,11383,33224,18665,40506,47787,5148,55069,12430,19711,41536,34257,48818,56096,9264,6176,10448,20736,35296,24848,38384,39568,52944,49856,54128,0,0,0,0
.short 25939,26980,28021,4102,11383,18664,40505,33226,47787,55068,12429,5150,19711,34256,48817,41538,56096,6176,10448,9264,20736,24848,38384,35296,39568,49856,54128,52944,0,0,0,0
.short 25939,26980,28021,11382,4103,18664,33225,47786,40507,55068,5149,19710,12431,34256,41537,56098,48816,6176,9264,20736,10448,24848,35296,39568,38384,49856,52944,54128,0,0,0,0
.short 25939,26980,28021,4102,18663,11384,33225,40506,55067,47788,5149,12430,34271,19696,41537,48818,6176,56096,9264,10448,24848,20736,35296,38384,49856,39568,52944,54128,0,0,0,0
.short 33220,34261,35302,4103,11384,18665,40506,25947,47788,55069,12430,5151,19696,26977,48818,41539,56096,6176,10448,9264,20736,23824,38384,25008,39568,49856,54128,52944,0,0,0,0
.short 33220,34261,35302,11383,4104,18665,25946,47787,40508,55069,5150,19711,12416,26977,41538,56099,48816,6176,9264,20736,10448,23824,25008,39568,38384,49856,52944,54128,0,0,0,0
.short 33220,34261,35302,4103,18664,11385,25946,40507,55068,47789,5150,12431,26976,19697,41538,48819,6176,56096,9264,10448,23824,20736,25008,38384,49856,39568,52944,54128,0,0,0,0
.short 33220,34261,35302,4103,11384,25945,18666,40507,47788,5149,55070,12431,19696,41537,26978,48819,56096,9264,6176,10448,20736,25008,23824,38384,39568,52944,49856,54128,0,0,0,0
.short 40501,41542,42583,11384,4105,18666,25947,47788,33229,55070,5151,19696,12417,26978,34259,56100,48816,6176,9264,20736,10448,23824,25008,39408,35296,49856,52944,54128,0,0,0,0
.short 40501,41542,42583,4104,18665,11386,25947,33228,55069,47790,5151,12416,26977,19698,34259,48820,6176,56096,9264,10448,23824,20736,25008,35296,49856,39408,52944,54128,0,0,0,0
.short 40501,41542,42583,4104,11385,25946,18667,33228,47789,5150,55071,12416,19697,34258,26979,48820,56096,9264,6176,10448,20736,25008,23824,35296,39408,52944,49856,54128,0,0,0,0
.short 40501,41542,42583,4104,11385,18666,33227,25948,47789,55070,12431,5136,19697,26978,48819,34260,56096,6176,10448,9264,20736,23824,35296,25008,39408,49856,54128,52944,0,0,0,0
.short 47782,48823,49864,4105,18666,11387,25948,33229,55070,40511,5136,12417,26978,19699,34260,41541,6176,56096,9264,10448,23824,20736,25008,35296,39568,38384,52944,54128,0,0,0,0
.short 47782,48823,49864,4105,11386,25947,18668,33229,40510,5151,55056,12417,19698,34259,26980,41541,56096,9264,6176,10448,20736,25008,23824,35296,38384,52944,39568,54128,0,0,0,0
.short 47782,48823,49864,4105,11386,18667,33228,25949,40510,55071,12416,5137,19698,26979,41540,34261,56096,6176,10448,9264,20736,23824,35296,25008,38384,39568,54128,52944,0,0,0,0
.short 47782,48823,49864,11385,4106,18667,25948,40509,33230,55071,5136,19697,12418,26979,34260,56101,41536,6176,9264,20736,10448,23824,25008,38384,35296,39568,52944,54128,0,0,0,0
.short 55063,56104,57145,4106,11387,25948,18669,33230,40511,5136,47777,12418,19699,34260,26981,41542,48816,9264,6176,10448,20736,25008,23824,35296,38384,49856,39568,53968,0,0,0,0
.short 55063,56104,57145,4106,11387,18668,33229,25950,40511,47776,12417,5138,19699,26980,41541,34262,48816,6176,10448,9264,20736,23824,35296,25008,38384,39568,53968,49856,0,0,0,0
.short 55063,56104,57145,11386,4107,18668,25949,40510,33231,47776,5137,19698,12419,26980,34261,48822,41536,6176,9264,20736,10448,23824,25008,38384,35296,39568,49856,53968,0,0,0,0
.short 55063,56104,57145,4106,18667,11388,25949,33230,47791,40496,5137,12418,26979,19700,34261,41542,6176,48816,9264,10448,23824,20736,25008,35296,39568,38384,49856,53968,0,0,0,0
.short 4104,5145,6186,11387,18668,25949,40510,33231,47776,55057,19698,12419,26980,34261,48822,41543,56096,9264,20736,10448,23824,25008,38384,35296,39568,49856,54128,52944,0,0,0,0
.short 4104,5145,6186,18667,11388,25949,33230,47791,40496,55057,12418,26979,19700,34261,41542,56103,48816,9264,10448,23824,20736,25008,35296,39568,38384,49856,52944,54128,0,0,0,0
.short 4104,5145,6186,11387,25948,18669,33230,40511,55056,47777,12418,19699,34260,26981,41542,48823,9264,56096,10448,20736,25008,23824,35296,38384,49856,39568,52944,54128,0,0,0,0
.short 4104,5145,6186,11387,18668,33229,25950,40511,47776,12417,55058,19699,26980,41541,34262,48823,56096,10448,9264,20736,23824,35296,25008,38384,39568,52944,49856,54128,0,0,0,0
.short 11385,12426,13467,18668,4109,25950,33231,47776,40497,55058,5139,26980,19701,34262,41543,56104,48816,6176,10288,23824,20736,25008,35296,39568,38384,49856,52944,54128,0,0,0,0
.short 11385,12426,13467,4108,25949,18670,33231,40496,55057,47778,5139,19700,34261,26982,41543,48824,6176,56096,10288,20736,25008,23824,35296,38384,49856,39568,52944,54128,0,0,0,0
.short 11385,12426,13467,4108,18669,33230,25951,40496,47777,5138,55059,19700,26981,41542,34263,48824,56096,10288,6176,20736,23824,35296,25008,38384,39568,52944,49856,54128,0,0,0,0
.short 11385,12426,13467,4108,18669,25950,40511,33216,47777,55058,19699,5140,26981,34262,48823,41544,56096,6176,20736,10288,23824,25008,38384,35296,39568,49856,54128,52944,0,0,0,0
.short 18666,19707,20748,4109,25950,11391,33216,40497,55058,47779,5140,12421,34262,26983,41544,48825,6176,56096,9264,10448,25008,23824,35296,38384,49856,39568,52944,54128,0,0,0,0
.short 18666,19707,20748,4109,11390,33231,25936,40497,47778,5139,55060,12421,26982,41543,34264,48825,56096,9264,6176,10448,23824,35296,25008,38384,39568,52944,49856,54128,0,0,0,0
.short 18666,19707,20748,4109,11390,25951,40496,33217,47778,55059,12420,5141,26982,34263,48824,41545,56096,6176,10448,9264,23824,25008,38384,35296,39568,49856,54128,52944,0,0,0,0
.short 18666,19707,20748,11389,4110,25951,33216,47777,40498,55059,5140,26981,12422,34263,41544,56105,48816,6176,9264,23824,10448,25008,35296,39568,38384,49856,52944,54128,0,0,0,0
.short 25947,26988,28029,4110,11391,33216,18657,40498,47779,5140,55061,12422,19703,41544,34265,48826,56096,9264,6176,10448,20736,35296,24848,38384,39568,52944,49856,54128,0,0,0,0
.short 25947,26988,28029,4110,11391,18656,40497,33218,47779,55060,12421,5142,19703,34264,48825,41546,56096,6176,10448,9264,20736,24848,38384,35296,39568,49856,54128,52944,0,0,0,0
.short 25947,26988,28029,11390,4111,18656,33217,47778,40499,55060,5141,19702,12423,34264,41545,56106,48816,6176,9264,20736,10448,24848,35296,39568,38384,49856,52944,54128,0,0,0,0
.short 25947,26988,28029,4110,18671,11376,33217,40498,55059,47780,5141,12422,34263,19704,41545,48826,6176,56096,9264,10448,24848,20736,35296,38384,49856,39568,52944,54128,0,0,0,0
.short 33228,34269,35310,4111,11376,18657,40498,25939,47780,55061,12422,5143,19704,26985,48826,41547,56096,6176,10448,9264,20736,23824,38384,25008,39568,49856,54128,52944,0,0,0,0
.short 33228,34269,35310,11391,4096,18657,25938,47779,40500,55061,5142,19703,12424,26985,41546,56107,48816,6176,9264,20736,10448,23824,25008,39568,38384,49856,52944,54128,0,0,0,0
.short 33228,34269,35310,4111,18656,11377,25938,40499,55060,47781,5142,12423,26984,19705,41546,48827,6176,56096,9264,10448,23824,20736,25008,38384,49856,39568,52944,54128,0,0,0,0
.short 33228,34269,35310,4111,11376,25937,18658,40499,47780,5141,55062,12423,19704,41545,26986,48827,56096,9264,6176,10448,20736,25008,23824,38384,39568,52944,49856,54128,0,0,0,0
.short 40509,41550,42591,11376,4097,18658,25939,47780,33221,55062,5143,19704,12425,26986,34267,56108,48816,6176,9264,20736,10448,23824,25008,39408,35296,49856,52944,54128,0,0,0,0
.short 40509,41550,42591,4096,18657,11378,25939,33220,55061,47782,5143,12424,26985,19706,34267,48828,6176,56096,9264,10448,23824,20736,25008,35296,49856,39408,52944,54128,0,0,0,0
.short 40509,41550,42591,4096,11377,25938,18659,33220,47781,5142,55063,12424,19705,34266,26987,48828,56096,9264,6176,10448,20736,25008,23824,35296,39408,52944,49856,54128,0,0,0,0
.short 40509,41550,42591,4096,11377,18658,33219,25940,47781,55062,12423,5144,19705,26986,48827,34268,56096,6176,10448,9264,20736,23824,35296,25008,39408,49856,54128,52944,0,0,0,0
.short 47790,48831,49856,4097,18658,11379,25940,33221,55062,40503,5144,12425,26986,19707,34268,41549,6176,56096,9264,10448,23824,20736,25008,35296,39568,38384,52944,54128,0,0,0,0
.short 47790,48831,49856,4097,11378,25939,18660,33221,40502,5143,55064,12425,19706,34267,26988,41549,56096,9264,6176,10448,20736,25008,23824,35296,38384,52944,39568,54128,0,0,0,0
.short 47790,48831,49856,4097,11378,18659,33220,25941,40502,55063,12424,5145,19706,26987,41548,34269,56096,6176,10448,9264,20736,23824,35296,25008,38384,39568,54128,52944,0,0,0,0
.short 47790,48831,49856,11377,4098,18659,25940,40501,33222,55063,5144,19705,12426,26987,34268,56109,41536,6176,9264,20736,10448,23824,25008,38384,35296,39568,52944,54128,0,0,0,0
.short 55071,56096,57137,4098,11379,25940,18661,33222,40503,5144,47785,12426,19707,34268,26989,41550,48816,9264,6176,10448,20736,25008,23824,35296,38384,49856,39568,53968,0,0,0,0
.short 55071,56096,57137,4098,11379,18660,33221,25942,40503,47784,12425,5146,19707,26988,41549,34270,48816,6176,10448,9264,20736,23824,35296,25008,38384,39568,53968,49856,0,0,0,0
.short 55071,56096,57137,11378,4099,18660,25941,40502,33223,47784,5145,19706,12427,26988,34269,48830,41536,6176,9264,20736,10448,23824,25008,38384,35296,39568,49856,53968,0,0,0,0
.short 55071,56096,57137,4098,18659,11380,25941,33222,47783,40504,5145,12426,26987,19708,34269,41550,6176,48816,9264,10448,23824,20736,25008,35296,39568,38384,49856,53968,0,0,0,0
.section .rodata,"a"
.p2align 6
.amdhsa_kernel interleave_layers__ssm_conv_h3__mixer_s_mlp__prompt_kernel
  .amdhsa_next_free_vgpr 256
  .amdhsa_next_free_sgpr 102
  .amdhsa_accum_offset 256
  .amdhsa_group_segment_fixed_size 0
  .amdhsa_kernarg_size 112
  .amdhsa_user_sgpr_count 2
  .amdhsa_user_sgpr_kernarg_segment_ptr 1
  .amdhsa_system_sgpr_workgroup_id_x 1
  .amdhsa_float_denorm_mode_32 3
.end_amdhsa_kernel
```
